```python
import torch

def _softmax(x, axis=-1):
    return torch.softmax(x, dim=axis)

def _gelu(x):
    return torch.nn.functional.gelu(x, approximate='tanh')

def _silu(x):
    return torch.nn.functional.silu(x)

def _sigmoid(x):
    return torch.sigmoid(x)

def _layernorm(x, axis=-1, eps=1e-05):
    m = x.mean(dim=axis, keepdim=True)
    v = x.var(dim=axis, keepdim=True, unbiased=False)
    return (x - m) / torch.sqrt(v + eps)

def _scatter_add(tgt, idx, src, axis=0):
    return tgt.clone().index_add_(axis, idx, src)

def _segment_sum(src, seg, n):
    out = torch.zeros((n,) + src.shape[1:], dtype=src.dtype)
    return out.index_add_(0, seg, src)

def _pad(x, pw):
    flat = tuple((v for pair in reversed(pw) for v in pair))
    return torch.nn.functional.pad(x, flat)
kernel_name = 'interleave_layers__memory_aug_recurrent_mem_tr__softmax_full_mha__prompt'

def setup_inputs():

    _w = lambda a: (lambda t: t.to(torch.bfloat16) if t.is_floating_point() else t)(torch.as_tensor(a))

    def _A_setup():
        B, S, Dm = (1, 2048, 640)
        H, Dh = (32, 192)
        M, seg = (8, 32)
        seg = min(seg, S)
        S = S // seg * seg
        return {'x': _w((lambda *s: torch.randn(*s, dtype=torch.bfloat16) * 0.05)(B, S, Dm)), 'mem0': _w((lambda *s: torch.randn(*s, dtype=torch.bfloat16) * 0.8)(B, M, Dm)), 'Wq': _w((lambda *s: torch.randn(*s, dtype=torch.bfloat16) * 0.8)(Dm, H, Dh) * Dm ** (-0.5)), 'Wk': _w((lambda *s: torch.randn(*s, dtype=torch.bfloat16) * 0.8)(Dm, H, Dh) * Dm ** (-0.5)), 'Wv': _w((lambda *s: torch.randn(*s, dtype=torch.bfloat16) * 0.8)(Dm, H, Dh) * Dm ** (-0.5)), 'Wo': _w((lambda *s: torch.randn(*s, dtype=torch.bfloat16) * 0.8)(H, Dh, Dm) * (H * Dh) ** (-0.5)), 'seg_len': seg}
    _A_in = _A_setup()

    def _B_setup():
        B, S, D = (1, 2048, 640)
        return {'x': _w((lambda *s: torch.randn(*s, dtype=torch.bfloat16) * 0.05)(B, S, D)), 'wqkv': _w((lambda *s: torch.randn(*s, dtype=torch.bfloat16) * 0.05)(D, 3 * D)), 'wo': _w((lambda *s: torch.randn(*s, dtype=torch.bfloat16) * 0.05)(D, D))}
    _B_in = _B_setup()
    return {'A_x': _A_in['x'], 'A_mem0': _A_in['mem0'], 'A_Wq': _A_in['Wq'], 'A_Wk': _A_in['Wk'], 'A_Wv': _A_in['Wv'], 'A_Wo': _A_in['Wo'], 'A_seg_len': _A_in['seg_len'], 'B_x': _B_in['x'], 'B_wqkv': _B_in['wqkv'], 'B_wo': _B_in['wo']}

def reference(A_x, A_mem0, A_Wq, A_Wk, A_Wv, A_Wo, A_seg_len, B_x, B_wqkv, B_wo):

    def _A_ref(x, mem0, Wq, Wk, Wv, Wo, seg_len):
        B, S, Dm = x.shape
        H, Dh = (Wq.shape[1], Wq.shape[2])
        M = mem0.shape[1]
        scale = Dh ** (-0.5)
        n_seg = S // seg_len
        L = M + seg_len
        idx = torch.arange(L)
        mask = (idx[:, None] < M) | (idx[:, None] >= idx[None, :])
        mem = mem0
        outs = []
        for s in range(n_seg):
            xs = x[:, s * seg_len:(s + 1) * seg_len, :].clone()
            h = torch.concatenate([mem, xs], axis=1)
            q = torch.einsum('btd,dhe->bhte', h, Wq)
            k = torch.einsum('btd,dhe->bhte', h, Wk)
            v = torch.einsum('btd,dhe->bhte', h, Wv)
            scores = torch.einsum('bhqe,bhke->bhqk', q, k) * scale
            scores = torch.where(mask[None, None], scores, -1000000000.0)
            p = _softmax(scores, axis=-1)
            o = torch.einsum('bhqk,bhke->bhqe', p, v)
            o = torch.einsum('bhte,hed->btd', o, Wo)
            mem = o[:, :M, :].clone()
            outs.append(o[:, M:, :])
        return torch.concatenate(outs, axis=1)

    def _B_ref(x, wqkv, wo):
        B, S, D = x.shape
        H = 32
        Dh = D // H
        qkv = (lambda x, *d: x.permute(*d))((x @ wqkv).reshape(B, S, 3, H, Dh), 2, 0, 3, 1, 4)
        q, k, v = (qkv[0], qkv[1], qkv[2])
        scale = Dh ** (-0.5)
        scores = torch.einsum('bhqd,bhkd->bhqk', q, k) * scale
        p = _softmax(scores, axis=-1)
        o = torch.einsum('bhqk,bhkd->bhqd', p, v)
        return (lambda x, *d: x.permute(*d))(o, 0, 2, 1, 3).reshape(B, S, D) @ wo
    x = A_x
    x = x + _A_ref(_layernorm(x, axis=-1), A_mem0, A_Wq, A_Wk, A_Wv, A_Wo, A_seg_len)
    x = x + _B_ref(_layernorm(x, axis=-1), B_wqkv, B_wo)
    x = x + _A_ref(_layernorm(x, axis=-1), A_mem0, A_Wq, A_Wk, A_Wv, A_Wo, A_seg_len)
    x = x + _B_ref(_layernorm(x, axis=-1), B_wqkv, B_wo)
    return x
```

```asm
; @launch kernel=prep_kernel grid=(256,1,1) block=(256,1,1) lds=32768
; @launch kernel=ka_kernel grid=(256,1,1) block=(256,1,1) lds=163840
; @launch kernel=red1_kernel grid=(256,1,1) block=(320,1,1) lds=1024
; @launch kernel=qkv_kernel grid=(256,1,1) block=(256,1,1) lds=122880
; @launch kernel=att1_kernel grid=(256,1,1) block=(256,1,1) lds=131072
; @launch kernel=out1_kernel grid=(64,1,1) block=(256,1,1) lds=40960
; @launch kernel=ka_kernel grid=(256,1,1) block=(256,1,1) lds=163840
; @launch kernel=red2_kernel grid=(256,1,1) block=(320,1,1) lds=1024
; @launch kernel=qkv_kernel grid=(256,1,1) block=(256,1,1) lds=122880
; @launch kernel=att2_kernel grid=(256,1,1) block=(256,1,1) lds=131072
; @launch kernel=out2_kernel grid=(64,1,1) block=(256,1,1) lds=40960
.amdgcn_target "amdgcn-amd-amdhsa--gfx950"
.text
.globl prep_kernel
.p2align 8
.type prep_kernel,@function
prep_kernel:
  s_cmp_ge_u32 s2, 256
  s_cbranch_scc1 k0_exit
  s_load_dwordx4 s[36:39], s[0:1], 0
  s_load_dwordx4 s[40:43], s[0:1], 32
  s_load_dwordx4 s[44:47], s[0:1], 64
  s_load_dwordx2 s[4:5], s[0:1], 96
  v_lshrrev_b32 v1, 6, v0
  s_nop 0
  v_readfirstlane_b32 s21, v1
  v_and_b32 v1, 63, v0
  v_lshlrev_b32 v2, 4, v1
  s_waitcnt lgkmcnt(0)
  s_mov_b32 s8, s4
  s_and_b32 s9, s5, 0xffff
  s_mov_b32 s10, 0x10000000
  s_mov_b32 s11, 0x20000
  v_mov_b32 v4, -1
  v_mov_b32 v5, -1
  v_mov_b32 v6, -1
  v_mov_b32 v7, -1
  s_mul_i32 s26, s2, 61440
  s_mul_i32 s27, s21, 15360
  s_add_u32 s26, s26, s27
  s_add_u32 s26, s26, 0x400000
  buffer_store_dwordx4 v[4:7], v2, s[8:11], s26 offen
  s_add_u32 s26, s26, 1024
  buffer_store_dwordx4 v[4:7], v2, s[8:11], s26 offen
  s_add_u32 s26, s26, 1024
  buffer_store_dwordx4 v[4:7], v2, s[8:11], s26 offen
  s_add_u32 s26, s26, 1024
  buffer_store_dwordx4 v[4:7], v2, s[8:11], s26 offen
  s_add_u32 s26, s26, 1024
  buffer_store_dwordx4 v[4:7], v2, s[8:11], s26 offen
  s_add_u32 s26, s26, 1024
  buffer_store_dwordx4 v[4:7], v2, s[8:11], s26 offen
  s_add_u32 s26, s26, 1024
  buffer_store_dwordx4 v[4:7], v2, s[8:11], s26 offen
  s_add_u32 s26, s26, 1024
  buffer_store_dwordx4 v[4:7], v2, s[8:11], s26 offen
  s_add_u32 s26, s26, 1024
  buffer_store_dwordx4 v[4:7], v2, s[8:11], s26 offen
  s_add_u32 s26, s26, 1024
  buffer_store_dwordx4 v[4:7], v2, s[8:11], s26 offen
  s_add_u32 s26, s26, 1024
  buffer_store_dwordx4 v[4:7], v2, s[8:11], s26 offen
  s_add_u32 s26, s26, 1024
  buffer_store_dwordx4 v[4:7], v2, s[8:11], s26 offen
  s_add_u32 s26, s26, 1024
  buffer_store_dwordx4 v[4:7], v2, s[8:11], s26 offen
  s_add_u32 s26, s26, 1024
  buffer_store_dwordx4 v[4:7], v2, s[8:11], s26 offen
  s_add_u32 s26, s26, 1024
  buffer_store_dwordx4 v[4:7], v2, s[8:11], s26 offen
  s_add_u32 s26, s26, 1024
  s_cmp_eq_u32 s2, 0
  s_cbranch_scc0 z_1
  s_cmp_eq_u32 s21, 0
  s_cbranch_scc0 z_1
  v_mov_b32 v8, 0
  v_mov_b32 v9, 0
  v_mov_b32 v10, 0
  v_mov_b32 v11, 0
  s_mov_b32 s26, 0x0
  buffer_store_dwordx4 v[8:11], v2, s[8:11], s26 offen
  s_add_u32 s26, s26, 1024
  buffer_store_dwordx4 v[8:11], v2, s[8:11], s26 offen
  s_add_u32 s26, s26, 1024
  buffer_store_dwordx4 v[8:11], v2, s[8:11], s26 offen
  s_add_u32 s26, s26, 1024
  buffer_store_dwordx4 v[8:11], v2, s[8:11], s26 offen
  s_add_u32 s26, s26, 1024
  buffer_store_dwordx4 v[8:11], v2, s[8:11], s26 offen
  s_add_u32 s26, s26, 1024
  buffer_store_dwordx4 v[8:11], v2, s[8:11], s26 offen
  s_add_u32 s26, s26, 1024
z_1:
  s_cmp_eq_u32 s2, 1
  s_cbranch_scc0 m0_2
  s_cmp_eq_u32 s21, 0
  s_cbranch_scc0 m0_2
  s_mov_b32 s12, s38
  s_and_b32 s13, s39, 0xffff
  s_mov_b32 s14, 0x2800
  s_mov_b32 s15, 0x20000
  v_and_b32 v8, 7, v1
  v_mul_u32_u24 v8, 1280, v8
  v_lshrrev_b32 v9, 4, v1
  v_lshlrev_b32 v9, 5, v9
  v_add_u32 v8, v8, v9
  v_bfe_u32 v9, v1, 3, 1
  v_lshlrev_b32 v9, 2, v9
  v_add_u32 v8, v8, v9
  s_mov_b32 s26, 0x4000
  buffer_load_dword v12, v8, s[12:15], 0 offen offset:0
  buffer_load_dword v13, v8, s[12:15], 0 offen offset:8
  buffer_load_dword v14, v8, s[12:15], 0 offen offset:16
  buffer_load_dword v15, v8, s[12:15], 0 offen offset:24
  s_waitcnt vmcnt(0)
  buffer_store_dwordx4 v[12:15], v2, s[8:11], s26 offen
  s_add_u32 s26, s26, 1024
  s_nop 1
  buffer_load_dword v12, v8, s[12:15], 0 offen offset:128
  buffer_load_dword v13, v8, s[12:15], 0 offen offset:136
  buffer_load_dword v14, v8, s[12:15], 0 offen offset:144
  buffer_load_dword v15, v8, s[12:15], 0 offen offset:152
  s_waitcnt vmcnt(0)
  buffer_store_dwordx4 v[12:15], v2, s[8:11], s26 offen
  s_add_u32 s26, s26, 1024
  s_nop 1
  buffer_load_dword v12, v8, s[12:15], 0 offen offset:256
  buffer_load_dword v13, v8, s[12:15], 0 offen offset:264
  buffer_load_dword v14, v8, s[12:15], 0 offen offset:272
  buffer_load_dword v15, v8, s[12:15], 0 offen offset:280
  s_waitcnt vmcnt(0)
  buffer_store_dwordx4 v[12:15], v2, s[8:11], s26 offen
  s_add_u32 s26, s26, 1024
  s_nop 1
  buffer_load_dword v12, v8, s[12:15], 0 offen offset:384
  buffer_load_dword v13, v8, s[12:15], 0 offen offset:392
  buffer_load_dword v14, v8, s[12:15], 0 offen offset:400
  buffer_load_dword v15, v8, s[12:15], 0 offen offset:408
  s_waitcnt vmcnt(0)
  buffer_store_dwordx4 v[12:15], v2, s[8:11], s26 offen
  s_add_u32 s26, s26, 1024
  s_nop 1
  buffer_load_dword v12, v8, s[12:15], 0 offen offset:512
  buffer_load_dword v13, v8, s[12:15], 0 offen offset:520
  buffer_load_dword v14, v8, s[12:15], 0 offen offset:528
  buffer_load_dword v15, v8, s[12:15], 0 offen offset:536
  s_waitcnt vmcnt(0)
  buffer_store_dwordx4 v[12:15], v2, s[8:11], s26 offen
  s_add_u32 s26, s26, 1024
  s_nop 1
  buffer_load_dword v12, v8, s[12:15], 0 offen offset:640
  buffer_load_dword v13, v8, s[12:15], 0 offen offset:648
  buffer_load_dword v14, v8, s[12:15], 0 offen offset:656
  buffer_load_dword v15, v8, s[12:15], 0 offen offset:664
  s_waitcnt vmcnt(0)
  buffer_store_dwordx4 v[12:15], v2, s[8:11], s26 offen
  s_add_u32 s26, s26, 1024
  s_nop 1
  buffer_load_dword v12, v8, s[12:15], 0 offen offset:768
  buffer_load_dword v13, v8, s[12:15], 0 offen offset:776
  buffer_load_dword v14, v8, s[12:15], 0 offen offset:784
  buffer_load_dword v15, v8, s[12:15], 0 offen offset:792
  s_waitcnt vmcnt(0)
  buffer_store_dwordx4 v[12:15], v2, s[8:11], s26 offen
  s_add_u32 s26, s26, 1024
  s_nop 1
  buffer_load_dword v12, v8, s[12:15], 0 offen offset:896
  buffer_load_dword v13, v8, s[12:15], 0 offen offset:904
  buffer_load_dword v14, v8, s[12:15], 0 offen offset:912
  buffer_load_dword v15, v8, s[12:15], 0 offen offset:920
  s_waitcnt vmcnt(0)
  buffer_store_dwordx4 v[12:15], v2, s[8:11], s26 offen
  s_add_u32 s26, s26, 1024
  s_nop 1
  buffer_load_dword v12, v8, s[12:15], 0 offen offset:1024
  buffer_load_dword v13, v8, s[12:15], 0 offen offset:1032
  buffer_load_dword v14, v8, s[12:15], 0 offen offset:1040
  buffer_load_dword v15, v8, s[12:15], 0 offen offset:1048
  s_waitcnt vmcnt(0)
  buffer_store_dwordx4 v[12:15], v2, s[8:11], s26 offen
  s_add_u32 s26, s26, 1024
  s_nop 1
  buffer_load_dword v12, v8, s[12:15], 0 offen offset:1152
  buffer_load_dword v13, v8, s[12:15], 0 offen offset:1160
  buffer_load_dword v14, v8, s[12:15], 0 offen offset:1168
  buffer_load_dword v15, v8, s[12:15], 0 offen offset:1176
  s_waitcnt vmcnt(0)
  buffer_store_dwordx4 v[12:15], v2, s[8:11], s26 offen
  s_add_u32 s26, s26, 1024
  s_nop 1
m0_2:
  s_cmp_eq_u32 s21, 3
  s_cbranch_scc0 ln_3
  s_mov_b32 s12, s36
  s_and_b32 s13, s37, 0xffff
  s_mov_b32 s14, 0x280000
  s_mov_b32 s15, 0x20000
  v_lshrrev_b32 v8, 3, v1
  v_and_b32 v9, 7, v1
  s_lshl_b32 s26, s2, 3
  v_add_u32 v10, s26, v8
  v_mul_u32_u24 v11, 1280, v10
  v_lshlrev_b32 v12, 4, v9
  v_add_u32 v11, v11, v12
  buffer_load_dwordx4 v[16:19], v11, s[12:15], 0 offen offset:0
  buffer_load_dwordx4 v[20:23], v11, s[12:15], 0 offen offset:128
  buffer_load_dwordx4 v[24:27], v11, s[12:15], 0 offen offset:256
  buffer_load_dwordx4 v[28:31], v11, s[12:15], 0 offen offset:384
  buffer_load_dwordx4 v[32:35], v11, s[12:15], 0 offen offset:512
  buffer_load_dwordx4 v[36:39], v11, s[12:15], 0 offen offset:640
  buffer_load_dwordx4 v[40:43], v11, s[12:15], 0 offen offset:768
  buffer_load_dwordx4 v[44:47], v11, s[12:15], 0 offen offset:896
  buffer_load_dwordx4 v[48:51], v11, s[12:15], 0 offen offset:1024
  buffer_load_dwordx4 v[52:55], v11, s[12:15], 0 offen offset:1152
  v_lshrrev_b32 v12, 5, v10
  v_mul_u32_u24 v12, 40960, v12
  v_lshrrev_b32 v13, 1, v9
  v_lshlrev_b32 v13, 10, v13
  v_add_u32 v12, v12, v13
  v_and_b32 v13, 1, v9
  v_lshlrev_b32 v13, 5, v13
  v_and_b32 v14, 31, v10
  v_add_u32 v13, v13, v14
  v_lshlrev_b32 v13, 4, v13
  v_add_u32 v12, v12, v13
  s_waitcnt vmcnt(0)
  v_lshlrev_b32 v64, 16, v16
  v_and_b32 v65, 0xffff0000, v16
  v_lshlrev_b32 v66, 16, v17
  v_and_b32 v67, 0xffff0000, v17
  v_lshlrev_b32 v68, 16, v18
  v_and_b32 v69, 0xffff0000, v18
  v_lshlrev_b32 v70, 16, v19
  v_and_b32 v71, 0xffff0000, v19
  v_lshlrev_b32 v72, 16, v20
  v_and_b32 v73, 0xffff0000, v20
  v_lshlrev_b32 v74, 16, v21
  v_and_b32 v75, 0xffff0000, v21
  v_lshlrev_b32 v76, 16, v22
  v_and_b32 v77, 0xffff0000, v22
  v_lshlrev_b32 v78, 16, v23
  v_and_b32 v79, 0xffff0000, v23
  v_lshlrev_b32 v80, 16, v24
  v_and_b32 v81, 0xffff0000, v24
  v_lshlrev_b32 v82, 16, v25
  v_and_b32 v83, 0xffff0000, v25
  v_lshlrev_b32 v84, 16, v26
  v_and_b32 v85, 0xffff0000, v26
  v_lshlrev_b32 v86, 16, v27
  v_and_b32 v87, 0xffff0000, v27
  v_lshlrev_b32 v88, 16, v28
  v_and_b32 v89, 0xffff0000, v28
  v_lshlrev_b32 v90, 16, v29
  v_and_b32 v91, 0xffff0000, v29
  v_lshlrev_b32 v92, 16, v30
  v_and_b32 v93, 0xffff0000, v30
  v_lshlrev_b32 v94, 16, v31
  v_and_b32 v95, 0xffff0000, v31
  v_lshlrev_b32 v96, 16, v32
  v_and_b32 v97, 0xffff0000, v32
  v_lshlrev_b32 v98, 16, v33
  v_and_b32 v99, 0xffff0000, v33
  v_lshlrev_b32 v100, 16, v34
  v_and_b32 v101, 0xffff0000, v34
  v_lshlrev_b32 v102, 16, v35
  v_and_b32 v103, 0xffff0000, v35
  v_lshlrev_b32 v104, 16, v36
  v_and_b32 v105, 0xffff0000, v36
  v_lshlrev_b32 v106, 16, v37
  v_and_b32 v107, 0xffff0000, v37
  v_lshlrev_b32 v108, 16, v38
  v_and_b32 v109, 0xffff0000, v38
  v_lshlrev_b32 v110, 16, v39
  v_and_b32 v111, 0xffff0000, v39
  v_lshlrev_b32 v112, 16, v40
  v_and_b32 v113, 0xffff0000, v40
  v_lshlrev_b32 v114, 16, v41
  v_and_b32 v115, 0xffff0000, v41
  v_lshlrev_b32 v116, 16, v42
  v_and_b32 v117, 0xffff0000, v42
  v_lshlrev_b32 v118, 16, v43
  v_and_b32 v119, 0xffff0000, v43
  v_lshlrev_b32 v120, 16, v44
  v_and_b32 v121, 0xffff0000, v44
  v_lshlrev_b32 v122, 16, v45
  v_and_b32 v123, 0xffff0000, v45
  v_lshlrev_b32 v124, 16, v46
  v_and_b32 v125, 0xffff0000, v46
  v_lshlrev_b32 v126, 16, v47
  v_and_b32 v127, 0xffff0000, v47
  v_lshlrev_b32 v128, 16, v48
  v_and_b32 v129, 0xffff0000, v48
  v_lshlrev_b32 v130, 16, v49
  v_and_b32 v131, 0xffff0000, v49
  v_lshlrev_b32 v132, 16, v50
  v_and_b32 v133, 0xffff0000, v50
  v_lshlrev_b32 v134, 16, v51
  v_and_b32 v135, 0xffff0000, v51
  v_lshlrev_b32 v136, 16, v52
  v_and_b32 v137, 0xffff0000, v52
  v_lshlrev_b32 v138, 16, v53
  v_and_b32 v139, 0xffff0000, v53
  v_lshlrev_b32 v140, 16, v54
  v_and_b32 v141, 0xffff0000, v54
  v_lshlrev_b32 v142, 16, v55
  v_and_b32 v143, 0xffff0000, v55
  v_add_f32 v14, v64, v65
  v_add_f32 v14, v14, v66
  v_add_f32 v14, v14, v67
  v_add_f32 v14, v14, v68
  v_add_f32 v14, v14, v69
  v_add_f32 v14, v14, v70
  v_add_f32 v14, v14, v71
  v_add_f32 v14, v14, v72
  v_add_f32 v14, v14, v73
  v_add_f32 v14, v14, v74
  v_add_f32 v14, v14, v75
  v_add_f32 v14, v14, v76
  v_add_f32 v14, v14, v77
  v_add_f32 v14, v14, v78
  v_add_f32 v14, v14, v79
  v_add_f32 v14, v14, v80
  v_add_f32 v14, v14, v81
  v_add_f32 v14, v14, v82
  v_add_f32 v14, v14, v83
  v_add_f32 v14, v14, v84
  v_add_f32 v14, v14, v85
  v_add_f32 v14, v14, v86
  v_add_f32 v14, v14, v87
  v_add_f32 v14, v14, v88
  v_add_f32 v14, v14, v89
  v_add_f32 v14, v14, v90
  v_add_f32 v14, v14, v91
  v_add_f32 v14, v14, v92
  v_add_f32 v14, v14, v93
  v_add_f32 v14, v14, v94
  v_add_f32 v14, v14, v95
  v_add_f32 v14, v14, v96
  v_add_f32 v14, v14, v97
  v_add_f32 v14, v14, v98
  v_add_f32 v14, v14, v99
  v_add_f32 v14, v14, v100
  v_add_f32 v14, v14, v101
  v_add_f32 v14, v14, v102
  v_add_f32 v14, v14, v103
  v_add_f32 v14, v14, v104
  v_add_f32 v14, v14, v105
  v_add_f32 v14, v14, v106
  v_add_f32 v14, v14, v107
  v_add_f32 v14, v14, v108
  v_add_f32 v14, v14, v109
  v_add_f32 v14, v14, v110
  v_add_f32 v14, v14, v111
  v_add_f32 v14, v14, v112
  v_add_f32 v14, v14, v113
  v_add_f32 v14, v14, v114
  v_add_f32 v14, v14, v115
  v_add_f32 v14, v14, v116
  v_add_f32 v14, v14, v117
  v_add_f32 v14, v14, v118
  v_add_f32 v14, v14, v119
  v_add_f32 v14, v14, v120
  v_add_f32 v14, v14, v121
  v_add_f32 v14, v14, v122
  v_add_f32 v14, v14, v123
  v_add_f32 v14, v14, v124
  v_add_f32 v14, v14, v125
  v_add_f32 v14, v14, v126
  v_add_f32 v14, v14, v127
  v_add_f32 v14, v14, v128
  v_add_f32 v14, v14, v129
  v_add_f32 v14, v14, v130
  v_add_f32 v14, v14, v131
  v_add_f32 v14, v14, v132
  v_add_f32 v14, v14, v133
  v_add_f32 v14, v14, v134
  v_add_f32 v14, v14, v135
  v_add_f32 v14, v14, v136
  v_add_f32 v14, v14, v137
  v_add_f32 v14, v14, v138
  v_add_f32 v14, v14, v139
  v_add_f32 v14, v14, v140
  v_add_f32 v14, v14, v141
  v_add_f32 v14, v14, v142
  v_add_f32 v14, v14, v143
  s_nop 1
  v_add_f32_dpp v15, v14, v14 quad_perm:[1,0,3,2] row_mask:0xf bank_mask:0xf
  s_nop 1
  v_add_f32_dpp v14, v15, v15 quad_perm:[2,3,0,1] row_mask:0xf bank_mask:0xf
  s_nop 1
  v_add_f32_dpp v15, v14, v14 row_half_mirror row_mask:0xf bank_mask:0xf
  v_mov_b32 v14, v15
  v_mul_f32 v14, 0x3acccccd, v14
  v_sub_f32 v64, v64, v14
  v_sub_f32 v65, v65, v14
  v_sub_f32 v66, v66, v14
  v_sub_f32 v67, v67, v14
  v_sub_f32 v68, v68, v14
  v_sub_f32 v69, v69, v14
  v_sub_f32 v70, v70, v14
  v_sub_f32 v71, v71, v14
  v_sub_f32 v72, v72, v14
  v_sub_f32 v73, v73, v14
  v_sub_f32 v74, v74, v14
  v_sub_f32 v75, v75, v14
  v_sub_f32 v76, v76, v14
  v_sub_f32 v77, v77, v14
  v_sub_f32 v78, v78, v14
  v_sub_f32 v79, v79, v14
  v_sub_f32 v80, v80, v14
  v_sub_f32 v81, v81, v14
  v_sub_f32 v82, v82, v14
  v_sub_f32 v83, v83, v14
  v_sub_f32 v84, v84, v14
  v_sub_f32 v85, v85, v14
  v_sub_f32 v86, v86, v14
  v_sub_f32 v87, v87, v14
  v_sub_f32 v88, v88, v14
  v_sub_f32 v89, v89, v14
  v_sub_f32 v90, v90, v14
  v_sub_f32 v91, v91, v14
  v_sub_f32 v92, v92, v14
  v_sub_f32 v93, v93, v14
  v_sub_f32 v94, v94, v14
  v_sub_f32 v95, v95, v14
  v_sub_f32 v96, v96, v14
  v_sub_f32 v97, v97, v14
  v_sub_f32 v98, v98, v14
  v_sub_f32 v99, v99, v14
  v_sub_f32 v100, v100, v14
  v_sub_f32 v101, v101, v14
  v_sub_f32 v102, v102, v14
  v_sub_f32 v103, v103, v14
  v_sub_f32 v104, v104, v14
  v_sub_f32 v105, v105, v14
  v_sub_f32 v106, v106, v14
  v_sub_f32 v107, v107, v14
  v_sub_f32 v108, v108, v14
  v_sub_f32 v109, v109, v14
  v_sub_f32 v110, v110, v14
  v_sub_f32 v111, v111, v14
  v_sub_f32 v112, v112, v14
  v_sub_f32 v113, v113, v14
  v_sub_f32 v114, v114, v14
  v_sub_f32 v115, v115, v14
  v_sub_f32 v116, v116, v14
  v_sub_f32 v117, v117, v14
  v_sub_f32 v118, v118, v14
  v_sub_f32 v119, v119, v14
  v_sub_f32 v120, v120, v14
  v_sub_f32 v121, v121, v14
  v_sub_f32 v122, v122, v14
  v_sub_f32 v123, v123, v14
  v_sub_f32 v124, v124, v14
  v_sub_f32 v125, v125, v14
  v_sub_f32 v126, v126, v14
  v_sub_f32 v127, v127, v14
  v_sub_f32 v128, v128, v14
  v_sub_f32 v129, v129, v14
  v_sub_f32 v130, v130, v14
  v_sub_f32 v131, v131, v14
  v_sub_f32 v132, v132, v14
  v_sub_f32 v133, v133, v14
  v_sub_f32 v134, v134, v14
  v_sub_f32 v135, v135, v14
  v_sub_f32 v136, v136, v14
  v_sub_f32 v137, v137, v14
  v_sub_f32 v138, v138, v14
  v_sub_f32 v139, v139, v14
  v_sub_f32 v140, v140, v14
  v_sub_f32 v141, v141, v14
  v_sub_f32 v142, v142, v14
  v_sub_f32 v143, v143, v14
  v_mul_f32 v15, v64, v64
  v_fmac_f32 v15, v65, v65
  v_fmac_f32 v15, v66, v66
  v_fmac_f32 v15, v67, v67
  v_fmac_f32 v15, v68, v68
  v_fmac_f32 v15, v69, v69
  v_fmac_f32 v15, v70, v70
  v_fmac_f32 v15, v71, v71
  v_fmac_f32 v15, v72, v72
  v_fmac_f32 v15, v73, v73
  v_fmac_f32 v15, v74, v74
  v_fmac_f32 v15, v75, v75
  v_fmac_f32 v15, v76, v76
  v_fmac_f32 v15, v77, v77
  v_fmac_f32 v15, v78, v78
  v_fmac_f32 v15, v79, v79
  v_fmac_f32 v15, v80, v80
  v_fmac_f32 v15, v81, v81
  v_fmac_f32 v15, v82, v82
  v_fmac_f32 v15, v83, v83
  v_fmac_f32 v15, v84, v84
  v_fmac_f32 v15, v85, v85
  v_fmac_f32 v15, v86, v86
  v_fmac_f32 v15, v87, v87
  v_fmac_f32 v15, v88, v88
  v_fmac_f32 v15, v89, v89
  v_fmac_f32 v15, v90, v90
  v_fmac_f32 v15, v91, v91
  v_fmac_f32 v15, v92, v92
  v_fmac_f32 v15, v93, v93
  v_fmac_f32 v15, v94, v94
  v_fmac_f32 v15, v95, v95
  v_fmac_f32 v15, v96, v96
  v_fmac_f32 v15, v97, v97
  v_fmac_f32 v15, v98, v98
  v_fmac_f32 v15, v99, v99
  v_fmac_f32 v15, v100, v100
  v_fmac_f32 v15, v101, v101
  v_fmac_f32 v15, v102, v102
  v_fmac_f32 v15, v103, v103
  v_fmac_f32 v15, v104, v104
  v_fmac_f32 v15, v105, v105
  v_fmac_f32 v15, v106, v106
  v_fmac_f32 v15, v107, v107
  v_fmac_f32 v15, v108, v108
  v_fmac_f32 v15, v109, v109
  v_fmac_f32 v15, v110, v110
  v_fmac_f32 v15, v111, v111
  v_fmac_f32 v15, v112, v112
  v_fmac_f32 v15, v113, v113
  v_fmac_f32 v15, v114, v114
  v_fmac_f32 v15, v115, v115
  v_fmac_f32 v15, v116, v116
  v_fmac_f32 v15, v117, v117
  v_fmac_f32 v15, v118, v118
  v_fmac_f32 v15, v119, v119
  v_fmac_f32 v15, v120, v120
  v_fmac_f32 v15, v121, v121
  v_fmac_f32 v15, v122, v122
  v_fmac_f32 v15, v123, v123
  v_fmac_f32 v15, v124, v124
  v_fmac_f32 v15, v125, v125
  v_fmac_f32 v15, v126, v126
  v_fmac_f32 v15, v127, v127
  v_fmac_f32 v15, v128, v128
  v_fmac_f32 v15, v129, v129
  v_fmac_f32 v15, v130, v130
  v_fmac_f32 v15, v131, v131
  v_fmac_f32 v15, v132, v132
  v_fmac_f32 v15, v133, v133
  v_fmac_f32 v15, v134, v134
  v_fmac_f32 v15, v135, v135
  v_fmac_f32 v15, v136, v136
  v_fmac_f32 v15, v137, v137
  v_fmac_f32 v15, v138, v138
  v_fmac_f32 v15, v139, v139
  v_fmac_f32 v15, v140, v140
  v_fmac_f32 v15, v141, v141
  v_fmac_f32 v15, v142, v142
  v_fmac_f32 v15, v143, v143
  s_nop 1
  v_add_f32_dpp v14, v15, v15 quad_perm:[1,0,3,2] row_mask:0xf bank_mask:0xf
  s_nop 1
  v_add_f32_dpp v15, v14, v14 quad_perm:[2,3,0,1] row_mask:0xf bank_mask:0xf
  s_nop 1
  v_add_f32_dpp v14, v15, v15 row_half_mirror row_mask:0xf bank_mask:0xf
  v_mov_b32 v15, v14
  v_mov_b32 v14, 0x3727c5ac
  v_fmac_f32 v14, 0x3acccccd, v15
  v_rsq_f32 v14, v14
  s_nop 0
  v_mul_f32 v64, v64, v14
  v_mul_f32 v65, v65, v14
  v_cvt_pk_bf16_f32 v16, v64, v65
  v_mul_f32 v66, v66, v14
  v_mul_f32 v67, v67, v14
  v_cvt_pk_bf16_f32 v17, v66, v67
  v_mul_f32 v68, v68, v14
  v_mul_f32 v69, v69, v14
  v_cvt_pk_bf16_f32 v18, v68, v69
  v_mul_f32 v70, v70, v14
  v_mul_f32 v71, v71, v14
  v_cvt_pk_bf16_f32 v19, v70, v71
  v_mul_f32 v72, v72, v14
  v_mul_f32 v73, v73, v14
  v_cvt_pk_bf16_f32 v20, v72, v73
  v_mul_f32 v74, v74, v14
  v_mul_f32 v75, v75, v14
  v_cvt_pk_bf16_f32 v21, v74, v75
  v_mul_f32 v76, v76, v14
  v_mul_f32 v77, v77, v14
  v_cvt_pk_bf16_f32 v22, v76, v77
  v_mul_f32 v78, v78, v14
  v_mul_f32 v79, v79, v14
  v_cvt_pk_bf16_f32 v23, v78, v79
  v_mul_f32 v80, v80, v14
  v_mul_f32 v81, v81, v14
  v_cvt_pk_bf16_f32 v24, v80, v81
  v_mul_f32 v82, v82, v14
  v_mul_f32 v83, v83, v14
  v_cvt_pk_bf16_f32 v25, v82, v83
  v_mul_f32 v84, v84, v14
  v_mul_f32 v85, v85, v14
  v_cvt_pk_bf16_f32 v26, v84, v85
  v_mul_f32 v86, v86, v14
  v_mul_f32 v87, v87, v14
  v_cvt_pk_bf16_f32 v27, v86, v87
  v_mul_f32 v88, v88, v14
  v_mul_f32 v89, v89, v14
  v_cvt_pk_bf16_f32 v28, v88, v89
  v_mul_f32 v90, v90, v14
  v_mul_f32 v91, v91, v14
  v_cvt_pk_bf16_f32 v29, v90, v91
  v_mul_f32 v92, v92, v14
  v_mul_f32 v93, v93, v14
  v_cvt_pk_bf16_f32 v30, v92, v93
  v_mul_f32 v94, v94, v14
  v_mul_f32 v95, v95, v14
  v_cvt_pk_bf16_f32 v31, v94, v95
  v_mul_f32 v96, v96, v14
  v_mul_f32 v97, v97, v14
  v_cvt_pk_bf16_f32 v32, v96, v97
  v_mul_f32 v98, v98, v14
  v_mul_f32 v99, v99, v14
  v_cvt_pk_bf16_f32 v33, v98, v99
  v_mul_f32 v100, v100, v14
  v_mul_f32 v101, v101, v14
  v_cvt_pk_bf16_f32 v34, v100, v101
  v_mul_f32 v102, v102, v14
  v_mul_f32 v103, v103, v14
  v_cvt_pk_bf16_f32 v35, v102, v103
  v_mul_f32 v104, v104, v14
  v_mul_f32 v105, v105, v14
  v_cvt_pk_bf16_f32 v36, v104, v105
  v_mul_f32 v106, v106, v14
  v_mul_f32 v107, v107, v14
  v_cvt_pk_bf16_f32 v37, v106, v107
  v_mul_f32 v108, v108, v14
  v_mul_f32 v109, v109, v14
  v_cvt_pk_bf16_f32 v38, v108, v109
  v_mul_f32 v110, v110, v14
  v_mul_f32 v111, v111, v14
  v_cvt_pk_bf16_f32 v39, v110, v111
  v_mul_f32 v112, v112, v14
  v_mul_f32 v113, v113, v14
  v_cvt_pk_bf16_f32 v40, v112, v113
  v_mul_f32 v114, v114, v14
  v_mul_f32 v115, v115, v14
  v_cvt_pk_bf16_f32 v41, v114, v115
  v_mul_f32 v116, v116, v14
  v_mul_f32 v117, v117, v14
  v_cvt_pk_bf16_f32 v42, v116, v117
  v_mul_f32 v118, v118, v14
  v_mul_f32 v119, v119, v14
  v_cvt_pk_bf16_f32 v43, v118, v119
  v_mul_f32 v120, v120, v14
  v_mul_f32 v121, v121, v14
  v_cvt_pk_bf16_f32 v44, v120, v121
  v_mul_f32 v122, v122, v14
  v_mul_f32 v123, v123, v14
  v_cvt_pk_bf16_f32 v45, v122, v123
  v_mul_f32 v124, v124, v14
  v_mul_f32 v125, v125, v14
  v_cvt_pk_bf16_f32 v46, v124, v125
  v_mul_f32 v126, v126, v14
  v_mul_f32 v127, v127, v14
  v_cvt_pk_bf16_f32 v47, v126, v127
  v_mul_f32 v128, v128, v14
  v_mul_f32 v129, v129, v14
  v_cvt_pk_bf16_f32 v48, v128, v129
  v_mul_f32 v130, v130, v14
  v_mul_f32 v131, v131, v14
  v_cvt_pk_bf16_f32 v49, v130, v131
  v_mul_f32 v132, v132, v14
  v_mul_f32 v133, v133, v14
  v_cvt_pk_bf16_f32 v50, v132, v133
  v_mul_f32 v134, v134, v14
  v_mul_f32 v135, v135, v14
  v_cvt_pk_bf16_f32 v51, v134, v135
  v_mul_f32 v136, v136, v14
  v_mul_f32 v137, v137, v14
  v_cvt_pk_bf16_f32 v52, v136, v137
  v_mul_f32 v138, v138, v14
  v_mul_f32 v139, v139, v14
  v_cvt_pk_bf16_f32 v53, v138, v139
  v_mul_f32 v140, v140, v14
  v_mul_f32 v141, v141, v14
  v_cvt_pk_bf16_f32 v54, v140, v141
  v_mul_f32 v142, v142, v14
  v_mul_f32 v143, v143, v14
  v_cvt_pk_bf16_f32 v55, v142, v143
  s_mov_b32 s26, 0x100000
  buffer_store_dwordx4 v[16:19], v12, s[8:11], s26 offen
  s_add_u32 s26, s26, 4096
  buffer_store_dwordx4 v[20:23], v12, s[8:11], s26 offen
  s_add_u32 s26, s26, 4096
  buffer_store_dwordx4 v[24:27], v12, s[8:11], s26 offen
  s_add_u32 s26, s26, 4096
  buffer_store_dwordx4 v[28:31], v12, s[8:11], s26 offen
  s_add_u32 s26, s26, 4096
  buffer_store_dwordx4 v[32:35], v12, s[8:11], s26 offen
  s_add_u32 s26, s26, 4096
  buffer_store_dwordx4 v[36:39], v12, s[8:11], s26 offen
  s_add_u32 s26, s26, 4096
  buffer_store_dwordx4 v[40:43], v12, s[8:11], s26 offen
  s_add_u32 s26, s26, 4096
  buffer_store_dwordx4 v[44:47], v12, s[8:11], s26 offen
  s_add_u32 s26, s26, 4096
  buffer_store_dwordx4 v[48:51], v12, s[8:11], s26 offen
  s_add_u32 s26, s26, 4096
  buffer_store_dwordx4 v[52:55], v12, s[8:11], s26 offen
  s_add_u32 s26, s26, 4096
ln_3:
  s_mov_b32 s12, s46
  s_and_b32 s13, s47, 0xffff
  s_mov_b32 s14, 0xc8000
  s_mov_b32 s15, 0x20000
  s_mov_b32 s16, s44
  s_and_b32 s17, s45, 0xffff
  s_mov_b32 s18, 0x258000
  s_mov_b32 s19, 0x20000
  s_lshl_b32 s26, s2, 2
  s_add_u32 s26, s26, s21
  v_and_b32 v8, 31, v1
  v_lshrrev_b32 v9, 5, v1
  v_lshrrev_b32 v10, 4, v8
  v_lshlrev_b32 v10, 4, v10
  v_bfe_u32 v11, v8, 2, 1
  v_lshlrev_b32 v11, 3, v11
  v_add_u32 v10, v10, v11
  v_bfe_u32 v11, v8, 3, 1
  v_lshlrev_b32 v11, 2, v11
  v_add_u32 v10, v10, v11
  v_and_b32 v11, 3, v8
  v_add_u32 v10, v10, v11
  v_mov_b32 v15, 0x40000000
  s_add_u32 s27, s26, 0
  s_cmp_lt_u32 s27, 800
  s_cbranch_scc0 gq_5
  s_mul_i32 s28, s27, 6554
  s_lshr_b32 s28, s28, 18
  s_mul_i32 s29, s28, 40
  s_sub_u32 s29, s27, s29
  s_lshl_b32 s30, s28, 6
  s_mul_i32 s31, s29, 20480
  s_add_u32 s30, s30, s31
  v_mul_u32_u24 v12, 10240, v9
  v_lshlrev_b32 v13, 1, v10
  v_add_u32 v12, v12, v13
  s_add_u32 s31, s30, 0
  buffer_load_ushort v20, v12, s[12:15], s31 offen
  s_add_u32 s31, s30, 1280
  buffer_load_ushort v21, v12, s[12:15], s31 offen
  s_add_u32 s31, s30, 2560
  buffer_load_ushort v22, v12, s[12:15], s31 offen
  s_add_u32 s31, s30, 3840
  buffer_load_ushort v23, v12, s[12:15], s31 offen
  s_add_u32 s31, s30, 5120
  buffer_load_ushort v24, v12, s[12:15], s31 offen
  s_add_u32 s31, s30, 6400
  buffer_load_ushort v25, v12, s[12:15], s31 offen
  s_add_u32 s31, s30, 7680
  buffer_load_ushort v26, v12, s[12:15], s31 offen
  s_add_u32 s31, s30, 8960
  buffer_load_ushort v27, v12, s[12:15], s31 offen
  s_lshl_b32 s28, s27, 10
  s_add_u32 s28, s28, 0xe000000
  s_branch gd_6
gq_5:
  s_sub_u32 s27, s27, 800
  s_cmp_lt_u32 s27, 3840
  s_cbranch_scc0 g_4
  s_mul_i32 s28, s27, 6554
  s_lshr_b32 s28, s28, 18
  s_mul_i32 s29, s28, 40
  s_sub_u32 s29, s27, s29
  s_mul_i32 s30, s28, 21846
  s_lshr_b32 s30, s30, 16
  s_mul_i32 s31, s30, 3
  s_sub_u32 s31, s28, s31
  s_cmp_lt_u32 s31, 2
  s_cselect_b64 vcc, -1, 0
  v_cndmask_b32 v12, v8, v10, vcc
  v_cmp_gt_u32 vcc, 20, v12
  v_lshlrev_b32 v12, 1, v12
  v_mul_u32_u24 v13, 30720, v9
  v_add_u32 v12, v12, v13
  v_cndmask_b32 v12, v15, v12, vcc
  s_mul_i32 s31, s31, 1280
  s_mul_i32 s30, s30, 40
  s_add_u32 s30, s30, s31
  s_mul_i32 s31, s29, 61440
  s_add_u32 s30, s30, s31
  s_add_u32 s31, s30, 0
  buffer_load_ushort v20, v12, s[16:19], s31 offen
  s_add_u32 s31, s30, 3840
  buffer_load_ushort v21, v12, s[16:19], s31 offen
  s_add_u32 s31, s30, 7680
  buffer_load_ushort v22, v12, s[16:19], s31 offen
  s_add_u32 s31, s30, 11520
  buffer_load_ushort v23, v12, s[16:19], s31 offen
  s_add_u32 s31, s30, 15360
  buffer_load_ushort v24, v12, s[16:19], s31 offen
  s_add_u32 s31, s30, 19200
  buffer_load_ushort v25, v12, s[16:19], s31 offen
  s_add_u32 s31, s30, 23040
  buffer_load_ushort v26, v12, s[16:19], s31 offen
  s_add_u32 s31, s30, 26880
  buffer_load_ushort v27, v12, s[16:19], s31 offen
  s_lshl_b32 s28, s27, 10
  s_add_u32 s28, s28, 0xe100000
gd_6:
  s_waitcnt vmcnt(0)
  v_lshl_or_b32 v28, v21, 16, v20
  v_lshl_or_b32 v29, v23, 16, v22
  v_lshl_or_b32 v30, v25, 16, v24
  v_lshl_or_b32 v31, v27, 16, v26
  buffer_store_dwordx4 v[28:31], v2, s[8:11], s28 offen
  s_nop 1
g_4:
  s_add_u32 s27, s26, 1024
  s_cmp_lt_u32 s27, 800
  s_cbranch_scc0 gq_8
  s_mul_i32 s28, s27, 6554
  s_lshr_b32 s28, s28, 18
  s_mul_i32 s29, s28, 40
  s_sub_u32 s29, s27, s29
  s_lshl_b32 s30, s28, 6
  s_mul_i32 s31, s29, 20480
  s_add_u32 s30, s30, s31
  v_mul_u32_u24 v12, 10240, v9
  v_lshlrev_b32 v13, 1, v10
  v_add_u32 v12, v12, v13
  s_add_u32 s31, s30, 0
  buffer_load_ushort v20, v12, s[12:15], s31 offen
  s_add_u32 s31, s30, 1280
  buffer_load_ushort v21, v12, s[12:15], s31 offen
  s_add_u32 s31, s30, 2560
  buffer_load_ushort v22, v12, s[12:15], s31 offen
  s_add_u32 s31, s30, 3840
  buffer_load_ushort v23, v12, s[12:15], s31 offen
  s_add_u32 s31, s30, 5120
  buffer_load_ushort v24, v12, s[12:15], s31 offen
  s_add_u32 s31, s30, 6400
  buffer_load_ushort v25, v12, s[12:15], s31 offen
  s_add_u32 s31, s30, 7680
  buffer_load_ushort v26, v12, s[12:15], s31 offen
  s_add_u32 s31, s30, 8960
  buffer_load_ushort v27, v12, s[12:15], s31 offen
  s_lshl_b32 s28, s27, 10
  s_add_u32 s28, s28, 0xe000000
  s_branch gd_9
gq_8:
  s_sub_u32 s27, s27, 800
  s_cmp_lt_u32 s27, 3840
  s_cbranch_scc0 g_7
  s_mul_i32 s28, s27, 6554
  s_lshr_b32 s28, s28, 18
  s_mul_i32 s29, s28, 40
  s_sub_u32 s29, s27, s29
  s_mul_i32 s30, s28, 21846
  s_lshr_b32 s30, s30, 16
  s_mul_i32 s31, s30, 3
  s_sub_u32 s31, s28, s31
  s_cmp_lt_u32 s31, 2
  s_cselect_b64 vcc, -1, 0
  v_cndmask_b32 v12, v8, v10, vcc
  v_cmp_gt_u32 vcc, 20, v12
  v_lshlrev_b32 v12, 1, v12
  v_mul_u32_u24 v13, 30720, v9
  v_add_u32 v12, v12, v13
  v_cndmask_b32 v12, v15, v12, vcc
  s_mul_i32 s31, s31, 1280
  s_mul_i32 s30, s30, 40
  s_add_u32 s30, s30, s31
  s_mul_i32 s31, s29, 61440
  s_add_u32 s30, s30, s31
  s_add_u32 s31, s30, 0
  buffer_load_ushort v20, v12, s[16:19], s31 offen
  s_add_u32 s31, s30, 3840
  buffer_load_ushort v21, v12, s[16:19], s31 offen
  s_add_u32 s31, s30, 7680
  buffer_load_ushort v22, v12, s[16:19], s31 offen
  s_add_u32 s31, s30, 11520
  buffer_load_ushort v23, v12, s[16:19], s31 offen
  s_add_u32 s31, s30, 15360
  buffer_load_ushort v24, v12, s[16:19], s31 offen
  s_add_u32 s31, s30, 19200
  buffer_load_ushort v25, v12, s[16:19], s31 offen
  s_add_u32 s31, s30, 23040
  buffer_load_ushort v26, v12, s[16:19], s31 offen
  s_add_u32 s31, s30, 26880
  buffer_load_ushort v27, v12, s[16:19], s31 offen
  s_lshl_b32 s28, s27, 10
  s_add_u32 s28, s28, 0xe100000
gd_9:
  s_waitcnt vmcnt(0)
  v_lshl_or_b32 v28, v21, 16, v20
  v_lshl_or_b32 v29, v23, 16, v22
  v_lshl_or_b32 v30, v25, 16, v24
  v_lshl_or_b32 v31, v27, 16, v26
  buffer_store_dwordx4 v[28:31], v2, s[8:11], s28 offen
  s_nop 1
g_7:
  s_add_u32 s27, s26, 2048
  s_cmp_lt_u32 s27, 800
  s_cbranch_scc0 gq_11
  s_mul_i32 s28, s27, 6554
  s_lshr_b32 s28, s28, 18
  s_mul_i32 s29, s28, 40
  s_sub_u32 s29, s27, s29
  s_lshl_b32 s30, s28, 6
  s_mul_i32 s31, s29, 20480
  s_add_u32 s30, s30, s31
  v_mul_u32_u24 v12, 10240, v9
  v_lshlrev_b32 v13, 1, v10
  v_add_u32 v12, v12, v13
  s_add_u32 s31, s30, 0
  buffer_load_ushort v20, v12, s[12:15], s31 offen
  s_add_u32 s31, s30, 1280
  buffer_load_ushort v21, v12, s[12:15], s31 offen
  s_add_u32 s31, s30, 2560
  buffer_load_ushort v22, v12, s[12:15], s31 offen
  s_add_u32 s31, s30, 3840
  buffer_load_ushort v23, v12, s[12:15], s31 offen
  s_add_u32 s31, s30, 5120
  buffer_load_ushort v24, v12, s[12:15], s31 offen
  s_add_u32 s31, s30, 6400
  buffer_load_ushort v25, v12, s[12:15], s31 offen
  s_add_u32 s31, s30, 7680
  buffer_load_ushort v26, v12, s[12:15], s31 offen
  s_add_u32 s31, s30, 8960
  buffer_load_ushort v27, v12, s[12:15], s31 offen
  s_lshl_b32 s28, s27, 10
  s_add_u32 s28, s28, 0xe000000
  s_branch gd_12
gq_11:
  s_sub_u32 s27, s27, 800
  s_cmp_lt_u32 s27, 3840
  s_cbranch_scc0 g_10
  s_mul_i32 s28, s27, 6554
  s_lshr_b32 s28, s28, 18
  s_mul_i32 s29, s28, 40
  s_sub_u32 s29, s27, s29
  s_mul_i32 s30, s28, 21846
  s_lshr_b32 s30, s30, 16
  s_mul_i32 s31, s30, 3
  s_sub_u32 s31, s28, s31
  s_cmp_lt_u32 s31, 2
  s_cselect_b64 vcc, -1, 0
  v_cndmask_b32 v12, v8, v10, vcc
  v_cmp_gt_u32 vcc, 20, v12
  v_lshlrev_b32 v12, 1, v12
  v_mul_u32_u24 v13, 30720, v9
  v_add_u32 v12, v12, v13
  v_cndmask_b32 v12, v15, v12, vcc
  s_mul_i32 s31, s31, 1280
  s_mul_i32 s30, s30, 40
  s_add_u32 s30, s30, s31
  s_mul_i32 s31, s29, 61440
  s_add_u32 s30, s30, s31
  s_add_u32 s31, s30, 0
  buffer_load_ushort v20, v12, s[16:19], s31 offen
  s_add_u32 s31, s30, 3840
  buffer_load_ushort v21, v12, s[16:19], s31 offen
  s_add_u32 s31, s30, 7680
  buffer_load_ushort v22, v12, s[16:19], s31 offen
  s_add_u32 s31, s30, 11520
  buffer_load_ushort v23, v12, s[16:19], s31 offen
  s_add_u32 s31, s30, 15360
  buffer_load_ushort v24, v12, s[16:19], s31 offen
  s_add_u32 s31, s30, 19200
  buffer_load_ushort v25, v12, s[16:19], s31 offen
  s_add_u32 s31, s30, 23040
  buffer_load_ushort v26, v12, s[16:19], s31 offen
  s_add_u32 s31, s30, 26880
  buffer_load_ushort v27, v12, s[16:19], s31 offen
  s_lshl_b32 s28, s27, 10
  s_add_u32 s28, s28, 0xe100000
gd_12:
  s_waitcnt vmcnt(0)
  v_lshl_or_b32 v28, v21, 16, v20
  v_lshl_or_b32 v29, v23, 16, v22
  v_lshl_or_b32 v30, v25, 16, v24
  v_lshl_or_b32 v31, v27, 16, v26
  buffer_store_dwordx4 v[28:31], v2, s[8:11], s28 offen
  s_nop 1
g_10:
  s_add_u32 s27, s26, 3072
  s_cmp_lt_u32 s27, 800
  s_cbranch_scc0 gq_14
  s_mul_i32 s28, s27, 6554
  s_lshr_b32 s28, s28, 18
  s_mul_i32 s29, s28, 40
  s_sub_u32 s29, s27, s29
  s_lshl_b32 s30, s28, 6
  s_mul_i32 s31, s29, 20480
  s_add_u32 s30, s30, s31
  v_mul_u32_u24 v12, 10240, v9
  v_lshlrev_b32 v13, 1, v10
  v_add_u32 v12, v12, v13
  s_add_u32 s31, s30, 0
  buffer_load_ushort v20, v12, s[12:15], s31 offen
  s_add_u32 s31, s30, 1280
  buffer_load_ushort v21, v12, s[12:15], s31 offen
  s_add_u32 s31, s30, 2560
  buffer_load_ushort v22, v12, s[12:15], s31 offen
  s_add_u32 s31, s30, 3840
  buffer_load_ushort v23, v12, s[12:15], s31 offen
  s_add_u32 s31, s30, 5120
  buffer_load_ushort v24, v12, s[12:15], s31 offen
  s_add_u32 s31, s30, 6400
  buffer_load_ushort v25, v12, s[12:15], s31 offen
  s_add_u32 s31, s30, 7680
  buffer_load_ushort v26, v12, s[12:15], s31 offen
  s_add_u32 s31, s30, 8960
  buffer_load_ushort v27, v12, s[12:15], s31 offen
  s_lshl_b32 s28, s27, 10
  s_add_u32 s28, s28, 0xe000000
  s_branch gd_15
gq_14:
  s_sub_u32 s27, s27, 800
  s_cmp_lt_u32 s27, 3840
  s_cbranch_scc0 g_13
  s_mul_i32 s28, s27, 6554
  s_lshr_b32 s28, s28, 18
  s_mul_i32 s29, s28, 40
  s_sub_u32 s29, s27, s29
  s_mul_i32 s30, s28, 21846
  s_lshr_b32 s30, s30, 16
  s_mul_i32 s31, s30, 3
  s_sub_u32 s31, s28, s31
  s_cmp_lt_u32 s31, 2
  s_cselect_b64 vcc, -1, 0
  v_cndmask_b32 v12, v8, v10, vcc
  v_cmp_gt_u32 vcc, 20, v12
  v_lshlrev_b32 v12, 1, v12
  v_mul_u32_u24 v13, 30720, v9
  v_add_u32 v12, v12, v13
  v_cndmask_b32 v12, v15, v12, vcc
  s_mul_i32 s31, s31, 1280
  s_mul_i32 s30, s30, 40
  s_add_u32 s30, s30, s31
  s_mul_i32 s31, s29, 61440
  s_add_u32 s30, s30, s31
  s_add_u32 s31, s30, 0
  buffer_load_ushort v20, v12, s[16:19], s31 offen
  s_add_u32 s31, s30, 3840
  buffer_load_ushort v21, v12, s[16:19], s31 offen
  s_add_u32 s31, s30, 7680
  buffer_load_ushort v22, v12, s[16:19], s31 offen
  s_add_u32 s31, s30, 11520
  buffer_load_ushort v23, v12, s[16:19], s31 offen
  s_add_u32 s31, s30, 15360
  buffer_load_ushort v24, v12, s[16:19], s31 offen
  s_add_u32 s31, s30, 19200
  buffer_load_ushort v25, v12, s[16:19], s31 offen
  s_add_u32 s31, s30, 23040
  buffer_load_ushort v26, v12, s[16:19], s31 offen
  s_add_u32 s31, s30, 26880
  buffer_load_ushort v27, v12, s[16:19], s31 offen
  s_lshl_b32 s28, s27, 10
  s_add_u32 s28, s28, 0xe100000
gd_15:
  s_waitcnt vmcnt(0)
  v_lshl_or_b32 v28, v21, 16, v20
  v_lshl_or_b32 v29, v23, 16, v22
  v_lshl_or_b32 v30, v25, 16, v24
  v_lshl_or_b32 v31, v27, 16, v26
  buffer_store_dwordx4 v[28:31], v2, s[8:11], s28 offen
  s_nop 1
g_13:
  s_add_u32 s27, s26, 4096
  s_cmp_lt_u32 s27, 800
  s_cbranch_scc0 gq_17
  s_mul_i32 s28, s27, 6554
  s_lshr_b32 s28, s28, 18
  s_mul_i32 s29, s28, 40
  s_sub_u32 s29, s27, s29
  s_lshl_b32 s30, s28, 6
  s_mul_i32 s31, s29, 20480
  s_add_u32 s30, s30, s31
  v_mul_u32_u24 v12, 10240, v9
  v_lshlrev_b32 v13, 1, v10
  v_add_u32 v12, v12, v13
  s_add_u32 s31, s30, 0
  buffer_load_ushort v20, v12, s[12:15], s31 offen
  s_add_u32 s31, s30, 1280
  buffer_load_ushort v21, v12, s[12:15], s31 offen
  s_add_u32 s31, s30, 2560
  buffer_load_ushort v22, v12, s[12:15], s31 offen
  s_add_u32 s31, s30, 3840
  buffer_load_ushort v23, v12, s[12:15], s31 offen
  s_add_u32 s31, s30, 5120
  buffer_load_ushort v24, v12, s[12:15], s31 offen
  s_add_u32 s31, s30, 6400
  buffer_load_ushort v25, v12, s[12:15], s31 offen
  s_add_u32 s31, s30, 7680
  buffer_load_ushort v26, v12, s[12:15], s31 offen
  s_add_u32 s31, s30, 8960
  buffer_load_ushort v27, v12, s[12:15], s31 offen
  s_lshl_b32 s28, s27, 10
  s_add_u32 s28, s28, 0xe000000
  s_branch gd_18
gq_17:
  s_sub_u32 s27, s27, 800
  s_cmp_lt_u32 s27, 3840
  s_cbranch_scc0 g_16
  s_mul_i32 s28, s27, 6554
  s_lshr_b32 s28, s28, 18
  s_mul_i32 s29, s28, 40
  s_sub_u32 s29, s27, s29
  s_mul_i32 s30, s28, 21846
  s_lshr_b32 s30, s30, 16
  s_mul_i32 s31, s30, 3
  s_sub_u32 s31, s28, s31
  s_cmp_lt_u32 s31, 2
  s_cselect_b64 vcc, -1, 0
  v_cndmask_b32 v12, v8, v10, vcc
  v_cmp_gt_u32 vcc, 20, v12
  v_lshlrev_b32 v12, 1, v12
  v_mul_u32_u24 v13, 30720, v9
  v_add_u32 v12, v12, v13
  v_cndmask_b32 v12, v15, v12, vcc
  s_mul_i32 s31, s31, 1280
  s_mul_i32 s30, s30, 40
  s_add_u32 s30, s30, s31
  s_mul_i32 s31, s29, 61440
  s_add_u32 s30, s30, s31
  s_add_u32 s31, s30, 0
  buffer_load_ushort v20, v12, s[16:19], s31 offen
  s_add_u32 s31, s30, 3840
  buffer_load_ushort v21, v12, s[16:19], s31 offen
  s_add_u32 s31, s30, 7680
  buffer_load_ushort v22, v12, s[16:19], s31 offen
  s_add_u32 s31, s30, 11520
  buffer_load_ushort v23, v12, s[16:19], s31 offen
  s_add_u32 s31, s30, 15360
  buffer_load_ushort v24, v12, s[16:19], s31 offen
  s_add_u32 s31, s30, 19200
  buffer_load_ushort v25, v12, s[16:19], s31 offen
  s_add_u32 s31, s30, 23040
  buffer_load_ushort v26, v12, s[16:19], s31 offen
  s_add_u32 s31, s30, 26880
  buffer_load_ushort v27, v12, s[16:19], s31 offen
  s_lshl_b32 s28, s27, 10
  s_add_u32 s28, s28, 0xe100000
gd_18:
  s_waitcnt vmcnt(0)
  v_lshl_or_b32 v28, v21, 16, v20
  v_lshl_or_b32 v29, v23, 16, v22
  v_lshl_or_b32 v30, v25, 16, v24
  v_lshl_or_b32 v31, v27, 16, v26
  buffer_store_dwordx4 v[28:31], v2, s[8:11], s28 offen
  s_nop 1
g_16:
  s_mov_b32 s12, s40
  s_and_b32 s13, s41, 0xffff
  s_mov_b32 s14, 0x780000
  s_mov_b32 s15, 0x20000
  s_mov_b32 s16, s42
  s_and_b32 s17, s43, 0xffff
  s_mov_b32 s18, 0x780000
  s_mov_b32 s19, 0x20000
  s_and_b32 s22, s2, 7
  s_lshl_b32 s22, s22, 2
  s_lshr_b32 s23, s2, 6
  s_add_u32 s22, s22, s23
  s_bfe_u32 s23, s2, 0x30003
  s_waitcnt vmcnt(0)
  v_lshrrev_b32 v8, 3, v1
  v_bfe_u32 v9, v1, 1, 2
  v_and_b32 v10, 1, v1
  s_mul_i32 s24, s22, 245760
  s_mul_i32 s25, s23, 160
  s_add_u32 s24, s24, s25
  s_add_u32 s26, s21, 0
  s_cmp_lt_u32 s26, 30
  s_cbranch_scc0 wd_19
  s_lshl_b32 s27, s26, 3
  v_add_u32 v11, s27, v8
  v_mul_u32_u24 v12, 52429, v11
  v_lshrrev_b32 v12, 18, v12
  v_mul_u32_u24 v13, 5, v12
  v_sub_u32 v13, v11, v13
  v_lshlrev_b32 v12, 2, v12
  v_add_u32 v12, v12, v9
  v_mul_u32_u24 v12, 1280, v12
  v_lshlrev_b32 v13, 5, v13
  v_add_u32 v12, v12, v13
  v_lshlrev_b32 v13, 4, v10
  v_add_u32 v12, v12, v13
  s_lshl_b32 m0, s26, 10
  s_nop 0
  buffer_load_dwordx4 v12, s[16:19], s24 offen lds
wd_19:
  s_add_u32 s26, s21, 4
  s_cmp_lt_u32 s26, 30
  s_cbranch_scc0 wd_20
  s_lshl_b32 s27, s26, 3
  v_add_u32 v11, s27, v8
  v_mul_u32_u24 v12, 52429, v11
  v_lshrrev_b32 v12, 18, v12
  v_mul_u32_u24 v13, 5, v12
  v_sub_u32 v13, v11, v13
  v_lshlrev_b32 v12, 2, v12
  v_add_u32 v12, v12, v9
  v_mul_u32_u24 v12, 1280, v12
  v_lshlrev_b32 v13, 5, v13
  v_add_u32 v12, v12, v13
  v_lshlrev_b32 v13, 4, v10
  v_add_u32 v12, v12, v13
  s_lshl_b32 m0, s26, 10
  s_nop 0
  buffer_load_dwordx4 v12, s[16:19], s24 offen lds
wd_20:
  s_add_u32 s26, s21, 8
  s_cmp_lt_u32 s26, 30
  s_cbranch_scc0 wd_21
  s_lshl_b32 s27, s26, 3
  v_add_u32 v11, s27, v8
  v_mul_u32_u24 v12, 52429, v11
  v_lshrrev_b32 v12, 18, v12
  v_mul_u32_u24 v13, 5, v12
  v_sub_u32 v13, v11, v13
  v_lshlrev_b32 v12, 2, v12
  v_add_u32 v12, v12, v9
  v_mul_u32_u24 v12, 1280, v12
  v_lshlrev_b32 v13, 5, v13
  v_add_u32 v12, v12, v13
  v_lshlrev_b32 v13, 4, v10
  v_add_u32 v12, v12, v13
  s_lshl_b32 m0, s26, 10
  s_nop 0
  buffer_load_dwordx4 v12, s[16:19], s24 offen lds
wd_21:
  s_add_u32 s26, s21, 12
  s_cmp_lt_u32 s26, 30
  s_cbranch_scc0 wd_22
  s_lshl_b32 s27, s26, 3
  v_add_u32 v11, s27, v8
  v_mul_u32_u24 v12, 52429, v11
  v_lshrrev_b32 v12, 18, v12
  v_mul_u32_u24 v13, 5, v12
  v_sub_u32 v13, v11, v13
  v_lshlrev_b32 v12, 2, v12
  v_add_u32 v12, v12, v9
  v_mul_u32_u24 v12, 1280, v12
  v_lshlrev_b32 v13, 5, v13
  v_add_u32 v12, v12, v13
  v_lshlrev_b32 v13, 4, v10
  v_add_u32 v12, v12, v13
  s_lshl_b32 m0, s26, 10
  s_nop 0
  buffer_load_dwordx4 v12, s[16:19], s24 offen lds
wd_22:
  s_add_u32 s26, s21, 16
  s_cmp_lt_u32 s26, 30
  s_cbranch_scc0 wd_23
  s_lshl_b32 s27, s26, 3
  v_add_u32 v11, s27, v8
  v_mul_u32_u24 v12, 52429, v11
  v_lshrrev_b32 v12, 18, v12
  v_mul_u32_u24 v13, 5, v12
  v_sub_u32 v13, v11, v13
  v_lshlrev_b32 v12, 2, v12
  v_add_u32 v12, v12, v9
  v_mul_u32_u24 v12, 1280, v12
  v_lshlrev_b32 v13, 5, v13
  v_add_u32 v12, v12, v13
  v_lshlrev_b32 v13, 4, v10
  v_add_u32 v12, v12, v13
  s_lshl_b32 m0, s26, 10
  s_nop 0
  buffer_load_dwordx4 v12, s[16:19], s24 offen lds
wd_23:
  s_add_u32 s26, s21, 20
  s_cmp_lt_u32 s26, 30
  s_cbranch_scc0 wd_24
  s_lshl_b32 s27, s26, 3
  v_add_u32 v11, s27, v8
  v_mul_u32_u24 v12, 52429, v11
  v_lshrrev_b32 v12, 18, v12
  v_mul_u32_u24 v13, 5, v12
  v_sub_u32 v13, v11, v13
  v_lshlrev_b32 v12, 2, v12
  v_add_u32 v12, v12, v9
  v_mul_u32_u24 v12, 1280, v12
  v_lshlrev_b32 v13, 5, v13
  v_add_u32 v12, v12, v13
  v_lshlrev_b32 v13, 4, v10
  v_add_u32 v12, v12, v13
  s_lshl_b32 m0, s26, 10
  s_nop 0
  buffer_load_dwordx4 v12, s[16:19], s24 offen lds
wd_24:
  s_add_u32 s26, s21, 24
  s_cmp_lt_u32 s26, 30
  s_cbranch_scc0 wd_25
  s_lshl_b32 s27, s26, 3
  v_add_u32 v11, s27, v8
  v_mul_u32_u24 v12, 52429, v11
  v_lshrrev_b32 v12, 18, v12
  v_mul_u32_u24 v13, 5, v12
  v_sub_u32 v13, v11, v13
  v_lshlrev_b32 v12, 2, v12
  v_add_u32 v12, v12, v9
  v_mul_u32_u24 v12, 1280, v12
  v_lshlrev_b32 v13, 5, v13
  v_add_u32 v12, v12, v13
  v_lshlrev_b32 v13, 4, v10
  v_add_u32 v12, v12, v13
  s_lshl_b32 m0, s26, 10
  s_nop 0
  buffer_load_dwordx4 v12, s[16:19], s24 offen lds
wd_25:
  s_add_u32 s26, s21, 28
  s_cmp_lt_u32 s26, 30
  s_cbranch_scc0 wd_26
  s_lshl_b32 s27, s26, 3
  v_add_u32 v11, s27, v8
  v_mul_u32_u24 v12, 52429, v11
  v_lshrrev_b32 v12, 18, v12
  v_mul_u32_u24 v13, 5, v12
  v_sub_u32 v13, v11, v13
  v_lshlrev_b32 v12, 2, v12
  v_add_u32 v12, v12, v9
  v_mul_u32_u24 v12, 1280, v12
  v_lshlrev_b32 v13, 5, v13
  v_add_u32 v12, v12, v13
  v_lshlrev_b32 v13, 4, v10
  v_add_u32 v12, v12, v13
  s_lshl_b32 m0, s26, 10
  s_nop 0
  buffer_load_dwordx4 v12, s[16:19], s24 offen lds
wd_26:
  v_lshrrev_b32 v8, 4, v1
  v_mul_u32_u24 v8, 1280, v8
  v_bfe_u32 v9, v1, 2, 2
  v_lshlrev_b32 v9, 5, v9
  v_add_u32 v8, v8, v9
  v_bfe_u32 v9, v1, 1, 1
  v_lshlrev_b32 v9, 4, v9
  v_add_u32 v8, v8, v9
  v_and_b32 v9, 1, v1
  v_lshlrev_b32 v9, 3, v9
  v_add_u32 v8, v8, v9
  s_waitcnt vmcnt(0)
  s_barrier
  ds_read_b64_tr_b16 a[0:1], v8 offset:0
  ds_read_b64_tr_b16 a[2:3], v8 offset:640
  ds_read_b64_tr_b16 a[4:5], v8 offset:128
  ds_read_b64_tr_b16 a[6:7], v8 offset:768
  ds_read_b64_tr_b16 a[8:9], v8 offset:256
  ds_read_b64_tr_b16 a[10:11], v8 offset:896
  ds_read_b64_tr_b16 a[12:13], v8 offset:384
  ds_read_b64_tr_b16 a[14:15], v8 offset:1024
  ds_read_b64_tr_b16 a[16:17], v8 offset:512
  ds_read_b64_tr_b16 a[18:19], v8 offset:1152
  ds_read_b64_tr_b16 a[20:21], v8 offset:5120
  ds_read_b64_tr_b16 a[22:23], v8 offset:5760
  s_waitcnt lgkmcnt(0)
  ds_read_b64_tr_b16 a[24:25], v8 offset:5248
  ds_read_b64_tr_b16 a[26:27], v8 offset:5888
  ds_read_b64_tr_b16 a[28:29], v8 offset:5376
  ds_read_b64_tr_b16 a[30:31], v8 offset:6016
  ds_read_b64_tr_b16 a[32:33], v8 offset:5504
  ds_read_b64_tr_b16 a[34:35], v8 offset:6144
  ds_read_b64_tr_b16 a[36:37], v8 offset:5632
  ds_read_b64_tr_b16 a[38:39], v8 offset:6272
  ds_read_b64_tr_b16 a[40:41], v8 offset:10240
  ds_read_b64_tr_b16 a[42:43], v8 offset:10880
  ds_read_b64_tr_b16 a[44:45], v8 offset:10368
  ds_read_b64_tr_b16 a[46:47], v8 offset:11008
  s_waitcnt lgkmcnt(0)
  ds_read_b64_tr_b16 a[48:49], v8 offset:10496
  ds_read_b64_tr_b16 a[50:51], v8 offset:11136
  ds_read_b64_tr_b16 a[52:53], v8 offset:10624
  ds_read_b64_tr_b16 a[54:55], v8 offset:11264
  ds_read_b64_tr_b16 a[56:57], v8 offset:10752
  ds_read_b64_tr_b16 a[58:59], v8 offset:11392
  ds_read_b64_tr_b16 a[60:61], v8 offset:15360
  ds_read_b64_tr_b16 a[62:63], v8 offset:16000
  ds_read_b64_tr_b16 a[64:65], v8 offset:15488
  ds_read_b64_tr_b16 a[66:67], v8 offset:16128
  ds_read_b64_tr_b16 a[68:69], v8 offset:15616
  ds_read_b64_tr_b16 a[70:71], v8 offset:16256
  s_waitcnt lgkmcnt(0)
  ds_read_b64_tr_b16 a[72:73], v8 offset:15744
  ds_read_b64_tr_b16 a[74:75], v8 offset:16384
  ds_read_b64_tr_b16 a[76:77], v8 offset:15872
  ds_read_b64_tr_b16 a[78:79], v8 offset:16512
  ds_read_b64_tr_b16 a[80:81], v8 offset:20480
  ds_read_b64_tr_b16 a[82:83], v8 offset:21120
  ds_read_b64_tr_b16 a[84:85], v8 offset:20608
  ds_read_b64_tr_b16 a[86:87], v8 offset:21248
  ds_read_b64_tr_b16 a[88:89], v8 offset:20736
  ds_read_b64_tr_b16 a[90:91], v8 offset:21376
  ds_read_b64_tr_b16 a[92:93], v8 offset:20864
  ds_read_b64_tr_b16 a[94:95], v8 offset:21504
  s_waitcnt lgkmcnt(0)
  ds_read_b64_tr_b16 a[96:97], v8 offset:20992
  ds_read_b64_tr_b16 a[98:99], v8 offset:21632
  ds_read_b64_tr_b16 a[100:101], v8 offset:25600
  ds_read_b64_tr_b16 a[102:103], v8 offset:26240
  ds_read_b64_tr_b16 a[104:105], v8 offset:25728
  ds_read_b64_tr_b16 a[106:107], v8 offset:26368
  ds_read_b64_tr_b16 a[108:109], v8 offset:25856
  ds_read_b64_tr_b16 a[110:111], v8 offset:26496
  ds_read_b64_tr_b16 a[112:113], v8 offset:25984
  ds_read_b64_tr_b16 a[114:115], v8 offset:26624
  ds_read_b64_tr_b16 a[116:117], v8 offset:26112
  ds_read_b64_tr_b16 a[118:119], v8 offset:26752
  s_waitcnt lgkmcnt(0)
  s_waitcnt lgkmcnt(0)
  v_and_b32 v8, 15, v1
  v_lshrrev_b32 v9, 2, v8
  v_lshlrev_b32 v9, 3, v9
  v_and_b32 v10, 3, v8
  v_add_u32 v9, v9, v10
  v_mul_u32_u24 v9, 12288, v9
  v_lshrrev_b32 v10, 4, v1
  v_lshlrev_b32 v10, 4, v10
  v_add_u32 v9, v9, v10
  v_add_u32 v10, 49152, v9
  s_mul_i32 s24, s22, 384
  s_mul_i32 s25, s21, 1966080
  s_add_u32 s24, s24, s25
  s_mul_i32 s26, s22, 40
  s_mul_i32 s27, s23, 5
  s_add_u32 s26, s26, s27
  s_mul_i32 s26, s26, 20
  s_mul_i32 s27, s21, 5
  s_add_u32 s26, s26, s27
  s_lshl_b32 s26, s26, 10
  s_add_u32 s26, s26, 0x2e00000
  s_add_u32 s27, s24, 0
  buffer_load_dwordx4 v[16:19], v9, s[12:15], s27 offen offset:0
  buffer_load_dwordx4 v[20:23], v9, s[12:15], s27 offen offset:64
  buffer_load_dwordx4 v[24:27], v9, s[12:15], s27 offen offset:128
  buffer_load_dwordx4 v[28:31], v9, s[12:15], s27 offen offset:192
  buffer_load_dwordx4 v[32:35], v9, s[12:15], s27 offen offset:256
  buffer_load_dwordx4 v[36:39], v9, s[12:15], s27 offen offset:320
  buffer_load_dwordx4 v[40:43], v10, s[12:15], s27 offen offset:0
  buffer_load_dwordx4 v[44:47], v10, s[12:15], s27 offen offset:64
  buffer_load_dwordx4 v[48:51], v10, s[12:15], s27 offen offset:128
  buffer_load_dwordx4 v[52:55], v10, s[12:15], s27 offen offset:192
  buffer_load_dwordx4 v[56:59], v10, s[12:15], s27 offen offset:256
  buffer_load_dwordx4 v[60:63], v10, s[12:15], s27 offen offset:320
  s_add_u32 s27, s24, 393216
  buffer_load_dwordx4 v[64:67], v9, s[12:15], s27 offen offset:0
  buffer_load_dwordx4 v[68:71], v9, s[12:15], s27 offen offset:64
  buffer_load_dwordx4 v[72:75], v9, s[12:15], s27 offen offset:128
  buffer_load_dwordx4 v[76:79], v9, s[12:15], s27 offen offset:192
  buffer_load_dwordx4 v[80:83], v9, s[12:15], s27 offen offset:256
  buffer_load_dwordx4 v[84:87], v9, s[12:15], s27 offen offset:320
  buffer_load_dwordx4 v[88:91], v10, s[12:15], s27 offen offset:0
  buffer_load_dwordx4 v[92:95], v10, s[12:15], s27 offen offset:64
  buffer_load_dwordx4 v[96:99], v10, s[12:15], s27 offen offset:128
  buffer_load_dwordx4 v[100:103], v10, s[12:15], s27 offen offset:192
  buffer_load_dwordx4 v[104:107], v10, s[12:15], s27 offen offset:256
  buffer_load_dwordx4 v[108:111], v10, s[12:15], s27 offen offset:320
  s_waitcnt vmcnt(12)
  v_mfma_f32_16x16x32_bf16 v[112:115], v[16:19], a[0:3], 0
  v_mfma_f32_16x16x32_bf16 v[116:119], v[16:19], a[4:7], 0
  v_mfma_f32_16x16x32_bf16 v[120:123], v[16:19], a[8:11], 0
  v_mfma_f32_16x16x32_bf16 v[124:127], v[16:19], a[12:15], 0
  v_mfma_f32_16x16x32_bf16 v[128:131], v[16:19], a[16:19], 0
  v_mfma_f32_16x16x32_bf16 v[132:135], v[40:43], a[0:3], 0
  v_mfma_f32_16x16x32_bf16 v[136:139], v[40:43], a[4:7], 0
  v_mfma_f32_16x16x32_bf16 v[140:143], v[40:43], a[8:11], 0
  v_mfma_f32_16x16x32_bf16 v[144:147], v[40:43], a[12:15], 0
  v_mfma_f32_16x16x32_bf16 v[148:151], v[40:43], a[16:19], 0
  v_mfma_f32_16x16x32_bf16 v[112:115], v[20:23], a[20:23], v[112:115]
  v_mfma_f32_16x16x32_bf16 v[116:119], v[20:23], a[24:27], v[116:119]
  v_mfma_f32_16x16x32_bf16 v[120:123], v[20:23], a[28:31], v[120:123]
  v_mfma_f32_16x16x32_bf16 v[124:127], v[20:23], a[32:35], v[124:127]
  v_mfma_f32_16x16x32_bf16 v[128:131], v[20:23], a[36:39], v[128:131]
  v_mfma_f32_16x16x32_bf16 v[132:135], v[44:47], a[20:23], v[132:135]
  v_mfma_f32_16x16x32_bf16 v[136:139], v[44:47], a[24:27], v[136:139]
  v_mfma_f32_16x16x32_bf16 v[140:143], v[44:47], a[28:31], v[140:143]
  v_mfma_f32_16x16x32_bf16 v[144:147], v[44:47], a[32:35], v[144:147]
  v_mfma_f32_16x16x32_bf16 v[148:151], v[44:47], a[36:39], v[148:151]
  v_mfma_f32_16x16x32_bf16 v[112:115], v[24:27], a[40:43], v[112:115]
  v_mfma_f32_16x16x32_bf16 v[116:119], v[24:27], a[44:47], v[116:119]
  v_mfma_f32_16x16x32_bf16 v[120:123], v[24:27], a[48:51], v[120:123]
  v_mfma_f32_16x16x32_bf16 v[124:127], v[24:27], a[52:55], v[124:127]
  v_mfma_f32_16x16x32_bf16 v[128:131], v[24:27], a[56:59], v[128:131]
  v_mfma_f32_16x16x32_bf16 v[132:135], v[48:51], a[40:43], v[132:135]
  v_mfma_f32_16x16x32_bf16 v[136:139], v[48:51], a[44:47], v[136:139]
  v_mfma_f32_16x16x32_bf16 v[140:143], v[48:51], a[48:51], v[140:143]
  v_mfma_f32_16x16x32_bf16 v[144:147], v[48:51], a[52:55], v[144:147]
  v_mfma_f32_16x16x32_bf16 v[148:151], v[48:51], a[56:59], v[148:151]
  v_mfma_f32_16x16x32_bf16 v[112:115], v[28:31], a[60:63], v[112:115]
  v_mfma_f32_16x16x32_bf16 v[116:119], v[28:31], a[64:67], v[116:119]
  v_mfma_f32_16x16x32_bf16 v[120:123], v[28:31], a[68:71], v[120:123]
  v_mfma_f32_16x16x32_bf16 v[124:127], v[28:31], a[72:75], v[124:127]
  v_mfma_f32_16x16x32_bf16 v[128:131], v[28:31], a[76:79], v[128:131]
  v_mfma_f32_16x16x32_bf16 v[132:135], v[52:55], a[60:63], v[132:135]
  v_mfma_f32_16x16x32_bf16 v[136:139], v[52:55], a[64:67], v[136:139]
  v_mfma_f32_16x16x32_bf16 v[140:143], v[52:55], a[68:71], v[140:143]
  v_mfma_f32_16x16x32_bf16 v[144:147], v[52:55], a[72:75], v[144:147]
  v_mfma_f32_16x16x32_bf16 v[148:151], v[52:55], a[76:79], v[148:151]
  v_mfma_f32_16x16x32_bf16 v[112:115], v[32:35], a[80:83], v[112:115]
  v_mfma_f32_16x16x32_bf16 v[116:119], v[32:35], a[84:87], v[116:119]
  v_mfma_f32_16x16x32_bf16 v[120:123], v[32:35], a[88:91], v[120:123]
  v_mfma_f32_16x16x32_bf16 v[124:127], v[32:35], a[92:95], v[124:127]
  v_mfma_f32_16x16x32_bf16 v[128:131], v[32:35], a[96:99], v[128:131]
  v_mfma_f32_16x16x32_bf16 v[132:135], v[56:59], a[80:83], v[132:135]
  v_mfma_f32_16x16x32_bf16 v[136:139], v[56:59], a[84:87], v[136:139]
  v_mfma_f32_16x16x32_bf16 v[140:143], v[56:59], a[88:91], v[140:143]
  v_mfma_f32_16x16x32_bf16 v[144:147], v[56:59], a[92:95], v[144:147]
  v_mfma_f32_16x16x32_bf16 v[148:151], v[56:59], a[96:99], v[148:151]
  v_mfma_f32_16x16x32_bf16 v[112:115], v[36:39], a[100:103], v[112:115]
  v_mfma_f32_16x16x32_bf16 v[116:119], v[36:39], a[104:107], v[116:119]
  v_mfma_f32_16x16x32_bf16 v[120:123], v[36:39], a[108:111], v[120:123]
  v_mfma_f32_16x16x32_bf16 v[124:127], v[36:39], a[112:115], v[124:127]
  v_mfma_f32_16x16x32_bf16 v[128:131], v[36:39], a[116:119], v[128:131]
  v_mfma_f32_16x16x32_bf16 v[132:135], v[60:63], a[100:103], v[132:135]
  v_mfma_f32_16x16x32_bf16 v[136:139], v[60:63], a[104:107], v[136:139]
  v_mfma_f32_16x16x32_bf16 v[140:143], v[60:63], a[108:111], v[140:143]
  v_mfma_f32_16x16x32_bf16 v[144:147], v[60:63], a[112:115], v[144:147]
  v_mfma_f32_16x16x32_bf16 v[148:151], v[60:63], a[116:119], v[148:151]
  s_nop 7
  v_cvt_pk_bf16_f32 v160, v112, v113
  v_cvt_pk_bf16_f32 v161, v114, v115
  v_cvt_pk_bf16_f32 v162, v132, v133
  v_cvt_pk_bf16_f32 v163, v134, v135
  s_add_u32 s27, s26, 0
  buffer_store_dwordx4 v[160:163], v2, s[8:11], s27 offen
  v_cvt_pk_bf16_f32 v164, v116, v117
  v_cvt_pk_bf16_f32 v165, v118, v119
  v_cvt_pk_bf16_f32 v166, v136, v137
  v_cvt_pk_bf16_f32 v167, v138, v139
  s_add_u32 s27, s26, 20480
  buffer_store_dwordx4 v[164:167], v2, s[8:11], s27 offen
  v_cvt_pk_bf16_f32 v160, v120, v121
  v_cvt_pk_bf16_f32 v161, v122, v123
  v_cvt_pk_bf16_f32 v162, v140, v141
  v_cvt_pk_bf16_f32 v163, v142, v143
  s_add_u32 s27, s26, 40960
  buffer_store_dwordx4 v[160:163], v2, s[8:11], s27 offen
  v_cvt_pk_bf16_f32 v164, v124, v125
  v_cvt_pk_bf16_f32 v165, v126, v127
  v_cvt_pk_bf16_f32 v166, v144, v145
  v_cvt_pk_bf16_f32 v167, v146, v147
  s_add_u32 s27, s26, 61440
  buffer_store_dwordx4 v[164:167], v2, s[8:11], s27 offen
  v_cvt_pk_bf16_f32 v160, v128, v129
  v_cvt_pk_bf16_f32 v161, v130, v131
  v_cvt_pk_bf16_f32 v162, v148, v149
  v_cvt_pk_bf16_f32 v163, v150, v151
  s_add_u32 s27, s26, 81920
  buffer_store_dwordx4 v[160:163], v2, s[8:11], s27 offen
  s_add_u32 s27, s24, 786432
  buffer_load_dwordx4 v[16:19], v9, s[12:15], s27 offen offset:0
  buffer_load_dwordx4 v[20:23], v9, s[12:15], s27 offen offset:64
  buffer_load_dwordx4 v[24:27], v9, s[12:15], s27 offen offset:128
  buffer_load_dwordx4 v[28:31], v9, s[12:15], s27 offen offset:192
  buffer_load_dwordx4 v[32:35], v9, s[12:15], s27 offen offset:256
  buffer_load_dwordx4 v[36:39], v9, s[12:15], s27 offen offset:320
  buffer_load_dwordx4 v[40:43], v10, s[12:15], s27 offen offset:0
  buffer_load_dwordx4 v[44:47], v10, s[12:15], s27 offen offset:64
  buffer_load_dwordx4 v[48:51], v10, s[12:15], s27 offen offset:128
  buffer_load_dwordx4 v[52:55], v10, s[12:15], s27 offen offset:192
  buffer_load_dwordx4 v[56:59], v10, s[12:15], s27 offen offset:256
  buffer_load_dwordx4 v[60:63], v10, s[12:15], s27 offen offset:320
  s_waitcnt vmcnt(17)
  v_mfma_f32_16x16x32_bf16 v[112:115], v[64:67], a[0:3], 0
  v_mfma_f32_16x16x32_bf16 v[116:119], v[64:67], a[4:7], 0
  v_mfma_f32_16x16x32_bf16 v[120:123], v[64:67], a[8:11], 0
  v_mfma_f32_16x16x32_bf16 v[124:127], v[64:67], a[12:15], 0
  v_mfma_f32_16x16x32_bf16 v[128:131], v[64:67], a[16:19], 0
  v_mfma_f32_16x16x32_bf16 v[132:135], v[88:91], a[0:3], 0
  v_mfma_f32_16x16x32_bf16 v[136:139], v[88:91], a[4:7], 0
  v_mfma_f32_16x16x32_bf16 v[140:143], v[88:91], a[8:11], 0
  v_mfma_f32_16x16x32_bf16 v[144:147], v[88:91], a[12:15], 0
  v_mfma_f32_16x16x32_bf16 v[148:151], v[88:91], a[16:19], 0
  v_mfma_f32_16x16x32_bf16 v[112:115], v[68:71], a[20:23], v[112:115]
  v_mfma_f32_16x16x32_bf16 v[116:119], v[68:71], a[24:27], v[116:119]
  v_mfma_f32_16x16x32_bf16 v[120:123], v[68:71], a[28:31], v[120:123]
  v_mfma_f32_16x16x32_bf16 v[124:127], v[68:71], a[32:35], v[124:127]
  v_mfma_f32_16x16x32_bf16 v[128:131], v[68:71], a[36:39], v[128:131]
  v_mfma_f32_16x16x32_bf16 v[132:135], v[92:95], a[20:23], v[132:135]
  v_mfma_f32_16x16x32_bf16 v[136:139], v[92:95], a[24:27], v[136:139]
  v_mfma_f32_16x16x32_bf16 v[140:143], v[92:95], a[28:31], v[140:143]
  v_mfma_f32_16x16x32_bf16 v[144:147], v[92:95], a[32:35], v[144:147]
  v_mfma_f32_16x16x32_bf16 v[148:151], v[92:95], a[36:39], v[148:151]
  v_mfma_f32_16x16x32_bf16 v[112:115], v[72:75], a[40:43], v[112:115]
  v_mfma_f32_16x16x32_bf16 v[116:119], v[72:75], a[44:47], v[116:119]
  v_mfma_f32_16x16x32_bf16 v[120:123], v[72:75], a[48:51], v[120:123]
  v_mfma_f32_16x16x32_bf16 v[124:127], v[72:75], a[52:55], v[124:127]
  v_mfma_f32_16x16x32_bf16 v[128:131], v[72:75], a[56:59], v[128:131]
  v_mfma_f32_16x16x32_bf16 v[132:135], v[96:99], a[40:43], v[132:135]
  v_mfma_f32_16x16x32_bf16 v[136:139], v[96:99], a[44:47], v[136:139]
  v_mfma_f32_16x16x32_bf16 v[140:143], v[96:99], a[48:51], v[140:143]
  v_mfma_f32_16x16x32_bf16 v[144:147], v[96:99], a[52:55], v[144:147]
  v_mfma_f32_16x16x32_bf16 v[148:151], v[96:99], a[56:59], v[148:151]
  v_mfma_f32_16x16x32_bf16 v[112:115], v[76:79], a[60:63], v[112:115]
  v_mfma_f32_16x16x32_bf16 v[116:119], v[76:79], a[64:67], v[116:119]
  v_mfma_f32_16x16x32_bf16 v[120:123], v[76:79], a[68:71], v[120:123]
  v_mfma_f32_16x16x32_bf16 v[124:127], v[76:79], a[72:75], v[124:127]
  v_mfma_f32_16x16x32_bf16 v[128:131], v[76:79], a[76:79], v[128:131]
  v_mfma_f32_16x16x32_bf16 v[132:135], v[100:103], a[60:63], v[132:135]
  v_mfma_f32_16x16x32_bf16 v[136:139], v[100:103], a[64:67], v[136:139]
  v_mfma_f32_16x16x32_bf16 v[140:143], v[100:103], a[68:71], v[140:143]
  v_mfma_f32_16x16x32_bf16 v[144:147], v[100:103], a[72:75], v[144:147]
  v_mfma_f32_16x16x32_bf16 v[148:151], v[100:103], a[76:79], v[148:151]
  v_mfma_f32_16x16x32_bf16 v[112:115], v[80:83], a[80:83], v[112:115]
  v_mfma_f32_16x16x32_bf16 v[116:119], v[80:83], a[84:87], v[116:119]
  v_mfma_f32_16x16x32_bf16 v[120:123], v[80:83], a[88:91], v[120:123]
  v_mfma_f32_16x16x32_bf16 v[124:127], v[80:83], a[92:95], v[124:127]
  v_mfma_f32_16x16x32_bf16 v[128:131], v[80:83], a[96:99], v[128:131]
  v_mfma_f32_16x16x32_bf16 v[132:135], v[104:107], a[80:83], v[132:135]
  v_mfma_f32_16x16x32_bf16 v[136:139], v[104:107], a[84:87], v[136:139]
  v_mfma_f32_16x16x32_bf16 v[140:143], v[104:107], a[88:91], v[140:143]
  v_mfma_f32_16x16x32_bf16 v[144:147], v[104:107], a[92:95], v[144:147]
  v_mfma_f32_16x16x32_bf16 v[148:151], v[104:107], a[96:99], v[148:151]
  v_mfma_f32_16x16x32_bf16 v[112:115], v[84:87], a[100:103], v[112:115]
  v_mfma_f32_16x16x32_bf16 v[116:119], v[84:87], a[104:107], v[116:119]
  v_mfma_f32_16x16x32_bf16 v[120:123], v[84:87], a[108:111], v[120:123]
  v_mfma_f32_16x16x32_bf16 v[124:127], v[84:87], a[112:115], v[124:127]
  v_mfma_f32_16x16x32_bf16 v[128:131], v[84:87], a[116:119], v[128:131]
  v_mfma_f32_16x16x32_bf16 v[132:135], v[108:111], a[100:103], v[132:135]
  v_mfma_f32_16x16x32_bf16 v[136:139], v[108:111], a[104:107], v[136:139]
  v_mfma_f32_16x16x32_bf16 v[140:143], v[108:111], a[108:111], v[140:143]
  v_mfma_f32_16x16x32_bf16 v[144:147], v[108:111], a[112:115], v[144:147]
  v_mfma_f32_16x16x32_bf16 v[148:151], v[108:111], a[116:119], v[148:151]
  s_nop 7
  v_cvt_pk_bf16_f32 v160, v112, v113
  v_cvt_pk_bf16_f32 v161, v114, v115
  v_cvt_pk_bf16_f32 v162, v132, v133
  v_cvt_pk_bf16_f32 v163, v134, v135
  s_add_u32 s27, s26, 1024
  buffer_store_dwordx4 v[160:163], v2, s[8:11], s27 offen
  v_cvt_pk_bf16_f32 v164, v116, v117
  v_cvt_pk_bf16_f32 v165, v118, v119
  v_cvt_pk_bf16_f32 v166, v136, v137
  v_cvt_pk_bf16_f32 v167, v138, v139
  s_add_u32 s27, s26, 21504
  buffer_store_dwordx4 v[164:167], v2, s[8:11], s27 offen
  v_cvt_pk_bf16_f32 v160, v120, v121
  v_cvt_pk_bf16_f32 v161, v122, v123
  v_cvt_pk_bf16_f32 v162, v140, v141
  v_cvt_pk_bf16_f32 v163, v142, v143
  s_add_u32 s27, s26, 41984
  buffer_store_dwordx4 v[160:163], v2, s[8:11], s27 offen
  v_cvt_pk_bf16_f32 v164, v124, v125
  v_cvt_pk_bf16_f32 v165, v126, v127
  v_cvt_pk_bf16_f32 v166, v144, v145
  v_cvt_pk_bf16_f32 v167, v146, v147
  s_add_u32 s27, s26, 62464
  buffer_store_dwordx4 v[164:167], v2, s[8:11], s27 offen
  v_cvt_pk_bf16_f32 v160, v128, v129
  v_cvt_pk_bf16_f32 v161, v130, v131
  v_cvt_pk_bf16_f32 v162, v148, v149
  v_cvt_pk_bf16_f32 v163, v150, v151
  s_add_u32 s27, s26, 82944
  buffer_store_dwordx4 v[160:163], v2, s[8:11], s27 offen
  s_add_u32 s27, s24, 1179648
  buffer_load_dwordx4 v[64:67], v9, s[12:15], s27 offen offset:0
  buffer_load_dwordx4 v[68:71], v9, s[12:15], s27 offen offset:64
  buffer_load_dwordx4 v[72:75], v9, s[12:15], s27 offen offset:128
  buffer_load_dwordx4 v[76:79], v9, s[12:15], s27 offen offset:192
  buffer_load_dwordx4 v[80:83], v9, s[12:15], s27 offen offset:256
  buffer_load_dwordx4 v[84:87], v9, s[12:15], s27 offen offset:320
  buffer_load_dwordx4 v[88:91], v10, s[12:15], s27 offen offset:0
  buffer_load_dwordx4 v[92:95], v10, s[12:15], s27 offen offset:64
  buffer_load_dwordx4 v[96:99], v10, s[12:15], s27 offen offset:128
  buffer_load_dwordx4 v[100:103], v10, s[12:15], s27 offen offset:192
  buffer_load_dwordx4 v[104:107], v10, s[12:15], s27 offen offset:256
  buffer_load_dwordx4 v[108:111], v10, s[12:15], s27 offen offset:320
  s_waitcnt vmcnt(17)
  v_mfma_f32_16x16x32_bf16 v[112:115], v[16:19], a[0:3], 0
  v_mfma_f32_16x16x32_bf16 v[116:119], v[16:19], a[4:7], 0
  v_mfma_f32_16x16x32_bf16 v[120:123], v[16:19], a[8:11], 0
  v_mfma_f32_16x16x32_bf16 v[124:127], v[16:19], a[12:15], 0
  v_mfma_f32_16x16x32_bf16 v[128:131], v[16:19], a[16:19], 0
  v_mfma_f32_16x16x32_bf16 v[132:135], v[40:43], a[0:3], 0
  v_mfma_f32_16x16x32_bf16 v[136:139], v[40:43], a[4:7], 0
  v_mfma_f32_16x16x32_bf16 v[140:143], v[40:43], a[8:11], 0
  v_mfma_f32_16x16x32_bf16 v[144:147], v[40:43], a[12:15], 0
  v_mfma_f32_16x16x32_bf16 v[148:151], v[40:43], a[16:19], 0
  v_mfma_f32_16x16x32_bf16 v[112:115], v[20:23], a[20:23], v[112:115]
  v_mfma_f32_16x16x32_bf16 v[116:119], v[20:23], a[24:27], v[116:119]
  v_mfma_f32_16x16x32_bf16 v[120:123], v[20:23], a[28:31], v[120:123]
  v_mfma_f32_16x16x32_bf16 v[124:127], v[20:23], a[32:35], v[124:127]
  v_mfma_f32_16x16x32_bf16 v[128:131], v[20:23], a[36:39], v[128:131]
  v_mfma_f32_16x16x32_bf16 v[132:135], v[44:47], a[20:23], v[132:135]
  v_mfma_f32_16x16x32_bf16 v[136:139], v[44:47], a[24:27], v[136:139]
  v_mfma_f32_16x16x32_bf16 v[140:143], v[44:47], a[28:31], v[140:143]
  v_mfma_f32_16x16x32_bf16 v[144:147], v[44:47], a[32:35], v[144:147]
  v_mfma_f32_16x16x32_bf16 v[148:151], v[44:47], a[36:39], v[148:151]
  v_mfma_f32_16x16x32_bf16 v[112:115], v[24:27], a[40:43], v[112:115]
  v_mfma_f32_16x16x32_bf16 v[116:119], v[24:27], a[44:47], v[116:119]
  v_mfma_f32_16x16x32_bf16 v[120:123], v[24:27], a[48:51], v[120:123]
  v_mfma_f32_16x16x32_bf16 v[124:127], v[24:27], a[52:55], v[124:127]
  v_mfma_f32_16x16x32_bf16 v[128:131], v[24:27], a[56:59], v[128:131]
  v_mfma_f32_16x16x32_bf16 v[132:135], v[48:51], a[40:43], v[132:135]
  v_mfma_f32_16x16x32_bf16 v[136:139], v[48:51], a[44:47], v[136:139]
  v_mfma_f32_16x16x32_bf16 v[140:143], v[48:51], a[48:51], v[140:143]
  v_mfma_f32_16x16x32_bf16 v[144:147], v[48:51], a[52:55], v[144:147]
  v_mfma_f32_16x16x32_bf16 v[148:151], v[48:51], a[56:59], v[148:151]
  v_mfma_f32_16x16x32_bf16 v[112:115], v[28:31], a[60:63], v[112:115]
  v_mfma_f32_16x16x32_bf16 v[116:119], v[28:31], a[64:67], v[116:119]
  v_mfma_f32_16x16x32_bf16 v[120:123], v[28:31], a[68:71], v[120:123]
  v_mfma_f32_16x16x32_bf16 v[124:127], v[28:31], a[72:75], v[124:127]
  v_mfma_f32_16x16x32_bf16 v[128:131], v[28:31], a[76:79], v[128:131]
  v_mfma_f32_16x16x32_bf16 v[132:135], v[52:55], a[60:63], v[132:135]
  v_mfma_f32_16x16x32_bf16 v[136:139], v[52:55], a[64:67], v[136:139]
  v_mfma_f32_16x16x32_bf16 v[140:143], v[52:55], a[68:71], v[140:143]
  v_mfma_f32_16x16x32_bf16 v[144:147], v[52:55], a[72:75], v[144:147]
  v_mfma_f32_16x16x32_bf16 v[148:151], v[52:55], a[76:79], v[148:151]
  v_mfma_f32_16x16x32_bf16 v[112:115], v[32:35], a[80:83], v[112:115]
  v_mfma_f32_16x16x32_bf16 v[116:119], v[32:35], a[84:87], v[116:119]
  v_mfma_f32_16x16x32_bf16 v[120:123], v[32:35], a[88:91], v[120:123]
  v_mfma_f32_16x16x32_bf16 v[124:127], v[32:35], a[92:95], v[124:127]
  v_mfma_f32_16x16x32_bf16 v[128:131], v[32:35], a[96:99], v[128:131]
  v_mfma_f32_16x16x32_bf16 v[132:135], v[56:59], a[80:83], v[132:135]
  v_mfma_f32_16x16x32_bf16 v[136:139], v[56:59], a[84:87], v[136:139]
  v_mfma_f32_16x16x32_bf16 v[140:143], v[56:59], a[88:91], v[140:143]
  v_mfma_f32_16x16x32_bf16 v[144:147], v[56:59], a[92:95], v[144:147]
  v_mfma_f32_16x16x32_bf16 v[148:151], v[56:59], a[96:99], v[148:151]
  v_mfma_f32_16x16x32_bf16 v[112:115], v[36:39], a[100:103], v[112:115]
  v_mfma_f32_16x16x32_bf16 v[116:119], v[36:39], a[104:107], v[116:119]
  v_mfma_f32_16x16x32_bf16 v[120:123], v[36:39], a[108:111], v[120:123]
  v_mfma_f32_16x16x32_bf16 v[124:127], v[36:39], a[112:115], v[124:127]
  v_mfma_f32_16x16x32_bf16 v[128:131], v[36:39], a[116:119], v[128:131]
  v_mfma_f32_16x16x32_bf16 v[132:135], v[60:63], a[100:103], v[132:135]
  v_mfma_f32_16x16x32_bf16 v[136:139], v[60:63], a[104:107], v[136:139]
  v_mfma_f32_16x16x32_bf16 v[140:143], v[60:63], a[108:111], v[140:143]
  v_mfma_f32_16x16x32_bf16 v[144:147], v[60:63], a[112:115], v[144:147]
  v_mfma_f32_16x16x32_bf16 v[148:151], v[60:63], a[116:119], v[148:151]
  s_nop 7
  v_cvt_pk_bf16_f32 v160, v112, v113
  v_cvt_pk_bf16_f32 v161, v114, v115
  v_cvt_pk_bf16_f32 v162, v132, v133
  v_cvt_pk_bf16_f32 v163, v134, v135
  s_add_u32 s27, s26, 2048
  buffer_store_dwordx4 v[160:163], v2, s[8:11], s27 offen
  v_cvt_pk_bf16_f32 v164, v116, v117
  v_cvt_pk_bf16_f32 v165, v118, v119
  v_cvt_pk_bf16_f32 v166, v136, v137
  v_cvt_pk_bf16_f32 v167, v138, v139
  s_add_u32 s27, s26, 22528
  buffer_store_dwordx4 v[164:167], v2, s[8:11], s27 offen
  v_cvt_pk_bf16_f32 v160, v120, v121
  v_cvt_pk_bf16_f32 v161, v122, v123
  v_cvt_pk_bf16_f32 v162, v140, v141
  v_cvt_pk_bf16_f32 v163, v142, v143
  s_add_u32 s27, s26, 43008
  buffer_store_dwordx4 v[160:163], v2, s[8:11], s27 offen
  v_cvt_pk_bf16_f32 v164, v124, v125
  v_cvt_pk_bf16_f32 v165, v126, v127
  v_cvt_pk_bf16_f32 v166, v144, v145
  v_cvt_pk_bf16_f32 v167, v146, v147
  s_add_u32 s27, s26, 63488
  buffer_store_dwordx4 v[164:167], v2, s[8:11], s27 offen
  v_cvt_pk_bf16_f32 v160, v128, v129
  v_cvt_pk_bf16_f32 v161, v130, v131
  v_cvt_pk_bf16_f32 v162, v148, v149
  v_cvt_pk_bf16_f32 v163, v150, v151
  s_add_u32 s27, s26, 83968
  buffer_store_dwordx4 v[160:163], v2, s[8:11], s27 offen
  s_add_u32 s27, s24, 1572864
  buffer_load_dwordx4 v[16:19], v9, s[12:15], s27 offen offset:0
  buffer_load_dwordx4 v[20:23], v9, s[12:15], s27 offen offset:64
  buffer_load_dwordx4 v[24:27], v9, s[12:15], s27 offen offset:128
  buffer_load_dwordx4 v[28:31], v9, s[12:15], s27 offen offset:192
  buffer_load_dwordx4 v[32:35], v9, s[12:15], s27 offen offset:256
  buffer_load_dwordx4 v[36:39], v9, s[12:15], s27 offen offset:320
  buffer_load_dwordx4 v[40:43], v10, s[12:15], s27 offen offset:0
  buffer_load_dwordx4 v[44:47], v10, s[12:15], s27 offen offset:64
  buffer_load_dwordx4 v[48:51], v10, s[12:15], s27 offen offset:128
  buffer_load_dwordx4 v[52:55], v10, s[12:15], s27 offen offset:192
  buffer_load_dwordx4 v[56:59], v10, s[12:15], s27 offen offset:256
  buffer_load_dwordx4 v[60:63], v10, s[12:15], s27 offen offset:320
  s_waitcnt vmcnt(17)
  v_mfma_f32_16x16x32_bf16 v[112:115], v[64:67], a[0:3], 0
  v_mfma_f32_16x16x32_bf16 v[116:119], v[64:67], a[4:7], 0
  v_mfma_f32_16x16x32_bf16 v[120:123], v[64:67], a[8:11], 0
  v_mfma_f32_16x16x32_bf16 v[124:127], v[64:67], a[12:15], 0
  v_mfma_f32_16x16x32_bf16 v[128:131], v[64:67], a[16:19], 0
  v_mfma_f32_16x16x32_bf16 v[132:135], v[88:91], a[0:3], 0
  v_mfma_f32_16x16x32_bf16 v[136:139], v[88:91], a[4:7], 0
  v_mfma_f32_16x16x32_bf16 v[140:143], v[88:91], a[8:11], 0
  v_mfma_f32_16x16x32_bf16 v[144:147], v[88:91], a[12:15], 0
  v_mfma_f32_16x16x32_bf16 v[148:151], v[88:91], a[16:19], 0
  v_mfma_f32_16x16x32_bf16 v[112:115], v[68:71], a[20:23], v[112:115]
  v_mfma_f32_16x16x32_bf16 v[116:119], v[68:71], a[24:27], v[116:119]
  v_mfma_f32_16x16x32_bf16 v[120:123], v[68:71], a[28:31], v[120:123]
  v_mfma_f32_16x16x32_bf16 v[124:127], v[68:71], a[32:35], v[124:127]
  v_mfma_f32_16x16x32_bf16 v[128:131], v[68:71], a[36:39], v[128:131]
  v_mfma_f32_16x16x32_bf16 v[132:135], v[92:95], a[20:23], v[132:135]
  v_mfma_f32_16x16x32_bf16 v[136:139], v[92:95], a[24:27], v[136:139]
  v_mfma_f32_16x16x32_bf16 v[140:143], v[92:95], a[28:31], v[140:143]
  v_mfma_f32_16x16x32_bf16 v[144:147], v[92:95], a[32:35], v[144:147]
  v_mfma_f32_16x16x32_bf16 v[148:151], v[92:95], a[36:39], v[148:151]
  v_mfma_f32_16x16x32_bf16 v[112:115], v[72:75], a[40:43], v[112:115]
  v_mfma_f32_16x16x32_bf16 v[116:119], v[72:75], a[44:47], v[116:119]
  v_mfma_f32_16x16x32_bf16 v[120:123], v[72:75], a[48:51], v[120:123]
  v_mfma_f32_16x16x32_bf16 v[124:127], v[72:75], a[52:55], v[124:127]
  v_mfma_f32_16x16x32_bf16 v[128:131], v[72:75], a[56:59], v[128:131]
  v_mfma_f32_16x16x32_bf16 v[132:135], v[96:99], a[40:43], v[132:135]
  v_mfma_f32_16x16x32_bf16 v[136:139], v[96:99], a[44:47], v[136:139]
  v_mfma_f32_16x16x32_bf16 v[140:143], v[96:99], a[48:51], v[140:143]
  v_mfma_f32_16x16x32_bf16 v[144:147], v[96:99], a[52:55], v[144:147]
  v_mfma_f32_16x16x32_bf16 v[148:151], v[96:99], a[56:59], v[148:151]
  v_mfma_f32_16x16x32_bf16 v[112:115], v[76:79], a[60:63], v[112:115]
  v_mfma_f32_16x16x32_bf16 v[116:119], v[76:79], a[64:67], v[116:119]
  v_mfma_f32_16x16x32_bf16 v[120:123], v[76:79], a[68:71], v[120:123]
  v_mfma_f32_16x16x32_bf16 v[124:127], v[76:79], a[72:75], v[124:127]
  v_mfma_f32_16x16x32_bf16 v[128:131], v[76:79], a[76:79], v[128:131]
  v_mfma_f32_16x16x32_bf16 v[132:135], v[100:103], a[60:63], v[132:135]
  v_mfma_f32_16x16x32_bf16 v[136:139], v[100:103], a[64:67], v[136:139]
  v_mfma_f32_16x16x32_bf16 v[140:143], v[100:103], a[68:71], v[140:143]
  v_mfma_f32_16x16x32_bf16 v[144:147], v[100:103], a[72:75], v[144:147]
  v_mfma_f32_16x16x32_bf16 v[148:151], v[100:103], a[76:79], v[148:151]
  v_mfma_f32_16x16x32_bf16 v[112:115], v[80:83], a[80:83], v[112:115]
  v_mfma_f32_16x16x32_bf16 v[116:119], v[80:83], a[84:87], v[116:119]
  v_mfma_f32_16x16x32_bf16 v[120:123], v[80:83], a[88:91], v[120:123]
  v_mfma_f32_16x16x32_bf16 v[124:127], v[80:83], a[92:95], v[124:127]
  v_mfma_f32_16x16x32_bf16 v[128:131], v[80:83], a[96:99], v[128:131]
  v_mfma_f32_16x16x32_bf16 v[132:135], v[104:107], a[80:83], v[132:135]
  v_mfma_f32_16x16x32_bf16 v[136:139], v[104:107], a[84:87], v[136:139]
  v_mfma_f32_16x16x32_bf16 v[140:143], v[104:107], a[88:91], v[140:143]
  v_mfma_f32_16x16x32_bf16 v[144:147], v[104:107], a[92:95], v[144:147]
  v_mfma_f32_16x16x32_bf16 v[148:151], v[104:107], a[96:99], v[148:151]
  v_mfma_f32_16x16x32_bf16 v[112:115], v[84:87], a[100:103], v[112:115]
  v_mfma_f32_16x16x32_bf16 v[116:119], v[84:87], a[104:107], v[116:119]
  v_mfma_f32_16x16x32_bf16 v[120:123], v[84:87], a[108:111], v[120:123]
  v_mfma_f32_16x16x32_bf16 v[124:127], v[84:87], a[112:115], v[124:127]
  v_mfma_f32_16x16x32_bf16 v[128:131], v[84:87], a[116:119], v[128:131]
  v_mfma_f32_16x16x32_bf16 v[132:135], v[108:111], a[100:103], v[132:135]
  v_mfma_f32_16x16x32_bf16 v[136:139], v[108:111], a[104:107], v[136:139]
  v_mfma_f32_16x16x32_bf16 v[140:143], v[108:111], a[108:111], v[140:143]
  v_mfma_f32_16x16x32_bf16 v[144:147], v[108:111], a[112:115], v[144:147]
  v_mfma_f32_16x16x32_bf16 v[148:151], v[108:111], a[116:119], v[148:151]
  s_nop 7
  v_cvt_pk_bf16_f32 v160, v112, v113
  v_cvt_pk_bf16_f32 v161, v114, v115
  v_cvt_pk_bf16_f32 v162, v132, v133
  v_cvt_pk_bf16_f32 v163, v134, v135
  s_add_u32 s27, s26, 3072
  buffer_store_dwordx4 v[160:163], v2, s[8:11], s27 offen
  v_cvt_pk_bf16_f32 v164, v116, v117
  v_cvt_pk_bf16_f32 v165, v118, v119
  v_cvt_pk_bf16_f32 v166, v136, v137
  v_cvt_pk_bf16_f32 v167, v138, v139
  s_add_u32 s27, s26, 23552
  buffer_store_dwordx4 v[164:167], v2, s[8:11], s27 offen
  v_cvt_pk_bf16_f32 v160, v120, v121
  v_cvt_pk_bf16_f32 v161, v122, v123
  v_cvt_pk_bf16_f32 v162, v140, v141
  v_cvt_pk_bf16_f32 v163, v142, v143
  s_add_u32 s27, s26, 44032
  buffer_store_dwordx4 v[160:163], v2, s[8:11], s27 offen
  v_cvt_pk_bf16_f32 v164, v124, v125
  v_cvt_pk_bf16_f32 v165, v126, v127
  v_cvt_pk_bf16_f32 v166, v144, v145
  v_cvt_pk_bf16_f32 v167, v146, v147
  s_add_u32 s27, s26, 64512
  buffer_store_dwordx4 v[164:167], v2, s[8:11], s27 offen
  v_cvt_pk_bf16_f32 v160, v128, v129
  v_cvt_pk_bf16_f32 v161, v130, v131
  v_cvt_pk_bf16_f32 v162, v148, v149
  v_cvt_pk_bf16_f32 v163, v150, v151
  s_add_u32 s27, s26, 84992
  buffer_store_dwordx4 v[160:163], v2, s[8:11], s27 offen
  s_waitcnt vmcnt(5)
  v_mfma_f32_16x16x32_bf16 v[112:115], v[16:19], a[0:3], 0
  v_mfma_f32_16x16x32_bf16 v[116:119], v[16:19], a[4:7], 0
  v_mfma_f32_16x16x32_bf16 v[120:123], v[16:19], a[8:11], 0
  v_mfma_f32_16x16x32_bf16 v[124:127], v[16:19], a[12:15], 0
  v_mfma_f32_16x16x32_bf16 v[128:131], v[16:19], a[16:19], 0
  v_mfma_f32_16x16x32_bf16 v[132:135], v[40:43], a[0:3], 0
  v_mfma_f32_16x16x32_bf16 v[136:139], v[40:43], a[4:7], 0
  v_mfma_f32_16x16x32_bf16 v[140:143], v[40:43], a[8:11], 0
  v_mfma_f32_16x16x32_bf16 v[144:147], v[40:43], a[12:15], 0
  v_mfma_f32_16x16x32_bf16 v[148:151], v[40:43], a[16:19], 0
  v_mfma_f32_16x16x32_bf16 v[112:115], v[20:23], a[20:23], v[112:115]
  v_mfma_f32_16x16x32_bf16 v[116:119], v[20:23], a[24:27], v[116:119]
  v_mfma_f32_16x16x32_bf16 v[120:123], v[20:23], a[28:31], v[120:123]
  v_mfma_f32_16x16x32_bf16 v[124:127], v[20:23], a[32:35], v[124:127]
  v_mfma_f32_16x16x32_bf16 v[128:131], v[20:23], a[36:39], v[128:131]
  v_mfma_f32_16x16x32_bf16 v[132:135], v[44:47], a[20:23], v[132:135]
  v_mfma_f32_16x16x32_bf16 v[136:139], v[44:47], a[24:27], v[136:139]
  v_mfma_f32_16x16x32_bf16 v[140:143], v[44:47], a[28:31], v[140:143]
  v_mfma_f32_16x16x32_bf16 v[144:147], v[44:47], a[32:35], v[144:147]
  v_mfma_f32_16x16x32_bf16 v[148:151], v[44:47], a[36:39], v[148:151]
  v_mfma_f32_16x16x32_bf16 v[112:115], v[24:27], a[40:43], v[112:115]
  v_mfma_f32_16x16x32_bf16 v[116:119], v[24:27], a[44:47], v[116:119]
  v_mfma_f32_16x16x32_bf16 v[120:123], v[24:27], a[48:51], v[120:123]
  v_mfma_f32_16x16x32_bf16 v[124:127], v[24:27], a[52:55], v[124:127]
  v_mfma_f32_16x16x32_bf16 v[128:131], v[24:27], a[56:59], v[128:131]
  v_mfma_f32_16x16x32_bf16 v[132:135], v[48:51], a[40:43], v[132:135]
  v_mfma_f32_16x16x32_bf16 v[136:139], v[48:51], a[44:47], v[136:139]
  v_mfma_f32_16x16x32_bf16 v[140:143], v[48:51], a[48:51], v[140:143]
  v_mfma_f32_16x16x32_bf16 v[144:147], v[48:51], a[52:55], v[144:147]
  v_mfma_f32_16x16x32_bf16 v[148:151], v[48:51], a[56:59], v[148:151]
  v_mfma_f32_16x16x32_bf16 v[112:115], v[28:31], a[60:63], v[112:115]
  v_mfma_f32_16x16x32_bf16 v[116:119], v[28:31], a[64:67], v[116:119]
  v_mfma_f32_16x16x32_bf16 v[120:123], v[28:31], a[68:71], v[120:123]
  v_mfma_f32_16x16x32_bf16 v[124:127], v[28:31], a[72:75], v[124:127]
  v_mfma_f32_16x16x32_bf16 v[128:131], v[28:31], a[76:79], v[128:131]
  v_mfma_f32_16x16x32_bf16 v[132:135], v[52:55], a[60:63], v[132:135]
  v_mfma_f32_16x16x32_bf16 v[136:139], v[52:55], a[64:67], v[136:139]
  v_mfma_f32_16x16x32_bf16 v[140:143], v[52:55], a[68:71], v[140:143]
  v_mfma_f32_16x16x32_bf16 v[144:147], v[52:55], a[72:75], v[144:147]
  v_mfma_f32_16x16x32_bf16 v[148:151], v[52:55], a[76:79], v[148:151]
  v_mfma_f32_16x16x32_bf16 v[112:115], v[32:35], a[80:83], v[112:115]
  v_mfma_f32_16x16x32_bf16 v[116:119], v[32:35], a[84:87], v[116:119]
  v_mfma_f32_16x16x32_bf16 v[120:123], v[32:35], a[88:91], v[120:123]
  v_mfma_f32_16x16x32_bf16 v[124:127], v[32:35], a[92:95], v[124:127]
  v_mfma_f32_16x16x32_bf16 v[128:131], v[32:35], a[96:99], v[128:131]
  v_mfma_f32_16x16x32_bf16 v[132:135], v[56:59], a[80:83], v[132:135]
  v_mfma_f32_16x16x32_bf16 v[136:139], v[56:59], a[84:87], v[136:139]
  v_mfma_f32_16x16x32_bf16 v[140:143], v[56:59], a[88:91], v[140:143]
  v_mfma_f32_16x16x32_bf16 v[144:147], v[56:59], a[92:95], v[144:147]
  v_mfma_f32_16x16x32_bf16 v[148:151], v[56:59], a[96:99], v[148:151]
  v_mfma_f32_16x16x32_bf16 v[112:115], v[36:39], a[100:103], v[112:115]
  v_mfma_f32_16x16x32_bf16 v[116:119], v[36:39], a[104:107], v[116:119]
  v_mfma_f32_16x16x32_bf16 v[120:123], v[36:39], a[108:111], v[120:123]
  v_mfma_f32_16x16x32_bf16 v[124:127], v[36:39], a[112:115], v[124:127]
  v_mfma_f32_16x16x32_bf16 v[128:131], v[36:39], a[116:119], v[128:131]
  v_mfma_f32_16x16x32_bf16 v[132:135], v[60:63], a[100:103], v[132:135]
  v_mfma_f32_16x16x32_bf16 v[136:139], v[60:63], a[104:107], v[136:139]
  v_mfma_f32_16x16x32_bf16 v[140:143], v[60:63], a[108:111], v[140:143]
  v_mfma_f32_16x16x32_bf16 v[144:147], v[60:63], a[112:115], v[144:147]
  v_mfma_f32_16x16x32_bf16 v[148:151], v[60:63], a[116:119], v[148:151]
  s_nop 7
  v_cvt_pk_bf16_f32 v160, v112, v113
  v_cvt_pk_bf16_f32 v161, v114, v115
  v_cvt_pk_bf16_f32 v162, v132, v133
  v_cvt_pk_bf16_f32 v163, v134, v135
  s_add_u32 s27, s26, 4096
  buffer_store_dwordx4 v[160:163], v2, s[8:11], s27 offen
  v_cvt_pk_bf16_f32 v164, v116, v117
  v_cvt_pk_bf16_f32 v165, v118, v119
  v_cvt_pk_bf16_f32 v166, v136, v137
  v_cvt_pk_bf16_f32 v167, v138, v139
  s_add_u32 s27, s26, 24576
  buffer_store_dwordx4 v[164:167], v2, s[8:11], s27 offen
  v_cvt_pk_bf16_f32 v160, v120, v121
  v_cvt_pk_bf16_f32 v161, v122, v123
  v_cvt_pk_bf16_f32 v162, v140, v141
  v_cvt_pk_bf16_f32 v163, v142, v143
  s_add_u32 s27, s26, 45056
  buffer_store_dwordx4 v[160:163], v2, s[8:11], s27 offen
  v_cvt_pk_bf16_f32 v164, v124, v125
  v_cvt_pk_bf16_f32 v165, v126, v127
  v_cvt_pk_bf16_f32 v166, v144, v145
  v_cvt_pk_bf16_f32 v167, v146, v147
  s_add_u32 s27, s26, 65536
  buffer_store_dwordx4 v[164:167], v2, s[8:11], s27 offen
  v_cvt_pk_bf16_f32 v160, v128, v129
  v_cvt_pk_bf16_f32 v161, v130, v131
  v_cvt_pk_bf16_f32 v162, v148, v149
  v_cvt_pk_bf16_f32 v163, v150, v151
  s_add_u32 s27, s26, 86016
  buffer_store_dwordx4 v[160:163], v2, s[8:11], s27 offen
k0_exit:
  s_endpgm

.section .rodata,"a"
.p2align 6
.amdhsa_kernel prep_kernel
  .amdhsa_next_free_vgpr 512
  .amdhsa_next_free_sgpr 102
  .amdhsa_accum_offset 256
  .amdhsa_group_segment_fixed_size 0
  .amdhsa_kernarg_size 104
  .amdhsa_user_sgpr_count 2
  .amdhsa_user_sgpr_kernarg_segment_ptr 1
  .amdhsa_system_sgpr_workgroup_id_x 1
.end_amdhsa_kernel
.text
.globl ka_kernel
.p2align 8
.type ka_kernel,@function
ka_kernel:
  s_cmp_ge_u32 s2, 256
  s_cbranch_scc1 ka_exit

  s_load_dwordx2 s[4:5], s[0:1], 96
  s_load_dwordx2 s[6:7], s[0:1], 88
  s_load_dwordx4 s[36:39], s[0:1], 16
  s_load_dwordx4 s[40:43], s[0:1], 32
  s_getreg_b32 s26, hwreg(HW_REG_XCC_ID)
  s_and_b32 s26, s26, 15
  v_lshrrev_b32 v1, 6, v0
  s_nop 0
  v_readfirstlane_b32 s21, v1
  s_waitcnt lgkmcnt(0)
  s_mov_b32 s8, s4
  s_and_b32 s9, s5, 0xffff
  s_mov_b32 s10, 0x10000000
  s_mov_b32 s11, 0x20000
  s_cmp_eq_u32 s21, 0
  s_cbranch_scc0 ka_cen_done
  s_mov_b64 s[24:25], exec
  s_mov_b64 exec, 1
  v_mov_b32 v3, 1
  s_lshl_b32 s27, s26, 2
  v_mov_b32 v4, s27
  global_atomic_add v5, v4, v3, s[6:7] sc0
  v_mov_b32 v4, 64
  s_waitcnt vmcnt(0)
  global_atomic_add v6, v4, v3, s[6:7] sc0
  s_mov_b32 s45, 0
  s_waitcnt vmcnt(0)
ka_cen_spin:
  global_load_dword v7, v4, s[6:7] sc1
  s_add_u32 s45, s45, 1
  s_waitcnt vmcnt(0)
  v_readfirstlane_b32 s27, v7
  s_cmp_ge_u32 s27, 256
  s_cbranch_scc1 ka_cen_ok
  s_cmp_lt_u32 s45, 400000
  s_cbranch_scc1 ka_cen_spin
ka_cen_ok:
  s_mov_b64 exec, 0xff
  v_lshlrev_b32 v4, 2, v0
  global_load_dword v7, v4, s[6:7] sc1
  s_waitcnt vmcnt(0)
  v_cmp_ne_u32 vcc, 32, v7
  s_nop 1
  s_cmp_eq_u64 vcc, 0
  s_cselect_b32 s27, 1, 0
  s_cmp_ge_u32 s27, 1
  s_cselect_b32 s27, 1, 0
  s_mov_b64 exec, 1
  v_mov_b32 v8, s27
  v_mov_b32 v4, 0
  v_mov_b32 v9, 0
  ds_write_b128 v4, v[6:9]
  ds_write_b32 v4, v5 offset:16
  s_waitcnt lgkmcnt(0)
  s_mov_b64 exec, s[24:25]
ka_cen_done:
  s_barrier
  v_mov_b32 v4, 0
  ds_read_b128 v[6:9], v4
  ds_read_b32 v5, v4 offset:16
  s_waitcnt lgkmcnt(0)
  v_readfirstlane_b32 s27, v6
  v_readfirstlane_b32 s44, v8
  v_readfirstlane_b32 s28, v5
  s_barrier
  s_cmp_eq_u32 s44, 1
  s_cbranch_scc1 ka_cen_fast
  s_lshr_b32 s20, s27, 5
  s_and_b32 s22, s27, 31
  s_branch ka_cen_end
ka_cen_fast:
  s_mov_b32 s20, s26
  s_mov_b32 s22, s28
ka_cen_end:
  s_and_b32 s20, s20, 7
  s_and_b32 s22, s22, 31
  s_cmp_lt_u32 s20, 4
  s_cbranch_scc0 ka_bulk
  s_cmp_lt_u32 s22, 8
  s_cbranch_scc0 ka_noty
  s_lshl_b32 s23, s20, 3
  s_add_u32 s23, s23, s22
  s_cmp_eq_u32 s44, 1
  s_cbranch_scc1 kaf_x
  s_branch kas_x
ka_noty:
  s_cmp_lt_u32 s22, 28
  s_cbranch_scc0 ka_exit
  s_sub_u32 s23, s22, 8
  s_cmp_eq_u32 s44, 1
  s_cbranch_scc1 kaf_y
  s_branch kas_y
ka_bulk:
  s_sub_u32 s28, s20, 4
  s_lshl_b32 s23, s22, 2
  s_add_u32 s23, s23, s28
  s_cmp_lt_u32 s23, 72
  s_cbranch_scc1 ka_qkv
  s_sub_u32 s23, s23, 72
  s_cmp_lt_u32 s23, 32
  s_cbranch_scc1 ka_u
  s_branch ka_exit
ka_qkv:
  s_mul_i32 s26, s23, 43
  s_lshr_b32 s26, s26, 10
  s_mul_i32 s27, s26, 24
  s_sub_u32 s27, s23, s27
  s_cmp_eq_u32 s26, 0
  s_cselect_b32 s28, s36, s38
  s_cselect_b32 s29, s37, s39
  s_cmp_eq_u32 s26, 2
  s_cselect_b32 s28, s40, s28
  s_cselect_b32 s29, s41, s29
  s_mov_b32 s12, s28
  s_and_b32 s13, s29, 0xffff
  s_mov_b32 s14, 0x780000
  s_mov_b32 s15, 0x20000
  s_mul_i32 s46, s26, 0x1800000
  s_add_u32 s46, s46, 0x4800000
  s_lshl_b32 s47, s26, 10
  s_lshl_b32 s28, s27, 2
  s_add_u32 s47, s47, s28
  s_add_u32 s47, s47, 0
  s_lshl_b32 s28, s27, 3
  s_lshl_b32 s29, s21, 1
  s_add_u32 s28, s28, s29
  s_add_u32 s29, s28, 0
  s_mul_i32 s30, s29, 171
  s_lshr_b32 s30, s30, 10
  s_mul_i32 s31, s30, 6
  s_sub_u32 s31, s29, s31
  s_mul_i32 s30, s30, 786432
  s_lshl_b32 s31, s31, 11
  s_add_u32 s30, s30, s31
  s_add_u32 s48, s30, s46
  s_add_u32 s29, s28, 1
  s_mul_i32 s30, s29, 171
  s_lshr_b32 s30, s30, 10
  s_mul_i32 s31, s30, 6
  s_sub_u32 s31, s29, s31
  s_mul_i32 s30, s30, 786432
  s_lshl_b32 s31, s31, 11
  s_add_u32 s30, s30, s31
  s_add_u32 s49, s30, s46
  v_and_b32 v1, 63, v0
  v_lshrrev_b32 v2, 4, v1
  v_bfe_u32 v3, v1, 2, 2
  v_and_b32 v4, 3, v1
  s_lshr_b32 s28, s21, 1
  s_lshl_b32 s28, s28, 2
  v_add_u32 v5, s28, v3
  v_mul_u32_u24 v5, 12288, v5
  s_and_b32 s28, s21, 1
  s_lshl_b32 s28, s28, 8
  s_lshl_b32 s29, s27, 9
  s_add_u32 s28, s28, s29
  v_add_u32 v5, s28, v5
  v_lshlrev_b32 v6, 6, v2
  v_add_u32 v5, v5, v6
  v_lshlrev_b32 v6, 4, v4
  v_add_u32 v5, v5, v6
  v_lshrrev_b32 v6, 1, v2
  v_lshlrev_b32 v7, 12, v6
  v_lshlrev_b32 v6, 6, v3
  v_add_u32 v7, v7, v6
  v_and_b32 v6, 1, v2
  v_lshlrev_b32 v6, 5, v6
  v_add_u32 v7, v7, v6
  v_lshrrev_b32 v6, 1, v4
  v_lshlrev_b32 v6, 4, v6
  v_add_u32 v7, v7, v6
  v_and_b32 v6, 1, v4
  v_lshlrev_b32 v6, 3, v6
  v_add_u32 v7, v7, v6
  s_lshl_b32 s28, s21, 9
  v_add_u32 v7, s28, v7
  s_lshl_b32 s29, s21, 10
  s_add_u32 m0, s29, 0
  s_mov_b32 s28, 0
  buffer_load_dwordx4 v5, s[12:15], s28 offen lds
  s_lshl_b32 s29, s21, 10
  s_add_u32 m0, s29, 4096
  s_mov_b32 s28, 98304
  buffer_load_dwordx4 v5, s[12:15], s28 offen lds
  s_lshl_b32 s29, s21, 10
  s_add_u32 m0, s29, 8192
  s_mov_b32 s28, 196608
  buffer_load_dwordx4 v5, s[12:15], s28 offen lds
  s_lshl_b32 s29, s21, 10
  s_add_u32 m0, s29, 12288
  s_mov_b32 s28, 294912
  buffer_load_dwordx4 v5, s[12:15], s28 offen lds
  s_lshl_b32 s29, s21, 10
  s_add_u32 m0, s29, 16384
  s_mov_b32 s28, 393216
  buffer_load_dwordx4 v5, s[12:15], s28 offen lds
  s_lshl_b32 s29, s21, 10
  s_add_u32 m0, s29, 20480
  s_mov_b32 s28, 491520
  buffer_load_dwordx4 v5, s[12:15], s28 offen lds
  s_lshl_b32 s29, s21, 10
  s_add_u32 m0, s29, 24576
  s_mov_b32 s28, 589824
  buffer_load_dwordx4 v5, s[12:15], s28 offen lds
  s_lshl_b32 s29, s21, 10
  s_add_u32 m0, s29, 28672
  s_mov_b32 s28, 688128
  buffer_load_dwordx4 v5, s[12:15], s28 offen lds
  s_lshl_b32 s29, s21, 10
  s_add_u32 m0, s29, 32768
  s_mov_b32 s28, 786432
  buffer_load_dwordx4 v5, s[12:15], s28 offen lds
  s_lshl_b32 s29, s21, 10
  s_add_u32 m0, s29, 36864
  s_mov_b32 s28, 884736
  buffer_load_dwordx4 v5, s[12:15], s28 offen lds
  s_lshl_b32 s29, s21, 10
  s_add_u32 m0, s29, 40960
  s_mov_b32 s28, 983040
  buffer_load_dwordx4 v5, s[12:15], s28 offen lds
  s_lshl_b32 s29, s21, 10
  s_add_u32 m0, s29, 45056
  s_mov_b32 s28, 1081344
  buffer_load_dwordx4 v5, s[12:15], s28 offen lds
  s_lshl_b32 s29, s21, 10
  s_add_u32 m0, s29, 49152
  s_mov_b32 s28, 1179648
  buffer_load_dwordx4 v5, s[12:15], s28 offen lds
  s_lshl_b32 s29, s21, 10
  s_add_u32 m0, s29, 53248
  s_mov_b32 s28, 1277952
  buffer_load_dwordx4 v5, s[12:15], s28 offen lds
  s_lshl_b32 s29, s21, 10
  s_add_u32 m0, s29, 57344
  s_mov_b32 s28, 1376256
  buffer_load_dwordx4 v5, s[12:15], s28 offen lds
  s_lshl_b32 s29, s21, 10
  s_add_u32 m0, s29, 61440
  s_mov_b32 s28, 1474560
  buffer_load_dwordx4 v5, s[12:15], s28 offen lds
  s_lshl_b32 s29, s21, 10
  s_add_u32 m0, s29, 65536
  s_mov_b32 s28, 1572864
  buffer_load_dwordx4 v5, s[12:15], s28 offen lds
  s_lshl_b32 s29, s21, 10
  s_add_u32 m0, s29, 69632
  s_mov_b32 s28, 1671168
  buffer_load_dwordx4 v5, s[12:15], s28 offen lds
  s_lshl_b32 s29, s21, 10
  s_add_u32 m0, s29, 73728
  s_mov_b32 s28, 1769472
  buffer_load_dwordx4 v5, s[12:15], s28 offen lds
  s_lshl_b32 s29, s21, 10
  s_add_u32 m0, s29, 77824
  s_mov_b32 s28, 1867776
  buffer_load_dwordx4 v5, s[12:15], s28 offen lds
  s_lshl_b32 s29, s21, 10
  s_add_u32 m0, s29, 81920
  s_mov_b32 s28, 1966080
  buffer_load_dwordx4 v5, s[12:15], s28 offen lds
  s_lshl_b32 s29, s21, 10
  s_add_u32 m0, s29, 86016
  s_mov_b32 s28, 2064384
  buffer_load_dwordx4 v5, s[12:15], s28 offen lds
  s_lshl_b32 s29, s21, 10
  s_add_u32 m0, s29, 90112
  s_mov_b32 s28, 2162688
  buffer_load_dwordx4 v5, s[12:15], s28 offen lds
  s_lshl_b32 s29, s21, 10
  s_add_u32 m0, s29, 94208
  s_mov_b32 s28, 2260992
  buffer_load_dwordx4 v5, s[12:15], s28 offen lds
  s_waitcnt vmcnt(20)
  s_barrier
  s_lshl_b32 s29, s21, 10
  s_add_u32 m0, s29, 98304
  s_mov_b32 s28, 2359296
  buffer_load_dwordx4 v5, s[12:15], s28 offen lds
  s_lshl_b32 s29, s21, 10
  s_add_u32 m0, s29, 102400
  s_mov_b32 s28, 2457600
  buffer_load_dwordx4 v5, s[12:15], s28 offen lds
  s_lshl_b32 s29, s21, 10
  s_add_u32 m0, s29, 106496
  s_mov_b32 s28, 2555904
  buffer_load_dwordx4 v5, s[12:15], s28 offen lds
  s_lshl_b32 s29, s21, 10
  s_add_u32 m0, s29, 110592
  s_mov_b32 s28, 2654208
  buffer_load_dwordx4 v5, s[12:15], s28 offen lds
  v_add_u32 v8, 0, v7
  ds_read_b64_tr_b16 a[0:1], v8 offset:0
  ds_read_b64_tr_b16 a[2:3], v8 offset:2048
  ds_read_b64_tr_b16 a[4:5], v8 offset:8192
  ds_read_b64_tr_b16 a[6:7], v8 offset:10240
  ds_read_b64_tr_b16 a[160:161], v8 offset:256
  ds_read_b64_tr_b16 a[162:163], v8 offset:2304
  ds_read_b64_tr_b16 a[164:165], v8 offset:8448
  ds_read_b64_tr_b16 a[166:167], v8 offset:10496
  s_waitcnt lgkmcnt(0)
  s_waitcnt vmcnt(20)
  s_barrier
  s_lshl_b32 s29, s21, 10
  s_add_u32 m0, s29, 114688
  s_mov_b32 s28, 2752512
  buffer_load_dwordx4 v5, s[12:15], s28 offen lds
  s_lshl_b32 s29, s21, 10
  s_add_u32 m0, s29, 118784
  s_mov_b32 s28, 2850816
  buffer_load_dwordx4 v5, s[12:15], s28 offen lds
  s_lshl_b32 s29, s21, 10
  s_add_u32 m0, s29, 122880
  s_mov_b32 s28, 2949120
  buffer_load_dwordx4 v5, s[12:15], s28 offen lds
  s_lshl_b32 s29, s21, 10
  s_add_u32 m0, s29, 126976
  s_mov_b32 s28, 3047424
  buffer_load_dwordx4 v5, s[12:15], s28 offen lds
  v_add_u32 v8, 16384, v7
  ds_read_b64_tr_b16 a[8:9], v8 offset:0
  ds_read_b64_tr_b16 a[10:11], v8 offset:2048
  ds_read_b64_tr_b16 a[12:13], v8 offset:8192
  ds_read_b64_tr_b16 a[14:15], v8 offset:10240
  ds_read_b64_tr_b16 a[168:169], v8 offset:256
  ds_read_b64_tr_b16 a[170:171], v8 offset:2304
  ds_read_b64_tr_b16 a[172:173], v8 offset:8448
  ds_read_b64_tr_b16 a[174:175], v8 offset:10496
  s_waitcnt lgkmcnt(0)
  s_waitcnt vmcnt(20)
  s_barrier
  s_lshl_b32 s29, s21, 10
  s_add_u32 m0, s29, 0
  s_mov_b32 s28, 3145728
  buffer_load_dwordx4 v5, s[12:15], s28 offen lds
  s_lshl_b32 s29, s21, 10
  s_add_u32 m0, s29, 4096
  s_mov_b32 s28, 3244032
  buffer_load_dwordx4 v5, s[12:15], s28 offen lds
  s_lshl_b32 s29, s21, 10
  s_add_u32 m0, s29, 8192
  s_mov_b32 s28, 3342336
  buffer_load_dwordx4 v5, s[12:15], s28 offen lds
  s_lshl_b32 s29, s21, 10
  s_add_u32 m0, s29, 12288
  s_mov_b32 s28, 3440640
  buffer_load_dwordx4 v5, s[12:15], s28 offen lds
  v_add_u32 v8, 32768, v7
  ds_read_b64_tr_b16 a[16:17], v8 offset:0
  ds_read_b64_tr_b16 a[18:19], v8 offset:2048
  ds_read_b64_tr_b16 a[20:21], v8 offset:8192
  ds_read_b64_tr_b16 a[22:23], v8 offset:10240
  ds_read_b64_tr_b16 a[176:177], v8 offset:256
  ds_read_b64_tr_b16 a[178:179], v8 offset:2304
  ds_read_b64_tr_b16 a[180:181], v8 offset:8448
  ds_read_b64_tr_b16 a[182:183], v8 offset:10496
  s_waitcnt lgkmcnt(0)
  s_waitcnt vmcnt(20)
  s_barrier
  s_lshl_b32 s29, s21, 10
  s_add_u32 m0, s29, 16384
  s_mov_b32 s28, 3538944
  buffer_load_dwordx4 v5, s[12:15], s28 offen lds
  s_lshl_b32 s29, s21, 10
  s_add_u32 m0, s29, 20480
  s_mov_b32 s28, 3637248
  buffer_load_dwordx4 v5, s[12:15], s28 offen lds
  s_lshl_b32 s29, s21, 10
  s_add_u32 m0, s29, 24576
  s_mov_b32 s28, 3735552
  buffer_load_dwordx4 v5, s[12:15], s28 offen lds
  s_lshl_b32 s29, s21, 10
  s_add_u32 m0, s29, 28672
  s_mov_b32 s28, 3833856
  buffer_load_dwordx4 v5, s[12:15], s28 offen lds
  v_add_u32 v8, 49152, v7
  ds_read_b64_tr_b16 a[24:25], v8 offset:0
  ds_read_b64_tr_b16 a[26:27], v8 offset:2048
  ds_read_b64_tr_b16 a[28:29], v8 offset:8192
  ds_read_b64_tr_b16 a[30:31], v8 offset:10240
  ds_read_b64_tr_b16 a[184:185], v8 offset:256
  ds_read_b64_tr_b16 a[186:187], v8 offset:2304
  ds_read_b64_tr_b16 a[188:189], v8 offset:8448
  ds_read_b64_tr_b16 a[190:191], v8 offset:10496
  s_waitcnt lgkmcnt(0)
  s_waitcnt vmcnt(20)
  s_barrier
  s_lshl_b32 s29, s21, 10
  s_add_u32 m0, s29, 32768
  s_mov_b32 s28, 3932160
  buffer_load_dwordx4 v5, s[12:15], s28 offen lds
  s_lshl_b32 s29, s21, 10
  s_add_u32 m0, s29, 36864
  s_mov_b32 s28, 4030464
  buffer_load_dwordx4 v5, s[12:15], s28 offen lds
  s_lshl_b32 s29, s21, 10
  s_add_u32 m0, s29, 40960
  s_mov_b32 s28, 4128768
  buffer_load_dwordx4 v5, s[12:15], s28 offen lds
  s_lshl_b32 s29, s21, 10
  s_add_u32 m0, s29, 45056
  s_mov_b32 s28, 4227072
  buffer_load_dwordx4 v5, s[12:15], s28 offen lds
  v_add_u32 v8, 65536, v7
  ds_read_b64_tr_b16 a[32:33], v8 offset:0
  ds_read_b64_tr_b16 a[34:35], v8 offset:2048
  ds_read_b64_tr_b16 a[36:37], v8 offset:8192
  ds_read_b64_tr_b16 a[38:39], v8 offset:10240
  ds_read_b64_tr_b16 a[192:193], v8 offset:256
  ds_read_b64_tr_b16 a[194:195], v8 offset:2304
  ds_read_b64_tr_b16 a[196:197], v8 offset:8448
  ds_read_b64_tr_b16 a[198:199], v8 offset:10496
  s_waitcnt lgkmcnt(0)
  s_waitcnt vmcnt(20)
  s_barrier
  s_lshl_b32 s29, s21, 10
  s_add_u32 m0, s29, 49152
  s_mov_b32 s28, 4325376
  buffer_load_dwordx4 v5, s[12:15], s28 offen lds
  s_lshl_b32 s29, s21, 10
  s_add_u32 m0, s29, 53248
  s_mov_b32 s28, 4423680
  buffer_load_dwordx4 v5, s[12:15], s28 offen lds
  s_lshl_b32 s29, s21, 10
  s_add_u32 m0, s29, 57344
  s_mov_b32 s28, 4521984
  buffer_load_dwordx4 v5, s[12:15], s28 offen lds
  s_lshl_b32 s29, s21, 10
  s_add_u32 m0, s29, 61440
  s_mov_b32 s28, 4620288
  buffer_load_dwordx4 v5, s[12:15], s28 offen lds
  v_add_u32 v8, 81920, v7
  ds_read_b64_tr_b16 a[40:41], v8 offset:0
  ds_read_b64_tr_b16 a[42:43], v8 offset:2048
  ds_read_b64_tr_b16 a[44:45], v8 offset:8192
  ds_read_b64_tr_b16 a[46:47], v8 offset:10240
  ds_read_b64_tr_b16 a[200:201], v8 offset:256
  ds_read_b64_tr_b16 a[202:203], v8 offset:2304
  ds_read_b64_tr_b16 a[204:205], v8 offset:8448
  ds_read_b64_tr_b16 a[206:207], v8 offset:10496
  s_waitcnt lgkmcnt(0)
  s_waitcnt vmcnt(20)
  s_barrier
  s_lshl_b32 s29, s21, 10
  s_add_u32 m0, s29, 65536
  s_mov_b32 s28, 4718592
  buffer_load_dwordx4 v5, s[12:15], s28 offen lds
  s_lshl_b32 s29, s21, 10
  s_add_u32 m0, s29, 69632
  s_mov_b32 s28, 4816896
  buffer_load_dwordx4 v5, s[12:15], s28 offen lds
  s_lshl_b32 s29, s21, 10
  s_add_u32 m0, s29, 73728
  s_mov_b32 s28, 4915200
  buffer_load_dwordx4 v5, s[12:15], s28 offen lds
  s_lshl_b32 s29, s21, 10
  s_add_u32 m0, s29, 77824
  s_mov_b32 s28, 5013504
  buffer_load_dwordx4 v5, s[12:15], s28 offen lds
  v_add_u32 v8, 98304, v7
  ds_read_b64_tr_b16 a[48:49], v8 offset:0
  ds_read_b64_tr_b16 a[50:51], v8 offset:2048
  ds_read_b64_tr_b16 a[52:53], v8 offset:8192
  ds_read_b64_tr_b16 a[54:55], v8 offset:10240
  ds_read_b64_tr_b16 a[208:209], v8 offset:256
  ds_read_b64_tr_b16 a[210:211], v8 offset:2304
  ds_read_b64_tr_b16 a[212:213], v8 offset:8448
  ds_read_b64_tr_b16 a[214:215], v8 offset:10496
  s_waitcnt lgkmcnt(0)
  s_waitcnt vmcnt(20)
  s_barrier
  s_lshl_b32 s29, s21, 10
  s_add_u32 m0, s29, 81920
  s_mov_b32 s28, 5111808
  buffer_load_dwordx4 v5, s[12:15], s28 offen lds
  s_lshl_b32 s29, s21, 10
  s_add_u32 m0, s29, 86016
  s_mov_b32 s28, 5210112
  buffer_load_dwordx4 v5, s[12:15], s28 offen lds
  s_lshl_b32 s29, s21, 10
  s_add_u32 m0, s29, 90112
  s_mov_b32 s28, 5308416
  buffer_load_dwordx4 v5, s[12:15], s28 offen lds
  s_lshl_b32 s29, s21, 10
  s_add_u32 m0, s29, 94208
  s_mov_b32 s28, 5406720
  buffer_load_dwordx4 v5, s[12:15], s28 offen lds
  v_add_u32 v8, 114688, v7
  ds_read_b64_tr_b16 a[56:57], v8 offset:0
  ds_read_b64_tr_b16 a[58:59], v8 offset:2048
  ds_read_b64_tr_b16 a[60:61], v8 offset:8192
  ds_read_b64_tr_b16 a[62:63], v8 offset:10240
  ds_read_b64_tr_b16 a[216:217], v8 offset:256
  ds_read_b64_tr_b16 a[218:219], v8 offset:2304
  ds_read_b64_tr_b16 a[220:221], v8 offset:8448
  ds_read_b64_tr_b16 a[222:223], v8 offset:10496
  s_waitcnt lgkmcnt(0)
  s_waitcnt vmcnt(20)
  s_barrier
  s_lshl_b32 s29, s21, 10
  s_add_u32 m0, s29, 98304
  s_mov_b32 s28, 5505024
  buffer_load_dwordx4 v5, s[12:15], s28 offen lds
  s_lshl_b32 s29, s21, 10
  s_add_u32 m0, s29, 102400
  s_mov_b32 s28, 5603328
  buffer_load_dwordx4 v5, s[12:15], s28 offen lds
  s_lshl_b32 s29, s21, 10
  s_add_u32 m0, s29, 106496
  s_mov_b32 s28, 5701632
  buffer_load_dwordx4 v5, s[12:15], s28 offen lds
  s_lshl_b32 s29, s21, 10
  s_add_u32 m0, s29, 110592
  s_mov_b32 s28, 5799936
  buffer_load_dwordx4 v5, s[12:15], s28 offen lds
  v_add_u32 v8, 0, v7
  ds_read_b64_tr_b16 a[64:65], v8 offset:0
  ds_read_b64_tr_b16 a[66:67], v8 offset:2048
  ds_read_b64_tr_b16 a[68:69], v8 offset:8192
  ds_read_b64_tr_b16 a[70:71], v8 offset:10240
  ds_read_b64_tr_b16 a[224:225], v8 offset:256
  ds_read_b64_tr_b16 a[226:227], v8 offset:2304
  ds_read_b64_tr_b16 a[228:229], v8 offset:8448
  ds_read_b64_tr_b16 a[230:231], v8 offset:10496
  s_waitcnt lgkmcnt(0)
  s_waitcnt vmcnt(20)
  s_barrier
  s_lshl_b32 s29, s21, 10
  s_add_u32 m0, s29, 114688
  s_mov_b32 s28, 5898240
  buffer_load_dwordx4 v5, s[12:15], s28 offen lds
  s_lshl_b32 s29, s21, 10
  s_add_u32 m0, s29, 118784
  s_mov_b32 s28, 5996544
  buffer_load_dwordx4 v5, s[12:15], s28 offen lds
  s_lshl_b32 s29, s21, 10
  s_add_u32 m0, s29, 122880
  s_mov_b32 s28, 6094848
  buffer_load_dwordx4 v5, s[12:15], s28 offen lds
  s_lshl_b32 s29, s21, 10
  s_add_u32 m0, s29, 126976
  s_mov_b32 s28, 6193152
  buffer_load_dwordx4 v5, s[12:15], s28 offen lds
  v_add_u32 v8, 16384, v7
  ds_read_b64_tr_b16 a[72:73], v8 offset:0
  ds_read_b64_tr_b16 a[74:75], v8 offset:2048
  ds_read_b64_tr_b16 a[76:77], v8 offset:8192
  ds_read_b64_tr_b16 a[78:79], v8 offset:10240
  ds_read_b64_tr_b16 a[232:233], v8 offset:256
  ds_read_b64_tr_b16 a[234:235], v8 offset:2304
  ds_read_b64_tr_b16 a[236:237], v8 offset:8448
  ds_read_b64_tr_b16 a[238:239], v8 offset:10496
  s_waitcnt lgkmcnt(0)
  s_waitcnt vmcnt(20)
  s_barrier
  s_lshl_b32 s29, s21, 10
  s_add_u32 m0, s29, 0
  s_mov_b32 s28, 6291456
  buffer_load_dwordx4 v5, s[12:15], s28 offen lds
  s_lshl_b32 s29, s21, 10
  s_add_u32 m0, s29, 4096
  s_mov_b32 s28, 6389760
  buffer_load_dwordx4 v5, s[12:15], s28 offen lds
  s_lshl_b32 s29, s21, 10
  s_add_u32 m0, s29, 8192
  s_mov_b32 s28, 6488064
  buffer_load_dwordx4 v5, s[12:15], s28 offen lds
  s_lshl_b32 s29, s21, 10
  s_add_u32 m0, s29, 12288
  s_mov_b32 s28, 6586368
  buffer_load_dwordx4 v5, s[12:15], s28 offen lds
  v_add_u32 v8, 32768, v7
  ds_read_b64_tr_b16 a[80:81], v8 offset:0
  ds_read_b64_tr_b16 a[82:83], v8 offset:2048
  ds_read_b64_tr_b16 a[84:85], v8 offset:8192
  ds_read_b64_tr_b16 a[86:87], v8 offset:10240
  ds_read_b64_tr_b16 a[240:241], v8 offset:256
  ds_read_b64_tr_b16 a[242:243], v8 offset:2304
  ds_read_b64_tr_b16 a[244:245], v8 offset:8448
  ds_read_b64_tr_b16 a[246:247], v8 offset:10496
  s_waitcnt lgkmcnt(0)
  s_waitcnt vmcnt(20)
  s_barrier
  s_lshl_b32 s29, s21, 10
  s_add_u32 m0, s29, 16384
  s_mov_b32 s28, 6684672
  buffer_load_dwordx4 v5, s[12:15], s28 offen lds
  s_lshl_b32 s29, s21, 10
  s_add_u32 m0, s29, 20480
  s_mov_b32 s28, 6782976
  buffer_load_dwordx4 v5, s[12:15], s28 offen lds
  s_lshl_b32 s29, s21, 10
  s_add_u32 m0, s29, 24576
  s_mov_b32 s28, 6881280
  buffer_load_dwordx4 v5, s[12:15], s28 offen lds
  s_lshl_b32 s29, s21, 10
  s_add_u32 m0, s29, 28672
  s_mov_b32 s28, 6979584
  buffer_load_dwordx4 v5, s[12:15], s28 offen lds
  v_add_u32 v8, 49152, v7
  ds_read_b64_tr_b16 a[88:89], v8 offset:0
  ds_read_b64_tr_b16 a[90:91], v8 offset:2048
  ds_read_b64_tr_b16 a[92:93], v8 offset:8192
  ds_read_b64_tr_b16 a[94:95], v8 offset:10240
  ds_read_b64_tr_b16 a[248:249], v8 offset:256
  ds_read_b64_tr_b16 a[250:251], v8 offset:2304
  ds_read_b64_tr_b16 a[252:253], v8 offset:8448
  ds_read_b64_tr_b16 a[254:255], v8 offset:10496
  s_waitcnt lgkmcnt(0)
  s_waitcnt vmcnt(20)
  s_barrier
  s_lshl_b32 s29, s21, 10
  s_add_u32 m0, s29, 32768
  s_mov_b32 s28, 7077888
  buffer_load_dwordx4 v5, s[12:15], s28 offen lds
  s_lshl_b32 s29, s21, 10
  s_add_u32 m0, s29, 36864
  s_mov_b32 s28, 7176192
  buffer_load_dwordx4 v5, s[12:15], s28 offen lds
  s_lshl_b32 s29, s21, 10
  s_add_u32 m0, s29, 40960
  s_mov_b32 s28, 7274496
  buffer_load_dwordx4 v5, s[12:15], s28 offen lds
  s_lshl_b32 s29, s21, 10
  s_add_u32 m0, s29, 45056
  s_mov_b32 s28, 7372800
  buffer_load_dwordx4 v5, s[12:15], s28 offen lds
  v_add_u32 v8, 65536, v7
  ds_read_b64_tr_b16 a[96:97], v8 offset:0
  ds_read_b64_tr_b16 a[98:99], v8 offset:2048
  ds_read_b64_tr_b16 a[100:101], v8 offset:8192
  ds_read_b64_tr_b16 a[102:103], v8 offset:10240
  ds_read_b64_tr_b16 v[192:193], v8 offset:256
  ds_read_b64_tr_b16 v[194:195], v8 offset:2304
  ds_read_b64_tr_b16 v[196:197], v8 offset:8448
  ds_read_b64_tr_b16 v[198:199], v8 offset:10496
  s_waitcnt lgkmcnt(0)
  s_waitcnt vmcnt(20)
  s_barrier
  s_lshl_b32 s29, s21, 10
  s_add_u32 m0, s29, 49152
  s_mov_b32 s28, 7471104
  buffer_load_dwordx4 v5, s[12:15], s28 offen lds
  s_lshl_b32 s29, s21, 10
  s_add_u32 m0, s29, 53248
  s_mov_b32 s28, 7569408
  buffer_load_dwordx4 v5, s[12:15], s28 offen lds
  s_lshl_b32 s29, s21, 10
  s_add_u32 m0, s29, 57344
  s_mov_b32 s28, 7667712
  buffer_load_dwordx4 v5, s[12:15], s28 offen lds
  s_lshl_b32 s29, s21, 10
  s_add_u32 m0, s29, 61440
  s_mov_b32 s28, 7766016
  buffer_load_dwordx4 v5, s[12:15], s28 offen lds
  v_add_u32 v8, 81920, v7
  ds_read_b64_tr_b16 a[104:105], v8 offset:0
  ds_read_b64_tr_b16 a[106:107], v8 offset:2048
  ds_read_b64_tr_b16 a[108:109], v8 offset:8192
  ds_read_b64_tr_b16 a[110:111], v8 offset:10240
  ds_read_b64_tr_b16 v[200:201], v8 offset:256
  ds_read_b64_tr_b16 v[202:203], v8 offset:2304
  ds_read_b64_tr_b16 v[204:205], v8 offset:8448
  ds_read_b64_tr_b16 v[206:207], v8 offset:10496
  s_waitcnt lgkmcnt(0)
  s_waitcnt vmcnt(20)
  s_barrier
  v_add_u32 v8, 98304, v7
  ds_read_b64_tr_b16 a[112:113], v8 offset:0
  ds_read_b64_tr_b16 a[114:115], v8 offset:2048
  ds_read_b64_tr_b16 a[116:117], v8 offset:8192
  ds_read_b64_tr_b16 a[118:119], v8 offset:10240
  ds_read_b64_tr_b16 v[208:209], v8 offset:256
  ds_read_b64_tr_b16 v[210:211], v8 offset:2304
  ds_read_b64_tr_b16 v[212:213], v8 offset:8448
  ds_read_b64_tr_b16 v[214:215], v8 offset:10496
  s_waitcnt lgkmcnt(0)
  s_waitcnt vmcnt(16)
  s_barrier
  v_add_u32 v8, 114688, v7
  ds_read_b64_tr_b16 a[120:121], v8 offset:0
  ds_read_b64_tr_b16 a[122:123], v8 offset:2048
  ds_read_b64_tr_b16 a[124:125], v8 offset:8192
  ds_read_b64_tr_b16 a[126:127], v8 offset:10240
  ds_read_b64_tr_b16 v[216:217], v8 offset:256
  ds_read_b64_tr_b16 v[218:219], v8 offset:2304
  ds_read_b64_tr_b16 v[220:221], v8 offset:8448
  ds_read_b64_tr_b16 v[222:223], v8 offset:10496
  s_waitcnt lgkmcnt(0)
  s_waitcnt vmcnt(12)
  s_barrier
  v_add_u32 v8, 0, v7
  ds_read_b64_tr_b16 a[128:129], v8 offset:0
  ds_read_b64_tr_b16 a[130:131], v8 offset:2048
  ds_read_b64_tr_b16 a[132:133], v8 offset:8192
  ds_read_b64_tr_b16 a[134:135], v8 offset:10240
  ds_read_b64_tr_b16 v[224:225], v8 offset:256
  ds_read_b64_tr_b16 v[226:227], v8 offset:2304
  ds_read_b64_tr_b16 v[228:229], v8 offset:8448
  ds_read_b64_tr_b16 v[230:231], v8 offset:10496
  s_waitcnt lgkmcnt(0)
  s_waitcnt vmcnt(8)
  s_barrier
  v_add_u32 v8, 16384, v7
  ds_read_b64_tr_b16 a[136:137], v8 offset:0
  ds_read_b64_tr_b16 a[138:139], v8 offset:2048
  ds_read_b64_tr_b16 a[140:141], v8 offset:8192
  ds_read_b64_tr_b16 a[142:143], v8 offset:10240
  ds_read_b64_tr_b16 v[232:233], v8 offset:256
  ds_read_b64_tr_b16 v[234:235], v8 offset:2304
  ds_read_b64_tr_b16 v[236:237], v8 offset:8448
  ds_read_b64_tr_b16 v[238:239], v8 offset:10496
  s_waitcnt lgkmcnt(0)
  s_waitcnt vmcnt(4)
  s_barrier
  v_add_u32 v8, 32768, v7
  ds_read_b64_tr_b16 a[144:145], v8 offset:0
  ds_read_b64_tr_b16 a[146:147], v8 offset:2048
  ds_read_b64_tr_b16 a[148:149], v8 offset:8192
  ds_read_b64_tr_b16 a[150:151], v8 offset:10240
  ds_read_b64_tr_b16 v[240:241], v8 offset:256
  ds_read_b64_tr_b16 v[242:243], v8 offset:2304
  ds_read_b64_tr_b16 v[244:245], v8 offset:8448
  ds_read_b64_tr_b16 v[246:247], v8 offset:10496
  s_waitcnt lgkmcnt(0)
  s_waitcnt vmcnt(0)
  s_barrier
  v_add_u32 v8, 49152, v7
  ds_read_b64_tr_b16 a[152:153], v8 offset:0
  ds_read_b64_tr_b16 a[154:155], v8 offset:2048
  ds_read_b64_tr_b16 a[156:157], v8 offset:8192
  ds_read_b64_tr_b16 a[158:159], v8 offset:10240
  ds_read_b64_tr_b16 v[248:249], v8 offset:256
  ds_read_b64_tr_b16 v[250:251], v8 offset:2304
  ds_read_b64_tr_b16 v[252:253], v8 offset:8448
  ds_read_b64_tr_b16 v[254:255], v8 offset:10496
  s_waitcnt lgkmcnt(0)
  s_barrier
  v_lshlrev_b32 v5, 4, v1
  s_lshl_b32 s28, s21, 10
  v_add_u32 v6, s28, v5
  v_mov_b32 v9, v5
  v_add_u32 v10, 40960, v5
  v_bfe_u32 v2, v1, 4, 1
  v_lshlrev_b32 v11, 10, v2
  v_and_b32 v2, 15, v1
  v_lshlrev_b32 v2, 4, v2
  v_add_u32 v11, v11, v2
  v_lshrrev_b32 v2, 5, v1
  v_lshlrev_b32 v2, 9, v2
  v_add_u32 v11, v11, v2
  v_mov_b32 v12, s47
  s_mov_b32 s50, 0
  s_mov_b32 s51, 0x100000
  s_lshl_b32 s29, s21, 10
  s_add_u32 m0, s29, 0
  s_add_u32 s28, s51, 0
  buffer_load_dwordx4 v6, s[8:11], s28 offen lds
  s_lshl_b32 s29, s21, 10
  s_add_u32 m0, s29, 4096
  s_add_u32 s28, s51, 4096
  buffer_load_dwordx4 v6, s[8:11], s28 offen lds
  s_lshl_b32 s29, s21, 10
  s_add_u32 m0, s29, 8192
  s_add_u32 s28, s51, 8192
  buffer_load_dwordx4 v6, s[8:11], s28 offen lds
  s_lshl_b32 s29, s21, 10
  s_add_u32 m0, s29, 12288
  s_add_u32 s28, s51, 12288
  buffer_load_dwordx4 v6, s[8:11], s28 offen lds
  s_lshl_b32 s29, s21, 10
  s_add_u32 m0, s29, 16384
  s_add_u32 s28, s51, 16384
  buffer_load_dwordx4 v6, s[8:11], s28 offen lds
  s_lshl_b32 s29, s21, 10
  s_add_u32 m0, s29, 20480
  s_add_u32 s28, s51, 20480
  buffer_load_dwordx4 v6, s[8:11], s28 offen lds
  s_lshl_b32 s29, s21, 10
  s_add_u32 m0, s29, 24576
  s_add_u32 s28, s51, 24576
  buffer_load_dwordx4 v6, s[8:11], s28 offen lds
  s_lshl_b32 s29, s21, 10
  s_add_u32 m0, s29, 28672
  s_add_u32 s28, s51, 28672
  buffer_load_dwordx4 v6, s[8:11], s28 offen lds
  s_lshl_b32 s29, s21, 10
  s_add_u32 m0, s29, 32768
  s_add_u32 s28, s51, 32768
  buffer_load_dwordx4 v6, s[8:11], s28 offen lds
  s_lshl_b32 s29, s21, 10
  s_add_u32 m0, s29, 36864
  s_add_u32 s28, s51, 36864
  buffer_load_dwordx4 v6, s[8:11], s28 offen lds
  s_add_u32 s51, s51, 40960
ka_qkv_loop:
  s_cmp_eq_u32 s50, 0
  s_cbranch_scc0 q0_27
  s_waitcnt vmcnt(0)
q0_27:
  s_waitcnt vmcnt(4)
  s_barrier
  s_cmp_eq_u32 s21, 0
  s_cbranch_scc0 qp_28
  s_cmp_ge_u32 s50, 1
  s_cbranch_scc0 qp_28
  s_sub_u32 s28, s50, 1
  v_mov_b32 v13, s28
  s_mov_b64 s[24:25], exec
  s_mov_b64 exec, 1
  buffer_store_dword v13, v12, s[8:11], 0 offen sc1
  s_mov_b64 exec, s[24:25]
qp_28:
  s_cmp_ge_u32 s50, 63
  s_cbranch_scc1 qn_29
  s_lshl_b32 s29, s21, 10
  s_add_u32 m0, s29, 40960
  s_add_u32 s28, s51, 0
  buffer_load_dwordx4 v6, s[8:11], s28 offen lds
  s_lshl_b32 s29, s21, 10
  s_add_u32 m0, s29, 45056
  s_add_u32 s28, s51, 4096
  buffer_load_dwordx4 v6, s[8:11], s28 offen lds
  s_lshl_b32 s29, s21, 10
  s_add_u32 m0, s29, 49152
  s_add_u32 s28, s51, 8192
  buffer_load_dwordx4 v6, s[8:11], s28 offen lds
  s_lshl_b32 s29, s21, 10
  s_add_u32 m0, s29, 53248
  s_add_u32 s28, s51, 12288
  buffer_load_dwordx4 v6, s[8:11], s28 offen lds
  s_lshl_b32 s29, s21, 10
  s_add_u32 m0, s29, 57344
  s_add_u32 s28, s51, 16384
  buffer_load_dwordx4 v6, s[8:11], s28 offen lds
  s_lshl_b32 s29, s21, 10
  s_add_u32 m0, s29, 61440
  s_add_u32 s28, s51, 20480
  buffer_load_dwordx4 v6, s[8:11], s28 offen lds
  s_lshl_b32 s29, s21, 10
  s_add_u32 m0, s29, 65536
  s_add_u32 s28, s51, 24576
  buffer_load_dwordx4 v6, s[8:11], s28 offen lds
  s_lshl_b32 s29, s21, 10
  s_add_u32 m0, s29, 69632
  s_add_u32 s28, s51, 28672
  buffer_load_dwordx4 v6, s[8:11], s28 offen lds
  s_lshl_b32 s29, s21, 10
  s_add_u32 m0, s29, 73728
  s_add_u32 s28, s51, 32768
  buffer_load_dwordx4 v6, s[8:11], s28 offen lds
  s_lshl_b32 s29, s21, 10
  s_add_u32 m0, s29, 77824
  s_add_u32 s28, s51, 36864
  buffer_load_dwordx4 v6, s[8:11], s28 offen lds
  s_add_u32 s51, s51, 40960
qn_29:
  ds_read_b128 v[128:131], v9 offset:0
  ds_read_b128 v[132:135], v9 offset:1024
  ds_read_b128 v[136:139], v9 offset:2048
  ds_read_b128 v[140:143], v9 offset:3072
  s_waitcnt lgkmcnt(3)
  v_mfma_f32_32x32x16_bf16 v[64:79], a[0:3], v[128:131], 0
  v_mfma_f32_32x32x16_bf16 v[80:95], a[160:163], v[128:131], 0
  ds_read_b128 v[128:131], v9 offset:4096
  s_waitcnt lgkmcnt(3)
  v_mfma_f32_32x32x16_bf16 v[64:79], a[4:7], v[132:135], v[64:79]
  v_mfma_f32_32x32x16_bf16 v[80:95], a[164:167], v[132:135], v[80:95]
  ds_read_b128 v[132:135], v9 offset:5120
  s_waitcnt lgkmcnt(3)
  v_mfma_f32_32x32x16_bf16 v[64:79], a[8:11], v[136:139], v[64:79]
  v_mfma_f32_32x32x16_bf16 v[80:95], a[168:171], v[136:139], v[80:95]
  ds_read_b128 v[136:139], v9 offset:6144
  s_waitcnt lgkmcnt(3)
  v_mfma_f32_32x32x16_bf16 v[64:79], a[12:15], v[140:143], v[64:79]
  v_mfma_f32_32x32x16_bf16 v[80:95], a[172:175], v[140:143], v[80:95]
  ds_read_b128 v[140:143], v9 offset:7168
  s_waitcnt lgkmcnt(3)
  v_mfma_f32_32x32x16_bf16 v[64:79], a[16:19], v[128:131], v[64:79]
  v_mfma_f32_32x32x16_bf16 v[80:95], a[176:179], v[128:131], v[80:95]
  ds_read_b128 v[128:131], v9 offset:8192
  s_waitcnt lgkmcnt(3)
  v_mfma_f32_32x32x16_bf16 v[64:79], a[20:23], v[132:135], v[64:79]
  v_mfma_f32_32x32x16_bf16 v[80:95], a[180:183], v[132:135], v[80:95]
  ds_read_b128 v[132:135], v9 offset:9216
  s_waitcnt lgkmcnt(3)
  v_mfma_f32_32x32x16_bf16 v[64:79], a[24:27], v[136:139], v[64:79]
  v_mfma_f32_32x32x16_bf16 v[80:95], a[184:187], v[136:139], v[80:95]
  ds_read_b128 v[136:139], v9 offset:10240
  s_waitcnt lgkmcnt(3)
  v_mfma_f32_32x32x16_bf16 v[64:79], a[28:31], v[140:143], v[64:79]
  v_mfma_f32_32x32x16_bf16 v[80:95], a[188:191], v[140:143], v[80:95]
  ds_read_b128 v[140:143], v9 offset:11264
  s_waitcnt lgkmcnt(3)
  v_mfma_f32_32x32x16_bf16 v[64:79], a[32:35], v[128:131], v[64:79]
  v_mfma_f32_32x32x16_bf16 v[80:95], a[192:195], v[128:131], v[80:95]
  ds_read_b128 v[128:131], v9 offset:12288
  s_waitcnt lgkmcnt(3)
  v_mfma_f32_32x32x16_bf16 v[64:79], a[36:39], v[132:135], v[64:79]
  v_mfma_f32_32x32x16_bf16 v[80:95], a[196:199], v[132:135], v[80:95]
  ds_read_b128 v[132:135], v9 offset:13312
  s_waitcnt lgkmcnt(3)
  v_mfma_f32_32x32x16_bf16 v[64:79], a[40:43], v[136:139], v[64:79]
  v_mfma_f32_32x32x16_bf16 v[80:95], a[200:203], v[136:139], v[80:95]
  ds_read_b128 v[136:139], v9 offset:14336
  s_waitcnt lgkmcnt(3)
  v_mfma_f32_32x32x16_bf16 v[64:79], a[44:47], v[140:143], v[64:79]
  v_mfma_f32_32x32x16_bf16 v[80:95], a[204:207], v[140:143], v[80:95]
  ds_read_b128 v[140:143], v9 offset:15360
  s_waitcnt lgkmcnt(3)
  v_mfma_f32_32x32x16_bf16 v[64:79], a[48:51], v[128:131], v[64:79]
  v_mfma_f32_32x32x16_bf16 v[80:95], a[208:211], v[128:131], v[80:95]
  ds_read_b128 v[128:131], v9 offset:16384
  s_waitcnt lgkmcnt(3)
  v_mfma_f32_32x32x16_bf16 v[64:79], a[52:55], v[132:135], v[64:79]
  v_mfma_f32_32x32x16_bf16 v[80:95], a[212:215], v[132:135], v[80:95]
  ds_read_b128 v[132:135], v9 offset:17408
  s_waitcnt lgkmcnt(3)
  v_mfma_f32_32x32x16_bf16 v[64:79], a[56:59], v[136:139], v[64:79]
  v_mfma_f32_32x32x16_bf16 v[80:95], a[216:219], v[136:139], v[80:95]
  ds_read_b128 v[136:139], v9 offset:18432
  s_waitcnt lgkmcnt(3)
  v_mfma_f32_32x32x16_bf16 v[64:79], a[60:63], v[140:143], v[64:79]
  v_mfma_f32_32x32x16_bf16 v[80:95], a[220:223], v[140:143], v[80:95]
  ds_read_b128 v[140:143], v9 offset:19456
  s_waitcnt lgkmcnt(3)
  v_mfma_f32_32x32x16_bf16 v[64:79], a[64:67], v[128:131], v[64:79]
  v_mfma_f32_32x32x16_bf16 v[80:95], a[224:227], v[128:131], v[80:95]
  ds_read_b128 v[128:131], v9 offset:20480
  s_waitcnt lgkmcnt(3)
  v_mfma_f32_32x32x16_bf16 v[64:79], a[68:71], v[132:135], v[64:79]
  v_mfma_f32_32x32x16_bf16 v[80:95], a[228:231], v[132:135], v[80:95]
  ds_read_b128 v[132:135], v9 offset:21504
  s_waitcnt lgkmcnt(3)
  v_mfma_f32_32x32x16_bf16 v[64:79], a[72:75], v[136:139], v[64:79]
  v_mfma_f32_32x32x16_bf16 v[80:95], a[232:235], v[136:139], v[80:95]
  ds_read_b128 v[136:139], v9 offset:22528
  s_waitcnt lgkmcnt(3)
  v_mfma_f32_32x32x16_bf16 v[64:79], a[76:79], v[140:143], v[64:79]
  v_mfma_f32_32x32x16_bf16 v[80:95], a[236:239], v[140:143], v[80:95]
  ds_read_b128 v[140:143], v9 offset:23552
  s_waitcnt lgkmcnt(3)
  v_mfma_f32_32x32x16_bf16 v[64:79], a[80:83], v[128:131], v[64:79]
  v_mfma_f32_32x32x16_bf16 v[80:95], a[240:243], v[128:131], v[80:95]
  ds_read_b128 v[128:131], v9 offset:24576
  s_waitcnt lgkmcnt(3)
  v_mfma_f32_32x32x16_bf16 v[64:79], a[84:87], v[132:135], v[64:79]
  v_mfma_f32_32x32x16_bf16 v[80:95], a[244:247], v[132:135], v[80:95]
  ds_read_b128 v[132:135], v9 offset:25600
  s_waitcnt lgkmcnt(3)
  v_mfma_f32_32x32x16_bf16 v[64:79], a[88:91], v[136:139], v[64:79]
  v_mfma_f32_32x32x16_bf16 v[80:95], a[248:251], v[136:139], v[80:95]
  ds_read_b128 v[136:139], v9 offset:26624
  s_waitcnt lgkmcnt(3)
  v_mfma_f32_32x32x16_bf16 v[64:79], a[92:95], v[140:143], v[64:79]
  v_mfma_f32_32x32x16_bf16 v[80:95], a[252:255], v[140:143], v[80:95]
  ds_read_b128 v[140:143], v9 offset:27648
  s_waitcnt lgkmcnt(3)
  v_mfma_f32_32x32x16_bf16 v[64:79], a[96:99], v[128:131], v[64:79]
  v_mfma_f32_32x32x16_bf16 v[80:95], v[192:195], v[128:131], v[80:95]
  ds_read_b128 v[128:131], v9 offset:28672
  s_waitcnt lgkmcnt(3)
  v_mfma_f32_32x32x16_bf16 v[64:79], a[100:103], v[132:135], v[64:79]
  v_mfma_f32_32x32x16_bf16 v[80:95], v[196:199], v[132:135], v[80:95]
  ds_read_b128 v[132:135], v9 offset:29696
  s_waitcnt lgkmcnt(3)
  v_mfma_f32_32x32x16_bf16 v[64:79], a[104:107], v[136:139], v[64:79]
  v_mfma_f32_32x32x16_bf16 v[80:95], v[200:203], v[136:139], v[80:95]
  ds_read_b128 v[136:139], v9 offset:30720
  s_waitcnt lgkmcnt(3)
  v_mfma_f32_32x32x16_bf16 v[64:79], a[108:111], v[140:143], v[64:79]
  v_mfma_f32_32x32x16_bf16 v[80:95], v[204:207], v[140:143], v[80:95]
  ds_read_b128 v[140:143], v9 offset:31744
  s_waitcnt lgkmcnt(3)
  v_mfma_f32_32x32x16_bf16 v[64:79], a[112:115], v[128:131], v[64:79]
  v_mfma_f32_32x32x16_bf16 v[80:95], v[208:211], v[128:131], v[80:95]
  ds_read_b128 v[128:131], v9 offset:32768
  s_waitcnt lgkmcnt(3)
  v_mfma_f32_32x32x16_bf16 v[64:79], a[116:119], v[132:135], v[64:79]
  v_mfma_f32_32x32x16_bf16 v[80:95], v[212:215], v[132:135], v[80:95]
  ds_read_b128 v[132:135], v9 offset:33792
  s_waitcnt lgkmcnt(3)
  v_mfma_f32_32x32x16_bf16 v[64:79], a[120:123], v[136:139], v[64:79]
  v_mfma_f32_32x32x16_bf16 v[80:95], v[216:219], v[136:139], v[80:95]
  ds_read_b128 v[136:139], v9 offset:34816
  s_waitcnt lgkmcnt(3)
  v_mfma_f32_32x32x16_bf16 v[64:79], a[124:127], v[140:143], v[64:79]
  v_mfma_f32_32x32x16_bf16 v[80:95], v[220:223], v[140:143], v[80:95]
  ds_read_b128 v[140:143], v9 offset:35840
  s_waitcnt lgkmcnt(3)
  v_mfma_f32_32x32x16_bf16 v[64:79], a[128:131], v[128:131], v[64:79]
  v_mfma_f32_32x32x16_bf16 v[80:95], v[224:227], v[128:131], v[80:95]
  ds_read_b128 v[128:131], v9 offset:36864
  s_waitcnt lgkmcnt(3)
  v_mfma_f32_32x32x16_bf16 v[64:79], a[132:135], v[132:135], v[64:79]
  v_mfma_f32_32x32x16_bf16 v[80:95], v[228:231], v[132:135], v[80:95]
  ds_read_b128 v[132:135], v9 offset:37888
  s_waitcnt lgkmcnt(3)
  v_mfma_f32_32x32x16_bf16 v[64:79], a[136:139], v[136:139], v[64:79]
  v_mfma_f32_32x32x16_bf16 v[80:95], v[232:235], v[136:139], v[80:95]
  ds_read_b128 v[136:139], v9 offset:38912
  s_waitcnt lgkmcnt(3)
  v_mfma_f32_32x32x16_bf16 v[64:79], a[140:143], v[140:143], v[64:79]
  v_mfma_f32_32x32x16_bf16 v[80:95], v[236:239], v[140:143], v[80:95]
  ds_read_b128 v[140:143], v9 offset:39936
  s_waitcnt lgkmcnt(3)
  v_mfma_f32_32x32x16_bf16 v[64:79], a[144:147], v[128:131], v[64:79]
  v_mfma_f32_32x32x16_bf16 v[80:95], v[240:243], v[128:131], v[80:95]
  s_waitcnt lgkmcnt(2)
  v_mfma_f32_32x32x16_bf16 v[64:79], a[148:151], v[132:135], v[64:79]
  v_mfma_f32_32x32x16_bf16 v[80:95], v[244:247], v[132:135], v[80:95]
  s_waitcnt lgkmcnt(1)
  v_mfma_f32_32x32x16_bf16 v[64:79], a[152:155], v[136:139], v[64:79]
  v_mfma_f32_32x32x16_bf16 v[80:95], v[248:251], v[136:139], v[80:95]
  s_waitcnt lgkmcnt(0)
  v_mfma_f32_32x32x16_bf16 v[64:79], a[156:159], v[140:143], v[64:79]
  v_mfma_f32_32x32x16_bf16 v[80:95], v[252:255], v[140:143], v[80:95]
  s_nop 11
  v_cvt_pk_bf16_f32 v144, v64, v65
  v_cvt_pk_bf16_f32 v145, v66, v67
  v_cvt_pk_bf16_f32 v146, v68, v69
  v_cvt_pk_bf16_f32 v147, v70, v71
  v_cvt_pk_bf16_f32 v148, v72, v73
  v_cvt_pk_bf16_f32 v149, v74, v75
  v_cvt_pk_bf16_f32 v150, v76, v77
  v_cvt_pk_bf16_f32 v151, v78, v79
  v_cvt_pk_bf16_f32 v152, v80, v81
  v_cvt_pk_bf16_f32 v153, v82, v83
  v_cvt_pk_bf16_f32 v154, v84, v85
  v_cvt_pk_bf16_f32 v155, v86, v87
  v_cvt_pk_bf16_f32 v156, v88, v89
  v_cvt_pk_bf16_f32 v157, v90, v91
  v_cvt_pk_bf16_f32 v158, v92, v93
  v_cvt_pk_bf16_f32 v159, v94, v95
  s_mul_i32 s28, s50, 12288
  s_add_u32 s29, s28, s48
  buffer_store_dwordx4 v[144:147], v11, s[8:11], s29 offen offset:0 sc1
  buffer_store_dwordx4 v[148:151], v11, s[8:11], s29 offen offset:256 sc1
  s_add_u32 s29, s28, s49
  buffer_store_dwordx4 v[152:155], v11, s[8:11], s29 offen offset:0 sc1
  buffer_store_dwordx4 v[156:159], v11, s[8:11], s29 offen offset:256 sc1
  s_add_u32 s50, s50, 1
  s_waitcnt vmcnt(4)
  s_barrier
  s_cmp_eq_u32 s21, 0
  s_cbranch_scc0 qp_30
  s_cmp_ge_u32 s50, 1
  s_cbranch_scc0 qp_30
  s_sub_u32 s28, s50, 1
  v_mov_b32 v13, s28
  s_mov_b64 s[24:25], exec
  s_mov_b64 exec, 1
  buffer_store_dword v13, v12, s[8:11], 0 offen sc1
  s_mov_b64 exec, s[24:25]
qp_30:
  s_cmp_ge_u32 s50, 63
  s_cbranch_scc1 qn_31
  s_lshl_b32 s29, s21, 10
  s_add_u32 m0, s29, 0
  s_add_u32 s28, s51, 0
  buffer_load_dwordx4 v6, s[8:11], s28 offen lds
  s_lshl_b32 s29, s21, 10
  s_add_u32 m0, s29, 4096
  s_add_u32 s28, s51, 4096
  buffer_load_dwordx4 v6, s[8:11], s28 offen lds
  s_lshl_b32 s29, s21, 10
  s_add_u32 m0, s29, 8192
  s_add_u32 s28, s51, 8192
  buffer_load_dwordx4 v6, s[8:11], s28 offen lds
  s_lshl_b32 s29, s21, 10
  s_add_u32 m0, s29, 12288
  s_add_u32 s28, s51, 12288
  buffer_load_dwordx4 v6, s[8:11], s28 offen lds
  s_lshl_b32 s29, s21, 10
  s_add_u32 m0, s29, 16384
  s_add_u32 s28, s51, 16384
  buffer_load_dwordx4 v6, s[8:11], s28 offen lds
  s_lshl_b32 s29, s21, 10
  s_add_u32 m0, s29, 20480
  s_add_u32 s28, s51, 20480
  buffer_load_dwordx4 v6, s[8:11], s28 offen lds
  s_lshl_b32 s29, s21, 10
  s_add_u32 m0, s29, 24576
  s_add_u32 s28, s51, 24576
  buffer_load_dwordx4 v6, s[8:11], s28 offen lds
  s_lshl_b32 s29, s21, 10
  s_add_u32 m0, s29, 28672
  s_add_u32 s28, s51, 28672
  buffer_load_dwordx4 v6, s[8:11], s28 offen lds
  s_lshl_b32 s29, s21, 10
  s_add_u32 m0, s29, 32768
  s_add_u32 s28, s51, 32768
  buffer_load_dwordx4 v6, s[8:11], s28 offen lds
  s_lshl_b32 s29, s21, 10
  s_add_u32 m0, s29, 36864
  s_add_u32 s28, s51, 36864
  buffer_load_dwordx4 v6, s[8:11], s28 offen lds
  s_add_u32 s51, s51, 40960
qn_31:
  ds_read_b128 v[128:131], v10 offset:0
  ds_read_b128 v[132:135], v10 offset:1024
  ds_read_b128 v[136:139], v10 offset:2048
  ds_read_b128 v[140:143], v10 offset:3072
  s_waitcnt lgkmcnt(3)
  v_mfma_f32_32x32x16_bf16 v[64:79], a[0:3], v[128:131], 0
  v_mfma_f32_32x32x16_bf16 v[80:95], a[160:163], v[128:131], 0
  ds_read_b128 v[128:131], v10 offset:4096
  s_waitcnt lgkmcnt(3)
  v_mfma_f32_32x32x16_bf16 v[64:79], a[4:7], v[132:135], v[64:79]
  v_mfma_f32_32x32x16_bf16 v[80:95], a[164:167], v[132:135], v[80:95]
  ds_read_b128 v[132:135], v10 offset:5120
  s_waitcnt lgkmcnt(3)
  v_mfma_f32_32x32x16_bf16 v[64:79], a[8:11], v[136:139], v[64:79]
  v_mfma_f32_32x32x16_bf16 v[80:95], a[168:171], v[136:139], v[80:95]
  ds_read_b128 v[136:139], v10 offset:6144
  s_waitcnt lgkmcnt(3)
  v_mfma_f32_32x32x16_bf16 v[64:79], a[12:15], v[140:143], v[64:79]
  v_mfma_f32_32x32x16_bf16 v[80:95], a[172:175], v[140:143], v[80:95]
  ds_read_b128 v[140:143], v10 offset:7168
  s_waitcnt lgkmcnt(3)
  v_mfma_f32_32x32x16_bf16 v[64:79], a[16:19], v[128:131], v[64:79]
  v_mfma_f32_32x32x16_bf16 v[80:95], a[176:179], v[128:131], v[80:95]
  ds_read_b128 v[128:131], v10 offset:8192
  s_waitcnt lgkmcnt(3)
  v_mfma_f32_32x32x16_bf16 v[64:79], a[20:23], v[132:135], v[64:79]
  v_mfma_f32_32x32x16_bf16 v[80:95], a[180:183], v[132:135], v[80:95]
  ds_read_b128 v[132:135], v10 offset:9216
  s_waitcnt lgkmcnt(3)
  v_mfma_f32_32x32x16_bf16 v[64:79], a[24:27], v[136:139], v[64:79]
  v_mfma_f32_32x32x16_bf16 v[80:95], a[184:187], v[136:139], v[80:95]
  ds_read_b128 v[136:139], v10 offset:10240
  s_waitcnt lgkmcnt(3)
  v_mfma_f32_32x32x16_bf16 v[64:79], a[28:31], v[140:143], v[64:79]
  v_mfma_f32_32x32x16_bf16 v[80:95], a[188:191], v[140:143], v[80:95]
  ds_read_b128 v[140:143], v10 offset:11264
  s_waitcnt lgkmcnt(3)
  v_mfma_f32_32x32x16_bf16 v[64:79], a[32:35], v[128:131], v[64:79]
  v_mfma_f32_32x32x16_bf16 v[80:95], a[192:195], v[128:131], v[80:95]
  ds_read_b128 v[128:131], v10 offset:12288
  s_waitcnt lgkmcnt(3)
  v_mfma_f32_32x32x16_bf16 v[64:79], a[36:39], v[132:135], v[64:79]
  v_mfma_f32_32x32x16_bf16 v[80:95], a[196:199], v[132:135], v[80:95]
  ds_read_b128 v[132:135], v10 offset:13312
  s_waitcnt lgkmcnt(3)
  v_mfma_f32_32x32x16_bf16 v[64:79], a[40:43], v[136:139], v[64:79]
  v_mfma_f32_32x32x16_bf16 v[80:95], a[200:203], v[136:139], v[80:95]
  ds_read_b128 v[136:139], v10 offset:14336
  s_waitcnt lgkmcnt(3)
  v_mfma_f32_32x32x16_bf16 v[64:79], a[44:47], v[140:143], v[64:79]
  v_mfma_f32_32x32x16_bf16 v[80:95], a[204:207], v[140:143], v[80:95]
  ds_read_b128 v[140:143], v10 offset:15360
  s_waitcnt lgkmcnt(3)
  v_mfma_f32_32x32x16_bf16 v[64:79], a[48:51], v[128:131], v[64:79]
  v_mfma_f32_32x32x16_bf16 v[80:95], a[208:211], v[128:131], v[80:95]
  ds_read_b128 v[128:131], v10 offset:16384
  s_waitcnt lgkmcnt(3)
  v_mfma_f32_32x32x16_bf16 v[64:79], a[52:55], v[132:135], v[64:79]
  v_mfma_f32_32x32x16_bf16 v[80:95], a[212:215], v[132:135], v[80:95]
  ds_read_b128 v[132:135], v10 offset:17408
  s_waitcnt lgkmcnt(3)
  v_mfma_f32_32x32x16_bf16 v[64:79], a[56:59], v[136:139], v[64:79]
  v_mfma_f32_32x32x16_bf16 v[80:95], a[216:219], v[136:139], v[80:95]
  ds_read_b128 v[136:139], v10 offset:18432
  s_waitcnt lgkmcnt(3)
  v_mfma_f32_32x32x16_bf16 v[64:79], a[60:63], v[140:143], v[64:79]
  v_mfma_f32_32x32x16_bf16 v[80:95], a[220:223], v[140:143], v[80:95]
  ds_read_b128 v[140:143], v10 offset:19456
  s_waitcnt lgkmcnt(3)
  v_mfma_f32_32x32x16_bf16 v[64:79], a[64:67], v[128:131], v[64:79]
  v_mfma_f32_32x32x16_bf16 v[80:95], a[224:227], v[128:131], v[80:95]
  ds_read_b128 v[128:131], v10 offset:20480
  s_waitcnt lgkmcnt(3)
  v_mfma_f32_32x32x16_bf16 v[64:79], a[68:71], v[132:135], v[64:79]
  v_mfma_f32_32x32x16_bf16 v[80:95], a[228:231], v[132:135], v[80:95]
  ds_read_b128 v[132:135], v10 offset:21504
  s_waitcnt lgkmcnt(3)
  v_mfma_f32_32x32x16_bf16 v[64:79], a[72:75], v[136:139], v[64:79]
  v_mfma_f32_32x32x16_bf16 v[80:95], a[232:235], v[136:139], v[80:95]
  ds_read_b128 v[136:139], v10 offset:22528
  s_waitcnt lgkmcnt(3)
  v_mfma_f32_32x32x16_bf16 v[64:79], a[76:79], v[140:143], v[64:79]
  v_mfma_f32_32x32x16_bf16 v[80:95], a[236:239], v[140:143], v[80:95]
  ds_read_b128 v[140:143], v10 offset:23552
  s_waitcnt lgkmcnt(3)
  v_mfma_f32_32x32x16_bf16 v[64:79], a[80:83], v[128:131], v[64:79]
  v_mfma_f32_32x32x16_bf16 v[80:95], a[240:243], v[128:131], v[80:95]
  ds_read_b128 v[128:131], v10 offset:24576
  s_waitcnt lgkmcnt(3)
  v_mfma_f32_32x32x16_bf16 v[64:79], a[84:87], v[132:135], v[64:79]
  v_mfma_f32_32x32x16_bf16 v[80:95], a[244:247], v[132:135], v[80:95]
  ds_read_b128 v[132:135], v10 offset:25600
  s_waitcnt lgkmcnt(3)
  v_mfma_f32_32x32x16_bf16 v[64:79], a[88:91], v[136:139], v[64:79]
  v_mfma_f32_32x32x16_bf16 v[80:95], a[248:251], v[136:139], v[80:95]
  ds_read_b128 v[136:139], v10 offset:26624
  s_waitcnt lgkmcnt(3)
  v_mfma_f32_32x32x16_bf16 v[64:79], a[92:95], v[140:143], v[64:79]
  v_mfma_f32_32x32x16_bf16 v[80:95], a[252:255], v[140:143], v[80:95]
  ds_read_b128 v[140:143], v10 offset:27648
  s_waitcnt lgkmcnt(3)
  v_mfma_f32_32x32x16_bf16 v[64:79], a[96:99], v[128:131], v[64:79]
  v_mfma_f32_32x32x16_bf16 v[80:95], v[192:195], v[128:131], v[80:95]
  ds_read_b128 v[128:131], v10 offset:28672
  s_waitcnt lgkmcnt(3)
  v_mfma_f32_32x32x16_bf16 v[64:79], a[100:103], v[132:135], v[64:79]
  v_mfma_f32_32x32x16_bf16 v[80:95], v[196:199], v[132:135], v[80:95]
  ds_read_b128 v[132:135], v10 offset:29696
  s_waitcnt lgkmcnt(3)
  v_mfma_f32_32x32x16_bf16 v[64:79], a[104:107], v[136:139], v[64:79]
  v_mfma_f32_32x32x16_bf16 v[80:95], v[200:203], v[136:139], v[80:95]
  ds_read_b128 v[136:139], v10 offset:30720
  s_waitcnt lgkmcnt(3)
  v_mfma_f32_32x32x16_bf16 v[64:79], a[108:111], v[140:143], v[64:79]
  v_mfma_f32_32x32x16_bf16 v[80:95], v[204:207], v[140:143], v[80:95]
  ds_read_b128 v[140:143], v10 offset:31744
  s_waitcnt lgkmcnt(3)
  v_mfma_f32_32x32x16_bf16 v[64:79], a[112:115], v[128:131], v[64:79]
  v_mfma_f32_32x32x16_bf16 v[80:95], v[208:211], v[128:131], v[80:95]
  ds_read_b128 v[128:131], v10 offset:32768
  s_waitcnt lgkmcnt(3)
  v_mfma_f32_32x32x16_bf16 v[64:79], a[116:119], v[132:135], v[64:79]
  v_mfma_f32_32x32x16_bf16 v[80:95], v[212:215], v[132:135], v[80:95]
  ds_read_b128 v[132:135], v10 offset:33792
  s_waitcnt lgkmcnt(3)
  v_mfma_f32_32x32x16_bf16 v[64:79], a[120:123], v[136:139], v[64:79]
  v_mfma_f32_32x32x16_bf16 v[80:95], v[216:219], v[136:139], v[80:95]
  ds_read_b128 v[136:139], v10 offset:34816
  s_waitcnt lgkmcnt(3)
  v_mfma_f32_32x32x16_bf16 v[64:79], a[124:127], v[140:143], v[64:79]
  v_mfma_f32_32x32x16_bf16 v[80:95], v[220:223], v[140:143], v[80:95]
  ds_read_b128 v[140:143], v10 offset:35840
  s_waitcnt lgkmcnt(3)
  v_mfma_f32_32x32x16_bf16 v[64:79], a[128:131], v[128:131], v[64:79]
  v_mfma_f32_32x32x16_bf16 v[80:95], v[224:227], v[128:131], v[80:95]
  ds_read_b128 v[128:131], v10 offset:36864
  s_waitcnt lgkmcnt(3)
  v_mfma_f32_32x32x16_bf16 v[64:79], a[132:135], v[132:135], v[64:79]
  v_mfma_f32_32x32x16_bf16 v[80:95], v[228:231], v[132:135], v[80:95]
  ds_read_b128 v[132:135], v10 offset:37888
  s_waitcnt lgkmcnt(3)
  v_mfma_f32_32x32x16_bf16 v[64:79], a[136:139], v[136:139], v[64:79]
  v_mfma_f32_32x32x16_bf16 v[80:95], v[232:235], v[136:139], v[80:95]
  ds_read_b128 v[136:139], v10 offset:38912
  s_waitcnt lgkmcnt(3)
  v_mfma_f32_32x32x16_bf16 v[64:79], a[140:143], v[140:143], v[64:79]
  v_mfma_f32_32x32x16_bf16 v[80:95], v[236:239], v[140:143], v[80:95]
  ds_read_b128 v[140:143], v10 offset:39936
  s_waitcnt lgkmcnt(3)
  v_mfma_f32_32x32x16_bf16 v[64:79], a[144:147], v[128:131], v[64:79]
  v_mfma_f32_32x32x16_bf16 v[80:95], v[240:243], v[128:131], v[80:95]
  s_waitcnt lgkmcnt(2)
  v_mfma_f32_32x32x16_bf16 v[64:79], a[148:151], v[132:135], v[64:79]
  v_mfma_f32_32x32x16_bf16 v[80:95], v[244:247], v[132:135], v[80:95]
  s_waitcnt lgkmcnt(1)
  v_mfma_f32_32x32x16_bf16 v[64:79], a[152:155], v[136:139], v[64:79]
  v_mfma_f32_32x32x16_bf16 v[80:95], v[248:251], v[136:139], v[80:95]
  s_waitcnt lgkmcnt(0)
  v_mfma_f32_32x32x16_bf16 v[64:79], a[156:159], v[140:143], v[64:79]
  v_mfma_f32_32x32x16_bf16 v[80:95], v[252:255], v[140:143], v[80:95]
  s_nop 11
  v_cvt_pk_bf16_f32 v144, v64, v65
  v_cvt_pk_bf16_f32 v145, v66, v67
  v_cvt_pk_bf16_f32 v146, v68, v69
  v_cvt_pk_bf16_f32 v147, v70, v71
  v_cvt_pk_bf16_f32 v148, v72, v73
  v_cvt_pk_bf16_f32 v149, v74, v75
  v_cvt_pk_bf16_f32 v150, v76, v77
  v_cvt_pk_bf16_f32 v151, v78, v79
  v_cvt_pk_bf16_f32 v152, v80, v81
  v_cvt_pk_bf16_f32 v153, v82, v83
  v_cvt_pk_bf16_f32 v154, v84, v85
  v_cvt_pk_bf16_f32 v155, v86, v87
  v_cvt_pk_bf16_f32 v156, v88, v89
  v_cvt_pk_bf16_f32 v157, v90, v91
  v_cvt_pk_bf16_f32 v158, v92, v93
  v_cvt_pk_bf16_f32 v159, v94, v95
  s_mul_i32 s28, s50, 12288
  s_add_u32 s29, s28, s48
  buffer_store_dwordx4 v[144:147], v11, s[8:11], s29 offen offset:0 sc1
  buffer_store_dwordx4 v[148:151], v11, s[8:11], s29 offen offset:256 sc1
  s_add_u32 s29, s28, s49
  buffer_store_dwordx4 v[152:155], v11, s[8:11], s29 offen offset:0 sc1
  buffer_store_dwordx4 v[156:159], v11, s[8:11], s29 offen offset:256 sc1
  s_add_u32 s50, s50, 1
  s_cmp_lt_u32 s50, 64
  s_cbranch_scc1 ka_qkv_loop
  s_waitcnt vmcnt(0)
  s_barrier
  s_cmp_eq_u32 s21, 0
  s_cbranch_scc0 ka_exit
  v_mov_b32 v13, 64
  s_mov_b64 exec, 1
  buffer_store_dword v13, v12, s[8:11], 0 offen sc1
  s_waitcnt vmcnt(0)
  s_branch ka_exit
ka_u:
  s_mov_b32 s12, s42
  s_and_b32 s13, s43, 0xffff
  s_mov_b32 s14, 0x780000
  s_mov_b32 s15, 0x20000
  v_and_b32 v1, 63, v0
  v_lshrrev_b32 v2, 4, v1
  v_bfe_u32 v3, v1, 2, 2
  v_and_b32 v4, 3, v1
  s_lshl_b32 s28, s21, 3
  v_add_u32 v5, s28, v3
  v_mul_u32_u24 v5, 1280, v5
  v_lshlrev_b32 v6, 6, v2
  v_add_u32 v5, v5, v6
  v_lshlrev_b32 v6, 4, v4
  v_add_u32 v5, v5, v6
  v_lshrrev_b32 v6, 1, v2
  v_mul_u32_u24 v7, 20480, v6
  v_lshlrev_b32 v6, 6, v3
  v_add_u32 v7, v7, v6
  v_and_b32 v6, 1, v2
  v_lshlrev_b32 v6, 5, v6
  v_add_u32 v7, v7, v6
  v_lshrrev_b32 v6, 1, v4
  v_lshlrev_b32 v6, 4, v6
  v_add_u32 v7, v7, v6
  v_and_b32 v6, 1, v4
  v_lshlrev_b32 v6, 3, v6
  v_add_u32 v7, v7, v6
  s_mul_i32 s28, s21, 1280
  v_add_u32 v7, s28, v7
  s_mul_i32 s46, s23, 245760
  s_mul_i32 s29, s21, 10240
  s_add_u32 m0, s29, 0
  s_add_u32 s28, s46, 0
  buffer_load_dwordx4 v5, s[12:15], s28 offen lds
  s_mul_i32 s29, s21, 10240
  s_add_u32 m0, s29, 1024
  s_add_u32 s28, s46, 256
  buffer_load_dwordx4 v5, s[12:15], s28 offen lds
  s_mul_i32 s29, s21, 10240
  s_add_u32 m0, s29, 2048
  s_add_u32 s28, s46, 512
  buffer_load_dwordx4 v5, s[12:15], s28 offen lds
  s_mul_i32 s29, s21, 10240
  s_add_u32 m0, s29, 3072
  s_add_u32 s28, s46, 768
  buffer_load_dwordx4 v5, s[12:15], s28 offen lds
  s_mul_i32 s29, s21, 10240
  s_add_u32 m0, s29, 4096
  s_add_u32 s28, s46, 1024
  buffer_load_dwordx4 v5, s[12:15], s28 offen lds
  s_mul_i32 s29, s21, 10240
  s_add_u32 m0, s29, 5120
  s_add_u32 s28, s46, 5120
  buffer_load_dwordx4 v5, s[12:15], s28 offen lds
  s_mul_i32 s29, s21, 10240
  s_add_u32 m0, s29, 6144
  s_add_u32 s28, s46, 5376
  buffer_load_dwordx4 v5, s[12:15], s28 offen lds
  s_mul_i32 s29, s21, 10240
  s_add_u32 m0, s29, 7168
  s_add_u32 s28, s46, 5632
  buffer_load_dwordx4 v5, s[12:15], s28 offen lds
  s_mul_i32 s29, s21, 10240
  s_add_u32 m0, s29, 8192
  s_add_u32 s28, s46, 5888
  buffer_load_dwordx4 v5, s[12:15], s28 offen lds
  s_mul_i32 s29, s21, 10240
  s_add_u32 m0, s29, 9216
  s_add_u32 s28, s46, 6144
  buffer_load_dwordx4 v5, s[12:15], s28 offen lds
  s_mul_i32 s29, s21, 10240
  s_add_u32 m0, s29, 40960
  s_add_u32 s28, s46, 40960
  buffer_load_dwordx4 v5, s[12:15], s28 offen lds
  s_mul_i32 s29, s21, 10240
  s_add_u32 m0, s29, 41984
  s_add_u32 s28, s46, 41216
  buffer_load_dwordx4 v5, s[12:15], s28 offen lds
  s_mul_i32 s29, s21, 10240
  s_add_u32 m0, s29, 43008
  s_add_u32 s28, s46, 41472
  buffer_load_dwordx4 v5, s[12:15], s28 offen lds
  s_mul_i32 s29, s21, 10240
  s_add_u32 m0, s29, 44032
  s_add_u32 s28, s46, 41728
  buffer_load_dwordx4 v5, s[12:15], s28 offen lds
  s_mul_i32 s29, s21, 10240
  s_add_u32 m0, s29, 45056
  s_add_u32 s28, s46, 41984
  buffer_load_dwordx4 v5, s[12:15], s28 offen lds
  s_mul_i32 s29, s21, 10240
  s_add_u32 m0, s29, 46080
  s_add_u32 s28, s46, 46080
  buffer_load_dwordx4 v5, s[12:15], s28 offen lds
  s_mul_i32 s29, s21, 10240
  s_add_u32 m0, s29, 47104
  s_add_u32 s28, s46, 46336
  buffer_load_dwordx4 v5, s[12:15], s28 offen lds
  s_mul_i32 s29, s21, 10240
  s_add_u32 m0, s29, 48128
  s_add_u32 s28, s46, 46592
  buffer_load_dwordx4 v5, s[12:15], s28 offen lds
  s_mul_i32 s29, s21, 10240
  s_add_u32 m0, s29, 49152
  s_add_u32 s28, s46, 46848
  buffer_load_dwordx4 v5, s[12:15], s28 offen lds
  s_mul_i32 s29, s21, 10240
  s_add_u32 m0, s29, 50176
  s_add_u32 s28, s46, 47104
  buffer_load_dwordx4 v5, s[12:15], s28 offen lds
  s_waitcnt vmcnt(10)
  s_barrier
  s_mul_i32 s29, s21, 10240
  s_add_u32 m0, s29, 81920
  s_add_u32 s28, s46, 81920
  buffer_load_dwordx4 v5, s[12:15], s28 offen lds
  s_mul_i32 s29, s21, 10240
  s_add_u32 m0, s29, 82944
  s_add_u32 s28, s46, 82176
  buffer_load_dwordx4 v5, s[12:15], s28 offen lds
  s_mul_i32 s29, s21, 10240
  s_add_u32 m0, s29, 83968
  s_add_u32 s28, s46, 82432
  buffer_load_dwordx4 v5, s[12:15], s28 offen lds
  s_mul_i32 s29, s21, 10240
  s_add_u32 m0, s29, 84992
  s_add_u32 s28, s46, 82688
  buffer_load_dwordx4 v5, s[12:15], s28 offen lds
  s_mul_i32 s29, s21, 10240
  s_add_u32 m0, s29, 86016
  s_add_u32 s28, s46, 82944
  buffer_load_dwordx4 v5, s[12:15], s28 offen lds
  s_mul_i32 s29, s21, 10240
  s_add_u32 m0, s29, 87040
  s_add_u32 s28, s46, 87040
  buffer_load_dwordx4 v5, s[12:15], s28 offen lds
  s_mul_i32 s29, s21, 10240
  s_add_u32 m0, s29, 88064
  s_add_u32 s28, s46, 87296
  buffer_load_dwordx4 v5, s[12:15], s28 offen lds
  s_mul_i32 s29, s21, 10240
  s_add_u32 m0, s29, 89088
  s_add_u32 s28, s46, 87552
  buffer_load_dwordx4 v5, s[12:15], s28 offen lds
  s_mul_i32 s29, s21, 10240
  s_add_u32 m0, s29, 90112
  s_add_u32 s28, s46, 87808
  buffer_load_dwordx4 v5, s[12:15], s28 offen lds
  s_mul_i32 s29, s21, 10240
  s_add_u32 m0, s29, 91136
  s_add_u32 s28, s46, 88064
  buffer_load_dwordx4 v5, s[12:15], s28 offen lds
  v_add_u32 v8, 0, v7
  ds_read_b64_tr_b16 a[0:1], v8 offset:0
  ds_read_b64_tr_b16 a[2:3], v8 offset:10240
  ds_read_b64_tr_b16 a[4:5], v8 offset:5120
  ds_read_b64_tr_b16 a[6:7], v8 offset:15360
  ds_read_b64_tr_b16 a[48:49], v8 offset:256
  ds_read_b64_tr_b16 a[50:51], v8 offset:10496
  ds_read_b64_tr_b16 a[52:53], v8 offset:5376
  ds_read_b64_tr_b16 a[54:55], v8 offset:15616
  ds_read_b64_tr_b16 a[96:97], v8 offset:512
  ds_read_b64_tr_b16 a[98:99], v8 offset:10752
  ds_read_b64_tr_b16 a[100:101], v8 offset:5632
  ds_read_b64_tr_b16 a[102:103], v8 offset:15872
  s_waitcnt lgkmcnt(0)
  ds_read_b64_tr_b16 a[144:145], v8 offset:768
  ds_read_b64_tr_b16 a[146:147], v8 offset:11008
  ds_read_b64_tr_b16 a[148:149], v8 offset:5888
  ds_read_b64_tr_b16 a[150:151], v8 offset:16128
  ds_read_b64_tr_b16 a[192:193], v8 offset:1024
  ds_read_b64_tr_b16 a[194:195], v8 offset:11264
  ds_read_b64_tr_b16 a[196:197], v8 offset:6144
  ds_read_b64_tr_b16 a[198:199], v8 offset:16384
  s_waitcnt lgkmcnt(0)
  s_waitcnt vmcnt(10)
  s_barrier
  s_mul_i32 s29, s21, 10240
  s_add_u32 m0, s29, 0
  s_add_u32 s28, s46, 122880
  buffer_load_dwordx4 v5, s[12:15], s28 offen lds
  s_mul_i32 s29, s21, 10240
  s_add_u32 m0, s29, 1024
  s_add_u32 s28, s46, 123136
  buffer_load_dwordx4 v5, s[12:15], s28 offen lds
  s_mul_i32 s29, s21, 10240
  s_add_u32 m0, s29, 2048
  s_add_u32 s28, s46, 123392
  buffer_load_dwordx4 v5, s[12:15], s28 offen lds
  s_mul_i32 s29, s21, 10240
  s_add_u32 m0, s29, 3072
  s_add_u32 s28, s46, 123648
  buffer_load_dwordx4 v5, s[12:15], s28 offen lds
  s_mul_i32 s29, s21, 10240
  s_add_u32 m0, s29, 4096
  s_add_u32 s28, s46, 123904
  buffer_load_dwordx4 v5, s[12:15], s28 offen lds
  s_mul_i32 s29, s21, 10240
  s_add_u32 m0, s29, 5120
  s_add_u32 s28, s46, 128000
  buffer_load_dwordx4 v5, s[12:15], s28 offen lds
  s_mul_i32 s29, s21, 10240
  s_add_u32 m0, s29, 6144
  s_add_u32 s28, s46, 128256
  buffer_load_dwordx4 v5, s[12:15], s28 offen lds
  s_mul_i32 s29, s21, 10240
  s_add_u32 m0, s29, 7168
  s_add_u32 s28, s46, 128512
  buffer_load_dwordx4 v5, s[12:15], s28 offen lds
  s_mul_i32 s29, s21, 10240
  s_add_u32 m0, s29, 8192
  s_add_u32 s28, s46, 128768
  buffer_load_dwordx4 v5, s[12:15], s28 offen lds
  s_mul_i32 s29, s21, 10240
  s_add_u32 m0, s29, 9216
  s_add_u32 s28, s46, 129024
  buffer_load_dwordx4 v5, s[12:15], s28 offen lds
  v_add_u32 v8, 40960, v7
  ds_read_b64_tr_b16 a[8:9], v8 offset:0
  ds_read_b64_tr_b16 a[10:11], v8 offset:10240
  ds_read_b64_tr_b16 a[12:13], v8 offset:5120
  ds_read_b64_tr_b16 a[14:15], v8 offset:15360
  ds_read_b64_tr_b16 a[56:57], v8 offset:256
  ds_read_b64_tr_b16 a[58:59], v8 offset:10496
  ds_read_b64_tr_b16 a[60:61], v8 offset:5376
  ds_read_b64_tr_b16 a[62:63], v8 offset:15616
  ds_read_b64_tr_b16 a[104:105], v8 offset:512
  ds_read_b64_tr_b16 a[106:107], v8 offset:10752
  ds_read_b64_tr_b16 a[108:109], v8 offset:5632
  ds_read_b64_tr_b16 a[110:111], v8 offset:15872
  s_waitcnt lgkmcnt(0)
  ds_read_b64_tr_b16 a[152:153], v8 offset:768
  ds_read_b64_tr_b16 a[154:155], v8 offset:11008
  ds_read_b64_tr_b16 a[156:157], v8 offset:5888
  ds_read_b64_tr_b16 a[158:159], v8 offset:16128
  ds_read_b64_tr_b16 a[200:201], v8 offset:1024
  ds_read_b64_tr_b16 a[202:203], v8 offset:11264
  ds_read_b64_tr_b16 a[204:205], v8 offset:6144
  ds_read_b64_tr_b16 a[206:207], v8 offset:16384
  s_waitcnt lgkmcnt(0)
  s_waitcnt vmcnt(10)
  s_barrier
  s_mul_i32 s29, s21, 10240
  s_add_u32 m0, s29, 40960
  s_add_u32 s28, s46, 163840
  buffer_load_dwordx4 v5, s[12:15], s28 offen lds
  s_mul_i32 s29, s21, 10240
  s_add_u32 m0, s29, 41984
  s_add_u32 s28, s46, 164096
  buffer_load_dwordx4 v5, s[12:15], s28 offen lds
  s_mul_i32 s29, s21, 10240
  s_add_u32 m0, s29, 43008
  s_add_u32 s28, s46, 164352
  buffer_load_dwordx4 v5, s[12:15], s28 offen lds
  s_mul_i32 s29, s21, 10240
  s_add_u32 m0, s29, 44032
  s_add_u32 s28, s46, 164608
  buffer_load_dwordx4 v5, s[12:15], s28 offen lds
  s_mul_i32 s29, s21, 10240
  s_add_u32 m0, s29, 45056
  s_add_u32 s28, s46, 164864
  buffer_load_dwordx4 v5, s[12:15], s28 offen lds
  s_mul_i32 s29, s21, 10240
  s_add_u32 m0, s29, 46080
  s_add_u32 s28, s46, 168960
  buffer_load_dwordx4 v5, s[12:15], s28 offen lds
  s_mul_i32 s29, s21, 10240
  s_add_u32 m0, s29, 47104
  s_add_u32 s28, s46, 169216
  buffer_load_dwordx4 v5, s[12:15], s28 offen lds
  s_mul_i32 s29, s21, 10240
  s_add_u32 m0, s29, 48128
  s_add_u32 s28, s46, 169472
  buffer_load_dwordx4 v5, s[12:15], s28 offen lds
  s_mul_i32 s29, s21, 10240
  s_add_u32 m0, s29, 49152
  s_add_u32 s28, s46, 169728
  buffer_load_dwordx4 v5, s[12:15], s28 offen lds
  s_mul_i32 s29, s21, 10240
  s_add_u32 m0, s29, 50176
  s_add_u32 s28, s46, 169984
  buffer_load_dwordx4 v5, s[12:15], s28 offen lds
  v_add_u32 v8, 81920, v7
  ds_read_b64_tr_b16 a[16:17], v8 offset:0
  ds_read_b64_tr_b16 a[18:19], v8 offset:10240
  ds_read_b64_tr_b16 a[20:21], v8 offset:5120
  ds_read_b64_tr_b16 a[22:23], v8 offset:15360
  ds_read_b64_tr_b16 a[64:65], v8 offset:256
  ds_read_b64_tr_b16 a[66:67], v8 offset:10496
  ds_read_b64_tr_b16 a[68:69], v8 offset:5376
  ds_read_b64_tr_b16 a[70:71], v8 offset:15616
  ds_read_b64_tr_b16 a[112:113], v8 offset:512
  ds_read_b64_tr_b16 a[114:115], v8 offset:10752
  ds_read_b64_tr_b16 a[116:117], v8 offset:5632
  ds_read_b64_tr_b16 a[118:119], v8 offset:15872
  s_waitcnt lgkmcnt(0)
  ds_read_b64_tr_b16 a[160:161], v8 offset:768
  ds_read_b64_tr_b16 a[162:163], v8 offset:11008
  ds_read_b64_tr_b16 a[164:165], v8 offset:5888
  ds_read_b64_tr_b16 a[166:167], v8 offset:16128
  ds_read_b64_tr_b16 a[208:209], v8 offset:1024
  ds_read_b64_tr_b16 a[210:211], v8 offset:11264
  ds_read_b64_tr_b16 a[212:213], v8 offset:6144
  ds_read_b64_tr_b16 a[214:215], v8 offset:16384
  s_waitcnt lgkmcnt(0)
  s_waitcnt vmcnt(10)
  s_barrier
  s_mul_i32 s29, s21, 10240
  s_add_u32 m0, s29, 81920
  s_add_u32 s28, s46, 204800
  buffer_load_dwordx4 v5, s[12:15], s28 offen lds
  s_mul_i32 s29, s21, 10240
  s_add_u32 m0, s29, 82944
  s_add_u32 s28, s46, 205056
  buffer_load_dwordx4 v5, s[12:15], s28 offen lds
  s_mul_i32 s29, s21, 10240
  s_add_u32 m0, s29, 83968
  s_add_u32 s28, s46, 205312
  buffer_load_dwordx4 v5, s[12:15], s28 offen lds
  s_mul_i32 s29, s21, 10240
  s_add_u32 m0, s29, 84992
  s_add_u32 s28, s46, 205568
  buffer_load_dwordx4 v5, s[12:15], s28 offen lds
  s_mul_i32 s29, s21, 10240
  s_add_u32 m0, s29, 86016
  s_add_u32 s28, s46, 205824
  buffer_load_dwordx4 v5, s[12:15], s28 offen lds
  s_mul_i32 s29, s21, 10240
  s_add_u32 m0, s29, 87040
  s_add_u32 s28, s46, 209920
  buffer_load_dwordx4 v5, s[12:15], s28 offen lds
  s_mul_i32 s29, s21, 10240
  s_add_u32 m0, s29, 88064
  s_add_u32 s28, s46, 210176
  buffer_load_dwordx4 v5, s[12:15], s28 offen lds
  s_mul_i32 s29, s21, 10240
  s_add_u32 m0, s29, 89088
  s_add_u32 s28, s46, 210432
  buffer_load_dwordx4 v5, s[12:15], s28 offen lds
  s_mul_i32 s29, s21, 10240
  s_add_u32 m0, s29, 90112
  s_add_u32 s28, s46, 210688
  buffer_load_dwordx4 v5, s[12:15], s28 offen lds
  s_mul_i32 s29, s21, 10240
  s_add_u32 m0, s29, 91136
  s_add_u32 s28, s46, 210944
  buffer_load_dwordx4 v5, s[12:15], s28 offen lds
  v_add_u32 v8, 0, v7
  ds_read_b64_tr_b16 a[24:25], v8 offset:0
  ds_read_b64_tr_b16 a[26:27], v8 offset:10240
  ds_read_b64_tr_b16 a[28:29], v8 offset:5120
  ds_read_b64_tr_b16 a[30:31], v8 offset:15360
  ds_read_b64_tr_b16 a[72:73], v8 offset:256
  ds_read_b64_tr_b16 a[74:75], v8 offset:10496
  ds_read_b64_tr_b16 a[76:77], v8 offset:5376
  ds_read_b64_tr_b16 a[78:79], v8 offset:15616
  ds_read_b64_tr_b16 a[120:121], v8 offset:512
  ds_read_b64_tr_b16 a[122:123], v8 offset:10752
  ds_read_b64_tr_b16 a[124:125], v8 offset:5632
  ds_read_b64_tr_b16 a[126:127], v8 offset:15872
  s_waitcnt lgkmcnt(0)
  ds_read_b64_tr_b16 a[168:169], v8 offset:768
  ds_read_b64_tr_b16 a[170:171], v8 offset:11008
  ds_read_b64_tr_b16 a[172:173], v8 offset:5888
  ds_read_b64_tr_b16 a[174:175], v8 offset:16128
  ds_read_b64_tr_b16 a[216:217], v8 offset:1024
  ds_read_b64_tr_b16 a[218:219], v8 offset:11264
  ds_read_b64_tr_b16 a[220:221], v8 offset:6144
  ds_read_b64_tr_b16 a[222:223], v8 offset:16384
  s_waitcnt lgkmcnt(0)
  s_waitcnt vmcnt(10)
  s_barrier
  v_add_u32 v8, 40960, v7
  ds_read_b64_tr_b16 a[32:33], v8 offset:0
  ds_read_b64_tr_b16 a[34:35], v8 offset:10240
  ds_read_b64_tr_b16 a[36:37], v8 offset:5120
  ds_read_b64_tr_b16 a[38:39], v8 offset:15360
  ds_read_b64_tr_b16 a[80:81], v8 offset:256
  ds_read_b64_tr_b16 a[82:83], v8 offset:10496
  ds_read_b64_tr_b16 a[84:85], v8 offset:5376
  ds_read_b64_tr_b16 a[86:87], v8 offset:15616
  ds_read_b64_tr_b16 a[128:129], v8 offset:512
  ds_read_b64_tr_b16 a[130:131], v8 offset:10752
  ds_read_b64_tr_b16 a[132:133], v8 offset:5632
  ds_read_b64_tr_b16 a[134:135], v8 offset:15872
  s_waitcnt lgkmcnt(0)
  ds_read_b64_tr_b16 a[176:177], v8 offset:768
  ds_read_b64_tr_b16 a[178:179], v8 offset:11008
  ds_read_b64_tr_b16 a[180:181], v8 offset:5888
  ds_read_b64_tr_b16 a[182:183], v8 offset:16128
  ds_read_b64_tr_b16 a[224:225], v8 offset:1024
  ds_read_b64_tr_b16 a[226:227], v8 offset:11264
  ds_read_b64_tr_b16 a[228:229], v8 offset:6144
  ds_read_b64_tr_b16 a[230:231], v8 offset:16384
  s_waitcnt lgkmcnt(0)
  s_waitcnt vmcnt(0)
  s_barrier
  v_add_u32 v8, 81920, v7
  ds_read_b64_tr_b16 a[40:41], v8 offset:0
  ds_read_b64_tr_b16 a[42:43], v8 offset:10240
  ds_read_b64_tr_b16 a[44:45], v8 offset:5120
  ds_read_b64_tr_b16 a[46:47], v8 offset:15360
  ds_read_b64_tr_b16 a[88:89], v8 offset:256
  ds_read_b64_tr_b16 a[90:91], v8 offset:10496
  ds_read_b64_tr_b16 a[92:93], v8 offset:5376
  ds_read_b64_tr_b16 a[94:95], v8 offset:15616
  ds_read_b64_tr_b16 a[136:137], v8 offset:512
  ds_read_b64_tr_b16 a[138:139], v8 offset:10752
  ds_read_b64_tr_b16 a[140:141], v8 offset:5632
  ds_read_b64_tr_b16 a[142:143], v8 offset:15872
  s_waitcnt lgkmcnt(0)
  ds_read_b64_tr_b16 a[184:185], v8 offset:768
  ds_read_b64_tr_b16 a[186:187], v8 offset:11008
  ds_read_b64_tr_b16 a[188:189], v8 offset:5888
  ds_read_b64_tr_b16 a[190:191], v8 offset:16128
  ds_read_b64_tr_b16 a[232:233], v8 offset:1024
  ds_read_b64_tr_b16 a[234:235], v8 offset:11264
  ds_read_b64_tr_b16 a[236:237], v8 offset:6144
  ds_read_b64_tr_b16 a[238:239], v8 offset:16384
  s_waitcnt lgkmcnt(0)
  s_barrier
  v_lshlrev_b32 v5, 4, v1
  s_lshl_b32 s28, s21, 10
  v_add_u32 v6, s28, v5
  v_bfe_u32 v2, v1, 4, 1
  v_lshlrev_b32 v9, 10, v2
  v_and_b32 v2, 15, v1
  v_lshlrev_b32 v2, 4, v2
  v_add_u32 v9, v9, v2
  v_lshrrev_b32 v3, 5, v1
  v_lshlrev_b32 v3, 8, v3
  v_add_u32 v9, v9, v3
  v_add_u32 v10, 12288, v9
  v_bfe_u32 v3, v1, 4, 1
  v_lshlrev_b32 v11, 10, v3
  v_add_u32 v11, v11, v2
  v_lshrrev_b32 v3, 5, v1
  v_lshlrev_b32 v3, 9, v3
  v_add_u32 v11, v11, v3
  s_mul_i32 s28, s23, 6
  s_lshr_b32 s29, s28, 3
  s_add_u32 s28, s28, 5
  s_lshr_b32 s28, s28, 3
  v_and_b32 v2, 1, v1
  v_mov_b32 v12, s29
  v_mov_b32 v13, s28
  v_cmp_eq_u32 vcc, 1, v2
  s_nop 1
  v_cndmask_b32 v12, v12, v13, vcc
  v_lshlrev_b32 v12, 2, v12
  v_add_u32 v12, 2048, v12
  s_lshl_b32 s28, s23, 2
  s_add_u32 s28, s28, 3072
  v_mov_b32 v14, s28
  s_mul_i32 s47, s23, 786432
  s_add_u32 s47, s47, 0x7800000
  s_mul_i32 s48, s23, 40960
  s_mul_i32 s28, s21, 10240
  s_add_u32 s48, s48, s28
  s_add_u32 s48, s48, 0x9000000
  s_mov_b32 s50, 0
  s_mov_b32 s52, 0
  s_mov_b32 s53, 0
  s_cmp_gt_u32 s52, s53
  s_cbranch_scc1 ka_wp_32_ok
  s_mov_b32 s45, 0
ka_wp_32_spin:
  buffer_load_dword v2, v12, s[8:11], 0 offen sc1
  s_add_u32 s45, s45, 1
  s_waitcnt vmcnt(0)
  v_min_u32_dpp v3, v2, v2 quad_perm:[1,0,3,2] row_mask:0xf bank_mask:0xf
  s_nop 1
  v_min_u32_dpp v2, v3, v3 quad_perm:[2,3,0,1] row_mask:0xf bank_mask:0xf
  s_nop 1
  v_min_u32_dpp v3, v2, v2 row_half_mirror row_mask:0xf bank_mask:0xf
  s_nop 1
  v_min_u32_dpp v2, v3, v3 quad_perm:[0,1,2,3] row_mask:0xf bank_mask:0xf
  s_nop 0
  v_readfirstlane_b32 s52, v2
  s_cmp_gt_u32 s52, s53
  s_cbranch_scc1 ka_wp_32_ok
  s_cmp_lt_u32 s45, 400000
  s_cbranch_scc1 ka_wp_32_spin
  s_branch ka_abort
ka_wp_32_ok:
  s_lshl_b32 s29, s21, 10
  s_add_u32 m0, s29, 0
  s_add_u32 s28, s47, 0
  buffer_load_dwordx4 v6, s[8:11], s28 offen sc1 lds
  s_lshl_b32 s29, s21, 10
  s_add_u32 m0, s29, 4096
  s_add_u32 s28, s47, 4096
  buffer_load_dwordx4 v6, s[8:11], s28 offen sc1 lds
  s_lshl_b32 s29, s21, 10
  s_add_u32 m0, s29, 8192
  s_add_u32 s28, s47, 8192
  buffer_load_dwordx4 v6, s[8:11], s28 offen sc1 lds
  s_add_u32 s47, s47, 12288
ka_u_loop:
  s_cmp_eq_u32 s50, 0
  s_cbranch_scc0 u0_33
  s_waitcnt vmcnt(0)
u0_33:
  s_waitcnt vmcnt(10)
  s_barrier
  s_cmp_eq_u32 s21, 0
  s_cbranch_scc0 up_34
  s_cmp_ge_u32 s50, 1
  s_cbranch_scc0 up_34
  s_sub_u32 s28, s50, 1
  v_mov_b32 v13, s28
  s_mov_b64 s[24:25], exec
  s_mov_b64 exec, 1
  buffer_store_dword v13, v14, s[8:11], 0 offen sc1
  s_mov_b64 exec, s[24:25]
up_34:
  ds_read_b128 v[16:19], v9 offset:0
  ds_read_b128 v[20:23], v9 offset:512
  ds_read_b128 v[24:27], v9 offset:2048
  ds_read_b128 v[28:31], v9 offset:2560
  ds_read_b128 v[32:35], v9 offset:4096
  ds_read_b128 v[36:39], v9 offset:4608
  ds_read_b128 v[40:43], v9 offset:6144
  ds_read_b128 v[44:47], v9 offset:6656
  ds_read_b128 v[48:51], v9 offset:8192
  ds_read_b128 v[52:55], v9 offset:8704
  ds_read_b128 v[56:59], v9 offset:10240
  ds_read_b128 v[60:63], v9 offset:10752
  s_cmp_ge_u32 s50, 63
  s_cbranch_scc1 un_35
  s_add_u32 s53, s50, 1
  s_cmp_gt_u32 s52, s53
  s_cbranch_scc1 ka_wp_36_ok
  s_mov_b32 s45, 0
ka_wp_36_spin:
  buffer_load_dword v2, v12, s[8:11], 0 offen sc1
  s_add_u32 s45, s45, 1
  s_waitcnt vmcnt(0)
  v_min_u32_dpp v3, v2, v2 quad_perm:[1,0,3,2] row_mask:0xf bank_mask:0xf
  s_nop 1
  v_min_u32_dpp v2, v3, v3 quad_perm:[2,3,0,1] row_mask:0xf bank_mask:0xf
  s_nop 1
  v_min_u32_dpp v3, v2, v2 row_half_mirror row_mask:0xf bank_mask:0xf
  s_nop 1
  v_min_u32_dpp v2, v3, v3 quad_perm:[0,1,2,3] row_mask:0xf bank_mask:0xf
  s_nop 0
  v_readfirstlane_b32 s52, v2
  s_cmp_gt_u32 s52, s53
  s_cbranch_scc1 ka_wp_36_ok
  s_cmp_lt_u32 s45, 400000
  s_cbranch_scc1 ka_wp_36_spin
  s_branch ka_abort
ka_wp_36_ok:
  s_lshl_b32 s29, s21, 10
  s_add_u32 m0, s29, 12288
  s_add_u32 s28, s47, 0
  buffer_load_dwordx4 v6, s[8:11], s28 offen sc1 lds
  s_lshl_b32 s29, s21, 10
  s_add_u32 m0, s29, 16384
  s_add_u32 s28, s47, 4096
  buffer_load_dwordx4 v6, s[8:11], s28 offen sc1 lds
  s_lshl_b32 s29, s21, 10
  s_add_u32 m0, s29, 20480
  s_add_u32 s28, s47, 8192
  buffer_load_dwordx4 v6, s[8:11], s28 offen sc1 lds
  s_add_u32 s47, s47, 12288
un_35:
  s_mul_i32 s30, s50, 1310720
  s_add_u32 s30, s30, s48
  s_waitcnt lgkmcnt(11)
  v_mfma_f32_32x32x16_bf16 v[64:79], v[16:19], a[0:3], 0
  s_waitcnt lgkmcnt(10)
  v_mfma_f32_32x32x16_bf16 v[64:79], v[20:23], a[4:7], v[64:79]
  s_waitcnt lgkmcnt(9)
  v_mfma_f32_32x32x16_bf16 v[64:79], v[24:27], a[8:11], v[64:79]
  s_waitcnt lgkmcnt(8)
  v_mfma_f32_32x32x16_bf16 v[64:79], v[28:31], a[12:15], v[64:79]
  s_waitcnt lgkmcnt(7)
  v_mfma_f32_32x32x16_bf16 v[64:79], v[32:35], a[16:19], v[64:79]
  s_waitcnt lgkmcnt(6)
  v_mfma_f32_32x32x16_bf16 v[64:79], v[36:39], a[20:23], v[64:79]
  s_waitcnt lgkmcnt(5)
  v_mfma_f32_32x32x16_bf16 v[64:79], v[40:43], a[24:27], v[64:79]
  s_waitcnt lgkmcnt(4)
  v_mfma_f32_32x32x16_bf16 v[64:79], v[44:47], a[28:31], v[64:79]
  s_waitcnt lgkmcnt(3)
  v_mfma_f32_32x32x16_bf16 v[64:79], v[48:51], a[32:35], v[64:79]
  s_waitcnt lgkmcnt(2)
  v_mfma_f32_32x32x16_bf16 v[64:79], v[52:55], a[36:39], v[64:79]
  s_waitcnt lgkmcnt(1)
  v_mfma_f32_32x32x16_bf16 v[64:79], v[56:59], a[40:43], v[64:79]
  s_waitcnt lgkmcnt(0)
  v_mfma_f32_32x32x16_bf16 v[64:79], v[60:63], a[44:47], v[64:79]
  v_mfma_f32_32x32x16_bf16 v[80:95], v[16:19], a[48:51], 0
  v_mfma_f32_32x32x16_bf16 v[80:95], v[20:23], a[52:55], v[80:95]
  v_mfma_f32_32x32x16_bf16 v[80:95], v[24:27], a[56:59], v[80:95]
  v_cvt_pk_bf16_f32 v96, v64, v65
  v_cvt_pk_bf16_f32 v97, v66, v67
  v_mfma_f32_32x32x16_bf16 v[80:95], v[28:31], a[60:63], v[80:95]
  v_cvt_pk_bf16_f32 v98, v68, v69
  v_cvt_pk_bf16_f32 v99, v70, v71
  v_mfma_f32_32x32x16_bf16 v[80:95], v[32:35], a[64:67], v[80:95]
  v_cvt_pk_bf16_f32 v100, v72, v73
  v_cvt_pk_bf16_f32 v101, v74, v75
  v_mfma_f32_32x32x16_bf16 v[80:95], v[36:39], a[68:71], v[80:95]
  v_cvt_pk_bf16_f32 v102, v76, v77
  v_cvt_pk_bf16_f32 v103, v78, v79
  v_mfma_f32_32x32x16_bf16 v[80:95], v[40:43], a[72:75], v[80:95]
  s_add_u32 s29, s30, 0
  buffer_store_dwordx4 v[96:99], v11, s[8:11], s29 offen offset:0 sc1
  v_mfma_f32_32x32x16_bf16 v[80:95], v[44:47], a[76:79], v[80:95]
  buffer_store_dwordx4 v[100:103], v11, s[8:11], s29 offen offset:256 sc1
  v_mfma_f32_32x32x16_bf16 v[80:95], v[48:51], a[80:83], v[80:95]
  v_mfma_f32_32x32x16_bf16 v[80:95], v[52:55], a[84:87], v[80:95]
  v_mfma_f32_32x32x16_bf16 v[80:95], v[56:59], a[88:91], v[80:95]
  v_mfma_f32_32x32x16_bf16 v[80:95], v[60:63], a[92:95], v[80:95]
  v_mfma_f32_32x32x16_bf16 v[64:79], v[16:19], a[96:99], 0
  v_mfma_f32_32x32x16_bf16 v[64:79], v[20:23], a[100:103], v[64:79]
  v_mfma_f32_32x32x16_bf16 v[64:79], v[24:27], a[104:107], v[64:79]
  v_cvt_pk_bf16_f32 v96, v80, v81
  v_cvt_pk_bf16_f32 v97, v82, v83
  v_mfma_f32_32x32x16_bf16 v[64:79], v[28:31], a[108:111], v[64:79]
  v_cvt_pk_bf16_f32 v98, v84, v85
  v_cvt_pk_bf16_f32 v99, v86, v87
  v_mfma_f32_32x32x16_bf16 v[64:79], v[32:35], a[112:115], v[64:79]
  v_cvt_pk_bf16_f32 v100, v88, v89
  v_cvt_pk_bf16_f32 v101, v90, v91
  v_mfma_f32_32x32x16_bf16 v[64:79], v[36:39], a[116:119], v[64:79]
  v_cvt_pk_bf16_f32 v102, v92, v93
  v_cvt_pk_bf16_f32 v103, v94, v95
  v_mfma_f32_32x32x16_bf16 v[64:79], v[40:43], a[120:123], v[64:79]
  s_add_u32 s29, s30, 2048
  buffer_store_dwordx4 v[96:99], v11, s[8:11], s29 offen offset:0 sc1
  v_mfma_f32_32x32x16_bf16 v[64:79], v[44:47], a[124:127], v[64:79]
  buffer_store_dwordx4 v[100:103], v11, s[8:11], s29 offen offset:256 sc1
  v_mfma_f32_32x32x16_bf16 v[64:79], v[48:51], a[128:131], v[64:79]
  v_mfma_f32_32x32x16_bf16 v[64:79], v[52:55], a[132:135], v[64:79]
  v_mfma_f32_32x32x16_bf16 v[64:79], v[56:59], a[136:139], v[64:79]
  v_mfma_f32_32x32x16_bf16 v[64:79], v[60:63], a[140:143], v[64:79]
  v_mfma_f32_32x32x16_bf16 v[80:95], v[16:19], a[144:147], 0
  v_mfma_f32_32x32x16_bf16 v[80:95], v[20:23], a[148:151], v[80:95]
  v_mfma_f32_32x32x16_bf16 v[80:95], v[24:27], a[152:155], v[80:95]
  v_cvt_pk_bf16_f32 v96, v64, v65
  v_cvt_pk_bf16_f32 v97, v66, v67
  v_mfma_f32_32x32x16_bf16 v[80:95], v[28:31], a[156:159], v[80:95]
  v_cvt_pk_bf16_f32 v98, v68, v69
  v_cvt_pk_bf16_f32 v99, v70, v71
  v_mfma_f32_32x32x16_bf16 v[80:95], v[32:35], a[160:163], v[80:95]
  v_cvt_pk_bf16_f32 v100, v72, v73
  v_cvt_pk_bf16_f32 v101, v74, v75
  v_mfma_f32_32x32x16_bf16 v[80:95], v[36:39], a[164:167], v[80:95]
  v_cvt_pk_bf16_f32 v102, v76, v77
  v_cvt_pk_bf16_f32 v103, v78, v79
  v_mfma_f32_32x32x16_bf16 v[80:95], v[40:43], a[168:171], v[80:95]
  s_add_u32 s29, s30, 4096
  buffer_store_dwordx4 v[96:99], v11, s[8:11], s29 offen offset:0 sc1
  v_mfma_f32_32x32x16_bf16 v[80:95], v[44:47], a[172:175], v[80:95]
  buffer_store_dwordx4 v[100:103], v11, s[8:11], s29 offen offset:256 sc1
  v_mfma_f32_32x32x16_bf16 v[80:95], v[48:51], a[176:179], v[80:95]
  v_mfma_f32_32x32x16_bf16 v[80:95], v[52:55], a[180:183], v[80:95]
  v_mfma_f32_32x32x16_bf16 v[80:95], v[56:59], a[184:187], v[80:95]
  v_mfma_f32_32x32x16_bf16 v[80:95], v[60:63], a[188:191], v[80:95]
  v_mfma_f32_32x32x16_bf16 v[64:79], v[16:19], a[192:195], 0
  v_mfma_f32_32x32x16_bf16 v[64:79], v[20:23], a[196:199], v[64:79]
  v_mfma_f32_32x32x16_bf16 v[64:79], v[24:27], a[200:203], v[64:79]
  v_cvt_pk_bf16_f32 v96, v80, v81
  v_cvt_pk_bf16_f32 v97, v82, v83
  v_mfma_f32_32x32x16_bf16 v[64:79], v[28:31], a[204:207], v[64:79]
  v_cvt_pk_bf16_f32 v98, v84, v85
  v_cvt_pk_bf16_f32 v99, v86, v87
  v_mfma_f32_32x32x16_bf16 v[64:79], v[32:35], a[208:211], v[64:79]
  v_cvt_pk_bf16_f32 v100, v88, v89
  v_cvt_pk_bf16_f32 v101, v90, v91
  v_mfma_f32_32x32x16_bf16 v[64:79], v[36:39], a[212:215], v[64:79]
  v_cvt_pk_bf16_f32 v102, v92, v93
  v_cvt_pk_bf16_f32 v103, v94, v95
  v_mfma_f32_32x32x16_bf16 v[64:79], v[40:43], a[216:219], v[64:79]
  s_add_u32 s29, s30, 6144
  buffer_store_dwordx4 v[96:99], v11, s[8:11], s29 offen offset:0 sc1
  v_mfma_f32_32x32x16_bf16 v[64:79], v[44:47], a[220:223], v[64:79]
  buffer_store_dwordx4 v[100:103], v11, s[8:11], s29 offen offset:256 sc1
  v_mfma_f32_32x32x16_bf16 v[64:79], v[48:51], a[224:227], v[64:79]
  v_mfma_f32_32x32x16_bf16 v[64:79], v[52:55], a[228:231], v[64:79]
  v_mfma_f32_32x32x16_bf16 v[64:79], v[56:59], a[232:235], v[64:79]
  v_mfma_f32_32x32x16_bf16 v[64:79], v[60:63], a[236:239], v[64:79]
  s_nop 11
  v_cvt_pk_bf16_f32 v96, v64, v65
  v_cvt_pk_bf16_f32 v97, v66, v67
  v_cvt_pk_bf16_f32 v98, v68, v69
  v_cvt_pk_bf16_f32 v99, v70, v71
  v_cvt_pk_bf16_f32 v100, v72, v73
  v_cvt_pk_bf16_f32 v101, v74, v75
  v_cvt_pk_bf16_f32 v102, v76, v77
  v_cvt_pk_bf16_f32 v103, v78, v79
  s_add_u32 s29, s30, 8192
  buffer_store_dwordx4 v[96:99], v11, s[8:11], s29 offen offset:0 sc1
  buffer_store_dwordx4 v[100:103], v11, s[8:11], s29 offen offset:256 sc1
  s_add_u32 s50, s50, 1
  s_waitcnt vmcnt(10)
  s_barrier
  s_cmp_eq_u32 s21, 0
  s_cbranch_scc0 up_37
  s_cmp_ge_u32 s50, 1
  s_cbranch_scc0 up_37
  s_sub_u32 s28, s50, 1
  v_mov_b32 v13, s28
  s_mov_b64 s[24:25], exec
  s_mov_b64 exec, 1
  buffer_store_dword v13, v14, s[8:11], 0 offen sc1
  s_mov_b64 exec, s[24:25]
up_37:
  ds_read_b128 v[16:19], v10 offset:0
  ds_read_b128 v[20:23], v10 offset:512
  ds_read_b128 v[24:27], v10 offset:2048
  ds_read_b128 v[28:31], v10 offset:2560
  ds_read_b128 v[32:35], v10 offset:4096
  ds_read_b128 v[36:39], v10 offset:4608
  ds_read_b128 v[40:43], v10 offset:6144
  ds_read_b128 v[44:47], v10 offset:6656
  ds_read_b128 v[48:51], v10 offset:8192
  ds_read_b128 v[52:55], v10 offset:8704
  ds_read_b128 v[56:59], v10 offset:10240
  ds_read_b128 v[60:63], v10 offset:10752
  s_cmp_ge_u32 s50, 63
  s_cbranch_scc1 un_38
  s_add_u32 s53, s50, 1
  s_cmp_gt_u32 s52, s53
  s_cbranch_scc1 ka_wp_39_ok
  s_mov_b32 s45, 0
ka_wp_39_spin:
  buffer_load_dword v2, v12, s[8:11], 0 offen sc1
  s_add_u32 s45, s45, 1
  s_waitcnt vmcnt(0)
  v_min_u32_dpp v3, v2, v2 quad_perm:[1,0,3,2] row_mask:0xf bank_mask:0xf
  s_nop 1
  v_min_u32_dpp v2, v3, v3 quad_perm:[2,3,0,1] row_mask:0xf bank_mask:0xf
  s_nop 1
  v_min_u32_dpp v3, v2, v2 row_half_mirror row_mask:0xf bank_mask:0xf
  s_nop 1
  v_min_u32_dpp v2, v3, v3 quad_perm:[0,1,2,3] row_mask:0xf bank_mask:0xf
  s_nop 0
  v_readfirstlane_b32 s52, v2
  s_cmp_gt_u32 s52, s53
  s_cbranch_scc1 ka_wp_39_ok
  s_cmp_lt_u32 s45, 400000
  s_cbranch_scc1 ka_wp_39_spin
  s_branch ka_abort
ka_wp_39_ok:
  s_lshl_b32 s29, s21, 10
  s_add_u32 m0, s29, 0
  s_add_u32 s28, s47, 0
  buffer_load_dwordx4 v6, s[8:11], s28 offen sc1 lds
  s_lshl_b32 s29, s21, 10
  s_add_u32 m0, s29, 4096
  s_add_u32 s28, s47, 4096
  buffer_load_dwordx4 v6, s[8:11], s28 offen sc1 lds
  s_lshl_b32 s29, s21, 10
  s_add_u32 m0, s29, 8192
  s_add_u32 s28, s47, 8192
  buffer_load_dwordx4 v6, s[8:11], s28 offen sc1 lds
  s_add_u32 s47, s47, 12288
un_38:
  s_mul_i32 s30, s50, 1310720
  s_add_u32 s30, s30, s48
  s_waitcnt lgkmcnt(11)
  v_mfma_f32_32x32x16_bf16 v[64:79], v[16:19], a[0:3], 0
  s_waitcnt lgkmcnt(10)
  v_mfma_f32_32x32x16_bf16 v[64:79], v[20:23], a[4:7], v[64:79]
  s_waitcnt lgkmcnt(9)
  v_mfma_f32_32x32x16_bf16 v[64:79], v[24:27], a[8:11], v[64:79]
  s_waitcnt lgkmcnt(8)
  v_mfma_f32_32x32x16_bf16 v[64:79], v[28:31], a[12:15], v[64:79]
  s_waitcnt lgkmcnt(7)
  v_mfma_f32_32x32x16_bf16 v[64:79], v[32:35], a[16:19], v[64:79]
  s_waitcnt lgkmcnt(6)
  v_mfma_f32_32x32x16_bf16 v[64:79], v[36:39], a[20:23], v[64:79]
  s_waitcnt lgkmcnt(5)
  v_mfma_f32_32x32x16_bf16 v[64:79], v[40:43], a[24:27], v[64:79]
  s_waitcnt lgkmcnt(4)
  v_mfma_f32_32x32x16_bf16 v[64:79], v[44:47], a[28:31], v[64:79]
  s_waitcnt lgkmcnt(3)
  v_mfma_f32_32x32x16_bf16 v[64:79], v[48:51], a[32:35], v[64:79]
  s_waitcnt lgkmcnt(2)
  v_mfma_f32_32x32x16_bf16 v[64:79], v[52:55], a[36:39], v[64:79]
  s_waitcnt lgkmcnt(1)
  v_mfma_f32_32x32x16_bf16 v[64:79], v[56:59], a[40:43], v[64:79]
  s_waitcnt lgkmcnt(0)
  v_mfma_f32_32x32x16_bf16 v[64:79], v[60:63], a[44:47], v[64:79]
  v_mfma_f32_32x32x16_bf16 v[80:95], v[16:19], a[48:51], 0
  v_mfma_f32_32x32x16_bf16 v[80:95], v[20:23], a[52:55], v[80:95]
  v_mfma_f32_32x32x16_bf16 v[80:95], v[24:27], a[56:59], v[80:95]
  v_cvt_pk_bf16_f32 v96, v64, v65
  v_cvt_pk_bf16_f32 v97, v66, v67
  v_mfma_f32_32x32x16_bf16 v[80:95], v[28:31], a[60:63], v[80:95]
  v_cvt_pk_bf16_f32 v98, v68, v69
  v_cvt_pk_bf16_f32 v99, v70, v71
  v_mfma_f32_32x32x16_bf16 v[80:95], v[32:35], a[64:67], v[80:95]
  v_cvt_pk_bf16_f32 v100, v72, v73
  v_cvt_pk_bf16_f32 v101, v74, v75
  v_mfma_f32_32x32x16_bf16 v[80:95], v[36:39], a[68:71], v[80:95]
  v_cvt_pk_bf16_f32 v102, v76, v77
  v_cvt_pk_bf16_f32 v103, v78, v79
  v_mfma_f32_32x32x16_bf16 v[80:95], v[40:43], a[72:75], v[80:95]
  s_add_u32 s29, s30, 0
  buffer_store_dwordx4 v[96:99], v11, s[8:11], s29 offen offset:0 sc1
  v_mfma_f32_32x32x16_bf16 v[80:95], v[44:47], a[76:79], v[80:95]
  buffer_store_dwordx4 v[100:103], v11, s[8:11], s29 offen offset:256 sc1
  v_mfma_f32_32x32x16_bf16 v[80:95], v[48:51], a[80:83], v[80:95]
  v_mfma_f32_32x32x16_bf16 v[80:95], v[52:55], a[84:87], v[80:95]
  v_mfma_f32_32x32x16_bf16 v[80:95], v[56:59], a[88:91], v[80:95]
  v_mfma_f32_32x32x16_bf16 v[80:95], v[60:63], a[92:95], v[80:95]
  v_mfma_f32_32x32x16_bf16 v[64:79], v[16:19], a[96:99], 0
  v_mfma_f32_32x32x16_bf16 v[64:79], v[20:23], a[100:103], v[64:79]
  v_mfma_f32_32x32x16_bf16 v[64:79], v[24:27], a[104:107], v[64:79]
  v_cvt_pk_bf16_f32 v96, v80, v81
  v_cvt_pk_bf16_f32 v97, v82, v83
  v_mfma_f32_32x32x16_bf16 v[64:79], v[28:31], a[108:111], v[64:79]
  v_cvt_pk_bf16_f32 v98, v84, v85
  v_cvt_pk_bf16_f32 v99, v86, v87
  v_mfma_f32_32x32x16_bf16 v[64:79], v[32:35], a[112:115], v[64:79]
  v_cvt_pk_bf16_f32 v100, v88, v89
  v_cvt_pk_bf16_f32 v101, v90, v91
  v_mfma_f32_32x32x16_bf16 v[64:79], v[36:39], a[116:119], v[64:79]
  v_cvt_pk_bf16_f32 v102, v92, v93
  v_cvt_pk_bf16_f32 v103, v94, v95
  v_mfma_f32_32x32x16_bf16 v[64:79], v[40:43], a[120:123], v[64:79]
  s_add_u32 s29, s30, 2048
  buffer_store_dwordx4 v[96:99], v11, s[8:11], s29 offen offset:0 sc1
  v_mfma_f32_32x32x16_bf16 v[64:79], v[44:47], a[124:127], v[64:79]
  buffer_store_dwordx4 v[100:103], v11, s[8:11], s29 offen offset:256 sc1
  v_mfma_f32_32x32x16_bf16 v[64:79], v[48:51], a[128:131], v[64:79]
  v_mfma_f32_32x32x16_bf16 v[64:79], v[52:55], a[132:135], v[64:79]
  v_mfma_f32_32x32x16_bf16 v[64:79], v[56:59], a[136:139], v[64:79]
  v_mfma_f32_32x32x16_bf16 v[64:79], v[60:63], a[140:143], v[64:79]
  v_mfma_f32_32x32x16_bf16 v[80:95], v[16:19], a[144:147], 0
  v_mfma_f32_32x32x16_bf16 v[80:95], v[20:23], a[148:151], v[80:95]
  v_mfma_f32_32x32x16_bf16 v[80:95], v[24:27], a[152:155], v[80:95]
  v_cvt_pk_bf16_f32 v96, v64, v65
  v_cvt_pk_bf16_f32 v97, v66, v67
  v_mfma_f32_32x32x16_bf16 v[80:95], v[28:31], a[156:159], v[80:95]
  v_cvt_pk_bf16_f32 v98, v68, v69
  v_cvt_pk_bf16_f32 v99, v70, v71
  v_mfma_f32_32x32x16_bf16 v[80:95], v[32:35], a[160:163], v[80:95]
  v_cvt_pk_bf16_f32 v100, v72, v73
  v_cvt_pk_bf16_f32 v101, v74, v75
  v_mfma_f32_32x32x16_bf16 v[80:95], v[36:39], a[164:167], v[80:95]
  v_cvt_pk_bf16_f32 v102, v76, v77
  v_cvt_pk_bf16_f32 v103, v78, v79
  v_mfma_f32_32x32x16_bf16 v[80:95], v[40:43], a[168:171], v[80:95]
  s_add_u32 s29, s30, 4096
  buffer_store_dwordx4 v[96:99], v11, s[8:11], s29 offen offset:0 sc1
  v_mfma_f32_32x32x16_bf16 v[80:95], v[44:47], a[172:175], v[80:95]
  buffer_store_dwordx4 v[100:103], v11, s[8:11], s29 offen offset:256 sc1
  v_mfma_f32_32x32x16_bf16 v[80:95], v[48:51], a[176:179], v[80:95]
  v_mfma_f32_32x32x16_bf16 v[80:95], v[52:55], a[180:183], v[80:95]
  v_mfma_f32_32x32x16_bf16 v[80:95], v[56:59], a[184:187], v[80:95]
  v_mfma_f32_32x32x16_bf16 v[80:95], v[60:63], a[188:191], v[80:95]
  v_mfma_f32_32x32x16_bf16 v[64:79], v[16:19], a[192:195], 0
  v_mfma_f32_32x32x16_bf16 v[64:79], v[20:23], a[196:199], v[64:79]
  v_mfma_f32_32x32x16_bf16 v[64:79], v[24:27], a[200:203], v[64:79]
  v_cvt_pk_bf16_f32 v96, v80, v81
  v_cvt_pk_bf16_f32 v97, v82, v83
  v_mfma_f32_32x32x16_bf16 v[64:79], v[28:31], a[204:207], v[64:79]
  v_cvt_pk_bf16_f32 v98, v84, v85
  v_cvt_pk_bf16_f32 v99, v86, v87
  v_mfma_f32_32x32x16_bf16 v[64:79], v[32:35], a[208:211], v[64:79]
  v_cvt_pk_bf16_f32 v100, v88, v89
  v_cvt_pk_bf16_f32 v101, v90, v91
  v_mfma_f32_32x32x16_bf16 v[64:79], v[36:39], a[212:215], v[64:79]
  v_cvt_pk_bf16_f32 v102, v92, v93
  v_cvt_pk_bf16_f32 v103, v94, v95
  v_mfma_f32_32x32x16_bf16 v[64:79], v[40:43], a[216:219], v[64:79]
  s_add_u32 s29, s30, 6144
  buffer_store_dwordx4 v[96:99], v11, s[8:11], s29 offen offset:0 sc1
  v_mfma_f32_32x32x16_bf16 v[64:79], v[44:47], a[220:223], v[64:79]
  buffer_store_dwordx4 v[100:103], v11, s[8:11], s29 offen offset:256 sc1
  v_mfma_f32_32x32x16_bf16 v[64:79], v[48:51], a[224:227], v[64:79]
  v_mfma_f32_32x32x16_bf16 v[64:79], v[52:55], a[228:231], v[64:79]
  v_mfma_f32_32x32x16_bf16 v[64:79], v[56:59], a[232:235], v[64:79]
  v_mfma_f32_32x32x16_bf16 v[64:79], v[60:63], a[236:239], v[64:79]
  s_nop 11
  v_cvt_pk_bf16_f32 v96, v64, v65
  v_cvt_pk_bf16_f32 v97, v66, v67
  v_cvt_pk_bf16_f32 v98, v68, v69
  v_cvt_pk_bf16_f32 v99, v70, v71
  v_cvt_pk_bf16_f32 v100, v72, v73
  v_cvt_pk_bf16_f32 v101, v74, v75
  v_cvt_pk_bf16_f32 v102, v76, v77
  v_cvt_pk_bf16_f32 v103, v78, v79
  s_add_u32 s29, s30, 8192
  buffer_store_dwordx4 v[96:99], v11, s[8:11], s29 offen offset:0 sc1
  buffer_store_dwordx4 v[100:103], v11, s[8:11], s29 offen offset:256 sc1
  s_add_u32 s50, s50, 1
  s_cmp_lt_u32 s50, 64
  s_cbranch_scc1 ka_u_loop
  s_waitcnt vmcnt(0)
  s_barrier
  s_cmp_eq_u32 s21, 0
  s_cbranch_scc0 ka_exit
  v_mov_b32 v13, 64
  s_mov_b64 exec, 1
  buffer_store_dword v13, v14, s[8:11], 0 offen sc1
  s_waitcnt vmcnt(0)
  s_branch ka_exit
kaf_x:
  s_mov_b32 s12, s36
  s_and_b32 s13, s37, 0xffff
  s_mov_b32 s14, 0x780000
  s_mov_b32 s15, 0x20000
  s_mov_b32 s16, s38
  s_and_b32 s17, s39, 0xffff
  s_mov_b32 s18, 0x780000
  s_mov_b32 s19, 0x20000
  v_and_b32 v1, 63, v0
  v_lshrrev_b32 v2, 4, v1
  v_bfe_u32 v3, v1, 3, 1
  v_bfe_u32 v4, v1, 1, 2
  v_and_b32 v5, 1, v1
  s_mul_i32 s46, s23, 384
  s_lshl_b32 s28, s21, 2
  s_add_u32 s28, s28, 0
  v_add_u32 v6, s28, v2
  v_mul_u32_u24 v7, 43, v6
  v_lshrrev_b32 v7, 9, v7
  v_mul_u32_u24 v8, 12, v7
  v_sub_u32 v8, v6, v8
  v_lshrrev_b32 v9, 1, v7
  v_lshlrev_b32 v9, 4, v9
  v_and_b32 v10, 1, v7
  v_lshlrev_b32 v10, 2, v10
  v_add_u32 v9, v9, v10
  v_lshlrev_b32 v10, 3, v3
  v_add_u32 v9, v9, v10
  v_add_u32 v9, v9, v4
  v_mul_u32_u24 v9, 12288, v9
  v_lshrrev_b32 v10, 1, v8
  v_lshlrev_b32 v10, 2, v10
  v_lshlrev_b32 v11, 1, v5
  v_add_u32 v10, v10, v11
  v_and_b32 v11, 1, v8
  v_add_u32 v10, v10, v11
  v_lshlrev_b32 v10, 4, v10
  v_add_u32 v9, v9, v10
  v_add_u32 v136, s46, v9
  s_lshl_b32 s28, s21, 2
  s_add_u32 s28, s28, 16
  v_add_u32 v6, s28, v2
  v_mul_u32_u24 v7, 43, v6
  v_lshrrev_b32 v7, 9, v7
  v_mul_u32_u24 v8, 12, v7
  v_sub_u32 v8, v6, v8
  v_lshrrev_b32 v9, 1, v7
  v_lshlrev_b32 v9, 4, v9
  v_and_b32 v10, 1, v7
  v_lshlrev_b32 v10, 2, v10
  v_add_u32 v9, v9, v10
  v_lshlrev_b32 v10, 3, v3
  v_add_u32 v9, v9, v10
  v_add_u32 v9, v9, v4
  v_mul_u32_u24 v9, 12288, v9
  v_lshrrev_b32 v10, 1, v8
  v_lshlrev_b32 v10, 2, v10
  v_lshlrev_b32 v11, 1, v5
  v_add_u32 v10, v10, v11
  v_and_b32 v11, 1, v8
  v_add_u32 v10, v10, v11
  v_lshlrev_b32 v10, 4, v10
  v_add_u32 v9, v9, v10
  v_add_u32 v137, s46, v9
  s_lshl_b32 s28, s21, 2
  s_add_u32 s28, s28, 32
  v_add_u32 v6, s28, v2
  v_mul_u32_u24 v7, 43, v6
  v_lshrrev_b32 v7, 9, v7
  v_mul_u32_u24 v8, 12, v7
  v_sub_u32 v8, v6, v8
  v_lshrrev_b32 v9, 1, v7
  v_lshlrev_b32 v9, 4, v9
  v_and_b32 v10, 1, v7
  v_lshlrev_b32 v10, 2, v10
  v_add_u32 v9, v9, v10
  v_lshlrev_b32 v10, 3, v3
  v_add_u32 v9, v9, v10
  v_add_u32 v9, v9, v4
  v_mul_u32_u24 v9, 12288, v9
  v_lshrrev_b32 v10, 1, v8
  v_lshlrev_b32 v10, 2, v10
  v_lshlrev_b32 v11, 1, v5
  v_add_u32 v10, v10, v11
  v_and_b32 v11, 1, v8
  v_add_u32 v10, v10, v11
  v_lshlrev_b32 v10, 4, v10
  v_add_u32 v9, v9, v10
  v_add_u32 v138, s46, v9
  s_lshl_b32 s28, s21, 2
  s_add_u32 s28, s28, 48
  v_add_u32 v6, s28, v2
  v_mul_u32_u24 v7, 43, v6
  v_lshrrev_b32 v7, 9, v7
  v_mul_u32_u24 v8, 12, v7
  v_sub_u32 v8, v6, v8
  v_lshrrev_b32 v9, 1, v7
  v_lshlrev_b32 v9, 4, v9
  v_and_b32 v10, 1, v7
  v_lshlrev_b32 v10, 2, v10
  v_add_u32 v9, v9, v10
  v_lshlrev_b32 v10, 3, v3
  v_add_u32 v9, v9, v10
  v_add_u32 v9, v9, v4
  v_mul_u32_u24 v9, 12288, v9
  v_lshrrev_b32 v10, 1, v8
  v_lshlrev_b32 v10, 2, v10
  v_lshlrev_b32 v11, 1, v5
  v_add_u32 v10, v10, v11
  v_and_b32 v11, 1, v8
  v_add_u32 v10, v10, v11
  v_lshlrev_b32 v10, 4, v10
  v_add_u32 v9, v9, v10
  v_add_u32 v139, s46, v9
  s_lshl_b32 s28, s21, 2
  s_add_u32 s28, s28, 64
  v_add_u32 v6, s28, v2
  v_mul_u32_u24 v7, 43, v6
  v_lshrrev_b32 v7, 9, v7
  v_mul_u32_u24 v8, 12, v7
  v_sub_u32 v8, v6, v8
  v_lshrrev_b32 v9, 1, v7
  v_lshlrev_b32 v9, 4, v9
  v_and_b32 v10, 1, v7
  v_lshlrev_b32 v10, 2, v10
  v_add_u32 v9, v9, v10
  v_lshlrev_b32 v10, 3, v3
  v_add_u32 v9, v9, v10
  v_add_u32 v9, v9, v4
  v_mul_u32_u24 v9, 12288, v9
  v_lshrrev_b32 v10, 1, v8
  v_lshlrev_b32 v10, 2, v10
  v_lshlrev_b32 v11, 1, v5
  v_add_u32 v10, v10, v11
  v_and_b32 v11, 1, v8
  v_add_u32 v10, v10, v11
  v_lshlrev_b32 v10, 4, v10
  v_add_u32 v9, v9, v10
  v_add_u32 v140, s46, v9
  s_lshl_b32 s28, s21, 2
  s_add_u32 s28, s28, 80
  v_add_u32 v6, s28, v2
  v_mul_u32_u24 v7, 43, v6
  v_lshrrev_b32 v7, 9, v7
  v_mul_u32_u24 v8, 12, v7
  v_sub_u32 v8, v6, v8
  v_lshrrev_b32 v9, 1, v7
  v_lshlrev_b32 v9, 4, v9
  v_and_b32 v10, 1, v7
  v_lshlrev_b32 v10, 2, v10
  v_add_u32 v9, v9, v10
  v_lshlrev_b32 v10, 3, v3
  v_add_u32 v9, v9, v10
  v_add_u32 v9, v9, v4
  v_mul_u32_u24 v9, 12288, v9
  v_lshrrev_b32 v10, 1, v8
  v_lshlrev_b32 v10, 2, v10
  v_lshlrev_b32 v11, 1, v5
  v_add_u32 v10, v10, v11
  v_and_b32 v11, 1, v8
  v_add_u32 v10, v10, v11
  v_lshlrev_b32 v10, 4, v10
  v_add_u32 v9, v9, v10
  v_add_u32 v141, s46, v9
  v_lshrrev_b32 v6, 1, v2
  v_mul_u32_u24 v142, 6144, v6
  v_and_b32 v6, 1, v2
  v_lshlrev_b32 v6, 7, v6
  v_add_u32 v142, v142, v6
  v_bfe_u32 v6, v1, 2, 2
  v_lshlrev_b32 v6, 5, v6
  v_add_u32 v142, v142, v6
  v_and_b32 v6, 1, v1
  v_lshlrev_b32 v6, 4, v6
  v_add_u32 v142, v142, v6
  v_bfe_u32 v6, v1, 1, 1
  v_lshlrev_b32 v6, 3, v6
  v_add_u32 v142, v142, v6
  s_mul_i32 s28, s21, 768
  v_add_u32 v142, s28, v142
  s_lshl_b32 s29, s21, 10
  s_add_u32 m0, s29, 0
  s_mov_b32 s28, 0
  buffer_load_dwordx4 v136, s[12:15], s28 offen lds
  s_lshl_b32 s29, s21, 10
  s_add_u32 m0, s29, 4096
  s_mov_b32 s28, 0
  buffer_load_dwordx4 v137, s[12:15], s28 offen lds
  s_lshl_b32 s29, s21, 10
  s_add_u32 m0, s29, 8192
  s_mov_b32 s28, 0
  buffer_load_dwordx4 v138, s[12:15], s28 offen lds
  s_lshl_b32 s29, s21, 10
  s_add_u32 m0, s29, 12288
  s_mov_b32 s28, 0
  buffer_load_dwordx4 v139, s[12:15], s28 offen lds
  s_lshl_b32 s29, s21, 10
  s_add_u32 m0, s29, 16384
  s_mov_b32 s28, 0
  buffer_load_dwordx4 v140, s[12:15], s28 offen lds
  s_lshl_b32 s29, s21, 10
  s_add_u32 m0, s29, 20480
  s_mov_b32 s28, 0
  buffer_load_dwordx4 v141, s[12:15], s28 offen lds
  s_lshl_b32 s29, s21, 10
  s_add_u32 m0, s29, 24576
  s_mov_b32 s28, 786432
  buffer_load_dwordx4 v136, s[12:15], s28 offen lds
  s_lshl_b32 s29, s21, 10
  s_add_u32 m0, s29, 28672
  s_mov_b32 s28, 786432
  buffer_load_dwordx4 v137, s[12:15], s28 offen lds
  s_lshl_b32 s29, s21, 10
  s_add_u32 m0, s29, 32768
  s_mov_b32 s28, 786432
  buffer_load_dwordx4 v138, s[12:15], s28 offen lds
  s_lshl_b32 s29, s21, 10
  s_add_u32 m0, s29, 36864
  s_mov_b32 s28, 786432
  buffer_load_dwordx4 v139, s[12:15], s28 offen lds
  s_lshl_b32 s29, s21, 10
  s_add_u32 m0, s29, 40960
  s_mov_b32 s28, 786432
  buffer_load_dwordx4 v140, s[12:15], s28 offen lds
  s_lshl_b32 s29, s21, 10
  s_add_u32 m0, s29, 45056
  s_mov_b32 s28, 786432
  buffer_load_dwordx4 v141, s[12:15], s28 offen lds
  s_lshl_b32 s29, s21, 10
  s_add_u32 m0, s29, 49152
  s_mov_b32 s28, 1572864
  buffer_load_dwordx4 v136, s[12:15], s28 offen lds
  s_lshl_b32 s29, s21, 10
  s_add_u32 m0, s29, 53248
  s_mov_b32 s28, 1572864
  buffer_load_dwordx4 v137, s[12:15], s28 offen lds
  s_lshl_b32 s29, s21, 10
  s_add_u32 m0, s29, 57344
  s_mov_b32 s28, 1572864
  buffer_load_dwordx4 v138, s[12:15], s28 offen lds
  s_lshl_b32 s29, s21, 10
  s_add_u32 m0, s29, 61440
  s_mov_b32 s28, 1572864
  buffer_load_dwordx4 v139, s[12:15], s28 offen lds
  s_lshl_b32 s29, s21, 10
  s_add_u32 m0, s29, 65536
  s_mov_b32 s28, 1572864
  buffer_load_dwordx4 v140, s[12:15], s28 offen lds
  s_lshl_b32 s29, s21, 10
  s_add_u32 m0, s29, 69632
  s_mov_b32 s28, 1572864
  buffer_load_dwordx4 v141, s[12:15], s28 offen lds
  s_lshl_b32 s29, s21, 10
  s_add_u32 m0, s29, 73728
  s_mov_b32 s28, 2359296
  buffer_load_dwordx4 v136, s[12:15], s28 offen lds
  s_lshl_b32 s29, s21, 10
  s_add_u32 m0, s29, 77824
  s_mov_b32 s28, 2359296
  buffer_load_dwordx4 v137, s[12:15], s28 offen lds
  s_lshl_b32 s29, s21, 10
  s_add_u32 m0, s29, 81920
  s_mov_b32 s28, 2359296
  buffer_load_dwordx4 v138, s[12:15], s28 offen lds
  s_lshl_b32 s29, s21, 10
  s_add_u32 m0, s29, 86016
  s_mov_b32 s28, 2359296
  buffer_load_dwordx4 v139, s[12:15], s28 offen lds
  s_lshl_b32 s29, s21, 10
  s_add_u32 m0, s29, 90112
  s_mov_b32 s28, 2359296
  buffer_load_dwordx4 v140, s[12:15], s28 offen lds
  s_lshl_b32 s29, s21, 10
  s_add_u32 m0, s29, 94208
  s_mov_b32 s28, 2359296
  buffer_load_dwordx4 v141, s[12:15], s28 offen lds
  s_lshl_b32 s29, s21, 10
  s_add_u32 m0, s29, 98304
  s_mov_b32 s28, 3145728
  buffer_load_dwordx4 v136, s[12:15], s28 offen lds
  s_lshl_b32 s29, s21, 10
  s_add_u32 m0, s29, 102400
  s_mov_b32 s28, 3145728
  buffer_load_dwordx4 v137, s[12:15], s28 offen lds
  s_lshl_b32 s29, s21, 10
  s_add_u32 m0, s29, 106496
  s_mov_b32 s28, 3145728
  buffer_load_dwordx4 v138, s[12:15], s28 offen lds
  s_lshl_b32 s29, s21, 10
  s_add_u32 m0, s29, 110592
  s_mov_b32 s28, 3145728
  buffer_load_dwordx4 v139, s[12:15], s28 offen lds
  s_lshl_b32 s29, s21, 10
  s_add_u32 m0, s29, 114688
  s_mov_b32 s28, 3145728
  buffer_load_dwordx4 v140, s[12:15], s28 offen lds
  s_lshl_b32 s29, s21, 10
  s_add_u32 m0, s29, 118784
  s_mov_b32 s28, 3145728
  buffer_load_dwordx4 v141, s[12:15], s28 offen lds
  s_waitcnt vmcnt(24)
  s_barrier
  s_lshl_b32 s29, s21, 10
  s_add_u32 m0, s29, 122880
  s_mov_b32 s28, 3932160
  buffer_load_dwordx4 v136, s[12:15], s28 offen lds
  s_lshl_b32 s29, s21, 10
  s_add_u32 m0, s29, 126976
  s_mov_b32 s28, 3932160
  buffer_load_dwordx4 v137, s[12:15], s28 offen lds
  s_lshl_b32 s29, s21, 10
  s_add_u32 m0, s29, 131072
  s_mov_b32 s28, 3932160
  buffer_load_dwordx4 v138, s[12:15], s28 offen lds
  s_lshl_b32 s29, s21, 10
  s_add_u32 m0, s29, 135168
  s_mov_b32 s28, 3932160
  buffer_load_dwordx4 v139, s[12:15], s28 offen lds
  s_lshl_b32 s29, s21, 10
  s_add_u32 m0, s29, 139264
  s_mov_b32 s28, 3932160
  buffer_load_dwordx4 v140, s[12:15], s28 offen lds
  s_lshl_b32 s29, s21, 10
  s_add_u32 m0, s29, 143360
  s_mov_b32 s28, 3932160
  buffer_load_dwordx4 v141, s[12:15], s28 offen lds
  v_add_u32 v143, 0, v142
  ds_read_b64_tr_b16 a[0:1], v143 offset:0
  ds_read_b64_tr_b16 a[2:3], v143 offset:3072
  ds_read_b64_tr_b16 a[4:5], v143 offset:12288
  ds_read_b64_tr_b16 a[6:7], v143 offset:15360
  ds_read_b64_tr_b16 a[80:81], v143 offset:256
  ds_read_b64_tr_b16 a[82:83], v143 offset:3328
  ds_read_b64_tr_b16 a[84:85], v143 offset:12544
  ds_read_b64_tr_b16 a[86:87], v143 offset:15616
  ds_read_b64_tr_b16 a[160:161], v143 offset:512
  ds_read_b64_tr_b16 a[162:163], v143 offset:3584
  ds_read_b64_tr_b16 a[164:165], v143 offset:12800
  ds_read_b64_tr_b16 a[166:167], v143 offset:15872
  s_waitcnt lgkmcnt(0)
  s_waitcnt vmcnt(24)
  s_barrier
  s_lshl_b32 s29, s21, 10
  s_add_u32 m0, s29, 0
  s_mov_b32 s28, 4718592
  buffer_load_dwordx4 v136, s[12:15], s28 offen lds
  s_lshl_b32 s29, s21, 10
  s_add_u32 m0, s29, 4096
  s_mov_b32 s28, 4718592
  buffer_load_dwordx4 v137, s[12:15], s28 offen lds
  s_lshl_b32 s29, s21, 10
  s_add_u32 m0, s29, 8192
  s_mov_b32 s28, 4718592
  buffer_load_dwordx4 v138, s[12:15], s28 offen lds
  s_lshl_b32 s29, s21, 10
  s_add_u32 m0, s29, 12288
  s_mov_b32 s28, 4718592
  buffer_load_dwordx4 v139, s[12:15], s28 offen lds
  s_lshl_b32 s29, s21, 10
  s_add_u32 m0, s29, 16384
  s_mov_b32 s28, 4718592
  buffer_load_dwordx4 v140, s[12:15], s28 offen lds
  s_lshl_b32 s29, s21, 10
  s_add_u32 m0, s29, 20480
  s_mov_b32 s28, 4718592
  buffer_load_dwordx4 v141, s[12:15], s28 offen lds
  v_add_u32 v143, 24576, v142
  ds_read_b64_tr_b16 a[8:9], v143 offset:0
  ds_read_b64_tr_b16 a[10:11], v143 offset:3072
  ds_read_b64_tr_b16 a[12:13], v143 offset:12288
  ds_read_b64_tr_b16 a[14:15], v143 offset:15360
  ds_read_b64_tr_b16 a[88:89], v143 offset:256
  ds_read_b64_tr_b16 a[90:91], v143 offset:3328
  ds_read_b64_tr_b16 a[92:93], v143 offset:12544
  ds_read_b64_tr_b16 a[94:95], v143 offset:15616
  ds_read_b64_tr_b16 a[168:169], v143 offset:512
  ds_read_b64_tr_b16 a[170:171], v143 offset:3584
  ds_read_b64_tr_b16 a[172:173], v143 offset:12800
  ds_read_b64_tr_b16 a[174:175], v143 offset:15872
  s_waitcnt lgkmcnt(0)
  s_waitcnt vmcnt(24)
  s_barrier
  s_lshl_b32 s29, s21, 10
  s_add_u32 m0, s29, 24576
  s_mov_b32 s28, 5505024
  buffer_load_dwordx4 v136, s[12:15], s28 offen lds
  s_lshl_b32 s29, s21, 10
  s_add_u32 m0, s29, 28672
  s_mov_b32 s28, 5505024
  buffer_load_dwordx4 v137, s[12:15], s28 offen lds
  s_lshl_b32 s29, s21, 10
  s_add_u32 m0, s29, 32768
  s_mov_b32 s28, 5505024
  buffer_load_dwordx4 v138, s[12:15], s28 offen lds
  s_lshl_b32 s29, s21, 10
  s_add_u32 m0, s29, 36864
  s_mov_b32 s28, 5505024
  buffer_load_dwordx4 v139, s[12:15], s28 offen lds
  s_lshl_b32 s29, s21, 10
  s_add_u32 m0, s29, 40960
  s_mov_b32 s28, 5505024
  buffer_load_dwordx4 v140, s[12:15], s28 offen lds
  s_lshl_b32 s29, s21, 10
  s_add_u32 m0, s29, 45056
  s_mov_b32 s28, 5505024
  buffer_load_dwordx4 v141, s[12:15], s28 offen lds
  v_add_u32 v143, 49152, v142
  ds_read_b64_tr_b16 a[16:17], v143 offset:0
  ds_read_b64_tr_b16 a[18:19], v143 offset:3072
  ds_read_b64_tr_b16 a[20:21], v143 offset:12288
  ds_read_b64_tr_b16 a[22:23], v143 offset:15360
  ds_read_b64_tr_b16 a[96:97], v143 offset:256
  ds_read_b64_tr_b16 a[98:99], v143 offset:3328
  ds_read_b64_tr_b16 a[100:101], v143 offset:12544
  ds_read_b64_tr_b16 a[102:103], v143 offset:15616
  ds_read_b64_tr_b16 a[176:177], v143 offset:512
  ds_read_b64_tr_b16 a[178:179], v143 offset:3584
  ds_read_b64_tr_b16 a[180:181], v143 offset:12800
  ds_read_b64_tr_b16 a[182:183], v143 offset:15872
  s_waitcnt lgkmcnt(0)
  s_waitcnt vmcnt(24)
  s_barrier
  s_lshl_b32 s29, s21, 10
  s_add_u32 m0, s29, 49152
  s_mov_b32 s28, 6291456
  buffer_load_dwordx4 v136, s[12:15], s28 offen lds
  s_lshl_b32 s29, s21, 10
  s_add_u32 m0, s29, 53248
  s_mov_b32 s28, 6291456
  buffer_load_dwordx4 v137, s[12:15], s28 offen lds
  s_lshl_b32 s29, s21, 10
  s_add_u32 m0, s29, 57344
  s_mov_b32 s28, 6291456
  buffer_load_dwordx4 v138, s[12:15], s28 offen lds
  s_lshl_b32 s29, s21, 10
  s_add_u32 m0, s29, 61440
  s_mov_b32 s28, 6291456
  buffer_load_dwordx4 v139, s[12:15], s28 offen lds
  s_lshl_b32 s29, s21, 10
  s_add_u32 m0, s29, 65536
  s_mov_b32 s28, 6291456
  buffer_load_dwordx4 v140, s[12:15], s28 offen lds
  s_lshl_b32 s29, s21, 10
  s_add_u32 m0, s29, 69632
  s_mov_b32 s28, 6291456
  buffer_load_dwordx4 v141, s[12:15], s28 offen lds
  v_add_u32 v143, 73728, v142
  ds_read_b64_tr_b16 a[24:25], v143 offset:0
  ds_read_b64_tr_b16 a[26:27], v143 offset:3072
  ds_read_b64_tr_b16 a[28:29], v143 offset:12288
  ds_read_b64_tr_b16 a[30:31], v143 offset:15360
  ds_read_b64_tr_b16 a[104:105], v143 offset:256
  ds_read_b64_tr_b16 a[106:107], v143 offset:3328
  ds_read_b64_tr_b16 a[108:109], v143 offset:12544
  ds_read_b64_tr_b16 a[110:111], v143 offset:15616
  ds_read_b64_tr_b16 a[184:185], v143 offset:512
  ds_read_b64_tr_b16 a[186:187], v143 offset:3584
  ds_read_b64_tr_b16 a[188:189], v143 offset:12800
  ds_read_b64_tr_b16 a[190:191], v143 offset:15872
  s_waitcnt lgkmcnt(0)
  s_waitcnt vmcnt(24)
  s_barrier
  s_lshl_b32 s29, s21, 10
  s_add_u32 m0, s29, 73728
  s_mov_b32 s28, 7077888
  buffer_load_dwordx4 v136, s[12:15], s28 offen lds
  s_lshl_b32 s29, s21, 10
  s_add_u32 m0, s29, 77824
  s_mov_b32 s28, 7077888
  buffer_load_dwordx4 v137, s[12:15], s28 offen lds
  s_lshl_b32 s29, s21, 10
  s_add_u32 m0, s29, 81920
  s_mov_b32 s28, 7077888
  buffer_load_dwordx4 v138, s[12:15], s28 offen lds
  s_lshl_b32 s29, s21, 10
  s_add_u32 m0, s29, 86016
  s_mov_b32 s28, 7077888
  buffer_load_dwordx4 v139, s[12:15], s28 offen lds
  s_lshl_b32 s29, s21, 10
  s_add_u32 m0, s29, 90112
  s_mov_b32 s28, 7077888
  buffer_load_dwordx4 v140, s[12:15], s28 offen lds
  s_lshl_b32 s29, s21, 10
  s_add_u32 m0, s29, 94208
  s_mov_b32 s28, 7077888
  buffer_load_dwordx4 v141, s[12:15], s28 offen lds
  v_add_u32 v143, 98304, v142
  ds_read_b64_tr_b16 a[32:33], v143 offset:0
  ds_read_b64_tr_b16 a[34:35], v143 offset:3072
  ds_read_b64_tr_b16 a[36:37], v143 offset:12288
  ds_read_b64_tr_b16 a[38:39], v143 offset:15360
  ds_read_b64_tr_b16 a[112:113], v143 offset:256
  ds_read_b64_tr_b16 a[114:115], v143 offset:3328
  ds_read_b64_tr_b16 a[116:117], v143 offset:12544
  ds_read_b64_tr_b16 a[118:119], v143 offset:15616
  ds_read_b64_tr_b16 a[192:193], v143 offset:512
  ds_read_b64_tr_b16 a[194:195], v143 offset:3584
  ds_read_b64_tr_b16 a[196:197], v143 offset:12800
  ds_read_b64_tr_b16 a[198:199], v143 offset:15872
  s_waitcnt lgkmcnt(0)
  s_waitcnt vmcnt(24)
  s_barrier
  s_lshl_b32 s29, s21, 10
  s_add_u32 m0, s29, 98304
  s_mov_b32 s28, 0
  buffer_load_dwordx4 v136, s[16:19], s28 offen lds
  s_lshl_b32 s29, s21, 10
  s_add_u32 m0, s29, 102400
  s_mov_b32 s28, 0
  buffer_load_dwordx4 v137, s[16:19], s28 offen lds
  s_lshl_b32 s29, s21, 10
  s_add_u32 m0, s29, 106496
  s_mov_b32 s28, 0
  buffer_load_dwordx4 v138, s[16:19], s28 offen lds
  s_lshl_b32 s29, s21, 10
  s_add_u32 m0, s29, 110592
  s_mov_b32 s28, 0
  buffer_load_dwordx4 v139, s[16:19], s28 offen lds
  s_lshl_b32 s29, s21, 10
  s_add_u32 m0, s29, 114688
  s_mov_b32 s28, 0
  buffer_load_dwordx4 v140, s[16:19], s28 offen lds
  s_lshl_b32 s29, s21, 10
  s_add_u32 m0, s29, 118784
  s_mov_b32 s28, 0
  buffer_load_dwordx4 v141, s[16:19], s28 offen lds
  v_add_u32 v143, 122880, v142
  ds_read_b64_tr_b16 a[40:41], v143 offset:0
  ds_read_b64_tr_b16 a[42:43], v143 offset:3072
  ds_read_b64_tr_b16 a[44:45], v143 offset:12288
  ds_read_b64_tr_b16 a[46:47], v143 offset:15360
  ds_read_b64_tr_b16 a[120:121], v143 offset:256
  ds_read_b64_tr_b16 a[122:123], v143 offset:3328
  ds_read_b64_tr_b16 a[124:125], v143 offset:12544
  ds_read_b64_tr_b16 a[126:127], v143 offset:15616
  ds_read_b64_tr_b16 a[200:201], v143 offset:512
  ds_read_b64_tr_b16 a[202:203], v143 offset:3584
  ds_read_b64_tr_b16 a[204:205], v143 offset:12800
  ds_read_b64_tr_b16 a[206:207], v143 offset:15872
  s_waitcnt lgkmcnt(0)
  s_waitcnt vmcnt(24)
  s_barrier
  s_lshl_b32 s29, s21, 10
  s_add_u32 m0, s29, 122880
  s_mov_b32 s28, 1572864
  buffer_load_dwordx4 v136, s[16:19], s28 offen lds
  s_lshl_b32 s29, s21, 10
  s_add_u32 m0, s29, 126976
  s_mov_b32 s28, 1572864
  buffer_load_dwordx4 v137, s[16:19], s28 offen lds
  s_lshl_b32 s29, s21, 10
  s_add_u32 m0, s29, 131072
  s_mov_b32 s28, 1572864
  buffer_load_dwordx4 v138, s[16:19], s28 offen lds
  s_lshl_b32 s29, s21, 10
  s_add_u32 m0, s29, 135168
  s_mov_b32 s28, 1572864
  buffer_load_dwordx4 v139, s[16:19], s28 offen lds
  s_lshl_b32 s29, s21, 10
  s_add_u32 m0, s29, 139264
  s_mov_b32 s28, 1572864
  buffer_load_dwordx4 v140, s[16:19], s28 offen lds
  s_lshl_b32 s29, s21, 10
  s_add_u32 m0, s29, 143360
  s_mov_b32 s28, 1572864
  buffer_load_dwordx4 v141, s[16:19], s28 offen lds
  v_add_u32 v143, 0, v142
  ds_read_b64_tr_b16 a[48:49], v143 offset:0
  ds_read_b64_tr_b16 a[50:51], v143 offset:3072
  ds_read_b64_tr_b16 a[52:53], v143 offset:12288
  ds_read_b64_tr_b16 a[54:55], v143 offset:15360
  ds_read_b64_tr_b16 a[128:129], v143 offset:256
  ds_read_b64_tr_b16 a[130:131], v143 offset:3328
  ds_read_b64_tr_b16 a[132:133], v143 offset:12544
  ds_read_b64_tr_b16 a[134:135], v143 offset:15616
  ds_read_b64_tr_b16 a[208:209], v143 offset:512
  ds_read_b64_tr_b16 a[210:211], v143 offset:3584
  ds_read_b64_tr_b16 a[212:213], v143 offset:12800
  ds_read_b64_tr_b16 a[214:215], v143 offset:15872
  s_waitcnt lgkmcnt(0)
  s_waitcnt vmcnt(24)
  s_barrier
  s_lshl_b32 s29, s21, 10
  s_add_u32 m0, s29, 0
  s_mov_b32 s28, 3145728
  buffer_load_dwordx4 v136, s[16:19], s28 offen lds
  s_lshl_b32 s29, s21, 10
  s_add_u32 m0, s29, 4096
  s_mov_b32 s28, 3145728
  buffer_load_dwordx4 v137, s[16:19], s28 offen lds
  s_lshl_b32 s29, s21, 10
  s_add_u32 m0, s29, 8192
  s_mov_b32 s28, 3145728
  buffer_load_dwordx4 v138, s[16:19], s28 offen lds
  s_lshl_b32 s29, s21, 10
  s_add_u32 m0, s29, 12288
  s_mov_b32 s28, 3145728
  buffer_load_dwordx4 v139, s[16:19], s28 offen lds
  s_lshl_b32 s29, s21, 10
  s_add_u32 m0, s29, 16384
  s_mov_b32 s28, 3145728
  buffer_load_dwordx4 v140, s[16:19], s28 offen lds
  s_lshl_b32 s29, s21, 10
  s_add_u32 m0, s29, 20480
  s_mov_b32 s28, 3145728
  buffer_load_dwordx4 v141, s[16:19], s28 offen lds
  v_add_u32 v143, 24576, v142
  ds_read_b64_tr_b16 a[56:57], v143 offset:0
  ds_read_b64_tr_b16 a[58:59], v143 offset:3072
  ds_read_b64_tr_b16 a[60:61], v143 offset:12288
  ds_read_b64_tr_b16 a[62:63], v143 offset:15360
  ds_read_b64_tr_b16 a[136:137], v143 offset:256
  ds_read_b64_tr_b16 a[138:139], v143 offset:3328
  ds_read_b64_tr_b16 a[140:141], v143 offset:12544
  ds_read_b64_tr_b16 a[142:143], v143 offset:15616
  ds_read_b64_tr_b16 a[216:217], v143 offset:512
  ds_read_b64_tr_b16 a[218:219], v143 offset:3584
  ds_read_b64_tr_b16 a[220:221], v143 offset:12800
  ds_read_b64_tr_b16 a[222:223], v143 offset:15872
  s_waitcnt lgkmcnt(0)
  s_waitcnt vmcnt(24)
  s_barrier
  s_lshl_b32 s29, s21, 10
  s_add_u32 m0, s29, 24576
  s_mov_b32 s28, 4718592
  buffer_load_dwordx4 v136, s[16:19], s28 offen lds
  s_lshl_b32 s29, s21, 10
  s_add_u32 m0, s29, 28672
  s_mov_b32 s28, 4718592
  buffer_load_dwordx4 v137, s[16:19], s28 offen lds
  s_lshl_b32 s29, s21, 10
  s_add_u32 m0, s29, 32768
  s_mov_b32 s28, 4718592
  buffer_load_dwordx4 v138, s[16:19], s28 offen lds
  s_lshl_b32 s29, s21, 10
  s_add_u32 m0, s29, 36864
  s_mov_b32 s28, 4718592
  buffer_load_dwordx4 v139, s[16:19], s28 offen lds
  s_lshl_b32 s29, s21, 10
  s_add_u32 m0, s29, 40960
  s_mov_b32 s28, 4718592
  buffer_load_dwordx4 v140, s[16:19], s28 offen lds
  s_lshl_b32 s29, s21, 10
  s_add_u32 m0, s29, 45056
  s_mov_b32 s28, 4718592
  buffer_load_dwordx4 v141, s[16:19], s28 offen lds
  v_add_u32 v143, 49152, v142
  ds_read_b64_tr_b16 a[64:65], v143 offset:0
  ds_read_b64_tr_b16 a[66:67], v143 offset:3072
  ds_read_b64_tr_b16 a[68:69], v143 offset:12288
  ds_read_b64_tr_b16 a[70:71], v143 offset:15360
  ds_read_b64_tr_b16 a[144:145], v143 offset:256
  ds_read_b64_tr_b16 a[146:147], v143 offset:3328
  ds_read_b64_tr_b16 a[148:149], v143 offset:12544
  ds_read_b64_tr_b16 a[150:151], v143 offset:15616
  ds_read_b64_tr_b16 a[224:225], v143 offset:512
  ds_read_b64_tr_b16 a[226:227], v143 offset:3584
  ds_read_b64_tr_b16 a[228:229], v143 offset:12800
  ds_read_b64_tr_b16 a[230:231], v143 offset:15872
  s_waitcnt lgkmcnt(0)
  s_waitcnt vmcnt(24)
  s_barrier
  s_lshl_b32 s29, s21, 10
  s_add_u32 m0, s29, 49152
  s_mov_b32 s28, 6291456
  buffer_load_dwordx4 v136, s[16:19], s28 offen lds
  s_lshl_b32 s29, s21, 10
  s_add_u32 m0, s29, 53248
  s_mov_b32 s28, 6291456
  buffer_load_dwordx4 v137, s[16:19], s28 offen lds
  s_lshl_b32 s29, s21, 10
  s_add_u32 m0, s29, 57344
  s_mov_b32 s28, 6291456
  buffer_load_dwordx4 v138, s[16:19], s28 offen lds
  s_lshl_b32 s29, s21, 10
  s_add_u32 m0, s29, 61440
  s_mov_b32 s28, 6291456
  buffer_load_dwordx4 v139, s[16:19], s28 offen lds
  s_lshl_b32 s29, s21, 10
  s_add_u32 m0, s29, 65536
  s_mov_b32 s28, 6291456
  buffer_load_dwordx4 v140, s[16:19], s28 offen lds
  s_lshl_b32 s29, s21, 10
  s_add_u32 m0, s29, 69632
  s_mov_b32 s28, 6291456
  buffer_load_dwordx4 v141, s[16:19], s28 offen lds
  v_add_u32 v143, 73728, v142
  ds_read_b64_tr_b16 a[72:73], v143 offset:0
  ds_read_b64_tr_b16 a[74:75], v143 offset:3072
  ds_read_b64_tr_b16 a[76:77], v143 offset:12288
  ds_read_b64_tr_b16 a[78:79], v143 offset:15360
  ds_read_b64_tr_b16 a[152:153], v143 offset:256
  ds_read_b64_tr_b16 a[154:155], v143 offset:3328
  ds_read_b64_tr_b16 a[156:157], v143 offset:12544
  ds_read_b64_tr_b16 a[158:159], v143 offset:15616
  ds_read_b64_tr_b16 a[232:233], v143 offset:512
  ds_read_b64_tr_b16 a[234:235], v143 offset:3584
  ds_read_b64_tr_b16 a[236:237], v143 offset:12800
  ds_read_b64_tr_b16 a[238:239], v143 offset:15872
  s_waitcnt lgkmcnt(0)
  s_waitcnt vmcnt(24)
  s_barrier
  s_lshl_b32 s29, s21, 10
  s_add_u32 m0, s29, 73728
  s_mov_b32 s28, 786432
  buffer_load_dwordx4 v136, s[16:19], s28 offen lds
  s_lshl_b32 s29, s21, 10
  s_add_u32 m0, s29, 77824
  s_mov_b32 s28, 786432
  buffer_load_dwordx4 v137, s[16:19], s28 offen lds
  s_lshl_b32 s29, s21, 10
  s_add_u32 m0, s29, 81920
  s_mov_b32 s28, 786432
  buffer_load_dwordx4 v138, s[16:19], s28 offen lds
  s_lshl_b32 s29, s21, 10
  s_add_u32 m0, s29, 86016
  s_mov_b32 s28, 786432
  buffer_load_dwordx4 v139, s[16:19], s28 offen lds
  s_lshl_b32 s29, s21, 10
  s_add_u32 m0, s29, 90112
  s_mov_b32 s28, 786432
  buffer_load_dwordx4 v140, s[16:19], s28 offen lds
  s_lshl_b32 s29, s21, 10
  s_add_u32 m0, s29, 94208
  s_mov_b32 s28, 786432
  buffer_load_dwordx4 v141, s[16:19], s28 offen lds
  v_add_u32 v143, 98304, v142
  ds_read_b64_tr_b16 a[240:241], v143 offset:0
  ds_read_b64_tr_b16 a[242:243], v143 offset:3072
  ds_read_b64_tr_b16 a[244:245], v143 offset:12288
  ds_read_b64_tr_b16 a[246:247], v143 offset:15360
  ds_read_b64_tr_b16 v[176:177], v143 offset:256
  ds_read_b64_tr_b16 v[178:179], v143 offset:3328
  ds_read_b64_tr_b16 v[180:181], v143 offset:12544
  ds_read_b64_tr_b16 v[182:183], v143 offset:15616
  ds_read_b64_tr_b16 v[216:217], v143 offset:512
  ds_read_b64_tr_b16 v[218:219], v143 offset:3584
  ds_read_b64_tr_b16 v[220:221], v143 offset:12800
  ds_read_b64_tr_b16 v[222:223], v143 offset:15872
  s_waitcnt lgkmcnt(0)
  s_waitcnt vmcnt(24)
  s_barrier
  s_lshl_b32 s29, s21, 10
  s_add_u32 m0, s29, 98304
  s_mov_b32 s28, 2359296
  buffer_load_dwordx4 v136, s[16:19], s28 offen lds
  s_lshl_b32 s29, s21, 10
  s_add_u32 m0, s29, 102400
  s_mov_b32 s28, 2359296
  buffer_load_dwordx4 v137, s[16:19], s28 offen lds
  s_lshl_b32 s29, s21, 10
  s_add_u32 m0, s29, 106496
  s_mov_b32 s28, 2359296
  buffer_load_dwordx4 v138, s[16:19], s28 offen lds
  s_lshl_b32 s29, s21, 10
  s_add_u32 m0, s29, 110592
  s_mov_b32 s28, 2359296
  buffer_load_dwordx4 v139, s[16:19], s28 offen lds
  s_lshl_b32 s29, s21, 10
  s_add_u32 m0, s29, 114688
  s_mov_b32 s28, 2359296
  buffer_load_dwordx4 v140, s[16:19], s28 offen lds
  s_lshl_b32 s29, s21, 10
  s_add_u32 m0, s29, 118784
  s_mov_b32 s28, 2359296
  buffer_load_dwordx4 v141, s[16:19], s28 offen lds
  v_add_u32 v143, 122880, v142
  ds_read_b64_tr_b16 a[248:249], v143 offset:0
  ds_read_b64_tr_b16 a[250:251], v143 offset:3072
  ds_read_b64_tr_b16 a[252:253], v143 offset:12288
  ds_read_b64_tr_b16 a[254:255], v143 offset:15360
  ds_read_b64_tr_b16 v[184:185], v143 offset:256
  ds_read_b64_tr_b16 v[186:187], v143 offset:3328
  ds_read_b64_tr_b16 v[188:189], v143 offset:12544
  ds_read_b64_tr_b16 v[190:191], v143 offset:15616
  ds_read_b64_tr_b16 v[224:225], v143 offset:512
  ds_read_b64_tr_b16 v[226:227], v143 offset:3584
  ds_read_b64_tr_b16 v[228:229], v143 offset:12800
  ds_read_b64_tr_b16 v[230:231], v143 offset:15872
  s_waitcnt lgkmcnt(0)
  s_waitcnt vmcnt(24)
  s_barrier
  s_lshl_b32 s29, s21, 10
  s_add_u32 m0, s29, 122880
  s_mov_b32 s28, 3932160
  buffer_load_dwordx4 v136, s[16:19], s28 offen lds
  s_lshl_b32 s29, s21, 10
  s_add_u32 m0, s29, 126976
  s_mov_b32 s28, 3932160
  buffer_load_dwordx4 v137, s[16:19], s28 offen lds
  s_lshl_b32 s29, s21, 10
  s_add_u32 m0, s29, 131072
  s_mov_b32 s28, 3932160
  buffer_load_dwordx4 v138, s[16:19], s28 offen lds
  s_lshl_b32 s29, s21, 10
  s_add_u32 m0, s29, 135168
  s_mov_b32 s28, 3932160
  buffer_load_dwordx4 v139, s[16:19], s28 offen lds
  s_lshl_b32 s29, s21, 10
  s_add_u32 m0, s29, 139264
  s_mov_b32 s28, 3932160
  buffer_load_dwordx4 v140, s[16:19], s28 offen lds
  s_lshl_b32 s29, s21, 10
  s_add_u32 m0, s29, 143360
  s_mov_b32 s28, 3932160
  buffer_load_dwordx4 v141, s[16:19], s28 offen lds
  v_add_u32 v143, 0, v142
  ds_read_b64_tr_b16 v[152:153], v143 offset:0
  ds_read_b64_tr_b16 v[154:155], v143 offset:3072
  ds_read_b64_tr_b16 v[156:157], v143 offset:12288
  ds_read_b64_tr_b16 v[158:159], v143 offset:15360
  ds_read_b64_tr_b16 v[192:193], v143 offset:256
  ds_read_b64_tr_b16 v[194:195], v143 offset:3328
  ds_read_b64_tr_b16 v[196:197], v143 offset:12544
  ds_read_b64_tr_b16 v[198:199], v143 offset:15616
  ds_read_b64_tr_b16 v[232:233], v143 offset:512
  ds_read_b64_tr_b16 v[234:235], v143 offset:3584
  ds_read_b64_tr_b16 v[236:237], v143 offset:12800
  ds_read_b64_tr_b16 v[238:239], v143 offset:15872
  s_waitcnt lgkmcnt(0)
  s_waitcnt vmcnt(24)
  s_barrier
  s_lshl_b32 s29, s21, 10
  s_add_u32 m0, s29, 0
  s_mov_b32 s28, 5505024
  buffer_load_dwordx4 v136, s[16:19], s28 offen lds
  s_lshl_b32 s29, s21, 10
  s_add_u32 m0, s29, 4096
  s_mov_b32 s28, 5505024
  buffer_load_dwordx4 v137, s[16:19], s28 offen lds
  s_lshl_b32 s29, s21, 10
  s_add_u32 m0, s29, 8192
  s_mov_b32 s28, 5505024
  buffer_load_dwordx4 v138, s[16:19], s28 offen lds
  s_lshl_b32 s29, s21, 10
  s_add_u32 m0, s29, 12288
  s_mov_b32 s28, 5505024
  buffer_load_dwordx4 v139, s[16:19], s28 offen lds
  s_lshl_b32 s29, s21, 10
  s_add_u32 m0, s29, 16384
  s_mov_b32 s28, 5505024
  buffer_load_dwordx4 v140, s[16:19], s28 offen lds
  s_lshl_b32 s29, s21, 10
  s_add_u32 m0, s29, 20480
  s_mov_b32 s28, 5505024
  buffer_load_dwordx4 v141, s[16:19], s28 offen lds
  v_add_u32 v143, 24576, v142
  ds_read_b64_tr_b16 v[160:161], v143 offset:0
  ds_read_b64_tr_b16 v[162:163], v143 offset:3072
  ds_read_b64_tr_b16 v[164:165], v143 offset:12288
  ds_read_b64_tr_b16 v[166:167], v143 offset:15360
  ds_read_b64_tr_b16 v[200:201], v143 offset:256
  ds_read_b64_tr_b16 v[202:203], v143 offset:3328
  ds_read_b64_tr_b16 v[204:205], v143 offset:12544
  ds_read_b64_tr_b16 v[206:207], v143 offset:15616
  ds_read_b64_tr_b16 v[240:241], v143 offset:512
  ds_read_b64_tr_b16 v[242:243], v143 offset:3584
  ds_read_b64_tr_b16 v[244:245], v143 offset:12800
  ds_read_b64_tr_b16 v[246:247], v143 offset:15872
  s_waitcnt lgkmcnt(0)
  s_waitcnt vmcnt(24)
  s_barrier
  s_lshl_b32 s29, s21, 10
  s_add_u32 m0, s29, 24576
  s_mov_b32 s28, 7077888
  buffer_load_dwordx4 v136, s[16:19], s28 offen lds
  s_lshl_b32 s29, s21, 10
  s_add_u32 m0, s29, 28672
  s_mov_b32 s28, 7077888
  buffer_load_dwordx4 v137, s[16:19], s28 offen lds
  s_lshl_b32 s29, s21, 10
  s_add_u32 m0, s29, 32768
  s_mov_b32 s28, 7077888
  buffer_load_dwordx4 v138, s[16:19], s28 offen lds
  s_lshl_b32 s29, s21, 10
  s_add_u32 m0, s29, 36864
  s_mov_b32 s28, 7077888
  buffer_load_dwordx4 v139, s[16:19], s28 offen lds
  s_lshl_b32 s29, s21, 10
  s_add_u32 m0, s29, 40960
  s_mov_b32 s28, 7077888
  buffer_load_dwordx4 v140, s[16:19], s28 offen lds
  s_lshl_b32 s29, s21, 10
  s_add_u32 m0, s29, 45056
  s_mov_b32 s28, 7077888
  buffer_load_dwordx4 v141, s[16:19], s28 offen lds
  v_add_u32 v143, 49152, v142
  ds_read_b64_tr_b16 v[168:169], v143 offset:0
  ds_read_b64_tr_b16 v[170:171], v143 offset:3072
  ds_read_b64_tr_b16 v[172:173], v143 offset:12288
  ds_read_b64_tr_b16 v[174:175], v143 offset:15360
  ds_read_b64_tr_b16 v[208:209], v143 offset:256
  ds_read_b64_tr_b16 v[210:211], v143 offset:3328
  ds_read_b64_tr_b16 v[212:213], v143 offset:12544
  ds_read_b64_tr_b16 v[214:215], v143 offset:15616
  ds_read_b64_tr_b16 v[248:249], v143 offset:512
  ds_read_b64_tr_b16 v[250:251], v143 offset:3584
  ds_read_b64_tr_b16 v[252:253], v143 offset:12800
  ds_read_b64_tr_b16 v[254:255], v143 offset:15872
  s_waitcnt lgkmcnt(0)
  s_waitcnt vmcnt(24)
  s_barrier
  v_add_u32 v143, 73728, v142
  ds_read_b64_tr_b16 v[16:17], v143 offset:0
  ds_read_b64_tr_b16 v[18:19], v143 offset:3072
  ds_read_b64_tr_b16 v[20:21], v143 offset:12288
  ds_read_b64_tr_b16 v[22:23], v143 offset:15360
  ds_read_b64_tr_b16 v[24:25], v143 offset:256
  ds_read_b64_tr_b16 v[26:27], v143 offset:3328
  ds_read_b64_tr_b16 v[28:29], v143 offset:12544
  ds_read_b64_tr_b16 v[30:31], v143 offset:15616
  ds_read_b64_tr_b16 v[32:33], v143 offset:512
  ds_read_b64_tr_b16 v[34:35], v143 offset:3584
  ds_read_b64_tr_b16 v[36:37], v143 offset:12800
  ds_read_b64_tr_b16 v[38:39], v143 offset:15872
  s_waitcnt lgkmcnt(0)
  s_waitcnt vmcnt(18)
  s_barrier
  v_add_u32 v143, 98304, v142
  ds_read_b64_tr_b16 v[40:41], v143 offset:0
  ds_read_b64_tr_b16 v[42:43], v143 offset:3072
  ds_read_b64_tr_b16 v[44:45], v143 offset:12288
  ds_read_b64_tr_b16 v[46:47], v143 offset:15360
  ds_read_b64_tr_b16 v[48:49], v143 offset:256
  ds_read_b64_tr_b16 v[50:51], v143 offset:3328
  ds_read_b64_tr_b16 v[52:53], v143 offset:12544
  ds_read_b64_tr_b16 v[54:55], v143 offset:15616
  ds_read_b64_tr_b16 v[56:57], v143 offset:512
  ds_read_b64_tr_b16 v[58:59], v143 offset:3584
  ds_read_b64_tr_b16 v[60:61], v143 offset:12800
  ds_read_b64_tr_b16 v[62:63], v143 offset:15872
  s_waitcnt lgkmcnt(0)
  s_waitcnt vmcnt(12)
  s_barrier
  v_add_u32 v143, 122880, v142
  ds_read_b64_tr_b16 v[64:65], v143 offset:0
  ds_read_b64_tr_b16 v[66:67], v143 offset:3072
  ds_read_b64_tr_b16 v[68:69], v143 offset:12288
  ds_read_b64_tr_b16 v[70:71], v143 offset:15360
  ds_read_b64_tr_b16 v[72:73], v143 offset:256
  ds_read_b64_tr_b16 v[74:75], v143 offset:3328
  ds_read_b64_tr_b16 v[76:77], v143 offset:12544
  ds_read_b64_tr_b16 v[78:79], v143 offset:15616
  ds_read_b64_tr_b16 v[80:81], v143 offset:512
  ds_read_b64_tr_b16 v[82:83], v143 offset:3584
  ds_read_b64_tr_b16 v[84:85], v143 offset:12800
  ds_read_b64_tr_b16 v[86:87], v143 offset:15872
  s_waitcnt lgkmcnt(0)
  s_waitcnt vmcnt(6)
  s_barrier
  v_add_u32 v143, 0, v142
  ds_read_b64_tr_b16 v[88:89], v143 offset:0
  ds_read_b64_tr_b16 v[90:91], v143 offset:3072
  ds_read_b64_tr_b16 v[92:93], v143 offset:12288
  ds_read_b64_tr_b16 v[94:95], v143 offset:15360
  ds_read_b64_tr_b16 v[96:97], v143 offset:256
  ds_read_b64_tr_b16 v[98:99], v143 offset:3328
  ds_read_b64_tr_b16 v[100:101], v143 offset:12544
  ds_read_b64_tr_b16 v[102:103], v143 offset:15616
  ds_read_b64_tr_b16 v[104:105], v143 offset:512
  ds_read_b64_tr_b16 v[106:107], v143 offset:3584
  ds_read_b64_tr_b16 v[108:109], v143 offset:12800
  ds_read_b64_tr_b16 v[110:111], v143 offset:15872
  s_waitcnt lgkmcnt(0)
  s_waitcnt vmcnt(0)
  s_barrier
  v_add_u32 v143, 24576, v142
  ds_read_b64_tr_b16 v[112:113], v143 offset:0
  ds_read_b64_tr_b16 v[114:115], v143 offset:3072
  ds_read_b64_tr_b16 v[116:117], v143 offset:12288
  ds_read_b64_tr_b16 v[118:119], v143 offset:15360
  ds_read_b64_tr_b16 v[120:121], v143 offset:256
  ds_read_b64_tr_b16 v[122:123], v143 offset:3328
  ds_read_b64_tr_b16 v[124:125], v143 offset:12544
  ds_read_b64_tr_b16 v[126:127], v143 offset:15616
  ds_read_b64_tr_b16 v[128:129], v143 offset:512
  ds_read_b64_tr_b16 v[130:131], v143 offset:3584
  ds_read_b64_tr_b16 v[132:133], v143 offset:12800
  ds_read_b64_tr_b16 v[134:135], v143 offset:15872
  s_waitcnt lgkmcnt(0)
  s_barrier
  v_lshlrev_b32 v2, 4, v1
  s_mul_i32 s28, s21, 30720
  v_add_u32 v143, s28, v2
  ds_write_b128 v143, v[16:19] offset:0
  ds_write_b128 v143, v[20:23] offset:1024
  ds_write_b128 v143, v[24:27] offset:10240
  ds_write_b128 v143, v[28:31] offset:11264
  ds_write_b128 v143, v[32:35] offset:20480
  ds_write_b128 v143, v[36:39] offset:21504
  ds_write_b128 v143, v[40:43] offset:2048
  ds_write_b128 v143, v[44:47] offset:3072
  ds_write_b128 v143, v[48:51] offset:12288
  ds_write_b128 v143, v[52:55] offset:13312
  ds_write_b128 v143, v[56:59] offset:22528
  ds_write_b128 v143, v[60:63] offset:23552
  ds_write_b128 v143, v[64:67] offset:4096
  ds_write_b128 v143, v[68:71] offset:5120
  ds_write_b128 v143, v[72:75] offset:14336
  ds_write_b128 v143, v[76:79] offset:15360
  ds_write_b128 v143, v[80:83] offset:24576
  ds_write_b128 v143, v[84:87] offset:25600
  ds_write_b128 v143, v[88:91] offset:6144
  ds_write_b128 v143, v[92:95] offset:7168
  ds_write_b128 v143, v[96:99] offset:16384
  ds_write_b128 v143, v[100:103] offset:17408
  ds_write_b128 v143, v[104:107] offset:26624
  ds_write_b128 v143, v[108:111] offset:27648
  ds_write_b128 v143, v[112:115] offset:8192
  ds_write_b128 v143, v[116:119] offset:9216
  ds_write_b128 v143, v[120:123] offset:18432
  ds_write_b128 v143, v[124:127] offset:19456
  ds_write_b128 v143, v[128:131] offset:28672
  ds_write_b128 v143, v[132:135] offset:29696
  s_waitcnt lgkmcnt(0)
  v_and_b32 v1, 63, v0
  v_lshlrev_b32 v132, 4, v1
  s_mul_i32 s28, s21, 30720
  v_add_u32 v129, s28, v132
  s_lshl_b32 s28, s21, 10
  v_add_u32 v124, s28, v132
  v_add_u32 v125, 4096, v124
  v_add_u32 v126, 8192, v124
  v_add_u32 v127, 122880, v124
  v_add_u32 v128, 122880, v132
  s_mul_i32 s28, s21, 3072
  s_add_u32 s28, s28, 133120
  v_add_u32 v130, s28, v132
  s_mul_i32 s28, s21, 1536
  s_add_u32 s28, s28, 145408
  v_lshlrev_b32 v2, 3, v1
  v_add_u32 v131, s28, v2
  v_mov_b32 v110, 0x44444444
  v_mov_b32 v2, 0xeeeeeeee
  v_and_b32 v3, 8, v1
  v_cmp_ne_u32 vcc, 0, v3
  s_nop 1
  v_cndmask_b32 v110, v110, v2, vcc
  v_and_b32 v4, 15, v1
  v_lshrrev_b32 v5, 4, v1
  v_lshlrev_b32 v6, 2, v5
  v_sub_u32 v6, v4, v6
  v_mov_b32 v7, 0x3f80
  v_mov_b32 v8, 0x3f800000
  v_mov_b32 v108, 0
  v_mov_b32 v109, 0
  v_cmp_eq_u32 vcc, 0, v6
  s_nop 1
  v_cndmask_b32 v108, v108, v7, vcc
  v_cmp_eq_u32 vcc, 1, v6
  s_nop 1
  v_cndmask_b32 v108, v108, v8, vcc
  v_cmp_eq_u32 vcc, 2, v6
  s_nop 1
  v_cndmask_b32 v109, v109, v7, vcc
  v_cmp_eq_u32 vcc, 3, v6
  s_nop 1
  v_cndmask_b32 v109, v109, v8, vcc
  s_mul_i32 s28, s23, 6
  s_lshr_b32 s29, s28, 3
  s_add_u32 s28, s28, 5
  s_lshr_b32 s28, s28, 3
  v_mov_b32 v6, s29
  v_mov_b32 v7, s28
  v_and_b32 v8, 1, v1
  v_cmp_eq_u32 vcc, 1, v8
  s_nop 1
  v_cndmask_b32 v6, v6, v7, vcc
  v_lshlrev_b32 v6, 2, v6
  v_bfe_u32 v8, v1, 1, 1
  v_lshlrev_b32 v8, 10, v8
  v_add_u32 v6, v6, v8
  v_add_u32 v138, 0, v6
  s_mul_i32 s97, s20, 655360
  s_add_u32 s97, s97, 0x400000
  s_mov_b32 s48, 0x4000
  s_mul_i32 s49, s20, 327680
  s_add_u32 s49, s49, 0x700000
  s_mul_i32 s50, s23, 786432
  s_add_u32 s63, s50, 0x4800000
  s_add_u32 s50, s50, 0x6000000
  s_mov_b32 s51, 0
  s_mov_b32 s52, 0
  s_mul_i32 s28, s21, 3
  s_add_u32 s28, s28, 0
  s_lshr_b32 s29, s28, 1
  s_lshl_b32 s29, s29, 11
  s_and_b32 s28, s28, 1
  s_lshl_b32 s28, s28, 3
  s_add_u32 s53, s29, s28
  s_mul_i32 s28, s21, 3
  s_add_u32 s28, s28, 1
  s_lshr_b32 s29, s28, 1
  s_lshl_b32 s29, s29, 11
  s_and_b32 s28, s28, 1
  s_lshl_b32 s28, s28, 3
  s_add_u32 s54, s29, s28
  s_mul_i32 s28, s21, 3
  s_add_u32 s28, s28, 2
  s_lshr_b32 s29, s28, 1
  s_lshl_b32 s29, s29, 11
  s_and_b32 s28, s28, 1
  s_lshl_b32 s28, s28, 3
  s_add_u32 s55, s29, s28
  v_mov_b32 v60, 0
  v_mov_b32 v61, 0
  v_mov_b32 v62, 0
  v_mov_b32 v63, 0
  v_mov_b32 v64, 0
  v_mov_b32 v65, 0
  v_mov_b32 v66, 0
  v_mov_b32 v67, 0
  v_mov_b32 v68, 0
  v_mov_b32 v69, 0
  v_mov_b32 v70, 0
  v_mov_b32 v71, 0
  v_mov_b32 v72, 0
  v_mov_b32 v73, 0
  v_mov_b32 v74, 0
  v_mov_b32 v75, 0
  v_mov_b32 v36, 0
  v_mov_b32 v37, 0
  v_mov_b32 v38, 0
  v_mov_b32 v39, 0
  v_mov_b32 v40, 0
  v_mov_b32 v41, 0
  v_mov_b32 v42, 0
  v_mov_b32 v43, 0
  s_barrier
  s_cmp_gt_u32 s52, s51
  s_cbranch_scc1 kaf_x_wp_40_ok
  s_mov_b32 s45, 0
kaf_x_wp_40_spin:
  buffer_load_dword v2, v138, s[8:11], 0 offen sc1
  s_add_u32 s45, s45, 1
  s_waitcnt vmcnt(0)
  v_min_u32_dpp v3, v2, v2 quad_perm:[1,0,3,2] row_mask:0xf bank_mask:0xf
  s_nop 1
  v_min_u32_dpp v2, v3, v3 quad_perm:[2,3,0,1] row_mask:0xf bank_mask:0xf
  s_nop 1
  v_min_u32_dpp v3, v2, v2 row_half_mirror row_mask:0xf bank_mask:0xf
  s_nop 1
  v_min_u32_dpp v2, v3, v3 quad_perm:[0,1,2,3] row_mask:0xf bank_mask:0xf
  s_nop 0
  v_readfirstlane_b32 s52, v2
  s_cmp_gt_u32 s52, s51
  s_cbranch_scc1 kaf_x_wp_40_ok
  s_cmp_lt_u32 s45, 400000
  s_cbranch_scc1 kaf_x_wp_40_spin
  s_branch kaf_abort
kaf_x_wp_40_ok:
  s_add_u32 s28, s50, s53
  buffer_load_dwordx2 v[88:89], v132, s[8:11], s28 offen offset:0 sc1
  buffer_load_dwordx2 v[92:93], v132, s[8:11], s28 offen offset:1024 sc1
  s_add_u32 s28, s50, s54
  buffer_load_dwordx2 v[90:91], v132, s[8:11], s28 offen offset:0 sc1
  buffer_load_dwordx2 v[94:95], v132, s[8:11], s28 offen offset:1024 sc1
  s_add_u32 s28, s50, s55
  buffer_load_dwordx2 v[96:97], v132, s[8:11], s28 offen offset:0 sc1
  buffer_load_dwordx2 v[98:99], v132, s[8:11], s28 offen offset:1024 sc1
  s_cmp_eq_u32 s21, 0
  s_cbranch_scc1 kaf_x_w0
  s_cmp_eq_u32 s21, 1
  s_cbranch_scc1 kaf_x_w1
  s_branch kaf_x_w23
kaf_x_w0:
  v_lshrrev_b32 v4, 3, v1
  v_and_b32 v5, 7, v1
  v_lshrrev_b32 v6, 2, v5
  v_and_b32 v7, 3, v5
  v_lshlrev_b32 v8, 10, v6
  v_lshlrev_b32 v9, 4, v7
  v_add_u32 v9, v9, v4
  v_lshlrev_b32 v9, 4, v9
  v_add_u32 v8, v8, v9
  v_add_u32 v133, 134144, v8
  v_add_u32 v8, 2, v6
  v_lshlrev_b32 v8, 4, v8
  v_add_u32 v8, v8, v4
  v_lshlrev_b32 v8, 4, v8
  v_lshlrev_b32 v9, 2, v7
  v_add_u32 v8, v8, v9
  v_add_u32 v134, 133120, v8
  s_and_b32 s26, s23, 7
  v_and_b32 v8, 1, v7
  v_lshlrev_b32 v8, 1, v8
  v_add_u32 v8, v8, v6
  v_lshlrev_b32 v8, 4, v8
  v_add_u32 v8, v8, v4
  v_lshlrev_b32 v8, 4, v8
  v_lshrrev_b32 v9, 1, v7
  v_lshlrev_b32 v9, 3, v9
  v_add_u32 v8, v8, v9
  s_lshr_b32 s28, s26, 1
  s_lshl_b32 s28, s28, 10
  s_and_b32 s29, s26, 1
  s_lshl_b32 s29, s29, 7
  s_add_u32 s28, s28, s29
  v_add_u32 v135, s28, v8
  v_lshlrev_b32 v8, 4, v6
  v_add_u32 v8, v8, v4
  v_lshlrev_b32 v8, 4, v8
  v_lshlrev_b32 v9, 1, v7
  v_add_u32 v8, v8, v9
  s_lshr_b32 s28, s26, 2
  s_lshl_b32 s28, s28, 7
  s_and_b32 s29, s26, 1
  s_lshl_b32 s29, s29, 9
  s_add_u32 s28, s28, s29
  s_bfe_u32 s29, s26, 0x10001
  s_lshl_b32 s29, s29, 3
  s_add_u32 s28, s28, s29
  s_add_u32 s28, s28, 4096
  v_add_u32 v8, s28, v8
  v_mov_b32 v9, 0x40000000
  v_and_b32 v10, 1, v5
  v_cmp_eq_u32 vcc, 0, v10
  s_nop 1
  v_cndmask_b32 v136, v9, v8, vcc
  s_mov_b32 s64, 0x3dd53b95
  s_mov_b32 s65, 0x3dd53b95
kaf_x_w0l:
  ds_read_b128 v[44:47], v129 offset:0
  ds_read_b128 v[48:51], v129 offset:1024
  ds_read_b128 v[52:55], v129 offset:2048
  ds_read_b128 v[56:59], v129 offset:3072
  s_waitcnt lgkmcnt(0)
  s_mov_b32 s45, 0
kaf_x_pf_41:
  buffer_load_dwordx4 v[112:115], v124, s[8:11], s48 offen sc1
  buffer_load_dwordx4 v[116:119], v125, s[8:11], s48 offen sc1
  buffer_load_dwordx4 v[120:123], v126, s[8:11], s48 offen sc1
  s_add_u32 s45, s45, 1
  s_waitcnt vmcnt(2)
  ds_write_b128 v127, v[112:115] offset:0
  v_max3_u32 v139, v112, v113, v114
  v_max_u32 v139, v139, v115
  s_waitcnt vmcnt(1)
  ds_write_b128 v127, v[116:119] offset:4096
  v_max3_u32 v139, v139, v116, v117
  v_max3_u32 v139, v139, v118, v119
  s_waitcnt vmcnt(0)
  ds_write_b128 v127, v[120:123] offset:8192
  v_max3_u32 v139, v139, v120, v121
  v_max3_u32 v139, v139, v122, v123
  v_cmp_eq_u32 vcc, -1, v139
  s_cbranch_vccz kaf_x_pf_41_ok
  s_cmp_lt_u32 s45, 400000
  s_cbranch_scc1 kaf_x_pf_41
  s_branch kaf_abort
kaf_x_pf_41_ok:
  v_smfmac_f32_16x16x64_bf16 v[60:63], v[112:115], a[0:7], v110
  v_smfmac_f32_16x16x64_bf16 v[64:67], v[112:115], a[240:247], v110
  v_smfmac_f32_16x16x64_bf16 v[68:71], v[112:115], a[80:87], v110
  v_smfmac_f32_16x16x64_bf16 v[72:75], v[112:115], v[176:183], v110
  s_waitcnt lgkmcnt(0)
  s_barrier
  v_smfmac_f32_16x16x64_bf16 v[36:39], v[112:115], a[160:167], v110
  ds_read_b128 v[4:7], v128 offset:1024
  v_smfmac_f32_16x16x64_bf16 v[40:43], v[112:115], v[216:223], v110
  ds_read_b128 v[8:11], v128 offset:2048
  v_smfmac_f32_16x16x64_bf16 v[60:63], v[116:119], a[32:39], v110
  ds_read_b128 v[12:15], v128 offset:3072
  v_smfmac_f32_16x16x64_bf16 v[64:67], v[116:119], v[152:159], v110
  ds_read_b128 v[16:19], v128 offset:5120
  v_smfmac_f32_16x16x64_bf16 v[68:71], v[116:119], a[112:119], v110
  ds_read_b128 v[20:23], v128 offset:6144
  v_smfmac_f32_16x16x64_bf16 v[72:75], v[116:119], v[192:199], v110
  ds_read_b128 v[24:27], v128 offset:7168
  v_smfmac_f32_16x16x64_bf16 v[36:39], v[116:119], a[192:199], v110
  ds_read_b128 v[28:31], v128 offset:9216
  v_smfmac_f32_16x16x64_bf16 v[40:43], v[116:119], v[232:239], v110
  v_smfmac_f32_16x16x64_bf16 v[60:63], v[120:123], a[64:71], v110
  v_smfmac_f32_16x16x64_bf16 v[64:67], v[120:123], v[168:175], v110
  v_smfmac_f32_16x16x64_bf16 v[68:71], v[120:123], a[144:151], v110
  v_smfmac_f32_16x16x64_bf16 v[72:75], v[120:123], v[208:215], v110
  v_smfmac_f32_16x16x64_bf16 v[36:39], v[120:123], a[224:231], v110
  v_smfmac_f32_16x16x64_bf16 v[40:43], v[120:123], v[248:255], v110
  s_waitcnt lgkmcnt(6)
  v_smfmac_f32_16x16x64_bf16 v[60:63], v[4:7], a[8:15], v110
  v_smfmac_f32_16x16x64_bf16 v[64:67], v[4:7], v[44:51], v110
  ds_read_b128 v[44:47], v129 offset:4096
  s_waitcnt lgkmcnt(6)
  v_smfmac_f32_16x16x64_bf16 v[60:63], v[8:11], a[16:23], v110
  ds_read_b128 v[48:51], v129 offset:5120
  v_smfmac_f32_16x16x64_bf16 v[64:67], v[8:11], a[248:255], v110
  s_waitcnt lgkmcnt(6)
  v_smfmac_f32_16x16x64_bf16 v[60:63], v[12:15], a[24:31], v110
  v_smfmac_f32_16x16x64_bf16 v[64:67], v[12:15], v[52:59], v110
  ds_read_b128 v[52:55], v129 offset:6144
  s_waitcnt lgkmcnt(6)
  v_smfmac_f32_16x16x64_bf16 v[60:63], v[16:19], a[40:47], v110
  ds_read_b128 v[56:59], v129 offset:7168
  s_waitcnt lgkmcnt(2)
  v_smfmac_f32_16x16x64_bf16 v[64:67], v[16:19], v[44:51], v110
  ds_read_b128 v[44:47], v129 offset:8192
  v_smfmac_f32_16x16x64_bf16 v[60:63], v[20:23], a[48:55], v110
  ds_read_b128 v[48:51], v129 offset:9216
  v_smfmac_f32_16x16x64_bf16 v[64:67], v[20:23], v[160:167], v110
  v_smfmac_f32_16x16x64_bf16 v[60:63], v[24:27], a[56:63], v110
  s_waitcnt lgkmcnt(2)
  v_smfmac_f32_16x16x64_bf16 v[64:67], v[24:27], v[52:59], v110
  ds_read_b128 v[52:55], v129 offset:10240
  v_smfmac_f32_16x16x64_bf16 v[60:63], v[28:31], a[72:79], v110
  ds_read_b128 v[56:59], v129 offset:11264
  s_waitcnt lgkmcnt(2)
  v_smfmac_f32_16x16x64_bf16 v[64:67], v[28:31], v[44:51], v110
  ds_read_b128 v[44:47], v129 offset:12288
  v_smfmac_f32_16x16x64_bf16 v[68:71], v[4:7], a[88:95], v110
  ds_read_b128 v[48:51], v129 offset:13312
  s_waitcnt lgkmcnt(2)
  v_smfmac_f32_16x16x64_bf16 v[72:75], v[4:7], v[52:59], v110
  ds_read_b128 v[52:55], v129 offset:14336
  v_permlane32_swap_b32 v60, v64
  v_smfmac_f32_16x16x64_bf16 v[68:71], v[8:11], a[96:103], v110
  ds_read_b128 v[56:59], v129 offset:15360
  v_smfmac_f32_16x16x64_bf16 v[72:75], v[8:11], v[184:191], v110
  v_permlane32_swap_b32 v61, v65
  v_smfmac_f32_16x16x64_bf16 v[68:71], v[12:15], a[104:111], v110
  s_waitcnt lgkmcnt(2)
  v_smfmac_f32_16x16x64_bf16 v[72:75], v[12:15], v[44:51], v110
  ds_read_b128 v[44:47], v129 offset:16384
  v_permlane32_swap_b32 v62, v66
  v_smfmac_f32_16x16x64_bf16 v[68:71], v[16:19], a[120:127], v110
  ds_read_b128 v[48:51], v129 offset:17408
  v_permlane32_swap_b32 v63, v67
  s_waitcnt lgkmcnt(2)
  v_smfmac_f32_16x16x64_bf16 v[72:75], v[16:19], v[52:59], v110
  ds_read_b128 v[52:55], v129 offset:18432
  v_add_f32 v60, v60, v64
  v_smfmac_f32_16x16x64_bf16 v[68:71], v[20:23], a[128:135], v110
  ds_read_b128 v[56:59], v129 offset:19456
  v_add_f32 v61, v61, v65
  v_smfmac_f32_16x16x64_bf16 v[72:75], v[20:23], v[200:207], v110
  v_add_f32 v62, v62, v66
  v_smfmac_f32_16x16x64_bf16 v[68:71], v[24:27], a[136:143], v110
  v_add_f32 v63, v63, v67
  s_waitcnt lgkmcnt(2)
  v_smfmac_f32_16x16x64_bf16 v[72:75], v[24:27], v[44:51], v110
  ds_read_b128 v[44:47], v129 offset:20480
  v_cvt_pk_bf16_f32 v100, v60, v61
  v_smfmac_f32_16x16x64_bf16 v[68:71], v[28:31], a[152:159], v110
  ds_read_b128 v[48:51], v129 offset:21504
  v_cvt_pk_bf16_f32 v101, v62, v63
  s_waitcnt lgkmcnt(2)
  v_smfmac_f32_16x16x64_bf16 v[72:75], v[28:31], v[52:59], v110
  ds_read_b128 v[52:55], v129 offset:22528
  v_smfmac_f32_16x16x64_bf16 v[36:39], v[4:7], a[168:175], v110
  ds_read_b128 v[56:59], v129 offset:23552
  s_waitcnt lgkmcnt(2)
  v_smfmac_f32_16x16x64_bf16 v[40:43], v[4:7], v[44:51], v110
  ds_read_b128 v[44:47], v129 offset:24576
  v_permlane32_swap_b32 v68, v72
  v_smfmac_f32_16x16x64_bf16 v[36:39], v[8:11], a[176:183], v110
  ds_read_b128 v[48:51], v129 offset:25600
  v_smfmac_f32_16x16x64_bf16 v[40:43], v[8:11], v[224:231], v110
  v_permlane32_swap_b32 v69, v73
  v_smfmac_f32_16x16x64_bf16 v[36:39], v[12:15], a[184:191], v110
  s_waitcnt lgkmcnt(2)
  v_smfmac_f32_16x16x64_bf16 v[40:43], v[12:15], v[52:59], v110
  ds_read_b128 v[52:55], v129 offset:26624
  v_permlane32_swap_b32 v70, v74
  v_smfmac_f32_16x16x64_bf16 v[36:39], v[16:19], a[200:207], v110
  ds_read_b128 v[56:59], v129 offset:27648
  v_permlane32_swap_b32 v71, v75
  s_waitcnt lgkmcnt(2)
  v_smfmac_f32_16x16x64_bf16 v[40:43], v[16:19], v[44:51], v110
  ds_read_b128 v[44:47], v129 offset:28672
  v_add_f32 v68, v68, v72
  v_smfmac_f32_16x16x64_bf16 v[36:39], v[20:23], a[208:215], v110
  ds_read_b128 v[48:51], v129 offset:29696
  v_add_f32 v69, v69, v73
  v_smfmac_f32_16x16x64_bf16 v[40:43], v[20:23], v[240:247], v110
  v_add_f32 v70, v70, v74
  v_smfmac_f32_16x16x64_bf16 v[36:39], v[24:27], a[216:223], v110
  v_add_f32 v71, v71, v75
  s_waitcnt lgkmcnt(2)
  v_smfmac_f32_16x16x64_bf16 v[40:43], v[24:27], v[52:59], v110
  v_cvt_pk_bf16_f32 v102, v68, v69
  v_smfmac_f32_16x16x64_bf16 v[36:39], v[28:31], a[232:239], v110
  v_cvt_pk_bf16_f32 v103, v70, v71
  s_waitcnt lgkmcnt(0)
  v_smfmac_f32_16x16x64_bf16 v[40:43], v[28:31], v[44:51], v110
  v_mfma_f32_16x16x16_bf16 v[142:145], v[100:101], v[108:109], 0
  v_mfma_f32_16x16x16_bf16 v[146:149], v[102:103], v[108:109], 0
  s_nop 1
  v_permlane32_swap_b32 v36, v40
  v_permlane32_swap_b32 v37, v41
  v_permlane32_swap_b32 v38, v42
  v_permlane32_swap_b32 v39, v43
  v_add_f32 v36, v36, v40
  v_add_f32 v37, v37, v41
  v_add_f32 v38, v38, v42
  v_add_f32 v39, v39, v43
  v_cvt_pk_bf16_f32 v104, v36, v37
  v_cvt_pk_bf16_f32 v105, v38, v39
  v_cvt_pk_bf16_f32 v44, v142, v143
  v_cvt_pk_bf16_f32 v45, v144, v145
  v_mfma_f32_16x16x16_bf16 v[142:145], v[104:105], v[108:109], 0
  v_cvt_pk_bf16_f32 v46, v146, v147
  v_cvt_pk_bf16_f32 v47, v148, v149
  ds_write_b64 v131, v[44:45]
  ds_write_b64 v131, v[46:47] offset:512
  v_mfma_f32_16x16x32_bf16 v[76:79], v[44:47], v[44:47], 0
  v_mfma_f32_16x16x32_bf16 v[80:83], v[88:91], v[44:47], 0
  v_mfma_f32_16x16x32_bf16 v[84:87], v[92:95], v[44:47], 0
  v_cvt_pk_bf16_f32 v106, v142, v143
  v_cvt_pk_bf16_f32 v107, v144, v145
  ds_write_b64 v131, v[106:107] offset:1024
  s_nop 0
  v_mfma_f32_16x16x16_bf16 v[76:79], v[106:107], v[106:107], v[76:79]
  v_mfma_f32_16x16x16_bf16 v[80:83], v[96:97], v[106:107], v[80:83]
  v_mfma_f32_16x16x16_bf16 v[84:87], v[98:99], v[106:107], v[84:87]
  s_nop 6
  ds_write_b128 v130, v[76:79] offset:0
  ds_write_b128 v130, v[80:83] offset:1024
  s_nop 0
  ds_write_b128 v130, v[84:87] offset:2048
  s_waitcnt lgkmcnt(0)
  s_barrier
  s_cmp_ge_u32 s51, 63
  s_cbranch_scc1 kaf_x_done
  ds_read_b128 v[4:7], v133 offset:0
  ds_read_b32 v20, v134 offset:0
  ds_read_b128 v[8:11], v133 offset:3072
  ds_read_b32 v21, v134 offset:3072
  ds_read_b128 v[12:15], v133 offset:6144
  ds_read_b32 v22, v134 offset:6144
  ds_read_b128 v[16:19], v133 offset:9216
  ds_read_b32 v23, v134 offset:9216
  s_waitcnt lgkmcnt(4)
  v_pk_add_f32 v[4:5], v[4:5], v[8:9]
  v_pk_add_f32 v[6:7], v[6:7], v[10:11]
  v_add_f32 v20, v20, v21
  s_waitcnt lgkmcnt(0)
  v_pk_add_f32 v[12:13], v[12:13], v[16:17]
  v_pk_add_f32 v[14:15], v[14:15], v[18:19]
  v_add_f32 v22, v22, v23
  v_pk_add_f32 v[4:5], v[4:5], v[12:13]
  v_pk_add_f32 v[6:7], v[6:7], v[14:15]
  v_add_f32 v8, v20, v22
  v_max3_f32 v24, v4, v5, v6
  v_max3_f32 v24, v24, v7, v8
  s_nop 1
  v_max_f32_dpp v25, v24, v24 quad_perm:[1,0,3,2] row_mask:0xf bank_mask:0xf
  s_nop 1
  v_max_f32_dpp v24, v25, v25 quad_perm:[2,3,0,1] row_mask:0xf bank_mask:0xf
  s_nop 1
  v_max_f32_dpp v25, v24, v24 row_half_mirror row_mask:0xf bank_mask:0xf
  v_mul_f32 v24, s64, v25
  v_fma_f32 v4, v4, s64, -v24
  v_fma_f32 v5, v5, s64, -v24
  v_fma_f32 v6, v6, s64, -v24
  v_fma_f32 v7, v7, s64, -v24
  v_fma_f32 v8, v8, s64, -v24
  v_exp_f32 v4, v4
  v_exp_f32 v5, v5
  v_exp_f32 v6, v6
  v_exp_f32 v7, v7
  v_exp_f32 v8, v8
  v_add_f32 v24, v4, v5
  v_add_f32 v25, v6, v7
  v_add_f32 v24, v24, v25
  v_add_f32 v24, v24, v8
  s_nop 1
  v_add_f32_dpp v25, v24, v24 quad_perm:[1,0,3,2] row_mask:0xf bank_mask:0xf
  s_nop 1
  v_add_f32_dpp v24, v25, v25 quad_perm:[2,3,0,1] row_mask:0xf bank_mask:0xf
  s_nop 1
  v_add_f32_dpp v25, v24, v24 row_half_mirror row_mask:0xf bank_mask:0xf
  s_nop 0
  v_rcp_f32 v24, v25
  s_nop 0
  v_mul_f32 v8, v8, v24
  v_mul_f32 v4, v4, v24
  v_mul_f32 v5, v5, v24
  v_mov_b32_dpp v9, v8 quad_perm:[1,0,3,2] row_mask:0xf bank_mask:0xf
  v_mul_f32 v6, v6, v24
  v_mul_f32 v7, v7, v24
  v_cvt_pk_bf16_f32 v10, v4, v5
  v_cvt_pk_bf16_f32 v11, v6, v7
  v_cvt_pk_bf16_f32 v12, v8, v9
  buffer_store_dwordx2 v[10:11], v135, s[8:11], s49 offen
  buffer_store_dword v12, v136, s[8:11], s49 offen
  v_mov_b32 v60, 0
  v_mov_b32 v61, 0
  v_mov_b32 v62, 0
  v_mov_b32 v63, 0
  v_mov_b32 v64, 0
  v_mov_b32 v65, 0
  v_mov_b32 v66, 0
  v_mov_b32 v67, 0
  v_mov_b32 v68, 0
  v_mov_b32 v69, 0
  v_mov_b32 v70, 0
  v_mov_b32 v71, 0
  v_mov_b32 v72, 0
  v_mov_b32 v73, 0
  v_mov_b32 v74, 0
  v_mov_b32 v75, 0
  v_mov_b32 v36, 0
  v_mov_b32 v37, 0
  v_mov_b32 v38, 0
  v_mov_b32 v39, 0
  v_mov_b32 v40, 0
  v_mov_b32 v41, 0
  v_mov_b32 v42, 0
  v_mov_b32 v43, 0
  s_add_u32 s97, s97, 10240
  s_mov_b32 s48, s97
  s_add_u32 s49, s49, 5120
  s_add_u32 s50, s50, 12288
  s_add_u32 s63, s63, 12288
  s_add_u32 s51, s51, 1
  s_cmp_gt_u32 s52, s51
  s_cbranch_scc1 kaf_x_wp_42_ok
  s_mov_b32 s45, 0
kaf_x_wp_42_spin:
  buffer_load_dword v2, v138, s[8:11], 0 offen sc1
  s_add_u32 s45, s45, 1
  s_waitcnt vmcnt(0)
  v_min_u32_dpp v3, v2, v2 quad_perm:[1,0,3,2] row_mask:0xf bank_mask:0xf
  s_nop 1
  v_min_u32_dpp v2, v3, v3 quad_perm:[2,3,0,1] row_mask:0xf bank_mask:0xf
  s_nop 1
  v_min_u32_dpp v3, v2, v2 row_half_mirror row_mask:0xf bank_mask:0xf
  s_nop 1
  v_min_u32_dpp v2, v3, v3 quad_perm:[0,1,2,3] row_mask:0xf bank_mask:0xf
  s_nop 0
  v_readfirstlane_b32 s52, v2
  s_cmp_gt_u32 s52, s51
  s_cbranch_scc1 kaf_x_wp_42_ok
  s_cmp_lt_u32 s45, 400000
  s_cbranch_scc1 kaf_x_wp_42_spin
  s_branch kaf_abort
kaf_x_wp_42_ok:
  s_add_u32 s28, s50, s53
  buffer_load_dwordx2 v[88:89], v132, s[8:11], s28 offen offset:0 sc1
  buffer_load_dwordx2 v[92:93], v132, s[8:11], s28 offen offset:1024 sc1
  s_add_u32 s28, s50, s54
  buffer_load_dwordx2 v[90:91], v132, s[8:11], s28 offen offset:0 sc1
  buffer_load_dwordx2 v[94:95], v132, s[8:11], s28 offen offset:1024 sc1
  s_add_u32 s28, s50, s55
  buffer_load_dwordx2 v[96:97], v132, s[8:11], s28 offen offset:0 sc1
  buffer_load_dwordx2 v[98:99], v132, s[8:11], s28 offen offset:1024 sc1
  s_branch kaf_x_w0l
kaf_x_w1:
kaf_x_w1l:
  ds_read_b128 v[44:47], v129 offset:0
  ds_read_b128 v[48:51], v129 offset:1024
  ds_read_b128 v[52:55], v129 offset:10240
  ds_read_b128 v[56:59], v129 offset:11264
  s_waitcnt lgkmcnt(0)
  s_mov_b32 s45, 0
kaf_x_pf_43:
  buffer_load_dwordx4 v[112:115], v124, s[8:11], s48 offen sc1
  buffer_load_dwordx4 v[116:119], v125, s[8:11], s48 offen sc1
  buffer_load_dwordx4 v[120:123], v126, s[8:11], s48 offen sc1
  s_add_u32 s45, s45, 1
  s_waitcnt vmcnt(2)
  ds_write_b128 v127, v[112:115] offset:0
  v_max3_u32 v139, v112, v113, v114
  v_max_u32 v139, v139, v115
  s_waitcnt vmcnt(1)
  ds_write_b128 v127, v[116:119] offset:4096
  v_max3_u32 v139, v139, v116, v117
  v_max3_u32 v139, v139, v118, v119
  s_waitcnt vmcnt(0)
  ds_write_b128 v127, v[120:123] offset:8192
  v_max3_u32 v139, v139, v120, v121
  v_max3_u32 v139, v139, v122, v123
  v_cmp_eq_u32 vcc, -1, v139
  s_cbranch_vccz kaf_x_pf_43_ok
  s_cmp_lt_u32 s45, 400000
  s_cbranch_scc1 kaf_x_pf_43
  s_branch kaf_abort
kaf_x_pf_43_ok:
  v_smfmac_f32_16x16x64_bf16 v[60:63], v[112:115], a[8:15], v110
  v_smfmac_f32_16x16x64_bf16 v[64:67], v[112:115], v[44:51], v110
  ds_read_b128 v[44:47], v129 offset:20480
  v_smfmac_f32_16x16x64_bf16 v[68:71], v[112:115], a[88:95], v110
  ds_read_b128 v[48:51], v129 offset:21504
  v_smfmac_f32_16x16x64_bf16 v[72:75], v[112:115], v[52:59], v110
  ds_read_b128 v[52:55], v129 offset:4096
  s_waitcnt lgkmcnt(3)
  s_barrier
  v_smfmac_f32_16x16x64_bf16 v[36:39], v[112:115], a[168:175], v110
  ds_read_b128 v[56:59], v129 offset:5120
  ds_read_b128 v[4:7], v128 offset:0
  s_waitcnt lgkmcnt(3)
  v_smfmac_f32_16x16x64_bf16 v[40:43], v[112:115], v[44:51], v110
  ds_read_b128 v[44:47], v129 offset:14336
  ds_read_b128 v[8:11], v128 offset:2048
  v_smfmac_f32_16x16x64_bf16 v[60:63], v[116:119], a[40:47], v110
  ds_read_b128 v[48:51], v129 offset:15360
  ds_read_b128 v[12:15], v128 offset:3072
  s_waitcnt lgkmcnt(5)
  v_smfmac_f32_16x16x64_bf16 v[64:67], v[116:119], v[52:59], v110
  ds_read_b128 v[52:55], v129 offset:24576
  ds_read_b128 v[16:19], v128 offset:4096
  v_smfmac_f32_16x16x64_bf16 v[68:71], v[116:119], a[120:127], v110
  ds_read_b128 v[56:59], v129 offset:25600
  ds_read_b128 v[20:23], v128 offset:6144
  s_waitcnt lgkmcnt(5)
  v_smfmac_f32_16x16x64_bf16 v[72:75], v[116:119], v[44:51], v110
  ds_read_b128 v[44:47], v129 offset:8192
  ds_read_b128 v[24:27], v128 offset:7168
  v_smfmac_f32_16x16x64_bf16 v[36:39], v[116:119], a[200:207], v110
  ds_read_b128 v[48:51], v129 offset:9216
  ds_read_b128 v[28:31], v128 offset:8192
  s_waitcnt lgkmcnt(5)
  v_smfmac_f32_16x16x64_bf16 v[40:43], v[116:119], v[52:59], v110
  ds_read_b128 v[52:55], v129 offset:18432
  v_smfmac_f32_16x16x64_bf16 v[60:63], v[120:123], a[72:79], v110
  ds_read_b128 v[56:59], v129 offset:19456
  s_waitcnt lgkmcnt(3)
  v_smfmac_f32_16x16x64_bf16 v[64:67], v[120:123], v[44:51], v110
  ds_read_b128 v[44:47], v129 offset:28672
  v_smfmac_f32_16x16x64_bf16 v[68:71], v[120:123], a[152:159], v110
  ds_read_b128 v[48:51], v129 offset:29696
  s_waitcnt lgkmcnt(2)
  v_smfmac_f32_16x16x64_bf16 v[72:75], v[120:123], v[52:59], v110
  ds_read_b128 v[52:55], v129 offset:2048
  v_smfmac_f32_16x16x64_bf16 v[36:39], v[120:123], a[232:239], v110
  ds_read_b128 v[56:59], v129 offset:3072
  s_waitcnt lgkmcnt(2)
  v_smfmac_f32_16x16x64_bf16 v[40:43], v[120:123], v[44:51], v110
  ds_read_b128 v[44:47], v129 offset:6144
  v_smfmac_f32_16x16x64_bf16 v[60:63], v[4:7], a[0:7], v110
  ds_read_b128 v[48:51], v129 offset:7168
  v_smfmac_f32_16x16x64_bf16 v[64:67], v[4:7], a[240:247], v110
  v_smfmac_f32_16x16x64_bf16 v[60:63], v[8:11], a[16:23], v110
  v_smfmac_f32_16x16x64_bf16 v[64:67], v[8:11], a[248:255], v110
  v_smfmac_f32_16x16x64_bf16 v[60:63], v[12:15], a[24:31], v110
  s_waitcnt lgkmcnt(2)
  v_smfmac_f32_16x16x64_bf16 v[64:67], v[12:15], v[52:59], v110
  ds_read_b128 v[52:55], v129 offset:12288
  v_smfmac_f32_16x16x64_bf16 v[60:63], v[16:19], a[32:39], v110
  ds_read_b128 v[56:59], v129 offset:13312
  v_smfmac_f32_16x16x64_bf16 v[64:67], v[16:19], v[152:159], v110
  v_smfmac_f32_16x16x64_bf16 v[60:63], v[20:23], a[48:55], v110
  v_smfmac_f32_16x16x64_bf16 v[64:67], v[20:23], v[160:167], v110
  v_smfmac_f32_16x16x64_bf16 v[60:63], v[24:27], a[56:63], v110
  s_waitcnt lgkmcnt(2)
  v_smfmac_f32_16x16x64_bf16 v[64:67], v[24:27], v[44:51], v110
  ds_read_b128 v[44:47], v129 offset:16384
  v_smfmac_f32_16x16x64_bf16 v[60:63], v[28:31], a[64:71], v110
  ds_read_b128 v[48:51], v129 offset:17408
  v_smfmac_f32_16x16x64_bf16 v[64:67], v[28:31], v[168:175], v110
  v_smfmac_f32_16x16x64_bf16 v[68:71], v[4:7], a[80:87], v110
  v_smfmac_f32_16x16x64_bf16 v[72:75], v[4:7], v[176:183], v110
  v_permlane32_swap_b32 v60, v64
  v_smfmac_f32_16x16x64_bf16 v[68:71], v[8:11], a[96:103], v110
  v_smfmac_f32_16x16x64_bf16 v[72:75], v[8:11], v[184:191], v110
  v_permlane32_swap_b32 v61, v65
  v_smfmac_f32_16x16x64_bf16 v[68:71], v[12:15], a[104:111], v110
  s_waitcnt lgkmcnt(2)
  v_smfmac_f32_16x16x64_bf16 v[72:75], v[12:15], v[52:59], v110
  ds_read_b128 v[52:55], v129 offset:22528
  v_permlane32_swap_b32 v62, v66
  v_smfmac_f32_16x16x64_bf16 v[68:71], v[16:19], a[112:119], v110
  ds_read_b128 v[56:59], v129 offset:23552
  v_permlane32_swap_b32 v63, v67
  v_smfmac_f32_16x16x64_bf16 v[72:75], v[16:19], v[192:199], v110
  v_add_f32 v60, v60, v64
  v_smfmac_f32_16x16x64_bf16 v[68:71], v[20:23], a[128:135], v110
  v_add_f32 v61, v61, v65
  v_smfmac_f32_16x16x64_bf16 v[72:75], v[20:23], v[200:207], v110
  v_add_f32 v62, v62, v66
  v_smfmac_f32_16x16x64_bf16 v[68:71], v[24:27], a[136:143], v110
  v_add_f32 v63, v63, v67
  s_waitcnt lgkmcnt(2)
  v_smfmac_f32_16x16x64_bf16 v[72:75], v[24:27], v[44:51], v110
  ds_read_b128 v[44:47], v129 offset:26624
  v_cvt_pk_bf16_f32 v100, v60, v61
  v_smfmac_f32_16x16x64_bf16 v[68:71], v[28:31], a[144:151], v110
  ds_read_b128 v[48:51], v129 offset:27648
  v_cvt_pk_bf16_f32 v101, v62, v63
  v_smfmac_f32_16x16x64_bf16 v[72:75], v[28:31], v[208:215], v110
  v_smfmac_f32_16x16x64_bf16 v[36:39], v[4:7], a[160:167], v110
  v_smfmac_f32_16x16x64_bf16 v[40:43], v[4:7], v[216:223], v110
  v_permlane32_swap_b32 v68, v72
  v_smfmac_f32_16x16x64_bf16 v[36:39], v[8:11], a[176:183], v110
  v_smfmac_f32_16x16x64_bf16 v[40:43], v[8:11], v[224:231], v110
  v_permlane32_swap_b32 v69, v73
  v_smfmac_f32_16x16x64_bf16 v[36:39], v[12:15], a[184:191], v110
  s_waitcnt lgkmcnt(2)
  v_smfmac_f32_16x16x64_bf16 v[40:43], v[12:15], v[52:59], v110
  v_permlane32_swap_b32 v70, v74
  v_smfmac_f32_16x16x64_bf16 v[36:39], v[16:19], a[192:199], v110
  v_permlane32_swap_b32 v71, v75
  v_smfmac_f32_16x16x64_bf16 v[40:43], v[16:19], v[232:239], v110
  v_add_f32 v68, v68, v72
  v_smfmac_f32_16x16x64_bf16 v[36:39], v[20:23], a[208:215], v110
  v_add_f32 v69, v69, v73
  v_smfmac_f32_16x16x64_bf16 v[40:43], v[20:23], v[240:247], v110
  v_add_f32 v70, v70, v74
  v_smfmac_f32_16x16x64_bf16 v[36:39], v[24:27], a[216:223], v110
  v_add_f32 v71, v71, v75
  s_waitcnt lgkmcnt(0)
  v_smfmac_f32_16x16x64_bf16 v[40:43], v[24:27], v[44:51], v110
  v_cvt_pk_bf16_f32 v102, v68, v69
  v_smfmac_f32_16x16x64_bf16 v[36:39], v[28:31], a[224:231], v110
  v_cvt_pk_bf16_f32 v103, v70, v71
  v_smfmac_f32_16x16x64_bf16 v[40:43], v[28:31], v[248:255], v110
  v_mfma_f32_16x16x16_bf16 v[142:145], v[100:101], v[108:109], 0
  v_mfma_f32_16x16x16_bf16 v[146:149], v[102:103], v[108:109], 0
  s_nop 1
  v_permlane32_swap_b32 v36, v40
  v_permlane32_swap_b32 v37, v41
  v_permlane32_swap_b32 v38, v42
  v_permlane32_swap_b32 v39, v43
  v_add_f32 v36, v36, v40
  v_add_f32 v37, v37, v41
  v_add_f32 v38, v38, v42
  v_add_f32 v39, v39, v43
  v_cvt_pk_bf16_f32 v104, v36, v37
  v_cvt_pk_bf16_f32 v105, v38, v39
  v_cvt_pk_bf16_f32 v44, v142, v143
  v_cvt_pk_bf16_f32 v45, v144, v145
  v_mfma_f32_16x16x16_bf16 v[142:145], v[104:105], v[108:109], 0
  v_cvt_pk_bf16_f32 v46, v146, v147
  v_cvt_pk_bf16_f32 v47, v148, v149
  ds_write_b64 v131, v[44:45]
  ds_write_b64 v131, v[46:47] offset:512
  v_mfma_f32_16x16x32_bf16 v[76:79], v[44:47], v[44:47], 0
  v_mfma_f32_16x16x32_bf16 v[80:83], v[88:91], v[44:47], 0
  v_mfma_f32_16x16x32_bf16 v[84:87], v[92:95], v[44:47], 0
  v_cvt_pk_bf16_f32 v106, v142, v143
  v_cvt_pk_bf16_f32 v107, v144, v145
  ds_write_b64 v131, v[106:107] offset:1024
  s_nop 0
  v_mfma_f32_16x16x16_bf16 v[76:79], v[106:107], v[106:107], v[76:79]
  v_mfma_f32_16x16x16_bf16 v[80:83], v[96:97], v[106:107], v[80:83]
  v_mfma_f32_16x16x16_bf16 v[84:87], v[98:99], v[106:107], v[84:87]
  s_nop 6
  ds_write_b128 v130, v[76:79] offset:0
  ds_write_b128 v130, v[80:83] offset:1024
  s_nop 0
  ds_write_b128 v130, v[84:87] offset:2048
  s_waitcnt lgkmcnt(0)
  s_barrier
  s_cmp_ge_u32 s51, 63
  s_cbranch_scc1 kaf_x_done
  v_mov_b32 v60, 0
  v_mov_b32 v61, 0
  v_mov_b32 v62, 0
  v_mov_b32 v63, 0
  v_mov_b32 v64, 0
  v_mov_b32 v65, 0
  v_mov_b32 v66, 0
  v_mov_b32 v67, 0
  v_mov_b32 v68, 0
  v_mov_b32 v69, 0
  v_mov_b32 v70, 0
  v_mov_b32 v71, 0
  v_mov_b32 v72, 0
  v_mov_b32 v73, 0
  v_mov_b32 v74, 0
  v_mov_b32 v75, 0
  v_mov_b32 v36, 0
  v_mov_b32 v37, 0
  v_mov_b32 v38, 0
  v_mov_b32 v39, 0
  v_mov_b32 v40, 0
  v_mov_b32 v41, 0
  v_mov_b32 v42, 0
  v_mov_b32 v43, 0
  s_add_u32 s97, s97, 10240
  s_mov_b32 s48, s97
  s_add_u32 s49, s49, 5120
  s_add_u32 s50, s50, 12288
  s_add_u32 s63, s63, 12288
  s_add_u32 s51, s51, 1
  s_cmp_gt_u32 s52, s51
  s_cbranch_scc1 kaf_x_wp_44_ok
  s_mov_b32 s45, 0
kaf_x_wp_44_spin:
  buffer_load_dword v2, v138, s[8:11], 0 offen sc1
  s_add_u32 s45, s45, 1
  s_waitcnt vmcnt(0)
  v_min_u32_dpp v3, v2, v2 quad_perm:[1,0,3,2] row_mask:0xf bank_mask:0xf
  s_nop 1
  v_min_u32_dpp v2, v3, v3 quad_perm:[2,3,0,1] row_mask:0xf bank_mask:0xf
  s_nop 1
  v_min_u32_dpp v3, v2, v2 row_half_mirror row_mask:0xf bank_mask:0xf
  s_nop 1
  v_min_u32_dpp v2, v3, v3 quad_perm:[0,1,2,3] row_mask:0xf bank_mask:0xf
  s_nop 0
  v_readfirstlane_b32 s52, v2
  s_cmp_gt_u32 s52, s51
  s_cbranch_scc1 kaf_x_wp_44_ok
  s_cmp_lt_u32 s45, 400000
  s_cbranch_scc1 kaf_x_wp_44_spin
  s_branch kaf_abort
kaf_x_wp_44_ok:
  s_add_u32 s28, s50, s53
  buffer_load_dwordx2 v[88:89], v132, s[8:11], s28 offen offset:0 sc1
  buffer_load_dwordx2 v[92:93], v132, s[8:11], s28 offen offset:1024 sc1
  s_add_u32 s28, s50, s54
  buffer_load_dwordx2 v[90:91], v132, s[8:11], s28 offen offset:0 sc1
  buffer_load_dwordx2 v[94:95], v132, s[8:11], s28 offen offset:1024 sc1
  s_add_u32 s28, s50, s55
  buffer_load_dwordx2 v[96:97], v132, s[8:11], s28 offen offset:0 sc1
  buffer_load_dwordx2 v[98:99], v132, s[8:11], s28 offen offset:1024 sc1
  s_branch kaf_x_w1l
kaf_x_w23:
  s_sub_u32 s65, s21, 2
  s_and_b32 s26, s23, 7
  v_and_b32 v4, 15, v1
  v_lshrrev_b32 v5, 4, v1
  v_and_b32 v6, 1, v5
  v_lshlrev_b32 v6, 5, v6
  v_add_u32 v6, v6, v4
  v_lshlrev_b32 v6, 4, v6
  v_lshrrev_b32 v7, 1, v5
  v_lshlrev_b32 v7, 3, v7
  v_add_u32 v6, v6, v7
  s_lshl_b32 s28, s26, 1
  s_add_u32 s28, s28, s65
  s_lshl_b32 s28, s28, 10
  v_add_u32 v133, s28, v6
  s_lshr_b32 s28, s26, 2
  s_lshl_b32 s28, s28, 1
  s_add_u32 s28, s28, s65
  s_lshl_b32 s28, s28, 10
  s_and_b32 s29, s26, 1
  s_lshl_b32 s29, s29, 9
  s_add_u32 s28, s28, s29
  s_bfe_u32 s29, s26, 0x10001
  s_lshl_b32 s29, s29, 3
  s_add_u32 s28, s28, s29
  s_add_u32 s28, s28, 15872
  v_lshlrev_b32 v6, 4, v5
  v_add_u32 v6, v6, v4
  v_lshlrev_b32 v6, 4, v6
  v_add_u32 v6, s28, v6
  v_mov_b32 v7, 0x40000000
  v_cmp_le_u32 vcc, 2, v5
  s_nop 1
  v_cndmask_b32 v134, v7, v6, vcc
  v_mov_b32 v135, 0xf149f2ca
  v_lshlrev_b32 v6, 3, v1
  v_add_u32 v136, 145408, v6
  s_mul_i32 s94, s65, 6144
  s_add_u32 s94, s94, 151552
  v_add_u32 v137, s94, v132
  v_cmp_le_u32 s[66:67], 2, v5
  v_lshlrev_b32 v6, 2, v5
  v_sub_u32 v6, v4, v6
  v_cmp_le_i32 s[68:69], 0, v6
  v_cmp_le_i32 s[70:71], 1, v6
  v_cmp_le_i32 s[72:73], 2, v6
  v_cmp_le_i32 s[74:75], 3, v6
  s_nop 1
  s_cmp_eq_u32 s65, 0
  s_cselect_b64 s[76:77], s[68:69], -1
  s_cselect_b64 s[84:85], 0, s[68:69]
  s_cselect_b64 s[78:79], s[70:71], -1
  s_cselect_b64 s[86:87], 0, s[70:71]
  s_cselect_b64 s[80:81], s[72:73], -1
  s_cselect_b64 s[88:89], 0, s[72:73]
  s_cselect_b64 s[82:83], s[74:75], -1
  s_cselect_b64 s[90:91], 0, s[74:75]
  s_mul_i32 s92, s20, 1310720
  s_add_u32 s92, s92, 0xe00000
  s_lshl_b32 s93, s65, 10
  s_mov_b32 s64, 0x3dd53b95
  s_add_u32 s95, s63, s93
  s_add_u32 m0, s94, 0
  s_add_u32 s28, s95, 0
  buffer_load_dwordx4 v132, s[8:11], s28 offen sc1 lds
  s_add_u32 m0, s94, 1024
  s_add_u32 s28, s95, 2048
  buffer_load_dwordx4 v132, s[8:11], s28 offen sc1 lds
  s_add_u32 m0, s94, 2048
  s_add_u32 s28, s95, 4096
  buffer_load_dwordx4 v132, s[8:11], s28 offen sc1 lds
  s_add_u32 m0, s94, 3072
  s_add_u32 s28, s95, 6144
  buffer_load_dwordx4 v132, s[8:11], s28 offen sc1 lds
  s_add_u32 m0, s94, 4096
  s_add_u32 s28, s95, 8192
  buffer_load_dwordx4 v132, s[8:11], s28 offen sc1 lds
  s_add_u32 m0, s94, 5120
  s_add_u32 s28, s95, 10240
  buffer_load_dwordx4 v132, s[8:11], s28 offen sc1 lds
  s_cmp_eq_u32 s21, 3
  s_cbranch_scc1 kaf_x_w3l
kaf_x_w2l:
  ds_read_b128 v[44:47], v129 offset:0
  ds_read_b128 v[48:51], v129 offset:1024
  ds_read_b128 v[52:55], v129 offset:2048
  ds_read_b128 v[56:59], v129 offset:3072
  s_waitcnt lgkmcnt(0)
  s_mov_b32 s45, 0
kaf_x_pf_45:
  buffer_load_dwordx4 v[112:115], v124, s[8:11], s48 offen sc1
  buffer_load_dwordx4 v[116:119], v125, s[8:11], s48 offen sc1
  s_add_u32 s45, s45, 1
  s_waitcnt vmcnt(1)
  ds_write_b128 v127, v[112:115] offset:0
  v_max3_u32 v139, v112, v113, v114
  v_max_u32 v139, v139, v115
  s_waitcnt vmcnt(0)
  ds_write_b128 v127, v[116:119] offset:4096
  v_max3_u32 v139, v139, v116, v117
  v_max3_u32 v139, v139, v118, v119
  v_cmp_eq_u32 vcc, -1, v139
  s_cbranch_vccz kaf_x_pf_45_ok
  s_cmp_lt_u32 s45, 400000
  s_cbranch_scc1 kaf_x_pf_45
  s_branch kaf_abort
kaf_x_pf_45_ok:
  v_smfmac_f32_16x16x64_bf16 v[60:63], v[112:115], a[16:23], v110
  v_smfmac_f32_16x16x64_bf16 v[64:67], v[112:115], a[248:255], v110
  v_smfmac_f32_16x16x64_bf16 v[68:71], v[112:115], a[96:103], v110
  v_smfmac_f32_16x16x64_bf16 v[72:75], v[112:115], v[184:191], v110
  s_waitcnt lgkmcnt(0)
  s_barrier
  v_smfmac_f32_16x16x64_bf16 v[36:39], v[112:115], a[176:183], v110
  ds_read_b128 v[4:7], v128 offset:0
  v_smfmac_f32_16x16x64_bf16 v[40:43], v[112:115], v[224:231], v110
  ds_read_b128 v[8:11], v128 offset:1024
  v_smfmac_f32_16x16x64_bf16 v[60:63], v[116:119], a[48:55], v110
  ds_read_b128 v[12:15], v128 offset:3072
  v_smfmac_f32_16x16x64_bf16 v[64:67], v[116:119], v[160:167], v110
  ds_read_b128 v[16:19], v128 offset:4096
  v_smfmac_f32_16x16x64_bf16 v[68:71], v[116:119], a[128:135], v110
  ds_read_b128 v[20:23], v128 offset:5120
  v_smfmac_f32_16x16x64_bf16 v[72:75], v[116:119], v[200:207], v110
  ds_read_b128 v[24:27], v128 offset:7168
  v_smfmac_f32_16x16x64_bf16 v[36:39], v[116:119], a[208:215], v110
  ds_read_b128 v[28:31], v128 offset:8192
  v_smfmac_f32_16x16x64_bf16 v[40:43], v[116:119], v[240:247], v110
  ds_read_b128 v[32:35], v128 offset:9216
  s_waitcnt lgkmcnt(7)
  v_smfmac_f32_16x16x64_bf16 v[60:63], v[4:7], a[0:7], v110
  v_smfmac_f32_16x16x64_bf16 v[64:67], v[4:7], a[240:247], v110
  s_waitcnt lgkmcnt(6)
  v_smfmac_f32_16x16x64_bf16 v[60:63], v[8:11], a[8:15], v110
  v_smfmac_f32_16x16x64_bf16 v[64:67], v[8:11], v[44:51], v110
  ds_read_b128 v[44:47], v129 offset:4096
  s_waitcnt lgkmcnt(6)
  v_smfmac_f32_16x16x64_bf16 v[60:63], v[12:15], a[24:31], v110
  ds_read_b128 v[48:51], v129 offset:5120
  v_smfmac_f32_16x16x64_bf16 v[64:67], v[12:15], v[52:59], v110
  ds_read_b128 v[52:55], v129 offset:6144
  s_waitcnt lgkmcnt(7)
  v_smfmac_f32_16x16x64_bf16 v[60:63], v[16:19], a[32:39], v110
  ds_read_b128 v[56:59], v129 offset:7168
  v_smfmac_f32_16x16x64_bf16 v[64:67], v[16:19], v[152:159], v110
  s_waitcnt lgkmcnt(7)
  v_smfmac_f32_16x16x64_bf16 v[60:63], v[20:23], a[40:47], v110
  s_waitcnt lgkmcnt(2)
  v_smfmac_f32_16x16x64_bf16 v[64:67], v[20:23], v[44:51], v110
  ds_read_b128 v[44:47], v129 offset:8192
  v_smfmac_f32_16x16x64_bf16 v[60:63], v[24:27], a[56:63], v110
  ds_read_b128 v[48:51], v129 offset:9216
  s_waitcnt lgkmcnt(2)
  v_smfmac_f32_16x16x64_bf16 v[64:67], v[24:27], v[52:59], v110
  ds_read_b128 v[52:55], v129 offset:10240
  v_smfmac_f32_16x16x64_bf16 v[60:63], v[28:31], a[64:71], v110
  ds_read_b128 v[56:59], v129 offset:11264
  v_smfmac_f32_16x16x64_bf16 v[64:67], v[28:31], v[168:175], v110
  v_smfmac_f32_16x16x64_bf16 v[60:63], v[32:35], a[72:79], v110
  s_waitcnt lgkmcnt(2)
  v_smfmac_f32_16x16x64_bf16 v[64:67], v[32:35], v[44:51], v110
  ds_read_b128 v[44:47], v129 offset:12288
  v_smfmac_f32_16x16x64_bf16 v[68:71], v[4:7], a[80:87], v110
  ds_read_b128 v[48:51], v129 offset:13312
  v_smfmac_f32_16x16x64_bf16 v[72:75], v[4:7], v[176:183], v110
  v_permlane32_swap_b32 v60, v64
  v_smfmac_f32_16x16x64_bf16 v[68:71], v[8:11], a[88:95], v110
  s_waitcnt lgkmcnt(2)
  v_smfmac_f32_16x16x64_bf16 v[72:75], v[8:11], v[52:59], v110
  ds_read_b128 v[52:55], v129 offset:14336
  v_permlane32_swap_b32 v61, v65
  v_smfmac_f32_16x16x64_bf16 v[68:71], v[12:15], a[104:111], v110
  ds_read_b128 v[56:59], v129 offset:15360
  s_waitcnt lgkmcnt(2)
  v_smfmac_f32_16x16x64_bf16 v[72:75], v[12:15], v[44:51], v110
  ds_read_b128 v[44:47], v129 offset:16384
  v_permlane32_swap_b32 v62, v66
  v_smfmac_f32_16x16x64_bf16 v[68:71], v[16:19], a[112:119], v110
  ds_read_b128 v[48:51], v129 offset:17408
  v_permlane32_swap_b32 v63, v67
  v_smfmac_f32_16x16x64_bf16 v[72:75], v[16:19], v[192:199], v110
  v_add_f32 v60, v60, v64
  v_smfmac_f32_16x16x64_bf16 v[68:71], v[20:23], a[120:127], v110
  v_add_f32 v61, v61, v65
  s_waitcnt lgkmcnt(2)
  v_smfmac_f32_16x16x64_bf16 v[72:75], v[20:23], v[52:59], v110
  ds_read_b128 v[52:55], v129 offset:18432
  v_add_f32 v62, v62, v66
  v_smfmac_f32_16x16x64_bf16 v[68:71], v[24:27], a[136:143], v110
  ds_read_b128 v[56:59], v129 offset:19456
  v_add_f32 v63, v63, v67
  s_waitcnt lgkmcnt(2)
  v_smfmac_f32_16x16x64_bf16 v[72:75], v[24:27], v[44:51], v110
  ds_read_b128 v[44:47], v129 offset:20480
  v_cvt_pk_bf16_f32 v100, v60, v61
  v_smfmac_f32_16x16x64_bf16 v[68:71], v[28:31], a[144:151], v110
  ds_read_b128 v[48:51], v129 offset:21504
  v_cvt_pk_bf16_f32 v101, v62, v63
  v_smfmac_f32_16x16x64_bf16 v[72:75], v[28:31], v[208:215], v110
  v_smfmac_f32_16x16x64_bf16 v[68:71], v[32:35], a[152:159], v110
  s_waitcnt lgkmcnt(2)
  v_smfmac_f32_16x16x64_bf16 v[72:75], v[32:35], v[52:59], v110
  ds_read_b128 v[52:55], v129 offset:22528
  v_smfmac_f32_16x16x64_bf16 v[36:39], v[4:7], a[160:167], v110
  ds_read_b128 v[56:59], v129 offset:23552
  v_smfmac_f32_16x16x64_bf16 v[40:43], v[4:7], v[216:223], v110
  v_permlane32_swap_b32 v68, v72
  v_smfmac_f32_16x16x64_bf16 v[36:39], v[8:11], a[168:175], v110
  s_waitcnt lgkmcnt(2)
  v_smfmac_f32_16x16x64_bf16 v[40:43], v[8:11], v[44:51], v110
  ds_read_b128 v[44:47], v129 offset:24576
  v_permlane32_swap_b32 v69, v73
  v_smfmac_f32_16x16x64_bf16 v[36:39], v[12:15], a[184:191], v110
  ds_read_b128 v[48:51], v129 offset:25600
  s_waitcnt lgkmcnt(2)
  v_smfmac_f32_16x16x64_bf16 v[40:43], v[12:15], v[52:59], v110
  ds_read_b128 v[52:55], v129 offset:26624
  v_permlane32_swap_b32 v70, v74
  v_smfmac_f32_16x16x64_bf16 v[36:39], v[16:19], a[192:199], v110
  ds_read_b128 v[56:59], v129 offset:27648
  v_permlane32_swap_b32 v71, v75
  v_smfmac_f32_16x16x64_bf16 v[40:43], v[16:19], v[232:239], v110
  v_add_f32 v68, v68, v72
  v_smfmac_f32_16x16x64_bf16 v[36:39], v[20:23], a[200:207], v110
  v_add_f32 v69, v69, v73
  s_waitcnt lgkmcnt(2)
  v_smfmac_f32_16x16x64_bf16 v[40:43], v[20:23], v[44:51], v110
  ds_read_b128 v[44:47], v129 offset:28672
  v_add_f32 v70, v70, v74
  v_smfmac_f32_16x16x64_bf16 v[36:39], v[24:27], a[216:223], v110
  ds_read_b128 v[48:51], v129 offset:29696
  v_add_f32 v71, v71, v75
  s_waitcnt lgkmcnt(2)
  v_smfmac_f32_16x16x64_bf16 v[40:43], v[24:27], v[52:59], v110
  v_cvt_pk_bf16_f32 v102, v68, v69
  v_smfmac_f32_16x16x64_bf16 v[36:39], v[28:31], a[224:231], v110
  v_cvt_pk_bf16_f32 v103, v70, v71
  v_smfmac_f32_16x16x64_bf16 v[40:43], v[28:31], v[248:255], v110
  v_smfmac_f32_16x16x64_bf16 v[36:39], v[32:35], a[232:239], v110
  s_waitcnt lgkmcnt(0)
  v_smfmac_f32_16x16x64_bf16 v[40:43], v[32:35], v[44:51], v110
  v_mfma_f32_16x16x16_bf16 v[142:145], v[100:101], v[108:109], 0
  v_mfma_f32_16x16x16_bf16 v[146:149], v[102:103], v[108:109], 0
  s_nop 1
  v_permlane32_swap_b32 v36, v40
  v_permlane32_swap_b32 v37, v41
  v_permlane32_swap_b32 v38, v42
  v_permlane32_swap_b32 v39, v43
  v_add_f32 v36, v36, v40
  v_add_f32 v37, v37, v41
  v_add_f32 v38, v38, v42
  v_add_f32 v39, v39, v43
  v_cvt_pk_bf16_f32 v104, v36, v37
  v_cvt_pk_bf16_f32 v105, v38, v39
  v_cvt_pk_bf16_f32 v44, v142, v143
  v_cvt_pk_bf16_f32 v45, v144, v145
  v_mfma_f32_16x16x16_bf16 v[142:145], v[104:105], v[108:109], 0
  v_cvt_pk_bf16_f32 v46, v146, v147
  v_cvt_pk_bf16_f32 v47, v148, v149
  ds_write_b64 v131, v[44:45]
  ds_write_b64 v131, v[46:47] offset:512
  v_mfma_f32_16x16x32_bf16 v[76:79], v[44:47], v[44:47], 0
  v_mfma_f32_16x16x32_bf16 v[80:83], v[88:91], v[44:47], 0
  v_mfma_f32_16x16x32_bf16 v[84:87], v[92:95], v[44:47], 0
  v_cvt_pk_bf16_f32 v106, v142, v143
  v_cvt_pk_bf16_f32 v107, v144, v145
  ds_write_b64 v131, v[106:107] offset:1024
  s_nop 0
  v_mfma_f32_16x16x16_bf16 v[76:79], v[106:107], v[106:107], v[76:79]
  v_mfma_f32_16x16x16_bf16 v[80:83], v[96:97], v[106:107], v[80:83]
  v_mfma_f32_16x16x16_bf16 v[84:87], v[98:99], v[106:107], v[84:87]
  s_nop 6
  ds_write_b128 v130, v[76:79] offset:0
  ds_write_b128 v130, v[80:83] offset:1024
  s_nop 0
  ds_write_b128 v130, v[84:87] offset:2048
  s_mov_b32 s28, s50
  buffer_load_dwordx4 v[4:7], v132, s[8:11], s28 offen sc1
  buffer_load_dwordx4 v[8:11], v132, s[8:11], s28 offen offset:1024 sc1
  s_add_u32 s28, s28, 2048
  buffer_load_dwordx4 v[12:15], v132, s[8:11], s28 offen sc1
  buffer_load_dwordx4 v[16:19], v132, s[8:11], s28 offen offset:1024 sc1
  s_add_u32 s28, s28, 2048
  buffer_load_dwordx4 v[20:23], v132, s[8:11], s28 offen sc1
  buffer_load_dwordx4 v[24:27], v132, s[8:11], s28 offen offset:1024 sc1
  s_add_u32 s28, s28, 2048
  buffer_load_dwordx4 v[28:31], v132, s[8:11], s28 offen sc1
  buffer_load_dwordx4 v[32:35], v132, s[8:11], s28 offen offset:1024 sc1
  s_add_u32 s28, s28, 2048
  buffer_load_dwordx4 v[36:39], v132, s[8:11], s28 offen sc1
  buffer_load_dwordx4 v[40:43], v132, s[8:11], s28 offen offset:1024 sc1
  s_add_u32 s28, s28, 2048
  buffer_load_dwordx4 v[60:63], v132, s[8:11], s28 offen sc1
  buffer_load_dwordx4 v[64:67], v132, s[8:11], s28 offen offset:1024 sc1
  s_add_u32 s28, s28, 2048
  s_waitcnt lgkmcnt(0)
  s_barrier
  ds_read_b64 v[76:77], v136 offset:0
  ds_read_b64 v[78:79], v136 offset:512
  ds_read_b64 v[80:81], v136 offset:1024
  ds_read_b64 v[82:83], v136 offset:1536
  ds_read_b64 v[84:85], v136 offset:2048
  ds_read_b64 v[86:87], v136 offset:2560
  ds_read_b64 v[88:89], v136 offset:3072
  ds_read_b64 v[90:91], v136 offset:3584
  ds_read_b64 v[92:93], v136 offset:4096
  ds_read_b64 v[94:95], v136 offset:4608
  ds_read_b64 v[96:97], v136 offset:5120
  ds_read_b64 v[98:99], v136 offset:5632
  ds_read_b128 v[44:47], v137 offset:0
  ds_read_b128 v[48:51], v137 offset:1024
  ds_read_b128 v[52:55], v137 offset:2048
  s_waitcnt lgkmcnt(3)
  ds_read_b128 v[56:59], v137 offset:3072
  ds_read_b128 v[68:71], v137 offset:4096
  ds_read_b128 v[72:75], v137 offset:5120
  s_waitcnt lgkmcnt(0)
  s_cmp_ge_u32 s51, 63
  s_cbranch_scc1 xq_46
  s_add_u32 s96, s51, 1
  s_cmp_gt_u32 s52, s96
  s_cbranch_scc1 kaf_x_wp_47_ok
  s_mov_b32 s45, 0
kaf_x_wp_47_spin:
  buffer_load_dword v2, v138, s[8:11], 0 offen sc1
  s_add_u32 s45, s45, 1
  s_waitcnt vmcnt(0)
  v_min_u32_dpp v3, v2, v2 quad_perm:[1,0,3,2] row_mask:0xf bank_mask:0xf
  s_nop 1
  v_min_u32_dpp v2, v3, v3 quad_perm:[2,3,0,1] row_mask:0xf bank_mask:0xf
  s_nop 1
  v_min_u32_dpp v3, v2, v2 row_half_mirror row_mask:0xf bank_mask:0xf
  s_nop 1
  v_min_u32_dpp v2, v3, v3 quad_perm:[0,1,2,3] row_mask:0xf bank_mask:0xf
  s_nop 0
  v_readfirstlane_b32 s52, v2
  s_cmp_gt_u32 s52, s96
  s_cbranch_scc1 kaf_x_wp_47_ok
  s_cmp_lt_u32 s45, 400000
  s_cbranch_scc1 kaf_x_wp_47_spin
  s_branch kaf_abort
kaf_x_wp_47_ok:
  s_add_u32 s95, s63, s93
  s_add_u32 s95, s95, 12288
  s_add_u32 m0, s94, 0
  s_add_u32 s28, s95, 0
  buffer_load_dwordx4 v132, s[8:11], s28 offen sc1 lds
  s_add_u32 m0, s94, 1024
  s_add_u32 s28, s95, 2048
  buffer_load_dwordx4 v132, s[8:11], s28 offen sc1 lds
  s_add_u32 m0, s94, 2048
  s_add_u32 s28, s95, 4096
  buffer_load_dwordx4 v132, s[8:11], s28 offen sc1 lds
  s_add_u32 m0, s94, 3072
  s_add_u32 s28, s95, 6144
  buffer_load_dwordx4 v132, s[8:11], s28 offen sc1 lds
  s_add_u32 m0, s94, 4096
  s_add_u32 s28, s95, 8192
  buffer_load_dwordx4 v132, s[8:11], s28 offen sc1 lds
  s_add_u32 m0, s94, 5120
  s_add_u32 s28, s95, 10240
  buffer_load_dwordx4 v132, s[8:11], s28 offen sc1 lds
  s_branch xq_46_j
xq_46:
  s_waitcnt vmcnt(0)
xq_46_j:
  s_waitcnt vmcnt(16)
  v_mfma_f32_16x16x32_bf16 v[112:115], v[76:79], v[44:47], 0
  v_mfma_f32_16x16x32_bf16 v[116:119], v[4:7], v[44:47], 0
  v_mfma_f32_16x16x32_bf16 v[120:123], v[8:11], v[44:47], 0
  s_waitcnt vmcnt(14)
  v_mfma_f32_16x16x32_bf16 v[112:115], v[80:83], v[48:51], v[112:115]
  v_mfma_f32_16x16x32_bf16 v[116:119], v[12:15], v[48:51], v[116:119]
  v_mfma_f32_16x16x32_bf16 v[120:123], v[16:19], v[48:51], v[120:123]
  s_waitcnt vmcnt(12)
  v_mfma_f32_16x16x32_bf16 v[112:115], v[84:87], v[52:55], v[112:115]
  v_mfma_f32_16x16x32_bf16 v[116:119], v[20:23], v[52:55], v[116:119]
  v_mfma_f32_16x16x32_bf16 v[120:123], v[24:27], v[52:55], v[120:123]
  s_waitcnt vmcnt(10)
  v_mfma_f32_16x16x32_bf16 v[112:115], v[88:91], v[56:59], v[112:115]
  v_mfma_f32_16x16x32_bf16 v[116:119], v[28:31], v[56:59], v[116:119]
  v_mfma_f32_16x16x32_bf16 v[120:123], v[32:35], v[56:59], v[120:123]
  s_waitcnt vmcnt(8)
  v_mfma_f32_16x16x32_bf16 v[112:115], v[92:95], v[68:71], v[112:115]
  v_mfma_f32_16x16x32_bf16 v[116:119], v[36:39], v[68:71], v[116:119]
  v_mfma_f32_16x16x32_bf16 v[120:123], v[40:43], v[68:71], v[120:123]
  s_waitcnt vmcnt(6)
  v_mfma_f32_16x16x32_bf16 v[112:115], v[96:99], v[72:75], v[112:115]
  v_mfma_f32_16x16x32_bf16 v[116:119], v[60:63], v[72:75], v[116:119]
  v_mfma_f32_16x16x32_bf16 v[120:123], v[64:67], v[72:75], v[120:123]
  s_nop 8
  v_cndmask_b32 v112, v135, v112, s[66:67]
  v_cndmask_b32 v113, v135, v113, s[66:67]
  v_cndmask_b32 v114, v135, v114, s[66:67]
  v_cndmask_b32 v115, v135, v115, s[66:67]
  v_cndmask_b32 v116, v135, v116, s[76:77]
  v_cndmask_b32 v120, v135, v120, s[84:85]
  v_cndmask_b32 v117, v135, v117, s[78:79]
  v_cndmask_b32 v121, v135, v121, s[86:87]
  v_cndmask_b32 v118, v135, v118, s[80:81]
  v_cndmask_b32 v122, v135, v122, s[88:89]
  v_cndmask_b32 v119, v135, v119, s[82:83]
  v_cndmask_b32 v123, v135, v123, s[90:91]
  v_max3_f32 v4, v112, v113, v114
  v_max3_f32 v5, v115, v116, v117
  v_max3_f32 v6, v118, v119, v120
  v_max3_f32 v7, v121, v122, v123
  v_max3_f32 v4, v4, v5, v6
  v_max_f32 v4, v4, v7
  v_mov_b32 v5, v4
  s_nop 1
  v_permlane16_swap_b32 v4, v5
  v_max_f32 v4, v4, v5
  v_mov_b32 v5, v4
  s_nop 1
  v_permlane32_swap_b32 v4, v5
  v_max_f32 v4, v4, v5
  v_mul_f32 v4, s64, v4
  v_fma_f32 v112, v112, s64, -v4
  v_fma_f32 v113, v113, s64, -v4
  v_fma_f32 v114, v114, s64, -v4
  v_fma_f32 v115, v115, s64, -v4
  v_fma_f32 v116, v116, s64, -v4
  v_fma_f32 v117, v117, s64, -v4
  v_fma_f32 v118, v118, s64, -v4
  v_fma_f32 v119, v119, s64, -v4
  v_fma_f32 v120, v120, s64, -v4
  v_fma_f32 v121, v121, s64, -v4
  v_fma_f32 v122, v122, s64, -v4
  v_fma_f32 v123, v123, s64, -v4
  v_exp_f32 v112, v112
  v_exp_f32 v113, v113
  v_exp_f32 v114, v114
  v_exp_f32 v115, v115
  v_exp_f32 v116, v116
  v_exp_f32 v117, v117
  v_exp_f32 v118, v118
  v_exp_f32 v119, v119
  v_exp_f32 v120, v120
  v_exp_f32 v121, v121
  v_exp_f32 v122, v122
  v_exp_f32 v123, v123
  v_add_f32 v5, v112, v113
  v_add_f32 v6, v114, v115
  v_add_f32 v7, v116, v117
  v_add_f32 v8, v118, v119
  v_add_f32 v9, v120, v121
  v_add_f32 v10, v122, v123
  v_add_f32 v5, v5, v6
  v_add_f32 v7, v7, v8
  v_add_f32 v9, v9, v10
  v_add_f32 v5, v5, v7
  v_add_f32 v5, v5, v9
  v_mov_b32 v6, v5
  s_nop 1
  v_permlane16_swap_b32 v5, v6
  v_add_f32 v5, v5, v6
  v_mov_b32 v6, v5
  s_nop 1
  v_permlane32_swap_b32 v5, v6
  v_add_f32 v5, v5, v6
  v_rcp_f32 v5, v5
  s_nop 0
  v_mul_f32 v112, v112, v5
  v_mul_f32 v113, v113, v5
  v_mul_f32 v114, v114, v5
  v_mul_f32 v115, v115, v5
  v_mul_f32 v116, v116, v5
  v_mul_f32 v117, v117, v5
  v_mul_f32 v118, v118, v5
  v_mul_f32 v119, v119, v5
  v_mul_f32 v120, v120, v5
  v_mul_f32 v121, v121, v5
  v_mul_f32 v122, v122, v5
  v_mul_f32 v123, v123, v5
  v_cvt_pk_bf16_f32 v8, v112, v113
  v_cvt_pk_bf16_f32 v9, v114, v115
  v_cvt_pk_bf16_f32 v10, v116, v117
  v_cvt_pk_bf16_f32 v11, v118, v119
  v_cvt_pk_bf16_f32 v12, v120, v121
  v_cvt_pk_bf16_f32 v13, v122, v123
  buffer_store_dwordx2 v[10:11], v133, s[8:11], s92 offen
  buffer_store_dwordx2 v[12:13], v133, s[8:11], s92 offen offset:256
  buffer_store_dwordx2 v[8:9], v134, s[8:11], s92 offen
  s_add_u32 s92, s92, 20480
  s_cmp_ge_u32 s51, 63
  s_cbranch_scc1 kaf_x_done
  v_mov_b32 v60, 0
  v_mov_b32 v61, 0
  v_mov_b32 v62, 0
  v_mov_b32 v63, 0
  v_mov_b32 v64, 0
  v_mov_b32 v65, 0
  v_mov_b32 v66, 0
  v_mov_b32 v67, 0
  v_mov_b32 v68, 0
  v_mov_b32 v69, 0
  v_mov_b32 v70, 0
  v_mov_b32 v71, 0
  v_mov_b32 v72, 0
  v_mov_b32 v73, 0
  v_mov_b32 v74, 0
  v_mov_b32 v75, 0
  v_mov_b32 v36, 0
  v_mov_b32 v37, 0
  v_mov_b32 v38, 0
  v_mov_b32 v39, 0
  v_mov_b32 v40, 0
  v_mov_b32 v41, 0
  v_mov_b32 v42, 0
  v_mov_b32 v43, 0
  s_add_u32 s97, s97, 10240
  s_mov_b32 s48, s97
  s_add_u32 s49, s49, 5120
  s_add_u32 s50, s50, 12288
  s_add_u32 s63, s63, 12288
  s_add_u32 s51, s51, 1
  s_cmp_gt_u32 s52, s51
  s_cbranch_scc1 kaf_x_wp_48_ok
  s_mov_b32 s45, 0
kaf_x_wp_48_spin:
  buffer_load_dword v2, v138, s[8:11], 0 offen sc1
  s_add_u32 s45, s45, 1
  s_waitcnt vmcnt(0)
  v_min_u32_dpp v3, v2, v2 quad_perm:[1,0,3,2] row_mask:0xf bank_mask:0xf
  s_nop 1
  v_min_u32_dpp v2, v3, v3 quad_perm:[2,3,0,1] row_mask:0xf bank_mask:0xf
  s_nop 1
  v_min_u32_dpp v3, v2, v2 row_half_mirror row_mask:0xf bank_mask:0xf
  s_nop 1
  v_min_u32_dpp v2, v3, v3 quad_perm:[0,1,2,3] row_mask:0xf bank_mask:0xf
  s_nop 0
  v_readfirstlane_b32 s52, v2
  s_cmp_gt_u32 s52, s51
  s_cbranch_scc1 kaf_x_wp_48_ok
  s_cmp_lt_u32 s45, 400000
  s_cbranch_scc1 kaf_x_wp_48_spin
  s_branch kaf_abort
kaf_x_wp_48_ok:
  s_add_u32 s28, s50, s53
  buffer_load_dwordx2 v[88:89], v132, s[8:11], s28 offen offset:0 sc1
  buffer_load_dwordx2 v[92:93], v132, s[8:11], s28 offen offset:1024 sc1
  s_add_u32 s28, s50, s54
  buffer_load_dwordx2 v[90:91], v132, s[8:11], s28 offen offset:0 sc1
  buffer_load_dwordx2 v[94:95], v132, s[8:11], s28 offen offset:1024 sc1
  s_add_u32 s28, s50, s55
  buffer_load_dwordx2 v[96:97], v132, s[8:11], s28 offen offset:0 sc1
  buffer_load_dwordx2 v[98:99], v132, s[8:11], s28 offen offset:1024 sc1
  s_branch kaf_x_w2l
kaf_x_w3l:
  ds_read_b128 v[44:47], v129 offset:2048
  ds_read_b128 v[48:51], v129 offset:3072
  ds_read_b128 v[52:55], v129 offset:12288
  ds_read_b128 v[56:59], v129 offset:13312
  s_waitcnt lgkmcnt(0)
  s_mov_b32 s45, 0
kaf_x_pf_49:
  buffer_load_dwordx4 v[112:115], v124, s[8:11], s48 offen sc1
  buffer_load_dwordx4 v[116:119], v125, s[8:11], s48 offen sc1
  s_add_u32 s45, s45, 1
  s_waitcnt vmcnt(1)
  ds_write_b128 v127, v[112:115] offset:0
  v_max3_u32 v139, v112, v113, v114
  v_max_u32 v139, v139, v115
  s_waitcnt vmcnt(0)
  ds_write_b128 v127, v[116:119] offset:4096
  v_max3_u32 v139, v139, v116, v117
  v_max3_u32 v139, v139, v118, v119
  v_cmp_eq_u32 vcc, -1, v139
  s_cbranch_vccz kaf_x_pf_49_ok
  s_cmp_lt_u32 s45, 400000
  s_cbranch_scc1 kaf_x_pf_49
  s_branch kaf_abort
kaf_x_pf_49_ok:
  v_smfmac_f32_16x16x64_bf16 v[60:63], v[112:115], a[24:31], v110
  v_smfmac_f32_16x16x64_bf16 v[64:67], v[112:115], v[44:51], v110
  ds_read_b128 v[44:47], v129 offset:22528
  v_smfmac_f32_16x16x64_bf16 v[68:71], v[112:115], a[104:111], v110
  ds_read_b128 v[48:51], v129 offset:23552
  v_smfmac_f32_16x16x64_bf16 v[72:75], v[112:115], v[52:59], v110
  ds_read_b128 v[52:55], v129 offset:6144
  s_waitcnt lgkmcnt(3)
  s_barrier
  v_smfmac_f32_16x16x64_bf16 v[36:39], v[112:115], a[184:191], v110
  ds_read_b128 v[56:59], v129 offset:7168
  ds_read_b128 v[4:7], v128 offset:0
  s_waitcnt lgkmcnt(3)
  v_smfmac_f32_16x16x64_bf16 v[40:43], v[112:115], v[44:51], v110
  ds_read_b128 v[44:47], v129 offset:16384
  ds_read_b128 v[8:11], v128 offset:1024
  v_smfmac_f32_16x16x64_bf16 v[60:63], v[116:119], a[56:63], v110
  ds_read_b128 v[48:51], v129 offset:17408
  ds_read_b128 v[12:15], v128 offset:2048
  s_waitcnt lgkmcnt(5)
  v_smfmac_f32_16x16x64_bf16 v[64:67], v[116:119], v[52:59], v110
  ds_read_b128 v[52:55], v129 offset:26624
  ds_read_b128 v[16:19], v128 offset:4096
  v_smfmac_f32_16x16x64_bf16 v[68:71], v[116:119], a[136:143], v110
  ds_read_b128 v[56:59], v129 offset:27648
  ds_read_b128 v[20:23], v128 offset:5120
  s_waitcnt lgkmcnt(5)
  v_smfmac_f32_16x16x64_bf16 v[72:75], v[116:119], v[44:51], v110
  ds_read_b128 v[44:47], v129 offset:0
  ds_read_b128 v[24:27], v128 offset:6144
  v_smfmac_f32_16x16x64_bf16 v[36:39], v[116:119], a[216:223], v110
  ds_read_b128 v[48:51], v129 offset:1024
  ds_read_b128 v[28:31], v128 offset:8192
  s_waitcnt lgkmcnt(5)
  v_smfmac_f32_16x16x64_bf16 v[40:43], v[116:119], v[52:59], v110
  ds_read_b128 v[52:55], v129 offset:4096
  ds_read_b128 v[32:35], v128 offset:9216
  v_smfmac_f32_16x16x64_bf16 v[60:63], v[4:7], a[0:7], v110
  ds_read_b128 v[56:59], v129 offset:5120
  v_smfmac_f32_16x16x64_bf16 v[64:67], v[4:7], a[240:247], v110
  v_smfmac_f32_16x16x64_bf16 v[60:63], v[8:11], a[8:15], v110
  s_waitcnt lgkmcnt(4)
  v_smfmac_f32_16x16x64_bf16 v[64:67], v[8:11], v[44:51], v110
  ds_read_b128 v[44:47], v129 offset:8192
  v_smfmac_f32_16x16x64_bf16 v[60:63], v[12:15], a[16:23], v110
  ds_read_b128 v[48:51], v129 offset:9216
  v_smfmac_f32_16x16x64_bf16 v[64:67], v[12:15], a[248:255], v110
  v_smfmac_f32_16x16x64_bf16 v[60:63], v[16:19], a[32:39], v110
  v_smfmac_f32_16x16x64_bf16 v[64:67], v[16:19], v[152:159], v110
  v_smfmac_f32_16x16x64_bf16 v[60:63], v[20:23], a[40:47], v110
  s_waitcnt lgkmcnt(2)
  v_smfmac_f32_16x16x64_bf16 v[64:67], v[20:23], v[52:59], v110
  ds_read_b128 v[52:55], v129 offset:10240
  v_smfmac_f32_16x16x64_bf16 v[60:63], v[24:27], a[48:55], v110
  ds_read_b128 v[56:59], v129 offset:11264
  v_smfmac_f32_16x16x64_bf16 v[64:67], v[24:27], v[160:167], v110
  v_smfmac_f32_16x16x64_bf16 v[60:63], v[28:31], a[64:71], v110
  v_smfmac_f32_16x16x64_bf16 v[64:67], v[28:31], v[168:175], v110
  v_smfmac_f32_16x16x64_bf16 v[60:63], v[32:35], a[72:79], v110
  s_waitcnt lgkmcnt(2)
  v_smfmac_f32_16x16x64_bf16 v[64:67], v[32:35], v[44:51], v110
  ds_read_b128 v[44:47], v129 offset:14336
  v_smfmac_f32_16x16x64_bf16 v[68:71], v[4:7], a[80:87], v110
  ds_read_b128 v[48:51], v129 offset:15360
  v_smfmac_f32_16x16x64_bf16 v[72:75], v[4:7], v[176:183], v110
  v_permlane32_swap_b32 v60, v64
  v_smfmac_f32_16x16x64_bf16 v[68:71], v[8:11], a[88:95], v110
  s_waitcnt lgkmcnt(2)
  v_smfmac_f32_16x16x64_bf16 v[72:75], v[8:11], v[52:59], v110
  ds_read_b128 v[52:55], v129 offset:18432
  v_permlane32_swap_b32 v61, v65
  v_smfmac_f32_16x16x64_bf16 v[68:71], v[12:15], a[96:103], v110
  ds_read_b128 v[56:59], v129 offset:19456
  v_smfmac_f32_16x16x64_bf16 v[72:75], v[12:15], v[184:191], v110
  v_permlane32_swap_b32 v62, v66
  v_smfmac_f32_16x16x64_bf16 v[68:71], v[16:19], a[112:119], v110
  v_permlane32_swap_b32 v63, v67
  v_smfmac_f32_16x16x64_bf16 v[72:75], v[16:19], v[192:199], v110
  v_add_f32 v60, v60, v64
  v_smfmac_f32_16x16x64_bf16 v[68:71], v[20:23], a[120:127], v110
  v_add_f32 v61, v61, v65
  s_waitcnt lgkmcnt(2)
  v_smfmac_f32_16x16x64_bf16 v[72:75], v[20:23], v[44:51], v110
  ds_read_b128 v[44:47], v129 offset:20480
  v_add_f32 v62, v62, v66
  v_smfmac_f32_16x16x64_bf16 v[68:71], v[24:27], a[128:135], v110
  ds_read_b128 v[48:51], v129 offset:21504
  v_add_f32 v63, v63, v67
  v_smfmac_f32_16x16x64_bf16 v[72:75], v[24:27], v[200:207], v110
  v_cvt_pk_bf16_f32 v100, v60, v61
  v_smfmac_f32_16x16x64_bf16 v[68:71], v[28:31], a[144:151], v110
  v_cvt_pk_bf16_f32 v101, v62, v63
  v_smfmac_f32_16x16x64_bf16 v[72:75], v[28:31], v[208:215], v110
  v_smfmac_f32_16x16x64_bf16 v[68:71], v[32:35], a[152:159], v110
  s_waitcnt lgkmcnt(2)
  v_smfmac_f32_16x16x64_bf16 v[72:75], v[32:35], v[52:59], v110
  ds_read_b128 v[52:55], v129 offset:24576
  v_smfmac_f32_16x16x64_bf16 v[36:39], v[4:7], a[160:167], v110
  ds_read_b128 v[56:59], v129 offset:25600
  v_smfmac_f32_16x16x64_bf16 v[40:43], v[4:7], v[216:223], v110
  v_permlane32_swap_b32 v68, v72
  v_smfmac_f32_16x16x64_bf16 v[36:39], v[8:11], a[168:175], v110
  s_waitcnt lgkmcnt(2)
  v_smfmac_f32_16x16x64_bf16 v[40:43], v[8:11], v[44:51], v110
  ds_read_b128 v[44:47], v129 offset:28672
  v_permlane32_swap_b32 v69, v73
  v_smfmac_f32_16x16x64_bf16 v[36:39], v[12:15], a[176:183], v110
  ds_read_b128 v[48:51], v129 offset:29696
  v_smfmac_f32_16x16x64_bf16 v[40:43], v[12:15], v[224:231], v110
  v_permlane32_swap_b32 v70, v74
  v_smfmac_f32_16x16x64_bf16 v[36:39], v[16:19], a[192:199], v110
  v_permlane32_swap_b32 v71, v75
  v_smfmac_f32_16x16x64_bf16 v[40:43], v[16:19], v[232:239], v110
  v_add_f32 v68, v68, v72
  v_smfmac_f32_16x16x64_bf16 v[36:39], v[20:23], a[200:207], v110
  v_add_f32 v69, v69, v73
  s_waitcnt lgkmcnt(2)
  v_smfmac_f32_16x16x64_bf16 v[40:43], v[20:23], v[52:59], v110
  v_add_f32 v70, v70, v74
  v_smfmac_f32_16x16x64_bf16 v[36:39], v[24:27], a[208:215], v110
  v_add_f32 v71, v71, v75
  v_smfmac_f32_16x16x64_bf16 v[40:43], v[24:27], v[240:247], v110
  v_cvt_pk_bf16_f32 v102, v68, v69
  v_smfmac_f32_16x16x64_bf16 v[36:39], v[28:31], a[224:231], v110
  v_cvt_pk_bf16_f32 v103, v70, v71
  v_smfmac_f32_16x16x64_bf16 v[40:43], v[28:31], v[248:255], v110
  v_smfmac_f32_16x16x64_bf16 v[36:39], v[32:35], a[232:239], v110
  s_waitcnt lgkmcnt(0)
  v_smfmac_f32_16x16x64_bf16 v[40:43], v[32:35], v[44:51], v110
  v_mfma_f32_16x16x16_bf16 v[142:145], v[100:101], v[108:109], 0
  v_mfma_f32_16x16x16_bf16 v[146:149], v[102:103], v[108:109], 0
  s_nop 1
  v_permlane32_swap_b32 v36, v40
  v_permlane32_swap_b32 v37, v41
  v_permlane32_swap_b32 v38, v42
  v_permlane32_swap_b32 v39, v43
  v_add_f32 v36, v36, v40
  v_add_f32 v37, v37, v41
  v_add_f32 v38, v38, v42
  v_add_f32 v39, v39, v43
  v_cvt_pk_bf16_f32 v104, v36, v37
  v_cvt_pk_bf16_f32 v105, v38, v39
  v_cvt_pk_bf16_f32 v44, v142, v143
  v_cvt_pk_bf16_f32 v45, v144, v145
  v_mfma_f32_16x16x16_bf16 v[142:145], v[104:105], v[108:109], 0
  v_cvt_pk_bf16_f32 v46, v146, v147
  v_cvt_pk_bf16_f32 v47, v148, v149
  ds_write_b64 v131, v[44:45]
  ds_write_b64 v131, v[46:47] offset:512
  v_mfma_f32_16x16x32_bf16 v[76:79], v[44:47], v[44:47], 0
  v_mfma_f32_16x16x32_bf16 v[80:83], v[88:91], v[44:47], 0
  v_mfma_f32_16x16x32_bf16 v[84:87], v[92:95], v[44:47], 0
  v_cvt_pk_bf16_f32 v106, v142, v143
  v_cvt_pk_bf16_f32 v107, v144, v145
  ds_write_b64 v131, v[106:107] offset:1024
  s_nop 0
  v_mfma_f32_16x16x16_bf16 v[76:79], v[106:107], v[106:107], v[76:79]
  v_mfma_f32_16x16x16_bf16 v[80:83], v[96:97], v[106:107], v[80:83]
  v_mfma_f32_16x16x16_bf16 v[84:87], v[98:99], v[106:107], v[84:87]
  s_nop 6
  ds_write_b128 v130, v[76:79] offset:0
  ds_write_b128 v130, v[80:83] offset:1024
  s_nop 0
  ds_write_b128 v130, v[84:87] offset:2048
  s_mov_b32 s28, s50
  buffer_load_dwordx4 v[4:7], v132, s[8:11], s28 offen sc1
  buffer_load_dwordx4 v[8:11], v132, s[8:11], s28 offen offset:1024 sc1
  s_add_u32 s28, s28, 2048
  buffer_load_dwordx4 v[12:15], v132, s[8:11], s28 offen sc1
  buffer_load_dwordx4 v[16:19], v132, s[8:11], s28 offen offset:1024 sc1
  s_add_u32 s28, s28, 2048
  buffer_load_dwordx4 v[20:23], v132, s[8:11], s28 offen sc1
  buffer_load_dwordx4 v[24:27], v132, s[8:11], s28 offen offset:1024 sc1
  s_add_u32 s28, s28, 2048
  buffer_load_dwordx4 v[28:31], v132, s[8:11], s28 offen sc1
  buffer_load_dwordx4 v[32:35], v132, s[8:11], s28 offen offset:1024 sc1
  s_add_u32 s28, s28, 2048
  buffer_load_dwordx4 v[36:39], v132, s[8:11], s28 offen sc1
  buffer_load_dwordx4 v[40:43], v132, s[8:11], s28 offen offset:1024 sc1
  s_add_u32 s28, s28, 2048
  buffer_load_dwordx4 v[60:63], v132, s[8:11], s28 offen sc1
  buffer_load_dwordx4 v[64:67], v132, s[8:11], s28 offen offset:1024 sc1
  s_add_u32 s28, s28, 2048
  s_waitcnt lgkmcnt(0)
  s_barrier
  ds_read_b64 v[76:77], v136 offset:0
  ds_read_b64 v[78:79], v136 offset:512
  ds_read_b64 v[80:81], v136 offset:1024
  ds_read_b64 v[82:83], v136 offset:1536
  ds_read_b64 v[84:85], v136 offset:2048
  ds_read_b64 v[86:87], v136 offset:2560
  ds_read_b64 v[88:89], v136 offset:3072
  ds_read_b64 v[90:91], v136 offset:3584
  ds_read_b64 v[92:93], v136 offset:4096
  ds_read_b64 v[94:95], v136 offset:4608
  ds_read_b64 v[96:97], v136 offset:5120
  ds_read_b64 v[98:99], v136 offset:5632
  ds_read_b128 v[44:47], v137 offset:0
  ds_read_b128 v[48:51], v137 offset:1024
  ds_read_b128 v[52:55], v137 offset:2048
  s_waitcnt lgkmcnt(3)
  ds_read_b128 v[56:59], v137 offset:3072
  ds_read_b128 v[68:71], v137 offset:4096
  ds_read_b128 v[72:75], v137 offset:5120
  s_waitcnt lgkmcnt(0)
  s_cmp_ge_u32 s51, 63
  s_cbranch_scc1 xq_50
  s_add_u32 s96, s51, 1
  s_cmp_gt_u32 s52, s96
  s_cbranch_scc1 kaf_x_wp_51_ok
  s_mov_b32 s45, 0
kaf_x_wp_51_spin:
  buffer_load_dword v2, v138, s[8:11], 0 offen sc1
  s_add_u32 s45, s45, 1
  s_waitcnt vmcnt(0)
  v_min_u32_dpp v3, v2, v2 quad_perm:[1,0,3,2] row_mask:0xf bank_mask:0xf
  s_nop 1
  v_min_u32_dpp v2, v3, v3 quad_perm:[2,3,0,1] row_mask:0xf bank_mask:0xf
  s_nop 1
  v_min_u32_dpp v3, v2, v2 row_half_mirror row_mask:0xf bank_mask:0xf
  s_nop 1
  v_min_u32_dpp v2, v3, v3 quad_perm:[0,1,2,3] row_mask:0xf bank_mask:0xf
  s_nop 0
  v_readfirstlane_b32 s52, v2
  s_cmp_gt_u32 s52, s96
  s_cbranch_scc1 kaf_x_wp_51_ok
  s_cmp_lt_u32 s45, 400000
  s_cbranch_scc1 kaf_x_wp_51_spin
  s_branch kaf_abort
kaf_x_wp_51_ok:
  s_add_u32 s95, s63, s93
  s_add_u32 s95, s95, 12288
  s_add_u32 m0, s94, 0
  s_add_u32 s28, s95, 0
  buffer_load_dwordx4 v132, s[8:11], s28 offen sc1 lds
  s_add_u32 m0, s94, 1024
  s_add_u32 s28, s95, 2048
  buffer_load_dwordx4 v132, s[8:11], s28 offen sc1 lds
  s_add_u32 m0, s94, 2048
  s_add_u32 s28, s95, 4096
  buffer_load_dwordx4 v132, s[8:11], s28 offen sc1 lds
  s_add_u32 m0, s94, 3072
  s_add_u32 s28, s95, 6144
  buffer_load_dwordx4 v132, s[8:11], s28 offen sc1 lds
  s_add_u32 m0, s94, 4096
  s_add_u32 s28, s95, 8192
  buffer_load_dwordx4 v132, s[8:11], s28 offen sc1 lds
  s_add_u32 m0, s94, 5120
  s_add_u32 s28, s95, 10240
  buffer_load_dwordx4 v132, s[8:11], s28 offen sc1 lds
  s_branch xq_50_j
xq_50:
  s_waitcnt vmcnt(0)
xq_50_j:
  s_waitcnt vmcnt(16)
  v_mfma_f32_16x16x32_bf16 v[112:115], v[76:79], v[44:47], 0
  v_mfma_f32_16x16x32_bf16 v[116:119], v[4:7], v[44:47], 0
  v_mfma_f32_16x16x32_bf16 v[120:123], v[8:11], v[44:47], 0
  s_waitcnt vmcnt(14)
  v_mfma_f32_16x16x32_bf16 v[112:115], v[80:83], v[48:51], v[112:115]
  v_mfma_f32_16x16x32_bf16 v[116:119], v[12:15], v[48:51], v[116:119]
  v_mfma_f32_16x16x32_bf16 v[120:123], v[16:19], v[48:51], v[120:123]
  s_waitcnt vmcnt(12)
  v_mfma_f32_16x16x32_bf16 v[112:115], v[84:87], v[52:55], v[112:115]
  v_mfma_f32_16x16x32_bf16 v[116:119], v[20:23], v[52:55], v[116:119]
  v_mfma_f32_16x16x32_bf16 v[120:123], v[24:27], v[52:55], v[120:123]
  s_waitcnt vmcnt(10)
  v_mfma_f32_16x16x32_bf16 v[112:115], v[88:91], v[56:59], v[112:115]
  v_mfma_f32_16x16x32_bf16 v[116:119], v[28:31], v[56:59], v[116:119]
  v_mfma_f32_16x16x32_bf16 v[120:123], v[32:35], v[56:59], v[120:123]
  s_waitcnt vmcnt(8)
  v_mfma_f32_16x16x32_bf16 v[112:115], v[92:95], v[68:71], v[112:115]
  v_mfma_f32_16x16x32_bf16 v[116:119], v[36:39], v[68:71], v[116:119]
  v_mfma_f32_16x16x32_bf16 v[120:123], v[40:43], v[68:71], v[120:123]
  s_waitcnt vmcnt(6)
  v_mfma_f32_16x16x32_bf16 v[112:115], v[96:99], v[72:75], v[112:115]
  v_mfma_f32_16x16x32_bf16 v[116:119], v[60:63], v[72:75], v[116:119]
  v_mfma_f32_16x16x32_bf16 v[120:123], v[64:67], v[72:75], v[120:123]
  s_nop 8
  v_cndmask_b32 v112, v135, v112, s[66:67]
  v_cndmask_b32 v113, v135, v113, s[66:67]
  v_cndmask_b32 v114, v135, v114, s[66:67]
  v_cndmask_b32 v115, v135, v115, s[66:67]
  v_cndmask_b32 v116, v135, v116, s[76:77]
  v_cndmask_b32 v120, v135, v120, s[84:85]
  v_cndmask_b32 v117, v135, v117, s[78:79]
  v_cndmask_b32 v121, v135, v121, s[86:87]
  v_cndmask_b32 v118, v135, v118, s[80:81]
  v_cndmask_b32 v122, v135, v122, s[88:89]
  v_cndmask_b32 v119, v135, v119, s[82:83]
  v_cndmask_b32 v123, v135, v123, s[90:91]
  v_max3_f32 v4, v112, v113, v114
  v_max3_f32 v5, v115, v116, v117
  v_max3_f32 v6, v118, v119, v120
  v_max3_f32 v7, v121, v122, v123
  v_max3_f32 v4, v4, v5, v6
  v_max_f32 v4, v4, v7
  v_mov_b32 v5, v4
  s_nop 1
  v_permlane16_swap_b32 v4, v5
  v_max_f32 v4, v4, v5
  v_mov_b32 v5, v4
  s_nop 1
  v_permlane32_swap_b32 v4, v5
  v_max_f32 v4, v4, v5
  v_mul_f32 v4, s64, v4
  v_fma_f32 v112, v112, s64, -v4
  v_fma_f32 v113, v113, s64, -v4
  v_fma_f32 v114, v114, s64, -v4
  v_fma_f32 v115, v115, s64, -v4
  v_fma_f32 v116, v116, s64, -v4
  v_fma_f32 v117, v117, s64, -v4
  v_fma_f32 v118, v118, s64, -v4
  v_fma_f32 v119, v119, s64, -v4
  v_fma_f32 v120, v120, s64, -v4
  v_fma_f32 v121, v121, s64, -v4
  v_fma_f32 v122, v122, s64, -v4
  v_fma_f32 v123, v123, s64, -v4
  v_exp_f32 v112, v112
  v_exp_f32 v113, v113
  v_exp_f32 v114, v114
  v_exp_f32 v115, v115
  v_exp_f32 v116, v116
  v_exp_f32 v117, v117
  v_exp_f32 v118, v118
  v_exp_f32 v119, v119
  v_exp_f32 v120, v120
  v_exp_f32 v121, v121
  v_exp_f32 v122, v122
  v_exp_f32 v123, v123
  v_add_f32 v5, v112, v113
  v_add_f32 v6, v114, v115
  v_add_f32 v7, v116, v117
  v_add_f32 v8, v118, v119
  v_add_f32 v9, v120, v121
  v_add_f32 v10, v122, v123
  v_add_f32 v5, v5, v6
  v_add_f32 v7, v7, v8
  v_add_f32 v9, v9, v10
  v_add_f32 v5, v5, v7
  v_add_f32 v5, v5, v9
  v_mov_b32 v6, v5
  s_nop 1
  v_permlane16_swap_b32 v5, v6
  v_add_f32 v5, v5, v6
  v_mov_b32 v6, v5
  s_nop 1
  v_permlane32_swap_b32 v5, v6
  v_add_f32 v5, v5, v6
  v_rcp_f32 v5, v5
  s_nop 0
  v_mul_f32 v112, v112, v5
  v_mul_f32 v113, v113, v5
  v_mul_f32 v114, v114, v5
  v_mul_f32 v115, v115, v5
  v_mul_f32 v116, v116, v5
  v_mul_f32 v117, v117, v5
  v_mul_f32 v118, v118, v5
  v_mul_f32 v119, v119, v5
  v_mul_f32 v120, v120, v5
  v_mul_f32 v121, v121, v5
  v_mul_f32 v122, v122, v5
  v_mul_f32 v123, v123, v5
  v_cvt_pk_bf16_f32 v8, v112, v113
  v_cvt_pk_bf16_f32 v9, v114, v115
  v_cvt_pk_bf16_f32 v10, v116, v117
  v_cvt_pk_bf16_f32 v11, v118, v119
  v_cvt_pk_bf16_f32 v12, v120, v121
  v_cvt_pk_bf16_f32 v13, v122, v123
  buffer_store_dwordx2 v[10:11], v133, s[8:11], s92 offen
  buffer_store_dwordx2 v[12:13], v133, s[8:11], s92 offen offset:256
  buffer_store_dwordx2 v[8:9], v134, s[8:11], s92 offen
  s_add_u32 s92, s92, 20480
  s_cmp_ge_u32 s51, 63
  s_cbranch_scc1 kaf_x_done
  v_mov_b32 v60, 0
  v_mov_b32 v61, 0
  v_mov_b32 v62, 0
  v_mov_b32 v63, 0
  v_mov_b32 v64, 0
  v_mov_b32 v65, 0
  v_mov_b32 v66, 0
  v_mov_b32 v67, 0
  v_mov_b32 v68, 0
  v_mov_b32 v69, 0
  v_mov_b32 v70, 0
  v_mov_b32 v71, 0
  v_mov_b32 v72, 0
  v_mov_b32 v73, 0
  v_mov_b32 v74, 0
  v_mov_b32 v75, 0
  v_mov_b32 v36, 0
  v_mov_b32 v37, 0
  v_mov_b32 v38, 0
  v_mov_b32 v39, 0
  v_mov_b32 v40, 0
  v_mov_b32 v41, 0
  v_mov_b32 v42, 0
  v_mov_b32 v43, 0
  s_add_u32 s97, s97, 10240
  s_mov_b32 s48, s97
  s_add_u32 s49, s49, 5120
  s_add_u32 s50, s50, 12288
  s_add_u32 s63, s63, 12288
  s_add_u32 s51, s51, 1
  s_cmp_gt_u32 s52, s51
  s_cbranch_scc1 kaf_x_wp_52_ok
  s_mov_b32 s45, 0
kaf_x_wp_52_spin:
  buffer_load_dword v2, v138, s[8:11], 0 offen sc1
  s_add_u32 s45, s45, 1
  s_waitcnt vmcnt(0)
  v_min_u32_dpp v3, v2, v2 quad_perm:[1,0,3,2] row_mask:0xf bank_mask:0xf
  s_nop 1
  v_min_u32_dpp v2, v3, v3 quad_perm:[2,3,0,1] row_mask:0xf bank_mask:0xf
  s_nop 1
  v_min_u32_dpp v3, v2, v2 row_half_mirror row_mask:0xf bank_mask:0xf
  s_nop 1
  v_min_u32_dpp v2, v3, v3 quad_perm:[0,1,2,3] row_mask:0xf bank_mask:0xf
  s_nop 0
  v_readfirstlane_b32 s52, v2
  s_cmp_gt_u32 s52, s51
  s_cbranch_scc1 kaf_x_wp_52_ok
  s_cmp_lt_u32 s45, 400000
  s_cbranch_scc1 kaf_x_wp_52_spin
  s_branch kaf_abort
kaf_x_wp_52_ok:
  s_add_u32 s28, s50, s53
  buffer_load_dwordx2 v[88:89], v132, s[8:11], s28 offen offset:0 sc1
  buffer_load_dwordx2 v[92:93], v132, s[8:11], s28 offen offset:1024 sc1
  s_add_u32 s28, s50, s54
  buffer_load_dwordx2 v[90:91], v132, s[8:11], s28 offen offset:0 sc1
  buffer_load_dwordx2 v[94:95], v132, s[8:11], s28 offen offset:1024 sc1
  s_add_u32 s28, s50, s55
  buffer_load_dwordx2 v[96:97], v132, s[8:11], s28 offen offset:0 sc1
  buffer_load_dwordx2 v[98:99], v132, s[8:11], s28 offen offset:1024 sc1
  s_branch kaf_x_w3l
kaf_x_done:
  s_waitcnt vmcnt(0) lgkmcnt(0)
  s_branch kaf_exit
kaf_y:
  v_and_b32 v1, 63, v0
  v_lshlrev_b32 v178, 4, v1
  s_and_b32 s28, s21, 1
  s_lshl_b32 s46, s23, 1
  s_add_u32 s46, s46, s28
  s_lshr_b32 s28, s21, 1
  s_lshl_b32 s28, s28, 2
  s_lshl_b32 s47, s20, 3
  s_add_u32 s47, s47, s28
  s_mul_i32 s28, s47, 40
  s_add_u32 s28, s28, s46
  s_mul_i32 s28, s28, 20480
  s_add_u32 s28, s28, 0x2e00000
  s_add_u32 s29, s28, 0
  buffer_load_dwordx4 a[0:3], v178, s[8:11], s29 offen
  buffer_load_dwordx4 a[4:7], v178, s[8:11], s29 offen offset:1024
  s_add_u32 s29, s28, 2048
  buffer_load_dwordx4 a[8:11], v178, s[8:11], s29 offen
  buffer_load_dwordx4 a[12:15], v178, s[8:11], s29 offen offset:1024
  s_add_u32 s29, s28, 4096
  buffer_load_dwordx4 a[16:19], v178, s[8:11], s29 offen
  buffer_load_dwordx4 a[20:23], v178, s[8:11], s29 offen offset:1024
  s_add_u32 s29, s28, 6144
  buffer_load_dwordx4 a[24:27], v178, s[8:11], s29 offen
  buffer_load_dwordx4 a[28:31], v178, s[8:11], s29 offen offset:1024
  s_add_u32 s29, s28, 8192
  buffer_load_dwordx4 a[32:35], v178, s[8:11], s29 offen
  buffer_load_dwordx4 a[36:39], v178, s[8:11], s29 offen offset:1024
  s_add_u32 s29, s28, 10240
  buffer_load_dwordx4 a[40:43], v178, s[8:11], s29 offen
  buffer_load_dwordx4 a[44:47], v178, s[8:11], s29 offen offset:1024
  s_add_u32 s29, s28, 12288
  buffer_load_dwordx4 a[48:51], v178, s[8:11], s29 offen
  buffer_load_dwordx4 a[52:55], v178, s[8:11], s29 offen offset:1024
  s_add_u32 s29, s28, 14336
  buffer_load_dwordx4 a[56:59], v178, s[8:11], s29 offen
  buffer_load_dwordx4 a[60:63], v178, s[8:11], s29 offen offset:1024
  s_add_u32 s29, s28, 16384
  buffer_load_dwordx4 a[64:67], v178, s[8:11], s29 offen
  buffer_load_dwordx4 a[68:71], v178, s[8:11], s29 offen offset:1024
  s_add_u32 s29, s28, 18432
  buffer_load_dwordx4 a[72:75], v178, s[8:11], s29 offen
  buffer_load_dwordx4 a[76:79], v178, s[8:11], s29 offen offset:1024
  s_add_u32 s29, s28, 819200
  buffer_load_dwordx4 a[80:83], v178, s[8:11], s29 offen
  buffer_load_dwordx4 a[84:87], v178, s[8:11], s29 offen offset:1024
  s_add_u32 s29, s28, 821248
  buffer_load_dwordx4 a[88:91], v178, s[8:11], s29 offen
  buffer_load_dwordx4 a[92:95], v178, s[8:11], s29 offen offset:1024
  s_add_u32 s29, s28, 823296
  buffer_load_dwordx4 a[96:99], v178, s[8:11], s29 offen
  buffer_load_dwordx4 a[100:103], v178, s[8:11], s29 offen offset:1024
  s_add_u32 s29, s28, 825344
  buffer_load_dwordx4 a[104:107], v178, s[8:11], s29 offen
  buffer_load_dwordx4 a[108:111], v178, s[8:11], s29 offen offset:1024
  s_add_u32 s29, s28, 827392
  buffer_load_dwordx4 a[112:115], v178, s[8:11], s29 offen
  buffer_load_dwordx4 a[116:119], v178, s[8:11], s29 offen offset:1024
  s_add_u32 s29, s28, 829440
  buffer_load_dwordx4 a[120:123], v178, s[8:11], s29 offen
  buffer_load_dwordx4 a[124:127], v178, s[8:11], s29 offen offset:1024
  s_add_u32 s29, s28, 831488
  buffer_load_dwordx4 a[128:131], v178, s[8:11], s29 offen
  buffer_load_dwordx4 a[132:135], v178, s[8:11], s29 offen offset:1024
  s_add_u32 s29, s28, 833536
  buffer_load_dwordx4 a[136:139], v178, s[8:11], s29 offen
  buffer_load_dwordx4 a[140:143], v178, s[8:11], s29 offen offset:1024
  s_add_u32 s29, s28, 835584
  buffer_load_dwordx4 a[144:147], v178, s[8:11], s29 offen
  buffer_load_dwordx4 a[148:151], v178, s[8:11], s29 offen offset:1024
  s_add_u32 s29, s28, 837632
  buffer_load_dwordx4 a[152:155], v178, s[8:11], s29 offen
  buffer_load_dwordx4 a[156:159], v178, s[8:11], s29 offen offset:1024
  s_waitcnt vmcnt(30)
  s_add_u32 s29, s28, 1638400
  buffer_load_dwordx4 a[160:163], v178, s[8:11], s29 offen
  buffer_load_dwordx4 a[164:167], v178, s[8:11], s29 offen offset:1024
  s_add_u32 s29, s28, 1640448
  buffer_load_dwordx4 a[168:171], v178, s[8:11], s29 offen
  buffer_load_dwordx4 a[172:175], v178, s[8:11], s29 offen offset:1024
  s_add_u32 s29, s28, 1642496
  buffer_load_dwordx4 a[176:179], v178, s[8:11], s29 offen
  buffer_load_dwordx4 a[180:183], v178, s[8:11], s29 offen offset:1024
  s_add_u32 s29, s28, 1644544
  buffer_load_dwordx4 a[184:187], v178, s[8:11], s29 offen
  buffer_load_dwordx4 a[188:191], v178, s[8:11], s29 offen offset:1024
  s_add_u32 s29, s28, 1646592
  buffer_load_dwordx4 a[192:195], v178, s[8:11], s29 offen
  buffer_load_dwordx4 a[196:199], v178, s[8:11], s29 offen offset:1024
  s_add_u32 s29, s28, 1648640
  buffer_load_dwordx4 a[200:203], v178, s[8:11], s29 offen
  buffer_load_dwordx4 a[204:207], v178, s[8:11], s29 offen offset:1024
  s_add_u32 s29, s28, 1650688
  buffer_load_dwordx4 a[208:211], v178, s[8:11], s29 offen
  buffer_load_dwordx4 a[212:215], v178, s[8:11], s29 offen offset:1024
  s_add_u32 s29, s28, 1652736
  buffer_load_dwordx4 a[216:219], v178, s[8:11], s29 offen
  buffer_load_dwordx4 a[220:223], v178, s[8:11], s29 offen offset:1024
  s_add_u32 s29, s28, 1654784
  buffer_load_dwordx4 a[224:227], v178, s[8:11], s29 offen
  buffer_load_dwordx4 a[228:231], v178, s[8:11], s29 offen offset:1024
  s_add_u32 s29, s28, 1656832
  buffer_load_dwordx4 a[232:235], v178, s[8:11], s29 offen
  buffer_load_dwordx4 a[236:239], v178, s[8:11], s29 offen offset:1024
  s_waitcnt vmcnt(30)
  s_add_u32 s29, s28, 2457600
  buffer_load_dwordx4 a[240:243], v178, s[8:11], s29 offen
  buffer_load_dwordx4 a[244:247], v178, s[8:11], s29 offen offset:1024
  s_add_u32 s29, s28, 2459648
  buffer_load_dwordx4 a[248:251], v178, s[8:11], s29 offen
  buffer_load_dwordx4 a[252:255], v178, s[8:11], s29 offen offset:1024
  s_add_u32 s29, s28, 2461696
  buffer_load_dwordx4 v[192:195], v178, s[8:11], s29 offen
  buffer_load_dwordx4 v[196:199], v178, s[8:11], s29 offen offset:1024
  s_add_u32 s29, s28, 2463744
  buffer_load_dwordx4 v[200:203], v178, s[8:11], s29 offen
  buffer_load_dwordx4 v[204:207], v178, s[8:11], s29 offen offset:1024
  s_add_u32 s29, s28, 2465792
  buffer_load_dwordx4 v[208:211], v178, s[8:11], s29 offen
  buffer_load_dwordx4 v[212:215], v178, s[8:11], s29 offen offset:1024
  s_add_u32 s29, s28, 2467840
  buffer_load_dwordx4 v[216:219], v178, s[8:11], s29 offen
  buffer_load_dwordx4 v[220:223], v178, s[8:11], s29 offen offset:1024
  s_add_u32 s29, s28, 2469888
  buffer_load_dwordx4 v[224:227], v178, s[8:11], s29 offen
  buffer_load_dwordx4 v[228:231], v178, s[8:11], s29 offen offset:1024
  s_add_u32 s29, s28, 2471936
  buffer_load_dwordx4 v[232:235], v178, s[8:11], s29 offen
  buffer_load_dwordx4 v[236:239], v178, s[8:11], s29 offen offset:1024
  s_add_u32 s29, s28, 2473984
  buffer_load_dwordx4 v[240:243], v178, s[8:11], s29 offen
  buffer_load_dwordx4 v[244:247], v178, s[8:11], s29 offen offset:1024
  s_add_u32 s29, s28, 2476032
  buffer_load_dwordx4 v[248:251], v178, s[8:11], s29 offen
  buffer_load_dwordx4 v[252:255], v178, s[8:11], s29 offen offset:1024
  s_waitcnt vmcnt(30)
  v_mov_b32 v172, 0x44444444
  v_mov_b32 v2, 0xeeeeeeee
  v_and_b32 v3, 8, v1
  v_cmp_ne_u32 vcc, 0, v3
  s_nop 1
  v_cndmask_b32 v172, v172, v2, vcc
  s_lshl_b32 s28, s21, 10
  v_add_u32 v173, s28, v178
  v_add_u32 v174, 4096, v173
  v_add_u32 v175, 8192, v173
  v_add_u32 v176, 0, v173
  v_add_u32 v177, 0, v178
  v_add_u32 v179, 10240, v173
  s_xor_b32 s28, s21, 2
  s_lshl_b32 s28, s28, 10
  s_add_u32 s28, s28, 10240
  v_add_u32 v180, s28, v178
  v_and_b32 v4, 15, v1
  v_lshrrev_b32 v5, 4, v1
  v_and_b32 v6, 7, v1
  v_lshlrev_b32 v7, 3, v5
  v_add_u32 v7, v7, v6
  v_lshlrev_b32 v185, 4, v7
  v_add_u32 v182, 4096, v178
  v_mov_b32 v8, 0x40000000
  v_cmp_gt_u32 vcc, 8, v4
  s_nop 1
  v_cndmask_b32 v184, v8, v185, vcc
  v_lshlrev_b32 v7, 4, v4
  v_lshlrev_b32 v9, 2, v5
  v_add_u32 v7, v7, v9
  v_cndmask_b32 v186, v8, v7, vcc
  s_lshl_b32 s28, s20, 5
  s_add_u32 s28, s28, 3072
  v_lshlrev_b32 v7, 2, v6
  v_add_u32 v187, s28, v7
  v_and_b32 v7, 1, v5
  v_lshlrev_b32 v7, 10, v7
  v_lshrrev_b32 v9, 1, v5
  v_lshlrev_b32 v9, 5, v9
  v_add_u32 v9, v9, v4
  v_lshlrev_b32 v9, 4, v9
  v_add_u32 v189, v7, v9
  v_mov_b32 v44, 0
  v_mov_b32 v45, 0
  v_mov_b32 v46, 0
  v_mov_b32 v47, 0
  v_mov_b32 v48, 0
  v_mov_b32 v49, 0
  v_mov_b32 v50, 0
  v_mov_b32 v51, 0
  v_mov_b32 v52, 0
  v_mov_b32 v53, 0
  v_mov_b32 v54, 0
  v_mov_b32 v55, 0
  v_mov_b32 v56, 0
  v_mov_b32 v57, 0
  v_mov_b32 v58, 0
  v_mov_b32 v59, 0
  s_mul_i32 s97, s20, 655360
  s_add_u32 s97, s97, 0x400000
  s_mov_b32 s48, 0x4000
  s_mul_i32 s49, s20, 327680
  s_add_u32 s49, s49, 0x700000
  s_mul_i32 s50, s20, 327680
  s_lshl_b32 s28, s46, 10
  s_add_u32 s50, s50, s28
  s_add_u32 s50, s50, 0x9000000
  s_mov_b32 s51, 0
  s_mov_b32 s52, 0
  s_mov_b32 s53, 0
  s_and_b32 s29, s21, 1
  s_lshl_b32 s29, s29, 9
  s_lshl_b32 s28, s23, 10
  s_add_u32 s28, s28, s29
  s_add_u32 s28, s28, 0x900000
  s_add_u32 s29, s20, 0
  s_and_b32 s29, s29, 3
  s_mul_i32 s29, s29, 20480
  s_add_u32 s56, s28, s29
  s_add_u32 s29, s20, 1
  s_and_b32 s29, s29, 3
  s_mul_i32 s29, s29, 20480
  s_add_u32 s57, s28, s29
  s_add_u32 s29, s20, 2
  s_and_b32 s29, s29, 3
  s_mul_i32 s29, s29, 20480
  s_add_u32 s58, s28, s29
  s_add_u32 s29, s20, 3
  s_and_b32 s29, s29, 3
  s_mul_i32 s29, s29, 20480
  s_add_u32 s59, s28, s29
  s_lshr_b32 s28, s46, 2
  s_lshl_b32 s28, s28, 10
  s_and_b32 s29, s46, 3
  s_lshl_b32 s29, s29, 8
  s_add_u32 s28, s28, s29
  s_add_u32 s60, s28, s97
  s_add_u32 s60, s60, 10240
  s_waitcnt vmcnt(0)
  s_cmp_ge_u32 s21, 2
  s_cbranch_scc1 kaf_y_tok
kaf_y_crit:
  s_mov_b32 s45, 0
kaf_y_pf_53:
  buffer_load_dwordx4 v[160:163], v173, s[8:11], s48 offen sc1
  buffer_load_dwordx4 v[164:167], v174, s[8:11], s48 offen sc1
  buffer_load_dwordx4 v[168:171], v175, s[8:11], s48 offen sc1
  s_add_u32 s45, s45, 1
  s_waitcnt vmcnt(2)
  ds_write_b128 v176, v[160:163] offset:0
  v_max3_u32 v190, v160, v161, v162
  v_max_u32 v190, v190, v163
  s_waitcnt vmcnt(1)
  ds_write_b128 v176, v[164:167] offset:4096
  v_max3_u32 v190, v190, v164, v165
  v_max3_u32 v190, v190, v166, v167
  s_waitcnt vmcnt(0)
  ds_write_b128 v176, v[168:171] offset:8192
  v_max3_u32 v190, v190, v168, v169
  v_max3_u32 v190, v190, v170, v171
  v_cmp_eq_u32 vcc, -1, v190
  s_cbranch_vccz kaf_y_pf_53_ok
  s_cmp_lt_u32 s45, 400000
  s_cbranch_scc1 kaf_y_pf_53
  s_branch kaf_abort
kaf_y_pf_53_ok:
  s_waitcnt lgkmcnt(0)
  s_barrier
  ds_read_b128 v[4:7], v177 offset:0
  ds_read_b128 v[8:11], v177 offset:1024
  ds_read_b128 v[12:15], v177 offset:2048
  ds_read_b128 v[16:19], v177 offset:3072
  ds_read_b128 v[20:23], v177 offset:4096
  ds_read_b128 v[24:27], v177 offset:5120
  ds_read_b128 v[28:31], v177 offset:6144
  ds_read_b128 v[32:35], v177 offset:7168
  ds_read_b128 v[36:39], v177 offset:8192
  ds_read_b128 v[40:43], v177 offset:9216
  s_cmp_ge_u32 s51, 63
  s_cbranch_scc1 yu_54
  buffer_load_dwordx4 v[100:103], v178, s[8:11], s49 offen offset:0 sc1
  buffer_load_dwordx4 v[104:107], v178, s[8:11], s49 offen offset:1024 sc1
  buffer_load_dwordx4 v[108:111], v178, s[8:11], s49 offen offset:2048 sc1
  buffer_load_dwordx4 v[112:115], v178, s[8:11], s49 offen offset:3072 sc1
  buffer_load_dwordx4 v[116:119], v182, s[8:11], s49 offen sc1
  s_cmp_gt_u32 s52, s51
  s_cbranch_scc1 kaf_y_wp_55_ok
  s_mov_b32 s45, 0
kaf_y_wp_55_spin:
  buffer_load_dword v2, v187, s[8:11], 0 offen sc1
  s_add_u32 s45, s45, 1
  s_waitcnt vmcnt(0)
  v_min_u32_dpp v3, v2, v2 quad_perm:[1,0,3,2] row_mask:0xf bank_mask:0xf
  s_nop 1
  v_min_u32_dpp v2, v3, v3 quad_perm:[2,3,0,1] row_mask:0xf bank_mask:0xf
  s_nop 1
  v_min_u32_dpp v3, v2, v2 row_half_mirror row_mask:0xf bank_mask:0xf
  s_nop 1
  v_min_u32_dpp v2, v3, v3 quad_perm:[0,1,2,3] row_mask:0xf bank_mask:0xf
  s_nop 0
  v_readfirstlane_b32 s52, v2
  s_cmp_gt_u32 s52, s51
  s_cbranch_scc1 kaf_y_wp_55_ok
  s_cmp_lt_u32 s45, 400000
  s_cbranch_scc1 kaf_y_wp_55_spin
  s_branch kaf_abort
kaf_y_wp_55_ok:
  s_add_u32 s28, s50, 0
  buffer_load_dwordx4 v[68:71], v178, s[8:11], s28 offen sc1
  s_add_u32 s28, s50, 40960
  buffer_load_dwordx4 v[72:75], v178, s[8:11], s28 offen sc1
  s_add_u32 s28, s50, 81920
  buffer_load_dwordx4 v[76:79], v178, s[8:11], s28 offen sc1
  s_add_u32 s28, s50, 122880
  buffer_load_dwordx4 v[80:83], v178, s[8:11], s28 offen sc1
  s_add_u32 s28, s50, 163840
  buffer_load_dwordx4 v[84:87], v178, s[8:11], s28 offen sc1
  s_add_u32 s28, s50, 204800
  buffer_load_dwordx4 v[88:91], v178, s[8:11], s28 offen sc1
  s_add_u32 s28, s50, 245760
  buffer_load_dwordx4 v[92:95], v178, s[8:11], s28 offen sc1
  s_add_u32 s28, s50, 286720
  buffer_load_dwordx4 v[96:99], v178, s[8:11], s28 offen sc1
yu_54:
  s_waitcnt lgkmcnt(9)
  v_smfmac_f32_16x16x64_bf16 v[44:47], v[4:7], a[0:7], v172
  v_smfmac_f32_16x16x64_bf16 v[48:51], v[4:7], a[80:87], v172
  v_smfmac_f32_16x16x64_bf16 v[52:55], v[4:7], a[160:167], v172
  v_smfmac_f32_16x16x64_bf16 v[56:59], v[4:7], a[240:247], v172
  s_waitcnt lgkmcnt(8)
  v_smfmac_f32_16x16x64_bf16 v[44:47], v[8:11], a[8:15], v172
  v_smfmac_f32_16x16x64_bf16 v[48:51], v[8:11], a[88:95], v172
  v_smfmac_f32_16x16x64_bf16 v[52:55], v[8:11], a[168:175], v172
  v_smfmac_f32_16x16x64_bf16 v[56:59], v[8:11], a[248:255], v172
  s_waitcnt lgkmcnt(7)
  v_smfmac_f32_16x16x64_bf16 v[44:47], v[12:15], a[16:23], v172
  v_smfmac_f32_16x16x64_bf16 v[48:51], v[12:15], a[96:103], v172
  v_smfmac_f32_16x16x64_bf16 v[52:55], v[12:15], a[176:183], v172
  v_smfmac_f32_16x16x64_bf16 v[56:59], v[12:15], v[192:199], v172
  s_waitcnt lgkmcnt(6)
  v_smfmac_f32_16x16x64_bf16 v[44:47], v[16:19], a[24:31], v172
  v_smfmac_f32_16x16x64_bf16 v[48:51], v[16:19], a[104:111], v172
  v_smfmac_f32_16x16x64_bf16 v[52:55], v[16:19], a[184:191], v172
  v_smfmac_f32_16x16x64_bf16 v[56:59], v[16:19], v[200:207], v172
  s_waitcnt lgkmcnt(5)
  v_smfmac_f32_16x16x64_bf16 v[44:47], v[20:23], a[32:39], v172
  v_smfmac_f32_16x16x64_bf16 v[48:51], v[20:23], a[112:119], v172
  v_smfmac_f32_16x16x64_bf16 v[52:55], v[20:23], a[192:199], v172
  v_smfmac_f32_16x16x64_bf16 v[56:59], v[20:23], v[208:215], v172
  s_waitcnt lgkmcnt(4)
  v_smfmac_f32_16x16x64_bf16 v[44:47], v[24:27], a[40:47], v172
  v_smfmac_f32_16x16x64_bf16 v[48:51], v[24:27], a[120:127], v172
  v_smfmac_f32_16x16x64_bf16 v[52:55], v[24:27], a[200:207], v172
  v_smfmac_f32_16x16x64_bf16 v[56:59], v[24:27], v[216:223], v172
  s_waitcnt lgkmcnt(3)
  v_smfmac_f32_16x16x64_bf16 v[44:47], v[28:31], a[48:55], v172
  v_smfmac_f32_16x16x64_bf16 v[48:51], v[28:31], a[128:135], v172
  v_smfmac_f32_16x16x64_bf16 v[52:55], v[28:31], a[208:215], v172
  v_smfmac_f32_16x16x64_bf16 v[56:59], v[28:31], v[224:231], v172
  s_waitcnt lgkmcnt(2)
  v_smfmac_f32_16x16x64_bf16 v[44:47], v[32:35], a[56:63], v172
  v_smfmac_f32_16x16x64_bf16 v[48:51], v[32:35], a[136:143], v172
  v_smfmac_f32_16x16x64_bf16 v[52:55], v[32:35], a[216:223], v172
  v_smfmac_f32_16x16x64_bf16 v[56:59], v[32:35], v[232:239], v172
  s_waitcnt lgkmcnt(1)
  v_smfmac_f32_16x16x64_bf16 v[44:47], v[36:39], a[64:71], v172
  v_smfmac_f32_16x16x64_bf16 v[48:51], v[36:39], a[144:151], v172
  v_smfmac_f32_16x16x64_bf16 v[52:55], v[36:39], a[224:231], v172
  v_smfmac_f32_16x16x64_bf16 v[56:59], v[36:39], v[240:247], v172
  s_waitcnt lgkmcnt(0)
  v_smfmac_f32_16x16x64_bf16 v[44:47], v[40:43], a[72:79], v172
  v_smfmac_f32_16x16x64_bf16 v[48:51], v[40:43], a[152:159], v172
  v_smfmac_f32_16x16x64_bf16 v[52:55], v[40:43], a[232:239], v172
  v_smfmac_f32_16x16x64_bf16 v[56:59], v[40:43], v[248:255], v172
  s_nop 9
  v_permlane32_swap_b32 v44, v48
  v_permlane32_swap_b32 v45, v49
  v_permlane32_swap_b32 v46, v50
  v_permlane32_swap_b32 v47, v51
  v_permlane32_swap_b32 v52, v56
  v_permlane32_swap_b32 v53, v57
  v_permlane32_swap_b32 v54, v58
  v_permlane32_swap_b32 v55, v59
  v_add_f32 v44, v44, v48
  v_add_f32 v45, v45, v49
  v_add_f32 v46, v46, v50
  v_add_f32 v47, v47, v51
  v_add_f32 v52, v52, v56
  v_add_f32 v53, v53, v57
  v_add_f32 v54, v54, v58
  v_add_f32 v55, v55, v59
  v_cvt_pk_bf16_f32 v60, v44, v45
  v_cvt_pk_bf16_f32 v61, v46, v47
  v_cvt_pk_bf16_f32 v62, v52, v53
  v_cvt_pk_bf16_f32 v63, v54, v55
  ds_write_b128 v179, v[60:63]
  v_mov_b32 v44, 0
  v_mov_b32 v45, 0
  v_mov_b32 v46, 0
  v_mov_b32 v47, 0
  v_mov_b32 v48, 0
  v_mov_b32 v49, 0
  v_mov_b32 v50, 0
  v_mov_b32 v51, 0
  v_mov_b32 v52, 0
  v_mov_b32 v53, 0
  v_mov_b32 v54, 0
  v_mov_b32 v55, 0
  v_mov_b32 v56, 0
  v_mov_b32 v57, 0
  v_mov_b32 v58, 0
  v_mov_b32 v59, 0
  s_waitcnt lgkmcnt(0)
  s_barrier
  ds_read_b128 v[64:67], v180
  s_cmp_ge_u32 s51, 63
  s_cbranch_scc1 kaf_y_crit_end
  s_mov_b32 s45, 0
yp_56:
  buffer_load_dwordx4 v[100:103], v178, s[8:11], s49 offen offset:0 sc1
  buffer_load_dwordx4 v[104:107], v178, s[8:11], s49 offen offset:1024 sc1
  buffer_load_dwordx4 v[108:111], v178, s[8:11], s49 offen offset:2048 sc1
  buffer_load_dwordx4 v[112:115], v178, s[8:11], s49 offen offset:3072 sc1
  buffer_load_dwordx4 v[116:119], v182, s[8:11], s49 offen sc1
  s_add_u32 s45, s45, 1
  s_waitcnt vmcnt(4) lgkmcnt(0)
  v_mfma_f32_16x16x32_bf16 v[140:143], v[68:71], v[100:103], 0
  v_max_u32 v190, v100, v102
  v_mfma_f32_16x16x32_bf16 v[144:147], v[72:75], v[100:103], 0
  s_waitcnt vmcnt(3)
  v_mfma_f32_16x16x32_bf16 v[140:143], v[76:79], v[104:107], v[140:143]
  v_max3_u32 v190, v190, v104, v106
  v_mfma_f32_16x16x32_bf16 v[144:147], v[80:83], v[104:107], v[144:147]
  s_waitcnt vmcnt(2)
  v_mfma_f32_16x16x32_bf16 v[140:143], v[84:87], v[108:111], v[140:143]
  v_max3_u32 v190, v190, v108, v110
  v_mfma_f32_16x16x32_bf16 v[144:147], v[88:91], v[108:111], v[144:147]
  s_waitcnt vmcnt(1)
  v_mfma_f32_16x16x32_bf16 v[140:143], v[92:95], v[112:115], v[140:143]
  v_max3_u32 v190, v190, v112, v114
  v_mfma_f32_16x16x32_bf16 v[144:147], v[96:99], v[112:115], v[144:147]
  s_waitcnt vmcnt(0)
  v_mfma_f32_16x16x32_bf16 v[140:143], v[60:63], v[116:119], v[140:143]
  v_max3_u32 v190, v190, v116, v117
  v_mfma_f32_16x16x32_bf16 v[144:147], v[64:67], v[116:119], v[144:147]
  v_max3_u32 v190, v190, v118, v119
  v_cmp_eq_u32 vcc, -1, v190
  s_cbranch_vccz yp_56_ok
  s_cmp_lt_u32 s45, 400000
  s_cbranch_scc1 yp_56
  s_branch kaf_abort
yp_56_ok:
  s_nop 4
  v_add_f32_dpp v140, v144, v140 row_ror:8 row_mask:0xf bank_mask:0xf
  v_add_f32_dpp v141, v145, v141 row_ror:8 row_mask:0xf bank_mask:0xf
  v_add_f32_dpp v142, v146, v142 row_ror:8 row_mask:0xf bank_mask:0xf
  v_add_f32_dpp v143, v147, v143 row_ror:8 row_mask:0xf bank_mask:0xf
  buffer_store_dwordx4 v[140:143], v184, s[8:11], s56 offen sc1
  s_mov_b32 s45, 0
yc_57:
  buffer_load_dwordx4 v[148:151], v185, s[8:11], s57 offen sc1
  buffer_load_dwordx4 v[152:155], v185, s[8:11], s58 offen sc1
  buffer_load_dwordx4 v[156:159], v185, s[8:11], s59 offen sc1
  s_add_u32 s45, s45, 1
  s_waitcnt vmcnt(0)
  v_max3_u32 v190, v148, v151, v152
  v_max3_u32 v190, v190, v155, v156
  v_max_u32 v190, v190, v159
  v_add_f32 v160, v140, v148
  v_add_f32 v161, v141, v149
  v_add_f32 v162, v142, v150
  v_add_f32 v163, v143, v151
  v_cmp_eq_u32 vcc, -1, v190
  v_add_f32 v152, v152, v156
  v_add_f32 v153, v153, v157
  v_add_f32 v154, v154, v158
  v_add_f32 v155, v155, v159
  s_cbranch_vccz yc_57_ok
  s_cmp_lt_u32 s45, 400000
  s_cbranch_scc1 yc_57
  s_branch kaf_abort
yc_57_ok:
  v_add_f32 v160, v160, v152
  v_add_f32 v161, v161, v153
  v_add_f32 v162, v162, v154
  v_add_f32 v163, v163, v155
  v_cvt_pk_bf16_f32 v164, v160, v161
  v_cvt_pk_bf16_f32 v165, v162, v163
  buffer_store_dword v164, v186, s[8:11], s60 offen
  buffer_store_dword v165, v186, s[8:11], s60 offen offset:128
  s_add_u32 s97, s97, 10240
  s_mov_b32 s48, s97
  s_add_u32 s60, s60, 10240
  s_add_u32 s49, s49, 5120
  s_add_u32 s50, s50, 1310720
  s_add_u32 s56, s56, 81920
  s_add_u32 s57, s57, 81920
  s_add_u32 s58, s58, 81920
  s_add_u32 s59, s59, 81920
  s_add_u32 s51, s51, 1
  s_branch kaf_y_crit
kaf_y_crit_end:
  s_waitcnt vmcnt(0) lgkmcnt(0)
  s_branch kaf_exit
kaf_y_tok:
  s_mul_i32 s61, s20, 1310720
  s_add_u32 s61, s61, 0xe00000
  s_mul_i32 s62, s20, 5242880
  s_lshl_b32 s28, s46, 11
  s_add_u32 s62, s62, s28
  s_add_u32 s62, s62, 0x1a00000
  s_mov_b32 s54, 0
kaf_y_tokl:
  s_mov_b32 s45, 0
kaf_y_pf_58:
  buffer_load_dwordx4 v[160:163], v173, s[8:11], s48 offen sc1
  buffer_load_dwordx4 v[164:167], v174, s[8:11], s48 offen sc1
  s_add_u32 s45, s45, 1
  s_waitcnt vmcnt(1)
  ds_write_b128 v176, v[160:163] offset:0
  v_max3_u32 v190, v160, v161, v162
  v_max_u32 v190, v190, v163
  s_waitcnt vmcnt(0)
  ds_write_b128 v176, v[164:167] offset:4096
  v_max3_u32 v190, v190, v164, v165
  v_max3_u32 v190, v190, v166, v167
  v_cmp_eq_u32 vcc, -1, v190
  s_cbranch_vccz kaf_y_pf_58_ok
  s_cmp_lt_u32 s45, 400000
  s_cbranch_scc1 kaf_y_pf_58
  s_branch kaf_abort
kaf_y_pf_58_ok:
  s_waitcnt lgkmcnt(0)
  s_barrier
  ds_read_b128 v[4:7], v177 offset:0
  ds_read_b128 v[8:11], v177 offset:1024
  ds_read_b128 v[12:15], v177 offset:2048
  ds_read_b128 v[16:19], v177 offset:3072
  ds_read_b128 v[20:23], v177 offset:4096
  ds_read_b128 v[24:27], v177 offset:5120
  ds_read_b128 v[28:31], v177 offset:6144
  ds_read_b128 v[32:35], v177 offset:7168
  ds_read_b128 v[36:39], v177 offset:8192
  ds_read_b128 v[40:43], v177 offset:9216
  s_waitcnt lgkmcnt(9)
  v_smfmac_f32_16x16x64_bf16 v[44:47], v[4:7], a[0:7], v172
  v_smfmac_f32_16x16x64_bf16 v[48:51], v[4:7], a[80:87], v172
  v_smfmac_f32_16x16x64_bf16 v[52:55], v[4:7], a[160:167], v172
  v_smfmac_f32_16x16x64_bf16 v[56:59], v[4:7], a[240:247], v172
  s_waitcnt lgkmcnt(8)
  v_smfmac_f32_16x16x64_bf16 v[44:47], v[8:11], a[8:15], v172
  v_smfmac_f32_16x16x64_bf16 v[48:51], v[8:11], a[88:95], v172
  v_smfmac_f32_16x16x64_bf16 v[52:55], v[8:11], a[168:175], v172
  v_smfmac_f32_16x16x64_bf16 v[56:59], v[8:11], a[248:255], v172
  s_waitcnt lgkmcnt(7)
  v_smfmac_f32_16x16x64_bf16 v[44:47], v[12:15], a[16:23], v172
  v_smfmac_f32_16x16x64_bf16 v[48:51], v[12:15], a[96:103], v172
  v_smfmac_f32_16x16x64_bf16 v[52:55], v[12:15], a[176:183], v172
  v_smfmac_f32_16x16x64_bf16 v[56:59], v[12:15], v[192:199], v172
  s_waitcnt lgkmcnt(6)
  v_smfmac_f32_16x16x64_bf16 v[44:47], v[16:19], a[24:31], v172
  v_smfmac_f32_16x16x64_bf16 v[48:51], v[16:19], a[104:111], v172
  v_smfmac_f32_16x16x64_bf16 v[52:55], v[16:19], a[184:191], v172
  v_smfmac_f32_16x16x64_bf16 v[56:59], v[16:19], v[200:207], v172
  s_waitcnt lgkmcnt(5)
  v_smfmac_f32_16x16x64_bf16 v[44:47], v[20:23], a[32:39], v172
  v_smfmac_f32_16x16x64_bf16 v[48:51], v[20:23], a[112:119], v172
  v_smfmac_f32_16x16x64_bf16 v[52:55], v[20:23], a[192:199], v172
  v_smfmac_f32_16x16x64_bf16 v[56:59], v[20:23], v[208:215], v172
  s_waitcnt lgkmcnt(4)
  v_smfmac_f32_16x16x64_bf16 v[44:47], v[24:27], a[40:47], v172
  v_smfmac_f32_16x16x64_bf16 v[48:51], v[24:27], a[120:127], v172
  v_smfmac_f32_16x16x64_bf16 v[52:55], v[24:27], a[200:207], v172
  v_smfmac_f32_16x16x64_bf16 v[56:59], v[24:27], v[216:223], v172
  s_waitcnt lgkmcnt(3)
  v_smfmac_f32_16x16x64_bf16 v[44:47], v[28:31], a[48:55], v172
  v_smfmac_f32_16x16x64_bf16 v[48:51], v[28:31], a[128:135], v172
  v_smfmac_f32_16x16x64_bf16 v[52:55], v[28:31], a[208:215], v172
  v_smfmac_f32_16x16x64_bf16 v[56:59], v[28:31], v[224:231], v172
  s_waitcnt lgkmcnt(2)
  v_smfmac_f32_16x16x64_bf16 v[44:47], v[32:35], a[56:63], v172
  v_smfmac_f32_16x16x64_bf16 v[48:51], v[32:35], a[136:143], v172
  v_smfmac_f32_16x16x64_bf16 v[52:55], v[32:35], a[216:223], v172
  v_smfmac_f32_16x16x64_bf16 v[56:59], v[32:35], v[232:239], v172
  s_waitcnt lgkmcnt(1)
  v_smfmac_f32_16x16x64_bf16 v[44:47], v[36:39], a[64:71], v172
  v_smfmac_f32_16x16x64_bf16 v[48:51], v[36:39], a[144:151], v172
  v_smfmac_f32_16x16x64_bf16 v[52:55], v[36:39], a[224:231], v172
  v_smfmac_f32_16x16x64_bf16 v[56:59], v[36:39], v[240:247], v172
  s_waitcnt lgkmcnt(0)
  v_smfmac_f32_16x16x64_bf16 v[44:47], v[40:43], a[72:79], v172
  v_smfmac_f32_16x16x64_bf16 v[48:51], v[40:43], a[152:159], v172
  v_smfmac_f32_16x16x64_bf16 v[52:55], v[40:43], a[232:239], v172
  v_smfmac_f32_16x16x64_bf16 v[56:59], v[40:43], v[248:255], v172
  s_nop 9
  v_permlane32_swap_b32 v44, v48
  v_permlane32_swap_b32 v45, v49
  v_permlane32_swap_b32 v46, v50
  v_permlane32_swap_b32 v47, v51
  v_permlane32_swap_b32 v52, v56
  v_permlane32_swap_b32 v53, v57
  v_permlane32_swap_b32 v54, v58
  v_permlane32_swap_b32 v55, v59
  v_add_f32 v44, v44, v48
  v_add_f32 v45, v45, v49
  v_add_f32 v46, v46, v50
  v_add_f32 v47, v47, v51
  v_add_f32 v52, v52, v56
  v_add_f32 v53, v53, v57
  v_add_f32 v54, v54, v58
  v_add_f32 v55, v55, v59
  v_cvt_pk_bf16_f32 v64, v44, v45
  v_cvt_pk_bf16_f32 v65, v46, v47
  v_cvt_pk_bf16_f32 v66, v52, v53
  v_cvt_pk_bf16_f32 v67, v54, v55
  ds_write_b128 v179, v[64:67]
  v_mov_b32 v44, 0
  v_mov_b32 v45, 0
  v_mov_b32 v46, 0
  v_mov_b32 v47, 0
  v_mov_b32 v48, 0
  v_mov_b32 v49, 0
  v_mov_b32 v50, 0
  v_mov_b32 v51, 0
  v_mov_b32 v52, 0
  v_mov_b32 v53, 0
  v_mov_b32 v54, 0
  v_mov_b32 v55, 0
  v_mov_b32 v56, 0
  v_mov_b32 v57, 0
  v_mov_b32 v58, 0
  v_mov_b32 v59, 0
  s_waitcnt lgkmcnt(0)
  s_barrier
  ds_read_b128 v[60:63], v180
  s_cmp_eq_u32 s51, 0
  s_cbranch_scc1 yt_59
  s_cmp_gt_u32 s52, s54
  s_cbranch_scc1 kaf_y_wp_60_ok
  s_mov_b32 s45, 0
kaf_y_wp_60_spin:
  buffer_load_dword v2, v187, s[8:11], 0 offen sc1
  s_add_u32 s45, s45, 1
  s_waitcnt vmcnt(0)
  v_min_u32_dpp v3, v2, v2 quad_perm:[1,0,3,2] row_mask:0xf bank_mask:0xf
  s_nop 1
  v_min_u32_dpp v2, v3, v3 quad_perm:[2,3,0,1] row_mask:0xf bank_mask:0xf
  s_nop 1
  v_min_u32_dpp v3, v2, v2 row_half_mirror row_mask:0xf bank_mask:0xf
  s_nop 1
  v_min_u32_dpp v2, v3, v3 quad_perm:[0,1,2,3] row_mask:0xf bank_mask:0xf
  s_nop 0
  v_readfirstlane_b32 s52, v2
  s_cmp_gt_u32 s52, s54
  s_cbranch_scc1 kaf_y_wp_60_ok
  s_cmp_lt_u32 s45, 400000
  s_cbranch_scc1 kaf_y_wp_60_spin
  s_branch kaf_abort
kaf_y_wp_60_ok:
  s_add_u32 s28, s50, 0
  buffer_load_dwordx4 v[68:71], v178, s[8:11], s28 offen sc1
  s_add_u32 s28, s50, 40960
  buffer_load_dwordx4 v[72:75], v178, s[8:11], s28 offen sc1
  s_add_u32 s28, s50, 81920
  buffer_load_dwordx4 v[76:79], v178, s[8:11], s28 offen sc1
  s_add_u32 s28, s50, 122880
  buffer_load_dwordx4 v[80:83], v178, s[8:11], s28 offen sc1
  s_add_u32 s28, s50, 163840
  buffer_load_dwordx4 v[84:87], v178, s[8:11], s28 offen sc1
  s_add_u32 s28, s50, 204800
  buffer_load_dwordx4 v[88:91], v178, s[8:11], s28 offen sc1
  s_add_u32 s28, s50, 245760
  buffer_load_dwordx4 v[92:95], v178, s[8:11], s28 offen sc1
  s_add_u32 s28, s50, 286720
  buffer_load_dwordx4 v[96:99], v178, s[8:11], s28 offen sc1
  s_mov_b32 s45, 0
ytp_61:
  s_add_u32 s28, s61, 0
  buffer_load_dwordx4 v[100:103], v178, s[8:11], s28 offen sc1
  s_add_u32 s28, s61, 2048
  buffer_load_dwordx4 v[104:107], v178, s[8:11], s28 offen sc1
  s_add_u32 s28, s61, 4096
  buffer_load_dwordx4 v[108:111], v178, s[8:11], s28 offen sc1
  s_add_u32 s28, s61, 6144
  buffer_load_dwordx4 v[112:115], v178, s[8:11], s28 offen sc1
  s_add_u32 s28, s61, 8192
  buffer_load_dwordx4 v[116:119], v178, s[8:11], s28 offen sc1
  s_add_u32 s28, s61, 10240
  buffer_load_dwordx4 v[120:123], v178, s[8:11], s28 offen sc1
  s_add_u32 s28, s61, 12288
  buffer_load_dwordx4 v[124:127], v178, s[8:11], s28 offen sc1
  s_add_u32 s28, s61, 14336
  buffer_load_dwordx4 v[128:131], v178, s[8:11], s28 offen sc1
  s_add_u32 s28, s61, 16384
  buffer_load_dwordx4 v[132:135], v178, s[8:11], s28 offen sc1
  s_add_u32 s28, s61, 18432
  buffer_load_dwordx4 v[136:139], v178, s[8:11], s28 offen sc1
  s_add_u32 s45, s45, 1
  s_waitcnt vmcnt(0)
  v_max_u32 v190, v100, v102
  v_max3_u32 v190, v190, v104, v106
  v_max3_u32 v190, v190, v108, v110
  v_max3_u32 v190, v190, v112, v114
  v_max3_u32 v190, v190, v116, v118
  v_max3_u32 v190, v190, v120, v122
  v_max3_u32 v190, v190, v124, v126
  v_max3_u32 v190, v190, v128, v130
  v_max3_u32 v190, v190, v132, v134
  v_max3_u32 v190, v190, v136, v138
  v_cmp_eq_u32 vcc, -1, v190
  s_cbranch_vccz ytp_61_ok
  s_cmp_lt_u32 s45, 400000
  s_cbranch_scc1 ytp_61
  s_branch kaf_abort
ytp_61_ok:
  v_mfma_f32_16x16x32_bf16 v[140:143], v[68:71], v[100:103], 0
  v_mfma_f32_16x16x32_bf16 v[140:143], v[72:75], v[104:107], v[140:143]
  v_mfma_f32_16x16x32_bf16 v[140:143], v[76:79], v[108:111], v[140:143]
  v_mfma_f32_16x16x32_bf16 v[140:143], v[80:83], v[112:115], v[140:143]
  v_mfma_f32_16x16x32_bf16 v[140:143], v[84:87], v[116:119], v[140:143]
  v_mfma_f32_16x16x32_bf16 v[140:143], v[88:91], v[120:123], v[140:143]
  v_mfma_f32_16x16x32_bf16 v[140:143], v[92:95], v[124:127], v[140:143]
  v_mfma_f32_16x16x32_bf16 v[140:143], v[96:99], v[128:131], v[140:143]
  v_mfma_f32_16x16x32_bf16 v[140:143], v[148:151], v[132:135], v[140:143]
  v_mfma_f32_16x16x32_bf16 v[140:143], v[152:155], v[136:139], v[140:143]
  s_nop 8
  s_add_u32 s28, s62, 0
  buffer_store_dwordx4 v[140:143], v189, s[8:11], s28 offen
  s_nop 1
  s_mov_b32 s45, 0
ytp_62:
  s_add_u32 s28, s61, 1024
  buffer_load_dwordx4 v[100:103], v178, s[8:11], s28 offen sc1
  s_add_u32 s28, s61, 3072
  buffer_load_dwordx4 v[104:107], v178, s[8:11], s28 offen sc1
  s_add_u32 s28, s61, 5120
  buffer_load_dwordx4 v[108:111], v178, s[8:11], s28 offen sc1
  s_add_u32 s28, s61, 7168
  buffer_load_dwordx4 v[112:115], v178, s[8:11], s28 offen sc1
  s_add_u32 s28, s61, 9216
  buffer_load_dwordx4 v[116:119], v178, s[8:11], s28 offen sc1
  s_add_u32 s28, s61, 11264
  buffer_load_dwordx4 v[120:123], v178, s[8:11], s28 offen sc1
  s_add_u32 s28, s61, 13312
  buffer_load_dwordx4 v[124:127], v178, s[8:11], s28 offen sc1
  s_add_u32 s28, s61, 15360
  buffer_load_dwordx4 v[128:131], v178, s[8:11], s28 offen sc1
  s_add_u32 s28, s61, 17408
  buffer_load_dwordx4 v[132:135], v178, s[8:11], s28 offen sc1
  s_add_u32 s28, s61, 19456
  buffer_load_dwordx4 v[136:139], v178, s[8:11], s28 offen sc1
  s_add_u32 s45, s45, 1
  s_waitcnt vmcnt(0)
  v_max_u32 v190, v100, v102
  v_max3_u32 v190, v190, v104, v106
  v_max3_u32 v190, v190, v108, v110
  v_max3_u32 v190, v190, v112, v114
  v_max3_u32 v190, v190, v116, v118
  v_max3_u32 v190, v190, v120, v122
  v_max3_u32 v190, v190, v124, v126
  v_max3_u32 v190, v190, v128, v130
  v_max3_u32 v190, v190, v132, v134
  v_max3_u32 v190, v190, v136, v138
  v_cmp_eq_u32 vcc, -1, v190
  s_cbranch_vccz ytp_62_ok
  s_cmp_lt_u32 s45, 400000
  s_cbranch_scc1 ytp_62
  s_branch kaf_abort
ytp_62_ok:
  v_mfma_f32_16x16x32_bf16 v[140:143], v[68:71], v[100:103], 0
  v_mfma_f32_16x16x32_bf16 v[140:143], v[72:75], v[104:107], v[140:143]
  v_mfma_f32_16x16x32_bf16 v[140:143], v[76:79], v[108:111], v[140:143]
  v_mfma_f32_16x16x32_bf16 v[140:143], v[80:83], v[112:115], v[140:143]
  v_mfma_f32_16x16x32_bf16 v[140:143], v[84:87], v[116:119], v[140:143]
  v_mfma_f32_16x16x32_bf16 v[140:143], v[88:91], v[120:123], v[140:143]
  v_mfma_f32_16x16x32_bf16 v[140:143], v[92:95], v[124:127], v[140:143]
  v_mfma_f32_16x16x32_bf16 v[140:143], v[96:99], v[128:131], v[140:143]
  v_mfma_f32_16x16x32_bf16 v[140:143], v[148:151], v[132:135], v[140:143]
  v_mfma_f32_16x16x32_bf16 v[140:143], v[152:155], v[136:139], v[140:143]
  s_nop 8
  s_add_u32 s28, s62, 256
  buffer_store_dwordx4 v[140:143], v189, s[8:11], s28 offen
  s_nop 1
  s_add_u32 s50, s50, 1310720
  s_add_u32 s61, s61, 20480
  s_add_u32 s62, s62, 81920
  s_add_u32 s54, s54, 1
yt_59:
  s_waitcnt lgkmcnt(0)
  v_mov_b32 v148, v60
  v_mov_b32 v149, v61
  v_mov_b32 v150, v62
  v_mov_b32 v151, v63
  v_mov_b32 v152, v64
  v_mov_b32 v153, v65
  v_mov_b32 v154, v66
  v_mov_b32 v155, v67
  s_add_u32 s97, s97, 10240
  s_mov_b32 s48, s97
  s_add_u32 s51, s51, 1
  s_cmp_lt_u32 s51, 64
  s_cbranch_scc1 kaf_y_tokl
  s_cmp_gt_u32 s52, s54
  s_cbranch_scc1 kaf_y_wp_63_ok
  s_mov_b32 s45, 0
kaf_y_wp_63_spin:
  buffer_load_dword v2, v187, s[8:11], 0 offen sc1
  s_add_u32 s45, s45, 1
  s_waitcnt vmcnt(0)
  v_min_u32_dpp v3, v2, v2 quad_perm:[1,0,3,2] row_mask:0xf bank_mask:0xf
  s_nop 1
  v_min_u32_dpp v2, v3, v3 quad_perm:[2,3,0,1] row_mask:0xf bank_mask:0xf
  s_nop 1
  v_min_u32_dpp v3, v2, v2 row_half_mirror row_mask:0xf bank_mask:0xf
  s_nop 1
  v_min_u32_dpp v2, v3, v3 quad_perm:[0,1,2,3] row_mask:0xf bank_mask:0xf
  s_nop 0
  v_readfirstlane_b32 s52, v2
  s_cmp_gt_u32 s52, s54
  s_cbranch_scc1 kaf_y_wp_63_ok
  s_cmp_lt_u32 s45, 400000
  s_cbranch_scc1 kaf_y_wp_63_spin
  s_branch kaf_abort
kaf_y_wp_63_ok:
  s_add_u32 s28, s50, 0
  buffer_load_dwordx4 v[68:71], v178, s[8:11], s28 offen sc1
  s_add_u32 s28, s50, 40960
  buffer_load_dwordx4 v[72:75], v178, s[8:11], s28 offen sc1
  s_add_u32 s28, s50, 81920
  buffer_load_dwordx4 v[76:79], v178, s[8:11], s28 offen sc1
  s_add_u32 s28, s50, 122880
  buffer_load_dwordx4 v[80:83], v178, s[8:11], s28 offen sc1
  s_add_u32 s28, s50, 163840
  buffer_load_dwordx4 v[84:87], v178, s[8:11], s28 offen sc1
  s_add_u32 s28, s50, 204800
  buffer_load_dwordx4 v[88:91], v178, s[8:11], s28 offen sc1
  s_add_u32 s28, s50, 245760
  buffer_load_dwordx4 v[92:95], v178, s[8:11], s28 offen sc1
  s_add_u32 s28, s50, 286720
  buffer_load_dwordx4 v[96:99], v178, s[8:11], s28 offen sc1
  s_mov_b32 s45, 0
ytp_64:
  s_add_u32 s28, s61, 0
  buffer_load_dwordx4 v[100:103], v178, s[8:11], s28 offen sc1
  s_add_u32 s28, s61, 2048
  buffer_load_dwordx4 v[104:107], v178, s[8:11], s28 offen sc1
  s_add_u32 s28, s61, 4096
  buffer_load_dwordx4 v[108:111], v178, s[8:11], s28 offen sc1
  s_add_u32 s28, s61, 6144
  buffer_load_dwordx4 v[112:115], v178, s[8:11], s28 offen sc1
  s_add_u32 s28, s61, 8192
  buffer_load_dwordx4 v[116:119], v178, s[8:11], s28 offen sc1
  s_add_u32 s28, s61, 10240
  buffer_load_dwordx4 v[120:123], v178, s[8:11], s28 offen sc1
  s_add_u32 s28, s61, 12288
  buffer_load_dwordx4 v[124:127], v178, s[8:11], s28 offen sc1
  s_add_u32 s28, s61, 14336
  buffer_load_dwordx4 v[128:131], v178, s[8:11], s28 offen sc1
  s_add_u32 s28, s61, 16384
  buffer_load_dwordx4 v[132:135], v178, s[8:11], s28 offen sc1
  s_add_u32 s28, s61, 18432
  buffer_load_dwordx4 v[136:139], v178, s[8:11], s28 offen sc1
  s_add_u32 s45, s45, 1
  s_waitcnt vmcnt(0)
  v_max_u32 v190, v100, v102
  v_max3_u32 v190, v190, v104, v106
  v_max3_u32 v190, v190, v108, v110
  v_max3_u32 v190, v190, v112, v114
  v_max3_u32 v190, v190, v116, v118
  v_max3_u32 v190, v190, v120, v122
  v_max3_u32 v190, v190, v124, v126
  v_max3_u32 v190, v190, v128, v130
  v_max3_u32 v190, v190, v132, v134
  v_max3_u32 v190, v190, v136, v138
  v_cmp_eq_u32 vcc, -1, v190
  s_cbranch_vccz ytp_64_ok
  s_cmp_lt_u32 s45, 400000
  s_cbranch_scc1 ytp_64
  s_branch kaf_abort
ytp_64_ok:
  v_mfma_f32_16x16x32_bf16 v[140:143], v[68:71], v[100:103], 0
  v_mfma_f32_16x16x32_bf16 v[140:143], v[72:75], v[104:107], v[140:143]
  v_mfma_f32_16x16x32_bf16 v[140:143], v[76:79], v[108:111], v[140:143]
  v_mfma_f32_16x16x32_bf16 v[140:143], v[80:83], v[112:115], v[140:143]
  v_mfma_f32_16x16x32_bf16 v[140:143], v[84:87], v[116:119], v[140:143]
  v_mfma_f32_16x16x32_bf16 v[140:143], v[88:91], v[120:123], v[140:143]
  v_mfma_f32_16x16x32_bf16 v[140:143], v[92:95], v[124:127], v[140:143]
  v_mfma_f32_16x16x32_bf16 v[140:143], v[96:99], v[128:131], v[140:143]
  v_mfma_f32_16x16x32_bf16 v[140:143], v[148:151], v[132:135], v[140:143]
  v_mfma_f32_16x16x32_bf16 v[140:143], v[152:155], v[136:139], v[140:143]
  s_nop 8
  s_add_u32 s28, s62, 0
  buffer_store_dwordx4 v[140:143], v189, s[8:11], s28 offen
  s_nop 1
  s_mov_b32 s45, 0
ytp_65:
  s_add_u32 s28, s61, 1024
  buffer_load_dwordx4 v[100:103], v178, s[8:11], s28 offen sc1
  s_add_u32 s28, s61, 3072
  buffer_load_dwordx4 v[104:107], v178, s[8:11], s28 offen sc1
  s_add_u32 s28, s61, 5120
  buffer_load_dwordx4 v[108:111], v178, s[8:11], s28 offen sc1
  s_add_u32 s28, s61, 7168
  buffer_load_dwordx4 v[112:115], v178, s[8:11], s28 offen sc1
  s_add_u32 s28, s61, 9216
  buffer_load_dwordx4 v[116:119], v178, s[8:11], s28 offen sc1
  s_add_u32 s28, s61, 11264
  buffer_load_dwordx4 v[120:123], v178, s[8:11], s28 offen sc1
  s_add_u32 s28, s61, 13312
  buffer_load_dwordx4 v[124:127], v178, s[8:11], s28 offen sc1
  s_add_u32 s28, s61, 15360
  buffer_load_dwordx4 v[128:131], v178, s[8:11], s28 offen sc1
  s_add_u32 s28, s61, 17408
  buffer_load_dwordx4 v[132:135], v178, s[8:11], s28 offen sc1
  s_add_u32 s28, s61, 19456
  buffer_load_dwordx4 v[136:139], v178, s[8:11], s28 offen sc1
  s_add_u32 s45, s45, 1
  s_waitcnt vmcnt(0)
  v_max_u32 v190, v100, v102
  v_max3_u32 v190, v190, v104, v106
  v_max3_u32 v190, v190, v108, v110
  v_max3_u32 v190, v190, v112, v114
  v_max3_u32 v190, v190, v116, v118
  v_max3_u32 v190, v190, v120, v122
  v_max3_u32 v190, v190, v124, v126
  v_max3_u32 v190, v190, v128, v130
  v_max3_u32 v190, v190, v132, v134
  v_max3_u32 v190, v190, v136, v138
  v_cmp_eq_u32 vcc, -1, v190
  s_cbranch_vccz ytp_65_ok
  s_cmp_lt_u32 s45, 400000
  s_cbranch_scc1 ytp_65
  s_branch kaf_abort
ytp_65_ok:
  v_mfma_f32_16x16x32_bf16 v[140:143], v[68:71], v[100:103], 0
  v_mfma_f32_16x16x32_bf16 v[140:143], v[72:75], v[104:107], v[140:143]
  v_mfma_f32_16x16x32_bf16 v[140:143], v[76:79], v[108:111], v[140:143]
  v_mfma_f32_16x16x32_bf16 v[140:143], v[80:83], v[112:115], v[140:143]
  v_mfma_f32_16x16x32_bf16 v[140:143], v[84:87], v[116:119], v[140:143]
  v_mfma_f32_16x16x32_bf16 v[140:143], v[88:91], v[120:123], v[140:143]
  v_mfma_f32_16x16x32_bf16 v[140:143], v[92:95], v[124:127], v[140:143]
  v_mfma_f32_16x16x32_bf16 v[140:143], v[96:99], v[128:131], v[140:143]
  v_mfma_f32_16x16x32_bf16 v[140:143], v[148:151], v[132:135], v[140:143]
  v_mfma_f32_16x16x32_bf16 v[140:143], v[152:155], v[136:139], v[140:143]
  s_nop 8
  s_add_u32 s28, s62, 256
  buffer_store_dwordx4 v[140:143], v189, s[8:11], s28 offen
  s_nop 1
  s_add_u32 s50, s50, 1310720
  s_add_u32 s61, s61, 20480
  s_add_u32 s62, s62, 81920
  s_add_u32 s54, s54, 1
  s_waitcnt vmcnt(0)
  s_branch kaf_exit
kaf_abort:
  s_branch ka_abort
kaf_exit:
  s_branch ka_exit
kas_x:
  s_mov_b32 s12, s36
  s_and_b32 s13, s37, 0xffff
  s_mov_b32 s14, 0x780000
  s_mov_b32 s15, 0x20000
  s_mov_b32 s16, s38
  s_and_b32 s17, s39, 0xffff
  s_mov_b32 s18, 0x780000
  s_mov_b32 s19, 0x20000
  v_and_b32 v1, 63, v0
  v_lshrrev_b32 v2, 4, v1
  v_bfe_u32 v3, v1, 3, 1
  v_bfe_u32 v4, v1, 1, 2
  v_and_b32 v5, 1, v1
  s_mul_i32 s46, s23, 384
  s_lshl_b32 s28, s21, 2
  s_add_u32 s28, s28, 0
  v_add_u32 v6, s28, v2
  v_mul_u32_u24 v7, 43, v6
  v_lshrrev_b32 v7, 9, v7
  v_mul_u32_u24 v8, 12, v7
  v_sub_u32 v8, v6, v8
  v_lshrrev_b32 v9, 1, v7
  v_lshlrev_b32 v9, 4, v9
  v_and_b32 v10, 1, v7
  v_lshlrev_b32 v10, 2, v10
  v_add_u32 v9, v9, v10
  v_lshlrev_b32 v10, 3, v3
  v_add_u32 v9, v9, v10
  v_add_u32 v9, v9, v4
  v_mul_u32_u24 v9, 12288, v9
  v_lshrrev_b32 v10, 1, v8
  v_lshlrev_b32 v10, 2, v10
  v_lshlrev_b32 v11, 1, v5
  v_add_u32 v10, v10, v11
  v_and_b32 v11, 1, v8
  v_add_u32 v10, v10, v11
  v_lshlrev_b32 v10, 4, v10
  v_add_u32 v9, v9, v10
  v_add_u32 v136, s46, v9
  s_lshl_b32 s28, s21, 2
  s_add_u32 s28, s28, 16
  v_add_u32 v6, s28, v2
  v_mul_u32_u24 v7, 43, v6
  v_lshrrev_b32 v7, 9, v7
  v_mul_u32_u24 v8, 12, v7
  v_sub_u32 v8, v6, v8
  v_lshrrev_b32 v9, 1, v7
  v_lshlrev_b32 v9, 4, v9
  v_and_b32 v10, 1, v7
  v_lshlrev_b32 v10, 2, v10
  v_add_u32 v9, v9, v10
  v_lshlrev_b32 v10, 3, v3
  v_add_u32 v9, v9, v10
  v_add_u32 v9, v9, v4
  v_mul_u32_u24 v9, 12288, v9
  v_lshrrev_b32 v10, 1, v8
  v_lshlrev_b32 v10, 2, v10
  v_lshlrev_b32 v11, 1, v5
  v_add_u32 v10, v10, v11
  v_and_b32 v11, 1, v8
  v_add_u32 v10, v10, v11
  v_lshlrev_b32 v10, 4, v10
  v_add_u32 v9, v9, v10
  v_add_u32 v137, s46, v9
  s_lshl_b32 s28, s21, 2
  s_add_u32 s28, s28, 32
  v_add_u32 v6, s28, v2
  v_mul_u32_u24 v7, 43, v6
  v_lshrrev_b32 v7, 9, v7
  v_mul_u32_u24 v8, 12, v7
  v_sub_u32 v8, v6, v8
  v_lshrrev_b32 v9, 1, v7
  v_lshlrev_b32 v9, 4, v9
  v_and_b32 v10, 1, v7
  v_lshlrev_b32 v10, 2, v10
  v_add_u32 v9, v9, v10
  v_lshlrev_b32 v10, 3, v3
  v_add_u32 v9, v9, v10
  v_add_u32 v9, v9, v4
  v_mul_u32_u24 v9, 12288, v9
  v_lshrrev_b32 v10, 1, v8
  v_lshlrev_b32 v10, 2, v10
  v_lshlrev_b32 v11, 1, v5
  v_add_u32 v10, v10, v11
  v_and_b32 v11, 1, v8
  v_add_u32 v10, v10, v11
  v_lshlrev_b32 v10, 4, v10
  v_add_u32 v9, v9, v10
  v_add_u32 v138, s46, v9
  s_lshl_b32 s28, s21, 2
  s_add_u32 s28, s28, 48
  v_add_u32 v6, s28, v2
  v_mul_u32_u24 v7, 43, v6
  v_lshrrev_b32 v7, 9, v7
  v_mul_u32_u24 v8, 12, v7
  v_sub_u32 v8, v6, v8
  v_lshrrev_b32 v9, 1, v7
  v_lshlrev_b32 v9, 4, v9
  v_and_b32 v10, 1, v7
  v_lshlrev_b32 v10, 2, v10
  v_add_u32 v9, v9, v10
  v_lshlrev_b32 v10, 3, v3
  v_add_u32 v9, v9, v10
  v_add_u32 v9, v9, v4
  v_mul_u32_u24 v9, 12288, v9
  v_lshrrev_b32 v10, 1, v8
  v_lshlrev_b32 v10, 2, v10
  v_lshlrev_b32 v11, 1, v5
  v_add_u32 v10, v10, v11
  v_and_b32 v11, 1, v8
  v_add_u32 v10, v10, v11
  v_lshlrev_b32 v10, 4, v10
  v_add_u32 v9, v9, v10
  v_add_u32 v139, s46, v9
  s_lshl_b32 s28, s21, 2
  s_add_u32 s28, s28, 64
  v_add_u32 v6, s28, v2
  v_mul_u32_u24 v7, 43, v6
  v_lshrrev_b32 v7, 9, v7
  v_mul_u32_u24 v8, 12, v7
  v_sub_u32 v8, v6, v8
  v_lshrrev_b32 v9, 1, v7
  v_lshlrev_b32 v9, 4, v9
  v_and_b32 v10, 1, v7
  v_lshlrev_b32 v10, 2, v10
  v_add_u32 v9, v9, v10
  v_lshlrev_b32 v10, 3, v3
  v_add_u32 v9, v9, v10
  v_add_u32 v9, v9, v4
  v_mul_u32_u24 v9, 12288, v9
  v_lshrrev_b32 v10, 1, v8
  v_lshlrev_b32 v10, 2, v10
  v_lshlrev_b32 v11, 1, v5
  v_add_u32 v10, v10, v11
  v_and_b32 v11, 1, v8
  v_add_u32 v10, v10, v11
  v_lshlrev_b32 v10, 4, v10
  v_add_u32 v9, v9, v10
  v_add_u32 v140, s46, v9
  s_lshl_b32 s28, s21, 2
  s_add_u32 s28, s28, 80
  v_add_u32 v6, s28, v2
  v_mul_u32_u24 v7, 43, v6
  v_lshrrev_b32 v7, 9, v7
  v_mul_u32_u24 v8, 12, v7
  v_sub_u32 v8, v6, v8
  v_lshrrev_b32 v9, 1, v7
  v_lshlrev_b32 v9, 4, v9
  v_and_b32 v10, 1, v7
  v_lshlrev_b32 v10, 2, v10
  v_add_u32 v9, v9, v10
  v_lshlrev_b32 v10, 3, v3
  v_add_u32 v9, v9, v10
  v_add_u32 v9, v9, v4
  v_mul_u32_u24 v9, 12288, v9
  v_lshrrev_b32 v10, 1, v8
  v_lshlrev_b32 v10, 2, v10
  v_lshlrev_b32 v11, 1, v5
  v_add_u32 v10, v10, v11
  v_and_b32 v11, 1, v8
  v_add_u32 v10, v10, v11
  v_lshlrev_b32 v10, 4, v10
  v_add_u32 v9, v9, v10
  v_add_u32 v141, s46, v9
  v_lshrrev_b32 v6, 1, v2
  v_mul_u32_u24 v142, 6144, v6
  v_and_b32 v6, 1, v2
  v_lshlrev_b32 v6, 7, v6
  v_add_u32 v142, v142, v6
  v_bfe_u32 v6, v1, 2, 2
  v_lshlrev_b32 v6, 5, v6
  v_add_u32 v142, v142, v6
  v_and_b32 v6, 1, v1
  v_lshlrev_b32 v6, 4, v6
  v_add_u32 v142, v142, v6
  v_bfe_u32 v6, v1, 1, 1
  v_lshlrev_b32 v6, 3, v6
  v_add_u32 v142, v142, v6
  s_mul_i32 s28, s21, 768
  v_add_u32 v142, s28, v142
  s_lshl_b32 s29, s21, 10
  s_add_u32 m0, s29, 0
  s_mov_b32 s28, 0
  buffer_load_dwordx4 v136, s[12:15], s28 offen lds
  s_lshl_b32 s29, s21, 10
  s_add_u32 m0, s29, 4096
  s_mov_b32 s28, 0
  buffer_load_dwordx4 v137, s[12:15], s28 offen lds
  s_lshl_b32 s29, s21, 10
  s_add_u32 m0, s29, 8192
  s_mov_b32 s28, 0
  buffer_load_dwordx4 v138, s[12:15], s28 offen lds
  s_lshl_b32 s29, s21, 10
  s_add_u32 m0, s29, 12288
  s_mov_b32 s28, 0
  buffer_load_dwordx4 v139, s[12:15], s28 offen lds
  s_lshl_b32 s29, s21, 10
  s_add_u32 m0, s29, 16384
  s_mov_b32 s28, 0
  buffer_load_dwordx4 v140, s[12:15], s28 offen lds
  s_lshl_b32 s29, s21, 10
  s_add_u32 m0, s29, 20480
  s_mov_b32 s28, 0
  buffer_load_dwordx4 v141, s[12:15], s28 offen lds
  s_lshl_b32 s29, s21, 10
  s_add_u32 m0, s29, 24576
  s_mov_b32 s28, 786432
  buffer_load_dwordx4 v136, s[12:15], s28 offen lds
  s_lshl_b32 s29, s21, 10
  s_add_u32 m0, s29, 28672
  s_mov_b32 s28, 786432
  buffer_load_dwordx4 v137, s[12:15], s28 offen lds
  s_lshl_b32 s29, s21, 10
  s_add_u32 m0, s29, 32768
  s_mov_b32 s28, 786432
  buffer_load_dwordx4 v138, s[12:15], s28 offen lds
  s_lshl_b32 s29, s21, 10
  s_add_u32 m0, s29, 36864
  s_mov_b32 s28, 786432
  buffer_load_dwordx4 v139, s[12:15], s28 offen lds
  s_lshl_b32 s29, s21, 10
  s_add_u32 m0, s29, 40960
  s_mov_b32 s28, 786432
  buffer_load_dwordx4 v140, s[12:15], s28 offen lds
  s_lshl_b32 s29, s21, 10
  s_add_u32 m0, s29, 45056
  s_mov_b32 s28, 786432
  buffer_load_dwordx4 v141, s[12:15], s28 offen lds
  s_lshl_b32 s29, s21, 10
  s_add_u32 m0, s29, 49152
  s_mov_b32 s28, 1572864
  buffer_load_dwordx4 v136, s[12:15], s28 offen lds
  s_lshl_b32 s29, s21, 10
  s_add_u32 m0, s29, 53248
  s_mov_b32 s28, 1572864
  buffer_load_dwordx4 v137, s[12:15], s28 offen lds
  s_lshl_b32 s29, s21, 10
  s_add_u32 m0, s29, 57344
  s_mov_b32 s28, 1572864
  buffer_load_dwordx4 v138, s[12:15], s28 offen lds
  s_lshl_b32 s29, s21, 10
  s_add_u32 m0, s29, 61440
  s_mov_b32 s28, 1572864
  buffer_load_dwordx4 v139, s[12:15], s28 offen lds
  s_lshl_b32 s29, s21, 10
  s_add_u32 m0, s29, 65536
  s_mov_b32 s28, 1572864
  buffer_load_dwordx4 v140, s[12:15], s28 offen lds
  s_lshl_b32 s29, s21, 10
  s_add_u32 m0, s29, 69632
  s_mov_b32 s28, 1572864
  buffer_load_dwordx4 v141, s[12:15], s28 offen lds
  s_lshl_b32 s29, s21, 10
  s_add_u32 m0, s29, 73728
  s_mov_b32 s28, 2359296
  buffer_load_dwordx4 v136, s[12:15], s28 offen lds
  s_lshl_b32 s29, s21, 10
  s_add_u32 m0, s29, 77824
  s_mov_b32 s28, 2359296
  buffer_load_dwordx4 v137, s[12:15], s28 offen lds
  s_lshl_b32 s29, s21, 10
  s_add_u32 m0, s29, 81920
  s_mov_b32 s28, 2359296
  buffer_load_dwordx4 v138, s[12:15], s28 offen lds
  s_lshl_b32 s29, s21, 10
  s_add_u32 m0, s29, 86016
  s_mov_b32 s28, 2359296
  buffer_load_dwordx4 v139, s[12:15], s28 offen lds
  s_lshl_b32 s29, s21, 10
  s_add_u32 m0, s29, 90112
  s_mov_b32 s28, 2359296
  buffer_load_dwordx4 v140, s[12:15], s28 offen lds
  s_lshl_b32 s29, s21, 10
  s_add_u32 m0, s29, 94208
  s_mov_b32 s28, 2359296
  buffer_load_dwordx4 v141, s[12:15], s28 offen lds
  s_lshl_b32 s29, s21, 10
  s_add_u32 m0, s29, 98304
  s_mov_b32 s28, 3145728
  buffer_load_dwordx4 v136, s[12:15], s28 offen lds
  s_lshl_b32 s29, s21, 10
  s_add_u32 m0, s29, 102400
  s_mov_b32 s28, 3145728
  buffer_load_dwordx4 v137, s[12:15], s28 offen lds
  s_lshl_b32 s29, s21, 10
  s_add_u32 m0, s29, 106496
  s_mov_b32 s28, 3145728
  buffer_load_dwordx4 v138, s[12:15], s28 offen lds
  s_lshl_b32 s29, s21, 10
  s_add_u32 m0, s29, 110592
  s_mov_b32 s28, 3145728
  buffer_load_dwordx4 v139, s[12:15], s28 offen lds
  s_lshl_b32 s29, s21, 10
  s_add_u32 m0, s29, 114688
  s_mov_b32 s28, 3145728
  buffer_load_dwordx4 v140, s[12:15], s28 offen lds
  s_lshl_b32 s29, s21, 10
  s_add_u32 m0, s29, 118784
  s_mov_b32 s28, 3145728
  buffer_load_dwordx4 v141, s[12:15], s28 offen lds
  s_waitcnt vmcnt(24)
  s_barrier
  s_lshl_b32 s29, s21, 10
  s_add_u32 m0, s29, 122880
  s_mov_b32 s28, 3932160
  buffer_load_dwordx4 v136, s[12:15], s28 offen lds
  s_lshl_b32 s29, s21, 10
  s_add_u32 m0, s29, 126976
  s_mov_b32 s28, 3932160
  buffer_load_dwordx4 v137, s[12:15], s28 offen lds
  s_lshl_b32 s29, s21, 10
  s_add_u32 m0, s29, 131072
  s_mov_b32 s28, 3932160
  buffer_load_dwordx4 v138, s[12:15], s28 offen lds
  s_lshl_b32 s29, s21, 10
  s_add_u32 m0, s29, 135168
  s_mov_b32 s28, 3932160
  buffer_load_dwordx4 v139, s[12:15], s28 offen lds
  s_lshl_b32 s29, s21, 10
  s_add_u32 m0, s29, 139264
  s_mov_b32 s28, 3932160
  buffer_load_dwordx4 v140, s[12:15], s28 offen lds
  s_lshl_b32 s29, s21, 10
  s_add_u32 m0, s29, 143360
  s_mov_b32 s28, 3932160
  buffer_load_dwordx4 v141, s[12:15], s28 offen lds
  v_add_u32 v143, 0, v142
  ds_read_b64_tr_b16 a[0:1], v143 offset:0
  ds_read_b64_tr_b16 a[2:3], v143 offset:3072
  ds_read_b64_tr_b16 a[4:5], v143 offset:12288
  ds_read_b64_tr_b16 a[6:7], v143 offset:15360
  ds_read_b64_tr_b16 a[80:81], v143 offset:256
  ds_read_b64_tr_b16 a[82:83], v143 offset:3328
  ds_read_b64_tr_b16 a[84:85], v143 offset:12544
  ds_read_b64_tr_b16 a[86:87], v143 offset:15616
  ds_read_b64_tr_b16 a[160:161], v143 offset:512
  ds_read_b64_tr_b16 a[162:163], v143 offset:3584
  ds_read_b64_tr_b16 a[164:165], v143 offset:12800
  ds_read_b64_tr_b16 a[166:167], v143 offset:15872
  s_waitcnt lgkmcnt(0)
  s_waitcnt vmcnt(24)
  s_barrier
  s_lshl_b32 s29, s21, 10
  s_add_u32 m0, s29, 0
  s_mov_b32 s28, 4718592
  buffer_load_dwordx4 v136, s[12:15], s28 offen lds
  s_lshl_b32 s29, s21, 10
  s_add_u32 m0, s29, 4096
  s_mov_b32 s28, 4718592
  buffer_load_dwordx4 v137, s[12:15], s28 offen lds
  s_lshl_b32 s29, s21, 10
  s_add_u32 m0, s29, 8192
  s_mov_b32 s28, 4718592
  buffer_load_dwordx4 v138, s[12:15], s28 offen lds
  s_lshl_b32 s29, s21, 10
  s_add_u32 m0, s29, 12288
  s_mov_b32 s28, 4718592
  buffer_load_dwordx4 v139, s[12:15], s28 offen lds
  s_lshl_b32 s29, s21, 10
  s_add_u32 m0, s29, 16384
  s_mov_b32 s28, 4718592
  buffer_load_dwordx4 v140, s[12:15], s28 offen lds
  s_lshl_b32 s29, s21, 10
  s_add_u32 m0, s29, 20480
  s_mov_b32 s28, 4718592
  buffer_load_dwordx4 v141, s[12:15], s28 offen lds
  v_add_u32 v143, 24576, v142
  ds_read_b64_tr_b16 a[8:9], v143 offset:0
  ds_read_b64_tr_b16 a[10:11], v143 offset:3072
  ds_read_b64_tr_b16 a[12:13], v143 offset:12288
  ds_read_b64_tr_b16 a[14:15], v143 offset:15360
  ds_read_b64_tr_b16 a[88:89], v143 offset:256
  ds_read_b64_tr_b16 a[90:91], v143 offset:3328
  ds_read_b64_tr_b16 a[92:93], v143 offset:12544
  ds_read_b64_tr_b16 a[94:95], v143 offset:15616
  ds_read_b64_tr_b16 a[168:169], v143 offset:512
  ds_read_b64_tr_b16 a[170:171], v143 offset:3584
  ds_read_b64_tr_b16 a[172:173], v143 offset:12800
  ds_read_b64_tr_b16 a[174:175], v143 offset:15872
  s_waitcnt lgkmcnt(0)
  s_waitcnt vmcnt(24)
  s_barrier
  s_lshl_b32 s29, s21, 10
  s_add_u32 m0, s29, 24576
  s_mov_b32 s28, 5505024
  buffer_load_dwordx4 v136, s[12:15], s28 offen lds
  s_lshl_b32 s29, s21, 10
  s_add_u32 m0, s29, 28672
  s_mov_b32 s28, 5505024
  buffer_load_dwordx4 v137, s[12:15], s28 offen lds
  s_lshl_b32 s29, s21, 10
  s_add_u32 m0, s29, 32768
  s_mov_b32 s28, 5505024
  buffer_load_dwordx4 v138, s[12:15], s28 offen lds
  s_lshl_b32 s29, s21, 10
  s_add_u32 m0, s29, 36864
  s_mov_b32 s28, 5505024
  buffer_load_dwordx4 v139, s[12:15], s28 offen lds
  s_lshl_b32 s29, s21, 10
  s_add_u32 m0, s29, 40960
  s_mov_b32 s28, 5505024
  buffer_load_dwordx4 v140, s[12:15], s28 offen lds
  s_lshl_b32 s29, s21, 10
  s_add_u32 m0, s29, 45056
  s_mov_b32 s28, 5505024
  buffer_load_dwordx4 v141, s[12:15], s28 offen lds
  v_add_u32 v143, 49152, v142
  ds_read_b64_tr_b16 a[16:17], v143 offset:0
  ds_read_b64_tr_b16 a[18:19], v143 offset:3072
  ds_read_b64_tr_b16 a[20:21], v143 offset:12288
  ds_read_b64_tr_b16 a[22:23], v143 offset:15360
  ds_read_b64_tr_b16 a[96:97], v143 offset:256
  ds_read_b64_tr_b16 a[98:99], v143 offset:3328
  ds_read_b64_tr_b16 a[100:101], v143 offset:12544
  ds_read_b64_tr_b16 a[102:103], v143 offset:15616
  ds_read_b64_tr_b16 a[176:177], v143 offset:512
  ds_read_b64_tr_b16 a[178:179], v143 offset:3584
  ds_read_b64_tr_b16 a[180:181], v143 offset:12800
  ds_read_b64_tr_b16 a[182:183], v143 offset:15872
  s_waitcnt lgkmcnt(0)
  s_waitcnt vmcnt(24)
  s_barrier
  s_lshl_b32 s29, s21, 10
  s_add_u32 m0, s29, 49152
  s_mov_b32 s28, 6291456
  buffer_load_dwordx4 v136, s[12:15], s28 offen lds
  s_lshl_b32 s29, s21, 10
  s_add_u32 m0, s29, 53248
  s_mov_b32 s28, 6291456
  buffer_load_dwordx4 v137, s[12:15], s28 offen lds
  s_lshl_b32 s29, s21, 10
  s_add_u32 m0, s29, 57344
  s_mov_b32 s28, 6291456
  buffer_load_dwordx4 v138, s[12:15], s28 offen lds
  s_lshl_b32 s29, s21, 10
  s_add_u32 m0, s29, 61440
  s_mov_b32 s28, 6291456
  buffer_load_dwordx4 v139, s[12:15], s28 offen lds
  s_lshl_b32 s29, s21, 10
  s_add_u32 m0, s29, 65536
  s_mov_b32 s28, 6291456
  buffer_load_dwordx4 v140, s[12:15], s28 offen lds
  s_lshl_b32 s29, s21, 10
  s_add_u32 m0, s29, 69632
  s_mov_b32 s28, 6291456
  buffer_load_dwordx4 v141, s[12:15], s28 offen lds
  v_add_u32 v143, 73728, v142
  ds_read_b64_tr_b16 a[24:25], v143 offset:0
  ds_read_b64_tr_b16 a[26:27], v143 offset:3072
  ds_read_b64_tr_b16 a[28:29], v143 offset:12288
  ds_read_b64_tr_b16 a[30:31], v143 offset:15360
  ds_read_b64_tr_b16 a[104:105], v143 offset:256
  ds_read_b64_tr_b16 a[106:107], v143 offset:3328
  ds_read_b64_tr_b16 a[108:109], v143 offset:12544
  ds_read_b64_tr_b16 a[110:111], v143 offset:15616
  ds_read_b64_tr_b16 a[184:185], v143 offset:512
  ds_read_b64_tr_b16 a[186:187], v143 offset:3584
  ds_read_b64_tr_b16 a[188:189], v143 offset:12800
  ds_read_b64_tr_b16 a[190:191], v143 offset:15872
  s_waitcnt lgkmcnt(0)
  s_waitcnt vmcnt(24)
  s_barrier
  s_lshl_b32 s29, s21, 10
  s_add_u32 m0, s29, 73728
  s_mov_b32 s28, 7077888
  buffer_load_dwordx4 v136, s[12:15], s28 offen lds
  s_lshl_b32 s29, s21, 10
  s_add_u32 m0, s29, 77824
  s_mov_b32 s28, 7077888
  buffer_load_dwordx4 v137, s[12:15], s28 offen lds
  s_lshl_b32 s29, s21, 10
  s_add_u32 m0, s29, 81920
  s_mov_b32 s28, 7077888
  buffer_load_dwordx4 v138, s[12:15], s28 offen lds
  s_lshl_b32 s29, s21, 10
  s_add_u32 m0, s29, 86016
  s_mov_b32 s28, 7077888
  buffer_load_dwordx4 v139, s[12:15], s28 offen lds
  s_lshl_b32 s29, s21, 10
  s_add_u32 m0, s29, 90112
  s_mov_b32 s28, 7077888
  buffer_load_dwordx4 v140, s[12:15], s28 offen lds
  s_lshl_b32 s29, s21, 10
  s_add_u32 m0, s29, 94208
  s_mov_b32 s28, 7077888
  buffer_load_dwordx4 v141, s[12:15], s28 offen lds
  v_add_u32 v143, 98304, v142
  ds_read_b64_tr_b16 a[32:33], v143 offset:0
  ds_read_b64_tr_b16 a[34:35], v143 offset:3072
  ds_read_b64_tr_b16 a[36:37], v143 offset:12288
  ds_read_b64_tr_b16 a[38:39], v143 offset:15360
  ds_read_b64_tr_b16 a[112:113], v143 offset:256
  ds_read_b64_tr_b16 a[114:115], v143 offset:3328
  ds_read_b64_tr_b16 a[116:117], v143 offset:12544
  ds_read_b64_tr_b16 a[118:119], v143 offset:15616
  ds_read_b64_tr_b16 a[192:193], v143 offset:512
  ds_read_b64_tr_b16 a[194:195], v143 offset:3584
  ds_read_b64_tr_b16 a[196:197], v143 offset:12800
  ds_read_b64_tr_b16 a[198:199], v143 offset:15872
  s_waitcnt lgkmcnt(0)
  s_waitcnt vmcnt(24)
  s_barrier
  s_lshl_b32 s29, s21, 10
  s_add_u32 m0, s29, 98304
  s_mov_b32 s28, 0
  buffer_load_dwordx4 v136, s[16:19], s28 offen lds
  s_lshl_b32 s29, s21, 10
  s_add_u32 m0, s29, 102400
  s_mov_b32 s28, 0
  buffer_load_dwordx4 v137, s[16:19], s28 offen lds
  s_lshl_b32 s29, s21, 10
  s_add_u32 m0, s29, 106496
  s_mov_b32 s28, 0
  buffer_load_dwordx4 v138, s[16:19], s28 offen lds
  s_lshl_b32 s29, s21, 10
  s_add_u32 m0, s29, 110592
  s_mov_b32 s28, 0
  buffer_load_dwordx4 v139, s[16:19], s28 offen lds
  s_lshl_b32 s29, s21, 10
  s_add_u32 m0, s29, 114688
  s_mov_b32 s28, 0
  buffer_load_dwordx4 v140, s[16:19], s28 offen lds
  s_lshl_b32 s29, s21, 10
  s_add_u32 m0, s29, 118784
  s_mov_b32 s28, 0
  buffer_load_dwordx4 v141, s[16:19], s28 offen lds
  v_add_u32 v143, 122880, v142
  ds_read_b64_tr_b16 a[40:41], v143 offset:0
  ds_read_b64_tr_b16 a[42:43], v143 offset:3072
  ds_read_b64_tr_b16 a[44:45], v143 offset:12288
  ds_read_b64_tr_b16 a[46:47], v143 offset:15360
  ds_read_b64_tr_b16 a[120:121], v143 offset:256
  ds_read_b64_tr_b16 a[122:123], v143 offset:3328
  ds_read_b64_tr_b16 a[124:125], v143 offset:12544
  ds_read_b64_tr_b16 a[126:127], v143 offset:15616
  ds_read_b64_tr_b16 a[200:201], v143 offset:512
  ds_read_b64_tr_b16 a[202:203], v143 offset:3584
  ds_read_b64_tr_b16 a[204:205], v143 offset:12800
  ds_read_b64_tr_b16 a[206:207], v143 offset:15872
  s_waitcnt lgkmcnt(0)
  s_waitcnt vmcnt(24)
  s_barrier
  s_lshl_b32 s29, s21, 10
  s_add_u32 m0, s29, 122880
  s_mov_b32 s28, 1572864
  buffer_load_dwordx4 v136, s[16:19], s28 offen lds
  s_lshl_b32 s29, s21, 10
  s_add_u32 m0, s29, 126976
  s_mov_b32 s28, 1572864
  buffer_load_dwordx4 v137, s[16:19], s28 offen lds
  s_lshl_b32 s29, s21, 10
  s_add_u32 m0, s29, 131072
  s_mov_b32 s28, 1572864
  buffer_load_dwordx4 v138, s[16:19], s28 offen lds
  s_lshl_b32 s29, s21, 10
  s_add_u32 m0, s29, 135168
  s_mov_b32 s28, 1572864
  buffer_load_dwordx4 v139, s[16:19], s28 offen lds
  s_lshl_b32 s29, s21, 10
  s_add_u32 m0, s29, 139264
  s_mov_b32 s28, 1572864
  buffer_load_dwordx4 v140, s[16:19], s28 offen lds
  s_lshl_b32 s29, s21, 10
  s_add_u32 m0, s29, 143360
  s_mov_b32 s28, 1572864
  buffer_load_dwordx4 v141, s[16:19], s28 offen lds
  v_add_u32 v143, 0, v142
  ds_read_b64_tr_b16 a[48:49], v143 offset:0
  ds_read_b64_tr_b16 a[50:51], v143 offset:3072
  ds_read_b64_tr_b16 a[52:53], v143 offset:12288
  ds_read_b64_tr_b16 a[54:55], v143 offset:15360
  ds_read_b64_tr_b16 a[128:129], v143 offset:256
  ds_read_b64_tr_b16 a[130:131], v143 offset:3328
  ds_read_b64_tr_b16 a[132:133], v143 offset:12544
  ds_read_b64_tr_b16 a[134:135], v143 offset:15616
  ds_read_b64_tr_b16 a[208:209], v143 offset:512
  ds_read_b64_tr_b16 a[210:211], v143 offset:3584
  ds_read_b64_tr_b16 a[212:213], v143 offset:12800
  ds_read_b64_tr_b16 a[214:215], v143 offset:15872
  s_waitcnt lgkmcnt(0)
  s_waitcnt vmcnt(24)
  s_barrier
  s_lshl_b32 s29, s21, 10
  s_add_u32 m0, s29, 0
  s_mov_b32 s28, 3145728
  buffer_load_dwordx4 v136, s[16:19], s28 offen lds
  s_lshl_b32 s29, s21, 10
  s_add_u32 m0, s29, 4096
  s_mov_b32 s28, 3145728
  buffer_load_dwordx4 v137, s[16:19], s28 offen lds
  s_lshl_b32 s29, s21, 10
  s_add_u32 m0, s29, 8192
  s_mov_b32 s28, 3145728
  buffer_load_dwordx4 v138, s[16:19], s28 offen lds
  s_lshl_b32 s29, s21, 10
  s_add_u32 m0, s29, 12288
  s_mov_b32 s28, 3145728
  buffer_load_dwordx4 v139, s[16:19], s28 offen lds
  s_lshl_b32 s29, s21, 10
  s_add_u32 m0, s29, 16384
  s_mov_b32 s28, 3145728
  buffer_load_dwordx4 v140, s[16:19], s28 offen lds
  s_lshl_b32 s29, s21, 10
  s_add_u32 m0, s29, 20480
  s_mov_b32 s28, 3145728
  buffer_load_dwordx4 v141, s[16:19], s28 offen lds
  v_add_u32 v143, 24576, v142
  ds_read_b64_tr_b16 a[56:57], v143 offset:0
  ds_read_b64_tr_b16 a[58:59], v143 offset:3072
  ds_read_b64_tr_b16 a[60:61], v143 offset:12288
  ds_read_b64_tr_b16 a[62:63], v143 offset:15360
  ds_read_b64_tr_b16 a[136:137], v143 offset:256
  ds_read_b64_tr_b16 a[138:139], v143 offset:3328
  ds_read_b64_tr_b16 a[140:141], v143 offset:12544
  ds_read_b64_tr_b16 a[142:143], v143 offset:15616
  ds_read_b64_tr_b16 a[216:217], v143 offset:512
  ds_read_b64_tr_b16 a[218:219], v143 offset:3584
  ds_read_b64_tr_b16 a[220:221], v143 offset:12800
  ds_read_b64_tr_b16 a[222:223], v143 offset:15872
  s_waitcnt lgkmcnt(0)
  s_waitcnt vmcnt(24)
  s_barrier
  s_lshl_b32 s29, s21, 10
  s_add_u32 m0, s29, 24576
  s_mov_b32 s28, 4718592
  buffer_load_dwordx4 v136, s[16:19], s28 offen lds
  s_lshl_b32 s29, s21, 10
  s_add_u32 m0, s29, 28672
  s_mov_b32 s28, 4718592
  buffer_load_dwordx4 v137, s[16:19], s28 offen lds
  s_lshl_b32 s29, s21, 10
  s_add_u32 m0, s29, 32768
  s_mov_b32 s28, 4718592
  buffer_load_dwordx4 v138, s[16:19], s28 offen lds
  s_lshl_b32 s29, s21, 10
  s_add_u32 m0, s29, 36864
  s_mov_b32 s28, 4718592
  buffer_load_dwordx4 v139, s[16:19], s28 offen lds
  s_lshl_b32 s29, s21, 10
  s_add_u32 m0, s29, 40960
  s_mov_b32 s28, 4718592
  buffer_load_dwordx4 v140, s[16:19], s28 offen lds
  s_lshl_b32 s29, s21, 10
  s_add_u32 m0, s29, 45056
  s_mov_b32 s28, 4718592
  buffer_load_dwordx4 v141, s[16:19], s28 offen lds
  v_add_u32 v143, 49152, v142
  ds_read_b64_tr_b16 a[64:65], v143 offset:0
  ds_read_b64_tr_b16 a[66:67], v143 offset:3072
  ds_read_b64_tr_b16 a[68:69], v143 offset:12288
  ds_read_b64_tr_b16 a[70:71], v143 offset:15360
  ds_read_b64_tr_b16 a[144:145], v143 offset:256
  ds_read_b64_tr_b16 a[146:147], v143 offset:3328
  ds_read_b64_tr_b16 a[148:149], v143 offset:12544
  ds_read_b64_tr_b16 a[150:151], v143 offset:15616
  ds_read_b64_tr_b16 a[224:225], v143 offset:512
  ds_read_b64_tr_b16 a[226:227], v143 offset:3584
  ds_read_b64_tr_b16 a[228:229], v143 offset:12800
  ds_read_b64_tr_b16 a[230:231], v143 offset:15872
  s_waitcnt lgkmcnt(0)
  s_waitcnt vmcnt(24)
  s_barrier
  s_lshl_b32 s29, s21, 10
  s_add_u32 m0, s29, 49152
  s_mov_b32 s28, 6291456
  buffer_load_dwordx4 v136, s[16:19], s28 offen lds
  s_lshl_b32 s29, s21, 10
  s_add_u32 m0, s29, 53248
  s_mov_b32 s28, 6291456
  buffer_load_dwordx4 v137, s[16:19], s28 offen lds
  s_lshl_b32 s29, s21, 10
  s_add_u32 m0, s29, 57344
  s_mov_b32 s28, 6291456
  buffer_load_dwordx4 v138, s[16:19], s28 offen lds
  s_lshl_b32 s29, s21, 10
  s_add_u32 m0, s29, 61440
  s_mov_b32 s28, 6291456
  buffer_load_dwordx4 v139, s[16:19], s28 offen lds
  s_lshl_b32 s29, s21, 10
  s_add_u32 m0, s29, 65536
  s_mov_b32 s28, 6291456
  buffer_load_dwordx4 v140, s[16:19], s28 offen lds
  s_lshl_b32 s29, s21, 10
  s_add_u32 m0, s29, 69632
  s_mov_b32 s28, 6291456
  buffer_load_dwordx4 v141, s[16:19], s28 offen lds
  v_add_u32 v143, 73728, v142
  ds_read_b64_tr_b16 a[72:73], v143 offset:0
  ds_read_b64_tr_b16 a[74:75], v143 offset:3072
  ds_read_b64_tr_b16 a[76:77], v143 offset:12288
  ds_read_b64_tr_b16 a[78:79], v143 offset:15360
  ds_read_b64_tr_b16 a[152:153], v143 offset:256
  ds_read_b64_tr_b16 a[154:155], v143 offset:3328
  ds_read_b64_tr_b16 a[156:157], v143 offset:12544
  ds_read_b64_tr_b16 a[158:159], v143 offset:15616
  ds_read_b64_tr_b16 a[232:233], v143 offset:512
  ds_read_b64_tr_b16 a[234:235], v143 offset:3584
  ds_read_b64_tr_b16 a[236:237], v143 offset:12800
  ds_read_b64_tr_b16 a[238:239], v143 offset:15872
  s_waitcnt lgkmcnt(0)
  s_waitcnt vmcnt(24)
  s_barrier
  s_lshl_b32 s29, s21, 10
  s_add_u32 m0, s29, 73728
  s_mov_b32 s28, 786432
  buffer_load_dwordx4 v136, s[16:19], s28 offen lds
  s_lshl_b32 s29, s21, 10
  s_add_u32 m0, s29, 77824
  s_mov_b32 s28, 786432
  buffer_load_dwordx4 v137, s[16:19], s28 offen lds
  s_lshl_b32 s29, s21, 10
  s_add_u32 m0, s29, 81920
  s_mov_b32 s28, 786432
  buffer_load_dwordx4 v138, s[16:19], s28 offen lds
  s_lshl_b32 s29, s21, 10
  s_add_u32 m0, s29, 86016
  s_mov_b32 s28, 786432
  buffer_load_dwordx4 v139, s[16:19], s28 offen lds
  s_lshl_b32 s29, s21, 10
  s_add_u32 m0, s29, 90112
  s_mov_b32 s28, 786432
  buffer_load_dwordx4 v140, s[16:19], s28 offen lds
  s_lshl_b32 s29, s21, 10
  s_add_u32 m0, s29, 94208
  s_mov_b32 s28, 786432
  buffer_load_dwordx4 v141, s[16:19], s28 offen lds
  v_add_u32 v143, 98304, v142
  ds_read_b64_tr_b16 a[240:241], v143 offset:0
  ds_read_b64_tr_b16 a[242:243], v143 offset:3072
  ds_read_b64_tr_b16 a[244:245], v143 offset:12288
  ds_read_b64_tr_b16 a[246:247], v143 offset:15360
  ds_read_b64_tr_b16 v[176:177], v143 offset:256
  ds_read_b64_tr_b16 v[178:179], v143 offset:3328
  ds_read_b64_tr_b16 v[180:181], v143 offset:12544
  ds_read_b64_tr_b16 v[182:183], v143 offset:15616
  ds_read_b64_tr_b16 v[216:217], v143 offset:512
  ds_read_b64_tr_b16 v[218:219], v143 offset:3584
  ds_read_b64_tr_b16 v[220:221], v143 offset:12800
  ds_read_b64_tr_b16 v[222:223], v143 offset:15872
  s_waitcnt lgkmcnt(0)
  s_waitcnt vmcnt(24)
  s_barrier
  s_lshl_b32 s29, s21, 10
  s_add_u32 m0, s29, 98304
  s_mov_b32 s28, 2359296
  buffer_load_dwordx4 v136, s[16:19], s28 offen lds
  s_lshl_b32 s29, s21, 10
  s_add_u32 m0, s29, 102400
  s_mov_b32 s28, 2359296
  buffer_load_dwordx4 v137, s[16:19], s28 offen lds
  s_lshl_b32 s29, s21, 10
  s_add_u32 m0, s29, 106496
  s_mov_b32 s28, 2359296
  buffer_load_dwordx4 v138, s[16:19], s28 offen lds
  s_lshl_b32 s29, s21, 10
  s_add_u32 m0, s29, 110592
  s_mov_b32 s28, 2359296
  buffer_load_dwordx4 v139, s[16:19], s28 offen lds
  s_lshl_b32 s29, s21, 10
  s_add_u32 m0, s29, 114688
  s_mov_b32 s28, 2359296
  buffer_load_dwordx4 v140, s[16:19], s28 offen lds
  s_lshl_b32 s29, s21, 10
  s_add_u32 m0, s29, 118784
  s_mov_b32 s28, 2359296
  buffer_load_dwordx4 v141, s[16:19], s28 offen lds
  v_add_u32 v143, 122880, v142
  ds_read_b64_tr_b16 a[248:249], v143 offset:0
  ds_read_b64_tr_b16 a[250:251], v143 offset:3072
  ds_read_b64_tr_b16 a[252:253], v143 offset:12288
  ds_read_b64_tr_b16 a[254:255], v143 offset:15360
  ds_read_b64_tr_b16 v[184:185], v143 offset:256
  ds_read_b64_tr_b16 v[186:187], v143 offset:3328
  ds_read_b64_tr_b16 v[188:189], v143 offset:12544
  ds_read_b64_tr_b16 v[190:191], v143 offset:15616
  ds_read_b64_tr_b16 v[224:225], v143 offset:512
  ds_read_b64_tr_b16 v[226:227], v143 offset:3584
  ds_read_b64_tr_b16 v[228:229], v143 offset:12800
  ds_read_b64_tr_b16 v[230:231], v143 offset:15872
  s_waitcnt lgkmcnt(0)
  s_waitcnt vmcnt(24)
  s_barrier
  s_lshl_b32 s29, s21, 10
  s_add_u32 m0, s29, 122880
  s_mov_b32 s28, 3932160
  buffer_load_dwordx4 v136, s[16:19], s28 offen lds
  s_lshl_b32 s29, s21, 10
  s_add_u32 m0, s29, 126976
  s_mov_b32 s28, 3932160
  buffer_load_dwordx4 v137, s[16:19], s28 offen lds
  s_lshl_b32 s29, s21, 10
  s_add_u32 m0, s29, 131072
  s_mov_b32 s28, 3932160
  buffer_load_dwordx4 v138, s[16:19], s28 offen lds
  s_lshl_b32 s29, s21, 10
  s_add_u32 m0, s29, 135168
  s_mov_b32 s28, 3932160
  buffer_load_dwordx4 v139, s[16:19], s28 offen lds
  s_lshl_b32 s29, s21, 10
  s_add_u32 m0, s29, 139264
  s_mov_b32 s28, 3932160
  buffer_load_dwordx4 v140, s[16:19], s28 offen lds
  s_lshl_b32 s29, s21, 10
  s_add_u32 m0, s29, 143360
  s_mov_b32 s28, 3932160
  buffer_load_dwordx4 v141, s[16:19], s28 offen lds
  v_add_u32 v143, 0, v142
  ds_read_b64_tr_b16 v[152:153], v143 offset:0
  ds_read_b64_tr_b16 v[154:155], v143 offset:3072
  ds_read_b64_tr_b16 v[156:157], v143 offset:12288
  ds_read_b64_tr_b16 v[158:159], v143 offset:15360
  ds_read_b64_tr_b16 v[192:193], v143 offset:256
  ds_read_b64_tr_b16 v[194:195], v143 offset:3328
  ds_read_b64_tr_b16 v[196:197], v143 offset:12544
  ds_read_b64_tr_b16 v[198:199], v143 offset:15616
  ds_read_b64_tr_b16 v[232:233], v143 offset:512
  ds_read_b64_tr_b16 v[234:235], v143 offset:3584
  ds_read_b64_tr_b16 v[236:237], v143 offset:12800
  ds_read_b64_tr_b16 v[238:239], v143 offset:15872
  s_waitcnt lgkmcnt(0)
  s_waitcnt vmcnt(24)
  s_barrier
  s_lshl_b32 s29, s21, 10
  s_add_u32 m0, s29, 0
  s_mov_b32 s28, 5505024
  buffer_load_dwordx4 v136, s[16:19], s28 offen lds
  s_lshl_b32 s29, s21, 10
  s_add_u32 m0, s29, 4096
  s_mov_b32 s28, 5505024
  buffer_load_dwordx4 v137, s[16:19], s28 offen lds
  s_lshl_b32 s29, s21, 10
  s_add_u32 m0, s29, 8192
  s_mov_b32 s28, 5505024
  buffer_load_dwordx4 v138, s[16:19], s28 offen lds
  s_lshl_b32 s29, s21, 10
  s_add_u32 m0, s29, 12288
  s_mov_b32 s28, 5505024
  buffer_load_dwordx4 v139, s[16:19], s28 offen lds
  s_lshl_b32 s29, s21, 10
  s_add_u32 m0, s29, 16384
  s_mov_b32 s28, 5505024
  buffer_load_dwordx4 v140, s[16:19], s28 offen lds
  s_lshl_b32 s29, s21, 10
  s_add_u32 m0, s29, 20480
  s_mov_b32 s28, 5505024
  buffer_load_dwordx4 v141, s[16:19], s28 offen lds
  v_add_u32 v143, 24576, v142
  ds_read_b64_tr_b16 v[160:161], v143 offset:0
  ds_read_b64_tr_b16 v[162:163], v143 offset:3072
  ds_read_b64_tr_b16 v[164:165], v143 offset:12288
  ds_read_b64_tr_b16 v[166:167], v143 offset:15360
  ds_read_b64_tr_b16 v[200:201], v143 offset:256
  ds_read_b64_tr_b16 v[202:203], v143 offset:3328
  ds_read_b64_tr_b16 v[204:205], v143 offset:12544
  ds_read_b64_tr_b16 v[206:207], v143 offset:15616
  ds_read_b64_tr_b16 v[240:241], v143 offset:512
  ds_read_b64_tr_b16 v[242:243], v143 offset:3584
  ds_read_b64_tr_b16 v[244:245], v143 offset:12800
  ds_read_b64_tr_b16 v[246:247], v143 offset:15872
  s_waitcnt lgkmcnt(0)
  s_waitcnt vmcnt(24)
  s_barrier
  s_lshl_b32 s29, s21, 10
  s_add_u32 m0, s29, 24576
  s_mov_b32 s28, 7077888
  buffer_load_dwordx4 v136, s[16:19], s28 offen lds
  s_lshl_b32 s29, s21, 10
  s_add_u32 m0, s29, 28672
  s_mov_b32 s28, 7077888
  buffer_load_dwordx4 v137, s[16:19], s28 offen lds
  s_lshl_b32 s29, s21, 10
  s_add_u32 m0, s29, 32768
  s_mov_b32 s28, 7077888
  buffer_load_dwordx4 v138, s[16:19], s28 offen lds
  s_lshl_b32 s29, s21, 10
  s_add_u32 m0, s29, 36864
  s_mov_b32 s28, 7077888
  buffer_load_dwordx4 v139, s[16:19], s28 offen lds
  s_lshl_b32 s29, s21, 10
  s_add_u32 m0, s29, 40960
  s_mov_b32 s28, 7077888
  buffer_load_dwordx4 v140, s[16:19], s28 offen lds
  s_lshl_b32 s29, s21, 10
  s_add_u32 m0, s29, 45056
  s_mov_b32 s28, 7077888
  buffer_load_dwordx4 v141, s[16:19], s28 offen lds
  v_add_u32 v143, 49152, v142
  ds_read_b64_tr_b16 v[168:169], v143 offset:0
  ds_read_b64_tr_b16 v[170:171], v143 offset:3072
  ds_read_b64_tr_b16 v[172:173], v143 offset:12288
  ds_read_b64_tr_b16 v[174:175], v143 offset:15360
  ds_read_b64_tr_b16 v[208:209], v143 offset:256
  ds_read_b64_tr_b16 v[210:211], v143 offset:3328
  ds_read_b64_tr_b16 v[212:213], v143 offset:12544
  ds_read_b64_tr_b16 v[214:215], v143 offset:15616
  ds_read_b64_tr_b16 v[248:249], v143 offset:512
  ds_read_b64_tr_b16 v[250:251], v143 offset:3584
  ds_read_b64_tr_b16 v[252:253], v143 offset:12800
  ds_read_b64_tr_b16 v[254:255], v143 offset:15872
  s_waitcnt lgkmcnt(0)
  s_waitcnt vmcnt(24)
  s_barrier
  v_add_u32 v143, 73728, v142
  ds_read_b64_tr_b16 v[16:17], v143 offset:0
  ds_read_b64_tr_b16 v[18:19], v143 offset:3072
  ds_read_b64_tr_b16 v[20:21], v143 offset:12288
  ds_read_b64_tr_b16 v[22:23], v143 offset:15360
  ds_read_b64_tr_b16 v[24:25], v143 offset:256
  ds_read_b64_tr_b16 v[26:27], v143 offset:3328
  ds_read_b64_tr_b16 v[28:29], v143 offset:12544
  ds_read_b64_tr_b16 v[30:31], v143 offset:15616
  ds_read_b64_tr_b16 v[32:33], v143 offset:512
  ds_read_b64_tr_b16 v[34:35], v143 offset:3584
  ds_read_b64_tr_b16 v[36:37], v143 offset:12800
  ds_read_b64_tr_b16 v[38:39], v143 offset:15872
  s_waitcnt lgkmcnt(0)
  s_waitcnt vmcnt(18)
  s_barrier
  v_add_u32 v143, 98304, v142
  ds_read_b64_tr_b16 v[40:41], v143 offset:0
  ds_read_b64_tr_b16 v[42:43], v143 offset:3072
  ds_read_b64_tr_b16 v[44:45], v143 offset:12288
  ds_read_b64_tr_b16 v[46:47], v143 offset:15360
  ds_read_b64_tr_b16 v[48:49], v143 offset:256
  ds_read_b64_tr_b16 v[50:51], v143 offset:3328
  ds_read_b64_tr_b16 v[52:53], v143 offset:12544
  ds_read_b64_tr_b16 v[54:55], v143 offset:15616
  ds_read_b64_tr_b16 v[56:57], v143 offset:512
  ds_read_b64_tr_b16 v[58:59], v143 offset:3584
  ds_read_b64_tr_b16 v[60:61], v143 offset:12800
  ds_read_b64_tr_b16 v[62:63], v143 offset:15872
  s_waitcnt lgkmcnt(0)
  s_waitcnt vmcnt(12)
  s_barrier
  v_add_u32 v143, 122880, v142
  ds_read_b64_tr_b16 v[64:65], v143 offset:0
  ds_read_b64_tr_b16 v[66:67], v143 offset:3072
  ds_read_b64_tr_b16 v[68:69], v143 offset:12288
  ds_read_b64_tr_b16 v[70:71], v143 offset:15360
  ds_read_b64_tr_b16 v[72:73], v143 offset:256
  ds_read_b64_tr_b16 v[74:75], v143 offset:3328
  ds_read_b64_tr_b16 v[76:77], v143 offset:12544
  ds_read_b64_tr_b16 v[78:79], v143 offset:15616
  ds_read_b64_tr_b16 v[80:81], v143 offset:512
  ds_read_b64_tr_b16 v[82:83], v143 offset:3584
  ds_read_b64_tr_b16 v[84:85], v143 offset:12800
  ds_read_b64_tr_b16 v[86:87], v143 offset:15872
  s_waitcnt lgkmcnt(0)
  s_waitcnt vmcnt(6)
  s_barrier
  v_add_u32 v143, 0, v142
  ds_read_b64_tr_b16 v[88:89], v143 offset:0
  ds_read_b64_tr_b16 v[90:91], v143 offset:3072
  ds_read_b64_tr_b16 v[92:93], v143 offset:12288
  ds_read_b64_tr_b16 v[94:95], v143 offset:15360
  ds_read_b64_tr_b16 v[96:97], v143 offset:256
  ds_read_b64_tr_b16 v[98:99], v143 offset:3328
  ds_read_b64_tr_b16 v[100:101], v143 offset:12544
  ds_read_b64_tr_b16 v[102:103], v143 offset:15616
  ds_read_b64_tr_b16 v[104:105], v143 offset:512
  ds_read_b64_tr_b16 v[106:107], v143 offset:3584
  ds_read_b64_tr_b16 v[108:109], v143 offset:12800
  ds_read_b64_tr_b16 v[110:111], v143 offset:15872
  s_waitcnt lgkmcnt(0)
  s_waitcnt vmcnt(0)
  s_barrier
  v_add_u32 v143, 24576, v142
  ds_read_b64_tr_b16 v[112:113], v143 offset:0
  ds_read_b64_tr_b16 v[114:115], v143 offset:3072
  ds_read_b64_tr_b16 v[116:117], v143 offset:12288
  ds_read_b64_tr_b16 v[118:119], v143 offset:15360
  ds_read_b64_tr_b16 v[120:121], v143 offset:256
  ds_read_b64_tr_b16 v[122:123], v143 offset:3328
  ds_read_b64_tr_b16 v[124:125], v143 offset:12544
  ds_read_b64_tr_b16 v[126:127], v143 offset:15616
  ds_read_b64_tr_b16 v[128:129], v143 offset:512
  ds_read_b64_tr_b16 v[130:131], v143 offset:3584
  ds_read_b64_tr_b16 v[132:133], v143 offset:12800
  ds_read_b64_tr_b16 v[134:135], v143 offset:15872
  s_waitcnt lgkmcnt(0)
  s_barrier
  v_lshlrev_b32 v2, 4, v1
  s_mul_i32 s28, s21, 30720
  v_add_u32 v143, s28, v2
  ds_write_b128 v143, v[16:19] offset:0
  ds_write_b128 v143, v[20:23] offset:1024
  ds_write_b128 v143, v[24:27] offset:10240
  ds_write_b128 v143, v[28:31] offset:11264
  ds_write_b128 v143, v[32:35] offset:20480
  ds_write_b128 v143, v[36:39] offset:21504
  ds_write_b128 v143, v[40:43] offset:2048
  ds_write_b128 v143, v[44:47] offset:3072
  ds_write_b128 v143, v[48:51] offset:12288
  ds_write_b128 v143, v[52:55] offset:13312
  ds_write_b128 v143, v[56:59] offset:22528
  ds_write_b128 v143, v[60:63] offset:23552
  ds_write_b128 v143, v[64:67] offset:4096
  ds_write_b128 v143, v[68:71] offset:5120
  ds_write_b128 v143, v[72:75] offset:14336
  ds_write_b128 v143, v[76:79] offset:15360
  ds_write_b128 v143, v[80:83] offset:24576
  ds_write_b128 v143, v[84:87] offset:25600
  ds_write_b128 v143, v[88:91] offset:6144
  ds_write_b128 v143, v[92:95] offset:7168
  ds_write_b128 v143, v[96:99] offset:16384
  ds_write_b128 v143, v[100:103] offset:17408
  ds_write_b128 v143, v[104:107] offset:26624
  ds_write_b128 v143, v[108:111] offset:27648
  ds_write_b128 v143, v[112:115] offset:8192
  ds_write_b128 v143, v[116:119] offset:9216
  ds_write_b128 v143, v[120:123] offset:18432
  ds_write_b128 v143, v[124:127] offset:19456
  ds_write_b128 v143, v[128:131] offset:28672
  ds_write_b128 v143, v[132:135] offset:29696
  s_waitcnt lgkmcnt(0)
  v_and_b32 v1, 63, v0
  v_lshlrev_b32 v132, 4, v1
  s_mul_i32 s28, s21, 30720
  v_add_u32 v129, s28, v132
  s_lshl_b32 s28, s21, 10
  v_add_u32 v124, s28, v132
  v_add_u32 v125, 4096, v124
  v_add_u32 v126, 8192, v124
  v_add_u32 v127, 122880, v124
  v_add_u32 v128, 122880, v132
  s_mul_i32 s28, s21, 3072
  s_add_u32 s28, s28, 133120
  v_add_u32 v130, s28, v132
  s_mul_i32 s28, s21, 1536
  s_add_u32 s28, s28, 145408
  v_lshlrev_b32 v2, 3, v1
  v_add_u32 v131, s28, v2
  v_mov_b32 v110, 0x44444444
  v_mov_b32 v2, 0xeeeeeeee
  v_and_b32 v3, 8, v1
  v_cmp_ne_u32 vcc, 0, v3
  s_nop 1
  v_cndmask_b32 v110, v110, v2, vcc
  v_and_b32 v4, 15, v1
  v_lshrrev_b32 v5, 4, v1
  v_lshlrev_b32 v6, 2, v5
  v_sub_u32 v6, v4, v6
  v_mov_b32 v7, 0x3f80
  v_mov_b32 v8, 0x3f800000
  v_mov_b32 v108, 0
  v_mov_b32 v109, 0
  v_cmp_eq_u32 vcc, 0, v6
  s_nop 1
  v_cndmask_b32 v108, v108, v7, vcc
  v_cmp_eq_u32 vcc, 1, v6
  s_nop 1
  v_cndmask_b32 v108, v108, v8, vcc
  v_cmp_eq_u32 vcc, 2, v6
  s_nop 1
  v_cndmask_b32 v109, v109, v7, vcc
  v_cmp_eq_u32 vcc, 3, v6
  s_nop 1
  v_cndmask_b32 v109, v109, v8, vcc
  s_mul_i32 s28, s23, 6
  s_lshr_b32 s29, s28, 3
  s_add_u32 s28, s28, 5
  s_lshr_b32 s28, s28, 3
  v_mov_b32 v6, s29
  v_mov_b32 v7, s28
  v_and_b32 v8, 1, v1
  v_cmp_eq_u32 vcc, 1, v8
  s_nop 1
  v_cndmask_b32 v6, v6, v7, vcc
  v_lshlrev_b32 v6, 2, v6
  v_bfe_u32 v8, v1, 1, 1
  v_lshlrev_b32 v8, 10, v8
  v_add_u32 v6, v6, v8
  v_add_u32 v138, 0, v6
  s_mul_i32 s97, s20, 655360
  s_add_u32 s97, s97, 0x400000
  s_mov_b32 s48, 0x4000
  s_mul_i32 s49, s20, 327680
  s_add_u32 s49, s49, 0x700000
  s_mul_i32 s50, s23, 786432
  s_add_u32 s63, s50, 0x4800000
  s_add_u32 s50, s50, 0x6000000
  s_mov_b32 s51, 0
  s_mov_b32 s52, 0
  s_mul_i32 s28, s21, 3
  s_add_u32 s28, s28, 0
  s_lshr_b32 s29, s28, 1
  s_lshl_b32 s29, s29, 11
  s_and_b32 s28, s28, 1
  s_lshl_b32 s28, s28, 3
  s_add_u32 s53, s29, s28
  s_mul_i32 s28, s21, 3
  s_add_u32 s28, s28, 1
  s_lshr_b32 s29, s28, 1
  s_lshl_b32 s29, s29, 11
  s_and_b32 s28, s28, 1
  s_lshl_b32 s28, s28, 3
  s_add_u32 s54, s29, s28
  s_mul_i32 s28, s21, 3
  s_add_u32 s28, s28, 2
  s_lshr_b32 s29, s28, 1
  s_lshl_b32 s29, s29, 11
  s_and_b32 s28, s28, 1
  s_lshl_b32 s28, s28, 3
  s_add_u32 s55, s29, s28
  v_mov_b32 v60, 0
  v_mov_b32 v61, 0
  v_mov_b32 v62, 0
  v_mov_b32 v63, 0
  v_mov_b32 v64, 0
  v_mov_b32 v65, 0
  v_mov_b32 v66, 0
  v_mov_b32 v67, 0
  v_mov_b32 v68, 0
  v_mov_b32 v69, 0
  v_mov_b32 v70, 0
  v_mov_b32 v71, 0
  v_mov_b32 v72, 0
  v_mov_b32 v73, 0
  v_mov_b32 v74, 0
  v_mov_b32 v75, 0
  v_mov_b32 v36, 0
  v_mov_b32 v37, 0
  v_mov_b32 v38, 0
  v_mov_b32 v39, 0
  v_mov_b32 v40, 0
  v_mov_b32 v41, 0
  v_mov_b32 v42, 0
  v_mov_b32 v43, 0
  s_barrier
  s_cmp_gt_u32 s52, s51
  s_cbranch_scc1 kas_x_wp_66_ok
  s_mov_b32 s45, 0
kas_x_wp_66_spin:
  buffer_load_dword v2, v138, s[8:11], 0 offen sc1
  s_add_u32 s45, s45, 1
  s_waitcnt vmcnt(0)
  v_min_u32_dpp v3, v2, v2 quad_perm:[1,0,3,2] row_mask:0xf bank_mask:0xf
  s_nop 1
  v_min_u32_dpp v2, v3, v3 quad_perm:[2,3,0,1] row_mask:0xf bank_mask:0xf
  s_nop 1
  v_min_u32_dpp v3, v2, v2 row_half_mirror row_mask:0xf bank_mask:0xf
  s_nop 1
  v_min_u32_dpp v2, v3, v3 quad_perm:[0,1,2,3] row_mask:0xf bank_mask:0xf
  s_nop 0
  v_readfirstlane_b32 s52, v2
  s_cmp_gt_u32 s52, s51
  s_cbranch_scc1 kas_x_wp_66_ok
  s_cmp_lt_u32 s45, 400000
  s_cbranch_scc1 kas_x_wp_66_spin
  s_branch kas_abort
kas_x_wp_66_ok:
  s_add_u32 s28, s50, s53
  buffer_load_dwordx2 v[88:89], v132, s[8:11], s28 offen offset:0 sc1
  buffer_load_dwordx2 v[92:93], v132, s[8:11], s28 offen offset:1024 sc1
  s_add_u32 s28, s50, s54
  buffer_load_dwordx2 v[90:91], v132, s[8:11], s28 offen offset:0 sc1
  buffer_load_dwordx2 v[94:95], v132, s[8:11], s28 offen offset:1024 sc1
  s_add_u32 s28, s50, s55
  buffer_load_dwordx2 v[96:97], v132, s[8:11], s28 offen offset:0 sc1
  buffer_load_dwordx2 v[98:99], v132, s[8:11], s28 offen offset:1024 sc1
  s_cmp_eq_u32 s21, 0
  s_cbranch_scc1 kas_x_w0
  s_cmp_eq_u32 s21, 1
  s_cbranch_scc1 kas_x_w1
  s_branch kas_x_w23
kas_x_w0:
  v_lshrrev_b32 v4, 3, v1
  v_and_b32 v5, 7, v1
  v_lshrrev_b32 v6, 2, v5
  v_and_b32 v7, 3, v5
  v_lshlrev_b32 v8, 10, v6
  v_lshlrev_b32 v9, 4, v7
  v_add_u32 v9, v9, v4
  v_lshlrev_b32 v9, 4, v9
  v_add_u32 v8, v8, v9
  v_add_u32 v133, 134144, v8
  v_add_u32 v8, 2, v6
  v_lshlrev_b32 v8, 4, v8
  v_add_u32 v8, v8, v4
  v_lshlrev_b32 v8, 4, v8
  v_lshlrev_b32 v9, 2, v7
  v_add_u32 v8, v8, v9
  v_add_u32 v134, 133120, v8
  s_and_b32 s26, s23, 7
  v_and_b32 v8, 1, v7
  v_lshlrev_b32 v8, 1, v8
  v_add_u32 v8, v8, v6
  v_lshlrev_b32 v8, 4, v8
  v_add_u32 v8, v8, v4
  v_lshlrev_b32 v8, 4, v8
  v_lshrrev_b32 v9, 1, v7
  v_lshlrev_b32 v9, 3, v9
  v_add_u32 v8, v8, v9
  s_lshr_b32 s28, s26, 1
  s_lshl_b32 s28, s28, 10
  s_and_b32 s29, s26, 1
  s_lshl_b32 s29, s29, 7
  s_add_u32 s28, s28, s29
  v_add_u32 v135, s28, v8
  v_lshlrev_b32 v8, 4, v6
  v_add_u32 v8, v8, v4
  v_lshlrev_b32 v8, 4, v8
  v_lshlrev_b32 v9, 1, v7
  v_add_u32 v8, v8, v9
  s_lshr_b32 s28, s26, 2
  s_lshl_b32 s28, s28, 7
  s_and_b32 s29, s26, 1
  s_lshl_b32 s29, s29, 9
  s_add_u32 s28, s28, s29
  s_bfe_u32 s29, s26, 0x10001
  s_lshl_b32 s29, s29, 3
  s_add_u32 s28, s28, s29
  s_add_u32 s28, s28, 4096
  v_add_u32 v8, s28, v8
  v_mov_b32 v9, 0x40000000
  v_and_b32 v10, 1, v5
  v_cmp_eq_u32 vcc, 0, v10
  s_nop 1
  v_cndmask_b32 v136, v9, v8, vcc
  s_mov_b32 s64, 0x3dd53b95
  s_mov_b32 s65, 0x3dd53b95
kas_x_w0l:
  ds_read_b128 v[44:47], v129 offset:0
  ds_read_b128 v[48:51], v129 offset:1024
  ds_read_b128 v[52:55], v129 offset:2048
  ds_read_b128 v[56:59], v129 offset:3072
  s_waitcnt lgkmcnt(0)
  s_mov_b32 s45, 0
kas_x_pf_67:
  buffer_load_dwordx4 v[112:115], v124, s[8:11], s48 offen sc1
  buffer_load_dwordx4 v[116:119], v125, s[8:11], s48 offen sc1
  buffer_load_dwordx4 v[120:123], v126, s[8:11], s48 offen sc1
  s_add_u32 s45, s45, 1
  s_waitcnt vmcnt(2)
  ds_write_b128 v127, v[112:115] offset:0
  v_max3_u32 v139, v112, v113, v114
  v_max_u32 v139, v139, v115
  s_waitcnt vmcnt(1)
  ds_write_b128 v127, v[116:119] offset:4096
  v_max3_u32 v139, v139, v116, v117
  v_max3_u32 v139, v139, v118, v119
  s_waitcnt vmcnt(0)
  ds_write_b128 v127, v[120:123] offset:8192
  v_max3_u32 v139, v139, v120, v121
  v_max3_u32 v139, v139, v122, v123
  v_cmp_eq_u32 vcc, -1, v139
  s_cbranch_vccz kas_x_pf_67_ok
  s_cmp_lt_u32 s45, 400000
  s_cbranch_scc1 kas_x_pf_67
  s_branch kas_abort
kas_x_pf_67_ok:
  v_smfmac_f32_16x16x64_bf16 v[60:63], v[112:115], a[0:7], v110
  v_smfmac_f32_16x16x64_bf16 v[64:67], v[112:115], a[240:247], v110
  v_smfmac_f32_16x16x64_bf16 v[68:71], v[112:115], a[80:87], v110
  v_smfmac_f32_16x16x64_bf16 v[72:75], v[112:115], v[176:183], v110
  s_waitcnt lgkmcnt(0)
  s_barrier
  v_smfmac_f32_16x16x64_bf16 v[36:39], v[112:115], a[160:167], v110
  ds_read_b128 v[4:7], v128 offset:1024
  v_smfmac_f32_16x16x64_bf16 v[40:43], v[112:115], v[216:223], v110
  ds_read_b128 v[8:11], v128 offset:2048
  v_smfmac_f32_16x16x64_bf16 v[60:63], v[116:119], a[32:39], v110
  ds_read_b128 v[12:15], v128 offset:3072
  v_smfmac_f32_16x16x64_bf16 v[64:67], v[116:119], v[152:159], v110
  ds_read_b128 v[16:19], v128 offset:5120
  v_smfmac_f32_16x16x64_bf16 v[68:71], v[116:119], a[112:119], v110
  ds_read_b128 v[20:23], v128 offset:6144
  v_smfmac_f32_16x16x64_bf16 v[72:75], v[116:119], v[192:199], v110
  ds_read_b128 v[24:27], v128 offset:7168
  v_smfmac_f32_16x16x64_bf16 v[36:39], v[116:119], a[192:199], v110
  ds_read_b128 v[28:31], v128 offset:9216
  v_smfmac_f32_16x16x64_bf16 v[40:43], v[116:119], v[232:239], v110
  v_smfmac_f32_16x16x64_bf16 v[60:63], v[120:123], a[64:71], v110
  v_smfmac_f32_16x16x64_bf16 v[64:67], v[120:123], v[168:175], v110
  v_smfmac_f32_16x16x64_bf16 v[68:71], v[120:123], a[144:151], v110
  v_smfmac_f32_16x16x64_bf16 v[72:75], v[120:123], v[208:215], v110
  v_smfmac_f32_16x16x64_bf16 v[36:39], v[120:123], a[224:231], v110
  v_smfmac_f32_16x16x64_bf16 v[40:43], v[120:123], v[248:255], v110
  s_waitcnt lgkmcnt(6)
  v_smfmac_f32_16x16x64_bf16 v[60:63], v[4:7], a[8:15], v110
  v_smfmac_f32_16x16x64_bf16 v[64:67], v[4:7], v[44:51], v110
  ds_read_b128 v[44:47], v129 offset:4096
  s_waitcnt lgkmcnt(6)
  v_smfmac_f32_16x16x64_bf16 v[60:63], v[8:11], a[16:23], v110
  ds_read_b128 v[48:51], v129 offset:5120
  v_smfmac_f32_16x16x64_bf16 v[64:67], v[8:11], a[248:255], v110
  s_waitcnt lgkmcnt(6)
  v_smfmac_f32_16x16x64_bf16 v[60:63], v[12:15], a[24:31], v110
  v_smfmac_f32_16x16x64_bf16 v[64:67], v[12:15], v[52:59], v110
  ds_read_b128 v[52:55], v129 offset:6144
  s_waitcnt lgkmcnt(6)
  v_smfmac_f32_16x16x64_bf16 v[60:63], v[16:19], a[40:47], v110
  ds_read_b128 v[56:59], v129 offset:7168
  s_waitcnt lgkmcnt(2)
  v_smfmac_f32_16x16x64_bf16 v[64:67], v[16:19], v[44:51], v110
  ds_read_b128 v[44:47], v129 offset:8192
  v_smfmac_f32_16x16x64_bf16 v[60:63], v[20:23], a[48:55], v110
  ds_read_b128 v[48:51], v129 offset:9216
  v_smfmac_f32_16x16x64_bf16 v[64:67], v[20:23], v[160:167], v110
  v_smfmac_f32_16x16x64_bf16 v[60:63], v[24:27], a[56:63], v110
  s_waitcnt lgkmcnt(2)
  v_smfmac_f32_16x16x64_bf16 v[64:67], v[24:27], v[52:59], v110
  ds_read_b128 v[52:55], v129 offset:10240
  v_smfmac_f32_16x16x64_bf16 v[60:63], v[28:31], a[72:79], v110
  ds_read_b128 v[56:59], v129 offset:11264
  s_waitcnt lgkmcnt(2)
  v_smfmac_f32_16x16x64_bf16 v[64:67], v[28:31], v[44:51], v110
  ds_read_b128 v[44:47], v129 offset:12288
  v_smfmac_f32_16x16x64_bf16 v[68:71], v[4:7], a[88:95], v110
  ds_read_b128 v[48:51], v129 offset:13312
  s_waitcnt lgkmcnt(2)
  v_smfmac_f32_16x16x64_bf16 v[72:75], v[4:7], v[52:59], v110
  ds_read_b128 v[52:55], v129 offset:14336
  v_permlane32_swap_b32 v60, v64
  v_smfmac_f32_16x16x64_bf16 v[68:71], v[8:11], a[96:103], v110
  ds_read_b128 v[56:59], v129 offset:15360
  v_smfmac_f32_16x16x64_bf16 v[72:75], v[8:11], v[184:191], v110
  v_permlane32_swap_b32 v61, v65
  v_smfmac_f32_16x16x64_bf16 v[68:71], v[12:15], a[104:111], v110
  s_waitcnt lgkmcnt(2)
  v_smfmac_f32_16x16x64_bf16 v[72:75], v[12:15], v[44:51], v110
  ds_read_b128 v[44:47], v129 offset:16384
  v_permlane32_swap_b32 v62, v66
  v_smfmac_f32_16x16x64_bf16 v[68:71], v[16:19], a[120:127], v110
  ds_read_b128 v[48:51], v129 offset:17408
  v_permlane32_swap_b32 v63, v67
  s_waitcnt lgkmcnt(2)
  v_smfmac_f32_16x16x64_bf16 v[72:75], v[16:19], v[52:59], v110
  ds_read_b128 v[52:55], v129 offset:18432
  v_add_f32 v60, v60, v64
  v_smfmac_f32_16x16x64_bf16 v[68:71], v[20:23], a[128:135], v110
  ds_read_b128 v[56:59], v129 offset:19456
  v_add_f32 v61, v61, v65
  v_smfmac_f32_16x16x64_bf16 v[72:75], v[20:23], v[200:207], v110
  v_add_f32 v62, v62, v66
  v_smfmac_f32_16x16x64_bf16 v[68:71], v[24:27], a[136:143], v110
  v_add_f32 v63, v63, v67
  s_waitcnt lgkmcnt(2)
  v_smfmac_f32_16x16x64_bf16 v[72:75], v[24:27], v[44:51], v110
  ds_read_b128 v[44:47], v129 offset:20480
  v_cvt_pk_bf16_f32 v100, v60, v61
  v_smfmac_f32_16x16x64_bf16 v[68:71], v[28:31], a[152:159], v110
  ds_read_b128 v[48:51], v129 offset:21504
  v_cvt_pk_bf16_f32 v101, v62, v63
  s_waitcnt lgkmcnt(2)
  v_smfmac_f32_16x16x64_bf16 v[72:75], v[28:31], v[52:59], v110
  ds_read_b128 v[52:55], v129 offset:22528
  v_smfmac_f32_16x16x64_bf16 v[36:39], v[4:7], a[168:175], v110
  ds_read_b128 v[56:59], v129 offset:23552
  s_waitcnt lgkmcnt(2)
  v_smfmac_f32_16x16x64_bf16 v[40:43], v[4:7], v[44:51], v110
  ds_read_b128 v[44:47], v129 offset:24576
  v_permlane32_swap_b32 v68, v72
  v_smfmac_f32_16x16x64_bf16 v[36:39], v[8:11], a[176:183], v110
  ds_read_b128 v[48:51], v129 offset:25600
  v_smfmac_f32_16x16x64_bf16 v[40:43], v[8:11], v[224:231], v110
  v_permlane32_swap_b32 v69, v73
  v_smfmac_f32_16x16x64_bf16 v[36:39], v[12:15], a[184:191], v110
  s_waitcnt lgkmcnt(2)
  v_smfmac_f32_16x16x64_bf16 v[40:43], v[12:15], v[52:59], v110
  ds_read_b128 v[52:55], v129 offset:26624
  v_permlane32_swap_b32 v70, v74
  v_smfmac_f32_16x16x64_bf16 v[36:39], v[16:19], a[200:207], v110
  ds_read_b128 v[56:59], v129 offset:27648
  v_permlane32_swap_b32 v71, v75
  s_waitcnt lgkmcnt(2)
  v_smfmac_f32_16x16x64_bf16 v[40:43], v[16:19], v[44:51], v110
  ds_read_b128 v[44:47], v129 offset:28672
  v_add_f32 v68, v68, v72
  v_smfmac_f32_16x16x64_bf16 v[36:39], v[20:23], a[208:215], v110
  ds_read_b128 v[48:51], v129 offset:29696
  v_add_f32 v69, v69, v73
  v_smfmac_f32_16x16x64_bf16 v[40:43], v[20:23], v[240:247], v110
  v_add_f32 v70, v70, v74
  v_smfmac_f32_16x16x64_bf16 v[36:39], v[24:27], a[216:223], v110
  v_add_f32 v71, v71, v75
  s_waitcnt lgkmcnt(2)
  v_smfmac_f32_16x16x64_bf16 v[40:43], v[24:27], v[52:59], v110
  v_cvt_pk_bf16_f32 v102, v68, v69
  v_smfmac_f32_16x16x64_bf16 v[36:39], v[28:31], a[232:239], v110
  v_cvt_pk_bf16_f32 v103, v70, v71
  s_waitcnt lgkmcnt(0)
  v_smfmac_f32_16x16x64_bf16 v[40:43], v[28:31], v[44:51], v110
  v_mfma_f32_16x16x16_bf16 v[142:145], v[100:101], v[108:109], 0
  v_mfma_f32_16x16x16_bf16 v[146:149], v[102:103], v[108:109], 0
  s_nop 1
  v_permlane32_swap_b32 v36, v40
  v_permlane32_swap_b32 v37, v41
  v_permlane32_swap_b32 v38, v42
  v_permlane32_swap_b32 v39, v43
  v_add_f32 v36, v36, v40
  v_add_f32 v37, v37, v41
  v_add_f32 v38, v38, v42
  v_add_f32 v39, v39, v43
  v_cvt_pk_bf16_f32 v104, v36, v37
  v_cvt_pk_bf16_f32 v105, v38, v39
  v_cvt_pk_bf16_f32 v44, v142, v143
  v_cvt_pk_bf16_f32 v45, v144, v145
  v_mfma_f32_16x16x16_bf16 v[142:145], v[104:105], v[108:109], 0
  v_cvt_pk_bf16_f32 v46, v146, v147
  v_cvt_pk_bf16_f32 v47, v148, v149
  ds_write_b64 v131, v[44:45]
  ds_write_b64 v131, v[46:47] offset:512
  v_mfma_f32_16x16x32_bf16 v[76:79], v[44:47], v[44:47], 0
  v_mfma_f32_16x16x32_bf16 v[80:83], v[88:91], v[44:47], 0
  v_mfma_f32_16x16x32_bf16 v[84:87], v[92:95], v[44:47], 0
  v_cvt_pk_bf16_f32 v106, v142, v143
  v_cvt_pk_bf16_f32 v107, v144, v145
  ds_write_b64 v131, v[106:107] offset:1024
  s_nop 0
  v_mfma_f32_16x16x16_bf16 v[76:79], v[106:107], v[106:107], v[76:79]
  v_mfma_f32_16x16x16_bf16 v[80:83], v[96:97], v[106:107], v[80:83]
  v_mfma_f32_16x16x16_bf16 v[84:87], v[98:99], v[106:107], v[84:87]
  s_nop 6
  ds_write_b128 v130, v[76:79] offset:0
  ds_write_b128 v130, v[80:83] offset:1024
  s_nop 0
  ds_write_b128 v130, v[84:87] offset:2048
  s_waitcnt lgkmcnt(0)
  s_barrier
  s_cmp_ge_u32 s51, 63
  s_cbranch_scc1 kas_x_done
  ds_read_b128 v[4:7], v133 offset:0
  ds_read_b32 v20, v134 offset:0
  ds_read_b128 v[8:11], v133 offset:3072
  ds_read_b32 v21, v134 offset:3072
  ds_read_b128 v[12:15], v133 offset:6144
  ds_read_b32 v22, v134 offset:6144
  ds_read_b128 v[16:19], v133 offset:9216
  ds_read_b32 v23, v134 offset:9216
  s_waitcnt lgkmcnt(4)
  v_pk_add_f32 v[4:5], v[4:5], v[8:9]
  v_pk_add_f32 v[6:7], v[6:7], v[10:11]
  v_add_f32 v20, v20, v21
  s_waitcnt lgkmcnt(0)
  v_pk_add_f32 v[12:13], v[12:13], v[16:17]
  v_pk_add_f32 v[14:15], v[14:15], v[18:19]
  v_add_f32 v22, v22, v23
  v_pk_add_f32 v[4:5], v[4:5], v[12:13]
  v_pk_add_f32 v[6:7], v[6:7], v[14:15]
  v_add_f32 v8, v20, v22
  v_max3_f32 v24, v4, v5, v6
  v_max3_f32 v24, v24, v7, v8
  s_nop 1
  v_max_f32_dpp v25, v24, v24 quad_perm:[1,0,3,2] row_mask:0xf bank_mask:0xf
  s_nop 1
  v_max_f32_dpp v24, v25, v25 quad_perm:[2,3,0,1] row_mask:0xf bank_mask:0xf
  s_nop 1
  v_max_f32_dpp v25, v24, v24 row_half_mirror row_mask:0xf bank_mask:0xf
  v_mul_f32 v24, s64, v25
  v_fma_f32 v4, v4, s64, -v24
  v_fma_f32 v5, v5, s64, -v24
  v_fma_f32 v6, v6, s64, -v24
  v_fma_f32 v7, v7, s64, -v24
  v_fma_f32 v8, v8, s64, -v24
  v_exp_f32 v4, v4
  v_exp_f32 v5, v5
  v_exp_f32 v6, v6
  v_exp_f32 v7, v7
  v_exp_f32 v8, v8
  v_add_f32 v24, v4, v5
  v_add_f32 v25, v6, v7
  v_add_f32 v24, v24, v25
  v_add_f32 v24, v24, v8
  s_nop 1
  v_add_f32_dpp v25, v24, v24 quad_perm:[1,0,3,2] row_mask:0xf bank_mask:0xf
  s_nop 1
  v_add_f32_dpp v24, v25, v25 quad_perm:[2,3,0,1] row_mask:0xf bank_mask:0xf
  s_nop 1
  v_add_f32_dpp v25, v24, v24 row_half_mirror row_mask:0xf bank_mask:0xf
  s_nop 0
  v_rcp_f32 v24, v25
  s_nop 0
  v_mul_f32 v8, v8, v24
  v_mul_f32 v4, v4, v24
  v_mul_f32 v5, v5, v24
  v_mov_b32_dpp v9, v8 quad_perm:[1,0,3,2] row_mask:0xf bank_mask:0xf
  v_mul_f32 v6, v6, v24
  v_mul_f32 v7, v7, v24
  v_cvt_pk_bf16_f32 v10, v4, v5
  v_cvt_pk_bf16_f32 v11, v6, v7
  v_cvt_pk_bf16_f32 v12, v8, v9
  buffer_store_dwordx2 v[10:11], v135, s[8:11], s49 offen sc1
  buffer_store_dword v12, v136, s[8:11], s49 offen sc1
  v_mov_b32 v60, 0
  v_mov_b32 v61, 0
  v_mov_b32 v62, 0
  v_mov_b32 v63, 0
  v_mov_b32 v64, 0
  v_mov_b32 v65, 0
  v_mov_b32 v66, 0
  v_mov_b32 v67, 0
  v_mov_b32 v68, 0
  v_mov_b32 v69, 0
  v_mov_b32 v70, 0
  v_mov_b32 v71, 0
  v_mov_b32 v72, 0
  v_mov_b32 v73, 0
  v_mov_b32 v74, 0
  v_mov_b32 v75, 0
  v_mov_b32 v36, 0
  v_mov_b32 v37, 0
  v_mov_b32 v38, 0
  v_mov_b32 v39, 0
  v_mov_b32 v40, 0
  v_mov_b32 v41, 0
  v_mov_b32 v42, 0
  v_mov_b32 v43, 0
  s_add_u32 s97, s97, 10240
  s_mov_b32 s48, s97
  s_add_u32 s49, s49, 5120
  s_add_u32 s50, s50, 12288
  s_add_u32 s63, s63, 12288
  s_add_u32 s51, s51, 1
  s_cmp_gt_u32 s52, s51
  s_cbranch_scc1 kas_x_wp_68_ok
  s_mov_b32 s45, 0
kas_x_wp_68_spin:
  buffer_load_dword v2, v138, s[8:11], 0 offen sc1
  s_add_u32 s45, s45, 1
  s_waitcnt vmcnt(0)
  v_min_u32_dpp v3, v2, v2 quad_perm:[1,0,3,2] row_mask:0xf bank_mask:0xf
  s_nop 1
  v_min_u32_dpp v2, v3, v3 quad_perm:[2,3,0,1] row_mask:0xf bank_mask:0xf
  s_nop 1
  v_min_u32_dpp v3, v2, v2 row_half_mirror row_mask:0xf bank_mask:0xf
  s_nop 1
  v_min_u32_dpp v2, v3, v3 quad_perm:[0,1,2,3] row_mask:0xf bank_mask:0xf
  s_nop 0
  v_readfirstlane_b32 s52, v2
  s_cmp_gt_u32 s52, s51
  s_cbranch_scc1 kas_x_wp_68_ok
  s_cmp_lt_u32 s45, 400000
  s_cbranch_scc1 kas_x_wp_68_spin
  s_branch kas_abort
kas_x_wp_68_ok:
  s_add_u32 s28, s50, s53
  buffer_load_dwordx2 v[88:89], v132, s[8:11], s28 offen offset:0 sc1
  buffer_load_dwordx2 v[92:93], v132, s[8:11], s28 offen offset:1024 sc1
  s_add_u32 s28, s50, s54
  buffer_load_dwordx2 v[90:91], v132, s[8:11], s28 offen offset:0 sc1
  buffer_load_dwordx2 v[94:95], v132, s[8:11], s28 offen offset:1024 sc1
  s_add_u32 s28, s50, s55
  buffer_load_dwordx2 v[96:97], v132, s[8:11], s28 offen offset:0 sc1
  buffer_load_dwordx2 v[98:99], v132, s[8:11], s28 offen offset:1024 sc1
  s_branch kas_x_w0l
kas_x_w1:
kas_x_w1l:
  ds_read_b128 v[44:47], v129 offset:0
  ds_read_b128 v[48:51], v129 offset:1024
  ds_read_b128 v[52:55], v129 offset:10240
  ds_read_b128 v[56:59], v129 offset:11264
  s_waitcnt lgkmcnt(0)
  s_mov_b32 s45, 0
kas_x_pf_69:
  buffer_load_dwordx4 v[112:115], v124, s[8:11], s48 offen sc1
  buffer_load_dwordx4 v[116:119], v125, s[8:11], s48 offen sc1
  buffer_load_dwordx4 v[120:123], v126, s[8:11], s48 offen sc1
  s_add_u32 s45, s45, 1
  s_waitcnt vmcnt(2)
  ds_write_b128 v127, v[112:115] offset:0
  v_max3_u32 v139, v112, v113, v114
  v_max_u32 v139, v139, v115
  s_waitcnt vmcnt(1)
  ds_write_b128 v127, v[116:119] offset:4096
  v_max3_u32 v139, v139, v116, v117
  v_max3_u32 v139, v139, v118, v119
  s_waitcnt vmcnt(0)
  ds_write_b128 v127, v[120:123] offset:8192
  v_max3_u32 v139, v139, v120, v121
  v_max3_u32 v139, v139, v122, v123
  v_cmp_eq_u32 vcc, -1, v139
  s_cbranch_vccz kas_x_pf_69_ok
  s_cmp_lt_u32 s45, 400000
  s_cbranch_scc1 kas_x_pf_69
  s_branch kas_abort
kas_x_pf_69_ok:
  v_smfmac_f32_16x16x64_bf16 v[60:63], v[112:115], a[8:15], v110
  v_smfmac_f32_16x16x64_bf16 v[64:67], v[112:115], v[44:51], v110
  ds_read_b128 v[44:47], v129 offset:20480
  v_smfmac_f32_16x16x64_bf16 v[68:71], v[112:115], a[88:95], v110
  ds_read_b128 v[48:51], v129 offset:21504
  v_smfmac_f32_16x16x64_bf16 v[72:75], v[112:115], v[52:59], v110
  ds_read_b128 v[52:55], v129 offset:4096
  s_waitcnt lgkmcnt(3)
  s_barrier
  v_smfmac_f32_16x16x64_bf16 v[36:39], v[112:115], a[168:175], v110
  ds_read_b128 v[56:59], v129 offset:5120
  ds_read_b128 v[4:7], v128 offset:0
  s_waitcnt lgkmcnt(3)
  v_smfmac_f32_16x16x64_bf16 v[40:43], v[112:115], v[44:51], v110
  ds_read_b128 v[44:47], v129 offset:14336
  ds_read_b128 v[8:11], v128 offset:2048
  v_smfmac_f32_16x16x64_bf16 v[60:63], v[116:119], a[40:47], v110
  ds_read_b128 v[48:51], v129 offset:15360
  ds_read_b128 v[12:15], v128 offset:3072
  s_waitcnt lgkmcnt(5)
  v_smfmac_f32_16x16x64_bf16 v[64:67], v[116:119], v[52:59], v110
  ds_read_b128 v[52:55], v129 offset:24576
  ds_read_b128 v[16:19], v128 offset:4096
  v_smfmac_f32_16x16x64_bf16 v[68:71], v[116:119], a[120:127], v110
  ds_read_b128 v[56:59], v129 offset:25600
  ds_read_b128 v[20:23], v128 offset:6144
  s_waitcnt lgkmcnt(5)
  v_smfmac_f32_16x16x64_bf16 v[72:75], v[116:119], v[44:51], v110
  ds_read_b128 v[44:47], v129 offset:8192
  ds_read_b128 v[24:27], v128 offset:7168
  v_smfmac_f32_16x16x64_bf16 v[36:39], v[116:119], a[200:207], v110
  ds_read_b128 v[48:51], v129 offset:9216
  ds_read_b128 v[28:31], v128 offset:8192
  s_waitcnt lgkmcnt(5)
  v_smfmac_f32_16x16x64_bf16 v[40:43], v[116:119], v[52:59], v110
  ds_read_b128 v[52:55], v129 offset:18432
  v_smfmac_f32_16x16x64_bf16 v[60:63], v[120:123], a[72:79], v110
  ds_read_b128 v[56:59], v129 offset:19456
  s_waitcnt lgkmcnt(3)
  v_smfmac_f32_16x16x64_bf16 v[64:67], v[120:123], v[44:51], v110
  ds_read_b128 v[44:47], v129 offset:28672
  v_smfmac_f32_16x16x64_bf16 v[68:71], v[120:123], a[152:159], v110
  ds_read_b128 v[48:51], v129 offset:29696
  s_waitcnt lgkmcnt(2)
  v_smfmac_f32_16x16x64_bf16 v[72:75], v[120:123], v[52:59], v110
  ds_read_b128 v[52:55], v129 offset:2048
  v_smfmac_f32_16x16x64_bf16 v[36:39], v[120:123], a[232:239], v110
  ds_read_b128 v[56:59], v129 offset:3072
  s_waitcnt lgkmcnt(2)
  v_smfmac_f32_16x16x64_bf16 v[40:43], v[120:123], v[44:51], v110
  ds_read_b128 v[44:47], v129 offset:6144
  v_smfmac_f32_16x16x64_bf16 v[60:63], v[4:7], a[0:7], v110
  ds_read_b128 v[48:51], v129 offset:7168
  v_smfmac_f32_16x16x64_bf16 v[64:67], v[4:7], a[240:247], v110
  v_smfmac_f32_16x16x64_bf16 v[60:63], v[8:11], a[16:23], v110
  v_smfmac_f32_16x16x64_bf16 v[64:67], v[8:11], a[248:255], v110
  v_smfmac_f32_16x16x64_bf16 v[60:63], v[12:15], a[24:31], v110
  s_waitcnt lgkmcnt(2)
  v_smfmac_f32_16x16x64_bf16 v[64:67], v[12:15], v[52:59], v110
  ds_read_b128 v[52:55], v129 offset:12288
  v_smfmac_f32_16x16x64_bf16 v[60:63], v[16:19], a[32:39], v110
  ds_read_b128 v[56:59], v129 offset:13312
  v_smfmac_f32_16x16x64_bf16 v[64:67], v[16:19], v[152:159], v110
  v_smfmac_f32_16x16x64_bf16 v[60:63], v[20:23], a[48:55], v110
  v_smfmac_f32_16x16x64_bf16 v[64:67], v[20:23], v[160:167], v110
  v_smfmac_f32_16x16x64_bf16 v[60:63], v[24:27], a[56:63], v110
  s_waitcnt lgkmcnt(2)
  v_smfmac_f32_16x16x64_bf16 v[64:67], v[24:27], v[44:51], v110
  ds_read_b128 v[44:47], v129 offset:16384
  v_smfmac_f32_16x16x64_bf16 v[60:63], v[28:31], a[64:71], v110
  ds_read_b128 v[48:51], v129 offset:17408
  v_smfmac_f32_16x16x64_bf16 v[64:67], v[28:31], v[168:175], v110
  v_smfmac_f32_16x16x64_bf16 v[68:71], v[4:7], a[80:87], v110
  v_smfmac_f32_16x16x64_bf16 v[72:75], v[4:7], v[176:183], v110
  v_permlane32_swap_b32 v60, v64
  v_smfmac_f32_16x16x64_bf16 v[68:71], v[8:11], a[96:103], v110
  v_smfmac_f32_16x16x64_bf16 v[72:75], v[8:11], v[184:191], v110
  v_permlane32_swap_b32 v61, v65
  v_smfmac_f32_16x16x64_bf16 v[68:71], v[12:15], a[104:111], v110
  s_waitcnt lgkmcnt(2)
  v_smfmac_f32_16x16x64_bf16 v[72:75], v[12:15], v[52:59], v110
  ds_read_b128 v[52:55], v129 offset:22528
  v_permlane32_swap_b32 v62, v66
  v_smfmac_f32_16x16x64_bf16 v[68:71], v[16:19], a[112:119], v110
  ds_read_b128 v[56:59], v129 offset:23552
  v_permlane32_swap_b32 v63, v67
  v_smfmac_f32_16x16x64_bf16 v[72:75], v[16:19], v[192:199], v110
  v_add_f32 v60, v60, v64
  v_smfmac_f32_16x16x64_bf16 v[68:71], v[20:23], a[128:135], v110
  v_add_f32 v61, v61, v65
  v_smfmac_f32_16x16x64_bf16 v[72:75], v[20:23], v[200:207], v110
  v_add_f32 v62, v62, v66
  v_smfmac_f32_16x16x64_bf16 v[68:71], v[24:27], a[136:143], v110
  v_add_f32 v63, v63, v67
  s_waitcnt lgkmcnt(2)
  v_smfmac_f32_16x16x64_bf16 v[72:75], v[24:27], v[44:51], v110
  ds_read_b128 v[44:47], v129 offset:26624
  v_cvt_pk_bf16_f32 v100, v60, v61
  v_smfmac_f32_16x16x64_bf16 v[68:71], v[28:31], a[144:151], v110
  ds_read_b128 v[48:51], v129 offset:27648
  v_cvt_pk_bf16_f32 v101, v62, v63
  v_smfmac_f32_16x16x64_bf16 v[72:75], v[28:31], v[208:215], v110
  v_smfmac_f32_16x16x64_bf16 v[36:39], v[4:7], a[160:167], v110
  v_smfmac_f32_16x16x64_bf16 v[40:43], v[4:7], v[216:223], v110
  v_permlane32_swap_b32 v68, v72
  v_smfmac_f32_16x16x64_bf16 v[36:39], v[8:11], a[176:183], v110
  v_smfmac_f32_16x16x64_bf16 v[40:43], v[8:11], v[224:231], v110
  v_permlane32_swap_b32 v69, v73
  v_smfmac_f32_16x16x64_bf16 v[36:39], v[12:15], a[184:191], v110
  s_waitcnt lgkmcnt(2)
  v_smfmac_f32_16x16x64_bf16 v[40:43], v[12:15], v[52:59], v110
  v_permlane32_swap_b32 v70, v74
  v_smfmac_f32_16x16x64_bf16 v[36:39], v[16:19], a[192:199], v110
  v_permlane32_swap_b32 v71, v75
  v_smfmac_f32_16x16x64_bf16 v[40:43], v[16:19], v[232:239], v110
  v_add_f32 v68, v68, v72
  v_smfmac_f32_16x16x64_bf16 v[36:39], v[20:23], a[208:215], v110
  v_add_f32 v69, v69, v73
  v_smfmac_f32_16x16x64_bf16 v[40:43], v[20:23], v[240:247], v110
  v_add_f32 v70, v70, v74
  v_smfmac_f32_16x16x64_bf16 v[36:39], v[24:27], a[216:223], v110
  v_add_f32 v71, v71, v75
  s_waitcnt lgkmcnt(0)
  v_smfmac_f32_16x16x64_bf16 v[40:43], v[24:27], v[44:51], v110
  v_cvt_pk_bf16_f32 v102, v68, v69
  v_smfmac_f32_16x16x64_bf16 v[36:39], v[28:31], a[224:231], v110
  v_cvt_pk_bf16_f32 v103, v70, v71
  v_smfmac_f32_16x16x64_bf16 v[40:43], v[28:31], v[248:255], v110
  v_mfma_f32_16x16x16_bf16 v[142:145], v[100:101], v[108:109], 0
  v_mfma_f32_16x16x16_bf16 v[146:149], v[102:103], v[108:109], 0
  s_nop 1
  v_permlane32_swap_b32 v36, v40
  v_permlane32_swap_b32 v37, v41
  v_permlane32_swap_b32 v38, v42
  v_permlane32_swap_b32 v39, v43
  v_add_f32 v36, v36, v40
  v_add_f32 v37, v37, v41
  v_add_f32 v38, v38, v42
  v_add_f32 v39, v39, v43
  v_cvt_pk_bf16_f32 v104, v36, v37
  v_cvt_pk_bf16_f32 v105, v38, v39
  v_cvt_pk_bf16_f32 v44, v142, v143
  v_cvt_pk_bf16_f32 v45, v144, v145
  v_mfma_f32_16x16x16_bf16 v[142:145], v[104:105], v[108:109], 0
  v_cvt_pk_bf16_f32 v46, v146, v147
  v_cvt_pk_bf16_f32 v47, v148, v149
  ds_write_b64 v131, v[44:45]
  ds_write_b64 v131, v[46:47] offset:512
  v_mfma_f32_16x16x32_bf16 v[76:79], v[44:47], v[44:47], 0
  v_mfma_f32_16x16x32_bf16 v[80:83], v[88:91], v[44:47], 0
  v_mfma_f32_16x16x32_bf16 v[84:87], v[92:95], v[44:47], 0
  v_cvt_pk_bf16_f32 v106, v142, v143
  v_cvt_pk_bf16_f32 v107, v144, v145
  ds_write_b64 v131, v[106:107] offset:1024
  s_nop 0
  v_mfma_f32_16x16x16_bf16 v[76:79], v[106:107], v[106:107], v[76:79]
  v_mfma_f32_16x16x16_bf16 v[80:83], v[96:97], v[106:107], v[80:83]
  v_mfma_f32_16x16x16_bf16 v[84:87], v[98:99], v[106:107], v[84:87]
  s_nop 6
  ds_write_b128 v130, v[76:79] offset:0
  ds_write_b128 v130, v[80:83] offset:1024
  s_nop 0
  ds_write_b128 v130, v[84:87] offset:2048
  s_waitcnt lgkmcnt(0)
  s_barrier
  s_cmp_ge_u32 s51, 63
  s_cbranch_scc1 kas_x_done
  v_mov_b32 v60, 0
  v_mov_b32 v61, 0
  v_mov_b32 v62, 0
  v_mov_b32 v63, 0
  v_mov_b32 v64, 0
  v_mov_b32 v65, 0
  v_mov_b32 v66, 0
  v_mov_b32 v67, 0
  v_mov_b32 v68, 0
  v_mov_b32 v69, 0
  v_mov_b32 v70, 0
  v_mov_b32 v71, 0
  v_mov_b32 v72, 0
  v_mov_b32 v73, 0
  v_mov_b32 v74, 0
  v_mov_b32 v75, 0
  v_mov_b32 v36, 0
  v_mov_b32 v37, 0
  v_mov_b32 v38, 0
  v_mov_b32 v39, 0
  v_mov_b32 v40, 0
  v_mov_b32 v41, 0
  v_mov_b32 v42, 0
  v_mov_b32 v43, 0
  s_add_u32 s97, s97, 10240
  s_mov_b32 s48, s97
  s_add_u32 s49, s49, 5120
  s_add_u32 s50, s50, 12288
  s_add_u32 s63, s63, 12288
  s_add_u32 s51, s51, 1
  s_cmp_gt_u32 s52, s51
  s_cbranch_scc1 kas_x_wp_70_ok
  s_mov_b32 s45, 0
kas_x_wp_70_spin:
  buffer_load_dword v2, v138, s[8:11], 0 offen sc1
  s_add_u32 s45, s45, 1
  s_waitcnt vmcnt(0)
  v_min_u32_dpp v3, v2, v2 quad_perm:[1,0,3,2] row_mask:0xf bank_mask:0xf
  s_nop 1
  v_min_u32_dpp v2, v3, v3 quad_perm:[2,3,0,1] row_mask:0xf bank_mask:0xf
  s_nop 1
  v_min_u32_dpp v3, v2, v2 row_half_mirror row_mask:0xf bank_mask:0xf
  s_nop 1
  v_min_u32_dpp v2, v3, v3 quad_perm:[0,1,2,3] row_mask:0xf bank_mask:0xf
  s_nop 0
  v_readfirstlane_b32 s52, v2
  s_cmp_gt_u32 s52, s51
  s_cbranch_scc1 kas_x_wp_70_ok
  s_cmp_lt_u32 s45, 400000
  s_cbranch_scc1 kas_x_wp_70_spin
  s_branch kas_abort
kas_x_wp_70_ok:
  s_add_u32 s28, s50, s53
  buffer_load_dwordx2 v[88:89], v132, s[8:11], s28 offen offset:0 sc1
  buffer_load_dwordx2 v[92:93], v132, s[8:11], s28 offen offset:1024 sc1
  s_add_u32 s28, s50, s54
  buffer_load_dwordx2 v[90:91], v132, s[8:11], s28 offen offset:0 sc1
  buffer_load_dwordx2 v[94:95], v132, s[8:11], s28 offen offset:1024 sc1
  s_add_u32 s28, s50, s55
  buffer_load_dwordx2 v[96:97], v132, s[8:11], s28 offen offset:0 sc1
  buffer_load_dwordx2 v[98:99], v132, s[8:11], s28 offen offset:1024 sc1
  s_branch kas_x_w1l
kas_x_w23:
  s_sub_u32 s65, s21, 2
  s_and_b32 s26, s23, 7
  v_and_b32 v4, 15, v1
  v_lshrrev_b32 v5, 4, v1
  v_and_b32 v6, 1, v5
  v_lshlrev_b32 v6, 5, v6
  v_add_u32 v6, v6, v4
  v_lshlrev_b32 v6, 4, v6
  v_lshrrev_b32 v7, 1, v5
  v_lshlrev_b32 v7, 3, v7
  v_add_u32 v6, v6, v7
  s_lshl_b32 s28, s26, 1
  s_add_u32 s28, s28, s65
  s_lshl_b32 s28, s28, 10
  v_add_u32 v133, s28, v6
  s_lshr_b32 s28, s26, 2
  s_lshl_b32 s28, s28, 1
  s_add_u32 s28, s28, s65
  s_lshl_b32 s28, s28, 10
  s_and_b32 s29, s26, 1
  s_lshl_b32 s29, s29, 9
  s_add_u32 s28, s28, s29
  s_bfe_u32 s29, s26, 0x10001
  s_lshl_b32 s29, s29, 3
  s_add_u32 s28, s28, s29
  s_add_u32 s28, s28, 15872
  v_lshlrev_b32 v6, 4, v5
  v_add_u32 v6, v6, v4
  v_lshlrev_b32 v6, 4, v6
  v_add_u32 v6, s28, v6
  v_mov_b32 v7, 0x40000000
  v_cmp_le_u32 vcc, 2, v5
  s_nop 1
  v_cndmask_b32 v134, v7, v6, vcc
  v_mov_b32 v135, 0xf149f2ca
  v_lshlrev_b32 v6, 3, v1
  v_add_u32 v136, 145408, v6
  s_mul_i32 s94, s65, 6144
  s_add_u32 s94, s94, 151552
  v_add_u32 v137, s94, v132
  v_cmp_le_u32 s[66:67], 2, v5
  v_lshlrev_b32 v6, 2, v5
  v_sub_u32 v6, v4, v6
  v_cmp_le_i32 s[68:69], 0, v6
  v_cmp_le_i32 s[70:71], 1, v6
  v_cmp_le_i32 s[72:73], 2, v6
  v_cmp_le_i32 s[74:75], 3, v6
  s_nop 1
  s_cmp_eq_u32 s65, 0
  s_cselect_b64 s[76:77], s[68:69], -1
  s_cselect_b64 s[84:85], 0, s[68:69]
  s_cselect_b64 s[78:79], s[70:71], -1
  s_cselect_b64 s[86:87], 0, s[70:71]
  s_cselect_b64 s[80:81], s[72:73], -1
  s_cselect_b64 s[88:89], 0, s[72:73]
  s_cselect_b64 s[82:83], s[74:75], -1
  s_cselect_b64 s[90:91], 0, s[74:75]
  s_mul_i32 s92, s20, 1310720
  s_add_u32 s92, s92, 0xe00000
  s_lshl_b32 s93, s65, 10
  s_mov_b32 s64, 0x3dd53b95
  s_add_u32 s95, s63, s93
  s_add_u32 m0, s94, 0
  s_add_u32 s28, s95, 0
  buffer_load_dwordx4 v132, s[8:11], s28 offen sc1 lds
  s_add_u32 m0, s94, 1024
  s_add_u32 s28, s95, 2048
  buffer_load_dwordx4 v132, s[8:11], s28 offen sc1 lds
  s_add_u32 m0, s94, 2048
  s_add_u32 s28, s95, 4096
  buffer_load_dwordx4 v132, s[8:11], s28 offen sc1 lds
  s_add_u32 m0, s94, 3072
  s_add_u32 s28, s95, 6144
  buffer_load_dwordx4 v132, s[8:11], s28 offen sc1 lds
  s_add_u32 m0, s94, 4096
  s_add_u32 s28, s95, 8192
  buffer_load_dwordx4 v132, s[8:11], s28 offen sc1 lds
  s_add_u32 m0, s94, 5120
  s_add_u32 s28, s95, 10240
  buffer_load_dwordx4 v132, s[8:11], s28 offen sc1 lds
  s_cmp_eq_u32 s21, 3
  s_cbranch_scc1 kas_x_w3l
kas_x_w2l:
  ds_read_b128 v[44:47], v129 offset:0
  ds_read_b128 v[48:51], v129 offset:1024
  ds_read_b128 v[52:55], v129 offset:2048
  ds_read_b128 v[56:59], v129 offset:3072
  s_waitcnt lgkmcnt(0)
  s_mov_b32 s45, 0
kas_x_pf_71:
  buffer_load_dwordx4 v[112:115], v124, s[8:11], s48 offen sc1
  buffer_load_dwordx4 v[116:119], v125, s[8:11], s48 offen sc1
  s_add_u32 s45, s45, 1
  s_waitcnt vmcnt(1)
  ds_write_b128 v127, v[112:115] offset:0
  v_max3_u32 v139, v112, v113, v114
  v_max_u32 v139, v139, v115
  s_waitcnt vmcnt(0)
  ds_write_b128 v127, v[116:119] offset:4096
  v_max3_u32 v139, v139, v116, v117
  v_max3_u32 v139, v139, v118, v119
  v_cmp_eq_u32 vcc, -1, v139
  s_cbranch_vccz kas_x_pf_71_ok
  s_cmp_lt_u32 s45, 400000
  s_cbranch_scc1 kas_x_pf_71
  s_branch kas_abort
kas_x_pf_71_ok:
  v_smfmac_f32_16x16x64_bf16 v[60:63], v[112:115], a[16:23], v110
  v_smfmac_f32_16x16x64_bf16 v[64:67], v[112:115], a[248:255], v110
  v_smfmac_f32_16x16x64_bf16 v[68:71], v[112:115], a[96:103], v110
  v_smfmac_f32_16x16x64_bf16 v[72:75], v[112:115], v[184:191], v110
  s_waitcnt lgkmcnt(0)
  s_barrier
  v_smfmac_f32_16x16x64_bf16 v[36:39], v[112:115], a[176:183], v110
  ds_read_b128 v[4:7], v128 offset:0
  v_smfmac_f32_16x16x64_bf16 v[40:43], v[112:115], v[224:231], v110
  ds_read_b128 v[8:11], v128 offset:1024
  v_smfmac_f32_16x16x64_bf16 v[60:63], v[116:119], a[48:55], v110
  ds_read_b128 v[12:15], v128 offset:3072
  v_smfmac_f32_16x16x64_bf16 v[64:67], v[116:119], v[160:167], v110
  ds_read_b128 v[16:19], v128 offset:4096
  v_smfmac_f32_16x16x64_bf16 v[68:71], v[116:119], a[128:135], v110
  ds_read_b128 v[20:23], v128 offset:5120
  v_smfmac_f32_16x16x64_bf16 v[72:75], v[116:119], v[200:207], v110
  ds_read_b128 v[24:27], v128 offset:7168
  v_smfmac_f32_16x16x64_bf16 v[36:39], v[116:119], a[208:215], v110
  ds_read_b128 v[28:31], v128 offset:8192
  v_smfmac_f32_16x16x64_bf16 v[40:43], v[116:119], v[240:247], v110
  ds_read_b128 v[32:35], v128 offset:9216
  s_waitcnt lgkmcnt(7)
  v_smfmac_f32_16x16x64_bf16 v[60:63], v[4:7], a[0:7], v110
  v_smfmac_f32_16x16x64_bf16 v[64:67], v[4:7], a[240:247], v110
  s_waitcnt lgkmcnt(6)
  v_smfmac_f32_16x16x64_bf16 v[60:63], v[8:11], a[8:15], v110
  v_smfmac_f32_16x16x64_bf16 v[64:67], v[8:11], v[44:51], v110
  ds_read_b128 v[44:47], v129 offset:4096
  s_waitcnt lgkmcnt(6)
  v_smfmac_f32_16x16x64_bf16 v[60:63], v[12:15], a[24:31], v110
  ds_read_b128 v[48:51], v129 offset:5120
  v_smfmac_f32_16x16x64_bf16 v[64:67], v[12:15], v[52:59], v110
  ds_read_b128 v[52:55], v129 offset:6144
  s_waitcnt lgkmcnt(7)
  v_smfmac_f32_16x16x64_bf16 v[60:63], v[16:19], a[32:39], v110
  ds_read_b128 v[56:59], v129 offset:7168
  v_smfmac_f32_16x16x64_bf16 v[64:67], v[16:19], v[152:159], v110
  s_waitcnt lgkmcnt(7)
  v_smfmac_f32_16x16x64_bf16 v[60:63], v[20:23], a[40:47], v110
  s_waitcnt lgkmcnt(2)
  v_smfmac_f32_16x16x64_bf16 v[64:67], v[20:23], v[44:51], v110
  ds_read_b128 v[44:47], v129 offset:8192
  v_smfmac_f32_16x16x64_bf16 v[60:63], v[24:27], a[56:63], v110
  ds_read_b128 v[48:51], v129 offset:9216
  s_waitcnt lgkmcnt(2)
  v_smfmac_f32_16x16x64_bf16 v[64:67], v[24:27], v[52:59], v110
  ds_read_b128 v[52:55], v129 offset:10240
  v_smfmac_f32_16x16x64_bf16 v[60:63], v[28:31], a[64:71], v110
  ds_read_b128 v[56:59], v129 offset:11264
  v_smfmac_f32_16x16x64_bf16 v[64:67], v[28:31], v[168:175], v110
  v_smfmac_f32_16x16x64_bf16 v[60:63], v[32:35], a[72:79], v110
  s_waitcnt lgkmcnt(2)
  v_smfmac_f32_16x16x64_bf16 v[64:67], v[32:35], v[44:51], v110
  ds_read_b128 v[44:47], v129 offset:12288
  v_smfmac_f32_16x16x64_bf16 v[68:71], v[4:7], a[80:87], v110
  ds_read_b128 v[48:51], v129 offset:13312
  v_smfmac_f32_16x16x64_bf16 v[72:75], v[4:7], v[176:183], v110
  v_permlane32_swap_b32 v60, v64
  v_smfmac_f32_16x16x64_bf16 v[68:71], v[8:11], a[88:95], v110
  s_waitcnt lgkmcnt(2)
  v_smfmac_f32_16x16x64_bf16 v[72:75], v[8:11], v[52:59], v110
  ds_read_b128 v[52:55], v129 offset:14336
  v_permlane32_swap_b32 v61, v65
  v_smfmac_f32_16x16x64_bf16 v[68:71], v[12:15], a[104:111], v110
  ds_read_b128 v[56:59], v129 offset:15360
  s_waitcnt lgkmcnt(2)
  v_smfmac_f32_16x16x64_bf16 v[72:75], v[12:15], v[44:51], v110
  ds_read_b128 v[44:47], v129 offset:16384
  v_permlane32_swap_b32 v62, v66
  v_smfmac_f32_16x16x64_bf16 v[68:71], v[16:19], a[112:119], v110
  ds_read_b128 v[48:51], v129 offset:17408
  v_permlane32_swap_b32 v63, v67
  v_smfmac_f32_16x16x64_bf16 v[72:75], v[16:19], v[192:199], v110
  v_add_f32 v60, v60, v64
  v_smfmac_f32_16x16x64_bf16 v[68:71], v[20:23], a[120:127], v110
  v_add_f32 v61, v61, v65
  s_waitcnt lgkmcnt(2)
  v_smfmac_f32_16x16x64_bf16 v[72:75], v[20:23], v[52:59], v110
  ds_read_b128 v[52:55], v129 offset:18432
  v_add_f32 v62, v62, v66
  v_smfmac_f32_16x16x64_bf16 v[68:71], v[24:27], a[136:143], v110
  ds_read_b128 v[56:59], v129 offset:19456
  v_add_f32 v63, v63, v67
  s_waitcnt lgkmcnt(2)
  v_smfmac_f32_16x16x64_bf16 v[72:75], v[24:27], v[44:51], v110
  ds_read_b128 v[44:47], v129 offset:20480
  v_cvt_pk_bf16_f32 v100, v60, v61
  v_smfmac_f32_16x16x64_bf16 v[68:71], v[28:31], a[144:151], v110
  ds_read_b128 v[48:51], v129 offset:21504
  v_cvt_pk_bf16_f32 v101, v62, v63
  v_smfmac_f32_16x16x64_bf16 v[72:75], v[28:31], v[208:215], v110
  v_smfmac_f32_16x16x64_bf16 v[68:71], v[32:35], a[152:159], v110
  s_waitcnt lgkmcnt(2)
  v_smfmac_f32_16x16x64_bf16 v[72:75], v[32:35], v[52:59], v110
  ds_read_b128 v[52:55], v129 offset:22528
  v_smfmac_f32_16x16x64_bf16 v[36:39], v[4:7], a[160:167], v110
  ds_read_b128 v[56:59], v129 offset:23552
  v_smfmac_f32_16x16x64_bf16 v[40:43], v[4:7], v[216:223], v110
  v_permlane32_swap_b32 v68, v72
  v_smfmac_f32_16x16x64_bf16 v[36:39], v[8:11], a[168:175], v110
  s_waitcnt lgkmcnt(2)
  v_smfmac_f32_16x16x64_bf16 v[40:43], v[8:11], v[44:51], v110
  ds_read_b128 v[44:47], v129 offset:24576
  v_permlane32_swap_b32 v69, v73
  v_smfmac_f32_16x16x64_bf16 v[36:39], v[12:15], a[184:191], v110
  ds_read_b128 v[48:51], v129 offset:25600
  s_waitcnt lgkmcnt(2)
  v_smfmac_f32_16x16x64_bf16 v[40:43], v[12:15], v[52:59], v110
  ds_read_b128 v[52:55], v129 offset:26624
  v_permlane32_swap_b32 v70, v74
  v_smfmac_f32_16x16x64_bf16 v[36:39], v[16:19], a[192:199], v110
  ds_read_b128 v[56:59], v129 offset:27648
  v_permlane32_swap_b32 v71, v75
  v_smfmac_f32_16x16x64_bf16 v[40:43], v[16:19], v[232:239], v110
  v_add_f32 v68, v68, v72
  v_smfmac_f32_16x16x64_bf16 v[36:39], v[20:23], a[200:207], v110
  v_add_f32 v69, v69, v73
  s_waitcnt lgkmcnt(2)
  v_smfmac_f32_16x16x64_bf16 v[40:43], v[20:23], v[44:51], v110
  ds_read_b128 v[44:47], v129 offset:28672
  v_add_f32 v70, v70, v74
  v_smfmac_f32_16x16x64_bf16 v[36:39], v[24:27], a[216:223], v110
  ds_read_b128 v[48:51], v129 offset:29696
  v_add_f32 v71, v71, v75
  s_waitcnt lgkmcnt(2)
  v_smfmac_f32_16x16x64_bf16 v[40:43], v[24:27], v[52:59], v110
  v_cvt_pk_bf16_f32 v102, v68, v69
  v_smfmac_f32_16x16x64_bf16 v[36:39], v[28:31], a[224:231], v110
  v_cvt_pk_bf16_f32 v103, v70, v71
  v_smfmac_f32_16x16x64_bf16 v[40:43], v[28:31], v[248:255], v110
  v_smfmac_f32_16x16x64_bf16 v[36:39], v[32:35], a[232:239], v110
  s_waitcnt lgkmcnt(0)
  v_smfmac_f32_16x16x64_bf16 v[40:43], v[32:35], v[44:51], v110
  v_mfma_f32_16x16x16_bf16 v[142:145], v[100:101], v[108:109], 0
  v_mfma_f32_16x16x16_bf16 v[146:149], v[102:103], v[108:109], 0
  s_nop 1
  v_permlane32_swap_b32 v36, v40
  v_permlane32_swap_b32 v37, v41
  v_permlane32_swap_b32 v38, v42
  v_permlane32_swap_b32 v39, v43
  v_add_f32 v36, v36, v40
  v_add_f32 v37, v37, v41
  v_add_f32 v38, v38, v42
  v_add_f32 v39, v39, v43
  v_cvt_pk_bf16_f32 v104, v36, v37
  v_cvt_pk_bf16_f32 v105, v38, v39
  v_cvt_pk_bf16_f32 v44, v142, v143
  v_cvt_pk_bf16_f32 v45, v144, v145
  v_mfma_f32_16x16x16_bf16 v[142:145], v[104:105], v[108:109], 0
  v_cvt_pk_bf16_f32 v46, v146, v147
  v_cvt_pk_bf16_f32 v47, v148, v149
  ds_write_b64 v131, v[44:45]
  ds_write_b64 v131, v[46:47] offset:512
  v_mfma_f32_16x16x32_bf16 v[76:79], v[44:47], v[44:47], 0
  v_mfma_f32_16x16x32_bf16 v[80:83], v[88:91], v[44:47], 0
  v_mfma_f32_16x16x32_bf16 v[84:87], v[92:95], v[44:47], 0
  v_cvt_pk_bf16_f32 v106, v142, v143
  v_cvt_pk_bf16_f32 v107, v144, v145
  ds_write_b64 v131, v[106:107] offset:1024
  s_nop 0
  v_mfma_f32_16x16x16_bf16 v[76:79], v[106:107], v[106:107], v[76:79]
  v_mfma_f32_16x16x16_bf16 v[80:83], v[96:97], v[106:107], v[80:83]
  v_mfma_f32_16x16x16_bf16 v[84:87], v[98:99], v[106:107], v[84:87]
  s_nop 6
  ds_write_b128 v130, v[76:79] offset:0
  ds_write_b128 v130, v[80:83] offset:1024
  s_nop 0
  ds_write_b128 v130, v[84:87] offset:2048
  s_mov_b32 s28, s50
  buffer_load_dwordx4 v[4:7], v132, s[8:11], s28 offen sc1
  buffer_load_dwordx4 v[8:11], v132, s[8:11], s28 offen offset:1024 sc1
  s_add_u32 s28, s28, 2048
  buffer_load_dwordx4 v[12:15], v132, s[8:11], s28 offen sc1
  buffer_load_dwordx4 v[16:19], v132, s[8:11], s28 offen offset:1024 sc1
  s_add_u32 s28, s28, 2048
  buffer_load_dwordx4 v[20:23], v132, s[8:11], s28 offen sc1
  buffer_load_dwordx4 v[24:27], v132, s[8:11], s28 offen offset:1024 sc1
  s_add_u32 s28, s28, 2048
  buffer_load_dwordx4 v[28:31], v132, s[8:11], s28 offen sc1
  buffer_load_dwordx4 v[32:35], v132, s[8:11], s28 offen offset:1024 sc1
  s_add_u32 s28, s28, 2048
  buffer_load_dwordx4 v[36:39], v132, s[8:11], s28 offen sc1
  buffer_load_dwordx4 v[40:43], v132, s[8:11], s28 offen offset:1024 sc1
  s_add_u32 s28, s28, 2048
  buffer_load_dwordx4 v[60:63], v132, s[8:11], s28 offen sc1
  buffer_load_dwordx4 v[64:67], v132, s[8:11], s28 offen offset:1024 sc1
  s_add_u32 s28, s28, 2048
  s_waitcnt lgkmcnt(0)
  s_barrier
  ds_read_b64 v[76:77], v136 offset:0
  ds_read_b64 v[78:79], v136 offset:512
  ds_read_b64 v[80:81], v136 offset:1024
  ds_read_b64 v[82:83], v136 offset:1536
  ds_read_b64 v[84:85], v136 offset:2048
  ds_read_b64 v[86:87], v136 offset:2560
  ds_read_b64 v[88:89], v136 offset:3072
  ds_read_b64 v[90:91], v136 offset:3584
  ds_read_b64 v[92:93], v136 offset:4096
  ds_read_b64 v[94:95], v136 offset:4608
  ds_read_b64 v[96:97], v136 offset:5120
  ds_read_b64 v[98:99], v136 offset:5632
  ds_read_b128 v[44:47], v137 offset:0
  ds_read_b128 v[48:51], v137 offset:1024
  ds_read_b128 v[52:55], v137 offset:2048
  s_waitcnt lgkmcnt(3)
  ds_read_b128 v[56:59], v137 offset:3072
  ds_read_b128 v[68:71], v137 offset:4096
  ds_read_b128 v[72:75], v137 offset:5120
  s_waitcnt lgkmcnt(0)
  s_cmp_ge_u32 s51, 63
  s_cbranch_scc1 xq_72
  s_add_u32 s96, s51, 1
  s_cmp_gt_u32 s52, s96
  s_cbranch_scc1 kas_x_wp_73_ok
  s_mov_b32 s45, 0
kas_x_wp_73_spin:
  buffer_load_dword v2, v138, s[8:11], 0 offen sc1
  s_add_u32 s45, s45, 1
  s_waitcnt vmcnt(0)
  v_min_u32_dpp v3, v2, v2 quad_perm:[1,0,3,2] row_mask:0xf bank_mask:0xf
  s_nop 1
  v_min_u32_dpp v2, v3, v3 quad_perm:[2,3,0,1] row_mask:0xf bank_mask:0xf
  s_nop 1
  v_min_u32_dpp v3, v2, v2 row_half_mirror row_mask:0xf bank_mask:0xf
  s_nop 1
  v_min_u32_dpp v2, v3, v3 quad_perm:[0,1,2,3] row_mask:0xf bank_mask:0xf
  s_nop 0
  v_readfirstlane_b32 s52, v2
  s_cmp_gt_u32 s52, s96
  s_cbranch_scc1 kas_x_wp_73_ok
  s_cmp_lt_u32 s45, 400000
  s_cbranch_scc1 kas_x_wp_73_spin
  s_branch kas_abort
kas_x_wp_73_ok:
  s_add_u32 s95, s63, s93
  s_add_u32 s95, s95, 12288
  s_add_u32 m0, s94, 0
  s_add_u32 s28, s95, 0
  buffer_load_dwordx4 v132, s[8:11], s28 offen sc1 lds
  s_add_u32 m0, s94, 1024
  s_add_u32 s28, s95, 2048
  buffer_load_dwordx4 v132, s[8:11], s28 offen sc1 lds
  s_add_u32 m0, s94, 2048
  s_add_u32 s28, s95, 4096
  buffer_load_dwordx4 v132, s[8:11], s28 offen sc1 lds
  s_add_u32 m0, s94, 3072
  s_add_u32 s28, s95, 6144
  buffer_load_dwordx4 v132, s[8:11], s28 offen sc1 lds
  s_add_u32 m0, s94, 4096
  s_add_u32 s28, s95, 8192
  buffer_load_dwordx4 v132, s[8:11], s28 offen sc1 lds
  s_add_u32 m0, s94, 5120
  s_add_u32 s28, s95, 10240
  buffer_load_dwordx4 v132, s[8:11], s28 offen sc1 lds
  s_branch xq_72_j
xq_72:
  s_waitcnt vmcnt(0)
xq_72_j:
  s_waitcnt vmcnt(16)
  v_mfma_f32_16x16x32_bf16 v[112:115], v[76:79], v[44:47], 0
  v_mfma_f32_16x16x32_bf16 v[116:119], v[4:7], v[44:47], 0
  v_mfma_f32_16x16x32_bf16 v[120:123], v[8:11], v[44:47], 0
  s_waitcnt vmcnt(14)
  v_mfma_f32_16x16x32_bf16 v[112:115], v[80:83], v[48:51], v[112:115]
  v_mfma_f32_16x16x32_bf16 v[116:119], v[12:15], v[48:51], v[116:119]
  v_mfma_f32_16x16x32_bf16 v[120:123], v[16:19], v[48:51], v[120:123]
  s_waitcnt vmcnt(12)
  v_mfma_f32_16x16x32_bf16 v[112:115], v[84:87], v[52:55], v[112:115]
  v_mfma_f32_16x16x32_bf16 v[116:119], v[20:23], v[52:55], v[116:119]
  v_mfma_f32_16x16x32_bf16 v[120:123], v[24:27], v[52:55], v[120:123]
  s_waitcnt vmcnt(10)
  v_mfma_f32_16x16x32_bf16 v[112:115], v[88:91], v[56:59], v[112:115]
  v_mfma_f32_16x16x32_bf16 v[116:119], v[28:31], v[56:59], v[116:119]
  v_mfma_f32_16x16x32_bf16 v[120:123], v[32:35], v[56:59], v[120:123]
  s_waitcnt vmcnt(8)
  v_mfma_f32_16x16x32_bf16 v[112:115], v[92:95], v[68:71], v[112:115]
  v_mfma_f32_16x16x32_bf16 v[116:119], v[36:39], v[68:71], v[116:119]
  v_mfma_f32_16x16x32_bf16 v[120:123], v[40:43], v[68:71], v[120:123]
  s_waitcnt vmcnt(6)
  v_mfma_f32_16x16x32_bf16 v[112:115], v[96:99], v[72:75], v[112:115]
  v_mfma_f32_16x16x32_bf16 v[116:119], v[60:63], v[72:75], v[116:119]
  v_mfma_f32_16x16x32_bf16 v[120:123], v[64:67], v[72:75], v[120:123]
  s_nop 8
  v_cndmask_b32 v112, v135, v112, s[66:67]
  v_cndmask_b32 v113, v135, v113, s[66:67]
  v_cndmask_b32 v114, v135, v114, s[66:67]
  v_cndmask_b32 v115, v135, v115, s[66:67]
  v_cndmask_b32 v116, v135, v116, s[76:77]
  v_cndmask_b32 v120, v135, v120, s[84:85]
  v_cndmask_b32 v117, v135, v117, s[78:79]
  v_cndmask_b32 v121, v135, v121, s[86:87]
  v_cndmask_b32 v118, v135, v118, s[80:81]
  v_cndmask_b32 v122, v135, v122, s[88:89]
  v_cndmask_b32 v119, v135, v119, s[82:83]
  v_cndmask_b32 v123, v135, v123, s[90:91]
  v_max3_f32 v4, v112, v113, v114
  v_max3_f32 v5, v115, v116, v117
  v_max3_f32 v6, v118, v119, v120
  v_max3_f32 v7, v121, v122, v123
  v_max3_f32 v4, v4, v5, v6
  v_max_f32 v4, v4, v7
  v_mov_b32 v5, v4
  s_nop 1
  v_permlane16_swap_b32 v4, v5
  v_max_f32 v4, v4, v5
  v_mov_b32 v5, v4
  s_nop 1
  v_permlane32_swap_b32 v4, v5
  v_max_f32 v4, v4, v5
  v_mul_f32 v4, s64, v4
  v_fma_f32 v112, v112, s64, -v4
  v_fma_f32 v113, v113, s64, -v4
  v_fma_f32 v114, v114, s64, -v4
  v_fma_f32 v115, v115, s64, -v4
  v_fma_f32 v116, v116, s64, -v4
  v_fma_f32 v117, v117, s64, -v4
  v_fma_f32 v118, v118, s64, -v4
  v_fma_f32 v119, v119, s64, -v4
  v_fma_f32 v120, v120, s64, -v4
  v_fma_f32 v121, v121, s64, -v4
  v_fma_f32 v122, v122, s64, -v4
  v_fma_f32 v123, v123, s64, -v4
  v_exp_f32 v112, v112
  v_exp_f32 v113, v113
  v_exp_f32 v114, v114
  v_exp_f32 v115, v115
  v_exp_f32 v116, v116
  v_exp_f32 v117, v117
  v_exp_f32 v118, v118
  v_exp_f32 v119, v119
  v_exp_f32 v120, v120
  v_exp_f32 v121, v121
  v_exp_f32 v122, v122
  v_exp_f32 v123, v123
  v_add_f32 v5, v112, v113
  v_add_f32 v6, v114, v115
  v_add_f32 v7, v116, v117
  v_add_f32 v8, v118, v119
  v_add_f32 v9, v120, v121
  v_add_f32 v10, v122, v123
  v_add_f32 v5, v5, v6
  v_add_f32 v7, v7, v8
  v_add_f32 v9, v9, v10
  v_add_f32 v5, v5, v7
  v_add_f32 v5, v5, v9
  v_mov_b32 v6, v5
  s_nop 1
  v_permlane16_swap_b32 v5, v6
  v_add_f32 v5, v5, v6
  v_mov_b32 v6, v5
  s_nop 1
  v_permlane32_swap_b32 v5, v6
  v_add_f32 v5, v5, v6
  v_rcp_f32 v5, v5
  s_nop 0
  v_mul_f32 v112, v112, v5
  v_mul_f32 v113, v113, v5
  v_mul_f32 v114, v114, v5
  v_mul_f32 v115, v115, v5
  v_mul_f32 v116, v116, v5
  v_mul_f32 v117, v117, v5
  v_mul_f32 v118, v118, v5
  v_mul_f32 v119, v119, v5
  v_mul_f32 v120, v120, v5
  v_mul_f32 v121, v121, v5
  v_mul_f32 v122, v122, v5
  v_mul_f32 v123, v123, v5
  v_cvt_pk_bf16_f32 v8, v112, v113
  v_cvt_pk_bf16_f32 v9, v114, v115
  v_cvt_pk_bf16_f32 v10, v116, v117
  v_cvt_pk_bf16_f32 v11, v118, v119
  v_cvt_pk_bf16_f32 v12, v120, v121
  v_cvt_pk_bf16_f32 v13, v122, v123
  buffer_store_dwordx2 v[10:11], v133, s[8:11], s92 offen sc1
  buffer_store_dwordx2 v[12:13], v133, s[8:11], s92 offen offset:256 sc1
  buffer_store_dwordx2 v[8:9], v134, s[8:11], s92 offen sc1
  s_add_u32 s92, s92, 20480
  s_cmp_ge_u32 s51, 63
  s_cbranch_scc1 kas_x_done
  v_mov_b32 v60, 0
  v_mov_b32 v61, 0
  v_mov_b32 v62, 0
  v_mov_b32 v63, 0
  v_mov_b32 v64, 0
  v_mov_b32 v65, 0
  v_mov_b32 v66, 0
  v_mov_b32 v67, 0
  v_mov_b32 v68, 0
  v_mov_b32 v69, 0
  v_mov_b32 v70, 0
  v_mov_b32 v71, 0
  v_mov_b32 v72, 0
  v_mov_b32 v73, 0
  v_mov_b32 v74, 0
  v_mov_b32 v75, 0
  v_mov_b32 v36, 0
  v_mov_b32 v37, 0
  v_mov_b32 v38, 0
  v_mov_b32 v39, 0
  v_mov_b32 v40, 0
  v_mov_b32 v41, 0
  v_mov_b32 v42, 0
  v_mov_b32 v43, 0
  s_add_u32 s97, s97, 10240
  s_mov_b32 s48, s97
  s_add_u32 s49, s49, 5120
  s_add_u32 s50, s50, 12288
  s_add_u32 s63, s63, 12288
  s_add_u32 s51, s51, 1
  s_cmp_gt_u32 s52, s51
  s_cbranch_scc1 kas_x_wp_74_ok
  s_mov_b32 s45, 0
kas_x_wp_74_spin:
  buffer_load_dword v2, v138, s[8:11], 0 offen sc1
  s_add_u32 s45, s45, 1
  s_waitcnt vmcnt(0)
  v_min_u32_dpp v3, v2, v2 quad_perm:[1,0,3,2] row_mask:0xf bank_mask:0xf
  s_nop 1
  v_min_u32_dpp v2, v3, v3 quad_perm:[2,3,0,1] row_mask:0xf bank_mask:0xf
  s_nop 1
  v_min_u32_dpp v3, v2, v2 row_half_mirror row_mask:0xf bank_mask:0xf
  s_nop 1
  v_min_u32_dpp v2, v3, v3 quad_perm:[0,1,2,3] row_mask:0xf bank_mask:0xf
  s_nop 0
  v_readfirstlane_b32 s52, v2
  s_cmp_gt_u32 s52, s51
  s_cbranch_scc1 kas_x_wp_74_ok
  s_cmp_lt_u32 s45, 400000
  s_cbranch_scc1 kas_x_wp_74_spin
  s_branch kas_abort
kas_x_wp_74_ok:
  s_add_u32 s28, s50, s53
  buffer_load_dwordx2 v[88:89], v132, s[8:11], s28 offen offset:0 sc1
  buffer_load_dwordx2 v[92:93], v132, s[8:11], s28 offen offset:1024 sc1
  s_add_u32 s28, s50, s54
  buffer_load_dwordx2 v[90:91], v132, s[8:11], s28 offen offset:0 sc1
  buffer_load_dwordx2 v[94:95], v132, s[8:11], s28 offen offset:1024 sc1
  s_add_u32 s28, s50, s55
  buffer_load_dwordx2 v[96:97], v132, s[8:11], s28 offen offset:0 sc1
  buffer_load_dwordx2 v[98:99], v132, s[8:11], s28 offen offset:1024 sc1
  s_branch kas_x_w2l
kas_x_w3l:
  ds_read_b128 v[44:47], v129 offset:2048
  ds_read_b128 v[48:51], v129 offset:3072
  ds_read_b128 v[52:55], v129 offset:12288
  ds_read_b128 v[56:59], v129 offset:13312
  s_waitcnt lgkmcnt(0)
  s_mov_b32 s45, 0
kas_x_pf_75:
  buffer_load_dwordx4 v[112:115], v124, s[8:11], s48 offen sc1
  buffer_load_dwordx4 v[116:119], v125, s[8:11], s48 offen sc1
  s_add_u32 s45, s45, 1
  s_waitcnt vmcnt(1)
  ds_write_b128 v127, v[112:115] offset:0
  v_max3_u32 v139, v112, v113, v114
  v_max_u32 v139, v139, v115
  s_waitcnt vmcnt(0)
  ds_write_b128 v127, v[116:119] offset:4096
  v_max3_u32 v139, v139, v116, v117
  v_max3_u32 v139, v139, v118, v119
  v_cmp_eq_u32 vcc, -1, v139
  s_cbranch_vccz kas_x_pf_75_ok
  s_cmp_lt_u32 s45, 400000
  s_cbranch_scc1 kas_x_pf_75
  s_branch kas_abort
kas_x_pf_75_ok:
  v_smfmac_f32_16x16x64_bf16 v[60:63], v[112:115], a[24:31], v110
  v_smfmac_f32_16x16x64_bf16 v[64:67], v[112:115], v[44:51], v110
  ds_read_b128 v[44:47], v129 offset:22528
  v_smfmac_f32_16x16x64_bf16 v[68:71], v[112:115], a[104:111], v110
  ds_read_b128 v[48:51], v129 offset:23552
  v_smfmac_f32_16x16x64_bf16 v[72:75], v[112:115], v[52:59], v110
  ds_read_b128 v[52:55], v129 offset:6144
  s_waitcnt lgkmcnt(3)
  s_barrier
  v_smfmac_f32_16x16x64_bf16 v[36:39], v[112:115], a[184:191], v110
  ds_read_b128 v[56:59], v129 offset:7168
  ds_read_b128 v[4:7], v128 offset:0
  s_waitcnt lgkmcnt(3)
  v_smfmac_f32_16x16x64_bf16 v[40:43], v[112:115], v[44:51], v110
  ds_read_b128 v[44:47], v129 offset:16384
  ds_read_b128 v[8:11], v128 offset:1024
  v_smfmac_f32_16x16x64_bf16 v[60:63], v[116:119], a[56:63], v110
  ds_read_b128 v[48:51], v129 offset:17408
  ds_read_b128 v[12:15], v128 offset:2048
  s_waitcnt lgkmcnt(5)
  v_smfmac_f32_16x16x64_bf16 v[64:67], v[116:119], v[52:59], v110
  ds_read_b128 v[52:55], v129 offset:26624
  ds_read_b128 v[16:19], v128 offset:4096
  v_smfmac_f32_16x16x64_bf16 v[68:71], v[116:119], a[136:143], v110
  ds_read_b128 v[56:59], v129 offset:27648
  ds_read_b128 v[20:23], v128 offset:5120
  s_waitcnt lgkmcnt(5)
  v_smfmac_f32_16x16x64_bf16 v[72:75], v[116:119], v[44:51], v110
  ds_read_b128 v[44:47], v129 offset:0
  ds_read_b128 v[24:27], v128 offset:6144
  v_smfmac_f32_16x16x64_bf16 v[36:39], v[116:119], a[216:223], v110
  ds_read_b128 v[48:51], v129 offset:1024
  ds_read_b128 v[28:31], v128 offset:8192
  s_waitcnt lgkmcnt(5)
  v_smfmac_f32_16x16x64_bf16 v[40:43], v[116:119], v[52:59], v110
  ds_read_b128 v[52:55], v129 offset:4096
  ds_read_b128 v[32:35], v128 offset:9216
  v_smfmac_f32_16x16x64_bf16 v[60:63], v[4:7], a[0:7], v110
  ds_read_b128 v[56:59], v129 offset:5120
  v_smfmac_f32_16x16x64_bf16 v[64:67], v[4:7], a[240:247], v110
  v_smfmac_f32_16x16x64_bf16 v[60:63], v[8:11], a[8:15], v110
  s_waitcnt lgkmcnt(4)
  v_smfmac_f32_16x16x64_bf16 v[64:67], v[8:11], v[44:51], v110
  ds_read_b128 v[44:47], v129 offset:8192
  v_smfmac_f32_16x16x64_bf16 v[60:63], v[12:15], a[16:23], v110
  ds_read_b128 v[48:51], v129 offset:9216
  v_smfmac_f32_16x16x64_bf16 v[64:67], v[12:15], a[248:255], v110
  v_smfmac_f32_16x16x64_bf16 v[60:63], v[16:19], a[32:39], v110
  v_smfmac_f32_16x16x64_bf16 v[64:67], v[16:19], v[152:159], v110
  v_smfmac_f32_16x16x64_bf16 v[60:63], v[20:23], a[40:47], v110
  s_waitcnt lgkmcnt(2)
  v_smfmac_f32_16x16x64_bf16 v[64:67], v[20:23], v[52:59], v110
  ds_read_b128 v[52:55], v129 offset:10240
  v_smfmac_f32_16x16x64_bf16 v[60:63], v[24:27], a[48:55], v110
  ds_read_b128 v[56:59], v129 offset:11264
  v_smfmac_f32_16x16x64_bf16 v[64:67], v[24:27], v[160:167], v110
  v_smfmac_f32_16x16x64_bf16 v[60:63], v[28:31], a[64:71], v110
  v_smfmac_f32_16x16x64_bf16 v[64:67], v[28:31], v[168:175], v110
  v_smfmac_f32_16x16x64_bf16 v[60:63], v[32:35], a[72:79], v110
  s_waitcnt lgkmcnt(2)
  v_smfmac_f32_16x16x64_bf16 v[64:67], v[32:35], v[44:51], v110
  ds_read_b128 v[44:47], v129 offset:14336
  v_smfmac_f32_16x16x64_bf16 v[68:71], v[4:7], a[80:87], v110
  ds_read_b128 v[48:51], v129 offset:15360
  v_smfmac_f32_16x16x64_bf16 v[72:75], v[4:7], v[176:183], v110
  v_permlane32_swap_b32 v60, v64
  v_smfmac_f32_16x16x64_bf16 v[68:71], v[8:11], a[88:95], v110
  s_waitcnt lgkmcnt(2)
  v_smfmac_f32_16x16x64_bf16 v[72:75], v[8:11], v[52:59], v110
  ds_read_b128 v[52:55], v129 offset:18432
  v_permlane32_swap_b32 v61, v65
  v_smfmac_f32_16x16x64_bf16 v[68:71], v[12:15], a[96:103], v110
  ds_read_b128 v[56:59], v129 offset:19456
  v_smfmac_f32_16x16x64_bf16 v[72:75], v[12:15], v[184:191], v110
  v_permlane32_swap_b32 v62, v66
  v_smfmac_f32_16x16x64_bf16 v[68:71], v[16:19], a[112:119], v110
  v_permlane32_swap_b32 v63, v67
  v_smfmac_f32_16x16x64_bf16 v[72:75], v[16:19], v[192:199], v110
  v_add_f32 v60, v60, v64
  v_smfmac_f32_16x16x64_bf16 v[68:71], v[20:23], a[120:127], v110
  v_add_f32 v61, v61, v65
  s_waitcnt lgkmcnt(2)
  v_smfmac_f32_16x16x64_bf16 v[72:75], v[20:23], v[44:51], v110
  ds_read_b128 v[44:47], v129 offset:20480
  v_add_f32 v62, v62, v66
  v_smfmac_f32_16x16x64_bf16 v[68:71], v[24:27], a[128:135], v110
  ds_read_b128 v[48:51], v129 offset:21504
  v_add_f32 v63, v63, v67
  v_smfmac_f32_16x16x64_bf16 v[72:75], v[24:27], v[200:207], v110
  v_cvt_pk_bf16_f32 v100, v60, v61
  v_smfmac_f32_16x16x64_bf16 v[68:71], v[28:31], a[144:151], v110
  v_cvt_pk_bf16_f32 v101, v62, v63
  v_smfmac_f32_16x16x64_bf16 v[72:75], v[28:31], v[208:215], v110
  v_smfmac_f32_16x16x64_bf16 v[68:71], v[32:35], a[152:159], v110
  s_waitcnt lgkmcnt(2)
  v_smfmac_f32_16x16x64_bf16 v[72:75], v[32:35], v[52:59], v110
  ds_read_b128 v[52:55], v129 offset:24576
  v_smfmac_f32_16x16x64_bf16 v[36:39], v[4:7], a[160:167], v110
  ds_read_b128 v[56:59], v129 offset:25600
  v_smfmac_f32_16x16x64_bf16 v[40:43], v[4:7], v[216:223], v110
  v_permlane32_swap_b32 v68, v72
  v_smfmac_f32_16x16x64_bf16 v[36:39], v[8:11], a[168:175], v110
  s_waitcnt lgkmcnt(2)
  v_smfmac_f32_16x16x64_bf16 v[40:43], v[8:11], v[44:51], v110
  ds_read_b128 v[44:47], v129 offset:28672
  v_permlane32_swap_b32 v69, v73
  v_smfmac_f32_16x16x64_bf16 v[36:39], v[12:15], a[176:183], v110
  ds_read_b128 v[48:51], v129 offset:29696
  v_smfmac_f32_16x16x64_bf16 v[40:43], v[12:15], v[224:231], v110
  v_permlane32_swap_b32 v70, v74
  v_smfmac_f32_16x16x64_bf16 v[36:39], v[16:19], a[192:199], v110
  v_permlane32_swap_b32 v71, v75
  v_smfmac_f32_16x16x64_bf16 v[40:43], v[16:19], v[232:239], v110
  v_add_f32 v68, v68, v72
  v_smfmac_f32_16x16x64_bf16 v[36:39], v[20:23], a[200:207], v110
  v_add_f32 v69, v69, v73
  s_waitcnt lgkmcnt(2)
  v_smfmac_f32_16x16x64_bf16 v[40:43], v[20:23], v[52:59], v110
  v_add_f32 v70, v70, v74
  v_smfmac_f32_16x16x64_bf16 v[36:39], v[24:27], a[208:215], v110
  v_add_f32 v71, v71, v75
  v_smfmac_f32_16x16x64_bf16 v[40:43], v[24:27], v[240:247], v110
  v_cvt_pk_bf16_f32 v102, v68, v69
  v_smfmac_f32_16x16x64_bf16 v[36:39], v[28:31], a[224:231], v110
  v_cvt_pk_bf16_f32 v103, v70, v71
  v_smfmac_f32_16x16x64_bf16 v[40:43], v[28:31], v[248:255], v110
  v_smfmac_f32_16x16x64_bf16 v[36:39], v[32:35], a[232:239], v110
  s_waitcnt lgkmcnt(0)
  v_smfmac_f32_16x16x64_bf16 v[40:43], v[32:35], v[44:51], v110
  v_mfma_f32_16x16x16_bf16 v[142:145], v[100:101], v[108:109], 0
  v_mfma_f32_16x16x16_bf16 v[146:149], v[102:103], v[108:109], 0
  s_nop 1
  v_permlane32_swap_b32 v36, v40
  v_permlane32_swap_b32 v37, v41
  v_permlane32_swap_b32 v38, v42
  v_permlane32_swap_b32 v39, v43
  v_add_f32 v36, v36, v40
  v_add_f32 v37, v37, v41
  v_add_f32 v38, v38, v42
  v_add_f32 v39, v39, v43
  v_cvt_pk_bf16_f32 v104, v36, v37
  v_cvt_pk_bf16_f32 v105, v38, v39
  v_cvt_pk_bf16_f32 v44, v142, v143
  v_cvt_pk_bf16_f32 v45, v144, v145
  v_mfma_f32_16x16x16_bf16 v[142:145], v[104:105], v[108:109], 0
  v_cvt_pk_bf16_f32 v46, v146, v147
  v_cvt_pk_bf16_f32 v47, v148, v149
  ds_write_b64 v131, v[44:45]
  ds_write_b64 v131, v[46:47] offset:512
  v_mfma_f32_16x16x32_bf16 v[76:79], v[44:47], v[44:47], 0
  v_mfma_f32_16x16x32_bf16 v[80:83], v[88:91], v[44:47], 0
  v_mfma_f32_16x16x32_bf16 v[84:87], v[92:95], v[44:47], 0
  v_cvt_pk_bf16_f32 v106, v142, v143
  v_cvt_pk_bf16_f32 v107, v144, v145
  ds_write_b64 v131, v[106:107] offset:1024
  s_nop 0
  v_mfma_f32_16x16x16_bf16 v[76:79], v[106:107], v[106:107], v[76:79]
  v_mfma_f32_16x16x16_bf16 v[80:83], v[96:97], v[106:107], v[80:83]
  v_mfma_f32_16x16x16_bf16 v[84:87], v[98:99], v[106:107], v[84:87]
  s_nop 6
  ds_write_b128 v130, v[76:79] offset:0
  ds_write_b128 v130, v[80:83] offset:1024
  s_nop 0
  ds_write_b128 v130, v[84:87] offset:2048
  s_mov_b32 s28, s50
  buffer_load_dwordx4 v[4:7], v132, s[8:11], s28 offen sc1
  buffer_load_dwordx4 v[8:11], v132, s[8:11], s28 offen offset:1024 sc1
  s_add_u32 s28, s28, 2048
  buffer_load_dwordx4 v[12:15], v132, s[8:11], s28 offen sc1
  buffer_load_dwordx4 v[16:19], v132, s[8:11], s28 offen offset:1024 sc1
  s_add_u32 s28, s28, 2048
  buffer_load_dwordx4 v[20:23], v132, s[8:11], s28 offen sc1
  buffer_load_dwordx4 v[24:27], v132, s[8:11], s28 offen offset:1024 sc1
  s_add_u32 s28, s28, 2048
  buffer_load_dwordx4 v[28:31], v132, s[8:11], s28 offen sc1
  buffer_load_dwordx4 v[32:35], v132, s[8:11], s28 offen offset:1024 sc1
  s_add_u32 s28, s28, 2048
  buffer_load_dwordx4 v[36:39], v132, s[8:11], s28 offen sc1
  buffer_load_dwordx4 v[40:43], v132, s[8:11], s28 offen offset:1024 sc1
  s_add_u32 s28, s28, 2048
  buffer_load_dwordx4 v[60:63], v132, s[8:11], s28 offen sc1
  buffer_load_dwordx4 v[64:67], v132, s[8:11], s28 offen offset:1024 sc1
  s_add_u32 s28, s28, 2048
  s_waitcnt lgkmcnt(0)
  s_barrier
  ds_read_b64 v[76:77], v136 offset:0
  ds_read_b64 v[78:79], v136 offset:512
  ds_read_b64 v[80:81], v136 offset:1024
  ds_read_b64 v[82:83], v136 offset:1536
  ds_read_b64 v[84:85], v136 offset:2048
  ds_read_b64 v[86:87], v136 offset:2560
  ds_read_b64 v[88:89], v136 offset:3072
  ds_read_b64 v[90:91], v136 offset:3584
  ds_read_b64 v[92:93], v136 offset:4096
  ds_read_b64 v[94:95], v136 offset:4608
  ds_read_b64 v[96:97], v136 offset:5120
  ds_read_b64 v[98:99], v136 offset:5632
  ds_read_b128 v[44:47], v137 offset:0
  ds_read_b128 v[48:51], v137 offset:1024
  ds_read_b128 v[52:55], v137 offset:2048
  s_waitcnt lgkmcnt(3)
  ds_read_b128 v[56:59], v137 offset:3072
  ds_read_b128 v[68:71], v137 offset:4096
  ds_read_b128 v[72:75], v137 offset:5120
  s_waitcnt lgkmcnt(0)
  s_cmp_ge_u32 s51, 63
  s_cbranch_scc1 xq_76
  s_add_u32 s96, s51, 1
  s_cmp_gt_u32 s52, s96
  s_cbranch_scc1 kas_x_wp_77_ok
  s_mov_b32 s45, 0
kas_x_wp_77_spin:
  buffer_load_dword v2, v138, s[8:11], 0 offen sc1
  s_add_u32 s45, s45, 1
  s_waitcnt vmcnt(0)
  v_min_u32_dpp v3, v2, v2 quad_perm:[1,0,3,2] row_mask:0xf bank_mask:0xf
  s_nop 1
  v_min_u32_dpp v2, v3, v3 quad_perm:[2,3,0,1] row_mask:0xf bank_mask:0xf
  s_nop 1
  v_min_u32_dpp v3, v2, v2 row_half_mirror row_mask:0xf bank_mask:0xf
  s_nop 1
  v_min_u32_dpp v2, v3, v3 quad_perm:[0,1,2,3] row_mask:0xf bank_mask:0xf
  s_nop 0
  v_readfirstlane_b32 s52, v2
  s_cmp_gt_u32 s52, s96
  s_cbranch_scc1 kas_x_wp_77_ok
  s_cmp_lt_u32 s45, 400000
  s_cbranch_scc1 kas_x_wp_77_spin
  s_branch kas_abort
kas_x_wp_77_ok:
  s_add_u32 s95, s63, s93
  s_add_u32 s95, s95, 12288
  s_add_u32 m0, s94, 0
  s_add_u32 s28, s95, 0
  buffer_load_dwordx4 v132, s[8:11], s28 offen sc1 lds
  s_add_u32 m0, s94, 1024
  s_add_u32 s28, s95, 2048
  buffer_load_dwordx4 v132, s[8:11], s28 offen sc1 lds
  s_add_u32 m0, s94, 2048
  s_add_u32 s28, s95, 4096
  buffer_load_dwordx4 v132, s[8:11], s28 offen sc1 lds
  s_add_u32 m0, s94, 3072
  s_add_u32 s28, s95, 6144
  buffer_load_dwordx4 v132, s[8:11], s28 offen sc1 lds
  s_add_u32 m0, s94, 4096
  s_add_u32 s28, s95, 8192
  buffer_load_dwordx4 v132, s[8:11], s28 offen sc1 lds
  s_add_u32 m0, s94, 5120
  s_add_u32 s28, s95, 10240
  buffer_load_dwordx4 v132, s[8:11], s28 offen sc1 lds
  s_branch xq_76_j
xq_76:
  s_waitcnt vmcnt(0)
xq_76_j:
  s_waitcnt vmcnt(16)
  v_mfma_f32_16x16x32_bf16 v[112:115], v[76:79], v[44:47], 0
  v_mfma_f32_16x16x32_bf16 v[116:119], v[4:7], v[44:47], 0
  v_mfma_f32_16x16x32_bf16 v[120:123], v[8:11], v[44:47], 0
  s_waitcnt vmcnt(14)
  v_mfma_f32_16x16x32_bf16 v[112:115], v[80:83], v[48:51], v[112:115]
  v_mfma_f32_16x16x32_bf16 v[116:119], v[12:15], v[48:51], v[116:119]
  v_mfma_f32_16x16x32_bf16 v[120:123], v[16:19], v[48:51], v[120:123]
  s_waitcnt vmcnt(12)
  v_mfma_f32_16x16x32_bf16 v[112:115], v[84:87], v[52:55], v[112:115]
  v_mfma_f32_16x16x32_bf16 v[116:119], v[20:23], v[52:55], v[116:119]
  v_mfma_f32_16x16x32_bf16 v[120:123], v[24:27], v[52:55], v[120:123]
  s_waitcnt vmcnt(10)
  v_mfma_f32_16x16x32_bf16 v[112:115], v[88:91], v[56:59], v[112:115]
  v_mfma_f32_16x16x32_bf16 v[116:119], v[28:31], v[56:59], v[116:119]
  v_mfma_f32_16x16x32_bf16 v[120:123], v[32:35], v[56:59], v[120:123]
  s_waitcnt vmcnt(8)
  v_mfma_f32_16x16x32_bf16 v[112:115], v[92:95], v[68:71], v[112:115]
  v_mfma_f32_16x16x32_bf16 v[116:119], v[36:39], v[68:71], v[116:119]
  v_mfma_f32_16x16x32_bf16 v[120:123], v[40:43], v[68:71], v[120:123]
  s_waitcnt vmcnt(6)
  v_mfma_f32_16x16x32_bf16 v[112:115], v[96:99], v[72:75], v[112:115]
  v_mfma_f32_16x16x32_bf16 v[116:119], v[60:63], v[72:75], v[116:119]
  v_mfma_f32_16x16x32_bf16 v[120:123], v[64:67], v[72:75], v[120:123]
  s_nop 8
  v_cndmask_b32 v112, v135, v112, s[66:67]
  v_cndmask_b32 v113, v135, v113, s[66:67]
  v_cndmask_b32 v114, v135, v114, s[66:67]
  v_cndmask_b32 v115, v135, v115, s[66:67]
  v_cndmask_b32 v116, v135, v116, s[76:77]
  v_cndmask_b32 v120, v135, v120, s[84:85]
  v_cndmask_b32 v117, v135, v117, s[78:79]
  v_cndmask_b32 v121, v135, v121, s[86:87]
  v_cndmask_b32 v118, v135, v118, s[80:81]
  v_cndmask_b32 v122, v135, v122, s[88:89]
  v_cndmask_b32 v119, v135, v119, s[82:83]
  v_cndmask_b32 v123, v135, v123, s[90:91]
  v_max3_f32 v4, v112, v113, v114
  v_max3_f32 v5, v115, v116, v117
  v_max3_f32 v6, v118, v119, v120
  v_max3_f32 v7, v121, v122, v123
  v_max3_f32 v4, v4, v5, v6
  v_max_f32 v4, v4, v7
  v_mov_b32 v5, v4
  s_nop 1
  v_permlane16_swap_b32 v4, v5
  v_max_f32 v4, v4, v5
  v_mov_b32 v5, v4
  s_nop 1
  v_permlane32_swap_b32 v4, v5
  v_max_f32 v4, v4, v5
  v_mul_f32 v4, s64, v4
  v_fma_f32 v112, v112, s64, -v4
  v_fma_f32 v113, v113, s64, -v4
  v_fma_f32 v114, v114, s64, -v4
  v_fma_f32 v115, v115, s64, -v4
  v_fma_f32 v116, v116, s64, -v4
  v_fma_f32 v117, v117, s64, -v4
  v_fma_f32 v118, v118, s64, -v4
  v_fma_f32 v119, v119, s64, -v4
  v_fma_f32 v120, v120, s64, -v4
  v_fma_f32 v121, v121, s64, -v4
  v_fma_f32 v122, v122, s64, -v4
  v_fma_f32 v123, v123, s64, -v4
  v_exp_f32 v112, v112
  v_exp_f32 v113, v113
  v_exp_f32 v114, v114
  v_exp_f32 v115, v115
  v_exp_f32 v116, v116
  v_exp_f32 v117, v117
  v_exp_f32 v118, v118
  v_exp_f32 v119, v119
  v_exp_f32 v120, v120
  v_exp_f32 v121, v121
  v_exp_f32 v122, v122
  v_exp_f32 v123, v123
  v_add_f32 v5, v112, v113
  v_add_f32 v6, v114, v115
  v_add_f32 v7, v116, v117
  v_add_f32 v8, v118, v119
  v_add_f32 v9, v120, v121
  v_add_f32 v10, v122, v123
  v_add_f32 v5, v5, v6
  v_add_f32 v7, v7, v8
  v_add_f32 v9, v9, v10
  v_add_f32 v5, v5, v7
  v_add_f32 v5, v5, v9
  v_mov_b32 v6, v5
  s_nop 1
  v_permlane16_swap_b32 v5, v6
  v_add_f32 v5, v5, v6
  v_mov_b32 v6, v5
  s_nop 1
  v_permlane32_swap_b32 v5, v6
  v_add_f32 v5, v5, v6
  v_rcp_f32 v5, v5
  s_nop 0
  v_mul_f32 v112, v112, v5
  v_mul_f32 v113, v113, v5
  v_mul_f32 v114, v114, v5
  v_mul_f32 v115, v115, v5
  v_mul_f32 v116, v116, v5
  v_mul_f32 v117, v117, v5
  v_mul_f32 v118, v118, v5
  v_mul_f32 v119, v119, v5
  v_mul_f32 v120, v120, v5
  v_mul_f32 v121, v121, v5
  v_mul_f32 v122, v122, v5
  v_mul_f32 v123, v123, v5
  v_cvt_pk_bf16_f32 v8, v112, v113
  v_cvt_pk_bf16_f32 v9, v114, v115
  v_cvt_pk_bf16_f32 v10, v116, v117
  v_cvt_pk_bf16_f32 v11, v118, v119
  v_cvt_pk_bf16_f32 v12, v120, v121
  v_cvt_pk_bf16_f32 v13, v122, v123
  buffer_store_dwordx2 v[10:11], v133, s[8:11], s92 offen sc1
  buffer_store_dwordx2 v[12:13], v133, s[8:11], s92 offen offset:256 sc1
  buffer_store_dwordx2 v[8:9], v134, s[8:11], s92 offen sc1
  s_add_u32 s92, s92, 20480
  s_cmp_ge_u32 s51, 63
  s_cbranch_scc1 kas_x_done
  v_mov_b32 v60, 0
  v_mov_b32 v61, 0
  v_mov_b32 v62, 0
  v_mov_b32 v63, 0
  v_mov_b32 v64, 0
  v_mov_b32 v65, 0
  v_mov_b32 v66, 0
  v_mov_b32 v67, 0
  v_mov_b32 v68, 0
  v_mov_b32 v69, 0
  v_mov_b32 v70, 0
  v_mov_b32 v71, 0
  v_mov_b32 v72, 0
  v_mov_b32 v73, 0
  v_mov_b32 v74, 0
  v_mov_b32 v75, 0
  v_mov_b32 v36, 0
  v_mov_b32 v37, 0
  v_mov_b32 v38, 0
  v_mov_b32 v39, 0
  v_mov_b32 v40, 0
  v_mov_b32 v41, 0
  v_mov_b32 v42, 0
  v_mov_b32 v43, 0
  s_add_u32 s97, s97, 10240
  s_mov_b32 s48, s97
  s_add_u32 s49, s49, 5120
  s_add_u32 s50, s50, 12288
  s_add_u32 s63, s63, 12288
  s_add_u32 s51, s51, 1
  s_cmp_gt_u32 s52, s51
  s_cbranch_scc1 kas_x_wp_78_ok
  s_mov_b32 s45, 0
kas_x_wp_78_spin:
  buffer_load_dword v2, v138, s[8:11], 0 offen sc1
  s_add_u32 s45, s45, 1
  s_waitcnt vmcnt(0)
  v_min_u32_dpp v3, v2, v2 quad_perm:[1,0,3,2] row_mask:0xf bank_mask:0xf
  s_nop 1
  v_min_u32_dpp v2, v3, v3 quad_perm:[2,3,0,1] row_mask:0xf bank_mask:0xf
  s_nop 1
  v_min_u32_dpp v3, v2, v2 row_half_mirror row_mask:0xf bank_mask:0xf
  s_nop 1
  v_min_u32_dpp v2, v3, v3 quad_perm:[0,1,2,3] row_mask:0xf bank_mask:0xf
  s_nop 0
  v_readfirstlane_b32 s52, v2
  s_cmp_gt_u32 s52, s51
  s_cbranch_scc1 kas_x_wp_78_ok
  s_cmp_lt_u32 s45, 400000
  s_cbranch_scc1 kas_x_wp_78_spin
  s_branch kas_abort
kas_x_wp_78_ok:
  s_add_u32 s28, s50, s53
  buffer_load_dwordx2 v[88:89], v132, s[8:11], s28 offen offset:0 sc1
  buffer_load_dwordx2 v[92:93], v132, s[8:11], s28 offen offset:1024 sc1
  s_add_u32 s28, s50, s54
  buffer_load_dwordx2 v[90:91], v132, s[8:11], s28 offen offset:0 sc1
  buffer_load_dwordx2 v[94:95], v132, s[8:11], s28 offen offset:1024 sc1
  s_add_u32 s28, s50, s55
  buffer_load_dwordx2 v[96:97], v132, s[8:11], s28 offen offset:0 sc1
  buffer_load_dwordx2 v[98:99], v132, s[8:11], s28 offen offset:1024 sc1
  s_branch kas_x_w3l
kas_x_done:
  s_waitcnt vmcnt(0) lgkmcnt(0)
  s_branch kas_exit
kas_y:
  v_and_b32 v1, 63, v0
  v_lshlrev_b32 v178, 4, v1
  s_and_b32 s28, s21, 1
  s_lshl_b32 s46, s23, 1
  s_add_u32 s46, s46, s28
  s_lshr_b32 s28, s21, 1
  s_lshl_b32 s28, s28, 2
  s_lshl_b32 s47, s20, 3
  s_add_u32 s47, s47, s28
  s_mul_i32 s28, s47, 40
  s_add_u32 s28, s28, s46
  s_mul_i32 s28, s28, 20480
  s_add_u32 s28, s28, 0x2e00000
  s_add_u32 s29, s28, 0
  buffer_load_dwordx4 a[0:3], v178, s[8:11], s29 offen
  buffer_load_dwordx4 a[4:7], v178, s[8:11], s29 offen offset:1024
  s_add_u32 s29, s28, 2048
  buffer_load_dwordx4 a[8:11], v178, s[8:11], s29 offen
  buffer_load_dwordx4 a[12:15], v178, s[8:11], s29 offen offset:1024
  s_add_u32 s29, s28, 4096
  buffer_load_dwordx4 a[16:19], v178, s[8:11], s29 offen
  buffer_load_dwordx4 a[20:23], v178, s[8:11], s29 offen offset:1024
  s_add_u32 s29, s28, 6144
  buffer_load_dwordx4 a[24:27], v178, s[8:11], s29 offen
  buffer_load_dwordx4 a[28:31], v178, s[8:11], s29 offen offset:1024
  s_add_u32 s29, s28, 8192
  buffer_load_dwordx4 a[32:35], v178, s[8:11], s29 offen
  buffer_load_dwordx4 a[36:39], v178, s[8:11], s29 offen offset:1024
  s_add_u32 s29, s28, 10240
  buffer_load_dwordx4 a[40:43], v178, s[8:11], s29 offen
  buffer_load_dwordx4 a[44:47], v178, s[8:11], s29 offen offset:1024
  s_add_u32 s29, s28, 12288
  buffer_load_dwordx4 a[48:51], v178, s[8:11], s29 offen
  buffer_load_dwordx4 a[52:55], v178, s[8:11], s29 offen offset:1024
  s_add_u32 s29, s28, 14336
  buffer_load_dwordx4 a[56:59], v178, s[8:11], s29 offen
  buffer_load_dwordx4 a[60:63], v178, s[8:11], s29 offen offset:1024
  s_add_u32 s29, s28, 16384
  buffer_load_dwordx4 a[64:67], v178, s[8:11], s29 offen
  buffer_load_dwordx4 a[68:71], v178, s[8:11], s29 offen offset:1024
  s_add_u32 s29, s28, 18432
  buffer_load_dwordx4 a[72:75], v178, s[8:11], s29 offen
  buffer_load_dwordx4 a[76:79], v178, s[8:11], s29 offen offset:1024
  s_add_u32 s29, s28, 819200
  buffer_load_dwordx4 a[80:83], v178, s[8:11], s29 offen
  buffer_load_dwordx4 a[84:87], v178, s[8:11], s29 offen offset:1024
  s_add_u32 s29, s28, 821248
  buffer_load_dwordx4 a[88:91], v178, s[8:11], s29 offen
  buffer_load_dwordx4 a[92:95], v178, s[8:11], s29 offen offset:1024
  s_add_u32 s29, s28, 823296
  buffer_load_dwordx4 a[96:99], v178, s[8:11], s29 offen
  buffer_load_dwordx4 a[100:103], v178, s[8:11], s29 offen offset:1024
  s_add_u32 s29, s28, 825344
  buffer_load_dwordx4 a[104:107], v178, s[8:11], s29 offen
  buffer_load_dwordx4 a[108:111], v178, s[8:11], s29 offen offset:1024
  s_add_u32 s29, s28, 827392
  buffer_load_dwordx4 a[112:115], v178, s[8:11], s29 offen
  buffer_load_dwordx4 a[116:119], v178, s[8:11], s29 offen offset:1024
  s_add_u32 s29, s28, 829440
  buffer_load_dwordx4 a[120:123], v178, s[8:11], s29 offen
  buffer_load_dwordx4 a[124:127], v178, s[8:11], s29 offen offset:1024
  s_add_u32 s29, s28, 831488
  buffer_load_dwordx4 a[128:131], v178, s[8:11], s29 offen
  buffer_load_dwordx4 a[132:135], v178, s[8:11], s29 offen offset:1024
  s_add_u32 s29, s28, 833536
  buffer_load_dwordx4 a[136:139], v178, s[8:11], s29 offen
  buffer_load_dwordx4 a[140:143], v178, s[8:11], s29 offen offset:1024
  s_add_u32 s29, s28, 835584
  buffer_load_dwordx4 a[144:147], v178, s[8:11], s29 offen
  buffer_load_dwordx4 a[148:151], v178, s[8:11], s29 offen offset:1024
  s_add_u32 s29, s28, 837632
  buffer_load_dwordx4 a[152:155], v178, s[8:11], s29 offen
  buffer_load_dwordx4 a[156:159], v178, s[8:11], s29 offen offset:1024
  s_waitcnt vmcnt(30)
  s_add_u32 s29, s28, 1638400
  buffer_load_dwordx4 a[160:163], v178, s[8:11], s29 offen
  buffer_load_dwordx4 a[164:167], v178, s[8:11], s29 offen offset:1024
  s_add_u32 s29, s28, 1640448
  buffer_load_dwordx4 a[168:171], v178, s[8:11], s29 offen
  buffer_load_dwordx4 a[172:175], v178, s[8:11], s29 offen offset:1024
  s_add_u32 s29, s28, 1642496
  buffer_load_dwordx4 a[176:179], v178, s[8:11], s29 offen
  buffer_load_dwordx4 a[180:183], v178, s[8:11], s29 offen offset:1024
  s_add_u32 s29, s28, 1644544
  buffer_load_dwordx4 a[184:187], v178, s[8:11], s29 offen
  buffer_load_dwordx4 a[188:191], v178, s[8:11], s29 offen offset:1024
  s_add_u32 s29, s28, 1646592
  buffer_load_dwordx4 a[192:195], v178, s[8:11], s29 offen
  buffer_load_dwordx4 a[196:199], v178, s[8:11], s29 offen offset:1024
  s_add_u32 s29, s28, 1648640
  buffer_load_dwordx4 a[200:203], v178, s[8:11], s29 offen
  buffer_load_dwordx4 a[204:207], v178, s[8:11], s29 offen offset:1024
  s_add_u32 s29, s28, 1650688
  buffer_load_dwordx4 a[208:211], v178, s[8:11], s29 offen
  buffer_load_dwordx4 a[212:215], v178, s[8:11], s29 offen offset:1024
  s_add_u32 s29, s28, 1652736
  buffer_load_dwordx4 a[216:219], v178, s[8:11], s29 offen
  buffer_load_dwordx4 a[220:223], v178, s[8:11], s29 offen offset:1024
  s_add_u32 s29, s28, 1654784
  buffer_load_dwordx4 a[224:227], v178, s[8:11], s29 offen
  buffer_load_dwordx4 a[228:231], v178, s[8:11], s29 offen offset:1024
  s_add_u32 s29, s28, 1656832
  buffer_load_dwordx4 a[232:235], v178, s[8:11], s29 offen
  buffer_load_dwordx4 a[236:239], v178, s[8:11], s29 offen offset:1024
  s_waitcnt vmcnt(30)
  s_add_u32 s29, s28, 2457600
  buffer_load_dwordx4 a[240:243], v178, s[8:11], s29 offen
  buffer_load_dwordx4 a[244:247], v178, s[8:11], s29 offen offset:1024
  s_add_u32 s29, s28, 2459648
  buffer_load_dwordx4 a[248:251], v178, s[8:11], s29 offen
  buffer_load_dwordx4 a[252:255], v178, s[8:11], s29 offen offset:1024
  s_add_u32 s29, s28, 2461696
  buffer_load_dwordx4 v[192:195], v178, s[8:11], s29 offen
  buffer_load_dwordx4 v[196:199], v178, s[8:11], s29 offen offset:1024
  s_add_u32 s29, s28, 2463744
  buffer_load_dwordx4 v[200:203], v178, s[8:11], s29 offen
  buffer_load_dwordx4 v[204:207], v178, s[8:11], s29 offen offset:1024
  s_add_u32 s29, s28, 2465792
  buffer_load_dwordx4 v[208:211], v178, s[8:11], s29 offen
  buffer_load_dwordx4 v[212:215], v178, s[8:11], s29 offen offset:1024
  s_add_u32 s29, s28, 2467840
  buffer_load_dwordx4 v[216:219], v178, s[8:11], s29 offen
  buffer_load_dwordx4 v[220:223], v178, s[8:11], s29 offen offset:1024
  s_add_u32 s29, s28, 2469888
  buffer_load_dwordx4 v[224:227], v178, s[8:11], s29 offen
  buffer_load_dwordx4 v[228:231], v178, s[8:11], s29 offen offset:1024
  s_add_u32 s29, s28, 2471936
  buffer_load_dwordx4 v[232:235], v178, s[8:11], s29 offen
  buffer_load_dwordx4 v[236:239], v178, s[8:11], s29 offen offset:1024
  s_add_u32 s29, s28, 2473984
  buffer_load_dwordx4 v[240:243], v178, s[8:11], s29 offen
  buffer_load_dwordx4 v[244:247], v178, s[8:11], s29 offen offset:1024
  s_add_u32 s29, s28, 2476032
  buffer_load_dwordx4 v[248:251], v178, s[8:11], s29 offen
  buffer_load_dwordx4 v[252:255], v178, s[8:11], s29 offen offset:1024
  s_waitcnt vmcnt(30)
  v_mov_b32 v172, 0x44444444
  v_mov_b32 v2, 0xeeeeeeee
  v_and_b32 v3, 8, v1
  v_cmp_ne_u32 vcc, 0, v3
  s_nop 1
  v_cndmask_b32 v172, v172, v2, vcc
  s_lshl_b32 s28, s21, 10
  v_add_u32 v173, s28, v178
  v_add_u32 v174, 4096, v173
  v_add_u32 v175, 8192, v173
  v_add_u32 v176, 0, v173
  v_add_u32 v177, 0, v178
  v_add_u32 v179, 10240, v173
  s_xor_b32 s28, s21, 2
  s_lshl_b32 s28, s28, 10
  s_add_u32 s28, s28, 10240
  v_add_u32 v180, s28, v178
  v_and_b32 v4, 15, v1
  v_lshrrev_b32 v5, 4, v1
  v_and_b32 v6, 7, v1
  v_lshlrev_b32 v7, 3, v5
  v_add_u32 v7, v7, v6
  v_lshlrev_b32 v185, 4, v7
  v_add_u32 v182, 4096, v178
  v_mov_b32 v8, 0x40000000
  v_cmp_gt_u32 vcc, 8, v4
  s_nop 1
  v_cndmask_b32 v184, v8, v185, vcc
  v_lshlrev_b32 v7, 4, v4
  v_lshlrev_b32 v9, 2, v5
  v_add_u32 v7, v7, v9
  v_cndmask_b32 v186, v8, v7, vcc
  s_lshl_b32 s28, s20, 5
  s_add_u32 s28, s28, 3072
  v_lshlrev_b32 v7, 2, v6
  v_add_u32 v187, s28, v7
  v_and_b32 v7, 1, v5
  v_lshlrev_b32 v7, 10, v7
  v_lshrrev_b32 v9, 1, v5
  v_lshlrev_b32 v9, 5, v9
  v_add_u32 v9, v9, v4
  v_lshlrev_b32 v9, 4, v9
  v_add_u32 v189, v7, v9
  v_mov_b32 v44, 0
  v_mov_b32 v45, 0
  v_mov_b32 v46, 0
  v_mov_b32 v47, 0
  v_mov_b32 v48, 0
  v_mov_b32 v49, 0
  v_mov_b32 v50, 0
  v_mov_b32 v51, 0
  v_mov_b32 v52, 0
  v_mov_b32 v53, 0
  v_mov_b32 v54, 0
  v_mov_b32 v55, 0
  v_mov_b32 v56, 0
  v_mov_b32 v57, 0
  v_mov_b32 v58, 0
  v_mov_b32 v59, 0
  s_mul_i32 s97, s20, 655360
  s_add_u32 s97, s97, 0x400000
  s_mov_b32 s48, 0x4000
  s_mul_i32 s49, s20, 327680
  s_add_u32 s49, s49, 0x700000
  s_mul_i32 s50, s20, 327680
  s_lshl_b32 s28, s46, 10
  s_add_u32 s50, s50, s28
  s_add_u32 s50, s50, 0x9000000
  s_mov_b32 s51, 0
  s_mov_b32 s52, 0
  s_mov_b32 s53, 0
  s_and_b32 s29, s21, 1
  s_lshl_b32 s29, s29, 9
  s_lshl_b32 s28, s23, 10
  s_add_u32 s28, s28, s29
  s_add_u32 s28, s28, 0x900000
  s_add_u32 s29, s20, 0
  s_and_b32 s29, s29, 3
  s_mul_i32 s29, s29, 20480
  s_add_u32 s56, s28, s29
  s_add_u32 s29, s20, 1
  s_and_b32 s29, s29, 3
  s_mul_i32 s29, s29, 20480
  s_add_u32 s57, s28, s29
  s_add_u32 s29, s20, 2
  s_and_b32 s29, s29, 3
  s_mul_i32 s29, s29, 20480
  s_add_u32 s58, s28, s29
  s_add_u32 s29, s20, 3
  s_and_b32 s29, s29, 3
  s_mul_i32 s29, s29, 20480
  s_add_u32 s59, s28, s29
  s_lshr_b32 s28, s46, 2
  s_lshl_b32 s28, s28, 10
  s_and_b32 s29, s46, 3
  s_lshl_b32 s29, s29, 8
  s_add_u32 s28, s28, s29
  s_add_u32 s60, s28, s97
  s_add_u32 s60, s60, 10240
  s_waitcnt vmcnt(0)
  s_cmp_ge_u32 s21, 2
  s_cbranch_scc1 kas_y_tok
kas_y_crit:
  s_mov_b32 s45, 0
kas_y_pf_79:
  buffer_load_dwordx4 v[160:163], v173, s[8:11], s48 offen sc1
  buffer_load_dwordx4 v[164:167], v174, s[8:11], s48 offen sc1
  buffer_load_dwordx4 v[168:171], v175, s[8:11], s48 offen sc1
  s_add_u32 s45, s45, 1
  s_waitcnt vmcnt(2)
  ds_write_b128 v176, v[160:163] offset:0
  v_max3_u32 v190, v160, v161, v162
  v_max_u32 v190, v190, v163
  s_waitcnt vmcnt(1)
  ds_write_b128 v176, v[164:167] offset:4096
  v_max3_u32 v190, v190, v164, v165
  v_max3_u32 v190, v190, v166, v167
  s_waitcnt vmcnt(0)
  ds_write_b128 v176, v[168:171] offset:8192
  v_max3_u32 v190, v190, v168, v169
  v_max3_u32 v190, v190, v170, v171
  v_cmp_eq_u32 vcc, -1, v190
  s_cbranch_vccz kas_y_pf_79_ok
  s_cmp_lt_u32 s45, 400000
  s_cbranch_scc1 kas_y_pf_79
  s_branch kas_abort
kas_y_pf_79_ok:
  s_waitcnt lgkmcnt(0)
  s_barrier
  ds_read_b128 v[4:7], v177 offset:0
  ds_read_b128 v[8:11], v177 offset:1024
  ds_read_b128 v[12:15], v177 offset:2048
  ds_read_b128 v[16:19], v177 offset:3072
  ds_read_b128 v[20:23], v177 offset:4096
  ds_read_b128 v[24:27], v177 offset:5120
  ds_read_b128 v[28:31], v177 offset:6144
  ds_read_b128 v[32:35], v177 offset:7168
  ds_read_b128 v[36:39], v177 offset:8192
  ds_read_b128 v[40:43], v177 offset:9216
  s_cmp_ge_u32 s51, 63
  s_cbranch_scc1 yu_80
  buffer_load_dwordx4 v[100:103], v178, s[8:11], s49 offen offset:0 sc1
  buffer_load_dwordx4 v[104:107], v178, s[8:11], s49 offen offset:1024 sc1
  buffer_load_dwordx4 v[108:111], v178, s[8:11], s49 offen offset:2048 sc1
  buffer_load_dwordx4 v[112:115], v178, s[8:11], s49 offen offset:3072 sc1
  buffer_load_dwordx4 v[116:119], v182, s[8:11], s49 offen sc1
  s_cmp_gt_u32 s52, s51
  s_cbranch_scc1 kas_y_wp_81_ok
  s_mov_b32 s45, 0
kas_y_wp_81_spin:
  buffer_load_dword v2, v187, s[8:11], 0 offen sc1
  s_add_u32 s45, s45, 1
  s_waitcnt vmcnt(0)
  v_min_u32_dpp v3, v2, v2 quad_perm:[1,0,3,2] row_mask:0xf bank_mask:0xf
  s_nop 1
  v_min_u32_dpp v2, v3, v3 quad_perm:[2,3,0,1] row_mask:0xf bank_mask:0xf
  s_nop 1
  v_min_u32_dpp v3, v2, v2 row_half_mirror row_mask:0xf bank_mask:0xf
  s_nop 1
  v_min_u32_dpp v2, v3, v3 quad_perm:[0,1,2,3] row_mask:0xf bank_mask:0xf
  s_nop 0
  v_readfirstlane_b32 s52, v2
  s_cmp_gt_u32 s52, s51
  s_cbranch_scc1 kas_y_wp_81_ok
  s_cmp_lt_u32 s45, 400000
  s_cbranch_scc1 kas_y_wp_81_spin
  s_branch kas_abort
kas_y_wp_81_ok:
  s_add_u32 s28, s50, 0
  buffer_load_dwordx4 v[68:71], v178, s[8:11], s28 offen sc1
  s_add_u32 s28, s50, 40960
  buffer_load_dwordx4 v[72:75], v178, s[8:11], s28 offen sc1
  s_add_u32 s28, s50, 81920
  buffer_load_dwordx4 v[76:79], v178, s[8:11], s28 offen sc1
  s_add_u32 s28, s50, 122880
  buffer_load_dwordx4 v[80:83], v178, s[8:11], s28 offen sc1
  s_add_u32 s28, s50, 163840
  buffer_load_dwordx4 v[84:87], v178, s[8:11], s28 offen sc1
  s_add_u32 s28, s50, 204800
  buffer_load_dwordx4 v[88:91], v178, s[8:11], s28 offen sc1
  s_add_u32 s28, s50, 245760
  buffer_load_dwordx4 v[92:95], v178, s[8:11], s28 offen sc1
  s_add_u32 s28, s50, 286720
  buffer_load_dwordx4 v[96:99], v178, s[8:11], s28 offen sc1
yu_80:
  s_waitcnt lgkmcnt(9)
  v_smfmac_f32_16x16x64_bf16 v[44:47], v[4:7], a[0:7], v172
  v_smfmac_f32_16x16x64_bf16 v[48:51], v[4:7], a[80:87], v172
  v_smfmac_f32_16x16x64_bf16 v[52:55], v[4:7], a[160:167], v172
  v_smfmac_f32_16x16x64_bf16 v[56:59], v[4:7], a[240:247], v172
  s_waitcnt lgkmcnt(8)
  v_smfmac_f32_16x16x64_bf16 v[44:47], v[8:11], a[8:15], v172
  v_smfmac_f32_16x16x64_bf16 v[48:51], v[8:11], a[88:95], v172
  v_smfmac_f32_16x16x64_bf16 v[52:55], v[8:11], a[168:175], v172
  v_smfmac_f32_16x16x64_bf16 v[56:59], v[8:11], a[248:255], v172
  s_waitcnt lgkmcnt(7)
  v_smfmac_f32_16x16x64_bf16 v[44:47], v[12:15], a[16:23], v172
  v_smfmac_f32_16x16x64_bf16 v[48:51], v[12:15], a[96:103], v172
  v_smfmac_f32_16x16x64_bf16 v[52:55], v[12:15], a[176:183], v172
  v_smfmac_f32_16x16x64_bf16 v[56:59], v[12:15], v[192:199], v172
  s_waitcnt lgkmcnt(6)
  v_smfmac_f32_16x16x64_bf16 v[44:47], v[16:19], a[24:31], v172
  v_smfmac_f32_16x16x64_bf16 v[48:51], v[16:19], a[104:111], v172
  v_smfmac_f32_16x16x64_bf16 v[52:55], v[16:19], a[184:191], v172
  v_smfmac_f32_16x16x64_bf16 v[56:59], v[16:19], v[200:207], v172
  s_waitcnt lgkmcnt(5)
  v_smfmac_f32_16x16x64_bf16 v[44:47], v[20:23], a[32:39], v172
  v_smfmac_f32_16x16x64_bf16 v[48:51], v[20:23], a[112:119], v172
  v_smfmac_f32_16x16x64_bf16 v[52:55], v[20:23], a[192:199], v172
  v_smfmac_f32_16x16x64_bf16 v[56:59], v[20:23], v[208:215], v172
  s_waitcnt lgkmcnt(4)
  v_smfmac_f32_16x16x64_bf16 v[44:47], v[24:27], a[40:47], v172
  v_smfmac_f32_16x16x64_bf16 v[48:51], v[24:27], a[120:127], v172
  v_smfmac_f32_16x16x64_bf16 v[52:55], v[24:27], a[200:207], v172
  v_smfmac_f32_16x16x64_bf16 v[56:59], v[24:27], v[216:223], v172
  s_waitcnt lgkmcnt(3)
  v_smfmac_f32_16x16x64_bf16 v[44:47], v[28:31], a[48:55], v172
  v_smfmac_f32_16x16x64_bf16 v[48:51], v[28:31], a[128:135], v172
  v_smfmac_f32_16x16x64_bf16 v[52:55], v[28:31], a[208:215], v172
  v_smfmac_f32_16x16x64_bf16 v[56:59], v[28:31], v[224:231], v172
  s_waitcnt lgkmcnt(2)
  v_smfmac_f32_16x16x64_bf16 v[44:47], v[32:35], a[56:63], v172
  v_smfmac_f32_16x16x64_bf16 v[48:51], v[32:35], a[136:143], v172
  v_smfmac_f32_16x16x64_bf16 v[52:55], v[32:35], a[216:223], v172
  v_smfmac_f32_16x16x64_bf16 v[56:59], v[32:35], v[232:239], v172
  s_waitcnt lgkmcnt(1)
  v_smfmac_f32_16x16x64_bf16 v[44:47], v[36:39], a[64:71], v172
  v_smfmac_f32_16x16x64_bf16 v[48:51], v[36:39], a[144:151], v172
  v_smfmac_f32_16x16x64_bf16 v[52:55], v[36:39], a[224:231], v172
  v_smfmac_f32_16x16x64_bf16 v[56:59], v[36:39], v[240:247], v172
  s_waitcnt lgkmcnt(0)
  v_smfmac_f32_16x16x64_bf16 v[44:47], v[40:43], a[72:79], v172
  v_smfmac_f32_16x16x64_bf16 v[48:51], v[40:43], a[152:159], v172
  v_smfmac_f32_16x16x64_bf16 v[52:55], v[40:43], a[232:239], v172
  v_smfmac_f32_16x16x64_bf16 v[56:59], v[40:43], v[248:255], v172
  s_nop 9
  v_permlane32_swap_b32 v44, v48
  v_permlane32_swap_b32 v45, v49
  v_permlane32_swap_b32 v46, v50
  v_permlane32_swap_b32 v47, v51
  v_permlane32_swap_b32 v52, v56
  v_permlane32_swap_b32 v53, v57
  v_permlane32_swap_b32 v54, v58
  v_permlane32_swap_b32 v55, v59
  v_add_f32 v44, v44, v48
  v_add_f32 v45, v45, v49
  v_add_f32 v46, v46, v50
  v_add_f32 v47, v47, v51
  v_add_f32 v52, v52, v56
  v_add_f32 v53, v53, v57
  v_add_f32 v54, v54, v58
  v_add_f32 v55, v55, v59
  v_cvt_pk_bf16_f32 v60, v44, v45
  v_cvt_pk_bf16_f32 v61, v46, v47
  v_cvt_pk_bf16_f32 v62, v52, v53
  v_cvt_pk_bf16_f32 v63, v54, v55
  ds_write_b128 v179, v[60:63]
  v_mov_b32 v44, 0
  v_mov_b32 v45, 0
  v_mov_b32 v46, 0
  v_mov_b32 v47, 0
  v_mov_b32 v48, 0
  v_mov_b32 v49, 0
  v_mov_b32 v50, 0
  v_mov_b32 v51, 0
  v_mov_b32 v52, 0
  v_mov_b32 v53, 0
  v_mov_b32 v54, 0
  v_mov_b32 v55, 0
  v_mov_b32 v56, 0
  v_mov_b32 v57, 0
  v_mov_b32 v58, 0
  v_mov_b32 v59, 0
  s_waitcnt lgkmcnt(0)
  s_barrier
  ds_read_b128 v[64:67], v180
  s_cmp_ge_u32 s51, 63
  s_cbranch_scc1 kas_y_crit_end
  s_mov_b32 s45, 0
yp_82:
  buffer_load_dwordx4 v[100:103], v178, s[8:11], s49 offen offset:0 sc1
  buffer_load_dwordx4 v[104:107], v178, s[8:11], s49 offen offset:1024 sc1
  buffer_load_dwordx4 v[108:111], v178, s[8:11], s49 offen offset:2048 sc1
  buffer_load_dwordx4 v[112:115], v178, s[8:11], s49 offen offset:3072 sc1
  buffer_load_dwordx4 v[116:119], v182, s[8:11], s49 offen sc1
  s_add_u32 s45, s45, 1
  s_waitcnt vmcnt(4) lgkmcnt(0)
  v_mfma_f32_16x16x32_bf16 v[140:143], v[68:71], v[100:103], 0
  v_max_u32 v190, v100, v102
  v_mfma_f32_16x16x32_bf16 v[144:147], v[72:75], v[100:103], 0
  s_waitcnt vmcnt(3)
  v_mfma_f32_16x16x32_bf16 v[140:143], v[76:79], v[104:107], v[140:143]
  v_max3_u32 v190, v190, v104, v106
  v_mfma_f32_16x16x32_bf16 v[144:147], v[80:83], v[104:107], v[144:147]
  s_waitcnt vmcnt(2)
  v_mfma_f32_16x16x32_bf16 v[140:143], v[84:87], v[108:111], v[140:143]
  v_max3_u32 v190, v190, v108, v110
  v_mfma_f32_16x16x32_bf16 v[144:147], v[88:91], v[108:111], v[144:147]
  s_waitcnt vmcnt(1)
  v_mfma_f32_16x16x32_bf16 v[140:143], v[92:95], v[112:115], v[140:143]
  v_max3_u32 v190, v190, v112, v114
  v_mfma_f32_16x16x32_bf16 v[144:147], v[96:99], v[112:115], v[144:147]
  s_waitcnt vmcnt(0)
  v_mfma_f32_16x16x32_bf16 v[140:143], v[60:63], v[116:119], v[140:143]
  v_max3_u32 v190, v190, v116, v117
  v_mfma_f32_16x16x32_bf16 v[144:147], v[64:67], v[116:119], v[144:147]
  v_max3_u32 v190, v190, v118, v119
  v_cmp_eq_u32 vcc, -1, v190
  s_cbranch_vccz yp_82_ok
  s_cmp_lt_u32 s45, 400000
  s_cbranch_scc1 yp_82
  s_branch kas_abort
yp_82_ok:
  s_nop 4
  v_add_f32_dpp v140, v144, v140 row_ror:8 row_mask:0xf bank_mask:0xf
  v_add_f32_dpp v141, v145, v141 row_ror:8 row_mask:0xf bank_mask:0xf
  v_add_f32_dpp v142, v146, v142 row_ror:8 row_mask:0xf bank_mask:0xf
  v_add_f32_dpp v143, v147, v143 row_ror:8 row_mask:0xf bank_mask:0xf
  buffer_store_dwordx4 v[140:143], v184, s[8:11], s56 offen sc1
  s_mov_b32 s45, 0
yc_83:
  buffer_load_dwordx4 v[148:151], v185, s[8:11], s57 offen sc1
  buffer_load_dwordx4 v[152:155], v185, s[8:11], s58 offen sc1
  buffer_load_dwordx4 v[156:159], v185, s[8:11], s59 offen sc1
  s_add_u32 s45, s45, 1
  s_waitcnt vmcnt(0)
  v_max3_u32 v190, v148, v151, v152
  v_max3_u32 v190, v190, v155, v156
  v_max_u32 v190, v190, v159
  v_add_f32 v160, v140, v148
  v_add_f32 v161, v141, v149
  v_add_f32 v162, v142, v150
  v_add_f32 v163, v143, v151
  v_cmp_eq_u32 vcc, -1, v190
  v_add_f32 v152, v152, v156
  v_add_f32 v153, v153, v157
  v_add_f32 v154, v154, v158
  v_add_f32 v155, v155, v159
  s_cbranch_vccz yc_83_ok
  s_cmp_lt_u32 s45, 400000
  s_cbranch_scc1 yc_83
  s_branch kas_abort
yc_83_ok:
  v_add_f32 v160, v160, v152
  v_add_f32 v161, v161, v153
  v_add_f32 v162, v162, v154
  v_add_f32 v163, v163, v155
  v_cvt_pk_bf16_f32 v164, v160, v161
  v_cvt_pk_bf16_f32 v165, v162, v163
  buffer_store_dword v164, v186, s[8:11], s60 offen sc1
  buffer_store_dword v165, v186, s[8:11], s60 offen offset:128 sc1
  s_add_u32 s97, s97, 10240
  s_mov_b32 s48, s97
  s_add_u32 s60, s60, 10240
  s_add_u32 s49, s49, 5120
  s_add_u32 s50, s50, 1310720
  s_add_u32 s56, s56, 81920
  s_add_u32 s57, s57, 81920
  s_add_u32 s58, s58, 81920
  s_add_u32 s59, s59, 81920
  s_add_u32 s51, s51, 1
  s_branch kas_y_crit
kas_y_crit_end:
  s_waitcnt vmcnt(0) lgkmcnt(0)
  s_branch kas_exit
kas_y_tok:
  s_mul_i32 s61, s20, 1310720
  s_add_u32 s61, s61, 0xe00000
  s_mul_i32 s62, s20, 5242880
  s_lshl_b32 s28, s46, 11
  s_add_u32 s62, s62, s28
  s_add_u32 s62, s62, 0x1a00000
  s_mov_b32 s54, 0
kas_y_tokl:
  s_mov_b32 s45, 0
kas_y_pf_84:
  buffer_load_dwordx4 v[160:163], v173, s[8:11], s48 offen sc1
  buffer_load_dwordx4 v[164:167], v174, s[8:11], s48 offen sc1
  s_add_u32 s45, s45, 1
  s_waitcnt vmcnt(1)
  ds_write_b128 v176, v[160:163] offset:0
  v_max3_u32 v190, v160, v161, v162
  v_max_u32 v190, v190, v163
  s_waitcnt vmcnt(0)
  ds_write_b128 v176, v[164:167] offset:4096
  v_max3_u32 v190, v190, v164, v165
  v_max3_u32 v190, v190, v166, v167
  v_cmp_eq_u32 vcc, -1, v190
  s_cbranch_vccz kas_y_pf_84_ok
  s_cmp_lt_u32 s45, 400000
  s_cbranch_scc1 kas_y_pf_84
  s_branch kas_abort
kas_y_pf_84_ok:
  s_waitcnt lgkmcnt(0)
  s_barrier
  ds_read_b128 v[4:7], v177 offset:0
  ds_read_b128 v[8:11], v177 offset:1024
  ds_read_b128 v[12:15], v177 offset:2048
  ds_read_b128 v[16:19], v177 offset:3072
  ds_read_b128 v[20:23], v177 offset:4096
  ds_read_b128 v[24:27], v177 offset:5120
  ds_read_b128 v[28:31], v177 offset:6144
  ds_read_b128 v[32:35], v177 offset:7168
  ds_read_b128 v[36:39], v177 offset:8192
  ds_read_b128 v[40:43], v177 offset:9216
  s_waitcnt lgkmcnt(9)
  v_smfmac_f32_16x16x64_bf16 v[44:47], v[4:7], a[0:7], v172
  v_smfmac_f32_16x16x64_bf16 v[48:51], v[4:7], a[80:87], v172
  v_smfmac_f32_16x16x64_bf16 v[52:55], v[4:7], a[160:167], v172
  v_smfmac_f32_16x16x64_bf16 v[56:59], v[4:7], a[240:247], v172
  s_waitcnt lgkmcnt(8)
  v_smfmac_f32_16x16x64_bf16 v[44:47], v[8:11], a[8:15], v172
  v_smfmac_f32_16x16x64_bf16 v[48:51], v[8:11], a[88:95], v172
  v_smfmac_f32_16x16x64_bf16 v[52:55], v[8:11], a[168:175], v172
  v_smfmac_f32_16x16x64_bf16 v[56:59], v[8:11], a[248:255], v172
  s_waitcnt lgkmcnt(7)
  v_smfmac_f32_16x16x64_bf16 v[44:47], v[12:15], a[16:23], v172
  v_smfmac_f32_16x16x64_bf16 v[48:51], v[12:15], a[96:103], v172
  v_smfmac_f32_16x16x64_bf16 v[52:55], v[12:15], a[176:183], v172
  v_smfmac_f32_16x16x64_bf16 v[56:59], v[12:15], v[192:199], v172
  s_waitcnt lgkmcnt(6)
  v_smfmac_f32_16x16x64_bf16 v[44:47], v[16:19], a[24:31], v172
  v_smfmac_f32_16x16x64_bf16 v[48:51], v[16:19], a[104:111], v172
  v_smfmac_f32_16x16x64_bf16 v[52:55], v[16:19], a[184:191], v172
  v_smfmac_f32_16x16x64_bf16 v[56:59], v[16:19], v[200:207], v172
  s_waitcnt lgkmcnt(5)
  v_smfmac_f32_16x16x64_bf16 v[44:47], v[20:23], a[32:39], v172
  v_smfmac_f32_16x16x64_bf16 v[48:51], v[20:23], a[112:119], v172
  v_smfmac_f32_16x16x64_bf16 v[52:55], v[20:23], a[192:199], v172
  v_smfmac_f32_16x16x64_bf16 v[56:59], v[20:23], v[208:215], v172
  s_waitcnt lgkmcnt(4)
  v_smfmac_f32_16x16x64_bf16 v[44:47], v[24:27], a[40:47], v172
  v_smfmac_f32_16x16x64_bf16 v[48:51], v[24:27], a[120:127], v172
  v_smfmac_f32_16x16x64_bf16 v[52:55], v[24:27], a[200:207], v172
  v_smfmac_f32_16x16x64_bf16 v[56:59], v[24:27], v[216:223], v172
  s_waitcnt lgkmcnt(3)
  v_smfmac_f32_16x16x64_bf16 v[44:47], v[28:31], a[48:55], v172
  v_smfmac_f32_16x16x64_bf16 v[48:51], v[28:31], a[128:135], v172
  v_smfmac_f32_16x16x64_bf16 v[52:55], v[28:31], a[208:215], v172
  v_smfmac_f32_16x16x64_bf16 v[56:59], v[28:31], v[224:231], v172
  s_waitcnt lgkmcnt(2)
  v_smfmac_f32_16x16x64_bf16 v[44:47], v[32:35], a[56:63], v172
  v_smfmac_f32_16x16x64_bf16 v[48:51], v[32:35], a[136:143], v172
  v_smfmac_f32_16x16x64_bf16 v[52:55], v[32:35], a[216:223], v172
  v_smfmac_f32_16x16x64_bf16 v[56:59], v[32:35], v[232:239], v172
  s_waitcnt lgkmcnt(1)
  v_smfmac_f32_16x16x64_bf16 v[44:47], v[36:39], a[64:71], v172
  v_smfmac_f32_16x16x64_bf16 v[48:51], v[36:39], a[144:151], v172
  v_smfmac_f32_16x16x64_bf16 v[52:55], v[36:39], a[224:231], v172
  v_smfmac_f32_16x16x64_bf16 v[56:59], v[36:39], v[240:247], v172
  s_waitcnt lgkmcnt(0)
  v_smfmac_f32_16x16x64_bf16 v[44:47], v[40:43], a[72:79], v172
  v_smfmac_f32_16x16x64_bf16 v[48:51], v[40:43], a[152:159], v172
  v_smfmac_f32_16x16x64_bf16 v[52:55], v[40:43], a[232:239], v172
  v_smfmac_f32_16x16x64_bf16 v[56:59], v[40:43], v[248:255], v172
  s_nop 9
  v_permlane32_swap_b32 v44, v48
  v_permlane32_swap_b32 v45, v49
  v_permlane32_swap_b32 v46, v50
  v_permlane32_swap_b32 v47, v51
  v_permlane32_swap_b32 v52, v56
  v_permlane32_swap_b32 v53, v57
  v_permlane32_swap_b32 v54, v58
  v_permlane32_swap_b32 v55, v59
  v_add_f32 v44, v44, v48
  v_add_f32 v45, v45, v49
  v_add_f32 v46, v46, v50
  v_add_f32 v47, v47, v51
  v_add_f32 v52, v52, v56
  v_add_f32 v53, v53, v57
  v_add_f32 v54, v54, v58
  v_add_f32 v55, v55, v59
  v_cvt_pk_bf16_f32 v64, v44, v45
  v_cvt_pk_bf16_f32 v65, v46, v47
  v_cvt_pk_bf16_f32 v66, v52, v53
  v_cvt_pk_bf16_f32 v67, v54, v55
  ds_write_b128 v179, v[64:67]
  v_mov_b32 v44, 0
  v_mov_b32 v45, 0
  v_mov_b32 v46, 0
  v_mov_b32 v47, 0
  v_mov_b32 v48, 0
  v_mov_b32 v49, 0
  v_mov_b32 v50, 0
  v_mov_b32 v51, 0
  v_mov_b32 v52, 0
  v_mov_b32 v53, 0
  v_mov_b32 v54, 0
  v_mov_b32 v55, 0
  v_mov_b32 v56, 0
  v_mov_b32 v57, 0
  v_mov_b32 v58, 0
  v_mov_b32 v59, 0
  s_waitcnt lgkmcnt(0)
  s_barrier
  ds_read_b128 v[60:63], v180
  s_cmp_eq_u32 s51, 0
  s_cbranch_scc1 yt_85
  s_cmp_gt_u32 s52, s54
  s_cbranch_scc1 kas_y_wp_86_ok
  s_mov_b32 s45, 0
kas_y_wp_86_spin:
  buffer_load_dword v2, v187, s[8:11], 0 offen sc1
  s_add_u32 s45, s45, 1
  s_waitcnt vmcnt(0)
  v_min_u32_dpp v3, v2, v2 quad_perm:[1,0,3,2] row_mask:0xf bank_mask:0xf
  s_nop 1
  v_min_u32_dpp v2, v3, v3 quad_perm:[2,3,0,1] row_mask:0xf bank_mask:0xf
  s_nop 1
  v_min_u32_dpp v3, v2, v2 row_half_mirror row_mask:0xf bank_mask:0xf
  s_nop 1
  v_min_u32_dpp v2, v3, v3 quad_perm:[0,1,2,3] row_mask:0xf bank_mask:0xf
  s_nop 0
  v_readfirstlane_b32 s52, v2
  s_cmp_gt_u32 s52, s54
  s_cbranch_scc1 kas_y_wp_86_ok
  s_cmp_lt_u32 s45, 400000
  s_cbranch_scc1 kas_y_wp_86_spin
  s_branch kas_abort
kas_y_wp_86_ok:
  s_add_u32 s28, s50, 0
  buffer_load_dwordx4 v[68:71], v178, s[8:11], s28 offen sc1
  s_add_u32 s28, s50, 40960
  buffer_load_dwordx4 v[72:75], v178, s[8:11], s28 offen sc1
  s_add_u32 s28, s50, 81920
  buffer_load_dwordx4 v[76:79], v178, s[8:11], s28 offen sc1
  s_add_u32 s28, s50, 122880
  buffer_load_dwordx4 v[80:83], v178, s[8:11], s28 offen sc1
  s_add_u32 s28, s50, 163840
  buffer_load_dwordx4 v[84:87], v178, s[8:11], s28 offen sc1
  s_add_u32 s28, s50, 204800
  buffer_load_dwordx4 v[88:91], v178, s[8:11], s28 offen sc1
  s_add_u32 s28, s50, 245760
  buffer_load_dwordx4 v[92:95], v178, s[8:11], s28 offen sc1
  s_add_u32 s28, s50, 286720
  buffer_load_dwordx4 v[96:99], v178, s[8:11], s28 offen sc1
  s_mov_b32 s45, 0
ytp_87:
  s_add_u32 s28, s61, 0
  buffer_load_dwordx4 v[100:103], v178, s[8:11], s28 offen sc1
  s_add_u32 s28, s61, 2048
  buffer_load_dwordx4 v[104:107], v178, s[8:11], s28 offen sc1
  s_add_u32 s28, s61, 4096
  buffer_load_dwordx4 v[108:111], v178, s[8:11], s28 offen sc1
  s_add_u32 s28, s61, 6144
  buffer_load_dwordx4 v[112:115], v178, s[8:11], s28 offen sc1
  s_add_u32 s28, s61, 8192
  buffer_load_dwordx4 v[116:119], v178, s[8:11], s28 offen sc1
  s_add_u32 s28, s61, 10240
  buffer_load_dwordx4 v[120:123], v178, s[8:11], s28 offen sc1
  s_add_u32 s28, s61, 12288
  buffer_load_dwordx4 v[124:127], v178, s[8:11], s28 offen sc1
  s_add_u32 s28, s61, 14336
  buffer_load_dwordx4 v[128:131], v178, s[8:11], s28 offen sc1
  s_add_u32 s28, s61, 16384
  buffer_load_dwordx4 v[132:135], v178, s[8:11], s28 offen sc1
  s_add_u32 s28, s61, 18432
  buffer_load_dwordx4 v[136:139], v178, s[8:11], s28 offen sc1
  s_add_u32 s45, s45, 1
  s_waitcnt vmcnt(0)
  v_max_u32 v190, v100, v102
  v_max3_u32 v190, v190, v104, v106
  v_max3_u32 v190, v190, v108, v110
  v_max3_u32 v190, v190, v112, v114
  v_max3_u32 v190, v190, v116, v118
  v_max3_u32 v190, v190, v120, v122
  v_max3_u32 v190, v190, v124, v126
  v_max3_u32 v190, v190, v128, v130
  v_max3_u32 v190, v190, v132, v134
  v_max3_u32 v190, v190, v136, v138
  v_cmp_eq_u32 vcc, -1, v190
  s_cbranch_vccz ytp_87_ok
  s_cmp_lt_u32 s45, 400000
  s_cbranch_scc1 ytp_87
  s_branch kas_abort
ytp_87_ok:
  v_mfma_f32_16x16x32_bf16 v[140:143], v[68:71], v[100:103], 0
  v_mfma_f32_16x16x32_bf16 v[140:143], v[72:75], v[104:107], v[140:143]
  v_mfma_f32_16x16x32_bf16 v[140:143], v[76:79], v[108:111], v[140:143]
  v_mfma_f32_16x16x32_bf16 v[140:143], v[80:83], v[112:115], v[140:143]
  v_mfma_f32_16x16x32_bf16 v[140:143], v[84:87], v[116:119], v[140:143]
  v_mfma_f32_16x16x32_bf16 v[140:143], v[88:91], v[120:123], v[140:143]
  v_mfma_f32_16x16x32_bf16 v[140:143], v[92:95], v[124:127], v[140:143]
  v_mfma_f32_16x16x32_bf16 v[140:143], v[96:99], v[128:131], v[140:143]
  v_mfma_f32_16x16x32_bf16 v[140:143], v[148:151], v[132:135], v[140:143]
  v_mfma_f32_16x16x32_bf16 v[140:143], v[152:155], v[136:139], v[140:143]
  s_nop 8
  s_add_u32 s28, s62, 0
  buffer_store_dwordx4 v[140:143], v189, s[8:11], s28 offen
  s_nop 1
  s_mov_b32 s45, 0
ytp_88:
  s_add_u32 s28, s61, 1024
  buffer_load_dwordx4 v[100:103], v178, s[8:11], s28 offen sc1
  s_add_u32 s28, s61, 3072
  buffer_load_dwordx4 v[104:107], v178, s[8:11], s28 offen sc1
  s_add_u32 s28, s61, 5120
  buffer_load_dwordx4 v[108:111], v178, s[8:11], s28 offen sc1
  s_add_u32 s28, s61, 7168
  buffer_load_dwordx4 v[112:115], v178, s[8:11], s28 offen sc1
  s_add_u32 s28, s61, 9216
  buffer_load_dwordx4 v[116:119], v178, s[8:11], s28 offen sc1
  s_add_u32 s28, s61, 11264
  buffer_load_dwordx4 v[120:123], v178, s[8:11], s28 offen sc1
  s_add_u32 s28, s61, 13312
  buffer_load_dwordx4 v[124:127], v178, s[8:11], s28 offen sc1
  s_add_u32 s28, s61, 15360
  buffer_load_dwordx4 v[128:131], v178, s[8:11], s28 offen sc1
  s_add_u32 s28, s61, 17408
  buffer_load_dwordx4 v[132:135], v178, s[8:11], s28 offen sc1
  s_add_u32 s28, s61, 19456
  buffer_load_dwordx4 v[136:139], v178, s[8:11], s28 offen sc1
  s_add_u32 s45, s45, 1
  s_waitcnt vmcnt(0)
  v_max_u32 v190, v100, v102
  v_max3_u32 v190, v190, v104, v106
  v_max3_u32 v190, v190, v108, v110
  v_max3_u32 v190, v190, v112, v114
  v_max3_u32 v190, v190, v116, v118
  v_max3_u32 v190, v190, v120, v122
  v_max3_u32 v190, v190, v124, v126
  v_max3_u32 v190, v190, v128, v130
  v_max3_u32 v190, v190, v132, v134
  v_max3_u32 v190, v190, v136, v138
  v_cmp_eq_u32 vcc, -1, v190
  s_cbranch_vccz ytp_88_ok
  s_cmp_lt_u32 s45, 400000
  s_cbranch_scc1 ytp_88
  s_branch kas_abort
ytp_88_ok:
  v_mfma_f32_16x16x32_bf16 v[140:143], v[68:71], v[100:103], 0
  v_mfma_f32_16x16x32_bf16 v[140:143], v[72:75], v[104:107], v[140:143]
  v_mfma_f32_16x16x32_bf16 v[140:143], v[76:79], v[108:111], v[140:143]
  v_mfma_f32_16x16x32_bf16 v[140:143], v[80:83], v[112:115], v[140:143]
  v_mfma_f32_16x16x32_bf16 v[140:143], v[84:87], v[116:119], v[140:143]
  v_mfma_f32_16x16x32_bf16 v[140:143], v[88:91], v[120:123], v[140:143]
  v_mfma_f32_16x16x32_bf16 v[140:143], v[92:95], v[124:127], v[140:143]
  v_mfma_f32_16x16x32_bf16 v[140:143], v[96:99], v[128:131], v[140:143]
  v_mfma_f32_16x16x32_bf16 v[140:143], v[148:151], v[132:135], v[140:143]
  v_mfma_f32_16x16x32_bf16 v[140:143], v[152:155], v[136:139], v[140:143]
  s_nop 8
  s_add_u32 s28, s62, 256
  buffer_store_dwordx4 v[140:143], v189, s[8:11], s28 offen
  s_nop 1
  s_add_u32 s50, s50, 1310720
  s_add_u32 s61, s61, 20480
  s_add_u32 s62, s62, 81920
  s_add_u32 s54, s54, 1
yt_85:
  s_waitcnt lgkmcnt(0)
  v_mov_b32 v148, v60
  v_mov_b32 v149, v61
  v_mov_b32 v150, v62
  v_mov_b32 v151, v63
  v_mov_b32 v152, v64
  v_mov_b32 v153, v65
  v_mov_b32 v154, v66
  v_mov_b32 v155, v67
  s_add_u32 s97, s97, 10240
  s_mov_b32 s48, s97
  s_add_u32 s51, s51, 1
  s_cmp_lt_u32 s51, 64
  s_cbranch_scc1 kas_y_tokl
  s_cmp_gt_u32 s52, s54
  s_cbranch_scc1 kas_y_wp_89_ok
  s_mov_b32 s45, 0
kas_y_wp_89_spin:
  buffer_load_dword v2, v187, s[8:11], 0 offen sc1
  s_add_u32 s45, s45, 1
  s_waitcnt vmcnt(0)
  v_min_u32_dpp v3, v2, v2 quad_perm:[1,0,3,2] row_mask:0xf bank_mask:0xf
  s_nop 1
  v_min_u32_dpp v2, v3, v3 quad_perm:[2,3,0,1] row_mask:0xf bank_mask:0xf
  s_nop 1
  v_min_u32_dpp v3, v2, v2 row_half_mirror row_mask:0xf bank_mask:0xf
  s_nop 1
  v_min_u32_dpp v2, v3, v3 quad_perm:[0,1,2,3] row_mask:0xf bank_mask:0xf
  s_nop 0
  v_readfirstlane_b32 s52, v2
  s_cmp_gt_u32 s52, s54
  s_cbranch_scc1 kas_y_wp_89_ok
  s_cmp_lt_u32 s45, 400000
  s_cbranch_scc1 kas_y_wp_89_spin
  s_branch kas_abort
kas_y_wp_89_ok:
  s_add_u32 s28, s50, 0
  buffer_load_dwordx4 v[68:71], v178, s[8:11], s28 offen sc1
  s_add_u32 s28, s50, 40960
  buffer_load_dwordx4 v[72:75], v178, s[8:11], s28 offen sc1
  s_add_u32 s28, s50, 81920
  buffer_load_dwordx4 v[76:79], v178, s[8:11], s28 offen sc1
  s_add_u32 s28, s50, 122880
  buffer_load_dwordx4 v[80:83], v178, s[8:11], s28 offen sc1
  s_add_u32 s28, s50, 163840
  buffer_load_dwordx4 v[84:87], v178, s[8:11], s28 offen sc1
  s_add_u32 s28, s50, 204800
  buffer_load_dwordx4 v[88:91], v178, s[8:11], s28 offen sc1
  s_add_u32 s28, s50, 245760
  buffer_load_dwordx4 v[92:95], v178, s[8:11], s28 offen sc1
  s_add_u32 s28, s50, 286720
  buffer_load_dwordx4 v[96:99], v178, s[8:11], s28 offen sc1
  s_mov_b32 s45, 0
ytp_90:
  s_add_u32 s28, s61, 0
  buffer_load_dwordx4 v[100:103], v178, s[8:11], s28 offen sc1
  s_add_u32 s28, s61, 2048
  buffer_load_dwordx4 v[104:107], v178, s[8:11], s28 offen sc1
  s_add_u32 s28, s61, 4096
  buffer_load_dwordx4 v[108:111], v178, s[8:11], s28 offen sc1
  s_add_u32 s28, s61, 6144
  buffer_load_dwordx4 v[112:115], v178, s[8:11], s28 offen sc1
  s_add_u32 s28, s61, 8192
  buffer_load_dwordx4 v[116:119], v178, s[8:11], s28 offen sc1
  s_add_u32 s28, s61, 10240
  buffer_load_dwordx4 v[120:123], v178, s[8:11], s28 offen sc1
  s_add_u32 s28, s61, 12288
  buffer_load_dwordx4 v[124:127], v178, s[8:11], s28 offen sc1
  s_add_u32 s28, s61, 14336
  buffer_load_dwordx4 v[128:131], v178, s[8:11], s28 offen sc1
  s_add_u32 s28, s61, 16384
  buffer_load_dwordx4 v[132:135], v178, s[8:11], s28 offen sc1
  s_add_u32 s28, s61, 18432
  buffer_load_dwordx4 v[136:139], v178, s[8:11], s28 offen sc1
  s_add_u32 s45, s45, 1
  s_waitcnt vmcnt(0)
  v_max_u32 v190, v100, v102
  v_max3_u32 v190, v190, v104, v106
  v_max3_u32 v190, v190, v108, v110
  v_max3_u32 v190, v190, v112, v114
  v_max3_u32 v190, v190, v116, v118
  v_max3_u32 v190, v190, v120, v122
  v_max3_u32 v190, v190, v124, v126
  v_max3_u32 v190, v190, v128, v130
  v_max3_u32 v190, v190, v132, v134
  v_max3_u32 v190, v190, v136, v138
  v_cmp_eq_u32 vcc, -1, v190
  s_cbranch_vccz ytp_90_ok
  s_cmp_lt_u32 s45, 400000
  s_cbranch_scc1 ytp_90
  s_branch kas_abort
ytp_90_ok:
  v_mfma_f32_16x16x32_bf16 v[140:143], v[68:71], v[100:103], 0
  v_mfma_f32_16x16x32_bf16 v[140:143], v[72:75], v[104:107], v[140:143]
  v_mfma_f32_16x16x32_bf16 v[140:143], v[76:79], v[108:111], v[140:143]
  v_mfma_f32_16x16x32_bf16 v[140:143], v[80:83], v[112:115], v[140:143]
  v_mfma_f32_16x16x32_bf16 v[140:143], v[84:87], v[116:119], v[140:143]
  v_mfma_f32_16x16x32_bf16 v[140:143], v[88:91], v[120:123], v[140:143]
  v_mfma_f32_16x16x32_bf16 v[140:143], v[92:95], v[124:127], v[140:143]
  v_mfma_f32_16x16x32_bf16 v[140:143], v[96:99], v[128:131], v[140:143]
  v_mfma_f32_16x16x32_bf16 v[140:143], v[148:151], v[132:135], v[140:143]
  v_mfma_f32_16x16x32_bf16 v[140:143], v[152:155], v[136:139], v[140:143]
  s_nop 8
  s_add_u32 s28, s62, 0
  buffer_store_dwordx4 v[140:143], v189, s[8:11], s28 offen
  s_nop 1
  s_mov_b32 s45, 0
ytp_91:
  s_add_u32 s28, s61, 1024
  buffer_load_dwordx4 v[100:103], v178, s[8:11], s28 offen sc1
  s_add_u32 s28, s61, 3072
  buffer_load_dwordx4 v[104:107], v178, s[8:11], s28 offen sc1
  s_add_u32 s28, s61, 5120
  buffer_load_dwordx4 v[108:111], v178, s[8:11], s28 offen sc1
  s_add_u32 s28, s61, 7168
  buffer_load_dwordx4 v[112:115], v178, s[8:11], s28 offen sc1
  s_add_u32 s28, s61, 9216
  buffer_load_dwordx4 v[116:119], v178, s[8:11], s28 offen sc1
  s_add_u32 s28, s61, 11264
  buffer_load_dwordx4 v[120:123], v178, s[8:11], s28 offen sc1
  s_add_u32 s28, s61, 13312
  buffer_load_dwordx4 v[124:127], v178, s[8:11], s28 offen sc1
  s_add_u32 s28, s61, 15360
  buffer_load_dwordx4 v[128:131], v178, s[8:11], s28 offen sc1
  s_add_u32 s28, s61, 17408
  buffer_load_dwordx4 v[132:135], v178, s[8:11], s28 offen sc1
  s_add_u32 s28, s61, 19456
  buffer_load_dwordx4 v[136:139], v178, s[8:11], s28 offen sc1
  s_add_u32 s45, s45, 1
  s_waitcnt vmcnt(0)
  v_max_u32 v190, v100, v102
  v_max3_u32 v190, v190, v104, v106
  v_max3_u32 v190, v190, v108, v110
  v_max3_u32 v190, v190, v112, v114
  v_max3_u32 v190, v190, v116, v118
  v_max3_u32 v190, v190, v120, v122
  v_max3_u32 v190, v190, v124, v126
  v_max3_u32 v190, v190, v128, v130
  v_max3_u32 v190, v190, v132, v134
  v_max3_u32 v190, v190, v136, v138
  v_cmp_eq_u32 vcc, -1, v190
  s_cbranch_vccz ytp_91_ok
  s_cmp_lt_u32 s45, 400000
  s_cbranch_scc1 ytp_91
  s_branch kas_abort
ytp_91_ok:
  v_mfma_f32_16x16x32_bf16 v[140:143], v[68:71], v[100:103], 0
  v_mfma_f32_16x16x32_bf16 v[140:143], v[72:75], v[104:107], v[140:143]
  v_mfma_f32_16x16x32_bf16 v[140:143], v[76:79], v[108:111], v[140:143]
  v_mfma_f32_16x16x32_bf16 v[140:143], v[80:83], v[112:115], v[140:143]
  v_mfma_f32_16x16x32_bf16 v[140:143], v[84:87], v[116:119], v[140:143]
  v_mfma_f32_16x16x32_bf16 v[140:143], v[88:91], v[120:123], v[140:143]
  v_mfma_f32_16x16x32_bf16 v[140:143], v[92:95], v[124:127], v[140:143]
  v_mfma_f32_16x16x32_bf16 v[140:143], v[96:99], v[128:131], v[140:143]
  v_mfma_f32_16x16x32_bf16 v[140:143], v[148:151], v[132:135], v[140:143]
  v_mfma_f32_16x16x32_bf16 v[140:143], v[152:155], v[136:139], v[140:143]
  s_nop 8
  s_add_u32 s28, s62, 256
  buffer_store_dwordx4 v[140:143], v189, s[8:11], s28 offen
  s_nop 1
  s_add_u32 s50, s50, 1310720
  s_add_u32 s61, s61, 20480
  s_add_u32 s62, s62, 81920
  s_add_u32 s54, s54, 1
  s_waitcnt vmcnt(0)
  s_branch kas_exit
kas_abort:
  s_branch ka_abort
kas_exit:
  s_branch ka_exit
ka_abort:
  s_load_dwordx2 s[6:7], s[0:1], 88
  v_mov_b32 v2, 80
  v_mov_b32 v3, 1
  s_waitcnt lgkmcnt(0)
  s_mov_b64 exec, 1
  global_atomic_add v2, v3, s[6:7]
  s_waitcnt vmcnt(0)
ka_exit:
  s_endpgm

.section .rodata,"a"
.p2align 6
.amdhsa_kernel ka_kernel
  .amdhsa_next_free_vgpr 512
  .amdhsa_next_free_sgpr 102
  .amdhsa_accum_offset 256
  .amdhsa_group_segment_fixed_size 0
  .amdhsa_kernarg_size 104
  .amdhsa_user_sgpr_count 2
  .amdhsa_user_sgpr_kernarg_segment_ptr 1
  .amdhsa_system_sgpr_workgroup_id_x 1
.end_amdhsa_kernel
.text
.globl red1_kernel
.p2align 8
.type red1_kernel,@function
red1_kernel:
  s_cmp_ge_u32 s2, 256
  s_cbranch_scc1 kr1_exit
  s_load_dwordx2 s[36:37], s[0:1], 0
  s_load_dwordx2 s[4:5], s[0:1], 96
  v_lshrrev_b32 v1, 6, v0
  s_nop 0
  v_readfirstlane_b32 s21, v1
  v_and_b32 v1, 63, v0
  s_waitcnt lgkmcnt(0)
  s_mov_b32 s8, s4
  s_and_b32 s9, s5, 0xffff
  s_mov_b32 s10, 0x10000000
  s_mov_b32 s11, 0x20000
  s_mov_b32 s12, s36
  s_and_b32 s13, s37, 0xffff
  s_mov_b32 s14, 0x280000
  s_mov_b32 s15, 0x20000
  s_lshr_b32 s22, s2, 2
  s_and_b32 s23, s2, 3
  s_lshl_b32 s23, s23, 3
  v_and_b32 v2, 7, v1
  v_bfe_u32 v3, v1, 3, 1
  v_lshrrev_b32 v4, 4, v1
  v_lshlrev_b32 v5, 5, v3
  v_add_u32 v5, v5, v2
  v_add_u32 v5, s23, v5
  v_lshlrev_b32 v5, 4, v5
  v_lshlrev_b32 v6, 11, v4
  v_add_u32 v6, v6, v5
  v_lshlrev_b32 v7, 10, v4
  v_add_u32 v7, v7, v5
  s_mul_i32 s24, s22, 81920
  s_lshl_b32 s25, s21, 14
  s_add_u32 s24, s24, s25
  s_add_u32 s26, s24, 27262976
  buffer_load_dwordx4 v[32:35], v6, s[8:11], s26 offen
  s_add_u32 s26, s24, 27264000
  buffer_load_dwordx4 v[36:39], v6, s[8:11], s26 offen
  s_add_u32 s26, s24, 27271168
  buffer_load_dwordx4 v[40:43], v6, s[8:11], s26 offen
  s_add_u32 s26, s24, 27272192
  buffer_load_dwordx4 v[44:47], v6, s[8:11], s26 offen
  s_add_u32 s26, s24, 32505856
  buffer_load_dwordx4 v[48:51], v6, s[8:11], s26 offen
  s_add_u32 s26, s24, 32506880
  buffer_load_dwordx4 v[52:55], v6, s[8:11], s26 offen
  s_add_u32 s26, s24, 32514048
  buffer_load_dwordx4 v[56:59], v6, s[8:11], s26 offen
  s_add_u32 s26, s24, 32515072
  buffer_load_dwordx4 v[60:63], v6, s[8:11], s26 offen
  s_add_u32 s26, s24, 37748736
  buffer_load_dwordx4 v[64:67], v6, s[8:11], s26 offen
  s_add_u32 s26, s24, 37749760
  buffer_load_dwordx4 v[68:71], v6, s[8:11], s26 offen
  s_add_u32 s26, s24, 37756928
  buffer_load_dwordx4 v[72:75], v6, s[8:11], s26 offen
  s_add_u32 s26, s24, 37757952
  buffer_load_dwordx4 v[76:79], v6, s[8:11], s26 offen
  s_add_u32 s26, s24, 42991616
  buffer_load_dwordx4 v[80:83], v6, s[8:11], s26 offen
  s_add_u32 s26, s24, 42992640
  buffer_load_dwordx4 v[84:87], v6, s[8:11], s26 offen
  s_add_u32 s26, s24, 42999808
  buffer_load_dwordx4 v[88:91], v6, s[8:11], s26 offen
  s_add_u32 s26, s24, 43000832
  buffer_load_dwordx4 v[92:95], v6, s[8:11], s26 offen
  s_lshl_b32 s26, s22, 5
  s_add_u32 s26, s26, s23
  v_add_u32 v8, s26, v2
  v_mul_u32_u24 v8, 1280, v8
  v_lshlrev_b32 v9, 5, v4
  v_add_u32 v8, v8, v9
  v_lshlrev_b32 v9, 4, v3
  v_add_u32 v8, v8, v9
  s_lshl_b32 s26, s21, 8
  buffer_load_dwordx4 v[96:99], v8, s[12:15], s26 offen offset:0
  buffer_load_dwordx4 v[100:103], v8, s[12:15], s26 offen offset:128
  s_waitcnt vmcnt(0)
  v_lshlrev_b32 v16, 16, v96
  v_and_b32 v17, 0xffff0000, v96
  v_lshlrev_b32 v18, 16, v97
  v_and_b32 v19, 0xffff0000, v97
  v_lshlrev_b32 v20, 16, v98
  v_and_b32 v21, 0xffff0000, v98
  v_lshlrev_b32 v22, 16, v99
  v_and_b32 v23, 0xffff0000, v99
  v_lshlrev_b32 v24, 16, v100
  v_and_b32 v25, 0xffff0000, v100
  v_lshlrev_b32 v26, 16, v101
  v_and_b32 v27, 0xffff0000, v101
  v_lshlrev_b32 v28, 16, v102
  v_and_b32 v29, 0xffff0000, v102
  v_lshlrev_b32 v30, 16, v103
  v_and_b32 v31, 0xffff0000, v103
  v_add_f32 v32, v32, v48
  v_add_f32 v64, v64, v80
  v_add_f32 v33, v33, v49
  v_add_f32 v65, v65, v81
  v_add_f32 v34, v34, v50
  v_add_f32 v66, v66, v82
  v_add_f32 v35, v35, v51
  v_add_f32 v67, v67, v83
  v_add_f32 v36, v36, v52
  v_add_f32 v68, v68, v84
  v_add_f32 v37, v37, v53
  v_add_f32 v69, v69, v85
  v_add_f32 v38, v38, v54
  v_add_f32 v70, v70, v86
  v_add_f32 v39, v39, v55
  v_add_f32 v71, v71, v87
  v_add_f32 v40, v40, v56
  v_add_f32 v72, v72, v88
  v_add_f32 v41, v41, v57
  v_add_f32 v73, v73, v89
  v_add_f32 v42, v42, v58
  v_add_f32 v74, v74, v90
  v_add_f32 v43, v43, v59
  v_add_f32 v75, v75, v91
  v_add_f32 v44, v44, v60
  v_add_f32 v76, v76, v92
  v_add_f32 v45, v45, v61
  v_add_f32 v77, v77, v93
  v_add_f32 v46, v46, v62
  v_add_f32 v78, v78, v94
  v_add_f32 v47, v47, v63
  v_add_f32 v79, v79, v95
  v_add_f32 v32, v32, v64
  v_add_f32 v33, v33, v65
  v_add_f32 v34, v34, v66
  v_add_f32 v35, v35, v67
  v_add_f32 v36, v36, v68
  v_add_f32 v37, v37, v69
  v_add_f32 v38, v38, v70
  v_add_f32 v39, v39, v71
  v_add_f32 v40, v40, v72
  v_add_f32 v41, v41, v73
  v_add_f32 v42, v42, v74
  v_add_f32 v43, v43, v75
  v_add_f32 v44, v44, v76
  v_add_f32 v45, v45, v77
  v_add_f32 v46, v46, v78
  v_add_f32 v47, v47, v79
  v_add_f32 v16, v16, v32
  v_add_f32 v17, v17, v33
  v_add_f32 v18, v18, v34
  v_add_f32 v19, v19, v35
  v_add_f32 v20, v20, v36
  v_add_f32 v21, v21, v37
  v_add_f32 v22, v22, v38
  v_add_f32 v23, v23, v39
  v_add_f32 v24, v24, v40
  v_add_f32 v25, v25, v41
  v_add_f32 v26, v26, v42
  v_add_f32 v27, v27, v43
  v_add_f32 v28, v28, v44
  v_add_f32 v29, v29, v45
  v_add_f32 v30, v30, v46
  v_add_f32 v31, v31, v47
  s_add_u32 s26, s24, 20971520
  buffer_store_dwordx4 v[16:19], v6, s[8:11], s26 offen
  s_add_u32 s26, s24, 20972544
  buffer_store_dwordx4 v[20:23], v6, s[8:11], s26 offen
  s_add_u32 s26, s24, 20979712
  buffer_store_dwordx4 v[24:27], v6, s[8:11], s26 offen
  s_add_u32 s26, s24, 20980736
  buffer_store_dwordx4 v[28:31], v6, s[8:11], s26 offen
  v_add_f32 v10, v16, v17
  v_add_f32 v10, v10, v18
  v_add_f32 v10, v10, v19
  v_add_f32 v10, v10, v20
  v_add_f32 v10, v10, v21
  v_add_f32 v10, v10, v22
  v_add_f32 v10, v10, v23
  v_add_f32 v10, v10, v24
  v_add_f32 v10, v10, v25
  v_add_f32 v10, v10, v26
  v_add_f32 v10, v10, v27
  v_add_f32 v10, v10, v28
  v_add_f32 v10, v10, v29
  v_add_f32 v10, v10, v30
  v_add_f32 v10, v10, v31
  s_nop 1
  v_add_f32_dpp v10, v10, v10 row_ror:8 row_mask:0xf bank_mask:0xf
  v_mov_b32 v11, v10
  s_nop 1
  v_permlane16_swap_b32 v10, v11
  v_add_f32 v10, v10, v11
  v_mov_b32 v11, v10
  s_nop 1
  v_permlane32_swap_b32 v10, v11
  v_add_f32 v10, v10, v11
  v_lshlrev_b32 v12, 2, v2
  s_lshl_b32 s26, s21, 5
  v_add_u32 v13, s26, v12
  ds_write_b32 v13, v10
  s_waitcnt lgkmcnt(0)
  s_barrier
  ds_read_b32 v40, v12 offset:0
  ds_read_b32 v41, v12 offset:32
  ds_read_b32 v42, v12 offset:64
  ds_read_b32 v43, v12 offset:96
  ds_read_b32 v44, v12 offset:128
  s_waitcnt lgkmcnt(0)
  v_add_f32 v40, v40, v41
  v_add_f32 v42, v42, v43
  v_add_f32 v40, v40, v42
  v_add_f32 v40, v40, v44
  v_mul_f32 v40, 0x3acccccd, v40
  v_sub_f32 v48, v16, v40
  v_sub_f32 v49, v17, v40
  v_sub_f32 v50, v18, v40
  v_sub_f32 v51, v19, v40
  v_sub_f32 v52, v20, v40
  v_sub_f32 v53, v21, v40
  v_sub_f32 v54, v22, v40
  v_sub_f32 v55, v23, v40
  v_sub_f32 v56, v24, v40
  v_sub_f32 v57, v25, v40
  v_sub_f32 v58, v26, v40
  v_sub_f32 v59, v27, v40
  v_sub_f32 v60, v28, v40
  v_sub_f32 v61, v29, v40
  v_sub_f32 v62, v30, v40
  v_sub_f32 v63, v31, v40
  v_mul_f32 v10, v48, v48
  v_fmac_f32 v10, v49, v49
  v_fmac_f32 v10, v50, v50
  v_fmac_f32 v10, v51, v51
  v_fmac_f32 v10, v52, v52
  v_fmac_f32 v10, v53, v53
  v_fmac_f32 v10, v54, v54
  v_fmac_f32 v10, v55, v55
  v_fmac_f32 v10, v56, v56
  v_fmac_f32 v10, v57, v57
  v_fmac_f32 v10, v58, v58
  v_fmac_f32 v10, v59, v59
  v_fmac_f32 v10, v60, v60
  v_fmac_f32 v10, v61, v61
  v_fmac_f32 v10, v62, v62
  v_fmac_f32 v10, v63, v63
  s_nop 1
  v_add_f32_dpp v10, v10, v10 row_ror:8 row_mask:0xf bank_mask:0xf
  v_mov_b32 v11, v10
  s_nop 1
  v_permlane16_swap_b32 v10, v11
  v_add_f32 v10, v10, v11
  v_mov_b32 v11, v10
  s_nop 1
  v_permlane32_swap_b32 v10, v11
  v_add_f32 v10, v10, v11
  ds_write_b32 v13, v10 offset:256
  s_waitcnt lgkmcnt(0)
  s_barrier
  ds_read_b32 v40, v12 offset:256
  ds_read_b32 v41, v12 offset:288
  ds_read_b32 v42, v12 offset:320
  ds_read_b32 v43, v12 offset:352
  ds_read_b32 v44, v12 offset:384
  s_waitcnt lgkmcnt(0)
  v_add_f32 v40, v40, v41
  v_add_f32 v42, v42, v43
  v_add_f32 v40, v40, v42
  v_add_f32 v40, v40, v44
  v_mov_b32 v41, 0x3727c5ac
  v_fmac_f32 v41, 0x3acccccd, v40
  v_rsq_f32 v41, v41
  s_nop 0
  v_mul_f32 v48, v48, v41
  v_mul_f32 v49, v49, v41
  v_mul_f32 v50, v50, v41
  v_mul_f32 v51, v51, v41
  v_mul_f32 v52, v52, v41
  v_mul_f32 v53, v53, v41
  v_mul_f32 v54, v54, v41
  v_mul_f32 v55, v55, v41
  v_mul_f32 v56, v56, v41
  v_mul_f32 v57, v57, v41
  v_mul_f32 v58, v58, v41
  v_mul_f32 v59, v59, v41
  v_mul_f32 v60, v60, v41
  v_mul_f32 v61, v61, v41
  v_mul_f32 v62, v62, v41
  v_mul_f32 v63, v63, v41
  v_cvt_pk_bf16_f32 v64, v48, v49
  v_cvt_pk_bf16_f32 v65, v50, v51
  v_cvt_pk_bf16_f32 v66, v52, v53
  v_cvt_pk_bf16_f32 v67, v54, v55
  v_cvt_pk_bf16_f32 v68, v56, v57
  v_cvt_pk_bf16_f32 v69, v58, v59
  v_cvt_pk_bf16_f32 v70, v60, v61
  v_cvt_pk_bf16_f32 v71, v62, v63
  s_mul_i32 s26, s22, 40960
  s_lshl_b32 s27, s21, 13
  s_add_u32 s26, s26, s27
  s_add_u32 s26, s26, 0x100000
  buffer_store_dwordx4 v[64:67], v7, s[8:11], s26 offen
  s_add_u32 s26, s26, 4096
  buffer_store_dwordx4 v[68:71], v7, s[8:11], s26 offen
  s_cmp_eq_u32 s2, 0
  s_cbranch_scc0 kr1_exit
  s_cmp_eq_u32 s21, 0
  s_cbranch_scc0 kr1_exit
  v_mov_b32 v10, 0
  v_lshlrev_b32 v11, 2, v1
  s_mov_b32 s26, 0x1400
  buffer_store_dword v10, v11, s[8:11], s26 offen
kr1_exit:
  s_endpgm

.section .rodata,"a"
.p2align 6
.amdhsa_kernel red1_kernel
  .amdhsa_next_free_vgpr 128
  .amdhsa_next_free_sgpr 102
  .amdhsa_accum_offset 128
  .amdhsa_group_segment_fixed_size 0
  .amdhsa_kernarg_size 104
  .amdhsa_user_sgpr_count 2
  .amdhsa_user_sgpr_kernarg_segment_ptr 1
  .amdhsa_system_sgpr_workgroup_id_x 1
.end_amdhsa_kernel
.text
.globl qkv_kernel
.p2align 8
.type qkv_kernel,@function
qkv_kernel:
  s_cmp_ge_u32 s2, 256
  s_cbranch_scc1 kb1_exit
  s_load_dwordx2 s[4:5], s[0:1], 96
  v_lshrrev_b32 v1, 6, v0
  s_nop 0
  v_readfirstlane_b32 s21, v1
  v_and_b32 v1, 63, v0
  v_lshlrev_b32 v2, 4, v1
  s_waitcnt lgkmcnt(0)
  s_mov_b32 s8, s4
  s_and_b32 s9, s5, 0xffff
  s_mov_b32 s10, 0x10000000
  s_mov_b32 s11, 0x20000
  s_and_b32 s22, s2, 7
  s_lshl_b32 s22, s22, 2
  s_bfe_u32 s23, s2, 0x20003
  s_add_u32 s22, s22, s23
  s_lshr_b32 s23, s2, 5
  s_mul_i32 s24, s22, 122880
  s_mul_i32 s25, s21, 30720
  s_add_u32 s24, s24, s25
  s_add_u32 s24, s24, 0xe100000
  s_add_u32 m0, s25, 0
  s_add_u32 s26, s24, 0
  buffer_load_dwordx4 v2, s[8:11], s26 offen lds
  s_add_u32 m0, s25, 1024
  s_add_u32 s26, s24, 1024
  buffer_load_dwordx4 v2, s[8:11], s26 offen lds
  s_add_u32 m0, s25, 2048
  s_add_u32 s26, s24, 2048
  buffer_load_dwordx4 v2, s[8:11], s26 offen lds
  s_add_u32 m0, s25, 3072
  s_add_u32 s26, s24, 3072
  buffer_load_dwordx4 v2, s[8:11], s26 offen lds
  s_add_u32 m0, s25, 4096
  s_add_u32 s26, s24, 4096
  buffer_load_dwordx4 v2, s[8:11], s26 offen lds
  s_add_u32 m0, s25, 5120
  s_add_u32 s26, s24, 5120
  buffer_load_dwordx4 v2, s[8:11], s26 offen lds
  s_add_u32 m0, s25, 6144
  s_add_u32 s26, s24, 6144
  buffer_load_dwordx4 v2, s[8:11], s26 offen lds
  s_add_u32 m0, s25, 7168
  s_add_u32 s26, s24, 7168
  buffer_load_dwordx4 v2, s[8:11], s26 offen lds
  s_add_u32 m0, s25, 8192
  s_add_u32 s26, s24, 8192
  buffer_load_dwordx4 v2, s[8:11], s26 offen lds
  s_add_u32 m0, s25, 9216
  s_add_u32 s26, s24, 9216
  buffer_load_dwordx4 v2, s[8:11], s26 offen lds
  s_add_u32 m0, s25, 10240
  s_add_u32 s26, s24, 10240
  buffer_load_dwordx4 v2, s[8:11], s26 offen lds
  s_add_u32 m0, s25, 11264
  s_add_u32 s26, s24, 11264
  buffer_load_dwordx4 v2, s[8:11], s26 offen lds
  s_add_u32 m0, s25, 12288
  s_add_u32 s26, s24, 12288
  buffer_load_dwordx4 v2, s[8:11], s26 offen lds
  s_add_u32 m0, s25, 13312
  s_add_u32 s26, s24, 13312
  buffer_load_dwordx4 v2, s[8:11], s26 offen lds
  s_add_u32 m0, s25, 14336
  s_add_u32 s26, s24, 14336
  buffer_load_dwordx4 v2, s[8:11], s26 offen lds
  s_add_u32 m0, s25, 15360
  s_add_u32 s26, s24, 15360
  buffer_load_dwordx4 v2, s[8:11], s26 offen lds
  s_add_u32 m0, s25, 16384
  s_add_u32 s26, s24, 16384
  buffer_load_dwordx4 v2, s[8:11], s26 offen lds
  s_add_u32 m0, s25, 17408
  s_add_u32 s26, s24, 17408
  buffer_load_dwordx4 v2, s[8:11], s26 offen lds
  s_add_u32 m0, s25, 18432
  s_add_u32 s26, s24, 18432
  buffer_load_dwordx4 v2, s[8:11], s26 offen lds
  s_add_u32 m0, s25, 19456
  s_add_u32 s26, s24, 19456
  buffer_load_dwordx4 v2, s[8:11], s26 offen lds
  s_add_u32 m0, s25, 20480
  s_add_u32 s26, s24, 20480
  buffer_load_dwordx4 v2, s[8:11], s26 offen lds
  s_add_u32 m0, s25, 21504
  s_add_u32 s26, s24, 21504
  buffer_load_dwordx4 v2, s[8:11], s26 offen lds
  s_add_u32 m0, s25, 22528
  s_add_u32 s26, s24, 22528
  buffer_load_dwordx4 v2, s[8:11], s26 offen lds
  s_add_u32 m0, s25, 23552
  s_add_u32 s26, s24, 23552
  buffer_load_dwordx4 v2, s[8:11], s26 offen lds
  s_add_u32 m0, s25, 24576
  s_add_u32 s26, s24, 24576
  buffer_load_dwordx4 v2, s[8:11], s26 offen lds
  s_add_u32 m0, s25, 25600
  s_add_u32 s26, s24, 25600
  buffer_load_dwordx4 v2, s[8:11], s26 offen lds
  s_add_u32 m0, s25, 26624
  s_add_u32 s26, s24, 26624
  buffer_load_dwordx4 v2, s[8:11], s26 offen lds
  s_add_u32 m0, s25, 27648
  s_add_u32 s26, s24, 27648
  buffer_load_dwordx4 v2, s[8:11], s26 offen lds
  s_add_u32 m0, s25, 28672
  s_add_u32 s26, s24, 28672
  buffer_load_dwordx4 v2, s[8:11], s26 offen lds
  s_add_u32 m0, s25, 29696
  s_add_u32 s26, s24, 29696
  buffer_load_dwordx4 v2, s[8:11], s26 offen lds
  s_lshl_b32 s26, s23, 3
  s_lshl_b32 s27, s21, 1
  s_add_u32 s26, s26, s27
  s_mul_i32 s27, s26, 40960
  s_add_u32 s27, s27, 0x100000
  s_add_u32 s28, s27, 40960
  s_add_u32 s29, s27, 0
  buffer_load_dwordx4 v[16:19], v2, s[8:11], s29 offen
  s_add_u32 s29, s28, 0
  buffer_load_dwordx4 v[20:23], v2, s[8:11], s29 offen
  s_add_u32 s29, s27, 1024
  buffer_load_dwordx4 v[24:27], v2, s[8:11], s29 offen
  s_add_u32 s29, s28, 1024
  buffer_load_dwordx4 v[28:31], v2, s[8:11], s29 offen
  s_add_u32 s29, s27, 2048
  buffer_load_dwordx4 v[32:35], v2, s[8:11], s29 offen
  s_add_u32 s29, s28, 2048
  buffer_load_dwordx4 v[36:39], v2, s[8:11], s29 offen
  s_add_u32 s29, s27, 3072
  buffer_load_dwordx4 v[40:43], v2, s[8:11], s29 offen
  s_add_u32 s29, s28, 3072
  buffer_load_dwordx4 v[44:47], v2, s[8:11], s29 offen
  s_add_u32 s29, s27, 4096
  buffer_load_dwordx4 v[48:51], v2, s[8:11], s29 offen
  s_add_u32 s29, s28, 4096
  buffer_load_dwordx4 v[52:55], v2, s[8:11], s29 offen
  s_waitcnt vmcnt(10)
  s_barrier
  v_mov_b32 v3, v2
  v_add_u32 v4, 65536, v2
  ds_read_b128 v[160:163], v3 offset:0
  ds_read_b128 v[164:167], v3 offset:40960
  ds_read_b128 v[168:171], v4 offset:16384
  s_add_u32 s29, s27, 5120
  buffer_load_dwordx4 v[56:59], v2, s[8:11], s29 offen
  s_add_u32 s29, s28, 5120
  buffer_load_dwordx4 v[60:63], v2, s[8:11], s29 offen
  ds_read_b128 v[172:175], v3 offset:1024
  ds_read_b128 v[176:179], v3 offset:41984
  ds_read_b128 v[180:183], v4 offset:17408
  s_waitcnt lgkmcnt(3)
  s_waitcnt vmcnt(10)
  v_mfma_f32_32x32x16_bf16 v[64:79], v[160:163], v[16:19], 0
  v_mfma_f32_32x32x16_bf16 v[80:95], v[164:167], v[16:19], 0
  v_mfma_f32_32x32x16_bf16 v[96:111], v[16:19], v[168:171], 0
  v_mfma_f32_32x32x16_bf16 v[112:127], v[160:163], v[20:23], 0
  v_mfma_f32_32x32x16_bf16 v[128:143], v[164:167], v[20:23], 0
  v_mfma_f32_32x32x16_bf16 v[144:159], v[20:23], v[168:171], 0
  s_add_u32 s29, s27, 6144
  buffer_load_dwordx4 v[16:19], v2, s[8:11], s29 offen
  s_add_u32 s29, s28, 6144
  buffer_load_dwordx4 v[20:23], v2, s[8:11], s29 offen
  ds_read_b128 v[160:163], v3 offset:2048
  ds_read_b128 v[164:167], v3 offset:43008
  ds_read_b128 v[168:171], v4 offset:18432
  s_waitcnt lgkmcnt(3)
  s_waitcnt vmcnt(10)
  v_mfma_f32_32x32x16_bf16 v[64:79], v[172:175], v[24:27], v[64:79]
  v_mfma_f32_32x32x16_bf16 v[80:95], v[176:179], v[24:27], v[80:95]
  v_mfma_f32_32x32x16_bf16 v[96:111], v[24:27], v[180:183], v[96:111]
  v_mfma_f32_32x32x16_bf16 v[112:127], v[172:175], v[28:31], v[112:127]
  v_mfma_f32_32x32x16_bf16 v[128:143], v[176:179], v[28:31], v[128:143]
  v_mfma_f32_32x32x16_bf16 v[144:159], v[28:31], v[180:183], v[144:159]
  s_add_u32 s29, s27, 7168
  buffer_load_dwordx4 v[24:27], v2, s[8:11], s29 offen
  s_add_u32 s29, s28, 7168
  buffer_load_dwordx4 v[28:31], v2, s[8:11], s29 offen
  ds_read_b128 v[172:175], v3 offset:3072
  ds_read_b128 v[176:179], v3 offset:44032
  ds_read_b128 v[180:183], v4 offset:19456
  s_waitcnt lgkmcnt(3)
  s_waitcnt vmcnt(10)
  v_mfma_f32_32x32x16_bf16 v[64:79], v[160:163], v[32:35], v[64:79]
  v_mfma_f32_32x32x16_bf16 v[80:95], v[164:167], v[32:35], v[80:95]
  v_mfma_f32_32x32x16_bf16 v[96:111], v[32:35], v[168:171], v[96:111]
  v_mfma_f32_32x32x16_bf16 v[112:127], v[160:163], v[36:39], v[112:127]
  v_mfma_f32_32x32x16_bf16 v[128:143], v[164:167], v[36:39], v[128:143]
  v_mfma_f32_32x32x16_bf16 v[144:159], v[36:39], v[168:171], v[144:159]
  s_add_u32 s29, s27, 8192
  buffer_load_dwordx4 v[32:35], v2, s[8:11], s29 offen
  s_add_u32 s29, s28, 8192
  buffer_load_dwordx4 v[36:39], v2, s[8:11], s29 offen
  ds_read_b128 v[160:163], v3 offset:4096
  ds_read_b128 v[164:167], v3 offset:45056
  ds_read_b128 v[168:171], v4 offset:20480
  s_waitcnt lgkmcnt(3)
  s_waitcnt vmcnt(10)
  v_mfma_f32_32x32x16_bf16 v[64:79], v[172:175], v[40:43], v[64:79]
  v_mfma_f32_32x32x16_bf16 v[80:95], v[176:179], v[40:43], v[80:95]
  v_mfma_f32_32x32x16_bf16 v[96:111], v[40:43], v[180:183], v[96:111]
  v_mfma_f32_32x32x16_bf16 v[112:127], v[172:175], v[44:47], v[112:127]
  v_mfma_f32_32x32x16_bf16 v[128:143], v[176:179], v[44:47], v[128:143]
  v_mfma_f32_32x32x16_bf16 v[144:159], v[44:47], v[180:183], v[144:159]
  s_add_u32 s29, s27, 9216
  buffer_load_dwordx4 v[40:43], v2, s[8:11], s29 offen
  s_add_u32 s29, s28, 9216
  buffer_load_dwordx4 v[44:47], v2, s[8:11], s29 offen
  ds_read_b128 v[172:175], v3 offset:5120
  ds_read_b128 v[176:179], v3 offset:46080
  ds_read_b128 v[180:183], v4 offset:21504
  s_waitcnt lgkmcnt(3)
  s_waitcnt vmcnt(10)
  v_mfma_f32_32x32x16_bf16 v[64:79], v[160:163], v[48:51], v[64:79]
  v_mfma_f32_32x32x16_bf16 v[80:95], v[164:167], v[48:51], v[80:95]
  v_mfma_f32_32x32x16_bf16 v[96:111], v[48:51], v[168:171], v[96:111]
  v_mfma_f32_32x32x16_bf16 v[112:127], v[160:163], v[52:55], v[112:127]
  v_mfma_f32_32x32x16_bf16 v[128:143], v[164:167], v[52:55], v[128:143]
  v_mfma_f32_32x32x16_bf16 v[144:159], v[52:55], v[168:171], v[144:159]
  s_add_u32 s29, s27, 10240
  buffer_load_dwordx4 v[48:51], v2, s[8:11], s29 offen
  s_add_u32 s29, s28, 10240
  buffer_load_dwordx4 v[52:55], v2, s[8:11], s29 offen
  ds_read_b128 v[160:163], v3 offset:6144
  ds_read_b128 v[164:167], v3 offset:47104
  ds_read_b128 v[168:171], v4 offset:22528
  s_waitcnt lgkmcnt(3)
  s_waitcnt vmcnt(10)
  v_mfma_f32_32x32x16_bf16 v[64:79], v[172:175], v[56:59], v[64:79]
  v_mfma_f32_32x32x16_bf16 v[80:95], v[176:179], v[56:59], v[80:95]
  v_mfma_f32_32x32x16_bf16 v[96:111], v[56:59], v[180:183], v[96:111]
  v_mfma_f32_32x32x16_bf16 v[112:127], v[172:175], v[60:63], v[112:127]
  v_mfma_f32_32x32x16_bf16 v[128:143], v[176:179], v[60:63], v[128:143]
  v_mfma_f32_32x32x16_bf16 v[144:159], v[60:63], v[180:183], v[144:159]
  s_add_u32 s29, s27, 11264
  buffer_load_dwordx4 v[56:59], v2, s[8:11], s29 offen
  s_add_u32 s29, s28, 11264
  buffer_load_dwordx4 v[60:63], v2, s[8:11], s29 offen
  ds_read_b128 v[172:175], v3 offset:7168
  ds_read_b128 v[176:179], v3 offset:48128
  ds_read_b128 v[180:183], v4 offset:23552
  s_waitcnt lgkmcnt(3)
  s_waitcnt vmcnt(10)
  v_mfma_f32_32x32x16_bf16 v[64:79], v[160:163], v[16:19], v[64:79]
  v_mfma_f32_32x32x16_bf16 v[80:95], v[164:167], v[16:19], v[80:95]
  v_mfma_f32_32x32x16_bf16 v[96:111], v[16:19], v[168:171], v[96:111]
  v_mfma_f32_32x32x16_bf16 v[112:127], v[160:163], v[20:23], v[112:127]
  v_mfma_f32_32x32x16_bf16 v[128:143], v[164:167], v[20:23], v[128:143]
  v_mfma_f32_32x32x16_bf16 v[144:159], v[20:23], v[168:171], v[144:159]
  s_add_u32 s29, s27, 12288
  buffer_load_dwordx4 v[16:19], v2, s[8:11], s29 offen
  s_add_u32 s29, s28, 12288
  buffer_load_dwordx4 v[20:23], v2, s[8:11], s29 offen
  ds_read_b128 v[160:163], v3 offset:8192
  ds_read_b128 v[164:167], v3 offset:49152
  ds_read_b128 v[168:171], v4 offset:24576
  s_waitcnt lgkmcnt(3)
  s_waitcnt vmcnt(10)
  v_mfma_f32_32x32x16_bf16 v[64:79], v[172:175], v[24:27], v[64:79]
  v_mfma_f32_32x32x16_bf16 v[80:95], v[176:179], v[24:27], v[80:95]
  v_mfma_f32_32x32x16_bf16 v[96:111], v[24:27], v[180:183], v[96:111]
  v_mfma_f32_32x32x16_bf16 v[112:127], v[172:175], v[28:31], v[112:127]
  v_mfma_f32_32x32x16_bf16 v[128:143], v[176:179], v[28:31], v[128:143]
  v_mfma_f32_32x32x16_bf16 v[144:159], v[28:31], v[180:183], v[144:159]
  s_add_u32 s29, s27, 13312
  buffer_load_dwordx4 v[24:27], v2, s[8:11], s29 offen
  s_add_u32 s29, s28, 13312
  buffer_load_dwordx4 v[28:31], v2, s[8:11], s29 offen
  ds_read_b128 v[172:175], v3 offset:9216
  ds_read_b128 v[176:179], v3 offset:50176
  ds_read_b128 v[180:183], v4 offset:25600
  s_waitcnt lgkmcnt(3)
  s_waitcnt vmcnt(10)
  v_mfma_f32_32x32x16_bf16 v[64:79], v[160:163], v[32:35], v[64:79]
  v_mfma_f32_32x32x16_bf16 v[80:95], v[164:167], v[32:35], v[80:95]
  v_mfma_f32_32x32x16_bf16 v[96:111], v[32:35], v[168:171], v[96:111]
  v_mfma_f32_32x32x16_bf16 v[112:127], v[160:163], v[36:39], v[112:127]
  v_mfma_f32_32x32x16_bf16 v[128:143], v[164:167], v[36:39], v[128:143]
  v_mfma_f32_32x32x16_bf16 v[144:159], v[36:39], v[168:171], v[144:159]
  s_add_u32 s29, s27, 14336
  buffer_load_dwordx4 v[32:35], v2, s[8:11], s29 offen
  s_add_u32 s29, s28, 14336
  buffer_load_dwordx4 v[36:39], v2, s[8:11], s29 offen
  ds_read_b128 v[160:163], v3 offset:10240
  ds_read_b128 v[164:167], v3 offset:51200
  ds_read_b128 v[168:171], v4 offset:26624
  s_waitcnt lgkmcnt(3)
  s_waitcnt vmcnt(10)
  v_mfma_f32_32x32x16_bf16 v[64:79], v[172:175], v[40:43], v[64:79]
  v_mfma_f32_32x32x16_bf16 v[80:95], v[176:179], v[40:43], v[80:95]
  v_mfma_f32_32x32x16_bf16 v[96:111], v[40:43], v[180:183], v[96:111]
  v_mfma_f32_32x32x16_bf16 v[112:127], v[172:175], v[44:47], v[112:127]
  v_mfma_f32_32x32x16_bf16 v[128:143], v[176:179], v[44:47], v[128:143]
  v_mfma_f32_32x32x16_bf16 v[144:159], v[44:47], v[180:183], v[144:159]
  s_add_u32 s29, s27, 15360
  buffer_load_dwordx4 v[40:43], v2, s[8:11], s29 offen
  s_add_u32 s29, s28, 15360
  buffer_load_dwordx4 v[44:47], v2, s[8:11], s29 offen
  ds_read_b128 v[172:175], v3 offset:11264
  ds_read_b128 v[176:179], v3 offset:52224
  ds_read_b128 v[180:183], v4 offset:27648
  s_waitcnt lgkmcnt(3)
  s_waitcnt vmcnt(10)
  v_mfma_f32_32x32x16_bf16 v[64:79], v[160:163], v[48:51], v[64:79]
  v_mfma_f32_32x32x16_bf16 v[80:95], v[164:167], v[48:51], v[80:95]
  v_mfma_f32_32x32x16_bf16 v[96:111], v[48:51], v[168:171], v[96:111]
  v_mfma_f32_32x32x16_bf16 v[112:127], v[160:163], v[52:55], v[112:127]
  v_mfma_f32_32x32x16_bf16 v[128:143], v[164:167], v[52:55], v[128:143]
  v_mfma_f32_32x32x16_bf16 v[144:159], v[52:55], v[168:171], v[144:159]
  s_add_u32 s29, s27, 16384
  buffer_load_dwordx4 v[48:51], v2, s[8:11], s29 offen
  s_add_u32 s29, s28, 16384
  buffer_load_dwordx4 v[52:55], v2, s[8:11], s29 offen
  ds_read_b128 v[160:163], v3 offset:12288
  ds_read_b128 v[164:167], v3 offset:53248
  ds_read_b128 v[168:171], v4 offset:28672
  s_waitcnt lgkmcnt(3)
  s_waitcnt vmcnt(10)
  v_mfma_f32_32x32x16_bf16 v[64:79], v[172:175], v[56:59], v[64:79]
  v_mfma_f32_32x32x16_bf16 v[80:95], v[176:179], v[56:59], v[80:95]
  v_mfma_f32_32x32x16_bf16 v[96:111], v[56:59], v[180:183], v[96:111]
  v_mfma_f32_32x32x16_bf16 v[112:127], v[172:175], v[60:63], v[112:127]
  v_mfma_f32_32x32x16_bf16 v[128:143], v[176:179], v[60:63], v[128:143]
  v_mfma_f32_32x32x16_bf16 v[144:159], v[60:63], v[180:183], v[144:159]
  s_add_u32 s29, s27, 17408
  buffer_load_dwordx4 v[56:59], v2, s[8:11], s29 offen
  s_add_u32 s29, s28, 17408
  buffer_load_dwordx4 v[60:63], v2, s[8:11], s29 offen
  ds_read_b128 v[172:175], v3 offset:13312
  ds_read_b128 v[176:179], v3 offset:54272
  ds_read_b128 v[180:183], v4 offset:29696
  s_waitcnt lgkmcnt(3)
  s_waitcnt vmcnt(10)
  v_mfma_f32_32x32x16_bf16 v[64:79], v[160:163], v[16:19], v[64:79]
  v_mfma_f32_32x32x16_bf16 v[80:95], v[164:167], v[16:19], v[80:95]
  v_mfma_f32_32x32x16_bf16 v[96:111], v[16:19], v[168:171], v[96:111]
  v_mfma_f32_32x32x16_bf16 v[112:127], v[160:163], v[20:23], v[112:127]
  v_mfma_f32_32x32x16_bf16 v[128:143], v[164:167], v[20:23], v[128:143]
  v_mfma_f32_32x32x16_bf16 v[144:159], v[20:23], v[168:171], v[144:159]
  s_add_u32 s29, s27, 18432
  buffer_load_dwordx4 v[16:19], v2, s[8:11], s29 offen
  s_add_u32 s29, s28, 18432
  buffer_load_dwordx4 v[20:23], v2, s[8:11], s29 offen
  ds_read_b128 v[160:163], v3 offset:14336
  ds_read_b128 v[164:167], v3 offset:55296
  ds_read_b128 v[168:171], v4 offset:30720
  s_waitcnt lgkmcnt(3)
  s_waitcnt vmcnt(10)
  v_mfma_f32_32x32x16_bf16 v[64:79], v[172:175], v[24:27], v[64:79]
  v_mfma_f32_32x32x16_bf16 v[80:95], v[176:179], v[24:27], v[80:95]
  v_mfma_f32_32x32x16_bf16 v[96:111], v[24:27], v[180:183], v[96:111]
  v_mfma_f32_32x32x16_bf16 v[112:127], v[172:175], v[28:31], v[112:127]
  v_mfma_f32_32x32x16_bf16 v[128:143], v[176:179], v[28:31], v[128:143]
  v_mfma_f32_32x32x16_bf16 v[144:159], v[28:31], v[180:183], v[144:159]
  s_add_u32 s29, s27, 19456
  buffer_load_dwordx4 v[24:27], v2, s[8:11], s29 offen
  s_add_u32 s29, s28, 19456
  buffer_load_dwordx4 v[28:31], v2, s[8:11], s29 offen
  ds_read_b128 v[172:175], v3 offset:15360
  ds_read_b128 v[176:179], v3 offset:56320
  ds_read_b128 v[180:183], v4 offset:31744
  s_waitcnt lgkmcnt(3)
  s_waitcnt vmcnt(10)
  v_mfma_f32_32x32x16_bf16 v[64:79], v[160:163], v[32:35], v[64:79]
  v_mfma_f32_32x32x16_bf16 v[80:95], v[164:167], v[32:35], v[80:95]
  v_mfma_f32_32x32x16_bf16 v[96:111], v[32:35], v[168:171], v[96:111]
  v_mfma_f32_32x32x16_bf16 v[112:127], v[160:163], v[36:39], v[112:127]
  v_mfma_f32_32x32x16_bf16 v[128:143], v[164:167], v[36:39], v[128:143]
  v_mfma_f32_32x32x16_bf16 v[144:159], v[36:39], v[168:171], v[144:159]
  s_add_u32 s29, s27, 20480
  buffer_load_dwordx4 v[32:35], v2, s[8:11], s29 offen
  s_add_u32 s29, s28, 20480
  buffer_load_dwordx4 v[36:39], v2, s[8:11], s29 offen
  ds_read_b128 v[160:163], v3 offset:16384
  ds_read_b128 v[164:167], v3 offset:57344
  ds_read_b128 v[168:171], v4 offset:32768
  s_waitcnt lgkmcnt(3)
  s_waitcnt vmcnt(10)
  v_mfma_f32_32x32x16_bf16 v[64:79], v[172:175], v[40:43], v[64:79]
  v_mfma_f32_32x32x16_bf16 v[80:95], v[176:179], v[40:43], v[80:95]
  v_mfma_f32_32x32x16_bf16 v[96:111], v[40:43], v[180:183], v[96:111]
  v_mfma_f32_32x32x16_bf16 v[112:127], v[172:175], v[44:47], v[112:127]
  v_mfma_f32_32x32x16_bf16 v[128:143], v[176:179], v[44:47], v[128:143]
  v_mfma_f32_32x32x16_bf16 v[144:159], v[44:47], v[180:183], v[144:159]
  s_add_u32 s29, s27, 21504
  buffer_load_dwordx4 v[40:43], v2, s[8:11], s29 offen
  s_add_u32 s29, s28, 21504
  buffer_load_dwordx4 v[44:47], v2, s[8:11], s29 offen
  ds_read_b128 v[172:175], v3 offset:17408
  ds_read_b128 v[176:179], v3 offset:58368
  ds_read_b128 v[180:183], v4 offset:33792
  s_waitcnt lgkmcnt(3)
  s_waitcnt vmcnt(10)
  v_mfma_f32_32x32x16_bf16 v[64:79], v[160:163], v[48:51], v[64:79]
  v_mfma_f32_32x32x16_bf16 v[80:95], v[164:167], v[48:51], v[80:95]
  v_mfma_f32_32x32x16_bf16 v[96:111], v[48:51], v[168:171], v[96:111]
  v_mfma_f32_32x32x16_bf16 v[112:127], v[160:163], v[52:55], v[112:127]
  v_mfma_f32_32x32x16_bf16 v[128:143], v[164:167], v[52:55], v[128:143]
  v_mfma_f32_32x32x16_bf16 v[144:159], v[52:55], v[168:171], v[144:159]
  s_add_u32 s29, s27, 22528
  buffer_load_dwordx4 v[48:51], v2, s[8:11], s29 offen
  s_add_u32 s29, s28, 22528
  buffer_load_dwordx4 v[52:55], v2, s[8:11], s29 offen
  ds_read_b128 v[160:163], v3 offset:18432
  ds_read_b128 v[164:167], v3 offset:59392
  ds_read_b128 v[168:171], v4 offset:34816
  s_waitcnt lgkmcnt(3)
  s_waitcnt vmcnt(10)
  v_mfma_f32_32x32x16_bf16 v[64:79], v[172:175], v[56:59], v[64:79]
  v_mfma_f32_32x32x16_bf16 v[80:95], v[176:179], v[56:59], v[80:95]
  v_mfma_f32_32x32x16_bf16 v[96:111], v[56:59], v[180:183], v[96:111]
  v_mfma_f32_32x32x16_bf16 v[112:127], v[172:175], v[60:63], v[112:127]
  v_mfma_f32_32x32x16_bf16 v[128:143], v[176:179], v[60:63], v[128:143]
  v_mfma_f32_32x32x16_bf16 v[144:159], v[60:63], v[180:183], v[144:159]
  s_add_u32 s29, s27, 23552
  buffer_load_dwordx4 v[56:59], v2, s[8:11], s29 offen
  s_add_u32 s29, s28, 23552
  buffer_load_dwordx4 v[60:63], v2, s[8:11], s29 offen
  ds_read_b128 v[172:175], v3 offset:19456
  ds_read_b128 v[176:179], v3 offset:60416
  ds_read_b128 v[180:183], v4 offset:35840
  s_waitcnt lgkmcnt(3)
  s_waitcnt vmcnt(10)
  v_mfma_f32_32x32x16_bf16 v[64:79], v[160:163], v[16:19], v[64:79]
  v_mfma_f32_32x32x16_bf16 v[80:95], v[164:167], v[16:19], v[80:95]
  v_mfma_f32_32x32x16_bf16 v[96:111], v[16:19], v[168:171], v[96:111]
  v_mfma_f32_32x32x16_bf16 v[112:127], v[160:163], v[20:23], v[112:127]
  v_mfma_f32_32x32x16_bf16 v[128:143], v[164:167], v[20:23], v[128:143]
  v_mfma_f32_32x32x16_bf16 v[144:159], v[20:23], v[168:171], v[144:159]
  s_add_u32 s29, s27, 24576
  buffer_load_dwordx4 v[16:19], v2, s[8:11], s29 offen
  s_add_u32 s29, s28, 24576
  buffer_load_dwordx4 v[20:23], v2, s[8:11], s29 offen
  ds_read_b128 v[160:163], v3 offset:20480
  ds_read_b128 v[164:167], v3 offset:61440
  ds_read_b128 v[168:171], v4 offset:36864
  s_waitcnt lgkmcnt(3)
  s_waitcnt vmcnt(10)
  v_mfma_f32_32x32x16_bf16 v[64:79], v[172:175], v[24:27], v[64:79]
  v_mfma_f32_32x32x16_bf16 v[80:95], v[176:179], v[24:27], v[80:95]
  v_mfma_f32_32x32x16_bf16 v[96:111], v[24:27], v[180:183], v[96:111]
  v_mfma_f32_32x32x16_bf16 v[112:127], v[172:175], v[28:31], v[112:127]
  v_mfma_f32_32x32x16_bf16 v[128:143], v[176:179], v[28:31], v[128:143]
  v_mfma_f32_32x32x16_bf16 v[144:159], v[28:31], v[180:183], v[144:159]
  s_add_u32 s29, s27, 25600
  buffer_load_dwordx4 v[24:27], v2, s[8:11], s29 offen
  s_add_u32 s29, s28, 25600
  buffer_load_dwordx4 v[28:31], v2, s[8:11], s29 offen
  ds_read_b128 v[172:175], v3 offset:21504
  ds_read_b128 v[176:179], v3 offset:62464
  ds_read_b128 v[180:183], v4 offset:37888
  s_waitcnt lgkmcnt(3)
  s_waitcnt vmcnt(10)
  v_mfma_f32_32x32x16_bf16 v[64:79], v[160:163], v[32:35], v[64:79]
  v_mfma_f32_32x32x16_bf16 v[80:95], v[164:167], v[32:35], v[80:95]
  v_mfma_f32_32x32x16_bf16 v[96:111], v[32:35], v[168:171], v[96:111]
  v_mfma_f32_32x32x16_bf16 v[112:127], v[160:163], v[36:39], v[112:127]
  v_mfma_f32_32x32x16_bf16 v[128:143], v[164:167], v[36:39], v[128:143]
  v_mfma_f32_32x32x16_bf16 v[144:159], v[36:39], v[168:171], v[144:159]
  s_add_u32 s29, s27, 26624
  buffer_load_dwordx4 v[32:35], v2, s[8:11], s29 offen
  s_add_u32 s29, s28, 26624
  buffer_load_dwordx4 v[36:39], v2, s[8:11], s29 offen
  ds_read_b128 v[160:163], v3 offset:22528
  ds_read_b128 v[164:167], v3 offset:63488
  ds_read_b128 v[168:171], v4 offset:38912
  s_waitcnt lgkmcnt(3)
  s_waitcnt vmcnt(10)
  v_mfma_f32_32x32x16_bf16 v[64:79], v[172:175], v[40:43], v[64:79]
  v_mfma_f32_32x32x16_bf16 v[80:95], v[176:179], v[40:43], v[80:95]
  v_mfma_f32_32x32x16_bf16 v[96:111], v[40:43], v[180:183], v[96:111]
  v_mfma_f32_32x32x16_bf16 v[112:127], v[172:175], v[44:47], v[112:127]
  v_mfma_f32_32x32x16_bf16 v[128:143], v[176:179], v[44:47], v[128:143]
  v_mfma_f32_32x32x16_bf16 v[144:159], v[44:47], v[180:183], v[144:159]
  s_add_u32 s29, s27, 27648
  buffer_load_dwordx4 v[40:43], v2, s[8:11], s29 offen
  s_add_u32 s29, s28, 27648
  buffer_load_dwordx4 v[44:47], v2, s[8:11], s29 offen
  ds_read_b128 v[172:175], v3 offset:23552
  ds_read_b128 v[176:179], v3 offset:64512
  ds_read_b128 v[180:183], v4 offset:39936
  s_waitcnt lgkmcnt(3)
  s_waitcnt vmcnt(10)
  v_mfma_f32_32x32x16_bf16 v[64:79], v[160:163], v[48:51], v[64:79]
  v_mfma_f32_32x32x16_bf16 v[80:95], v[164:167], v[48:51], v[80:95]
  v_mfma_f32_32x32x16_bf16 v[96:111], v[48:51], v[168:171], v[96:111]
  v_mfma_f32_32x32x16_bf16 v[112:127], v[160:163], v[52:55], v[112:127]
  v_mfma_f32_32x32x16_bf16 v[128:143], v[164:167], v[52:55], v[128:143]
  v_mfma_f32_32x32x16_bf16 v[144:159], v[52:55], v[168:171], v[144:159]
  s_add_u32 s29, s27, 28672
  buffer_load_dwordx4 v[48:51], v2, s[8:11], s29 offen
  s_add_u32 s29, s28, 28672
  buffer_load_dwordx4 v[52:55], v2, s[8:11], s29 offen
  ds_read_b128 v[160:163], v3 offset:24576
  ds_read_b128 v[164:167], v4 offset:0
  ds_read_b128 v[168:171], v4 offset:40960
  s_waitcnt lgkmcnt(3)
  s_waitcnt vmcnt(10)
  v_mfma_f32_32x32x16_bf16 v[64:79], v[172:175], v[56:59], v[64:79]
  v_mfma_f32_32x32x16_bf16 v[80:95], v[176:179], v[56:59], v[80:95]
  v_mfma_f32_32x32x16_bf16 v[96:111], v[56:59], v[180:183], v[96:111]
  v_mfma_f32_32x32x16_bf16 v[112:127], v[172:175], v[60:63], v[112:127]
  v_mfma_f32_32x32x16_bf16 v[128:143], v[176:179], v[60:63], v[128:143]
  v_mfma_f32_32x32x16_bf16 v[144:159], v[60:63], v[180:183], v[144:159]
  s_add_u32 s29, s27, 29696
  buffer_load_dwordx4 v[56:59], v2, s[8:11], s29 offen
  s_add_u32 s29, s28, 29696
  buffer_load_dwordx4 v[60:63], v2, s[8:11], s29 offen
  ds_read_b128 v[172:175], v3 offset:25600
  ds_read_b128 v[176:179], v4 offset:1024
  ds_read_b128 v[180:183], v4 offset:41984
  s_waitcnt lgkmcnt(3)
  s_waitcnt vmcnt(10)
  v_mfma_f32_32x32x16_bf16 v[64:79], v[160:163], v[16:19], v[64:79]
  v_mfma_f32_32x32x16_bf16 v[80:95], v[164:167], v[16:19], v[80:95]
  v_mfma_f32_32x32x16_bf16 v[96:111], v[16:19], v[168:171], v[96:111]
  v_mfma_f32_32x32x16_bf16 v[112:127], v[160:163], v[20:23], v[112:127]
  v_mfma_f32_32x32x16_bf16 v[128:143], v[164:167], v[20:23], v[128:143]
  v_mfma_f32_32x32x16_bf16 v[144:159], v[20:23], v[168:171], v[144:159]
  s_add_u32 s29, s27, 30720
  buffer_load_dwordx4 v[16:19], v2, s[8:11], s29 offen
  s_add_u32 s29, s28, 30720
  buffer_load_dwordx4 v[20:23], v2, s[8:11], s29 offen
  ds_read_b128 v[160:163], v3 offset:26624
  ds_read_b128 v[164:167], v4 offset:2048
  ds_read_b128 v[168:171], v4 offset:43008
  s_waitcnt lgkmcnt(3)
  s_waitcnt vmcnt(10)
  v_mfma_f32_32x32x16_bf16 v[64:79], v[172:175], v[24:27], v[64:79]
  v_mfma_f32_32x32x16_bf16 v[80:95], v[176:179], v[24:27], v[80:95]
  v_mfma_f32_32x32x16_bf16 v[96:111], v[24:27], v[180:183], v[96:111]
  v_mfma_f32_32x32x16_bf16 v[112:127], v[172:175], v[28:31], v[112:127]
  v_mfma_f32_32x32x16_bf16 v[128:143], v[176:179], v[28:31], v[128:143]
  v_mfma_f32_32x32x16_bf16 v[144:159], v[28:31], v[180:183], v[144:159]
  s_add_u32 s29, s27, 31744
  buffer_load_dwordx4 v[24:27], v2, s[8:11], s29 offen
  s_add_u32 s29, s28, 31744
  buffer_load_dwordx4 v[28:31], v2, s[8:11], s29 offen
  ds_read_b128 v[172:175], v3 offset:27648
  ds_read_b128 v[176:179], v4 offset:3072
  ds_read_b128 v[180:183], v4 offset:44032
  s_waitcnt lgkmcnt(3)
  s_waitcnt vmcnt(10)
  v_mfma_f32_32x32x16_bf16 v[64:79], v[160:163], v[32:35], v[64:79]
  v_mfma_f32_32x32x16_bf16 v[80:95], v[164:167], v[32:35], v[80:95]
  v_mfma_f32_32x32x16_bf16 v[96:111], v[32:35], v[168:171], v[96:111]
  v_mfma_f32_32x32x16_bf16 v[112:127], v[160:163], v[36:39], v[112:127]
  v_mfma_f32_32x32x16_bf16 v[128:143], v[164:167], v[36:39], v[128:143]
  v_mfma_f32_32x32x16_bf16 v[144:159], v[36:39], v[168:171], v[144:159]
  s_add_u32 s29, s27, 32768
  buffer_load_dwordx4 v[32:35], v2, s[8:11], s29 offen
  s_add_u32 s29, s28, 32768
  buffer_load_dwordx4 v[36:39], v2, s[8:11], s29 offen
  ds_read_b128 v[160:163], v3 offset:28672
  ds_read_b128 v[164:167], v4 offset:4096
  ds_read_b128 v[168:171], v4 offset:45056
  s_waitcnt lgkmcnt(3)
  s_waitcnt vmcnt(10)
  v_mfma_f32_32x32x16_bf16 v[64:79], v[172:175], v[40:43], v[64:79]
  v_mfma_f32_32x32x16_bf16 v[80:95], v[176:179], v[40:43], v[80:95]
  v_mfma_f32_32x32x16_bf16 v[96:111], v[40:43], v[180:183], v[96:111]
  v_mfma_f32_32x32x16_bf16 v[112:127], v[172:175], v[44:47], v[112:127]
  v_mfma_f32_32x32x16_bf16 v[128:143], v[176:179], v[44:47], v[128:143]
  v_mfma_f32_32x32x16_bf16 v[144:159], v[44:47], v[180:183], v[144:159]
  s_add_u32 s29, s27, 33792
  buffer_load_dwordx4 v[40:43], v2, s[8:11], s29 offen
  s_add_u32 s29, s28, 33792
  buffer_load_dwordx4 v[44:47], v2, s[8:11], s29 offen
  ds_read_b128 v[172:175], v3 offset:29696
  ds_read_b128 v[176:179], v4 offset:5120
  ds_read_b128 v[180:183], v4 offset:46080
  s_waitcnt lgkmcnt(3)
  s_waitcnt vmcnt(10)
  v_mfma_f32_32x32x16_bf16 v[64:79], v[160:163], v[48:51], v[64:79]
  v_mfma_f32_32x32x16_bf16 v[80:95], v[164:167], v[48:51], v[80:95]
  v_mfma_f32_32x32x16_bf16 v[96:111], v[48:51], v[168:171], v[96:111]
  v_mfma_f32_32x32x16_bf16 v[112:127], v[160:163], v[52:55], v[112:127]
  v_mfma_f32_32x32x16_bf16 v[128:143], v[164:167], v[52:55], v[128:143]
  v_mfma_f32_32x32x16_bf16 v[144:159], v[52:55], v[168:171], v[144:159]
  s_add_u32 s29, s27, 34816
  buffer_load_dwordx4 v[48:51], v2, s[8:11], s29 offen
  s_add_u32 s29, s28, 34816
  buffer_load_dwordx4 v[52:55], v2, s[8:11], s29 offen
  ds_read_b128 v[160:163], v3 offset:30720
  ds_read_b128 v[164:167], v4 offset:6144
  ds_read_b128 v[168:171], v4 offset:47104
  s_waitcnt lgkmcnt(3)
  s_waitcnt vmcnt(10)
  v_mfma_f32_32x32x16_bf16 v[64:79], v[172:175], v[56:59], v[64:79]
  v_mfma_f32_32x32x16_bf16 v[80:95], v[176:179], v[56:59], v[80:95]
  v_mfma_f32_32x32x16_bf16 v[96:111], v[56:59], v[180:183], v[96:111]
  v_mfma_f32_32x32x16_bf16 v[112:127], v[172:175], v[60:63], v[112:127]
  v_mfma_f32_32x32x16_bf16 v[128:143], v[176:179], v[60:63], v[128:143]
  v_mfma_f32_32x32x16_bf16 v[144:159], v[60:63], v[180:183], v[144:159]
  s_add_u32 s29, s27, 35840
  buffer_load_dwordx4 v[56:59], v2, s[8:11], s29 offen
  s_add_u32 s29, s28, 35840
  buffer_load_dwordx4 v[60:63], v2, s[8:11], s29 offen
  ds_read_b128 v[172:175], v3 offset:31744
  ds_read_b128 v[176:179], v4 offset:7168
  ds_read_b128 v[180:183], v4 offset:48128
  s_waitcnt lgkmcnt(3)
  s_waitcnt vmcnt(10)
  v_mfma_f32_32x32x16_bf16 v[64:79], v[160:163], v[16:19], v[64:79]
  v_mfma_f32_32x32x16_bf16 v[80:95], v[164:167], v[16:19], v[80:95]
  v_mfma_f32_32x32x16_bf16 v[96:111], v[16:19], v[168:171], v[96:111]
  v_mfma_f32_32x32x16_bf16 v[112:127], v[160:163], v[20:23], v[112:127]
  v_mfma_f32_32x32x16_bf16 v[128:143], v[164:167], v[20:23], v[128:143]
  v_mfma_f32_32x32x16_bf16 v[144:159], v[20:23], v[168:171], v[144:159]
  s_add_u32 s29, s27, 36864
  buffer_load_dwordx4 v[16:19], v2, s[8:11], s29 offen
  s_add_u32 s29, s28, 36864
  buffer_load_dwordx4 v[20:23], v2, s[8:11], s29 offen
  ds_read_b128 v[160:163], v3 offset:32768
  ds_read_b128 v[164:167], v4 offset:8192
  ds_read_b128 v[168:171], v4 offset:49152
  s_waitcnt lgkmcnt(3)
  s_waitcnt vmcnt(10)
  v_mfma_f32_32x32x16_bf16 v[64:79], v[172:175], v[24:27], v[64:79]
  v_mfma_f32_32x32x16_bf16 v[80:95], v[176:179], v[24:27], v[80:95]
  v_mfma_f32_32x32x16_bf16 v[96:111], v[24:27], v[180:183], v[96:111]
  v_mfma_f32_32x32x16_bf16 v[112:127], v[172:175], v[28:31], v[112:127]
  v_mfma_f32_32x32x16_bf16 v[128:143], v[176:179], v[28:31], v[128:143]
  v_mfma_f32_32x32x16_bf16 v[144:159], v[28:31], v[180:183], v[144:159]
  s_add_u32 s29, s27, 37888
  buffer_load_dwordx4 v[24:27], v2, s[8:11], s29 offen
  s_add_u32 s29, s28, 37888
  buffer_load_dwordx4 v[28:31], v2, s[8:11], s29 offen
  ds_read_b128 v[172:175], v3 offset:33792
  ds_read_b128 v[176:179], v4 offset:9216
  ds_read_b128 v[180:183], v4 offset:50176
  s_waitcnt lgkmcnt(3)
  s_waitcnt vmcnt(10)
  v_mfma_f32_32x32x16_bf16 v[64:79], v[160:163], v[32:35], v[64:79]
  v_mfma_f32_32x32x16_bf16 v[80:95], v[164:167], v[32:35], v[80:95]
  v_mfma_f32_32x32x16_bf16 v[96:111], v[32:35], v[168:171], v[96:111]
  v_mfma_f32_32x32x16_bf16 v[112:127], v[160:163], v[36:39], v[112:127]
  v_mfma_f32_32x32x16_bf16 v[128:143], v[164:167], v[36:39], v[128:143]
  v_mfma_f32_32x32x16_bf16 v[144:159], v[36:39], v[168:171], v[144:159]
  s_add_u32 s29, s27, 38912
  buffer_load_dwordx4 v[32:35], v2, s[8:11], s29 offen
  s_add_u32 s29, s28, 38912
  buffer_load_dwordx4 v[36:39], v2, s[8:11], s29 offen
  ds_read_b128 v[160:163], v3 offset:34816
  ds_read_b128 v[164:167], v4 offset:10240
  ds_read_b128 v[168:171], v4 offset:51200
  s_waitcnt lgkmcnt(3)
  s_waitcnt vmcnt(10)
  v_mfma_f32_32x32x16_bf16 v[64:79], v[172:175], v[40:43], v[64:79]
  v_mfma_f32_32x32x16_bf16 v[80:95], v[176:179], v[40:43], v[80:95]
  v_mfma_f32_32x32x16_bf16 v[96:111], v[40:43], v[180:183], v[96:111]
  v_mfma_f32_32x32x16_bf16 v[112:127], v[172:175], v[44:47], v[112:127]
  v_mfma_f32_32x32x16_bf16 v[128:143], v[176:179], v[44:47], v[128:143]
  v_mfma_f32_32x32x16_bf16 v[144:159], v[44:47], v[180:183], v[144:159]
  s_add_u32 s29, s27, 39936
  buffer_load_dwordx4 v[40:43], v2, s[8:11], s29 offen
  s_add_u32 s29, s28, 39936
  buffer_load_dwordx4 v[44:47], v2, s[8:11], s29 offen
  ds_read_b128 v[172:175], v3 offset:35840
  ds_read_b128 v[176:179], v4 offset:11264
  ds_read_b128 v[180:183], v4 offset:52224
  s_waitcnt lgkmcnt(3)
  s_waitcnt vmcnt(10)
  v_mfma_f32_32x32x16_bf16 v[64:79], v[160:163], v[48:51], v[64:79]
  v_mfma_f32_32x32x16_bf16 v[80:95], v[164:167], v[48:51], v[80:95]
  v_mfma_f32_32x32x16_bf16 v[96:111], v[48:51], v[168:171], v[96:111]
  v_mfma_f32_32x32x16_bf16 v[112:127], v[160:163], v[52:55], v[112:127]
  v_mfma_f32_32x32x16_bf16 v[128:143], v[164:167], v[52:55], v[128:143]
  v_mfma_f32_32x32x16_bf16 v[144:159], v[52:55], v[168:171], v[144:159]
  ds_read_b128 v[160:163], v3 offset:36864
  ds_read_b128 v[164:167], v4 offset:12288
  ds_read_b128 v[168:171], v4 offset:53248
  s_waitcnt lgkmcnt(3)
  s_waitcnt vmcnt(8)
  v_mfma_f32_32x32x16_bf16 v[64:79], v[172:175], v[56:59], v[64:79]
  v_mfma_f32_32x32x16_bf16 v[80:95], v[176:179], v[56:59], v[80:95]
  v_mfma_f32_32x32x16_bf16 v[96:111], v[56:59], v[180:183], v[96:111]
  v_mfma_f32_32x32x16_bf16 v[112:127], v[172:175], v[60:63], v[112:127]
  v_mfma_f32_32x32x16_bf16 v[128:143], v[176:179], v[60:63], v[128:143]
  v_mfma_f32_32x32x16_bf16 v[144:159], v[60:63], v[180:183], v[144:159]
  ds_read_b128 v[172:175], v3 offset:37888
  ds_read_b128 v[176:179], v4 offset:13312
  ds_read_b128 v[180:183], v4 offset:54272
  s_waitcnt lgkmcnt(3)
  s_waitcnt vmcnt(6)
  v_mfma_f32_32x32x16_bf16 v[64:79], v[160:163], v[16:19], v[64:79]
  v_mfma_f32_32x32x16_bf16 v[80:95], v[164:167], v[16:19], v[80:95]
  v_mfma_f32_32x32x16_bf16 v[96:111], v[16:19], v[168:171], v[96:111]
  v_mfma_f32_32x32x16_bf16 v[112:127], v[160:163], v[20:23], v[112:127]
  v_mfma_f32_32x32x16_bf16 v[128:143], v[164:167], v[20:23], v[128:143]
  v_mfma_f32_32x32x16_bf16 v[144:159], v[20:23], v[168:171], v[144:159]
  ds_read_b128 v[160:163], v3 offset:38912
  ds_read_b128 v[164:167], v4 offset:14336
  ds_read_b128 v[168:171], v4 offset:55296
  s_waitcnt lgkmcnt(3)
  s_waitcnt vmcnt(4)
  v_mfma_f32_32x32x16_bf16 v[64:79], v[172:175], v[24:27], v[64:79]
  v_mfma_f32_32x32x16_bf16 v[80:95], v[176:179], v[24:27], v[80:95]
  v_mfma_f32_32x32x16_bf16 v[96:111], v[24:27], v[180:183], v[96:111]
  v_mfma_f32_32x32x16_bf16 v[112:127], v[172:175], v[28:31], v[112:127]
  v_mfma_f32_32x32x16_bf16 v[128:143], v[176:179], v[28:31], v[128:143]
  v_mfma_f32_32x32x16_bf16 v[144:159], v[28:31], v[180:183], v[144:159]
  ds_read_b128 v[172:175], v3 offset:39936
  ds_read_b128 v[176:179], v4 offset:15360
  ds_read_b128 v[180:183], v4 offset:56320
  s_waitcnt lgkmcnt(3)
  s_waitcnt vmcnt(2)
  v_mfma_f32_32x32x16_bf16 v[64:79], v[160:163], v[32:35], v[64:79]
  v_mfma_f32_32x32x16_bf16 v[80:95], v[164:167], v[32:35], v[80:95]
  v_mfma_f32_32x32x16_bf16 v[96:111], v[32:35], v[168:171], v[96:111]
  v_mfma_f32_32x32x16_bf16 v[112:127], v[160:163], v[36:39], v[112:127]
  v_mfma_f32_32x32x16_bf16 v[128:143], v[164:167], v[36:39], v[128:143]
  v_mfma_f32_32x32x16_bf16 v[144:159], v[36:39], v[168:171], v[144:159]
  s_waitcnt lgkmcnt(0)
  s_waitcnt vmcnt(0)
  v_mfma_f32_32x32x16_bf16 v[64:79], v[172:175], v[40:43], v[64:79]
  v_mfma_f32_32x32x16_bf16 v[80:95], v[176:179], v[40:43], v[80:95]
  v_mfma_f32_32x32x16_bf16 v[96:111], v[40:43], v[180:183], v[96:111]
  v_mfma_f32_32x32x16_bf16 v[112:127], v[172:175], v[44:47], v[112:127]
  v_mfma_f32_32x32x16_bf16 v[128:143], v[176:179], v[44:47], v[128:143]
  v_mfma_f32_32x32x16_bf16 v[144:159], v[44:47], v[180:183], v[144:159]
  s_nop 11
  s_mov_b32 s30, 0x3ea52b5c
  v_mov_b32 v5, 0
  v_cmp_gt_u32 vcc, 32, v1
  v_mov_b32 v6, 1.0
  s_nop 0
  v_cndmask_b32 v6, v5, v6, vcc
  v_and_b32 v7, 31, v1
  v_cmp_eq_u32 s[32:33], 20, v7
  v_mov_b32 v8, 1.0
  s_lshl_b32 s31, s22, 6
  s_add_u32 s31, s31, s26
  s_lshl_b32 s31, s31, 11
  v_mov_b32 v9, 0
  v_mul_f32 v64, s30, v64
  v_mul_f32 v65, s30, v65
  v_mul_f32 v66, s30, v66
  v_mul_f32 v67, s30, v67
  v_mul_f32 v68, s30, v68
  v_mul_f32 v69, s30, v69
  v_mul_f32 v70, s30, v70
  v_mul_f32 v71, s30, v71
  v_mul_f32 v72, s30, v72
  v_mul_f32 v73, s30, v73
  v_mul_f32 v74, s30, v74
  v_mul_f32 v75, s30, v75
  v_mul_f32 v76, s30, v76
  v_mul_f32 v77, s30, v77
  v_mul_f32 v78, s30, v78
  v_mul_f32 v79, s30, v79
  v_max3_f32 v9, v9, abs(v80), abs(v81)
  v_max3_f32 v9, v9, abs(v82), abs(v83)
  v_max3_f32 v9, v9, abs(v84), abs(v85)
  v_max3_f32 v9, v9, abs(v86), abs(v87)
  v_max3_f32 v9, v9, abs(v88), abs(v89)
  v_max3_f32 v9, v9, abs(v90), abs(v91)
  v_max3_f32 v9, v9, abs(v92), abs(v93)
  v_max3_f32 v9, v9, abs(v94), abs(v95)
  v_add_f32 v92, v92, v6
  v_cndmask_b32 v96, v96, v8, s[32:33]
  v_cndmask_b32 v97, v97, v8, s[32:33]
  v_cndmask_b32 v98, v98, v8, s[32:33]
  v_cndmask_b32 v99, v99, v8, s[32:33]
  v_cndmask_b32 v100, v100, v8, s[32:33]
  v_cndmask_b32 v101, v101, v8, s[32:33]
  v_cndmask_b32 v102, v102, v8, s[32:33]
  v_cndmask_b32 v103, v103, v8, s[32:33]
  v_cndmask_b32 v104, v104, v8, s[32:33]
  v_cndmask_b32 v105, v105, v8, s[32:33]
  v_cndmask_b32 v106, v106, v8, s[32:33]
  v_cndmask_b32 v107, v107, v8, s[32:33]
  v_cndmask_b32 v108, v108, v8, s[32:33]
  v_cndmask_b32 v109, v109, v8, s[32:33]
  v_cndmask_b32 v110, v110, v8, s[32:33]
  v_cndmask_b32 v111, v111, v8, s[32:33]
  v_cvt_pk_bf16_f32 v16, v64, v65
  v_cvt_pk_bf16_f32 v17, v66, v67
  v_cvt_pk_bf16_f32 v18, v68, v69
  v_cvt_pk_bf16_f32 v19, v70, v71
  v_cvt_pk_bf16_f32 v20, v72, v73
  v_cvt_pk_bf16_f32 v21, v74, v75
  v_cvt_pk_bf16_f32 v22, v76, v77
  v_cvt_pk_bf16_f32 v23, v78, v79
  s_add_u32 s29, s31, 241172480
  buffer_store_dwordx4 v[16:19], v2, s[8:11], s29 offen
  buffer_store_dwordx4 v[20:23], v2, s[8:11], s29 offen offset:1024
  s_nop 1
  v_cvt_pk_bf16_f32 v16, v80, v81
  v_cvt_pk_bf16_f32 v17, v82, v83
  v_cvt_pk_bf16_f32 v18, v84, v85
  v_cvt_pk_bf16_f32 v19, v86, v87
  v_cvt_pk_bf16_f32 v20, v88, v89
  v_cvt_pk_bf16_f32 v21, v90, v91
  v_cvt_pk_bf16_f32 v22, v92, v93
  v_cvt_pk_bf16_f32 v23, v94, v95
  s_add_u32 s29, s31, 245366784
  buffer_store_dwordx4 v[16:19], v2, s[8:11], s29 offen
  buffer_store_dwordx4 v[20:23], v2, s[8:11], s29 offen offset:1024
  s_nop 1
  v_cvt_pk_bf16_f32 v16, v96, v97
  v_cvt_pk_bf16_f32 v17, v98, v99
  v_cvt_pk_bf16_f32 v18, v100, v101
  v_cvt_pk_bf16_f32 v19, v102, v103
  v_cvt_pk_bf16_f32 v20, v104, v105
  v_cvt_pk_bf16_f32 v21, v106, v107
  v_cvt_pk_bf16_f32 v22, v108, v109
  v_cvt_pk_bf16_f32 v23, v110, v111
  s_add_u32 s29, s31, 249561088
  buffer_store_dwordx4 v[16:19], v2, s[8:11], s29 offen
  buffer_store_dwordx4 v[20:23], v2, s[8:11], s29 offen offset:1024
  s_nop 1
  v_mul_f32 v112, s30, v112
  v_mul_f32 v113, s30, v113
  v_mul_f32 v114, s30, v114
  v_mul_f32 v115, s30, v115
  v_mul_f32 v116, s30, v116
  v_mul_f32 v117, s30, v117
  v_mul_f32 v118, s30, v118
  v_mul_f32 v119, s30, v119
  v_mul_f32 v120, s30, v120
  v_mul_f32 v121, s30, v121
  v_mul_f32 v122, s30, v122
  v_mul_f32 v123, s30, v123
  v_mul_f32 v124, s30, v124
  v_mul_f32 v125, s30, v125
  v_mul_f32 v126, s30, v126
  v_mul_f32 v127, s30, v127
  v_max3_f32 v9, v9, abs(v128), abs(v129)
  v_max3_f32 v9, v9, abs(v130), abs(v131)
  v_max3_f32 v9, v9, abs(v132), abs(v133)
  v_max3_f32 v9, v9, abs(v134), abs(v135)
  v_max3_f32 v9, v9, abs(v136), abs(v137)
  v_max3_f32 v9, v9, abs(v138), abs(v139)
  v_max3_f32 v9, v9, abs(v140), abs(v141)
  v_max3_f32 v9, v9, abs(v142), abs(v143)
  v_add_f32 v140, v140, v6
  v_cndmask_b32 v144, v144, v8, s[32:33]
  v_cndmask_b32 v145, v145, v8, s[32:33]
  v_cndmask_b32 v146, v146, v8, s[32:33]
  v_cndmask_b32 v147, v147, v8, s[32:33]
  v_cndmask_b32 v148, v148, v8, s[32:33]
  v_cndmask_b32 v149, v149, v8, s[32:33]
  v_cndmask_b32 v150, v150, v8, s[32:33]
  v_cndmask_b32 v151, v151, v8, s[32:33]
  v_cndmask_b32 v152, v152, v8, s[32:33]
  v_cndmask_b32 v153, v153, v8, s[32:33]
  v_cndmask_b32 v154, v154, v8, s[32:33]
  v_cndmask_b32 v155, v155, v8, s[32:33]
  v_cndmask_b32 v156, v156, v8, s[32:33]
  v_cndmask_b32 v157, v157, v8, s[32:33]
  v_cndmask_b32 v158, v158, v8, s[32:33]
  v_cndmask_b32 v159, v159, v8, s[32:33]
  v_cvt_pk_bf16_f32 v16, v112, v113
  v_cvt_pk_bf16_f32 v17, v114, v115
  v_cvt_pk_bf16_f32 v18, v116, v117
  v_cvt_pk_bf16_f32 v19, v118, v119
  v_cvt_pk_bf16_f32 v20, v120, v121
  v_cvt_pk_bf16_f32 v21, v122, v123
  v_cvt_pk_bf16_f32 v22, v124, v125
  v_cvt_pk_bf16_f32 v23, v126, v127
  s_add_u32 s29, s31, 241174528
  buffer_store_dwordx4 v[16:19], v2, s[8:11], s29 offen
  buffer_store_dwordx4 v[20:23], v2, s[8:11], s29 offen offset:1024
  s_nop 1
  v_cvt_pk_bf16_f32 v16, v128, v129
  v_cvt_pk_bf16_f32 v17, v130, v131
  v_cvt_pk_bf16_f32 v18, v132, v133
  v_cvt_pk_bf16_f32 v19, v134, v135
  v_cvt_pk_bf16_f32 v20, v136, v137
  v_cvt_pk_bf16_f32 v21, v138, v139
  v_cvt_pk_bf16_f32 v22, v140, v141
  v_cvt_pk_bf16_f32 v23, v142, v143
  s_add_u32 s29, s31, 245368832
  buffer_store_dwordx4 v[16:19], v2, s[8:11], s29 offen
  buffer_store_dwordx4 v[20:23], v2, s[8:11], s29 offen offset:1024
  s_nop 1
  v_cvt_pk_bf16_f32 v16, v144, v145
  v_cvt_pk_bf16_f32 v17, v146, v147
  v_cvt_pk_bf16_f32 v18, v148, v149
  v_cvt_pk_bf16_f32 v19, v150, v151
  v_cvt_pk_bf16_f32 v20, v152, v153
  v_cvt_pk_bf16_f32 v21, v154, v155
  v_cvt_pk_bf16_f32 v22, v156, v157
  v_cvt_pk_bf16_f32 v23, v158, v159
  s_add_u32 s29, s31, 249563136
  buffer_store_dwordx4 v[16:19], v2, s[8:11], s29 offen
  buffer_store_dwordx4 v[20:23], v2, s[8:11], s29 offen offset:1024
  s_nop 1
  s_nop 1
  v_max_f32_dpp v10, v9, v9 quad_perm:[1,0,3,2] row_mask:0xf bank_mask:0xf
  s_nop 1
  v_max_f32_dpp v9, v10, v10 quad_perm:[2,3,0,1] row_mask:0xf bank_mask:0xf
  s_nop 1
  v_max_f32_dpp v10, v9, v9 row_half_mirror row_mask:0xf bank_mask:0xf
  s_nop 1
  v_max_f32_dpp v9, v10, v10 row_mirror row_mask:0xf bank_mask:0xf
  v_mov_b32 v10, v9
  s_nop 1
  v_permlane16_swap_b32 v9, v10
  v_max_f32 v9, v9, v10
  v_mov_b32 v10, v9
  s_nop 1
  v_permlane32_swap_b32 v9, v10
  v_max_f32 v9, v9, v10
  s_lshl_b32 s29, s22, 2
  s_add_u32 s29, s29, 0x1400
  v_mov_b32 v11, 0
  s_mov_b64 exec, 1
  buffer_atomic_umax v9, v11, s[8:11], s29 offen
kb1_exit:
  s_endpgm

.section .rodata,"a"
.p2align 6
.amdhsa_kernel qkv_kernel
  .amdhsa_next_free_vgpr 256
  .amdhsa_next_free_sgpr 102
  .amdhsa_accum_offset 256
  .amdhsa_group_segment_fixed_size 0
  .amdhsa_kernarg_size 104
  .amdhsa_user_sgpr_count 2
  .amdhsa_user_sgpr_kernarg_segment_ptr 1
  .amdhsa_system_sgpr_workgroup_id_x 1
.end_amdhsa_kernel
.text
.globl att1_kernel
.p2align 8
.type att1_kernel,@function
att1_kernel:
  s_cmp_ge_u32 s2, 256
  s_cbranch_scc1 kb2a_exit
  s_load_dwordx2 s[4:5], s[0:1], 96
  v_lshrrev_b32 v1, 6, v0
  s_nop 0
  v_readfirstlane_b32 s21, v1
  v_and_b32 v1, 63, v0
  v_lshlrev_b32 v2, 4, v1
  s_waitcnt lgkmcnt(0)
  s_mov_b32 s8, s4
  s_and_b32 s9, s5, 0xffff
  s_mov_b32 s10, 0x10000000
  s_mov_b32 s11, 0x20000
  s_and_b32 s22, s2, 7
  s_lshl_b32 s22, s22, 2
  s_bfe_u32 s23, s2, 0x20003
  s_add_u32 s22, s22, s23
  s_lshr_b32 s23, s2, 5
  s_lshl_b32 s24, s23, 3
  s_lshl_b32 s25, s21, 1
  s_add_u32 s24, s24, s25
  s_lshl_b32 s25, s22, 6
  s_add_u32 s26, s25, s24
  s_lshl_b32 s26, s26, 11
  s_add_u32 s26, s26, 0xe600000
  buffer_load_dwordx4 v[16:19], v2, s[8:11], s26 offen
  buffer_load_dwordx4 v[20:23], v2, s[8:11], s26 offen offset:1024
  s_add_u32 s26, s26, 2048
  buffer_load_dwordx4 v[24:27], v2, s[8:11], s26 offen
  buffer_load_dwordx4 v[28:31], v2, s[8:11], s26 offen offset:1024
  s_lshl_b32 s26, s22, 2
  s_add_u32 s26, s26, 0x1400
  v_mov_b32 v3, 0
  buffer_load_dword v4, v3, s[8:11], s26 offen
  s_lshl_b32 s27, s25, 11
  s_add_u32 s28, s27, 0xee00000
  s_add_u32 s27, s27, 0xea00000
  v_mov_b32 v8, -1
  v_mov_b32 v9, -1
  v_mov_b32 v10, -1
  v_mov_b32 v11, -1
  s_mul_i32 s30, s2, 61440
  s_mul_i32 s31, s21, 15360
  s_add_u32 s30, s30, s31
  s_add_u32 s30, s30, 0x400000
  buffer_store_dwordx4 v[8:11], v2, s[8:11], s30 offen
  s_add_u32 s30, s30, 1024
  buffer_store_dwordx4 v[8:11], v2, s[8:11], s30 offen
  s_add_u32 s30, s30, 1024
  buffer_store_dwordx4 v[8:11], v2, s[8:11], s30 offen
  s_add_u32 s30, s30, 1024
  buffer_store_dwordx4 v[8:11], v2, s[8:11], s30 offen
  s_add_u32 s30, s30, 1024
  buffer_store_dwordx4 v[8:11], v2, s[8:11], s30 offen
  s_add_u32 s30, s30, 1024
  buffer_store_dwordx4 v[8:11], v2, s[8:11], s30 offen
  s_add_u32 s30, s30, 1024
  buffer_store_dwordx4 v[8:11], v2, s[8:11], s30 offen
  s_add_u32 s30, s30, 1024
  buffer_store_dwordx4 v[8:11], v2, s[8:11], s30 offen
  s_add_u32 s30, s30, 1024
  buffer_store_dwordx4 v[8:11], v2, s[8:11], s30 offen
  s_add_u32 s30, s30, 1024
  buffer_store_dwordx4 v[8:11], v2, s[8:11], s30 offen
  s_add_u32 s30, s30, 1024
  buffer_store_dwordx4 v[8:11], v2, s[8:11], s30 offen
  s_add_u32 s30, s30, 1024
  buffer_store_dwordx4 v[8:11], v2, s[8:11], s30 offen
  s_add_u32 s30, s30, 1024
  buffer_store_dwordx4 v[8:11], v2, s[8:11], s30 offen
  s_add_u32 s30, s30, 1024
  buffer_store_dwordx4 v[8:11], v2, s[8:11], s30 offen
  s_add_u32 s30, s30, 1024
  buffer_store_dwordx4 v[8:11], v2, s[8:11], s30 offen
  s_add_u32 s30, s30, 1024
  s_cmp_eq_u32 s2, 0
  s_cbranch_scc0 z_92
  s_cmp_eq_u32 s21, 0
  s_cbranch_scc0 z_92
  v_mov_b32 v8, 0
  v_mov_b32 v9, 0
  v_mov_b32 v10, 0
  v_mov_b32 v11, 0
  s_mov_b32 s30, 0x0
  buffer_store_dwordx4 v[8:11], v2, s[8:11], s30 offen
  s_add_u32 s30, s30, 1024
  buffer_store_dwordx4 v[8:11], v2, s[8:11], s30 offen
  s_add_u32 s30, s30, 1024
  buffer_store_dwordx4 v[8:11], v2, s[8:11], s30 offen
  s_add_u32 s30, s30, 1024
  buffer_store_dwordx4 v[8:11], v2, s[8:11], s30 offen
  s_add_u32 s30, s30, 1024
  buffer_store_dwordx4 v[8:11], v2, s[8:11], s30 offen
  s_add_u32 s30, s30, 1024
z_92:
  s_waitcnt vmcnt(0)
  v_mov_b32 v5, 0
  v_lshlrev_b32 v6, 16, v16
  v_and_b32 v7, 0xffff0000, v16
  v_add_f32_e64 v5, v5, abs(v6)
  v_add_f32_e64 v5, v5, abs(v7)
  v_lshlrev_b32 v6, 16, v17
  v_and_b32 v7, 0xffff0000, v17
  v_add_f32_e64 v5, v5, abs(v6)
  v_add_f32_e64 v5, v5, abs(v7)
  v_lshlrev_b32 v6, 16, v18
  v_and_b32 v7, 0xffff0000, v18
  v_add_f32_e64 v5, v5, abs(v6)
  v_add_f32_e64 v5, v5, abs(v7)
  v_lshlrev_b32 v6, 16, v19
  v_and_b32 v7, 0xffff0000, v19
  v_add_f32_e64 v5, v5, abs(v6)
  v_add_f32_e64 v5, v5, abs(v7)
  v_lshlrev_b32 v6, 16, v20
  v_and_b32 v7, 0xffff0000, v20
  v_add_f32_e64 v5, v5, abs(v6)
  v_add_f32_e64 v5, v5, abs(v7)
  v_lshlrev_b32 v6, 16, v21
  v_and_b32 v7, 0xffff0000, v21
  v_add_f32_e64 v5, v5, abs(v6)
  v_add_f32_e64 v5, v5, abs(v7)
  v_lshlrev_b32 v6, 16, v22
  v_and_b32 v7, 0xffff0000, v22
  v_add_f32_e64 v5, v5, abs(v6)
  v_add_f32_e64 v5, v5, abs(v7)
  v_lshlrev_b32 v6, 16, v23
  v_and_b32 v7, 0xffff0000, v23
  v_add_f32_e64 v5, v5, abs(v6)
  v_add_f32_e64 v5, v5, abs(v7)
  v_mov_b32 v6, v5
  s_nop 1
  v_permlane32_swap_b32 v5, v6
  v_add_f32 v5, v5, v6
  v_mul_f32 v5, v5, v4
  v_mul_f32 v5, 0x3f820000, v5
  v_mov_b32 v12, v5
  v_mov_b32 v5, 0
  v_lshlrev_b32 v6, 16, v24
  v_and_b32 v7, 0xffff0000, v24
  v_add_f32_e64 v5, v5, abs(v6)
  v_add_f32_e64 v5, v5, abs(v7)
  v_lshlrev_b32 v6, 16, v25
  v_and_b32 v7, 0xffff0000, v25
  v_add_f32_e64 v5, v5, abs(v6)
  v_add_f32_e64 v5, v5, abs(v7)
  v_lshlrev_b32 v6, 16, v26
  v_and_b32 v7, 0xffff0000, v26
  v_add_f32_e64 v5, v5, abs(v6)
  v_add_f32_e64 v5, v5, abs(v7)
  v_lshlrev_b32 v6, 16, v27
  v_and_b32 v7, 0xffff0000, v27
  v_add_f32_e64 v5, v5, abs(v6)
  v_add_f32_e64 v5, v5, abs(v7)
  v_lshlrev_b32 v6, 16, v28
  v_and_b32 v7, 0xffff0000, v28
  v_add_f32_e64 v5, v5, abs(v6)
  v_add_f32_e64 v5, v5, abs(v7)
  v_lshlrev_b32 v6, 16, v29
  v_and_b32 v7, 0xffff0000, v29
  v_add_f32_e64 v5, v5, abs(v6)
  v_add_f32_e64 v5, v5, abs(v7)
  v_lshlrev_b32 v6, 16, v30
  v_and_b32 v7, 0xffff0000, v30
  v_add_f32_e64 v5, v5, abs(v6)
  v_add_f32_e64 v5, v5, abs(v7)
  v_lshlrev_b32 v6, 16, v31
  v_and_b32 v7, 0xffff0000, v31
  v_add_f32_e64 v5, v5, abs(v6)
  v_add_f32_e64 v5, v5, abs(v7)
  v_mov_b32 v6, v5
  s_nop 1
  v_permlane32_swap_b32 v5, v6
  v_add_f32 v5, v5, v6
  v_mul_f32 v5, v5, v4
  v_mul_f32 v5, 0x3f820000, v5
  v_mov_b32 v13, v5
  v_cmp_gt_u32 s[34:35], 32, v1
  s_mov_b32 s40, 0
kb2a_main:
  v_lshrrev_b32 v5, 16, v12
  v_or_b32 v5, 0x8000, v5
  v_and_b32 v6, 0xffff0000, v22
  v_or_b32 v5, v5, v6
  v_cndmask_b32 v22, v22, v5, s[34:35]
  v_lshrrev_b32 v5, 16, v13
  v_or_b32 v5, 0x8000, v5
  v_and_b32 v6, 0xffff0000, v30
  v_or_b32 v5, v5, v6
  v_cndmask_b32 v30, v30, v5, s[34:35]
kb2a_main2:
  v_mov_b32 v112, 0
  v_mov_b32 v113, 0
  v_mov_b32 v114, 0
  v_mov_b32 v115, 0
  v_mov_b32 v116, 0
  v_mov_b32 v117, 0
  v_mov_b32 v118, 0
  v_mov_b32 v119, 0
  v_mov_b32 v120, 0
  v_mov_b32 v121, 0
  v_mov_b32 v122, 0
  v_mov_b32 v123, 0
  v_mov_b32 v124, 0
  v_mov_b32 v125, 0
  v_mov_b32 v126, 0
  v_mov_b32 v127, 0
  v_mov_b32 v128, 0
  v_mov_b32 v129, 0
  v_mov_b32 v130, 0
  v_mov_b32 v131, 0
  v_mov_b32 v132, 0
  v_mov_b32 v133, 0
  v_mov_b32 v134, 0
  v_mov_b32 v135, 0
  v_mov_b32 v136, 0
  v_mov_b32 v137, 0
  v_mov_b32 v138, 0
  v_mov_b32 v139, 0
  v_mov_b32 v140, 0
  v_mov_b32 v141, 0
  v_mov_b32 v142, 0
  v_mov_b32 v143, 0
  s_barrier
  s_mov_b32 s41, 0
  s_mul_i32 s30, s41, 32768
  s_lshl_b32 s31, s21, 13
  s_add_u32 s30, s30, s31
  s_add_u32 m0, s31, 0
  s_add_u32 s29, s30, s27
  s_add_u32 s29, s29, 0
  buffer_load_dwordx4 v2, s[8:11], s29 offen lds
  s_add_u32 m0, s31, 1024
  s_add_u32 s29, s30, s27
  s_add_u32 s29, s29, 1024
  buffer_load_dwordx4 v2, s[8:11], s29 offen lds
  s_add_u32 m0, s31, 2048
  s_add_u32 s29, s30, s27
  s_add_u32 s29, s29, 2048
  buffer_load_dwordx4 v2, s[8:11], s29 offen lds
  s_add_u32 m0, s31, 3072
  s_add_u32 s29, s30, s27
  s_add_u32 s29, s29, 3072
  buffer_load_dwordx4 v2, s[8:11], s29 offen lds
  s_add_u32 m0, s31, 4096
  s_add_u32 s29, s30, s27
  s_add_u32 s29, s29, 4096
  buffer_load_dwordx4 v2, s[8:11], s29 offen lds
  s_add_u32 m0, s31, 5120
  s_add_u32 s29, s30, s27
  s_add_u32 s29, s29, 5120
  buffer_load_dwordx4 v2, s[8:11], s29 offen lds
  s_add_u32 m0, s31, 6144
  s_add_u32 s29, s30, s27
  s_add_u32 s29, s29, 6144
  buffer_load_dwordx4 v2, s[8:11], s29 offen lds
  s_add_u32 m0, s31, 7168
  s_add_u32 s29, s30, s27
  s_add_u32 s29, s29, 7168
  buffer_load_dwordx4 v2, s[8:11], s29 offen lds
  s_add_u32 m0, s31, 32768
  s_add_u32 s29, s30, s28
  s_add_u32 s29, s29, 0
  buffer_load_dwordx4 v2, s[8:11], s29 offen lds
  s_add_u32 m0, s31, 33792
  s_add_u32 s29, s30, s28
  s_add_u32 s29, s29, 1024
  buffer_load_dwordx4 v2, s[8:11], s29 offen lds
  s_add_u32 m0, s31, 34816
  s_add_u32 s29, s30, s28
  s_add_u32 s29, s29, 2048
  buffer_load_dwordx4 v2, s[8:11], s29 offen lds
  s_add_u32 m0, s31, 35840
  s_add_u32 s29, s30, s28
  s_add_u32 s29, s29, 3072
  buffer_load_dwordx4 v2, s[8:11], s29 offen lds
  s_add_u32 m0, s31, 36864
  s_add_u32 s29, s30, s28
  s_add_u32 s29, s29, 4096
  buffer_load_dwordx4 v2, s[8:11], s29 offen lds
  s_add_u32 m0, s31, 37888
  s_add_u32 s29, s30, s28
  s_add_u32 s29, s29, 5120
  buffer_load_dwordx4 v2, s[8:11], s29 offen lds
  s_add_u32 m0, s31, 38912
  s_add_u32 s29, s30, s28
  s_add_u32 s29, s29, 6144
  buffer_load_dwordx4 v2, s[8:11], s29 offen lds
  s_add_u32 m0, s31, 39936
  s_add_u32 s29, s30, s28
  s_add_u32 s29, s29, 7168
  buffer_load_dwordx4 v2, s[8:11], s29 offen lds
  v_mov_b32 v3, v2
  v_add_u32 v4, 65536, v2
kb2a_chunk2:
  s_waitcnt vmcnt(0)
  s_barrier
  s_add_u32 s41, s41, 1
  s_cmp_ge_u32 s41, 4
  s_cbranch_scc1 nd_93
  s_mul_i32 s30, s41, 32768
  s_lshl_b32 s31, s21, 13
  s_add_u32 s30, s30, s31
  s_add_u32 m0, s31, 65536
  s_add_u32 s29, s30, s27
  s_add_u32 s29, s29, 0
  buffer_load_dwordx4 v2, s[8:11], s29 offen lds
  s_add_u32 m0, s31, 66560
  s_add_u32 s29, s30, s27
  s_add_u32 s29, s29, 1024
  buffer_load_dwordx4 v2, s[8:11], s29 offen lds
  s_add_u32 m0, s31, 67584
  s_add_u32 s29, s30, s27
  s_add_u32 s29, s29, 2048
  buffer_load_dwordx4 v2, s[8:11], s29 offen lds
  s_add_u32 m0, s31, 68608
  s_add_u32 s29, s30, s27
  s_add_u32 s29, s29, 3072
  buffer_load_dwordx4 v2, s[8:11], s29 offen lds
  s_add_u32 m0, s31, 69632
  s_add_u32 s29, s30, s27
  s_add_u32 s29, s29, 4096
  buffer_load_dwordx4 v2, s[8:11], s29 offen lds
  s_add_u32 m0, s31, 70656
  s_add_u32 s29, s30, s27
  s_add_u32 s29, s29, 5120
  buffer_load_dwordx4 v2, s[8:11], s29 offen lds
  s_add_u32 m0, s31, 71680
  s_add_u32 s29, s30, s27
  s_add_u32 s29, s29, 6144
  buffer_load_dwordx4 v2, s[8:11], s29 offen lds
  s_add_u32 m0, s31, 72704
  s_add_u32 s29, s30, s27
  s_add_u32 s29, s29, 7168
  buffer_load_dwordx4 v2, s[8:11], s29 offen lds
  s_add_u32 m0, s31, 98304
  s_add_u32 s29, s30, s28
  s_add_u32 s29, s29, 0
  buffer_load_dwordx4 v2, s[8:11], s29 offen lds
  s_add_u32 m0, s31, 99328
  s_add_u32 s29, s30, s28
  s_add_u32 s29, s29, 1024
  buffer_load_dwordx4 v2, s[8:11], s29 offen lds
  s_add_u32 m0, s31, 100352
  s_add_u32 s29, s30, s28
  s_add_u32 s29, s29, 2048
  buffer_load_dwordx4 v2, s[8:11], s29 offen lds
  s_add_u32 m0, s31, 101376
  s_add_u32 s29, s30, s28
  s_add_u32 s29, s29, 3072
  buffer_load_dwordx4 v2, s[8:11], s29 offen lds
  s_add_u32 m0, s31, 102400
  s_add_u32 s29, s30, s28
  s_add_u32 s29, s29, 4096
  buffer_load_dwordx4 v2, s[8:11], s29 offen lds
  s_add_u32 m0, s31, 103424
  s_add_u32 s29, s30, s28
  s_add_u32 s29, s29, 5120
  buffer_load_dwordx4 v2, s[8:11], s29 offen lds
  s_add_u32 m0, s31, 104448
  s_add_u32 s29, s30, s28
  s_add_u32 s29, s29, 6144
  buffer_load_dwordx4 v2, s[8:11], s29 offen lds
  s_add_u32 m0, s31, 105472
  s_add_u32 s29, s30, s28
  s_add_u32 s29, s29, 7168
  buffer_load_dwordx4 v2, s[8:11], s29 offen lds
nd_93:
  ds_read_b128 v[32:35], v3 offset:0
  ds_read_b128 v[36:39], v3 offset:1024
  ds_read_b128 v[48:51], v3 offset:32768
  ds_read_b128 v[52:55], v3 offset:33792
  ds_read_b128 v[40:43], v3 offset:2048
  ds_read_b128 v[44:47], v3 offset:3072
  s_waitcnt lgkmcnt(4)
  v_mfma_f32_32x32x16_bf16 v[64:79], v[32:35], v[16:19], 0
  v_mfma_f32_32x32x16_bf16 v[64:79], v[36:39], v[20:23], v[64:79]
  s_nop 11
  v_exp_f32 v64, v64
  v_exp_f32 v65, v65
  v_exp_f32 v66, v66
  v_exp_f32 v67, v67
  v_cvt_pk_bf16_f32 v96, v64, v65
  v_exp_f32 v68, v68
  v_exp_f32 v69, v69
  v_cvt_pk_bf16_f32 v97, v66, v67
  v_mfma_f32_32x32x16_bf16 v[80:95], v[32:35], v[24:27], 0
  v_exp_f32 v70, v70
  v_exp_f32 v71, v71
  v_cvt_pk_bf16_f32 v98, v68, v69
  v_exp_f32 v72, v72
  v_mfma_f32_32x32x16_bf16 v[80:95], v[36:39], v[28:31], v[80:95]
  v_exp_f32 v73, v73
  v_cvt_pk_bf16_f32 v99, v70, v71
  v_exp_f32 v74, v74
  ds_read_b128 v[56:59], v3 offset:34816
  v_exp_f32 v75, v75
  v_cvt_pk_bf16_f32 v100, v72, v73
  v_exp_f32 v76, v76
  ds_read_b128 v[60:63], v3 offset:35840
  v_exp_f32 v77, v77
  v_cvt_pk_bf16_f32 v101, v74, v75
  v_exp_f32 v78, v78
  v_exp_f32 v79, v79
  v_cvt_pk_bf16_f32 v102, v76, v77
  v_cvt_pk_bf16_f32 v103, v78, v79
  s_waitcnt lgkmcnt(4)
  v_mfma_f32_32x32x16_bf16 v[112:127], v[48:51], v[96:99], v[112:127]
  v_exp_f32 v80, v80
  v_exp_f32 v81, v81
  v_exp_f32 v82, v82
  v_mfma_f32_32x32x16_bf16 v[112:127], v[52:55], v[100:103], v[112:127]
  v_exp_f32 v83, v83
  v_cvt_pk_bf16_f32 v104, v80, v81
  v_exp_f32 v84, v84
  v_exp_f32 v85, v85
  v_cvt_pk_bf16_f32 v105, v82, v83
  s_waitcnt lgkmcnt(2)
  v_mfma_f32_32x32x16_bf16 v[64:79], v[40:43], v[16:19], 0
  v_exp_f32 v86, v86
  v_exp_f32 v87, v87
  v_cvt_pk_bf16_f32 v106, v84, v85
  v_exp_f32 v88, v88
  v_mfma_f32_32x32x16_bf16 v[64:79], v[44:47], v[20:23], v[64:79]
  v_exp_f32 v89, v89
  v_cvt_pk_bf16_f32 v107, v86, v87
  v_exp_f32 v90, v90
  ds_read_b128 v[32:35], v3 offset:4096
  v_exp_f32 v91, v91
  v_cvt_pk_bf16_f32 v108, v88, v89
  v_exp_f32 v92, v92
  ds_read_b128 v[36:39], v3 offset:5120
  v_exp_f32 v93, v93
  v_cvt_pk_bf16_f32 v109, v90, v91
  v_exp_f32 v94, v94
  v_exp_f32 v95, v95
  v_cvt_pk_bf16_f32 v110, v92, v93
  v_cvt_pk_bf16_f32 v111, v94, v95
  v_mfma_f32_32x32x16_bf16 v[128:143], v[48:51], v[104:107], v[128:143]
  v_exp_f32 v64, v64
  v_exp_f32 v65, v65
  v_exp_f32 v66, v66
  v_mfma_f32_32x32x16_bf16 v[128:143], v[52:55], v[108:111], v[128:143]
  v_exp_f32 v67, v67
  v_cvt_pk_bf16_f32 v96, v64, v65
  v_exp_f32 v68, v68
  v_exp_f32 v69, v69
  v_cvt_pk_bf16_f32 v97, v66, v67
  v_mfma_f32_32x32x16_bf16 v[80:95], v[40:43], v[24:27], 0
  v_exp_f32 v70, v70
  v_exp_f32 v71, v71
  v_cvt_pk_bf16_f32 v98, v68, v69
  v_exp_f32 v72, v72
  v_mfma_f32_32x32x16_bf16 v[80:95], v[44:47], v[28:31], v[80:95]
  v_exp_f32 v73, v73
  v_cvt_pk_bf16_f32 v99, v70, v71
  v_exp_f32 v74, v74
  ds_read_b128 v[48:51], v3 offset:36864
  v_exp_f32 v75, v75
  v_cvt_pk_bf16_f32 v100, v72, v73
  v_exp_f32 v76, v76
  ds_read_b128 v[52:55], v3 offset:37888
  v_exp_f32 v77, v77
  v_cvt_pk_bf16_f32 v101, v74, v75
  v_exp_f32 v78, v78
  v_exp_f32 v79, v79
  v_cvt_pk_bf16_f32 v102, v76, v77
  v_cvt_pk_bf16_f32 v103, v78, v79
  s_waitcnt lgkmcnt(4)
  v_mfma_f32_32x32x16_bf16 v[112:127], v[56:59], v[96:99], v[112:127]
  v_exp_f32 v80, v80
  v_exp_f32 v81, v81
  v_exp_f32 v82, v82
  v_mfma_f32_32x32x16_bf16 v[112:127], v[60:63], v[100:103], v[112:127]
  v_exp_f32 v83, v83
  v_cvt_pk_bf16_f32 v104, v80, v81
  v_exp_f32 v84, v84
  v_exp_f32 v85, v85
  v_cvt_pk_bf16_f32 v105, v82, v83
  s_waitcnt lgkmcnt(2)
  v_mfma_f32_32x32x16_bf16 v[64:79], v[32:35], v[16:19], 0
  v_exp_f32 v86, v86
  v_exp_f32 v87, v87
  v_cvt_pk_bf16_f32 v106, v84, v85
  v_exp_f32 v88, v88
  v_mfma_f32_32x32x16_bf16 v[64:79], v[36:39], v[20:23], v[64:79]
  v_exp_f32 v89, v89
  v_cvt_pk_bf16_f32 v107, v86, v87
  v_exp_f32 v90, v90
  ds_read_b128 v[40:43], v3 offset:6144
  v_exp_f32 v91, v91
  v_cvt_pk_bf16_f32 v108, v88, v89
  v_exp_f32 v92, v92
  ds_read_b128 v[44:47], v3 offset:7168
  v_exp_f32 v93, v93
  v_cvt_pk_bf16_f32 v109, v90, v91
  v_exp_f32 v94, v94
  v_exp_f32 v95, v95
  v_cvt_pk_bf16_f32 v110, v92, v93
  v_cvt_pk_bf16_f32 v111, v94, v95
  v_mfma_f32_32x32x16_bf16 v[128:143], v[56:59], v[104:107], v[128:143]
  v_exp_f32 v64, v64
  v_exp_f32 v65, v65
  v_exp_f32 v66, v66
  v_mfma_f32_32x32x16_bf16 v[128:143], v[60:63], v[108:111], v[128:143]
  v_exp_f32 v67, v67
  v_cvt_pk_bf16_f32 v96, v64, v65
  v_exp_f32 v68, v68
  v_exp_f32 v69, v69
  v_cvt_pk_bf16_f32 v97, v66, v67
  v_mfma_f32_32x32x16_bf16 v[80:95], v[32:35], v[24:27], 0
  v_exp_f32 v70, v70
  v_exp_f32 v71, v71
  v_cvt_pk_bf16_f32 v98, v68, v69
  v_exp_f32 v72, v72
  v_mfma_f32_32x32x16_bf16 v[80:95], v[36:39], v[28:31], v[80:95]
  v_exp_f32 v73, v73
  v_cvt_pk_bf16_f32 v99, v70, v71
  v_exp_f32 v74, v74
  ds_read_b128 v[56:59], v3 offset:38912
  v_exp_f32 v75, v75
  v_cvt_pk_bf16_f32 v100, v72, v73
  v_exp_f32 v76, v76
  ds_read_b128 v[60:63], v3 offset:39936
  v_exp_f32 v77, v77
  v_cvt_pk_bf16_f32 v101, v74, v75
  v_exp_f32 v78, v78
  v_exp_f32 v79, v79
  v_cvt_pk_bf16_f32 v102, v76, v77
  v_cvt_pk_bf16_f32 v103, v78, v79
  s_waitcnt lgkmcnt(4)
  v_mfma_f32_32x32x16_bf16 v[112:127], v[48:51], v[96:99], v[112:127]
  v_exp_f32 v80, v80
  v_exp_f32 v81, v81
  v_exp_f32 v82, v82
  v_mfma_f32_32x32x16_bf16 v[112:127], v[52:55], v[100:103], v[112:127]
  v_exp_f32 v83, v83
  v_cvt_pk_bf16_f32 v104, v80, v81
  v_exp_f32 v84, v84
  v_exp_f32 v85, v85
  v_cvt_pk_bf16_f32 v105, v82, v83
  s_waitcnt lgkmcnt(2)
  v_mfma_f32_32x32x16_bf16 v[64:79], v[40:43], v[16:19], 0
  v_exp_f32 v86, v86
  v_exp_f32 v87, v87
  v_cvt_pk_bf16_f32 v106, v84, v85
  v_exp_f32 v88, v88
  v_mfma_f32_32x32x16_bf16 v[64:79], v[44:47], v[20:23], v[64:79]
  v_exp_f32 v89, v89
  v_cvt_pk_bf16_f32 v107, v86, v87
  v_exp_f32 v90, v90
  ds_read_b128 v[32:35], v3 offset:8192
  v_exp_f32 v91, v91
  v_cvt_pk_bf16_f32 v108, v88, v89
  v_exp_f32 v92, v92
  ds_read_b128 v[36:39], v3 offset:9216
  v_exp_f32 v93, v93
  v_cvt_pk_bf16_f32 v109, v90, v91
  v_exp_f32 v94, v94
  v_exp_f32 v95, v95
  v_cvt_pk_bf16_f32 v110, v92, v93
  v_cvt_pk_bf16_f32 v111, v94, v95
  v_mfma_f32_32x32x16_bf16 v[128:143], v[48:51], v[104:107], v[128:143]
  v_exp_f32 v64, v64
  v_exp_f32 v65, v65
  v_exp_f32 v66, v66
  v_mfma_f32_32x32x16_bf16 v[128:143], v[52:55], v[108:111], v[128:143]
  v_exp_f32 v67, v67
  v_cvt_pk_bf16_f32 v96, v64, v65
  v_exp_f32 v68, v68
  v_exp_f32 v69, v69
  v_cvt_pk_bf16_f32 v97, v66, v67
  v_mfma_f32_32x32x16_bf16 v[80:95], v[40:43], v[24:27], 0
  v_exp_f32 v70, v70
  v_exp_f32 v71, v71
  v_cvt_pk_bf16_f32 v98, v68, v69
  v_exp_f32 v72, v72
  v_mfma_f32_32x32x16_bf16 v[80:95], v[44:47], v[28:31], v[80:95]
  v_exp_f32 v73, v73
  v_cvt_pk_bf16_f32 v99, v70, v71
  v_exp_f32 v74, v74
  ds_read_b128 v[48:51], v3 offset:40960
  v_exp_f32 v75, v75
  v_cvt_pk_bf16_f32 v100, v72, v73
  v_exp_f32 v76, v76
  ds_read_b128 v[52:55], v3 offset:41984
  v_exp_f32 v77, v77
  v_cvt_pk_bf16_f32 v101, v74, v75
  v_exp_f32 v78, v78
  v_exp_f32 v79, v79
  v_cvt_pk_bf16_f32 v102, v76, v77
  v_cvt_pk_bf16_f32 v103, v78, v79
  s_waitcnt lgkmcnt(4)
  v_mfma_f32_32x32x16_bf16 v[112:127], v[56:59], v[96:99], v[112:127]
  v_exp_f32 v80, v80
  v_exp_f32 v81, v81
  v_exp_f32 v82, v82
  v_mfma_f32_32x32x16_bf16 v[112:127], v[60:63], v[100:103], v[112:127]
  v_exp_f32 v83, v83
  v_cvt_pk_bf16_f32 v104, v80, v81
  v_exp_f32 v84, v84
  v_exp_f32 v85, v85
  v_cvt_pk_bf16_f32 v105, v82, v83
  s_waitcnt lgkmcnt(2)
  v_mfma_f32_32x32x16_bf16 v[64:79], v[32:35], v[16:19], 0
  v_exp_f32 v86, v86
  v_exp_f32 v87, v87
  v_cvt_pk_bf16_f32 v106, v84, v85
  v_exp_f32 v88, v88
  v_mfma_f32_32x32x16_bf16 v[64:79], v[36:39], v[20:23], v[64:79]
  v_exp_f32 v89, v89
  v_cvt_pk_bf16_f32 v107, v86, v87
  v_exp_f32 v90, v90
  ds_read_b128 v[40:43], v3 offset:10240
  v_exp_f32 v91, v91
  v_cvt_pk_bf16_f32 v108, v88, v89
  v_exp_f32 v92, v92
  ds_read_b128 v[44:47], v3 offset:11264
  v_exp_f32 v93, v93
  v_cvt_pk_bf16_f32 v109, v90, v91
  v_exp_f32 v94, v94
  v_exp_f32 v95, v95
  v_cvt_pk_bf16_f32 v110, v92, v93
  v_cvt_pk_bf16_f32 v111, v94, v95
  v_mfma_f32_32x32x16_bf16 v[128:143], v[56:59], v[104:107], v[128:143]
  v_exp_f32 v64, v64
  v_exp_f32 v65, v65
  v_exp_f32 v66, v66
  v_mfma_f32_32x32x16_bf16 v[128:143], v[60:63], v[108:111], v[128:143]
  v_exp_f32 v67, v67
  v_cvt_pk_bf16_f32 v96, v64, v65
  v_exp_f32 v68, v68
  v_exp_f32 v69, v69
  v_cvt_pk_bf16_f32 v97, v66, v67
  v_mfma_f32_32x32x16_bf16 v[80:95], v[32:35], v[24:27], 0
  v_exp_f32 v70, v70
  v_exp_f32 v71, v71
  v_cvt_pk_bf16_f32 v98, v68, v69
  v_exp_f32 v72, v72
  v_mfma_f32_32x32x16_bf16 v[80:95], v[36:39], v[28:31], v[80:95]
  v_exp_f32 v73, v73
  v_cvt_pk_bf16_f32 v99, v70, v71
  v_exp_f32 v74, v74
  ds_read_b128 v[56:59], v3 offset:43008
  v_exp_f32 v75, v75
  v_cvt_pk_bf16_f32 v100, v72, v73
  v_exp_f32 v76, v76
  ds_read_b128 v[60:63], v3 offset:44032
  v_exp_f32 v77, v77
  v_cvt_pk_bf16_f32 v101, v74, v75
  v_exp_f32 v78, v78
  v_exp_f32 v79, v79
  v_cvt_pk_bf16_f32 v102, v76, v77
  v_cvt_pk_bf16_f32 v103, v78, v79
  s_waitcnt lgkmcnt(4)
  v_mfma_f32_32x32x16_bf16 v[112:127], v[48:51], v[96:99], v[112:127]
  v_exp_f32 v80, v80
  v_exp_f32 v81, v81
  v_exp_f32 v82, v82
  v_mfma_f32_32x32x16_bf16 v[112:127], v[52:55], v[100:103], v[112:127]
  v_exp_f32 v83, v83
  v_cvt_pk_bf16_f32 v104, v80, v81
  v_exp_f32 v84, v84
  v_exp_f32 v85, v85
  v_cvt_pk_bf16_f32 v105, v82, v83
  s_waitcnt lgkmcnt(2)
  v_mfma_f32_32x32x16_bf16 v[64:79], v[40:43], v[16:19], 0
  v_exp_f32 v86, v86
  v_exp_f32 v87, v87
  v_cvt_pk_bf16_f32 v106, v84, v85
  v_exp_f32 v88, v88
  v_mfma_f32_32x32x16_bf16 v[64:79], v[44:47], v[20:23], v[64:79]
  v_exp_f32 v89, v89
  v_cvt_pk_bf16_f32 v107, v86, v87
  v_exp_f32 v90, v90
  ds_read_b128 v[32:35], v3 offset:12288
  v_exp_f32 v91, v91
  v_cvt_pk_bf16_f32 v108, v88, v89
  v_exp_f32 v92, v92
  ds_read_b128 v[36:39], v3 offset:13312
  v_exp_f32 v93, v93
  v_cvt_pk_bf16_f32 v109, v90, v91
  v_exp_f32 v94, v94
  v_exp_f32 v95, v95
  v_cvt_pk_bf16_f32 v110, v92, v93
  v_cvt_pk_bf16_f32 v111, v94, v95
  v_mfma_f32_32x32x16_bf16 v[128:143], v[48:51], v[104:107], v[128:143]
  v_exp_f32 v64, v64
  v_exp_f32 v65, v65
  v_exp_f32 v66, v66
  v_mfma_f32_32x32x16_bf16 v[128:143], v[52:55], v[108:111], v[128:143]
  v_exp_f32 v67, v67
  v_cvt_pk_bf16_f32 v96, v64, v65
  v_exp_f32 v68, v68
  v_exp_f32 v69, v69
  v_cvt_pk_bf16_f32 v97, v66, v67
  v_mfma_f32_32x32x16_bf16 v[80:95], v[40:43], v[24:27], 0
  v_exp_f32 v70, v70
  v_exp_f32 v71, v71
  v_cvt_pk_bf16_f32 v98, v68, v69
  v_exp_f32 v72, v72
  v_mfma_f32_32x32x16_bf16 v[80:95], v[44:47], v[28:31], v[80:95]
  v_exp_f32 v73, v73
  v_cvt_pk_bf16_f32 v99, v70, v71
  v_exp_f32 v74, v74
  ds_read_b128 v[48:51], v3 offset:45056
  v_exp_f32 v75, v75
  v_cvt_pk_bf16_f32 v100, v72, v73
  v_exp_f32 v76, v76
  ds_read_b128 v[52:55], v3 offset:46080
  v_exp_f32 v77, v77
  v_cvt_pk_bf16_f32 v101, v74, v75
  v_exp_f32 v78, v78
  v_exp_f32 v79, v79
  v_cvt_pk_bf16_f32 v102, v76, v77
  v_cvt_pk_bf16_f32 v103, v78, v79
  s_waitcnt lgkmcnt(4)
  v_mfma_f32_32x32x16_bf16 v[112:127], v[56:59], v[96:99], v[112:127]
  v_exp_f32 v80, v80
  v_exp_f32 v81, v81
  v_exp_f32 v82, v82
  v_mfma_f32_32x32x16_bf16 v[112:127], v[60:63], v[100:103], v[112:127]
  v_exp_f32 v83, v83
  v_cvt_pk_bf16_f32 v104, v80, v81
  v_exp_f32 v84, v84
  v_exp_f32 v85, v85
  v_cvt_pk_bf16_f32 v105, v82, v83
  s_waitcnt lgkmcnt(2)
  v_mfma_f32_32x32x16_bf16 v[64:79], v[32:35], v[16:19], 0
  v_exp_f32 v86, v86
  v_exp_f32 v87, v87
  v_cvt_pk_bf16_f32 v106, v84, v85
  v_exp_f32 v88, v88
  v_mfma_f32_32x32x16_bf16 v[64:79], v[36:39], v[20:23], v[64:79]
  v_exp_f32 v89, v89
  v_cvt_pk_bf16_f32 v107, v86, v87
  v_exp_f32 v90, v90
  ds_read_b128 v[40:43], v3 offset:14336
  v_exp_f32 v91, v91
  v_cvt_pk_bf16_f32 v108, v88, v89
  v_exp_f32 v92, v92
  ds_read_b128 v[44:47], v3 offset:15360
  v_exp_f32 v93, v93
  v_cvt_pk_bf16_f32 v109, v90, v91
  v_exp_f32 v94, v94
  v_exp_f32 v95, v95
  v_cvt_pk_bf16_f32 v110, v92, v93
  v_cvt_pk_bf16_f32 v111, v94, v95
  v_mfma_f32_32x32x16_bf16 v[128:143], v[56:59], v[104:107], v[128:143]
  v_exp_f32 v64, v64
  v_exp_f32 v65, v65
  v_exp_f32 v66, v66
  v_mfma_f32_32x32x16_bf16 v[128:143], v[60:63], v[108:111], v[128:143]
  v_exp_f32 v67, v67
  v_cvt_pk_bf16_f32 v96, v64, v65
  v_exp_f32 v68, v68
  v_exp_f32 v69, v69
  v_cvt_pk_bf16_f32 v97, v66, v67
  v_mfma_f32_32x32x16_bf16 v[80:95], v[32:35], v[24:27], 0
  v_exp_f32 v70, v70
  v_exp_f32 v71, v71
  v_cvt_pk_bf16_f32 v98, v68, v69
  v_exp_f32 v72, v72
  v_mfma_f32_32x32x16_bf16 v[80:95], v[36:39], v[28:31], v[80:95]
  v_exp_f32 v73, v73
  v_cvt_pk_bf16_f32 v99, v70, v71
  v_exp_f32 v74, v74
  ds_read_b128 v[56:59], v3 offset:47104
  v_exp_f32 v75, v75
  v_cvt_pk_bf16_f32 v100, v72, v73
  v_exp_f32 v76, v76
  ds_read_b128 v[60:63], v3 offset:48128
  v_exp_f32 v77, v77
  v_cvt_pk_bf16_f32 v101, v74, v75
  v_exp_f32 v78, v78
  v_exp_f32 v79, v79
  v_cvt_pk_bf16_f32 v102, v76, v77
  v_cvt_pk_bf16_f32 v103, v78, v79
  s_waitcnt lgkmcnt(4)
  v_mfma_f32_32x32x16_bf16 v[112:127], v[48:51], v[96:99], v[112:127]
  v_exp_f32 v80, v80
  v_exp_f32 v81, v81
  v_exp_f32 v82, v82
  v_mfma_f32_32x32x16_bf16 v[112:127], v[52:55], v[100:103], v[112:127]
  v_exp_f32 v83, v83
  v_cvt_pk_bf16_f32 v104, v80, v81
  v_exp_f32 v84, v84
  v_exp_f32 v85, v85
  v_cvt_pk_bf16_f32 v105, v82, v83
  s_waitcnt lgkmcnt(2)
  v_mfma_f32_32x32x16_bf16 v[64:79], v[40:43], v[16:19], 0
  v_exp_f32 v86, v86
  v_exp_f32 v87, v87
  v_cvt_pk_bf16_f32 v106, v84, v85
  v_exp_f32 v88, v88
  v_mfma_f32_32x32x16_bf16 v[64:79], v[44:47], v[20:23], v[64:79]
  v_exp_f32 v89, v89
  v_cvt_pk_bf16_f32 v107, v86, v87
  v_exp_f32 v90, v90
  ds_read_b128 v[32:35], v3 offset:16384
  v_exp_f32 v91, v91
  v_cvt_pk_bf16_f32 v108, v88, v89
  v_exp_f32 v92, v92
  ds_read_b128 v[36:39], v3 offset:17408
  v_exp_f32 v93, v93
  v_cvt_pk_bf16_f32 v109, v90, v91
  v_exp_f32 v94, v94
  v_exp_f32 v95, v95
  v_cvt_pk_bf16_f32 v110, v92, v93
  v_cvt_pk_bf16_f32 v111, v94, v95
  v_mfma_f32_32x32x16_bf16 v[128:143], v[48:51], v[104:107], v[128:143]
  v_exp_f32 v64, v64
  v_exp_f32 v65, v65
  v_exp_f32 v66, v66
  v_mfma_f32_32x32x16_bf16 v[128:143], v[52:55], v[108:111], v[128:143]
  v_exp_f32 v67, v67
  v_cvt_pk_bf16_f32 v96, v64, v65
  v_exp_f32 v68, v68
  v_exp_f32 v69, v69
  v_cvt_pk_bf16_f32 v97, v66, v67
  v_mfma_f32_32x32x16_bf16 v[80:95], v[40:43], v[24:27], 0
  v_exp_f32 v70, v70
  v_exp_f32 v71, v71
  v_cvt_pk_bf16_f32 v98, v68, v69
  v_exp_f32 v72, v72
  v_mfma_f32_32x32x16_bf16 v[80:95], v[44:47], v[28:31], v[80:95]
  v_exp_f32 v73, v73
  v_cvt_pk_bf16_f32 v99, v70, v71
  v_exp_f32 v74, v74
  ds_read_b128 v[48:51], v3 offset:49152
  v_exp_f32 v75, v75
  v_cvt_pk_bf16_f32 v100, v72, v73
  v_exp_f32 v76, v76
  ds_read_b128 v[52:55], v3 offset:50176
  v_exp_f32 v77, v77
  v_cvt_pk_bf16_f32 v101, v74, v75
  v_exp_f32 v78, v78
  v_exp_f32 v79, v79
  v_cvt_pk_bf16_f32 v102, v76, v77
  v_cvt_pk_bf16_f32 v103, v78, v79
  s_waitcnt lgkmcnt(4)
  v_mfma_f32_32x32x16_bf16 v[112:127], v[56:59], v[96:99], v[112:127]
  v_exp_f32 v80, v80
  v_exp_f32 v81, v81
  v_exp_f32 v82, v82
  v_mfma_f32_32x32x16_bf16 v[112:127], v[60:63], v[100:103], v[112:127]
  v_exp_f32 v83, v83
  v_cvt_pk_bf16_f32 v104, v80, v81
  v_exp_f32 v84, v84
  v_exp_f32 v85, v85
  v_cvt_pk_bf16_f32 v105, v82, v83
  s_waitcnt lgkmcnt(2)
  v_mfma_f32_32x32x16_bf16 v[64:79], v[32:35], v[16:19], 0
  v_exp_f32 v86, v86
  v_exp_f32 v87, v87
  v_cvt_pk_bf16_f32 v106, v84, v85
  v_exp_f32 v88, v88
  v_mfma_f32_32x32x16_bf16 v[64:79], v[36:39], v[20:23], v[64:79]
  v_exp_f32 v89, v89
  v_cvt_pk_bf16_f32 v107, v86, v87
  v_exp_f32 v90, v90
  ds_read_b128 v[40:43], v3 offset:18432
  v_exp_f32 v91, v91
  v_cvt_pk_bf16_f32 v108, v88, v89
  v_exp_f32 v92, v92
  ds_read_b128 v[44:47], v3 offset:19456
  v_exp_f32 v93, v93
  v_cvt_pk_bf16_f32 v109, v90, v91
  v_exp_f32 v94, v94
  v_exp_f32 v95, v95
  v_cvt_pk_bf16_f32 v110, v92, v93
  v_cvt_pk_bf16_f32 v111, v94, v95
  v_mfma_f32_32x32x16_bf16 v[128:143], v[56:59], v[104:107], v[128:143]
  v_exp_f32 v64, v64
  v_exp_f32 v65, v65
  v_exp_f32 v66, v66
  v_mfma_f32_32x32x16_bf16 v[128:143], v[60:63], v[108:111], v[128:143]
  v_exp_f32 v67, v67
  v_cvt_pk_bf16_f32 v96, v64, v65
  v_exp_f32 v68, v68
  v_exp_f32 v69, v69
  v_cvt_pk_bf16_f32 v97, v66, v67
  v_mfma_f32_32x32x16_bf16 v[80:95], v[32:35], v[24:27], 0
  v_exp_f32 v70, v70
  v_exp_f32 v71, v71
  v_cvt_pk_bf16_f32 v98, v68, v69
  v_exp_f32 v72, v72
  v_mfma_f32_32x32x16_bf16 v[80:95], v[36:39], v[28:31], v[80:95]
  v_exp_f32 v73, v73
  v_cvt_pk_bf16_f32 v99, v70, v71
  v_exp_f32 v74, v74
  ds_read_b128 v[56:59], v3 offset:51200
  v_exp_f32 v75, v75
  v_cvt_pk_bf16_f32 v100, v72, v73
  v_exp_f32 v76, v76
  ds_read_b128 v[60:63], v3 offset:52224
  v_exp_f32 v77, v77
  v_cvt_pk_bf16_f32 v101, v74, v75
  v_exp_f32 v78, v78
  v_exp_f32 v79, v79
  v_cvt_pk_bf16_f32 v102, v76, v77
  v_cvt_pk_bf16_f32 v103, v78, v79
  s_waitcnt lgkmcnt(4)
  v_mfma_f32_32x32x16_bf16 v[112:127], v[48:51], v[96:99], v[112:127]
  v_exp_f32 v80, v80
  v_exp_f32 v81, v81
  v_exp_f32 v82, v82
  v_mfma_f32_32x32x16_bf16 v[112:127], v[52:55], v[100:103], v[112:127]
  v_exp_f32 v83, v83
  v_cvt_pk_bf16_f32 v104, v80, v81
  v_exp_f32 v84, v84
  v_exp_f32 v85, v85
  v_cvt_pk_bf16_f32 v105, v82, v83
  s_waitcnt lgkmcnt(2)
  v_mfma_f32_32x32x16_bf16 v[64:79], v[40:43], v[16:19], 0
  v_exp_f32 v86, v86
  v_exp_f32 v87, v87
  v_cvt_pk_bf16_f32 v106, v84, v85
  v_exp_f32 v88, v88
  v_mfma_f32_32x32x16_bf16 v[64:79], v[44:47], v[20:23], v[64:79]
  v_exp_f32 v89, v89
  v_cvt_pk_bf16_f32 v107, v86, v87
  v_exp_f32 v90, v90
  ds_read_b128 v[32:35], v3 offset:20480
  v_exp_f32 v91, v91
  v_cvt_pk_bf16_f32 v108, v88, v89
  v_exp_f32 v92, v92
  ds_read_b128 v[36:39], v3 offset:21504
  v_exp_f32 v93, v93
  v_cvt_pk_bf16_f32 v109, v90, v91
  v_exp_f32 v94, v94
  v_exp_f32 v95, v95
  v_cvt_pk_bf16_f32 v110, v92, v93
  v_cvt_pk_bf16_f32 v111, v94, v95
  v_mfma_f32_32x32x16_bf16 v[128:143], v[48:51], v[104:107], v[128:143]
  v_exp_f32 v64, v64
  v_exp_f32 v65, v65
  v_exp_f32 v66, v66
  v_mfma_f32_32x32x16_bf16 v[128:143], v[52:55], v[108:111], v[128:143]
  v_exp_f32 v67, v67
  v_cvt_pk_bf16_f32 v96, v64, v65
  v_exp_f32 v68, v68
  v_exp_f32 v69, v69
  v_cvt_pk_bf16_f32 v97, v66, v67
  v_mfma_f32_32x32x16_bf16 v[80:95], v[40:43], v[24:27], 0
  v_exp_f32 v70, v70
  v_exp_f32 v71, v71
  v_cvt_pk_bf16_f32 v98, v68, v69
  v_exp_f32 v72, v72
  v_mfma_f32_32x32x16_bf16 v[80:95], v[44:47], v[28:31], v[80:95]
  v_exp_f32 v73, v73
  v_cvt_pk_bf16_f32 v99, v70, v71
  v_exp_f32 v74, v74
  ds_read_b128 v[48:51], v3 offset:53248
  v_exp_f32 v75, v75
  v_cvt_pk_bf16_f32 v100, v72, v73
  v_exp_f32 v76, v76
  ds_read_b128 v[52:55], v3 offset:54272
  v_exp_f32 v77, v77
  v_cvt_pk_bf16_f32 v101, v74, v75
  v_exp_f32 v78, v78
  v_exp_f32 v79, v79
  v_cvt_pk_bf16_f32 v102, v76, v77
  v_cvt_pk_bf16_f32 v103, v78, v79
  s_waitcnt lgkmcnt(4)
  v_mfma_f32_32x32x16_bf16 v[112:127], v[56:59], v[96:99], v[112:127]
  v_exp_f32 v80, v80
  v_exp_f32 v81, v81
  v_exp_f32 v82, v82
  v_mfma_f32_32x32x16_bf16 v[112:127], v[60:63], v[100:103], v[112:127]
  v_exp_f32 v83, v83
  v_cvt_pk_bf16_f32 v104, v80, v81
  v_exp_f32 v84, v84
  v_exp_f32 v85, v85
  v_cvt_pk_bf16_f32 v105, v82, v83
  s_waitcnt lgkmcnt(2)
  v_mfma_f32_32x32x16_bf16 v[64:79], v[32:35], v[16:19], 0
  v_exp_f32 v86, v86
  v_exp_f32 v87, v87
  v_cvt_pk_bf16_f32 v106, v84, v85
  v_exp_f32 v88, v88
  v_mfma_f32_32x32x16_bf16 v[64:79], v[36:39], v[20:23], v[64:79]
  v_exp_f32 v89, v89
  v_cvt_pk_bf16_f32 v107, v86, v87
  v_exp_f32 v90, v90
  ds_read_b128 v[40:43], v3 offset:22528
  v_exp_f32 v91, v91
  v_cvt_pk_bf16_f32 v108, v88, v89
  v_exp_f32 v92, v92
  ds_read_b128 v[44:47], v3 offset:23552
  v_exp_f32 v93, v93
  v_cvt_pk_bf16_f32 v109, v90, v91
  v_exp_f32 v94, v94
  v_exp_f32 v95, v95
  v_cvt_pk_bf16_f32 v110, v92, v93
  v_cvt_pk_bf16_f32 v111, v94, v95
  v_mfma_f32_32x32x16_bf16 v[128:143], v[56:59], v[104:107], v[128:143]
  v_exp_f32 v64, v64
  v_exp_f32 v65, v65
  v_exp_f32 v66, v66
  v_mfma_f32_32x32x16_bf16 v[128:143], v[60:63], v[108:111], v[128:143]
  v_exp_f32 v67, v67
  v_cvt_pk_bf16_f32 v96, v64, v65
  v_exp_f32 v68, v68
  v_exp_f32 v69, v69
  v_cvt_pk_bf16_f32 v97, v66, v67
  v_mfma_f32_32x32x16_bf16 v[80:95], v[32:35], v[24:27], 0
  v_exp_f32 v70, v70
  v_exp_f32 v71, v71
  v_cvt_pk_bf16_f32 v98, v68, v69
  v_exp_f32 v72, v72
  v_mfma_f32_32x32x16_bf16 v[80:95], v[36:39], v[28:31], v[80:95]
  v_exp_f32 v73, v73
  v_cvt_pk_bf16_f32 v99, v70, v71
  v_exp_f32 v74, v74
  ds_read_b128 v[56:59], v3 offset:55296
  v_exp_f32 v75, v75
  v_cvt_pk_bf16_f32 v100, v72, v73
  v_exp_f32 v76, v76
  ds_read_b128 v[60:63], v3 offset:56320
  v_exp_f32 v77, v77
  v_cvt_pk_bf16_f32 v101, v74, v75
  v_exp_f32 v78, v78
  v_exp_f32 v79, v79
  v_cvt_pk_bf16_f32 v102, v76, v77
  v_cvt_pk_bf16_f32 v103, v78, v79
  s_waitcnt lgkmcnt(4)
  v_mfma_f32_32x32x16_bf16 v[112:127], v[48:51], v[96:99], v[112:127]
  v_exp_f32 v80, v80
  v_exp_f32 v81, v81
  v_exp_f32 v82, v82
  v_mfma_f32_32x32x16_bf16 v[112:127], v[52:55], v[100:103], v[112:127]
  v_exp_f32 v83, v83
  v_cvt_pk_bf16_f32 v104, v80, v81
  v_exp_f32 v84, v84
  v_exp_f32 v85, v85
  v_cvt_pk_bf16_f32 v105, v82, v83
  s_waitcnt lgkmcnt(2)
  v_mfma_f32_32x32x16_bf16 v[64:79], v[40:43], v[16:19], 0
  v_exp_f32 v86, v86
  v_exp_f32 v87, v87
  v_cvt_pk_bf16_f32 v106, v84, v85
  v_exp_f32 v88, v88
  v_mfma_f32_32x32x16_bf16 v[64:79], v[44:47], v[20:23], v[64:79]
  v_exp_f32 v89, v89
  v_cvt_pk_bf16_f32 v107, v86, v87
  v_exp_f32 v90, v90
  ds_read_b128 v[32:35], v3 offset:24576
  v_exp_f32 v91, v91
  v_cvt_pk_bf16_f32 v108, v88, v89
  v_exp_f32 v92, v92
  ds_read_b128 v[36:39], v3 offset:25600
  v_exp_f32 v93, v93
  v_cvt_pk_bf16_f32 v109, v90, v91
  v_exp_f32 v94, v94
  v_exp_f32 v95, v95
  v_cvt_pk_bf16_f32 v110, v92, v93
  v_cvt_pk_bf16_f32 v111, v94, v95
  v_mfma_f32_32x32x16_bf16 v[128:143], v[48:51], v[104:107], v[128:143]
  v_exp_f32 v64, v64
  v_exp_f32 v65, v65
  v_exp_f32 v66, v66
  v_mfma_f32_32x32x16_bf16 v[128:143], v[52:55], v[108:111], v[128:143]
  v_exp_f32 v67, v67
  v_cvt_pk_bf16_f32 v96, v64, v65
  v_exp_f32 v68, v68
  v_exp_f32 v69, v69
  v_cvt_pk_bf16_f32 v97, v66, v67
  v_mfma_f32_32x32x16_bf16 v[80:95], v[40:43], v[24:27], 0
  v_exp_f32 v70, v70
  v_exp_f32 v71, v71
  v_cvt_pk_bf16_f32 v98, v68, v69
  v_exp_f32 v72, v72
  v_mfma_f32_32x32x16_bf16 v[80:95], v[44:47], v[28:31], v[80:95]
  v_exp_f32 v73, v73
  v_cvt_pk_bf16_f32 v99, v70, v71
  v_exp_f32 v74, v74
  ds_read_b128 v[48:51], v3 offset:57344
  v_exp_f32 v75, v75
  v_cvt_pk_bf16_f32 v100, v72, v73
  v_exp_f32 v76, v76
  ds_read_b128 v[52:55], v3 offset:58368
  v_exp_f32 v77, v77
  v_cvt_pk_bf16_f32 v101, v74, v75
  v_exp_f32 v78, v78
  v_exp_f32 v79, v79
  v_cvt_pk_bf16_f32 v102, v76, v77
  v_cvt_pk_bf16_f32 v103, v78, v79
  s_waitcnt lgkmcnt(4)
  v_mfma_f32_32x32x16_bf16 v[112:127], v[56:59], v[96:99], v[112:127]
  v_exp_f32 v80, v80
  v_exp_f32 v81, v81
  v_exp_f32 v82, v82
  v_mfma_f32_32x32x16_bf16 v[112:127], v[60:63], v[100:103], v[112:127]
  v_exp_f32 v83, v83
  v_cvt_pk_bf16_f32 v104, v80, v81
  v_exp_f32 v84, v84
  v_exp_f32 v85, v85
  v_cvt_pk_bf16_f32 v105, v82, v83
  s_waitcnt lgkmcnt(2)
  v_mfma_f32_32x32x16_bf16 v[64:79], v[32:35], v[16:19], 0
  v_exp_f32 v86, v86
  v_exp_f32 v87, v87
  v_cvt_pk_bf16_f32 v106, v84, v85
  v_exp_f32 v88, v88
  v_mfma_f32_32x32x16_bf16 v[64:79], v[36:39], v[20:23], v[64:79]
  v_exp_f32 v89, v89
  v_cvt_pk_bf16_f32 v107, v86, v87
  v_exp_f32 v90, v90
  ds_read_b128 v[40:43], v3 offset:26624
  v_exp_f32 v91, v91
  v_cvt_pk_bf16_f32 v108, v88, v89
  v_exp_f32 v92, v92
  ds_read_b128 v[44:47], v3 offset:27648
  v_exp_f32 v93, v93
  v_cvt_pk_bf16_f32 v109, v90, v91
  v_exp_f32 v94, v94
  v_exp_f32 v95, v95
  v_cvt_pk_bf16_f32 v110, v92, v93
  v_cvt_pk_bf16_f32 v111, v94, v95
  v_mfma_f32_32x32x16_bf16 v[128:143], v[56:59], v[104:107], v[128:143]
  v_exp_f32 v64, v64
  v_exp_f32 v65, v65
  v_exp_f32 v66, v66
  v_mfma_f32_32x32x16_bf16 v[128:143], v[60:63], v[108:111], v[128:143]
  v_exp_f32 v67, v67
  v_cvt_pk_bf16_f32 v96, v64, v65
  v_exp_f32 v68, v68
  v_exp_f32 v69, v69
  v_cvt_pk_bf16_f32 v97, v66, v67
  v_mfma_f32_32x32x16_bf16 v[80:95], v[32:35], v[24:27], 0
  v_exp_f32 v70, v70
  v_exp_f32 v71, v71
  v_cvt_pk_bf16_f32 v98, v68, v69
  v_exp_f32 v72, v72
  v_mfma_f32_32x32x16_bf16 v[80:95], v[36:39], v[28:31], v[80:95]
  v_exp_f32 v73, v73
  v_cvt_pk_bf16_f32 v99, v70, v71
  v_exp_f32 v74, v74
  ds_read_b128 v[56:59], v3 offset:59392
  v_exp_f32 v75, v75
  v_cvt_pk_bf16_f32 v100, v72, v73
  v_exp_f32 v76, v76
  ds_read_b128 v[60:63], v3 offset:60416
  v_exp_f32 v77, v77
  v_cvt_pk_bf16_f32 v101, v74, v75
  v_exp_f32 v78, v78
  v_exp_f32 v79, v79
  v_cvt_pk_bf16_f32 v102, v76, v77
  v_cvt_pk_bf16_f32 v103, v78, v79
  s_waitcnt lgkmcnt(4)
  v_mfma_f32_32x32x16_bf16 v[112:127], v[48:51], v[96:99], v[112:127]
  v_exp_f32 v80, v80
  v_exp_f32 v81, v81
  v_exp_f32 v82, v82
  v_mfma_f32_32x32x16_bf16 v[112:127], v[52:55], v[100:103], v[112:127]
  v_exp_f32 v83, v83
  v_cvt_pk_bf16_f32 v104, v80, v81
  v_exp_f32 v84, v84
  v_exp_f32 v85, v85
  v_cvt_pk_bf16_f32 v105, v82, v83
  s_waitcnt lgkmcnt(2)
  v_mfma_f32_32x32x16_bf16 v[64:79], v[40:43], v[16:19], 0
  v_exp_f32 v86, v86
  v_exp_f32 v87, v87
  v_cvt_pk_bf16_f32 v106, v84, v85
  v_exp_f32 v88, v88
  v_mfma_f32_32x32x16_bf16 v[64:79], v[44:47], v[20:23], v[64:79]
  v_exp_f32 v89, v89
  v_cvt_pk_bf16_f32 v107, v86, v87
  v_exp_f32 v90, v90
  ds_read_b128 v[32:35], v3 offset:28672
  v_exp_f32 v91, v91
  v_cvt_pk_bf16_f32 v108, v88, v89
  v_exp_f32 v92, v92
  ds_read_b128 v[36:39], v3 offset:29696
  v_exp_f32 v93, v93
  v_cvt_pk_bf16_f32 v109, v90, v91
  v_exp_f32 v94, v94
  v_exp_f32 v95, v95
  v_cvt_pk_bf16_f32 v110, v92, v93
  v_cvt_pk_bf16_f32 v111, v94, v95
  v_mfma_f32_32x32x16_bf16 v[128:143], v[48:51], v[104:107], v[128:143]
  v_exp_f32 v64, v64
  v_exp_f32 v65, v65
  v_exp_f32 v66, v66
  v_mfma_f32_32x32x16_bf16 v[128:143], v[52:55], v[108:111], v[128:143]
  v_exp_f32 v67, v67
  v_cvt_pk_bf16_f32 v96, v64, v65
  v_exp_f32 v68, v68
  v_exp_f32 v69, v69
  v_cvt_pk_bf16_f32 v97, v66, v67
  v_mfma_f32_32x32x16_bf16 v[80:95], v[40:43], v[24:27], 0
  v_exp_f32 v70, v70
  v_exp_f32 v71, v71
  v_cvt_pk_bf16_f32 v98, v68, v69
  v_exp_f32 v72, v72
  v_mfma_f32_32x32x16_bf16 v[80:95], v[44:47], v[28:31], v[80:95]
  v_exp_f32 v73, v73
  v_cvt_pk_bf16_f32 v99, v70, v71
  v_exp_f32 v74, v74
  ds_read_b128 v[48:51], v3 offset:61440
  v_exp_f32 v75, v75
  v_cvt_pk_bf16_f32 v100, v72, v73
  v_exp_f32 v76, v76
  ds_read_b128 v[52:55], v3 offset:62464
  v_exp_f32 v77, v77
  v_cvt_pk_bf16_f32 v101, v74, v75
  v_exp_f32 v78, v78
  v_exp_f32 v79, v79
  v_cvt_pk_bf16_f32 v102, v76, v77
  v_cvt_pk_bf16_f32 v103, v78, v79
  s_waitcnt lgkmcnt(4)
  v_mfma_f32_32x32x16_bf16 v[112:127], v[56:59], v[96:99], v[112:127]
  v_exp_f32 v80, v80
  v_exp_f32 v81, v81
  v_exp_f32 v82, v82
  v_mfma_f32_32x32x16_bf16 v[112:127], v[60:63], v[100:103], v[112:127]
  v_exp_f32 v83, v83
  v_cvt_pk_bf16_f32 v104, v80, v81
  v_exp_f32 v84, v84
  v_exp_f32 v85, v85
  v_cvt_pk_bf16_f32 v105, v82, v83
  s_waitcnt lgkmcnt(2)
  v_mfma_f32_32x32x16_bf16 v[64:79], v[32:35], v[16:19], 0
  v_exp_f32 v86, v86
  v_exp_f32 v87, v87
  v_cvt_pk_bf16_f32 v106, v84, v85
  v_exp_f32 v88, v88
  v_mfma_f32_32x32x16_bf16 v[64:79], v[36:39], v[20:23], v[64:79]
  v_exp_f32 v89, v89
  v_cvt_pk_bf16_f32 v107, v86, v87
  v_exp_f32 v90, v90
  ds_read_b128 v[40:43], v3 offset:30720
  v_exp_f32 v91, v91
  v_cvt_pk_bf16_f32 v108, v88, v89
  v_exp_f32 v92, v92
  ds_read_b128 v[44:47], v3 offset:31744
  v_exp_f32 v93, v93
  v_cvt_pk_bf16_f32 v109, v90, v91
  v_exp_f32 v94, v94
  v_exp_f32 v95, v95
  v_cvt_pk_bf16_f32 v110, v92, v93
  v_cvt_pk_bf16_f32 v111, v94, v95
  v_mfma_f32_32x32x16_bf16 v[128:143], v[56:59], v[104:107], v[128:143]
  v_exp_f32 v64, v64
  v_exp_f32 v65, v65
  v_exp_f32 v66, v66
  v_mfma_f32_32x32x16_bf16 v[128:143], v[60:63], v[108:111], v[128:143]
  v_exp_f32 v67, v67
  v_cvt_pk_bf16_f32 v96, v64, v65
  v_exp_f32 v68, v68
  v_exp_f32 v69, v69
  v_cvt_pk_bf16_f32 v97, v66, v67
  v_mfma_f32_32x32x16_bf16 v[80:95], v[32:35], v[24:27], 0
  v_exp_f32 v70, v70
  v_exp_f32 v71, v71
  v_cvt_pk_bf16_f32 v98, v68, v69
  v_exp_f32 v72, v72
  v_mfma_f32_32x32x16_bf16 v[80:95], v[36:39], v[28:31], v[80:95]
  v_exp_f32 v73, v73
  v_cvt_pk_bf16_f32 v99, v70, v71
  v_exp_f32 v74, v74
  ds_read_b128 v[56:59], v3 offset:63488
  v_exp_f32 v75, v75
  v_cvt_pk_bf16_f32 v100, v72, v73
  v_exp_f32 v76, v76
  ds_read_b128 v[60:63], v3 offset:64512
  v_exp_f32 v77, v77
  v_cvt_pk_bf16_f32 v101, v74, v75
  v_exp_f32 v78, v78
  v_exp_f32 v79, v79
  v_cvt_pk_bf16_f32 v102, v76, v77
  v_cvt_pk_bf16_f32 v103, v78, v79
  s_waitcnt lgkmcnt(4)
  v_mfma_f32_32x32x16_bf16 v[112:127], v[48:51], v[96:99], v[112:127]
  v_exp_f32 v80, v80
  v_exp_f32 v81, v81
  v_exp_f32 v82, v82
  v_mfma_f32_32x32x16_bf16 v[112:127], v[52:55], v[100:103], v[112:127]
  v_exp_f32 v83, v83
  v_cvt_pk_bf16_f32 v104, v80, v81
  v_exp_f32 v84, v84
  v_exp_f32 v85, v85
  v_cvt_pk_bf16_f32 v105, v82, v83
  s_waitcnt lgkmcnt(2)
  v_mfma_f32_32x32x16_bf16 v[64:79], v[40:43], v[16:19], 0
  v_exp_f32 v86, v86
  v_exp_f32 v87, v87
  v_cvt_pk_bf16_f32 v106, v84, v85
  v_exp_f32 v88, v88
  v_mfma_f32_32x32x16_bf16 v[64:79], v[44:47], v[20:23], v[64:79]
  v_exp_f32 v89, v89
  v_cvt_pk_bf16_f32 v107, v86, v87
  v_exp_f32 v90, v90
  v_exp_f32 v91, v91
  v_cvt_pk_bf16_f32 v108, v88, v89
  v_exp_f32 v92, v92
  v_exp_f32 v93, v93
  v_cvt_pk_bf16_f32 v109, v90, v91
  v_exp_f32 v94, v94
  v_exp_f32 v95, v95
  v_cvt_pk_bf16_f32 v110, v92, v93
  v_cvt_pk_bf16_f32 v111, v94, v95
  v_mfma_f32_32x32x16_bf16 v[128:143], v[48:51], v[104:107], v[128:143]
  v_exp_f32 v64, v64
  v_exp_f32 v65, v65
  v_exp_f32 v66, v66
  v_mfma_f32_32x32x16_bf16 v[128:143], v[52:55], v[108:111], v[128:143]
  v_exp_f32 v67, v67
  v_cvt_pk_bf16_f32 v96, v64, v65
  v_exp_f32 v68, v68
  v_exp_f32 v69, v69
  v_cvt_pk_bf16_f32 v97, v66, v67
  v_mfma_f32_32x32x16_bf16 v[80:95], v[40:43], v[24:27], 0
  v_exp_f32 v70, v70
  v_exp_f32 v71, v71
  v_cvt_pk_bf16_f32 v98, v68, v69
  v_exp_f32 v72, v72
  v_mfma_f32_32x32x16_bf16 v[80:95], v[44:47], v[28:31], v[80:95]
  v_exp_f32 v73, v73
  v_cvt_pk_bf16_f32 v99, v70, v71
  v_exp_f32 v74, v74
  v_exp_f32 v75, v75
  v_cvt_pk_bf16_f32 v100, v72, v73
  v_exp_f32 v76, v76
  v_exp_f32 v77, v77
  v_cvt_pk_bf16_f32 v101, v74, v75
  v_exp_f32 v78, v78
  v_exp_f32 v79, v79
  v_cvt_pk_bf16_f32 v102, v76, v77
  v_cvt_pk_bf16_f32 v103, v78, v79
  s_waitcnt lgkmcnt(0)
  v_mfma_f32_32x32x16_bf16 v[112:127], v[56:59], v[96:99], v[112:127]
  v_exp_f32 v80, v80
  v_exp_f32 v81, v81
  v_exp_f32 v82, v82
  v_mfma_f32_32x32x16_bf16 v[112:127], v[60:63], v[100:103], v[112:127]
  v_exp_f32 v83, v83
  v_cvt_pk_bf16_f32 v104, v80, v81
  v_exp_f32 v84, v84
  v_exp_f32 v85, v85
  v_cvt_pk_bf16_f32 v105, v82, v83
  v_exp_f32 v86, v86
  v_exp_f32 v87, v87
  v_cvt_pk_bf16_f32 v106, v84, v85
  v_exp_f32 v88, v88
  v_exp_f32 v89, v89
  v_cvt_pk_bf16_f32 v107, v86, v87
  v_exp_f32 v90, v90
  v_exp_f32 v91, v91
  v_cvt_pk_bf16_f32 v108, v88, v89
  v_exp_f32 v92, v92
  v_exp_f32 v93, v93
  v_cvt_pk_bf16_f32 v109, v90, v91
  v_exp_f32 v94, v94
  v_exp_f32 v95, v95
  v_cvt_pk_bf16_f32 v110, v92, v93
  v_cvt_pk_bf16_f32 v111, v94, v95
  s_nop 1
  v_mfma_f32_32x32x16_bf16 v[128:143], v[56:59], v[104:107], v[128:143]
  v_mfma_f32_32x32x16_bf16 v[128:143], v[60:63], v[108:111], v[128:143]
  s_waitcnt vmcnt(0)
  s_barrier
  s_add_u32 s41, s41, 1
  s_cmp_ge_u32 s41, 4
  s_cbranch_scc1 nd_94
  s_mul_i32 s30, s41, 32768
  s_lshl_b32 s31, s21, 13
  s_add_u32 s30, s30, s31
  s_add_u32 m0, s31, 0
  s_add_u32 s29, s30, s27
  s_add_u32 s29, s29, 0
  buffer_load_dwordx4 v2, s[8:11], s29 offen lds
  s_add_u32 m0, s31, 1024
  s_add_u32 s29, s30, s27
  s_add_u32 s29, s29, 1024
  buffer_load_dwordx4 v2, s[8:11], s29 offen lds
  s_add_u32 m0, s31, 2048
  s_add_u32 s29, s30, s27
  s_add_u32 s29, s29, 2048
  buffer_load_dwordx4 v2, s[8:11], s29 offen lds
  s_add_u32 m0, s31, 3072
  s_add_u32 s29, s30, s27
  s_add_u32 s29, s29, 3072
  buffer_load_dwordx4 v2, s[8:11], s29 offen lds
  s_add_u32 m0, s31, 4096
  s_add_u32 s29, s30, s27
  s_add_u32 s29, s29, 4096
  buffer_load_dwordx4 v2, s[8:11], s29 offen lds
  s_add_u32 m0, s31, 5120
  s_add_u32 s29, s30, s27
  s_add_u32 s29, s29, 5120
  buffer_load_dwordx4 v2, s[8:11], s29 offen lds
  s_add_u32 m0, s31, 6144
  s_add_u32 s29, s30, s27
  s_add_u32 s29, s29, 6144
  buffer_load_dwordx4 v2, s[8:11], s29 offen lds
  s_add_u32 m0, s31, 7168
  s_add_u32 s29, s30, s27
  s_add_u32 s29, s29, 7168
  buffer_load_dwordx4 v2, s[8:11], s29 offen lds
  s_add_u32 m0, s31, 32768
  s_add_u32 s29, s30, s28
  s_add_u32 s29, s29, 0
  buffer_load_dwordx4 v2, s[8:11], s29 offen lds
  s_add_u32 m0, s31, 33792
  s_add_u32 s29, s30, s28
  s_add_u32 s29, s29, 1024
  buffer_load_dwordx4 v2, s[8:11], s29 offen lds
  s_add_u32 m0, s31, 34816
  s_add_u32 s29, s30, s28
  s_add_u32 s29, s29, 2048
  buffer_load_dwordx4 v2, s[8:11], s29 offen lds
  s_add_u32 m0, s31, 35840
  s_add_u32 s29, s30, s28
  s_add_u32 s29, s29, 3072
  buffer_load_dwordx4 v2, s[8:11], s29 offen lds
  s_add_u32 m0, s31, 36864
  s_add_u32 s29, s30, s28
  s_add_u32 s29, s29, 4096
  buffer_load_dwordx4 v2, s[8:11], s29 offen lds
  s_add_u32 m0, s31, 37888
  s_add_u32 s29, s30, s28
  s_add_u32 s29, s29, 5120
  buffer_load_dwordx4 v2, s[8:11], s29 offen lds
  s_add_u32 m0, s31, 38912
  s_add_u32 s29, s30, s28
  s_add_u32 s29, s29, 6144
  buffer_load_dwordx4 v2, s[8:11], s29 offen lds
  s_add_u32 m0, s31, 39936
  s_add_u32 s29, s30, s28
  s_add_u32 s29, s29, 7168
  buffer_load_dwordx4 v2, s[8:11], s29 offen lds
nd_94:
  ds_read_b128 v[32:35], v4 offset:0
  ds_read_b128 v[36:39], v4 offset:1024
  ds_read_b128 v[48:51], v4 offset:32768
  ds_read_b128 v[52:55], v4 offset:33792
  ds_read_b128 v[40:43], v4 offset:2048
  ds_read_b128 v[44:47], v4 offset:3072
  s_waitcnt lgkmcnt(4)
  v_mfma_f32_32x32x16_bf16 v[64:79], v[32:35], v[16:19], 0
  v_mfma_f32_32x32x16_bf16 v[64:79], v[36:39], v[20:23], v[64:79]
  s_nop 11
  v_exp_f32 v64, v64
  v_exp_f32 v65, v65
  v_exp_f32 v66, v66
  v_exp_f32 v67, v67
  v_cvt_pk_bf16_f32 v96, v64, v65
  v_exp_f32 v68, v68
  v_exp_f32 v69, v69
  v_cvt_pk_bf16_f32 v97, v66, v67
  v_mfma_f32_32x32x16_bf16 v[80:95], v[32:35], v[24:27], 0
  v_exp_f32 v70, v70
  v_exp_f32 v71, v71
  v_cvt_pk_bf16_f32 v98, v68, v69
  v_exp_f32 v72, v72
  v_mfma_f32_32x32x16_bf16 v[80:95], v[36:39], v[28:31], v[80:95]
  v_exp_f32 v73, v73
  v_cvt_pk_bf16_f32 v99, v70, v71
  v_exp_f32 v74, v74
  ds_read_b128 v[56:59], v4 offset:34816
  v_exp_f32 v75, v75
  v_cvt_pk_bf16_f32 v100, v72, v73
  v_exp_f32 v76, v76
  ds_read_b128 v[60:63], v4 offset:35840
  v_exp_f32 v77, v77
  v_cvt_pk_bf16_f32 v101, v74, v75
  v_exp_f32 v78, v78
  v_exp_f32 v79, v79
  v_cvt_pk_bf16_f32 v102, v76, v77
  v_cvt_pk_bf16_f32 v103, v78, v79
  s_waitcnt lgkmcnt(4)
  v_mfma_f32_32x32x16_bf16 v[112:127], v[48:51], v[96:99], v[112:127]
  v_exp_f32 v80, v80
  v_exp_f32 v81, v81
  v_exp_f32 v82, v82
  v_mfma_f32_32x32x16_bf16 v[112:127], v[52:55], v[100:103], v[112:127]
  v_exp_f32 v83, v83
  v_cvt_pk_bf16_f32 v104, v80, v81
  v_exp_f32 v84, v84
  v_exp_f32 v85, v85
  v_cvt_pk_bf16_f32 v105, v82, v83
  s_waitcnt lgkmcnt(2)
  v_mfma_f32_32x32x16_bf16 v[64:79], v[40:43], v[16:19], 0
  v_exp_f32 v86, v86
  v_exp_f32 v87, v87
  v_cvt_pk_bf16_f32 v106, v84, v85
  v_exp_f32 v88, v88
  v_mfma_f32_32x32x16_bf16 v[64:79], v[44:47], v[20:23], v[64:79]
  v_exp_f32 v89, v89
  v_cvt_pk_bf16_f32 v107, v86, v87
  v_exp_f32 v90, v90
  ds_read_b128 v[32:35], v4 offset:4096
  v_exp_f32 v91, v91
  v_cvt_pk_bf16_f32 v108, v88, v89
  v_exp_f32 v92, v92
  ds_read_b128 v[36:39], v4 offset:5120
  v_exp_f32 v93, v93
  v_cvt_pk_bf16_f32 v109, v90, v91
  v_exp_f32 v94, v94
  v_exp_f32 v95, v95
  v_cvt_pk_bf16_f32 v110, v92, v93
  v_cvt_pk_bf16_f32 v111, v94, v95
  v_mfma_f32_32x32x16_bf16 v[128:143], v[48:51], v[104:107], v[128:143]
  v_exp_f32 v64, v64
  v_exp_f32 v65, v65
  v_exp_f32 v66, v66
  v_mfma_f32_32x32x16_bf16 v[128:143], v[52:55], v[108:111], v[128:143]
  v_exp_f32 v67, v67
  v_cvt_pk_bf16_f32 v96, v64, v65
  v_exp_f32 v68, v68
  v_exp_f32 v69, v69
  v_cvt_pk_bf16_f32 v97, v66, v67
  v_mfma_f32_32x32x16_bf16 v[80:95], v[40:43], v[24:27], 0
  v_exp_f32 v70, v70
  v_exp_f32 v71, v71
  v_cvt_pk_bf16_f32 v98, v68, v69
  v_exp_f32 v72, v72
  v_mfma_f32_32x32x16_bf16 v[80:95], v[44:47], v[28:31], v[80:95]
  v_exp_f32 v73, v73
  v_cvt_pk_bf16_f32 v99, v70, v71
  v_exp_f32 v74, v74
  ds_read_b128 v[48:51], v4 offset:36864
  v_exp_f32 v75, v75
  v_cvt_pk_bf16_f32 v100, v72, v73
  v_exp_f32 v76, v76
  ds_read_b128 v[52:55], v4 offset:37888
  v_exp_f32 v77, v77
  v_cvt_pk_bf16_f32 v101, v74, v75
  v_exp_f32 v78, v78
  v_exp_f32 v79, v79
  v_cvt_pk_bf16_f32 v102, v76, v77
  v_cvt_pk_bf16_f32 v103, v78, v79
  s_waitcnt lgkmcnt(4)
  v_mfma_f32_32x32x16_bf16 v[112:127], v[56:59], v[96:99], v[112:127]
  v_exp_f32 v80, v80
  v_exp_f32 v81, v81
  v_exp_f32 v82, v82
  v_mfma_f32_32x32x16_bf16 v[112:127], v[60:63], v[100:103], v[112:127]
  v_exp_f32 v83, v83
  v_cvt_pk_bf16_f32 v104, v80, v81
  v_exp_f32 v84, v84
  v_exp_f32 v85, v85
  v_cvt_pk_bf16_f32 v105, v82, v83
  s_waitcnt lgkmcnt(2)
  v_mfma_f32_32x32x16_bf16 v[64:79], v[32:35], v[16:19], 0
  v_exp_f32 v86, v86
  v_exp_f32 v87, v87
  v_cvt_pk_bf16_f32 v106, v84, v85
  v_exp_f32 v88, v88
  v_mfma_f32_32x32x16_bf16 v[64:79], v[36:39], v[20:23], v[64:79]
  v_exp_f32 v89, v89
  v_cvt_pk_bf16_f32 v107, v86, v87
  v_exp_f32 v90, v90
  ds_read_b128 v[40:43], v4 offset:6144
  v_exp_f32 v91, v91
  v_cvt_pk_bf16_f32 v108, v88, v89
  v_exp_f32 v92, v92
  ds_read_b128 v[44:47], v4 offset:7168
  v_exp_f32 v93, v93
  v_cvt_pk_bf16_f32 v109, v90, v91
  v_exp_f32 v94, v94
  v_exp_f32 v95, v95
  v_cvt_pk_bf16_f32 v110, v92, v93
  v_cvt_pk_bf16_f32 v111, v94, v95
  v_mfma_f32_32x32x16_bf16 v[128:143], v[56:59], v[104:107], v[128:143]
  v_exp_f32 v64, v64
  v_exp_f32 v65, v65
  v_exp_f32 v66, v66
  v_mfma_f32_32x32x16_bf16 v[128:143], v[60:63], v[108:111], v[128:143]
  v_exp_f32 v67, v67
  v_cvt_pk_bf16_f32 v96, v64, v65
  v_exp_f32 v68, v68
  v_exp_f32 v69, v69
  v_cvt_pk_bf16_f32 v97, v66, v67
  v_mfma_f32_32x32x16_bf16 v[80:95], v[32:35], v[24:27], 0
  v_exp_f32 v70, v70
  v_exp_f32 v71, v71
  v_cvt_pk_bf16_f32 v98, v68, v69
  v_exp_f32 v72, v72
  v_mfma_f32_32x32x16_bf16 v[80:95], v[36:39], v[28:31], v[80:95]
  v_exp_f32 v73, v73
  v_cvt_pk_bf16_f32 v99, v70, v71
  v_exp_f32 v74, v74
  ds_read_b128 v[56:59], v4 offset:38912
  v_exp_f32 v75, v75
  v_cvt_pk_bf16_f32 v100, v72, v73
  v_exp_f32 v76, v76
  ds_read_b128 v[60:63], v4 offset:39936
  v_exp_f32 v77, v77
  v_cvt_pk_bf16_f32 v101, v74, v75
  v_exp_f32 v78, v78
  v_exp_f32 v79, v79
  v_cvt_pk_bf16_f32 v102, v76, v77
  v_cvt_pk_bf16_f32 v103, v78, v79
  s_waitcnt lgkmcnt(4)
  v_mfma_f32_32x32x16_bf16 v[112:127], v[48:51], v[96:99], v[112:127]
  v_exp_f32 v80, v80
  v_exp_f32 v81, v81
  v_exp_f32 v82, v82
  v_mfma_f32_32x32x16_bf16 v[112:127], v[52:55], v[100:103], v[112:127]
  v_exp_f32 v83, v83
  v_cvt_pk_bf16_f32 v104, v80, v81
  v_exp_f32 v84, v84
  v_exp_f32 v85, v85
  v_cvt_pk_bf16_f32 v105, v82, v83
  s_waitcnt lgkmcnt(2)
  v_mfma_f32_32x32x16_bf16 v[64:79], v[40:43], v[16:19], 0
  v_exp_f32 v86, v86
  v_exp_f32 v87, v87
  v_cvt_pk_bf16_f32 v106, v84, v85
  v_exp_f32 v88, v88
  v_mfma_f32_32x32x16_bf16 v[64:79], v[44:47], v[20:23], v[64:79]
  v_exp_f32 v89, v89
  v_cvt_pk_bf16_f32 v107, v86, v87
  v_exp_f32 v90, v90
  ds_read_b128 v[32:35], v4 offset:8192
  v_exp_f32 v91, v91
  v_cvt_pk_bf16_f32 v108, v88, v89
  v_exp_f32 v92, v92
  ds_read_b128 v[36:39], v4 offset:9216
  v_exp_f32 v93, v93
  v_cvt_pk_bf16_f32 v109, v90, v91
  v_exp_f32 v94, v94
  v_exp_f32 v95, v95
  v_cvt_pk_bf16_f32 v110, v92, v93
  v_cvt_pk_bf16_f32 v111, v94, v95
  v_mfma_f32_32x32x16_bf16 v[128:143], v[48:51], v[104:107], v[128:143]
  v_exp_f32 v64, v64
  v_exp_f32 v65, v65
  v_exp_f32 v66, v66
  v_mfma_f32_32x32x16_bf16 v[128:143], v[52:55], v[108:111], v[128:143]
  v_exp_f32 v67, v67
  v_cvt_pk_bf16_f32 v96, v64, v65
  v_exp_f32 v68, v68
  v_exp_f32 v69, v69
  v_cvt_pk_bf16_f32 v97, v66, v67
  v_mfma_f32_32x32x16_bf16 v[80:95], v[40:43], v[24:27], 0
  v_exp_f32 v70, v70
  v_exp_f32 v71, v71
  v_cvt_pk_bf16_f32 v98, v68, v69
  v_exp_f32 v72, v72
  v_mfma_f32_32x32x16_bf16 v[80:95], v[44:47], v[28:31], v[80:95]
  v_exp_f32 v73, v73
  v_cvt_pk_bf16_f32 v99, v70, v71
  v_exp_f32 v74, v74
  ds_read_b128 v[48:51], v4 offset:40960
  v_exp_f32 v75, v75
  v_cvt_pk_bf16_f32 v100, v72, v73
  v_exp_f32 v76, v76
  ds_read_b128 v[52:55], v4 offset:41984
  v_exp_f32 v77, v77
  v_cvt_pk_bf16_f32 v101, v74, v75
  v_exp_f32 v78, v78
  v_exp_f32 v79, v79
  v_cvt_pk_bf16_f32 v102, v76, v77
  v_cvt_pk_bf16_f32 v103, v78, v79
  s_waitcnt lgkmcnt(4)
  v_mfma_f32_32x32x16_bf16 v[112:127], v[56:59], v[96:99], v[112:127]
  v_exp_f32 v80, v80
  v_exp_f32 v81, v81
  v_exp_f32 v82, v82
  v_mfma_f32_32x32x16_bf16 v[112:127], v[60:63], v[100:103], v[112:127]
  v_exp_f32 v83, v83
  v_cvt_pk_bf16_f32 v104, v80, v81
  v_exp_f32 v84, v84
  v_exp_f32 v85, v85
  v_cvt_pk_bf16_f32 v105, v82, v83
  s_waitcnt lgkmcnt(2)
  v_mfma_f32_32x32x16_bf16 v[64:79], v[32:35], v[16:19], 0
  v_exp_f32 v86, v86
  v_exp_f32 v87, v87
  v_cvt_pk_bf16_f32 v106, v84, v85
  v_exp_f32 v88, v88
  v_mfma_f32_32x32x16_bf16 v[64:79], v[36:39], v[20:23], v[64:79]
  v_exp_f32 v89, v89
  v_cvt_pk_bf16_f32 v107, v86, v87
  v_exp_f32 v90, v90
  ds_read_b128 v[40:43], v4 offset:10240
  v_exp_f32 v91, v91
  v_cvt_pk_bf16_f32 v108, v88, v89
  v_exp_f32 v92, v92
  ds_read_b128 v[44:47], v4 offset:11264
  v_exp_f32 v93, v93
  v_cvt_pk_bf16_f32 v109, v90, v91
  v_exp_f32 v94, v94
  v_exp_f32 v95, v95
  v_cvt_pk_bf16_f32 v110, v92, v93
  v_cvt_pk_bf16_f32 v111, v94, v95
  v_mfma_f32_32x32x16_bf16 v[128:143], v[56:59], v[104:107], v[128:143]
  v_exp_f32 v64, v64
  v_exp_f32 v65, v65
  v_exp_f32 v66, v66
  v_mfma_f32_32x32x16_bf16 v[128:143], v[60:63], v[108:111], v[128:143]
  v_exp_f32 v67, v67
  v_cvt_pk_bf16_f32 v96, v64, v65
  v_exp_f32 v68, v68
  v_exp_f32 v69, v69
  v_cvt_pk_bf16_f32 v97, v66, v67
  v_mfma_f32_32x32x16_bf16 v[80:95], v[32:35], v[24:27], 0
  v_exp_f32 v70, v70
  v_exp_f32 v71, v71
  v_cvt_pk_bf16_f32 v98, v68, v69
  v_exp_f32 v72, v72
  v_mfma_f32_32x32x16_bf16 v[80:95], v[36:39], v[28:31], v[80:95]
  v_exp_f32 v73, v73
  v_cvt_pk_bf16_f32 v99, v70, v71
  v_exp_f32 v74, v74
  ds_read_b128 v[56:59], v4 offset:43008
  v_exp_f32 v75, v75
  v_cvt_pk_bf16_f32 v100, v72, v73
  v_exp_f32 v76, v76
  ds_read_b128 v[60:63], v4 offset:44032
  v_exp_f32 v77, v77
  v_cvt_pk_bf16_f32 v101, v74, v75
  v_exp_f32 v78, v78
  v_exp_f32 v79, v79
  v_cvt_pk_bf16_f32 v102, v76, v77
  v_cvt_pk_bf16_f32 v103, v78, v79
  s_waitcnt lgkmcnt(4)
  v_mfma_f32_32x32x16_bf16 v[112:127], v[48:51], v[96:99], v[112:127]
  v_exp_f32 v80, v80
  v_exp_f32 v81, v81
  v_exp_f32 v82, v82
  v_mfma_f32_32x32x16_bf16 v[112:127], v[52:55], v[100:103], v[112:127]
  v_exp_f32 v83, v83
  v_cvt_pk_bf16_f32 v104, v80, v81
  v_exp_f32 v84, v84
  v_exp_f32 v85, v85
  v_cvt_pk_bf16_f32 v105, v82, v83
  s_waitcnt lgkmcnt(2)
  v_mfma_f32_32x32x16_bf16 v[64:79], v[40:43], v[16:19], 0
  v_exp_f32 v86, v86
  v_exp_f32 v87, v87
  v_cvt_pk_bf16_f32 v106, v84, v85
  v_exp_f32 v88, v88
  v_mfma_f32_32x32x16_bf16 v[64:79], v[44:47], v[20:23], v[64:79]
  v_exp_f32 v89, v89
  v_cvt_pk_bf16_f32 v107, v86, v87
  v_exp_f32 v90, v90
  ds_read_b128 v[32:35], v4 offset:12288
  v_exp_f32 v91, v91
  v_cvt_pk_bf16_f32 v108, v88, v89
  v_exp_f32 v92, v92
  ds_read_b128 v[36:39], v4 offset:13312
  v_exp_f32 v93, v93
  v_cvt_pk_bf16_f32 v109, v90, v91
  v_exp_f32 v94, v94
  v_exp_f32 v95, v95
  v_cvt_pk_bf16_f32 v110, v92, v93
  v_cvt_pk_bf16_f32 v111, v94, v95
  v_mfma_f32_32x32x16_bf16 v[128:143], v[48:51], v[104:107], v[128:143]
  v_exp_f32 v64, v64
  v_exp_f32 v65, v65
  v_exp_f32 v66, v66
  v_mfma_f32_32x32x16_bf16 v[128:143], v[52:55], v[108:111], v[128:143]
  v_exp_f32 v67, v67
  v_cvt_pk_bf16_f32 v96, v64, v65
  v_exp_f32 v68, v68
  v_exp_f32 v69, v69
  v_cvt_pk_bf16_f32 v97, v66, v67
  v_mfma_f32_32x32x16_bf16 v[80:95], v[40:43], v[24:27], 0
  v_exp_f32 v70, v70
  v_exp_f32 v71, v71
  v_cvt_pk_bf16_f32 v98, v68, v69
  v_exp_f32 v72, v72
  v_mfma_f32_32x32x16_bf16 v[80:95], v[44:47], v[28:31], v[80:95]
  v_exp_f32 v73, v73
  v_cvt_pk_bf16_f32 v99, v70, v71
  v_exp_f32 v74, v74
  ds_read_b128 v[48:51], v4 offset:45056
  v_exp_f32 v75, v75
  v_cvt_pk_bf16_f32 v100, v72, v73
  v_exp_f32 v76, v76
  ds_read_b128 v[52:55], v4 offset:46080
  v_exp_f32 v77, v77
  v_cvt_pk_bf16_f32 v101, v74, v75
  v_exp_f32 v78, v78
  v_exp_f32 v79, v79
  v_cvt_pk_bf16_f32 v102, v76, v77
  v_cvt_pk_bf16_f32 v103, v78, v79
  s_waitcnt lgkmcnt(4)
  v_mfma_f32_32x32x16_bf16 v[112:127], v[56:59], v[96:99], v[112:127]
  v_exp_f32 v80, v80
  v_exp_f32 v81, v81
  v_exp_f32 v82, v82
  v_mfma_f32_32x32x16_bf16 v[112:127], v[60:63], v[100:103], v[112:127]
  v_exp_f32 v83, v83
  v_cvt_pk_bf16_f32 v104, v80, v81
  v_exp_f32 v84, v84
  v_exp_f32 v85, v85
  v_cvt_pk_bf16_f32 v105, v82, v83
  s_waitcnt lgkmcnt(2)
  v_mfma_f32_32x32x16_bf16 v[64:79], v[32:35], v[16:19], 0
  v_exp_f32 v86, v86
  v_exp_f32 v87, v87
  v_cvt_pk_bf16_f32 v106, v84, v85
  v_exp_f32 v88, v88
  v_mfma_f32_32x32x16_bf16 v[64:79], v[36:39], v[20:23], v[64:79]
  v_exp_f32 v89, v89
  v_cvt_pk_bf16_f32 v107, v86, v87
  v_exp_f32 v90, v90
  ds_read_b128 v[40:43], v4 offset:14336
  v_exp_f32 v91, v91
  v_cvt_pk_bf16_f32 v108, v88, v89
  v_exp_f32 v92, v92
  ds_read_b128 v[44:47], v4 offset:15360
  v_exp_f32 v93, v93
  v_cvt_pk_bf16_f32 v109, v90, v91
  v_exp_f32 v94, v94
  v_exp_f32 v95, v95
  v_cvt_pk_bf16_f32 v110, v92, v93
  v_cvt_pk_bf16_f32 v111, v94, v95
  v_mfma_f32_32x32x16_bf16 v[128:143], v[56:59], v[104:107], v[128:143]
  v_exp_f32 v64, v64
  v_exp_f32 v65, v65
  v_exp_f32 v66, v66
  v_mfma_f32_32x32x16_bf16 v[128:143], v[60:63], v[108:111], v[128:143]
  v_exp_f32 v67, v67
  v_cvt_pk_bf16_f32 v96, v64, v65
  v_exp_f32 v68, v68
  v_exp_f32 v69, v69
  v_cvt_pk_bf16_f32 v97, v66, v67
  v_mfma_f32_32x32x16_bf16 v[80:95], v[32:35], v[24:27], 0
  v_exp_f32 v70, v70
  v_exp_f32 v71, v71
  v_cvt_pk_bf16_f32 v98, v68, v69
  v_exp_f32 v72, v72
  v_mfma_f32_32x32x16_bf16 v[80:95], v[36:39], v[28:31], v[80:95]
  v_exp_f32 v73, v73
  v_cvt_pk_bf16_f32 v99, v70, v71
  v_exp_f32 v74, v74
  ds_read_b128 v[56:59], v4 offset:47104
  v_exp_f32 v75, v75
  v_cvt_pk_bf16_f32 v100, v72, v73
  v_exp_f32 v76, v76
  ds_read_b128 v[60:63], v4 offset:48128
  v_exp_f32 v77, v77
  v_cvt_pk_bf16_f32 v101, v74, v75
  v_exp_f32 v78, v78
  v_exp_f32 v79, v79
  v_cvt_pk_bf16_f32 v102, v76, v77
  v_cvt_pk_bf16_f32 v103, v78, v79
  s_waitcnt lgkmcnt(4)
  v_mfma_f32_32x32x16_bf16 v[112:127], v[48:51], v[96:99], v[112:127]
  v_exp_f32 v80, v80
  v_exp_f32 v81, v81
  v_exp_f32 v82, v82
  v_mfma_f32_32x32x16_bf16 v[112:127], v[52:55], v[100:103], v[112:127]
  v_exp_f32 v83, v83
  v_cvt_pk_bf16_f32 v104, v80, v81
  v_exp_f32 v84, v84
  v_exp_f32 v85, v85
  v_cvt_pk_bf16_f32 v105, v82, v83
  s_waitcnt lgkmcnt(2)
  v_mfma_f32_32x32x16_bf16 v[64:79], v[40:43], v[16:19], 0
  v_exp_f32 v86, v86
  v_exp_f32 v87, v87
  v_cvt_pk_bf16_f32 v106, v84, v85
  v_exp_f32 v88, v88
  v_mfma_f32_32x32x16_bf16 v[64:79], v[44:47], v[20:23], v[64:79]
  v_exp_f32 v89, v89
  v_cvt_pk_bf16_f32 v107, v86, v87
  v_exp_f32 v90, v90
  ds_read_b128 v[32:35], v4 offset:16384
  v_exp_f32 v91, v91
  v_cvt_pk_bf16_f32 v108, v88, v89
  v_exp_f32 v92, v92
  ds_read_b128 v[36:39], v4 offset:17408
  v_exp_f32 v93, v93
  v_cvt_pk_bf16_f32 v109, v90, v91
  v_exp_f32 v94, v94
  v_exp_f32 v95, v95
  v_cvt_pk_bf16_f32 v110, v92, v93
  v_cvt_pk_bf16_f32 v111, v94, v95
  v_mfma_f32_32x32x16_bf16 v[128:143], v[48:51], v[104:107], v[128:143]
  v_exp_f32 v64, v64
  v_exp_f32 v65, v65
  v_exp_f32 v66, v66
  v_mfma_f32_32x32x16_bf16 v[128:143], v[52:55], v[108:111], v[128:143]
  v_exp_f32 v67, v67
  v_cvt_pk_bf16_f32 v96, v64, v65
  v_exp_f32 v68, v68
  v_exp_f32 v69, v69
  v_cvt_pk_bf16_f32 v97, v66, v67
  v_mfma_f32_32x32x16_bf16 v[80:95], v[40:43], v[24:27], 0
  v_exp_f32 v70, v70
  v_exp_f32 v71, v71
  v_cvt_pk_bf16_f32 v98, v68, v69
  v_exp_f32 v72, v72
  v_mfma_f32_32x32x16_bf16 v[80:95], v[44:47], v[28:31], v[80:95]
  v_exp_f32 v73, v73
  v_cvt_pk_bf16_f32 v99, v70, v71
  v_exp_f32 v74, v74
  ds_read_b128 v[48:51], v4 offset:49152
  v_exp_f32 v75, v75
  v_cvt_pk_bf16_f32 v100, v72, v73
  v_exp_f32 v76, v76
  ds_read_b128 v[52:55], v4 offset:50176
  v_exp_f32 v77, v77
  v_cvt_pk_bf16_f32 v101, v74, v75
  v_exp_f32 v78, v78
  v_exp_f32 v79, v79
  v_cvt_pk_bf16_f32 v102, v76, v77
  v_cvt_pk_bf16_f32 v103, v78, v79
  s_waitcnt lgkmcnt(4)
  v_mfma_f32_32x32x16_bf16 v[112:127], v[56:59], v[96:99], v[112:127]
  v_exp_f32 v80, v80
  v_exp_f32 v81, v81
  v_exp_f32 v82, v82
  v_mfma_f32_32x32x16_bf16 v[112:127], v[60:63], v[100:103], v[112:127]
  v_exp_f32 v83, v83
  v_cvt_pk_bf16_f32 v104, v80, v81
  v_exp_f32 v84, v84
  v_exp_f32 v85, v85
  v_cvt_pk_bf16_f32 v105, v82, v83
  s_waitcnt lgkmcnt(2)
  v_mfma_f32_32x32x16_bf16 v[64:79], v[32:35], v[16:19], 0
  v_exp_f32 v86, v86
  v_exp_f32 v87, v87
  v_cvt_pk_bf16_f32 v106, v84, v85
  v_exp_f32 v88, v88
  v_mfma_f32_32x32x16_bf16 v[64:79], v[36:39], v[20:23], v[64:79]
  v_exp_f32 v89, v89
  v_cvt_pk_bf16_f32 v107, v86, v87
  v_exp_f32 v90, v90
  ds_read_b128 v[40:43], v4 offset:18432
  v_exp_f32 v91, v91
  v_cvt_pk_bf16_f32 v108, v88, v89
  v_exp_f32 v92, v92
  ds_read_b128 v[44:47], v4 offset:19456
  v_exp_f32 v93, v93
  v_cvt_pk_bf16_f32 v109, v90, v91
  v_exp_f32 v94, v94
  v_exp_f32 v95, v95
  v_cvt_pk_bf16_f32 v110, v92, v93
  v_cvt_pk_bf16_f32 v111, v94, v95
  v_mfma_f32_32x32x16_bf16 v[128:143], v[56:59], v[104:107], v[128:143]
  v_exp_f32 v64, v64
  v_exp_f32 v65, v65
  v_exp_f32 v66, v66
  v_mfma_f32_32x32x16_bf16 v[128:143], v[60:63], v[108:111], v[128:143]
  v_exp_f32 v67, v67
  v_cvt_pk_bf16_f32 v96, v64, v65
  v_exp_f32 v68, v68
  v_exp_f32 v69, v69
  v_cvt_pk_bf16_f32 v97, v66, v67
  v_mfma_f32_32x32x16_bf16 v[80:95], v[32:35], v[24:27], 0
  v_exp_f32 v70, v70
  v_exp_f32 v71, v71
  v_cvt_pk_bf16_f32 v98, v68, v69
  v_exp_f32 v72, v72
  v_mfma_f32_32x32x16_bf16 v[80:95], v[36:39], v[28:31], v[80:95]
  v_exp_f32 v73, v73
  v_cvt_pk_bf16_f32 v99, v70, v71
  v_exp_f32 v74, v74
  ds_read_b128 v[56:59], v4 offset:51200
  v_exp_f32 v75, v75
  v_cvt_pk_bf16_f32 v100, v72, v73
  v_exp_f32 v76, v76
  ds_read_b128 v[60:63], v4 offset:52224
  v_exp_f32 v77, v77
  v_cvt_pk_bf16_f32 v101, v74, v75
  v_exp_f32 v78, v78
  v_exp_f32 v79, v79
  v_cvt_pk_bf16_f32 v102, v76, v77
  v_cvt_pk_bf16_f32 v103, v78, v79
  s_waitcnt lgkmcnt(4)
  v_mfma_f32_32x32x16_bf16 v[112:127], v[48:51], v[96:99], v[112:127]
  v_exp_f32 v80, v80
  v_exp_f32 v81, v81
  v_exp_f32 v82, v82
  v_mfma_f32_32x32x16_bf16 v[112:127], v[52:55], v[100:103], v[112:127]
  v_exp_f32 v83, v83
  v_cvt_pk_bf16_f32 v104, v80, v81
  v_exp_f32 v84, v84
  v_exp_f32 v85, v85
  v_cvt_pk_bf16_f32 v105, v82, v83
  s_waitcnt lgkmcnt(2)
  v_mfma_f32_32x32x16_bf16 v[64:79], v[40:43], v[16:19], 0
  v_exp_f32 v86, v86
  v_exp_f32 v87, v87
  v_cvt_pk_bf16_f32 v106, v84, v85
  v_exp_f32 v88, v88
  v_mfma_f32_32x32x16_bf16 v[64:79], v[44:47], v[20:23], v[64:79]
  v_exp_f32 v89, v89
  v_cvt_pk_bf16_f32 v107, v86, v87
  v_exp_f32 v90, v90
  ds_read_b128 v[32:35], v4 offset:20480
  v_exp_f32 v91, v91
  v_cvt_pk_bf16_f32 v108, v88, v89
  v_exp_f32 v92, v92
  ds_read_b128 v[36:39], v4 offset:21504
  v_exp_f32 v93, v93
  v_cvt_pk_bf16_f32 v109, v90, v91
  v_exp_f32 v94, v94
  v_exp_f32 v95, v95
  v_cvt_pk_bf16_f32 v110, v92, v93
  v_cvt_pk_bf16_f32 v111, v94, v95
  v_mfma_f32_32x32x16_bf16 v[128:143], v[48:51], v[104:107], v[128:143]
  v_exp_f32 v64, v64
  v_exp_f32 v65, v65
  v_exp_f32 v66, v66
  v_mfma_f32_32x32x16_bf16 v[128:143], v[52:55], v[108:111], v[128:143]
  v_exp_f32 v67, v67
  v_cvt_pk_bf16_f32 v96, v64, v65
  v_exp_f32 v68, v68
  v_exp_f32 v69, v69
  v_cvt_pk_bf16_f32 v97, v66, v67
  v_mfma_f32_32x32x16_bf16 v[80:95], v[40:43], v[24:27], 0
  v_exp_f32 v70, v70
  v_exp_f32 v71, v71
  v_cvt_pk_bf16_f32 v98, v68, v69
  v_exp_f32 v72, v72
  v_mfma_f32_32x32x16_bf16 v[80:95], v[44:47], v[28:31], v[80:95]
  v_exp_f32 v73, v73
  v_cvt_pk_bf16_f32 v99, v70, v71
  v_exp_f32 v74, v74
  ds_read_b128 v[48:51], v4 offset:53248
  v_exp_f32 v75, v75
  v_cvt_pk_bf16_f32 v100, v72, v73
  v_exp_f32 v76, v76
  ds_read_b128 v[52:55], v4 offset:54272
  v_exp_f32 v77, v77
  v_cvt_pk_bf16_f32 v101, v74, v75
  v_exp_f32 v78, v78
  v_exp_f32 v79, v79
  v_cvt_pk_bf16_f32 v102, v76, v77
  v_cvt_pk_bf16_f32 v103, v78, v79
  s_waitcnt lgkmcnt(4)
  v_mfma_f32_32x32x16_bf16 v[112:127], v[56:59], v[96:99], v[112:127]
  v_exp_f32 v80, v80
  v_exp_f32 v81, v81
  v_exp_f32 v82, v82
  v_mfma_f32_32x32x16_bf16 v[112:127], v[60:63], v[100:103], v[112:127]
  v_exp_f32 v83, v83
  v_cvt_pk_bf16_f32 v104, v80, v81
  v_exp_f32 v84, v84
  v_exp_f32 v85, v85
  v_cvt_pk_bf16_f32 v105, v82, v83
  s_waitcnt lgkmcnt(2)
  v_mfma_f32_32x32x16_bf16 v[64:79], v[32:35], v[16:19], 0
  v_exp_f32 v86, v86
  v_exp_f32 v87, v87
  v_cvt_pk_bf16_f32 v106, v84, v85
  v_exp_f32 v88, v88
  v_mfma_f32_32x32x16_bf16 v[64:79], v[36:39], v[20:23], v[64:79]
  v_exp_f32 v89, v89
  v_cvt_pk_bf16_f32 v107, v86, v87
  v_exp_f32 v90, v90
  ds_read_b128 v[40:43], v4 offset:22528
  v_exp_f32 v91, v91
  v_cvt_pk_bf16_f32 v108, v88, v89
  v_exp_f32 v92, v92
  ds_read_b128 v[44:47], v4 offset:23552
  v_exp_f32 v93, v93
  v_cvt_pk_bf16_f32 v109, v90, v91
  v_exp_f32 v94, v94
  v_exp_f32 v95, v95
  v_cvt_pk_bf16_f32 v110, v92, v93
  v_cvt_pk_bf16_f32 v111, v94, v95
  v_mfma_f32_32x32x16_bf16 v[128:143], v[56:59], v[104:107], v[128:143]
  v_exp_f32 v64, v64
  v_exp_f32 v65, v65
  v_exp_f32 v66, v66
  v_mfma_f32_32x32x16_bf16 v[128:143], v[60:63], v[108:111], v[128:143]
  v_exp_f32 v67, v67
  v_cvt_pk_bf16_f32 v96, v64, v65
  v_exp_f32 v68, v68
  v_exp_f32 v69, v69
  v_cvt_pk_bf16_f32 v97, v66, v67
  v_mfma_f32_32x32x16_bf16 v[80:95], v[32:35], v[24:27], 0
  v_exp_f32 v70, v70
  v_exp_f32 v71, v71
  v_cvt_pk_bf16_f32 v98, v68, v69
  v_exp_f32 v72, v72
  v_mfma_f32_32x32x16_bf16 v[80:95], v[36:39], v[28:31], v[80:95]
  v_exp_f32 v73, v73
  v_cvt_pk_bf16_f32 v99, v70, v71
  v_exp_f32 v74, v74
  ds_read_b128 v[56:59], v4 offset:55296
  v_exp_f32 v75, v75
  v_cvt_pk_bf16_f32 v100, v72, v73
  v_exp_f32 v76, v76
  ds_read_b128 v[60:63], v4 offset:56320
  v_exp_f32 v77, v77
  v_cvt_pk_bf16_f32 v101, v74, v75
  v_exp_f32 v78, v78
  v_exp_f32 v79, v79
  v_cvt_pk_bf16_f32 v102, v76, v77
  v_cvt_pk_bf16_f32 v103, v78, v79
  s_waitcnt lgkmcnt(4)
  v_mfma_f32_32x32x16_bf16 v[112:127], v[48:51], v[96:99], v[112:127]
  v_exp_f32 v80, v80
  v_exp_f32 v81, v81
  v_exp_f32 v82, v82
  v_mfma_f32_32x32x16_bf16 v[112:127], v[52:55], v[100:103], v[112:127]
  v_exp_f32 v83, v83
  v_cvt_pk_bf16_f32 v104, v80, v81
  v_exp_f32 v84, v84
  v_exp_f32 v85, v85
  v_cvt_pk_bf16_f32 v105, v82, v83
  s_waitcnt lgkmcnt(2)
  v_mfma_f32_32x32x16_bf16 v[64:79], v[40:43], v[16:19], 0
  v_exp_f32 v86, v86
  v_exp_f32 v87, v87
  v_cvt_pk_bf16_f32 v106, v84, v85
  v_exp_f32 v88, v88
  v_mfma_f32_32x32x16_bf16 v[64:79], v[44:47], v[20:23], v[64:79]
  v_exp_f32 v89, v89
  v_cvt_pk_bf16_f32 v107, v86, v87
  v_exp_f32 v90, v90
  ds_read_b128 v[32:35], v4 offset:24576
  v_exp_f32 v91, v91
  v_cvt_pk_bf16_f32 v108, v88, v89
  v_exp_f32 v92, v92
  ds_read_b128 v[36:39], v4 offset:25600
  v_exp_f32 v93, v93
  v_cvt_pk_bf16_f32 v109, v90, v91
  v_exp_f32 v94, v94
  v_exp_f32 v95, v95
  v_cvt_pk_bf16_f32 v110, v92, v93
  v_cvt_pk_bf16_f32 v111, v94, v95
  v_mfma_f32_32x32x16_bf16 v[128:143], v[48:51], v[104:107], v[128:143]
  v_exp_f32 v64, v64
  v_exp_f32 v65, v65
  v_exp_f32 v66, v66
  v_mfma_f32_32x32x16_bf16 v[128:143], v[52:55], v[108:111], v[128:143]
  v_exp_f32 v67, v67
  v_cvt_pk_bf16_f32 v96, v64, v65
  v_exp_f32 v68, v68
  v_exp_f32 v69, v69
  v_cvt_pk_bf16_f32 v97, v66, v67
  v_mfma_f32_32x32x16_bf16 v[80:95], v[40:43], v[24:27], 0
  v_exp_f32 v70, v70
  v_exp_f32 v71, v71
  v_cvt_pk_bf16_f32 v98, v68, v69
  v_exp_f32 v72, v72
  v_mfma_f32_32x32x16_bf16 v[80:95], v[44:47], v[28:31], v[80:95]
  v_exp_f32 v73, v73
  v_cvt_pk_bf16_f32 v99, v70, v71
  v_exp_f32 v74, v74
  ds_read_b128 v[48:51], v4 offset:57344
  v_exp_f32 v75, v75
  v_cvt_pk_bf16_f32 v100, v72, v73
  v_exp_f32 v76, v76
  ds_read_b128 v[52:55], v4 offset:58368
  v_exp_f32 v77, v77
  v_cvt_pk_bf16_f32 v101, v74, v75
  v_exp_f32 v78, v78
  v_exp_f32 v79, v79
  v_cvt_pk_bf16_f32 v102, v76, v77
  v_cvt_pk_bf16_f32 v103, v78, v79
  s_waitcnt lgkmcnt(4)
  v_mfma_f32_32x32x16_bf16 v[112:127], v[56:59], v[96:99], v[112:127]
  v_exp_f32 v80, v80
  v_exp_f32 v81, v81
  v_exp_f32 v82, v82
  v_mfma_f32_32x32x16_bf16 v[112:127], v[60:63], v[100:103], v[112:127]
  v_exp_f32 v83, v83
  v_cvt_pk_bf16_f32 v104, v80, v81
  v_exp_f32 v84, v84
  v_exp_f32 v85, v85
  v_cvt_pk_bf16_f32 v105, v82, v83
  s_waitcnt lgkmcnt(2)
  v_mfma_f32_32x32x16_bf16 v[64:79], v[32:35], v[16:19], 0
  v_exp_f32 v86, v86
  v_exp_f32 v87, v87
  v_cvt_pk_bf16_f32 v106, v84, v85
  v_exp_f32 v88, v88
  v_mfma_f32_32x32x16_bf16 v[64:79], v[36:39], v[20:23], v[64:79]
  v_exp_f32 v89, v89
  v_cvt_pk_bf16_f32 v107, v86, v87
  v_exp_f32 v90, v90
  ds_read_b128 v[40:43], v4 offset:26624
  v_exp_f32 v91, v91
  v_cvt_pk_bf16_f32 v108, v88, v89
  v_exp_f32 v92, v92
  ds_read_b128 v[44:47], v4 offset:27648
  v_exp_f32 v93, v93
  v_cvt_pk_bf16_f32 v109, v90, v91
  v_exp_f32 v94, v94
  v_exp_f32 v95, v95
  v_cvt_pk_bf16_f32 v110, v92, v93
  v_cvt_pk_bf16_f32 v111, v94, v95
  v_mfma_f32_32x32x16_bf16 v[128:143], v[56:59], v[104:107], v[128:143]
  v_exp_f32 v64, v64
  v_exp_f32 v65, v65
  v_exp_f32 v66, v66
  v_mfma_f32_32x32x16_bf16 v[128:143], v[60:63], v[108:111], v[128:143]
  v_exp_f32 v67, v67
  v_cvt_pk_bf16_f32 v96, v64, v65
  v_exp_f32 v68, v68
  v_exp_f32 v69, v69
  v_cvt_pk_bf16_f32 v97, v66, v67
  v_mfma_f32_32x32x16_bf16 v[80:95], v[32:35], v[24:27], 0
  v_exp_f32 v70, v70
  v_exp_f32 v71, v71
  v_cvt_pk_bf16_f32 v98, v68, v69
  v_exp_f32 v72, v72
  v_mfma_f32_32x32x16_bf16 v[80:95], v[36:39], v[28:31], v[80:95]
  v_exp_f32 v73, v73
  v_cvt_pk_bf16_f32 v99, v70, v71
  v_exp_f32 v74, v74
  ds_read_b128 v[56:59], v4 offset:59392
  v_exp_f32 v75, v75
  v_cvt_pk_bf16_f32 v100, v72, v73
  v_exp_f32 v76, v76
  ds_read_b128 v[60:63], v4 offset:60416
  v_exp_f32 v77, v77
  v_cvt_pk_bf16_f32 v101, v74, v75
  v_exp_f32 v78, v78
  v_exp_f32 v79, v79
  v_cvt_pk_bf16_f32 v102, v76, v77
  v_cvt_pk_bf16_f32 v103, v78, v79
  s_waitcnt lgkmcnt(4)
  v_mfma_f32_32x32x16_bf16 v[112:127], v[48:51], v[96:99], v[112:127]
  v_exp_f32 v80, v80
  v_exp_f32 v81, v81
  v_exp_f32 v82, v82
  v_mfma_f32_32x32x16_bf16 v[112:127], v[52:55], v[100:103], v[112:127]
  v_exp_f32 v83, v83
  v_cvt_pk_bf16_f32 v104, v80, v81
  v_exp_f32 v84, v84
  v_exp_f32 v85, v85
  v_cvt_pk_bf16_f32 v105, v82, v83
  s_waitcnt lgkmcnt(2)
  v_mfma_f32_32x32x16_bf16 v[64:79], v[40:43], v[16:19], 0
  v_exp_f32 v86, v86
  v_exp_f32 v87, v87
  v_cvt_pk_bf16_f32 v106, v84, v85
  v_exp_f32 v88, v88
  v_mfma_f32_32x32x16_bf16 v[64:79], v[44:47], v[20:23], v[64:79]
  v_exp_f32 v89, v89
  v_cvt_pk_bf16_f32 v107, v86, v87
  v_exp_f32 v90, v90
  ds_read_b128 v[32:35], v4 offset:28672
  v_exp_f32 v91, v91
  v_cvt_pk_bf16_f32 v108, v88, v89
  v_exp_f32 v92, v92
  ds_read_b128 v[36:39], v4 offset:29696
  v_exp_f32 v93, v93
  v_cvt_pk_bf16_f32 v109, v90, v91
  v_exp_f32 v94, v94
  v_exp_f32 v95, v95
  v_cvt_pk_bf16_f32 v110, v92, v93
  v_cvt_pk_bf16_f32 v111, v94, v95
  v_mfma_f32_32x32x16_bf16 v[128:143], v[48:51], v[104:107], v[128:143]
  v_exp_f32 v64, v64
  v_exp_f32 v65, v65
  v_exp_f32 v66, v66
  v_mfma_f32_32x32x16_bf16 v[128:143], v[52:55], v[108:111], v[128:143]
  v_exp_f32 v67, v67
  v_cvt_pk_bf16_f32 v96, v64, v65
  v_exp_f32 v68, v68
  v_exp_f32 v69, v69
  v_cvt_pk_bf16_f32 v97, v66, v67
  v_mfma_f32_32x32x16_bf16 v[80:95], v[40:43], v[24:27], 0
  v_exp_f32 v70, v70
  v_exp_f32 v71, v71
  v_cvt_pk_bf16_f32 v98, v68, v69
  v_exp_f32 v72, v72
  v_mfma_f32_32x32x16_bf16 v[80:95], v[44:47], v[28:31], v[80:95]
  v_exp_f32 v73, v73
  v_cvt_pk_bf16_f32 v99, v70, v71
  v_exp_f32 v74, v74
  ds_read_b128 v[48:51], v4 offset:61440
  v_exp_f32 v75, v75
  v_cvt_pk_bf16_f32 v100, v72, v73
  v_exp_f32 v76, v76
  ds_read_b128 v[52:55], v4 offset:62464
  v_exp_f32 v77, v77
  v_cvt_pk_bf16_f32 v101, v74, v75
  v_exp_f32 v78, v78
  v_exp_f32 v79, v79
  v_cvt_pk_bf16_f32 v102, v76, v77
  v_cvt_pk_bf16_f32 v103, v78, v79
  s_waitcnt lgkmcnt(4)
  v_mfma_f32_32x32x16_bf16 v[112:127], v[56:59], v[96:99], v[112:127]
  v_exp_f32 v80, v80
  v_exp_f32 v81, v81
  v_exp_f32 v82, v82
  v_mfma_f32_32x32x16_bf16 v[112:127], v[60:63], v[100:103], v[112:127]
  v_exp_f32 v83, v83
  v_cvt_pk_bf16_f32 v104, v80, v81
  v_exp_f32 v84, v84
  v_exp_f32 v85, v85
  v_cvt_pk_bf16_f32 v105, v82, v83
  s_waitcnt lgkmcnt(2)
  v_mfma_f32_32x32x16_bf16 v[64:79], v[32:35], v[16:19], 0
  v_exp_f32 v86, v86
  v_exp_f32 v87, v87
  v_cvt_pk_bf16_f32 v106, v84, v85
  v_exp_f32 v88, v88
  v_mfma_f32_32x32x16_bf16 v[64:79], v[36:39], v[20:23], v[64:79]
  v_exp_f32 v89, v89
  v_cvt_pk_bf16_f32 v107, v86, v87
  v_exp_f32 v90, v90
  ds_read_b128 v[40:43], v4 offset:30720
  v_exp_f32 v91, v91
  v_cvt_pk_bf16_f32 v108, v88, v89
  v_exp_f32 v92, v92
  ds_read_b128 v[44:47], v4 offset:31744
  v_exp_f32 v93, v93
  v_cvt_pk_bf16_f32 v109, v90, v91
  v_exp_f32 v94, v94
  v_exp_f32 v95, v95
  v_cvt_pk_bf16_f32 v110, v92, v93
  v_cvt_pk_bf16_f32 v111, v94, v95
  v_mfma_f32_32x32x16_bf16 v[128:143], v[56:59], v[104:107], v[128:143]
  v_exp_f32 v64, v64
  v_exp_f32 v65, v65
  v_exp_f32 v66, v66
  v_mfma_f32_32x32x16_bf16 v[128:143], v[60:63], v[108:111], v[128:143]
  v_exp_f32 v67, v67
  v_cvt_pk_bf16_f32 v96, v64, v65
  v_exp_f32 v68, v68
  v_exp_f32 v69, v69
  v_cvt_pk_bf16_f32 v97, v66, v67
  v_mfma_f32_32x32x16_bf16 v[80:95], v[32:35], v[24:27], 0
  v_exp_f32 v70, v70
  v_exp_f32 v71, v71
  v_cvt_pk_bf16_f32 v98, v68, v69
  v_exp_f32 v72, v72
  v_mfma_f32_32x32x16_bf16 v[80:95], v[36:39], v[28:31], v[80:95]
  v_exp_f32 v73, v73
  v_cvt_pk_bf16_f32 v99, v70, v71
  v_exp_f32 v74, v74
  ds_read_b128 v[56:59], v4 offset:63488
  v_exp_f32 v75, v75
  v_cvt_pk_bf16_f32 v100, v72, v73
  v_exp_f32 v76, v76
  ds_read_b128 v[60:63], v4 offset:64512
  v_exp_f32 v77, v77
  v_cvt_pk_bf16_f32 v101, v74, v75
  v_exp_f32 v78, v78
  v_exp_f32 v79, v79
  v_cvt_pk_bf16_f32 v102, v76, v77
  v_cvt_pk_bf16_f32 v103, v78, v79
  s_waitcnt lgkmcnt(4)
  v_mfma_f32_32x32x16_bf16 v[112:127], v[48:51], v[96:99], v[112:127]
  v_exp_f32 v80, v80
  v_exp_f32 v81, v81
  v_exp_f32 v82, v82
  v_mfma_f32_32x32x16_bf16 v[112:127], v[52:55], v[100:103], v[112:127]
  v_exp_f32 v83, v83
  v_cvt_pk_bf16_f32 v104, v80, v81
  v_exp_f32 v84, v84
  v_exp_f32 v85, v85
  v_cvt_pk_bf16_f32 v105, v82, v83
  s_waitcnt lgkmcnt(2)
  v_mfma_f32_32x32x16_bf16 v[64:79], v[40:43], v[16:19], 0
  v_exp_f32 v86, v86
  v_exp_f32 v87, v87
  v_cvt_pk_bf16_f32 v106, v84, v85
  v_exp_f32 v88, v88
  v_mfma_f32_32x32x16_bf16 v[64:79], v[44:47], v[20:23], v[64:79]
  v_exp_f32 v89, v89
  v_cvt_pk_bf16_f32 v107, v86, v87
  v_exp_f32 v90, v90
  v_exp_f32 v91, v91
  v_cvt_pk_bf16_f32 v108, v88, v89
  v_exp_f32 v92, v92
  v_exp_f32 v93, v93
  v_cvt_pk_bf16_f32 v109, v90, v91
  v_exp_f32 v94, v94
  v_exp_f32 v95, v95
  v_cvt_pk_bf16_f32 v110, v92, v93
  v_cvt_pk_bf16_f32 v111, v94, v95
  v_mfma_f32_32x32x16_bf16 v[128:143], v[48:51], v[104:107], v[128:143]
  v_exp_f32 v64, v64
  v_exp_f32 v65, v65
  v_exp_f32 v66, v66
  v_mfma_f32_32x32x16_bf16 v[128:143], v[52:55], v[108:111], v[128:143]
  v_exp_f32 v67, v67
  v_cvt_pk_bf16_f32 v96, v64, v65
  v_exp_f32 v68, v68
  v_exp_f32 v69, v69
  v_cvt_pk_bf16_f32 v97, v66, v67
  v_mfma_f32_32x32x16_bf16 v[80:95], v[40:43], v[24:27], 0
  v_exp_f32 v70, v70
  v_exp_f32 v71, v71
  v_cvt_pk_bf16_f32 v98, v68, v69
  v_exp_f32 v72, v72
  v_mfma_f32_32x32x16_bf16 v[80:95], v[44:47], v[28:31], v[80:95]
  v_exp_f32 v73, v73
  v_cvt_pk_bf16_f32 v99, v70, v71
  v_exp_f32 v74, v74
  v_exp_f32 v75, v75
  v_cvt_pk_bf16_f32 v100, v72, v73
  v_exp_f32 v76, v76
  v_exp_f32 v77, v77
  v_cvt_pk_bf16_f32 v101, v74, v75
  v_exp_f32 v78, v78
  v_exp_f32 v79, v79
  v_cvt_pk_bf16_f32 v102, v76, v77
  v_cvt_pk_bf16_f32 v103, v78, v79
  s_waitcnt lgkmcnt(0)
  v_mfma_f32_32x32x16_bf16 v[112:127], v[56:59], v[96:99], v[112:127]
  v_exp_f32 v80, v80
  v_exp_f32 v81, v81
  v_exp_f32 v82, v82
  v_mfma_f32_32x32x16_bf16 v[112:127], v[60:63], v[100:103], v[112:127]
  v_exp_f32 v83, v83
  v_cvt_pk_bf16_f32 v104, v80, v81
  v_exp_f32 v84, v84
  v_exp_f32 v85, v85
  v_cvt_pk_bf16_f32 v105, v82, v83
  v_exp_f32 v86, v86
  v_exp_f32 v87, v87
  v_cvt_pk_bf16_f32 v106, v84, v85
  v_exp_f32 v88, v88
  v_exp_f32 v89, v89
  v_cvt_pk_bf16_f32 v107, v86, v87
  v_exp_f32 v90, v90
  v_exp_f32 v91, v91
  v_cvt_pk_bf16_f32 v108, v88, v89
  v_exp_f32 v92, v92
  v_exp_f32 v93, v93
  v_cvt_pk_bf16_f32 v109, v90, v91
  v_exp_f32 v94, v94
  v_exp_f32 v95, v95
  v_cvt_pk_bf16_f32 v110, v92, v93
  v_cvt_pk_bf16_f32 v111, v94, v95
  s_nop 1
  v_mfma_f32_32x32x16_bf16 v[128:143], v[56:59], v[104:107], v[128:143]
  v_mfma_f32_32x32x16_bf16 v[128:143], v[60:63], v[108:111], v[128:143]
  s_cmp_lt_u32 s41, 4
  s_cbranch_scc1 kb2a_chunk2
  s_nop 11
  v_mov_b32 v5, v120
  v_mov_b32 v6, v120
  s_nop 1
  v_permlane32_swap_b32 v5, v6
  v_mov_b32 v14, v6
  v_mov_b32 v5, v136
  v_mov_b32 v6, v136
  s_nop 1
  v_permlane32_swap_b32 v5, v6
  v_mov_b32 v15, v6
  s_cmp_eq_u32 s40, 0
  s_cbranch_scc0 kb2a_fin
  v_min_f32 v5, v14, v15
  v_cmp_gt_f32 vcc, 0x12800000, v5
  v_cmp_u_f32 s[36:37], v5, v5
  s_nop 1
  s_or_b64 vcc, vcc, s[36:37]
  s_cmp_lg_u64 vcc, 0
  s_cselect_b32 s42, 1, 0
  v_mov_b32 v5, s42
  s_lshl_b32 s30, s21, 2
  v_mov_b32 v6, s30
  s_barrier
  ds_write_b32 v6, v5
  s_waitcnt lgkmcnt(0)
  s_barrier
  v_mov_b32 v6, 0
  ds_read_b128 v[8:11], v6
  s_waitcnt lgkmcnt(0)
  v_or_b32 v8, v8, v9
  v_or_b32 v10, v10, v11
  v_or_b32 v8, v8, v10
  s_nop 0
  v_readfirstlane_b32 s42, v8
  s_cmp_eq_u32 s42, 0
  s_cbranch_scc1 kb2a_fin
  s_mov_b32 s40, 1
  v_and_b32 v5, 0xffff0000, v22
  v_cndmask_b32 v22, v22, v5, s[34:35]
  v_mov_b32 v12, 0xff7fffff
  v_and_b32 v5, 0xffff0000, v30
  v_cndmask_b32 v30, v30, v5, s[34:35]
  v_mov_b32 v13, 0xff7fffff
  s_mov_b32 s41, 0
kb2a_mx:
  s_lshl_b32 s30, s41, 11
  s_add_u32 s30, s30, s27
  buffer_load_dwordx4 v[32:35], v2, s[8:11], s30 offen
  buffer_load_dwordx4 v[36:39], v2, s[8:11], s30 offen offset:1024
  s_waitcnt vmcnt(0)
  v_mfma_f32_32x32x16_bf16 v[64:79], v[32:35], v[16:19], 0
  v_mfma_f32_32x32x16_bf16 v[64:79], v[36:39], v[20:23], v[64:79]
  v_mfma_f32_32x32x16_bf16 v[80:95], v[32:35], v[24:27], 0
  v_mfma_f32_32x32x16_bf16 v[80:95], v[36:39], v[28:31], v[80:95]
  s_nop 11
  v_max3_f32 v12, v12, v64, v65
  v_max3_f32 v12, v12, v66, v67
  v_max3_f32 v12, v12, v68, v69
  v_max3_f32 v12, v12, v70, v71
  v_max3_f32 v12, v12, v72, v73
  v_max3_f32 v12, v12, v74, v75
  v_max3_f32 v12, v12, v76, v77
  v_max3_f32 v12, v12, v78, v79
  v_max3_f32 v13, v13, v80, v81
  v_max3_f32 v13, v13, v82, v83
  v_max3_f32 v13, v13, v84, v85
  v_max3_f32 v13, v13, v86, v87
  v_max3_f32 v13, v13, v88, v89
  v_max3_f32 v13, v13, v90, v91
  v_max3_f32 v13, v13, v92, v93
  v_max3_f32 v13, v13, v94, v95
  s_add_u32 s41, s41, 1
  s_cmp_lt_u32 s41, 64
  s_cbranch_scc1 kb2a_mx
  v_mov_b32 v5, v12
  s_nop 1
  v_permlane32_swap_b32 v12, v5
  v_max_f32 v12, v12, v5
  v_cvt_pk_bf16_f32 v5, v12, v12
  v_lshlrev_b32 v5, 16, v5
  v_xor_b32 v12, 0x80000000, v5
  v_mov_b32 v5, v13
  s_nop 1
  v_permlane32_swap_b32 v13, v5
  v_max_f32 v13, v13, v5
  v_cvt_pk_bf16_f32 v5, v13, v13
  v_lshlrev_b32 v5, 16, v5
  v_xor_b32 v13, 0x80000000, v5
  v_lshrrev_b32 v5, 16, v12
  v_and_b32 v6, 0xffff0000, v22
  v_or_b32 v5, v5, v6
  v_cndmask_b32 v22, v22, v5, s[34:35]
  v_lshrrev_b32 v5, 16, v13
  v_and_b32 v6, 0xffff0000, v30
  v_or_b32 v5, v5, v6
  v_cndmask_b32 v30, v30, v5, s[34:35]
  s_branch kb2a_main2
kb2a_fin:
  v_and_b32 v3, 31, v1
  v_lshrrev_b32 v4, 5, v1
  s_mul_i32 s30, s22, 20
  v_lshlrev_b32 v5, 2, v4
  v_add_u32 v5, 0, v5
  v_add_u32 v5, s30, v5
  v_lshrrev_b32 v6, 4, v5
  v_lshlrev_b32 v6, 10, v6
  v_bfe_u32 v7, v5, 3, 1
  v_lshlrev_b32 v7, 5, v7
  v_add_u32 v7, v7, v3
  v_lshlrev_b32 v7, 4, v7
  v_add_u32 v6, v6, v7
  v_bfe_u32 v7, v5, 2, 1
  v_lshlrev_b32 v7, 3, v7
  v_add_u32 v32, v6, v7
  v_lshlrev_b32 v5, 2, v4
  v_add_u32 v5, 8, v5
  v_add_u32 v5, s30, v5
  v_lshrrev_b32 v6, 4, v5
  v_lshlrev_b32 v6, 10, v6
  v_bfe_u32 v7, v5, 3, 1
  v_lshlrev_b32 v7, 5, v7
  v_add_u32 v7, v7, v3
  v_lshlrev_b32 v7, 4, v7
  v_add_u32 v6, v6, v7
  v_bfe_u32 v7, v5, 2, 1
  v_lshlrev_b32 v7, 3, v7
  v_add_u32 v33, v6, v7
  v_lshlrev_b32 v5, 2, v4
  v_add_u32 v5, 16, v5
  v_add_u32 v5, s30, v5
  v_lshrrev_b32 v6, 4, v5
  v_lshlrev_b32 v6, 10, v6
  v_bfe_u32 v7, v5, 3, 1
  v_lshlrev_b32 v7, 5, v7
  v_add_u32 v7, v7, v3
  v_lshlrev_b32 v7, 4, v7
  v_add_u32 v6, v6, v7
  v_bfe_u32 v7, v5, 2, 1
  v_lshlrev_b32 v7, 3, v7
  v_add_u32 v34, v6, v7
  v_mov_b32 v5, 0x40000000
  v_cndmask_b32 v34, v5, v34, s[34:35]
  v_rcp_f32 v5, v14
  s_nop 0
  v_mul_f32 v112, v112, v5
  v_mul_f32 v113, v113, v5
  v_mul_f32 v114, v114, v5
  v_mul_f32 v115, v115, v5
  v_mul_f32 v116, v116, v5
  v_mul_f32 v117, v117, v5
  v_mul_f32 v118, v118, v5
  v_mul_f32 v119, v119, v5
  v_mul_f32 v120, v120, v5
  v_mul_f32 v121, v121, v5
  v_mul_f32 v122, v122, v5
  v_mul_f32 v123, v123, v5
  v_cvt_pk_bf16_f32 v40, v112, v113
  v_cvt_pk_bf16_f32 v41, v114, v115
  v_cvt_pk_bf16_f32 v42, v116, v117
  v_cvt_pk_bf16_f32 v43, v118, v119
  v_cvt_pk_bf16_f32 v44, v120, v121
  v_cvt_pk_bf16_f32 v45, v122, v123
  s_add_u32 s31, s24, 0
  s_mul_i32 s31, s31, 40960
  s_add_u32 s31, s31, 0xf200000
  buffer_store_dwordx2 v[40:41], v32, s[8:11], s31 offen
  buffer_store_dwordx2 v[42:43], v33, s[8:11], s31 offen
  buffer_store_dwordx2 v[44:45], v34, s[8:11], s31 offen
  s_nop 1
  v_rcp_f32 v5, v15
  s_nop 0
  v_mul_f32 v128, v128, v5
  v_mul_f32 v129, v129, v5
  v_mul_f32 v130, v130, v5
  v_mul_f32 v131, v131, v5
  v_mul_f32 v132, v132, v5
  v_mul_f32 v133, v133, v5
  v_mul_f32 v134, v134, v5
  v_mul_f32 v135, v135, v5
  v_mul_f32 v136, v136, v5
  v_mul_f32 v137, v137, v5
  v_mul_f32 v138, v138, v5
  v_mul_f32 v139, v139, v5
  v_cvt_pk_bf16_f32 v40, v128, v129
  v_cvt_pk_bf16_f32 v41, v130, v131
  v_cvt_pk_bf16_f32 v42, v132, v133
  v_cvt_pk_bf16_f32 v43, v134, v135
  v_cvt_pk_bf16_f32 v44, v136, v137
  v_cvt_pk_bf16_f32 v45, v138, v139
  s_add_u32 s31, s24, 1
  s_mul_i32 s31, s31, 40960
  s_add_u32 s31, s31, 0xf200000
  buffer_store_dwordx2 v[40:41], v32, s[8:11], s31 offen
  buffer_store_dwordx2 v[42:43], v33, s[8:11], s31 offen
  buffer_store_dwordx2 v[44:45], v34, s[8:11], s31 offen
  s_nop 1
kb2a_exit:
  s_endpgm

.section .rodata,"a"
.p2align 6
.amdhsa_kernel att1_kernel
  .amdhsa_next_free_vgpr 256
  .amdhsa_next_free_sgpr 102
  .amdhsa_accum_offset 256
  .amdhsa_group_segment_fixed_size 0
  .amdhsa_kernarg_size 104
  .amdhsa_user_sgpr_count 2
  .amdhsa_user_sgpr_kernarg_segment_ptr 1
  .amdhsa_system_sgpr_workgroup_id_x 1
.end_amdhsa_kernel
.text
.globl out1_kernel
.p2align 8
.type out1_kernel,@function
out1_kernel:
  s_cmp_ge_u32 s2, 64
  s_cbranch_scc1 kb3a_exit
  s_load_dwordx2 s[36:37], s[0:1], 80
  s_load_dwordx2 s[4:5], s[0:1], 96
  v_lshrrev_b32 v1, 6, v0
  s_nop 0
  v_readfirstlane_b32 s21, v1
  v_and_b32 v1, 63, v0
  v_lshlrev_b32 v2, 4, v1
  s_waitcnt lgkmcnt(0)
  s_mov_b32 s8, s4
  s_and_b32 s9, s5, 0xffff
  s_mov_b32 s10, 0x10000000
  s_mov_b32 s11, 0x20000
  s_mov_b32 s12, s36
  s_and_b32 s13, s37, 0xffff
  s_mov_b32 s14, 0x280000
  s_mov_b32 s15, 0x20000
  s_mul_i32 s24, s2, 40960
  s_mul_i32 s25, s21, 10240
  s_add_u32 s26, s24, s25
  s_add_u32 s26, s26, 0xf200000
  s_add_u32 m0, s25, 0
  s_add_u32 s27, s26, 0
  buffer_load_dwordx4 v2, s[8:11], s27 offen lds
  s_add_u32 m0, s25, 1024
  s_add_u32 s27, s26, 1024
  buffer_load_dwordx4 v2, s[8:11], s27 offen lds
  s_add_u32 m0, s25, 2048
  s_add_u32 s27, s26, 2048
  buffer_load_dwordx4 v2, s[8:11], s27 offen lds
  s_add_u32 m0, s25, 3072
  s_add_u32 s27, s26, 3072
  buffer_load_dwordx4 v2, s[8:11], s27 offen lds
  s_add_u32 m0, s25, 4096
  s_add_u32 s27, s26, 4096
  buffer_load_dwordx4 v2, s[8:11], s27 offen lds
  s_add_u32 m0, s25, 5120
  s_add_u32 s27, s26, 5120
  buffer_load_dwordx4 v2, s[8:11], s27 offen lds
  s_add_u32 m0, s25, 6144
  s_add_u32 s27, s26, 6144
  buffer_load_dwordx4 v2, s[8:11], s27 offen lds
  s_add_u32 m0, s25, 7168
  s_add_u32 s27, s26, 7168
  buffer_load_dwordx4 v2, s[8:11], s27 offen lds
  s_add_u32 m0, s25, 8192
  s_add_u32 s27, s26, 8192
  buffer_load_dwordx4 v2, s[8:11], s27 offen lds
  s_add_u32 m0, s25, 9216
  s_add_u32 s27, s26, 9216
  buffer_load_dwordx4 v2, s[8:11], s27 offen lds
  s_mul_i32 s28, s21, 204800
  s_add_u32 s28, s28, 0xe000000
  s_add_u32 s29, s28, 0
  buffer_load_dwordx4 v[16:19], v2, s[8:11], s29 offen
  s_add_u32 s29, s28, 40960
  buffer_load_dwordx4 v[20:23], v2, s[8:11], s29 offen
  s_add_u32 s29, s28, 81920
  buffer_load_dwordx4 v[24:27], v2, s[8:11], s29 offen
  s_add_u32 s29, s28, 122880
  buffer_load_dwordx4 v[28:31], v2, s[8:11], s29 offen
  s_add_u32 s29, s28, 163840
  buffer_load_dwordx4 v[32:35], v2, s[8:11], s29 offen
  s_add_u32 s29, s28, 1024
  buffer_load_dwordx4 v[36:39], v2, s[8:11], s29 offen
  s_add_u32 s29, s28, 41984
  buffer_load_dwordx4 v[40:43], v2, s[8:11], s29 offen
  s_add_u32 s29, s28, 82944
  buffer_load_dwordx4 v[44:47], v2, s[8:11], s29 offen
  s_add_u32 s29, s28, 123904
  buffer_load_dwordx4 v[48:51], v2, s[8:11], s29 offen
  s_add_u32 s29, s28, 164864
  buffer_load_dwordx4 v[52:55], v2, s[8:11], s29 offen
  s_add_u32 s29, s28, 2048
  buffer_load_dwordx4 v[56:59], v2, s[8:11], s29 offen
  s_add_u32 s29, s28, 43008
  buffer_load_dwordx4 v[60:63], v2, s[8:11], s29 offen
  s_add_u32 s29, s28, 83968
  buffer_load_dwordx4 v[64:67], v2, s[8:11], s29 offen
  s_add_u32 s29, s28, 124928
  buffer_load_dwordx4 v[68:71], v2, s[8:11], s29 offen
  s_add_u32 s29, s28, 165888
  buffer_load_dwordx4 v[72:75], v2, s[8:11], s29 offen
  s_waitcnt vmcnt(15)
  s_barrier
  ds_read_b128 v[176:179], v2
  s_add_u32 s29, s28, 3072
  buffer_load_dwordx4 v[76:79], v2, s[8:11], s29 offen
  s_add_u32 s29, s28, 44032
  buffer_load_dwordx4 v[80:83], v2, s[8:11], s29 offen
  s_add_u32 s29, s28, 84992
  buffer_load_dwordx4 v[84:87], v2, s[8:11], s29 offen
  s_add_u32 s29, s28, 125952
  buffer_load_dwordx4 v[88:91], v2, s[8:11], s29 offen
  s_add_u32 s29, s28, 166912
  buffer_load_dwordx4 v[92:95], v2, s[8:11], s29 offen
  ds_read_b128 v[180:183], v2 offset:1024
  s_waitcnt lgkmcnt(1)
  s_waitcnt vmcnt(15)
  v_mfma_f32_32x32x16_bf16 v[96:111], v[16:19], v[176:179], 0
  v_mfma_f32_32x32x16_bf16 v[112:127], v[20:23], v[176:179], 0
  v_mfma_f32_32x32x16_bf16 v[128:143], v[24:27], v[176:179], 0
  v_mfma_f32_32x32x16_bf16 v[144:159], v[28:31], v[176:179], 0
  v_mfma_f32_32x32x16_bf16 v[160:175], v[32:35], v[176:179], 0
  s_add_u32 s29, s28, 4096
  buffer_load_dwordx4 v[16:19], v2, s[8:11], s29 offen
  s_add_u32 s29, s28, 45056
  buffer_load_dwordx4 v[20:23], v2, s[8:11], s29 offen
  s_add_u32 s29, s28, 86016
  buffer_load_dwordx4 v[24:27], v2, s[8:11], s29 offen
  s_add_u32 s29, s28, 126976
  buffer_load_dwordx4 v[28:31], v2, s[8:11], s29 offen
  s_add_u32 s29, s28, 167936
  buffer_load_dwordx4 v[32:35], v2, s[8:11], s29 offen
  ds_read_b128 v[176:179], v2 offset:2048
  s_waitcnt lgkmcnt(1)
  s_waitcnt vmcnt(15)
  v_mfma_f32_32x32x16_bf16 v[96:111], v[36:39], v[180:183], v[96:111]
  v_mfma_f32_32x32x16_bf16 v[112:127], v[40:43], v[180:183], v[112:127]
  v_mfma_f32_32x32x16_bf16 v[128:143], v[44:47], v[180:183], v[128:143]
  v_mfma_f32_32x32x16_bf16 v[144:159], v[48:51], v[180:183], v[144:159]
  v_mfma_f32_32x32x16_bf16 v[160:175], v[52:55], v[180:183], v[160:175]
  s_add_u32 s29, s28, 5120
  buffer_load_dwordx4 v[36:39], v2, s[8:11], s29 offen
  s_add_u32 s29, s28, 46080
  buffer_load_dwordx4 v[40:43], v2, s[8:11], s29 offen
  s_add_u32 s29, s28, 87040
  buffer_load_dwordx4 v[44:47], v2, s[8:11], s29 offen
  s_add_u32 s29, s28, 128000
  buffer_load_dwordx4 v[48:51], v2, s[8:11], s29 offen
  s_add_u32 s29, s28, 168960
  buffer_load_dwordx4 v[52:55], v2, s[8:11], s29 offen
  ds_read_b128 v[180:183], v2 offset:3072
  s_waitcnt lgkmcnt(1)
  s_waitcnt vmcnt(15)
  v_mfma_f32_32x32x16_bf16 v[96:111], v[56:59], v[176:179], v[96:111]
  v_mfma_f32_32x32x16_bf16 v[112:127], v[60:63], v[176:179], v[112:127]
  v_mfma_f32_32x32x16_bf16 v[128:143], v[64:67], v[176:179], v[128:143]
  v_mfma_f32_32x32x16_bf16 v[144:159], v[68:71], v[176:179], v[144:159]
  v_mfma_f32_32x32x16_bf16 v[160:175], v[72:75], v[176:179], v[160:175]
  s_add_u32 s29, s28, 6144
  buffer_load_dwordx4 v[56:59], v2, s[8:11], s29 offen
  s_add_u32 s29, s28, 47104
  buffer_load_dwordx4 v[60:63], v2, s[8:11], s29 offen
  s_add_u32 s29, s28, 88064
  buffer_load_dwordx4 v[64:67], v2, s[8:11], s29 offen
  s_add_u32 s29, s28, 129024
  buffer_load_dwordx4 v[68:71], v2, s[8:11], s29 offen
  s_add_u32 s29, s28, 169984
  buffer_load_dwordx4 v[72:75], v2, s[8:11], s29 offen
  ds_read_b128 v[176:179], v2 offset:4096
  s_waitcnt lgkmcnt(1)
  s_waitcnt vmcnt(15)
  v_mfma_f32_32x32x16_bf16 v[96:111], v[76:79], v[180:183], v[96:111]
  v_mfma_f32_32x32x16_bf16 v[112:127], v[80:83], v[180:183], v[112:127]
  v_mfma_f32_32x32x16_bf16 v[128:143], v[84:87], v[180:183], v[128:143]
  v_mfma_f32_32x32x16_bf16 v[144:159], v[88:91], v[180:183], v[144:159]
  v_mfma_f32_32x32x16_bf16 v[160:175], v[92:95], v[180:183], v[160:175]
  s_add_u32 s29, s28, 7168
  buffer_load_dwordx4 v[76:79], v2, s[8:11], s29 offen
  s_add_u32 s29, s28, 48128
  buffer_load_dwordx4 v[80:83], v2, s[8:11], s29 offen
  s_add_u32 s29, s28, 89088
  buffer_load_dwordx4 v[84:87], v2, s[8:11], s29 offen
  s_add_u32 s29, s28, 130048
  buffer_load_dwordx4 v[88:91], v2, s[8:11], s29 offen
  s_add_u32 s29, s28, 171008
  buffer_load_dwordx4 v[92:95], v2, s[8:11], s29 offen
  ds_read_b128 v[180:183], v2 offset:5120
  s_waitcnt lgkmcnt(1)
  s_waitcnt vmcnt(15)
  v_mfma_f32_32x32x16_bf16 v[96:111], v[16:19], v[176:179], v[96:111]
  v_mfma_f32_32x32x16_bf16 v[112:127], v[20:23], v[176:179], v[112:127]
  v_mfma_f32_32x32x16_bf16 v[128:143], v[24:27], v[176:179], v[128:143]
  v_mfma_f32_32x32x16_bf16 v[144:159], v[28:31], v[176:179], v[144:159]
  v_mfma_f32_32x32x16_bf16 v[160:175], v[32:35], v[176:179], v[160:175]
  s_add_u32 s29, s28, 8192
  buffer_load_dwordx4 v[16:19], v2, s[8:11], s29 offen
  s_add_u32 s29, s28, 49152
  buffer_load_dwordx4 v[20:23], v2, s[8:11], s29 offen
  s_add_u32 s29, s28, 90112
  buffer_load_dwordx4 v[24:27], v2, s[8:11], s29 offen
  s_add_u32 s29, s28, 131072
  buffer_load_dwordx4 v[28:31], v2, s[8:11], s29 offen
  s_add_u32 s29, s28, 172032
  buffer_load_dwordx4 v[32:35], v2, s[8:11], s29 offen
  ds_read_b128 v[176:179], v2 offset:6144
  s_waitcnt lgkmcnt(1)
  s_waitcnt vmcnt(15)
  v_mfma_f32_32x32x16_bf16 v[96:111], v[36:39], v[180:183], v[96:111]
  v_mfma_f32_32x32x16_bf16 v[112:127], v[40:43], v[180:183], v[112:127]
  v_mfma_f32_32x32x16_bf16 v[128:143], v[44:47], v[180:183], v[128:143]
  v_mfma_f32_32x32x16_bf16 v[144:159], v[48:51], v[180:183], v[144:159]
  v_mfma_f32_32x32x16_bf16 v[160:175], v[52:55], v[180:183], v[160:175]
  s_add_u32 s29, s28, 9216
  buffer_load_dwordx4 v[36:39], v2, s[8:11], s29 offen
  s_add_u32 s29, s28, 50176
  buffer_load_dwordx4 v[40:43], v2, s[8:11], s29 offen
  s_add_u32 s29, s28, 91136
  buffer_load_dwordx4 v[44:47], v2, s[8:11], s29 offen
  s_add_u32 s29, s28, 132096
  buffer_load_dwordx4 v[48:51], v2, s[8:11], s29 offen
  s_add_u32 s29, s28, 173056
  buffer_load_dwordx4 v[52:55], v2, s[8:11], s29 offen
  ds_read_b128 v[180:183], v2 offset:7168
  s_waitcnt lgkmcnt(1)
  s_waitcnt vmcnt(15)
  v_mfma_f32_32x32x16_bf16 v[96:111], v[56:59], v[176:179], v[96:111]
  v_mfma_f32_32x32x16_bf16 v[112:127], v[60:63], v[176:179], v[112:127]
  v_mfma_f32_32x32x16_bf16 v[128:143], v[64:67], v[176:179], v[128:143]
  v_mfma_f32_32x32x16_bf16 v[144:159], v[68:71], v[176:179], v[144:159]
  v_mfma_f32_32x32x16_bf16 v[160:175], v[72:75], v[176:179], v[160:175]
  s_add_u32 s29, s28, 10240
  buffer_load_dwordx4 v[56:59], v2, s[8:11], s29 offen
  s_add_u32 s29, s28, 51200
  buffer_load_dwordx4 v[60:63], v2, s[8:11], s29 offen
  s_add_u32 s29, s28, 92160
  buffer_load_dwordx4 v[64:67], v2, s[8:11], s29 offen
  s_add_u32 s29, s28, 133120
  buffer_load_dwordx4 v[68:71], v2, s[8:11], s29 offen
  s_add_u32 s29, s28, 174080
  buffer_load_dwordx4 v[72:75], v2, s[8:11], s29 offen
  ds_read_b128 v[176:179], v2 offset:8192
  s_waitcnt lgkmcnt(1)
  s_waitcnt vmcnt(15)
  v_mfma_f32_32x32x16_bf16 v[96:111], v[76:79], v[180:183], v[96:111]
  v_mfma_f32_32x32x16_bf16 v[112:127], v[80:83], v[180:183], v[112:127]
  v_mfma_f32_32x32x16_bf16 v[128:143], v[84:87], v[180:183], v[128:143]
  v_mfma_f32_32x32x16_bf16 v[144:159], v[88:91], v[180:183], v[144:159]
  v_mfma_f32_32x32x16_bf16 v[160:175], v[92:95], v[180:183], v[160:175]
  s_add_u32 s29, s28, 11264
  buffer_load_dwordx4 v[76:79], v2, s[8:11], s29 offen
  s_add_u32 s29, s28, 52224
  buffer_load_dwordx4 v[80:83], v2, s[8:11], s29 offen
  s_add_u32 s29, s28, 93184
  buffer_load_dwordx4 v[84:87], v2, s[8:11], s29 offen
  s_add_u32 s29, s28, 134144
  buffer_load_dwordx4 v[88:91], v2, s[8:11], s29 offen
  s_add_u32 s29, s28, 175104
  buffer_load_dwordx4 v[92:95], v2, s[8:11], s29 offen
  ds_read_b128 v[180:183], v2 offset:9216
  s_waitcnt lgkmcnt(1)
  s_waitcnt vmcnt(15)
  v_mfma_f32_32x32x16_bf16 v[96:111], v[16:19], v[176:179], v[96:111]
  v_mfma_f32_32x32x16_bf16 v[112:127], v[20:23], v[176:179], v[112:127]
  v_mfma_f32_32x32x16_bf16 v[128:143], v[24:27], v[176:179], v[128:143]
  v_mfma_f32_32x32x16_bf16 v[144:159], v[28:31], v[176:179], v[144:159]
  v_mfma_f32_32x32x16_bf16 v[160:175], v[32:35], v[176:179], v[160:175]
  s_add_u32 s29, s28, 12288
  buffer_load_dwordx4 v[16:19], v2, s[8:11], s29 offen
  s_add_u32 s29, s28, 53248
  buffer_load_dwordx4 v[20:23], v2, s[8:11], s29 offen
  s_add_u32 s29, s28, 94208
  buffer_load_dwordx4 v[24:27], v2, s[8:11], s29 offen
  s_add_u32 s29, s28, 135168
  buffer_load_dwordx4 v[28:31], v2, s[8:11], s29 offen
  s_add_u32 s29, s28, 176128
  buffer_load_dwordx4 v[32:35], v2, s[8:11], s29 offen
  ds_read_b128 v[176:179], v2 offset:10240
  s_waitcnt lgkmcnt(1)
  s_waitcnt vmcnt(15)
  v_mfma_f32_32x32x16_bf16 v[96:111], v[36:39], v[180:183], v[96:111]
  v_mfma_f32_32x32x16_bf16 v[112:127], v[40:43], v[180:183], v[112:127]
  v_mfma_f32_32x32x16_bf16 v[128:143], v[44:47], v[180:183], v[128:143]
  v_mfma_f32_32x32x16_bf16 v[144:159], v[48:51], v[180:183], v[144:159]
  v_mfma_f32_32x32x16_bf16 v[160:175], v[52:55], v[180:183], v[160:175]
  s_add_u32 s29, s28, 13312
  buffer_load_dwordx4 v[36:39], v2, s[8:11], s29 offen
  s_add_u32 s29, s28, 54272
  buffer_load_dwordx4 v[40:43], v2, s[8:11], s29 offen
  s_add_u32 s29, s28, 95232
  buffer_load_dwordx4 v[44:47], v2, s[8:11], s29 offen
  s_add_u32 s29, s28, 136192
  buffer_load_dwordx4 v[48:51], v2, s[8:11], s29 offen
  s_add_u32 s29, s28, 177152
  buffer_load_dwordx4 v[52:55], v2, s[8:11], s29 offen
  ds_read_b128 v[180:183], v2 offset:11264
  s_waitcnt lgkmcnt(1)
  s_waitcnt vmcnt(15)
  v_mfma_f32_32x32x16_bf16 v[96:111], v[56:59], v[176:179], v[96:111]
  v_mfma_f32_32x32x16_bf16 v[112:127], v[60:63], v[176:179], v[112:127]
  v_mfma_f32_32x32x16_bf16 v[128:143], v[64:67], v[176:179], v[128:143]
  v_mfma_f32_32x32x16_bf16 v[144:159], v[68:71], v[176:179], v[144:159]
  v_mfma_f32_32x32x16_bf16 v[160:175], v[72:75], v[176:179], v[160:175]
  s_add_u32 s29, s28, 14336
  buffer_load_dwordx4 v[56:59], v2, s[8:11], s29 offen
  s_add_u32 s29, s28, 55296
  buffer_load_dwordx4 v[60:63], v2, s[8:11], s29 offen
  s_add_u32 s29, s28, 96256
  buffer_load_dwordx4 v[64:67], v2, s[8:11], s29 offen
  s_add_u32 s29, s28, 137216
  buffer_load_dwordx4 v[68:71], v2, s[8:11], s29 offen
  s_add_u32 s29, s28, 178176
  buffer_load_dwordx4 v[72:75], v2, s[8:11], s29 offen
  ds_read_b128 v[176:179], v2 offset:12288
  s_waitcnt lgkmcnt(1)
  s_waitcnt vmcnt(15)
  v_mfma_f32_32x32x16_bf16 v[96:111], v[76:79], v[180:183], v[96:111]
  v_mfma_f32_32x32x16_bf16 v[112:127], v[80:83], v[180:183], v[112:127]
  v_mfma_f32_32x32x16_bf16 v[128:143], v[84:87], v[180:183], v[128:143]
  v_mfma_f32_32x32x16_bf16 v[144:159], v[88:91], v[180:183], v[144:159]
  v_mfma_f32_32x32x16_bf16 v[160:175], v[92:95], v[180:183], v[160:175]
  s_add_u32 s29, s28, 15360
  buffer_load_dwordx4 v[76:79], v2, s[8:11], s29 offen
  s_add_u32 s29, s28, 56320
  buffer_load_dwordx4 v[80:83], v2, s[8:11], s29 offen
  s_add_u32 s29, s28, 97280
  buffer_load_dwordx4 v[84:87], v2, s[8:11], s29 offen
  s_add_u32 s29, s28, 138240
  buffer_load_dwordx4 v[88:91], v2, s[8:11], s29 offen
  s_add_u32 s29, s28, 179200
  buffer_load_dwordx4 v[92:95], v2, s[8:11], s29 offen
  ds_read_b128 v[180:183], v2 offset:13312
  s_waitcnt lgkmcnt(1)
  s_waitcnt vmcnt(15)
  v_mfma_f32_32x32x16_bf16 v[96:111], v[16:19], v[176:179], v[96:111]
  v_mfma_f32_32x32x16_bf16 v[112:127], v[20:23], v[176:179], v[112:127]
  v_mfma_f32_32x32x16_bf16 v[128:143], v[24:27], v[176:179], v[128:143]
  v_mfma_f32_32x32x16_bf16 v[144:159], v[28:31], v[176:179], v[144:159]
  v_mfma_f32_32x32x16_bf16 v[160:175], v[32:35], v[176:179], v[160:175]
  s_add_u32 s29, s28, 16384
  buffer_load_dwordx4 v[16:19], v2, s[8:11], s29 offen
  s_add_u32 s29, s28, 57344
  buffer_load_dwordx4 v[20:23], v2, s[8:11], s29 offen
  s_add_u32 s29, s28, 98304
  buffer_load_dwordx4 v[24:27], v2, s[8:11], s29 offen
  s_add_u32 s29, s28, 139264
  buffer_load_dwordx4 v[28:31], v2, s[8:11], s29 offen
  s_add_u32 s29, s28, 180224
  buffer_load_dwordx4 v[32:35], v2, s[8:11], s29 offen
  ds_read_b128 v[176:179], v2 offset:14336
  s_waitcnt lgkmcnt(1)
  s_waitcnt vmcnt(15)
  v_mfma_f32_32x32x16_bf16 v[96:111], v[36:39], v[180:183], v[96:111]
  v_mfma_f32_32x32x16_bf16 v[112:127], v[40:43], v[180:183], v[112:127]
  v_mfma_f32_32x32x16_bf16 v[128:143], v[44:47], v[180:183], v[128:143]
  v_mfma_f32_32x32x16_bf16 v[144:159], v[48:51], v[180:183], v[144:159]
  v_mfma_f32_32x32x16_bf16 v[160:175], v[52:55], v[180:183], v[160:175]
  s_add_u32 s29, s28, 17408
  buffer_load_dwordx4 v[36:39], v2, s[8:11], s29 offen
  s_add_u32 s29, s28, 58368
  buffer_load_dwordx4 v[40:43], v2, s[8:11], s29 offen
  s_add_u32 s29, s28, 99328
  buffer_load_dwordx4 v[44:47], v2, s[8:11], s29 offen
  s_add_u32 s29, s28, 140288
  buffer_load_dwordx4 v[48:51], v2, s[8:11], s29 offen
  s_add_u32 s29, s28, 181248
  buffer_load_dwordx4 v[52:55], v2, s[8:11], s29 offen
  ds_read_b128 v[180:183], v2 offset:15360
  s_waitcnt lgkmcnt(1)
  s_waitcnt vmcnt(15)
  v_mfma_f32_32x32x16_bf16 v[96:111], v[56:59], v[176:179], v[96:111]
  v_mfma_f32_32x32x16_bf16 v[112:127], v[60:63], v[176:179], v[112:127]
  v_mfma_f32_32x32x16_bf16 v[128:143], v[64:67], v[176:179], v[128:143]
  v_mfma_f32_32x32x16_bf16 v[144:159], v[68:71], v[176:179], v[144:159]
  v_mfma_f32_32x32x16_bf16 v[160:175], v[72:75], v[176:179], v[160:175]
  s_add_u32 s29, s28, 18432
  buffer_load_dwordx4 v[56:59], v2, s[8:11], s29 offen
  s_add_u32 s29, s28, 59392
  buffer_load_dwordx4 v[60:63], v2, s[8:11], s29 offen
  s_add_u32 s29, s28, 100352
  buffer_load_dwordx4 v[64:67], v2, s[8:11], s29 offen
  s_add_u32 s29, s28, 141312
  buffer_load_dwordx4 v[68:71], v2, s[8:11], s29 offen
  s_add_u32 s29, s28, 182272
  buffer_load_dwordx4 v[72:75], v2, s[8:11], s29 offen
  ds_read_b128 v[176:179], v2 offset:16384
  s_waitcnt lgkmcnt(1)
  s_waitcnt vmcnt(15)
  v_mfma_f32_32x32x16_bf16 v[96:111], v[76:79], v[180:183], v[96:111]
  v_mfma_f32_32x32x16_bf16 v[112:127], v[80:83], v[180:183], v[112:127]
  v_mfma_f32_32x32x16_bf16 v[128:143], v[84:87], v[180:183], v[128:143]
  v_mfma_f32_32x32x16_bf16 v[144:159], v[88:91], v[180:183], v[144:159]
  v_mfma_f32_32x32x16_bf16 v[160:175], v[92:95], v[180:183], v[160:175]
  s_add_u32 s29, s28, 19456
  buffer_load_dwordx4 v[76:79], v2, s[8:11], s29 offen
  s_add_u32 s29, s28, 60416
  buffer_load_dwordx4 v[80:83], v2, s[8:11], s29 offen
  s_add_u32 s29, s28, 101376
  buffer_load_dwordx4 v[84:87], v2, s[8:11], s29 offen
  s_add_u32 s29, s28, 142336
  buffer_load_dwordx4 v[88:91], v2, s[8:11], s29 offen
  s_add_u32 s29, s28, 183296
  buffer_load_dwordx4 v[92:95], v2, s[8:11], s29 offen
  ds_read_b128 v[180:183], v2 offset:17408
  s_waitcnt lgkmcnt(1)
  s_waitcnt vmcnt(15)
  v_mfma_f32_32x32x16_bf16 v[96:111], v[16:19], v[176:179], v[96:111]
  v_mfma_f32_32x32x16_bf16 v[112:127], v[20:23], v[176:179], v[112:127]
  v_mfma_f32_32x32x16_bf16 v[128:143], v[24:27], v[176:179], v[128:143]
  v_mfma_f32_32x32x16_bf16 v[144:159], v[28:31], v[176:179], v[144:159]
  v_mfma_f32_32x32x16_bf16 v[160:175], v[32:35], v[176:179], v[160:175]
  s_add_u32 s29, s28, 20480
  buffer_load_dwordx4 v[16:19], v2, s[8:11], s29 offen
  s_add_u32 s29, s28, 61440
  buffer_load_dwordx4 v[20:23], v2, s[8:11], s29 offen
  s_add_u32 s29, s28, 102400
  buffer_load_dwordx4 v[24:27], v2, s[8:11], s29 offen
  s_add_u32 s29, s28, 143360
  buffer_load_dwordx4 v[28:31], v2, s[8:11], s29 offen
  s_add_u32 s29, s28, 184320
  buffer_load_dwordx4 v[32:35], v2, s[8:11], s29 offen
  ds_read_b128 v[176:179], v2 offset:18432
  s_waitcnt lgkmcnt(1)
  s_waitcnt vmcnt(15)
  v_mfma_f32_32x32x16_bf16 v[96:111], v[36:39], v[180:183], v[96:111]
  v_mfma_f32_32x32x16_bf16 v[112:127], v[40:43], v[180:183], v[112:127]
  v_mfma_f32_32x32x16_bf16 v[128:143], v[44:47], v[180:183], v[128:143]
  v_mfma_f32_32x32x16_bf16 v[144:159], v[48:51], v[180:183], v[144:159]
  v_mfma_f32_32x32x16_bf16 v[160:175], v[52:55], v[180:183], v[160:175]
  s_add_u32 s29, s28, 21504
  buffer_load_dwordx4 v[36:39], v2, s[8:11], s29 offen
  s_add_u32 s29, s28, 62464
  buffer_load_dwordx4 v[40:43], v2, s[8:11], s29 offen
  s_add_u32 s29, s28, 103424
  buffer_load_dwordx4 v[44:47], v2, s[8:11], s29 offen
  s_add_u32 s29, s28, 144384
  buffer_load_dwordx4 v[48:51], v2, s[8:11], s29 offen
  s_add_u32 s29, s28, 185344
  buffer_load_dwordx4 v[52:55], v2, s[8:11], s29 offen
  ds_read_b128 v[180:183], v2 offset:19456
  s_waitcnt lgkmcnt(1)
  s_waitcnt vmcnt(15)
  v_mfma_f32_32x32x16_bf16 v[96:111], v[56:59], v[176:179], v[96:111]
  v_mfma_f32_32x32x16_bf16 v[112:127], v[60:63], v[176:179], v[112:127]
  v_mfma_f32_32x32x16_bf16 v[128:143], v[64:67], v[176:179], v[128:143]
  v_mfma_f32_32x32x16_bf16 v[144:159], v[68:71], v[176:179], v[144:159]
  v_mfma_f32_32x32x16_bf16 v[160:175], v[72:75], v[176:179], v[160:175]
  s_add_u32 s29, s28, 22528
  buffer_load_dwordx4 v[56:59], v2, s[8:11], s29 offen
  s_add_u32 s29, s28, 63488
  buffer_load_dwordx4 v[60:63], v2, s[8:11], s29 offen
  s_add_u32 s29, s28, 104448
  buffer_load_dwordx4 v[64:67], v2, s[8:11], s29 offen
  s_add_u32 s29, s28, 145408
  buffer_load_dwordx4 v[68:71], v2, s[8:11], s29 offen
  s_add_u32 s29, s28, 186368
  buffer_load_dwordx4 v[72:75], v2, s[8:11], s29 offen
  ds_read_b128 v[176:179], v2 offset:20480
  s_waitcnt lgkmcnt(1)
  s_waitcnt vmcnt(15)
  v_mfma_f32_32x32x16_bf16 v[96:111], v[76:79], v[180:183], v[96:111]
  v_mfma_f32_32x32x16_bf16 v[112:127], v[80:83], v[180:183], v[112:127]
  v_mfma_f32_32x32x16_bf16 v[128:143], v[84:87], v[180:183], v[128:143]
  v_mfma_f32_32x32x16_bf16 v[144:159], v[88:91], v[180:183], v[144:159]
  v_mfma_f32_32x32x16_bf16 v[160:175], v[92:95], v[180:183], v[160:175]
  s_add_u32 s29, s28, 23552
  buffer_load_dwordx4 v[76:79], v2, s[8:11], s29 offen
  s_add_u32 s29, s28, 64512
  buffer_load_dwordx4 v[80:83], v2, s[8:11], s29 offen
  s_add_u32 s29, s28, 105472
  buffer_load_dwordx4 v[84:87], v2, s[8:11], s29 offen
  s_add_u32 s29, s28, 146432
  buffer_load_dwordx4 v[88:91], v2, s[8:11], s29 offen
  s_add_u32 s29, s28, 187392
  buffer_load_dwordx4 v[92:95], v2, s[8:11], s29 offen
  ds_read_b128 v[180:183], v2 offset:21504
  s_waitcnt lgkmcnt(1)
  s_waitcnt vmcnt(15)
  v_mfma_f32_32x32x16_bf16 v[96:111], v[16:19], v[176:179], v[96:111]
  v_mfma_f32_32x32x16_bf16 v[112:127], v[20:23], v[176:179], v[112:127]
  v_mfma_f32_32x32x16_bf16 v[128:143], v[24:27], v[176:179], v[128:143]
  v_mfma_f32_32x32x16_bf16 v[144:159], v[28:31], v[176:179], v[144:159]
  v_mfma_f32_32x32x16_bf16 v[160:175], v[32:35], v[176:179], v[160:175]
  s_add_u32 s29, s28, 24576
  buffer_load_dwordx4 v[16:19], v2, s[8:11], s29 offen
  s_add_u32 s29, s28, 65536
  buffer_load_dwordx4 v[20:23], v2, s[8:11], s29 offen
  s_add_u32 s29, s28, 106496
  buffer_load_dwordx4 v[24:27], v2, s[8:11], s29 offen
  s_add_u32 s29, s28, 147456
  buffer_load_dwordx4 v[28:31], v2, s[8:11], s29 offen
  s_add_u32 s29, s28, 188416
  buffer_load_dwordx4 v[32:35], v2, s[8:11], s29 offen
  ds_read_b128 v[176:179], v2 offset:22528
  s_waitcnt lgkmcnt(1)
  s_waitcnt vmcnt(15)
  v_mfma_f32_32x32x16_bf16 v[96:111], v[36:39], v[180:183], v[96:111]
  v_mfma_f32_32x32x16_bf16 v[112:127], v[40:43], v[180:183], v[112:127]
  v_mfma_f32_32x32x16_bf16 v[128:143], v[44:47], v[180:183], v[128:143]
  v_mfma_f32_32x32x16_bf16 v[144:159], v[48:51], v[180:183], v[144:159]
  v_mfma_f32_32x32x16_bf16 v[160:175], v[52:55], v[180:183], v[160:175]
  s_add_u32 s29, s28, 25600
  buffer_load_dwordx4 v[36:39], v2, s[8:11], s29 offen
  s_add_u32 s29, s28, 66560
  buffer_load_dwordx4 v[40:43], v2, s[8:11], s29 offen
  s_add_u32 s29, s28, 107520
  buffer_load_dwordx4 v[44:47], v2, s[8:11], s29 offen
  s_add_u32 s29, s28, 148480
  buffer_load_dwordx4 v[48:51], v2, s[8:11], s29 offen
  s_add_u32 s29, s28, 189440
  buffer_load_dwordx4 v[52:55], v2, s[8:11], s29 offen
  ds_read_b128 v[180:183], v2 offset:23552
  s_waitcnt lgkmcnt(1)
  s_waitcnt vmcnt(15)
  v_mfma_f32_32x32x16_bf16 v[96:111], v[56:59], v[176:179], v[96:111]
  v_mfma_f32_32x32x16_bf16 v[112:127], v[60:63], v[176:179], v[112:127]
  v_mfma_f32_32x32x16_bf16 v[128:143], v[64:67], v[176:179], v[128:143]
  v_mfma_f32_32x32x16_bf16 v[144:159], v[68:71], v[176:179], v[144:159]
  v_mfma_f32_32x32x16_bf16 v[160:175], v[72:75], v[176:179], v[160:175]
  s_add_u32 s29, s28, 26624
  buffer_load_dwordx4 v[56:59], v2, s[8:11], s29 offen
  s_add_u32 s29, s28, 67584
  buffer_load_dwordx4 v[60:63], v2, s[8:11], s29 offen
  s_add_u32 s29, s28, 108544
  buffer_load_dwordx4 v[64:67], v2, s[8:11], s29 offen
  s_add_u32 s29, s28, 149504
  buffer_load_dwordx4 v[68:71], v2, s[8:11], s29 offen
  s_add_u32 s29, s28, 190464
  buffer_load_dwordx4 v[72:75], v2, s[8:11], s29 offen
  ds_read_b128 v[176:179], v2 offset:24576
  s_waitcnt lgkmcnt(1)
  s_waitcnt vmcnt(15)
  v_mfma_f32_32x32x16_bf16 v[96:111], v[76:79], v[180:183], v[96:111]
  v_mfma_f32_32x32x16_bf16 v[112:127], v[80:83], v[180:183], v[112:127]
  v_mfma_f32_32x32x16_bf16 v[128:143], v[84:87], v[180:183], v[128:143]
  v_mfma_f32_32x32x16_bf16 v[144:159], v[88:91], v[180:183], v[144:159]
  v_mfma_f32_32x32x16_bf16 v[160:175], v[92:95], v[180:183], v[160:175]
  s_add_u32 s29, s28, 27648
  buffer_load_dwordx4 v[76:79], v2, s[8:11], s29 offen
  s_add_u32 s29, s28, 68608
  buffer_load_dwordx4 v[80:83], v2, s[8:11], s29 offen
  s_add_u32 s29, s28, 109568
  buffer_load_dwordx4 v[84:87], v2, s[8:11], s29 offen
  s_add_u32 s29, s28, 150528
  buffer_load_dwordx4 v[88:91], v2, s[8:11], s29 offen
  s_add_u32 s29, s28, 191488
  buffer_load_dwordx4 v[92:95], v2, s[8:11], s29 offen
  ds_read_b128 v[180:183], v2 offset:25600
  s_waitcnt lgkmcnt(1)
  s_waitcnt vmcnt(15)
  v_mfma_f32_32x32x16_bf16 v[96:111], v[16:19], v[176:179], v[96:111]
  v_mfma_f32_32x32x16_bf16 v[112:127], v[20:23], v[176:179], v[112:127]
  v_mfma_f32_32x32x16_bf16 v[128:143], v[24:27], v[176:179], v[128:143]
  v_mfma_f32_32x32x16_bf16 v[144:159], v[28:31], v[176:179], v[144:159]
  v_mfma_f32_32x32x16_bf16 v[160:175], v[32:35], v[176:179], v[160:175]
  s_add_u32 s29, s28, 28672
  buffer_load_dwordx4 v[16:19], v2, s[8:11], s29 offen
  s_add_u32 s29, s28, 69632
  buffer_load_dwordx4 v[20:23], v2, s[8:11], s29 offen
  s_add_u32 s29, s28, 110592
  buffer_load_dwordx4 v[24:27], v2, s[8:11], s29 offen
  s_add_u32 s29, s28, 151552
  buffer_load_dwordx4 v[28:31], v2, s[8:11], s29 offen
  s_add_u32 s29, s28, 192512
  buffer_load_dwordx4 v[32:35], v2, s[8:11], s29 offen
  ds_read_b128 v[176:179], v2 offset:26624
  s_waitcnt lgkmcnt(1)
  s_waitcnt vmcnt(15)
  v_mfma_f32_32x32x16_bf16 v[96:111], v[36:39], v[180:183], v[96:111]
  v_mfma_f32_32x32x16_bf16 v[112:127], v[40:43], v[180:183], v[112:127]
  v_mfma_f32_32x32x16_bf16 v[128:143], v[44:47], v[180:183], v[128:143]
  v_mfma_f32_32x32x16_bf16 v[144:159], v[48:51], v[180:183], v[144:159]
  v_mfma_f32_32x32x16_bf16 v[160:175], v[52:55], v[180:183], v[160:175]
  s_add_u32 s29, s28, 29696
  buffer_load_dwordx4 v[36:39], v2, s[8:11], s29 offen
  s_add_u32 s29, s28, 70656
  buffer_load_dwordx4 v[40:43], v2, s[8:11], s29 offen
  s_add_u32 s29, s28, 111616
  buffer_load_dwordx4 v[44:47], v2, s[8:11], s29 offen
  s_add_u32 s29, s28, 152576
  buffer_load_dwordx4 v[48:51], v2, s[8:11], s29 offen
  s_add_u32 s29, s28, 193536
  buffer_load_dwordx4 v[52:55], v2, s[8:11], s29 offen
  ds_read_b128 v[180:183], v2 offset:27648
  s_waitcnt lgkmcnt(1)
  s_waitcnt vmcnt(15)
  v_mfma_f32_32x32x16_bf16 v[96:111], v[56:59], v[176:179], v[96:111]
  v_mfma_f32_32x32x16_bf16 v[112:127], v[60:63], v[176:179], v[112:127]
  v_mfma_f32_32x32x16_bf16 v[128:143], v[64:67], v[176:179], v[128:143]
  v_mfma_f32_32x32x16_bf16 v[144:159], v[68:71], v[176:179], v[144:159]
  v_mfma_f32_32x32x16_bf16 v[160:175], v[72:75], v[176:179], v[160:175]
  s_add_u32 s29, s28, 30720
  buffer_load_dwordx4 v[56:59], v2, s[8:11], s29 offen
  s_add_u32 s29, s28, 71680
  buffer_load_dwordx4 v[60:63], v2, s[8:11], s29 offen
  s_add_u32 s29, s28, 112640
  buffer_load_dwordx4 v[64:67], v2, s[8:11], s29 offen
  s_add_u32 s29, s28, 153600
  buffer_load_dwordx4 v[68:71], v2, s[8:11], s29 offen
  s_add_u32 s29, s28, 194560
  buffer_load_dwordx4 v[72:75], v2, s[8:11], s29 offen
  ds_read_b128 v[176:179], v2 offset:28672
  s_waitcnt lgkmcnt(1)
  s_waitcnt vmcnt(15)
  v_mfma_f32_32x32x16_bf16 v[96:111], v[76:79], v[180:183], v[96:111]
  v_mfma_f32_32x32x16_bf16 v[112:127], v[80:83], v[180:183], v[112:127]
  v_mfma_f32_32x32x16_bf16 v[128:143], v[84:87], v[180:183], v[128:143]
  v_mfma_f32_32x32x16_bf16 v[144:159], v[88:91], v[180:183], v[144:159]
  v_mfma_f32_32x32x16_bf16 v[160:175], v[92:95], v[180:183], v[160:175]
  s_add_u32 s29, s28, 31744
  buffer_load_dwordx4 v[76:79], v2, s[8:11], s29 offen
  s_add_u32 s29, s28, 72704
  buffer_load_dwordx4 v[80:83], v2, s[8:11], s29 offen
  s_add_u32 s29, s28, 113664
  buffer_load_dwordx4 v[84:87], v2, s[8:11], s29 offen
  s_add_u32 s29, s28, 154624
  buffer_load_dwordx4 v[88:91], v2, s[8:11], s29 offen
  s_add_u32 s29, s28, 195584
  buffer_load_dwordx4 v[92:95], v2, s[8:11], s29 offen
  ds_read_b128 v[180:183], v2 offset:29696
  s_waitcnt lgkmcnt(1)
  s_waitcnt vmcnt(15)
  v_mfma_f32_32x32x16_bf16 v[96:111], v[16:19], v[176:179], v[96:111]
  v_mfma_f32_32x32x16_bf16 v[112:127], v[20:23], v[176:179], v[112:127]
  v_mfma_f32_32x32x16_bf16 v[128:143], v[24:27], v[176:179], v[128:143]
  v_mfma_f32_32x32x16_bf16 v[144:159], v[28:31], v[176:179], v[144:159]
  v_mfma_f32_32x32x16_bf16 v[160:175], v[32:35], v[176:179], v[160:175]
  s_add_u32 s29, s28, 32768
  buffer_load_dwordx4 v[16:19], v2, s[8:11], s29 offen
  s_add_u32 s29, s28, 73728
  buffer_load_dwordx4 v[20:23], v2, s[8:11], s29 offen
  s_add_u32 s29, s28, 114688
  buffer_load_dwordx4 v[24:27], v2, s[8:11], s29 offen
  s_add_u32 s29, s28, 155648
  buffer_load_dwordx4 v[28:31], v2, s[8:11], s29 offen
  s_add_u32 s29, s28, 196608
  buffer_load_dwordx4 v[32:35], v2, s[8:11], s29 offen
  ds_read_b128 v[176:179], v2 offset:30720
  s_waitcnt lgkmcnt(1)
  s_waitcnt vmcnt(15)
  v_mfma_f32_32x32x16_bf16 v[96:111], v[36:39], v[180:183], v[96:111]
  v_mfma_f32_32x32x16_bf16 v[112:127], v[40:43], v[180:183], v[112:127]
  v_mfma_f32_32x32x16_bf16 v[128:143], v[44:47], v[180:183], v[128:143]
  v_mfma_f32_32x32x16_bf16 v[144:159], v[48:51], v[180:183], v[144:159]
  v_mfma_f32_32x32x16_bf16 v[160:175], v[52:55], v[180:183], v[160:175]
  s_add_u32 s29, s28, 33792
  buffer_load_dwordx4 v[36:39], v2, s[8:11], s29 offen
  s_add_u32 s29, s28, 74752
  buffer_load_dwordx4 v[40:43], v2, s[8:11], s29 offen
  s_add_u32 s29, s28, 115712
  buffer_load_dwordx4 v[44:47], v2, s[8:11], s29 offen
  s_add_u32 s29, s28, 156672
  buffer_load_dwordx4 v[48:51], v2, s[8:11], s29 offen
  s_add_u32 s29, s28, 197632
  buffer_load_dwordx4 v[52:55], v2, s[8:11], s29 offen
  ds_read_b128 v[180:183], v2 offset:31744
  s_waitcnt lgkmcnt(1)
  s_waitcnt vmcnt(15)
  v_mfma_f32_32x32x16_bf16 v[96:111], v[56:59], v[176:179], v[96:111]
  v_mfma_f32_32x32x16_bf16 v[112:127], v[60:63], v[176:179], v[112:127]
  v_mfma_f32_32x32x16_bf16 v[128:143], v[64:67], v[176:179], v[128:143]
  v_mfma_f32_32x32x16_bf16 v[144:159], v[68:71], v[176:179], v[144:159]
  v_mfma_f32_32x32x16_bf16 v[160:175], v[72:75], v[176:179], v[160:175]
  s_add_u32 s29, s28, 34816
  buffer_load_dwordx4 v[56:59], v2, s[8:11], s29 offen
  s_add_u32 s29, s28, 75776
  buffer_load_dwordx4 v[60:63], v2, s[8:11], s29 offen
  s_add_u32 s29, s28, 116736
  buffer_load_dwordx4 v[64:67], v2, s[8:11], s29 offen
  s_add_u32 s29, s28, 157696
  buffer_load_dwordx4 v[68:71], v2, s[8:11], s29 offen
  s_add_u32 s29, s28, 198656
  buffer_load_dwordx4 v[72:75], v2, s[8:11], s29 offen
  ds_read_b128 v[176:179], v2 offset:32768
  s_waitcnt lgkmcnt(1)
  s_waitcnt vmcnt(15)
  v_mfma_f32_32x32x16_bf16 v[96:111], v[76:79], v[180:183], v[96:111]
  v_mfma_f32_32x32x16_bf16 v[112:127], v[80:83], v[180:183], v[112:127]
  v_mfma_f32_32x32x16_bf16 v[128:143], v[84:87], v[180:183], v[128:143]
  v_mfma_f32_32x32x16_bf16 v[144:159], v[88:91], v[180:183], v[144:159]
  v_mfma_f32_32x32x16_bf16 v[160:175], v[92:95], v[180:183], v[160:175]
  s_add_u32 s29, s28, 35840
  buffer_load_dwordx4 v[76:79], v2, s[8:11], s29 offen
  s_add_u32 s29, s28, 76800
  buffer_load_dwordx4 v[80:83], v2, s[8:11], s29 offen
  s_add_u32 s29, s28, 117760
  buffer_load_dwordx4 v[84:87], v2, s[8:11], s29 offen
  s_add_u32 s29, s28, 158720
  buffer_load_dwordx4 v[88:91], v2, s[8:11], s29 offen
  s_add_u32 s29, s28, 199680
  buffer_load_dwordx4 v[92:95], v2, s[8:11], s29 offen
  ds_read_b128 v[180:183], v2 offset:33792
  s_waitcnt lgkmcnt(1)
  s_waitcnt vmcnt(15)
  v_mfma_f32_32x32x16_bf16 v[96:111], v[16:19], v[176:179], v[96:111]
  v_mfma_f32_32x32x16_bf16 v[112:127], v[20:23], v[176:179], v[112:127]
  v_mfma_f32_32x32x16_bf16 v[128:143], v[24:27], v[176:179], v[128:143]
  v_mfma_f32_32x32x16_bf16 v[144:159], v[28:31], v[176:179], v[144:159]
  v_mfma_f32_32x32x16_bf16 v[160:175], v[32:35], v[176:179], v[160:175]
  s_add_u32 s29, s28, 36864
  buffer_load_dwordx4 v[16:19], v2, s[8:11], s29 offen
  s_add_u32 s29, s28, 77824
  buffer_load_dwordx4 v[20:23], v2, s[8:11], s29 offen
  s_add_u32 s29, s28, 118784
  buffer_load_dwordx4 v[24:27], v2, s[8:11], s29 offen
  s_add_u32 s29, s28, 159744
  buffer_load_dwordx4 v[28:31], v2, s[8:11], s29 offen
  s_add_u32 s29, s28, 200704
  buffer_load_dwordx4 v[32:35], v2, s[8:11], s29 offen
  ds_read_b128 v[176:179], v2 offset:34816
  s_waitcnt lgkmcnt(1)
  s_waitcnt vmcnt(15)
  v_mfma_f32_32x32x16_bf16 v[96:111], v[36:39], v[180:183], v[96:111]
  v_mfma_f32_32x32x16_bf16 v[112:127], v[40:43], v[180:183], v[112:127]
  v_mfma_f32_32x32x16_bf16 v[128:143], v[44:47], v[180:183], v[128:143]
  v_mfma_f32_32x32x16_bf16 v[144:159], v[48:51], v[180:183], v[144:159]
  v_mfma_f32_32x32x16_bf16 v[160:175], v[52:55], v[180:183], v[160:175]
  s_add_u32 s29, s28, 37888
  buffer_load_dwordx4 v[36:39], v2, s[8:11], s29 offen
  s_add_u32 s29, s28, 78848
  buffer_load_dwordx4 v[40:43], v2, s[8:11], s29 offen
  s_add_u32 s29, s28, 119808
  buffer_load_dwordx4 v[44:47], v2, s[8:11], s29 offen
  s_add_u32 s29, s28, 160768
  buffer_load_dwordx4 v[48:51], v2, s[8:11], s29 offen
  s_add_u32 s29, s28, 201728
  buffer_load_dwordx4 v[52:55], v2, s[8:11], s29 offen
  ds_read_b128 v[180:183], v2 offset:35840
  s_waitcnt lgkmcnt(1)
  s_waitcnt vmcnt(15)
  v_mfma_f32_32x32x16_bf16 v[96:111], v[56:59], v[176:179], v[96:111]
  v_mfma_f32_32x32x16_bf16 v[112:127], v[60:63], v[176:179], v[112:127]
  v_mfma_f32_32x32x16_bf16 v[128:143], v[64:67], v[176:179], v[128:143]
  v_mfma_f32_32x32x16_bf16 v[144:159], v[68:71], v[176:179], v[144:159]
  v_mfma_f32_32x32x16_bf16 v[160:175], v[72:75], v[176:179], v[160:175]
  s_add_u32 s29, s28, 38912
  buffer_load_dwordx4 v[56:59], v2, s[8:11], s29 offen
  s_add_u32 s29, s28, 79872
  buffer_load_dwordx4 v[60:63], v2, s[8:11], s29 offen
  s_add_u32 s29, s28, 120832
  buffer_load_dwordx4 v[64:67], v2, s[8:11], s29 offen
  s_add_u32 s29, s28, 161792
  buffer_load_dwordx4 v[68:71], v2, s[8:11], s29 offen
  s_add_u32 s29, s28, 202752
  buffer_load_dwordx4 v[72:75], v2, s[8:11], s29 offen
  ds_read_b128 v[176:179], v2 offset:36864
  s_waitcnt lgkmcnt(1)
  s_waitcnt vmcnt(15)
  v_mfma_f32_32x32x16_bf16 v[96:111], v[76:79], v[180:183], v[96:111]
  v_mfma_f32_32x32x16_bf16 v[112:127], v[80:83], v[180:183], v[112:127]
  v_mfma_f32_32x32x16_bf16 v[128:143], v[84:87], v[180:183], v[128:143]
  v_mfma_f32_32x32x16_bf16 v[144:159], v[88:91], v[180:183], v[144:159]
  v_mfma_f32_32x32x16_bf16 v[160:175], v[92:95], v[180:183], v[160:175]
  s_add_u32 s29, s28, 39936
  buffer_load_dwordx4 v[76:79], v2, s[8:11], s29 offen
  s_add_u32 s29, s28, 80896
  buffer_load_dwordx4 v[80:83], v2, s[8:11], s29 offen
  s_add_u32 s29, s28, 121856
  buffer_load_dwordx4 v[84:87], v2, s[8:11], s29 offen
  s_add_u32 s29, s28, 162816
  buffer_load_dwordx4 v[88:91], v2, s[8:11], s29 offen
  s_add_u32 s29, s28, 203776
  buffer_load_dwordx4 v[92:95], v2, s[8:11], s29 offen
  ds_read_b128 v[180:183], v2 offset:37888
  s_waitcnt lgkmcnt(1)
  s_waitcnt vmcnt(15)
  v_mfma_f32_32x32x16_bf16 v[96:111], v[16:19], v[176:179], v[96:111]
  v_mfma_f32_32x32x16_bf16 v[112:127], v[20:23], v[176:179], v[112:127]
  v_mfma_f32_32x32x16_bf16 v[128:143], v[24:27], v[176:179], v[128:143]
  v_mfma_f32_32x32x16_bf16 v[144:159], v[28:31], v[176:179], v[144:159]
  v_mfma_f32_32x32x16_bf16 v[160:175], v[32:35], v[176:179], v[160:175]
  ds_read_b128 v[176:179], v2 offset:38912
  s_waitcnt lgkmcnt(1)
  s_waitcnt vmcnt(10)
  v_mfma_f32_32x32x16_bf16 v[96:111], v[36:39], v[180:183], v[96:111]
  v_mfma_f32_32x32x16_bf16 v[112:127], v[40:43], v[180:183], v[112:127]
  v_mfma_f32_32x32x16_bf16 v[128:143], v[44:47], v[180:183], v[128:143]
  v_mfma_f32_32x32x16_bf16 v[144:159], v[48:51], v[180:183], v[144:159]
  v_mfma_f32_32x32x16_bf16 v[160:175], v[52:55], v[180:183], v[160:175]
  ds_read_b128 v[180:183], v2 offset:39936
  s_waitcnt lgkmcnt(1)
  s_waitcnt vmcnt(5)
  v_mfma_f32_32x32x16_bf16 v[96:111], v[56:59], v[176:179], v[96:111]
  v_mfma_f32_32x32x16_bf16 v[112:127], v[60:63], v[176:179], v[112:127]
  v_mfma_f32_32x32x16_bf16 v[128:143], v[64:67], v[176:179], v[128:143]
  v_mfma_f32_32x32x16_bf16 v[144:159], v[68:71], v[176:179], v[144:159]
  v_mfma_f32_32x32x16_bf16 v[160:175], v[72:75], v[176:179], v[160:175]
  s_waitcnt lgkmcnt(0)
  s_waitcnt vmcnt(0)
  v_mfma_f32_32x32x16_bf16 v[96:111], v[76:79], v[180:183], v[96:111]
  v_mfma_f32_32x32x16_bf16 v[112:127], v[80:83], v[180:183], v[112:127]
  v_mfma_f32_32x32x16_bf16 v[128:143], v[84:87], v[180:183], v[128:143]
  v_mfma_f32_32x32x16_bf16 v[144:159], v[88:91], v[180:183], v[144:159]
  v_mfma_f32_32x32x16_bf16 v[160:175], v[92:95], v[180:183], v[160:175]
  s_mul_i32 s24, s2, 81920
  s_mul_i32 s25, s21, 20480
  s_add_u32 s24, s24, s25
  s_add_u32 s24, s24, 0x1400000
  s_add_u32 s29, s24, 0
  buffer_load_dwordx4 v[16:19], v2, s[8:11], s29 offen
  s_add_u32 s29, s24, 1024
  buffer_load_dwordx4 v[20:23], v2, s[8:11], s29 offen
  s_add_u32 s29, s24, 2048
  buffer_load_dwordx4 v[24:27], v2, s[8:11], s29 offen
  s_add_u32 s29, s24, 3072
  buffer_load_dwordx4 v[28:31], v2, s[8:11], s29 offen
  s_add_u32 s29, s24, 4096
  buffer_load_dwordx4 v[32:35], v2, s[8:11], s29 offen
  s_add_u32 s29, s24, 5120
  buffer_load_dwordx4 v[36:39], v2, s[8:11], s29 offen
  s_add_u32 s29, s24, 6144
  buffer_load_dwordx4 v[40:43], v2, s[8:11], s29 offen
  s_add_u32 s29, s24, 7168
  buffer_load_dwordx4 v[44:47], v2, s[8:11], s29 offen
  s_add_u32 s29, s24, 8192
  buffer_load_dwordx4 v[48:51], v2, s[8:11], s29 offen
  s_add_u32 s29, s24, 9216
  buffer_load_dwordx4 v[52:55], v2, s[8:11], s29 offen
  s_add_u32 s29, s24, 10240
  buffer_load_dwordx4 v[56:59], v2, s[8:11], s29 offen
  s_add_u32 s29, s24, 11264
  buffer_load_dwordx4 v[60:63], v2, s[8:11], s29 offen
  s_add_u32 s29, s24, 12288
  buffer_load_dwordx4 v[64:67], v2, s[8:11], s29 offen
  s_add_u32 s29, s24, 13312
  buffer_load_dwordx4 v[68:71], v2, s[8:11], s29 offen
  s_add_u32 s29, s24, 14336
  buffer_load_dwordx4 v[72:75], v2, s[8:11], s29 offen
  s_add_u32 s29, s24, 15360
  buffer_load_dwordx4 v[76:79], v2, s[8:11], s29 offen
  s_add_u32 s29, s24, 16384
  buffer_load_dwordx4 v[80:83], v2, s[8:11], s29 offen
  s_add_u32 s29, s24, 17408
  buffer_load_dwordx4 v[84:87], v2, s[8:11], s29 offen
  s_add_u32 s29, s24, 18432
  buffer_load_dwordx4 v[88:91], v2, s[8:11], s29 offen
  s_add_u32 s29, s24, 19456
  buffer_load_dwordx4 v[92:95], v2, s[8:11], s29 offen
  s_waitcnt vmcnt(0)
  v_add_f32 v96, v96, v16
  v_add_f32 v97, v97, v17
  v_add_f32 v98, v98, v18
  v_add_f32 v99, v99, v19
  v_add_f32 v100, v100, v20
  v_add_f32 v101, v101, v21
  v_add_f32 v102, v102, v22
  v_add_f32 v103, v103, v23
  v_add_f32 v104, v104, v24
  v_add_f32 v105, v105, v25
  v_add_f32 v106, v106, v26
  v_add_f32 v107, v107, v27
  v_add_f32 v108, v108, v28
  v_add_f32 v109, v109, v29
  v_add_f32 v110, v110, v30
  v_add_f32 v111, v111, v31
  v_add_f32 v112, v112, v32
  v_add_f32 v113, v113, v33
  v_add_f32 v114, v114, v34
  v_add_f32 v115, v115, v35
  v_add_f32 v116, v116, v36
  v_add_f32 v117, v117, v37
  v_add_f32 v118, v118, v38
  v_add_f32 v119, v119, v39
  v_add_f32 v120, v120, v40
  v_add_f32 v121, v121, v41
  v_add_f32 v122, v122, v42
  v_add_f32 v123, v123, v43
  v_add_f32 v124, v124, v44
  v_add_f32 v125, v125, v45
  v_add_f32 v126, v126, v46
  v_add_f32 v127, v127, v47
  v_add_f32 v128, v128, v48
  v_add_f32 v129, v129, v49
  v_add_f32 v130, v130, v50
  v_add_f32 v131, v131, v51
  v_add_f32 v132, v132, v52
  v_add_f32 v133, v133, v53
  v_add_f32 v134, v134, v54
  v_add_f32 v135, v135, v55
  v_add_f32 v136, v136, v56
  v_add_f32 v137, v137, v57
  v_add_f32 v138, v138, v58
  v_add_f32 v139, v139, v59
  v_add_f32 v140, v140, v60
  v_add_f32 v141, v141, v61
  v_add_f32 v142, v142, v62
  v_add_f32 v143, v143, v63
  v_add_f32 v144, v144, v64
  v_add_f32 v145, v145, v65
  v_add_f32 v146, v146, v66
  v_add_f32 v147, v147, v67
  v_add_f32 v148, v148, v68
  v_add_f32 v149, v149, v69
  v_add_f32 v150, v150, v70
  v_add_f32 v151, v151, v71
  v_add_f32 v152, v152, v72
  v_add_f32 v153, v153, v73
  v_add_f32 v154, v154, v74
  v_add_f32 v155, v155, v75
  v_add_f32 v156, v156, v76
  v_add_f32 v157, v157, v77
  v_add_f32 v158, v158, v78
  v_add_f32 v159, v159, v79
  v_add_f32 v160, v160, v80
  v_add_f32 v161, v161, v81
  v_add_f32 v162, v162, v82
  v_add_f32 v163, v163, v83
  v_add_f32 v164, v164, v84
  v_add_f32 v165, v165, v85
  v_add_f32 v166, v166, v86
  v_add_f32 v167, v167, v87
  v_add_f32 v168, v168, v88
  v_add_f32 v169, v169, v89
  v_add_f32 v170, v170, v90
  v_add_f32 v171, v171, v91
  v_add_f32 v172, v172, v92
  v_add_f32 v173, v173, v93
  v_add_f32 v174, v174, v94
  v_add_f32 v175, v175, v95
  s_add_u32 s29, s24, 0
  buffer_store_dwordx4 v[96:99], v2, s[8:11], s29 offen
  s_add_u32 s29, s24, 1024
  buffer_store_dwordx4 v[100:103], v2, s[8:11], s29 offen
  s_add_u32 s29, s24, 2048
  buffer_store_dwordx4 v[104:107], v2, s[8:11], s29 offen
  s_add_u32 s29, s24, 3072
  buffer_store_dwordx4 v[108:111], v2, s[8:11], s29 offen
  s_add_u32 s29, s24, 4096
  buffer_store_dwordx4 v[112:115], v2, s[8:11], s29 offen
  s_add_u32 s29, s24, 5120
  buffer_store_dwordx4 v[116:119], v2, s[8:11], s29 offen
  s_add_u32 s29, s24, 6144
  buffer_store_dwordx4 v[120:123], v2, s[8:11], s29 offen
  s_add_u32 s29, s24, 7168
  buffer_store_dwordx4 v[124:127], v2, s[8:11], s29 offen
  s_add_u32 s29, s24, 8192
  buffer_store_dwordx4 v[128:131], v2, s[8:11], s29 offen
  s_add_u32 s29, s24, 9216
  buffer_store_dwordx4 v[132:135], v2, s[8:11], s29 offen
  s_add_u32 s29, s24, 10240
  buffer_store_dwordx4 v[136:139], v2, s[8:11], s29 offen
  s_add_u32 s29, s24, 11264
  buffer_store_dwordx4 v[140:143], v2, s[8:11], s29 offen
  s_add_u32 s29, s24, 12288
  buffer_store_dwordx4 v[144:147], v2, s[8:11], s29 offen
  s_add_u32 s29, s24, 13312
  buffer_store_dwordx4 v[148:151], v2, s[8:11], s29 offen
  s_add_u32 s29, s24, 14336
  buffer_store_dwordx4 v[152:155], v2, s[8:11], s29 offen
  s_add_u32 s29, s24, 15360
  buffer_store_dwordx4 v[156:159], v2, s[8:11], s29 offen
  s_add_u32 s29, s24, 16384
  buffer_store_dwordx4 v[160:163], v2, s[8:11], s29 offen
  s_add_u32 s29, s24, 17408
  buffer_store_dwordx4 v[164:167], v2, s[8:11], s29 offen
  s_add_u32 s29, s24, 18432
  buffer_store_dwordx4 v[168:171], v2, s[8:11], s29 offen
  s_add_u32 s29, s24, 19456
  buffer_store_dwordx4 v[172:175], v2, s[8:11], s29 offen
  v_add_f32 v3, v96, v97
  v_add_f32 v3, v3, v98
  v_add_f32 v3, v3, v99
  v_add_f32 v3, v3, v100
  v_add_f32 v3, v3, v101
  v_add_f32 v3, v3, v102
  v_add_f32 v3, v3, v103
  v_add_f32 v3, v3, v104
  v_add_f32 v3, v3, v105
  v_add_f32 v3, v3, v106
  v_add_f32 v3, v3, v107
  v_add_f32 v3, v3, v108
  v_add_f32 v3, v3, v109
  v_add_f32 v3, v3, v110
  v_add_f32 v3, v3, v111
  v_add_f32 v3, v3, v112
  v_add_f32 v3, v3, v113
  v_add_f32 v3, v3, v114
  v_add_f32 v3, v3, v115
  v_add_f32 v3, v3, v116
  v_add_f32 v3, v3, v117
  v_add_f32 v3, v3, v118
  v_add_f32 v3, v3, v119
  v_add_f32 v3, v3, v120
  v_add_f32 v3, v3, v121
  v_add_f32 v3, v3, v122
  v_add_f32 v3, v3, v123
  v_add_f32 v3, v3, v124
  v_add_f32 v3, v3, v125
  v_add_f32 v3, v3, v126
  v_add_f32 v3, v3, v127
  v_add_f32 v3, v3, v128
  v_add_f32 v3, v3, v129
  v_add_f32 v3, v3, v130
  v_add_f32 v3, v3, v131
  v_add_f32 v3, v3, v132
  v_add_f32 v3, v3, v133
  v_add_f32 v3, v3, v134
  v_add_f32 v3, v3, v135
  v_add_f32 v3, v3, v136
  v_add_f32 v3, v3, v137
  v_add_f32 v3, v3, v138
  v_add_f32 v3, v3, v139
  v_add_f32 v3, v3, v140
  v_add_f32 v3, v3, v141
  v_add_f32 v3, v3, v142
  v_add_f32 v3, v3, v143
  v_add_f32 v3, v3, v144
  v_add_f32 v3, v3, v145
  v_add_f32 v3, v3, v146
  v_add_f32 v3, v3, v147
  v_add_f32 v3, v3, v148
  v_add_f32 v3, v3, v149
  v_add_f32 v3, v3, v150
  v_add_f32 v3, v3, v151
  v_add_f32 v3, v3, v152
  v_add_f32 v3, v3, v153
  v_add_f32 v3, v3, v154
  v_add_f32 v3, v3, v155
  v_add_f32 v3, v3, v156
  v_add_f32 v3, v3, v157
  v_add_f32 v3, v3, v158
  v_add_f32 v3, v3, v159
  v_add_f32 v3, v3, v160
  v_add_f32 v3, v3, v161
  v_add_f32 v3, v3, v162
  v_add_f32 v3, v3, v163
  v_add_f32 v3, v3, v164
  v_add_f32 v3, v3, v165
  v_add_f32 v3, v3, v166
  v_add_f32 v3, v3, v167
  v_add_f32 v3, v3, v168
  v_add_f32 v3, v3, v169
  v_add_f32 v3, v3, v170
  v_add_f32 v3, v3, v171
  v_add_f32 v3, v3, v172
  v_add_f32 v3, v3, v173
  v_add_f32 v3, v3, v174
  v_add_f32 v3, v3, v175
  v_mov_b32 v4, v3
  s_nop 1
  v_permlane32_swap_b32 v3, v4
  v_add_f32 v3, v3, v4
  v_and_b32 v5, 31, v1
  v_lshlrev_b32 v5, 2, v5
  s_lshl_b32 s26, s21, 7
  v_add_u32 v6, s26, v5
  s_barrier
  ds_write_b32 v6, v3 offset:0
  s_waitcnt lgkmcnt(0)
  s_barrier
  ds_read_b32 v8, v5 offset:0
  ds_read_b32 v9, v5 offset:128
  ds_read_b32 v10, v5 offset:256
  ds_read_b32 v11, v5 offset:384
  s_waitcnt lgkmcnt(0)
  v_add_f32 v8, v8, v9
  v_add_f32 v10, v10, v11
  v_add_f32 v3, v8, v10
  v_mul_f32 v7, 0x3acccccd, v3
  v_sub_f32 v96, v96, v7
  v_sub_f32 v97, v97, v7
  v_sub_f32 v98, v98, v7
  v_sub_f32 v99, v99, v7
  v_sub_f32 v100, v100, v7
  v_sub_f32 v101, v101, v7
  v_sub_f32 v102, v102, v7
  v_sub_f32 v103, v103, v7
  v_sub_f32 v104, v104, v7
  v_sub_f32 v105, v105, v7
  v_sub_f32 v106, v106, v7
  v_sub_f32 v107, v107, v7
  v_sub_f32 v108, v108, v7
  v_sub_f32 v109, v109, v7
  v_sub_f32 v110, v110, v7
  v_sub_f32 v111, v111, v7
  v_sub_f32 v112, v112, v7
  v_sub_f32 v113, v113, v7
  v_sub_f32 v114, v114, v7
  v_sub_f32 v115, v115, v7
  v_sub_f32 v116, v116, v7
  v_sub_f32 v117, v117, v7
  v_sub_f32 v118, v118, v7
  v_sub_f32 v119, v119, v7
  v_sub_f32 v120, v120, v7
  v_sub_f32 v121, v121, v7
  v_sub_f32 v122, v122, v7
  v_sub_f32 v123, v123, v7
  v_sub_f32 v124, v124, v7
  v_sub_f32 v125, v125, v7
  v_sub_f32 v126, v126, v7
  v_sub_f32 v127, v127, v7
  v_sub_f32 v128, v128, v7
  v_sub_f32 v129, v129, v7
  v_sub_f32 v130, v130, v7
  v_sub_f32 v131, v131, v7
  v_sub_f32 v132, v132, v7
  v_sub_f32 v133, v133, v7
  v_sub_f32 v134, v134, v7
  v_sub_f32 v135, v135, v7
  v_sub_f32 v136, v136, v7
  v_sub_f32 v137, v137, v7
  v_sub_f32 v138, v138, v7
  v_sub_f32 v139, v139, v7
  v_sub_f32 v140, v140, v7
  v_sub_f32 v141, v141, v7
  v_sub_f32 v142, v142, v7
  v_sub_f32 v143, v143, v7
  v_sub_f32 v144, v144, v7
  v_sub_f32 v145, v145, v7
  v_sub_f32 v146, v146, v7
  v_sub_f32 v147, v147, v7
  v_sub_f32 v148, v148, v7
  v_sub_f32 v149, v149, v7
  v_sub_f32 v150, v150, v7
  v_sub_f32 v151, v151, v7
  v_sub_f32 v152, v152, v7
  v_sub_f32 v153, v153, v7
  v_sub_f32 v154, v154, v7
  v_sub_f32 v155, v155, v7
  v_sub_f32 v156, v156, v7
  v_sub_f32 v157, v157, v7
  v_sub_f32 v158, v158, v7
  v_sub_f32 v159, v159, v7
  v_sub_f32 v160, v160, v7
  v_sub_f32 v161, v161, v7
  v_sub_f32 v162, v162, v7
  v_sub_f32 v163, v163, v7
  v_sub_f32 v164, v164, v7
  v_sub_f32 v165, v165, v7
  v_sub_f32 v166, v166, v7
  v_sub_f32 v167, v167, v7
  v_sub_f32 v168, v168, v7
  v_sub_f32 v169, v169, v7
  v_sub_f32 v170, v170, v7
  v_sub_f32 v171, v171, v7
  v_sub_f32 v172, v172, v7
  v_sub_f32 v173, v173, v7
  v_sub_f32 v174, v174, v7
  v_sub_f32 v175, v175, v7
  v_mul_f32 v3, v96, v96
  v_fmac_f32 v3, v97, v97
  v_fmac_f32 v3, v98, v98
  v_fmac_f32 v3, v99, v99
  v_fmac_f32 v3, v100, v100
  v_fmac_f32 v3, v101, v101
  v_fmac_f32 v3, v102, v102
  v_fmac_f32 v3, v103, v103
  v_fmac_f32 v3, v104, v104
  v_fmac_f32 v3, v105, v105
  v_fmac_f32 v3, v106, v106
  v_fmac_f32 v3, v107, v107
  v_fmac_f32 v3, v108, v108
  v_fmac_f32 v3, v109, v109
  v_fmac_f32 v3, v110, v110
  v_fmac_f32 v3, v111, v111
  v_fmac_f32 v3, v112, v112
  v_fmac_f32 v3, v113, v113
  v_fmac_f32 v3, v114, v114
  v_fmac_f32 v3, v115, v115
  v_fmac_f32 v3, v116, v116
  v_fmac_f32 v3, v117, v117
  v_fmac_f32 v3, v118, v118
  v_fmac_f32 v3, v119, v119
  v_fmac_f32 v3, v120, v120
  v_fmac_f32 v3, v121, v121
  v_fmac_f32 v3, v122, v122
  v_fmac_f32 v3, v123, v123
  v_fmac_f32 v3, v124, v124
  v_fmac_f32 v3, v125, v125
  v_fmac_f32 v3, v126, v126
  v_fmac_f32 v3, v127, v127
  v_fmac_f32 v3, v128, v128
  v_fmac_f32 v3, v129, v129
  v_fmac_f32 v3, v130, v130
  v_fmac_f32 v3, v131, v131
  v_fmac_f32 v3, v132, v132
  v_fmac_f32 v3, v133, v133
  v_fmac_f32 v3, v134, v134
  v_fmac_f32 v3, v135, v135
  v_fmac_f32 v3, v136, v136
  v_fmac_f32 v3, v137, v137
  v_fmac_f32 v3, v138, v138
  v_fmac_f32 v3, v139, v139
  v_fmac_f32 v3, v140, v140
  v_fmac_f32 v3, v141, v141
  v_fmac_f32 v3, v142, v142
  v_fmac_f32 v3, v143, v143
  v_fmac_f32 v3, v144, v144
  v_fmac_f32 v3, v145, v145
  v_fmac_f32 v3, v146, v146
  v_fmac_f32 v3, v147, v147
  v_fmac_f32 v3, v148, v148
  v_fmac_f32 v3, v149, v149
  v_fmac_f32 v3, v150, v150
  v_fmac_f32 v3, v151, v151
  v_fmac_f32 v3, v152, v152
  v_fmac_f32 v3, v153, v153
  v_fmac_f32 v3, v154, v154
  v_fmac_f32 v3, v155, v155
  v_fmac_f32 v3, v156, v156
  v_fmac_f32 v3, v157, v157
  v_fmac_f32 v3, v158, v158
  v_fmac_f32 v3, v159, v159
  v_fmac_f32 v3, v160, v160
  v_fmac_f32 v3, v161, v161
  v_fmac_f32 v3, v162, v162
  v_fmac_f32 v3, v163, v163
  v_fmac_f32 v3, v164, v164
  v_fmac_f32 v3, v165, v165
  v_fmac_f32 v3, v166, v166
  v_fmac_f32 v3, v167, v167
  v_fmac_f32 v3, v168, v168
  v_fmac_f32 v3, v169, v169
  v_fmac_f32 v3, v170, v170
  v_fmac_f32 v3, v171, v171
  v_fmac_f32 v3, v172, v172
  v_fmac_f32 v3, v173, v173
  v_fmac_f32 v3, v174, v174
  v_fmac_f32 v3, v175, v175
  v_mov_b32 v4, v3
  s_nop 1
  v_permlane32_swap_b32 v3, v4
  v_add_f32 v3, v3, v4
  v_and_b32 v5, 31, v1
  v_lshlrev_b32 v5, 2, v5
  s_lshl_b32 s26, s21, 7
  v_add_u32 v6, s26, v5
  s_barrier
  ds_write_b32 v6, v3 offset:1024
  s_waitcnt lgkmcnt(0)
  s_barrier
  ds_read_b32 v8, v5 offset:1024
  ds_read_b32 v9, v5 offset:1152
  ds_read_b32 v10, v5 offset:1280
  ds_read_b32 v11, v5 offset:1408
  s_waitcnt lgkmcnt(0)
  v_add_f32 v8, v8, v9
  v_add_f32 v10, v10, v11
  v_add_f32 v3, v8, v10
  v_mov_b32 v7, 0x3727c5ac
  v_fmac_f32 v7, 0x3acccccd, v3
  v_rsq_f32 v7, v7
  s_nop 0
  v_mul_f32 v96, v96, v7
  v_mul_f32 v97, v97, v7
  v_mul_f32 v98, v98, v7
  v_mul_f32 v99, v99, v7
  v_mul_f32 v100, v100, v7
  v_mul_f32 v101, v101, v7
  v_mul_f32 v102, v102, v7
  v_mul_f32 v103, v103, v7
  v_mul_f32 v104, v104, v7
  v_mul_f32 v105, v105, v7
  v_mul_f32 v106, v106, v7
  v_mul_f32 v107, v107, v7
  v_mul_f32 v108, v108, v7
  v_mul_f32 v109, v109, v7
  v_mul_f32 v110, v110, v7
  v_mul_f32 v111, v111, v7
  v_mul_f32 v112, v112, v7
  v_mul_f32 v113, v113, v7
  v_mul_f32 v114, v114, v7
  v_mul_f32 v115, v115, v7
  v_mul_f32 v116, v116, v7
  v_mul_f32 v117, v117, v7
  v_mul_f32 v118, v118, v7
  v_mul_f32 v119, v119, v7
  v_mul_f32 v120, v120, v7
  v_mul_f32 v121, v121, v7
  v_mul_f32 v122, v122, v7
  v_mul_f32 v123, v123, v7
  v_mul_f32 v124, v124, v7
  v_mul_f32 v125, v125, v7
  v_mul_f32 v126, v126, v7
  v_mul_f32 v127, v127, v7
  v_mul_f32 v128, v128, v7
  v_mul_f32 v129, v129, v7
  v_mul_f32 v130, v130, v7
  v_mul_f32 v131, v131, v7
  v_mul_f32 v132, v132, v7
  v_mul_f32 v133, v133, v7
  v_mul_f32 v134, v134, v7
  v_mul_f32 v135, v135, v7
  v_mul_f32 v136, v136, v7
  v_mul_f32 v137, v137, v7
  v_mul_f32 v138, v138, v7
  v_mul_f32 v139, v139, v7
  v_mul_f32 v140, v140, v7
  v_mul_f32 v141, v141, v7
  v_mul_f32 v142, v142, v7
  v_mul_f32 v143, v143, v7
  v_mul_f32 v144, v144, v7
  v_mul_f32 v145, v145, v7
  v_mul_f32 v146, v146, v7
  v_mul_f32 v147, v147, v7
  v_mul_f32 v148, v148, v7
  v_mul_f32 v149, v149, v7
  v_mul_f32 v150, v150, v7
  v_mul_f32 v151, v151, v7
  v_mul_f32 v152, v152, v7
  v_mul_f32 v153, v153, v7
  v_mul_f32 v154, v154, v7
  v_mul_f32 v155, v155, v7
  v_mul_f32 v156, v156, v7
  v_mul_f32 v157, v157, v7
  v_mul_f32 v158, v158, v7
  v_mul_f32 v159, v159, v7
  v_mul_f32 v160, v160, v7
  v_mul_f32 v161, v161, v7
  v_mul_f32 v162, v162, v7
  v_mul_f32 v163, v163, v7
  v_mul_f32 v164, v164, v7
  v_mul_f32 v165, v165, v7
  v_mul_f32 v166, v166, v7
  v_mul_f32 v167, v167, v7
  v_mul_f32 v168, v168, v7
  v_mul_f32 v169, v169, v7
  v_mul_f32 v170, v170, v7
  v_mul_f32 v171, v171, v7
  v_mul_f32 v172, v172, v7
  v_mul_f32 v173, v173, v7
  v_mul_f32 v174, v174, v7
  v_mul_f32 v175, v175, v7
  s_mul_i32 s26, s2, 40960
  s_mul_i32 s27, s21, 10240
  s_add_u32 s26, s26, s27
  s_add_u32 s26, s26, 0x100000
  v_cvt_pk_bf16_f32 v16, v96, v97
  v_cvt_pk_bf16_f32 v17, v98, v99
  v_cvt_pk_bf16_f32 v18, v100, v101
  v_cvt_pk_bf16_f32 v19, v102, v103
  v_cvt_pk_bf16_f32 v20, v104, v105
  v_cvt_pk_bf16_f32 v21, v106, v107
  v_cvt_pk_bf16_f32 v22, v108, v109
  v_cvt_pk_bf16_f32 v23, v110, v111
  s_add_u32 s29, s26, 0
  buffer_store_dwordx4 v[16:19], v2, s[8:11], s29 offen
  s_add_u32 s29, s26, 1024
  buffer_store_dwordx4 v[20:23], v2, s[8:11], s29 offen
  v_cvt_pk_bf16_f32 v24, v112, v113
  v_cvt_pk_bf16_f32 v25, v114, v115
  v_cvt_pk_bf16_f32 v26, v116, v117
  v_cvt_pk_bf16_f32 v27, v118, v119
  v_cvt_pk_bf16_f32 v28, v120, v121
  v_cvt_pk_bf16_f32 v29, v122, v123
  v_cvt_pk_bf16_f32 v30, v124, v125
  v_cvt_pk_bf16_f32 v31, v126, v127
  s_add_u32 s29, s26, 2048
  buffer_store_dwordx4 v[24:27], v2, s[8:11], s29 offen
  s_add_u32 s29, s26, 3072
  buffer_store_dwordx4 v[28:31], v2, s[8:11], s29 offen
  v_cvt_pk_bf16_f32 v32, v128, v129
  v_cvt_pk_bf16_f32 v33, v130, v131
  v_cvt_pk_bf16_f32 v34, v132, v133
  v_cvt_pk_bf16_f32 v35, v134, v135
  v_cvt_pk_bf16_f32 v36, v136, v137
  v_cvt_pk_bf16_f32 v37, v138, v139
  v_cvt_pk_bf16_f32 v38, v140, v141
  v_cvt_pk_bf16_f32 v39, v142, v143
  s_add_u32 s29, s26, 4096
  buffer_store_dwordx4 v[32:35], v2, s[8:11], s29 offen
  s_add_u32 s29, s26, 5120
  buffer_store_dwordx4 v[36:39], v2, s[8:11], s29 offen
  v_cvt_pk_bf16_f32 v40, v144, v145
  v_cvt_pk_bf16_f32 v41, v146, v147
  v_cvt_pk_bf16_f32 v42, v148, v149
  v_cvt_pk_bf16_f32 v43, v150, v151
  v_cvt_pk_bf16_f32 v44, v152, v153
  v_cvt_pk_bf16_f32 v45, v154, v155
  v_cvt_pk_bf16_f32 v46, v156, v157
  v_cvt_pk_bf16_f32 v47, v158, v159
  s_add_u32 s29, s26, 6144
  buffer_store_dwordx4 v[40:43], v2, s[8:11], s29 offen
  s_add_u32 s29, s26, 7168
  buffer_store_dwordx4 v[44:47], v2, s[8:11], s29 offen
  v_cvt_pk_bf16_f32 v48, v160, v161
  v_cvt_pk_bf16_f32 v49, v162, v163
  v_cvt_pk_bf16_f32 v50, v164, v165
  v_cvt_pk_bf16_f32 v51, v166, v167
  v_cvt_pk_bf16_f32 v52, v168, v169
  v_cvt_pk_bf16_f32 v53, v170, v171
  v_cvt_pk_bf16_f32 v54, v172, v173
  v_cvt_pk_bf16_f32 v55, v174, v175
  s_add_u32 s29, s26, 8192
  buffer_store_dwordx4 v[48:51], v2, s[8:11], s29 offen
  s_add_u32 s29, s26, 9216
  buffer_store_dwordx4 v[52:55], v2, s[8:11], s29 offen
kb3a_exit:
  s_endpgm

.section .rodata,"a"
.p2align 6
.amdhsa_kernel out1_kernel
  .amdhsa_next_free_vgpr 256
  .amdhsa_next_free_sgpr 102
  .amdhsa_accum_offset 256
  .amdhsa_group_segment_fixed_size 0
  .amdhsa_kernarg_size 104
  .amdhsa_user_sgpr_count 2
  .amdhsa_user_sgpr_kernarg_segment_ptr 1
  .amdhsa_system_sgpr_workgroup_id_x 1
.end_amdhsa_kernel
.text
.globl red2_kernel
.p2align 8
.type red2_kernel,@function
red2_kernel:
  s_cmp_ge_u32 s2, 256
  s_cbranch_scc1 kr2_exit
  s_load_dwordx2 s[36:37], s[0:1], 0
  s_load_dwordx2 s[4:5], s[0:1], 96
  v_lshrrev_b32 v1, 6, v0
  s_nop 0
  v_readfirstlane_b32 s21, v1
  v_and_b32 v1, 63, v0
  s_waitcnt lgkmcnt(0)
  s_mov_b32 s8, s4
  s_and_b32 s9, s5, 0xffff
  s_mov_b32 s10, 0x10000000
  s_mov_b32 s11, 0x20000
  s_mov_b32 s12, s36
  s_and_b32 s13, s37, 0xffff
  s_mov_b32 s14, 0x280000
  s_mov_b32 s15, 0x20000
  s_lshr_b32 s22, s2, 2
  s_and_b32 s23, s2, 3
  s_lshl_b32 s23, s23, 3
  v_and_b32 v2, 7, v1
  v_bfe_u32 v3, v1, 3, 1
  v_lshrrev_b32 v4, 4, v1
  v_lshlrev_b32 v5, 5, v3
  v_add_u32 v5, v5, v2
  v_add_u32 v5, s23, v5
  v_lshlrev_b32 v5, 4, v5
  v_lshlrev_b32 v6, 11, v4
  v_add_u32 v6, v6, v5
  v_lshlrev_b32 v7, 10, v4
  v_add_u32 v7, v7, v5
  s_mul_i32 s24, s22, 81920
  s_lshl_b32 s25, s21, 14
  s_add_u32 s24, s24, s25
  s_add_u32 s26, s24, 27262976
  buffer_load_dwordx4 v[32:35], v6, s[8:11], s26 offen
  s_add_u32 s26, s24, 27264000
  buffer_load_dwordx4 v[36:39], v6, s[8:11], s26 offen
  s_add_u32 s26, s24, 27271168
  buffer_load_dwordx4 v[40:43], v6, s[8:11], s26 offen
  s_add_u32 s26, s24, 27272192
  buffer_load_dwordx4 v[44:47], v6, s[8:11], s26 offen
  s_add_u32 s26, s24, 32505856
  buffer_load_dwordx4 v[48:51], v6, s[8:11], s26 offen
  s_add_u32 s26, s24, 32506880
  buffer_load_dwordx4 v[52:55], v6, s[8:11], s26 offen
  s_add_u32 s26, s24, 32514048
  buffer_load_dwordx4 v[56:59], v6, s[8:11], s26 offen
  s_add_u32 s26, s24, 32515072
  buffer_load_dwordx4 v[60:63], v6, s[8:11], s26 offen
  s_add_u32 s26, s24, 37748736
  buffer_load_dwordx4 v[64:67], v6, s[8:11], s26 offen
  s_add_u32 s26, s24, 37749760
  buffer_load_dwordx4 v[68:71], v6, s[8:11], s26 offen
  s_add_u32 s26, s24, 37756928
  buffer_load_dwordx4 v[72:75], v6, s[8:11], s26 offen
  s_add_u32 s26, s24, 37757952
  buffer_load_dwordx4 v[76:79], v6, s[8:11], s26 offen
  s_add_u32 s26, s24, 42991616
  buffer_load_dwordx4 v[80:83], v6, s[8:11], s26 offen
  s_add_u32 s26, s24, 42992640
  buffer_load_dwordx4 v[84:87], v6, s[8:11], s26 offen
  s_add_u32 s26, s24, 42999808
  buffer_load_dwordx4 v[88:91], v6, s[8:11], s26 offen
  s_add_u32 s26, s24, 43000832
  buffer_load_dwordx4 v[92:95], v6, s[8:11], s26 offen
  s_add_u32 s26, s24, 20971520
  buffer_load_dwordx4 v[16:19], v6, s[8:11], s26 offen
  s_add_u32 s26, s24, 20972544
  buffer_load_dwordx4 v[20:23], v6, s[8:11], s26 offen
  s_add_u32 s26, s24, 20979712
  buffer_load_dwordx4 v[24:27], v6, s[8:11], s26 offen
  s_add_u32 s26, s24, 20980736
  buffer_load_dwordx4 v[28:31], v6, s[8:11], s26 offen
  s_waitcnt vmcnt(0)
  v_add_f32 v32, v32, v48
  v_add_f32 v64, v64, v80
  v_add_f32 v33, v33, v49
  v_add_f32 v65, v65, v81
  v_add_f32 v34, v34, v50
  v_add_f32 v66, v66, v82
  v_add_f32 v35, v35, v51
  v_add_f32 v67, v67, v83
  v_add_f32 v36, v36, v52
  v_add_f32 v68, v68, v84
  v_add_f32 v37, v37, v53
  v_add_f32 v69, v69, v85
  v_add_f32 v38, v38, v54
  v_add_f32 v70, v70, v86
  v_add_f32 v39, v39, v55
  v_add_f32 v71, v71, v87
  v_add_f32 v40, v40, v56
  v_add_f32 v72, v72, v88
  v_add_f32 v41, v41, v57
  v_add_f32 v73, v73, v89
  v_add_f32 v42, v42, v58
  v_add_f32 v74, v74, v90
  v_add_f32 v43, v43, v59
  v_add_f32 v75, v75, v91
  v_add_f32 v44, v44, v60
  v_add_f32 v76, v76, v92
  v_add_f32 v45, v45, v61
  v_add_f32 v77, v77, v93
  v_add_f32 v46, v46, v62
  v_add_f32 v78, v78, v94
  v_add_f32 v47, v47, v63
  v_add_f32 v79, v79, v95
  v_add_f32 v32, v32, v64
  v_add_f32 v33, v33, v65
  v_add_f32 v34, v34, v66
  v_add_f32 v35, v35, v67
  v_add_f32 v36, v36, v68
  v_add_f32 v37, v37, v69
  v_add_f32 v38, v38, v70
  v_add_f32 v39, v39, v71
  v_add_f32 v40, v40, v72
  v_add_f32 v41, v41, v73
  v_add_f32 v42, v42, v74
  v_add_f32 v43, v43, v75
  v_add_f32 v44, v44, v76
  v_add_f32 v45, v45, v77
  v_add_f32 v46, v46, v78
  v_add_f32 v47, v47, v79
  v_add_f32 v16, v16, v32
  v_add_f32 v17, v17, v33
  v_add_f32 v18, v18, v34
  v_add_f32 v19, v19, v35
  v_add_f32 v20, v20, v36
  v_add_f32 v21, v21, v37
  v_add_f32 v22, v22, v38
  v_add_f32 v23, v23, v39
  v_add_f32 v24, v24, v40
  v_add_f32 v25, v25, v41
  v_add_f32 v26, v26, v42
  v_add_f32 v27, v27, v43
  v_add_f32 v28, v28, v44
  v_add_f32 v29, v29, v45
  v_add_f32 v30, v30, v46
  v_add_f32 v31, v31, v47
  s_add_u32 s26, s24, 20971520
  buffer_store_dwordx4 v[16:19], v6, s[8:11], s26 offen
  s_add_u32 s26, s24, 20972544
  buffer_store_dwordx4 v[20:23], v6, s[8:11], s26 offen
  s_add_u32 s26, s24, 20979712
  buffer_store_dwordx4 v[24:27], v6, s[8:11], s26 offen
  s_add_u32 s26, s24, 20980736
  buffer_store_dwordx4 v[28:31], v6, s[8:11], s26 offen
  v_add_f32 v10, v16, v17
  v_add_f32 v10, v10, v18
  v_add_f32 v10, v10, v19
  v_add_f32 v10, v10, v20
  v_add_f32 v10, v10, v21
  v_add_f32 v10, v10, v22
  v_add_f32 v10, v10, v23
  v_add_f32 v10, v10, v24
  v_add_f32 v10, v10, v25
  v_add_f32 v10, v10, v26
  v_add_f32 v10, v10, v27
  v_add_f32 v10, v10, v28
  v_add_f32 v10, v10, v29
  v_add_f32 v10, v10, v30
  v_add_f32 v10, v10, v31
  s_nop 1
  v_add_f32_dpp v10, v10, v10 row_ror:8 row_mask:0xf bank_mask:0xf
  v_mov_b32 v11, v10
  s_nop 1
  v_permlane16_swap_b32 v10, v11
  v_add_f32 v10, v10, v11
  v_mov_b32 v11, v10
  s_nop 1
  v_permlane32_swap_b32 v10, v11
  v_add_f32 v10, v10, v11
  v_lshlrev_b32 v12, 2, v2
  s_lshl_b32 s26, s21, 5
  v_add_u32 v13, s26, v12
  ds_write_b32 v13, v10
  s_waitcnt lgkmcnt(0)
  s_barrier
  ds_read_b32 v40, v12 offset:0
  ds_read_b32 v41, v12 offset:32
  ds_read_b32 v42, v12 offset:64
  ds_read_b32 v43, v12 offset:96
  ds_read_b32 v44, v12 offset:128
  s_waitcnt lgkmcnt(0)
  v_add_f32 v40, v40, v41
  v_add_f32 v42, v42, v43
  v_add_f32 v40, v40, v42
  v_add_f32 v40, v40, v44
  v_mul_f32 v40, 0x3acccccd, v40
  v_sub_f32 v48, v16, v40
  v_sub_f32 v49, v17, v40
  v_sub_f32 v50, v18, v40
  v_sub_f32 v51, v19, v40
  v_sub_f32 v52, v20, v40
  v_sub_f32 v53, v21, v40
  v_sub_f32 v54, v22, v40
  v_sub_f32 v55, v23, v40
  v_sub_f32 v56, v24, v40
  v_sub_f32 v57, v25, v40
  v_sub_f32 v58, v26, v40
  v_sub_f32 v59, v27, v40
  v_sub_f32 v60, v28, v40
  v_sub_f32 v61, v29, v40
  v_sub_f32 v62, v30, v40
  v_sub_f32 v63, v31, v40
  v_mul_f32 v10, v48, v48
  v_fmac_f32 v10, v49, v49
  v_fmac_f32 v10, v50, v50
  v_fmac_f32 v10, v51, v51
  v_fmac_f32 v10, v52, v52
  v_fmac_f32 v10, v53, v53
  v_fmac_f32 v10, v54, v54
  v_fmac_f32 v10, v55, v55
  v_fmac_f32 v10, v56, v56
  v_fmac_f32 v10, v57, v57
  v_fmac_f32 v10, v58, v58
  v_fmac_f32 v10, v59, v59
  v_fmac_f32 v10, v60, v60
  v_fmac_f32 v10, v61, v61
  v_fmac_f32 v10, v62, v62
  v_fmac_f32 v10, v63, v63
  s_nop 1
  v_add_f32_dpp v10, v10, v10 row_ror:8 row_mask:0xf bank_mask:0xf
  v_mov_b32 v11, v10
  s_nop 1
  v_permlane16_swap_b32 v10, v11
  v_add_f32 v10, v10, v11
  v_mov_b32 v11, v10
  s_nop 1
  v_permlane32_swap_b32 v10, v11
  v_add_f32 v10, v10, v11
  ds_write_b32 v13, v10 offset:256
  s_waitcnt lgkmcnt(0)
  s_barrier
  ds_read_b32 v40, v12 offset:256
  ds_read_b32 v41, v12 offset:288
  ds_read_b32 v42, v12 offset:320
  ds_read_b32 v43, v12 offset:352
  ds_read_b32 v44, v12 offset:384
  s_waitcnt lgkmcnt(0)
  v_add_f32 v40, v40, v41
  v_add_f32 v42, v42, v43
  v_add_f32 v40, v40, v42
  v_add_f32 v40, v40, v44
  v_mov_b32 v41, 0x3727c5ac
  v_fmac_f32 v41, 0x3acccccd, v40
  v_rsq_f32 v41, v41
  s_nop 0
  v_mul_f32 v48, v48, v41
  v_mul_f32 v49, v49, v41
  v_mul_f32 v50, v50, v41
  v_mul_f32 v51, v51, v41
  v_mul_f32 v52, v52, v41
  v_mul_f32 v53, v53, v41
  v_mul_f32 v54, v54, v41
  v_mul_f32 v55, v55, v41
  v_mul_f32 v56, v56, v41
  v_mul_f32 v57, v57, v41
  v_mul_f32 v58, v58, v41
  v_mul_f32 v59, v59, v41
  v_mul_f32 v60, v60, v41
  v_mul_f32 v61, v61, v41
  v_mul_f32 v62, v62, v41
  v_mul_f32 v63, v63, v41
  v_cvt_pk_bf16_f32 v64, v48, v49
  v_cvt_pk_bf16_f32 v65, v50, v51
  v_cvt_pk_bf16_f32 v66, v52, v53
  v_cvt_pk_bf16_f32 v67, v54, v55
  v_cvt_pk_bf16_f32 v68, v56, v57
  v_cvt_pk_bf16_f32 v69, v58, v59
  v_cvt_pk_bf16_f32 v70, v60, v61
  v_cvt_pk_bf16_f32 v71, v62, v63
  s_mul_i32 s26, s22, 40960
  s_lshl_b32 s27, s21, 13
  s_add_u32 s26, s26, s27
  s_add_u32 s26, s26, 0x100000
  buffer_store_dwordx4 v[64:67], v7, s[8:11], s26 offen
  s_add_u32 s26, s26, 4096
  buffer_store_dwordx4 v[68:71], v7, s[8:11], s26 offen
  s_cmp_eq_u32 s2, 0
  s_cbranch_scc0 kr2_exit
  s_cmp_eq_u32 s21, 0
  s_cbranch_scc0 kr2_exit
  v_mov_b32 v10, 0
  v_lshlrev_b32 v11, 2, v1
  s_mov_b32 s26, 0x1400
  buffer_store_dword v10, v11, s[8:11], s26 offen
kr2_exit:
  s_endpgm

.section .rodata,"a"
.p2align 6
.amdhsa_kernel red2_kernel
  .amdhsa_next_free_vgpr 128
  .amdhsa_next_free_sgpr 102
  .amdhsa_accum_offset 128
  .amdhsa_group_segment_fixed_size 0
  .amdhsa_kernarg_size 104
  .amdhsa_user_sgpr_count 2
  .amdhsa_user_sgpr_kernarg_segment_ptr 1
  .amdhsa_system_sgpr_workgroup_id_x 1
.end_amdhsa_kernel
.text
.globl att2_kernel
.p2align 8
.type att2_kernel,@function
att2_kernel:
  s_cmp_ge_u32 s2, 256
  s_cbranch_scc1 kb2b_exit
  s_load_dwordx2 s[4:5], s[0:1], 96
  v_lshrrev_b32 v1, 6, v0
  s_nop 0
  v_readfirstlane_b32 s21, v1
  v_and_b32 v1, 63, v0
  v_lshlrev_b32 v2, 4, v1
  s_waitcnt lgkmcnt(0)
  s_mov_b32 s8, s4
  s_and_b32 s9, s5, 0xffff
  s_mov_b32 s10, 0x10000000
  s_mov_b32 s11, 0x20000
  s_and_b32 s22, s2, 7
  s_lshl_b32 s22, s22, 2
  s_bfe_u32 s23, s2, 0x20003
  s_add_u32 s22, s22, s23
  s_lshr_b32 s23, s2, 5
  s_lshl_b32 s24, s23, 3
  s_lshl_b32 s25, s21, 1
  s_add_u32 s24, s24, s25
  s_lshl_b32 s25, s22, 6
  s_add_u32 s26, s25, s24
  s_lshl_b32 s26, s26, 11
  s_add_u32 s26, s26, 0xe600000
  buffer_load_dwordx4 v[16:19], v2, s[8:11], s26 offen
  buffer_load_dwordx4 v[20:23], v2, s[8:11], s26 offen offset:1024
  s_add_u32 s26, s26, 2048
  buffer_load_dwordx4 v[24:27], v2, s[8:11], s26 offen
  buffer_load_dwordx4 v[28:31], v2, s[8:11], s26 offen offset:1024
  s_lshl_b32 s26, s22, 2
  s_add_u32 s26, s26, 0x1400
  v_mov_b32 v3, 0
  buffer_load_dword v4, v3, s[8:11], s26 offen
  s_lshl_b32 s27, s25, 11
  s_add_u32 s28, s27, 0xee00000
  s_add_u32 s27, s27, 0xea00000
  s_waitcnt vmcnt(0)
  v_mov_b32 v5, 0
  v_lshlrev_b32 v6, 16, v16
  v_and_b32 v7, 0xffff0000, v16
  v_add_f32_e64 v5, v5, abs(v6)
  v_add_f32_e64 v5, v5, abs(v7)
  v_lshlrev_b32 v6, 16, v17
  v_and_b32 v7, 0xffff0000, v17
  v_add_f32_e64 v5, v5, abs(v6)
  v_add_f32_e64 v5, v5, abs(v7)
  v_lshlrev_b32 v6, 16, v18
  v_and_b32 v7, 0xffff0000, v18
  v_add_f32_e64 v5, v5, abs(v6)
  v_add_f32_e64 v5, v5, abs(v7)
  v_lshlrev_b32 v6, 16, v19
  v_and_b32 v7, 0xffff0000, v19
  v_add_f32_e64 v5, v5, abs(v6)
  v_add_f32_e64 v5, v5, abs(v7)
  v_lshlrev_b32 v6, 16, v20
  v_and_b32 v7, 0xffff0000, v20
  v_add_f32_e64 v5, v5, abs(v6)
  v_add_f32_e64 v5, v5, abs(v7)
  v_lshlrev_b32 v6, 16, v21
  v_and_b32 v7, 0xffff0000, v21
  v_add_f32_e64 v5, v5, abs(v6)
  v_add_f32_e64 v5, v5, abs(v7)
  v_lshlrev_b32 v6, 16, v22
  v_and_b32 v7, 0xffff0000, v22
  v_add_f32_e64 v5, v5, abs(v6)
  v_add_f32_e64 v5, v5, abs(v7)
  v_lshlrev_b32 v6, 16, v23
  v_and_b32 v7, 0xffff0000, v23
  v_add_f32_e64 v5, v5, abs(v6)
  v_add_f32_e64 v5, v5, abs(v7)
  v_mov_b32 v6, v5
  s_nop 1
  v_permlane32_swap_b32 v5, v6
  v_add_f32 v5, v5, v6
  v_mul_f32 v5, v5, v4
  v_mul_f32 v5, 0x3f820000, v5
  v_mov_b32 v12, v5
  v_mov_b32 v5, 0
  v_lshlrev_b32 v6, 16, v24
  v_and_b32 v7, 0xffff0000, v24
  v_add_f32_e64 v5, v5, abs(v6)
  v_add_f32_e64 v5, v5, abs(v7)
  v_lshlrev_b32 v6, 16, v25
  v_and_b32 v7, 0xffff0000, v25
  v_add_f32_e64 v5, v5, abs(v6)
  v_add_f32_e64 v5, v5, abs(v7)
  v_lshlrev_b32 v6, 16, v26
  v_and_b32 v7, 0xffff0000, v26
  v_add_f32_e64 v5, v5, abs(v6)
  v_add_f32_e64 v5, v5, abs(v7)
  v_lshlrev_b32 v6, 16, v27
  v_and_b32 v7, 0xffff0000, v27
  v_add_f32_e64 v5, v5, abs(v6)
  v_add_f32_e64 v5, v5, abs(v7)
  v_lshlrev_b32 v6, 16, v28
  v_and_b32 v7, 0xffff0000, v28
  v_add_f32_e64 v5, v5, abs(v6)
  v_add_f32_e64 v5, v5, abs(v7)
  v_lshlrev_b32 v6, 16, v29
  v_and_b32 v7, 0xffff0000, v29
  v_add_f32_e64 v5, v5, abs(v6)
  v_add_f32_e64 v5, v5, abs(v7)
  v_lshlrev_b32 v6, 16, v30
  v_and_b32 v7, 0xffff0000, v30
  v_add_f32_e64 v5, v5, abs(v6)
  v_add_f32_e64 v5, v5, abs(v7)
  v_lshlrev_b32 v6, 16, v31
  v_and_b32 v7, 0xffff0000, v31
  v_add_f32_e64 v5, v5, abs(v6)
  v_add_f32_e64 v5, v5, abs(v7)
  v_mov_b32 v6, v5
  s_nop 1
  v_permlane32_swap_b32 v5, v6
  v_add_f32 v5, v5, v6
  v_mul_f32 v5, v5, v4
  v_mul_f32 v5, 0x3f820000, v5
  v_mov_b32 v13, v5
  v_cmp_gt_u32 s[34:35], 32, v1
  s_mov_b32 s40, 0
kb2b_main:
  v_lshrrev_b32 v5, 16, v12
  v_or_b32 v5, 0x8000, v5
  v_and_b32 v6, 0xffff0000, v22
  v_or_b32 v5, v5, v6
  v_cndmask_b32 v22, v22, v5, s[34:35]
  v_lshrrev_b32 v5, 16, v13
  v_or_b32 v5, 0x8000, v5
  v_and_b32 v6, 0xffff0000, v30
  v_or_b32 v5, v5, v6
  v_cndmask_b32 v30, v30, v5, s[34:35]
kb2b_main2:
  v_mov_b32 v112, 0
  v_mov_b32 v113, 0
  v_mov_b32 v114, 0
  v_mov_b32 v115, 0
  v_mov_b32 v116, 0
  v_mov_b32 v117, 0
  v_mov_b32 v118, 0
  v_mov_b32 v119, 0
  v_mov_b32 v120, 0
  v_mov_b32 v121, 0
  v_mov_b32 v122, 0
  v_mov_b32 v123, 0
  v_mov_b32 v124, 0
  v_mov_b32 v125, 0
  v_mov_b32 v126, 0
  v_mov_b32 v127, 0
  v_mov_b32 v128, 0
  v_mov_b32 v129, 0
  v_mov_b32 v130, 0
  v_mov_b32 v131, 0
  v_mov_b32 v132, 0
  v_mov_b32 v133, 0
  v_mov_b32 v134, 0
  v_mov_b32 v135, 0
  v_mov_b32 v136, 0
  v_mov_b32 v137, 0
  v_mov_b32 v138, 0
  v_mov_b32 v139, 0
  v_mov_b32 v140, 0
  v_mov_b32 v141, 0
  v_mov_b32 v142, 0
  v_mov_b32 v143, 0
  s_barrier
  s_mov_b32 s41, 0
  s_mul_i32 s30, s41, 32768
  s_lshl_b32 s31, s21, 13
  s_add_u32 s30, s30, s31
  s_add_u32 m0, s31, 0
  s_add_u32 s29, s30, s27
  s_add_u32 s29, s29, 0
  buffer_load_dwordx4 v2, s[8:11], s29 offen lds
  s_add_u32 m0, s31, 1024
  s_add_u32 s29, s30, s27
  s_add_u32 s29, s29, 1024
  buffer_load_dwordx4 v2, s[8:11], s29 offen lds
  s_add_u32 m0, s31, 2048
  s_add_u32 s29, s30, s27
  s_add_u32 s29, s29, 2048
  buffer_load_dwordx4 v2, s[8:11], s29 offen lds
  s_add_u32 m0, s31, 3072
  s_add_u32 s29, s30, s27
  s_add_u32 s29, s29, 3072
  buffer_load_dwordx4 v2, s[8:11], s29 offen lds
  s_add_u32 m0, s31, 4096
  s_add_u32 s29, s30, s27
  s_add_u32 s29, s29, 4096
  buffer_load_dwordx4 v2, s[8:11], s29 offen lds
  s_add_u32 m0, s31, 5120
  s_add_u32 s29, s30, s27
  s_add_u32 s29, s29, 5120
  buffer_load_dwordx4 v2, s[8:11], s29 offen lds
  s_add_u32 m0, s31, 6144
  s_add_u32 s29, s30, s27
  s_add_u32 s29, s29, 6144
  buffer_load_dwordx4 v2, s[8:11], s29 offen lds
  s_add_u32 m0, s31, 7168
  s_add_u32 s29, s30, s27
  s_add_u32 s29, s29, 7168
  buffer_load_dwordx4 v2, s[8:11], s29 offen lds
  s_add_u32 m0, s31, 32768
  s_add_u32 s29, s30, s28
  s_add_u32 s29, s29, 0
  buffer_load_dwordx4 v2, s[8:11], s29 offen lds
  s_add_u32 m0, s31, 33792
  s_add_u32 s29, s30, s28
  s_add_u32 s29, s29, 1024
  buffer_load_dwordx4 v2, s[8:11], s29 offen lds
  s_add_u32 m0, s31, 34816
  s_add_u32 s29, s30, s28
  s_add_u32 s29, s29, 2048
  buffer_load_dwordx4 v2, s[8:11], s29 offen lds
  s_add_u32 m0, s31, 35840
  s_add_u32 s29, s30, s28
  s_add_u32 s29, s29, 3072
  buffer_load_dwordx4 v2, s[8:11], s29 offen lds
  s_add_u32 m0, s31, 36864
  s_add_u32 s29, s30, s28
  s_add_u32 s29, s29, 4096
  buffer_load_dwordx4 v2, s[8:11], s29 offen lds
  s_add_u32 m0, s31, 37888
  s_add_u32 s29, s30, s28
  s_add_u32 s29, s29, 5120
  buffer_load_dwordx4 v2, s[8:11], s29 offen lds
  s_add_u32 m0, s31, 38912
  s_add_u32 s29, s30, s28
  s_add_u32 s29, s29, 6144
  buffer_load_dwordx4 v2, s[8:11], s29 offen lds
  s_add_u32 m0, s31, 39936
  s_add_u32 s29, s30, s28
  s_add_u32 s29, s29, 7168
  buffer_load_dwordx4 v2, s[8:11], s29 offen lds
  v_mov_b32 v3, v2
  v_add_u32 v4, 65536, v2
kb2b_chunk2:
  s_waitcnt vmcnt(0)
  s_barrier
  s_add_u32 s41, s41, 1
  s_cmp_ge_u32 s41, 4
  s_cbranch_scc1 nd_96
  s_mul_i32 s30, s41, 32768
  s_lshl_b32 s31, s21, 13
  s_add_u32 s30, s30, s31
  s_add_u32 m0, s31, 65536
  s_add_u32 s29, s30, s27
  s_add_u32 s29, s29, 0
  buffer_load_dwordx4 v2, s[8:11], s29 offen lds
  s_add_u32 m0, s31, 66560
  s_add_u32 s29, s30, s27
  s_add_u32 s29, s29, 1024
  buffer_load_dwordx4 v2, s[8:11], s29 offen lds
  s_add_u32 m0, s31, 67584
  s_add_u32 s29, s30, s27
  s_add_u32 s29, s29, 2048
  buffer_load_dwordx4 v2, s[8:11], s29 offen lds
  s_add_u32 m0, s31, 68608
  s_add_u32 s29, s30, s27
  s_add_u32 s29, s29, 3072
  buffer_load_dwordx4 v2, s[8:11], s29 offen lds
  s_add_u32 m0, s31, 69632
  s_add_u32 s29, s30, s27
  s_add_u32 s29, s29, 4096
  buffer_load_dwordx4 v2, s[8:11], s29 offen lds
  s_add_u32 m0, s31, 70656
  s_add_u32 s29, s30, s27
  s_add_u32 s29, s29, 5120
  buffer_load_dwordx4 v2, s[8:11], s29 offen lds
  s_add_u32 m0, s31, 71680
  s_add_u32 s29, s30, s27
  s_add_u32 s29, s29, 6144
  buffer_load_dwordx4 v2, s[8:11], s29 offen lds
  s_add_u32 m0, s31, 72704
  s_add_u32 s29, s30, s27
  s_add_u32 s29, s29, 7168
  buffer_load_dwordx4 v2, s[8:11], s29 offen lds
  s_add_u32 m0, s31, 98304
  s_add_u32 s29, s30, s28
  s_add_u32 s29, s29, 0
  buffer_load_dwordx4 v2, s[8:11], s29 offen lds
  s_add_u32 m0, s31, 99328
  s_add_u32 s29, s30, s28
  s_add_u32 s29, s29, 1024
  buffer_load_dwordx4 v2, s[8:11], s29 offen lds
  s_add_u32 m0, s31, 100352
  s_add_u32 s29, s30, s28
  s_add_u32 s29, s29, 2048
  buffer_load_dwordx4 v2, s[8:11], s29 offen lds
  s_add_u32 m0, s31, 101376
  s_add_u32 s29, s30, s28
  s_add_u32 s29, s29, 3072
  buffer_load_dwordx4 v2, s[8:11], s29 offen lds
  s_add_u32 m0, s31, 102400
  s_add_u32 s29, s30, s28
  s_add_u32 s29, s29, 4096
  buffer_load_dwordx4 v2, s[8:11], s29 offen lds
  s_add_u32 m0, s31, 103424
  s_add_u32 s29, s30, s28
  s_add_u32 s29, s29, 5120
  buffer_load_dwordx4 v2, s[8:11], s29 offen lds
  s_add_u32 m0, s31, 104448
  s_add_u32 s29, s30, s28
  s_add_u32 s29, s29, 6144
  buffer_load_dwordx4 v2, s[8:11], s29 offen lds
  s_add_u32 m0, s31, 105472
  s_add_u32 s29, s30, s28
  s_add_u32 s29, s29, 7168
  buffer_load_dwordx4 v2, s[8:11], s29 offen lds
nd_96:
  ds_read_b128 v[32:35], v3 offset:0
  ds_read_b128 v[36:39], v3 offset:1024
  ds_read_b128 v[48:51], v3 offset:32768
  ds_read_b128 v[52:55], v3 offset:33792
  ds_read_b128 v[40:43], v3 offset:2048
  ds_read_b128 v[44:47], v3 offset:3072
  s_waitcnt lgkmcnt(4)
  v_mfma_f32_32x32x16_bf16 v[64:79], v[32:35], v[16:19], 0
  v_mfma_f32_32x32x16_bf16 v[64:79], v[36:39], v[20:23], v[64:79]
  s_nop 11
  v_exp_f32 v64, v64
  v_exp_f32 v65, v65
  v_exp_f32 v66, v66
  v_exp_f32 v67, v67
  v_cvt_pk_bf16_f32 v96, v64, v65
  v_exp_f32 v68, v68
  v_exp_f32 v69, v69
  v_cvt_pk_bf16_f32 v97, v66, v67
  v_mfma_f32_32x32x16_bf16 v[80:95], v[32:35], v[24:27], 0
  v_exp_f32 v70, v70
  v_exp_f32 v71, v71
  v_cvt_pk_bf16_f32 v98, v68, v69
  v_exp_f32 v72, v72
  v_mfma_f32_32x32x16_bf16 v[80:95], v[36:39], v[28:31], v[80:95]
  v_exp_f32 v73, v73
  v_cvt_pk_bf16_f32 v99, v70, v71
  v_exp_f32 v74, v74
  ds_read_b128 v[56:59], v3 offset:34816
  v_exp_f32 v75, v75
  v_cvt_pk_bf16_f32 v100, v72, v73
  v_exp_f32 v76, v76
  ds_read_b128 v[60:63], v3 offset:35840
  v_exp_f32 v77, v77
  v_cvt_pk_bf16_f32 v101, v74, v75
  v_exp_f32 v78, v78
  v_exp_f32 v79, v79
  v_cvt_pk_bf16_f32 v102, v76, v77
  v_cvt_pk_bf16_f32 v103, v78, v79
  s_waitcnt lgkmcnt(4)
  v_mfma_f32_32x32x16_bf16 v[112:127], v[48:51], v[96:99], v[112:127]
  v_exp_f32 v80, v80
  v_exp_f32 v81, v81
  v_exp_f32 v82, v82
  v_mfma_f32_32x32x16_bf16 v[112:127], v[52:55], v[100:103], v[112:127]
  v_exp_f32 v83, v83
  v_cvt_pk_bf16_f32 v104, v80, v81
  v_exp_f32 v84, v84
  v_exp_f32 v85, v85
  v_cvt_pk_bf16_f32 v105, v82, v83
  s_waitcnt lgkmcnt(2)
  v_mfma_f32_32x32x16_bf16 v[64:79], v[40:43], v[16:19], 0
  v_exp_f32 v86, v86
  v_exp_f32 v87, v87
  v_cvt_pk_bf16_f32 v106, v84, v85
  v_exp_f32 v88, v88
  v_mfma_f32_32x32x16_bf16 v[64:79], v[44:47], v[20:23], v[64:79]
  v_exp_f32 v89, v89
  v_cvt_pk_bf16_f32 v107, v86, v87
  v_exp_f32 v90, v90
  ds_read_b128 v[32:35], v3 offset:4096
  v_exp_f32 v91, v91
  v_cvt_pk_bf16_f32 v108, v88, v89
  v_exp_f32 v92, v92
  ds_read_b128 v[36:39], v3 offset:5120
  v_exp_f32 v93, v93
  v_cvt_pk_bf16_f32 v109, v90, v91
  v_exp_f32 v94, v94
  v_exp_f32 v95, v95
  v_cvt_pk_bf16_f32 v110, v92, v93
  v_cvt_pk_bf16_f32 v111, v94, v95
  v_mfma_f32_32x32x16_bf16 v[128:143], v[48:51], v[104:107], v[128:143]
  v_exp_f32 v64, v64
  v_exp_f32 v65, v65
  v_exp_f32 v66, v66
  v_mfma_f32_32x32x16_bf16 v[128:143], v[52:55], v[108:111], v[128:143]
  v_exp_f32 v67, v67
  v_cvt_pk_bf16_f32 v96, v64, v65
  v_exp_f32 v68, v68
  v_exp_f32 v69, v69
  v_cvt_pk_bf16_f32 v97, v66, v67
  v_mfma_f32_32x32x16_bf16 v[80:95], v[40:43], v[24:27], 0
  v_exp_f32 v70, v70
  v_exp_f32 v71, v71
  v_cvt_pk_bf16_f32 v98, v68, v69
  v_exp_f32 v72, v72
  v_mfma_f32_32x32x16_bf16 v[80:95], v[44:47], v[28:31], v[80:95]
  v_exp_f32 v73, v73
  v_cvt_pk_bf16_f32 v99, v70, v71
  v_exp_f32 v74, v74
  ds_read_b128 v[48:51], v3 offset:36864
  v_exp_f32 v75, v75
  v_cvt_pk_bf16_f32 v100, v72, v73
  v_exp_f32 v76, v76
  ds_read_b128 v[52:55], v3 offset:37888
  v_exp_f32 v77, v77
  v_cvt_pk_bf16_f32 v101, v74, v75
  v_exp_f32 v78, v78
  v_exp_f32 v79, v79
  v_cvt_pk_bf16_f32 v102, v76, v77
  v_cvt_pk_bf16_f32 v103, v78, v79
  s_waitcnt lgkmcnt(4)
  v_mfma_f32_32x32x16_bf16 v[112:127], v[56:59], v[96:99], v[112:127]
  v_exp_f32 v80, v80
  v_exp_f32 v81, v81
  v_exp_f32 v82, v82
  v_mfma_f32_32x32x16_bf16 v[112:127], v[60:63], v[100:103], v[112:127]
  v_exp_f32 v83, v83
  v_cvt_pk_bf16_f32 v104, v80, v81
  v_exp_f32 v84, v84
  v_exp_f32 v85, v85
  v_cvt_pk_bf16_f32 v105, v82, v83
  s_waitcnt lgkmcnt(2)
  v_mfma_f32_32x32x16_bf16 v[64:79], v[32:35], v[16:19], 0
  v_exp_f32 v86, v86
  v_exp_f32 v87, v87
  v_cvt_pk_bf16_f32 v106, v84, v85
  v_exp_f32 v88, v88
  v_mfma_f32_32x32x16_bf16 v[64:79], v[36:39], v[20:23], v[64:79]
  v_exp_f32 v89, v89
  v_cvt_pk_bf16_f32 v107, v86, v87
  v_exp_f32 v90, v90
  ds_read_b128 v[40:43], v3 offset:6144
  v_exp_f32 v91, v91
  v_cvt_pk_bf16_f32 v108, v88, v89
  v_exp_f32 v92, v92
  ds_read_b128 v[44:47], v3 offset:7168
  v_exp_f32 v93, v93
  v_cvt_pk_bf16_f32 v109, v90, v91
  v_exp_f32 v94, v94
  v_exp_f32 v95, v95
  v_cvt_pk_bf16_f32 v110, v92, v93
  v_cvt_pk_bf16_f32 v111, v94, v95
  v_mfma_f32_32x32x16_bf16 v[128:143], v[56:59], v[104:107], v[128:143]
  v_exp_f32 v64, v64
  v_exp_f32 v65, v65
  v_exp_f32 v66, v66
  v_mfma_f32_32x32x16_bf16 v[128:143], v[60:63], v[108:111], v[128:143]
  v_exp_f32 v67, v67
  v_cvt_pk_bf16_f32 v96, v64, v65
  v_exp_f32 v68, v68
  v_exp_f32 v69, v69
  v_cvt_pk_bf16_f32 v97, v66, v67
  v_mfma_f32_32x32x16_bf16 v[80:95], v[32:35], v[24:27], 0
  v_exp_f32 v70, v70
  v_exp_f32 v71, v71
  v_cvt_pk_bf16_f32 v98, v68, v69
  v_exp_f32 v72, v72
  v_mfma_f32_32x32x16_bf16 v[80:95], v[36:39], v[28:31], v[80:95]
  v_exp_f32 v73, v73
  v_cvt_pk_bf16_f32 v99, v70, v71
  v_exp_f32 v74, v74
  ds_read_b128 v[56:59], v3 offset:38912
  v_exp_f32 v75, v75
  v_cvt_pk_bf16_f32 v100, v72, v73
  v_exp_f32 v76, v76
  ds_read_b128 v[60:63], v3 offset:39936
  v_exp_f32 v77, v77
  v_cvt_pk_bf16_f32 v101, v74, v75
  v_exp_f32 v78, v78
  v_exp_f32 v79, v79
  v_cvt_pk_bf16_f32 v102, v76, v77
  v_cvt_pk_bf16_f32 v103, v78, v79
  s_waitcnt lgkmcnt(4)
  v_mfma_f32_32x32x16_bf16 v[112:127], v[48:51], v[96:99], v[112:127]
  v_exp_f32 v80, v80
  v_exp_f32 v81, v81
  v_exp_f32 v82, v82
  v_mfma_f32_32x32x16_bf16 v[112:127], v[52:55], v[100:103], v[112:127]
  v_exp_f32 v83, v83
  v_cvt_pk_bf16_f32 v104, v80, v81
  v_exp_f32 v84, v84
  v_exp_f32 v85, v85
  v_cvt_pk_bf16_f32 v105, v82, v83
  s_waitcnt lgkmcnt(2)
  v_mfma_f32_32x32x16_bf16 v[64:79], v[40:43], v[16:19], 0
  v_exp_f32 v86, v86
  v_exp_f32 v87, v87
  v_cvt_pk_bf16_f32 v106, v84, v85
  v_exp_f32 v88, v88
  v_mfma_f32_32x32x16_bf16 v[64:79], v[44:47], v[20:23], v[64:79]
  v_exp_f32 v89, v89
  v_cvt_pk_bf16_f32 v107, v86, v87
  v_exp_f32 v90, v90
  ds_read_b128 v[32:35], v3 offset:8192
  v_exp_f32 v91, v91
  v_cvt_pk_bf16_f32 v108, v88, v89
  v_exp_f32 v92, v92
  ds_read_b128 v[36:39], v3 offset:9216
  v_exp_f32 v93, v93
  v_cvt_pk_bf16_f32 v109, v90, v91
  v_exp_f32 v94, v94
  v_exp_f32 v95, v95
  v_cvt_pk_bf16_f32 v110, v92, v93
  v_cvt_pk_bf16_f32 v111, v94, v95
  v_mfma_f32_32x32x16_bf16 v[128:143], v[48:51], v[104:107], v[128:143]
  v_exp_f32 v64, v64
  v_exp_f32 v65, v65
  v_exp_f32 v66, v66
  v_mfma_f32_32x32x16_bf16 v[128:143], v[52:55], v[108:111], v[128:143]
  v_exp_f32 v67, v67
  v_cvt_pk_bf16_f32 v96, v64, v65
  v_exp_f32 v68, v68
  v_exp_f32 v69, v69
  v_cvt_pk_bf16_f32 v97, v66, v67
  v_mfma_f32_32x32x16_bf16 v[80:95], v[40:43], v[24:27], 0
  v_exp_f32 v70, v70
  v_exp_f32 v71, v71
  v_cvt_pk_bf16_f32 v98, v68, v69
  v_exp_f32 v72, v72
  v_mfma_f32_32x32x16_bf16 v[80:95], v[44:47], v[28:31], v[80:95]
  v_exp_f32 v73, v73
  v_cvt_pk_bf16_f32 v99, v70, v71
  v_exp_f32 v74, v74
  ds_read_b128 v[48:51], v3 offset:40960
  v_exp_f32 v75, v75
  v_cvt_pk_bf16_f32 v100, v72, v73
  v_exp_f32 v76, v76
  ds_read_b128 v[52:55], v3 offset:41984
  v_exp_f32 v77, v77
  v_cvt_pk_bf16_f32 v101, v74, v75
  v_exp_f32 v78, v78
  v_exp_f32 v79, v79
  v_cvt_pk_bf16_f32 v102, v76, v77
  v_cvt_pk_bf16_f32 v103, v78, v79
  s_waitcnt lgkmcnt(4)
  v_mfma_f32_32x32x16_bf16 v[112:127], v[56:59], v[96:99], v[112:127]
  v_exp_f32 v80, v80
  v_exp_f32 v81, v81
  v_exp_f32 v82, v82
  v_mfma_f32_32x32x16_bf16 v[112:127], v[60:63], v[100:103], v[112:127]
  v_exp_f32 v83, v83
  v_cvt_pk_bf16_f32 v104, v80, v81
  v_exp_f32 v84, v84
  v_exp_f32 v85, v85
  v_cvt_pk_bf16_f32 v105, v82, v83
  s_waitcnt lgkmcnt(2)
  v_mfma_f32_32x32x16_bf16 v[64:79], v[32:35], v[16:19], 0
  v_exp_f32 v86, v86
  v_exp_f32 v87, v87
  v_cvt_pk_bf16_f32 v106, v84, v85
  v_exp_f32 v88, v88
  v_mfma_f32_32x32x16_bf16 v[64:79], v[36:39], v[20:23], v[64:79]
  v_exp_f32 v89, v89
  v_cvt_pk_bf16_f32 v107, v86, v87
  v_exp_f32 v90, v90
  ds_read_b128 v[40:43], v3 offset:10240
  v_exp_f32 v91, v91
  v_cvt_pk_bf16_f32 v108, v88, v89
  v_exp_f32 v92, v92
  ds_read_b128 v[44:47], v3 offset:11264
  v_exp_f32 v93, v93
  v_cvt_pk_bf16_f32 v109, v90, v91
  v_exp_f32 v94, v94
  v_exp_f32 v95, v95
  v_cvt_pk_bf16_f32 v110, v92, v93
  v_cvt_pk_bf16_f32 v111, v94, v95
  v_mfma_f32_32x32x16_bf16 v[128:143], v[56:59], v[104:107], v[128:143]
  v_exp_f32 v64, v64
  v_exp_f32 v65, v65
  v_exp_f32 v66, v66
  v_mfma_f32_32x32x16_bf16 v[128:143], v[60:63], v[108:111], v[128:143]
  v_exp_f32 v67, v67
  v_cvt_pk_bf16_f32 v96, v64, v65
  v_exp_f32 v68, v68
  v_exp_f32 v69, v69
  v_cvt_pk_bf16_f32 v97, v66, v67
  v_mfma_f32_32x32x16_bf16 v[80:95], v[32:35], v[24:27], 0
  v_exp_f32 v70, v70
  v_exp_f32 v71, v71
  v_cvt_pk_bf16_f32 v98, v68, v69
  v_exp_f32 v72, v72
  v_mfma_f32_32x32x16_bf16 v[80:95], v[36:39], v[28:31], v[80:95]
  v_exp_f32 v73, v73
  v_cvt_pk_bf16_f32 v99, v70, v71
  v_exp_f32 v74, v74
  ds_read_b128 v[56:59], v3 offset:43008
  v_exp_f32 v75, v75
  v_cvt_pk_bf16_f32 v100, v72, v73
  v_exp_f32 v76, v76
  ds_read_b128 v[60:63], v3 offset:44032
  v_exp_f32 v77, v77
  v_cvt_pk_bf16_f32 v101, v74, v75
  v_exp_f32 v78, v78
  v_exp_f32 v79, v79
  v_cvt_pk_bf16_f32 v102, v76, v77
  v_cvt_pk_bf16_f32 v103, v78, v79
  s_waitcnt lgkmcnt(4)
  v_mfma_f32_32x32x16_bf16 v[112:127], v[48:51], v[96:99], v[112:127]
  v_exp_f32 v80, v80
  v_exp_f32 v81, v81
  v_exp_f32 v82, v82
  v_mfma_f32_32x32x16_bf16 v[112:127], v[52:55], v[100:103], v[112:127]
  v_exp_f32 v83, v83
  v_cvt_pk_bf16_f32 v104, v80, v81
  v_exp_f32 v84, v84
  v_exp_f32 v85, v85
  v_cvt_pk_bf16_f32 v105, v82, v83
  s_waitcnt lgkmcnt(2)
  v_mfma_f32_32x32x16_bf16 v[64:79], v[40:43], v[16:19], 0
  v_exp_f32 v86, v86
  v_exp_f32 v87, v87
  v_cvt_pk_bf16_f32 v106, v84, v85
  v_exp_f32 v88, v88
  v_mfma_f32_32x32x16_bf16 v[64:79], v[44:47], v[20:23], v[64:79]
  v_exp_f32 v89, v89
  v_cvt_pk_bf16_f32 v107, v86, v87
  v_exp_f32 v90, v90
  ds_read_b128 v[32:35], v3 offset:12288
  v_exp_f32 v91, v91
  v_cvt_pk_bf16_f32 v108, v88, v89
  v_exp_f32 v92, v92
  ds_read_b128 v[36:39], v3 offset:13312
  v_exp_f32 v93, v93
  v_cvt_pk_bf16_f32 v109, v90, v91
  v_exp_f32 v94, v94
  v_exp_f32 v95, v95
  v_cvt_pk_bf16_f32 v110, v92, v93
  v_cvt_pk_bf16_f32 v111, v94, v95
  v_mfma_f32_32x32x16_bf16 v[128:143], v[48:51], v[104:107], v[128:143]
  v_exp_f32 v64, v64
  v_exp_f32 v65, v65
  v_exp_f32 v66, v66
  v_mfma_f32_32x32x16_bf16 v[128:143], v[52:55], v[108:111], v[128:143]
  v_exp_f32 v67, v67
  v_cvt_pk_bf16_f32 v96, v64, v65
  v_exp_f32 v68, v68
  v_exp_f32 v69, v69
  v_cvt_pk_bf16_f32 v97, v66, v67
  v_mfma_f32_32x32x16_bf16 v[80:95], v[40:43], v[24:27], 0
  v_exp_f32 v70, v70
  v_exp_f32 v71, v71
  v_cvt_pk_bf16_f32 v98, v68, v69
  v_exp_f32 v72, v72
  v_mfma_f32_32x32x16_bf16 v[80:95], v[44:47], v[28:31], v[80:95]
  v_exp_f32 v73, v73
  v_cvt_pk_bf16_f32 v99, v70, v71
  v_exp_f32 v74, v74
  ds_read_b128 v[48:51], v3 offset:45056
  v_exp_f32 v75, v75
  v_cvt_pk_bf16_f32 v100, v72, v73
  v_exp_f32 v76, v76
  ds_read_b128 v[52:55], v3 offset:46080
  v_exp_f32 v77, v77
  v_cvt_pk_bf16_f32 v101, v74, v75
  v_exp_f32 v78, v78
  v_exp_f32 v79, v79
  v_cvt_pk_bf16_f32 v102, v76, v77
  v_cvt_pk_bf16_f32 v103, v78, v79
  s_waitcnt lgkmcnt(4)
  v_mfma_f32_32x32x16_bf16 v[112:127], v[56:59], v[96:99], v[112:127]
  v_exp_f32 v80, v80
  v_exp_f32 v81, v81
  v_exp_f32 v82, v82
  v_mfma_f32_32x32x16_bf16 v[112:127], v[60:63], v[100:103], v[112:127]
  v_exp_f32 v83, v83
  v_cvt_pk_bf16_f32 v104, v80, v81
  v_exp_f32 v84, v84
  v_exp_f32 v85, v85
  v_cvt_pk_bf16_f32 v105, v82, v83
  s_waitcnt lgkmcnt(2)
  v_mfma_f32_32x32x16_bf16 v[64:79], v[32:35], v[16:19], 0
  v_exp_f32 v86, v86
  v_exp_f32 v87, v87
  v_cvt_pk_bf16_f32 v106, v84, v85
  v_exp_f32 v88, v88
  v_mfma_f32_32x32x16_bf16 v[64:79], v[36:39], v[20:23], v[64:79]
  v_exp_f32 v89, v89
  v_cvt_pk_bf16_f32 v107, v86, v87
  v_exp_f32 v90, v90
  ds_read_b128 v[40:43], v3 offset:14336
  v_exp_f32 v91, v91
  v_cvt_pk_bf16_f32 v108, v88, v89
  v_exp_f32 v92, v92
  ds_read_b128 v[44:47], v3 offset:15360
  v_exp_f32 v93, v93
  v_cvt_pk_bf16_f32 v109, v90, v91
  v_exp_f32 v94, v94
  v_exp_f32 v95, v95
  v_cvt_pk_bf16_f32 v110, v92, v93
  v_cvt_pk_bf16_f32 v111, v94, v95
  v_mfma_f32_32x32x16_bf16 v[128:143], v[56:59], v[104:107], v[128:143]
  v_exp_f32 v64, v64
  v_exp_f32 v65, v65
  v_exp_f32 v66, v66
  v_mfma_f32_32x32x16_bf16 v[128:143], v[60:63], v[108:111], v[128:143]
  v_exp_f32 v67, v67
  v_cvt_pk_bf16_f32 v96, v64, v65
  v_exp_f32 v68, v68
  v_exp_f32 v69, v69
  v_cvt_pk_bf16_f32 v97, v66, v67
  v_mfma_f32_32x32x16_bf16 v[80:95], v[32:35], v[24:27], 0
  v_exp_f32 v70, v70
  v_exp_f32 v71, v71
  v_cvt_pk_bf16_f32 v98, v68, v69
  v_exp_f32 v72, v72
  v_mfma_f32_32x32x16_bf16 v[80:95], v[36:39], v[28:31], v[80:95]
  v_exp_f32 v73, v73
  v_cvt_pk_bf16_f32 v99, v70, v71
  v_exp_f32 v74, v74
  ds_read_b128 v[56:59], v3 offset:47104
  v_exp_f32 v75, v75
  v_cvt_pk_bf16_f32 v100, v72, v73
  v_exp_f32 v76, v76
  ds_read_b128 v[60:63], v3 offset:48128
  v_exp_f32 v77, v77
  v_cvt_pk_bf16_f32 v101, v74, v75
  v_exp_f32 v78, v78
  v_exp_f32 v79, v79
  v_cvt_pk_bf16_f32 v102, v76, v77
  v_cvt_pk_bf16_f32 v103, v78, v79
  s_waitcnt lgkmcnt(4)
  v_mfma_f32_32x32x16_bf16 v[112:127], v[48:51], v[96:99], v[112:127]
  v_exp_f32 v80, v80
  v_exp_f32 v81, v81
  v_exp_f32 v82, v82
  v_mfma_f32_32x32x16_bf16 v[112:127], v[52:55], v[100:103], v[112:127]
  v_exp_f32 v83, v83
  v_cvt_pk_bf16_f32 v104, v80, v81
  v_exp_f32 v84, v84
  v_exp_f32 v85, v85
  v_cvt_pk_bf16_f32 v105, v82, v83
  s_waitcnt lgkmcnt(2)
  v_mfma_f32_32x32x16_bf16 v[64:79], v[40:43], v[16:19], 0
  v_exp_f32 v86, v86
  v_exp_f32 v87, v87
  v_cvt_pk_bf16_f32 v106, v84, v85
  v_exp_f32 v88, v88
  v_mfma_f32_32x32x16_bf16 v[64:79], v[44:47], v[20:23], v[64:79]
  v_exp_f32 v89, v89
  v_cvt_pk_bf16_f32 v107, v86, v87
  v_exp_f32 v90, v90
  ds_read_b128 v[32:35], v3 offset:16384
  v_exp_f32 v91, v91
  v_cvt_pk_bf16_f32 v108, v88, v89
  v_exp_f32 v92, v92
  ds_read_b128 v[36:39], v3 offset:17408
  v_exp_f32 v93, v93
  v_cvt_pk_bf16_f32 v109, v90, v91
  v_exp_f32 v94, v94
  v_exp_f32 v95, v95
  v_cvt_pk_bf16_f32 v110, v92, v93
  v_cvt_pk_bf16_f32 v111, v94, v95
  v_mfma_f32_32x32x16_bf16 v[128:143], v[48:51], v[104:107], v[128:143]
  v_exp_f32 v64, v64
  v_exp_f32 v65, v65
  v_exp_f32 v66, v66
  v_mfma_f32_32x32x16_bf16 v[128:143], v[52:55], v[108:111], v[128:143]
  v_exp_f32 v67, v67
  v_cvt_pk_bf16_f32 v96, v64, v65
  v_exp_f32 v68, v68
  v_exp_f32 v69, v69
  v_cvt_pk_bf16_f32 v97, v66, v67
  v_mfma_f32_32x32x16_bf16 v[80:95], v[40:43], v[24:27], 0
  v_exp_f32 v70, v70
  v_exp_f32 v71, v71
  v_cvt_pk_bf16_f32 v98, v68, v69
  v_exp_f32 v72, v72
  v_mfma_f32_32x32x16_bf16 v[80:95], v[44:47], v[28:31], v[80:95]
  v_exp_f32 v73, v73
  v_cvt_pk_bf16_f32 v99, v70, v71
  v_exp_f32 v74, v74
  ds_read_b128 v[48:51], v3 offset:49152
  v_exp_f32 v75, v75
  v_cvt_pk_bf16_f32 v100, v72, v73
  v_exp_f32 v76, v76
  ds_read_b128 v[52:55], v3 offset:50176
  v_exp_f32 v77, v77
  v_cvt_pk_bf16_f32 v101, v74, v75
  v_exp_f32 v78, v78
  v_exp_f32 v79, v79
  v_cvt_pk_bf16_f32 v102, v76, v77
  v_cvt_pk_bf16_f32 v103, v78, v79
  s_waitcnt lgkmcnt(4)
  v_mfma_f32_32x32x16_bf16 v[112:127], v[56:59], v[96:99], v[112:127]
  v_exp_f32 v80, v80
  v_exp_f32 v81, v81
  v_exp_f32 v82, v82
  v_mfma_f32_32x32x16_bf16 v[112:127], v[60:63], v[100:103], v[112:127]
  v_exp_f32 v83, v83
  v_cvt_pk_bf16_f32 v104, v80, v81
  v_exp_f32 v84, v84
  v_exp_f32 v85, v85
  v_cvt_pk_bf16_f32 v105, v82, v83
  s_waitcnt lgkmcnt(2)
  v_mfma_f32_32x32x16_bf16 v[64:79], v[32:35], v[16:19], 0
  v_exp_f32 v86, v86
  v_exp_f32 v87, v87
  v_cvt_pk_bf16_f32 v106, v84, v85
  v_exp_f32 v88, v88
  v_mfma_f32_32x32x16_bf16 v[64:79], v[36:39], v[20:23], v[64:79]
  v_exp_f32 v89, v89
  v_cvt_pk_bf16_f32 v107, v86, v87
  v_exp_f32 v90, v90
  ds_read_b128 v[40:43], v3 offset:18432
  v_exp_f32 v91, v91
  v_cvt_pk_bf16_f32 v108, v88, v89
  v_exp_f32 v92, v92
  ds_read_b128 v[44:47], v3 offset:19456
  v_exp_f32 v93, v93
  v_cvt_pk_bf16_f32 v109, v90, v91
  v_exp_f32 v94, v94
  v_exp_f32 v95, v95
  v_cvt_pk_bf16_f32 v110, v92, v93
  v_cvt_pk_bf16_f32 v111, v94, v95
  v_mfma_f32_32x32x16_bf16 v[128:143], v[56:59], v[104:107], v[128:143]
  v_exp_f32 v64, v64
  v_exp_f32 v65, v65
  v_exp_f32 v66, v66
  v_mfma_f32_32x32x16_bf16 v[128:143], v[60:63], v[108:111], v[128:143]
  v_exp_f32 v67, v67
  v_cvt_pk_bf16_f32 v96, v64, v65
  v_exp_f32 v68, v68
  v_exp_f32 v69, v69
  v_cvt_pk_bf16_f32 v97, v66, v67
  v_mfma_f32_32x32x16_bf16 v[80:95], v[32:35], v[24:27], 0
  v_exp_f32 v70, v70
  v_exp_f32 v71, v71
  v_cvt_pk_bf16_f32 v98, v68, v69
  v_exp_f32 v72, v72
  v_mfma_f32_32x32x16_bf16 v[80:95], v[36:39], v[28:31], v[80:95]
  v_exp_f32 v73, v73
  v_cvt_pk_bf16_f32 v99, v70, v71
  v_exp_f32 v74, v74
  ds_read_b128 v[56:59], v3 offset:51200
  v_exp_f32 v75, v75
  v_cvt_pk_bf16_f32 v100, v72, v73
  v_exp_f32 v76, v76
  ds_read_b128 v[60:63], v3 offset:52224
  v_exp_f32 v77, v77
  v_cvt_pk_bf16_f32 v101, v74, v75
  v_exp_f32 v78, v78
  v_exp_f32 v79, v79
  v_cvt_pk_bf16_f32 v102, v76, v77
  v_cvt_pk_bf16_f32 v103, v78, v79
  s_waitcnt lgkmcnt(4)
  v_mfma_f32_32x32x16_bf16 v[112:127], v[48:51], v[96:99], v[112:127]
  v_exp_f32 v80, v80
  v_exp_f32 v81, v81
  v_exp_f32 v82, v82
  v_mfma_f32_32x32x16_bf16 v[112:127], v[52:55], v[100:103], v[112:127]
  v_exp_f32 v83, v83
  v_cvt_pk_bf16_f32 v104, v80, v81
  v_exp_f32 v84, v84
  v_exp_f32 v85, v85
  v_cvt_pk_bf16_f32 v105, v82, v83
  s_waitcnt lgkmcnt(2)
  v_mfma_f32_32x32x16_bf16 v[64:79], v[40:43], v[16:19], 0
  v_exp_f32 v86, v86
  v_exp_f32 v87, v87
  v_cvt_pk_bf16_f32 v106, v84, v85
  v_exp_f32 v88, v88
  v_mfma_f32_32x32x16_bf16 v[64:79], v[44:47], v[20:23], v[64:79]
  v_exp_f32 v89, v89
  v_cvt_pk_bf16_f32 v107, v86, v87
  v_exp_f32 v90, v90
  ds_read_b128 v[32:35], v3 offset:20480
  v_exp_f32 v91, v91
  v_cvt_pk_bf16_f32 v108, v88, v89
  v_exp_f32 v92, v92
  ds_read_b128 v[36:39], v3 offset:21504
  v_exp_f32 v93, v93
  v_cvt_pk_bf16_f32 v109, v90, v91
  v_exp_f32 v94, v94
  v_exp_f32 v95, v95
  v_cvt_pk_bf16_f32 v110, v92, v93
  v_cvt_pk_bf16_f32 v111, v94, v95
  v_mfma_f32_32x32x16_bf16 v[128:143], v[48:51], v[104:107], v[128:143]
  v_exp_f32 v64, v64
  v_exp_f32 v65, v65
  v_exp_f32 v66, v66
  v_mfma_f32_32x32x16_bf16 v[128:143], v[52:55], v[108:111], v[128:143]
  v_exp_f32 v67, v67
  v_cvt_pk_bf16_f32 v96, v64, v65
  v_exp_f32 v68, v68
  v_exp_f32 v69, v69
  v_cvt_pk_bf16_f32 v97, v66, v67
  v_mfma_f32_32x32x16_bf16 v[80:95], v[40:43], v[24:27], 0
  v_exp_f32 v70, v70
  v_exp_f32 v71, v71
  v_cvt_pk_bf16_f32 v98, v68, v69
  v_exp_f32 v72, v72
  v_mfma_f32_32x32x16_bf16 v[80:95], v[44:47], v[28:31], v[80:95]
  v_exp_f32 v73, v73
  v_cvt_pk_bf16_f32 v99, v70, v71
  v_exp_f32 v74, v74
  ds_read_b128 v[48:51], v3 offset:53248
  v_exp_f32 v75, v75
  v_cvt_pk_bf16_f32 v100, v72, v73
  v_exp_f32 v76, v76
  ds_read_b128 v[52:55], v3 offset:54272
  v_exp_f32 v77, v77
  v_cvt_pk_bf16_f32 v101, v74, v75
  v_exp_f32 v78, v78
  v_exp_f32 v79, v79
  v_cvt_pk_bf16_f32 v102, v76, v77
  v_cvt_pk_bf16_f32 v103, v78, v79
  s_waitcnt lgkmcnt(4)
  v_mfma_f32_32x32x16_bf16 v[112:127], v[56:59], v[96:99], v[112:127]
  v_exp_f32 v80, v80
  v_exp_f32 v81, v81
  v_exp_f32 v82, v82
  v_mfma_f32_32x32x16_bf16 v[112:127], v[60:63], v[100:103], v[112:127]
  v_exp_f32 v83, v83
  v_cvt_pk_bf16_f32 v104, v80, v81
  v_exp_f32 v84, v84
  v_exp_f32 v85, v85
  v_cvt_pk_bf16_f32 v105, v82, v83
  s_waitcnt lgkmcnt(2)
  v_mfma_f32_32x32x16_bf16 v[64:79], v[32:35], v[16:19], 0
  v_exp_f32 v86, v86
  v_exp_f32 v87, v87
  v_cvt_pk_bf16_f32 v106, v84, v85
  v_exp_f32 v88, v88
  v_mfma_f32_32x32x16_bf16 v[64:79], v[36:39], v[20:23], v[64:79]
  v_exp_f32 v89, v89
  v_cvt_pk_bf16_f32 v107, v86, v87
  v_exp_f32 v90, v90
  ds_read_b128 v[40:43], v3 offset:22528
  v_exp_f32 v91, v91
  v_cvt_pk_bf16_f32 v108, v88, v89
  v_exp_f32 v92, v92
  ds_read_b128 v[44:47], v3 offset:23552
  v_exp_f32 v93, v93
  v_cvt_pk_bf16_f32 v109, v90, v91
  v_exp_f32 v94, v94
  v_exp_f32 v95, v95
  v_cvt_pk_bf16_f32 v110, v92, v93
  v_cvt_pk_bf16_f32 v111, v94, v95
  v_mfma_f32_32x32x16_bf16 v[128:143], v[56:59], v[104:107], v[128:143]
  v_exp_f32 v64, v64
  v_exp_f32 v65, v65
  v_exp_f32 v66, v66
  v_mfma_f32_32x32x16_bf16 v[128:143], v[60:63], v[108:111], v[128:143]
  v_exp_f32 v67, v67
  v_cvt_pk_bf16_f32 v96, v64, v65
  v_exp_f32 v68, v68
  v_exp_f32 v69, v69
  v_cvt_pk_bf16_f32 v97, v66, v67
  v_mfma_f32_32x32x16_bf16 v[80:95], v[32:35], v[24:27], 0
  v_exp_f32 v70, v70
  v_exp_f32 v71, v71
  v_cvt_pk_bf16_f32 v98, v68, v69
  v_exp_f32 v72, v72
  v_mfma_f32_32x32x16_bf16 v[80:95], v[36:39], v[28:31], v[80:95]
  v_exp_f32 v73, v73
  v_cvt_pk_bf16_f32 v99, v70, v71
  v_exp_f32 v74, v74
  ds_read_b128 v[56:59], v3 offset:55296
  v_exp_f32 v75, v75
  v_cvt_pk_bf16_f32 v100, v72, v73
  v_exp_f32 v76, v76
  ds_read_b128 v[60:63], v3 offset:56320
  v_exp_f32 v77, v77
  v_cvt_pk_bf16_f32 v101, v74, v75
  v_exp_f32 v78, v78
  v_exp_f32 v79, v79
  v_cvt_pk_bf16_f32 v102, v76, v77
  v_cvt_pk_bf16_f32 v103, v78, v79
  s_waitcnt lgkmcnt(4)
  v_mfma_f32_32x32x16_bf16 v[112:127], v[48:51], v[96:99], v[112:127]
  v_exp_f32 v80, v80
  v_exp_f32 v81, v81
  v_exp_f32 v82, v82
  v_mfma_f32_32x32x16_bf16 v[112:127], v[52:55], v[100:103], v[112:127]
  v_exp_f32 v83, v83
  v_cvt_pk_bf16_f32 v104, v80, v81
  v_exp_f32 v84, v84
  v_exp_f32 v85, v85
  v_cvt_pk_bf16_f32 v105, v82, v83
  s_waitcnt lgkmcnt(2)
  v_mfma_f32_32x32x16_bf16 v[64:79], v[40:43], v[16:19], 0
  v_exp_f32 v86, v86
  v_exp_f32 v87, v87
  v_cvt_pk_bf16_f32 v106, v84, v85
  v_exp_f32 v88, v88
  v_mfma_f32_32x32x16_bf16 v[64:79], v[44:47], v[20:23], v[64:79]
  v_exp_f32 v89, v89
  v_cvt_pk_bf16_f32 v107, v86, v87
  v_exp_f32 v90, v90
  ds_read_b128 v[32:35], v3 offset:24576
  v_exp_f32 v91, v91
  v_cvt_pk_bf16_f32 v108, v88, v89
  v_exp_f32 v92, v92
  ds_read_b128 v[36:39], v3 offset:25600
  v_exp_f32 v93, v93
  v_cvt_pk_bf16_f32 v109, v90, v91
  v_exp_f32 v94, v94
  v_exp_f32 v95, v95
  v_cvt_pk_bf16_f32 v110, v92, v93
  v_cvt_pk_bf16_f32 v111, v94, v95
  v_mfma_f32_32x32x16_bf16 v[128:143], v[48:51], v[104:107], v[128:143]
  v_exp_f32 v64, v64
  v_exp_f32 v65, v65
  v_exp_f32 v66, v66
  v_mfma_f32_32x32x16_bf16 v[128:143], v[52:55], v[108:111], v[128:143]
  v_exp_f32 v67, v67
  v_cvt_pk_bf16_f32 v96, v64, v65
  v_exp_f32 v68, v68
  v_exp_f32 v69, v69
  v_cvt_pk_bf16_f32 v97, v66, v67
  v_mfma_f32_32x32x16_bf16 v[80:95], v[40:43], v[24:27], 0
  v_exp_f32 v70, v70
  v_exp_f32 v71, v71
  v_cvt_pk_bf16_f32 v98, v68, v69
  v_exp_f32 v72, v72
  v_mfma_f32_32x32x16_bf16 v[80:95], v[44:47], v[28:31], v[80:95]
  v_exp_f32 v73, v73
  v_cvt_pk_bf16_f32 v99, v70, v71
  v_exp_f32 v74, v74
  ds_read_b128 v[48:51], v3 offset:57344
  v_exp_f32 v75, v75
  v_cvt_pk_bf16_f32 v100, v72, v73
  v_exp_f32 v76, v76
  ds_read_b128 v[52:55], v3 offset:58368
  v_exp_f32 v77, v77
  v_cvt_pk_bf16_f32 v101, v74, v75
  v_exp_f32 v78, v78
  v_exp_f32 v79, v79
  v_cvt_pk_bf16_f32 v102, v76, v77
  v_cvt_pk_bf16_f32 v103, v78, v79
  s_waitcnt lgkmcnt(4)
  v_mfma_f32_32x32x16_bf16 v[112:127], v[56:59], v[96:99], v[112:127]
  v_exp_f32 v80, v80
  v_exp_f32 v81, v81
  v_exp_f32 v82, v82
  v_mfma_f32_32x32x16_bf16 v[112:127], v[60:63], v[100:103], v[112:127]
  v_exp_f32 v83, v83
  v_cvt_pk_bf16_f32 v104, v80, v81
  v_exp_f32 v84, v84
  v_exp_f32 v85, v85
  v_cvt_pk_bf16_f32 v105, v82, v83
  s_waitcnt lgkmcnt(2)
  v_mfma_f32_32x32x16_bf16 v[64:79], v[32:35], v[16:19], 0
  v_exp_f32 v86, v86
  v_exp_f32 v87, v87
  v_cvt_pk_bf16_f32 v106, v84, v85
  v_exp_f32 v88, v88
  v_mfma_f32_32x32x16_bf16 v[64:79], v[36:39], v[20:23], v[64:79]
  v_exp_f32 v89, v89
  v_cvt_pk_bf16_f32 v107, v86, v87
  v_exp_f32 v90, v90
  ds_read_b128 v[40:43], v3 offset:26624
  v_exp_f32 v91, v91
  v_cvt_pk_bf16_f32 v108, v88, v89
  v_exp_f32 v92, v92
  ds_read_b128 v[44:47], v3 offset:27648
  v_exp_f32 v93, v93
  v_cvt_pk_bf16_f32 v109, v90, v91
  v_exp_f32 v94, v94
  v_exp_f32 v95, v95
  v_cvt_pk_bf16_f32 v110, v92, v93
  v_cvt_pk_bf16_f32 v111, v94, v95
  v_mfma_f32_32x32x16_bf16 v[128:143], v[56:59], v[104:107], v[128:143]
  v_exp_f32 v64, v64
  v_exp_f32 v65, v65
  v_exp_f32 v66, v66
  v_mfma_f32_32x32x16_bf16 v[128:143], v[60:63], v[108:111], v[128:143]
  v_exp_f32 v67, v67
  v_cvt_pk_bf16_f32 v96, v64, v65
  v_exp_f32 v68, v68
  v_exp_f32 v69, v69
  v_cvt_pk_bf16_f32 v97, v66, v67
  v_mfma_f32_32x32x16_bf16 v[80:95], v[32:35], v[24:27], 0
  v_exp_f32 v70, v70
  v_exp_f32 v71, v71
  v_cvt_pk_bf16_f32 v98, v68, v69
  v_exp_f32 v72, v72
  v_mfma_f32_32x32x16_bf16 v[80:95], v[36:39], v[28:31], v[80:95]
  v_exp_f32 v73, v73
  v_cvt_pk_bf16_f32 v99, v70, v71
  v_exp_f32 v74, v74
  ds_read_b128 v[56:59], v3 offset:59392
  v_exp_f32 v75, v75
  v_cvt_pk_bf16_f32 v100, v72, v73
  v_exp_f32 v76, v76
  ds_read_b128 v[60:63], v3 offset:60416
  v_exp_f32 v77, v77
  v_cvt_pk_bf16_f32 v101, v74, v75
  v_exp_f32 v78, v78
  v_exp_f32 v79, v79
  v_cvt_pk_bf16_f32 v102, v76, v77
  v_cvt_pk_bf16_f32 v103, v78, v79
  s_waitcnt lgkmcnt(4)
  v_mfma_f32_32x32x16_bf16 v[112:127], v[48:51], v[96:99], v[112:127]
  v_exp_f32 v80, v80
  v_exp_f32 v81, v81
  v_exp_f32 v82, v82
  v_mfma_f32_32x32x16_bf16 v[112:127], v[52:55], v[100:103], v[112:127]
  v_exp_f32 v83, v83
  v_cvt_pk_bf16_f32 v104, v80, v81
  v_exp_f32 v84, v84
  v_exp_f32 v85, v85
  v_cvt_pk_bf16_f32 v105, v82, v83
  s_waitcnt lgkmcnt(2)
  v_mfma_f32_32x32x16_bf16 v[64:79], v[40:43], v[16:19], 0
  v_exp_f32 v86, v86
  v_exp_f32 v87, v87
  v_cvt_pk_bf16_f32 v106, v84, v85
  v_exp_f32 v88, v88
  v_mfma_f32_32x32x16_bf16 v[64:79], v[44:47], v[20:23], v[64:79]
  v_exp_f32 v89, v89
  v_cvt_pk_bf16_f32 v107, v86, v87
  v_exp_f32 v90, v90
  ds_read_b128 v[32:35], v3 offset:28672
  v_exp_f32 v91, v91
  v_cvt_pk_bf16_f32 v108, v88, v89
  v_exp_f32 v92, v92
  ds_read_b128 v[36:39], v3 offset:29696
  v_exp_f32 v93, v93
  v_cvt_pk_bf16_f32 v109, v90, v91
  v_exp_f32 v94, v94
  v_exp_f32 v95, v95
  v_cvt_pk_bf16_f32 v110, v92, v93
  v_cvt_pk_bf16_f32 v111, v94, v95
  v_mfma_f32_32x32x16_bf16 v[128:143], v[48:51], v[104:107], v[128:143]
  v_exp_f32 v64, v64
  v_exp_f32 v65, v65
  v_exp_f32 v66, v66
  v_mfma_f32_32x32x16_bf16 v[128:143], v[52:55], v[108:111], v[128:143]
  v_exp_f32 v67, v67
  v_cvt_pk_bf16_f32 v96, v64, v65
  v_exp_f32 v68, v68
  v_exp_f32 v69, v69
  v_cvt_pk_bf16_f32 v97, v66, v67
  v_mfma_f32_32x32x16_bf16 v[80:95], v[40:43], v[24:27], 0
  v_exp_f32 v70, v70
  v_exp_f32 v71, v71
  v_cvt_pk_bf16_f32 v98, v68, v69
  v_exp_f32 v72, v72
  v_mfma_f32_32x32x16_bf16 v[80:95], v[44:47], v[28:31], v[80:95]
  v_exp_f32 v73, v73
  v_cvt_pk_bf16_f32 v99, v70, v71
  v_exp_f32 v74, v74
  ds_read_b128 v[48:51], v3 offset:61440
  v_exp_f32 v75, v75
  v_cvt_pk_bf16_f32 v100, v72, v73
  v_exp_f32 v76, v76
  ds_read_b128 v[52:55], v3 offset:62464
  v_exp_f32 v77, v77
  v_cvt_pk_bf16_f32 v101, v74, v75
  v_exp_f32 v78, v78
  v_exp_f32 v79, v79
  v_cvt_pk_bf16_f32 v102, v76, v77
  v_cvt_pk_bf16_f32 v103, v78, v79
  s_waitcnt lgkmcnt(4)
  v_mfma_f32_32x32x16_bf16 v[112:127], v[56:59], v[96:99], v[112:127]
  v_exp_f32 v80, v80
  v_exp_f32 v81, v81
  v_exp_f32 v82, v82
  v_mfma_f32_32x32x16_bf16 v[112:127], v[60:63], v[100:103], v[112:127]
  v_exp_f32 v83, v83
  v_cvt_pk_bf16_f32 v104, v80, v81
  v_exp_f32 v84, v84
  v_exp_f32 v85, v85
  v_cvt_pk_bf16_f32 v105, v82, v83
  s_waitcnt lgkmcnt(2)
  v_mfma_f32_32x32x16_bf16 v[64:79], v[32:35], v[16:19], 0
  v_exp_f32 v86, v86
  v_exp_f32 v87, v87
  v_cvt_pk_bf16_f32 v106, v84, v85
  v_exp_f32 v88, v88
  v_mfma_f32_32x32x16_bf16 v[64:79], v[36:39], v[20:23], v[64:79]
  v_exp_f32 v89, v89
  v_cvt_pk_bf16_f32 v107, v86, v87
  v_exp_f32 v90, v90
  ds_read_b128 v[40:43], v3 offset:30720
  v_exp_f32 v91, v91
  v_cvt_pk_bf16_f32 v108, v88, v89
  v_exp_f32 v92, v92
  ds_read_b128 v[44:47], v3 offset:31744
  v_exp_f32 v93, v93
  v_cvt_pk_bf16_f32 v109, v90, v91
  v_exp_f32 v94, v94
  v_exp_f32 v95, v95
  v_cvt_pk_bf16_f32 v110, v92, v93
  v_cvt_pk_bf16_f32 v111, v94, v95
  v_mfma_f32_32x32x16_bf16 v[128:143], v[56:59], v[104:107], v[128:143]
  v_exp_f32 v64, v64
  v_exp_f32 v65, v65
  v_exp_f32 v66, v66
  v_mfma_f32_32x32x16_bf16 v[128:143], v[60:63], v[108:111], v[128:143]
  v_exp_f32 v67, v67
  v_cvt_pk_bf16_f32 v96, v64, v65
  v_exp_f32 v68, v68
  v_exp_f32 v69, v69
  v_cvt_pk_bf16_f32 v97, v66, v67
  v_mfma_f32_32x32x16_bf16 v[80:95], v[32:35], v[24:27], 0
  v_exp_f32 v70, v70
  v_exp_f32 v71, v71
  v_cvt_pk_bf16_f32 v98, v68, v69
  v_exp_f32 v72, v72
  v_mfma_f32_32x32x16_bf16 v[80:95], v[36:39], v[28:31], v[80:95]
  v_exp_f32 v73, v73
  v_cvt_pk_bf16_f32 v99, v70, v71
  v_exp_f32 v74, v74
  ds_read_b128 v[56:59], v3 offset:63488
  v_exp_f32 v75, v75
  v_cvt_pk_bf16_f32 v100, v72, v73
  v_exp_f32 v76, v76
  ds_read_b128 v[60:63], v3 offset:64512
  v_exp_f32 v77, v77
  v_cvt_pk_bf16_f32 v101, v74, v75
  v_exp_f32 v78, v78
  v_exp_f32 v79, v79
  v_cvt_pk_bf16_f32 v102, v76, v77
  v_cvt_pk_bf16_f32 v103, v78, v79
  s_waitcnt lgkmcnt(4)
  v_mfma_f32_32x32x16_bf16 v[112:127], v[48:51], v[96:99], v[112:127]
  v_exp_f32 v80, v80
  v_exp_f32 v81, v81
  v_exp_f32 v82, v82
  v_mfma_f32_32x32x16_bf16 v[112:127], v[52:55], v[100:103], v[112:127]
  v_exp_f32 v83, v83
  v_cvt_pk_bf16_f32 v104, v80, v81
  v_exp_f32 v84, v84
  v_exp_f32 v85, v85
  v_cvt_pk_bf16_f32 v105, v82, v83
  s_waitcnt lgkmcnt(2)
  v_mfma_f32_32x32x16_bf16 v[64:79], v[40:43], v[16:19], 0
  v_exp_f32 v86, v86
  v_exp_f32 v87, v87
  v_cvt_pk_bf16_f32 v106, v84, v85
  v_exp_f32 v88, v88
  v_mfma_f32_32x32x16_bf16 v[64:79], v[44:47], v[20:23], v[64:79]
  v_exp_f32 v89, v89
  v_cvt_pk_bf16_f32 v107, v86, v87
  v_exp_f32 v90, v90
  v_exp_f32 v91, v91
  v_cvt_pk_bf16_f32 v108, v88, v89
  v_exp_f32 v92, v92
  v_exp_f32 v93, v93
  v_cvt_pk_bf16_f32 v109, v90, v91
  v_exp_f32 v94, v94
  v_exp_f32 v95, v95
  v_cvt_pk_bf16_f32 v110, v92, v93
  v_cvt_pk_bf16_f32 v111, v94, v95
  v_mfma_f32_32x32x16_bf16 v[128:143], v[48:51], v[104:107], v[128:143]
  v_exp_f32 v64, v64
  v_exp_f32 v65, v65
  v_exp_f32 v66, v66
  v_mfma_f32_32x32x16_bf16 v[128:143], v[52:55], v[108:111], v[128:143]
  v_exp_f32 v67, v67
  v_cvt_pk_bf16_f32 v96, v64, v65
  v_exp_f32 v68, v68
  v_exp_f32 v69, v69
  v_cvt_pk_bf16_f32 v97, v66, v67
  v_mfma_f32_32x32x16_bf16 v[80:95], v[40:43], v[24:27], 0
  v_exp_f32 v70, v70
  v_exp_f32 v71, v71
  v_cvt_pk_bf16_f32 v98, v68, v69
  v_exp_f32 v72, v72
  v_mfma_f32_32x32x16_bf16 v[80:95], v[44:47], v[28:31], v[80:95]
  v_exp_f32 v73, v73
  v_cvt_pk_bf16_f32 v99, v70, v71
  v_exp_f32 v74, v74
  v_exp_f32 v75, v75
  v_cvt_pk_bf16_f32 v100, v72, v73
  v_exp_f32 v76, v76
  v_exp_f32 v77, v77
  v_cvt_pk_bf16_f32 v101, v74, v75
  v_exp_f32 v78, v78
  v_exp_f32 v79, v79
  v_cvt_pk_bf16_f32 v102, v76, v77
  v_cvt_pk_bf16_f32 v103, v78, v79
  s_waitcnt lgkmcnt(0)
  v_mfma_f32_32x32x16_bf16 v[112:127], v[56:59], v[96:99], v[112:127]
  v_exp_f32 v80, v80
  v_exp_f32 v81, v81
  v_exp_f32 v82, v82
  v_mfma_f32_32x32x16_bf16 v[112:127], v[60:63], v[100:103], v[112:127]
  v_exp_f32 v83, v83
  v_cvt_pk_bf16_f32 v104, v80, v81
  v_exp_f32 v84, v84
  v_exp_f32 v85, v85
  v_cvt_pk_bf16_f32 v105, v82, v83
  v_exp_f32 v86, v86
  v_exp_f32 v87, v87
  v_cvt_pk_bf16_f32 v106, v84, v85
  v_exp_f32 v88, v88
  v_exp_f32 v89, v89
  v_cvt_pk_bf16_f32 v107, v86, v87
  v_exp_f32 v90, v90
  v_exp_f32 v91, v91
  v_cvt_pk_bf16_f32 v108, v88, v89
  v_exp_f32 v92, v92
  v_exp_f32 v93, v93
  v_cvt_pk_bf16_f32 v109, v90, v91
  v_exp_f32 v94, v94
  v_exp_f32 v95, v95
  v_cvt_pk_bf16_f32 v110, v92, v93
  v_cvt_pk_bf16_f32 v111, v94, v95
  s_nop 1
  v_mfma_f32_32x32x16_bf16 v[128:143], v[56:59], v[104:107], v[128:143]
  v_mfma_f32_32x32x16_bf16 v[128:143], v[60:63], v[108:111], v[128:143]
  s_waitcnt vmcnt(0)
  s_barrier
  s_add_u32 s41, s41, 1
  s_cmp_ge_u32 s41, 4
  s_cbranch_scc1 nd_97
  s_mul_i32 s30, s41, 32768
  s_lshl_b32 s31, s21, 13
  s_add_u32 s30, s30, s31
  s_add_u32 m0, s31, 0
  s_add_u32 s29, s30, s27
  s_add_u32 s29, s29, 0
  buffer_load_dwordx4 v2, s[8:11], s29 offen lds
  s_add_u32 m0, s31, 1024
  s_add_u32 s29, s30, s27
  s_add_u32 s29, s29, 1024
  buffer_load_dwordx4 v2, s[8:11], s29 offen lds
  s_add_u32 m0, s31, 2048
  s_add_u32 s29, s30, s27
  s_add_u32 s29, s29, 2048
  buffer_load_dwordx4 v2, s[8:11], s29 offen lds
  s_add_u32 m0, s31, 3072
  s_add_u32 s29, s30, s27
  s_add_u32 s29, s29, 3072
  buffer_load_dwordx4 v2, s[8:11], s29 offen lds
  s_add_u32 m0, s31, 4096
  s_add_u32 s29, s30, s27
  s_add_u32 s29, s29, 4096
  buffer_load_dwordx4 v2, s[8:11], s29 offen lds
  s_add_u32 m0, s31, 5120
  s_add_u32 s29, s30, s27
  s_add_u32 s29, s29, 5120
  buffer_load_dwordx4 v2, s[8:11], s29 offen lds
  s_add_u32 m0, s31, 6144
  s_add_u32 s29, s30, s27
  s_add_u32 s29, s29, 6144
  buffer_load_dwordx4 v2, s[8:11], s29 offen lds
  s_add_u32 m0, s31, 7168
  s_add_u32 s29, s30, s27
  s_add_u32 s29, s29, 7168
  buffer_load_dwordx4 v2, s[8:11], s29 offen lds
  s_add_u32 m0, s31, 32768
  s_add_u32 s29, s30, s28
  s_add_u32 s29, s29, 0
  buffer_load_dwordx4 v2, s[8:11], s29 offen lds
  s_add_u32 m0, s31, 33792
  s_add_u32 s29, s30, s28
  s_add_u32 s29, s29, 1024
  buffer_load_dwordx4 v2, s[8:11], s29 offen lds
  s_add_u32 m0, s31, 34816
  s_add_u32 s29, s30, s28
  s_add_u32 s29, s29, 2048
  buffer_load_dwordx4 v2, s[8:11], s29 offen lds
  s_add_u32 m0, s31, 35840
  s_add_u32 s29, s30, s28
  s_add_u32 s29, s29, 3072
  buffer_load_dwordx4 v2, s[8:11], s29 offen lds
  s_add_u32 m0, s31, 36864
  s_add_u32 s29, s30, s28
  s_add_u32 s29, s29, 4096
  buffer_load_dwordx4 v2, s[8:11], s29 offen lds
  s_add_u32 m0, s31, 37888
  s_add_u32 s29, s30, s28
  s_add_u32 s29, s29, 5120
  buffer_load_dwordx4 v2, s[8:11], s29 offen lds
  s_add_u32 m0, s31, 38912
  s_add_u32 s29, s30, s28
  s_add_u32 s29, s29, 6144
  buffer_load_dwordx4 v2, s[8:11], s29 offen lds
  s_add_u32 m0, s31, 39936
  s_add_u32 s29, s30, s28
  s_add_u32 s29, s29, 7168
  buffer_load_dwordx4 v2, s[8:11], s29 offen lds
nd_97:
  ds_read_b128 v[32:35], v4 offset:0
  ds_read_b128 v[36:39], v4 offset:1024
  ds_read_b128 v[48:51], v4 offset:32768
  ds_read_b128 v[52:55], v4 offset:33792
  ds_read_b128 v[40:43], v4 offset:2048
  ds_read_b128 v[44:47], v4 offset:3072
  s_waitcnt lgkmcnt(4)
  v_mfma_f32_32x32x16_bf16 v[64:79], v[32:35], v[16:19], 0
  v_mfma_f32_32x32x16_bf16 v[64:79], v[36:39], v[20:23], v[64:79]
  s_nop 11
  v_exp_f32 v64, v64
  v_exp_f32 v65, v65
  v_exp_f32 v66, v66
  v_exp_f32 v67, v67
  v_cvt_pk_bf16_f32 v96, v64, v65
  v_exp_f32 v68, v68
  v_exp_f32 v69, v69
  v_cvt_pk_bf16_f32 v97, v66, v67
  v_mfma_f32_32x32x16_bf16 v[80:95], v[32:35], v[24:27], 0
  v_exp_f32 v70, v70
  v_exp_f32 v71, v71
  v_cvt_pk_bf16_f32 v98, v68, v69
  v_exp_f32 v72, v72
  v_mfma_f32_32x32x16_bf16 v[80:95], v[36:39], v[28:31], v[80:95]
  v_exp_f32 v73, v73
  v_cvt_pk_bf16_f32 v99, v70, v71
  v_exp_f32 v74, v74
  ds_read_b128 v[56:59], v4 offset:34816
  v_exp_f32 v75, v75
  v_cvt_pk_bf16_f32 v100, v72, v73
  v_exp_f32 v76, v76
  ds_read_b128 v[60:63], v4 offset:35840
  v_exp_f32 v77, v77
  v_cvt_pk_bf16_f32 v101, v74, v75
  v_exp_f32 v78, v78
  v_exp_f32 v79, v79
  v_cvt_pk_bf16_f32 v102, v76, v77
  v_cvt_pk_bf16_f32 v103, v78, v79
  s_waitcnt lgkmcnt(4)
  v_mfma_f32_32x32x16_bf16 v[112:127], v[48:51], v[96:99], v[112:127]
  v_exp_f32 v80, v80
  v_exp_f32 v81, v81
  v_exp_f32 v82, v82
  v_mfma_f32_32x32x16_bf16 v[112:127], v[52:55], v[100:103], v[112:127]
  v_exp_f32 v83, v83
  v_cvt_pk_bf16_f32 v104, v80, v81
  v_exp_f32 v84, v84
  v_exp_f32 v85, v85
  v_cvt_pk_bf16_f32 v105, v82, v83
  s_waitcnt lgkmcnt(2)
  v_mfma_f32_32x32x16_bf16 v[64:79], v[40:43], v[16:19], 0
  v_exp_f32 v86, v86
  v_exp_f32 v87, v87
  v_cvt_pk_bf16_f32 v106, v84, v85
  v_exp_f32 v88, v88
  v_mfma_f32_32x32x16_bf16 v[64:79], v[44:47], v[20:23], v[64:79]
  v_exp_f32 v89, v89
  v_cvt_pk_bf16_f32 v107, v86, v87
  v_exp_f32 v90, v90
  ds_read_b128 v[32:35], v4 offset:4096
  v_exp_f32 v91, v91
  v_cvt_pk_bf16_f32 v108, v88, v89
  v_exp_f32 v92, v92
  ds_read_b128 v[36:39], v4 offset:5120
  v_exp_f32 v93, v93
  v_cvt_pk_bf16_f32 v109, v90, v91
  v_exp_f32 v94, v94
  v_exp_f32 v95, v95
  v_cvt_pk_bf16_f32 v110, v92, v93
  v_cvt_pk_bf16_f32 v111, v94, v95
  v_mfma_f32_32x32x16_bf16 v[128:143], v[48:51], v[104:107], v[128:143]
  v_exp_f32 v64, v64
  v_exp_f32 v65, v65
  v_exp_f32 v66, v66
  v_mfma_f32_32x32x16_bf16 v[128:143], v[52:55], v[108:111], v[128:143]
  v_exp_f32 v67, v67
  v_cvt_pk_bf16_f32 v96, v64, v65
  v_exp_f32 v68, v68
  v_exp_f32 v69, v69
  v_cvt_pk_bf16_f32 v97, v66, v67
  v_mfma_f32_32x32x16_bf16 v[80:95], v[40:43], v[24:27], 0
  v_exp_f32 v70, v70
  v_exp_f32 v71, v71
  v_cvt_pk_bf16_f32 v98, v68, v69
  v_exp_f32 v72, v72
  v_mfma_f32_32x32x16_bf16 v[80:95], v[44:47], v[28:31], v[80:95]
  v_exp_f32 v73, v73
  v_cvt_pk_bf16_f32 v99, v70, v71
  v_exp_f32 v74, v74
  ds_read_b128 v[48:51], v4 offset:36864
  v_exp_f32 v75, v75
  v_cvt_pk_bf16_f32 v100, v72, v73
  v_exp_f32 v76, v76
  ds_read_b128 v[52:55], v4 offset:37888
  v_exp_f32 v77, v77
  v_cvt_pk_bf16_f32 v101, v74, v75
  v_exp_f32 v78, v78
  v_exp_f32 v79, v79
  v_cvt_pk_bf16_f32 v102, v76, v77
  v_cvt_pk_bf16_f32 v103, v78, v79
  s_waitcnt lgkmcnt(4)
  v_mfma_f32_32x32x16_bf16 v[112:127], v[56:59], v[96:99], v[112:127]
  v_exp_f32 v80, v80
  v_exp_f32 v81, v81
  v_exp_f32 v82, v82
  v_mfma_f32_32x32x16_bf16 v[112:127], v[60:63], v[100:103], v[112:127]
  v_exp_f32 v83, v83
  v_cvt_pk_bf16_f32 v104, v80, v81
  v_exp_f32 v84, v84
  v_exp_f32 v85, v85
  v_cvt_pk_bf16_f32 v105, v82, v83
  s_waitcnt lgkmcnt(2)
  v_mfma_f32_32x32x16_bf16 v[64:79], v[32:35], v[16:19], 0
  v_exp_f32 v86, v86
  v_exp_f32 v87, v87
  v_cvt_pk_bf16_f32 v106, v84, v85
  v_exp_f32 v88, v88
  v_mfma_f32_32x32x16_bf16 v[64:79], v[36:39], v[20:23], v[64:79]
  v_exp_f32 v89, v89
  v_cvt_pk_bf16_f32 v107, v86, v87
  v_exp_f32 v90, v90
  ds_read_b128 v[40:43], v4 offset:6144
  v_exp_f32 v91, v91
  v_cvt_pk_bf16_f32 v108, v88, v89
  v_exp_f32 v92, v92
  ds_read_b128 v[44:47], v4 offset:7168
  v_exp_f32 v93, v93
  v_cvt_pk_bf16_f32 v109, v90, v91
  v_exp_f32 v94, v94
  v_exp_f32 v95, v95
  v_cvt_pk_bf16_f32 v110, v92, v93
  v_cvt_pk_bf16_f32 v111, v94, v95
  v_mfma_f32_32x32x16_bf16 v[128:143], v[56:59], v[104:107], v[128:143]
  v_exp_f32 v64, v64
  v_exp_f32 v65, v65
  v_exp_f32 v66, v66
  v_mfma_f32_32x32x16_bf16 v[128:143], v[60:63], v[108:111], v[128:143]
  v_exp_f32 v67, v67
  v_cvt_pk_bf16_f32 v96, v64, v65
  v_exp_f32 v68, v68
  v_exp_f32 v69, v69
  v_cvt_pk_bf16_f32 v97, v66, v67
  v_mfma_f32_32x32x16_bf16 v[80:95], v[32:35], v[24:27], 0
  v_exp_f32 v70, v70
  v_exp_f32 v71, v71
  v_cvt_pk_bf16_f32 v98, v68, v69
  v_exp_f32 v72, v72
  v_mfma_f32_32x32x16_bf16 v[80:95], v[36:39], v[28:31], v[80:95]
  v_exp_f32 v73, v73
  v_cvt_pk_bf16_f32 v99, v70, v71
  v_exp_f32 v74, v74
  ds_read_b128 v[56:59], v4 offset:38912
  v_exp_f32 v75, v75
  v_cvt_pk_bf16_f32 v100, v72, v73
  v_exp_f32 v76, v76
  ds_read_b128 v[60:63], v4 offset:39936
  v_exp_f32 v77, v77
  v_cvt_pk_bf16_f32 v101, v74, v75
  v_exp_f32 v78, v78
  v_exp_f32 v79, v79
  v_cvt_pk_bf16_f32 v102, v76, v77
  v_cvt_pk_bf16_f32 v103, v78, v79
  s_waitcnt lgkmcnt(4)
  v_mfma_f32_32x32x16_bf16 v[112:127], v[48:51], v[96:99], v[112:127]
  v_exp_f32 v80, v80
  v_exp_f32 v81, v81
  v_exp_f32 v82, v82
  v_mfma_f32_32x32x16_bf16 v[112:127], v[52:55], v[100:103], v[112:127]
  v_exp_f32 v83, v83
  v_cvt_pk_bf16_f32 v104, v80, v81
  v_exp_f32 v84, v84
  v_exp_f32 v85, v85
  v_cvt_pk_bf16_f32 v105, v82, v83
  s_waitcnt lgkmcnt(2)
  v_mfma_f32_32x32x16_bf16 v[64:79], v[40:43], v[16:19], 0
  v_exp_f32 v86, v86
  v_exp_f32 v87, v87
  v_cvt_pk_bf16_f32 v106, v84, v85
  v_exp_f32 v88, v88
  v_mfma_f32_32x32x16_bf16 v[64:79], v[44:47], v[20:23], v[64:79]
  v_exp_f32 v89, v89
  v_cvt_pk_bf16_f32 v107, v86, v87
  v_exp_f32 v90, v90
  ds_read_b128 v[32:35], v4 offset:8192
  v_exp_f32 v91, v91
  v_cvt_pk_bf16_f32 v108, v88, v89
  v_exp_f32 v92, v92
  ds_read_b128 v[36:39], v4 offset:9216
  v_exp_f32 v93, v93
  v_cvt_pk_bf16_f32 v109, v90, v91
  v_exp_f32 v94, v94
  v_exp_f32 v95, v95
  v_cvt_pk_bf16_f32 v110, v92, v93
  v_cvt_pk_bf16_f32 v111, v94, v95
  v_mfma_f32_32x32x16_bf16 v[128:143], v[48:51], v[104:107], v[128:143]
  v_exp_f32 v64, v64
  v_exp_f32 v65, v65
  v_exp_f32 v66, v66
  v_mfma_f32_32x32x16_bf16 v[128:143], v[52:55], v[108:111], v[128:143]
  v_exp_f32 v67, v67
  v_cvt_pk_bf16_f32 v96, v64, v65
  v_exp_f32 v68, v68
  v_exp_f32 v69, v69
  v_cvt_pk_bf16_f32 v97, v66, v67
  v_mfma_f32_32x32x16_bf16 v[80:95], v[40:43], v[24:27], 0
  v_exp_f32 v70, v70
  v_exp_f32 v71, v71
  v_cvt_pk_bf16_f32 v98, v68, v69
  v_exp_f32 v72, v72
  v_mfma_f32_32x32x16_bf16 v[80:95], v[44:47], v[28:31], v[80:95]
  v_exp_f32 v73, v73
  v_cvt_pk_bf16_f32 v99, v70, v71
  v_exp_f32 v74, v74
  ds_read_b128 v[48:51], v4 offset:40960
  v_exp_f32 v75, v75
  v_cvt_pk_bf16_f32 v100, v72, v73
  v_exp_f32 v76, v76
  ds_read_b128 v[52:55], v4 offset:41984
  v_exp_f32 v77, v77
  v_cvt_pk_bf16_f32 v101, v74, v75
  v_exp_f32 v78, v78
  v_exp_f32 v79, v79
  v_cvt_pk_bf16_f32 v102, v76, v77
  v_cvt_pk_bf16_f32 v103, v78, v79
  s_waitcnt lgkmcnt(4)
  v_mfma_f32_32x32x16_bf16 v[112:127], v[56:59], v[96:99], v[112:127]
  v_exp_f32 v80, v80
  v_exp_f32 v81, v81
  v_exp_f32 v82, v82
  v_mfma_f32_32x32x16_bf16 v[112:127], v[60:63], v[100:103], v[112:127]
  v_exp_f32 v83, v83
  v_cvt_pk_bf16_f32 v104, v80, v81
  v_exp_f32 v84, v84
  v_exp_f32 v85, v85
  v_cvt_pk_bf16_f32 v105, v82, v83
  s_waitcnt lgkmcnt(2)
  v_mfma_f32_32x32x16_bf16 v[64:79], v[32:35], v[16:19], 0
  v_exp_f32 v86, v86
  v_exp_f32 v87, v87
  v_cvt_pk_bf16_f32 v106, v84, v85
  v_exp_f32 v88, v88
  v_mfma_f32_32x32x16_bf16 v[64:79], v[36:39], v[20:23], v[64:79]
  v_exp_f32 v89, v89
  v_cvt_pk_bf16_f32 v107, v86, v87
  v_exp_f32 v90, v90
  ds_read_b128 v[40:43], v4 offset:10240
  v_exp_f32 v91, v91
  v_cvt_pk_bf16_f32 v108, v88, v89
  v_exp_f32 v92, v92
  ds_read_b128 v[44:47], v4 offset:11264
  v_exp_f32 v93, v93
  v_cvt_pk_bf16_f32 v109, v90, v91
  v_exp_f32 v94, v94
  v_exp_f32 v95, v95
  v_cvt_pk_bf16_f32 v110, v92, v93
  v_cvt_pk_bf16_f32 v111, v94, v95
  v_mfma_f32_32x32x16_bf16 v[128:143], v[56:59], v[104:107], v[128:143]
  v_exp_f32 v64, v64
  v_exp_f32 v65, v65
  v_exp_f32 v66, v66
  v_mfma_f32_32x32x16_bf16 v[128:143], v[60:63], v[108:111], v[128:143]
  v_exp_f32 v67, v67
  v_cvt_pk_bf16_f32 v96, v64, v65
  v_exp_f32 v68, v68
  v_exp_f32 v69, v69
  v_cvt_pk_bf16_f32 v97, v66, v67
  v_mfma_f32_32x32x16_bf16 v[80:95], v[32:35], v[24:27], 0
  v_exp_f32 v70, v70
  v_exp_f32 v71, v71
  v_cvt_pk_bf16_f32 v98, v68, v69
  v_exp_f32 v72, v72
  v_mfma_f32_32x32x16_bf16 v[80:95], v[36:39], v[28:31], v[80:95]
  v_exp_f32 v73, v73
  v_cvt_pk_bf16_f32 v99, v70, v71
  v_exp_f32 v74, v74
  ds_read_b128 v[56:59], v4 offset:43008
  v_exp_f32 v75, v75
  v_cvt_pk_bf16_f32 v100, v72, v73
  v_exp_f32 v76, v76
  ds_read_b128 v[60:63], v4 offset:44032
  v_exp_f32 v77, v77
  v_cvt_pk_bf16_f32 v101, v74, v75
  v_exp_f32 v78, v78
  v_exp_f32 v79, v79
  v_cvt_pk_bf16_f32 v102, v76, v77
  v_cvt_pk_bf16_f32 v103, v78, v79
  s_waitcnt lgkmcnt(4)
  v_mfma_f32_32x32x16_bf16 v[112:127], v[48:51], v[96:99], v[112:127]
  v_exp_f32 v80, v80
  v_exp_f32 v81, v81
  v_exp_f32 v82, v82
  v_mfma_f32_32x32x16_bf16 v[112:127], v[52:55], v[100:103], v[112:127]
  v_exp_f32 v83, v83
  v_cvt_pk_bf16_f32 v104, v80, v81
  v_exp_f32 v84, v84
  v_exp_f32 v85, v85
  v_cvt_pk_bf16_f32 v105, v82, v83
  s_waitcnt lgkmcnt(2)
  v_mfma_f32_32x32x16_bf16 v[64:79], v[40:43], v[16:19], 0
  v_exp_f32 v86, v86
  v_exp_f32 v87, v87
  v_cvt_pk_bf16_f32 v106, v84, v85
  v_exp_f32 v88, v88
  v_mfma_f32_32x32x16_bf16 v[64:79], v[44:47], v[20:23], v[64:79]
  v_exp_f32 v89, v89
  v_cvt_pk_bf16_f32 v107, v86, v87
  v_exp_f32 v90, v90
  ds_read_b128 v[32:35], v4 offset:12288
  v_exp_f32 v91, v91
  v_cvt_pk_bf16_f32 v108, v88, v89
  v_exp_f32 v92, v92
  ds_read_b128 v[36:39], v4 offset:13312
  v_exp_f32 v93, v93
  v_cvt_pk_bf16_f32 v109, v90, v91
  v_exp_f32 v94, v94
  v_exp_f32 v95, v95
  v_cvt_pk_bf16_f32 v110, v92, v93
  v_cvt_pk_bf16_f32 v111, v94, v95
  v_mfma_f32_32x32x16_bf16 v[128:143], v[48:51], v[104:107], v[128:143]
  v_exp_f32 v64, v64
  v_exp_f32 v65, v65
  v_exp_f32 v66, v66
  v_mfma_f32_32x32x16_bf16 v[128:143], v[52:55], v[108:111], v[128:143]
  v_exp_f32 v67, v67
  v_cvt_pk_bf16_f32 v96, v64, v65
  v_exp_f32 v68, v68
  v_exp_f32 v69, v69
  v_cvt_pk_bf16_f32 v97, v66, v67
  v_mfma_f32_32x32x16_bf16 v[80:95], v[40:43], v[24:27], 0
  v_exp_f32 v70, v70
  v_exp_f32 v71, v71
  v_cvt_pk_bf16_f32 v98, v68, v69
  v_exp_f32 v72, v72
  v_mfma_f32_32x32x16_bf16 v[80:95], v[44:47], v[28:31], v[80:95]
  v_exp_f32 v73, v73
  v_cvt_pk_bf16_f32 v99, v70, v71
  v_exp_f32 v74, v74
  ds_read_b128 v[48:51], v4 offset:45056
  v_exp_f32 v75, v75
  v_cvt_pk_bf16_f32 v100, v72, v73
  v_exp_f32 v76, v76
  ds_read_b128 v[52:55], v4 offset:46080
  v_exp_f32 v77, v77
  v_cvt_pk_bf16_f32 v101, v74, v75
  v_exp_f32 v78, v78
  v_exp_f32 v79, v79
  v_cvt_pk_bf16_f32 v102, v76, v77
  v_cvt_pk_bf16_f32 v103, v78, v79
  s_waitcnt lgkmcnt(4)
  v_mfma_f32_32x32x16_bf16 v[112:127], v[56:59], v[96:99], v[112:127]
  v_exp_f32 v80, v80
  v_exp_f32 v81, v81
  v_exp_f32 v82, v82
  v_mfma_f32_32x32x16_bf16 v[112:127], v[60:63], v[100:103], v[112:127]
  v_exp_f32 v83, v83
  v_cvt_pk_bf16_f32 v104, v80, v81
  v_exp_f32 v84, v84
  v_exp_f32 v85, v85
  v_cvt_pk_bf16_f32 v105, v82, v83
  s_waitcnt lgkmcnt(2)
  v_mfma_f32_32x32x16_bf16 v[64:79], v[32:35], v[16:19], 0
  v_exp_f32 v86, v86
  v_exp_f32 v87, v87
  v_cvt_pk_bf16_f32 v106, v84, v85
  v_exp_f32 v88, v88
  v_mfma_f32_32x32x16_bf16 v[64:79], v[36:39], v[20:23], v[64:79]
  v_exp_f32 v89, v89
  v_cvt_pk_bf16_f32 v107, v86, v87
  v_exp_f32 v90, v90
  ds_read_b128 v[40:43], v4 offset:14336
  v_exp_f32 v91, v91
  v_cvt_pk_bf16_f32 v108, v88, v89
  v_exp_f32 v92, v92
  ds_read_b128 v[44:47], v4 offset:15360
  v_exp_f32 v93, v93
  v_cvt_pk_bf16_f32 v109, v90, v91
  v_exp_f32 v94, v94
  v_exp_f32 v95, v95
  v_cvt_pk_bf16_f32 v110, v92, v93
  v_cvt_pk_bf16_f32 v111, v94, v95
  v_mfma_f32_32x32x16_bf16 v[128:143], v[56:59], v[104:107], v[128:143]
  v_exp_f32 v64, v64
  v_exp_f32 v65, v65
  v_exp_f32 v66, v66
  v_mfma_f32_32x32x16_bf16 v[128:143], v[60:63], v[108:111], v[128:143]
  v_exp_f32 v67, v67
  v_cvt_pk_bf16_f32 v96, v64, v65
  v_exp_f32 v68, v68
  v_exp_f32 v69, v69
  v_cvt_pk_bf16_f32 v97, v66, v67
  v_mfma_f32_32x32x16_bf16 v[80:95], v[32:35], v[24:27], 0
  v_exp_f32 v70, v70
  v_exp_f32 v71, v71
  v_cvt_pk_bf16_f32 v98, v68, v69
  v_exp_f32 v72, v72
  v_mfma_f32_32x32x16_bf16 v[80:95], v[36:39], v[28:31], v[80:95]
  v_exp_f32 v73, v73
  v_cvt_pk_bf16_f32 v99, v70, v71
  v_exp_f32 v74, v74
  ds_read_b128 v[56:59], v4 offset:47104
  v_exp_f32 v75, v75
  v_cvt_pk_bf16_f32 v100, v72, v73
  v_exp_f32 v76, v76
  ds_read_b128 v[60:63], v4 offset:48128
  v_exp_f32 v77, v77
  v_cvt_pk_bf16_f32 v101, v74, v75
  v_exp_f32 v78, v78
  v_exp_f32 v79, v79
  v_cvt_pk_bf16_f32 v102, v76, v77
  v_cvt_pk_bf16_f32 v103, v78, v79
  s_waitcnt lgkmcnt(4)
  v_mfma_f32_32x32x16_bf16 v[112:127], v[48:51], v[96:99], v[112:127]
  v_exp_f32 v80, v80
  v_exp_f32 v81, v81
  v_exp_f32 v82, v82
  v_mfma_f32_32x32x16_bf16 v[112:127], v[52:55], v[100:103], v[112:127]
  v_exp_f32 v83, v83
  v_cvt_pk_bf16_f32 v104, v80, v81
  v_exp_f32 v84, v84
  v_exp_f32 v85, v85
  v_cvt_pk_bf16_f32 v105, v82, v83
  s_waitcnt lgkmcnt(2)
  v_mfma_f32_32x32x16_bf16 v[64:79], v[40:43], v[16:19], 0
  v_exp_f32 v86, v86
  v_exp_f32 v87, v87
  v_cvt_pk_bf16_f32 v106, v84, v85
  v_exp_f32 v88, v88
  v_mfma_f32_32x32x16_bf16 v[64:79], v[44:47], v[20:23], v[64:79]
  v_exp_f32 v89, v89
  v_cvt_pk_bf16_f32 v107, v86, v87
  v_exp_f32 v90, v90
  ds_read_b128 v[32:35], v4 offset:16384
  v_exp_f32 v91, v91
  v_cvt_pk_bf16_f32 v108, v88, v89
  v_exp_f32 v92, v92
  ds_read_b128 v[36:39], v4 offset:17408
  v_exp_f32 v93, v93
  v_cvt_pk_bf16_f32 v109, v90, v91
  v_exp_f32 v94, v94
  v_exp_f32 v95, v95
  v_cvt_pk_bf16_f32 v110, v92, v93
  v_cvt_pk_bf16_f32 v111, v94, v95
  v_mfma_f32_32x32x16_bf16 v[128:143], v[48:51], v[104:107], v[128:143]
  v_exp_f32 v64, v64
  v_exp_f32 v65, v65
  v_exp_f32 v66, v66
  v_mfma_f32_32x32x16_bf16 v[128:143], v[52:55], v[108:111], v[128:143]
  v_exp_f32 v67, v67
  v_cvt_pk_bf16_f32 v96, v64, v65
  v_exp_f32 v68, v68
  v_exp_f32 v69, v69
  v_cvt_pk_bf16_f32 v97, v66, v67
  v_mfma_f32_32x32x16_bf16 v[80:95], v[40:43], v[24:27], 0
  v_exp_f32 v70, v70
  v_exp_f32 v71, v71
  v_cvt_pk_bf16_f32 v98, v68, v69
  v_exp_f32 v72, v72
  v_mfma_f32_32x32x16_bf16 v[80:95], v[44:47], v[28:31], v[80:95]
  v_exp_f32 v73, v73
  v_cvt_pk_bf16_f32 v99, v70, v71
  v_exp_f32 v74, v74
  ds_read_b128 v[48:51], v4 offset:49152
  v_exp_f32 v75, v75
  v_cvt_pk_bf16_f32 v100, v72, v73
  v_exp_f32 v76, v76
  ds_read_b128 v[52:55], v4 offset:50176
  v_exp_f32 v77, v77
  v_cvt_pk_bf16_f32 v101, v74, v75
  v_exp_f32 v78, v78
  v_exp_f32 v79, v79
  v_cvt_pk_bf16_f32 v102, v76, v77
  v_cvt_pk_bf16_f32 v103, v78, v79
  s_waitcnt lgkmcnt(4)
  v_mfma_f32_32x32x16_bf16 v[112:127], v[56:59], v[96:99], v[112:127]
  v_exp_f32 v80, v80
  v_exp_f32 v81, v81
  v_exp_f32 v82, v82
  v_mfma_f32_32x32x16_bf16 v[112:127], v[60:63], v[100:103], v[112:127]
  v_exp_f32 v83, v83
  v_cvt_pk_bf16_f32 v104, v80, v81
  v_exp_f32 v84, v84
  v_exp_f32 v85, v85
  v_cvt_pk_bf16_f32 v105, v82, v83
  s_waitcnt lgkmcnt(2)
  v_mfma_f32_32x32x16_bf16 v[64:79], v[32:35], v[16:19], 0
  v_exp_f32 v86, v86
  v_exp_f32 v87, v87
  v_cvt_pk_bf16_f32 v106, v84, v85
  v_exp_f32 v88, v88
  v_mfma_f32_32x32x16_bf16 v[64:79], v[36:39], v[20:23], v[64:79]
  v_exp_f32 v89, v89
  v_cvt_pk_bf16_f32 v107, v86, v87
  v_exp_f32 v90, v90
  ds_read_b128 v[40:43], v4 offset:18432
  v_exp_f32 v91, v91
  v_cvt_pk_bf16_f32 v108, v88, v89
  v_exp_f32 v92, v92
  ds_read_b128 v[44:47], v4 offset:19456
  v_exp_f32 v93, v93
  v_cvt_pk_bf16_f32 v109, v90, v91
  v_exp_f32 v94, v94
  v_exp_f32 v95, v95
  v_cvt_pk_bf16_f32 v110, v92, v93
  v_cvt_pk_bf16_f32 v111, v94, v95
  v_mfma_f32_32x32x16_bf16 v[128:143], v[56:59], v[104:107], v[128:143]
  v_exp_f32 v64, v64
  v_exp_f32 v65, v65
  v_exp_f32 v66, v66
  v_mfma_f32_32x32x16_bf16 v[128:143], v[60:63], v[108:111], v[128:143]
  v_exp_f32 v67, v67
  v_cvt_pk_bf16_f32 v96, v64, v65
  v_exp_f32 v68, v68
  v_exp_f32 v69, v69
  v_cvt_pk_bf16_f32 v97, v66, v67
  v_mfma_f32_32x32x16_bf16 v[80:95], v[32:35], v[24:27], 0
  v_exp_f32 v70, v70
  v_exp_f32 v71, v71
  v_cvt_pk_bf16_f32 v98, v68, v69
  v_exp_f32 v72, v72
  v_mfma_f32_32x32x16_bf16 v[80:95], v[36:39], v[28:31], v[80:95]
  v_exp_f32 v73, v73
  v_cvt_pk_bf16_f32 v99, v70, v71
  v_exp_f32 v74, v74
  ds_read_b128 v[56:59], v4 offset:51200
  v_exp_f32 v75, v75
  v_cvt_pk_bf16_f32 v100, v72, v73
  v_exp_f32 v76, v76
  ds_read_b128 v[60:63], v4 offset:52224
  v_exp_f32 v77, v77
  v_cvt_pk_bf16_f32 v101, v74, v75
  v_exp_f32 v78, v78
  v_exp_f32 v79, v79
  v_cvt_pk_bf16_f32 v102, v76, v77
  v_cvt_pk_bf16_f32 v103, v78, v79
  s_waitcnt lgkmcnt(4)
  v_mfma_f32_32x32x16_bf16 v[112:127], v[48:51], v[96:99], v[112:127]
  v_exp_f32 v80, v80
  v_exp_f32 v81, v81
  v_exp_f32 v82, v82
  v_mfma_f32_32x32x16_bf16 v[112:127], v[52:55], v[100:103], v[112:127]
  v_exp_f32 v83, v83
  v_cvt_pk_bf16_f32 v104, v80, v81
  v_exp_f32 v84, v84
  v_exp_f32 v85, v85
  v_cvt_pk_bf16_f32 v105, v82, v83
  s_waitcnt lgkmcnt(2)
  v_mfma_f32_32x32x16_bf16 v[64:79], v[40:43], v[16:19], 0
  v_exp_f32 v86, v86
  v_exp_f32 v87, v87
  v_cvt_pk_bf16_f32 v106, v84, v85
  v_exp_f32 v88, v88
  v_mfma_f32_32x32x16_bf16 v[64:79], v[44:47], v[20:23], v[64:79]
  v_exp_f32 v89, v89
  v_cvt_pk_bf16_f32 v107, v86, v87
  v_exp_f32 v90, v90
  ds_read_b128 v[32:35], v4 offset:20480
  v_exp_f32 v91, v91
  v_cvt_pk_bf16_f32 v108, v88, v89
  v_exp_f32 v92, v92
  ds_read_b128 v[36:39], v4 offset:21504
  v_exp_f32 v93, v93
  v_cvt_pk_bf16_f32 v109, v90, v91
  v_exp_f32 v94, v94
  v_exp_f32 v95, v95
  v_cvt_pk_bf16_f32 v110, v92, v93
  v_cvt_pk_bf16_f32 v111, v94, v95
  v_mfma_f32_32x32x16_bf16 v[128:143], v[48:51], v[104:107], v[128:143]
  v_exp_f32 v64, v64
  v_exp_f32 v65, v65
  v_exp_f32 v66, v66
  v_mfma_f32_32x32x16_bf16 v[128:143], v[52:55], v[108:111], v[128:143]
  v_exp_f32 v67, v67
  v_cvt_pk_bf16_f32 v96, v64, v65
  v_exp_f32 v68, v68
  v_exp_f32 v69, v69
  v_cvt_pk_bf16_f32 v97, v66, v67
  v_mfma_f32_32x32x16_bf16 v[80:95], v[40:43], v[24:27], 0
  v_exp_f32 v70, v70
  v_exp_f32 v71, v71
  v_cvt_pk_bf16_f32 v98, v68, v69
  v_exp_f32 v72, v72
  v_mfma_f32_32x32x16_bf16 v[80:95], v[44:47], v[28:31], v[80:95]
  v_exp_f32 v73, v73
  v_cvt_pk_bf16_f32 v99, v70, v71
  v_exp_f32 v74, v74
  ds_read_b128 v[48:51], v4 offset:53248
  v_exp_f32 v75, v75
  v_cvt_pk_bf16_f32 v100, v72, v73
  v_exp_f32 v76, v76
  ds_read_b128 v[52:55], v4 offset:54272
  v_exp_f32 v77, v77
  v_cvt_pk_bf16_f32 v101, v74, v75
  v_exp_f32 v78, v78
  v_exp_f32 v79, v79
  v_cvt_pk_bf16_f32 v102, v76, v77
  v_cvt_pk_bf16_f32 v103, v78, v79
  s_waitcnt lgkmcnt(4)
  v_mfma_f32_32x32x16_bf16 v[112:127], v[56:59], v[96:99], v[112:127]
  v_exp_f32 v80, v80
  v_exp_f32 v81, v81
  v_exp_f32 v82, v82
  v_mfma_f32_32x32x16_bf16 v[112:127], v[60:63], v[100:103], v[112:127]
  v_exp_f32 v83, v83
  v_cvt_pk_bf16_f32 v104, v80, v81
  v_exp_f32 v84, v84
  v_exp_f32 v85, v85
  v_cvt_pk_bf16_f32 v105, v82, v83
  s_waitcnt lgkmcnt(2)
  v_mfma_f32_32x32x16_bf16 v[64:79], v[32:35], v[16:19], 0
  v_exp_f32 v86, v86
  v_exp_f32 v87, v87
  v_cvt_pk_bf16_f32 v106, v84, v85
  v_exp_f32 v88, v88
  v_mfma_f32_32x32x16_bf16 v[64:79], v[36:39], v[20:23], v[64:79]
  v_exp_f32 v89, v89
  v_cvt_pk_bf16_f32 v107, v86, v87
  v_exp_f32 v90, v90
  ds_read_b128 v[40:43], v4 offset:22528
  v_exp_f32 v91, v91
  v_cvt_pk_bf16_f32 v108, v88, v89
  v_exp_f32 v92, v92
  ds_read_b128 v[44:47], v4 offset:23552
  v_exp_f32 v93, v93
  v_cvt_pk_bf16_f32 v109, v90, v91
  v_exp_f32 v94, v94
  v_exp_f32 v95, v95
  v_cvt_pk_bf16_f32 v110, v92, v93
  v_cvt_pk_bf16_f32 v111, v94, v95
  v_mfma_f32_32x32x16_bf16 v[128:143], v[56:59], v[104:107], v[128:143]
  v_exp_f32 v64, v64
  v_exp_f32 v65, v65
  v_exp_f32 v66, v66
  v_mfma_f32_32x32x16_bf16 v[128:143], v[60:63], v[108:111], v[128:143]
  v_exp_f32 v67, v67
  v_cvt_pk_bf16_f32 v96, v64, v65
  v_exp_f32 v68, v68
  v_exp_f32 v69, v69
  v_cvt_pk_bf16_f32 v97, v66, v67
  v_mfma_f32_32x32x16_bf16 v[80:95], v[32:35], v[24:27], 0
  v_exp_f32 v70, v70
  v_exp_f32 v71, v71
  v_cvt_pk_bf16_f32 v98, v68, v69
  v_exp_f32 v72, v72
  v_mfma_f32_32x32x16_bf16 v[80:95], v[36:39], v[28:31], v[80:95]
  v_exp_f32 v73, v73
  v_cvt_pk_bf16_f32 v99, v70, v71
  v_exp_f32 v74, v74
  ds_read_b128 v[56:59], v4 offset:55296
  v_exp_f32 v75, v75
  v_cvt_pk_bf16_f32 v100, v72, v73
  v_exp_f32 v76, v76
  ds_read_b128 v[60:63], v4 offset:56320
  v_exp_f32 v77, v77
  v_cvt_pk_bf16_f32 v101, v74, v75
  v_exp_f32 v78, v78
  v_exp_f32 v79, v79
  v_cvt_pk_bf16_f32 v102, v76, v77
  v_cvt_pk_bf16_f32 v103, v78, v79
  s_waitcnt lgkmcnt(4)
  v_mfma_f32_32x32x16_bf16 v[112:127], v[48:51], v[96:99], v[112:127]
  v_exp_f32 v80, v80
  v_exp_f32 v81, v81
  v_exp_f32 v82, v82
  v_mfma_f32_32x32x16_bf16 v[112:127], v[52:55], v[100:103], v[112:127]
  v_exp_f32 v83, v83
  v_cvt_pk_bf16_f32 v104, v80, v81
  v_exp_f32 v84, v84
  v_exp_f32 v85, v85
  v_cvt_pk_bf16_f32 v105, v82, v83
  s_waitcnt lgkmcnt(2)
  v_mfma_f32_32x32x16_bf16 v[64:79], v[40:43], v[16:19], 0
  v_exp_f32 v86, v86
  v_exp_f32 v87, v87
  v_cvt_pk_bf16_f32 v106, v84, v85
  v_exp_f32 v88, v88
  v_mfma_f32_32x32x16_bf16 v[64:79], v[44:47], v[20:23], v[64:79]
  v_exp_f32 v89, v89
  v_cvt_pk_bf16_f32 v107, v86, v87
  v_exp_f32 v90, v90
  ds_read_b128 v[32:35], v4 offset:24576
  v_exp_f32 v91, v91
  v_cvt_pk_bf16_f32 v108, v88, v89
  v_exp_f32 v92, v92
  ds_read_b128 v[36:39], v4 offset:25600
  v_exp_f32 v93, v93
  v_cvt_pk_bf16_f32 v109, v90, v91
  v_exp_f32 v94, v94
  v_exp_f32 v95, v95
  v_cvt_pk_bf16_f32 v110, v92, v93
  v_cvt_pk_bf16_f32 v111, v94, v95
  v_mfma_f32_32x32x16_bf16 v[128:143], v[48:51], v[104:107], v[128:143]
  v_exp_f32 v64, v64
  v_exp_f32 v65, v65
  v_exp_f32 v66, v66
  v_mfma_f32_32x32x16_bf16 v[128:143], v[52:55], v[108:111], v[128:143]
  v_exp_f32 v67, v67
  v_cvt_pk_bf16_f32 v96, v64, v65
  v_exp_f32 v68, v68
  v_exp_f32 v69, v69
  v_cvt_pk_bf16_f32 v97, v66, v67
  v_mfma_f32_32x32x16_bf16 v[80:95], v[40:43], v[24:27], 0
  v_exp_f32 v70, v70
  v_exp_f32 v71, v71
  v_cvt_pk_bf16_f32 v98, v68, v69
  v_exp_f32 v72, v72
  v_mfma_f32_32x32x16_bf16 v[80:95], v[44:47], v[28:31], v[80:95]
  v_exp_f32 v73, v73
  v_cvt_pk_bf16_f32 v99, v70, v71
  v_exp_f32 v74, v74
  ds_read_b128 v[48:51], v4 offset:57344
  v_exp_f32 v75, v75
  v_cvt_pk_bf16_f32 v100, v72, v73
  v_exp_f32 v76, v76
  ds_read_b128 v[52:55], v4 offset:58368
  v_exp_f32 v77, v77
  v_cvt_pk_bf16_f32 v101, v74, v75
  v_exp_f32 v78, v78
  v_exp_f32 v79, v79
  v_cvt_pk_bf16_f32 v102, v76, v77
  v_cvt_pk_bf16_f32 v103, v78, v79
  s_waitcnt lgkmcnt(4)
  v_mfma_f32_32x32x16_bf16 v[112:127], v[56:59], v[96:99], v[112:127]
  v_exp_f32 v80, v80
  v_exp_f32 v81, v81
  v_exp_f32 v82, v82
  v_mfma_f32_32x32x16_bf16 v[112:127], v[60:63], v[100:103], v[112:127]
  v_exp_f32 v83, v83
  v_cvt_pk_bf16_f32 v104, v80, v81
  v_exp_f32 v84, v84
  v_exp_f32 v85, v85
  v_cvt_pk_bf16_f32 v105, v82, v83
  s_waitcnt lgkmcnt(2)
  v_mfma_f32_32x32x16_bf16 v[64:79], v[32:35], v[16:19], 0
  v_exp_f32 v86, v86
  v_exp_f32 v87, v87
  v_cvt_pk_bf16_f32 v106, v84, v85
  v_exp_f32 v88, v88
  v_mfma_f32_32x32x16_bf16 v[64:79], v[36:39], v[20:23], v[64:79]
  v_exp_f32 v89, v89
  v_cvt_pk_bf16_f32 v107, v86, v87
  v_exp_f32 v90, v90
  ds_read_b128 v[40:43], v4 offset:26624
  v_exp_f32 v91, v91
  v_cvt_pk_bf16_f32 v108, v88, v89
  v_exp_f32 v92, v92
  ds_read_b128 v[44:47], v4 offset:27648
  v_exp_f32 v93, v93
  v_cvt_pk_bf16_f32 v109, v90, v91
  v_exp_f32 v94, v94
  v_exp_f32 v95, v95
  v_cvt_pk_bf16_f32 v110, v92, v93
  v_cvt_pk_bf16_f32 v111, v94, v95
  v_mfma_f32_32x32x16_bf16 v[128:143], v[56:59], v[104:107], v[128:143]
  v_exp_f32 v64, v64
  v_exp_f32 v65, v65
  v_exp_f32 v66, v66
  v_mfma_f32_32x32x16_bf16 v[128:143], v[60:63], v[108:111], v[128:143]
  v_exp_f32 v67, v67
  v_cvt_pk_bf16_f32 v96, v64, v65
  v_exp_f32 v68, v68
  v_exp_f32 v69, v69
  v_cvt_pk_bf16_f32 v97, v66, v67
  v_mfma_f32_32x32x16_bf16 v[80:95], v[32:35], v[24:27], 0
  v_exp_f32 v70, v70
  v_exp_f32 v71, v71
  v_cvt_pk_bf16_f32 v98, v68, v69
  v_exp_f32 v72, v72
  v_mfma_f32_32x32x16_bf16 v[80:95], v[36:39], v[28:31], v[80:95]
  v_exp_f32 v73, v73
  v_cvt_pk_bf16_f32 v99, v70, v71
  v_exp_f32 v74, v74
  ds_read_b128 v[56:59], v4 offset:59392
  v_exp_f32 v75, v75
  v_cvt_pk_bf16_f32 v100, v72, v73
  v_exp_f32 v76, v76
  ds_read_b128 v[60:63], v4 offset:60416
  v_exp_f32 v77, v77
  v_cvt_pk_bf16_f32 v101, v74, v75
  v_exp_f32 v78, v78
  v_exp_f32 v79, v79
  v_cvt_pk_bf16_f32 v102, v76, v77
  v_cvt_pk_bf16_f32 v103, v78, v79
  s_waitcnt lgkmcnt(4)
  v_mfma_f32_32x32x16_bf16 v[112:127], v[48:51], v[96:99], v[112:127]
  v_exp_f32 v80, v80
  v_exp_f32 v81, v81
  v_exp_f32 v82, v82
  v_mfma_f32_32x32x16_bf16 v[112:127], v[52:55], v[100:103], v[112:127]
  v_exp_f32 v83, v83
  v_cvt_pk_bf16_f32 v104, v80, v81
  v_exp_f32 v84, v84
  v_exp_f32 v85, v85
  v_cvt_pk_bf16_f32 v105, v82, v83
  s_waitcnt lgkmcnt(2)
  v_mfma_f32_32x32x16_bf16 v[64:79], v[40:43], v[16:19], 0
  v_exp_f32 v86, v86
  v_exp_f32 v87, v87
  v_cvt_pk_bf16_f32 v106, v84, v85
  v_exp_f32 v88, v88
  v_mfma_f32_32x32x16_bf16 v[64:79], v[44:47], v[20:23], v[64:79]
  v_exp_f32 v89, v89
  v_cvt_pk_bf16_f32 v107, v86, v87
  v_exp_f32 v90, v90
  ds_read_b128 v[32:35], v4 offset:28672
  v_exp_f32 v91, v91
  v_cvt_pk_bf16_f32 v108, v88, v89
  v_exp_f32 v92, v92
  ds_read_b128 v[36:39], v4 offset:29696
  v_exp_f32 v93, v93
  v_cvt_pk_bf16_f32 v109, v90, v91
  v_exp_f32 v94, v94
  v_exp_f32 v95, v95
  v_cvt_pk_bf16_f32 v110, v92, v93
  v_cvt_pk_bf16_f32 v111, v94, v95
  v_mfma_f32_32x32x16_bf16 v[128:143], v[48:51], v[104:107], v[128:143]
  v_exp_f32 v64, v64
  v_exp_f32 v65, v65
  v_exp_f32 v66, v66
  v_mfma_f32_32x32x16_bf16 v[128:143], v[52:55], v[108:111], v[128:143]
  v_exp_f32 v67, v67
  v_cvt_pk_bf16_f32 v96, v64, v65
  v_exp_f32 v68, v68
  v_exp_f32 v69, v69
  v_cvt_pk_bf16_f32 v97, v66, v67
  v_mfma_f32_32x32x16_bf16 v[80:95], v[40:43], v[24:27], 0
  v_exp_f32 v70, v70
  v_exp_f32 v71, v71
  v_cvt_pk_bf16_f32 v98, v68, v69
  v_exp_f32 v72, v72
  v_mfma_f32_32x32x16_bf16 v[80:95], v[44:47], v[28:31], v[80:95]
  v_exp_f32 v73, v73
  v_cvt_pk_bf16_f32 v99, v70, v71
  v_exp_f32 v74, v74
  ds_read_b128 v[48:51], v4 offset:61440
  v_exp_f32 v75, v75
  v_cvt_pk_bf16_f32 v100, v72, v73
  v_exp_f32 v76, v76
  ds_read_b128 v[52:55], v4 offset:62464
  v_exp_f32 v77, v77
  v_cvt_pk_bf16_f32 v101, v74, v75
  v_exp_f32 v78, v78
  v_exp_f32 v79, v79
  v_cvt_pk_bf16_f32 v102, v76, v77
  v_cvt_pk_bf16_f32 v103, v78, v79
  s_waitcnt lgkmcnt(4)
  v_mfma_f32_32x32x16_bf16 v[112:127], v[56:59], v[96:99], v[112:127]
  v_exp_f32 v80, v80
  v_exp_f32 v81, v81
  v_exp_f32 v82, v82
  v_mfma_f32_32x32x16_bf16 v[112:127], v[60:63], v[100:103], v[112:127]
  v_exp_f32 v83, v83
  v_cvt_pk_bf16_f32 v104, v80, v81
  v_exp_f32 v84, v84
  v_exp_f32 v85, v85
  v_cvt_pk_bf16_f32 v105, v82, v83
  s_waitcnt lgkmcnt(2)
  v_mfma_f32_32x32x16_bf16 v[64:79], v[32:35], v[16:19], 0
  v_exp_f32 v86, v86
  v_exp_f32 v87, v87
  v_cvt_pk_bf16_f32 v106, v84, v85
  v_exp_f32 v88, v88
  v_mfma_f32_32x32x16_bf16 v[64:79], v[36:39], v[20:23], v[64:79]
  v_exp_f32 v89, v89
  v_cvt_pk_bf16_f32 v107, v86, v87
  v_exp_f32 v90, v90
  ds_read_b128 v[40:43], v4 offset:30720
  v_exp_f32 v91, v91
  v_cvt_pk_bf16_f32 v108, v88, v89
  v_exp_f32 v92, v92
  ds_read_b128 v[44:47], v4 offset:31744
  v_exp_f32 v93, v93
  v_cvt_pk_bf16_f32 v109, v90, v91
  v_exp_f32 v94, v94
  v_exp_f32 v95, v95
  v_cvt_pk_bf16_f32 v110, v92, v93
  v_cvt_pk_bf16_f32 v111, v94, v95
  v_mfma_f32_32x32x16_bf16 v[128:143], v[56:59], v[104:107], v[128:143]
  v_exp_f32 v64, v64
  v_exp_f32 v65, v65
  v_exp_f32 v66, v66
  v_mfma_f32_32x32x16_bf16 v[128:143], v[60:63], v[108:111], v[128:143]
  v_exp_f32 v67, v67
  v_cvt_pk_bf16_f32 v96, v64, v65
  v_exp_f32 v68, v68
  v_exp_f32 v69, v69
  v_cvt_pk_bf16_f32 v97, v66, v67
  v_mfma_f32_32x32x16_bf16 v[80:95], v[32:35], v[24:27], 0
  v_exp_f32 v70, v70
  v_exp_f32 v71, v71
  v_cvt_pk_bf16_f32 v98, v68, v69
  v_exp_f32 v72, v72
  v_mfma_f32_32x32x16_bf16 v[80:95], v[36:39], v[28:31], v[80:95]
  v_exp_f32 v73, v73
  v_cvt_pk_bf16_f32 v99, v70, v71
  v_exp_f32 v74, v74
  ds_read_b128 v[56:59], v4 offset:63488
  v_exp_f32 v75, v75
  v_cvt_pk_bf16_f32 v100, v72, v73
  v_exp_f32 v76, v76
  ds_read_b128 v[60:63], v4 offset:64512
  v_exp_f32 v77, v77
  v_cvt_pk_bf16_f32 v101, v74, v75
  v_exp_f32 v78, v78
  v_exp_f32 v79, v79
  v_cvt_pk_bf16_f32 v102, v76, v77
  v_cvt_pk_bf16_f32 v103, v78, v79
  s_waitcnt lgkmcnt(4)
  v_mfma_f32_32x32x16_bf16 v[112:127], v[48:51], v[96:99], v[112:127]
  v_exp_f32 v80, v80
  v_exp_f32 v81, v81
  v_exp_f32 v82, v82
  v_mfma_f32_32x32x16_bf16 v[112:127], v[52:55], v[100:103], v[112:127]
  v_exp_f32 v83, v83
  v_cvt_pk_bf16_f32 v104, v80, v81
  v_exp_f32 v84, v84
  v_exp_f32 v85, v85
  v_cvt_pk_bf16_f32 v105, v82, v83
  s_waitcnt lgkmcnt(2)
  v_mfma_f32_32x32x16_bf16 v[64:79], v[40:43], v[16:19], 0
  v_exp_f32 v86, v86
  v_exp_f32 v87, v87
  v_cvt_pk_bf16_f32 v106, v84, v85
  v_exp_f32 v88, v88
  v_mfma_f32_32x32x16_bf16 v[64:79], v[44:47], v[20:23], v[64:79]
  v_exp_f32 v89, v89
  v_cvt_pk_bf16_f32 v107, v86, v87
  v_exp_f32 v90, v90
  v_exp_f32 v91, v91
  v_cvt_pk_bf16_f32 v108, v88, v89
  v_exp_f32 v92, v92
  v_exp_f32 v93, v93
  v_cvt_pk_bf16_f32 v109, v90, v91
  v_exp_f32 v94, v94
  v_exp_f32 v95, v95
  v_cvt_pk_bf16_f32 v110, v92, v93
  v_cvt_pk_bf16_f32 v111, v94, v95
  v_mfma_f32_32x32x16_bf16 v[128:143], v[48:51], v[104:107], v[128:143]
  v_exp_f32 v64, v64
  v_exp_f32 v65, v65
  v_exp_f32 v66, v66
  v_mfma_f32_32x32x16_bf16 v[128:143], v[52:55], v[108:111], v[128:143]
  v_exp_f32 v67, v67
  v_cvt_pk_bf16_f32 v96, v64, v65
  v_exp_f32 v68, v68
  v_exp_f32 v69, v69
  v_cvt_pk_bf16_f32 v97, v66, v67
  v_mfma_f32_32x32x16_bf16 v[80:95], v[40:43], v[24:27], 0
  v_exp_f32 v70, v70
  v_exp_f32 v71, v71
  v_cvt_pk_bf16_f32 v98, v68, v69
  v_exp_f32 v72, v72
  v_mfma_f32_32x32x16_bf16 v[80:95], v[44:47], v[28:31], v[80:95]
  v_exp_f32 v73, v73
  v_cvt_pk_bf16_f32 v99, v70, v71
  v_exp_f32 v74, v74
  v_exp_f32 v75, v75
  v_cvt_pk_bf16_f32 v100, v72, v73
  v_exp_f32 v76, v76
  v_exp_f32 v77, v77
  v_cvt_pk_bf16_f32 v101, v74, v75
  v_exp_f32 v78, v78
  v_exp_f32 v79, v79
  v_cvt_pk_bf16_f32 v102, v76, v77
  v_cvt_pk_bf16_f32 v103, v78, v79
  s_waitcnt lgkmcnt(0)
  v_mfma_f32_32x32x16_bf16 v[112:127], v[56:59], v[96:99], v[112:127]
  v_exp_f32 v80, v80
  v_exp_f32 v81, v81
  v_exp_f32 v82, v82
  v_mfma_f32_32x32x16_bf16 v[112:127], v[60:63], v[100:103], v[112:127]
  v_exp_f32 v83, v83
  v_cvt_pk_bf16_f32 v104, v80, v81
  v_exp_f32 v84, v84
  v_exp_f32 v85, v85
  v_cvt_pk_bf16_f32 v105, v82, v83
  v_exp_f32 v86, v86
  v_exp_f32 v87, v87
  v_cvt_pk_bf16_f32 v106, v84, v85
  v_exp_f32 v88, v88
  v_exp_f32 v89, v89
  v_cvt_pk_bf16_f32 v107, v86, v87
  v_exp_f32 v90, v90
  v_exp_f32 v91, v91
  v_cvt_pk_bf16_f32 v108, v88, v89
  v_exp_f32 v92, v92
  v_exp_f32 v93, v93
  v_cvt_pk_bf16_f32 v109, v90, v91
  v_exp_f32 v94, v94
  v_exp_f32 v95, v95
  v_cvt_pk_bf16_f32 v110, v92, v93
  v_cvt_pk_bf16_f32 v111, v94, v95
  s_nop 1
  v_mfma_f32_32x32x16_bf16 v[128:143], v[56:59], v[104:107], v[128:143]
  v_mfma_f32_32x32x16_bf16 v[128:143], v[60:63], v[108:111], v[128:143]
  s_cmp_lt_u32 s41, 4
  s_cbranch_scc1 kb2b_chunk2
  s_nop 11
  v_mov_b32 v5, v120
  v_mov_b32 v6, v120
  s_nop 1
  v_permlane32_swap_b32 v5, v6
  v_mov_b32 v14, v6
  v_mov_b32 v5, v136
  v_mov_b32 v6, v136
  s_nop 1
  v_permlane32_swap_b32 v5, v6
  v_mov_b32 v15, v6
  s_cmp_eq_u32 s40, 0
  s_cbranch_scc0 kb2b_fin
  v_min_f32 v5, v14, v15
  v_cmp_gt_f32 vcc, 0x12800000, v5
  v_cmp_u_f32 s[36:37], v5, v5
  s_nop 1
  s_or_b64 vcc, vcc, s[36:37]
  s_cmp_lg_u64 vcc, 0
  s_cselect_b32 s42, 1, 0
  v_mov_b32 v5, s42
  s_lshl_b32 s30, s21, 2
  v_mov_b32 v6, s30
  s_barrier
  ds_write_b32 v6, v5
  s_waitcnt lgkmcnt(0)
  s_barrier
  v_mov_b32 v6, 0
  ds_read_b128 v[8:11], v6
  s_waitcnt lgkmcnt(0)
  v_or_b32 v8, v8, v9
  v_or_b32 v10, v10, v11
  v_or_b32 v8, v8, v10
  s_nop 0
  v_readfirstlane_b32 s42, v8
  s_cmp_eq_u32 s42, 0
  s_cbranch_scc1 kb2b_fin
  s_mov_b32 s40, 1
  v_and_b32 v5, 0xffff0000, v22
  v_cndmask_b32 v22, v22, v5, s[34:35]
  v_mov_b32 v12, 0xff7fffff
  v_and_b32 v5, 0xffff0000, v30
  v_cndmask_b32 v30, v30, v5, s[34:35]
  v_mov_b32 v13, 0xff7fffff
  s_mov_b32 s41, 0
kb2b_mx:
  s_lshl_b32 s30, s41, 11
  s_add_u32 s30, s30, s27
  buffer_load_dwordx4 v[32:35], v2, s[8:11], s30 offen
  buffer_load_dwordx4 v[36:39], v2, s[8:11], s30 offen offset:1024
  s_waitcnt vmcnt(0)
  v_mfma_f32_32x32x16_bf16 v[64:79], v[32:35], v[16:19], 0
  v_mfma_f32_32x32x16_bf16 v[64:79], v[36:39], v[20:23], v[64:79]
  v_mfma_f32_32x32x16_bf16 v[80:95], v[32:35], v[24:27], 0
  v_mfma_f32_32x32x16_bf16 v[80:95], v[36:39], v[28:31], v[80:95]
  s_nop 11
  v_max3_f32 v12, v12, v64, v65
  v_max3_f32 v12, v12, v66, v67
  v_max3_f32 v12, v12, v68, v69
  v_max3_f32 v12, v12, v70, v71
  v_max3_f32 v12, v12, v72, v73
  v_max3_f32 v12, v12, v74, v75
  v_max3_f32 v12, v12, v76, v77
  v_max3_f32 v12, v12, v78, v79
  v_max3_f32 v13, v13, v80, v81
  v_max3_f32 v13, v13, v82, v83
  v_max3_f32 v13, v13, v84, v85
  v_max3_f32 v13, v13, v86, v87
  v_max3_f32 v13, v13, v88, v89
  v_max3_f32 v13, v13, v90, v91
  v_max3_f32 v13, v13, v92, v93
  v_max3_f32 v13, v13, v94, v95
  s_add_u32 s41, s41, 1
  s_cmp_lt_u32 s41, 64
  s_cbranch_scc1 kb2b_mx
  v_mov_b32 v5, v12
  s_nop 1
  v_permlane32_swap_b32 v12, v5
  v_max_f32 v12, v12, v5
  v_cvt_pk_bf16_f32 v5, v12, v12
  v_lshlrev_b32 v5, 16, v5
  v_xor_b32 v12, 0x80000000, v5
  v_mov_b32 v5, v13
  s_nop 1
  v_permlane32_swap_b32 v13, v5
  v_max_f32 v13, v13, v5
  v_cvt_pk_bf16_f32 v5, v13, v13
  v_lshlrev_b32 v5, 16, v5
  v_xor_b32 v13, 0x80000000, v5
  v_lshrrev_b32 v5, 16, v12
  v_and_b32 v6, 0xffff0000, v22
  v_or_b32 v5, v5, v6
  v_cndmask_b32 v22, v22, v5, s[34:35]
  v_lshrrev_b32 v5, 16, v13
  v_and_b32 v6, 0xffff0000, v30
  v_or_b32 v5, v5, v6
  v_cndmask_b32 v30, v30, v5, s[34:35]
  s_branch kb2b_main2
kb2b_fin:
  v_and_b32 v3, 31, v1
  v_lshrrev_b32 v4, 5, v1
  s_mul_i32 s30, s22, 20
  v_lshlrev_b32 v5, 2, v4
  v_add_u32 v5, 0, v5
  v_add_u32 v5, s30, v5
  v_lshrrev_b32 v6, 4, v5
  v_lshlrev_b32 v6, 10, v6
  v_bfe_u32 v7, v5, 3, 1
  v_lshlrev_b32 v7, 5, v7
  v_add_u32 v7, v7, v3
  v_lshlrev_b32 v7, 4, v7
  v_add_u32 v6, v6, v7
  v_bfe_u32 v7, v5, 2, 1
  v_lshlrev_b32 v7, 3, v7
  v_add_u32 v32, v6, v7
  v_lshlrev_b32 v5, 2, v4
  v_add_u32 v5, 8, v5
  v_add_u32 v5, s30, v5
  v_lshrrev_b32 v6, 4, v5
  v_lshlrev_b32 v6, 10, v6
  v_bfe_u32 v7, v5, 3, 1
  v_lshlrev_b32 v7, 5, v7
  v_add_u32 v7, v7, v3
  v_lshlrev_b32 v7, 4, v7
  v_add_u32 v6, v6, v7
  v_bfe_u32 v7, v5, 2, 1
  v_lshlrev_b32 v7, 3, v7
  v_add_u32 v33, v6, v7
  v_lshlrev_b32 v5, 2, v4
  v_add_u32 v5, 16, v5
  v_add_u32 v5, s30, v5
  v_lshrrev_b32 v6, 4, v5
  v_lshlrev_b32 v6, 10, v6
  v_bfe_u32 v7, v5, 3, 1
  v_lshlrev_b32 v7, 5, v7
  v_add_u32 v7, v7, v3
  v_lshlrev_b32 v7, 4, v7
  v_add_u32 v6, v6, v7
  v_bfe_u32 v7, v5, 2, 1
  v_lshlrev_b32 v7, 3, v7
  v_add_u32 v34, v6, v7
  v_mov_b32 v5, 0x40000000
  v_cndmask_b32 v34, v5, v34, s[34:35]
  v_rcp_f32 v5, v14
  s_nop 0
  v_mul_f32 v112, v112, v5
  v_mul_f32 v113, v113, v5
  v_mul_f32 v114, v114, v5
  v_mul_f32 v115, v115, v5
  v_mul_f32 v116, v116, v5
  v_mul_f32 v117, v117, v5
  v_mul_f32 v118, v118, v5
  v_mul_f32 v119, v119, v5
  v_mul_f32 v120, v120, v5
  v_mul_f32 v121, v121, v5
  v_mul_f32 v122, v122, v5
  v_mul_f32 v123, v123, v5
  v_cvt_pk_bf16_f32 v40, v112, v113
  v_cvt_pk_bf16_f32 v41, v114, v115
  v_cvt_pk_bf16_f32 v42, v116, v117
  v_cvt_pk_bf16_f32 v43, v118, v119
  v_cvt_pk_bf16_f32 v44, v120, v121
  v_cvt_pk_bf16_f32 v45, v122, v123
  s_add_u32 s31, s24, 0
  s_mul_i32 s31, s31, 40960
  s_add_u32 s31, s31, 0xf200000
  buffer_store_dwordx2 v[40:41], v32, s[8:11], s31 offen
  buffer_store_dwordx2 v[42:43], v33, s[8:11], s31 offen
  buffer_store_dwordx2 v[44:45], v34, s[8:11], s31 offen
  s_nop 1
  v_rcp_f32 v5, v15
  s_nop 0
  v_mul_f32 v128, v128, v5
  v_mul_f32 v129, v129, v5
  v_mul_f32 v130, v130, v5
  v_mul_f32 v131, v131, v5
  v_mul_f32 v132, v132, v5
  v_mul_f32 v133, v133, v5
  v_mul_f32 v134, v134, v5
  v_mul_f32 v135, v135, v5
  v_mul_f32 v136, v136, v5
  v_mul_f32 v137, v137, v5
  v_mul_f32 v138, v138, v5
  v_mul_f32 v139, v139, v5
  v_cvt_pk_bf16_f32 v40, v128, v129
  v_cvt_pk_bf16_f32 v41, v130, v131
  v_cvt_pk_bf16_f32 v42, v132, v133
  v_cvt_pk_bf16_f32 v43, v134, v135
  v_cvt_pk_bf16_f32 v44, v136, v137
  v_cvt_pk_bf16_f32 v45, v138, v139
  s_add_u32 s31, s24, 1
  s_mul_i32 s31, s31, 40960
  s_add_u32 s31, s31, 0xf200000
  buffer_store_dwordx2 v[40:41], v32, s[8:11], s31 offen
  buffer_store_dwordx2 v[42:43], v33, s[8:11], s31 offen
  buffer_store_dwordx2 v[44:45], v34, s[8:11], s31 offen
  s_nop 1
kb2b_exit:
  s_endpgm

.section .rodata,"a"
.p2align 6
.amdhsa_kernel att2_kernel
  .amdhsa_next_free_vgpr 256
  .amdhsa_next_free_sgpr 102
  .amdhsa_accum_offset 256
  .amdhsa_group_segment_fixed_size 0
  .amdhsa_kernarg_size 104
  .amdhsa_user_sgpr_count 2
  .amdhsa_user_sgpr_kernarg_segment_ptr 1
  .amdhsa_system_sgpr_workgroup_id_x 1
.end_amdhsa_kernel
.text
.globl out2_kernel
.p2align 8
.type out2_kernel,@function
out2_kernel:
  s_cmp_ge_u32 s2, 64
  s_cbranch_scc1 kb3b_exit
  s_load_dwordx2 s[36:37], s[0:1], 80
  s_load_dwordx2 s[4:5], s[0:1], 96
  v_lshrrev_b32 v1, 6, v0
  s_nop 0
  v_readfirstlane_b32 s21, v1
  v_and_b32 v1, 63, v0
  v_lshlrev_b32 v2, 4, v1
  s_waitcnt lgkmcnt(0)
  s_mov_b32 s8, s4
  s_and_b32 s9, s5, 0xffff
  s_mov_b32 s10, 0x10000000
  s_mov_b32 s11, 0x20000
  s_mov_b32 s12, s36
  s_and_b32 s13, s37, 0xffff
  s_mov_b32 s14, 0x280000
  s_mov_b32 s15, 0x20000
  s_mul_i32 s24, s2, 40960
  s_mul_i32 s25, s21, 10240
  s_add_u32 s26, s24, s25
  s_add_u32 s26, s26, 0xf200000
  s_add_u32 m0, s25, 0
  s_add_u32 s27, s26, 0
  buffer_load_dwordx4 v2, s[8:11], s27 offen lds
  s_add_u32 m0, s25, 1024
  s_add_u32 s27, s26, 1024
  buffer_load_dwordx4 v2, s[8:11], s27 offen lds
  s_add_u32 m0, s25, 2048
  s_add_u32 s27, s26, 2048
  buffer_load_dwordx4 v2, s[8:11], s27 offen lds
  s_add_u32 m0, s25, 3072
  s_add_u32 s27, s26, 3072
  buffer_load_dwordx4 v2, s[8:11], s27 offen lds
  s_add_u32 m0, s25, 4096
  s_add_u32 s27, s26, 4096
  buffer_load_dwordx4 v2, s[8:11], s27 offen lds
  s_add_u32 m0, s25, 5120
  s_add_u32 s27, s26, 5120
  buffer_load_dwordx4 v2, s[8:11], s27 offen lds
  s_add_u32 m0, s25, 6144
  s_add_u32 s27, s26, 6144
  buffer_load_dwordx4 v2, s[8:11], s27 offen lds
  s_add_u32 m0, s25, 7168
  s_add_u32 s27, s26, 7168
  buffer_load_dwordx4 v2, s[8:11], s27 offen lds
  s_add_u32 m0, s25, 8192
  s_add_u32 s27, s26, 8192
  buffer_load_dwordx4 v2, s[8:11], s27 offen lds
  s_add_u32 m0, s25, 9216
  s_add_u32 s27, s26, 9216
  buffer_load_dwordx4 v2, s[8:11], s27 offen lds
  s_mul_i32 s28, s21, 204800
  s_add_u32 s28, s28, 0xe000000
  s_add_u32 s29, s28, 0
  buffer_load_dwordx4 v[16:19], v2, s[8:11], s29 offen
  s_add_u32 s29, s28, 40960
  buffer_load_dwordx4 v[20:23], v2, s[8:11], s29 offen
  s_add_u32 s29, s28, 81920
  buffer_load_dwordx4 v[24:27], v2, s[8:11], s29 offen
  s_add_u32 s29, s28, 122880
  buffer_load_dwordx4 v[28:31], v2, s[8:11], s29 offen
  s_add_u32 s29, s28, 163840
  buffer_load_dwordx4 v[32:35], v2, s[8:11], s29 offen
  s_add_u32 s29, s28, 1024
  buffer_load_dwordx4 v[36:39], v2, s[8:11], s29 offen
  s_add_u32 s29, s28, 41984
  buffer_load_dwordx4 v[40:43], v2, s[8:11], s29 offen
  s_add_u32 s29, s28, 82944
  buffer_load_dwordx4 v[44:47], v2, s[8:11], s29 offen
  s_add_u32 s29, s28, 123904
  buffer_load_dwordx4 v[48:51], v2, s[8:11], s29 offen
  s_add_u32 s29, s28, 164864
  buffer_load_dwordx4 v[52:55], v2, s[8:11], s29 offen
  s_add_u32 s29, s28, 2048
  buffer_load_dwordx4 v[56:59], v2, s[8:11], s29 offen
  s_add_u32 s29, s28, 43008
  buffer_load_dwordx4 v[60:63], v2, s[8:11], s29 offen
  s_add_u32 s29, s28, 83968
  buffer_load_dwordx4 v[64:67], v2, s[8:11], s29 offen
  s_add_u32 s29, s28, 124928
  buffer_load_dwordx4 v[68:71], v2, s[8:11], s29 offen
  s_add_u32 s29, s28, 165888
  buffer_load_dwordx4 v[72:75], v2, s[8:11], s29 offen
  s_waitcnt vmcnt(15)
  s_barrier
  ds_read_b128 v[176:179], v2
  s_add_u32 s29, s28, 3072
  buffer_load_dwordx4 v[76:79], v2, s[8:11], s29 offen
  s_add_u32 s29, s28, 44032
  buffer_load_dwordx4 v[80:83], v2, s[8:11], s29 offen
  s_add_u32 s29, s28, 84992
  buffer_load_dwordx4 v[84:87], v2, s[8:11], s29 offen
  s_add_u32 s29, s28, 125952
  buffer_load_dwordx4 v[88:91], v2, s[8:11], s29 offen
  s_add_u32 s29, s28, 166912
  buffer_load_dwordx4 v[92:95], v2, s[8:11], s29 offen
  ds_read_b128 v[180:183], v2 offset:1024
  s_waitcnt lgkmcnt(1)
  s_waitcnt vmcnt(15)
  v_mfma_f32_32x32x16_bf16 v[96:111], v[16:19], v[176:179], 0
  v_mfma_f32_32x32x16_bf16 v[112:127], v[20:23], v[176:179], 0
  v_mfma_f32_32x32x16_bf16 v[128:143], v[24:27], v[176:179], 0
  v_mfma_f32_32x32x16_bf16 v[144:159], v[28:31], v[176:179], 0
  v_mfma_f32_32x32x16_bf16 v[160:175], v[32:35], v[176:179], 0
  s_add_u32 s29, s28, 4096
  buffer_load_dwordx4 v[16:19], v2, s[8:11], s29 offen
  s_add_u32 s29, s28, 45056
  buffer_load_dwordx4 v[20:23], v2, s[8:11], s29 offen
  s_add_u32 s29, s28, 86016
  buffer_load_dwordx4 v[24:27], v2, s[8:11], s29 offen
  s_add_u32 s29, s28, 126976
  buffer_load_dwordx4 v[28:31], v2, s[8:11], s29 offen
  s_add_u32 s29, s28, 167936
  buffer_load_dwordx4 v[32:35], v2, s[8:11], s29 offen
  ds_read_b128 v[176:179], v2 offset:2048
  s_waitcnt lgkmcnt(1)
  s_waitcnt vmcnt(15)
  v_mfma_f32_32x32x16_bf16 v[96:111], v[36:39], v[180:183], v[96:111]
  v_mfma_f32_32x32x16_bf16 v[112:127], v[40:43], v[180:183], v[112:127]
  v_mfma_f32_32x32x16_bf16 v[128:143], v[44:47], v[180:183], v[128:143]
  v_mfma_f32_32x32x16_bf16 v[144:159], v[48:51], v[180:183], v[144:159]
  v_mfma_f32_32x32x16_bf16 v[160:175], v[52:55], v[180:183], v[160:175]
  s_add_u32 s29, s28, 5120
  buffer_load_dwordx4 v[36:39], v2, s[8:11], s29 offen
  s_add_u32 s29, s28, 46080
  buffer_load_dwordx4 v[40:43], v2, s[8:11], s29 offen
  s_add_u32 s29, s28, 87040
  buffer_load_dwordx4 v[44:47], v2, s[8:11], s29 offen
  s_add_u32 s29, s28, 128000
  buffer_load_dwordx4 v[48:51], v2, s[8:11], s29 offen
  s_add_u32 s29, s28, 168960
  buffer_load_dwordx4 v[52:55], v2, s[8:11], s29 offen
  ds_read_b128 v[180:183], v2 offset:3072
  s_waitcnt lgkmcnt(1)
  s_waitcnt vmcnt(15)
  v_mfma_f32_32x32x16_bf16 v[96:111], v[56:59], v[176:179], v[96:111]
  v_mfma_f32_32x32x16_bf16 v[112:127], v[60:63], v[176:179], v[112:127]
  v_mfma_f32_32x32x16_bf16 v[128:143], v[64:67], v[176:179], v[128:143]
  v_mfma_f32_32x32x16_bf16 v[144:159], v[68:71], v[176:179], v[144:159]
  v_mfma_f32_32x32x16_bf16 v[160:175], v[72:75], v[176:179], v[160:175]
  s_add_u32 s29, s28, 6144
  buffer_load_dwordx4 v[56:59], v2, s[8:11], s29 offen
  s_add_u32 s29, s28, 47104
  buffer_load_dwordx4 v[60:63], v2, s[8:11], s29 offen
  s_add_u32 s29, s28, 88064
  buffer_load_dwordx4 v[64:67], v2, s[8:11], s29 offen
  s_add_u32 s29, s28, 129024
  buffer_load_dwordx4 v[68:71], v2, s[8:11], s29 offen
  s_add_u32 s29, s28, 169984
  buffer_load_dwordx4 v[72:75], v2, s[8:11], s29 offen
  ds_read_b128 v[176:179], v2 offset:4096
  s_waitcnt lgkmcnt(1)
  s_waitcnt vmcnt(15)
  v_mfma_f32_32x32x16_bf16 v[96:111], v[76:79], v[180:183], v[96:111]
  v_mfma_f32_32x32x16_bf16 v[112:127], v[80:83], v[180:183], v[112:127]
  v_mfma_f32_32x32x16_bf16 v[128:143], v[84:87], v[180:183], v[128:143]
  v_mfma_f32_32x32x16_bf16 v[144:159], v[88:91], v[180:183], v[144:159]
  v_mfma_f32_32x32x16_bf16 v[160:175], v[92:95], v[180:183], v[160:175]
  s_add_u32 s29, s28, 7168
  buffer_load_dwordx4 v[76:79], v2, s[8:11], s29 offen
  s_add_u32 s29, s28, 48128
  buffer_load_dwordx4 v[80:83], v2, s[8:11], s29 offen
  s_add_u32 s29, s28, 89088
  buffer_load_dwordx4 v[84:87], v2, s[8:11], s29 offen
  s_add_u32 s29, s28, 130048
  buffer_load_dwordx4 v[88:91], v2, s[8:11], s29 offen
  s_add_u32 s29, s28, 171008
  buffer_load_dwordx4 v[92:95], v2, s[8:11], s29 offen
  ds_read_b128 v[180:183], v2 offset:5120
  s_waitcnt lgkmcnt(1)
  s_waitcnt vmcnt(15)
  v_mfma_f32_32x32x16_bf16 v[96:111], v[16:19], v[176:179], v[96:111]
  v_mfma_f32_32x32x16_bf16 v[112:127], v[20:23], v[176:179], v[112:127]
  v_mfma_f32_32x32x16_bf16 v[128:143], v[24:27], v[176:179], v[128:143]
  v_mfma_f32_32x32x16_bf16 v[144:159], v[28:31], v[176:179], v[144:159]
  v_mfma_f32_32x32x16_bf16 v[160:175], v[32:35], v[176:179], v[160:175]
  s_add_u32 s29, s28, 8192
  buffer_load_dwordx4 v[16:19], v2, s[8:11], s29 offen
  s_add_u32 s29, s28, 49152
  buffer_load_dwordx4 v[20:23], v2, s[8:11], s29 offen
  s_add_u32 s29, s28, 90112
  buffer_load_dwordx4 v[24:27], v2, s[8:11], s29 offen
  s_add_u32 s29, s28, 131072
  buffer_load_dwordx4 v[28:31], v2, s[8:11], s29 offen
  s_add_u32 s29, s28, 172032
  buffer_load_dwordx4 v[32:35], v2, s[8:11], s29 offen
  ds_read_b128 v[176:179], v2 offset:6144
  s_waitcnt lgkmcnt(1)
  s_waitcnt vmcnt(15)
  v_mfma_f32_32x32x16_bf16 v[96:111], v[36:39], v[180:183], v[96:111]
  v_mfma_f32_32x32x16_bf16 v[112:127], v[40:43], v[180:183], v[112:127]
  v_mfma_f32_32x32x16_bf16 v[128:143], v[44:47], v[180:183], v[128:143]
  v_mfma_f32_32x32x16_bf16 v[144:159], v[48:51], v[180:183], v[144:159]
  v_mfma_f32_32x32x16_bf16 v[160:175], v[52:55], v[180:183], v[160:175]
  s_add_u32 s29, s28, 9216
  buffer_load_dwordx4 v[36:39], v2, s[8:11], s29 offen
  s_add_u32 s29, s28, 50176
  buffer_load_dwordx4 v[40:43], v2, s[8:11], s29 offen
  s_add_u32 s29, s28, 91136
  buffer_load_dwordx4 v[44:47], v2, s[8:11], s29 offen
  s_add_u32 s29, s28, 132096
  buffer_load_dwordx4 v[48:51], v2, s[8:11], s29 offen
  s_add_u32 s29, s28, 173056
  buffer_load_dwordx4 v[52:55], v2, s[8:11], s29 offen
  ds_read_b128 v[180:183], v2 offset:7168
  s_waitcnt lgkmcnt(1)
  s_waitcnt vmcnt(15)
  v_mfma_f32_32x32x16_bf16 v[96:111], v[56:59], v[176:179], v[96:111]
  v_mfma_f32_32x32x16_bf16 v[112:127], v[60:63], v[176:179], v[112:127]
  v_mfma_f32_32x32x16_bf16 v[128:143], v[64:67], v[176:179], v[128:143]
  v_mfma_f32_32x32x16_bf16 v[144:159], v[68:71], v[176:179], v[144:159]
  v_mfma_f32_32x32x16_bf16 v[160:175], v[72:75], v[176:179], v[160:175]
  s_add_u32 s29, s28, 10240
  buffer_load_dwordx4 v[56:59], v2, s[8:11], s29 offen
  s_add_u32 s29, s28, 51200
  buffer_load_dwordx4 v[60:63], v2, s[8:11], s29 offen
  s_add_u32 s29, s28, 92160
  buffer_load_dwordx4 v[64:67], v2, s[8:11], s29 offen
  s_add_u32 s29, s28, 133120
  buffer_load_dwordx4 v[68:71], v2, s[8:11], s29 offen
  s_add_u32 s29, s28, 174080
  buffer_load_dwordx4 v[72:75], v2, s[8:11], s29 offen
  ds_read_b128 v[176:179], v2 offset:8192
  s_waitcnt lgkmcnt(1)
  s_waitcnt vmcnt(15)
  v_mfma_f32_32x32x16_bf16 v[96:111], v[76:79], v[180:183], v[96:111]
  v_mfma_f32_32x32x16_bf16 v[112:127], v[80:83], v[180:183], v[112:127]
  v_mfma_f32_32x32x16_bf16 v[128:143], v[84:87], v[180:183], v[128:143]
  v_mfma_f32_32x32x16_bf16 v[144:159], v[88:91], v[180:183], v[144:159]
  v_mfma_f32_32x32x16_bf16 v[160:175], v[92:95], v[180:183], v[160:175]
  s_add_u32 s29, s28, 11264
  buffer_load_dwordx4 v[76:79], v2, s[8:11], s29 offen
  s_add_u32 s29, s28, 52224
  buffer_load_dwordx4 v[80:83], v2, s[8:11], s29 offen
  s_add_u32 s29, s28, 93184
  buffer_load_dwordx4 v[84:87], v2, s[8:11], s29 offen
  s_add_u32 s29, s28, 134144
  buffer_load_dwordx4 v[88:91], v2, s[8:11], s29 offen
  s_add_u32 s29, s28, 175104
  buffer_load_dwordx4 v[92:95], v2, s[8:11], s29 offen
  ds_read_b128 v[180:183], v2 offset:9216
  s_waitcnt lgkmcnt(1)
  s_waitcnt vmcnt(15)
  v_mfma_f32_32x32x16_bf16 v[96:111], v[16:19], v[176:179], v[96:111]
  v_mfma_f32_32x32x16_bf16 v[112:127], v[20:23], v[176:179], v[112:127]
  v_mfma_f32_32x32x16_bf16 v[128:143], v[24:27], v[176:179], v[128:143]
  v_mfma_f32_32x32x16_bf16 v[144:159], v[28:31], v[176:179], v[144:159]
  v_mfma_f32_32x32x16_bf16 v[160:175], v[32:35], v[176:179], v[160:175]
  s_add_u32 s29, s28, 12288
  buffer_load_dwordx4 v[16:19], v2, s[8:11], s29 offen
  s_add_u32 s29, s28, 53248
  buffer_load_dwordx4 v[20:23], v2, s[8:11], s29 offen
  s_add_u32 s29, s28, 94208
  buffer_load_dwordx4 v[24:27], v2, s[8:11], s29 offen
  s_add_u32 s29, s28, 135168
  buffer_load_dwordx4 v[28:31], v2, s[8:11], s29 offen
  s_add_u32 s29, s28, 176128
  buffer_load_dwordx4 v[32:35], v2, s[8:11], s29 offen
  ds_read_b128 v[176:179], v2 offset:10240
  s_waitcnt lgkmcnt(1)
  s_waitcnt vmcnt(15)
  v_mfma_f32_32x32x16_bf16 v[96:111], v[36:39], v[180:183], v[96:111]
  v_mfma_f32_32x32x16_bf16 v[112:127], v[40:43], v[180:183], v[112:127]
  v_mfma_f32_32x32x16_bf16 v[128:143], v[44:47], v[180:183], v[128:143]
  v_mfma_f32_32x32x16_bf16 v[144:159], v[48:51], v[180:183], v[144:159]
  v_mfma_f32_32x32x16_bf16 v[160:175], v[52:55], v[180:183], v[160:175]
  s_add_u32 s29, s28, 13312
  buffer_load_dwordx4 v[36:39], v2, s[8:11], s29 offen
  s_add_u32 s29, s28, 54272
  buffer_load_dwordx4 v[40:43], v2, s[8:11], s29 offen
  s_add_u32 s29, s28, 95232
  buffer_load_dwordx4 v[44:47], v2, s[8:11], s29 offen
  s_add_u32 s29, s28, 136192
  buffer_load_dwordx4 v[48:51], v2, s[8:11], s29 offen
  s_add_u32 s29, s28, 177152
  buffer_load_dwordx4 v[52:55], v2, s[8:11], s29 offen
  ds_read_b128 v[180:183], v2 offset:11264
  s_waitcnt lgkmcnt(1)
  s_waitcnt vmcnt(15)
  v_mfma_f32_32x32x16_bf16 v[96:111], v[56:59], v[176:179], v[96:111]
  v_mfma_f32_32x32x16_bf16 v[112:127], v[60:63], v[176:179], v[112:127]
  v_mfma_f32_32x32x16_bf16 v[128:143], v[64:67], v[176:179], v[128:143]
  v_mfma_f32_32x32x16_bf16 v[144:159], v[68:71], v[176:179], v[144:159]
  v_mfma_f32_32x32x16_bf16 v[160:175], v[72:75], v[176:179], v[160:175]
  s_add_u32 s29, s28, 14336
  buffer_load_dwordx4 v[56:59], v2, s[8:11], s29 offen
  s_add_u32 s29, s28, 55296
  buffer_load_dwordx4 v[60:63], v2, s[8:11], s29 offen
  s_add_u32 s29, s28, 96256
  buffer_load_dwordx4 v[64:67], v2, s[8:11], s29 offen
  s_add_u32 s29, s28, 137216
  buffer_load_dwordx4 v[68:71], v2, s[8:11], s29 offen
  s_add_u32 s29, s28, 178176
  buffer_load_dwordx4 v[72:75], v2, s[8:11], s29 offen
  ds_read_b128 v[176:179], v2 offset:12288
  s_waitcnt lgkmcnt(1)
  s_waitcnt vmcnt(15)
  v_mfma_f32_32x32x16_bf16 v[96:111], v[76:79], v[180:183], v[96:111]
  v_mfma_f32_32x32x16_bf16 v[112:127], v[80:83], v[180:183], v[112:127]
  v_mfma_f32_32x32x16_bf16 v[128:143], v[84:87], v[180:183], v[128:143]
  v_mfma_f32_32x32x16_bf16 v[144:159], v[88:91], v[180:183], v[144:159]
  v_mfma_f32_32x32x16_bf16 v[160:175], v[92:95], v[180:183], v[160:175]
  s_add_u32 s29, s28, 15360
  buffer_load_dwordx4 v[76:79], v2, s[8:11], s29 offen
  s_add_u32 s29, s28, 56320
  buffer_load_dwordx4 v[80:83], v2, s[8:11], s29 offen
  s_add_u32 s29, s28, 97280
  buffer_load_dwordx4 v[84:87], v2, s[8:11], s29 offen
  s_add_u32 s29, s28, 138240
  buffer_load_dwordx4 v[88:91], v2, s[8:11], s29 offen
  s_add_u32 s29, s28, 179200
  buffer_load_dwordx4 v[92:95], v2, s[8:11], s29 offen
  ds_read_b128 v[180:183], v2 offset:13312
  s_waitcnt lgkmcnt(1)
  s_waitcnt vmcnt(15)
  v_mfma_f32_32x32x16_bf16 v[96:111], v[16:19], v[176:179], v[96:111]
  v_mfma_f32_32x32x16_bf16 v[112:127], v[20:23], v[176:179], v[112:127]
  v_mfma_f32_32x32x16_bf16 v[128:143], v[24:27], v[176:179], v[128:143]
  v_mfma_f32_32x32x16_bf16 v[144:159], v[28:31], v[176:179], v[144:159]
  v_mfma_f32_32x32x16_bf16 v[160:175], v[32:35], v[176:179], v[160:175]
  s_add_u32 s29, s28, 16384
  buffer_load_dwordx4 v[16:19], v2, s[8:11], s29 offen
  s_add_u32 s29, s28, 57344
  buffer_load_dwordx4 v[20:23], v2, s[8:11], s29 offen
  s_add_u32 s29, s28, 98304
  buffer_load_dwordx4 v[24:27], v2, s[8:11], s29 offen
  s_add_u32 s29, s28, 139264
  buffer_load_dwordx4 v[28:31], v2, s[8:11], s29 offen
  s_add_u32 s29, s28, 180224
  buffer_load_dwordx4 v[32:35], v2, s[8:11], s29 offen
  ds_read_b128 v[176:179], v2 offset:14336
  s_waitcnt lgkmcnt(1)
  s_waitcnt vmcnt(15)
  v_mfma_f32_32x32x16_bf16 v[96:111], v[36:39], v[180:183], v[96:111]
  v_mfma_f32_32x32x16_bf16 v[112:127], v[40:43], v[180:183], v[112:127]
  v_mfma_f32_32x32x16_bf16 v[128:143], v[44:47], v[180:183], v[128:143]
  v_mfma_f32_32x32x16_bf16 v[144:159], v[48:51], v[180:183], v[144:159]
  v_mfma_f32_32x32x16_bf16 v[160:175], v[52:55], v[180:183], v[160:175]
  s_add_u32 s29, s28, 17408
  buffer_load_dwordx4 v[36:39], v2, s[8:11], s29 offen
  s_add_u32 s29, s28, 58368
  buffer_load_dwordx4 v[40:43], v2, s[8:11], s29 offen
  s_add_u32 s29, s28, 99328
  buffer_load_dwordx4 v[44:47], v2, s[8:11], s29 offen
  s_add_u32 s29, s28, 140288
  buffer_load_dwordx4 v[48:51], v2, s[8:11], s29 offen
  s_add_u32 s29, s28, 181248
  buffer_load_dwordx4 v[52:55], v2, s[8:11], s29 offen
  ds_read_b128 v[180:183], v2 offset:15360
  s_waitcnt lgkmcnt(1)
  s_waitcnt vmcnt(15)
  v_mfma_f32_32x32x16_bf16 v[96:111], v[56:59], v[176:179], v[96:111]
  v_mfma_f32_32x32x16_bf16 v[112:127], v[60:63], v[176:179], v[112:127]
  v_mfma_f32_32x32x16_bf16 v[128:143], v[64:67], v[176:179], v[128:143]
  v_mfma_f32_32x32x16_bf16 v[144:159], v[68:71], v[176:179], v[144:159]
  v_mfma_f32_32x32x16_bf16 v[160:175], v[72:75], v[176:179], v[160:175]
  s_add_u32 s29, s28, 18432
  buffer_load_dwordx4 v[56:59], v2, s[8:11], s29 offen
  s_add_u32 s29, s28, 59392
  buffer_load_dwordx4 v[60:63], v2, s[8:11], s29 offen
  s_add_u32 s29, s28, 100352
  buffer_load_dwordx4 v[64:67], v2, s[8:11], s29 offen
  s_add_u32 s29, s28, 141312
  buffer_load_dwordx4 v[68:71], v2, s[8:11], s29 offen
  s_add_u32 s29, s28, 182272
  buffer_load_dwordx4 v[72:75], v2, s[8:11], s29 offen
  ds_read_b128 v[176:179], v2 offset:16384
  s_waitcnt lgkmcnt(1)
  s_waitcnt vmcnt(15)
  v_mfma_f32_32x32x16_bf16 v[96:111], v[76:79], v[180:183], v[96:111]
  v_mfma_f32_32x32x16_bf16 v[112:127], v[80:83], v[180:183], v[112:127]
  v_mfma_f32_32x32x16_bf16 v[128:143], v[84:87], v[180:183], v[128:143]
  v_mfma_f32_32x32x16_bf16 v[144:159], v[88:91], v[180:183], v[144:159]
  v_mfma_f32_32x32x16_bf16 v[160:175], v[92:95], v[180:183], v[160:175]
  s_add_u32 s29, s28, 19456
  buffer_load_dwordx4 v[76:79], v2, s[8:11], s29 offen
  s_add_u32 s29, s28, 60416
  buffer_load_dwordx4 v[80:83], v2, s[8:11], s29 offen
  s_add_u32 s29, s28, 101376
  buffer_load_dwordx4 v[84:87], v2, s[8:11], s29 offen
  s_add_u32 s29, s28, 142336
  buffer_load_dwordx4 v[88:91], v2, s[8:11], s29 offen
  s_add_u32 s29, s28, 183296
  buffer_load_dwordx4 v[92:95], v2, s[8:11], s29 offen
  ds_read_b128 v[180:183], v2 offset:17408
  s_waitcnt lgkmcnt(1)
  s_waitcnt vmcnt(15)
  v_mfma_f32_32x32x16_bf16 v[96:111], v[16:19], v[176:179], v[96:111]
  v_mfma_f32_32x32x16_bf16 v[112:127], v[20:23], v[176:179], v[112:127]
  v_mfma_f32_32x32x16_bf16 v[128:143], v[24:27], v[176:179], v[128:143]
  v_mfma_f32_32x32x16_bf16 v[144:159], v[28:31], v[176:179], v[144:159]
  v_mfma_f32_32x32x16_bf16 v[160:175], v[32:35], v[176:179], v[160:175]
  s_add_u32 s29, s28, 20480
  buffer_load_dwordx4 v[16:19], v2, s[8:11], s29 offen
  s_add_u32 s29, s28, 61440
  buffer_load_dwordx4 v[20:23], v2, s[8:11], s29 offen
  s_add_u32 s29, s28, 102400
  buffer_load_dwordx4 v[24:27], v2, s[8:11], s29 offen
  s_add_u32 s29, s28, 143360
  buffer_load_dwordx4 v[28:31], v2, s[8:11], s29 offen
  s_add_u32 s29, s28, 184320
  buffer_load_dwordx4 v[32:35], v2, s[8:11], s29 offen
  ds_read_b128 v[176:179], v2 offset:18432
  s_waitcnt lgkmcnt(1)
  s_waitcnt vmcnt(15)
  v_mfma_f32_32x32x16_bf16 v[96:111], v[36:39], v[180:183], v[96:111]
  v_mfma_f32_32x32x16_bf16 v[112:127], v[40:43], v[180:183], v[112:127]
  v_mfma_f32_32x32x16_bf16 v[128:143], v[44:47], v[180:183], v[128:143]
  v_mfma_f32_32x32x16_bf16 v[144:159], v[48:51], v[180:183], v[144:159]
  v_mfma_f32_32x32x16_bf16 v[160:175], v[52:55], v[180:183], v[160:175]
  s_add_u32 s29, s28, 21504
  buffer_load_dwordx4 v[36:39], v2, s[8:11], s29 offen
  s_add_u32 s29, s28, 62464
  buffer_load_dwordx4 v[40:43], v2, s[8:11], s29 offen
  s_add_u32 s29, s28, 103424
  buffer_load_dwordx4 v[44:47], v2, s[8:11], s29 offen
  s_add_u32 s29, s28, 144384
  buffer_load_dwordx4 v[48:51], v2, s[8:11], s29 offen
  s_add_u32 s29, s28, 185344
  buffer_load_dwordx4 v[52:55], v2, s[8:11], s29 offen
  ds_read_b128 v[180:183], v2 offset:19456
  s_waitcnt lgkmcnt(1)
  s_waitcnt vmcnt(15)
  v_mfma_f32_32x32x16_bf16 v[96:111], v[56:59], v[176:179], v[96:111]
  v_mfma_f32_32x32x16_bf16 v[112:127], v[60:63], v[176:179], v[112:127]
  v_mfma_f32_32x32x16_bf16 v[128:143], v[64:67], v[176:179], v[128:143]
  v_mfma_f32_32x32x16_bf16 v[144:159], v[68:71], v[176:179], v[144:159]
  v_mfma_f32_32x32x16_bf16 v[160:175], v[72:75], v[176:179], v[160:175]
  s_add_u32 s29, s28, 22528
  buffer_load_dwordx4 v[56:59], v2, s[8:11], s29 offen
  s_add_u32 s29, s28, 63488
  buffer_load_dwordx4 v[60:63], v2, s[8:11], s29 offen
  s_add_u32 s29, s28, 104448
  buffer_load_dwordx4 v[64:67], v2, s[8:11], s29 offen
  s_add_u32 s29, s28, 145408
  buffer_load_dwordx4 v[68:71], v2, s[8:11], s29 offen
  s_add_u32 s29, s28, 186368
  buffer_load_dwordx4 v[72:75], v2, s[8:11], s29 offen
  ds_read_b128 v[176:179], v2 offset:20480
  s_waitcnt lgkmcnt(1)
  s_waitcnt vmcnt(15)
  v_mfma_f32_32x32x16_bf16 v[96:111], v[76:79], v[180:183], v[96:111]
  v_mfma_f32_32x32x16_bf16 v[112:127], v[80:83], v[180:183], v[112:127]
  v_mfma_f32_32x32x16_bf16 v[128:143], v[84:87], v[180:183], v[128:143]
  v_mfma_f32_32x32x16_bf16 v[144:159], v[88:91], v[180:183], v[144:159]
  v_mfma_f32_32x32x16_bf16 v[160:175], v[92:95], v[180:183], v[160:175]
  s_add_u32 s29, s28, 23552
  buffer_load_dwordx4 v[76:79], v2, s[8:11], s29 offen
  s_add_u32 s29, s28, 64512
  buffer_load_dwordx4 v[80:83], v2, s[8:11], s29 offen
  s_add_u32 s29, s28, 105472
  buffer_load_dwordx4 v[84:87], v2, s[8:11], s29 offen
  s_add_u32 s29, s28, 146432
  buffer_load_dwordx4 v[88:91], v2, s[8:11], s29 offen
  s_add_u32 s29, s28, 187392
  buffer_load_dwordx4 v[92:95], v2, s[8:11], s29 offen
  ds_read_b128 v[180:183], v2 offset:21504
  s_waitcnt lgkmcnt(1)
  s_waitcnt vmcnt(15)
  v_mfma_f32_32x32x16_bf16 v[96:111], v[16:19], v[176:179], v[96:111]
  v_mfma_f32_32x32x16_bf16 v[112:127], v[20:23], v[176:179], v[112:127]
  v_mfma_f32_32x32x16_bf16 v[128:143], v[24:27], v[176:179], v[128:143]
  v_mfma_f32_32x32x16_bf16 v[144:159], v[28:31], v[176:179], v[144:159]
  v_mfma_f32_32x32x16_bf16 v[160:175], v[32:35], v[176:179], v[160:175]
  s_add_u32 s29, s28, 24576
  buffer_load_dwordx4 v[16:19], v2, s[8:11], s29 offen
  s_add_u32 s29, s28, 65536
  buffer_load_dwordx4 v[20:23], v2, s[8:11], s29 offen
  s_add_u32 s29, s28, 106496
  buffer_load_dwordx4 v[24:27], v2, s[8:11], s29 offen
  s_add_u32 s29, s28, 147456
  buffer_load_dwordx4 v[28:31], v2, s[8:11], s29 offen
  s_add_u32 s29, s28, 188416
  buffer_load_dwordx4 v[32:35], v2, s[8:11], s29 offen
  ds_read_b128 v[176:179], v2 offset:22528
  s_waitcnt lgkmcnt(1)
  s_waitcnt vmcnt(15)
  v_mfma_f32_32x32x16_bf16 v[96:111], v[36:39], v[180:183], v[96:111]
  v_mfma_f32_32x32x16_bf16 v[112:127], v[40:43], v[180:183], v[112:127]
  v_mfma_f32_32x32x16_bf16 v[128:143], v[44:47], v[180:183], v[128:143]
  v_mfma_f32_32x32x16_bf16 v[144:159], v[48:51], v[180:183], v[144:159]
  v_mfma_f32_32x32x16_bf16 v[160:175], v[52:55], v[180:183], v[160:175]
  s_add_u32 s29, s28, 25600
  buffer_load_dwordx4 v[36:39], v2, s[8:11], s29 offen
  s_add_u32 s29, s28, 66560
  buffer_load_dwordx4 v[40:43], v2, s[8:11], s29 offen
  s_add_u32 s29, s28, 107520
  buffer_load_dwordx4 v[44:47], v2, s[8:11], s29 offen
  s_add_u32 s29, s28, 148480
  buffer_load_dwordx4 v[48:51], v2, s[8:11], s29 offen
  s_add_u32 s29, s28, 189440
  buffer_load_dwordx4 v[52:55], v2, s[8:11], s29 offen
  ds_read_b128 v[180:183], v2 offset:23552
  s_waitcnt lgkmcnt(1)
  s_waitcnt vmcnt(15)
  v_mfma_f32_32x32x16_bf16 v[96:111], v[56:59], v[176:179], v[96:111]
  v_mfma_f32_32x32x16_bf16 v[112:127], v[60:63], v[176:179], v[112:127]
  v_mfma_f32_32x32x16_bf16 v[128:143], v[64:67], v[176:179], v[128:143]
  v_mfma_f32_32x32x16_bf16 v[144:159], v[68:71], v[176:179], v[144:159]
  v_mfma_f32_32x32x16_bf16 v[160:175], v[72:75], v[176:179], v[160:175]
  s_add_u32 s29, s28, 26624
  buffer_load_dwordx4 v[56:59], v2, s[8:11], s29 offen
  s_add_u32 s29, s28, 67584
  buffer_load_dwordx4 v[60:63], v2, s[8:11], s29 offen
  s_add_u32 s29, s28, 108544
  buffer_load_dwordx4 v[64:67], v2, s[8:11], s29 offen
  s_add_u32 s29, s28, 149504
  buffer_load_dwordx4 v[68:71], v2, s[8:11], s29 offen
  s_add_u32 s29, s28, 190464
  buffer_load_dwordx4 v[72:75], v2, s[8:11], s29 offen
  ds_read_b128 v[176:179], v2 offset:24576
  s_waitcnt lgkmcnt(1)
  s_waitcnt vmcnt(15)
  v_mfma_f32_32x32x16_bf16 v[96:111], v[76:79], v[180:183], v[96:111]
  v_mfma_f32_32x32x16_bf16 v[112:127], v[80:83], v[180:183], v[112:127]
  v_mfma_f32_32x32x16_bf16 v[128:143], v[84:87], v[180:183], v[128:143]
  v_mfma_f32_32x32x16_bf16 v[144:159], v[88:91], v[180:183], v[144:159]
  v_mfma_f32_32x32x16_bf16 v[160:175], v[92:95], v[180:183], v[160:175]
  s_add_u32 s29, s28, 27648
  buffer_load_dwordx4 v[76:79], v2, s[8:11], s29 offen
  s_add_u32 s29, s28, 68608
  buffer_load_dwordx4 v[80:83], v2, s[8:11], s29 offen
  s_add_u32 s29, s28, 109568
  buffer_load_dwordx4 v[84:87], v2, s[8:11], s29 offen
  s_add_u32 s29, s28, 150528
  buffer_load_dwordx4 v[88:91], v2, s[8:11], s29 offen
  s_add_u32 s29, s28, 191488
  buffer_load_dwordx4 v[92:95], v2, s[8:11], s29 offen
  ds_read_b128 v[180:183], v2 offset:25600
  s_waitcnt lgkmcnt(1)
  s_waitcnt vmcnt(15)
  v_mfma_f32_32x32x16_bf16 v[96:111], v[16:19], v[176:179], v[96:111]
  v_mfma_f32_32x32x16_bf16 v[112:127], v[20:23], v[176:179], v[112:127]
  v_mfma_f32_32x32x16_bf16 v[128:143], v[24:27], v[176:179], v[128:143]
  v_mfma_f32_32x32x16_bf16 v[144:159], v[28:31], v[176:179], v[144:159]
  v_mfma_f32_32x32x16_bf16 v[160:175], v[32:35], v[176:179], v[160:175]
  s_add_u32 s29, s28, 28672
  buffer_load_dwordx4 v[16:19], v2, s[8:11], s29 offen
  s_add_u32 s29, s28, 69632
  buffer_load_dwordx4 v[20:23], v2, s[8:11], s29 offen
  s_add_u32 s29, s28, 110592
  buffer_load_dwordx4 v[24:27], v2, s[8:11], s29 offen
  s_add_u32 s29, s28, 151552
  buffer_load_dwordx4 v[28:31], v2, s[8:11], s29 offen
  s_add_u32 s29, s28, 192512
  buffer_load_dwordx4 v[32:35], v2, s[8:11], s29 offen
  ds_read_b128 v[176:179], v2 offset:26624
  s_waitcnt lgkmcnt(1)
  s_waitcnt vmcnt(15)
  v_mfma_f32_32x32x16_bf16 v[96:111], v[36:39], v[180:183], v[96:111]
  v_mfma_f32_32x32x16_bf16 v[112:127], v[40:43], v[180:183], v[112:127]
  v_mfma_f32_32x32x16_bf16 v[128:143], v[44:47], v[180:183], v[128:143]
  v_mfma_f32_32x32x16_bf16 v[144:159], v[48:51], v[180:183], v[144:159]
  v_mfma_f32_32x32x16_bf16 v[160:175], v[52:55], v[180:183], v[160:175]
  s_add_u32 s29, s28, 29696
  buffer_load_dwordx4 v[36:39], v2, s[8:11], s29 offen
  s_add_u32 s29, s28, 70656
  buffer_load_dwordx4 v[40:43], v2, s[8:11], s29 offen
  s_add_u32 s29, s28, 111616
  buffer_load_dwordx4 v[44:47], v2, s[8:11], s29 offen
  s_add_u32 s29, s28, 152576
  buffer_load_dwordx4 v[48:51], v2, s[8:11], s29 offen
  s_add_u32 s29, s28, 193536
  buffer_load_dwordx4 v[52:55], v2, s[8:11], s29 offen
  ds_read_b128 v[180:183], v2 offset:27648
  s_waitcnt lgkmcnt(1)
  s_waitcnt vmcnt(15)
  v_mfma_f32_32x32x16_bf16 v[96:111], v[56:59], v[176:179], v[96:111]
  v_mfma_f32_32x32x16_bf16 v[112:127], v[60:63], v[176:179], v[112:127]
  v_mfma_f32_32x32x16_bf16 v[128:143], v[64:67], v[176:179], v[128:143]
  v_mfma_f32_32x32x16_bf16 v[144:159], v[68:71], v[176:179], v[144:159]
  v_mfma_f32_32x32x16_bf16 v[160:175], v[72:75], v[176:179], v[160:175]
  s_add_u32 s29, s28, 30720
  buffer_load_dwordx4 v[56:59], v2, s[8:11], s29 offen
  s_add_u32 s29, s28, 71680
  buffer_load_dwordx4 v[60:63], v2, s[8:11], s29 offen
  s_add_u32 s29, s28, 112640
  buffer_load_dwordx4 v[64:67], v2, s[8:11], s29 offen
  s_add_u32 s29, s28, 153600
  buffer_load_dwordx4 v[68:71], v2, s[8:11], s29 offen
  s_add_u32 s29, s28, 194560
  buffer_load_dwordx4 v[72:75], v2, s[8:11], s29 offen
  ds_read_b128 v[176:179], v2 offset:28672
  s_waitcnt lgkmcnt(1)
  s_waitcnt vmcnt(15)
  v_mfma_f32_32x32x16_bf16 v[96:111], v[76:79], v[180:183], v[96:111]
  v_mfma_f32_32x32x16_bf16 v[112:127], v[80:83], v[180:183], v[112:127]
  v_mfma_f32_32x32x16_bf16 v[128:143], v[84:87], v[180:183], v[128:143]
  v_mfma_f32_32x32x16_bf16 v[144:159], v[88:91], v[180:183], v[144:159]
  v_mfma_f32_32x32x16_bf16 v[160:175], v[92:95], v[180:183], v[160:175]
  s_add_u32 s29, s28, 31744
  buffer_load_dwordx4 v[76:79], v2, s[8:11], s29 offen
  s_add_u32 s29, s28, 72704
  buffer_load_dwordx4 v[80:83], v2, s[8:11], s29 offen
  s_add_u32 s29, s28, 113664
  buffer_load_dwordx4 v[84:87], v2, s[8:11], s29 offen
  s_add_u32 s29, s28, 154624
  buffer_load_dwordx4 v[88:91], v2, s[8:11], s29 offen
  s_add_u32 s29, s28, 195584
  buffer_load_dwordx4 v[92:95], v2, s[8:11], s29 offen
  ds_read_b128 v[180:183], v2 offset:29696
  s_waitcnt lgkmcnt(1)
  s_waitcnt vmcnt(15)
  v_mfma_f32_32x32x16_bf16 v[96:111], v[16:19], v[176:179], v[96:111]
  v_mfma_f32_32x32x16_bf16 v[112:127], v[20:23], v[176:179], v[112:127]
  v_mfma_f32_32x32x16_bf16 v[128:143], v[24:27], v[176:179], v[128:143]
  v_mfma_f32_32x32x16_bf16 v[144:159], v[28:31], v[176:179], v[144:159]
  v_mfma_f32_32x32x16_bf16 v[160:175], v[32:35], v[176:179], v[160:175]
  s_add_u32 s29, s28, 32768
  buffer_load_dwordx4 v[16:19], v2, s[8:11], s29 offen
  s_add_u32 s29, s28, 73728
  buffer_load_dwordx4 v[20:23], v2, s[8:11], s29 offen
  s_add_u32 s29, s28, 114688
  buffer_load_dwordx4 v[24:27], v2, s[8:11], s29 offen
  s_add_u32 s29, s28, 155648
  buffer_load_dwordx4 v[28:31], v2, s[8:11], s29 offen
  s_add_u32 s29, s28, 196608
  buffer_load_dwordx4 v[32:35], v2, s[8:11], s29 offen
  ds_read_b128 v[176:179], v2 offset:30720
  s_waitcnt lgkmcnt(1)
  s_waitcnt vmcnt(15)
  v_mfma_f32_32x32x16_bf16 v[96:111], v[36:39], v[180:183], v[96:111]
  v_mfma_f32_32x32x16_bf16 v[112:127], v[40:43], v[180:183], v[112:127]
  v_mfma_f32_32x32x16_bf16 v[128:143], v[44:47], v[180:183], v[128:143]
  v_mfma_f32_32x32x16_bf16 v[144:159], v[48:51], v[180:183], v[144:159]
  v_mfma_f32_32x32x16_bf16 v[160:175], v[52:55], v[180:183], v[160:175]
  s_add_u32 s29, s28, 33792
  buffer_load_dwordx4 v[36:39], v2, s[8:11], s29 offen
  s_add_u32 s29, s28, 74752
  buffer_load_dwordx4 v[40:43], v2, s[8:11], s29 offen
  s_add_u32 s29, s28, 115712
  buffer_load_dwordx4 v[44:47], v2, s[8:11], s29 offen
  s_add_u32 s29, s28, 156672
  buffer_load_dwordx4 v[48:51], v2, s[8:11], s29 offen
  s_add_u32 s29, s28, 197632
  buffer_load_dwordx4 v[52:55], v2, s[8:11], s29 offen
  ds_read_b128 v[180:183], v2 offset:31744
  s_waitcnt lgkmcnt(1)
  s_waitcnt vmcnt(15)
  v_mfma_f32_32x32x16_bf16 v[96:111], v[56:59], v[176:179], v[96:111]
  v_mfma_f32_32x32x16_bf16 v[112:127], v[60:63], v[176:179], v[112:127]
  v_mfma_f32_32x32x16_bf16 v[128:143], v[64:67], v[176:179], v[128:143]
  v_mfma_f32_32x32x16_bf16 v[144:159], v[68:71], v[176:179], v[144:159]
  v_mfma_f32_32x32x16_bf16 v[160:175], v[72:75], v[176:179], v[160:175]
  s_add_u32 s29, s28, 34816
  buffer_load_dwordx4 v[56:59], v2, s[8:11], s29 offen
  s_add_u32 s29, s28, 75776
  buffer_load_dwordx4 v[60:63], v2, s[8:11], s29 offen
  s_add_u32 s29, s28, 116736
  buffer_load_dwordx4 v[64:67], v2, s[8:11], s29 offen
  s_add_u32 s29, s28, 157696
  buffer_load_dwordx4 v[68:71], v2, s[8:11], s29 offen
  s_add_u32 s29, s28, 198656
  buffer_load_dwordx4 v[72:75], v2, s[8:11], s29 offen
  ds_read_b128 v[176:179], v2 offset:32768
  s_waitcnt lgkmcnt(1)
  s_waitcnt vmcnt(15)
  v_mfma_f32_32x32x16_bf16 v[96:111], v[76:79], v[180:183], v[96:111]
  v_mfma_f32_32x32x16_bf16 v[112:127], v[80:83], v[180:183], v[112:127]
  v_mfma_f32_32x32x16_bf16 v[128:143], v[84:87], v[180:183], v[128:143]
  v_mfma_f32_32x32x16_bf16 v[144:159], v[88:91], v[180:183], v[144:159]
  v_mfma_f32_32x32x16_bf16 v[160:175], v[92:95], v[180:183], v[160:175]
  s_add_u32 s29, s28, 35840
  buffer_load_dwordx4 v[76:79], v2, s[8:11], s29 offen
  s_add_u32 s29, s28, 76800
  buffer_load_dwordx4 v[80:83], v2, s[8:11], s29 offen
  s_add_u32 s29, s28, 117760
  buffer_load_dwordx4 v[84:87], v2, s[8:11], s29 offen
  s_add_u32 s29, s28, 158720
  buffer_load_dwordx4 v[88:91], v2, s[8:11], s29 offen
  s_add_u32 s29, s28, 199680
  buffer_load_dwordx4 v[92:95], v2, s[8:11], s29 offen
  ds_read_b128 v[180:183], v2 offset:33792
  s_waitcnt lgkmcnt(1)
  s_waitcnt vmcnt(15)
  v_mfma_f32_32x32x16_bf16 v[96:111], v[16:19], v[176:179], v[96:111]
  v_mfma_f32_32x32x16_bf16 v[112:127], v[20:23], v[176:179], v[112:127]
  v_mfma_f32_32x32x16_bf16 v[128:143], v[24:27], v[176:179], v[128:143]
  v_mfma_f32_32x32x16_bf16 v[144:159], v[28:31], v[176:179], v[144:159]
  v_mfma_f32_32x32x16_bf16 v[160:175], v[32:35], v[176:179], v[160:175]
  s_add_u32 s29, s28, 36864
  buffer_load_dwordx4 v[16:19], v2, s[8:11], s29 offen
  s_add_u32 s29, s28, 77824
  buffer_load_dwordx4 v[20:23], v2, s[8:11], s29 offen
  s_add_u32 s29, s28, 118784
  buffer_load_dwordx4 v[24:27], v2, s[8:11], s29 offen
  s_add_u32 s29, s28, 159744
  buffer_load_dwordx4 v[28:31], v2, s[8:11], s29 offen
  s_add_u32 s29, s28, 200704
  buffer_load_dwordx4 v[32:35], v2, s[8:11], s29 offen
  ds_read_b128 v[176:179], v2 offset:34816
  s_waitcnt lgkmcnt(1)
  s_waitcnt vmcnt(15)
  v_mfma_f32_32x32x16_bf16 v[96:111], v[36:39], v[180:183], v[96:111]
  v_mfma_f32_32x32x16_bf16 v[112:127], v[40:43], v[180:183], v[112:127]
  v_mfma_f32_32x32x16_bf16 v[128:143], v[44:47], v[180:183], v[128:143]
  v_mfma_f32_32x32x16_bf16 v[144:159], v[48:51], v[180:183], v[144:159]
  v_mfma_f32_32x32x16_bf16 v[160:175], v[52:55], v[180:183], v[160:175]
  s_add_u32 s29, s28, 37888
  buffer_load_dwordx4 v[36:39], v2, s[8:11], s29 offen
  s_add_u32 s29, s28, 78848
  buffer_load_dwordx4 v[40:43], v2, s[8:11], s29 offen
  s_add_u32 s29, s28, 119808
  buffer_load_dwordx4 v[44:47], v2, s[8:11], s29 offen
  s_add_u32 s29, s28, 160768
  buffer_load_dwordx4 v[48:51], v2, s[8:11], s29 offen
  s_add_u32 s29, s28, 201728
  buffer_load_dwordx4 v[52:55], v2, s[8:11], s29 offen
  ds_read_b128 v[180:183], v2 offset:35840
  s_waitcnt lgkmcnt(1)
  s_waitcnt vmcnt(15)
  v_mfma_f32_32x32x16_bf16 v[96:111], v[56:59], v[176:179], v[96:111]
  v_mfma_f32_32x32x16_bf16 v[112:127], v[60:63], v[176:179], v[112:127]
  v_mfma_f32_32x32x16_bf16 v[128:143], v[64:67], v[176:179], v[128:143]
  v_mfma_f32_32x32x16_bf16 v[144:159], v[68:71], v[176:179], v[144:159]
  v_mfma_f32_32x32x16_bf16 v[160:175], v[72:75], v[176:179], v[160:175]
  s_add_u32 s29, s28, 38912
  buffer_load_dwordx4 v[56:59], v2, s[8:11], s29 offen
  s_add_u32 s29, s28, 79872
  buffer_load_dwordx4 v[60:63], v2, s[8:11], s29 offen
  s_add_u32 s29, s28, 120832
  buffer_load_dwordx4 v[64:67], v2, s[8:11], s29 offen
  s_add_u32 s29, s28, 161792
  buffer_load_dwordx4 v[68:71], v2, s[8:11], s29 offen
  s_add_u32 s29, s28, 202752
  buffer_load_dwordx4 v[72:75], v2, s[8:11], s29 offen
  ds_read_b128 v[176:179], v2 offset:36864
  s_waitcnt lgkmcnt(1)
  s_waitcnt vmcnt(15)
  v_mfma_f32_32x32x16_bf16 v[96:111], v[76:79], v[180:183], v[96:111]
  v_mfma_f32_32x32x16_bf16 v[112:127], v[80:83], v[180:183], v[112:127]
  v_mfma_f32_32x32x16_bf16 v[128:143], v[84:87], v[180:183], v[128:143]
  v_mfma_f32_32x32x16_bf16 v[144:159], v[88:91], v[180:183], v[144:159]
  v_mfma_f32_32x32x16_bf16 v[160:175], v[92:95], v[180:183], v[160:175]
  s_add_u32 s29, s28, 39936
  buffer_load_dwordx4 v[76:79], v2, s[8:11], s29 offen
  s_add_u32 s29, s28, 80896
  buffer_load_dwordx4 v[80:83], v2, s[8:11], s29 offen
  s_add_u32 s29, s28, 121856
  buffer_load_dwordx4 v[84:87], v2, s[8:11], s29 offen
  s_add_u32 s29, s28, 162816
  buffer_load_dwordx4 v[88:91], v2, s[8:11], s29 offen
  s_add_u32 s29, s28, 203776
  buffer_load_dwordx4 v[92:95], v2, s[8:11], s29 offen
  ds_read_b128 v[180:183], v2 offset:37888
  s_waitcnt lgkmcnt(1)
  s_waitcnt vmcnt(15)
  v_mfma_f32_32x32x16_bf16 v[96:111], v[16:19], v[176:179], v[96:111]
  v_mfma_f32_32x32x16_bf16 v[112:127], v[20:23], v[176:179], v[112:127]
  v_mfma_f32_32x32x16_bf16 v[128:143], v[24:27], v[176:179], v[128:143]
  v_mfma_f32_32x32x16_bf16 v[144:159], v[28:31], v[176:179], v[144:159]
  v_mfma_f32_32x32x16_bf16 v[160:175], v[32:35], v[176:179], v[160:175]
  ds_read_b128 v[176:179], v2 offset:38912
  s_waitcnt lgkmcnt(1)
  s_waitcnt vmcnt(10)
  v_mfma_f32_32x32x16_bf16 v[96:111], v[36:39], v[180:183], v[96:111]
  v_mfma_f32_32x32x16_bf16 v[112:127], v[40:43], v[180:183], v[112:127]
  v_mfma_f32_32x32x16_bf16 v[128:143], v[44:47], v[180:183], v[128:143]
  v_mfma_f32_32x32x16_bf16 v[144:159], v[48:51], v[180:183], v[144:159]
  v_mfma_f32_32x32x16_bf16 v[160:175], v[52:55], v[180:183], v[160:175]
  ds_read_b128 v[180:183], v2 offset:39936
  s_waitcnt lgkmcnt(1)
  s_waitcnt vmcnt(5)
  v_mfma_f32_32x32x16_bf16 v[96:111], v[56:59], v[176:179], v[96:111]
  v_mfma_f32_32x32x16_bf16 v[112:127], v[60:63], v[176:179], v[112:127]
  v_mfma_f32_32x32x16_bf16 v[128:143], v[64:67], v[176:179], v[128:143]
  v_mfma_f32_32x32x16_bf16 v[144:159], v[68:71], v[176:179], v[144:159]
  v_mfma_f32_32x32x16_bf16 v[160:175], v[72:75], v[176:179], v[160:175]
  s_waitcnt lgkmcnt(0)
  s_waitcnt vmcnt(0)
  v_mfma_f32_32x32x16_bf16 v[96:111], v[76:79], v[180:183], v[96:111]
  v_mfma_f32_32x32x16_bf16 v[112:127], v[80:83], v[180:183], v[112:127]
  v_mfma_f32_32x32x16_bf16 v[128:143], v[84:87], v[180:183], v[128:143]
  v_mfma_f32_32x32x16_bf16 v[144:159], v[88:91], v[180:183], v[144:159]
  v_mfma_f32_32x32x16_bf16 v[160:175], v[92:95], v[180:183], v[160:175]
  s_mul_i32 s24, s2, 81920
  s_mul_i32 s25, s21, 20480
  s_add_u32 s24, s24, s25
  s_add_u32 s24, s24, 0x1400000
  s_add_u32 s29, s24, 0
  buffer_load_dwordx4 v[16:19], v2, s[8:11], s29 offen
  s_add_u32 s29, s24, 1024
  buffer_load_dwordx4 v[20:23], v2, s[8:11], s29 offen
  s_add_u32 s29, s24, 2048
  buffer_load_dwordx4 v[24:27], v2, s[8:11], s29 offen
  s_add_u32 s29, s24, 3072
  buffer_load_dwordx4 v[28:31], v2, s[8:11], s29 offen
  s_add_u32 s29, s24, 4096
  buffer_load_dwordx4 v[32:35], v2, s[8:11], s29 offen
  s_add_u32 s29, s24, 5120
  buffer_load_dwordx4 v[36:39], v2, s[8:11], s29 offen
  s_add_u32 s29, s24, 6144
  buffer_load_dwordx4 v[40:43], v2, s[8:11], s29 offen
  s_add_u32 s29, s24, 7168
  buffer_load_dwordx4 v[44:47], v2, s[8:11], s29 offen
  s_add_u32 s29, s24, 8192
  buffer_load_dwordx4 v[48:51], v2, s[8:11], s29 offen
  s_add_u32 s29, s24, 9216
  buffer_load_dwordx4 v[52:55], v2, s[8:11], s29 offen
  s_add_u32 s29, s24, 10240
  buffer_load_dwordx4 v[56:59], v2, s[8:11], s29 offen
  s_add_u32 s29, s24, 11264
  buffer_load_dwordx4 v[60:63], v2, s[8:11], s29 offen
  s_add_u32 s29, s24, 12288
  buffer_load_dwordx4 v[64:67], v2, s[8:11], s29 offen
  s_add_u32 s29, s24, 13312
  buffer_load_dwordx4 v[68:71], v2, s[8:11], s29 offen
  s_add_u32 s29, s24, 14336
  buffer_load_dwordx4 v[72:75], v2, s[8:11], s29 offen
  s_add_u32 s29, s24, 15360
  buffer_load_dwordx4 v[76:79], v2, s[8:11], s29 offen
  s_add_u32 s29, s24, 16384
  buffer_load_dwordx4 v[80:83], v2, s[8:11], s29 offen
  s_add_u32 s29, s24, 17408
  buffer_load_dwordx4 v[84:87], v2, s[8:11], s29 offen
  s_add_u32 s29, s24, 18432
  buffer_load_dwordx4 v[88:91], v2, s[8:11], s29 offen
  s_add_u32 s29, s24, 19456
  buffer_load_dwordx4 v[92:95], v2, s[8:11], s29 offen
  s_waitcnt vmcnt(0)
  v_add_f32 v96, v96, v16
  v_add_f32 v97, v97, v17
  v_add_f32 v98, v98, v18
  v_add_f32 v99, v99, v19
  v_add_f32 v100, v100, v20
  v_add_f32 v101, v101, v21
  v_add_f32 v102, v102, v22
  v_add_f32 v103, v103, v23
  v_add_f32 v104, v104, v24
  v_add_f32 v105, v105, v25
  v_add_f32 v106, v106, v26
  v_add_f32 v107, v107, v27
  v_add_f32 v108, v108, v28
  v_add_f32 v109, v109, v29
  v_add_f32 v110, v110, v30
  v_add_f32 v111, v111, v31
  v_add_f32 v112, v112, v32
  v_add_f32 v113, v113, v33
  v_add_f32 v114, v114, v34
  v_add_f32 v115, v115, v35
  v_add_f32 v116, v116, v36
  v_add_f32 v117, v117, v37
  v_add_f32 v118, v118, v38
  v_add_f32 v119, v119, v39
  v_add_f32 v120, v120, v40
  v_add_f32 v121, v121, v41
  v_add_f32 v122, v122, v42
  v_add_f32 v123, v123, v43
  v_add_f32 v124, v124, v44
  v_add_f32 v125, v125, v45
  v_add_f32 v126, v126, v46
  v_add_f32 v127, v127, v47
  v_add_f32 v128, v128, v48
  v_add_f32 v129, v129, v49
  v_add_f32 v130, v130, v50
  v_add_f32 v131, v131, v51
  v_add_f32 v132, v132, v52
  v_add_f32 v133, v133, v53
  v_add_f32 v134, v134, v54
  v_add_f32 v135, v135, v55
  v_add_f32 v136, v136, v56
  v_add_f32 v137, v137, v57
  v_add_f32 v138, v138, v58
  v_add_f32 v139, v139, v59
  v_add_f32 v140, v140, v60
  v_add_f32 v141, v141, v61
  v_add_f32 v142, v142, v62
  v_add_f32 v143, v143, v63
  v_add_f32 v144, v144, v64
  v_add_f32 v145, v145, v65
  v_add_f32 v146, v146, v66
  v_add_f32 v147, v147, v67
  v_add_f32 v148, v148, v68
  v_add_f32 v149, v149, v69
  v_add_f32 v150, v150, v70
  v_add_f32 v151, v151, v71
  v_add_f32 v152, v152, v72
  v_add_f32 v153, v153, v73
  v_add_f32 v154, v154, v74
  v_add_f32 v155, v155, v75
  v_add_f32 v156, v156, v76
  v_add_f32 v157, v157, v77
  v_add_f32 v158, v158, v78
  v_add_f32 v159, v159, v79
  v_add_f32 v160, v160, v80
  v_add_f32 v161, v161, v81
  v_add_f32 v162, v162, v82
  v_add_f32 v163, v163, v83
  v_add_f32 v164, v164, v84
  v_add_f32 v165, v165, v85
  v_add_f32 v166, v166, v86
  v_add_f32 v167, v167, v87
  v_add_f32 v168, v168, v88
  v_add_f32 v169, v169, v89
  v_add_f32 v170, v170, v90
  v_add_f32 v171, v171, v91
  v_add_f32 v172, v172, v92
  v_add_f32 v173, v173, v93
  v_add_f32 v174, v174, v94
  v_add_f32 v175, v175, v95
  v_and_b32 v3, 31, v1
  s_lshl_b32 s26, s2, 5
  v_add_u32 v3, s26, v3
  v_mul_u32_u24 v3, 1280, v3
  v_lshrrev_b32 v4, 5, v1
  v_lshlrev_b32 v4, 4, v4
  v_add_u32 v3, v3, v4
  s_mul_i32 s26, s21, 320
  v_cvt_pk_bf16_f32 v16, v96, v97
  v_cvt_pk_bf16_f32 v17, v98, v99
  v_cvt_pk_bf16_f32 v18, v100, v101
  v_cvt_pk_bf16_f32 v19, v102, v103
  v_cvt_pk_bf16_f32 v20, v104, v105
  v_cvt_pk_bf16_f32 v21, v106, v107
  v_cvt_pk_bf16_f32 v22, v108, v109
  v_cvt_pk_bf16_f32 v23, v110, v111
  buffer_store_dwordx4 v[16:19], v3, s[12:15], s26 offen offset:0
  buffer_store_dwordx4 v[20:23], v3, s[12:15], s26 offen offset:32
  v_cvt_pk_bf16_f32 v24, v112, v113
  v_cvt_pk_bf16_f32 v25, v114, v115
  v_cvt_pk_bf16_f32 v26, v116, v117
  v_cvt_pk_bf16_f32 v27, v118, v119
  v_cvt_pk_bf16_f32 v28, v120, v121
  v_cvt_pk_bf16_f32 v29, v122, v123
  v_cvt_pk_bf16_f32 v30, v124, v125
  v_cvt_pk_bf16_f32 v31, v126, v127
  buffer_store_dwordx4 v[24:27], v3, s[12:15], s26 offen offset:64
  buffer_store_dwordx4 v[28:31], v3, s[12:15], s26 offen offset:96
  v_cvt_pk_bf16_f32 v32, v128, v129
  v_cvt_pk_bf16_f32 v33, v130, v131
  v_cvt_pk_bf16_f32 v34, v132, v133
  v_cvt_pk_bf16_f32 v35, v134, v135
  v_cvt_pk_bf16_f32 v36, v136, v137
  v_cvt_pk_bf16_f32 v37, v138, v139
  v_cvt_pk_bf16_f32 v38, v140, v141
  v_cvt_pk_bf16_f32 v39, v142, v143
  buffer_store_dwordx4 v[32:35], v3, s[12:15], s26 offen offset:128
  buffer_store_dwordx4 v[36:39], v3, s[12:15], s26 offen offset:160
  v_cvt_pk_bf16_f32 v40, v144, v145
  v_cvt_pk_bf16_f32 v41, v146, v147
  v_cvt_pk_bf16_f32 v42, v148, v149
  v_cvt_pk_bf16_f32 v43, v150, v151
  v_cvt_pk_bf16_f32 v44, v152, v153
  v_cvt_pk_bf16_f32 v45, v154, v155
  v_cvt_pk_bf16_f32 v46, v156, v157
  v_cvt_pk_bf16_f32 v47, v158, v159
  buffer_store_dwordx4 v[40:43], v3, s[12:15], s26 offen offset:192
  buffer_store_dwordx4 v[44:47], v3, s[12:15], s26 offen offset:224
  v_cvt_pk_bf16_f32 v48, v160, v161
  v_cvt_pk_bf16_f32 v49, v162, v163
  v_cvt_pk_bf16_f32 v50, v164, v165
  v_cvt_pk_bf16_f32 v51, v166, v167
  v_cvt_pk_bf16_f32 v52, v168, v169
  v_cvt_pk_bf16_f32 v53, v170, v171
  v_cvt_pk_bf16_f32 v54, v172, v173
  v_cvt_pk_bf16_f32 v55, v174, v175
  buffer_store_dwordx4 v[48:51], v3, s[12:15], s26 offen offset:256
  buffer_store_dwordx4 v[52:55], v3, s[12:15], s26 offen offset:288
kb3b_exit:
  s_endpgm

.section .rodata,"a"
.p2align 6
.amdhsa_kernel out2_kernel
  .amdhsa_next_free_vgpr 256
  .amdhsa_next_free_sgpr 102
  .amdhsa_accum_offset 256
  .amdhsa_group_segment_fixed_size 0
  .amdhsa_kernarg_size 104
  .amdhsa_user_sgpr_count 2
  .amdhsa_user_sgpr_kernarg_segment_ptr 1
  .amdhsa_system_sgpr_workgroup_id_x 1
.end_amdhsa_kernel
```

```asm
; @launch kernel=prep_kernel grid=(256,1,1) block=(256,1,1) lds=32768
; @launch kernel=ka1_kernel grid=(256,1,1) block=(256,1,1) lds=163840
; @launch kernel=kb1_kernel grid=(256,1,1) block=(256,1,1) lds=135168
; @launch kernel=ka2_kernel grid=(256,1,1) block=(256,1,1) lds=163840
; @launch kernel=kb2_kernel grid=(256,1,1) block=(256,1,1) lds=135168
.amdgcn_target "amdgcn-amd-amdhsa--gfx950"
.text
.globl prep_kernel
.p2align 8
.type prep_kernel,@function
prep_kernel:
  s_cmp_ge_u32 s2, 256
  s_cbranch_scc1 k0_exit
  s_load_dwordx4 s[36:39], s[0:1], 0
  s_load_dwordx4 s[40:43], s[0:1], 32
  s_load_dwordx4 s[44:47], s[0:1], 64
  s_load_dwordx2 s[4:5], s[0:1], 96
  v_lshrrev_b32 v1, 6, v0
  s_nop 0
  v_readfirstlane_b32 s21, v1
  v_and_b32 v1, 63, v0
  v_lshlrev_b32 v2, 4, v1
  s_waitcnt lgkmcnt(0)
  s_mov_b32 s8, s4
  s_and_b32 s9, s5, 0xffff
  s_mov_b32 s10, 0x10000000
  s_mov_b32 s11, 0x20000
  v_mov_b32 v4, -1
  v_mov_b32 v5, -1
  v_mov_b32 v6, -1
  v_mov_b32 v7, -1
  s_mul_i32 s26, s2, 61440
  s_mul_i32 s27, s21, 15360
  s_add_u32 s26, s26, s27
  s_add_u32 s26, s26, 0x400000
  buffer_store_dwordx4 v[4:7], v2, s[8:11], s26 offen
  s_add_u32 s26, s26, 1024
  buffer_store_dwordx4 v[4:7], v2, s[8:11], s26 offen
  s_add_u32 s26, s26, 1024
  buffer_store_dwordx4 v[4:7], v2, s[8:11], s26 offen
  s_add_u32 s26, s26, 1024
  buffer_store_dwordx4 v[4:7], v2, s[8:11], s26 offen
  s_add_u32 s26, s26, 1024
  buffer_store_dwordx4 v[4:7], v2, s[8:11], s26 offen
  s_add_u32 s26, s26, 1024
  buffer_store_dwordx4 v[4:7], v2, s[8:11], s26 offen
  s_add_u32 s26, s26, 1024
  buffer_store_dwordx4 v[4:7], v2, s[8:11], s26 offen
  s_add_u32 s26, s26, 1024
  buffer_store_dwordx4 v[4:7], v2, s[8:11], s26 offen
  s_add_u32 s26, s26, 1024
  buffer_store_dwordx4 v[4:7], v2, s[8:11], s26 offen
  s_add_u32 s26, s26, 1024
  buffer_store_dwordx4 v[4:7], v2, s[8:11], s26 offen
  s_add_u32 s26, s26, 1024
  buffer_store_dwordx4 v[4:7], v2, s[8:11], s26 offen
  s_add_u32 s26, s26, 1024
  buffer_store_dwordx4 v[4:7], v2, s[8:11], s26 offen
  s_add_u32 s26, s26, 1024
  buffer_store_dwordx4 v[4:7], v2, s[8:11], s26 offen
  s_add_u32 s26, s26, 1024
  buffer_store_dwordx4 v[4:7], v2, s[8:11], s26 offen
  s_add_u32 s26, s26, 1024
  buffer_store_dwordx4 v[4:7], v2, s[8:11], s26 offen
  s_add_u32 s26, s26, 1024
  s_cmp_eq_u32 s2, 0
  s_cbranch_scc0 z_1
  s_cmp_eq_u32 s21, 0
  s_cbranch_scc0 z_1
  v_mov_b32 v8, 0
  v_mov_b32 v9, 0
  v_mov_b32 v10, 0
  v_mov_b32 v11, 0
  s_mov_b32 s26, 0x0
  buffer_store_dwordx4 v[8:11], v2, s[8:11], s26 offen
  s_add_u32 s26, s26, 1024
  buffer_store_dwordx4 v[8:11], v2, s[8:11], s26 offen
  s_add_u32 s26, s26, 1024
  buffer_store_dwordx4 v[8:11], v2, s[8:11], s26 offen
  s_add_u32 s26, s26, 1024
  buffer_store_dwordx4 v[8:11], v2, s[8:11], s26 offen
  s_add_u32 s26, s26, 1024
  buffer_store_dwordx4 v[8:11], v2, s[8:11], s26 offen
  s_add_u32 s26, s26, 1024
  buffer_store_dwordx4 v[8:11], v2, s[8:11], s26 offen
  s_add_u32 s26, s26, 1024
  s_mov_b32 s26, 0x8000
  buffer_store_dwordx4 v[8:11], v2, s[8:11], s26 offen
  s_add_u32 s26, s26, 1024
  buffer_store_dwordx4 v[8:11], v2, s[8:11], s26 offen
  s_add_u32 s26, s26, 1024
  buffer_store_dwordx4 v[8:11], v2, s[8:11], s26 offen
  s_add_u32 s26, s26, 1024
  buffer_store_dwordx4 v[8:11], v2, s[8:11], s26 offen
  s_add_u32 s26, s26, 1024
  buffer_store_dwordx4 v[8:11], v2, s[8:11], s26 offen
  s_add_u32 s26, s26, 1024
  buffer_store_dwordx4 v[8:11], v2, s[8:11], s26 offen
  s_add_u32 s26, s26, 1024
  buffer_store_dwordx4 v[8:11], v2, s[8:11], s26 offen
  s_add_u32 s26, s26, 1024
  buffer_store_dwordx4 v[8:11], v2, s[8:11], s26 offen
  s_add_u32 s26, s26, 1024
  buffer_store_dwordx4 v[8:11], v2, s[8:11], s26 offen
  s_add_u32 s26, s26, 1024
  buffer_store_dwordx4 v[8:11], v2, s[8:11], s26 offen
  s_add_u32 s26, s26, 1024
  buffer_store_dwordx4 v[8:11], v2, s[8:11], s26 offen
  s_add_u32 s26, s26, 1024
  buffer_store_dwordx4 v[8:11], v2, s[8:11], s26 offen
  s_add_u32 s26, s26, 1024
  buffer_store_dwordx4 v[8:11], v2, s[8:11], s26 offen
  s_add_u32 s26, s26, 1024
  buffer_store_dwordx4 v[8:11], v2, s[8:11], s26 offen
  s_add_u32 s26, s26, 1024
  buffer_store_dwordx4 v[8:11], v2, s[8:11], s26 offen
  s_add_u32 s26, s26, 1024
  buffer_store_dwordx4 v[8:11], v2, s[8:11], s26 offen
  s_add_u32 s26, s26, 1024
z_1:
  s_cmp_eq_u32 s2, 1
  s_cbranch_scc0 m0_2
  s_cmp_eq_u32 s21, 0
  s_cbranch_scc0 m0_2
  s_mov_b32 s12, s38
  s_and_b32 s13, s39, 0xffff
  s_mov_b32 s14, 0x2800
  s_mov_b32 s15, 0x20000
  v_and_b32 v8, 7, v1
  v_mul_u32_u24 v8, 1280, v8
  v_lshrrev_b32 v9, 4, v1
  v_lshlrev_b32 v9, 5, v9
  v_add_u32 v8, v8, v9
  v_bfe_u32 v9, v1, 3, 1
  v_lshlrev_b32 v9, 2, v9
  v_add_u32 v8, v8, v9
  s_mov_b32 s26, 0x4000
  buffer_load_dword v12, v8, s[12:15], 0 offen offset:0
  buffer_load_dword v13, v8, s[12:15], 0 offen offset:8
  buffer_load_dword v14, v8, s[12:15], 0 offen offset:16
  buffer_load_dword v15, v8, s[12:15], 0 offen offset:24
  s_waitcnt vmcnt(0)
  buffer_store_dwordx4 v[12:15], v2, s[8:11], s26 offen
  s_add_u32 s26, s26, 1024
  s_nop 1
  buffer_load_dword v12, v8, s[12:15], 0 offen offset:128
  buffer_load_dword v13, v8, s[12:15], 0 offen offset:136
  buffer_load_dword v14, v8, s[12:15], 0 offen offset:144
  buffer_load_dword v15, v8, s[12:15], 0 offen offset:152
  s_waitcnt vmcnt(0)
  buffer_store_dwordx4 v[12:15], v2, s[8:11], s26 offen
  s_add_u32 s26, s26, 1024
  s_nop 1
  buffer_load_dword v12, v8, s[12:15], 0 offen offset:256
  buffer_load_dword v13, v8, s[12:15], 0 offen offset:264
  buffer_load_dword v14, v8, s[12:15], 0 offen offset:272
  buffer_load_dword v15, v8, s[12:15], 0 offen offset:280
  s_waitcnt vmcnt(0)
  buffer_store_dwordx4 v[12:15], v2, s[8:11], s26 offen
  s_add_u32 s26, s26, 1024
  s_nop 1
  buffer_load_dword v12, v8, s[12:15], 0 offen offset:384
  buffer_load_dword v13, v8, s[12:15], 0 offen offset:392
  buffer_load_dword v14, v8, s[12:15], 0 offen offset:400
  buffer_load_dword v15, v8, s[12:15], 0 offen offset:408
  s_waitcnt vmcnt(0)
  buffer_store_dwordx4 v[12:15], v2, s[8:11], s26 offen
  s_add_u32 s26, s26, 1024
  s_nop 1
  buffer_load_dword v12, v8, s[12:15], 0 offen offset:512
  buffer_load_dword v13, v8, s[12:15], 0 offen offset:520
  buffer_load_dword v14, v8, s[12:15], 0 offen offset:528
  buffer_load_dword v15, v8, s[12:15], 0 offen offset:536
  s_waitcnt vmcnt(0)
  buffer_store_dwordx4 v[12:15], v2, s[8:11], s26 offen
  s_add_u32 s26, s26, 1024
  s_nop 1
  buffer_load_dword v12, v8, s[12:15], 0 offen offset:640
  buffer_load_dword v13, v8, s[12:15], 0 offen offset:648
  buffer_load_dword v14, v8, s[12:15], 0 offen offset:656
  buffer_load_dword v15, v8, s[12:15], 0 offen offset:664
  s_waitcnt vmcnt(0)
  buffer_store_dwordx4 v[12:15], v2, s[8:11], s26 offen
  s_add_u32 s26, s26, 1024
  s_nop 1
  buffer_load_dword v12, v8, s[12:15], 0 offen offset:768
  buffer_load_dword v13, v8, s[12:15], 0 offen offset:776
  buffer_load_dword v14, v8, s[12:15], 0 offen offset:784
  buffer_load_dword v15, v8, s[12:15], 0 offen offset:792
  s_waitcnt vmcnt(0)
  buffer_store_dwordx4 v[12:15], v2, s[8:11], s26 offen
  s_add_u32 s26, s26, 1024
  s_nop 1
  buffer_load_dword v12, v8, s[12:15], 0 offen offset:896
  buffer_load_dword v13, v8, s[12:15], 0 offen offset:904
  buffer_load_dword v14, v8, s[12:15], 0 offen offset:912
  buffer_load_dword v15, v8, s[12:15], 0 offen offset:920
  s_waitcnt vmcnt(0)
  buffer_store_dwordx4 v[12:15], v2, s[8:11], s26 offen
  s_add_u32 s26, s26, 1024
  s_nop 1
  buffer_load_dword v12, v8, s[12:15], 0 offen offset:1024
  buffer_load_dword v13, v8, s[12:15], 0 offen offset:1032
  buffer_load_dword v14, v8, s[12:15], 0 offen offset:1040
  buffer_load_dword v15, v8, s[12:15], 0 offen offset:1048
  s_waitcnt vmcnt(0)
  buffer_store_dwordx4 v[12:15], v2, s[8:11], s26 offen
  s_add_u32 s26, s26, 1024
  s_nop 1
  buffer_load_dword v12, v8, s[12:15], 0 offen offset:1152
  buffer_load_dword v13, v8, s[12:15], 0 offen offset:1160
  buffer_load_dword v14, v8, s[12:15], 0 offen offset:1168
  buffer_load_dword v15, v8, s[12:15], 0 offen offset:1176
  s_waitcnt vmcnt(0)
  buffer_store_dwordx4 v[12:15], v2, s[8:11], s26 offen
  s_add_u32 s26, s26, 1024
  s_nop 1
m0_2:
  s_cmp_eq_u32 s21, 3
  s_cbranch_scc0 ln_3
  s_mov_b32 s12, s36
  s_and_b32 s13, s37, 0xffff
  s_mov_b32 s14, 0x280000
  s_mov_b32 s15, 0x20000
  v_lshrrev_b32 v8, 3, v1
  v_and_b32 v9, 7, v1
  s_lshl_b32 s26, s2, 3
  v_add_u32 v10, s26, v8
  v_mul_u32_u24 v11, 1280, v10
  v_lshlrev_b32 v12, 4, v9
  v_add_u32 v11, v11, v12
  buffer_load_dwordx4 v[16:19], v11, s[12:15], 0 offen offset:0
  buffer_load_dwordx4 v[20:23], v11, s[12:15], 0 offen offset:128
  buffer_load_dwordx4 v[24:27], v11, s[12:15], 0 offen offset:256
  buffer_load_dwordx4 v[28:31], v11, s[12:15], 0 offen offset:384
  buffer_load_dwordx4 v[32:35], v11, s[12:15], 0 offen offset:512
  buffer_load_dwordx4 v[36:39], v11, s[12:15], 0 offen offset:640
  buffer_load_dwordx4 v[40:43], v11, s[12:15], 0 offen offset:768
  buffer_load_dwordx4 v[44:47], v11, s[12:15], 0 offen offset:896
  buffer_load_dwordx4 v[48:51], v11, s[12:15], 0 offen offset:1024
  buffer_load_dwordx4 v[52:55], v11, s[12:15], 0 offen offset:1152
  v_lshrrev_b32 v12, 5, v10
  v_mul_u32_u24 v12, 40960, v12
  v_lshrrev_b32 v13, 1, v9
  v_lshlrev_b32 v13, 10, v13
  v_add_u32 v12, v12, v13
  v_and_b32 v13, 1, v9
  v_lshlrev_b32 v13, 5, v13
  v_and_b32 v14, 31, v10
  v_add_u32 v13, v13, v14
  v_lshlrev_b32 v13, 4, v13
  v_add_u32 v12, v12, v13
  s_waitcnt vmcnt(0)
  v_lshlrev_b32 v64, 16, v16
  v_and_b32 v65, 0xffff0000, v16
  v_lshlrev_b32 v66, 16, v17
  v_and_b32 v67, 0xffff0000, v17
  v_lshlrev_b32 v68, 16, v18
  v_and_b32 v69, 0xffff0000, v18
  v_lshlrev_b32 v70, 16, v19
  v_and_b32 v71, 0xffff0000, v19
  v_lshlrev_b32 v72, 16, v20
  v_and_b32 v73, 0xffff0000, v20
  v_lshlrev_b32 v74, 16, v21
  v_and_b32 v75, 0xffff0000, v21
  v_lshlrev_b32 v76, 16, v22
  v_and_b32 v77, 0xffff0000, v22
  v_lshlrev_b32 v78, 16, v23
  v_and_b32 v79, 0xffff0000, v23
  v_lshlrev_b32 v80, 16, v24
  v_and_b32 v81, 0xffff0000, v24
  v_lshlrev_b32 v82, 16, v25
  v_and_b32 v83, 0xffff0000, v25
  v_lshlrev_b32 v84, 16, v26
  v_and_b32 v85, 0xffff0000, v26
  v_lshlrev_b32 v86, 16, v27
  v_and_b32 v87, 0xffff0000, v27
  v_lshlrev_b32 v88, 16, v28
  v_and_b32 v89, 0xffff0000, v28
  v_lshlrev_b32 v90, 16, v29
  v_and_b32 v91, 0xffff0000, v29
  v_lshlrev_b32 v92, 16, v30
  v_and_b32 v93, 0xffff0000, v30
  v_lshlrev_b32 v94, 16, v31
  v_and_b32 v95, 0xffff0000, v31
  v_lshlrev_b32 v96, 16, v32
  v_and_b32 v97, 0xffff0000, v32
  v_lshlrev_b32 v98, 16, v33
  v_and_b32 v99, 0xffff0000, v33
  v_lshlrev_b32 v100, 16, v34
  v_and_b32 v101, 0xffff0000, v34
  v_lshlrev_b32 v102, 16, v35
  v_and_b32 v103, 0xffff0000, v35
  v_lshlrev_b32 v104, 16, v36
  v_and_b32 v105, 0xffff0000, v36
  v_lshlrev_b32 v106, 16, v37
  v_and_b32 v107, 0xffff0000, v37
  v_lshlrev_b32 v108, 16, v38
  v_and_b32 v109, 0xffff0000, v38
  v_lshlrev_b32 v110, 16, v39
  v_and_b32 v111, 0xffff0000, v39
  v_lshlrev_b32 v112, 16, v40
  v_and_b32 v113, 0xffff0000, v40
  v_lshlrev_b32 v114, 16, v41
  v_and_b32 v115, 0xffff0000, v41
  v_lshlrev_b32 v116, 16, v42
  v_and_b32 v117, 0xffff0000, v42
  v_lshlrev_b32 v118, 16, v43
  v_and_b32 v119, 0xffff0000, v43
  v_lshlrev_b32 v120, 16, v44
  v_and_b32 v121, 0xffff0000, v44
  v_lshlrev_b32 v122, 16, v45
  v_and_b32 v123, 0xffff0000, v45
  v_lshlrev_b32 v124, 16, v46
  v_and_b32 v125, 0xffff0000, v46
  v_lshlrev_b32 v126, 16, v47
  v_and_b32 v127, 0xffff0000, v47
  v_lshlrev_b32 v128, 16, v48
  v_and_b32 v129, 0xffff0000, v48
  v_lshlrev_b32 v130, 16, v49
  v_and_b32 v131, 0xffff0000, v49
  v_lshlrev_b32 v132, 16, v50
  v_and_b32 v133, 0xffff0000, v50
  v_lshlrev_b32 v134, 16, v51
  v_and_b32 v135, 0xffff0000, v51
  v_lshlrev_b32 v136, 16, v52
  v_and_b32 v137, 0xffff0000, v52
  v_lshlrev_b32 v138, 16, v53
  v_and_b32 v139, 0xffff0000, v53
  v_lshlrev_b32 v140, 16, v54
  v_and_b32 v141, 0xffff0000, v54
  v_lshlrev_b32 v142, 16, v55
  v_and_b32 v143, 0xffff0000, v55
  v_add_f32 v14, v64, v65
  v_add_f32 v14, v14, v66
  v_add_f32 v14, v14, v67
  v_add_f32 v14, v14, v68
  v_add_f32 v14, v14, v69
  v_add_f32 v14, v14, v70
  v_add_f32 v14, v14, v71
  v_add_f32 v14, v14, v72
  v_add_f32 v14, v14, v73
  v_add_f32 v14, v14, v74
  v_add_f32 v14, v14, v75
  v_add_f32 v14, v14, v76
  v_add_f32 v14, v14, v77
  v_add_f32 v14, v14, v78
  v_add_f32 v14, v14, v79
  v_add_f32 v14, v14, v80
  v_add_f32 v14, v14, v81
  v_add_f32 v14, v14, v82
  v_add_f32 v14, v14, v83
  v_add_f32 v14, v14, v84
  v_add_f32 v14, v14, v85
  v_add_f32 v14, v14, v86
  v_add_f32 v14, v14, v87
  v_add_f32 v14, v14, v88
  v_add_f32 v14, v14, v89
  v_add_f32 v14, v14, v90
  v_add_f32 v14, v14, v91
  v_add_f32 v14, v14, v92
  v_add_f32 v14, v14, v93
  v_add_f32 v14, v14, v94
  v_add_f32 v14, v14, v95
  v_add_f32 v14, v14, v96
  v_add_f32 v14, v14, v97
  v_add_f32 v14, v14, v98
  v_add_f32 v14, v14, v99
  v_add_f32 v14, v14, v100
  v_add_f32 v14, v14, v101
  v_add_f32 v14, v14, v102
  v_add_f32 v14, v14, v103
  v_add_f32 v14, v14, v104
  v_add_f32 v14, v14, v105
  v_add_f32 v14, v14, v106
  v_add_f32 v14, v14, v107
  v_add_f32 v14, v14, v108
  v_add_f32 v14, v14, v109
  v_add_f32 v14, v14, v110
  v_add_f32 v14, v14, v111
  v_add_f32 v14, v14, v112
  v_add_f32 v14, v14, v113
  v_add_f32 v14, v14, v114
  v_add_f32 v14, v14, v115
  v_add_f32 v14, v14, v116
  v_add_f32 v14, v14, v117
  v_add_f32 v14, v14, v118
  v_add_f32 v14, v14, v119
  v_add_f32 v14, v14, v120
  v_add_f32 v14, v14, v121
  v_add_f32 v14, v14, v122
  v_add_f32 v14, v14, v123
  v_add_f32 v14, v14, v124
  v_add_f32 v14, v14, v125
  v_add_f32 v14, v14, v126
  v_add_f32 v14, v14, v127
  v_add_f32 v14, v14, v128
  v_add_f32 v14, v14, v129
  v_add_f32 v14, v14, v130
  v_add_f32 v14, v14, v131
  v_add_f32 v14, v14, v132
  v_add_f32 v14, v14, v133
  v_add_f32 v14, v14, v134
  v_add_f32 v14, v14, v135
  v_add_f32 v14, v14, v136
  v_add_f32 v14, v14, v137
  v_add_f32 v14, v14, v138
  v_add_f32 v14, v14, v139
  v_add_f32 v14, v14, v140
  v_add_f32 v14, v14, v141
  v_add_f32 v14, v14, v142
  v_add_f32 v14, v14, v143
  s_nop 1
  v_add_f32_dpp v15, v14, v14 quad_perm:[1,0,3,2] row_mask:0xf bank_mask:0xf
  s_nop 1
  v_add_f32_dpp v14, v15, v15 quad_perm:[2,3,0,1] row_mask:0xf bank_mask:0xf
  s_nop 1
  v_add_f32_dpp v15, v14, v14 row_half_mirror row_mask:0xf bank_mask:0xf
  v_mov_b32 v14, v15
  v_mul_f32 v14, 0x3acccccd, v14
  v_sub_f32 v64, v64, v14
  v_sub_f32 v65, v65, v14
  v_sub_f32 v66, v66, v14
  v_sub_f32 v67, v67, v14
  v_sub_f32 v68, v68, v14
  v_sub_f32 v69, v69, v14
  v_sub_f32 v70, v70, v14
  v_sub_f32 v71, v71, v14
  v_sub_f32 v72, v72, v14
  v_sub_f32 v73, v73, v14
  v_sub_f32 v74, v74, v14
  v_sub_f32 v75, v75, v14
  v_sub_f32 v76, v76, v14
  v_sub_f32 v77, v77, v14
  v_sub_f32 v78, v78, v14
  v_sub_f32 v79, v79, v14
  v_sub_f32 v80, v80, v14
  v_sub_f32 v81, v81, v14
  v_sub_f32 v82, v82, v14
  v_sub_f32 v83, v83, v14
  v_sub_f32 v84, v84, v14
  v_sub_f32 v85, v85, v14
  v_sub_f32 v86, v86, v14
  v_sub_f32 v87, v87, v14
  v_sub_f32 v88, v88, v14
  v_sub_f32 v89, v89, v14
  v_sub_f32 v90, v90, v14
  v_sub_f32 v91, v91, v14
  v_sub_f32 v92, v92, v14
  v_sub_f32 v93, v93, v14
  v_sub_f32 v94, v94, v14
  v_sub_f32 v95, v95, v14
  v_sub_f32 v96, v96, v14
  v_sub_f32 v97, v97, v14
  v_sub_f32 v98, v98, v14
  v_sub_f32 v99, v99, v14
  v_sub_f32 v100, v100, v14
  v_sub_f32 v101, v101, v14
  v_sub_f32 v102, v102, v14
  v_sub_f32 v103, v103, v14
  v_sub_f32 v104, v104, v14
  v_sub_f32 v105, v105, v14
  v_sub_f32 v106, v106, v14
  v_sub_f32 v107, v107, v14
  v_sub_f32 v108, v108, v14
  v_sub_f32 v109, v109, v14
  v_sub_f32 v110, v110, v14
  v_sub_f32 v111, v111, v14
  v_sub_f32 v112, v112, v14
  v_sub_f32 v113, v113, v14
  v_sub_f32 v114, v114, v14
  v_sub_f32 v115, v115, v14
  v_sub_f32 v116, v116, v14
  v_sub_f32 v117, v117, v14
  v_sub_f32 v118, v118, v14
  v_sub_f32 v119, v119, v14
  v_sub_f32 v120, v120, v14
  v_sub_f32 v121, v121, v14
  v_sub_f32 v122, v122, v14
  v_sub_f32 v123, v123, v14
  v_sub_f32 v124, v124, v14
  v_sub_f32 v125, v125, v14
  v_sub_f32 v126, v126, v14
  v_sub_f32 v127, v127, v14
  v_sub_f32 v128, v128, v14
  v_sub_f32 v129, v129, v14
  v_sub_f32 v130, v130, v14
  v_sub_f32 v131, v131, v14
  v_sub_f32 v132, v132, v14
  v_sub_f32 v133, v133, v14
  v_sub_f32 v134, v134, v14
  v_sub_f32 v135, v135, v14
  v_sub_f32 v136, v136, v14
  v_sub_f32 v137, v137, v14
  v_sub_f32 v138, v138, v14
  v_sub_f32 v139, v139, v14
  v_sub_f32 v140, v140, v14
  v_sub_f32 v141, v141, v14
  v_sub_f32 v142, v142, v14
  v_sub_f32 v143, v143, v14
  v_mul_f32 v15, v64, v64
  v_fmac_f32 v15, v65, v65
  v_fmac_f32 v15, v66, v66
  v_fmac_f32 v15, v67, v67
  v_fmac_f32 v15, v68, v68
  v_fmac_f32 v15, v69, v69
  v_fmac_f32 v15, v70, v70
  v_fmac_f32 v15, v71, v71
  v_fmac_f32 v15, v72, v72
  v_fmac_f32 v15, v73, v73
  v_fmac_f32 v15, v74, v74
  v_fmac_f32 v15, v75, v75
  v_fmac_f32 v15, v76, v76
  v_fmac_f32 v15, v77, v77
  v_fmac_f32 v15, v78, v78
  v_fmac_f32 v15, v79, v79
  v_fmac_f32 v15, v80, v80
  v_fmac_f32 v15, v81, v81
  v_fmac_f32 v15, v82, v82
  v_fmac_f32 v15, v83, v83
  v_fmac_f32 v15, v84, v84
  v_fmac_f32 v15, v85, v85
  v_fmac_f32 v15, v86, v86
  v_fmac_f32 v15, v87, v87
  v_fmac_f32 v15, v88, v88
  v_fmac_f32 v15, v89, v89
  v_fmac_f32 v15, v90, v90
  v_fmac_f32 v15, v91, v91
  v_fmac_f32 v15, v92, v92
  v_fmac_f32 v15, v93, v93
  v_fmac_f32 v15, v94, v94
  v_fmac_f32 v15, v95, v95
  v_fmac_f32 v15, v96, v96
  v_fmac_f32 v15, v97, v97
  v_fmac_f32 v15, v98, v98
  v_fmac_f32 v15, v99, v99
  v_fmac_f32 v15, v100, v100
  v_fmac_f32 v15, v101, v101
  v_fmac_f32 v15, v102, v102
  v_fmac_f32 v15, v103, v103
  v_fmac_f32 v15, v104, v104
  v_fmac_f32 v15, v105, v105
  v_fmac_f32 v15, v106, v106
  v_fmac_f32 v15, v107, v107
  v_fmac_f32 v15, v108, v108
  v_fmac_f32 v15, v109, v109
  v_fmac_f32 v15, v110, v110
  v_fmac_f32 v15, v111, v111
  v_fmac_f32 v15, v112, v112
  v_fmac_f32 v15, v113, v113
  v_fmac_f32 v15, v114, v114
  v_fmac_f32 v15, v115, v115
  v_fmac_f32 v15, v116, v116
  v_fmac_f32 v15, v117, v117
  v_fmac_f32 v15, v118, v118
  v_fmac_f32 v15, v119, v119
  v_fmac_f32 v15, v120, v120
  v_fmac_f32 v15, v121, v121
  v_fmac_f32 v15, v122, v122
  v_fmac_f32 v15, v123, v123
  v_fmac_f32 v15, v124, v124
  v_fmac_f32 v15, v125, v125
  v_fmac_f32 v15, v126, v126
  v_fmac_f32 v15, v127, v127
  v_fmac_f32 v15, v128, v128
  v_fmac_f32 v15, v129, v129
  v_fmac_f32 v15, v130, v130
  v_fmac_f32 v15, v131, v131
  v_fmac_f32 v15, v132, v132
  v_fmac_f32 v15, v133, v133
  v_fmac_f32 v15, v134, v134
  v_fmac_f32 v15, v135, v135
  v_fmac_f32 v15, v136, v136
  v_fmac_f32 v15, v137, v137
  v_fmac_f32 v15, v138, v138
  v_fmac_f32 v15, v139, v139
  v_fmac_f32 v15, v140, v140
  v_fmac_f32 v15, v141, v141
  v_fmac_f32 v15, v142, v142
  v_fmac_f32 v15, v143, v143
  s_nop 1
  v_add_f32_dpp v14, v15, v15 quad_perm:[1,0,3,2] row_mask:0xf bank_mask:0xf
  s_nop 1
  v_add_f32_dpp v15, v14, v14 quad_perm:[2,3,0,1] row_mask:0xf bank_mask:0xf
  s_nop 1
  v_add_f32_dpp v14, v15, v15 row_half_mirror row_mask:0xf bank_mask:0xf
  v_mov_b32 v15, v14
  v_mov_b32 v14, 0x3727c5ac
  v_fmac_f32 v14, 0x3acccccd, v15
  v_rsq_f32 v14, v14
  s_nop 0
  v_mul_f32 v64, v64, v14
  v_mul_f32 v65, v65, v14
  v_cvt_pk_bf16_f32 v16, v64, v65
  v_mul_f32 v66, v66, v14
  v_mul_f32 v67, v67, v14
  v_cvt_pk_bf16_f32 v17, v66, v67
  v_mul_f32 v68, v68, v14
  v_mul_f32 v69, v69, v14
  v_cvt_pk_bf16_f32 v18, v68, v69
  v_mul_f32 v70, v70, v14
  v_mul_f32 v71, v71, v14
  v_cvt_pk_bf16_f32 v19, v70, v71
  v_mul_f32 v72, v72, v14
  v_mul_f32 v73, v73, v14
  v_cvt_pk_bf16_f32 v20, v72, v73
  v_mul_f32 v74, v74, v14
  v_mul_f32 v75, v75, v14
  v_cvt_pk_bf16_f32 v21, v74, v75
  v_mul_f32 v76, v76, v14
  v_mul_f32 v77, v77, v14
  v_cvt_pk_bf16_f32 v22, v76, v77
  v_mul_f32 v78, v78, v14
  v_mul_f32 v79, v79, v14
  v_cvt_pk_bf16_f32 v23, v78, v79
  v_mul_f32 v80, v80, v14
  v_mul_f32 v81, v81, v14
  v_cvt_pk_bf16_f32 v24, v80, v81
  v_mul_f32 v82, v82, v14
  v_mul_f32 v83, v83, v14
  v_cvt_pk_bf16_f32 v25, v82, v83
  v_mul_f32 v84, v84, v14
  v_mul_f32 v85, v85, v14
  v_cvt_pk_bf16_f32 v26, v84, v85
  v_mul_f32 v86, v86, v14
  v_mul_f32 v87, v87, v14
  v_cvt_pk_bf16_f32 v27, v86, v87
  v_mul_f32 v88, v88, v14
  v_mul_f32 v89, v89, v14
  v_cvt_pk_bf16_f32 v28, v88, v89
  v_mul_f32 v90, v90, v14
  v_mul_f32 v91, v91, v14
  v_cvt_pk_bf16_f32 v29, v90, v91
  v_mul_f32 v92, v92, v14
  v_mul_f32 v93, v93, v14
  v_cvt_pk_bf16_f32 v30, v92, v93
  v_mul_f32 v94, v94, v14
  v_mul_f32 v95, v95, v14
  v_cvt_pk_bf16_f32 v31, v94, v95
  v_mul_f32 v96, v96, v14
  v_mul_f32 v97, v97, v14
  v_cvt_pk_bf16_f32 v32, v96, v97
  v_mul_f32 v98, v98, v14
  v_mul_f32 v99, v99, v14
  v_cvt_pk_bf16_f32 v33, v98, v99
  v_mul_f32 v100, v100, v14
  v_mul_f32 v101, v101, v14
  v_cvt_pk_bf16_f32 v34, v100, v101
  v_mul_f32 v102, v102, v14
  v_mul_f32 v103, v103, v14
  v_cvt_pk_bf16_f32 v35, v102, v103
  v_mul_f32 v104, v104, v14
  v_mul_f32 v105, v105, v14
  v_cvt_pk_bf16_f32 v36, v104, v105
  v_mul_f32 v106, v106, v14
  v_mul_f32 v107, v107, v14
  v_cvt_pk_bf16_f32 v37, v106, v107
  v_mul_f32 v108, v108, v14
  v_mul_f32 v109, v109, v14
  v_cvt_pk_bf16_f32 v38, v108, v109
  v_mul_f32 v110, v110, v14
  v_mul_f32 v111, v111, v14
  v_cvt_pk_bf16_f32 v39, v110, v111
  v_mul_f32 v112, v112, v14
  v_mul_f32 v113, v113, v14
  v_cvt_pk_bf16_f32 v40, v112, v113
  v_mul_f32 v114, v114, v14
  v_mul_f32 v115, v115, v14
  v_cvt_pk_bf16_f32 v41, v114, v115
  v_mul_f32 v116, v116, v14
  v_mul_f32 v117, v117, v14
  v_cvt_pk_bf16_f32 v42, v116, v117
  v_mul_f32 v118, v118, v14
  v_mul_f32 v119, v119, v14
  v_cvt_pk_bf16_f32 v43, v118, v119
  v_mul_f32 v120, v120, v14
  v_mul_f32 v121, v121, v14
  v_cvt_pk_bf16_f32 v44, v120, v121
  v_mul_f32 v122, v122, v14
  v_mul_f32 v123, v123, v14
  v_cvt_pk_bf16_f32 v45, v122, v123
  v_mul_f32 v124, v124, v14
  v_mul_f32 v125, v125, v14
  v_cvt_pk_bf16_f32 v46, v124, v125
  v_mul_f32 v126, v126, v14
  v_mul_f32 v127, v127, v14
  v_cvt_pk_bf16_f32 v47, v126, v127
  v_mul_f32 v128, v128, v14
  v_mul_f32 v129, v129, v14
  v_cvt_pk_bf16_f32 v48, v128, v129
  v_mul_f32 v130, v130, v14
  v_mul_f32 v131, v131, v14
  v_cvt_pk_bf16_f32 v49, v130, v131
  v_mul_f32 v132, v132, v14
  v_mul_f32 v133, v133, v14
  v_cvt_pk_bf16_f32 v50, v132, v133
  v_mul_f32 v134, v134, v14
  v_mul_f32 v135, v135, v14
  v_cvt_pk_bf16_f32 v51, v134, v135
  v_mul_f32 v136, v136, v14
  v_mul_f32 v137, v137, v14
  v_cvt_pk_bf16_f32 v52, v136, v137
  v_mul_f32 v138, v138, v14
  v_mul_f32 v139, v139, v14
  v_cvt_pk_bf16_f32 v53, v138, v139
  v_mul_f32 v140, v140, v14
  v_mul_f32 v141, v141, v14
  v_cvt_pk_bf16_f32 v54, v140, v141
  v_mul_f32 v142, v142, v14
  v_mul_f32 v143, v143, v14
  v_cvt_pk_bf16_f32 v55, v142, v143
  s_mov_b32 s26, 0x100000
  buffer_store_dwordx4 v[16:19], v12, s[8:11], s26 offen
  s_add_u32 s26, s26, 4096
  buffer_store_dwordx4 v[20:23], v12, s[8:11], s26 offen
  s_add_u32 s26, s26, 4096
  buffer_store_dwordx4 v[24:27], v12, s[8:11], s26 offen
  s_add_u32 s26, s26, 4096
  buffer_store_dwordx4 v[28:31], v12, s[8:11], s26 offen
  s_add_u32 s26, s26, 4096
  buffer_store_dwordx4 v[32:35], v12, s[8:11], s26 offen
  s_add_u32 s26, s26, 4096
  buffer_store_dwordx4 v[36:39], v12, s[8:11], s26 offen
  s_add_u32 s26, s26, 4096
  buffer_store_dwordx4 v[40:43], v12, s[8:11], s26 offen
  s_add_u32 s26, s26, 4096
  buffer_store_dwordx4 v[44:47], v12, s[8:11], s26 offen
  s_add_u32 s26, s26, 4096
  buffer_store_dwordx4 v[48:51], v12, s[8:11], s26 offen
  s_add_u32 s26, s26, 4096
  buffer_store_dwordx4 v[52:55], v12, s[8:11], s26 offen
  s_add_u32 s26, s26, 4096
ln_3:
  s_mov_b32 s12, s46
  s_and_b32 s13, s47, 0xffff
  s_mov_b32 s14, 0xc8000
  s_mov_b32 s15, 0x20000
  s_mov_b32 s16, s44
  s_and_b32 s17, s45, 0xffff
  s_mov_b32 s18, 0x258000
  s_mov_b32 s19, 0x20000
  s_lshl_b32 s26, s2, 2
  s_add_u32 s26, s26, s21
  v_and_b32 v8, 31, v1
  v_lshrrev_b32 v9, 5, v1
  v_lshrrev_b32 v10, 4, v8
  v_lshlrev_b32 v10, 4, v10
  v_bfe_u32 v11, v8, 2, 1
  v_lshlrev_b32 v11, 3, v11
  v_add_u32 v10, v10, v11
  v_bfe_u32 v11, v8, 3, 1
  v_lshlrev_b32 v11, 2, v11
  v_add_u32 v10, v10, v11
  v_and_b32 v11, 3, v8
  v_add_u32 v10, v10, v11
  v_mov_b32 v15, 0x40000000
  s_add_u32 s27, s26, 0
  s_cmp_lt_u32 s27, 800
  s_cbranch_scc0 gq_5
  s_mul_i32 s28, s27, 3277
  s_lshr_b32 s28, s28, 16
  s_mul_i32 s29, s28, 20
  s_sub_u32 s29, s27, s29
  s_lshl_b32 s30, s28, 5
  s_mul_i32 s31, s29, 40960
  s_add_u32 s30, s30, s31
  v_lshrrev_b32 v12, 4, v1
  v_mul_u32_u24 v12, 10240, v12
  v_and_b32 v13, 15, v1
  v_lshlrev_b32 v13, 1, v13
  v_add_u32 v12, v12, v13
  s_add_u32 s31, s30, 0
  buffer_load_ushort v20, v12, s[12:15], s31 offen
  s_add_u32 s31, s30, 1280
  buffer_load_ushort v21, v12, s[12:15], s31 offen
  s_add_u32 s31, s30, 2560
  buffer_load_ushort v22, v12, s[12:15], s31 offen
  s_add_u32 s31, s30, 3840
  buffer_load_ushort v23, v12, s[12:15], s31 offen
  s_add_u32 s31, s30, 5120
  buffer_load_ushort v24, v12, s[12:15], s31 offen
  s_add_u32 s31, s30, 6400
  buffer_load_ushort v25, v12, s[12:15], s31 offen
  s_add_u32 s31, s30, 7680
  buffer_load_ushort v26, v12, s[12:15], s31 offen
  s_add_u32 s31, s30, 8960
  buffer_load_ushort v27, v12, s[12:15], s31 offen
  s_lshl_b32 s28, s27, 10
  s_add_u32 s28, s28, 0xe000000
  s_branch gd_6
gq_5:
  s_sub_u32 s27, s27, 800
  s_cmp_lt_u32 s27, 3840
  s_cbranch_scc0 g_4
  s_mul_i32 s28, s27, 6554
  s_lshr_b32 s28, s28, 18
  s_mul_i32 s29, s28, 40
  s_sub_u32 s29, s27, s29
  s_mul_i32 s30, s28, 21846
  s_lshr_b32 s30, s30, 16
  s_mul_i32 s31, s30, 3
  s_sub_u32 s31, s28, s31
  s_cmp_lt_u32 s31, 2
  s_cselect_b64 vcc, -1, 0
  v_cndmask_b32 v12, v8, v10, vcc
  v_cmp_gt_u32 vcc, 20, v12
  v_lshlrev_b32 v12, 1, v12
  v_mul_u32_u24 v13, 30720, v9
  v_add_u32 v12, v12, v13
  v_cndmask_b32 v12, v15, v12, vcc
  s_mul_i32 s31, s31, 1280
  s_mul_i32 s30, s30, 40
  s_add_u32 s30, s30, s31
  s_mul_i32 s31, s29, 61440
  s_add_u32 s30, s30, s31
  s_add_u32 s31, s30, 0
  buffer_load_ushort v20, v12, s[16:19], s31 offen
  s_add_u32 s31, s30, 3840
  buffer_load_ushort v21, v12, s[16:19], s31 offen
  s_add_u32 s31, s30, 7680
  buffer_load_ushort v22, v12, s[16:19], s31 offen
  s_add_u32 s31, s30, 11520
  buffer_load_ushort v23, v12, s[16:19], s31 offen
  s_add_u32 s31, s30, 15360
  buffer_load_ushort v24, v12, s[16:19], s31 offen
  s_add_u32 s31, s30, 19200
  buffer_load_ushort v25, v12, s[16:19], s31 offen
  s_add_u32 s31, s30, 23040
  buffer_load_ushort v26, v12, s[16:19], s31 offen
  s_add_u32 s31, s30, 26880
  buffer_load_ushort v27, v12, s[16:19], s31 offen
  s_lshl_b32 s28, s27, 10
  s_add_u32 s28, s28, 0xe100000
gd_6:
  s_waitcnt vmcnt(0)
  v_lshl_or_b32 v28, v21, 16, v20
  v_lshl_or_b32 v29, v23, 16, v22
  v_lshl_or_b32 v30, v25, 16, v24
  v_lshl_or_b32 v31, v27, 16, v26
  buffer_store_dwordx4 v[28:31], v2, s[8:11], s28 offen
  s_nop 1
g_4:
  s_add_u32 s27, s26, 1024
  s_cmp_lt_u32 s27, 800
  s_cbranch_scc0 gq_8
  s_mul_i32 s28, s27, 3277
  s_lshr_b32 s28, s28, 16
  s_mul_i32 s29, s28, 20
  s_sub_u32 s29, s27, s29
  s_lshl_b32 s30, s28, 5
  s_mul_i32 s31, s29, 40960
  s_add_u32 s30, s30, s31
  v_lshrrev_b32 v12, 4, v1
  v_mul_u32_u24 v12, 10240, v12
  v_and_b32 v13, 15, v1
  v_lshlrev_b32 v13, 1, v13
  v_add_u32 v12, v12, v13
  s_add_u32 s31, s30, 0
  buffer_load_ushort v20, v12, s[12:15], s31 offen
  s_add_u32 s31, s30, 1280
  buffer_load_ushort v21, v12, s[12:15], s31 offen
  s_add_u32 s31, s30, 2560
  buffer_load_ushort v22, v12, s[12:15], s31 offen
  s_add_u32 s31, s30, 3840
  buffer_load_ushort v23, v12, s[12:15], s31 offen
  s_add_u32 s31, s30, 5120
  buffer_load_ushort v24, v12, s[12:15], s31 offen
  s_add_u32 s31, s30, 6400
  buffer_load_ushort v25, v12, s[12:15], s31 offen
  s_add_u32 s31, s30, 7680
  buffer_load_ushort v26, v12, s[12:15], s31 offen
  s_add_u32 s31, s30, 8960
  buffer_load_ushort v27, v12, s[12:15], s31 offen
  s_lshl_b32 s28, s27, 10
  s_add_u32 s28, s28, 0xe000000
  s_branch gd_9
gq_8:
  s_sub_u32 s27, s27, 800
  s_cmp_lt_u32 s27, 3840
  s_cbranch_scc0 g_7
  s_mul_i32 s28, s27, 6554
  s_lshr_b32 s28, s28, 18
  s_mul_i32 s29, s28, 40
  s_sub_u32 s29, s27, s29
  s_mul_i32 s30, s28, 21846
  s_lshr_b32 s30, s30, 16
  s_mul_i32 s31, s30, 3
  s_sub_u32 s31, s28, s31
  s_cmp_lt_u32 s31, 2
  s_cselect_b64 vcc, -1, 0
  v_cndmask_b32 v12, v8, v10, vcc
  v_cmp_gt_u32 vcc, 20, v12
  v_lshlrev_b32 v12, 1, v12
  v_mul_u32_u24 v13, 30720, v9
  v_add_u32 v12, v12, v13
  v_cndmask_b32 v12, v15, v12, vcc
  s_mul_i32 s31, s31, 1280
  s_mul_i32 s30, s30, 40
  s_add_u32 s30, s30, s31
  s_mul_i32 s31, s29, 61440
  s_add_u32 s30, s30, s31
  s_add_u32 s31, s30, 0
  buffer_load_ushort v20, v12, s[16:19], s31 offen
  s_add_u32 s31, s30, 3840
  buffer_load_ushort v21, v12, s[16:19], s31 offen
  s_add_u32 s31, s30, 7680
  buffer_load_ushort v22, v12, s[16:19], s31 offen
  s_add_u32 s31, s30, 11520
  buffer_load_ushort v23, v12, s[16:19], s31 offen
  s_add_u32 s31, s30, 15360
  buffer_load_ushort v24, v12, s[16:19], s31 offen
  s_add_u32 s31, s30, 19200
  buffer_load_ushort v25, v12, s[16:19], s31 offen
  s_add_u32 s31, s30, 23040
  buffer_load_ushort v26, v12, s[16:19], s31 offen
  s_add_u32 s31, s30, 26880
  buffer_load_ushort v27, v12, s[16:19], s31 offen
  s_lshl_b32 s28, s27, 10
  s_add_u32 s28, s28, 0xe100000
gd_9:
  s_waitcnt vmcnt(0)
  v_lshl_or_b32 v28, v21, 16, v20
  v_lshl_or_b32 v29, v23, 16, v22
  v_lshl_or_b32 v30, v25, 16, v24
  v_lshl_or_b32 v31, v27, 16, v26
  buffer_store_dwordx4 v[28:31], v2, s[8:11], s28 offen
  s_nop 1
g_7:
  s_add_u32 s27, s26, 2048
  s_cmp_lt_u32 s27, 800
  s_cbranch_scc0 gq_11
  s_mul_i32 s28, s27, 3277
  s_lshr_b32 s28, s28, 16
  s_mul_i32 s29, s28, 20
  s_sub_u32 s29, s27, s29
  s_lshl_b32 s30, s28, 5
  s_mul_i32 s31, s29, 40960
  s_add_u32 s30, s30, s31
  v_lshrrev_b32 v12, 4, v1
  v_mul_u32_u24 v12, 10240, v12
  v_and_b32 v13, 15, v1
  v_lshlrev_b32 v13, 1, v13
  v_add_u32 v12, v12, v13
  s_add_u32 s31, s30, 0
  buffer_load_ushort v20, v12, s[12:15], s31 offen
  s_add_u32 s31, s30, 1280
  buffer_load_ushort v21, v12, s[12:15], s31 offen
  s_add_u32 s31, s30, 2560
  buffer_load_ushort v22, v12, s[12:15], s31 offen
  s_add_u32 s31, s30, 3840
  buffer_load_ushort v23, v12, s[12:15], s31 offen
  s_add_u32 s31, s30, 5120
  buffer_load_ushort v24, v12, s[12:15], s31 offen
  s_add_u32 s31, s30, 6400
  buffer_load_ushort v25, v12, s[12:15], s31 offen
  s_add_u32 s31, s30, 7680
  buffer_load_ushort v26, v12, s[12:15], s31 offen
  s_add_u32 s31, s30, 8960
  buffer_load_ushort v27, v12, s[12:15], s31 offen
  s_lshl_b32 s28, s27, 10
  s_add_u32 s28, s28, 0xe000000
  s_branch gd_12
gq_11:
  s_sub_u32 s27, s27, 800
  s_cmp_lt_u32 s27, 3840
  s_cbranch_scc0 g_10
  s_mul_i32 s28, s27, 6554
  s_lshr_b32 s28, s28, 18
  s_mul_i32 s29, s28, 40
  s_sub_u32 s29, s27, s29
  s_mul_i32 s30, s28, 21846
  s_lshr_b32 s30, s30, 16
  s_mul_i32 s31, s30, 3
  s_sub_u32 s31, s28, s31
  s_cmp_lt_u32 s31, 2
  s_cselect_b64 vcc, -1, 0
  v_cndmask_b32 v12, v8, v10, vcc
  v_cmp_gt_u32 vcc, 20, v12
  v_lshlrev_b32 v12, 1, v12
  v_mul_u32_u24 v13, 30720, v9
  v_add_u32 v12, v12, v13
  v_cndmask_b32 v12, v15, v12, vcc
  s_mul_i32 s31, s31, 1280
  s_mul_i32 s30, s30, 40
  s_add_u32 s30, s30, s31
  s_mul_i32 s31, s29, 61440
  s_add_u32 s30, s30, s31
  s_add_u32 s31, s30, 0
  buffer_load_ushort v20, v12, s[16:19], s31 offen
  s_add_u32 s31, s30, 3840
  buffer_load_ushort v21, v12, s[16:19], s31 offen
  s_add_u32 s31, s30, 7680
  buffer_load_ushort v22, v12, s[16:19], s31 offen
  s_add_u32 s31, s30, 11520
  buffer_load_ushort v23, v12, s[16:19], s31 offen
  s_add_u32 s31, s30, 15360
  buffer_load_ushort v24, v12, s[16:19], s31 offen
  s_add_u32 s31, s30, 19200
  buffer_load_ushort v25, v12, s[16:19], s31 offen
  s_add_u32 s31, s30, 23040
  buffer_load_ushort v26, v12, s[16:19], s31 offen
  s_add_u32 s31, s30, 26880
  buffer_load_ushort v27, v12, s[16:19], s31 offen
  s_lshl_b32 s28, s27, 10
  s_add_u32 s28, s28, 0xe100000
gd_12:
  s_waitcnt vmcnt(0)
  v_lshl_or_b32 v28, v21, 16, v20
  v_lshl_or_b32 v29, v23, 16, v22
  v_lshl_or_b32 v30, v25, 16, v24
  v_lshl_or_b32 v31, v27, 16, v26
  buffer_store_dwordx4 v[28:31], v2, s[8:11], s28 offen
  s_nop 1
g_10:
  s_add_u32 s27, s26, 3072
  s_cmp_lt_u32 s27, 800
  s_cbranch_scc0 gq_14
  s_mul_i32 s28, s27, 3277
  s_lshr_b32 s28, s28, 16
  s_mul_i32 s29, s28, 20
  s_sub_u32 s29, s27, s29
  s_lshl_b32 s30, s28, 5
  s_mul_i32 s31, s29, 40960
  s_add_u32 s30, s30, s31
  v_lshrrev_b32 v12, 4, v1
  v_mul_u32_u24 v12, 10240, v12
  v_and_b32 v13, 15, v1
  v_lshlrev_b32 v13, 1, v13
  v_add_u32 v12, v12, v13
  s_add_u32 s31, s30, 0
  buffer_load_ushort v20, v12, s[12:15], s31 offen
  s_add_u32 s31, s30, 1280
  buffer_load_ushort v21, v12, s[12:15], s31 offen
  s_add_u32 s31, s30, 2560
  buffer_load_ushort v22, v12, s[12:15], s31 offen
  s_add_u32 s31, s30, 3840
  buffer_load_ushort v23, v12, s[12:15], s31 offen
  s_add_u32 s31, s30, 5120
  buffer_load_ushort v24, v12, s[12:15], s31 offen
  s_add_u32 s31, s30, 6400
  buffer_load_ushort v25, v12, s[12:15], s31 offen
  s_add_u32 s31, s30, 7680
  buffer_load_ushort v26, v12, s[12:15], s31 offen
  s_add_u32 s31, s30, 8960
  buffer_load_ushort v27, v12, s[12:15], s31 offen
  s_lshl_b32 s28, s27, 10
  s_add_u32 s28, s28, 0xe000000
  s_branch gd_15
gq_14:
  s_sub_u32 s27, s27, 800
  s_cmp_lt_u32 s27, 3840
  s_cbranch_scc0 g_13
  s_mul_i32 s28, s27, 6554
  s_lshr_b32 s28, s28, 18
  s_mul_i32 s29, s28, 40
  s_sub_u32 s29, s27, s29
  s_mul_i32 s30, s28, 21846
  s_lshr_b32 s30, s30, 16
  s_mul_i32 s31, s30, 3
  s_sub_u32 s31, s28, s31
  s_cmp_lt_u32 s31, 2
  s_cselect_b64 vcc, -1, 0
  v_cndmask_b32 v12, v8, v10, vcc
  v_cmp_gt_u32 vcc, 20, v12
  v_lshlrev_b32 v12, 1, v12
  v_mul_u32_u24 v13, 30720, v9
  v_add_u32 v12, v12, v13
  v_cndmask_b32 v12, v15, v12, vcc
  s_mul_i32 s31, s31, 1280
  s_mul_i32 s30, s30, 40
  s_add_u32 s30, s30, s31
  s_mul_i32 s31, s29, 61440
  s_add_u32 s30, s30, s31
  s_add_u32 s31, s30, 0
  buffer_load_ushort v20, v12, s[16:19], s31 offen
  s_add_u32 s31, s30, 3840
  buffer_load_ushort v21, v12, s[16:19], s31 offen
  s_add_u32 s31, s30, 7680
  buffer_load_ushort v22, v12, s[16:19], s31 offen
  s_add_u32 s31, s30, 11520
  buffer_load_ushort v23, v12, s[16:19], s31 offen
  s_add_u32 s31, s30, 15360
  buffer_load_ushort v24, v12, s[16:19], s31 offen
  s_add_u32 s31, s30, 19200
  buffer_load_ushort v25, v12, s[16:19], s31 offen
  s_add_u32 s31, s30, 23040
  buffer_load_ushort v26, v12, s[16:19], s31 offen
  s_add_u32 s31, s30, 26880
  buffer_load_ushort v27, v12, s[16:19], s31 offen
  s_lshl_b32 s28, s27, 10
  s_add_u32 s28, s28, 0xe100000
gd_15:
  s_waitcnt vmcnt(0)
  v_lshl_or_b32 v28, v21, 16, v20
  v_lshl_or_b32 v29, v23, 16, v22
  v_lshl_or_b32 v30, v25, 16, v24
  v_lshl_or_b32 v31, v27, 16, v26
  buffer_store_dwordx4 v[28:31], v2, s[8:11], s28 offen
  s_nop 1
g_13:
  s_add_u32 s27, s26, 4096
  s_cmp_lt_u32 s27, 800
  s_cbranch_scc0 gq_17
  s_mul_i32 s28, s27, 3277
  s_lshr_b32 s28, s28, 16
  s_mul_i32 s29, s28, 20
  s_sub_u32 s29, s27, s29
  s_lshl_b32 s30, s28, 5
  s_mul_i32 s31, s29, 40960
  s_add_u32 s30, s30, s31
  v_lshrrev_b32 v12, 4, v1
  v_mul_u32_u24 v12, 10240, v12
  v_and_b32 v13, 15, v1
  v_lshlrev_b32 v13, 1, v13
  v_add_u32 v12, v12, v13
  s_add_u32 s31, s30, 0
  buffer_load_ushort v20, v12, s[12:15], s31 offen
  s_add_u32 s31, s30, 1280
  buffer_load_ushort v21, v12, s[12:15], s31 offen
  s_add_u32 s31, s30, 2560
  buffer_load_ushort v22, v12, s[12:15], s31 offen
  s_add_u32 s31, s30, 3840
  buffer_load_ushort v23, v12, s[12:15], s31 offen
  s_add_u32 s31, s30, 5120
  buffer_load_ushort v24, v12, s[12:15], s31 offen
  s_add_u32 s31, s30, 6400
  buffer_load_ushort v25, v12, s[12:15], s31 offen
  s_add_u32 s31, s30, 7680
  buffer_load_ushort v26, v12, s[12:15], s31 offen
  s_add_u32 s31, s30, 8960
  buffer_load_ushort v27, v12, s[12:15], s31 offen
  s_lshl_b32 s28, s27, 10
  s_add_u32 s28, s28, 0xe000000
  s_branch gd_18
gq_17:
  s_sub_u32 s27, s27, 800
  s_cmp_lt_u32 s27, 3840
  s_cbranch_scc0 g_16
  s_mul_i32 s28, s27, 6554
  s_lshr_b32 s28, s28, 18
  s_mul_i32 s29, s28, 40
  s_sub_u32 s29, s27, s29
  s_mul_i32 s30, s28, 21846
  s_lshr_b32 s30, s30, 16
  s_mul_i32 s31, s30, 3
  s_sub_u32 s31, s28, s31
  s_cmp_lt_u32 s31, 2
  s_cselect_b64 vcc, -1, 0
  v_cndmask_b32 v12, v8, v10, vcc
  v_cmp_gt_u32 vcc, 20, v12
  v_lshlrev_b32 v12, 1, v12
  v_mul_u32_u24 v13, 30720, v9
  v_add_u32 v12, v12, v13
  v_cndmask_b32 v12, v15, v12, vcc
  s_mul_i32 s31, s31, 1280
  s_mul_i32 s30, s30, 40
  s_add_u32 s30, s30, s31
  s_mul_i32 s31, s29, 61440
  s_add_u32 s30, s30, s31
  s_add_u32 s31, s30, 0
  buffer_load_ushort v20, v12, s[16:19], s31 offen
  s_add_u32 s31, s30, 3840
  buffer_load_ushort v21, v12, s[16:19], s31 offen
  s_add_u32 s31, s30, 7680
  buffer_load_ushort v22, v12, s[16:19], s31 offen
  s_add_u32 s31, s30, 11520
  buffer_load_ushort v23, v12, s[16:19], s31 offen
  s_add_u32 s31, s30, 15360
  buffer_load_ushort v24, v12, s[16:19], s31 offen
  s_add_u32 s31, s30, 19200
  buffer_load_ushort v25, v12, s[16:19], s31 offen
  s_add_u32 s31, s30, 23040
  buffer_load_ushort v26, v12, s[16:19], s31 offen
  s_add_u32 s31, s30, 26880
  buffer_load_ushort v27, v12, s[16:19], s31 offen
  s_lshl_b32 s28, s27, 10
  s_add_u32 s28, s28, 0xe100000
gd_18:
  s_waitcnt vmcnt(0)
  v_lshl_or_b32 v28, v21, 16, v20
  v_lshl_or_b32 v29, v23, 16, v22
  v_lshl_or_b32 v30, v25, 16, v24
  v_lshl_or_b32 v31, v27, 16, v26
  buffer_store_dwordx4 v[28:31], v2, s[8:11], s28 offen
  s_nop 1
g_16:
  s_mov_b32 s12, s40
  s_and_b32 s13, s41, 0xffff
  s_mov_b32 s14, 0x780000
  s_mov_b32 s15, 0x20000
  s_mov_b32 s16, s42
  s_and_b32 s17, s43, 0xffff
  s_mov_b32 s18, 0x780000
  s_mov_b32 s19, 0x20000
  s_and_b32 s22, s2, 7
  s_lshl_b32 s22, s22, 2
  s_lshr_b32 s23, s2, 6
  s_add_u32 s22, s22, s23
  s_bfe_u32 s23, s2, 0x30003
  s_waitcnt vmcnt(0)
  v_lshrrev_b32 v8, 3, v1
  v_bfe_u32 v9, v1, 1, 2
  v_and_b32 v10, 1, v1
  s_mul_i32 s24, s22, 245760
  s_mul_i32 s25, s23, 160
  s_add_u32 s24, s24, s25
  s_add_u32 s26, s21, 0
  s_cmp_lt_u32 s26, 30
  s_cbranch_scc0 wd_19
  s_lshl_b32 s27, s26, 3
  v_add_u32 v11, s27, v8
  v_mul_u32_u24 v12, 52429, v11
  v_lshrrev_b32 v12, 18, v12
  v_mul_u32_u24 v13, 5, v12
  v_sub_u32 v13, v11, v13
  v_lshlrev_b32 v12, 2, v12
  v_add_u32 v12, v12, v9
  v_mul_u32_u24 v12, 1280, v12
  v_lshlrev_b32 v13, 5, v13
  v_add_u32 v12, v12, v13
  v_lshlrev_b32 v13, 4, v10
  v_add_u32 v12, v12, v13
  s_lshl_b32 m0, s26, 10
  s_nop 0
  buffer_load_dwordx4 v12, s[16:19], s24 offen lds
wd_19:
  s_add_u32 s26, s21, 4
  s_cmp_lt_u32 s26, 30
  s_cbranch_scc0 wd_20
  s_lshl_b32 s27, s26, 3
  v_add_u32 v11, s27, v8
  v_mul_u32_u24 v12, 52429, v11
  v_lshrrev_b32 v12, 18, v12
  v_mul_u32_u24 v13, 5, v12
  v_sub_u32 v13, v11, v13
  v_lshlrev_b32 v12, 2, v12
  v_add_u32 v12, v12, v9
  v_mul_u32_u24 v12, 1280, v12
  v_lshlrev_b32 v13, 5, v13
  v_add_u32 v12, v12, v13
  v_lshlrev_b32 v13, 4, v10
  v_add_u32 v12, v12, v13
  s_lshl_b32 m0, s26, 10
  s_nop 0
  buffer_load_dwordx4 v12, s[16:19], s24 offen lds
wd_20:
  s_add_u32 s26, s21, 8
  s_cmp_lt_u32 s26, 30
  s_cbranch_scc0 wd_21
  s_lshl_b32 s27, s26, 3
  v_add_u32 v11, s27, v8
  v_mul_u32_u24 v12, 52429, v11
  v_lshrrev_b32 v12, 18, v12
  v_mul_u32_u24 v13, 5, v12
  v_sub_u32 v13, v11, v13
  v_lshlrev_b32 v12, 2, v12
  v_add_u32 v12, v12, v9
  v_mul_u32_u24 v12, 1280, v12
  v_lshlrev_b32 v13, 5, v13
  v_add_u32 v12, v12, v13
  v_lshlrev_b32 v13, 4, v10
  v_add_u32 v12, v12, v13
  s_lshl_b32 m0, s26, 10
  s_nop 0
  buffer_load_dwordx4 v12, s[16:19], s24 offen lds
wd_21:
  s_add_u32 s26, s21, 12
  s_cmp_lt_u32 s26, 30
  s_cbranch_scc0 wd_22
  s_lshl_b32 s27, s26, 3
  v_add_u32 v11, s27, v8
  v_mul_u32_u24 v12, 52429, v11
  v_lshrrev_b32 v12, 18, v12
  v_mul_u32_u24 v13, 5, v12
  v_sub_u32 v13, v11, v13
  v_lshlrev_b32 v12, 2, v12
  v_add_u32 v12, v12, v9
  v_mul_u32_u24 v12, 1280, v12
  v_lshlrev_b32 v13, 5, v13
  v_add_u32 v12, v12, v13
  v_lshlrev_b32 v13, 4, v10
  v_add_u32 v12, v12, v13
  s_lshl_b32 m0, s26, 10
  s_nop 0
  buffer_load_dwordx4 v12, s[16:19], s24 offen lds
wd_22:
  s_add_u32 s26, s21, 16
  s_cmp_lt_u32 s26, 30
  s_cbranch_scc0 wd_23
  s_lshl_b32 s27, s26, 3
  v_add_u32 v11, s27, v8
  v_mul_u32_u24 v12, 52429, v11
  v_lshrrev_b32 v12, 18, v12
  v_mul_u32_u24 v13, 5, v12
  v_sub_u32 v13, v11, v13
  v_lshlrev_b32 v12, 2, v12
  v_add_u32 v12, v12, v9
  v_mul_u32_u24 v12, 1280, v12
  v_lshlrev_b32 v13, 5, v13
  v_add_u32 v12, v12, v13
  v_lshlrev_b32 v13, 4, v10
  v_add_u32 v12, v12, v13
  s_lshl_b32 m0, s26, 10
  s_nop 0
  buffer_load_dwordx4 v12, s[16:19], s24 offen lds
wd_23:
  s_add_u32 s26, s21, 20
  s_cmp_lt_u32 s26, 30
  s_cbranch_scc0 wd_24
  s_lshl_b32 s27, s26, 3
  v_add_u32 v11, s27, v8
  v_mul_u32_u24 v12, 52429, v11
  v_lshrrev_b32 v12, 18, v12
  v_mul_u32_u24 v13, 5, v12
  v_sub_u32 v13, v11, v13
  v_lshlrev_b32 v12, 2, v12
  v_add_u32 v12, v12, v9
  v_mul_u32_u24 v12, 1280, v12
  v_lshlrev_b32 v13, 5, v13
  v_add_u32 v12, v12, v13
  v_lshlrev_b32 v13, 4, v10
  v_add_u32 v12, v12, v13
  s_lshl_b32 m0, s26, 10
  s_nop 0
  buffer_load_dwordx4 v12, s[16:19], s24 offen lds
wd_24:
  s_add_u32 s26, s21, 24
  s_cmp_lt_u32 s26, 30
  s_cbranch_scc0 wd_25
  s_lshl_b32 s27, s26, 3
  v_add_u32 v11, s27, v8
  v_mul_u32_u24 v12, 52429, v11
  v_lshrrev_b32 v12, 18, v12
  v_mul_u32_u24 v13, 5, v12
  v_sub_u32 v13, v11, v13
  v_lshlrev_b32 v12, 2, v12
  v_add_u32 v12, v12, v9
  v_mul_u32_u24 v12, 1280, v12
  v_lshlrev_b32 v13, 5, v13
  v_add_u32 v12, v12, v13
  v_lshlrev_b32 v13, 4, v10
  v_add_u32 v12, v12, v13
  s_lshl_b32 m0, s26, 10
  s_nop 0
  buffer_load_dwordx4 v12, s[16:19], s24 offen lds
wd_25:
  s_add_u32 s26, s21, 28
  s_cmp_lt_u32 s26, 30
  s_cbranch_scc0 wd_26
  s_lshl_b32 s27, s26, 3
  v_add_u32 v11, s27, v8
  v_mul_u32_u24 v12, 52429, v11
  v_lshrrev_b32 v12, 18, v12
  v_mul_u32_u24 v13, 5, v12
  v_sub_u32 v13, v11, v13
  v_lshlrev_b32 v12, 2, v12
  v_add_u32 v12, v12, v9
  v_mul_u32_u24 v12, 1280, v12
  v_lshlrev_b32 v13, 5, v13
  v_add_u32 v12, v12, v13
  v_lshlrev_b32 v13, 4, v10
  v_add_u32 v12, v12, v13
  s_lshl_b32 m0, s26, 10
  s_nop 0
  buffer_load_dwordx4 v12, s[16:19], s24 offen lds
wd_26:
  v_lshrrev_b32 v8, 4, v1
  v_mul_u32_u24 v8, 1280, v8
  v_bfe_u32 v9, v1, 2, 2
  v_lshlrev_b32 v9, 5, v9
  v_add_u32 v8, v8, v9
  v_bfe_u32 v9, v1, 1, 1
  v_lshlrev_b32 v9, 4, v9
  v_add_u32 v8, v8, v9
  v_and_b32 v9, 1, v1
  v_lshlrev_b32 v9, 3, v9
  v_add_u32 v8, v8, v9
  s_waitcnt vmcnt(0)
  s_barrier
  ds_read_b64_tr_b16 a[0:1], v8 offset:0
  ds_read_b64_tr_b16 a[2:3], v8 offset:640
  ds_read_b64_tr_b16 a[4:5], v8 offset:128
  ds_read_b64_tr_b16 a[6:7], v8 offset:768
  ds_read_b64_tr_b16 a[8:9], v8 offset:256
  ds_read_b64_tr_b16 a[10:11], v8 offset:896
  ds_read_b64_tr_b16 a[12:13], v8 offset:384
  ds_read_b64_tr_b16 a[14:15], v8 offset:1024
  ds_read_b64_tr_b16 a[16:17], v8 offset:512
  ds_read_b64_tr_b16 a[18:19], v8 offset:1152
  ds_read_b64_tr_b16 a[20:21], v8 offset:5120
  ds_read_b64_tr_b16 a[22:23], v8 offset:5760
  s_waitcnt lgkmcnt(0)
  ds_read_b64_tr_b16 a[24:25], v8 offset:5248
  ds_read_b64_tr_b16 a[26:27], v8 offset:5888
  ds_read_b64_tr_b16 a[28:29], v8 offset:5376
  ds_read_b64_tr_b16 a[30:31], v8 offset:6016
  ds_read_b64_tr_b16 a[32:33], v8 offset:5504
  ds_read_b64_tr_b16 a[34:35], v8 offset:6144
  ds_read_b64_tr_b16 a[36:37], v8 offset:5632
  ds_read_b64_tr_b16 a[38:39], v8 offset:6272
  ds_read_b64_tr_b16 a[40:41], v8 offset:10240
  ds_read_b64_tr_b16 a[42:43], v8 offset:10880
  ds_read_b64_tr_b16 a[44:45], v8 offset:10368
  ds_read_b64_tr_b16 a[46:47], v8 offset:11008
  s_waitcnt lgkmcnt(0)
  ds_read_b64_tr_b16 a[48:49], v8 offset:10496
  ds_read_b64_tr_b16 a[50:51], v8 offset:11136
  ds_read_b64_tr_b16 a[52:53], v8 offset:10624
  ds_read_b64_tr_b16 a[54:55], v8 offset:11264
  ds_read_b64_tr_b16 a[56:57], v8 offset:10752
  ds_read_b64_tr_b16 a[58:59], v8 offset:11392
  ds_read_b64_tr_b16 a[60:61], v8 offset:15360
  ds_read_b64_tr_b16 a[62:63], v8 offset:16000
  ds_read_b64_tr_b16 a[64:65], v8 offset:15488
  ds_read_b64_tr_b16 a[66:67], v8 offset:16128
  ds_read_b64_tr_b16 a[68:69], v8 offset:15616
  ds_read_b64_tr_b16 a[70:71], v8 offset:16256
  s_waitcnt lgkmcnt(0)
  ds_read_b64_tr_b16 a[72:73], v8 offset:15744
  ds_read_b64_tr_b16 a[74:75], v8 offset:16384
  ds_read_b64_tr_b16 a[76:77], v8 offset:15872
  ds_read_b64_tr_b16 a[78:79], v8 offset:16512
  ds_read_b64_tr_b16 a[80:81], v8 offset:20480
  ds_read_b64_tr_b16 a[82:83], v8 offset:21120
  ds_read_b64_tr_b16 a[84:85], v8 offset:20608
  ds_read_b64_tr_b16 a[86:87], v8 offset:21248
  ds_read_b64_tr_b16 a[88:89], v8 offset:20736
  ds_read_b64_tr_b16 a[90:91], v8 offset:21376
  ds_read_b64_tr_b16 a[92:93], v8 offset:20864
  ds_read_b64_tr_b16 a[94:95], v8 offset:21504
  s_waitcnt lgkmcnt(0)
  ds_read_b64_tr_b16 a[96:97], v8 offset:20992
  ds_read_b64_tr_b16 a[98:99], v8 offset:21632
  ds_read_b64_tr_b16 a[100:101], v8 offset:25600
  ds_read_b64_tr_b16 a[102:103], v8 offset:26240
  ds_read_b64_tr_b16 a[104:105], v8 offset:25728
  ds_read_b64_tr_b16 a[106:107], v8 offset:26368
  ds_read_b64_tr_b16 a[108:109], v8 offset:25856
  ds_read_b64_tr_b16 a[110:111], v8 offset:26496
  ds_read_b64_tr_b16 a[112:113], v8 offset:25984
  ds_read_b64_tr_b16 a[114:115], v8 offset:26624
  ds_read_b64_tr_b16 a[116:117], v8 offset:26112
  ds_read_b64_tr_b16 a[118:119], v8 offset:26752
  s_waitcnt lgkmcnt(0)
  s_waitcnt lgkmcnt(0)
  v_and_b32 v8, 15, v1
  v_lshrrev_b32 v9, 2, v8
  v_lshlrev_b32 v9, 3, v9
  v_and_b32 v10, 3, v8
  v_add_u32 v9, v9, v10
  v_mul_u32_u24 v9, 12288, v9
  v_lshrrev_b32 v10, 4, v1
  v_lshlrev_b32 v10, 4, v10
  v_add_u32 v9, v9, v10
  v_add_u32 v10, 49152, v9
  s_mul_i32 s24, s22, 384
  s_mul_i32 s25, s21, 1966080
  s_add_u32 s24, s24, s25
  s_mul_i32 s26, s22, 40
  s_mul_i32 s27, s23, 5
  s_add_u32 s26, s26, s27
  s_mul_i32 s26, s26, 20
  s_mul_i32 s27, s21, 5
  s_add_u32 s26, s26, s27
  s_lshl_b32 s26, s26, 10
  s_add_u32 s26, s26, 0x2e00000
  s_add_u32 s27, s24, 0
  buffer_load_dwordx4 v[16:19], v9, s[12:15], s27 offen offset:0
  buffer_load_dwordx4 v[20:23], v9, s[12:15], s27 offen offset:64
  buffer_load_dwordx4 v[24:27], v9, s[12:15], s27 offen offset:128
  buffer_load_dwordx4 v[28:31], v9, s[12:15], s27 offen offset:192
  buffer_load_dwordx4 v[32:35], v9, s[12:15], s27 offen offset:256
  buffer_load_dwordx4 v[36:39], v9, s[12:15], s27 offen offset:320
  buffer_load_dwordx4 v[40:43], v10, s[12:15], s27 offen offset:0
  buffer_load_dwordx4 v[44:47], v10, s[12:15], s27 offen offset:64
  buffer_load_dwordx4 v[48:51], v10, s[12:15], s27 offen offset:128
  buffer_load_dwordx4 v[52:55], v10, s[12:15], s27 offen offset:192
  buffer_load_dwordx4 v[56:59], v10, s[12:15], s27 offen offset:256
  buffer_load_dwordx4 v[60:63], v10, s[12:15], s27 offen offset:320
  s_add_u32 s27, s24, 393216
  buffer_load_dwordx4 v[64:67], v9, s[12:15], s27 offen offset:0
  buffer_load_dwordx4 v[68:71], v9, s[12:15], s27 offen offset:64
  buffer_load_dwordx4 v[72:75], v9, s[12:15], s27 offen offset:128
  buffer_load_dwordx4 v[76:79], v9, s[12:15], s27 offen offset:192
  buffer_load_dwordx4 v[80:83], v9, s[12:15], s27 offen offset:256
  buffer_load_dwordx4 v[84:87], v9, s[12:15], s27 offen offset:320
  buffer_load_dwordx4 v[88:91], v10, s[12:15], s27 offen offset:0
  buffer_load_dwordx4 v[92:95], v10, s[12:15], s27 offen offset:64
  buffer_load_dwordx4 v[96:99], v10, s[12:15], s27 offen offset:128
  buffer_load_dwordx4 v[100:103], v10, s[12:15], s27 offen offset:192
  buffer_load_dwordx4 v[104:107], v10, s[12:15], s27 offen offset:256
  buffer_load_dwordx4 v[108:111], v10, s[12:15], s27 offen offset:320
  s_waitcnt vmcnt(12)
  v_mfma_f32_16x16x32_bf16 v[112:115], v[16:19], a[0:3], 0
  v_mfma_f32_16x16x32_bf16 v[116:119], v[16:19], a[4:7], 0
  v_mfma_f32_16x16x32_bf16 v[120:123], v[16:19], a[8:11], 0
  v_mfma_f32_16x16x32_bf16 v[124:127], v[16:19], a[12:15], 0
  v_mfma_f32_16x16x32_bf16 v[128:131], v[16:19], a[16:19], 0
  v_mfma_f32_16x16x32_bf16 v[132:135], v[40:43], a[0:3], 0
  v_mfma_f32_16x16x32_bf16 v[136:139], v[40:43], a[4:7], 0
  v_mfma_f32_16x16x32_bf16 v[140:143], v[40:43], a[8:11], 0
  v_mfma_f32_16x16x32_bf16 v[144:147], v[40:43], a[12:15], 0
  v_mfma_f32_16x16x32_bf16 v[148:151], v[40:43], a[16:19], 0
  v_mfma_f32_16x16x32_bf16 v[112:115], v[20:23], a[20:23], v[112:115]
  v_mfma_f32_16x16x32_bf16 v[116:119], v[20:23], a[24:27], v[116:119]
  v_mfma_f32_16x16x32_bf16 v[120:123], v[20:23], a[28:31], v[120:123]
  v_mfma_f32_16x16x32_bf16 v[124:127], v[20:23], a[32:35], v[124:127]
  v_mfma_f32_16x16x32_bf16 v[128:131], v[20:23], a[36:39], v[128:131]
  v_mfma_f32_16x16x32_bf16 v[132:135], v[44:47], a[20:23], v[132:135]
  v_mfma_f32_16x16x32_bf16 v[136:139], v[44:47], a[24:27], v[136:139]
  v_mfma_f32_16x16x32_bf16 v[140:143], v[44:47], a[28:31], v[140:143]
  v_mfma_f32_16x16x32_bf16 v[144:147], v[44:47], a[32:35], v[144:147]
  v_mfma_f32_16x16x32_bf16 v[148:151], v[44:47], a[36:39], v[148:151]
  v_mfma_f32_16x16x32_bf16 v[112:115], v[24:27], a[40:43], v[112:115]
  v_mfma_f32_16x16x32_bf16 v[116:119], v[24:27], a[44:47], v[116:119]
  v_mfma_f32_16x16x32_bf16 v[120:123], v[24:27], a[48:51], v[120:123]
  v_mfma_f32_16x16x32_bf16 v[124:127], v[24:27], a[52:55], v[124:127]
  v_mfma_f32_16x16x32_bf16 v[128:131], v[24:27], a[56:59], v[128:131]
  v_mfma_f32_16x16x32_bf16 v[132:135], v[48:51], a[40:43], v[132:135]
  v_mfma_f32_16x16x32_bf16 v[136:139], v[48:51], a[44:47], v[136:139]
  v_mfma_f32_16x16x32_bf16 v[140:143], v[48:51], a[48:51], v[140:143]
  v_mfma_f32_16x16x32_bf16 v[144:147], v[48:51], a[52:55], v[144:147]
  v_mfma_f32_16x16x32_bf16 v[148:151], v[48:51], a[56:59], v[148:151]
  v_mfma_f32_16x16x32_bf16 v[112:115], v[28:31], a[60:63], v[112:115]
  v_mfma_f32_16x16x32_bf16 v[116:119], v[28:31], a[64:67], v[116:119]
  v_mfma_f32_16x16x32_bf16 v[120:123], v[28:31], a[68:71], v[120:123]
  v_mfma_f32_16x16x32_bf16 v[124:127], v[28:31], a[72:75], v[124:127]
  v_mfma_f32_16x16x32_bf16 v[128:131], v[28:31], a[76:79], v[128:131]
  v_mfma_f32_16x16x32_bf16 v[132:135], v[52:55], a[60:63], v[132:135]
  v_mfma_f32_16x16x32_bf16 v[136:139], v[52:55], a[64:67], v[136:139]
  v_mfma_f32_16x16x32_bf16 v[140:143], v[52:55], a[68:71], v[140:143]
  v_mfma_f32_16x16x32_bf16 v[144:147], v[52:55], a[72:75], v[144:147]
  v_mfma_f32_16x16x32_bf16 v[148:151], v[52:55], a[76:79], v[148:151]
  v_mfma_f32_16x16x32_bf16 v[112:115], v[32:35], a[80:83], v[112:115]
  v_mfma_f32_16x16x32_bf16 v[116:119], v[32:35], a[84:87], v[116:119]
  v_mfma_f32_16x16x32_bf16 v[120:123], v[32:35], a[88:91], v[120:123]
  v_mfma_f32_16x16x32_bf16 v[124:127], v[32:35], a[92:95], v[124:127]
  v_mfma_f32_16x16x32_bf16 v[128:131], v[32:35], a[96:99], v[128:131]
  v_mfma_f32_16x16x32_bf16 v[132:135], v[56:59], a[80:83], v[132:135]
  v_mfma_f32_16x16x32_bf16 v[136:139], v[56:59], a[84:87], v[136:139]
  v_mfma_f32_16x16x32_bf16 v[140:143], v[56:59], a[88:91], v[140:143]
  v_mfma_f32_16x16x32_bf16 v[144:147], v[56:59], a[92:95], v[144:147]
  v_mfma_f32_16x16x32_bf16 v[148:151], v[56:59], a[96:99], v[148:151]
  v_mfma_f32_16x16x32_bf16 v[112:115], v[36:39], a[100:103], v[112:115]
  v_mfma_f32_16x16x32_bf16 v[116:119], v[36:39], a[104:107], v[116:119]
  v_mfma_f32_16x16x32_bf16 v[120:123], v[36:39], a[108:111], v[120:123]
  v_mfma_f32_16x16x32_bf16 v[124:127], v[36:39], a[112:115], v[124:127]
  v_mfma_f32_16x16x32_bf16 v[128:131], v[36:39], a[116:119], v[128:131]
  v_mfma_f32_16x16x32_bf16 v[132:135], v[60:63], a[100:103], v[132:135]
  v_mfma_f32_16x16x32_bf16 v[136:139], v[60:63], a[104:107], v[136:139]
  v_mfma_f32_16x16x32_bf16 v[140:143], v[60:63], a[108:111], v[140:143]
  v_mfma_f32_16x16x32_bf16 v[144:147], v[60:63], a[112:115], v[144:147]
  v_mfma_f32_16x16x32_bf16 v[148:151], v[60:63], a[116:119], v[148:151]
  s_nop 7
  v_cvt_pk_bf16_f32 v160, v112, v113
  v_cvt_pk_bf16_f32 v161, v114, v115
  v_cvt_pk_bf16_f32 v162, v132, v133
  v_cvt_pk_bf16_f32 v163, v134, v135
  s_add_u32 s27, s26, 0
  buffer_store_dwordx4 v[160:163], v2, s[8:11], s27 offen
  v_cvt_pk_bf16_f32 v164, v116, v117
  v_cvt_pk_bf16_f32 v165, v118, v119
  v_cvt_pk_bf16_f32 v166, v136, v137
  v_cvt_pk_bf16_f32 v167, v138, v139
  s_add_u32 s27, s26, 20480
  buffer_store_dwordx4 v[164:167], v2, s[8:11], s27 offen
  v_cvt_pk_bf16_f32 v160, v120, v121
  v_cvt_pk_bf16_f32 v161, v122, v123
  v_cvt_pk_bf16_f32 v162, v140, v141
  v_cvt_pk_bf16_f32 v163, v142, v143
  s_add_u32 s27, s26, 40960
  buffer_store_dwordx4 v[160:163], v2, s[8:11], s27 offen
  v_cvt_pk_bf16_f32 v164, v124, v125
  v_cvt_pk_bf16_f32 v165, v126, v127
  v_cvt_pk_bf16_f32 v166, v144, v145
  v_cvt_pk_bf16_f32 v167, v146, v147
  s_add_u32 s27, s26, 61440
  buffer_store_dwordx4 v[164:167], v2, s[8:11], s27 offen
  v_cvt_pk_bf16_f32 v160, v128, v129
  v_cvt_pk_bf16_f32 v161, v130, v131
  v_cvt_pk_bf16_f32 v162, v148, v149
  v_cvt_pk_bf16_f32 v163, v150, v151
  s_add_u32 s27, s26, 81920
  buffer_store_dwordx4 v[160:163], v2, s[8:11], s27 offen
  s_add_u32 s27, s24, 786432
  buffer_load_dwordx4 v[16:19], v9, s[12:15], s27 offen offset:0
  buffer_load_dwordx4 v[20:23], v9, s[12:15], s27 offen offset:64
  buffer_load_dwordx4 v[24:27], v9, s[12:15], s27 offen offset:128
  buffer_load_dwordx4 v[28:31], v9, s[12:15], s27 offen offset:192
  buffer_load_dwordx4 v[32:35], v9, s[12:15], s27 offen offset:256
  buffer_load_dwordx4 v[36:39], v9, s[12:15], s27 offen offset:320
  buffer_load_dwordx4 v[40:43], v10, s[12:15], s27 offen offset:0
  buffer_load_dwordx4 v[44:47], v10, s[12:15], s27 offen offset:64
  buffer_load_dwordx4 v[48:51], v10, s[12:15], s27 offen offset:128
  buffer_load_dwordx4 v[52:55], v10, s[12:15], s27 offen offset:192
  buffer_load_dwordx4 v[56:59], v10, s[12:15], s27 offen offset:256
  buffer_load_dwordx4 v[60:63], v10, s[12:15], s27 offen offset:320
  s_waitcnt vmcnt(17)
  v_mfma_f32_16x16x32_bf16 v[112:115], v[64:67], a[0:3], 0
  v_mfma_f32_16x16x32_bf16 v[116:119], v[64:67], a[4:7], 0
  v_mfma_f32_16x16x32_bf16 v[120:123], v[64:67], a[8:11], 0
  v_mfma_f32_16x16x32_bf16 v[124:127], v[64:67], a[12:15], 0
  v_mfma_f32_16x16x32_bf16 v[128:131], v[64:67], a[16:19], 0
  v_mfma_f32_16x16x32_bf16 v[132:135], v[88:91], a[0:3], 0
  v_mfma_f32_16x16x32_bf16 v[136:139], v[88:91], a[4:7], 0
  v_mfma_f32_16x16x32_bf16 v[140:143], v[88:91], a[8:11], 0
  v_mfma_f32_16x16x32_bf16 v[144:147], v[88:91], a[12:15], 0
  v_mfma_f32_16x16x32_bf16 v[148:151], v[88:91], a[16:19], 0
  v_mfma_f32_16x16x32_bf16 v[112:115], v[68:71], a[20:23], v[112:115]
  v_mfma_f32_16x16x32_bf16 v[116:119], v[68:71], a[24:27], v[116:119]
  v_mfma_f32_16x16x32_bf16 v[120:123], v[68:71], a[28:31], v[120:123]
  v_mfma_f32_16x16x32_bf16 v[124:127], v[68:71], a[32:35], v[124:127]
  v_mfma_f32_16x16x32_bf16 v[128:131], v[68:71], a[36:39], v[128:131]
  v_mfma_f32_16x16x32_bf16 v[132:135], v[92:95], a[20:23], v[132:135]
  v_mfma_f32_16x16x32_bf16 v[136:139], v[92:95], a[24:27], v[136:139]
  v_mfma_f32_16x16x32_bf16 v[140:143], v[92:95], a[28:31], v[140:143]
  v_mfma_f32_16x16x32_bf16 v[144:147], v[92:95], a[32:35], v[144:147]
  v_mfma_f32_16x16x32_bf16 v[148:151], v[92:95], a[36:39], v[148:151]
  v_mfma_f32_16x16x32_bf16 v[112:115], v[72:75], a[40:43], v[112:115]
  v_mfma_f32_16x16x32_bf16 v[116:119], v[72:75], a[44:47], v[116:119]
  v_mfma_f32_16x16x32_bf16 v[120:123], v[72:75], a[48:51], v[120:123]
  v_mfma_f32_16x16x32_bf16 v[124:127], v[72:75], a[52:55], v[124:127]
  v_mfma_f32_16x16x32_bf16 v[128:131], v[72:75], a[56:59], v[128:131]
  v_mfma_f32_16x16x32_bf16 v[132:135], v[96:99], a[40:43], v[132:135]
  v_mfma_f32_16x16x32_bf16 v[136:139], v[96:99], a[44:47], v[136:139]
  v_mfma_f32_16x16x32_bf16 v[140:143], v[96:99], a[48:51], v[140:143]
  v_mfma_f32_16x16x32_bf16 v[144:147], v[96:99], a[52:55], v[144:147]
  v_mfma_f32_16x16x32_bf16 v[148:151], v[96:99], a[56:59], v[148:151]
  v_mfma_f32_16x16x32_bf16 v[112:115], v[76:79], a[60:63], v[112:115]
  v_mfma_f32_16x16x32_bf16 v[116:119], v[76:79], a[64:67], v[116:119]
  v_mfma_f32_16x16x32_bf16 v[120:123], v[76:79], a[68:71], v[120:123]
  v_mfma_f32_16x16x32_bf16 v[124:127], v[76:79], a[72:75], v[124:127]
  v_mfma_f32_16x16x32_bf16 v[128:131], v[76:79], a[76:79], v[128:131]
  v_mfma_f32_16x16x32_bf16 v[132:135], v[100:103], a[60:63], v[132:135]
  v_mfma_f32_16x16x32_bf16 v[136:139], v[100:103], a[64:67], v[136:139]
  v_mfma_f32_16x16x32_bf16 v[140:143], v[100:103], a[68:71], v[140:143]
  v_mfma_f32_16x16x32_bf16 v[144:147], v[100:103], a[72:75], v[144:147]
  v_mfma_f32_16x16x32_bf16 v[148:151], v[100:103], a[76:79], v[148:151]
  v_mfma_f32_16x16x32_bf16 v[112:115], v[80:83], a[80:83], v[112:115]
  v_mfma_f32_16x16x32_bf16 v[116:119], v[80:83], a[84:87], v[116:119]
  v_mfma_f32_16x16x32_bf16 v[120:123], v[80:83], a[88:91], v[120:123]
  v_mfma_f32_16x16x32_bf16 v[124:127], v[80:83], a[92:95], v[124:127]
  v_mfma_f32_16x16x32_bf16 v[128:131], v[80:83], a[96:99], v[128:131]
  v_mfma_f32_16x16x32_bf16 v[132:135], v[104:107], a[80:83], v[132:135]
  v_mfma_f32_16x16x32_bf16 v[136:139], v[104:107], a[84:87], v[136:139]
  v_mfma_f32_16x16x32_bf16 v[140:143], v[104:107], a[88:91], v[140:143]
  v_mfma_f32_16x16x32_bf16 v[144:147], v[104:107], a[92:95], v[144:147]
  v_mfma_f32_16x16x32_bf16 v[148:151], v[104:107], a[96:99], v[148:151]
  v_mfma_f32_16x16x32_bf16 v[112:115], v[84:87], a[100:103], v[112:115]
  v_mfma_f32_16x16x32_bf16 v[116:119], v[84:87], a[104:107], v[116:119]
  v_mfma_f32_16x16x32_bf16 v[120:123], v[84:87], a[108:111], v[120:123]
  v_mfma_f32_16x16x32_bf16 v[124:127], v[84:87], a[112:115], v[124:127]
  v_mfma_f32_16x16x32_bf16 v[128:131], v[84:87], a[116:119], v[128:131]
  v_mfma_f32_16x16x32_bf16 v[132:135], v[108:111], a[100:103], v[132:135]
  v_mfma_f32_16x16x32_bf16 v[136:139], v[108:111], a[104:107], v[136:139]
  v_mfma_f32_16x16x32_bf16 v[140:143], v[108:111], a[108:111], v[140:143]
  v_mfma_f32_16x16x32_bf16 v[144:147], v[108:111], a[112:115], v[144:147]
  v_mfma_f32_16x16x32_bf16 v[148:151], v[108:111], a[116:119], v[148:151]
  s_nop 7
  v_cvt_pk_bf16_f32 v160, v112, v113
  v_cvt_pk_bf16_f32 v161, v114, v115
  v_cvt_pk_bf16_f32 v162, v132, v133
  v_cvt_pk_bf16_f32 v163, v134, v135
  s_add_u32 s27, s26, 1024
  buffer_store_dwordx4 v[160:163], v2, s[8:11], s27 offen
  v_cvt_pk_bf16_f32 v164, v116, v117
  v_cvt_pk_bf16_f32 v165, v118, v119
  v_cvt_pk_bf16_f32 v166, v136, v137
  v_cvt_pk_bf16_f32 v167, v138, v139
  s_add_u32 s27, s26, 21504
  buffer_store_dwordx4 v[164:167], v2, s[8:11], s27 offen
  v_cvt_pk_bf16_f32 v160, v120, v121
  v_cvt_pk_bf16_f32 v161, v122, v123
  v_cvt_pk_bf16_f32 v162, v140, v141
  v_cvt_pk_bf16_f32 v163, v142, v143
  s_add_u32 s27, s26, 41984
  buffer_store_dwordx4 v[160:163], v2, s[8:11], s27 offen
  v_cvt_pk_bf16_f32 v164, v124, v125
  v_cvt_pk_bf16_f32 v165, v126, v127
  v_cvt_pk_bf16_f32 v166, v144, v145
  v_cvt_pk_bf16_f32 v167, v146, v147
  s_add_u32 s27, s26, 62464
  buffer_store_dwordx4 v[164:167], v2, s[8:11], s27 offen
  v_cvt_pk_bf16_f32 v160, v128, v129
  v_cvt_pk_bf16_f32 v161, v130, v131
  v_cvt_pk_bf16_f32 v162, v148, v149
  v_cvt_pk_bf16_f32 v163, v150, v151
  s_add_u32 s27, s26, 82944
  buffer_store_dwordx4 v[160:163], v2, s[8:11], s27 offen
  s_add_u32 s27, s24, 1179648
  buffer_load_dwordx4 v[64:67], v9, s[12:15], s27 offen offset:0
  buffer_load_dwordx4 v[68:71], v9, s[12:15], s27 offen offset:64
  buffer_load_dwordx4 v[72:75], v9, s[12:15], s27 offen offset:128
  buffer_load_dwordx4 v[76:79], v9, s[12:15], s27 offen offset:192
  buffer_load_dwordx4 v[80:83], v9, s[12:15], s27 offen offset:256
  buffer_load_dwordx4 v[84:87], v9, s[12:15], s27 offen offset:320
  buffer_load_dwordx4 v[88:91], v10, s[12:15], s27 offen offset:0
  buffer_load_dwordx4 v[92:95], v10, s[12:15], s27 offen offset:64
  buffer_load_dwordx4 v[96:99], v10, s[12:15], s27 offen offset:128
  buffer_load_dwordx4 v[100:103], v10, s[12:15], s27 offen offset:192
  buffer_load_dwordx4 v[104:107], v10, s[12:15], s27 offen offset:256
  buffer_load_dwordx4 v[108:111], v10, s[12:15], s27 offen offset:320
  s_waitcnt vmcnt(17)
  v_mfma_f32_16x16x32_bf16 v[112:115], v[16:19], a[0:3], 0
  v_mfma_f32_16x16x32_bf16 v[116:119], v[16:19], a[4:7], 0
  v_mfma_f32_16x16x32_bf16 v[120:123], v[16:19], a[8:11], 0
  v_mfma_f32_16x16x32_bf16 v[124:127], v[16:19], a[12:15], 0
  v_mfma_f32_16x16x32_bf16 v[128:131], v[16:19], a[16:19], 0
  v_mfma_f32_16x16x32_bf16 v[132:135], v[40:43], a[0:3], 0
  v_mfma_f32_16x16x32_bf16 v[136:139], v[40:43], a[4:7], 0
  v_mfma_f32_16x16x32_bf16 v[140:143], v[40:43], a[8:11], 0
  v_mfma_f32_16x16x32_bf16 v[144:147], v[40:43], a[12:15], 0
  v_mfma_f32_16x16x32_bf16 v[148:151], v[40:43], a[16:19], 0
  v_mfma_f32_16x16x32_bf16 v[112:115], v[20:23], a[20:23], v[112:115]
  v_mfma_f32_16x16x32_bf16 v[116:119], v[20:23], a[24:27], v[116:119]
  v_mfma_f32_16x16x32_bf16 v[120:123], v[20:23], a[28:31], v[120:123]
  v_mfma_f32_16x16x32_bf16 v[124:127], v[20:23], a[32:35], v[124:127]
  v_mfma_f32_16x16x32_bf16 v[128:131], v[20:23], a[36:39], v[128:131]
  v_mfma_f32_16x16x32_bf16 v[132:135], v[44:47], a[20:23], v[132:135]
  v_mfma_f32_16x16x32_bf16 v[136:139], v[44:47], a[24:27], v[136:139]
  v_mfma_f32_16x16x32_bf16 v[140:143], v[44:47], a[28:31], v[140:143]
  v_mfma_f32_16x16x32_bf16 v[144:147], v[44:47], a[32:35], v[144:147]
  v_mfma_f32_16x16x32_bf16 v[148:151], v[44:47], a[36:39], v[148:151]
  v_mfma_f32_16x16x32_bf16 v[112:115], v[24:27], a[40:43], v[112:115]
  v_mfma_f32_16x16x32_bf16 v[116:119], v[24:27], a[44:47], v[116:119]
  v_mfma_f32_16x16x32_bf16 v[120:123], v[24:27], a[48:51], v[120:123]
  v_mfma_f32_16x16x32_bf16 v[124:127], v[24:27], a[52:55], v[124:127]
  v_mfma_f32_16x16x32_bf16 v[128:131], v[24:27], a[56:59], v[128:131]
  v_mfma_f32_16x16x32_bf16 v[132:135], v[48:51], a[40:43], v[132:135]
  v_mfma_f32_16x16x32_bf16 v[136:139], v[48:51], a[44:47], v[136:139]
  v_mfma_f32_16x16x32_bf16 v[140:143], v[48:51], a[48:51], v[140:143]
  v_mfma_f32_16x16x32_bf16 v[144:147], v[48:51], a[52:55], v[144:147]
  v_mfma_f32_16x16x32_bf16 v[148:151], v[48:51], a[56:59], v[148:151]
  v_mfma_f32_16x16x32_bf16 v[112:115], v[28:31], a[60:63], v[112:115]
  v_mfma_f32_16x16x32_bf16 v[116:119], v[28:31], a[64:67], v[116:119]
  v_mfma_f32_16x16x32_bf16 v[120:123], v[28:31], a[68:71], v[120:123]
  v_mfma_f32_16x16x32_bf16 v[124:127], v[28:31], a[72:75], v[124:127]
  v_mfma_f32_16x16x32_bf16 v[128:131], v[28:31], a[76:79], v[128:131]
  v_mfma_f32_16x16x32_bf16 v[132:135], v[52:55], a[60:63], v[132:135]
  v_mfma_f32_16x16x32_bf16 v[136:139], v[52:55], a[64:67], v[136:139]
  v_mfma_f32_16x16x32_bf16 v[140:143], v[52:55], a[68:71], v[140:143]
  v_mfma_f32_16x16x32_bf16 v[144:147], v[52:55], a[72:75], v[144:147]
  v_mfma_f32_16x16x32_bf16 v[148:151], v[52:55], a[76:79], v[148:151]
  v_mfma_f32_16x16x32_bf16 v[112:115], v[32:35], a[80:83], v[112:115]
  v_mfma_f32_16x16x32_bf16 v[116:119], v[32:35], a[84:87], v[116:119]
  v_mfma_f32_16x16x32_bf16 v[120:123], v[32:35], a[88:91], v[120:123]
  v_mfma_f32_16x16x32_bf16 v[124:127], v[32:35], a[92:95], v[124:127]
  v_mfma_f32_16x16x32_bf16 v[128:131], v[32:35], a[96:99], v[128:131]
  v_mfma_f32_16x16x32_bf16 v[132:135], v[56:59], a[80:83], v[132:135]
  v_mfma_f32_16x16x32_bf16 v[136:139], v[56:59], a[84:87], v[136:139]
  v_mfma_f32_16x16x32_bf16 v[140:143], v[56:59], a[88:91], v[140:143]
  v_mfma_f32_16x16x32_bf16 v[144:147], v[56:59], a[92:95], v[144:147]
  v_mfma_f32_16x16x32_bf16 v[148:151], v[56:59], a[96:99], v[148:151]
  v_mfma_f32_16x16x32_bf16 v[112:115], v[36:39], a[100:103], v[112:115]
  v_mfma_f32_16x16x32_bf16 v[116:119], v[36:39], a[104:107], v[116:119]
  v_mfma_f32_16x16x32_bf16 v[120:123], v[36:39], a[108:111], v[120:123]
  v_mfma_f32_16x16x32_bf16 v[124:127], v[36:39], a[112:115], v[124:127]
  v_mfma_f32_16x16x32_bf16 v[128:131], v[36:39], a[116:119], v[128:131]
  v_mfma_f32_16x16x32_bf16 v[132:135], v[60:63], a[100:103], v[132:135]
  v_mfma_f32_16x16x32_bf16 v[136:139], v[60:63], a[104:107], v[136:139]
  v_mfma_f32_16x16x32_bf16 v[140:143], v[60:63], a[108:111], v[140:143]
  v_mfma_f32_16x16x32_bf16 v[144:147], v[60:63], a[112:115], v[144:147]
  v_mfma_f32_16x16x32_bf16 v[148:151], v[60:63], a[116:119], v[148:151]
  s_nop 7
  v_cvt_pk_bf16_f32 v160, v112, v113
  v_cvt_pk_bf16_f32 v161, v114, v115
  v_cvt_pk_bf16_f32 v162, v132, v133
  v_cvt_pk_bf16_f32 v163, v134, v135
  s_add_u32 s27, s26, 2048
  buffer_store_dwordx4 v[160:163], v2, s[8:11], s27 offen
  v_cvt_pk_bf16_f32 v164, v116, v117
  v_cvt_pk_bf16_f32 v165, v118, v119
  v_cvt_pk_bf16_f32 v166, v136, v137
  v_cvt_pk_bf16_f32 v167, v138, v139
  s_add_u32 s27, s26, 22528
  buffer_store_dwordx4 v[164:167], v2, s[8:11], s27 offen
  v_cvt_pk_bf16_f32 v160, v120, v121
  v_cvt_pk_bf16_f32 v161, v122, v123
  v_cvt_pk_bf16_f32 v162, v140, v141
  v_cvt_pk_bf16_f32 v163, v142, v143
  s_add_u32 s27, s26, 43008
  buffer_store_dwordx4 v[160:163], v2, s[8:11], s27 offen
  v_cvt_pk_bf16_f32 v164, v124, v125
  v_cvt_pk_bf16_f32 v165, v126, v127
  v_cvt_pk_bf16_f32 v166, v144, v145
  v_cvt_pk_bf16_f32 v167, v146, v147
  s_add_u32 s27, s26, 63488
  buffer_store_dwordx4 v[164:167], v2, s[8:11], s27 offen
  v_cvt_pk_bf16_f32 v160, v128, v129
  v_cvt_pk_bf16_f32 v161, v130, v131
  v_cvt_pk_bf16_f32 v162, v148, v149
  v_cvt_pk_bf16_f32 v163, v150, v151
  s_add_u32 s27, s26, 83968
  buffer_store_dwordx4 v[160:163], v2, s[8:11], s27 offen
  s_add_u32 s27, s24, 1572864
  buffer_load_dwordx4 v[16:19], v9, s[12:15], s27 offen offset:0
  buffer_load_dwordx4 v[20:23], v9, s[12:15], s27 offen offset:64
  buffer_load_dwordx4 v[24:27], v9, s[12:15], s27 offen offset:128
  buffer_load_dwordx4 v[28:31], v9, s[12:15], s27 offen offset:192
  buffer_load_dwordx4 v[32:35], v9, s[12:15], s27 offen offset:256
  buffer_load_dwordx4 v[36:39], v9, s[12:15], s27 offen offset:320
  buffer_load_dwordx4 v[40:43], v10, s[12:15], s27 offen offset:0
  buffer_load_dwordx4 v[44:47], v10, s[12:15], s27 offen offset:64
  buffer_load_dwordx4 v[48:51], v10, s[12:15], s27 offen offset:128
  buffer_load_dwordx4 v[52:55], v10, s[12:15], s27 offen offset:192
  buffer_load_dwordx4 v[56:59], v10, s[12:15], s27 offen offset:256
  buffer_load_dwordx4 v[60:63], v10, s[12:15], s27 offen offset:320
  s_waitcnt vmcnt(17)
  v_mfma_f32_16x16x32_bf16 v[112:115], v[64:67], a[0:3], 0
  v_mfma_f32_16x16x32_bf16 v[116:119], v[64:67], a[4:7], 0
  v_mfma_f32_16x16x32_bf16 v[120:123], v[64:67], a[8:11], 0
  v_mfma_f32_16x16x32_bf16 v[124:127], v[64:67], a[12:15], 0
  v_mfma_f32_16x16x32_bf16 v[128:131], v[64:67], a[16:19], 0
  v_mfma_f32_16x16x32_bf16 v[132:135], v[88:91], a[0:3], 0
  v_mfma_f32_16x16x32_bf16 v[136:139], v[88:91], a[4:7], 0
  v_mfma_f32_16x16x32_bf16 v[140:143], v[88:91], a[8:11], 0
  v_mfma_f32_16x16x32_bf16 v[144:147], v[88:91], a[12:15], 0
  v_mfma_f32_16x16x32_bf16 v[148:151], v[88:91], a[16:19], 0
  v_mfma_f32_16x16x32_bf16 v[112:115], v[68:71], a[20:23], v[112:115]
  v_mfma_f32_16x16x32_bf16 v[116:119], v[68:71], a[24:27], v[116:119]
  v_mfma_f32_16x16x32_bf16 v[120:123], v[68:71], a[28:31], v[120:123]
  v_mfma_f32_16x16x32_bf16 v[124:127], v[68:71], a[32:35], v[124:127]
  v_mfma_f32_16x16x32_bf16 v[128:131], v[68:71], a[36:39], v[128:131]
  v_mfma_f32_16x16x32_bf16 v[132:135], v[92:95], a[20:23], v[132:135]
  v_mfma_f32_16x16x32_bf16 v[136:139], v[92:95], a[24:27], v[136:139]
  v_mfma_f32_16x16x32_bf16 v[140:143], v[92:95], a[28:31], v[140:143]
  v_mfma_f32_16x16x32_bf16 v[144:147], v[92:95], a[32:35], v[144:147]
  v_mfma_f32_16x16x32_bf16 v[148:151], v[92:95], a[36:39], v[148:151]
  v_mfma_f32_16x16x32_bf16 v[112:115], v[72:75], a[40:43], v[112:115]
  v_mfma_f32_16x16x32_bf16 v[116:119], v[72:75], a[44:47], v[116:119]
  v_mfma_f32_16x16x32_bf16 v[120:123], v[72:75], a[48:51], v[120:123]
  v_mfma_f32_16x16x32_bf16 v[124:127], v[72:75], a[52:55], v[124:127]
  v_mfma_f32_16x16x32_bf16 v[128:131], v[72:75], a[56:59], v[128:131]
  v_mfma_f32_16x16x32_bf16 v[132:135], v[96:99], a[40:43], v[132:135]
  v_mfma_f32_16x16x32_bf16 v[136:139], v[96:99], a[44:47], v[136:139]
  v_mfma_f32_16x16x32_bf16 v[140:143], v[96:99], a[48:51], v[140:143]
  v_mfma_f32_16x16x32_bf16 v[144:147], v[96:99], a[52:55], v[144:147]
  v_mfma_f32_16x16x32_bf16 v[148:151], v[96:99], a[56:59], v[148:151]
  v_mfma_f32_16x16x32_bf16 v[112:115], v[76:79], a[60:63], v[112:115]
  v_mfma_f32_16x16x32_bf16 v[116:119], v[76:79], a[64:67], v[116:119]
  v_mfma_f32_16x16x32_bf16 v[120:123], v[76:79], a[68:71], v[120:123]
  v_mfma_f32_16x16x32_bf16 v[124:127], v[76:79], a[72:75], v[124:127]
  v_mfma_f32_16x16x32_bf16 v[128:131], v[76:79], a[76:79], v[128:131]
  v_mfma_f32_16x16x32_bf16 v[132:135], v[100:103], a[60:63], v[132:135]
  v_mfma_f32_16x16x32_bf16 v[136:139], v[100:103], a[64:67], v[136:139]
  v_mfma_f32_16x16x32_bf16 v[140:143], v[100:103], a[68:71], v[140:143]
  v_mfma_f32_16x16x32_bf16 v[144:147], v[100:103], a[72:75], v[144:147]
  v_mfma_f32_16x16x32_bf16 v[148:151], v[100:103], a[76:79], v[148:151]
  v_mfma_f32_16x16x32_bf16 v[112:115], v[80:83], a[80:83], v[112:115]
  v_mfma_f32_16x16x32_bf16 v[116:119], v[80:83], a[84:87], v[116:119]
  v_mfma_f32_16x16x32_bf16 v[120:123], v[80:83], a[88:91], v[120:123]
  v_mfma_f32_16x16x32_bf16 v[124:127], v[80:83], a[92:95], v[124:127]
  v_mfma_f32_16x16x32_bf16 v[128:131], v[80:83], a[96:99], v[128:131]
  v_mfma_f32_16x16x32_bf16 v[132:135], v[104:107], a[80:83], v[132:135]
  v_mfma_f32_16x16x32_bf16 v[136:139], v[104:107], a[84:87], v[136:139]
  v_mfma_f32_16x16x32_bf16 v[140:143], v[104:107], a[88:91], v[140:143]
  v_mfma_f32_16x16x32_bf16 v[144:147], v[104:107], a[92:95], v[144:147]
  v_mfma_f32_16x16x32_bf16 v[148:151], v[104:107], a[96:99], v[148:151]
  v_mfma_f32_16x16x32_bf16 v[112:115], v[84:87], a[100:103], v[112:115]
  v_mfma_f32_16x16x32_bf16 v[116:119], v[84:87], a[104:107], v[116:119]
  v_mfma_f32_16x16x32_bf16 v[120:123], v[84:87], a[108:111], v[120:123]
  v_mfma_f32_16x16x32_bf16 v[124:127], v[84:87], a[112:115], v[124:127]
  v_mfma_f32_16x16x32_bf16 v[128:131], v[84:87], a[116:119], v[128:131]
  v_mfma_f32_16x16x32_bf16 v[132:135], v[108:111], a[100:103], v[132:135]
  v_mfma_f32_16x16x32_bf16 v[136:139], v[108:111], a[104:107], v[136:139]
  v_mfma_f32_16x16x32_bf16 v[140:143], v[108:111], a[108:111], v[140:143]
  v_mfma_f32_16x16x32_bf16 v[144:147], v[108:111], a[112:115], v[144:147]
  v_mfma_f32_16x16x32_bf16 v[148:151], v[108:111], a[116:119], v[148:151]
  s_nop 7
  v_cvt_pk_bf16_f32 v160, v112, v113
  v_cvt_pk_bf16_f32 v161, v114, v115
  v_cvt_pk_bf16_f32 v162, v132, v133
  v_cvt_pk_bf16_f32 v163, v134, v135
  s_add_u32 s27, s26, 3072
  buffer_store_dwordx4 v[160:163], v2, s[8:11], s27 offen
  v_cvt_pk_bf16_f32 v164, v116, v117
  v_cvt_pk_bf16_f32 v165, v118, v119
  v_cvt_pk_bf16_f32 v166, v136, v137
  v_cvt_pk_bf16_f32 v167, v138, v139
  s_add_u32 s27, s26, 23552
  buffer_store_dwordx4 v[164:167], v2, s[8:11], s27 offen
  v_cvt_pk_bf16_f32 v160, v120, v121
  v_cvt_pk_bf16_f32 v161, v122, v123
  v_cvt_pk_bf16_f32 v162, v140, v141
  v_cvt_pk_bf16_f32 v163, v142, v143
  s_add_u32 s27, s26, 44032
  buffer_store_dwordx4 v[160:163], v2, s[8:11], s27 offen
  v_cvt_pk_bf16_f32 v164, v124, v125
  v_cvt_pk_bf16_f32 v165, v126, v127
  v_cvt_pk_bf16_f32 v166, v144, v145
  v_cvt_pk_bf16_f32 v167, v146, v147
  s_add_u32 s27, s26, 64512
  buffer_store_dwordx4 v[164:167], v2, s[8:11], s27 offen
  v_cvt_pk_bf16_f32 v160, v128, v129
  v_cvt_pk_bf16_f32 v161, v130, v131
  v_cvt_pk_bf16_f32 v162, v148, v149
  v_cvt_pk_bf16_f32 v163, v150, v151
  s_add_u32 s27, s26, 84992
  buffer_store_dwordx4 v[160:163], v2, s[8:11], s27 offen
  s_waitcnt vmcnt(5)
  v_mfma_f32_16x16x32_bf16 v[112:115], v[16:19], a[0:3], 0
  v_mfma_f32_16x16x32_bf16 v[116:119], v[16:19], a[4:7], 0
  v_mfma_f32_16x16x32_bf16 v[120:123], v[16:19], a[8:11], 0
  v_mfma_f32_16x16x32_bf16 v[124:127], v[16:19], a[12:15], 0
  v_mfma_f32_16x16x32_bf16 v[128:131], v[16:19], a[16:19], 0
  v_mfma_f32_16x16x32_bf16 v[132:135], v[40:43], a[0:3], 0
  v_mfma_f32_16x16x32_bf16 v[136:139], v[40:43], a[4:7], 0
  v_mfma_f32_16x16x32_bf16 v[140:143], v[40:43], a[8:11], 0
  v_mfma_f32_16x16x32_bf16 v[144:147], v[40:43], a[12:15], 0
  v_mfma_f32_16x16x32_bf16 v[148:151], v[40:43], a[16:19], 0
  v_mfma_f32_16x16x32_bf16 v[112:115], v[20:23], a[20:23], v[112:115]
  v_mfma_f32_16x16x32_bf16 v[116:119], v[20:23], a[24:27], v[116:119]
  v_mfma_f32_16x16x32_bf16 v[120:123], v[20:23], a[28:31], v[120:123]
  v_mfma_f32_16x16x32_bf16 v[124:127], v[20:23], a[32:35], v[124:127]
  v_mfma_f32_16x16x32_bf16 v[128:131], v[20:23], a[36:39], v[128:131]
  v_mfma_f32_16x16x32_bf16 v[132:135], v[44:47], a[20:23], v[132:135]
  v_mfma_f32_16x16x32_bf16 v[136:139], v[44:47], a[24:27], v[136:139]
  v_mfma_f32_16x16x32_bf16 v[140:143], v[44:47], a[28:31], v[140:143]
  v_mfma_f32_16x16x32_bf16 v[144:147], v[44:47], a[32:35], v[144:147]
  v_mfma_f32_16x16x32_bf16 v[148:151], v[44:47], a[36:39], v[148:151]
  v_mfma_f32_16x16x32_bf16 v[112:115], v[24:27], a[40:43], v[112:115]
  v_mfma_f32_16x16x32_bf16 v[116:119], v[24:27], a[44:47], v[116:119]
  v_mfma_f32_16x16x32_bf16 v[120:123], v[24:27], a[48:51], v[120:123]
  v_mfma_f32_16x16x32_bf16 v[124:127], v[24:27], a[52:55], v[124:127]
  v_mfma_f32_16x16x32_bf16 v[128:131], v[24:27], a[56:59], v[128:131]
  v_mfma_f32_16x16x32_bf16 v[132:135], v[48:51], a[40:43], v[132:135]
  v_mfma_f32_16x16x32_bf16 v[136:139], v[48:51], a[44:47], v[136:139]
  v_mfma_f32_16x16x32_bf16 v[140:143], v[48:51], a[48:51], v[140:143]
  v_mfma_f32_16x16x32_bf16 v[144:147], v[48:51], a[52:55], v[144:147]
  v_mfma_f32_16x16x32_bf16 v[148:151], v[48:51], a[56:59], v[148:151]
  v_mfma_f32_16x16x32_bf16 v[112:115], v[28:31], a[60:63], v[112:115]
  v_mfma_f32_16x16x32_bf16 v[116:119], v[28:31], a[64:67], v[116:119]
  v_mfma_f32_16x16x32_bf16 v[120:123], v[28:31], a[68:71], v[120:123]
  v_mfma_f32_16x16x32_bf16 v[124:127], v[28:31], a[72:75], v[124:127]
  v_mfma_f32_16x16x32_bf16 v[128:131], v[28:31], a[76:79], v[128:131]
  v_mfma_f32_16x16x32_bf16 v[132:135], v[52:55], a[60:63], v[132:135]
  v_mfma_f32_16x16x32_bf16 v[136:139], v[52:55], a[64:67], v[136:139]
  v_mfma_f32_16x16x32_bf16 v[140:143], v[52:55], a[68:71], v[140:143]
  v_mfma_f32_16x16x32_bf16 v[144:147], v[52:55], a[72:75], v[144:147]
  v_mfma_f32_16x16x32_bf16 v[148:151], v[52:55], a[76:79], v[148:151]
  v_mfma_f32_16x16x32_bf16 v[112:115], v[32:35], a[80:83], v[112:115]
  v_mfma_f32_16x16x32_bf16 v[116:119], v[32:35], a[84:87], v[116:119]
  v_mfma_f32_16x16x32_bf16 v[120:123], v[32:35], a[88:91], v[120:123]
  v_mfma_f32_16x16x32_bf16 v[124:127], v[32:35], a[92:95], v[124:127]
  v_mfma_f32_16x16x32_bf16 v[128:131], v[32:35], a[96:99], v[128:131]
  v_mfma_f32_16x16x32_bf16 v[132:135], v[56:59], a[80:83], v[132:135]
  v_mfma_f32_16x16x32_bf16 v[136:139], v[56:59], a[84:87], v[136:139]
  v_mfma_f32_16x16x32_bf16 v[140:143], v[56:59], a[88:91], v[140:143]
  v_mfma_f32_16x16x32_bf16 v[144:147], v[56:59], a[92:95], v[144:147]
  v_mfma_f32_16x16x32_bf16 v[148:151], v[56:59], a[96:99], v[148:151]
  v_mfma_f32_16x16x32_bf16 v[112:115], v[36:39], a[100:103], v[112:115]
  v_mfma_f32_16x16x32_bf16 v[116:119], v[36:39], a[104:107], v[116:119]
  v_mfma_f32_16x16x32_bf16 v[120:123], v[36:39], a[108:111], v[120:123]
  v_mfma_f32_16x16x32_bf16 v[124:127], v[36:39], a[112:115], v[124:127]
  v_mfma_f32_16x16x32_bf16 v[128:131], v[36:39], a[116:119], v[128:131]
  v_mfma_f32_16x16x32_bf16 v[132:135], v[60:63], a[100:103], v[132:135]
  v_mfma_f32_16x16x32_bf16 v[136:139], v[60:63], a[104:107], v[136:139]
  v_mfma_f32_16x16x32_bf16 v[140:143], v[60:63], a[108:111], v[140:143]
  v_mfma_f32_16x16x32_bf16 v[144:147], v[60:63], a[112:115], v[144:147]
  v_mfma_f32_16x16x32_bf16 v[148:151], v[60:63], a[116:119], v[148:151]
  s_nop 7
  v_cvt_pk_bf16_f32 v160, v112, v113
  v_cvt_pk_bf16_f32 v161, v114, v115
  v_cvt_pk_bf16_f32 v162, v132, v133
  v_cvt_pk_bf16_f32 v163, v134, v135
  s_add_u32 s27, s26, 4096
  buffer_store_dwordx4 v[160:163], v2, s[8:11], s27 offen
  v_cvt_pk_bf16_f32 v164, v116, v117
  v_cvt_pk_bf16_f32 v165, v118, v119
  v_cvt_pk_bf16_f32 v166, v136, v137
  v_cvt_pk_bf16_f32 v167, v138, v139
  s_add_u32 s27, s26, 24576
  buffer_store_dwordx4 v[164:167], v2, s[8:11], s27 offen
  v_cvt_pk_bf16_f32 v160, v120, v121
  v_cvt_pk_bf16_f32 v161, v122, v123
  v_cvt_pk_bf16_f32 v162, v140, v141
  v_cvt_pk_bf16_f32 v163, v142, v143
  s_add_u32 s27, s26, 45056
  buffer_store_dwordx4 v[160:163], v2, s[8:11], s27 offen
  v_cvt_pk_bf16_f32 v164, v124, v125
  v_cvt_pk_bf16_f32 v165, v126, v127
  v_cvt_pk_bf16_f32 v166, v144, v145
  v_cvt_pk_bf16_f32 v167, v146, v147
  s_add_u32 s27, s26, 65536
  buffer_store_dwordx4 v[164:167], v2, s[8:11], s27 offen
  v_cvt_pk_bf16_f32 v160, v128, v129
  v_cvt_pk_bf16_f32 v161, v130, v131
  v_cvt_pk_bf16_f32 v162, v148, v149
  v_cvt_pk_bf16_f32 v163, v150, v151
  s_add_u32 s27, s26, 86016
  buffer_store_dwordx4 v[160:163], v2, s[8:11], s27 offen
k0_exit:
  s_endpgm

.section .rodata,"a"
.p2align 6
.amdhsa_kernel prep_kernel
  .amdhsa_next_free_vgpr 512
  .amdhsa_next_free_sgpr 102
  .amdhsa_accum_offset 256
  .amdhsa_group_segment_fixed_size 0
  .amdhsa_kernarg_size 104
  .amdhsa_user_sgpr_count 2
  .amdhsa_user_sgpr_kernarg_segment_ptr 1
  .amdhsa_system_sgpr_workgroup_id_x 1
.end_amdhsa_kernel
.text
.globl ka1_kernel
.p2align 8
.type ka1_kernel,@function
ka1_kernel:
  s_mov_b32 s99, 0
  s_branch ka_body

.section .rodata,"a"
.p2align 6
.amdhsa_kernel ka1_kernel
  .amdhsa_next_free_vgpr 512
  .amdhsa_next_free_sgpr 102
  .amdhsa_accum_offset 256
  .amdhsa_group_segment_fixed_size 0
  .amdhsa_kernarg_size 104
  .amdhsa_user_sgpr_count 2
  .amdhsa_user_sgpr_kernarg_segment_ptr 1
  .amdhsa_system_sgpr_workgroup_id_x 1
.end_amdhsa_kernel
.text
.globl kb1_kernel
.p2align 8
.type kb1_kernel,@function
kb1_kernel:
  s_cmp_ge_u32 s2, 256
  s_cbranch_scc1 kb1_exit
  s_load_dwordx2 s[36:37], s[0:1], 0
  s_load_dwordx2 s[38:39], s[0:1], 80
  s_load_dwordx2 s[4:5], s[0:1], 96
  v_lshrrev_b32 v1, 6, v0
  s_nop 0
  v_readfirstlane_b32 s21, v1
  v_and_b32 v1, 63, v0
  v_lshlrev_b32 v2, 4, v1
  s_waitcnt lgkmcnt(0)
  s_mov_b32 s8, s4
  s_and_b32 s9, s5, 0xffff
  s_mov_b32 s10, 0x10000000
  s_mov_b32 s11, 0x20000
  s_mov_b32 s12, s36
  s_and_b32 s13, s37, 0xffff
  s_mov_b32 s14, 0x280000
  s_mov_b32 s15, 0x20000
  s_mov_b32 s16, s38
  s_and_b32 s17, s39, 0xffff
  s_mov_b32 s18, 0x280000
  s_mov_b32 s19, 0x20000
  s_and_b32 s22, s2, 7
  s_lshl_b32 s22, s22, 2
  s_bfe_u32 s23, s2, 0x20003
  s_add_u32 s22, s22, s23
  s_lshr_b32 s23, s2, 5
  s_lshl_b32 s46, s23, 7
  s_add_u32 s46, s46, 0x8000
  s_add_u32 s48, s46, 0x1400
  s_lshl_b32 s47, s22, 7
  s_add_u32 s47, s47, 0x8400
  s_lshr_b32 s26, s2, 2
  s_and_b32 s27, s2, 3
  s_lshl_b32 s27, s27, 3
  v_and_b32 v5, 7, v1
  v_bfe_u32 v6, v1, 3, 1
  v_lshrrev_b32 v7, 4, v1
  v_lshlrev_b32 v8, 5, v6
  v_add_u32 v8, v8, v5
  v_add_u32 v8, s27, v8
  v_lshlrev_b32 v8, 4, v8
  v_lshlrev_b32 v9, 11, v7
  v_add_u32 v9, v9, v8
  v_lshlrev_b32 v10, 10, v7
  v_add_u32 v10, v10, v8
  s_mul_i32 s28, s26, 81920
  s_lshl_b32 s29, s21, 13
  s_add_u32 s28, s28, s29
  s_cmp_lt_u32 s21, 2
  s_cselect_b32 s49, 3, 2
  v_mov_b32 v32, 0
  v_mov_b32 v33, 0
  v_mov_b32 v34, 0
  v_mov_b32 v35, 0
  v_mov_b32 v36, 0
  v_mov_b32 v37, 0
  v_mov_b32 v38, 0
  v_mov_b32 v39, 0
  v_mov_b32 v64, 0
  v_mov_b32 v65, 0
  v_mov_b32 v66, 0
  v_mov_b32 v67, 0
  v_mov_b32 v68, 0
  v_mov_b32 v69, 0
  v_mov_b32 v70, 0
  v_mov_b32 v71, 0
  v_mov_b32 v88, 0
  v_mov_b32 v89, 0
  v_mov_b32 v90, 0
  v_mov_b32 v91, 0
  v_mov_b32 v92, 0
  v_mov_b32 v93, 0
  v_mov_b32 v94, 0
  v_mov_b32 v95, 0
  v_mov_b32 v112, 0
  v_mov_b32 v113, 0
  v_mov_b32 v114, 0
  v_mov_b32 v115, 0
  v_mov_b32 v116, 0
  v_mov_b32 v117, 0
  v_mov_b32 v118, 0
  v_mov_b32 v119, 0
  v_mov_b32 v136, 0
  v_mov_b32 v137, 0
  v_mov_b32 v138, 0
  v_mov_b32 v139, 0
  v_mov_b32 v140, 0
  v_mov_b32 v141, 0
  v_mov_b32 v142, 0
  v_mov_b32 v143, 0
  s_add_u32 s30, s28, 27262976
  buffer_load_dwordx4 v[48:51], v9, s[8:11], s30 offen
  s_add_u32 s30, s28, 27264000
  buffer_load_dwordx4 v[52:55], v9, s[8:11], s30 offen
  s_add_u32 s30, s28, 32505856
  buffer_load_dwordx4 v[72:75], v9, s[8:11], s30 offen
  s_add_u32 s30, s28, 32506880
  buffer_load_dwordx4 v[76:79], v9, s[8:11], s30 offen
  s_add_u32 s30, s28, 37748736
  buffer_load_dwordx4 v[96:99], v9, s[8:11], s30 offen
  s_add_u32 s30, s28, 37749760
  buffer_load_dwordx4 v[100:103], v9, s[8:11], s30 offen
  s_add_u32 s30, s28, 42991616
  buffer_load_dwordx4 v[120:123], v9, s[8:11], s30 offen
  s_add_u32 s30, s28, 42992640
  buffer_load_dwordx4 v[124:127], v9, s[8:11], s30 offen
  s_add_u32 s30, s28, 27295744
  buffer_load_dwordx4 v[56:59], v9, s[8:11], s30 offen
  s_add_u32 s30, s28, 27296768
  buffer_load_dwordx4 v[60:63], v9, s[8:11], s30 offen
  s_add_u32 s30, s28, 32538624
  buffer_load_dwordx4 v[80:83], v9, s[8:11], s30 offen
  s_add_u32 s30, s28, 32539648
  buffer_load_dwordx4 v[84:87], v9, s[8:11], s30 offen
  s_add_u32 s30, s28, 37781504
  buffer_load_dwordx4 v[104:107], v9, s[8:11], s30 offen
  s_add_u32 s30, s28, 37782528
  buffer_load_dwordx4 v[108:111], v9, s[8:11], s30 offen
  s_add_u32 s30, s28, 43024384
  buffer_load_dwordx4 v[128:131], v9, s[8:11], s30 offen
  s_add_u32 s30, s28, 43025408
  buffer_load_dwordx4 v[132:135], v9, s[8:11], s30 offen
  s_cmp_lt_u32 s21, 2
  s_cbranch_scc0 g3_27
  s_add_u32 s30, s28, 27328512
  buffer_load_dwordx4 v[64:67], v9, s[8:11], s30 offen
  s_add_u32 s30, s28, 27329536
  buffer_load_dwordx4 v[68:71], v9, s[8:11], s30 offen
  s_add_u32 s30, s28, 32571392
  buffer_load_dwordx4 v[88:91], v9, s[8:11], s30 offen
  s_add_u32 s30, s28, 32572416
  buffer_load_dwordx4 v[92:95], v9, s[8:11], s30 offen
  s_add_u32 s30, s28, 37814272
  buffer_load_dwordx4 v[112:115], v9, s[8:11], s30 offen
  s_add_u32 s30, s28, 37815296
  buffer_load_dwordx4 v[116:119], v9, s[8:11], s30 offen
  s_add_u32 s30, s28, 43057152
  buffer_load_dwordx4 v[136:139], v9, s[8:11], s30 offen
  s_add_u32 s30, s28, 43058176
  buffer_load_dwordx4 v[140:143], v9, s[8:11], s30 offen
g3_27:
  s_lshl_b32 s30, s26, 5
  s_add_u32 s30, s30, s27
  v_add_u32 v11, s30, v5
  v_mul_u32_u24 v11, 1280, v11
  v_lshlrev_b32 v12, 5, v7
  v_add_u32 v11, v11, v12
  v_lshlrev_b32 v12, 4, v6
  v_add_u32 v11, v11, v12
  s_lshl_b32 s30, s21, 7
  buffer_load_dwordx4 v[144:147], v11, s[12:15], s30 offen offset:0
  buffer_load_dwordx4 v[148:151], v11, s[12:15], s30 offen offset:512
  s_cmp_lt_u32 s21, 2
  s_cbranch_scc0 g3_28
  buffer_load_dwordx4 v[152:155], v11, s[12:15], s30 offen offset:1024
g3_28:
  s_mul_i32 s30, s22, 122880
  s_mul_i32 s31, s21, 30720
  s_add_u32 s30, s30, s31
  s_add_u32 s30, s30, 0xe100000
  s_add_u32 m0, s31, 0
  s_add_u32 s29, s30, 0
  buffer_load_dwordx4 v2, s[8:11], s29 offen lds
  s_add_u32 m0, s31, 1024
  s_add_u32 s29, s30, 1024
  buffer_load_dwordx4 v2, s[8:11], s29 offen lds
  s_add_u32 m0, s31, 2048
  s_add_u32 s29, s30, 2048
  buffer_load_dwordx4 v2, s[8:11], s29 offen lds
  s_add_u32 m0, s31, 3072
  s_add_u32 s29, s30, 3072
  buffer_load_dwordx4 v2, s[8:11], s29 offen lds
  s_add_u32 m0, s31, 4096
  s_add_u32 s29, s30, 4096
  buffer_load_dwordx4 v2, s[8:11], s29 offen lds
  s_add_u32 m0, s31, 5120
  s_add_u32 s29, s30, 5120
  buffer_load_dwordx4 v2, s[8:11], s29 offen lds
  s_add_u32 m0, s31, 6144
  s_add_u32 s29, s30, 6144
  buffer_load_dwordx4 v2, s[8:11], s29 offen lds
  s_add_u32 m0, s31, 7168
  s_add_u32 s29, s30, 7168
  buffer_load_dwordx4 v2, s[8:11], s29 offen lds
  s_add_u32 m0, s31, 8192
  s_add_u32 s29, s30, 8192
  buffer_load_dwordx4 v2, s[8:11], s29 offen lds
  s_add_u32 m0, s31, 9216
  s_add_u32 s29, s30, 9216
  buffer_load_dwordx4 v2, s[8:11], s29 offen lds
  s_add_u32 m0, s31, 10240
  s_add_u32 s29, s30, 10240
  buffer_load_dwordx4 v2, s[8:11], s29 offen lds
  s_add_u32 m0, s31, 11264
  s_add_u32 s29, s30, 11264
  buffer_load_dwordx4 v2, s[8:11], s29 offen lds
  s_add_u32 m0, s31, 12288
  s_add_u32 s29, s30, 12288
  buffer_load_dwordx4 v2, s[8:11], s29 offen lds
  s_add_u32 m0, s31, 13312
  s_add_u32 s29, s30, 13312
  buffer_load_dwordx4 v2, s[8:11], s29 offen lds
  s_add_u32 m0, s31, 14336
  s_add_u32 s29, s30, 14336
  buffer_load_dwordx4 v2, s[8:11], s29 offen lds
  s_add_u32 m0, s31, 15360
  s_add_u32 s29, s30, 15360
  buffer_load_dwordx4 v2, s[8:11], s29 offen lds
  s_add_u32 m0, s31, 16384
  s_add_u32 s29, s30, 16384
  buffer_load_dwordx4 v2, s[8:11], s29 offen lds
  s_add_u32 m0, s31, 17408
  s_add_u32 s29, s30, 17408
  buffer_load_dwordx4 v2, s[8:11], s29 offen lds
  s_add_u32 m0, s31, 18432
  s_add_u32 s29, s30, 18432
  buffer_load_dwordx4 v2, s[8:11], s29 offen lds
  s_add_u32 m0, s31, 19456
  s_add_u32 s29, s30, 19456
  buffer_load_dwordx4 v2, s[8:11], s29 offen lds
  s_add_u32 m0, s31, 20480
  s_add_u32 s29, s30, 20480
  buffer_load_dwordx4 v2, s[8:11], s29 offen lds
  s_add_u32 m0, s31, 21504
  s_add_u32 s29, s30, 21504
  buffer_load_dwordx4 v2, s[8:11], s29 offen lds
  s_add_u32 m0, s31, 22528
  s_add_u32 s29, s30, 22528
  buffer_load_dwordx4 v2, s[8:11], s29 offen lds
  s_add_u32 m0, s31, 23552
  s_add_u32 s29, s30, 23552
  buffer_load_dwordx4 v2, s[8:11], s29 offen lds
  s_add_u32 m0, s31, 24576
  s_add_u32 s29, s30, 24576
  buffer_load_dwordx4 v2, s[8:11], s29 offen lds
  s_add_u32 m0, s31, 25600
  s_add_u32 s29, s30, 25600
  buffer_load_dwordx4 v2, s[8:11], s29 offen lds
  s_add_u32 m0, s31, 26624
  s_add_u32 s29, s30, 26624
  buffer_load_dwordx4 v2, s[8:11], s29 offen lds
  s_add_u32 m0, s31, 27648
  s_add_u32 s29, s30, 27648
  buffer_load_dwordx4 v2, s[8:11], s29 offen lds
  s_add_u32 m0, s31, 28672
  s_add_u32 s29, s30, 28672
  buffer_load_dwordx4 v2, s[8:11], s29 offen lds
  s_add_u32 m0, s31, 29696
  s_add_u32 s29, s30, 29696
  buffer_load_dwordx4 v2, s[8:11], s29 offen lds
  s_waitcnt vmcnt(30)
  v_lshlrev_b32 v16, 16, v144
  v_and_b32 v17, 0xffff0000, v144
  v_lshlrev_b32 v18, 16, v145
  v_and_b32 v19, 0xffff0000, v145
  v_lshlrev_b32 v20, 16, v146
  v_and_b32 v21, 0xffff0000, v146
  v_lshlrev_b32 v22, 16, v147
  v_and_b32 v23, 0xffff0000, v147
  v_lshlrev_b32 v24, 16, v148
  v_and_b32 v25, 0xffff0000, v148
  v_lshlrev_b32 v26, 16, v149
  v_and_b32 v27, 0xffff0000, v149
  v_lshlrev_b32 v28, 16, v150
  v_and_b32 v29, 0xffff0000, v150
  v_lshlrev_b32 v30, 16, v151
  v_and_b32 v31, 0xffff0000, v151
  s_cmp_lt_u32 s21, 2
  s_cbranch_scc0 g3_29
  v_lshlrev_b32 v32, 16, v152
  v_and_b32 v33, 0xffff0000, v152
  v_lshlrev_b32 v34, 16, v153
  v_and_b32 v35, 0xffff0000, v153
  v_lshlrev_b32 v36, 16, v154
  v_and_b32 v37, 0xffff0000, v154
  v_lshlrev_b32 v38, 16, v155
  v_and_b32 v39, 0xffff0000, v155
g3_29:
  v_add_f32 v48, v48, v72
  v_add_f32 v96, v96, v120
  v_add_f32 v49, v49, v73
  v_add_f32 v97, v97, v121
  v_add_f32 v50, v50, v74
  v_add_f32 v98, v98, v122
  v_add_f32 v51, v51, v75
  v_add_f32 v99, v99, v123
  v_add_f32 v52, v52, v76
  v_add_f32 v100, v100, v124
  v_add_f32 v53, v53, v77
  v_add_f32 v101, v101, v125
  v_add_f32 v54, v54, v78
  v_add_f32 v102, v102, v126
  v_add_f32 v55, v55, v79
  v_add_f32 v103, v103, v127
  v_add_f32 v56, v56, v80
  v_add_f32 v104, v104, v128
  v_add_f32 v57, v57, v81
  v_add_f32 v105, v105, v129
  v_add_f32 v58, v58, v82
  v_add_f32 v106, v106, v130
  v_add_f32 v59, v59, v83
  v_add_f32 v107, v107, v131
  v_add_f32 v60, v60, v84
  v_add_f32 v108, v108, v132
  v_add_f32 v61, v61, v85
  v_add_f32 v109, v109, v133
  v_add_f32 v62, v62, v86
  v_add_f32 v110, v110, v134
  v_add_f32 v63, v63, v87
  v_add_f32 v111, v111, v135
  v_add_f32 v64, v64, v88
  v_add_f32 v112, v112, v136
  v_add_f32 v65, v65, v89
  v_add_f32 v113, v113, v137
  v_add_f32 v66, v66, v90
  v_add_f32 v114, v114, v138
  v_add_f32 v67, v67, v91
  v_add_f32 v115, v115, v139
  v_add_f32 v68, v68, v92
  v_add_f32 v116, v116, v140
  v_add_f32 v69, v69, v93
  v_add_f32 v117, v117, v141
  v_add_f32 v70, v70, v94
  v_add_f32 v118, v118, v142
  v_add_f32 v71, v71, v95
  v_add_f32 v119, v119, v143
  v_add_f32 v48, v48, v96
  v_add_f32 v16, v16, v48
  v_add_f32 v49, v49, v97
  v_add_f32 v17, v17, v49
  v_add_f32 v50, v50, v98
  v_add_f32 v18, v18, v50
  v_add_f32 v51, v51, v99
  v_add_f32 v19, v19, v51
  v_add_f32 v52, v52, v100
  v_add_f32 v20, v20, v52
  v_add_f32 v53, v53, v101
  v_add_f32 v21, v21, v53
  v_add_f32 v54, v54, v102
  v_add_f32 v22, v22, v54
  v_add_f32 v55, v55, v103
  v_add_f32 v23, v23, v55
  v_add_f32 v56, v56, v104
  v_add_f32 v24, v24, v56
  v_add_f32 v57, v57, v105
  v_add_f32 v25, v25, v57
  v_add_f32 v58, v58, v106
  v_add_f32 v26, v26, v58
  v_add_f32 v59, v59, v107
  v_add_f32 v27, v27, v59
  v_add_f32 v60, v60, v108
  v_add_f32 v28, v28, v60
  v_add_f32 v61, v61, v109
  v_add_f32 v29, v29, v61
  v_add_f32 v62, v62, v110
  v_add_f32 v30, v30, v62
  v_add_f32 v63, v63, v111
  v_add_f32 v31, v31, v63
  v_add_f32 v64, v64, v112
  v_add_f32 v32, v32, v64
  v_add_f32 v65, v65, v113
  v_add_f32 v33, v33, v65
  v_add_f32 v66, v66, v114
  v_add_f32 v34, v34, v66
  v_add_f32 v67, v67, v115
  v_add_f32 v35, v35, v67
  v_add_f32 v68, v68, v116
  v_add_f32 v36, v36, v68
  v_add_f32 v69, v69, v117
  v_add_f32 v37, v37, v69
  v_add_f32 v70, v70, v118
  v_add_f32 v38, v38, v70
  v_add_f32 v71, v71, v119
  v_add_f32 v39, v39, v71
  s_add_u32 s30, s28, 20971520
  buffer_store_dwordx4 v[16:19], v9, s[8:11], s30 offen sc1
  s_add_u32 s30, s28, 20972544
  buffer_store_dwordx4 v[20:23], v9, s[8:11], s30 offen sc1
  s_add_u32 s30, s28, 21004288
  buffer_store_dwordx4 v[24:27], v9, s[8:11], s30 offen sc1
  s_add_u32 s30, s28, 21005312
  buffer_store_dwordx4 v[28:31], v9, s[8:11], s30 offen sc1
  s_cmp_lt_u32 s21, 2
  s_cbranch_scc0 g3_30
  s_add_u32 s30, s28, 21037056
  buffer_store_dwordx4 v[32:35], v9, s[8:11], s30 offen sc1
  s_add_u32 s30, s28, 21038080
  buffer_store_dwordx4 v[36:39], v9, s[8:11], s30 offen sc1
g3_30:
  v_add_f32 v12, v16, v17
  v_add_f32 v12, v12, v18
  v_add_f32 v12, v12, v19
  v_add_f32 v12, v12, v20
  v_add_f32 v12, v12, v21
  v_add_f32 v12, v12, v22
  v_add_f32 v12, v12, v23
  v_add_f32 v12, v12, v24
  v_add_f32 v12, v12, v25
  v_add_f32 v12, v12, v26
  v_add_f32 v12, v12, v27
  v_add_f32 v12, v12, v28
  v_add_f32 v12, v12, v29
  v_add_f32 v12, v12, v30
  v_add_f32 v12, v12, v31
  v_add_f32 v12, v12, v32
  v_add_f32 v12, v12, v33
  v_add_f32 v12, v12, v34
  v_add_f32 v12, v12, v35
  v_add_f32 v12, v12, v36
  v_add_f32 v12, v12, v37
  v_add_f32 v12, v12, v38
  v_add_f32 v12, v12, v39
  s_nop 1
  v_add_f32_dpp v12, v12, v12 row_ror:8 row_mask:0xf bank_mask:0xf
  v_mov_b32 v13, v12
  s_nop 1
  v_permlane16_swap_b32 v12, v13
  v_add_f32 v12, v12, v13
  v_mov_b32 v13, v12
  s_nop 1
  v_permlane32_swap_b32 v12, v13
  v_add_f32 v12, v12, v13
  v_lshlrev_b32 v14, 2, v5
  v_add_u32 v14, 131072, v14
  s_lshl_b32 s30, s21, 5
  v_add_u32 v15, s30, v14
  ds_write_b32 v15, v12
  s_waitcnt lgkmcnt(0)
  s_barrier
  ds_read_b32 v48, v14
  ds_read_b32 v49, v14 offset:32
  ds_read_b32 v50, v14 offset:64
  ds_read_b32 v51, v14 offset:96
  s_waitcnt lgkmcnt(0)
  v_add_f32 v48, v48, v49
  v_add_f32 v50, v50, v51
  v_add_f32 v48, v48, v50
  v_mul_f32 v48, 0x3acccccd, v48
  v_sub_f32 v56, v16, v48
  v_sub_f32 v57, v17, v48
  v_sub_f32 v58, v18, v48
  v_sub_f32 v59, v19, v48
  v_sub_f32 v60, v20, v48
  v_sub_f32 v61, v21, v48
  v_sub_f32 v62, v22, v48
  v_sub_f32 v63, v23, v48
  v_sub_f32 v64, v24, v48
  v_sub_f32 v65, v25, v48
  v_sub_f32 v66, v26, v48
  v_sub_f32 v67, v27, v48
  v_sub_f32 v68, v28, v48
  v_sub_f32 v69, v29, v48
  v_sub_f32 v70, v30, v48
  v_sub_f32 v71, v31, v48
  v_sub_f32 v72, v32, v48
  v_sub_f32 v73, v33, v48
  v_sub_f32 v74, v34, v48
  v_sub_f32 v75, v35, v48
  v_sub_f32 v76, v36, v48
  v_sub_f32 v77, v37, v48
  v_sub_f32 v78, v38, v48
  v_sub_f32 v79, v39, v48
  s_cmp_lt_u32 s21, 2
  s_cbranch_scc1 g3z_31
  v_mov_b32 v72, 0
  v_mov_b32 v73, 0
  v_mov_b32 v74, 0
  v_mov_b32 v75, 0
  v_mov_b32 v76, 0
  v_mov_b32 v77, 0
  v_mov_b32 v78, 0
  v_mov_b32 v79, 0
g3z_31:
  v_mul_f32 v12, v56, v56
  v_fmac_f32 v12, v57, v57
  v_fmac_f32 v12, v58, v58
  v_fmac_f32 v12, v59, v59
  v_fmac_f32 v12, v60, v60
  v_fmac_f32 v12, v61, v61
  v_fmac_f32 v12, v62, v62
  v_fmac_f32 v12, v63, v63
  v_fmac_f32 v12, v64, v64
  v_fmac_f32 v12, v65, v65
  v_fmac_f32 v12, v66, v66
  v_fmac_f32 v12, v67, v67
  v_fmac_f32 v12, v68, v68
  v_fmac_f32 v12, v69, v69
  v_fmac_f32 v12, v70, v70
  v_fmac_f32 v12, v71, v71
  v_fmac_f32 v12, v72, v72
  v_fmac_f32 v12, v73, v73
  v_fmac_f32 v12, v74, v74
  v_fmac_f32 v12, v75, v75
  v_fmac_f32 v12, v76, v76
  v_fmac_f32 v12, v77, v77
  v_fmac_f32 v12, v78, v78
  v_fmac_f32 v12, v79, v79
  s_nop 1
  v_add_f32_dpp v12, v12, v12 row_ror:8 row_mask:0xf bank_mask:0xf
  v_mov_b32 v13, v12
  s_nop 1
  v_permlane16_swap_b32 v12, v13
  v_add_f32 v12, v12, v13
  v_mov_b32 v13, v12
  s_nop 1
  v_permlane32_swap_b32 v12, v13
  v_add_f32 v12, v12, v13
  v_lshlrev_b32 v14, 2, v5
  v_add_u32 v14, 131328, v14
  s_lshl_b32 s30, s21, 5
  v_add_u32 v15, s30, v14
  ds_write_b32 v15, v12
  s_waitcnt lgkmcnt(0)
  s_barrier
  ds_read_b32 v48, v14
  ds_read_b32 v49, v14 offset:32
  ds_read_b32 v50, v14 offset:64
  ds_read_b32 v51, v14 offset:96
  s_waitcnt lgkmcnt(0)
  v_add_f32 v48, v48, v49
  v_add_f32 v50, v50, v51
  v_add_f32 v48, v48, v50
  v_mov_b32 v49, 0x3727c5ac
  v_fmac_f32 v49, 0x3acccccd, v48
  v_rsq_f32 v49, v49
  s_nop 0
  v_mul_f32 v56, v56, v49
  v_mul_f32 v57, v57, v49
  v_mul_f32 v58, v58, v49
  v_mul_f32 v59, v59, v49
  v_mul_f32 v60, v60, v49
  v_mul_f32 v61, v61, v49
  v_mul_f32 v62, v62, v49
  v_mul_f32 v63, v63, v49
  v_mul_f32 v64, v64, v49
  v_mul_f32 v65, v65, v49
  v_mul_f32 v66, v66, v49
  v_mul_f32 v67, v67, v49
  v_mul_f32 v68, v68, v49
  v_mul_f32 v69, v69, v49
  v_mul_f32 v70, v70, v49
  v_mul_f32 v71, v71, v49
  v_mul_f32 v72, v72, v49
  v_mul_f32 v73, v73, v49
  v_mul_f32 v74, v74, v49
  v_mul_f32 v75, v75, v49
  v_mul_f32 v76, v76, v49
  v_mul_f32 v77, v77, v49
  v_mul_f32 v78, v78, v49
  v_mul_f32 v79, v79, v49
  v_cvt_pk_bf16_f32 v80, v56, v57
  v_cvt_pk_bf16_f32 v81, v58, v59
  v_cvt_pk_bf16_f32 v82, v60, v61
  v_cvt_pk_bf16_f32 v83, v62, v63
  v_cvt_pk_bf16_f32 v84, v64, v65
  v_cvt_pk_bf16_f32 v85, v66, v67
  v_cvt_pk_bf16_f32 v86, v68, v69
  v_cvt_pk_bf16_f32 v87, v70, v71
  v_cvt_pk_bf16_f32 v88, v72, v73
  v_cvt_pk_bf16_f32 v89, v74, v75
  v_cvt_pk_bf16_f32 v90, v76, v77
  v_cvt_pk_bf16_f32 v91, v78, v79
  s_mul_i32 s30, s26, 40960
  s_lshl_b32 s31, s21, 12
  s_add_u32 s30, s30, s31
  s_add_u32 s30, s30, 0x100000
  s_add_u32 s31, s30, 0
  buffer_store_dwordx4 v[80:83], v10, s[8:11], s31 offen sc1
  s_add_u32 s31, s30, 16384
  buffer_store_dwordx4 v[84:87], v10, s[8:11], s31 offen sc1
  s_cmp_lt_u32 s21, 2
  s_cbranch_scc0 g3_32
  s_add_u32 s31, s30, 32768
  buffer_store_dwordx4 v[88:91], v10, s[8:11], s31 offen sc1
g3_32:
  s_waitcnt vmcnt(0)
  s_barrier
  s_cmp_eq_u32 s21, 0
  s_cbranch_scc0 arr_33
  s_mov_b64 s[24:25], exec
  s_mov_b64 exec, 1
  v_mov_b32 v3, 0
  v_mov_b32 v4, 1
  buffer_atomic_add v4, v3, s[8:11], s46 offen
  s_mov_b64 exec, s[24:25]
arr_33:
  s_mov_b32 s45, 0
  v_mov_b32 v3, 0
aw_34:
  buffer_load_dword v4, v3, s[8:11], s46 offen sc1
  s_add_u32 s45, s45, 1
  s_waitcnt vmcnt(0)
  v_readfirstlane_b32 s29, v4
  s_cmp_ge_u32 s29, 32
  s_cbranch_scc1 aw_34_ok
  s_cmp_lt_u32 s45, 400000
  s_cbranch_scc1 aw_34
  s_branch kb1_abort
aw_34_ok:
  s_barrier
  s_lshl_b32 s26, s23, 3
  s_lshl_b32 s27, s21, 1
  s_add_u32 s24, s26, s27
  s_mul_i32 s27, s24, 40960
  s_add_u32 s27, s27, 0x100000
  s_add_u32 s28, s27, 40960
  v_mov_b32 v3, v2
  v_add_u32 v4, 65536, v2
  v_lshlrev_b32 v5, 7, v1
  s_add_u32 s29, s27, 0
  buffer_load_dword v6, v5, s[8:11], s29 offen sc1
  s_add_u32 s29, s27, 8192
  buffer_load_dword v6, v5, s[8:11], s29 offen sc1
  s_add_u32 s29, s27, 16384
  buffer_load_dword v6, v5, s[8:11], s29 offen sc1
  s_add_u32 s29, s27, 24576
  buffer_load_dword v6, v5, s[8:11], s29 offen sc1
  s_add_u32 s29, s27, 32768
  buffer_load_dword v6, v5, s[8:11], s29 offen sc1
  s_add_u32 s29, s27, 40960
  buffer_load_dword v6, v5, s[8:11], s29 offen sc1
  s_add_u32 s29, s27, 49152
  buffer_load_dword v6, v5, s[8:11], s29 offen sc1
  s_add_u32 s29, s27, 57344
  buffer_load_dword v6, v5, s[8:11], s29 offen sc1
  s_add_u32 s29, s27, 65536
  buffer_load_dword v6, v5, s[8:11], s29 offen sc1
  s_add_u32 s29, s27, 73728
  buffer_load_dword v6, v5, s[8:11], s29 offen sc1
  s_add_u32 s29, s27, 0
  buffer_load_dwordx4 v[16:19], v2, s[8:11], s29 offen sc1
  s_add_u32 s29, s28, 0
  buffer_load_dwordx4 v[20:23], v2, s[8:11], s29 offen sc1
  s_add_u32 s29, s27, 1024
  buffer_load_dwordx4 v[24:27], v2, s[8:11], s29 offen sc1
  s_add_u32 s29, s28, 1024
  buffer_load_dwordx4 v[28:31], v2, s[8:11], s29 offen sc1
  s_add_u32 s29, s27, 2048
  buffer_load_dwordx4 v[32:35], v2, s[8:11], s29 offen sc1
  s_add_u32 s29, s28, 2048
  buffer_load_dwordx4 v[36:39], v2, s[8:11], s29 offen sc1
  s_add_u32 s29, s27, 3072
  buffer_load_dwordx4 v[40:43], v2, s[8:11], s29 offen sc1
  s_add_u32 s29, s28, 3072
  buffer_load_dwordx4 v[44:47], v2, s[8:11], s29 offen sc1
  s_add_u32 s29, s27, 4096
  buffer_load_dwordx4 v[48:51], v2, s[8:11], s29 offen sc1
  s_add_u32 s29, s28, 4096
  buffer_load_dwordx4 v[52:55], v2, s[8:11], s29 offen sc1
  s_add_u32 s29, s27, 5120
  buffer_load_dwordx4 v[56:59], v2, s[8:11], s29 offen sc1
  s_add_u32 s29, s28, 5120
  buffer_load_dwordx4 v[60:63], v2, s[8:11], s29 offen sc1
  s_add_u32 s29, s27, 6144
  buffer_load_dwordx4 v[64:67], v2, s[8:11], s29 offen sc1
  s_add_u32 s29, s28, 6144
  buffer_load_dwordx4 v[68:71], v2, s[8:11], s29 offen sc1
  ds_read_b128 v[208:211], v3 offset:0
  ds_read_b128 v[212:215], v3 offset:40960
  ds_read_b128 v[216:219], v4 offset:16384
  s_add_u32 s29, s27, 7168
  buffer_load_dwordx4 v[72:75], v2, s[8:11], s29 offen sc1
  s_add_u32 s29, s28, 7168
  buffer_load_dwordx4 v[76:79], v2, s[8:11], s29 offen sc1
  ds_read_b128 v[220:223], v3 offset:1024
  ds_read_b128 v[224:227], v3 offset:41984
  ds_read_b128 v[228:231], v4 offset:17408
  s_waitcnt lgkmcnt(3)
  s_waitcnt vmcnt(14)
  v_mfma_f32_32x32x16_bf16 v[80:95], v[208:211], v[16:19], 0
  v_mfma_f32_32x32x16_bf16 v[96:111], v[212:215], v[16:19], 0
  v_mfma_f32_32x32x16_bf16 v[112:127], v[16:19], v[216:219], 0
  v_mfma_f32_32x32x16_bf16 v[128:143], v[208:211], v[20:23], 0
  v_mfma_f32_32x32x16_bf16 v[144:159], v[212:215], v[20:23], 0
  v_mfma_f32_32x32x16_bf16 v[160:175], v[20:23], v[216:219], 0
  s_add_u32 s29, s27, 8192
  buffer_load_dwordx4 v[16:19], v2, s[8:11], s29 offen sc1
  s_add_u32 s29, s28, 8192
  buffer_load_dwordx4 v[20:23], v2, s[8:11], s29 offen sc1
  ds_read_b128 v[208:211], v3 offset:2048
  ds_read_b128 v[212:215], v3 offset:43008
  ds_read_b128 v[216:219], v4 offset:18432
  s_waitcnt lgkmcnt(3)
  s_waitcnt vmcnt(14)
  v_mfma_f32_32x32x16_bf16 v[80:95], v[220:223], v[24:27], v[80:95]
  v_mfma_f32_32x32x16_bf16 v[96:111], v[224:227], v[24:27], v[96:111]
  v_mfma_f32_32x32x16_bf16 v[112:127], v[24:27], v[228:231], v[112:127]
  v_mfma_f32_32x32x16_bf16 v[128:143], v[220:223], v[28:31], v[128:143]
  v_mfma_f32_32x32x16_bf16 v[144:159], v[224:227], v[28:31], v[144:159]
  v_mfma_f32_32x32x16_bf16 v[160:175], v[28:31], v[228:231], v[160:175]
  s_add_u32 s29, s27, 9216
  buffer_load_dwordx4 v[24:27], v2, s[8:11], s29 offen sc1
  s_add_u32 s29, s28, 9216
  buffer_load_dwordx4 v[28:31], v2, s[8:11], s29 offen sc1
  ds_read_b128 v[220:223], v3 offset:3072
  ds_read_b128 v[224:227], v3 offset:44032
  ds_read_b128 v[228:231], v4 offset:19456
  s_waitcnt lgkmcnt(3)
  s_waitcnt vmcnt(14)
  v_mfma_f32_32x32x16_bf16 v[80:95], v[208:211], v[32:35], v[80:95]
  v_mfma_f32_32x32x16_bf16 v[96:111], v[212:215], v[32:35], v[96:111]
  v_mfma_f32_32x32x16_bf16 v[112:127], v[32:35], v[216:219], v[112:127]
  v_mfma_f32_32x32x16_bf16 v[128:143], v[208:211], v[36:39], v[128:143]
  v_mfma_f32_32x32x16_bf16 v[144:159], v[212:215], v[36:39], v[144:159]
  v_mfma_f32_32x32x16_bf16 v[160:175], v[36:39], v[216:219], v[160:175]
  s_add_u32 s29, s27, 10240
  buffer_load_dwordx4 v[32:35], v2, s[8:11], s29 offen sc1
  s_add_u32 s29, s28, 10240
  buffer_load_dwordx4 v[36:39], v2, s[8:11], s29 offen sc1
  ds_read_b128 v[208:211], v3 offset:4096
  ds_read_b128 v[212:215], v3 offset:45056
  ds_read_b128 v[216:219], v4 offset:20480
  s_waitcnt lgkmcnt(3)
  s_waitcnt vmcnt(14)
  v_mfma_f32_32x32x16_bf16 v[80:95], v[220:223], v[40:43], v[80:95]
  v_mfma_f32_32x32x16_bf16 v[96:111], v[224:227], v[40:43], v[96:111]
  v_mfma_f32_32x32x16_bf16 v[112:127], v[40:43], v[228:231], v[112:127]
  v_mfma_f32_32x32x16_bf16 v[128:143], v[220:223], v[44:47], v[128:143]
  v_mfma_f32_32x32x16_bf16 v[144:159], v[224:227], v[44:47], v[144:159]
  v_mfma_f32_32x32x16_bf16 v[160:175], v[44:47], v[228:231], v[160:175]
  s_add_u32 s29, s27, 11264
  buffer_load_dwordx4 v[40:43], v2, s[8:11], s29 offen sc1
  s_add_u32 s29, s28, 11264
  buffer_load_dwordx4 v[44:47], v2, s[8:11], s29 offen sc1
  ds_read_b128 v[220:223], v3 offset:5120
  ds_read_b128 v[224:227], v3 offset:46080
  ds_read_b128 v[228:231], v4 offset:21504
  s_waitcnt lgkmcnt(3)
  s_waitcnt vmcnt(14)
  v_mfma_f32_32x32x16_bf16 v[80:95], v[208:211], v[48:51], v[80:95]
  v_mfma_f32_32x32x16_bf16 v[96:111], v[212:215], v[48:51], v[96:111]
  v_mfma_f32_32x32x16_bf16 v[112:127], v[48:51], v[216:219], v[112:127]
  v_mfma_f32_32x32x16_bf16 v[128:143], v[208:211], v[52:55], v[128:143]
  v_mfma_f32_32x32x16_bf16 v[144:159], v[212:215], v[52:55], v[144:159]
  v_mfma_f32_32x32x16_bf16 v[160:175], v[52:55], v[216:219], v[160:175]
  s_add_u32 s29, s27, 12288
  buffer_load_dwordx4 v[48:51], v2, s[8:11], s29 offen sc1
  s_add_u32 s29, s28, 12288
  buffer_load_dwordx4 v[52:55], v2, s[8:11], s29 offen sc1
  ds_read_b128 v[208:211], v3 offset:6144
  ds_read_b128 v[212:215], v3 offset:47104
  ds_read_b128 v[216:219], v4 offset:22528
  s_waitcnt lgkmcnt(3)
  s_waitcnt vmcnt(14)
  v_mfma_f32_32x32x16_bf16 v[80:95], v[220:223], v[56:59], v[80:95]
  v_mfma_f32_32x32x16_bf16 v[96:111], v[224:227], v[56:59], v[96:111]
  v_mfma_f32_32x32x16_bf16 v[112:127], v[56:59], v[228:231], v[112:127]
  v_mfma_f32_32x32x16_bf16 v[128:143], v[220:223], v[60:63], v[128:143]
  v_mfma_f32_32x32x16_bf16 v[144:159], v[224:227], v[60:63], v[144:159]
  v_mfma_f32_32x32x16_bf16 v[160:175], v[60:63], v[228:231], v[160:175]
  s_add_u32 s29, s27, 13312
  buffer_load_dwordx4 v[56:59], v2, s[8:11], s29 offen sc1
  s_add_u32 s29, s28, 13312
  buffer_load_dwordx4 v[60:63], v2, s[8:11], s29 offen sc1
  ds_read_b128 v[220:223], v3 offset:7168
  ds_read_b128 v[224:227], v3 offset:48128
  ds_read_b128 v[228:231], v4 offset:23552
  s_waitcnt lgkmcnt(3)
  s_waitcnt vmcnt(14)
  v_mfma_f32_32x32x16_bf16 v[80:95], v[208:211], v[64:67], v[80:95]
  v_mfma_f32_32x32x16_bf16 v[96:111], v[212:215], v[64:67], v[96:111]
  v_mfma_f32_32x32x16_bf16 v[112:127], v[64:67], v[216:219], v[112:127]
  v_mfma_f32_32x32x16_bf16 v[128:143], v[208:211], v[68:71], v[128:143]
  v_mfma_f32_32x32x16_bf16 v[144:159], v[212:215], v[68:71], v[144:159]
  v_mfma_f32_32x32x16_bf16 v[160:175], v[68:71], v[216:219], v[160:175]
  s_add_u32 s29, s27, 14336
  buffer_load_dwordx4 v[64:67], v2, s[8:11], s29 offen sc1
  s_add_u32 s29, s28, 14336
  buffer_load_dwordx4 v[68:71], v2, s[8:11], s29 offen sc1
  ds_read_b128 v[208:211], v3 offset:8192
  ds_read_b128 v[212:215], v3 offset:49152
  ds_read_b128 v[216:219], v4 offset:24576
  s_waitcnt lgkmcnt(3)
  s_waitcnt vmcnt(14)
  v_mfma_f32_32x32x16_bf16 v[80:95], v[220:223], v[72:75], v[80:95]
  v_mfma_f32_32x32x16_bf16 v[96:111], v[224:227], v[72:75], v[96:111]
  v_mfma_f32_32x32x16_bf16 v[112:127], v[72:75], v[228:231], v[112:127]
  v_mfma_f32_32x32x16_bf16 v[128:143], v[220:223], v[76:79], v[128:143]
  v_mfma_f32_32x32x16_bf16 v[144:159], v[224:227], v[76:79], v[144:159]
  v_mfma_f32_32x32x16_bf16 v[160:175], v[76:79], v[228:231], v[160:175]
  s_add_u32 s29, s27, 15360
  buffer_load_dwordx4 v[72:75], v2, s[8:11], s29 offen sc1
  s_add_u32 s29, s28, 15360
  buffer_load_dwordx4 v[76:79], v2, s[8:11], s29 offen sc1
  ds_read_b128 v[220:223], v3 offset:9216
  ds_read_b128 v[224:227], v3 offset:50176
  ds_read_b128 v[228:231], v4 offset:25600
  s_waitcnt lgkmcnt(3)
  s_waitcnt vmcnt(14)
  v_mfma_f32_32x32x16_bf16 v[80:95], v[208:211], v[16:19], v[80:95]
  v_mfma_f32_32x32x16_bf16 v[96:111], v[212:215], v[16:19], v[96:111]
  v_mfma_f32_32x32x16_bf16 v[112:127], v[16:19], v[216:219], v[112:127]
  v_mfma_f32_32x32x16_bf16 v[128:143], v[208:211], v[20:23], v[128:143]
  v_mfma_f32_32x32x16_bf16 v[144:159], v[212:215], v[20:23], v[144:159]
  v_mfma_f32_32x32x16_bf16 v[160:175], v[20:23], v[216:219], v[160:175]
  s_add_u32 s29, s27, 16384
  buffer_load_dwordx4 v[16:19], v2, s[8:11], s29 offen sc1
  s_add_u32 s29, s28, 16384
  buffer_load_dwordx4 v[20:23], v2, s[8:11], s29 offen sc1
  ds_read_b128 v[208:211], v3 offset:10240
  ds_read_b128 v[212:215], v3 offset:51200
  ds_read_b128 v[216:219], v4 offset:26624
  s_waitcnt lgkmcnt(3)
  s_waitcnt vmcnt(14)
  v_mfma_f32_32x32x16_bf16 v[80:95], v[220:223], v[24:27], v[80:95]
  v_mfma_f32_32x32x16_bf16 v[96:111], v[224:227], v[24:27], v[96:111]
  v_mfma_f32_32x32x16_bf16 v[112:127], v[24:27], v[228:231], v[112:127]
  v_mfma_f32_32x32x16_bf16 v[128:143], v[220:223], v[28:31], v[128:143]
  v_mfma_f32_32x32x16_bf16 v[144:159], v[224:227], v[28:31], v[144:159]
  v_mfma_f32_32x32x16_bf16 v[160:175], v[28:31], v[228:231], v[160:175]
  s_add_u32 s29, s27, 17408
  buffer_load_dwordx4 v[24:27], v2, s[8:11], s29 offen sc1
  s_add_u32 s29, s28, 17408
  buffer_load_dwordx4 v[28:31], v2, s[8:11], s29 offen sc1
  ds_read_b128 v[220:223], v3 offset:11264
  ds_read_b128 v[224:227], v3 offset:52224
  ds_read_b128 v[228:231], v4 offset:27648
  s_waitcnt lgkmcnt(3)
  s_waitcnt vmcnt(14)
  v_mfma_f32_32x32x16_bf16 v[80:95], v[208:211], v[32:35], v[80:95]
  v_mfma_f32_32x32x16_bf16 v[96:111], v[212:215], v[32:35], v[96:111]
  v_mfma_f32_32x32x16_bf16 v[112:127], v[32:35], v[216:219], v[112:127]
  v_mfma_f32_32x32x16_bf16 v[128:143], v[208:211], v[36:39], v[128:143]
  v_mfma_f32_32x32x16_bf16 v[144:159], v[212:215], v[36:39], v[144:159]
  v_mfma_f32_32x32x16_bf16 v[160:175], v[36:39], v[216:219], v[160:175]
  s_add_u32 s29, s27, 18432
  buffer_load_dwordx4 v[32:35], v2, s[8:11], s29 offen sc1
  s_add_u32 s29, s28, 18432
  buffer_load_dwordx4 v[36:39], v2, s[8:11], s29 offen sc1
  ds_read_b128 v[208:211], v3 offset:12288
  ds_read_b128 v[212:215], v3 offset:53248
  ds_read_b128 v[216:219], v4 offset:28672
  s_waitcnt lgkmcnt(3)
  s_waitcnt vmcnt(14)
  v_mfma_f32_32x32x16_bf16 v[80:95], v[220:223], v[40:43], v[80:95]
  v_mfma_f32_32x32x16_bf16 v[96:111], v[224:227], v[40:43], v[96:111]
  v_mfma_f32_32x32x16_bf16 v[112:127], v[40:43], v[228:231], v[112:127]
  v_mfma_f32_32x32x16_bf16 v[128:143], v[220:223], v[44:47], v[128:143]
  v_mfma_f32_32x32x16_bf16 v[144:159], v[224:227], v[44:47], v[144:159]
  v_mfma_f32_32x32x16_bf16 v[160:175], v[44:47], v[228:231], v[160:175]
  s_add_u32 s29, s27, 19456
  buffer_load_dwordx4 v[40:43], v2, s[8:11], s29 offen sc1
  s_add_u32 s29, s28, 19456
  buffer_load_dwordx4 v[44:47], v2, s[8:11], s29 offen sc1
  ds_read_b128 v[220:223], v3 offset:13312
  ds_read_b128 v[224:227], v3 offset:54272
  ds_read_b128 v[228:231], v4 offset:29696
  s_waitcnt lgkmcnt(3)
  s_waitcnt vmcnt(14)
  v_mfma_f32_32x32x16_bf16 v[80:95], v[208:211], v[48:51], v[80:95]
  v_mfma_f32_32x32x16_bf16 v[96:111], v[212:215], v[48:51], v[96:111]
  v_mfma_f32_32x32x16_bf16 v[112:127], v[48:51], v[216:219], v[112:127]
  v_mfma_f32_32x32x16_bf16 v[128:143], v[208:211], v[52:55], v[128:143]
  v_mfma_f32_32x32x16_bf16 v[144:159], v[212:215], v[52:55], v[144:159]
  v_mfma_f32_32x32x16_bf16 v[160:175], v[52:55], v[216:219], v[160:175]
  s_add_u32 s29, s27, 20480
  buffer_load_dwordx4 v[48:51], v2, s[8:11], s29 offen sc1
  s_add_u32 s29, s28, 20480
  buffer_load_dwordx4 v[52:55], v2, s[8:11], s29 offen sc1
  ds_read_b128 v[208:211], v3 offset:14336
  ds_read_b128 v[212:215], v3 offset:55296
  ds_read_b128 v[216:219], v4 offset:30720
  s_waitcnt lgkmcnt(3)
  s_waitcnt vmcnt(14)
  v_mfma_f32_32x32x16_bf16 v[80:95], v[220:223], v[56:59], v[80:95]
  v_mfma_f32_32x32x16_bf16 v[96:111], v[224:227], v[56:59], v[96:111]
  v_mfma_f32_32x32x16_bf16 v[112:127], v[56:59], v[228:231], v[112:127]
  v_mfma_f32_32x32x16_bf16 v[128:143], v[220:223], v[60:63], v[128:143]
  v_mfma_f32_32x32x16_bf16 v[144:159], v[224:227], v[60:63], v[144:159]
  v_mfma_f32_32x32x16_bf16 v[160:175], v[60:63], v[228:231], v[160:175]
  s_add_u32 s29, s27, 21504
  buffer_load_dwordx4 v[56:59], v2, s[8:11], s29 offen sc1
  s_add_u32 s29, s28, 21504
  buffer_load_dwordx4 v[60:63], v2, s[8:11], s29 offen sc1
  ds_read_b128 v[220:223], v3 offset:15360
  ds_read_b128 v[224:227], v3 offset:56320
  ds_read_b128 v[228:231], v4 offset:31744
  s_waitcnt lgkmcnt(3)
  s_waitcnt vmcnt(14)
  v_mfma_f32_32x32x16_bf16 v[80:95], v[208:211], v[64:67], v[80:95]
  v_mfma_f32_32x32x16_bf16 v[96:111], v[212:215], v[64:67], v[96:111]
  v_mfma_f32_32x32x16_bf16 v[112:127], v[64:67], v[216:219], v[112:127]
  v_mfma_f32_32x32x16_bf16 v[128:143], v[208:211], v[68:71], v[128:143]
  v_mfma_f32_32x32x16_bf16 v[144:159], v[212:215], v[68:71], v[144:159]
  v_mfma_f32_32x32x16_bf16 v[160:175], v[68:71], v[216:219], v[160:175]
  s_add_u32 s29, s27, 22528
  buffer_load_dwordx4 v[64:67], v2, s[8:11], s29 offen sc1
  s_add_u32 s29, s28, 22528
  buffer_load_dwordx4 v[68:71], v2, s[8:11], s29 offen sc1
  ds_read_b128 v[208:211], v3 offset:16384
  ds_read_b128 v[212:215], v3 offset:57344
  ds_read_b128 v[216:219], v4 offset:32768
  s_waitcnt lgkmcnt(3)
  s_waitcnt vmcnt(14)
  v_mfma_f32_32x32x16_bf16 v[80:95], v[220:223], v[72:75], v[80:95]
  v_mfma_f32_32x32x16_bf16 v[96:111], v[224:227], v[72:75], v[96:111]
  v_mfma_f32_32x32x16_bf16 v[112:127], v[72:75], v[228:231], v[112:127]
  v_mfma_f32_32x32x16_bf16 v[128:143], v[220:223], v[76:79], v[128:143]
  v_mfma_f32_32x32x16_bf16 v[144:159], v[224:227], v[76:79], v[144:159]
  v_mfma_f32_32x32x16_bf16 v[160:175], v[76:79], v[228:231], v[160:175]
  s_add_u32 s29, s27, 23552
  buffer_load_dwordx4 v[72:75], v2, s[8:11], s29 offen sc1
  s_add_u32 s29, s28, 23552
  buffer_load_dwordx4 v[76:79], v2, s[8:11], s29 offen sc1
  ds_read_b128 v[220:223], v3 offset:17408
  ds_read_b128 v[224:227], v3 offset:58368
  ds_read_b128 v[228:231], v4 offset:33792
  s_waitcnt lgkmcnt(3)
  s_waitcnt vmcnt(14)
  v_mfma_f32_32x32x16_bf16 v[80:95], v[208:211], v[16:19], v[80:95]
  v_mfma_f32_32x32x16_bf16 v[96:111], v[212:215], v[16:19], v[96:111]
  v_mfma_f32_32x32x16_bf16 v[112:127], v[16:19], v[216:219], v[112:127]
  v_mfma_f32_32x32x16_bf16 v[128:143], v[208:211], v[20:23], v[128:143]
  v_mfma_f32_32x32x16_bf16 v[144:159], v[212:215], v[20:23], v[144:159]
  v_mfma_f32_32x32x16_bf16 v[160:175], v[20:23], v[216:219], v[160:175]
  s_add_u32 s29, s27, 24576
  buffer_load_dwordx4 v[16:19], v2, s[8:11], s29 offen sc1
  s_add_u32 s29, s28, 24576
  buffer_load_dwordx4 v[20:23], v2, s[8:11], s29 offen sc1
  ds_read_b128 v[208:211], v3 offset:18432
  ds_read_b128 v[212:215], v3 offset:59392
  ds_read_b128 v[216:219], v4 offset:34816
  s_waitcnt lgkmcnt(3)
  s_waitcnt vmcnt(14)
  v_mfma_f32_32x32x16_bf16 v[80:95], v[220:223], v[24:27], v[80:95]
  v_mfma_f32_32x32x16_bf16 v[96:111], v[224:227], v[24:27], v[96:111]
  v_mfma_f32_32x32x16_bf16 v[112:127], v[24:27], v[228:231], v[112:127]
  v_mfma_f32_32x32x16_bf16 v[128:143], v[220:223], v[28:31], v[128:143]
  v_mfma_f32_32x32x16_bf16 v[144:159], v[224:227], v[28:31], v[144:159]
  v_mfma_f32_32x32x16_bf16 v[160:175], v[28:31], v[228:231], v[160:175]
  s_add_u32 s29, s27, 25600
  buffer_load_dwordx4 v[24:27], v2, s[8:11], s29 offen sc1
  s_add_u32 s29, s28, 25600
  buffer_load_dwordx4 v[28:31], v2, s[8:11], s29 offen sc1
  ds_read_b128 v[220:223], v3 offset:19456
  ds_read_b128 v[224:227], v3 offset:60416
  ds_read_b128 v[228:231], v4 offset:35840
  s_waitcnt lgkmcnt(3)
  s_waitcnt vmcnt(14)
  v_mfma_f32_32x32x16_bf16 v[80:95], v[208:211], v[32:35], v[80:95]
  v_mfma_f32_32x32x16_bf16 v[96:111], v[212:215], v[32:35], v[96:111]
  v_mfma_f32_32x32x16_bf16 v[112:127], v[32:35], v[216:219], v[112:127]
  v_mfma_f32_32x32x16_bf16 v[128:143], v[208:211], v[36:39], v[128:143]
  v_mfma_f32_32x32x16_bf16 v[144:159], v[212:215], v[36:39], v[144:159]
  v_mfma_f32_32x32x16_bf16 v[160:175], v[36:39], v[216:219], v[160:175]
  s_add_u32 s29, s27, 26624
  buffer_load_dwordx4 v[32:35], v2, s[8:11], s29 offen sc1
  s_add_u32 s29, s28, 26624
  buffer_load_dwordx4 v[36:39], v2, s[8:11], s29 offen sc1
  ds_read_b128 v[208:211], v3 offset:20480
  ds_read_b128 v[212:215], v3 offset:61440
  ds_read_b128 v[216:219], v4 offset:36864
  s_waitcnt lgkmcnt(3)
  s_waitcnt vmcnt(14)
  v_mfma_f32_32x32x16_bf16 v[80:95], v[220:223], v[40:43], v[80:95]
  v_mfma_f32_32x32x16_bf16 v[96:111], v[224:227], v[40:43], v[96:111]
  v_mfma_f32_32x32x16_bf16 v[112:127], v[40:43], v[228:231], v[112:127]
  v_mfma_f32_32x32x16_bf16 v[128:143], v[220:223], v[44:47], v[128:143]
  v_mfma_f32_32x32x16_bf16 v[144:159], v[224:227], v[44:47], v[144:159]
  v_mfma_f32_32x32x16_bf16 v[160:175], v[44:47], v[228:231], v[160:175]
  s_add_u32 s29, s27, 27648
  buffer_load_dwordx4 v[40:43], v2, s[8:11], s29 offen sc1
  s_add_u32 s29, s28, 27648
  buffer_load_dwordx4 v[44:47], v2, s[8:11], s29 offen sc1
  ds_read_b128 v[220:223], v3 offset:21504
  ds_read_b128 v[224:227], v3 offset:62464
  ds_read_b128 v[228:231], v4 offset:37888
  s_waitcnt lgkmcnt(3)
  s_waitcnt vmcnt(14)
  v_mfma_f32_32x32x16_bf16 v[80:95], v[208:211], v[48:51], v[80:95]
  v_mfma_f32_32x32x16_bf16 v[96:111], v[212:215], v[48:51], v[96:111]
  v_mfma_f32_32x32x16_bf16 v[112:127], v[48:51], v[216:219], v[112:127]
  v_mfma_f32_32x32x16_bf16 v[128:143], v[208:211], v[52:55], v[128:143]
  v_mfma_f32_32x32x16_bf16 v[144:159], v[212:215], v[52:55], v[144:159]
  v_mfma_f32_32x32x16_bf16 v[160:175], v[52:55], v[216:219], v[160:175]
  s_add_u32 s29, s27, 28672
  buffer_load_dwordx4 v[48:51], v2, s[8:11], s29 offen sc1
  s_add_u32 s29, s28, 28672
  buffer_load_dwordx4 v[52:55], v2, s[8:11], s29 offen sc1
  ds_read_b128 v[208:211], v3 offset:22528
  ds_read_b128 v[212:215], v3 offset:63488
  ds_read_b128 v[216:219], v4 offset:38912
  s_waitcnt lgkmcnt(3)
  s_waitcnt vmcnt(14)
  v_mfma_f32_32x32x16_bf16 v[80:95], v[220:223], v[56:59], v[80:95]
  v_mfma_f32_32x32x16_bf16 v[96:111], v[224:227], v[56:59], v[96:111]
  v_mfma_f32_32x32x16_bf16 v[112:127], v[56:59], v[228:231], v[112:127]
  v_mfma_f32_32x32x16_bf16 v[128:143], v[220:223], v[60:63], v[128:143]
  v_mfma_f32_32x32x16_bf16 v[144:159], v[224:227], v[60:63], v[144:159]
  v_mfma_f32_32x32x16_bf16 v[160:175], v[60:63], v[228:231], v[160:175]
  s_add_u32 s29, s27, 29696
  buffer_load_dwordx4 v[56:59], v2, s[8:11], s29 offen sc1
  s_add_u32 s29, s28, 29696
  buffer_load_dwordx4 v[60:63], v2, s[8:11], s29 offen sc1
  ds_read_b128 v[220:223], v3 offset:23552
  ds_read_b128 v[224:227], v3 offset:64512
  ds_read_b128 v[228:231], v4 offset:39936
  s_waitcnt lgkmcnt(3)
  s_waitcnt vmcnt(14)
  v_mfma_f32_32x32x16_bf16 v[80:95], v[208:211], v[64:67], v[80:95]
  v_mfma_f32_32x32x16_bf16 v[96:111], v[212:215], v[64:67], v[96:111]
  v_mfma_f32_32x32x16_bf16 v[112:127], v[64:67], v[216:219], v[112:127]
  v_mfma_f32_32x32x16_bf16 v[128:143], v[208:211], v[68:71], v[128:143]
  v_mfma_f32_32x32x16_bf16 v[144:159], v[212:215], v[68:71], v[144:159]
  v_mfma_f32_32x32x16_bf16 v[160:175], v[68:71], v[216:219], v[160:175]
  s_add_u32 s29, s27, 30720
  buffer_load_dwordx4 v[64:67], v2, s[8:11], s29 offen sc1
  s_add_u32 s29, s28, 30720
  buffer_load_dwordx4 v[68:71], v2, s[8:11], s29 offen sc1
  ds_read_b128 v[208:211], v3 offset:24576
  ds_read_b128 v[212:215], v4 offset:0
  ds_read_b128 v[216:219], v4 offset:40960
  s_waitcnt lgkmcnt(3)
  s_waitcnt vmcnt(14)
  v_mfma_f32_32x32x16_bf16 v[80:95], v[220:223], v[72:75], v[80:95]
  v_mfma_f32_32x32x16_bf16 v[96:111], v[224:227], v[72:75], v[96:111]
  v_mfma_f32_32x32x16_bf16 v[112:127], v[72:75], v[228:231], v[112:127]
  v_mfma_f32_32x32x16_bf16 v[128:143], v[220:223], v[76:79], v[128:143]
  v_mfma_f32_32x32x16_bf16 v[144:159], v[224:227], v[76:79], v[144:159]
  v_mfma_f32_32x32x16_bf16 v[160:175], v[76:79], v[228:231], v[160:175]
  s_add_u32 s29, s27, 31744
  buffer_load_dwordx4 v[72:75], v2, s[8:11], s29 offen sc1
  s_add_u32 s29, s28, 31744
  buffer_load_dwordx4 v[76:79], v2, s[8:11], s29 offen sc1
  ds_read_b128 v[220:223], v3 offset:25600
  ds_read_b128 v[224:227], v4 offset:1024
  ds_read_b128 v[228:231], v4 offset:41984
  s_waitcnt lgkmcnt(3)
  s_waitcnt vmcnt(14)
  v_mfma_f32_32x32x16_bf16 v[80:95], v[208:211], v[16:19], v[80:95]
  v_mfma_f32_32x32x16_bf16 v[96:111], v[212:215], v[16:19], v[96:111]
  v_mfma_f32_32x32x16_bf16 v[112:127], v[16:19], v[216:219], v[112:127]
  v_mfma_f32_32x32x16_bf16 v[128:143], v[208:211], v[20:23], v[128:143]
  v_mfma_f32_32x32x16_bf16 v[144:159], v[212:215], v[20:23], v[144:159]
  v_mfma_f32_32x32x16_bf16 v[160:175], v[20:23], v[216:219], v[160:175]
  s_add_u32 s29, s27, 32768
  buffer_load_dwordx4 v[16:19], v2, s[8:11], s29 offen sc1
  s_add_u32 s29, s28, 32768
  buffer_load_dwordx4 v[20:23], v2, s[8:11], s29 offen sc1
  ds_read_b128 v[208:211], v3 offset:26624
  ds_read_b128 v[212:215], v4 offset:2048
  ds_read_b128 v[216:219], v4 offset:43008
  s_waitcnt lgkmcnt(3)
  s_waitcnt vmcnt(14)
  v_mfma_f32_32x32x16_bf16 v[80:95], v[220:223], v[24:27], v[80:95]
  v_mfma_f32_32x32x16_bf16 v[96:111], v[224:227], v[24:27], v[96:111]
  v_mfma_f32_32x32x16_bf16 v[112:127], v[24:27], v[228:231], v[112:127]
  v_mfma_f32_32x32x16_bf16 v[128:143], v[220:223], v[28:31], v[128:143]
  v_mfma_f32_32x32x16_bf16 v[144:159], v[224:227], v[28:31], v[144:159]
  v_mfma_f32_32x32x16_bf16 v[160:175], v[28:31], v[228:231], v[160:175]
  s_add_u32 s29, s27, 33792
  buffer_load_dwordx4 v[24:27], v2, s[8:11], s29 offen sc1
  s_add_u32 s29, s28, 33792
  buffer_load_dwordx4 v[28:31], v2, s[8:11], s29 offen sc1
  ds_read_b128 v[220:223], v3 offset:27648
  ds_read_b128 v[224:227], v4 offset:3072
  ds_read_b128 v[228:231], v4 offset:44032
  s_waitcnt lgkmcnt(3)
  s_waitcnt vmcnt(14)
  v_mfma_f32_32x32x16_bf16 v[80:95], v[208:211], v[32:35], v[80:95]
  v_mfma_f32_32x32x16_bf16 v[96:111], v[212:215], v[32:35], v[96:111]
  v_mfma_f32_32x32x16_bf16 v[112:127], v[32:35], v[216:219], v[112:127]
  v_mfma_f32_32x32x16_bf16 v[128:143], v[208:211], v[36:39], v[128:143]
  v_mfma_f32_32x32x16_bf16 v[144:159], v[212:215], v[36:39], v[144:159]
  v_mfma_f32_32x32x16_bf16 v[160:175], v[36:39], v[216:219], v[160:175]
  s_add_u32 s29, s27, 34816
  buffer_load_dwordx4 v[32:35], v2, s[8:11], s29 offen sc1
  s_add_u32 s29, s28, 34816
  buffer_load_dwordx4 v[36:39], v2, s[8:11], s29 offen sc1
  ds_read_b128 v[208:211], v3 offset:28672
  ds_read_b128 v[212:215], v4 offset:4096
  ds_read_b128 v[216:219], v4 offset:45056
  s_waitcnt lgkmcnt(3)
  s_waitcnt vmcnt(14)
  v_mfma_f32_32x32x16_bf16 v[80:95], v[220:223], v[40:43], v[80:95]
  v_mfma_f32_32x32x16_bf16 v[96:111], v[224:227], v[40:43], v[96:111]
  v_mfma_f32_32x32x16_bf16 v[112:127], v[40:43], v[228:231], v[112:127]
  v_mfma_f32_32x32x16_bf16 v[128:143], v[220:223], v[44:47], v[128:143]
  v_mfma_f32_32x32x16_bf16 v[144:159], v[224:227], v[44:47], v[144:159]
  v_mfma_f32_32x32x16_bf16 v[160:175], v[44:47], v[228:231], v[160:175]
  s_add_u32 s29, s27, 35840
  buffer_load_dwordx4 v[40:43], v2, s[8:11], s29 offen sc1
  s_add_u32 s29, s28, 35840
  buffer_load_dwordx4 v[44:47], v2, s[8:11], s29 offen sc1
  ds_read_b128 v[220:223], v3 offset:29696
  ds_read_b128 v[224:227], v4 offset:5120
  ds_read_b128 v[228:231], v4 offset:46080
  s_waitcnt lgkmcnt(3)
  s_waitcnt vmcnt(14)
  v_mfma_f32_32x32x16_bf16 v[80:95], v[208:211], v[48:51], v[80:95]
  v_mfma_f32_32x32x16_bf16 v[96:111], v[212:215], v[48:51], v[96:111]
  v_mfma_f32_32x32x16_bf16 v[112:127], v[48:51], v[216:219], v[112:127]
  v_mfma_f32_32x32x16_bf16 v[128:143], v[208:211], v[52:55], v[128:143]
  v_mfma_f32_32x32x16_bf16 v[144:159], v[212:215], v[52:55], v[144:159]
  v_mfma_f32_32x32x16_bf16 v[160:175], v[52:55], v[216:219], v[160:175]
  s_add_u32 s29, s27, 36864
  buffer_load_dwordx4 v[48:51], v2, s[8:11], s29 offen sc1
  s_add_u32 s29, s28, 36864
  buffer_load_dwordx4 v[52:55], v2, s[8:11], s29 offen sc1
  ds_read_b128 v[208:211], v3 offset:30720
  ds_read_b128 v[212:215], v4 offset:6144
  ds_read_b128 v[216:219], v4 offset:47104
  s_waitcnt lgkmcnt(3)
  s_waitcnt vmcnt(14)
  v_mfma_f32_32x32x16_bf16 v[80:95], v[220:223], v[56:59], v[80:95]
  v_mfma_f32_32x32x16_bf16 v[96:111], v[224:227], v[56:59], v[96:111]
  v_mfma_f32_32x32x16_bf16 v[112:127], v[56:59], v[228:231], v[112:127]
  v_mfma_f32_32x32x16_bf16 v[128:143], v[220:223], v[60:63], v[128:143]
  v_mfma_f32_32x32x16_bf16 v[144:159], v[224:227], v[60:63], v[144:159]
  v_mfma_f32_32x32x16_bf16 v[160:175], v[60:63], v[228:231], v[160:175]
  s_add_u32 s29, s27, 37888
  buffer_load_dwordx4 v[56:59], v2, s[8:11], s29 offen sc1
  s_add_u32 s29, s28, 37888
  buffer_load_dwordx4 v[60:63], v2, s[8:11], s29 offen sc1
  ds_read_b128 v[220:223], v3 offset:31744
  ds_read_b128 v[224:227], v4 offset:7168
  ds_read_b128 v[228:231], v4 offset:48128
  s_waitcnt lgkmcnt(3)
  s_waitcnt vmcnt(14)
  v_mfma_f32_32x32x16_bf16 v[80:95], v[208:211], v[64:67], v[80:95]
  v_mfma_f32_32x32x16_bf16 v[96:111], v[212:215], v[64:67], v[96:111]
  v_mfma_f32_32x32x16_bf16 v[112:127], v[64:67], v[216:219], v[112:127]
  v_mfma_f32_32x32x16_bf16 v[128:143], v[208:211], v[68:71], v[128:143]
  v_mfma_f32_32x32x16_bf16 v[144:159], v[212:215], v[68:71], v[144:159]
  v_mfma_f32_32x32x16_bf16 v[160:175], v[68:71], v[216:219], v[160:175]
  s_add_u32 s29, s27, 38912
  buffer_load_dwordx4 v[64:67], v2, s[8:11], s29 offen sc1
  s_add_u32 s29, s28, 38912
  buffer_load_dwordx4 v[68:71], v2, s[8:11], s29 offen sc1
  ds_read_b128 v[208:211], v3 offset:32768
  ds_read_b128 v[212:215], v4 offset:8192
  ds_read_b128 v[216:219], v4 offset:49152
  s_waitcnt lgkmcnt(3)
  s_waitcnt vmcnt(14)
  v_mfma_f32_32x32x16_bf16 v[80:95], v[220:223], v[72:75], v[80:95]
  v_mfma_f32_32x32x16_bf16 v[96:111], v[224:227], v[72:75], v[96:111]
  v_mfma_f32_32x32x16_bf16 v[112:127], v[72:75], v[228:231], v[112:127]
  v_mfma_f32_32x32x16_bf16 v[128:143], v[220:223], v[76:79], v[128:143]
  v_mfma_f32_32x32x16_bf16 v[144:159], v[224:227], v[76:79], v[144:159]
  v_mfma_f32_32x32x16_bf16 v[160:175], v[76:79], v[228:231], v[160:175]
  s_add_u32 s29, s27, 39936
  buffer_load_dwordx4 v[72:75], v2, s[8:11], s29 offen sc1
  s_add_u32 s29, s28, 39936
  buffer_load_dwordx4 v[76:79], v2, s[8:11], s29 offen sc1
  ds_read_b128 v[220:223], v3 offset:33792
  ds_read_b128 v[224:227], v4 offset:9216
  ds_read_b128 v[228:231], v4 offset:50176
  s_waitcnt lgkmcnt(3)
  s_waitcnt vmcnt(14)
  v_mfma_f32_32x32x16_bf16 v[80:95], v[208:211], v[16:19], v[80:95]
  v_mfma_f32_32x32x16_bf16 v[96:111], v[212:215], v[16:19], v[96:111]
  v_mfma_f32_32x32x16_bf16 v[112:127], v[16:19], v[216:219], v[112:127]
  v_mfma_f32_32x32x16_bf16 v[128:143], v[208:211], v[20:23], v[128:143]
  v_mfma_f32_32x32x16_bf16 v[144:159], v[212:215], v[20:23], v[144:159]
  v_mfma_f32_32x32x16_bf16 v[160:175], v[20:23], v[216:219], v[160:175]
  ds_read_b128 v[208:211], v3 offset:34816
  ds_read_b128 v[212:215], v4 offset:10240
  ds_read_b128 v[216:219], v4 offset:51200
  s_waitcnt lgkmcnt(3)
  s_waitcnt vmcnt(12)
  v_mfma_f32_32x32x16_bf16 v[80:95], v[220:223], v[24:27], v[80:95]
  v_mfma_f32_32x32x16_bf16 v[96:111], v[224:227], v[24:27], v[96:111]
  v_mfma_f32_32x32x16_bf16 v[112:127], v[24:27], v[228:231], v[112:127]
  v_mfma_f32_32x32x16_bf16 v[128:143], v[220:223], v[28:31], v[128:143]
  v_mfma_f32_32x32x16_bf16 v[144:159], v[224:227], v[28:31], v[144:159]
  v_mfma_f32_32x32x16_bf16 v[160:175], v[28:31], v[228:231], v[160:175]
  ds_read_b128 v[220:223], v3 offset:35840
  ds_read_b128 v[224:227], v4 offset:11264
  ds_read_b128 v[228:231], v4 offset:52224
  s_waitcnt lgkmcnt(3)
  s_waitcnt vmcnt(10)
  v_mfma_f32_32x32x16_bf16 v[80:95], v[208:211], v[32:35], v[80:95]
  v_mfma_f32_32x32x16_bf16 v[96:111], v[212:215], v[32:35], v[96:111]
  v_mfma_f32_32x32x16_bf16 v[112:127], v[32:35], v[216:219], v[112:127]
  v_mfma_f32_32x32x16_bf16 v[128:143], v[208:211], v[36:39], v[128:143]
  v_mfma_f32_32x32x16_bf16 v[144:159], v[212:215], v[36:39], v[144:159]
  v_mfma_f32_32x32x16_bf16 v[160:175], v[36:39], v[216:219], v[160:175]
  ds_read_b128 v[208:211], v3 offset:36864
  ds_read_b128 v[212:215], v4 offset:12288
  ds_read_b128 v[216:219], v4 offset:53248
  s_waitcnt lgkmcnt(3)
  s_waitcnt vmcnt(8)
  v_mfma_f32_32x32x16_bf16 v[80:95], v[220:223], v[40:43], v[80:95]
  v_mfma_f32_32x32x16_bf16 v[96:111], v[224:227], v[40:43], v[96:111]
  v_mfma_f32_32x32x16_bf16 v[112:127], v[40:43], v[228:231], v[112:127]
  v_mfma_f32_32x32x16_bf16 v[128:143], v[220:223], v[44:47], v[128:143]
  v_mfma_f32_32x32x16_bf16 v[144:159], v[224:227], v[44:47], v[144:159]
  v_mfma_f32_32x32x16_bf16 v[160:175], v[44:47], v[228:231], v[160:175]
  ds_read_b128 v[220:223], v3 offset:37888
  ds_read_b128 v[224:227], v4 offset:13312
  ds_read_b128 v[228:231], v4 offset:54272
  s_waitcnt lgkmcnt(3)
  s_waitcnt vmcnt(6)
  v_mfma_f32_32x32x16_bf16 v[80:95], v[208:211], v[48:51], v[80:95]
  v_mfma_f32_32x32x16_bf16 v[96:111], v[212:215], v[48:51], v[96:111]
  v_mfma_f32_32x32x16_bf16 v[112:127], v[48:51], v[216:219], v[112:127]
  v_mfma_f32_32x32x16_bf16 v[128:143], v[208:211], v[52:55], v[128:143]
  v_mfma_f32_32x32x16_bf16 v[144:159], v[212:215], v[52:55], v[144:159]
  v_mfma_f32_32x32x16_bf16 v[160:175], v[52:55], v[216:219], v[160:175]
  ds_read_b128 v[208:211], v3 offset:38912
  ds_read_b128 v[212:215], v4 offset:14336
  ds_read_b128 v[216:219], v4 offset:55296
  s_waitcnt lgkmcnt(3)
  s_waitcnt vmcnt(4)
  v_mfma_f32_32x32x16_bf16 v[80:95], v[220:223], v[56:59], v[80:95]
  v_mfma_f32_32x32x16_bf16 v[96:111], v[224:227], v[56:59], v[96:111]
  v_mfma_f32_32x32x16_bf16 v[112:127], v[56:59], v[228:231], v[112:127]
  v_mfma_f32_32x32x16_bf16 v[128:143], v[220:223], v[60:63], v[128:143]
  v_mfma_f32_32x32x16_bf16 v[144:159], v[224:227], v[60:63], v[144:159]
  v_mfma_f32_32x32x16_bf16 v[160:175], v[60:63], v[228:231], v[160:175]
  ds_read_b128 v[220:223], v3 offset:39936
  ds_read_b128 v[224:227], v4 offset:15360
  ds_read_b128 v[228:231], v4 offset:56320
  s_waitcnt lgkmcnt(3)
  s_waitcnt vmcnt(2)
  v_mfma_f32_32x32x16_bf16 v[80:95], v[208:211], v[64:67], v[80:95]
  v_mfma_f32_32x32x16_bf16 v[96:111], v[212:215], v[64:67], v[96:111]
  v_mfma_f32_32x32x16_bf16 v[112:127], v[64:67], v[216:219], v[112:127]
  v_mfma_f32_32x32x16_bf16 v[128:143], v[208:211], v[68:71], v[128:143]
  v_mfma_f32_32x32x16_bf16 v[144:159], v[212:215], v[68:71], v[144:159]
  v_mfma_f32_32x32x16_bf16 v[160:175], v[68:71], v[216:219], v[160:175]
  s_waitcnt lgkmcnt(0)
  s_waitcnt vmcnt(0)
  v_mfma_f32_32x32x16_bf16 v[80:95], v[220:223], v[72:75], v[80:95]
  v_mfma_f32_32x32x16_bf16 v[96:111], v[224:227], v[72:75], v[96:111]
  v_mfma_f32_32x32x16_bf16 v[112:127], v[72:75], v[228:231], v[112:127]
  v_mfma_f32_32x32x16_bf16 v[128:143], v[220:223], v[76:79], v[128:143]
  v_mfma_f32_32x32x16_bf16 v[144:159], v[224:227], v[76:79], v[144:159]
  v_mfma_f32_32x32x16_bf16 v[160:175], v[76:79], v[228:231], v[160:175]
  s_nop 11
  s_mov_b32 s30, 0x3ea52b5c
  v_mov_b32 v5, 0
  v_cmp_gt_u32 s[34:35], 32, v1
  v_mov_b32 v6, 1.0
  v_and_b32 v7, 31, v1
  v_cndmask_b32 v6, v5, v6, s[34:35]
  v_cmp_eq_u32 s[32:33], 20, v7
  v_mov_b32 v8, 1.0
  s_lshl_b32 s31, s22, 6
  s_add_u32 s31, s31, s24
  s_lshl_b32 s31, s31, 11
  v_mov_b32 v9, 0
  v_max3_f32 v9, v9, abs(v96), abs(v97)
  v_max3_f32 v9, v9, abs(v98), abs(v99)
  v_max3_f32 v9, v9, abs(v100), abs(v101)
  v_max3_f32 v9, v9, abs(v102), abs(v103)
  v_max3_f32 v9, v9, abs(v104), abs(v105)
  v_max3_f32 v9, v9, abs(v106), abs(v107)
  v_max3_f32 v9, v9, abs(v108), abs(v109)
  v_max3_f32 v9, v9, abs(v110), abs(v111)
  v_add_f32 v108, v108, v6
  v_cndmask_b32 v112, v112, v8, s[32:33]
  v_cndmask_b32 v113, v113, v8, s[32:33]
  v_cndmask_b32 v114, v114, v8, s[32:33]
  v_cndmask_b32 v115, v115, v8, s[32:33]
  v_cndmask_b32 v116, v116, v8, s[32:33]
  v_cndmask_b32 v117, v117, v8, s[32:33]
  v_cndmask_b32 v118, v118, v8, s[32:33]
  v_cndmask_b32 v119, v119, v8, s[32:33]
  v_cndmask_b32 v120, v120, v8, s[32:33]
  v_cndmask_b32 v121, v121, v8, s[32:33]
  v_cndmask_b32 v122, v122, v8, s[32:33]
  v_cndmask_b32 v123, v123, v8, s[32:33]
  v_cndmask_b32 v124, v124, v8, s[32:33]
  v_cndmask_b32 v125, v125, v8, s[32:33]
  v_cndmask_b32 v126, v126, v8, s[32:33]
  v_cndmask_b32 v127, v127, v8, s[32:33]
  v_cvt_pk_bf16_f32 v16, v96, v97
  v_cvt_pk_bf16_f32 v17, v98, v99
  v_cvt_pk_bf16_f32 v18, v100, v101
  v_cvt_pk_bf16_f32 v19, v102, v103
  v_cvt_pk_bf16_f32 v20, v104, v105
  v_cvt_pk_bf16_f32 v21, v106, v107
  v_cvt_pk_bf16_f32 v22, v108, v109
  v_cvt_pk_bf16_f32 v23, v110, v111
  s_add_u32 s29, s31, 245366784
  buffer_store_dwordx4 v[16:19], v2, s[8:11], s29 offen sc1
  buffer_store_dwordx4 v[20:23], v2, s[8:11], s29 offen offset:1024 sc1
  v_cvt_pk_bf16_f32 v24, v112, v113
  v_cvt_pk_bf16_f32 v25, v114, v115
  v_cvt_pk_bf16_f32 v26, v116, v117
  v_cvt_pk_bf16_f32 v27, v118, v119
  v_cvt_pk_bf16_f32 v28, v120, v121
  v_cvt_pk_bf16_f32 v29, v122, v123
  v_cvt_pk_bf16_f32 v30, v124, v125
  v_cvt_pk_bf16_f32 v31, v126, v127
  s_add_u32 s29, s31, 249561088
  buffer_store_dwordx4 v[24:27], v2, s[8:11], s29 offen sc1
  buffer_store_dwordx4 v[28:31], v2, s[8:11], s29 offen offset:1024 sc1
  v_mul_f32 v80, s30, v80
  v_mul_f32 v81, s30, v81
  v_mul_f32 v82, s30, v82
  v_mul_f32 v83, s30, v83
  v_mul_f32 v84, s30, v84
  v_mul_f32 v85, s30, v85
  v_mul_f32 v86, s30, v86
  v_mul_f32 v87, s30, v87
  v_mul_f32 v88, s30, v88
  v_mul_f32 v89, s30, v89
  v_mul_f32 v90, s30, v90
  v_mul_f32 v91, s30, v91
  v_mul_f32 v92, s30, v92
  v_mul_f32 v93, s30, v93
  v_mul_f32 v94, s30, v94
  v_mul_f32 v95, s30, v95
  v_cvt_pk_bf16_f32 v192, v80, v81
  v_cvt_pk_bf16_f32 v193, v82, v83
  v_cvt_pk_bf16_f32 v194, v84, v85
  v_cvt_pk_bf16_f32 v195, v86, v87
  v_cvt_pk_bf16_f32 v196, v88, v89
  v_cvt_pk_bf16_f32 v197, v90, v91
  v_cvt_pk_bf16_f32 v198, v92, v93
  v_cvt_pk_bf16_f32 v199, v94, v95
  v_max3_f32 v9, v9, abs(v144), abs(v145)
  v_max3_f32 v9, v9, abs(v146), abs(v147)
  v_max3_f32 v9, v9, abs(v148), abs(v149)
  v_max3_f32 v9, v9, abs(v150), abs(v151)
  v_max3_f32 v9, v9, abs(v152), abs(v153)
  v_max3_f32 v9, v9, abs(v154), abs(v155)
  v_max3_f32 v9, v9, abs(v156), abs(v157)
  v_max3_f32 v9, v9, abs(v158), abs(v159)
  v_add_f32 v156, v156, v6
  v_cndmask_b32 v160, v160, v8, s[32:33]
  v_cndmask_b32 v161, v161, v8, s[32:33]
  v_cndmask_b32 v162, v162, v8, s[32:33]
  v_cndmask_b32 v163, v163, v8, s[32:33]
  v_cndmask_b32 v164, v164, v8, s[32:33]
  v_cndmask_b32 v165, v165, v8, s[32:33]
  v_cndmask_b32 v166, v166, v8, s[32:33]
  v_cndmask_b32 v167, v167, v8, s[32:33]
  v_cndmask_b32 v168, v168, v8, s[32:33]
  v_cndmask_b32 v169, v169, v8, s[32:33]
  v_cndmask_b32 v170, v170, v8, s[32:33]
  v_cndmask_b32 v171, v171, v8, s[32:33]
  v_cndmask_b32 v172, v172, v8, s[32:33]
  v_cndmask_b32 v173, v173, v8, s[32:33]
  v_cndmask_b32 v174, v174, v8, s[32:33]
  v_cndmask_b32 v175, v175, v8, s[32:33]
  v_cvt_pk_bf16_f32 v32, v144, v145
  v_cvt_pk_bf16_f32 v33, v146, v147
  v_cvt_pk_bf16_f32 v34, v148, v149
  v_cvt_pk_bf16_f32 v35, v150, v151
  v_cvt_pk_bf16_f32 v36, v152, v153
  v_cvt_pk_bf16_f32 v37, v154, v155
  v_cvt_pk_bf16_f32 v38, v156, v157
  v_cvt_pk_bf16_f32 v39, v158, v159
  s_add_u32 s29, s31, 245368832
  buffer_store_dwordx4 v[32:35], v2, s[8:11], s29 offen sc1
  buffer_store_dwordx4 v[36:39], v2, s[8:11], s29 offen offset:1024 sc1
  v_cvt_pk_bf16_f32 v40, v160, v161
  v_cvt_pk_bf16_f32 v41, v162, v163
  v_cvt_pk_bf16_f32 v42, v164, v165
  v_cvt_pk_bf16_f32 v43, v166, v167
  v_cvt_pk_bf16_f32 v44, v168, v169
  v_cvt_pk_bf16_f32 v45, v170, v171
  v_cvt_pk_bf16_f32 v46, v172, v173
  v_cvt_pk_bf16_f32 v47, v174, v175
  s_add_u32 s29, s31, 249563136
  buffer_store_dwordx4 v[40:43], v2, s[8:11], s29 offen sc1
  buffer_store_dwordx4 v[44:47], v2, s[8:11], s29 offen offset:1024 sc1
  v_mul_f32 v128, s30, v128
  v_mul_f32 v129, s30, v129
  v_mul_f32 v130, s30, v130
  v_mul_f32 v131, s30, v131
  v_mul_f32 v132, s30, v132
  v_mul_f32 v133, s30, v133
  v_mul_f32 v134, s30, v134
  v_mul_f32 v135, s30, v135
  v_mul_f32 v136, s30, v136
  v_mul_f32 v137, s30, v137
  v_mul_f32 v138, s30, v138
  v_mul_f32 v139, s30, v139
  v_mul_f32 v140, s30, v140
  v_mul_f32 v141, s30, v141
  v_mul_f32 v142, s30, v142
  v_mul_f32 v143, s30, v143
  v_cvt_pk_bf16_f32 v200, v128, v129
  v_cvt_pk_bf16_f32 v201, v130, v131
  v_cvt_pk_bf16_f32 v202, v132, v133
  v_cvt_pk_bf16_f32 v203, v134, v135
  v_cvt_pk_bf16_f32 v204, v136, v137
  v_cvt_pk_bf16_f32 v205, v138, v139
  v_cvt_pk_bf16_f32 v206, v140, v141
  v_cvt_pk_bf16_f32 v207, v142, v143
  s_nop 1
  v_max_f32_dpp v10, v9, v9 quad_perm:[1,0,3,2] row_mask:0xf bank_mask:0xf
  s_nop 1
  v_max_f32_dpp v9, v10, v10 quad_perm:[2,3,0,1] row_mask:0xf bank_mask:0xf
  s_nop 1
  v_max_f32_dpp v10, v9, v9 row_half_mirror row_mask:0xf bank_mask:0xf
  s_nop 1
  v_max_f32_dpp v9, v10, v10 row_mirror row_mask:0xf bank_mask:0xf
  v_mov_b32 v10, v9
  s_nop 1
  v_permlane16_swap_b32 v9, v10
  v_max_f32 v9, v9, v10
  v_mov_b32 v10, v9
  s_nop 1
  v_permlane32_swap_b32 v9, v10
  v_max_f32 v9, v9, v10
  s_lshl_b32 s51, s22, 2
  s_add_u32 s51, s51, 0x9800
  v_mov_b32 v11, 0
  s_mov_b64 s[40:41], exec
  s_mov_b64 exec, 1
  buffer_atomic_umax v9, v11, s[8:11], s51 offen
  s_mov_b64 exec, s[40:41]
  s_mov_b32 s52, s24
  s_waitcnt vmcnt(0)
  s_barrier
  s_cmp_eq_u32 s21, 0
  s_cbranch_scc0 arr_35
  s_mov_b64 s[24:25], exec
  s_mov_b64 exec, 1
  v_mov_b32 v3, 0
  v_mov_b32 v4, 1
  buffer_atomic_add v4, v3, s[8:11], s47 offen
  s_mov_b64 exec, s[24:25]
arr_35:
  s_and_b32 s26, s2, 3
  s_mul_i32 s26, s26, 10
  s_mul_i32 s27, s21, 3
  s_cmp_eq_u32 s21, 3
  s_cselect_b32 s27, 8, s27
  s_add_u32 s50, s26, s27
  s_mul_i32 s26, s50, 20480
  s_add_u32 s26, s26, 0xe000000
  s_add_u32 s27, s26, 0
  buffer_load_dwordx4 a[0:3], v2, s[8:11], s27 offen
  s_add_u32 s27, s26, 1024
  buffer_load_dwordx4 a[4:7], v2, s[8:11], s27 offen
  s_add_u32 s27, s26, 2048
  buffer_load_dwordx4 a[8:11], v2, s[8:11], s27 offen
  s_add_u32 s27, s26, 3072
  buffer_load_dwordx4 a[12:15], v2, s[8:11], s27 offen
  s_add_u32 s27, s26, 4096
  buffer_load_dwordx4 a[16:19], v2, s[8:11], s27 offen
  s_add_u32 s27, s26, 5120
  buffer_load_dwordx4 a[20:23], v2, s[8:11], s27 offen
  s_add_u32 s27, s26, 6144
  buffer_load_dwordx4 a[24:27], v2, s[8:11], s27 offen
  s_add_u32 s27, s26, 7168
  buffer_load_dwordx4 a[28:31], v2, s[8:11], s27 offen
  s_add_u32 s27, s26, 8192
  buffer_load_dwordx4 a[32:35], v2, s[8:11], s27 offen
  s_add_u32 s27, s26, 9216
  buffer_load_dwordx4 a[36:39], v2, s[8:11], s27 offen
  s_add_u32 s27, s26, 10240
  buffer_load_dwordx4 a[40:43], v2, s[8:11], s27 offen
  s_add_u32 s27, s26, 11264
  buffer_load_dwordx4 a[44:47], v2, s[8:11], s27 offen
  s_add_u32 s27, s26, 12288
  buffer_load_dwordx4 a[48:51], v2, s[8:11], s27 offen
  s_add_u32 s27, s26, 13312
  buffer_load_dwordx4 a[52:55], v2, s[8:11], s27 offen
  s_add_u32 s27, s26, 14336
  buffer_load_dwordx4 a[56:59], v2, s[8:11], s27 offen
  s_add_u32 s27, s26, 15360
  buffer_load_dwordx4 a[60:63], v2, s[8:11], s27 offen
  s_add_u32 s27, s26, 16384
  buffer_load_dwordx4 a[64:67], v2, s[8:11], s27 offen
  s_add_u32 s27, s26, 17408
  buffer_load_dwordx4 a[68:71], v2, s[8:11], s27 offen
  s_add_u32 s27, s26, 18432
  buffer_load_dwordx4 a[72:75], v2, s[8:11], s27 offen
  s_add_u32 s27, s26, 19456
  buffer_load_dwordx4 a[76:79], v2, s[8:11], s27 offen
  s_add_u32 s27, s26, 20480
  buffer_load_dwordx4 a[80:83], v2, s[8:11], s27 offen
  s_add_u32 s27, s26, 21504
  buffer_load_dwordx4 a[84:87], v2, s[8:11], s27 offen
  s_add_u32 s27, s26, 22528
  buffer_load_dwordx4 a[88:91], v2, s[8:11], s27 offen
  s_add_u32 s27, s26, 23552
  buffer_load_dwordx4 a[92:95], v2, s[8:11], s27 offen
  s_add_u32 s27, s26, 24576
  buffer_load_dwordx4 a[96:99], v2, s[8:11], s27 offen
  s_add_u32 s27, s26, 25600
  buffer_load_dwordx4 a[100:103], v2, s[8:11], s27 offen
  s_add_u32 s27, s26, 26624
  buffer_load_dwordx4 a[104:107], v2, s[8:11], s27 offen
  s_add_u32 s27, s26, 27648
  buffer_load_dwordx4 a[108:111], v2, s[8:11], s27 offen
  s_add_u32 s27, s26, 28672
  buffer_load_dwordx4 a[112:115], v2, s[8:11], s27 offen
  s_add_u32 s27, s26, 29696
  buffer_load_dwordx4 a[116:119], v2, s[8:11], s27 offen
  s_add_u32 s27, s26, 30720
  buffer_load_dwordx4 a[120:123], v2, s[8:11], s27 offen
  s_add_u32 s27, s26, 31744
  buffer_load_dwordx4 a[124:127], v2, s[8:11], s27 offen
  s_add_u32 s27, s26, 32768
  buffer_load_dwordx4 a[128:131], v2, s[8:11], s27 offen
  s_add_u32 s27, s26, 33792
  buffer_load_dwordx4 a[132:135], v2, s[8:11], s27 offen
  s_add_u32 s27, s26, 34816
  buffer_load_dwordx4 a[136:139], v2, s[8:11], s27 offen
  s_add_u32 s27, s26, 35840
  buffer_load_dwordx4 a[140:143], v2, s[8:11], s27 offen
  s_add_u32 s27, s26, 36864
  buffer_load_dwordx4 a[144:147], v2, s[8:11], s27 offen
  s_add_u32 s27, s26, 37888
  buffer_load_dwordx4 a[148:151], v2, s[8:11], s27 offen
  s_add_u32 s27, s26, 38912
  buffer_load_dwordx4 a[152:155], v2, s[8:11], s27 offen
  s_add_u32 s27, s26, 39936
  buffer_load_dwordx4 a[156:159], v2, s[8:11], s27 offen
  s_cmp_lt_u32 s21, 2
  s_cbranch_scc0 g3_36
  s_add_u32 s27, s26, 40960
  buffer_load_dwordx4 a[160:163], v2, s[8:11], s27 offen
  s_add_u32 s27, s26, 41984
  buffer_load_dwordx4 a[164:167], v2, s[8:11], s27 offen
  s_add_u32 s27, s26, 43008
  buffer_load_dwordx4 a[168:171], v2, s[8:11], s27 offen
  s_add_u32 s27, s26, 44032
  buffer_load_dwordx4 a[172:175], v2, s[8:11], s27 offen
  s_add_u32 s27, s26, 45056
  buffer_load_dwordx4 a[176:179], v2, s[8:11], s27 offen
  s_add_u32 s27, s26, 46080
  buffer_load_dwordx4 a[180:183], v2, s[8:11], s27 offen
  s_add_u32 s27, s26, 47104
  buffer_load_dwordx4 a[184:187], v2, s[8:11], s27 offen
  s_add_u32 s27, s26, 48128
  buffer_load_dwordx4 a[188:191], v2, s[8:11], s27 offen
  s_add_u32 s27, s26, 49152
  buffer_load_dwordx4 a[192:195], v2, s[8:11], s27 offen
  s_add_u32 s27, s26, 50176
  buffer_load_dwordx4 a[196:199], v2, s[8:11], s27 offen
  s_add_u32 s27, s26, 51200
  buffer_load_dwordx4 a[200:203], v2, s[8:11], s27 offen
  s_add_u32 s27, s26, 52224
  buffer_load_dwordx4 a[204:207], v2, s[8:11], s27 offen
  s_add_u32 s27, s26, 53248
  buffer_load_dwordx4 a[208:211], v2, s[8:11], s27 offen
  s_add_u32 s27, s26, 54272
  buffer_load_dwordx4 a[212:215], v2, s[8:11], s27 offen
  s_add_u32 s27, s26, 55296
  buffer_load_dwordx4 a[216:219], v2, s[8:11], s27 offen
  s_add_u32 s27, s26, 56320
  buffer_load_dwordx4 a[220:223], v2, s[8:11], s27 offen
  s_add_u32 s27, s26, 57344
  buffer_load_dwordx4 a[224:227], v2, s[8:11], s27 offen
  s_add_u32 s27, s26, 58368
  buffer_load_dwordx4 a[228:231], v2, s[8:11], s27 offen
  s_add_u32 s27, s26, 59392
  buffer_load_dwordx4 a[232:235], v2, s[8:11], s27 offen
  s_add_u32 s27, s26, 60416
  buffer_load_dwordx4 a[236:239], v2, s[8:11], s27 offen
g3_36:
  v_mov_b32 v12, 0
  v_lshlrev_b32 v6, 16, v192
  v_and_b32 v7, 0xffff0000, v192
  v_add_f32_e64 v12, v12, abs(v6)
  v_add_f32_e64 v12, v12, abs(v7)
  v_lshlrev_b32 v6, 16, v193
  v_and_b32 v7, 0xffff0000, v193
  v_add_f32_e64 v12, v12, abs(v6)
  v_add_f32_e64 v12, v12, abs(v7)
  v_lshlrev_b32 v6, 16, v194
  v_and_b32 v7, 0xffff0000, v194
  v_add_f32_e64 v12, v12, abs(v6)
  v_add_f32_e64 v12, v12, abs(v7)
  v_lshlrev_b32 v6, 16, v195
  v_and_b32 v7, 0xffff0000, v195
  v_add_f32_e64 v12, v12, abs(v6)
  v_add_f32_e64 v12, v12, abs(v7)
  v_lshlrev_b32 v6, 16, v196
  v_and_b32 v7, 0xffff0000, v196
  v_add_f32_e64 v12, v12, abs(v6)
  v_add_f32_e64 v12, v12, abs(v7)
  v_lshlrev_b32 v6, 16, v197
  v_and_b32 v7, 0xffff0000, v197
  v_add_f32_e64 v12, v12, abs(v6)
  v_add_f32_e64 v12, v12, abs(v7)
  v_lshlrev_b32 v6, 16, v198
  v_and_b32 v7, 0xffff0000, v198
  v_add_f32_e64 v12, v12, abs(v6)
  v_add_f32_e64 v12, v12, abs(v7)
  v_lshlrev_b32 v6, 16, v199
  v_and_b32 v7, 0xffff0000, v199
  v_add_f32_e64 v12, v12, abs(v6)
  v_add_f32_e64 v12, v12, abs(v7)
  v_mov_b32 v6, v12
  s_nop 1
  v_permlane32_swap_b32 v12, v6
  v_add_f32 v12, v12, v6
  v_mov_b32 v13, 0
  v_lshlrev_b32 v6, 16, v200
  v_and_b32 v7, 0xffff0000, v200
  v_add_f32_e64 v13, v13, abs(v6)
  v_add_f32_e64 v13, v13, abs(v7)
  v_lshlrev_b32 v6, 16, v201
  v_and_b32 v7, 0xffff0000, v201
  v_add_f32_e64 v13, v13, abs(v6)
  v_add_f32_e64 v13, v13, abs(v7)
  v_lshlrev_b32 v6, 16, v202
  v_and_b32 v7, 0xffff0000, v202
  v_add_f32_e64 v13, v13, abs(v6)
  v_add_f32_e64 v13, v13, abs(v7)
  v_lshlrev_b32 v6, 16, v203
  v_and_b32 v7, 0xffff0000, v203
  v_add_f32_e64 v13, v13, abs(v6)
  v_add_f32_e64 v13, v13, abs(v7)
  v_lshlrev_b32 v6, 16, v204
  v_and_b32 v7, 0xffff0000, v204
  v_add_f32_e64 v13, v13, abs(v6)
  v_add_f32_e64 v13, v13, abs(v7)
  v_lshlrev_b32 v6, 16, v205
  v_and_b32 v7, 0xffff0000, v205
  v_add_f32_e64 v13, v13, abs(v6)
  v_add_f32_e64 v13, v13, abs(v7)
  v_lshlrev_b32 v6, 16, v206
  v_and_b32 v7, 0xffff0000, v206
  v_add_f32_e64 v13, v13, abs(v6)
  v_add_f32_e64 v13, v13, abs(v7)
  v_lshlrev_b32 v6, 16, v207
  v_and_b32 v7, 0xffff0000, v207
  v_add_f32_e64 v13, v13, abs(v6)
  v_add_f32_e64 v13, v13, abs(v7)
  v_mov_b32 v6, v13
  s_nop 1
  v_permlane32_swap_b32 v13, v6
  v_add_f32 v13, v13, v6
  v_mov_b32 v8, -1
  v_mov_b32 v9, -1
  v_mov_b32 v10, -1
  v_mov_b32 v11, -1
  s_mul_i32 s30, s2, 61440
  s_mul_i32 s31, s21, 15360
  s_add_u32 s30, s30, s31
  s_add_u32 s30, s30, 0x400000
  buffer_store_dwordx4 v[8:11], v2, s[8:11], s30 offen
  s_add_u32 s30, s30, 1024
  buffer_store_dwordx4 v[8:11], v2, s[8:11], s30 offen
  s_add_u32 s30, s30, 1024
  buffer_store_dwordx4 v[8:11], v2, s[8:11], s30 offen
  s_add_u32 s30, s30, 1024
  buffer_store_dwordx4 v[8:11], v2, s[8:11], s30 offen
  s_add_u32 s30, s30, 1024
  buffer_store_dwordx4 v[8:11], v2, s[8:11], s30 offen
  s_add_u32 s30, s30, 1024
  buffer_store_dwordx4 v[8:11], v2, s[8:11], s30 offen
  s_add_u32 s30, s30, 1024
  buffer_store_dwordx4 v[8:11], v2, s[8:11], s30 offen
  s_add_u32 s30, s30, 1024
  buffer_store_dwordx4 v[8:11], v2, s[8:11], s30 offen
  s_add_u32 s30, s30, 1024
  buffer_store_dwordx4 v[8:11], v2, s[8:11], s30 offen
  s_add_u32 s30, s30, 1024
  buffer_store_dwordx4 v[8:11], v2, s[8:11], s30 offen
  s_add_u32 s30, s30, 1024
  buffer_store_dwordx4 v[8:11], v2, s[8:11], s30 offen
  s_add_u32 s30, s30, 1024
  buffer_store_dwordx4 v[8:11], v2, s[8:11], s30 offen
  s_add_u32 s30, s30, 1024
  buffer_store_dwordx4 v[8:11], v2, s[8:11], s30 offen
  s_add_u32 s30, s30, 1024
  buffer_store_dwordx4 v[8:11], v2, s[8:11], s30 offen
  s_add_u32 s30, s30, 1024
  buffer_store_dwordx4 v[8:11], v2, s[8:11], s30 offen
  s_add_u32 s30, s30, 1024
  s_cmp_eq_u32 s2, 0
  s_cbranch_scc0 z_37
  s_cmp_eq_u32 s21, 0
  s_cbranch_scc0 z_37
  v_mov_b32 v8, 0
  v_mov_b32 v9, 0
  v_mov_b32 v10, 0
  v_mov_b32 v11, 0
  s_mov_b32 s30, 0x0
  buffer_store_dwordx4 v[8:11], v2, s[8:11], s30 offen
  s_add_u32 s30, s30, 1024
  buffer_store_dwordx4 v[8:11], v2, s[8:11], s30 offen
  s_add_u32 s30, s30, 1024
  buffer_store_dwordx4 v[8:11], v2, s[8:11], s30 offen
  s_add_u32 s30, s30, 1024
  buffer_store_dwordx4 v[8:11], v2, s[8:11], s30 offen
  s_add_u32 s30, s30, 1024
  buffer_store_dwordx4 v[8:11], v2, s[8:11], s30 offen
  s_add_u32 s30, s30, 1024
z_37:
  s_mov_b32 s45, 0
  v_mov_b32 v3, 0
aw_38:
  buffer_load_dword v4, v3, s[8:11], s47 offen sc1
  s_add_u32 s45, s45, 1
  s_waitcnt vmcnt(0)
  v_readfirstlane_b32 s29, v4
  s_cmp_ge_u32 s29, 8
  s_cbranch_scc1 aw_38_ok
  s_cmp_lt_u32 s45, 400000
  s_cbranch_scc1 aw_38
  s_branch kb1_abort
aw_38_ok:
  v_mov_b32 v3, 0
  buffer_load_dword v4, v3, s[8:11], s51 offen sc1
  s_lshl_b32 s25, s22, 6
  s_lshl_b32 s27, s25, 11
  s_add_u32 s28, s27, 0xee00000
  s_add_u32 s27, s27, 0xea00000
  s_mov_b32 s41, 0
  s_mul_i32 s53, s41, 32768
  s_lshl_b32 s31, s21, 13
  s_add_u32 s53, s53, s31
  s_add_u32 m0, s31, 0
  s_add_u32 s29, s53, s27
  s_add_u32 s29, s29, 0
  buffer_load_dwordx4 v2, s[8:11], s29 offen sc1 lds
  s_add_u32 m0, s31, 1024
  s_add_u32 s29, s53, s27
  s_add_u32 s29, s29, 1024
  buffer_load_dwordx4 v2, s[8:11], s29 offen sc1 lds
  s_add_u32 m0, s31, 2048
  s_add_u32 s29, s53, s27
  s_add_u32 s29, s29, 2048
  buffer_load_dwordx4 v2, s[8:11], s29 offen sc1 lds
  s_add_u32 m0, s31, 3072
  s_add_u32 s29, s53, s27
  s_add_u32 s29, s29, 3072
  buffer_load_dwordx4 v2, s[8:11], s29 offen sc1 lds
  s_add_u32 m0, s31, 4096
  s_add_u32 s29, s53, s27
  s_add_u32 s29, s29, 4096
  buffer_load_dwordx4 v2, s[8:11], s29 offen sc1 lds
  s_add_u32 m0, s31, 5120
  s_add_u32 s29, s53, s27
  s_add_u32 s29, s29, 5120
  buffer_load_dwordx4 v2, s[8:11], s29 offen sc1 lds
  s_add_u32 m0, s31, 6144
  s_add_u32 s29, s53, s27
  s_add_u32 s29, s29, 6144
  buffer_load_dwordx4 v2, s[8:11], s29 offen sc1 lds
  s_add_u32 m0, s31, 7168
  s_add_u32 s29, s53, s27
  s_add_u32 s29, s29, 7168
  buffer_load_dwordx4 v2, s[8:11], s29 offen sc1 lds
  s_add_u32 m0, s31, 32768
  s_add_u32 s29, s53, s28
  s_add_u32 s29, s29, 0
  buffer_load_dwordx4 v2, s[8:11], s29 offen sc1 lds
  s_add_u32 m0, s31, 33792
  s_add_u32 s29, s53, s28
  s_add_u32 s29, s29, 1024
  buffer_load_dwordx4 v2, s[8:11], s29 offen sc1 lds
  s_add_u32 m0, s31, 34816
  s_add_u32 s29, s53, s28
  s_add_u32 s29, s29, 2048
  buffer_load_dwordx4 v2, s[8:11], s29 offen sc1 lds
  s_add_u32 m0, s31, 35840
  s_add_u32 s29, s53, s28
  s_add_u32 s29, s29, 3072
  buffer_load_dwordx4 v2, s[8:11], s29 offen sc1 lds
  s_add_u32 m0, s31, 36864
  s_add_u32 s29, s53, s28
  s_add_u32 s29, s29, 4096
  buffer_load_dwordx4 v2, s[8:11], s29 offen sc1 lds
  s_add_u32 m0, s31, 37888
  s_add_u32 s29, s53, s28
  s_add_u32 s29, s29, 5120
  buffer_load_dwordx4 v2, s[8:11], s29 offen sc1 lds
  s_add_u32 m0, s31, 38912
  s_add_u32 s29, s53, s28
  s_add_u32 s29, s29, 6144
  buffer_load_dwordx4 v2, s[8:11], s29 offen sc1 lds
  s_add_u32 m0, s31, 39936
  s_add_u32 s29, s53, s28
  s_add_u32 s29, s29, 7168
  buffer_load_dwordx4 v2, s[8:11], s29 offen sc1 lds
  s_waitcnt vmcnt(16)
  v_mul_f32 v12, v12, v4
  v_mul_f32 v12, 0x3f820000, v12
  v_mul_f32 v13, v13, v4
  v_mul_f32 v13, 0x3f820000, v13
  s_mov_b32 s40, 0
kb1_main:
  v_lshrrev_b32 v5, 16, v12
  v_or_b32 v5, 0x8000, v5
  v_and_b32 v6, 0xffff0000, v198
  v_or_b32 v5, v5, v6
  v_cndmask_b32 v198, v198, v5, s[34:35]
  v_lshrrev_b32 v5, 16, v13
  v_or_b32 v5, 0x8000, v5
  v_and_b32 v6, 0xffff0000, v206
  v_or_b32 v5, v5, v6
  v_cndmask_b32 v206, v206, v5, s[34:35]
kb1_main2:
  v_mov_b32 v112, 0
  v_mov_b32 v113, 0
  v_mov_b32 v114, 0
  v_mov_b32 v115, 0
  v_mov_b32 v116, 0
  v_mov_b32 v117, 0
  v_mov_b32 v118, 0
  v_mov_b32 v119, 0
  v_mov_b32 v120, 0
  v_mov_b32 v121, 0
  v_mov_b32 v122, 0
  v_mov_b32 v123, 0
  v_mov_b32 v124, 0
  v_mov_b32 v125, 0
  v_mov_b32 v126, 0
  v_mov_b32 v127, 0
  v_mov_b32 v128, 0
  v_mov_b32 v129, 0
  v_mov_b32 v130, 0
  v_mov_b32 v131, 0
  v_mov_b32 v132, 0
  v_mov_b32 v133, 0
  v_mov_b32 v134, 0
  v_mov_b32 v135, 0
  v_mov_b32 v136, 0
  v_mov_b32 v137, 0
  v_mov_b32 v138, 0
  v_mov_b32 v139, 0
  v_mov_b32 v140, 0
  v_mov_b32 v141, 0
  v_mov_b32 v142, 0
  v_mov_b32 v143, 0
  v_mov_b32 v3, v2
  v_add_u32 v4, 65536, v2
kb1_chunk2:
  s_waitcnt vmcnt(0)
  s_barrier
  s_add_u32 s41, s41, 1
  s_min_u32 s29, s41, 3
  s_mul_i32 s53, s29, 32768
  s_lshl_b32 s31, s21, 13
  s_add_u32 s53, s53, s31
  ds_read_b128 v[32:35], v3 offset:0
  ds_read_b128 v[36:39], v3 offset:1024
  ds_read_b128 v[48:51], v3 offset:32768
  ds_read_b128 v[52:55], v3 offset:33792
  ds_read_b128 v[40:43], v3 offset:2048
  ds_read_b128 v[44:47], v3 offset:3072
  s_waitcnt lgkmcnt(4)
  v_mfma_f32_32x32x16_bf16 v[64:79], v[32:35], v[192:195], 0
  v_mfma_f32_32x32x16_bf16 v[64:79], v[36:39], v[196:199], v[64:79]
  s_nop 11
  v_exp_f32 v64, v64
  v_exp_f32 v65, v65
  v_exp_f32 v66, v66
  v_exp_f32 v67, v67
  v_cvt_pk_bf16_f32 v96, v64, v65
  v_exp_f32 v68, v68
  v_exp_f32 v69, v69
  v_cvt_pk_bf16_f32 v97, v66, v67
  v_exp_f32 v70, v70
  v_mfma_f32_32x32x16_bf16 v[80:95], v[32:35], v[200:203], 0
  v_exp_f32 v71, v71
  v_cvt_pk_bf16_f32 v98, v68, v69
  v_exp_f32 v72, v72
  v_exp_f32 v73, v73
  v_cvt_pk_bf16_f32 v99, v70, v71
  v_mfma_f32_32x32x16_bf16 v[80:95], v[36:39], v[204:207], v[80:95]
  v_exp_f32 v74, v74
  v_exp_f32 v75, v75
  ds_read_b128 v[56:59], v3 offset:34816
  v_cvt_pk_bf16_f32 v100, v72, v73
  v_exp_f32 v76, v76
  v_exp_f32 v77, v77
  ds_read_b128 v[60:63], v3 offset:35840
  v_cvt_pk_bf16_f32 v101, v74, v75
  v_exp_f32 v78, v78
  s_add_u32 m0, s31, 65536
  s_add_u32 s29, s53, s27
  s_add_u32 s29, s29, 0
  buffer_load_dwordx4 v2, s[8:11], s29 offen sc1 lds
  v_exp_f32 v79, v79
  v_cvt_pk_bf16_f32 v102, v76, v77
  v_cvt_pk_bf16_f32 v103, v78, v79
  s_waitcnt lgkmcnt(4)
  v_mfma_f32_32x32x16_bf16 v[112:127], v[48:51], v[96:99], v[112:127]
  v_exp_f32 v80, v80
  v_exp_f32 v81, v81
  v_exp_f32 v82, v82
  v_exp_f32 v83, v83
  v_mfma_f32_32x32x16_bf16 v[112:127], v[52:55], v[100:103], v[112:127]
  v_cvt_pk_bf16_f32 v104, v80, v81
  v_exp_f32 v84, v84
  v_exp_f32 v85, v85
  v_cvt_pk_bf16_f32 v105, v82, v83
  v_exp_f32 v86, v86
  s_waitcnt lgkmcnt(2)
  v_mfma_f32_32x32x16_bf16 v[64:79], v[40:43], v[192:195], 0
  v_exp_f32 v87, v87
  v_cvt_pk_bf16_f32 v106, v84, v85
  v_exp_f32 v88, v88
  v_exp_f32 v89, v89
  v_cvt_pk_bf16_f32 v107, v86, v87
  v_mfma_f32_32x32x16_bf16 v[64:79], v[44:47], v[196:199], v[64:79]
  v_exp_f32 v90, v90
  v_exp_f32 v91, v91
  ds_read_b128 v[32:35], v3 offset:4096
  v_cvt_pk_bf16_f32 v108, v88, v89
  v_exp_f32 v92, v92
  v_exp_f32 v93, v93
  ds_read_b128 v[36:39], v3 offset:5120
  v_cvt_pk_bf16_f32 v109, v90, v91
  v_exp_f32 v94, v94
  v_exp_f32 v95, v95
  v_cvt_pk_bf16_f32 v110, v92, v93
  v_cvt_pk_bf16_f32 v111, v94, v95
  v_mfma_f32_32x32x16_bf16 v[128:143], v[48:51], v[104:107], v[128:143]
  v_exp_f32 v64, v64
  v_exp_f32 v65, v65
  v_exp_f32 v66, v66
  v_exp_f32 v67, v67
  v_mfma_f32_32x32x16_bf16 v[128:143], v[52:55], v[108:111], v[128:143]
  v_cvt_pk_bf16_f32 v96, v64, v65
  v_exp_f32 v68, v68
  v_exp_f32 v69, v69
  v_cvt_pk_bf16_f32 v97, v66, v67
  v_exp_f32 v70, v70
  v_mfma_f32_32x32x16_bf16 v[80:95], v[40:43], v[200:203], 0
  v_exp_f32 v71, v71
  v_cvt_pk_bf16_f32 v98, v68, v69
  v_exp_f32 v72, v72
  v_exp_f32 v73, v73
  v_cvt_pk_bf16_f32 v99, v70, v71
  v_mfma_f32_32x32x16_bf16 v[80:95], v[44:47], v[204:207], v[80:95]
  v_exp_f32 v74, v74
  v_exp_f32 v75, v75
  ds_read_b128 v[48:51], v3 offset:36864
  v_cvt_pk_bf16_f32 v100, v72, v73
  v_exp_f32 v76, v76
  v_exp_f32 v77, v77
  ds_read_b128 v[52:55], v3 offset:37888
  v_cvt_pk_bf16_f32 v101, v74, v75
  v_exp_f32 v78, v78
  s_add_u32 m0, s31, 66560
  s_add_u32 s29, s53, s27
  s_add_u32 s29, s29, 1024
  buffer_load_dwordx4 v2, s[8:11], s29 offen sc1 lds
  v_exp_f32 v79, v79
  v_cvt_pk_bf16_f32 v102, v76, v77
  v_cvt_pk_bf16_f32 v103, v78, v79
  s_waitcnt lgkmcnt(4)
  v_mfma_f32_32x32x16_bf16 v[112:127], v[56:59], v[96:99], v[112:127]
  v_exp_f32 v80, v80
  v_exp_f32 v81, v81
  v_exp_f32 v82, v82
  v_exp_f32 v83, v83
  v_mfma_f32_32x32x16_bf16 v[112:127], v[60:63], v[100:103], v[112:127]
  v_cvt_pk_bf16_f32 v104, v80, v81
  v_exp_f32 v84, v84
  v_exp_f32 v85, v85
  v_cvt_pk_bf16_f32 v105, v82, v83
  v_exp_f32 v86, v86
  s_waitcnt lgkmcnt(2)
  v_mfma_f32_32x32x16_bf16 v[64:79], v[32:35], v[192:195], 0
  v_exp_f32 v87, v87
  v_cvt_pk_bf16_f32 v106, v84, v85
  v_exp_f32 v88, v88
  v_exp_f32 v89, v89
  v_cvt_pk_bf16_f32 v107, v86, v87
  v_mfma_f32_32x32x16_bf16 v[64:79], v[36:39], v[196:199], v[64:79]
  v_exp_f32 v90, v90
  v_exp_f32 v91, v91
  ds_read_b128 v[40:43], v3 offset:6144
  v_cvt_pk_bf16_f32 v108, v88, v89
  v_exp_f32 v92, v92
  v_exp_f32 v93, v93
  ds_read_b128 v[44:47], v3 offset:7168
  v_cvt_pk_bf16_f32 v109, v90, v91
  v_exp_f32 v94, v94
  v_exp_f32 v95, v95
  v_cvt_pk_bf16_f32 v110, v92, v93
  v_cvt_pk_bf16_f32 v111, v94, v95
  v_mfma_f32_32x32x16_bf16 v[128:143], v[56:59], v[104:107], v[128:143]
  v_exp_f32 v64, v64
  v_exp_f32 v65, v65
  v_exp_f32 v66, v66
  v_exp_f32 v67, v67
  v_mfma_f32_32x32x16_bf16 v[128:143], v[60:63], v[108:111], v[128:143]
  v_cvt_pk_bf16_f32 v96, v64, v65
  v_exp_f32 v68, v68
  v_exp_f32 v69, v69
  v_cvt_pk_bf16_f32 v97, v66, v67
  v_exp_f32 v70, v70
  v_mfma_f32_32x32x16_bf16 v[80:95], v[32:35], v[200:203], 0
  v_exp_f32 v71, v71
  v_cvt_pk_bf16_f32 v98, v68, v69
  v_exp_f32 v72, v72
  v_exp_f32 v73, v73
  v_cvt_pk_bf16_f32 v99, v70, v71
  v_mfma_f32_32x32x16_bf16 v[80:95], v[36:39], v[204:207], v[80:95]
  v_exp_f32 v74, v74
  v_exp_f32 v75, v75
  ds_read_b128 v[56:59], v3 offset:38912
  v_cvt_pk_bf16_f32 v100, v72, v73
  v_exp_f32 v76, v76
  v_exp_f32 v77, v77
  ds_read_b128 v[60:63], v3 offset:39936
  v_cvt_pk_bf16_f32 v101, v74, v75
  v_exp_f32 v78, v78
  s_add_u32 m0, s31, 67584
  s_add_u32 s29, s53, s27
  s_add_u32 s29, s29, 2048
  buffer_load_dwordx4 v2, s[8:11], s29 offen sc1 lds
  v_exp_f32 v79, v79
  v_cvt_pk_bf16_f32 v102, v76, v77
  v_cvt_pk_bf16_f32 v103, v78, v79
  s_waitcnt lgkmcnt(4)
  v_mfma_f32_32x32x16_bf16 v[112:127], v[48:51], v[96:99], v[112:127]
  v_exp_f32 v80, v80
  v_exp_f32 v81, v81
  v_exp_f32 v82, v82
  v_exp_f32 v83, v83
  v_mfma_f32_32x32x16_bf16 v[112:127], v[52:55], v[100:103], v[112:127]
  v_cvt_pk_bf16_f32 v104, v80, v81
  v_exp_f32 v84, v84
  v_exp_f32 v85, v85
  v_cvt_pk_bf16_f32 v105, v82, v83
  v_exp_f32 v86, v86
  s_waitcnt lgkmcnt(2)
  v_mfma_f32_32x32x16_bf16 v[64:79], v[40:43], v[192:195], 0
  v_exp_f32 v87, v87
  v_cvt_pk_bf16_f32 v106, v84, v85
  v_exp_f32 v88, v88
  v_exp_f32 v89, v89
  v_cvt_pk_bf16_f32 v107, v86, v87
  v_mfma_f32_32x32x16_bf16 v[64:79], v[44:47], v[196:199], v[64:79]
  v_exp_f32 v90, v90
  v_exp_f32 v91, v91
  ds_read_b128 v[32:35], v3 offset:8192
  v_cvt_pk_bf16_f32 v108, v88, v89
  v_exp_f32 v92, v92
  v_exp_f32 v93, v93
  ds_read_b128 v[36:39], v3 offset:9216
  v_cvt_pk_bf16_f32 v109, v90, v91
  v_exp_f32 v94, v94
  v_exp_f32 v95, v95
  v_cvt_pk_bf16_f32 v110, v92, v93
  v_cvt_pk_bf16_f32 v111, v94, v95
  v_mfma_f32_32x32x16_bf16 v[128:143], v[48:51], v[104:107], v[128:143]
  v_exp_f32 v64, v64
  v_exp_f32 v65, v65
  v_exp_f32 v66, v66
  v_exp_f32 v67, v67
  v_mfma_f32_32x32x16_bf16 v[128:143], v[52:55], v[108:111], v[128:143]
  v_cvt_pk_bf16_f32 v96, v64, v65
  v_exp_f32 v68, v68
  v_exp_f32 v69, v69
  v_cvt_pk_bf16_f32 v97, v66, v67
  v_exp_f32 v70, v70
  v_mfma_f32_32x32x16_bf16 v[80:95], v[40:43], v[200:203], 0
  v_exp_f32 v71, v71
  v_cvt_pk_bf16_f32 v98, v68, v69
  v_exp_f32 v72, v72
  v_exp_f32 v73, v73
  v_cvt_pk_bf16_f32 v99, v70, v71
  v_mfma_f32_32x32x16_bf16 v[80:95], v[44:47], v[204:207], v[80:95]
  v_exp_f32 v74, v74
  v_exp_f32 v75, v75
  ds_read_b128 v[48:51], v3 offset:40960
  v_cvt_pk_bf16_f32 v100, v72, v73
  v_exp_f32 v76, v76
  v_exp_f32 v77, v77
  ds_read_b128 v[52:55], v3 offset:41984
  v_cvt_pk_bf16_f32 v101, v74, v75
  v_exp_f32 v78, v78
  s_add_u32 m0, s31, 68608
  s_add_u32 s29, s53, s27
  s_add_u32 s29, s29, 3072
  buffer_load_dwordx4 v2, s[8:11], s29 offen sc1 lds
  v_exp_f32 v79, v79
  v_cvt_pk_bf16_f32 v102, v76, v77
  v_cvt_pk_bf16_f32 v103, v78, v79
  s_waitcnt lgkmcnt(4)
  v_mfma_f32_32x32x16_bf16 v[112:127], v[56:59], v[96:99], v[112:127]
  v_exp_f32 v80, v80
  v_exp_f32 v81, v81
  v_exp_f32 v82, v82
  v_exp_f32 v83, v83
  v_mfma_f32_32x32x16_bf16 v[112:127], v[60:63], v[100:103], v[112:127]
  v_cvt_pk_bf16_f32 v104, v80, v81
  v_exp_f32 v84, v84
  v_exp_f32 v85, v85
  v_cvt_pk_bf16_f32 v105, v82, v83
  v_exp_f32 v86, v86
  s_waitcnt lgkmcnt(2)
  v_mfma_f32_32x32x16_bf16 v[64:79], v[32:35], v[192:195], 0
  v_exp_f32 v87, v87
  v_cvt_pk_bf16_f32 v106, v84, v85
  v_exp_f32 v88, v88
  v_exp_f32 v89, v89
  v_cvt_pk_bf16_f32 v107, v86, v87
  v_mfma_f32_32x32x16_bf16 v[64:79], v[36:39], v[196:199], v[64:79]
  v_exp_f32 v90, v90
  v_exp_f32 v91, v91
  ds_read_b128 v[40:43], v3 offset:10240
  v_cvt_pk_bf16_f32 v108, v88, v89
  v_exp_f32 v92, v92
  v_exp_f32 v93, v93
  ds_read_b128 v[44:47], v3 offset:11264
  v_cvt_pk_bf16_f32 v109, v90, v91
  v_exp_f32 v94, v94
  v_exp_f32 v95, v95
  v_cvt_pk_bf16_f32 v110, v92, v93
  v_cvt_pk_bf16_f32 v111, v94, v95
  v_mfma_f32_32x32x16_bf16 v[128:143], v[56:59], v[104:107], v[128:143]
  v_exp_f32 v64, v64
  v_exp_f32 v65, v65
  v_exp_f32 v66, v66
  v_exp_f32 v67, v67
  v_mfma_f32_32x32x16_bf16 v[128:143], v[60:63], v[108:111], v[128:143]
  v_cvt_pk_bf16_f32 v96, v64, v65
  v_exp_f32 v68, v68
  v_exp_f32 v69, v69
  v_cvt_pk_bf16_f32 v97, v66, v67
  v_exp_f32 v70, v70
  v_mfma_f32_32x32x16_bf16 v[80:95], v[32:35], v[200:203], 0
  v_exp_f32 v71, v71
  v_cvt_pk_bf16_f32 v98, v68, v69
  v_exp_f32 v72, v72
  v_exp_f32 v73, v73
  v_cvt_pk_bf16_f32 v99, v70, v71
  v_mfma_f32_32x32x16_bf16 v[80:95], v[36:39], v[204:207], v[80:95]
  v_exp_f32 v74, v74
  v_exp_f32 v75, v75
  ds_read_b128 v[56:59], v3 offset:43008
  v_cvt_pk_bf16_f32 v100, v72, v73
  v_exp_f32 v76, v76
  v_exp_f32 v77, v77
  ds_read_b128 v[60:63], v3 offset:44032
  v_cvt_pk_bf16_f32 v101, v74, v75
  v_exp_f32 v78, v78
  s_add_u32 m0, s31, 69632
  s_add_u32 s29, s53, s27
  s_add_u32 s29, s29, 4096
  buffer_load_dwordx4 v2, s[8:11], s29 offen sc1 lds
  v_exp_f32 v79, v79
  v_cvt_pk_bf16_f32 v102, v76, v77
  v_cvt_pk_bf16_f32 v103, v78, v79
  s_waitcnt lgkmcnt(4)
  v_mfma_f32_32x32x16_bf16 v[112:127], v[48:51], v[96:99], v[112:127]
  v_exp_f32 v80, v80
  v_exp_f32 v81, v81
  v_exp_f32 v82, v82
  v_exp_f32 v83, v83
  v_mfma_f32_32x32x16_bf16 v[112:127], v[52:55], v[100:103], v[112:127]
  v_cvt_pk_bf16_f32 v104, v80, v81
  v_exp_f32 v84, v84
  v_exp_f32 v85, v85
  v_cvt_pk_bf16_f32 v105, v82, v83
  v_exp_f32 v86, v86
  s_waitcnt lgkmcnt(2)
  v_mfma_f32_32x32x16_bf16 v[64:79], v[40:43], v[192:195], 0
  v_exp_f32 v87, v87
  v_cvt_pk_bf16_f32 v106, v84, v85
  v_exp_f32 v88, v88
  v_exp_f32 v89, v89
  v_cvt_pk_bf16_f32 v107, v86, v87
  v_mfma_f32_32x32x16_bf16 v[64:79], v[44:47], v[196:199], v[64:79]
  v_exp_f32 v90, v90
  v_exp_f32 v91, v91
  ds_read_b128 v[32:35], v3 offset:12288
  v_cvt_pk_bf16_f32 v108, v88, v89
  v_exp_f32 v92, v92
  v_exp_f32 v93, v93
  ds_read_b128 v[36:39], v3 offset:13312
  v_cvt_pk_bf16_f32 v109, v90, v91
  v_exp_f32 v94, v94
  v_exp_f32 v95, v95
  v_cvt_pk_bf16_f32 v110, v92, v93
  v_cvt_pk_bf16_f32 v111, v94, v95
  v_mfma_f32_32x32x16_bf16 v[128:143], v[48:51], v[104:107], v[128:143]
  v_exp_f32 v64, v64
  v_exp_f32 v65, v65
  v_exp_f32 v66, v66
  v_exp_f32 v67, v67
  v_mfma_f32_32x32x16_bf16 v[128:143], v[52:55], v[108:111], v[128:143]
  v_cvt_pk_bf16_f32 v96, v64, v65
  v_exp_f32 v68, v68
  v_exp_f32 v69, v69
  v_cvt_pk_bf16_f32 v97, v66, v67
  v_exp_f32 v70, v70
  v_mfma_f32_32x32x16_bf16 v[80:95], v[40:43], v[200:203], 0
  v_exp_f32 v71, v71
  v_cvt_pk_bf16_f32 v98, v68, v69
  v_exp_f32 v72, v72
  v_exp_f32 v73, v73
  v_cvt_pk_bf16_f32 v99, v70, v71
  v_mfma_f32_32x32x16_bf16 v[80:95], v[44:47], v[204:207], v[80:95]
  v_exp_f32 v74, v74
  v_exp_f32 v75, v75
  ds_read_b128 v[48:51], v3 offset:45056
  v_cvt_pk_bf16_f32 v100, v72, v73
  v_exp_f32 v76, v76
  v_exp_f32 v77, v77
  ds_read_b128 v[52:55], v3 offset:46080
  v_cvt_pk_bf16_f32 v101, v74, v75
  v_exp_f32 v78, v78
  s_add_u32 m0, s31, 70656
  s_add_u32 s29, s53, s27
  s_add_u32 s29, s29, 5120
  buffer_load_dwordx4 v2, s[8:11], s29 offen sc1 lds
  v_exp_f32 v79, v79
  v_cvt_pk_bf16_f32 v102, v76, v77
  v_cvt_pk_bf16_f32 v103, v78, v79
  s_waitcnt lgkmcnt(4)
  v_mfma_f32_32x32x16_bf16 v[112:127], v[56:59], v[96:99], v[112:127]
  v_exp_f32 v80, v80
  v_exp_f32 v81, v81
  v_exp_f32 v82, v82
  v_exp_f32 v83, v83
  v_mfma_f32_32x32x16_bf16 v[112:127], v[60:63], v[100:103], v[112:127]
  v_cvt_pk_bf16_f32 v104, v80, v81
  v_exp_f32 v84, v84
  v_exp_f32 v85, v85
  v_cvt_pk_bf16_f32 v105, v82, v83
  v_exp_f32 v86, v86
  s_waitcnt lgkmcnt(2)
  v_mfma_f32_32x32x16_bf16 v[64:79], v[32:35], v[192:195], 0
  v_exp_f32 v87, v87
  v_cvt_pk_bf16_f32 v106, v84, v85
  v_exp_f32 v88, v88
  v_exp_f32 v89, v89
  v_cvt_pk_bf16_f32 v107, v86, v87
  v_mfma_f32_32x32x16_bf16 v[64:79], v[36:39], v[196:199], v[64:79]
  v_exp_f32 v90, v90
  v_exp_f32 v91, v91
  ds_read_b128 v[40:43], v3 offset:14336
  v_cvt_pk_bf16_f32 v108, v88, v89
  v_exp_f32 v92, v92
  v_exp_f32 v93, v93
  ds_read_b128 v[44:47], v3 offset:15360
  v_cvt_pk_bf16_f32 v109, v90, v91
  v_exp_f32 v94, v94
  v_exp_f32 v95, v95
  v_cvt_pk_bf16_f32 v110, v92, v93
  v_cvt_pk_bf16_f32 v111, v94, v95
  v_mfma_f32_32x32x16_bf16 v[128:143], v[56:59], v[104:107], v[128:143]
  v_exp_f32 v64, v64
  v_exp_f32 v65, v65
  v_exp_f32 v66, v66
  v_exp_f32 v67, v67
  v_mfma_f32_32x32x16_bf16 v[128:143], v[60:63], v[108:111], v[128:143]
  v_cvt_pk_bf16_f32 v96, v64, v65
  v_exp_f32 v68, v68
  v_exp_f32 v69, v69
  v_cvt_pk_bf16_f32 v97, v66, v67
  v_exp_f32 v70, v70
  v_mfma_f32_32x32x16_bf16 v[80:95], v[32:35], v[200:203], 0
  v_exp_f32 v71, v71
  v_cvt_pk_bf16_f32 v98, v68, v69
  v_exp_f32 v72, v72
  v_exp_f32 v73, v73
  v_cvt_pk_bf16_f32 v99, v70, v71
  v_mfma_f32_32x32x16_bf16 v[80:95], v[36:39], v[204:207], v[80:95]
  v_exp_f32 v74, v74
  v_exp_f32 v75, v75
  ds_read_b128 v[56:59], v3 offset:47104
  v_cvt_pk_bf16_f32 v100, v72, v73
  v_exp_f32 v76, v76
  v_exp_f32 v77, v77
  ds_read_b128 v[60:63], v3 offset:48128
  v_cvt_pk_bf16_f32 v101, v74, v75
  v_exp_f32 v78, v78
  s_add_u32 m0, s31, 71680
  s_add_u32 s29, s53, s27
  s_add_u32 s29, s29, 6144
  buffer_load_dwordx4 v2, s[8:11], s29 offen sc1 lds
  v_exp_f32 v79, v79
  v_cvt_pk_bf16_f32 v102, v76, v77
  v_cvt_pk_bf16_f32 v103, v78, v79
  s_waitcnt lgkmcnt(4)
  v_mfma_f32_32x32x16_bf16 v[112:127], v[48:51], v[96:99], v[112:127]
  v_exp_f32 v80, v80
  v_exp_f32 v81, v81
  v_exp_f32 v82, v82
  v_exp_f32 v83, v83
  v_mfma_f32_32x32x16_bf16 v[112:127], v[52:55], v[100:103], v[112:127]
  v_cvt_pk_bf16_f32 v104, v80, v81
  v_exp_f32 v84, v84
  v_exp_f32 v85, v85
  v_cvt_pk_bf16_f32 v105, v82, v83
  v_exp_f32 v86, v86
  s_waitcnt lgkmcnt(2)
  v_mfma_f32_32x32x16_bf16 v[64:79], v[40:43], v[192:195], 0
  v_exp_f32 v87, v87
  v_cvt_pk_bf16_f32 v106, v84, v85
  v_exp_f32 v88, v88
  v_exp_f32 v89, v89
  v_cvt_pk_bf16_f32 v107, v86, v87
  v_mfma_f32_32x32x16_bf16 v[64:79], v[44:47], v[196:199], v[64:79]
  v_exp_f32 v90, v90
  v_exp_f32 v91, v91
  ds_read_b128 v[32:35], v3 offset:16384
  v_cvt_pk_bf16_f32 v108, v88, v89
  v_exp_f32 v92, v92
  v_exp_f32 v93, v93
  ds_read_b128 v[36:39], v3 offset:17408
  v_cvt_pk_bf16_f32 v109, v90, v91
  v_exp_f32 v94, v94
  v_exp_f32 v95, v95
  v_cvt_pk_bf16_f32 v110, v92, v93
  v_cvt_pk_bf16_f32 v111, v94, v95
  v_mfma_f32_32x32x16_bf16 v[128:143], v[48:51], v[104:107], v[128:143]
  v_exp_f32 v64, v64
  v_exp_f32 v65, v65
  v_exp_f32 v66, v66
  v_exp_f32 v67, v67
  v_mfma_f32_32x32x16_bf16 v[128:143], v[52:55], v[108:111], v[128:143]
  v_cvt_pk_bf16_f32 v96, v64, v65
  v_exp_f32 v68, v68
  v_exp_f32 v69, v69
  v_cvt_pk_bf16_f32 v97, v66, v67
  v_exp_f32 v70, v70
  v_mfma_f32_32x32x16_bf16 v[80:95], v[40:43], v[200:203], 0
  v_exp_f32 v71, v71
  v_cvt_pk_bf16_f32 v98, v68, v69
  v_exp_f32 v72, v72
  v_exp_f32 v73, v73
  v_cvt_pk_bf16_f32 v99, v70, v71
  v_mfma_f32_32x32x16_bf16 v[80:95], v[44:47], v[204:207], v[80:95]
  v_exp_f32 v74, v74
  v_exp_f32 v75, v75
  ds_read_b128 v[48:51], v3 offset:49152
  v_cvt_pk_bf16_f32 v100, v72, v73
  v_exp_f32 v76, v76
  v_exp_f32 v77, v77
  ds_read_b128 v[52:55], v3 offset:50176
  v_cvt_pk_bf16_f32 v101, v74, v75
  v_exp_f32 v78, v78
  s_add_u32 m0, s31, 72704
  s_add_u32 s29, s53, s27
  s_add_u32 s29, s29, 7168
  buffer_load_dwordx4 v2, s[8:11], s29 offen sc1 lds
  v_exp_f32 v79, v79
  v_cvt_pk_bf16_f32 v102, v76, v77
  v_cvt_pk_bf16_f32 v103, v78, v79
  s_waitcnt lgkmcnt(4)
  v_mfma_f32_32x32x16_bf16 v[112:127], v[56:59], v[96:99], v[112:127]
  v_exp_f32 v80, v80
  v_exp_f32 v81, v81
  v_exp_f32 v82, v82
  v_exp_f32 v83, v83
  v_mfma_f32_32x32x16_bf16 v[112:127], v[60:63], v[100:103], v[112:127]
  v_cvt_pk_bf16_f32 v104, v80, v81
  v_exp_f32 v84, v84
  v_exp_f32 v85, v85
  v_cvt_pk_bf16_f32 v105, v82, v83
  v_exp_f32 v86, v86
  s_waitcnt lgkmcnt(2)
  v_mfma_f32_32x32x16_bf16 v[64:79], v[32:35], v[192:195], 0
  v_exp_f32 v87, v87
  v_cvt_pk_bf16_f32 v106, v84, v85
  v_exp_f32 v88, v88
  v_exp_f32 v89, v89
  v_cvt_pk_bf16_f32 v107, v86, v87
  v_mfma_f32_32x32x16_bf16 v[64:79], v[36:39], v[196:199], v[64:79]
  v_exp_f32 v90, v90
  v_exp_f32 v91, v91
  ds_read_b128 v[40:43], v3 offset:18432
  v_cvt_pk_bf16_f32 v108, v88, v89
  v_exp_f32 v92, v92
  v_exp_f32 v93, v93
  ds_read_b128 v[44:47], v3 offset:19456
  v_cvt_pk_bf16_f32 v109, v90, v91
  v_exp_f32 v94, v94
  v_exp_f32 v95, v95
  v_cvt_pk_bf16_f32 v110, v92, v93
  v_cvt_pk_bf16_f32 v111, v94, v95
  v_mfma_f32_32x32x16_bf16 v[128:143], v[56:59], v[104:107], v[128:143]
  v_exp_f32 v64, v64
  v_exp_f32 v65, v65
  v_exp_f32 v66, v66
  v_exp_f32 v67, v67
  v_mfma_f32_32x32x16_bf16 v[128:143], v[60:63], v[108:111], v[128:143]
  v_cvt_pk_bf16_f32 v96, v64, v65
  v_exp_f32 v68, v68
  v_exp_f32 v69, v69
  v_cvt_pk_bf16_f32 v97, v66, v67
  v_exp_f32 v70, v70
  v_mfma_f32_32x32x16_bf16 v[80:95], v[32:35], v[200:203], 0
  v_exp_f32 v71, v71
  v_cvt_pk_bf16_f32 v98, v68, v69
  v_exp_f32 v72, v72
  v_exp_f32 v73, v73
  v_cvt_pk_bf16_f32 v99, v70, v71
  v_mfma_f32_32x32x16_bf16 v[80:95], v[36:39], v[204:207], v[80:95]
  v_exp_f32 v74, v74
  v_exp_f32 v75, v75
  ds_read_b128 v[56:59], v3 offset:51200
  v_cvt_pk_bf16_f32 v100, v72, v73
  v_exp_f32 v76, v76
  v_exp_f32 v77, v77
  ds_read_b128 v[60:63], v3 offset:52224
  v_cvt_pk_bf16_f32 v101, v74, v75
  v_exp_f32 v78, v78
  s_add_u32 m0, s31, 98304
  s_add_u32 s29, s53, s28
  s_add_u32 s29, s29, 0
  buffer_load_dwordx4 v2, s[8:11], s29 offen sc1 lds
  v_exp_f32 v79, v79
  v_cvt_pk_bf16_f32 v102, v76, v77
  v_cvt_pk_bf16_f32 v103, v78, v79
  s_waitcnt lgkmcnt(4)
  v_mfma_f32_32x32x16_bf16 v[112:127], v[48:51], v[96:99], v[112:127]
  v_exp_f32 v80, v80
  v_exp_f32 v81, v81
  v_exp_f32 v82, v82
  v_exp_f32 v83, v83
  v_mfma_f32_32x32x16_bf16 v[112:127], v[52:55], v[100:103], v[112:127]
  v_cvt_pk_bf16_f32 v104, v80, v81
  v_exp_f32 v84, v84
  v_exp_f32 v85, v85
  v_cvt_pk_bf16_f32 v105, v82, v83
  v_exp_f32 v86, v86
  s_waitcnt lgkmcnt(2)
  v_mfma_f32_32x32x16_bf16 v[64:79], v[40:43], v[192:195], 0
  v_exp_f32 v87, v87
  v_cvt_pk_bf16_f32 v106, v84, v85
  v_exp_f32 v88, v88
  v_exp_f32 v89, v89
  v_cvt_pk_bf16_f32 v107, v86, v87
  v_mfma_f32_32x32x16_bf16 v[64:79], v[44:47], v[196:199], v[64:79]
  v_exp_f32 v90, v90
  v_exp_f32 v91, v91
  ds_read_b128 v[32:35], v3 offset:20480
  v_cvt_pk_bf16_f32 v108, v88, v89
  v_exp_f32 v92, v92
  v_exp_f32 v93, v93
  ds_read_b128 v[36:39], v3 offset:21504
  v_cvt_pk_bf16_f32 v109, v90, v91
  v_exp_f32 v94, v94
  v_exp_f32 v95, v95
  v_cvt_pk_bf16_f32 v110, v92, v93
  v_cvt_pk_bf16_f32 v111, v94, v95
  v_mfma_f32_32x32x16_bf16 v[128:143], v[48:51], v[104:107], v[128:143]
  v_exp_f32 v64, v64
  v_exp_f32 v65, v65
  v_exp_f32 v66, v66
  v_exp_f32 v67, v67
  v_mfma_f32_32x32x16_bf16 v[128:143], v[52:55], v[108:111], v[128:143]
  v_cvt_pk_bf16_f32 v96, v64, v65
  v_exp_f32 v68, v68
  v_exp_f32 v69, v69
  v_cvt_pk_bf16_f32 v97, v66, v67
  v_exp_f32 v70, v70
  v_mfma_f32_32x32x16_bf16 v[80:95], v[40:43], v[200:203], 0
  v_exp_f32 v71, v71
  v_cvt_pk_bf16_f32 v98, v68, v69
  v_exp_f32 v72, v72
  v_exp_f32 v73, v73
  v_cvt_pk_bf16_f32 v99, v70, v71
  v_mfma_f32_32x32x16_bf16 v[80:95], v[44:47], v[204:207], v[80:95]
  v_exp_f32 v74, v74
  v_exp_f32 v75, v75
  ds_read_b128 v[48:51], v3 offset:53248
  v_cvt_pk_bf16_f32 v100, v72, v73
  v_exp_f32 v76, v76
  v_exp_f32 v77, v77
  ds_read_b128 v[52:55], v3 offset:54272
  v_cvt_pk_bf16_f32 v101, v74, v75
  v_exp_f32 v78, v78
  s_add_u32 m0, s31, 99328
  s_add_u32 s29, s53, s28
  s_add_u32 s29, s29, 1024
  buffer_load_dwordx4 v2, s[8:11], s29 offen sc1 lds
  v_exp_f32 v79, v79
  v_cvt_pk_bf16_f32 v102, v76, v77
  v_cvt_pk_bf16_f32 v103, v78, v79
  s_waitcnt lgkmcnt(4)
  v_mfma_f32_32x32x16_bf16 v[112:127], v[56:59], v[96:99], v[112:127]
  v_exp_f32 v80, v80
  v_exp_f32 v81, v81
  v_exp_f32 v82, v82
  v_exp_f32 v83, v83
  v_mfma_f32_32x32x16_bf16 v[112:127], v[60:63], v[100:103], v[112:127]
  v_cvt_pk_bf16_f32 v104, v80, v81
  v_exp_f32 v84, v84
  v_exp_f32 v85, v85
  v_cvt_pk_bf16_f32 v105, v82, v83
  v_exp_f32 v86, v86
  s_waitcnt lgkmcnt(2)
  v_mfma_f32_32x32x16_bf16 v[64:79], v[32:35], v[192:195], 0
  v_exp_f32 v87, v87
  v_cvt_pk_bf16_f32 v106, v84, v85
  v_exp_f32 v88, v88
  v_exp_f32 v89, v89
  v_cvt_pk_bf16_f32 v107, v86, v87
  v_mfma_f32_32x32x16_bf16 v[64:79], v[36:39], v[196:199], v[64:79]
  v_exp_f32 v90, v90
  v_exp_f32 v91, v91
  ds_read_b128 v[40:43], v3 offset:22528
  v_cvt_pk_bf16_f32 v108, v88, v89
  v_exp_f32 v92, v92
  v_exp_f32 v93, v93
  ds_read_b128 v[44:47], v3 offset:23552
  v_cvt_pk_bf16_f32 v109, v90, v91
  v_exp_f32 v94, v94
  v_exp_f32 v95, v95
  v_cvt_pk_bf16_f32 v110, v92, v93
  v_cvt_pk_bf16_f32 v111, v94, v95
  v_mfma_f32_32x32x16_bf16 v[128:143], v[56:59], v[104:107], v[128:143]
  v_exp_f32 v64, v64
  v_exp_f32 v65, v65
  v_exp_f32 v66, v66
  v_exp_f32 v67, v67
  v_mfma_f32_32x32x16_bf16 v[128:143], v[60:63], v[108:111], v[128:143]
  v_cvt_pk_bf16_f32 v96, v64, v65
  v_exp_f32 v68, v68
  v_exp_f32 v69, v69
  v_cvt_pk_bf16_f32 v97, v66, v67
  v_exp_f32 v70, v70
  v_mfma_f32_32x32x16_bf16 v[80:95], v[32:35], v[200:203], 0
  v_exp_f32 v71, v71
  v_cvt_pk_bf16_f32 v98, v68, v69
  v_exp_f32 v72, v72
  v_exp_f32 v73, v73
  v_cvt_pk_bf16_f32 v99, v70, v71
  v_mfma_f32_32x32x16_bf16 v[80:95], v[36:39], v[204:207], v[80:95]
  v_exp_f32 v74, v74
  v_exp_f32 v75, v75
  ds_read_b128 v[56:59], v3 offset:55296
  v_cvt_pk_bf16_f32 v100, v72, v73
  v_exp_f32 v76, v76
  v_exp_f32 v77, v77
  ds_read_b128 v[60:63], v3 offset:56320
  v_cvt_pk_bf16_f32 v101, v74, v75
  v_exp_f32 v78, v78
  s_add_u32 m0, s31, 100352
  s_add_u32 s29, s53, s28
  s_add_u32 s29, s29, 2048
  buffer_load_dwordx4 v2, s[8:11], s29 offen sc1 lds
  v_exp_f32 v79, v79
  v_cvt_pk_bf16_f32 v102, v76, v77
  v_cvt_pk_bf16_f32 v103, v78, v79
  s_waitcnt lgkmcnt(4)
  v_mfma_f32_32x32x16_bf16 v[112:127], v[48:51], v[96:99], v[112:127]
  v_exp_f32 v80, v80
  v_exp_f32 v81, v81
  v_exp_f32 v82, v82
  v_exp_f32 v83, v83
  v_mfma_f32_32x32x16_bf16 v[112:127], v[52:55], v[100:103], v[112:127]
  v_cvt_pk_bf16_f32 v104, v80, v81
  v_exp_f32 v84, v84
  v_exp_f32 v85, v85
  v_cvt_pk_bf16_f32 v105, v82, v83
  v_exp_f32 v86, v86
  s_waitcnt lgkmcnt(2)
  v_mfma_f32_32x32x16_bf16 v[64:79], v[40:43], v[192:195], 0
  v_exp_f32 v87, v87
  v_cvt_pk_bf16_f32 v106, v84, v85
  v_exp_f32 v88, v88
  v_exp_f32 v89, v89
  v_cvt_pk_bf16_f32 v107, v86, v87
  v_mfma_f32_32x32x16_bf16 v[64:79], v[44:47], v[196:199], v[64:79]
  v_exp_f32 v90, v90
  v_exp_f32 v91, v91
  ds_read_b128 v[32:35], v3 offset:24576
  v_cvt_pk_bf16_f32 v108, v88, v89
  v_exp_f32 v92, v92
  v_exp_f32 v93, v93
  ds_read_b128 v[36:39], v3 offset:25600
  v_cvt_pk_bf16_f32 v109, v90, v91
  v_exp_f32 v94, v94
  v_exp_f32 v95, v95
  v_cvt_pk_bf16_f32 v110, v92, v93
  v_cvt_pk_bf16_f32 v111, v94, v95
  v_mfma_f32_32x32x16_bf16 v[128:143], v[48:51], v[104:107], v[128:143]
  v_exp_f32 v64, v64
  v_exp_f32 v65, v65
  v_exp_f32 v66, v66
  v_exp_f32 v67, v67
  v_mfma_f32_32x32x16_bf16 v[128:143], v[52:55], v[108:111], v[128:143]
  v_cvt_pk_bf16_f32 v96, v64, v65
  v_exp_f32 v68, v68
  v_exp_f32 v69, v69
  v_cvt_pk_bf16_f32 v97, v66, v67
  v_exp_f32 v70, v70
  v_mfma_f32_32x32x16_bf16 v[80:95], v[40:43], v[200:203], 0
  v_exp_f32 v71, v71
  v_cvt_pk_bf16_f32 v98, v68, v69
  v_exp_f32 v72, v72
  v_exp_f32 v73, v73
  v_cvt_pk_bf16_f32 v99, v70, v71
  v_mfma_f32_32x32x16_bf16 v[80:95], v[44:47], v[204:207], v[80:95]
  v_exp_f32 v74, v74
  v_exp_f32 v75, v75
  ds_read_b128 v[48:51], v3 offset:57344
  v_cvt_pk_bf16_f32 v100, v72, v73
  v_exp_f32 v76, v76
  v_exp_f32 v77, v77
  ds_read_b128 v[52:55], v3 offset:58368
  v_cvt_pk_bf16_f32 v101, v74, v75
  v_exp_f32 v78, v78
  s_add_u32 m0, s31, 101376
  s_add_u32 s29, s53, s28
  s_add_u32 s29, s29, 3072
  buffer_load_dwordx4 v2, s[8:11], s29 offen sc1 lds
  v_exp_f32 v79, v79
  v_cvt_pk_bf16_f32 v102, v76, v77
  v_cvt_pk_bf16_f32 v103, v78, v79
  s_waitcnt lgkmcnt(4)
  v_mfma_f32_32x32x16_bf16 v[112:127], v[56:59], v[96:99], v[112:127]
  v_exp_f32 v80, v80
  v_exp_f32 v81, v81
  v_exp_f32 v82, v82
  v_exp_f32 v83, v83
  v_mfma_f32_32x32x16_bf16 v[112:127], v[60:63], v[100:103], v[112:127]
  v_cvt_pk_bf16_f32 v104, v80, v81
  v_exp_f32 v84, v84
  v_exp_f32 v85, v85
  v_cvt_pk_bf16_f32 v105, v82, v83
  v_exp_f32 v86, v86
  s_waitcnt lgkmcnt(2)
  v_mfma_f32_32x32x16_bf16 v[64:79], v[32:35], v[192:195], 0
  v_exp_f32 v87, v87
  v_cvt_pk_bf16_f32 v106, v84, v85
  v_exp_f32 v88, v88
  v_exp_f32 v89, v89
  v_cvt_pk_bf16_f32 v107, v86, v87
  v_mfma_f32_32x32x16_bf16 v[64:79], v[36:39], v[196:199], v[64:79]
  v_exp_f32 v90, v90
  v_exp_f32 v91, v91
  ds_read_b128 v[40:43], v3 offset:26624
  v_cvt_pk_bf16_f32 v108, v88, v89
  v_exp_f32 v92, v92
  v_exp_f32 v93, v93
  ds_read_b128 v[44:47], v3 offset:27648
  v_cvt_pk_bf16_f32 v109, v90, v91
  v_exp_f32 v94, v94
  v_exp_f32 v95, v95
  v_cvt_pk_bf16_f32 v110, v92, v93
  v_cvt_pk_bf16_f32 v111, v94, v95
  v_mfma_f32_32x32x16_bf16 v[128:143], v[56:59], v[104:107], v[128:143]
  v_exp_f32 v64, v64
  v_exp_f32 v65, v65
  v_exp_f32 v66, v66
  v_exp_f32 v67, v67
  v_mfma_f32_32x32x16_bf16 v[128:143], v[60:63], v[108:111], v[128:143]
  v_cvt_pk_bf16_f32 v96, v64, v65
  v_exp_f32 v68, v68
  v_exp_f32 v69, v69
  v_cvt_pk_bf16_f32 v97, v66, v67
  v_exp_f32 v70, v70
  v_mfma_f32_32x32x16_bf16 v[80:95], v[32:35], v[200:203], 0
  v_exp_f32 v71, v71
  v_cvt_pk_bf16_f32 v98, v68, v69
  v_exp_f32 v72, v72
  v_exp_f32 v73, v73
  v_cvt_pk_bf16_f32 v99, v70, v71
  v_mfma_f32_32x32x16_bf16 v[80:95], v[36:39], v[204:207], v[80:95]
  v_exp_f32 v74, v74
  v_exp_f32 v75, v75
  ds_read_b128 v[56:59], v3 offset:59392
  v_cvt_pk_bf16_f32 v100, v72, v73
  v_exp_f32 v76, v76
  v_exp_f32 v77, v77
  ds_read_b128 v[60:63], v3 offset:60416
  v_cvt_pk_bf16_f32 v101, v74, v75
  v_exp_f32 v78, v78
  s_add_u32 m0, s31, 102400
  s_add_u32 s29, s53, s28
  s_add_u32 s29, s29, 4096
  buffer_load_dwordx4 v2, s[8:11], s29 offen sc1 lds
  v_exp_f32 v79, v79
  v_cvt_pk_bf16_f32 v102, v76, v77
  v_cvt_pk_bf16_f32 v103, v78, v79
  s_waitcnt lgkmcnt(4)
  v_mfma_f32_32x32x16_bf16 v[112:127], v[48:51], v[96:99], v[112:127]
  v_exp_f32 v80, v80
  v_exp_f32 v81, v81
  v_exp_f32 v82, v82
  v_exp_f32 v83, v83
  v_mfma_f32_32x32x16_bf16 v[112:127], v[52:55], v[100:103], v[112:127]
  v_cvt_pk_bf16_f32 v104, v80, v81
  v_exp_f32 v84, v84
  v_exp_f32 v85, v85
  v_cvt_pk_bf16_f32 v105, v82, v83
  v_exp_f32 v86, v86
  s_waitcnt lgkmcnt(2)
  v_mfma_f32_32x32x16_bf16 v[64:79], v[40:43], v[192:195], 0
  v_exp_f32 v87, v87
  v_cvt_pk_bf16_f32 v106, v84, v85
  v_exp_f32 v88, v88
  v_exp_f32 v89, v89
  v_cvt_pk_bf16_f32 v107, v86, v87
  v_mfma_f32_32x32x16_bf16 v[64:79], v[44:47], v[196:199], v[64:79]
  v_exp_f32 v90, v90
  v_exp_f32 v91, v91
  ds_read_b128 v[32:35], v3 offset:28672
  v_cvt_pk_bf16_f32 v108, v88, v89
  v_exp_f32 v92, v92
  v_exp_f32 v93, v93
  ds_read_b128 v[36:39], v3 offset:29696
  v_cvt_pk_bf16_f32 v109, v90, v91
  v_exp_f32 v94, v94
  v_exp_f32 v95, v95
  v_cvt_pk_bf16_f32 v110, v92, v93
  v_cvt_pk_bf16_f32 v111, v94, v95
  v_mfma_f32_32x32x16_bf16 v[128:143], v[48:51], v[104:107], v[128:143]
  v_exp_f32 v64, v64
  v_exp_f32 v65, v65
  v_exp_f32 v66, v66
  v_exp_f32 v67, v67
  v_mfma_f32_32x32x16_bf16 v[128:143], v[52:55], v[108:111], v[128:143]
  v_cvt_pk_bf16_f32 v96, v64, v65
  v_exp_f32 v68, v68
  v_exp_f32 v69, v69
  v_cvt_pk_bf16_f32 v97, v66, v67
  v_exp_f32 v70, v70
  v_mfma_f32_32x32x16_bf16 v[80:95], v[40:43], v[200:203], 0
  v_exp_f32 v71, v71
  v_cvt_pk_bf16_f32 v98, v68, v69
  v_exp_f32 v72, v72
  v_exp_f32 v73, v73
  v_cvt_pk_bf16_f32 v99, v70, v71
  v_mfma_f32_32x32x16_bf16 v[80:95], v[44:47], v[204:207], v[80:95]
  v_exp_f32 v74, v74
  v_exp_f32 v75, v75
  ds_read_b128 v[48:51], v3 offset:61440
  v_cvt_pk_bf16_f32 v100, v72, v73
  v_exp_f32 v76, v76
  v_exp_f32 v77, v77
  ds_read_b128 v[52:55], v3 offset:62464
  v_cvt_pk_bf16_f32 v101, v74, v75
  v_exp_f32 v78, v78
  s_add_u32 m0, s31, 103424
  s_add_u32 s29, s53, s28
  s_add_u32 s29, s29, 5120
  buffer_load_dwordx4 v2, s[8:11], s29 offen sc1 lds
  v_exp_f32 v79, v79
  v_cvt_pk_bf16_f32 v102, v76, v77
  v_cvt_pk_bf16_f32 v103, v78, v79
  s_waitcnt lgkmcnt(4)
  v_mfma_f32_32x32x16_bf16 v[112:127], v[56:59], v[96:99], v[112:127]
  v_exp_f32 v80, v80
  v_exp_f32 v81, v81
  v_exp_f32 v82, v82
  v_exp_f32 v83, v83
  v_mfma_f32_32x32x16_bf16 v[112:127], v[60:63], v[100:103], v[112:127]
  v_cvt_pk_bf16_f32 v104, v80, v81
  v_exp_f32 v84, v84
  v_exp_f32 v85, v85
  v_cvt_pk_bf16_f32 v105, v82, v83
  v_exp_f32 v86, v86
  s_waitcnt lgkmcnt(2)
  v_mfma_f32_32x32x16_bf16 v[64:79], v[32:35], v[192:195], 0
  v_exp_f32 v87, v87
  v_cvt_pk_bf16_f32 v106, v84, v85
  v_exp_f32 v88, v88
  v_exp_f32 v89, v89
  v_cvt_pk_bf16_f32 v107, v86, v87
  v_mfma_f32_32x32x16_bf16 v[64:79], v[36:39], v[196:199], v[64:79]
  v_exp_f32 v90, v90
  v_exp_f32 v91, v91
  ds_read_b128 v[40:43], v3 offset:30720
  v_cvt_pk_bf16_f32 v108, v88, v89
  v_exp_f32 v92, v92
  v_exp_f32 v93, v93
  ds_read_b128 v[44:47], v3 offset:31744
  v_cvt_pk_bf16_f32 v109, v90, v91
  v_exp_f32 v94, v94
  v_exp_f32 v95, v95
  v_cvt_pk_bf16_f32 v110, v92, v93
  v_cvt_pk_bf16_f32 v111, v94, v95
  v_mfma_f32_32x32x16_bf16 v[128:143], v[56:59], v[104:107], v[128:143]
  v_exp_f32 v64, v64
  v_exp_f32 v65, v65
  v_exp_f32 v66, v66
  v_exp_f32 v67, v67
  v_mfma_f32_32x32x16_bf16 v[128:143], v[60:63], v[108:111], v[128:143]
  v_cvt_pk_bf16_f32 v96, v64, v65
  v_exp_f32 v68, v68
  v_exp_f32 v69, v69
  v_cvt_pk_bf16_f32 v97, v66, v67
  v_exp_f32 v70, v70
  v_mfma_f32_32x32x16_bf16 v[80:95], v[32:35], v[200:203], 0
  v_exp_f32 v71, v71
  v_cvt_pk_bf16_f32 v98, v68, v69
  v_exp_f32 v72, v72
  v_exp_f32 v73, v73
  v_cvt_pk_bf16_f32 v99, v70, v71
  v_mfma_f32_32x32x16_bf16 v[80:95], v[36:39], v[204:207], v[80:95]
  v_exp_f32 v74, v74
  v_exp_f32 v75, v75
  ds_read_b128 v[56:59], v3 offset:63488
  v_cvt_pk_bf16_f32 v100, v72, v73
  v_exp_f32 v76, v76
  v_exp_f32 v77, v77
  ds_read_b128 v[60:63], v3 offset:64512
  v_cvt_pk_bf16_f32 v101, v74, v75
  v_exp_f32 v78, v78
  s_add_u32 m0, s31, 104448
  s_add_u32 s29, s53, s28
  s_add_u32 s29, s29, 6144
  buffer_load_dwordx4 v2, s[8:11], s29 offen sc1 lds
  v_exp_f32 v79, v79
  v_cvt_pk_bf16_f32 v102, v76, v77
  v_cvt_pk_bf16_f32 v103, v78, v79
  s_waitcnt lgkmcnt(4)
  v_mfma_f32_32x32x16_bf16 v[112:127], v[48:51], v[96:99], v[112:127]
  v_exp_f32 v80, v80
  v_exp_f32 v81, v81
  v_exp_f32 v82, v82
  v_exp_f32 v83, v83
  v_mfma_f32_32x32x16_bf16 v[112:127], v[52:55], v[100:103], v[112:127]
  v_cvt_pk_bf16_f32 v104, v80, v81
  v_exp_f32 v84, v84
  v_exp_f32 v85, v85
  v_cvt_pk_bf16_f32 v105, v82, v83
  v_exp_f32 v86, v86
  s_waitcnt lgkmcnt(2)
  v_mfma_f32_32x32x16_bf16 v[64:79], v[40:43], v[192:195], 0
  v_exp_f32 v87, v87
  v_cvt_pk_bf16_f32 v106, v84, v85
  v_exp_f32 v88, v88
  v_exp_f32 v89, v89
  v_cvt_pk_bf16_f32 v107, v86, v87
  v_mfma_f32_32x32x16_bf16 v[64:79], v[44:47], v[196:199], v[64:79]
  v_exp_f32 v90, v90
  v_exp_f32 v91, v91
  v_cvt_pk_bf16_f32 v108, v88, v89
  v_exp_f32 v92, v92
  v_exp_f32 v93, v93
  v_cvt_pk_bf16_f32 v109, v90, v91
  v_exp_f32 v94, v94
  v_exp_f32 v95, v95
  v_cvt_pk_bf16_f32 v110, v92, v93
  v_cvt_pk_bf16_f32 v111, v94, v95
  v_mfma_f32_32x32x16_bf16 v[128:143], v[48:51], v[104:107], v[128:143]
  v_exp_f32 v64, v64
  v_exp_f32 v65, v65
  v_exp_f32 v66, v66
  v_exp_f32 v67, v67
  v_mfma_f32_32x32x16_bf16 v[128:143], v[52:55], v[108:111], v[128:143]
  v_cvt_pk_bf16_f32 v96, v64, v65
  v_exp_f32 v68, v68
  v_exp_f32 v69, v69
  v_cvt_pk_bf16_f32 v97, v66, v67
  v_exp_f32 v70, v70
  v_mfma_f32_32x32x16_bf16 v[80:95], v[40:43], v[200:203], 0
  v_exp_f32 v71, v71
  v_cvt_pk_bf16_f32 v98, v68, v69
  v_exp_f32 v72, v72
  v_exp_f32 v73, v73
  v_cvt_pk_bf16_f32 v99, v70, v71
  v_mfma_f32_32x32x16_bf16 v[80:95], v[44:47], v[204:207], v[80:95]
  v_exp_f32 v74, v74
  v_exp_f32 v75, v75
  v_cvt_pk_bf16_f32 v100, v72, v73
  v_exp_f32 v76, v76
  v_exp_f32 v77, v77
  v_cvt_pk_bf16_f32 v101, v74, v75
  v_exp_f32 v78, v78
  s_add_u32 m0, s31, 105472
  s_add_u32 s29, s53, s28
  s_add_u32 s29, s29, 7168
  buffer_load_dwordx4 v2, s[8:11], s29 offen sc1 lds
  v_exp_f32 v79, v79
  v_cvt_pk_bf16_f32 v102, v76, v77
  v_cvt_pk_bf16_f32 v103, v78, v79
  s_waitcnt lgkmcnt(0)
  v_mfma_f32_32x32x16_bf16 v[112:127], v[56:59], v[96:99], v[112:127]
  v_exp_f32 v80, v80
  v_exp_f32 v81, v81
  v_exp_f32 v82, v82
  v_exp_f32 v83, v83
  v_mfma_f32_32x32x16_bf16 v[112:127], v[60:63], v[100:103], v[112:127]
  v_cvt_pk_bf16_f32 v104, v80, v81
  v_exp_f32 v84, v84
  v_exp_f32 v85, v85
  v_cvt_pk_bf16_f32 v105, v82, v83
  v_exp_f32 v86, v86
  v_exp_f32 v87, v87
  v_cvt_pk_bf16_f32 v106, v84, v85
  v_exp_f32 v88, v88
  v_exp_f32 v89, v89
  v_cvt_pk_bf16_f32 v107, v86, v87
  v_exp_f32 v90, v90
  v_exp_f32 v91, v91
  v_cvt_pk_bf16_f32 v108, v88, v89
  v_exp_f32 v92, v92
  v_exp_f32 v93, v93
  v_cvt_pk_bf16_f32 v109, v90, v91
  v_exp_f32 v94, v94
  v_exp_f32 v95, v95
  v_cvt_pk_bf16_f32 v110, v92, v93
  v_cvt_pk_bf16_f32 v111, v94, v95
  s_nop 1
  v_mfma_f32_32x32x16_bf16 v[128:143], v[56:59], v[104:107], v[128:143]
  v_mfma_f32_32x32x16_bf16 v[128:143], v[60:63], v[108:111], v[128:143]
  s_waitcnt vmcnt(0)
  s_barrier
  s_add_u32 s41, s41, 1
  s_min_u32 s29, s41, 3
  s_mul_i32 s53, s29, 32768
  s_lshl_b32 s31, s21, 13
  s_add_u32 s53, s53, s31
  ds_read_b128 v[32:35], v4 offset:0
  ds_read_b128 v[36:39], v4 offset:1024
  ds_read_b128 v[48:51], v4 offset:32768
  ds_read_b128 v[52:55], v4 offset:33792
  ds_read_b128 v[40:43], v4 offset:2048
  ds_read_b128 v[44:47], v4 offset:3072
  s_waitcnt lgkmcnt(4)
  v_mfma_f32_32x32x16_bf16 v[64:79], v[32:35], v[192:195], 0
  v_mfma_f32_32x32x16_bf16 v[64:79], v[36:39], v[196:199], v[64:79]
  s_nop 11
  v_exp_f32 v64, v64
  v_exp_f32 v65, v65
  v_exp_f32 v66, v66
  v_exp_f32 v67, v67
  v_cvt_pk_bf16_f32 v96, v64, v65
  v_exp_f32 v68, v68
  v_exp_f32 v69, v69
  v_cvt_pk_bf16_f32 v97, v66, v67
  v_exp_f32 v70, v70
  v_mfma_f32_32x32x16_bf16 v[80:95], v[32:35], v[200:203], 0
  v_exp_f32 v71, v71
  v_cvt_pk_bf16_f32 v98, v68, v69
  v_exp_f32 v72, v72
  v_exp_f32 v73, v73
  v_cvt_pk_bf16_f32 v99, v70, v71
  v_mfma_f32_32x32x16_bf16 v[80:95], v[36:39], v[204:207], v[80:95]
  v_exp_f32 v74, v74
  v_exp_f32 v75, v75
  ds_read_b128 v[56:59], v4 offset:34816
  v_cvt_pk_bf16_f32 v100, v72, v73
  v_exp_f32 v76, v76
  v_exp_f32 v77, v77
  ds_read_b128 v[60:63], v4 offset:35840
  v_cvt_pk_bf16_f32 v101, v74, v75
  v_exp_f32 v78, v78
  s_add_u32 m0, s31, 0
  s_add_u32 s29, s53, s27
  s_add_u32 s29, s29, 0
  buffer_load_dwordx4 v2, s[8:11], s29 offen sc1 lds
  v_exp_f32 v79, v79
  v_cvt_pk_bf16_f32 v102, v76, v77
  v_cvt_pk_bf16_f32 v103, v78, v79
  s_waitcnt lgkmcnt(4)
  v_mfma_f32_32x32x16_bf16 v[112:127], v[48:51], v[96:99], v[112:127]
  v_exp_f32 v80, v80
  v_exp_f32 v81, v81
  v_exp_f32 v82, v82
  v_exp_f32 v83, v83
  v_mfma_f32_32x32x16_bf16 v[112:127], v[52:55], v[100:103], v[112:127]
  v_cvt_pk_bf16_f32 v104, v80, v81
  v_exp_f32 v84, v84
  v_exp_f32 v85, v85
  v_cvt_pk_bf16_f32 v105, v82, v83
  v_exp_f32 v86, v86
  s_waitcnt lgkmcnt(2)
  v_mfma_f32_32x32x16_bf16 v[64:79], v[40:43], v[192:195], 0
  v_exp_f32 v87, v87
  v_cvt_pk_bf16_f32 v106, v84, v85
  v_exp_f32 v88, v88
  v_exp_f32 v89, v89
  v_cvt_pk_bf16_f32 v107, v86, v87
  v_mfma_f32_32x32x16_bf16 v[64:79], v[44:47], v[196:199], v[64:79]
  v_exp_f32 v90, v90
  v_exp_f32 v91, v91
  ds_read_b128 v[32:35], v4 offset:4096
  v_cvt_pk_bf16_f32 v108, v88, v89
  v_exp_f32 v92, v92
  v_exp_f32 v93, v93
  ds_read_b128 v[36:39], v4 offset:5120
  v_cvt_pk_bf16_f32 v109, v90, v91
  v_exp_f32 v94, v94
  v_exp_f32 v95, v95
  v_cvt_pk_bf16_f32 v110, v92, v93
  v_cvt_pk_bf16_f32 v111, v94, v95
  v_mfma_f32_32x32x16_bf16 v[128:143], v[48:51], v[104:107], v[128:143]
  v_exp_f32 v64, v64
  v_exp_f32 v65, v65
  v_exp_f32 v66, v66
  v_exp_f32 v67, v67
  v_mfma_f32_32x32x16_bf16 v[128:143], v[52:55], v[108:111], v[128:143]
  v_cvt_pk_bf16_f32 v96, v64, v65
  v_exp_f32 v68, v68
  v_exp_f32 v69, v69
  v_cvt_pk_bf16_f32 v97, v66, v67
  v_exp_f32 v70, v70
  v_mfma_f32_32x32x16_bf16 v[80:95], v[40:43], v[200:203], 0
  v_exp_f32 v71, v71
  v_cvt_pk_bf16_f32 v98, v68, v69
  v_exp_f32 v72, v72
  v_exp_f32 v73, v73
  v_cvt_pk_bf16_f32 v99, v70, v71
  v_mfma_f32_32x32x16_bf16 v[80:95], v[44:47], v[204:207], v[80:95]
  v_exp_f32 v74, v74
  v_exp_f32 v75, v75
  ds_read_b128 v[48:51], v4 offset:36864
  v_cvt_pk_bf16_f32 v100, v72, v73
  v_exp_f32 v76, v76
  v_exp_f32 v77, v77
  ds_read_b128 v[52:55], v4 offset:37888
  v_cvt_pk_bf16_f32 v101, v74, v75
  v_exp_f32 v78, v78
  s_add_u32 m0, s31, 1024
  s_add_u32 s29, s53, s27
  s_add_u32 s29, s29, 1024
  buffer_load_dwordx4 v2, s[8:11], s29 offen sc1 lds
  v_exp_f32 v79, v79
  v_cvt_pk_bf16_f32 v102, v76, v77
  v_cvt_pk_bf16_f32 v103, v78, v79
  s_waitcnt lgkmcnt(4)
  v_mfma_f32_32x32x16_bf16 v[112:127], v[56:59], v[96:99], v[112:127]
  v_exp_f32 v80, v80
  v_exp_f32 v81, v81
  v_exp_f32 v82, v82
  v_exp_f32 v83, v83
  v_mfma_f32_32x32x16_bf16 v[112:127], v[60:63], v[100:103], v[112:127]
  v_cvt_pk_bf16_f32 v104, v80, v81
  v_exp_f32 v84, v84
  v_exp_f32 v85, v85
  v_cvt_pk_bf16_f32 v105, v82, v83
  v_exp_f32 v86, v86
  s_waitcnt lgkmcnt(2)
  v_mfma_f32_32x32x16_bf16 v[64:79], v[32:35], v[192:195], 0
  v_exp_f32 v87, v87
  v_cvt_pk_bf16_f32 v106, v84, v85
  v_exp_f32 v88, v88
  v_exp_f32 v89, v89
  v_cvt_pk_bf16_f32 v107, v86, v87
  v_mfma_f32_32x32x16_bf16 v[64:79], v[36:39], v[196:199], v[64:79]
  v_exp_f32 v90, v90
  v_exp_f32 v91, v91
  ds_read_b128 v[40:43], v4 offset:6144
  v_cvt_pk_bf16_f32 v108, v88, v89
  v_exp_f32 v92, v92
  v_exp_f32 v93, v93
  ds_read_b128 v[44:47], v4 offset:7168
  v_cvt_pk_bf16_f32 v109, v90, v91
  v_exp_f32 v94, v94
  v_exp_f32 v95, v95
  v_cvt_pk_bf16_f32 v110, v92, v93
  v_cvt_pk_bf16_f32 v111, v94, v95
  v_mfma_f32_32x32x16_bf16 v[128:143], v[56:59], v[104:107], v[128:143]
  v_exp_f32 v64, v64
  v_exp_f32 v65, v65
  v_exp_f32 v66, v66
  v_exp_f32 v67, v67
  v_mfma_f32_32x32x16_bf16 v[128:143], v[60:63], v[108:111], v[128:143]
  v_cvt_pk_bf16_f32 v96, v64, v65
  v_exp_f32 v68, v68
  v_exp_f32 v69, v69
  v_cvt_pk_bf16_f32 v97, v66, v67
  v_exp_f32 v70, v70
  v_mfma_f32_32x32x16_bf16 v[80:95], v[32:35], v[200:203], 0
  v_exp_f32 v71, v71
  v_cvt_pk_bf16_f32 v98, v68, v69
  v_exp_f32 v72, v72
  v_exp_f32 v73, v73
  v_cvt_pk_bf16_f32 v99, v70, v71
  v_mfma_f32_32x32x16_bf16 v[80:95], v[36:39], v[204:207], v[80:95]
  v_exp_f32 v74, v74
  v_exp_f32 v75, v75
  ds_read_b128 v[56:59], v4 offset:38912
  v_cvt_pk_bf16_f32 v100, v72, v73
  v_exp_f32 v76, v76
  v_exp_f32 v77, v77
  ds_read_b128 v[60:63], v4 offset:39936
  v_cvt_pk_bf16_f32 v101, v74, v75
  v_exp_f32 v78, v78
  s_add_u32 m0, s31, 2048
  s_add_u32 s29, s53, s27
  s_add_u32 s29, s29, 2048
  buffer_load_dwordx4 v2, s[8:11], s29 offen sc1 lds
  v_exp_f32 v79, v79
  v_cvt_pk_bf16_f32 v102, v76, v77
  v_cvt_pk_bf16_f32 v103, v78, v79
  s_waitcnt lgkmcnt(4)
  v_mfma_f32_32x32x16_bf16 v[112:127], v[48:51], v[96:99], v[112:127]
  v_exp_f32 v80, v80
  v_exp_f32 v81, v81
  v_exp_f32 v82, v82
  v_exp_f32 v83, v83
  v_mfma_f32_32x32x16_bf16 v[112:127], v[52:55], v[100:103], v[112:127]
  v_cvt_pk_bf16_f32 v104, v80, v81
  v_exp_f32 v84, v84
  v_exp_f32 v85, v85
  v_cvt_pk_bf16_f32 v105, v82, v83
  v_exp_f32 v86, v86
  s_waitcnt lgkmcnt(2)
  v_mfma_f32_32x32x16_bf16 v[64:79], v[40:43], v[192:195], 0
  v_exp_f32 v87, v87
  v_cvt_pk_bf16_f32 v106, v84, v85
  v_exp_f32 v88, v88
  v_exp_f32 v89, v89
  v_cvt_pk_bf16_f32 v107, v86, v87
  v_mfma_f32_32x32x16_bf16 v[64:79], v[44:47], v[196:199], v[64:79]
  v_exp_f32 v90, v90
  v_exp_f32 v91, v91
  ds_read_b128 v[32:35], v4 offset:8192
  v_cvt_pk_bf16_f32 v108, v88, v89
  v_exp_f32 v92, v92
  v_exp_f32 v93, v93
  ds_read_b128 v[36:39], v4 offset:9216
  v_cvt_pk_bf16_f32 v109, v90, v91
  v_exp_f32 v94, v94
  v_exp_f32 v95, v95
  v_cvt_pk_bf16_f32 v110, v92, v93
  v_cvt_pk_bf16_f32 v111, v94, v95
  v_mfma_f32_32x32x16_bf16 v[128:143], v[48:51], v[104:107], v[128:143]
  v_exp_f32 v64, v64
  v_exp_f32 v65, v65
  v_exp_f32 v66, v66
  v_exp_f32 v67, v67
  v_mfma_f32_32x32x16_bf16 v[128:143], v[52:55], v[108:111], v[128:143]
  v_cvt_pk_bf16_f32 v96, v64, v65
  v_exp_f32 v68, v68
  v_exp_f32 v69, v69
  v_cvt_pk_bf16_f32 v97, v66, v67
  v_exp_f32 v70, v70
  v_mfma_f32_32x32x16_bf16 v[80:95], v[40:43], v[200:203], 0
  v_exp_f32 v71, v71
  v_cvt_pk_bf16_f32 v98, v68, v69
  v_exp_f32 v72, v72
  v_exp_f32 v73, v73
  v_cvt_pk_bf16_f32 v99, v70, v71
  v_mfma_f32_32x32x16_bf16 v[80:95], v[44:47], v[204:207], v[80:95]
  v_exp_f32 v74, v74
  v_exp_f32 v75, v75
  ds_read_b128 v[48:51], v4 offset:40960
  v_cvt_pk_bf16_f32 v100, v72, v73
  v_exp_f32 v76, v76
  v_exp_f32 v77, v77
  ds_read_b128 v[52:55], v4 offset:41984
  v_cvt_pk_bf16_f32 v101, v74, v75
  v_exp_f32 v78, v78
  s_add_u32 m0, s31, 3072
  s_add_u32 s29, s53, s27
  s_add_u32 s29, s29, 3072
  buffer_load_dwordx4 v2, s[8:11], s29 offen sc1 lds
  v_exp_f32 v79, v79
  v_cvt_pk_bf16_f32 v102, v76, v77
  v_cvt_pk_bf16_f32 v103, v78, v79
  s_waitcnt lgkmcnt(4)
  v_mfma_f32_32x32x16_bf16 v[112:127], v[56:59], v[96:99], v[112:127]
  v_exp_f32 v80, v80
  v_exp_f32 v81, v81
  v_exp_f32 v82, v82
  v_exp_f32 v83, v83
  v_mfma_f32_32x32x16_bf16 v[112:127], v[60:63], v[100:103], v[112:127]
  v_cvt_pk_bf16_f32 v104, v80, v81
  v_exp_f32 v84, v84
  v_exp_f32 v85, v85
  v_cvt_pk_bf16_f32 v105, v82, v83
  v_exp_f32 v86, v86
  s_waitcnt lgkmcnt(2)
  v_mfma_f32_32x32x16_bf16 v[64:79], v[32:35], v[192:195], 0
  v_exp_f32 v87, v87
  v_cvt_pk_bf16_f32 v106, v84, v85
  v_exp_f32 v88, v88
  v_exp_f32 v89, v89
  v_cvt_pk_bf16_f32 v107, v86, v87
  v_mfma_f32_32x32x16_bf16 v[64:79], v[36:39], v[196:199], v[64:79]
  v_exp_f32 v90, v90
  v_exp_f32 v91, v91
  ds_read_b128 v[40:43], v4 offset:10240
  v_cvt_pk_bf16_f32 v108, v88, v89
  v_exp_f32 v92, v92
  v_exp_f32 v93, v93
  ds_read_b128 v[44:47], v4 offset:11264
  v_cvt_pk_bf16_f32 v109, v90, v91
  v_exp_f32 v94, v94
  v_exp_f32 v95, v95
  v_cvt_pk_bf16_f32 v110, v92, v93
  v_cvt_pk_bf16_f32 v111, v94, v95
  v_mfma_f32_32x32x16_bf16 v[128:143], v[56:59], v[104:107], v[128:143]
  v_exp_f32 v64, v64
  v_exp_f32 v65, v65
  v_exp_f32 v66, v66
  v_exp_f32 v67, v67
  v_mfma_f32_32x32x16_bf16 v[128:143], v[60:63], v[108:111], v[128:143]
  v_cvt_pk_bf16_f32 v96, v64, v65
  v_exp_f32 v68, v68
  v_exp_f32 v69, v69
  v_cvt_pk_bf16_f32 v97, v66, v67
  v_exp_f32 v70, v70
  v_mfma_f32_32x32x16_bf16 v[80:95], v[32:35], v[200:203], 0
  v_exp_f32 v71, v71
  v_cvt_pk_bf16_f32 v98, v68, v69
  v_exp_f32 v72, v72
  v_exp_f32 v73, v73
  v_cvt_pk_bf16_f32 v99, v70, v71
  v_mfma_f32_32x32x16_bf16 v[80:95], v[36:39], v[204:207], v[80:95]
  v_exp_f32 v74, v74
  v_exp_f32 v75, v75
  ds_read_b128 v[56:59], v4 offset:43008
  v_cvt_pk_bf16_f32 v100, v72, v73
  v_exp_f32 v76, v76
  v_exp_f32 v77, v77
  ds_read_b128 v[60:63], v4 offset:44032
  v_cvt_pk_bf16_f32 v101, v74, v75
  v_exp_f32 v78, v78
  s_add_u32 m0, s31, 4096
  s_add_u32 s29, s53, s27
  s_add_u32 s29, s29, 4096
  buffer_load_dwordx4 v2, s[8:11], s29 offen sc1 lds
  v_exp_f32 v79, v79
  v_cvt_pk_bf16_f32 v102, v76, v77
  v_cvt_pk_bf16_f32 v103, v78, v79
  s_waitcnt lgkmcnt(4)
  v_mfma_f32_32x32x16_bf16 v[112:127], v[48:51], v[96:99], v[112:127]
  v_exp_f32 v80, v80
  v_exp_f32 v81, v81
  v_exp_f32 v82, v82
  v_exp_f32 v83, v83
  v_mfma_f32_32x32x16_bf16 v[112:127], v[52:55], v[100:103], v[112:127]
  v_cvt_pk_bf16_f32 v104, v80, v81
  v_exp_f32 v84, v84
  v_exp_f32 v85, v85
  v_cvt_pk_bf16_f32 v105, v82, v83
  v_exp_f32 v86, v86
  s_waitcnt lgkmcnt(2)
  v_mfma_f32_32x32x16_bf16 v[64:79], v[40:43], v[192:195], 0
  v_exp_f32 v87, v87
  v_cvt_pk_bf16_f32 v106, v84, v85
  v_exp_f32 v88, v88
  v_exp_f32 v89, v89
  v_cvt_pk_bf16_f32 v107, v86, v87
  v_mfma_f32_32x32x16_bf16 v[64:79], v[44:47], v[196:199], v[64:79]
  v_exp_f32 v90, v90
  v_exp_f32 v91, v91
  ds_read_b128 v[32:35], v4 offset:12288
  v_cvt_pk_bf16_f32 v108, v88, v89
  v_exp_f32 v92, v92
  v_exp_f32 v93, v93
  ds_read_b128 v[36:39], v4 offset:13312
  v_cvt_pk_bf16_f32 v109, v90, v91
  v_exp_f32 v94, v94
  v_exp_f32 v95, v95
  v_cvt_pk_bf16_f32 v110, v92, v93
  v_cvt_pk_bf16_f32 v111, v94, v95
  v_mfma_f32_32x32x16_bf16 v[128:143], v[48:51], v[104:107], v[128:143]
  v_exp_f32 v64, v64
  v_exp_f32 v65, v65
  v_exp_f32 v66, v66
  v_exp_f32 v67, v67
  v_mfma_f32_32x32x16_bf16 v[128:143], v[52:55], v[108:111], v[128:143]
  v_cvt_pk_bf16_f32 v96, v64, v65
  v_exp_f32 v68, v68
  v_exp_f32 v69, v69
  v_cvt_pk_bf16_f32 v97, v66, v67
  v_exp_f32 v70, v70
  v_mfma_f32_32x32x16_bf16 v[80:95], v[40:43], v[200:203], 0
  v_exp_f32 v71, v71
  v_cvt_pk_bf16_f32 v98, v68, v69
  v_exp_f32 v72, v72
  v_exp_f32 v73, v73
  v_cvt_pk_bf16_f32 v99, v70, v71
  v_mfma_f32_32x32x16_bf16 v[80:95], v[44:47], v[204:207], v[80:95]
  v_exp_f32 v74, v74
  v_exp_f32 v75, v75
  ds_read_b128 v[48:51], v4 offset:45056
  v_cvt_pk_bf16_f32 v100, v72, v73
  v_exp_f32 v76, v76
  v_exp_f32 v77, v77
  ds_read_b128 v[52:55], v4 offset:46080
  v_cvt_pk_bf16_f32 v101, v74, v75
  v_exp_f32 v78, v78
  s_add_u32 m0, s31, 5120
  s_add_u32 s29, s53, s27
  s_add_u32 s29, s29, 5120
  buffer_load_dwordx4 v2, s[8:11], s29 offen sc1 lds
  v_exp_f32 v79, v79
  v_cvt_pk_bf16_f32 v102, v76, v77
  v_cvt_pk_bf16_f32 v103, v78, v79
  s_waitcnt lgkmcnt(4)
  v_mfma_f32_32x32x16_bf16 v[112:127], v[56:59], v[96:99], v[112:127]
  v_exp_f32 v80, v80
  v_exp_f32 v81, v81
  v_exp_f32 v82, v82
  v_exp_f32 v83, v83
  v_mfma_f32_32x32x16_bf16 v[112:127], v[60:63], v[100:103], v[112:127]
  v_cvt_pk_bf16_f32 v104, v80, v81
  v_exp_f32 v84, v84
  v_exp_f32 v85, v85
  v_cvt_pk_bf16_f32 v105, v82, v83
  v_exp_f32 v86, v86
  s_waitcnt lgkmcnt(2)
  v_mfma_f32_32x32x16_bf16 v[64:79], v[32:35], v[192:195], 0
  v_exp_f32 v87, v87
  v_cvt_pk_bf16_f32 v106, v84, v85
  v_exp_f32 v88, v88
  v_exp_f32 v89, v89
  v_cvt_pk_bf16_f32 v107, v86, v87
  v_mfma_f32_32x32x16_bf16 v[64:79], v[36:39], v[196:199], v[64:79]
  v_exp_f32 v90, v90
  v_exp_f32 v91, v91
  ds_read_b128 v[40:43], v4 offset:14336
  v_cvt_pk_bf16_f32 v108, v88, v89
  v_exp_f32 v92, v92
  v_exp_f32 v93, v93
  ds_read_b128 v[44:47], v4 offset:15360
  v_cvt_pk_bf16_f32 v109, v90, v91
  v_exp_f32 v94, v94
  v_exp_f32 v95, v95
  v_cvt_pk_bf16_f32 v110, v92, v93
  v_cvt_pk_bf16_f32 v111, v94, v95
  v_mfma_f32_32x32x16_bf16 v[128:143], v[56:59], v[104:107], v[128:143]
  v_exp_f32 v64, v64
  v_exp_f32 v65, v65
  v_exp_f32 v66, v66
  v_exp_f32 v67, v67
  v_mfma_f32_32x32x16_bf16 v[128:143], v[60:63], v[108:111], v[128:143]
  v_cvt_pk_bf16_f32 v96, v64, v65
  v_exp_f32 v68, v68
  v_exp_f32 v69, v69
  v_cvt_pk_bf16_f32 v97, v66, v67
  v_exp_f32 v70, v70
  v_mfma_f32_32x32x16_bf16 v[80:95], v[32:35], v[200:203], 0
  v_exp_f32 v71, v71
  v_cvt_pk_bf16_f32 v98, v68, v69
  v_exp_f32 v72, v72
  v_exp_f32 v73, v73
  v_cvt_pk_bf16_f32 v99, v70, v71
  v_mfma_f32_32x32x16_bf16 v[80:95], v[36:39], v[204:207], v[80:95]
  v_exp_f32 v74, v74
  v_exp_f32 v75, v75
  ds_read_b128 v[56:59], v4 offset:47104
  v_cvt_pk_bf16_f32 v100, v72, v73
  v_exp_f32 v76, v76
  v_exp_f32 v77, v77
  ds_read_b128 v[60:63], v4 offset:48128
  v_cvt_pk_bf16_f32 v101, v74, v75
  v_exp_f32 v78, v78
  s_add_u32 m0, s31, 6144
  s_add_u32 s29, s53, s27
  s_add_u32 s29, s29, 6144
  buffer_load_dwordx4 v2, s[8:11], s29 offen sc1 lds
  v_exp_f32 v79, v79
  v_cvt_pk_bf16_f32 v102, v76, v77
  v_cvt_pk_bf16_f32 v103, v78, v79
  s_waitcnt lgkmcnt(4)
  v_mfma_f32_32x32x16_bf16 v[112:127], v[48:51], v[96:99], v[112:127]
  v_exp_f32 v80, v80
  v_exp_f32 v81, v81
  v_exp_f32 v82, v82
  v_exp_f32 v83, v83
  v_mfma_f32_32x32x16_bf16 v[112:127], v[52:55], v[100:103], v[112:127]
  v_cvt_pk_bf16_f32 v104, v80, v81
  v_exp_f32 v84, v84
  v_exp_f32 v85, v85
  v_cvt_pk_bf16_f32 v105, v82, v83
  v_exp_f32 v86, v86
  s_waitcnt lgkmcnt(2)
  v_mfma_f32_32x32x16_bf16 v[64:79], v[40:43], v[192:195], 0
  v_exp_f32 v87, v87
  v_cvt_pk_bf16_f32 v106, v84, v85
  v_exp_f32 v88, v88
  v_exp_f32 v89, v89
  v_cvt_pk_bf16_f32 v107, v86, v87
  v_mfma_f32_32x32x16_bf16 v[64:79], v[44:47], v[196:199], v[64:79]
  v_exp_f32 v90, v90
  v_exp_f32 v91, v91
  ds_read_b128 v[32:35], v4 offset:16384
  v_cvt_pk_bf16_f32 v108, v88, v89
  v_exp_f32 v92, v92
  v_exp_f32 v93, v93
  ds_read_b128 v[36:39], v4 offset:17408
  v_cvt_pk_bf16_f32 v109, v90, v91
  v_exp_f32 v94, v94
  v_exp_f32 v95, v95
  v_cvt_pk_bf16_f32 v110, v92, v93
  v_cvt_pk_bf16_f32 v111, v94, v95
  v_mfma_f32_32x32x16_bf16 v[128:143], v[48:51], v[104:107], v[128:143]
  v_exp_f32 v64, v64
  v_exp_f32 v65, v65
  v_exp_f32 v66, v66
  v_exp_f32 v67, v67
  v_mfma_f32_32x32x16_bf16 v[128:143], v[52:55], v[108:111], v[128:143]
  v_cvt_pk_bf16_f32 v96, v64, v65
  v_exp_f32 v68, v68
  v_exp_f32 v69, v69
  v_cvt_pk_bf16_f32 v97, v66, v67
  v_exp_f32 v70, v70
  v_mfma_f32_32x32x16_bf16 v[80:95], v[40:43], v[200:203], 0
  v_exp_f32 v71, v71
  v_cvt_pk_bf16_f32 v98, v68, v69
  v_exp_f32 v72, v72
  v_exp_f32 v73, v73
  v_cvt_pk_bf16_f32 v99, v70, v71
  v_mfma_f32_32x32x16_bf16 v[80:95], v[44:47], v[204:207], v[80:95]
  v_exp_f32 v74, v74
  v_exp_f32 v75, v75
  ds_read_b128 v[48:51], v4 offset:49152
  v_cvt_pk_bf16_f32 v100, v72, v73
  v_exp_f32 v76, v76
  v_exp_f32 v77, v77
  ds_read_b128 v[52:55], v4 offset:50176
  v_cvt_pk_bf16_f32 v101, v74, v75
  v_exp_f32 v78, v78
  s_add_u32 m0, s31, 7168
  s_add_u32 s29, s53, s27
  s_add_u32 s29, s29, 7168
  buffer_load_dwordx4 v2, s[8:11], s29 offen sc1 lds
  v_exp_f32 v79, v79
  v_cvt_pk_bf16_f32 v102, v76, v77
  v_cvt_pk_bf16_f32 v103, v78, v79
  s_waitcnt lgkmcnt(4)
  v_mfma_f32_32x32x16_bf16 v[112:127], v[56:59], v[96:99], v[112:127]
  v_exp_f32 v80, v80
  v_exp_f32 v81, v81
  v_exp_f32 v82, v82
  v_exp_f32 v83, v83
  v_mfma_f32_32x32x16_bf16 v[112:127], v[60:63], v[100:103], v[112:127]
  v_cvt_pk_bf16_f32 v104, v80, v81
  v_exp_f32 v84, v84
  v_exp_f32 v85, v85
  v_cvt_pk_bf16_f32 v105, v82, v83
  v_exp_f32 v86, v86
  s_waitcnt lgkmcnt(2)
  v_mfma_f32_32x32x16_bf16 v[64:79], v[32:35], v[192:195], 0
  v_exp_f32 v87, v87
  v_cvt_pk_bf16_f32 v106, v84, v85
  v_exp_f32 v88, v88
  v_exp_f32 v89, v89
  v_cvt_pk_bf16_f32 v107, v86, v87
  v_mfma_f32_32x32x16_bf16 v[64:79], v[36:39], v[196:199], v[64:79]
  v_exp_f32 v90, v90
  v_exp_f32 v91, v91
  ds_read_b128 v[40:43], v4 offset:18432
  v_cvt_pk_bf16_f32 v108, v88, v89
  v_exp_f32 v92, v92
  v_exp_f32 v93, v93
  ds_read_b128 v[44:47], v4 offset:19456
  v_cvt_pk_bf16_f32 v109, v90, v91
  v_exp_f32 v94, v94
  v_exp_f32 v95, v95
  v_cvt_pk_bf16_f32 v110, v92, v93
  v_cvt_pk_bf16_f32 v111, v94, v95
  v_mfma_f32_32x32x16_bf16 v[128:143], v[56:59], v[104:107], v[128:143]
  v_exp_f32 v64, v64
  v_exp_f32 v65, v65
  v_exp_f32 v66, v66
  v_exp_f32 v67, v67
  v_mfma_f32_32x32x16_bf16 v[128:143], v[60:63], v[108:111], v[128:143]
  v_cvt_pk_bf16_f32 v96, v64, v65
  v_exp_f32 v68, v68
  v_exp_f32 v69, v69
  v_cvt_pk_bf16_f32 v97, v66, v67
  v_exp_f32 v70, v70
  v_mfma_f32_32x32x16_bf16 v[80:95], v[32:35], v[200:203], 0
  v_exp_f32 v71, v71
  v_cvt_pk_bf16_f32 v98, v68, v69
  v_exp_f32 v72, v72
  v_exp_f32 v73, v73
  v_cvt_pk_bf16_f32 v99, v70, v71
  v_mfma_f32_32x32x16_bf16 v[80:95], v[36:39], v[204:207], v[80:95]
  v_exp_f32 v74, v74
  v_exp_f32 v75, v75
  ds_read_b128 v[56:59], v4 offset:51200
  v_cvt_pk_bf16_f32 v100, v72, v73
  v_exp_f32 v76, v76
  v_exp_f32 v77, v77
  ds_read_b128 v[60:63], v4 offset:52224
  v_cvt_pk_bf16_f32 v101, v74, v75
  v_exp_f32 v78, v78
  s_add_u32 m0, s31, 32768
  s_add_u32 s29, s53, s28
  s_add_u32 s29, s29, 0
  buffer_load_dwordx4 v2, s[8:11], s29 offen sc1 lds
  v_exp_f32 v79, v79
  v_cvt_pk_bf16_f32 v102, v76, v77
  v_cvt_pk_bf16_f32 v103, v78, v79
  s_waitcnt lgkmcnt(4)
  v_mfma_f32_32x32x16_bf16 v[112:127], v[48:51], v[96:99], v[112:127]
  v_exp_f32 v80, v80
  v_exp_f32 v81, v81
  v_exp_f32 v82, v82
  v_exp_f32 v83, v83
  v_mfma_f32_32x32x16_bf16 v[112:127], v[52:55], v[100:103], v[112:127]
  v_cvt_pk_bf16_f32 v104, v80, v81
  v_exp_f32 v84, v84
  v_exp_f32 v85, v85
  v_cvt_pk_bf16_f32 v105, v82, v83
  v_exp_f32 v86, v86
  s_waitcnt lgkmcnt(2)
  v_mfma_f32_32x32x16_bf16 v[64:79], v[40:43], v[192:195], 0
  v_exp_f32 v87, v87
  v_cvt_pk_bf16_f32 v106, v84, v85
  v_exp_f32 v88, v88
  v_exp_f32 v89, v89
  v_cvt_pk_bf16_f32 v107, v86, v87
  v_mfma_f32_32x32x16_bf16 v[64:79], v[44:47], v[196:199], v[64:79]
  v_exp_f32 v90, v90
  v_exp_f32 v91, v91
  ds_read_b128 v[32:35], v4 offset:20480
  v_cvt_pk_bf16_f32 v108, v88, v89
  v_exp_f32 v92, v92
  v_exp_f32 v93, v93
  ds_read_b128 v[36:39], v4 offset:21504
  v_cvt_pk_bf16_f32 v109, v90, v91
  v_exp_f32 v94, v94
  v_exp_f32 v95, v95
  v_cvt_pk_bf16_f32 v110, v92, v93
  v_cvt_pk_bf16_f32 v111, v94, v95
  v_mfma_f32_32x32x16_bf16 v[128:143], v[48:51], v[104:107], v[128:143]
  v_exp_f32 v64, v64
  v_exp_f32 v65, v65
  v_exp_f32 v66, v66
  v_exp_f32 v67, v67
  v_mfma_f32_32x32x16_bf16 v[128:143], v[52:55], v[108:111], v[128:143]
  v_cvt_pk_bf16_f32 v96, v64, v65
  v_exp_f32 v68, v68
  v_exp_f32 v69, v69
  v_cvt_pk_bf16_f32 v97, v66, v67
  v_exp_f32 v70, v70
  v_mfma_f32_32x32x16_bf16 v[80:95], v[40:43], v[200:203], 0
  v_exp_f32 v71, v71
  v_cvt_pk_bf16_f32 v98, v68, v69
  v_exp_f32 v72, v72
  v_exp_f32 v73, v73
  v_cvt_pk_bf16_f32 v99, v70, v71
  v_mfma_f32_32x32x16_bf16 v[80:95], v[44:47], v[204:207], v[80:95]
  v_exp_f32 v74, v74
  v_exp_f32 v75, v75
  ds_read_b128 v[48:51], v4 offset:53248
  v_cvt_pk_bf16_f32 v100, v72, v73
  v_exp_f32 v76, v76
  v_exp_f32 v77, v77
  ds_read_b128 v[52:55], v4 offset:54272
  v_cvt_pk_bf16_f32 v101, v74, v75
  v_exp_f32 v78, v78
  s_add_u32 m0, s31, 33792
  s_add_u32 s29, s53, s28
  s_add_u32 s29, s29, 1024
  buffer_load_dwordx4 v2, s[8:11], s29 offen sc1 lds
  v_exp_f32 v79, v79
  v_cvt_pk_bf16_f32 v102, v76, v77
  v_cvt_pk_bf16_f32 v103, v78, v79
  s_waitcnt lgkmcnt(4)
  v_mfma_f32_32x32x16_bf16 v[112:127], v[56:59], v[96:99], v[112:127]
  v_exp_f32 v80, v80
  v_exp_f32 v81, v81
  v_exp_f32 v82, v82
  v_exp_f32 v83, v83
  v_mfma_f32_32x32x16_bf16 v[112:127], v[60:63], v[100:103], v[112:127]
  v_cvt_pk_bf16_f32 v104, v80, v81
  v_exp_f32 v84, v84
  v_exp_f32 v85, v85
  v_cvt_pk_bf16_f32 v105, v82, v83
  v_exp_f32 v86, v86
  s_waitcnt lgkmcnt(2)
  v_mfma_f32_32x32x16_bf16 v[64:79], v[32:35], v[192:195], 0
  v_exp_f32 v87, v87
  v_cvt_pk_bf16_f32 v106, v84, v85
  v_exp_f32 v88, v88
  v_exp_f32 v89, v89
  v_cvt_pk_bf16_f32 v107, v86, v87
  v_mfma_f32_32x32x16_bf16 v[64:79], v[36:39], v[196:199], v[64:79]
  v_exp_f32 v90, v90
  v_exp_f32 v91, v91
  ds_read_b128 v[40:43], v4 offset:22528
  v_cvt_pk_bf16_f32 v108, v88, v89
  v_exp_f32 v92, v92
  v_exp_f32 v93, v93
  ds_read_b128 v[44:47], v4 offset:23552
  v_cvt_pk_bf16_f32 v109, v90, v91
  v_exp_f32 v94, v94
  v_exp_f32 v95, v95
  v_cvt_pk_bf16_f32 v110, v92, v93
  v_cvt_pk_bf16_f32 v111, v94, v95
  v_mfma_f32_32x32x16_bf16 v[128:143], v[56:59], v[104:107], v[128:143]
  v_exp_f32 v64, v64
  v_exp_f32 v65, v65
  v_exp_f32 v66, v66
  v_exp_f32 v67, v67
  v_mfma_f32_32x32x16_bf16 v[128:143], v[60:63], v[108:111], v[128:143]
  v_cvt_pk_bf16_f32 v96, v64, v65
  v_exp_f32 v68, v68
  v_exp_f32 v69, v69
  v_cvt_pk_bf16_f32 v97, v66, v67
  v_exp_f32 v70, v70
  v_mfma_f32_32x32x16_bf16 v[80:95], v[32:35], v[200:203], 0
  v_exp_f32 v71, v71
  v_cvt_pk_bf16_f32 v98, v68, v69
  v_exp_f32 v72, v72
  v_exp_f32 v73, v73
  v_cvt_pk_bf16_f32 v99, v70, v71
  v_mfma_f32_32x32x16_bf16 v[80:95], v[36:39], v[204:207], v[80:95]
  v_exp_f32 v74, v74
  v_exp_f32 v75, v75
  ds_read_b128 v[56:59], v4 offset:55296
  v_cvt_pk_bf16_f32 v100, v72, v73
  v_exp_f32 v76, v76
  v_exp_f32 v77, v77
  ds_read_b128 v[60:63], v4 offset:56320
  v_cvt_pk_bf16_f32 v101, v74, v75
  v_exp_f32 v78, v78
  s_add_u32 m0, s31, 34816
  s_add_u32 s29, s53, s28
  s_add_u32 s29, s29, 2048
  buffer_load_dwordx4 v2, s[8:11], s29 offen sc1 lds
  v_exp_f32 v79, v79
  v_cvt_pk_bf16_f32 v102, v76, v77
  v_cvt_pk_bf16_f32 v103, v78, v79
  s_waitcnt lgkmcnt(4)
  v_mfma_f32_32x32x16_bf16 v[112:127], v[48:51], v[96:99], v[112:127]
  v_exp_f32 v80, v80
  v_exp_f32 v81, v81
  v_exp_f32 v82, v82
  v_exp_f32 v83, v83
  v_mfma_f32_32x32x16_bf16 v[112:127], v[52:55], v[100:103], v[112:127]
  v_cvt_pk_bf16_f32 v104, v80, v81
  v_exp_f32 v84, v84
  v_exp_f32 v85, v85
  v_cvt_pk_bf16_f32 v105, v82, v83
  v_exp_f32 v86, v86
  s_waitcnt lgkmcnt(2)
  v_mfma_f32_32x32x16_bf16 v[64:79], v[40:43], v[192:195], 0
  v_exp_f32 v87, v87
  v_cvt_pk_bf16_f32 v106, v84, v85
  v_exp_f32 v88, v88
  v_exp_f32 v89, v89
  v_cvt_pk_bf16_f32 v107, v86, v87
  v_mfma_f32_32x32x16_bf16 v[64:79], v[44:47], v[196:199], v[64:79]
  v_exp_f32 v90, v90
  v_exp_f32 v91, v91
  ds_read_b128 v[32:35], v4 offset:24576
  v_cvt_pk_bf16_f32 v108, v88, v89
  v_exp_f32 v92, v92
  v_exp_f32 v93, v93
  ds_read_b128 v[36:39], v4 offset:25600
  v_cvt_pk_bf16_f32 v109, v90, v91
  v_exp_f32 v94, v94
  v_exp_f32 v95, v95
  v_cvt_pk_bf16_f32 v110, v92, v93
  v_cvt_pk_bf16_f32 v111, v94, v95
  v_mfma_f32_32x32x16_bf16 v[128:143], v[48:51], v[104:107], v[128:143]
  v_exp_f32 v64, v64
  v_exp_f32 v65, v65
  v_exp_f32 v66, v66
  v_exp_f32 v67, v67
  v_mfma_f32_32x32x16_bf16 v[128:143], v[52:55], v[108:111], v[128:143]
  v_cvt_pk_bf16_f32 v96, v64, v65
  v_exp_f32 v68, v68
  v_exp_f32 v69, v69
  v_cvt_pk_bf16_f32 v97, v66, v67
  v_exp_f32 v70, v70
  v_mfma_f32_32x32x16_bf16 v[80:95], v[40:43], v[200:203], 0
  v_exp_f32 v71, v71
  v_cvt_pk_bf16_f32 v98, v68, v69
  v_exp_f32 v72, v72
  v_exp_f32 v73, v73
  v_cvt_pk_bf16_f32 v99, v70, v71
  v_mfma_f32_32x32x16_bf16 v[80:95], v[44:47], v[204:207], v[80:95]
  v_exp_f32 v74, v74
  v_exp_f32 v75, v75
  ds_read_b128 v[48:51], v4 offset:57344
  v_cvt_pk_bf16_f32 v100, v72, v73
  v_exp_f32 v76, v76
  v_exp_f32 v77, v77
  ds_read_b128 v[52:55], v4 offset:58368
  v_cvt_pk_bf16_f32 v101, v74, v75
  v_exp_f32 v78, v78
  s_add_u32 m0, s31, 35840
  s_add_u32 s29, s53, s28
  s_add_u32 s29, s29, 3072
  buffer_load_dwordx4 v2, s[8:11], s29 offen sc1 lds
  v_exp_f32 v79, v79
  v_cvt_pk_bf16_f32 v102, v76, v77
  v_cvt_pk_bf16_f32 v103, v78, v79
  s_waitcnt lgkmcnt(4)
  v_mfma_f32_32x32x16_bf16 v[112:127], v[56:59], v[96:99], v[112:127]
  v_exp_f32 v80, v80
  v_exp_f32 v81, v81
  v_exp_f32 v82, v82
  v_exp_f32 v83, v83
  v_mfma_f32_32x32x16_bf16 v[112:127], v[60:63], v[100:103], v[112:127]
  v_cvt_pk_bf16_f32 v104, v80, v81
  v_exp_f32 v84, v84
  v_exp_f32 v85, v85
  v_cvt_pk_bf16_f32 v105, v82, v83
  v_exp_f32 v86, v86
  s_waitcnt lgkmcnt(2)
  v_mfma_f32_32x32x16_bf16 v[64:79], v[32:35], v[192:195], 0
  v_exp_f32 v87, v87
  v_cvt_pk_bf16_f32 v106, v84, v85
  v_exp_f32 v88, v88
  v_exp_f32 v89, v89
  v_cvt_pk_bf16_f32 v107, v86, v87
  v_mfma_f32_32x32x16_bf16 v[64:79], v[36:39], v[196:199], v[64:79]
  v_exp_f32 v90, v90
  v_exp_f32 v91, v91
  ds_read_b128 v[40:43], v4 offset:26624
  v_cvt_pk_bf16_f32 v108, v88, v89
  v_exp_f32 v92, v92
  v_exp_f32 v93, v93
  ds_read_b128 v[44:47], v4 offset:27648
  v_cvt_pk_bf16_f32 v109, v90, v91
  v_exp_f32 v94, v94
  v_exp_f32 v95, v95
  v_cvt_pk_bf16_f32 v110, v92, v93
  v_cvt_pk_bf16_f32 v111, v94, v95
  v_mfma_f32_32x32x16_bf16 v[128:143], v[56:59], v[104:107], v[128:143]
  v_exp_f32 v64, v64
  v_exp_f32 v65, v65
  v_exp_f32 v66, v66
  v_exp_f32 v67, v67
  v_mfma_f32_32x32x16_bf16 v[128:143], v[60:63], v[108:111], v[128:143]
  v_cvt_pk_bf16_f32 v96, v64, v65
  v_exp_f32 v68, v68
  v_exp_f32 v69, v69
  v_cvt_pk_bf16_f32 v97, v66, v67
  v_exp_f32 v70, v70
  v_mfma_f32_32x32x16_bf16 v[80:95], v[32:35], v[200:203], 0
  v_exp_f32 v71, v71
  v_cvt_pk_bf16_f32 v98, v68, v69
  v_exp_f32 v72, v72
  v_exp_f32 v73, v73
  v_cvt_pk_bf16_f32 v99, v70, v71
  v_mfma_f32_32x32x16_bf16 v[80:95], v[36:39], v[204:207], v[80:95]
  v_exp_f32 v74, v74
  v_exp_f32 v75, v75
  ds_read_b128 v[56:59], v4 offset:59392
  v_cvt_pk_bf16_f32 v100, v72, v73
  v_exp_f32 v76, v76
  v_exp_f32 v77, v77
  ds_read_b128 v[60:63], v4 offset:60416
  v_cvt_pk_bf16_f32 v101, v74, v75
  v_exp_f32 v78, v78
  s_add_u32 m0, s31, 36864
  s_add_u32 s29, s53, s28
  s_add_u32 s29, s29, 4096
  buffer_load_dwordx4 v2, s[8:11], s29 offen sc1 lds
  v_exp_f32 v79, v79
  v_cvt_pk_bf16_f32 v102, v76, v77
  v_cvt_pk_bf16_f32 v103, v78, v79
  s_waitcnt lgkmcnt(4)
  v_mfma_f32_32x32x16_bf16 v[112:127], v[48:51], v[96:99], v[112:127]
  v_exp_f32 v80, v80
  v_exp_f32 v81, v81
  v_exp_f32 v82, v82
  v_exp_f32 v83, v83
  v_mfma_f32_32x32x16_bf16 v[112:127], v[52:55], v[100:103], v[112:127]
  v_cvt_pk_bf16_f32 v104, v80, v81
  v_exp_f32 v84, v84
  v_exp_f32 v85, v85
  v_cvt_pk_bf16_f32 v105, v82, v83
  v_exp_f32 v86, v86
  s_waitcnt lgkmcnt(2)
  v_mfma_f32_32x32x16_bf16 v[64:79], v[40:43], v[192:195], 0
  v_exp_f32 v87, v87
  v_cvt_pk_bf16_f32 v106, v84, v85
  v_exp_f32 v88, v88
  v_exp_f32 v89, v89
  v_cvt_pk_bf16_f32 v107, v86, v87
  v_mfma_f32_32x32x16_bf16 v[64:79], v[44:47], v[196:199], v[64:79]
  v_exp_f32 v90, v90
  v_exp_f32 v91, v91
  ds_read_b128 v[32:35], v4 offset:28672
  v_cvt_pk_bf16_f32 v108, v88, v89
  v_exp_f32 v92, v92
  v_exp_f32 v93, v93
  ds_read_b128 v[36:39], v4 offset:29696
  v_cvt_pk_bf16_f32 v109, v90, v91
  v_exp_f32 v94, v94
  v_exp_f32 v95, v95
  v_cvt_pk_bf16_f32 v110, v92, v93
  v_cvt_pk_bf16_f32 v111, v94, v95
  v_mfma_f32_32x32x16_bf16 v[128:143], v[48:51], v[104:107], v[128:143]
  v_exp_f32 v64, v64
  v_exp_f32 v65, v65
  v_exp_f32 v66, v66
  v_exp_f32 v67, v67
  v_mfma_f32_32x32x16_bf16 v[128:143], v[52:55], v[108:111], v[128:143]
  v_cvt_pk_bf16_f32 v96, v64, v65
  v_exp_f32 v68, v68
  v_exp_f32 v69, v69
  v_cvt_pk_bf16_f32 v97, v66, v67
  v_exp_f32 v70, v70
  v_mfma_f32_32x32x16_bf16 v[80:95], v[40:43], v[200:203], 0
  v_exp_f32 v71, v71
  v_cvt_pk_bf16_f32 v98, v68, v69
  v_exp_f32 v72, v72
  v_exp_f32 v73, v73
  v_cvt_pk_bf16_f32 v99, v70, v71
  v_mfma_f32_32x32x16_bf16 v[80:95], v[44:47], v[204:207], v[80:95]
  v_exp_f32 v74, v74
  v_exp_f32 v75, v75
  ds_read_b128 v[48:51], v4 offset:61440
  v_cvt_pk_bf16_f32 v100, v72, v73
  v_exp_f32 v76, v76
  v_exp_f32 v77, v77
  ds_read_b128 v[52:55], v4 offset:62464
  v_cvt_pk_bf16_f32 v101, v74, v75
  v_exp_f32 v78, v78
  s_add_u32 m0, s31, 37888
  s_add_u32 s29, s53, s28
  s_add_u32 s29, s29, 5120
  buffer_load_dwordx4 v2, s[8:11], s29 offen sc1 lds
  v_exp_f32 v79, v79
  v_cvt_pk_bf16_f32 v102, v76, v77
  v_cvt_pk_bf16_f32 v103, v78, v79
  s_waitcnt lgkmcnt(4)
  v_mfma_f32_32x32x16_bf16 v[112:127], v[56:59], v[96:99], v[112:127]
  v_exp_f32 v80, v80
  v_exp_f32 v81, v81
  v_exp_f32 v82, v82
  v_exp_f32 v83, v83
  v_mfma_f32_32x32x16_bf16 v[112:127], v[60:63], v[100:103], v[112:127]
  v_cvt_pk_bf16_f32 v104, v80, v81
  v_exp_f32 v84, v84
  v_exp_f32 v85, v85
  v_cvt_pk_bf16_f32 v105, v82, v83
  v_exp_f32 v86, v86
  s_waitcnt lgkmcnt(2)
  v_mfma_f32_32x32x16_bf16 v[64:79], v[32:35], v[192:195], 0
  v_exp_f32 v87, v87
  v_cvt_pk_bf16_f32 v106, v84, v85
  v_exp_f32 v88, v88
  v_exp_f32 v89, v89
  v_cvt_pk_bf16_f32 v107, v86, v87
  v_mfma_f32_32x32x16_bf16 v[64:79], v[36:39], v[196:199], v[64:79]
  v_exp_f32 v90, v90
  v_exp_f32 v91, v91
  ds_read_b128 v[40:43], v4 offset:30720
  v_cvt_pk_bf16_f32 v108, v88, v89
  v_exp_f32 v92, v92
  v_exp_f32 v93, v93
  ds_read_b128 v[44:47], v4 offset:31744
  v_cvt_pk_bf16_f32 v109, v90, v91
  v_exp_f32 v94, v94
  v_exp_f32 v95, v95
  v_cvt_pk_bf16_f32 v110, v92, v93
  v_cvt_pk_bf16_f32 v111, v94, v95
  v_mfma_f32_32x32x16_bf16 v[128:143], v[56:59], v[104:107], v[128:143]
  v_exp_f32 v64, v64
  v_exp_f32 v65, v65
  v_exp_f32 v66, v66
  v_exp_f32 v67, v67
  v_mfma_f32_32x32x16_bf16 v[128:143], v[60:63], v[108:111], v[128:143]
  v_cvt_pk_bf16_f32 v96, v64, v65
  v_exp_f32 v68, v68
  v_exp_f32 v69, v69
  v_cvt_pk_bf16_f32 v97, v66, v67
  v_exp_f32 v70, v70
  v_mfma_f32_32x32x16_bf16 v[80:95], v[32:35], v[200:203], 0
  v_exp_f32 v71, v71
  v_cvt_pk_bf16_f32 v98, v68, v69
  v_exp_f32 v72, v72
  v_exp_f32 v73, v73
  v_cvt_pk_bf16_f32 v99, v70, v71
  v_mfma_f32_32x32x16_bf16 v[80:95], v[36:39], v[204:207], v[80:95]
  v_exp_f32 v74, v74
  v_exp_f32 v75, v75
  ds_read_b128 v[56:59], v4 offset:63488
  v_cvt_pk_bf16_f32 v100, v72, v73
  v_exp_f32 v76, v76
  v_exp_f32 v77, v77
  ds_read_b128 v[60:63], v4 offset:64512
  v_cvt_pk_bf16_f32 v101, v74, v75
  v_exp_f32 v78, v78
  s_add_u32 m0, s31, 38912
  s_add_u32 s29, s53, s28
  s_add_u32 s29, s29, 6144
  buffer_load_dwordx4 v2, s[8:11], s29 offen sc1 lds
  v_exp_f32 v79, v79
  v_cvt_pk_bf16_f32 v102, v76, v77
  v_cvt_pk_bf16_f32 v103, v78, v79
  s_waitcnt lgkmcnt(4)
  v_mfma_f32_32x32x16_bf16 v[112:127], v[48:51], v[96:99], v[112:127]
  v_exp_f32 v80, v80
  v_exp_f32 v81, v81
  v_exp_f32 v82, v82
  v_exp_f32 v83, v83
  v_mfma_f32_32x32x16_bf16 v[112:127], v[52:55], v[100:103], v[112:127]
  v_cvt_pk_bf16_f32 v104, v80, v81
  v_exp_f32 v84, v84
  v_exp_f32 v85, v85
  v_cvt_pk_bf16_f32 v105, v82, v83
  v_exp_f32 v86, v86
  s_waitcnt lgkmcnt(2)
  v_mfma_f32_32x32x16_bf16 v[64:79], v[40:43], v[192:195], 0
  v_exp_f32 v87, v87
  v_cvt_pk_bf16_f32 v106, v84, v85
  v_exp_f32 v88, v88
  v_exp_f32 v89, v89
  v_cvt_pk_bf16_f32 v107, v86, v87
  v_mfma_f32_32x32x16_bf16 v[64:79], v[44:47], v[196:199], v[64:79]
  v_exp_f32 v90, v90
  v_exp_f32 v91, v91
  v_cvt_pk_bf16_f32 v108, v88, v89
  v_exp_f32 v92, v92
  v_exp_f32 v93, v93
  v_cvt_pk_bf16_f32 v109, v90, v91
  v_exp_f32 v94, v94
  v_exp_f32 v95, v95
  v_cvt_pk_bf16_f32 v110, v92, v93
  v_cvt_pk_bf16_f32 v111, v94, v95
  v_mfma_f32_32x32x16_bf16 v[128:143], v[48:51], v[104:107], v[128:143]
  v_exp_f32 v64, v64
  v_exp_f32 v65, v65
  v_exp_f32 v66, v66
  v_exp_f32 v67, v67
  v_mfma_f32_32x32x16_bf16 v[128:143], v[52:55], v[108:111], v[128:143]
  v_cvt_pk_bf16_f32 v96, v64, v65
  v_exp_f32 v68, v68
  v_exp_f32 v69, v69
  v_cvt_pk_bf16_f32 v97, v66, v67
  v_exp_f32 v70, v70
  v_mfma_f32_32x32x16_bf16 v[80:95], v[40:43], v[200:203], 0
  v_exp_f32 v71, v71
  v_cvt_pk_bf16_f32 v98, v68, v69
  v_exp_f32 v72, v72
  v_exp_f32 v73, v73
  v_cvt_pk_bf16_f32 v99, v70, v71
  v_mfma_f32_32x32x16_bf16 v[80:95], v[44:47], v[204:207], v[80:95]
  v_exp_f32 v74, v74
  v_exp_f32 v75, v75
  v_cvt_pk_bf16_f32 v100, v72, v73
  v_exp_f32 v76, v76
  v_exp_f32 v77, v77
  v_cvt_pk_bf16_f32 v101, v74, v75
  v_exp_f32 v78, v78
  s_add_u32 m0, s31, 39936
  s_add_u32 s29, s53, s28
  s_add_u32 s29, s29, 7168
  buffer_load_dwordx4 v2, s[8:11], s29 offen sc1 lds
  v_exp_f32 v79, v79
  v_cvt_pk_bf16_f32 v102, v76, v77
  v_cvt_pk_bf16_f32 v103, v78, v79
  s_waitcnt lgkmcnt(0)
  v_mfma_f32_32x32x16_bf16 v[112:127], v[56:59], v[96:99], v[112:127]
  v_exp_f32 v80, v80
  v_exp_f32 v81, v81
  v_exp_f32 v82, v82
  v_exp_f32 v83, v83
  v_mfma_f32_32x32x16_bf16 v[112:127], v[60:63], v[100:103], v[112:127]
  v_cvt_pk_bf16_f32 v104, v80, v81
  v_exp_f32 v84, v84
  v_exp_f32 v85, v85
  v_cvt_pk_bf16_f32 v105, v82, v83
  v_exp_f32 v86, v86
  v_exp_f32 v87, v87
  v_cvt_pk_bf16_f32 v106, v84, v85
  v_exp_f32 v88, v88
  v_exp_f32 v89, v89
  v_cvt_pk_bf16_f32 v107, v86, v87
  v_exp_f32 v90, v90
  v_exp_f32 v91, v91
  v_cvt_pk_bf16_f32 v108, v88, v89
  v_exp_f32 v92, v92
  v_exp_f32 v93, v93
  v_cvt_pk_bf16_f32 v109, v90, v91
  v_exp_f32 v94, v94
  v_exp_f32 v95, v95
  v_cvt_pk_bf16_f32 v110, v92, v93
  v_cvt_pk_bf16_f32 v111, v94, v95
  s_nop 1
  v_mfma_f32_32x32x16_bf16 v[128:143], v[56:59], v[104:107], v[128:143]
  v_mfma_f32_32x32x16_bf16 v[128:143], v[60:63], v[108:111], v[128:143]
  s_cmp_lt_u32 s41, 4
  s_cbranch_scc1 kb1_chunk2
  s_nop 11
  v_mov_b32 v5, v120
  v_mov_b32 v6, v120
  s_nop 1
  v_permlane32_swap_b32 v5, v6
  v_mov_b32 v14, v6
  v_mov_b32 v5, v136
  v_mov_b32 v6, v136
  s_nop 1
  v_permlane32_swap_b32 v5, v6
  v_mov_b32 v15, v6
  s_cmp_eq_u32 s40, 0
  s_cbranch_scc0 kb1_fin
  v_min_f32 v5, v14, v15
  v_cmp_gt_f32 vcc, 0x12800000, v5
  v_cmp_u_f32 s[36:37], v5, v5
  s_nop 1
  s_or_b64 vcc, vcc, s[36:37]
  s_cmp_lg_u64 vcc, 0
  s_cselect_b32 s42, 1, 0
  v_mov_b32 v5, s42
  s_lshl_b32 s30, s21, 2
  s_add_u32 s30, s30, 131584
  v_mov_b32 v6, s30
  ds_write_b32 v6, v5
  s_waitcnt vmcnt(0) lgkmcnt(0)
  s_barrier
  v_mov_b32 v6, 131584
  ds_read_b128 v[8:11], v6
  s_waitcnt lgkmcnt(0)
  v_or_b32 v8, v8, v9
  v_or_b32 v10, v10, v11
  v_or_b32 v8, v8, v10
  s_nop 0
  v_readfirstlane_b32 s42, v8
  s_cmp_eq_u32 s42, 0
  s_cbranch_scc1 kb1_fin
  s_mov_b32 s40, 1
  v_and_b32 v5, 0xffff0000, v198
  v_cndmask_b32 v198, v198, v5, s[34:35]
  v_mov_b32 v12, 0xff7fffff
  v_and_b32 v5, 0xffff0000, v206
  v_cndmask_b32 v206, v206, v5, s[34:35]
  v_mov_b32 v13, 0xff7fffff
  s_mov_b32 s41, 0
kb1_mx:
  s_lshl_b32 s30, s41, 11
  s_add_u32 s30, s30, s27
  buffer_load_dwordx4 v[32:35], v2, s[8:11], s30 offen sc1
  buffer_load_dwordx4 v[36:39], v2, s[8:11], s30 offen offset:1024 sc1
  s_waitcnt vmcnt(0)
  v_mfma_f32_32x32x16_bf16 v[64:79], v[32:35], v[192:195], 0
  v_mfma_f32_32x32x16_bf16 v[64:79], v[36:39], v[196:199], v[64:79]
  v_mfma_f32_32x32x16_bf16 v[80:95], v[32:35], v[200:203], 0
  v_mfma_f32_32x32x16_bf16 v[80:95], v[36:39], v[204:207], v[80:95]
  s_nop 11
  v_max3_f32 v12, v12, v64, v65
  v_max3_f32 v12, v12, v66, v67
  v_max3_f32 v12, v12, v68, v69
  v_max3_f32 v12, v12, v70, v71
  v_max3_f32 v12, v12, v72, v73
  v_max3_f32 v12, v12, v74, v75
  v_max3_f32 v12, v12, v76, v77
  v_max3_f32 v12, v12, v78, v79
  v_max3_f32 v13, v13, v80, v81
  v_max3_f32 v13, v13, v82, v83
  v_max3_f32 v13, v13, v84, v85
  v_max3_f32 v13, v13, v86, v87
  v_max3_f32 v13, v13, v88, v89
  v_max3_f32 v13, v13, v90, v91
  v_max3_f32 v13, v13, v92, v93
  v_max3_f32 v13, v13, v94, v95
  s_add_u32 s41, s41, 1
  s_cmp_lt_u32 s41, 64
  s_cbranch_scc1 kb1_mx
  v_mov_b32 v5, v12
  s_nop 1
  v_permlane32_swap_b32 v12, v5
  v_max_f32 v12, v12, v5
  v_cvt_pk_bf16_f32 v5, v12, v12
  v_and_b32 v5, 0xffff, v5
  v_xor_b32 v5, 0x8000, v5
  v_and_b32 v6, 0xffff0000, v198
  v_or_b32 v5, v5, v6
  v_cndmask_b32 v198, v198, v5, s[34:35]
  v_mov_b32 v5, v13
  s_nop 1
  v_permlane32_swap_b32 v13, v5
  v_max_f32 v13, v13, v5
  v_cvt_pk_bf16_f32 v5, v13, v13
  v_and_b32 v5, 0xffff, v5
  v_xor_b32 v5, 0x8000, v5
  v_and_b32 v6, 0xffff0000, v206
  v_or_b32 v5, v5, v6
  v_cndmask_b32 v206, v206, v5, s[34:35]
  s_barrier
  s_mov_b32 s41, 0
  s_mul_i32 s53, s41, 32768
  s_lshl_b32 s31, s21, 13
  s_add_u32 s53, s53, s31
  s_add_u32 m0, s31, 0
  s_add_u32 s29, s53, s27
  s_add_u32 s29, s29, 0
  buffer_load_dwordx4 v2, s[8:11], s29 offen sc1 lds
  s_add_u32 m0, s31, 1024
  s_add_u32 s29, s53, s27
  s_add_u32 s29, s29, 1024
  buffer_load_dwordx4 v2, s[8:11], s29 offen sc1 lds
  s_add_u32 m0, s31, 2048
  s_add_u32 s29, s53, s27
  s_add_u32 s29, s29, 2048
  buffer_load_dwordx4 v2, s[8:11], s29 offen sc1 lds
  s_add_u32 m0, s31, 3072
  s_add_u32 s29, s53, s27
  s_add_u32 s29, s29, 3072
  buffer_load_dwordx4 v2, s[8:11], s29 offen sc1 lds
  s_add_u32 m0, s31, 4096
  s_add_u32 s29, s53, s27
  s_add_u32 s29, s29, 4096
  buffer_load_dwordx4 v2, s[8:11], s29 offen sc1 lds
  s_add_u32 m0, s31, 5120
  s_add_u32 s29, s53, s27
  s_add_u32 s29, s29, 5120
  buffer_load_dwordx4 v2, s[8:11], s29 offen sc1 lds
  s_add_u32 m0, s31, 6144
  s_add_u32 s29, s53, s27
  s_add_u32 s29, s29, 6144
  buffer_load_dwordx4 v2, s[8:11], s29 offen sc1 lds
  s_add_u32 m0, s31, 7168
  s_add_u32 s29, s53, s27
  s_add_u32 s29, s29, 7168
  buffer_load_dwordx4 v2, s[8:11], s29 offen sc1 lds
  s_add_u32 m0, s31, 32768
  s_add_u32 s29, s53, s28
  s_add_u32 s29, s29, 0
  buffer_load_dwordx4 v2, s[8:11], s29 offen sc1 lds
  s_add_u32 m0, s31, 33792
  s_add_u32 s29, s53, s28
  s_add_u32 s29, s29, 1024
  buffer_load_dwordx4 v2, s[8:11], s29 offen sc1 lds
  s_add_u32 m0, s31, 34816
  s_add_u32 s29, s53, s28
  s_add_u32 s29, s29, 2048
  buffer_load_dwordx4 v2, s[8:11], s29 offen sc1 lds
  s_add_u32 m0, s31, 35840
  s_add_u32 s29, s53, s28
  s_add_u32 s29, s29, 3072
  buffer_load_dwordx4 v2, s[8:11], s29 offen sc1 lds
  s_add_u32 m0, s31, 36864
  s_add_u32 s29, s53, s28
  s_add_u32 s29, s29, 4096
  buffer_load_dwordx4 v2, s[8:11], s29 offen sc1 lds
  s_add_u32 m0, s31, 37888
  s_add_u32 s29, s53, s28
  s_add_u32 s29, s29, 5120
  buffer_load_dwordx4 v2, s[8:11], s29 offen sc1 lds
  s_add_u32 m0, s31, 38912
  s_add_u32 s29, s53, s28
  s_add_u32 s29, s29, 6144
  buffer_load_dwordx4 v2, s[8:11], s29 offen sc1 lds
  s_add_u32 m0, s31, 39936
  s_add_u32 s29, s53, s28
  s_add_u32 s29, s29, 7168
  buffer_load_dwordx4 v2, s[8:11], s29 offen sc1 lds
  s_branch kb1_main2
kb1_fin:
  v_and_b32 v3, 15, v1
  v_bfe_u32 v11, v1, 4, 1
  v_mul_u32_u24 v11, 20480, v11
  v_lshrrev_b32 v4, 5, v1
  s_mul_i32 s30, s22, 20
  v_lshlrev_b32 v5, 2, v4
  v_add_u32 v5, 0, v5
  v_add_u32 v5, s30, v5
  v_lshrrev_b32 v6, 5, v5
  v_lshlrev_b32 v6, 10, v6
  v_bfe_u32 v7, v5, 3, 2
  v_lshlrev_b32 v7, 4, v7
  v_add_u32 v7, v7, v3
  v_lshlrev_b32 v7, 4, v7
  v_add_u32 v6, v6, v7
  v_bfe_u32 v7, v5, 2, 1
  v_lshlrev_b32 v7, 3, v7
  v_add_u32 v6, v6, v7
  v_add_u32 v32, v6, v11
  v_lshlrev_b32 v5, 2, v4
  v_add_u32 v5, 8, v5
  v_add_u32 v5, s30, v5
  v_lshrrev_b32 v6, 5, v5
  v_lshlrev_b32 v6, 10, v6
  v_bfe_u32 v7, v5, 3, 2
  v_lshlrev_b32 v7, 4, v7
  v_add_u32 v7, v7, v3
  v_lshlrev_b32 v7, 4, v7
  v_add_u32 v6, v6, v7
  v_bfe_u32 v7, v5, 2, 1
  v_lshlrev_b32 v7, 3, v7
  v_add_u32 v6, v6, v7
  v_add_u32 v33, v6, v11
  v_lshlrev_b32 v5, 2, v4
  v_add_u32 v5, 16, v5
  v_add_u32 v5, s30, v5
  v_lshrrev_b32 v6, 5, v5
  v_lshlrev_b32 v6, 10, v6
  v_bfe_u32 v7, v5, 3, 2
  v_lshlrev_b32 v7, 4, v7
  v_add_u32 v7, v7, v3
  v_lshlrev_b32 v7, 4, v7
  v_add_u32 v6, v6, v7
  v_bfe_u32 v7, v5, 2, 1
  v_lshlrev_b32 v7, 3, v7
  v_add_u32 v6, v6, v7
  v_add_u32 v34, v6, v11
  v_mov_b32 v5, 0x40000000
  v_cndmask_b32 v34, v5, v34, s[34:35]
  v_rcp_f32 v5, v14
  s_nop 0
  v_mul_f32 v112, v112, v5
  v_mul_f32 v113, v113, v5
  v_mul_f32 v114, v114, v5
  v_mul_f32 v115, v115, v5
  v_mul_f32 v116, v116, v5
  v_mul_f32 v117, v117, v5
  v_mul_f32 v118, v118, v5
  v_mul_f32 v119, v119, v5
  v_mul_f32 v120, v120, v5
  v_mul_f32 v121, v121, v5
  v_mul_f32 v122, v122, v5
  v_mul_f32 v123, v123, v5
  v_cvt_pk_bf16_f32 v40, v112, v113
  v_cvt_pk_bf16_f32 v41, v114, v115
  v_cvt_pk_bf16_f32 v42, v116, v117
  v_cvt_pk_bf16_f32 v43, v118, v119
  v_cvt_pk_bf16_f32 v44, v120, v121
  v_cvt_pk_bf16_f32 v45, v122, v123
  s_add_u32 s31, s52, 0
  s_mul_i32 s31, s31, 40960
  s_add_u32 s31, s31, 0xf200000
  buffer_store_dwordx2 v[40:41], v32, s[8:11], s31 offen sc1
  buffer_store_dwordx2 v[42:43], v33, s[8:11], s31 offen sc1
  buffer_store_dwordx2 v[44:45], v34, s[8:11], s31 offen sc1
  v_rcp_f32 v5, v15
  s_nop 0
  v_mul_f32 v128, v128, v5
  v_mul_f32 v129, v129, v5
  v_mul_f32 v130, v130, v5
  v_mul_f32 v131, v131, v5
  v_mul_f32 v132, v132, v5
  v_mul_f32 v133, v133, v5
  v_mul_f32 v134, v134, v5
  v_mul_f32 v135, v135, v5
  v_mul_f32 v136, v136, v5
  v_mul_f32 v137, v137, v5
  v_mul_f32 v138, v138, v5
  v_mul_f32 v139, v139, v5
  v_cvt_pk_bf16_f32 v48, v128, v129
  v_cvt_pk_bf16_f32 v49, v130, v131
  v_cvt_pk_bf16_f32 v50, v132, v133
  v_cvt_pk_bf16_f32 v51, v134, v135
  v_cvt_pk_bf16_f32 v52, v136, v137
  v_cvt_pk_bf16_f32 v53, v138, v139
  s_add_u32 s31, s52, 1
  s_mul_i32 s31, s31, 40960
  s_add_u32 s31, s31, 0xf200000
  buffer_store_dwordx2 v[48:49], v32, s[8:11], s31 offen sc1
  buffer_store_dwordx2 v[50:51], v33, s[8:11], s31 offen sc1
  buffer_store_dwordx2 v[52:53], v34, s[8:11], s31 offen sc1
  s_waitcnt vmcnt(0)
  s_barrier
  s_cmp_eq_u32 s21, 0
  s_cbranch_scc0 arr_39
  s_mov_b64 s[24:25], exec
  s_mov_b64 exec, 1
  v_mov_b32 v3, 0
  v_mov_b32 v4, 1
  buffer_atomic_add v4, v3, s[8:11], s48 offen
  s_mov_b64 exec, s[24:25]
arr_39:
  v_and_b32 v5, 15, v1
  v_lshrrev_b32 v6, 4, v1
  v_and_b32 v7, 1, v6
  v_lshlrev_b32 v7, 10, v7
  v_lshrrev_b32 v8, 1, v6
  v_lshlrev_b32 v8, 5, v8
  v_add_u32 v8, v8, v5
  v_lshlrev_b32 v8, 4, v8
  v_add_u32 v9, v7, v8
  s_lshr_b32 s26, s2, 2
  s_mul_i32 s27, s26, 81920
  s_lshl_b32 s28, s50, 11
  s_add_u32 s27, s27, s28
  s_add_u32 s27, s27, 0x1400000
  s_add_u32 s28, s27, 0
  buffer_load_dwordx4 v[16:19], v9, s[8:11], s28 offen sc1
  s_add_u32 s28, s27, 256
  buffer_load_dwordx4 v[20:23], v9, s[8:11], s28 offen sc1
  s_add_u32 s28, s27, 2048
  buffer_load_dwordx4 v[24:27], v9, s[8:11], s28 offen sc1
  s_add_u32 s28, s27, 2304
  buffer_load_dwordx4 v[28:31], v9, s[8:11], s28 offen sc1
  s_cmp_lt_u32 s21, 2
  s_cbranch_scc0 g3_40
  s_add_u32 s28, s27, 4096
  buffer_load_dwordx4 v[32:35], v9, s[8:11], s28 offen sc1
  s_add_u32 s28, s27, 4352
  buffer_load_dwordx4 v[36:39], v9, s[8:11], s28 offen sc1
g3_40:
  s_mov_b32 s45, 0
  v_mov_b32 v3, 0
aw_41:
  buffer_load_dword v4, v3, s[8:11], s48 offen sc1
  s_add_u32 s45, s45, 1
  s_waitcnt vmcnt(0)
  v_readfirstlane_b32 s29, v4
  s_cmp_ge_u32 s29, 32
  s_cbranch_scc1 aw_41_ok
  s_cmp_lt_u32 s45, 400000
  s_cbranch_scc1 aw_41
  s_branch kb1_abort
aw_41_ok:
  s_mul_i32 s28, s26, 40960
  s_mul_i32 s31, s21, 10240
  s_add_u32 s28, s28, s31
  s_add_u32 s28, s28, 0xf200000
  s_add_u32 m0, s31, 0
  s_add_u32 s29, s28, 0
  buffer_load_dwordx4 v2, s[8:11], s29 offen sc1 lds
  s_add_u32 m0, s31, 1024
  s_add_u32 s29, s28, 1024
  buffer_load_dwordx4 v2, s[8:11], s29 offen sc1 lds
  s_add_u32 m0, s31, 2048
  s_add_u32 s29, s28, 2048
  buffer_load_dwordx4 v2, s[8:11], s29 offen sc1 lds
  s_add_u32 m0, s31, 3072
  s_add_u32 s29, s28, 3072
  buffer_load_dwordx4 v2, s[8:11], s29 offen sc1 lds
  s_add_u32 m0, s31, 4096
  s_add_u32 s29, s28, 4096
  buffer_load_dwordx4 v2, s[8:11], s29 offen sc1 lds
  s_add_u32 m0, s31, 5120
  s_add_u32 s29, s28, 5120
  buffer_load_dwordx4 v2, s[8:11], s29 offen sc1 lds
  s_add_u32 m0, s31, 6144
  s_add_u32 s29, s28, 6144
  buffer_load_dwordx4 v2, s[8:11], s29 offen sc1 lds
  s_add_u32 m0, s31, 7168
  s_add_u32 s29, s28, 7168
  buffer_load_dwordx4 v2, s[8:11], s29 offen sc1 lds
  s_add_u32 m0, s31, 8192
  s_add_u32 s29, s28, 8192
  buffer_load_dwordx4 v2, s[8:11], s29 offen sc1 lds
  s_add_u32 m0, s31, 9216
  s_add_u32 s29, s28, 9216
  buffer_load_dwordx4 v2, s[8:11], s29 offen sc1 lds
  s_waitcnt vmcnt(0)
  s_barrier
  ds_read_b128 v[80:83], v2 offset:0
  ds_read_b128 v[84:87], v2 offset:20480
  ds_read_b128 v[88:91], v2 offset:1024
  ds_read_b128 v[92:95], v2 offset:21504
  ds_read_b128 v[96:99], v2 offset:2048
  ds_read_b128 v[100:103], v2 offset:22528
  s_waitcnt lgkmcnt(4)
  v_mfma_f32_16x16x32_bf16 v[48:51], a[0:3], v[80:83], 0
  v_mfma_f32_16x16x32_bf16 v[52:55], a[0:3], v[84:87], 0
  v_mfma_f32_16x16x32_bf16 v[56:59], a[80:83], v[80:83], 0
  v_mfma_f32_16x16x32_bf16 v[60:63], a[80:83], v[84:87], 0
  v_mfma_f32_16x16x32_bf16 v[64:67], a[160:163], v[80:83], 0
  v_mfma_f32_16x16x32_bf16 v[68:71], a[160:163], v[84:87], 0
  ds_read_b128 v[80:83], v2 offset:3072
  ds_read_b128 v[84:87], v2 offset:23552
  s_waitcnt lgkmcnt(4)
  v_mfma_f32_16x16x32_bf16 v[48:51], a[4:7], v[88:91], v[48:51]
  v_mfma_f32_16x16x32_bf16 v[52:55], a[4:7], v[92:95], v[52:55]
  v_mfma_f32_16x16x32_bf16 v[56:59], a[84:87], v[88:91], v[56:59]
  v_mfma_f32_16x16x32_bf16 v[60:63], a[84:87], v[92:95], v[60:63]
  v_mfma_f32_16x16x32_bf16 v[64:67], a[164:167], v[88:91], v[64:67]
  v_mfma_f32_16x16x32_bf16 v[68:71], a[164:167], v[92:95], v[68:71]
  ds_read_b128 v[88:91], v2 offset:4096
  ds_read_b128 v[92:95], v2 offset:24576
  s_waitcnt lgkmcnt(4)
  v_mfma_f32_16x16x32_bf16 v[48:51], a[8:11], v[96:99], v[48:51]
  v_mfma_f32_16x16x32_bf16 v[52:55], a[8:11], v[100:103], v[52:55]
  v_mfma_f32_16x16x32_bf16 v[56:59], a[88:91], v[96:99], v[56:59]
  v_mfma_f32_16x16x32_bf16 v[60:63], a[88:91], v[100:103], v[60:63]
  v_mfma_f32_16x16x32_bf16 v[64:67], a[168:171], v[96:99], v[64:67]
  v_mfma_f32_16x16x32_bf16 v[68:71], a[168:171], v[100:103], v[68:71]
  ds_read_b128 v[96:99], v2 offset:5120
  ds_read_b128 v[100:103], v2 offset:25600
  s_waitcnt lgkmcnt(4)
  v_mfma_f32_16x16x32_bf16 v[48:51], a[12:15], v[80:83], v[48:51]
  v_mfma_f32_16x16x32_bf16 v[52:55], a[12:15], v[84:87], v[52:55]
  v_mfma_f32_16x16x32_bf16 v[56:59], a[92:95], v[80:83], v[56:59]
  v_mfma_f32_16x16x32_bf16 v[60:63], a[92:95], v[84:87], v[60:63]
  v_mfma_f32_16x16x32_bf16 v[64:67], a[172:175], v[80:83], v[64:67]
  v_mfma_f32_16x16x32_bf16 v[68:71], a[172:175], v[84:87], v[68:71]
  ds_read_b128 v[80:83], v2 offset:6144
  ds_read_b128 v[84:87], v2 offset:26624
  s_waitcnt lgkmcnt(4)
  v_mfma_f32_16x16x32_bf16 v[48:51], a[16:19], v[88:91], v[48:51]
  v_mfma_f32_16x16x32_bf16 v[52:55], a[16:19], v[92:95], v[52:55]
  v_mfma_f32_16x16x32_bf16 v[56:59], a[96:99], v[88:91], v[56:59]
  v_mfma_f32_16x16x32_bf16 v[60:63], a[96:99], v[92:95], v[60:63]
  v_mfma_f32_16x16x32_bf16 v[64:67], a[176:179], v[88:91], v[64:67]
  v_mfma_f32_16x16x32_bf16 v[68:71], a[176:179], v[92:95], v[68:71]
  ds_read_b128 v[88:91], v2 offset:7168
  ds_read_b128 v[92:95], v2 offset:27648
  s_waitcnt lgkmcnt(4)
  v_mfma_f32_16x16x32_bf16 v[48:51], a[20:23], v[96:99], v[48:51]
  v_mfma_f32_16x16x32_bf16 v[52:55], a[20:23], v[100:103], v[52:55]
  v_mfma_f32_16x16x32_bf16 v[56:59], a[100:103], v[96:99], v[56:59]
  v_mfma_f32_16x16x32_bf16 v[60:63], a[100:103], v[100:103], v[60:63]
  v_mfma_f32_16x16x32_bf16 v[64:67], a[180:183], v[96:99], v[64:67]
  v_mfma_f32_16x16x32_bf16 v[68:71], a[180:183], v[100:103], v[68:71]
  ds_read_b128 v[96:99], v2 offset:8192
  ds_read_b128 v[100:103], v2 offset:28672
  s_waitcnt lgkmcnt(4)
  v_mfma_f32_16x16x32_bf16 v[48:51], a[24:27], v[80:83], v[48:51]
  v_mfma_f32_16x16x32_bf16 v[52:55], a[24:27], v[84:87], v[52:55]
  v_mfma_f32_16x16x32_bf16 v[56:59], a[104:107], v[80:83], v[56:59]
  v_mfma_f32_16x16x32_bf16 v[60:63], a[104:107], v[84:87], v[60:63]
  v_mfma_f32_16x16x32_bf16 v[64:67], a[184:187], v[80:83], v[64:67]
  v_mfma_f32_16x16x32_bf16 v[68:71], a[184:187], v[84:87], v[68:71]
  ds_read_b128 v[80:83], v2 offset:9216
  ds_read_b128 v[84:87], v2 offset:29696
  s_waitcnt lgkmcnt(4)
  v_mfma_f32_16x16x32_bf16 v[48:51], a[28:31], v[88:91], v[48:51]
  v_mfma_f32_16x16x32_bf16 v[52:55], a[28:31], v[92:95], v[52:55]
  v_mfma_f32_16x16x32_bf16 v[56:59], a[108:111], v[88:91], v[56:59]
  v_mfma_f32_16x16x32_bf16 v[60:63], a[108:111], v[92:95], v[60:63]
  v_mfma_f32_16x16x32_bf16 v[64:67], a[188:191], v[88:91], v[64:67]
  v_mfma_f32_16x16x32_bf16 v[68:71], a[188:191], v[92:95], v[68:71]
  ds_read_b128 v[88:91], v2 offset:10240
  ds_read_b128 v[92:95], v2 offset:30720
  s_waitcnt lgkmcnt(4)
  v_mfma_f32_16x16x32_bf16 v[48:51], a[32:35], v[96:99], v[48:51]
  v_mfma_f32_16x16x32_bf16 v[52:55], a[32:35], v[100:103], v[52:55]
  v_mfma_f32_16x16x32_bf16 v[56:59], a[112:115], v[96:99], v[56:59]
  v_mfma_f32_16x16x32_bf16 v[60:63], a[112:115], v[100:103], v[60:63]
  v_mfma_f32_16x16x32_bf16 v[64:67], a[192:195], v[96:99], v[64:67]
  v_mfma_f32_16x16x32_bf16 v[68:71], a[192:195], v[100:103], v[68:71]
  ds_read_b128 v[96:99], v2 offset:11264
  ds_read_b128 v[100:103], v2 offset:31744
  s_waitcnt lgkmcnt(4)
  v_mfma_f32_16x16x32_bf16 v[48:51], a[36:39], v[80:83], v[48:51]
  v_mfma_f32_16x16x32_bf16 v[52:55], a[36:39], v[84:87], v[52:55]
  v_mfma_f32_16x16x32_bf16 v[56:59], a[116:119], v[80:83], v[56:59]
  v_mfma_f32_16x16x32_bf16 v[60:63], a[116:119], v[84:87], v[60:63]
  v_mfma_f32_16x16x32_bf16 v[64:67], a[196:199], v[80:83], v[64:67]
  v_mfma_f32_16x16x32_bf16 v[68:71], a[196:199], v[84:87], v[68:71]
  ds_read_b128 v[80:83], v2 offset:12288
  ds_read_b128 v[84:87], v2 offset:32768
  s_waitcnt lgkmcnt(4)
  v_mfma_f32_16x16x32_bf16 v[48:51], a[40:43], v[88:91], v[48:51]
  v_mfma_f32_16x16x32_bf16 v[52:55], a[40:43], v[92:95], v[52:55]
  v_mfma_f32_16x16x32_bf16 v[56:59], a[120:123], v[88:91], v[56:59]
  v_mfma_f32_16x16x32_bf16 v[60:63], a[120:123], v[92:95], v[60:63]
  v_mfma_f32_16x16x32_bf16 v[64:67], a[200:203], v[88:91], v[64:67]
  v_mfma_f32_16x16x32_bf16 v[68:71], a[200:203], v[92:95], v[68:71]
  ds_read_b128 v[88:91], v2 offset:13312
  ds_read_b128 v[92:95], v2 offset:33792
  s_waitcnt lgkmcnt(4)
  v_mfma_f32_16x16x32_bf16 v[48:51], a[44:47], v[96:99], v[48:51]
  v_mfma_f32_16x16x32_bf16 v[52:55], a[44:47], v[100:103], v[52:55]
  v_mfma_f32_16x16x32_bf16 v[56:59], a[124:127], v[96:99], v[56:59]
  v_mfma_f32_16x16x32_bf16 v[60:63], a[124:127], v[100:103], v[60:63]
  v_mfma_f32_16x16x32_bf16 v[64:67], a[204:207], v[96:99], v[64:67]
  v_mfma_f32_16x16x32_bf16 v[68:71], a[204:207], v[100:103], v[68:71]
  ds_read_b128 v[96:99], v2 offset:14336
  ds_read_b128 v[100:103], v2 offset:34816
  s_waitcnt lgkmcnt(4)
  v_mfma_f32_16x16x32_bf16 v[48:51], a[48:51], v[80:83], v[48:51]
  v_mfma_f32_16x16x32_bf16 v[52:55], a[48:51], v[84:87], v[52:55]
  v_mfma_f32_16x16x32_bf16 v[56:59], a[128:131], v[80:83], v[56:59]
  v_mfma_f32_16x16x32_bf16 v[60:63], a[128:131], v[84:87], v[60:63]
  v_mfma_f32_16x16x32_bf16 v[64:67], a[208:211], v[80:83], v[64:67]
  v_mfma_f32_16x16x32_bf16 v[68:71], a[208:211], v[84:87], v[68:71]
  ds_read_b128 v[80:83], v2 offset:15360
  ds_read_b128 v[84:87], v2 offset:35840
  s_waitcnt lgkmcnt(4)
  v_mfma_f32_16x16x32_bf16 v[48:51], a[52:55], v[88:91], v[48:51]
  v_mfma_f32_16x16x32_bf16 v[52:55], a[52:55], v[92:95], v[52:55]
  v_mfma_f32_16x16x32_bf16 v[56:59], a[132:135], v[88:91], v[56:59]
  v_mfma_f32_16x16x32_bf16 v[60:63], a[132:135], v[92:95], v[60:63]
  v_mfma_f32_16x16x32_bf16 v[64:67], a[212:215], v[88:91], v[64:67]
  v_mfma_f32_16x16x32_bf16 v[68:71], a[212:215], v[92:95], v[68:71]
  ds_read_b128 v[88:91], v2 offset:16384
  ds_read_b128 v[92:95], v2 offset:36864
  s_waitcnt lgkmcnt(4)
  v_mfma_f32_16x16x32_bf16 v[48:51], a[56:59], v[96:99], v[48:51]
  v_mfma_f32_16x16x32_bf16 v[52:55], a[56:59], v[100:103], v[52:55]
  v_mfma_f32_16x16x32_bf16 v[56:59], a[136:139], v[96:99], v[56:59]
  v_mfma_f32_16x16x32_bf16 v[60:63], a[136:139], v[100:103], v[60:63]
  v_mfma_f32_16x16x32_bf16 v[64:67], a[216:219], v[96:99], v[64:67]
  v_mfma_f32_16x16x32_bf16 v[68:71], a[216:219], v[100:103], v[68:71]
  ds_read_b128 v[96:99], v2 offset:17408
  ds_read_b128 v[100:103], v2 offset:37888
  s_waitcnt lgkmcnt(4)
  v_mfma_f32_16x16x32_bf16 v[48:51], a[60:63], v[80:83], v[48:51]
  v_mfma_f32_16x16x32_bf16 v[52:55], a[60:63], v[84:87], v[52:55]
  v_mfma_f32_16x16x32_bf16 v[56:59], a[140:143], v[80:83], v[56:59]
  v_mfma_f32_16x16x32_bf16 v[60:63], a[140:143], v[84:87], v[60:63]
  v_mfma_f32_16x16x32_bf16 v[64:67], a[220:223], v[80:83], v[64:67]
  v_mfma_f32_16x16x32_bf16 v[68:71], a[220:223], v[84:87], v[68:71]
  ds_read_b128 v[80:83], v2 offset:18432
  ds_read_b128 v[84:87], v2 offset:38912
  s_waitcnt lgkmcnt(4)
  v_mfma_f32_16x16x32_bf16 v[48:51], a[64:67], v[88:91], v[48:51]
  v_mfma_f32_16x16x32_bf16 v[52:55], a[64:67], v[92:95], v[52:55]
  v_mfma_f32_16x16x32_bf16 v[56:59], a[144:147], v[88:91], v[56:59]
  v_mfma_f32_16x16x32_bf16 v[60:63], a[144:147], v[92:95], v[60:63]
  v_mfma_f32_16x16x32_bf16 v[64:67], a[224:227], v[88:91], v[64:67]
  v_mfma_f32_16x16x32_bf16 v[68:71], a[224:227], v[92:95], v[68:71]
  ds_read_b128 v[88:91], v2 offset:19456
  ds_read_b128 v[92:95], v2 offset:39936
  s_waitcnt lgkmcnt(4)
  v_mfma_f32_16x16x32_bf16 v[48:51], a[68:71], v[96:99], v[48:51]
  v_mfma_f32_16x16x32_bf16 v[52:55], a[68:71], v[100:103], v[52:55]
  v_mfma_f32_16x16x32_bf16 v[56:59], a[148:151], v[96:99], v[56:59]
  v_mfma_f32_16x16x32_bf16 v[60:63], a[148:151], v[100:103], v[60:63]
  v_mfma_f32_16x16x32_bf16 v[64:67], a[228:231], v[96:99], v[64:67]
  v_mfma_f32_16x16x32_bf16 v[68:71], a[228:231], v[100:103], v[68:71]
  s_waitcnt lgkmcnt(2)
  v_mfma_f32_16x16x32_bf16 v[48:51], a[72:75], v[80:83], v[48:51]
  v_mfma_f32_16x16x32_bf16 v[52:55], a[72:75], v[84:87], v[52:55]
  v_mfma_f32_16x16x32_bf16 v[56:59], a[152:155], v[80:83], v[56:59]
  v_mfma_f32_16x16x32_bf16 v[60:63], a[152:155], v[84:87], v[60:63]
  v_mfma_f32_16x16x32_bf16 v[64:67], a[232:235], v[80:83], v[64:67]
  v_mfma_f32_16x16x32_bf16 v[68:71], a[232:235], v[84:87], v[68:71]
  s_waitcnt lgkmcnt(0)
  v_mfma_f32_16x16x32_bf16 v[48:51], a[76:79], v[88:91], v[48:51]
  v_mfma_f32_16x16x32_bf16 v[52:55], a[76:79], v[92:95], v[52:55]
  v_mfma_f32_16x16x32_bf16 v[56:59], a[156:159], v[88:91], v[56:59]
  v_mfma_f32_16x16x32_bf16 v[60:63], a[156:159], v[92:95], v[60:63]
  v_mfma_f32_16x16x32_bf16 v[64:67], a[236:239], v[88:91], v[64:67]
  v_mfma_f32_16x16x32_bf16 v[68:71], a[236:239], v[92:95], v[68:71]
  s_nop 7
  v_add_f32 v48, v48, v16
  v_add_f32 v49, v49, v17
  v_add_f32 v50, v50, v18
  v_add_f32 v51, v51, v19
  s_add_u32 s28, s27, 0
  buffer_store_dwordx4 v[48:51], v9, s[8:11], s28 offen
  v_add_f32 v52, v52, v20
  v_add_f32 v53, v53, v21
  v_add_f32 v54, v54, v22
  v_add_f32 v55, v55, v23
  s_add_u32 s28, s27, 256
  buffer_store_dwordx4 v[52:55], v9, s[8:11], s28 offen
  v_add_f32 v56, v56, v24
  v_add_f32 v57, v57, v25
  v_add_f32 v58, v58, v26
  v_add_f32 v59, v59, v27
  s_add_u32 s28, s27, 2048
  buffer_store_dwordx4 v[56:59], v9, s[8:11], s28 offen
  v_add_f32 v60, v60, v28
  v_add_f32 v61, v61, v29
  v_add_f32 v62, v62, v30
  v_add_f32 v63, v63, v31
  s_add_u32 s28, s27, 2304
  buffer_store_dwordx4 v[60:63], v9, s[8:11], s28 offen
  s_cmp_lt_u32 s21, 2
  s_cbranch_scc0 g3_42
  v_add_f32 v64, v64, v32
  v_add_f32 v65, v65, v33
  v_add_f32 v66, v66, v34
  v_add_f32 v67, v67, v35
  s_add_u32 s28, s27, 4096
  buffer_store_dwordx4 v[64:67], v9, s[8:11], s28 offen
  v_add_f32 v68, v68, v36
  v_add_f32 v69, v69, v37
  v_add_f32 v70, v70, v38
  v_add_f32 v71, v71, v39
  s_add_u32 s28, s27, 4352
  buffer_store_dwordx4 v[68:71], v9, s[8:11], s28 offen
g3_42:
  s_endpgm
kb1_abort:
  s_load_dwordx2 s[6:7], s[0:1], 88
  v_mov_b32 v2, 80
  v_mov_b32 v3, 1
  s_waitcnt lgkmcnt(0)
  s_mov_b64 exec, 1
  global_atomic_add v2, v3, s[6:7]
  s_waitcnt vmcnt(0)
kb1_exit:
  s_endpgm

.section .rodata,"a"
.p2align 6
.amdhsa_kernel kb1_kernel
  .amdhsa_next_free_vgpr 512
  .amdhsa_next_free_sgpr 102
  .amdhsa_accum_offset 256
  .amdhsa_group_segment_fixed_size 0
  .amdhsa_kernarg_size 104
  .amdhsa_user_sgpr_count 2
  .amdhsa_user_sgpr_kernarg_segment_ptr 1
  .amdhsa_system_sgpr_workgroup_id_x 1
.end_amdhsa_kernel
.text
.globl ka2_kernel
.p2align 8
.type ka2_kernel,@function
ka2_kernel:
  s_mov_b32 s99, 1
ka_body:
  s_cmp_ge_u32 s2, 256
  s_cbranch_scc1 ka_exit

  s_load_dwordx2 s[4:5], s[0:1], 96
  s_load_dwordx2 s[6:7], s[0:1], 88
  s_load_dwordx4 s[36:39], s[0:1], 16
  s_load_dwordx4 s[40:43], s[0:1], 32
  s_getreg_b32 s26, hwreg(HW_REG_XCC_ID)
  s_and_b32 s26, s26, 15
  v_lshrrev_b32 v1, 6, v0
  s_nop 0
  v_readfirstlane_b32 s21, v1
  s_waitcnt lgkmcnt(0)
  s_mov_b32 s8, s4
  s_and_b32 s9, s5, 0xffff
  s_mov_b32 s10, 0x10000000
  s_mov_b32 s11, 0x20000
  s_cmp_eq_u32 s21, 0
  s_cbranch_scc0 ka_cen_done
  s_mov_b64 s[24:25], exec
  s_mov_b64 exec, 1
  v_mov_b32 v3, 1
  s_lshl_b32 s27, s26, 2
  v_mov_b32 v4, s27
  global_atomic_add v5, v4, v3, s[6:7] sc0
  v_mov_b32 v4, 64
  s_waitcnt vmcnt(0)
  global_atomic_add v6, v4, v3, s[6:7] sc0
  s_mov_b32 s45, 0
  s_waitcnt vmcnt(0)
ka_cen_spin:
  global_load_dword v7, v4, s[6:7] sc1
  s_add_u32 s45, s45, 1
  s_waitcnt vmcnt(0)
  v_readfirstlane_b32 s27, v7
  s_cmp_ge_u32 s27, 256
  s_cbranch_scc1 ka_cen_ok
  s_cmp_lt_u32 s45, 400000
  s_cbranch_scc1 ka_cen_spin
ka_cen_ok:
  s_mov_b64 exec, 0xff
  v_lshlrev_b32 v4, 2, v0
  global_load_dword v7, v4, s[6:7] sc1
  s_waitcnt vmcnt(0)
  v_cmp_ne_u32 vcc, 32, v7
  s_nop 1
  s_cmp_eq_u64 vcc, 0
  s_cselect_b32 s27, 1, 0
  s_cmp_ge_u32 s27, 1
  s_cselect_b32 s27, 1, 0
  s_mov_b64 exec, 1
  v_mov_b32 v8, s27
  v_mov_b32 v4, 0
  v_mov_b32 v9, 0
  ds_write_b128 v4, v[6:9]
  ds_write_b32 v4, v5 offset:16
  s_waitcnt lgkmcnt(0)
  s_mov_b64 exec, s[24:25]
ka_cen_done:
  s_barrier
  v_mov_b32 v4, 0
  ds_read_b128 v[6:9], v4
  ds_read_b32 v5, v4 offset:16
  s_waitcnt lgkmcnt(0)
  v_readfirstlane_b32 s27, v6
  v_readfirstlane_b32 s44, v8
  v_readfirstlane_b32 s28, v5
  s_barrier
  s_cmp_eq_u32 s44, 1
  s_cbranch_scc1 ka_cen_fast
  s_lshr_b32 s20, s27, 5
  s_and_b32 s22, s27, 31
  s_branch ka_cen_end
ka_cen_fast:
  s_mov_b32 s20, s26
  s_mov_b32 s22, s28
ka_cen_end:
  s_and_b32 s20, s20, 7
  s_and_b32 s22, s22, 31
  s_cmp_lt_u32 s20, 4
  s_cbranch_scc0 ka_bulk
  s_cmp_lt_u32 s22, 8
  s_cbranch_scc0 ka_noty
  s_lshl_b32 s23, s20, 3
  s_add_u32 s23, s23, s22
  s_cmp_eq_u32 s44, 1
  s_cbranch_scc1 kaf_x
  s_branch kas_x
ka_noty:
  s_cmp_lt_u32 s22, 28
  s_cbranch_scc0 ka_spare
  s_sub_u32 s23, s22, 8
  s_cmp_eq_u32 s44, 1
  s_cbranch_scc1 kaf_y
  s_branch kas_y
ka_bulk:
  s_sub_u32 s28, s20, 4
  s_lshl_b32 s23, s22, 2
  s_add_u32 s23, s23, s28
  s_cmp_lt_u32 s23, 72
  s_cbranch_scc1 ka_qkv
  s_sub_u32 s23, s23, 72
  s_cmp_lt_u32 s23, 32
  s_cbranch_scc1 ka_u
  s_sub_u32 s23, s23, 32
  s_cmp_eq_u32 s99, 1
  s_cbranch_scc1 ka_ln
  s_branch ka_exit
ka_ln:
  v_and_b32 v1, 63, v0
  s_lshl_b32 s46, s23, 2
  s_add_u32 s46, s46, s21
  v_and_b32 v5, 7, v1
  v_bfe_u32 v6, v1, 3, 1
  v_lshrrev_b32 v7, 4, v1
  v_lshlrev_b32 v8, 5, v6
  v_add_u32 v8, v8, v5
  v_lshlrev_b32 v8, 4, v8
  v_lshlrev_b32 v9, 11, v7
  v_add_u32 v9, v9, v8
  v_lshlrev_b32 v10, 10, v7
  v_add_u32 v10, v10, v8
ka_lnl:
  s_lshr_b32 s26, s46, 2
  s_and_b32 s27, s46, 3
  s_lshl_b32 s27, s27, 7
  s_mul_i32 s28, s26, 81920
  s_add_u32 s28, s28, s27
  s_add_u32 s28, s28, 0x1400000
  s_add_u32 s29, s28, 0
  buffer_load_dwordx4 v[16:19], v9, s[8:11], s29 offen
  s_add_u32 s29, s28, 1024
  buffer_load_dwordx4 v[20:23], v9, s[8:11], s29 offen
  s_add_u32 s29, s28, 8192
  buffer_load_dwordx4 v[24:27], v9, s[8:11], s29 offen
  s_add_u32 s29, s28, 9216
  buffer_load_dwordx4 v[28:31], v9, s[8:11], s29 offen
  s_add_u32 s29, s28, 16384
  buffer_load_dwordx4 v[32:35], v9, s[8:11], s29 offen
  s_add_u32 s29, s28, 17408
  buffer_load_dwordx4 v[36:39], v9, s[8:11], s29 offen
  s_add_u32 s29, s28, 24576
  buffer_load_dwordx4 v[40:43], v9, s[8:11], s29 offen
  s_add_u32 s29, s28, 25600
  buffer_load_dwordx4 v[44:47], v9, s[8:11], s29 offen
  s_add_u32 s29, s28, 32768
  buffer_load_dwordx4 v[48:51], v9, s[8:11], s29 offen
  s_add_u32 s29, s28, 33792
  buffer_load_dwordx4 v[52:55], v9, s[8:11], s29 offen
  s_add_u32 s29, s28, 40960
  buffer_load_dwordx4 v[56:59], v9, s[8:11], s29 offen
  s_add_u32 s29, s28, 41984
  buffer_load_dwordx4 v[60:63], v9, s[8:11], s29 offen
  s_add_u32 s29, s28, 49152
  buffer_load_dwordx4 v[64:67], v9, s[8:11], s29 offen
  s_add_u32 s29, s28, 50176
  buffer_load_dwordx4 v[68:71], v9, s[8:11], s29 offen
  s_add_u32 s29, s28, 57344
  buffer_load_dwordx4 v[72:75], v9, s[8:11], s29 offen
  s_add_u32 s29, s28, 58368
  buffer_load_dwordx4 v[76:79], v9, s[8:11], s29 offen
  s_add_u32 s29, s28, 65536
  buffer_load_dwordx4 v[80:83], v9, s[8:11], s29 offen
  s_add_u32 s29, s28, 66560
  buffer_load_dwordx4 v[84:87], v9, s[8:11], s29 offen
  s_add_u32 s29, s28, 73728
  buffer_load_dwordx4 v[88:91], v9, s[8:11], s29 offen
  s_add_u32 s29, s28, 74752
  buffer_load_dwordx4 v[92:95], v9, s[8:11], s29 offen
  s_waitcnt vmcnt(0)
  v_add_f32 v12, v16, v17
  v_add_f32 v12, v12, v18
  v_add_f32 v12, v12, v19
  v_add_f32 v12, v12, v20
  v_add_f32 v12, v12, v21
  v_add_f32 v12, v12, v22
  v_add_f32 v12, v12, v23
  v_add_f32 v12, v12, v24
  v_add_f32 v12, v12, v25
  v_add_f32 v12, v12, v26
  v_add_f32 v12, v12, v27
  v_add_f32 v12, v12, v28
  v_add_f32 v12, v12, v29
  v_add_f32 v12, v12, v30
  v_add_f32 v12, v12, v31
  v_add_f32 v12, v12, v32
  v_add_f32 v12, v12, v33
  v_add_f32 v12, v12, v34
  v_add_f32 v12, v12, v35
  v_add_f32 v12, v12, v36
  v_add_f32 v12, v12, v37
  v_add_f32 v12, v12, v38
  v_add_f32 v12, v12, v39
  v_add_f32 v12, v12, v40
  v_add_f32 v12, v12, v41
  v_add_f32 v12, v12, v42
  v_add_f32 v12, v12, v43
  v_add_f32 v12, v12, v44
  v_add_f32 v12, v12, v45
  v_add_f32 v12, v12, v46
  v_add_f32 v12, v12, v47
  v_add_f32 v12, v12, v48
  v_add_f32 v12, v12, v49
  v_add_f32 v12, v12, v50
  v_add_f32 v12, v12, v51
  v_add_f32 v12, v12, v52
  v_add_f32 v12, v12, v53
  v_add_f32 v12, v12, v54
  v_add_f32 v12, v12, v55
  v_add_f32 v12, v12, v56
  v_add_f32 v12, v12, v57
  v_add_f32 v12, v12, v58
  v_add_f32 v12, v12, v59
  v_add_f32 v12, v12, v60
  v_add_f32 v12, v12, v61
  v_add_f32 v12, v12, v62
  v_add_f32 v12, v12, v63
  v_add_f32 v12, v12, v64
  v_add_f32 v12, v12, v65
  v_add_f32 v12, v12, v66
  v_add_f32 v12, v12, v67
  v_add_f32 v12, v12, v68
  v_add_f32 v12, v12, v69
  v_add_f32 v12, v12, v70
  v_add_f32 v12, v12, v71
  v_add_f32 v12, v12, v72
  v_add_f32 v12, v12, v73
  v_add_f32 v12, v12, v74
  v_add_f32 v12, v12, v75
  v_add_f32 v12, v12, v76
  v_add_f32 v12, v12, v77
  v_add_f32 v12, v12, v78
  v_add_f32 v12, v12, v79
  v_add_f32 v12, v12, v80
  v_add_f32 v12, v12, v81
  v_add_f32 v12, v12, v82
  v_add_f32 v12, v12, v83
  v_add_f32 v12, v12, v84
  v_add_f32 v12, v12, v85
  v_add_f32 v12, v12, v86
  v_add_f32 v12, v12, v87
  v_add_f32 v12, v12, v88
  v_add_f32 v12, v12, v89
  v_add_f32 v12, v12, v90
  v_add_f32 v12, v12, v91
  v_add_f32 v12, v12, v92
  v_add_f32 v12, v12, v93
  v_add_f32 v12, v12, v94
  v_add_f32 v12, v12, v95
  s_nop 1
  v_add_f32_dpp v12, v12, v12 row_ror:8 row_mask:0xf bank_mask:0xf
  v_mov_b32 v13, v12
  s_nop 1
  v_permlane16_swap_b32 v12, v13
  v_add_f32 v12, v12, v13
  v_mov_b32 v13, v12
  s_nop 1
  v_permlane32_swap_b32 v12, v13
  v_add_f32 v12, v12, v13
  v_mul_f32 v12, 0x3acccccd, v12
  v_sub_f32 v16, v16, v12
  v_sub_f32 v17, v17, v12
  v_sub_f32 v18, v18, v12
  v_sub_f32 v19, v19, v12
  v_sub_f32 v20, v20, v12
  v_sub_f32 v21, v21, v12
  v_sub_f32 v22, v22, v12
  v_sub_f32 v23, v23, v12
  v_sub_f32 v24, v24, v12
  v_sub_f32 v25, v25, v12
  v_sub_f32 v26, v26, v12
  v_sub_f32 v27, v27, v12
  v_sub_f32 v28, v28, v12
  v_sub_f32 v29, v29, v12
  v_sub_f32 v30, v30, v12
  v_sub_f32 v31, v31, v12
  v_sub_f32 v32, v32, v12
  v_sub_f32 v33, v33, v12
  v_sub_f32 v34, v34, v12
  v_sub_f32 v35, v35, v12
  v_sub_f32 v36, v36, v12
  v_sub_f32 v37, v37, v12
  v_sub_f32 v38, v38, v12
  v_sub_f32 v39, v39, v12
  v_sub_f32 v40, v40, v12
  v_sub_f32 v41, v41, v12
  v_sub_f32 v42, v42, v12
  v_sub_f32 v43, v43, v12
  v_sub_f32 v44, v44, v12
  v_sub_f32 v45, v45, v12
  v_sub_f32 v46, v46, v12
  v_sub_f32 v47, v47, v12
  v_sub_f32 v48, v48, v12
  v_sub_f32 v49, v49, v12
  v_sub_f32 v50, v50, v12
  v_sub_f32 v51, v51, v12
  v_sub_f32 v52, v52, v12
  v_sub_f32 v53, v53, v12
  v_sub_f32 v54, v54, v12
  v_sub_f32 v55, v55, v12
  v_sub_f32 v56, v56, v12
  v_sub_f32 v57, v57, v12
  v_sub_f32 v58, v58, v12
  v_sub_f32 v59, v59, v12
  v_sub_f32 v60, v60, v12
  v_sub_f32 v61, v61, v12
  v_sub_f32 v62, v62, v12
  v_sub_f32 v63, v63, v12
  v_sub_f32 v64, v64, v12
  v_sub_f32 v65, v65, v12
  v_sub_f32 v66, v66, v12
  v_sub_f32 v67, v67, v12
  v_sub_f32 v68, v68, v12
  v_sub_f32 v69, v69, v12
  v_sub_f32 v70, v70, v12
  v_sub_f32 v71, v71, v12
  v_sub_f32 v72, v72, v12
  v_sub_f32 v73, v73, v12
  v_sub_f32 v74, v74, v12
  v_sub_f32 v75, v75, v12
  v_sub_f32 v76, v76, v12
  v_sub_f32 v77, v77, v12
  v_sub_f32 v78, v78, v12
  v_sub_f32 v79, v79, v12
  v_sub_f32 v80, v80, v12
  v_sub_f32 v81, v81, v12
  v_sub_f32 v82, v82, v12
  v_sub_f32 v83, v83, v12
  v_sub_f32 v84, v84, v12
  v_sub_f32 v85, v85, v12
  v_sub_f32 v86, v86, v12
  v_sub_f32 v87, v87, v12
  v_sub_f32 v88, v88, v12
  v_sub_f32 v89, v89, v12
  v_sub_f32 v90, v90, v12
  v_sub_f32 v91, v91, v12
  v_sub_f32 v92, v92, v12
  v_sub_f32 v93, v93, v12
  v_sub_f32 v94, v94, v12
  v_sub_f32 v95, v95, v12
  v_mul_f32 v12, v16, v16
  v_fmac_f32 v12, v17, v17
  v_fmac_f32 v12, v18, v18
  v_fmac_f32 v12, v19, v19
  v_fmac_f32 v12, v20, v20
  v_fmac_f32 v12, v21, v21
  v_fmac_f32 v12, v22, v22
  v_fmac_f32 v12, v23, v23
  v_fmac_f32 v12, v24, v24
  v_fmac_f32 v12, v25, v25
  v_fmac_f32 v12, v26, v26
  v_fmac_f32 v12, v27, v27
  v_fmac_f32 v12, v28, v28
  v_fmac_f32 v12, v29, v29
  v_fmac_f32 v12, v30, v30
  v_fmac_f32 v12, v31, v31
  v_fmac_f32 v12, v32, v32
  v_fmac_f32 v12, v33, v33
  v_fmac_f32 v12, v34, v34
  v_fmac_f32 v12, v35, v35
  v_fmac_f32 v12, v36, v36
  v_fmac_f32 v12, v37, v37
  v_fmac_f32 v12, v38, v38
  v_fmac_f32 v12, v39, v39
  v_fmac_f32 v12, v40, v40
  v_fmac_f32 v12, v41, v41
  v_fmac_f32 v12, v42, v42
  v_fmac_f32 v12, v43, v43
  v_fmac_f32 v12, v44, v44
  v_fmac_f32 v12, v45, v45
  v_fmac_f32 v12, v46, v46
  v_fmac_f32 v12, v47, v47
  v_fmac_f32 v12, v48, v48
  v_fmac_f32 v12, v49, v49
  v_fmac_f32 v12, v50, v50
  v_fmac_f32 v12, v51, v51
  v_fmac_f32 v12, v52, v52
  v_fmac_f32 v12, v53, v53
  v_fmac_f32 v12, v54, v54
  v_fmac_f32 v12, v55, v55
  v_fmac_f32 v12, v56, v56
  v_fmac_f32 v12, v57, v57
  v_fmac_f32 v12, v58, v58
  v_fmac_f32 v12, v59, v59
  v_fmac_f32 v12, v60, v60
  v_fmac_f32 v12, v61, v61
  v_fmac_f32 v12, v62, v62
  v_fmac_f32 v12, v63, v63
  v_fmac_f32 v12, v64, v64
  v_fmac_f32 v12, v65, v65
  v_fmac_f32 v12, v66, v66
  v_fmac_f32 v12, v67, v67
  v_fmac_f32 v12, v68, v68
  v_fmac_f32 v12, v69, v69
  v_fmac_f32 v12, v70, v70
  v_fmac_f32 v12, v71, v71
  v_fmac_f32 v12, v72, v72
  v_fmac_f32 v12, v73, v73
  v_fmac_f32 v12, v74, v74
  v_fmac_f32 v12, v75, v75
  v_fmac_f32 v12, v76, v76
  v_fmac_f32 v12, v77, v77
  v_fmac_f32 v12, v78, v78
  v_fmac_f32 v12, v79, v79
  v_fmac_f32 v12, v80, v80
  v_fmac_f32 v12, v81, v81
  v_fmac_f32 v12, v82, v82
  v_fmac_f32 v12, v83, v83
  v_fmac_f32 v12, v84, v84
  v_fmac_f32 v12, v85, v85
  v_fmac_f32 v12, v86, v86
  v_fmac_f32 v12, v87, v87
  v_fmac_f32 v12, v88, v88
  v_fmac_f32 v12, v89, v89
  v_fmac_f32 v12, v90, v90
  v_fmac_f32 v12, v91, v91
  v_fmac_f32 v12, v92, v92
  v_fmac_f32 v12, v93, v93
  v_fmac_f32 v12, v94, v94
  v_fmac_f32 v12, v95, v95
  s_nop 1
  v_add_f32_dpp v12, v12, v12 row_ror:8 row_mask:0xf bank_mask:0xf
  v_mov_b32 v13, v12
  s_nop 1
  v_permlane16_swap_b32 v12, v13
  v_add_f32 v12, v12, v13
  v_mov_b32 v13, v12
  s_nop 1
  v_permlane32_swap_b32 v12, v13
  v_add_f32 v12, v12, v13
  v_mov_b32 v13, 0x3727c5ac
  v_fmac_f32 v13, 0x3acccccd, v12
  v_rsq_f32 v13, v13
  s_nop 0
  v_mul_f32 v16, v16, v13
  v_mul_f32 v17, v17, v13
  v_mul_f32 v18, v18, v13
  v_mul_f32 v19, v19, v13
  v_mul_f32 v20, v20, v13
  v_mul_f32 v21, v21, v13
  v_mul_f32 v22, v22, v13
  v_mul_f32 v23, v23, v13
  v_mul_f32 v24, v24, v13
  v_mul_f32 v25, v25, v13
  v_mul_f32 v26, v26, v13
  v_mul_f32 v27, v27, v13
  v_mul_f32 v28, v28, v13
  v_mul_f32 v29, v29, v13
  v_mul_f32 v30, v30, v13
  v_mul_f32 v31, v31, v13
  v_mul_f32 v32, v32, v13
  v_mul_f32 v33, v33, v13
  v_mul_f32 v34, v34, v13
  v_mul_f32 v35, v35, v13
  v_mul_f32 v36, v36, v13
  v_mul_f32 v37, v37, v13
  v_mul_f32 v38, v38, v13
  v_mul_f32 v39, v39, v13
  v_mul_f32 v40, v40, v13
  v_mul_f32 v41, v41, v13
  v_mul_f32 v42, v42, v13
  v_mul_f32 v43, v43, v13
  v_mul_f32 v44, v44, v13
  v_mul_f32 v45, v45, v13
  v_mul_f32 v46, v46, v13
  v_mul_f32 v47, v47, v13
  v_mul_f32 v48, v48, v13
  v_mul_f32 v49, v49, v13
  v_mul_f32 v50, v50, v13
  v_mul_f32 v51, v51, v13
  v_mul_f32 v52, v52, v13
  v_mul_f32 v53, v53, v13
  v_mul_f32 v54, v54, v13
  v_mul_f32 v55, v55, v13
  v_mul_f32 v56, v56, v13
  v_mul_f32 v57, v57, v13
  v_mul_f32 v58, v58, v13
  v_mul_f32 v59, v59, v13
  v_mul_f32 v60, v60, v13
  v_mul_f32 v61, v61, v13
  v_mul_f32 v62, v62, v13
  v_mul_f32 v63, v63, v13
  v_mul_f32 v64, v64, v13
  v_mul_f32 v65, v65, v13
  v_mul_f32 v66, v66, v13
  v_mul_f32 v67, v67, v13
  v_mul_f32 v68, v68, v13
  v_mul_f32 v69, v69, v13
  v_mul_f32 v70, v70, v13
  v_mul_f32 v71, v71, v13
  v_mul_f32 v72, v72, v13
  v_mul_f32 v73, v73, v13
  v_mul_f32 v74, v74, v13
  v_mul_f32 v75, v75, v13
  v_mul_f32 v76, v76, v13
  v_mul_f32 v77, v77, v13
  v_mul_f32 v78, v78, v13
  v_mul_f32 v79, v79, v13
  v_mul_f32 v80, v80, v13
  v_mul_f32 v81, v81, v13
  v_mul_f32 v82, v82, v13
  v_mul_f32 v83, v83, v13
  v_mul_f32 v84, v84, v13
  v_mul_f32 v85, v85, v13
  v_mul_f32 v86, v86, v13
  v_mul_f32 v87, v87, v13
  v_mul_f32 v88, v88, v13
  v_mul_f32 v89, v89, v13
  v_mul_f32 v90, v90, v13
  v_mul_f32 v91, v91, v13
  v_mul_f32 v92, v92, v13
  v_mul_f32 v93, v93, v13
  v_mul_f32 v94, v94, v13
  v_mul_f32 v95, v95, v13
  v_cvt_pk_bf16_f32 v16, v16, v17
  v_cvt_pk_bf16_f32 v17, v18, v19
  v_cvt_pk_bf16_f32 v18, v20, v21
  v_cvt_pk_bf16_f32 v19, v22, v23
  v_cvt_pk_bf16_f32 v20, v24, v25
  v_cvt_pk_bf16_f32 v21, v26, v27
  v_cvt_pk_bf16_f32 v22, v28, v29
  v_cvt_pk_bf16_f32 v23, v30, v31
  v_cvt_pk_bf16_f32 v24, v32, v33
  v_cvt_pk_bf16_f32 v25, v34, v35
  v_cvt_pk_bf16_f32 v26, v36, v37
  v_cvt_pk_bf16_f32 v27, v38, v39
  v_cvt_pk_bf16_f32 v28, v40, v41
  v_cvt_pk_bf16_f32 v29, v42, v43
  v_cvt_pk_bf16_f32 v30, v44, v45
  v_cvt_pk_bf16_f32 v31, v46, v47
  v_cvt_pk_bf16_f32 v32, v48, v49
  v_cvt_pk_bf16_f32 v33, v50, v51
  v_cvt_pk_bf16_f32 v34, v52, v53
  v_cvt_pk_bf16_f32 v35, v54, v55
  v_cvt_pk_bf16_f32 v36, v56, v57
  v_cvt_pk_bf16_f32 v37, v58, v59
  v_cvt_pk_bf16_f32 v38, v60, v61
  v_cvt_pk_bf16_f32 v39, v62, v63
  v_cvt_pk_bf16_f32 v40, v64, v65
  v_cvt_pk_bf16_f32 v41, v66, v67
  v_cvt_pk_bf16_f32 v42, v68, v69
  v_cvt_pk_bf16_f32 v43, v70, v71
  v_cvt_pk_bf16_f32 v44, v72, v73
  v_cvt_pk_bf16_f32 v45, v74, v75
  v_cvt_pk_bf16_f32 v46, v76, v77
  v_cvt_pk_bf16_f32 v47, v78, v79
  v_cvt_pk_bf16_f32 v48, v80, v81
  v_cvt_pk_bf16_f32 v49, v82, v83
  v_cvt_pk_bf16_f32 v50, v84, v85
  v_cvt_pk_bf16_f32 v51, v86, v87
  v_cvt_pk_bf16_f32 v52, v88, v89
  v_cvt_pk_bf16_f32 v53, v90, v91
  v_cvt_pk_bf16_f32 v54, v92, v93
  v_cvt_pk_bf16_f32 v55, v94, v95
  s_mul_i32 s28, s26, 40960
  s_add_u32 s28, s28, s27
  s_add_u32 s28, s28, 0x100000
  s_add_u32 s29, s28, 0
  buffer_store_dwordx4 v[16:19], v10, s[8:11], s29 offen sc1
  s_add_u32 s29, s28, 4096
  buffer_store_dwordx4 v[20:23], v10, s[8:11], s29 offen sc1
  s_add_u32 s29, s28, 8192
  buffer_store_dwordx4 v[24:27], v10, s[8:11], s29 offen sc1
  s_add_u32 s29, s28, 12288
  buffer_store_dwordx4 v[28:31], v10, s[8:11], s29 offen sc1
  s_add_u32 s29, s28, 16384
  buffer_store_dwordx4 v[32:35], v10, s[8:11], s29 offen sc1
  s_add_u32 s29, s28, 20480
  buffer_store_dwordx4 v[36:39], v10, s[8:11], s29 offen sc1
  s_add_u32 s29, s28, 24576
  buffer_store_dwordx4 v[40:43], v10, s[8:11], s29 offen sc1
  s_add_u32 s29, s28, 28672
  buffer_store_dwordx4 v[44:47], v10, s[8:11], s29 offen sc1
  s_add_u32 s29, s28, 32768
  buffer_store_dwordx4 v[48:51], v10, s[8:11], s29 offen sc1
  s_add_u32 s29, s28, 36864
  buffer_store_dwordx4 v[52:55], v10, s[8:11], s29 offen sc1
  s_waitcnt vmcnt(0)
  s_mov_b64 s[24:25], exec
  s_mov_b64 exec, 1
  v_mov_b32 v3, 4992
  v_mov_b32 v4, 1
  buffer_atomic_add v4, v3, s[8:11], 0 offen
  s_mov_b64 exec, s[24:25]
  s_add_u32 s46, s46, 96
  s_cmp_lt_u32 s46, 256
  s_cbranch_scc1 ka_lnl
  s_waitcnt vmcnt(0)
  s_branch ka_exit
ka_spare:
  s_cmp_eq_u32 s20, 0
  s_cbranch_scc0 ka_pf
  s_cmp_eq_u32 s22, 28
  s_cbranch_scc0 ka_pf
  s_cmp_eq_u32 s21, 0
  s_cbranch_scc0 ka_pf
  s_mov_b64 s[24:25], exec
  s_mov_b64 exec, 1
  v_mov_b32 v2, 0
  v_mov_b32 v3, 0
  s_mov_b32 s30, -1
  s_mov_b32 s31, -1
  s_mov_b32 s28, 0xb00000
  buffer_store_dword v3, v2, s[8:11], s28 offen sc1
  s_waitcnt vmcnt(0)
  s_memtime s[32:33]
  s_waitcnt lgkmcnt(0)
  buffer_load_dword v4, v2, s[8:11], s28 offen sc1
  s_waitcnt vmcnt(0)
  s_memtime s[34:35]
  s_waitcnt lgkmcnt(0)
  s_sub_u32 s34, s34, s32
  s_min_u32 s30, s30, s34
  s_mov_b32 s28, 0xb02000
  buffer_store_dword v3, v2, s[8:11], s28 offen sc1
  s_waitcnt vmcnt(0)
  s_memtime s[32:33]
  s_waitcnt lgkmcnt(0)
  buffer_load_dword v4, v2, s[8:11], s28 offen sc1
  s_waitcnt vmcnt(0)
  s_memtime s[34:35]
  s_waitcnt lgkmcnt(0)
  s_sub_u32 s34, s34, s32
  s_min_u32 s31, s31, s34
  s_mov_b32 s28, 0xb00100
  buffer_store_dword v3, v2, s[8:11], s28 offen sc1
  s_waitcnt vmcnt(0)
  s_memtime s[32:33]
  s_waitcnt lgkmcnt(0)
  buffer_load_dword v4, v2, s[8:11], s28 offen sc1
  s_waitcnt vmcnt(0)
  s_memtime s[34:35]
  s_waitcnt lgkmcnt(0)
  s_sub_u32 s34, s34, s32
  s_min_u32 s30, s30, s34
  s_mov_b32 s28, 0xb02100
  buffer_store_dword v3, v2, s[8:11], s28 offen sc1
  s_waitcnt vmcnt(0)
  s_memtime s[32:33]
  s_waitcnt lgkmcnt(0)
  buffer_load_dword v4, v2, s[8:11], s28 offen sc1
  s_waitcnt vmcnt(0)
  s_memtime s[34:35]
  s_waitcnt lgkmcnt(0)
  s_sub_u32 s34, s34, s32
  s_min_u32 s31, s31, s34
  s_mov_b32 s28, 0xb00200
  buffer_store_dword v3, v2, s[8:11], s28 offen sc1
  s_waitcnt vmcnt(0)
  s_memtime s[32:33]
  s_waitcnt lgkmcnt(0)
  buffer_load_dword v4, v2, s[8:11], s28 offen sc1
  s_waitcnt vmcnt(0)
  s_memtime s[34:35]
  s_waitcnt lgkmcnt(0)
  s_sub_u32 s34, s34, s32
  s_min_u32 s30, s30, s34
  s_mov_b32 s28, 0xb02200
  buffer_store_dword v3, v2, s[8:11], s28 offen sc1
  s_waitcnt vmcnt(0)
  s_memtime s[32:33]
  s_waitcnt lgkmcnt(0)
  buffer_load_dword v4, v2, s[8:11], s28 offen sc1
  s_waitcnt vmcnt(0)
  s_memtime s[34:35]
  s_waitcnt lgkmcnt(0)
  s_sub_u32 s34, s34, s32
  s_min_u32 s31, s31, s34
  s_mov_b32 s28, 0xb00300
  buffer_store_dword v3, v2, s[8:11], s28 offen sc1
  s_waitcnt vmcnt(0)
  s_memtime s[32:33]
  s_waitcnt lgkmcnt(0)
  buffer_load_dword v4, v2, s[8:11], s28 offen sc1
  s_waitcnt vmcnt(0)
  s_memtime s[34:35]
  s_waitcnt lgkmcnt(0)
  s_sub_u32 s34, s34, s32
  s_min_u32 s30, s30, s34
  s_mov_b32 s28, 0xb02300
  buffer_store_dword v3, v2, s[8:11], s28 offen sc1
  s_waitcnt vmcnt(0)
  s_memtime s[32:33]
  s_waitcnt lgkmcnt(0)
  buffer_load_dword v4, v2, s[8:11], s28 offen sc1
  s_waitcnt vmcnt(0)
  s_memtime s[34:35]
  s_waitcnt lgkmcnt(0)
  s_sub_u32 s34, s34, s32
  s_min_u32 s31, s31, s34
  s_cmp_lt_u32 s30, s31
  s_cselect_b32 s28, 1, 2
  v_mov_b32 v3, s28
  v_mov_b32 v2, 5056
  buffer_store_dword v3, v2, s[8:11], 0 offen sc1
  v_mov_b32 v3, s30
  buffer_store_dword v3, v2, s[8:11], 0 offen offset:4 sc1
  v_mov_b32 v3, s31
  buffer_store_dword v3, v2, s[8:11], 0 offen offset:8 sc1
  s_waitcnt vmcnt(0)
  s_mov_b64 exec, s[24:25]
ka_pf:
  v_and_b32 v1, 63, v0
  v_lshlrev_b32 v4, 6, v1
  s_sub_u32 s46, s22, 28
  s_lshl_b32 s46, s46, 2
  s_add_u32 s46, s46, s21
  s_mul_i32 s28, s20, 24
  v_and_b32 v5, 15, v1
  v_min_u32 v5, 11, v5
  v_cmp_le_u32 vcc, 6, v5
  v_subrev_u32 v6, 6, v5
  v_mov_b32 v7, 0x400
  v_cndmask_b32 v5, v5, v6, vcc
  v_cndmask_b32 v7, 0, v7, vcc
  v_lshlrev_b32 v5, 2, v5
  v_add_u32 v5, v5, v7
  s_add_u32 s28, s28, 0
  v_add_u32 v5, s28, v5
  v_and_b32 v6, 7, v1
  v_lshlrev_b32 v6, 2, v6
  s_lshl_b32 s28, s20, 5
  s_add_u32 s28, s28, 3072
  v_add_u32 v6, s28, v6
  s_mul_i32 s47, s20, 327680
  s_mul_i32 s28, s46, 20480
  s_add_u32 s47, s47, s28
  s_add_u32 s47, s47, 0x9000000
  s_mul_i32 s28, s46, 3
  s_add_u32 s28, s28, 0
  s_cmp_ge_u32 s28, 24
  s_cselect_b32 s29, 0x1800000, 0
  s_cselect_b32 s30, 24, 0
  s_sub_u32 s28, s28, s30
  s_mul_i32 s30, s28, 43
  s_lshr_b32 s30, s30, 7
  s_mul_i32 s31, s30, 3
  s_sub_u32 s31, s28, s31
  s_lshl_b32 s28, s20, 3
  s_add_u32 s30, s30, s28
  s_mul_i32 s30, s30, 786432
  s_lshl_b32 s31, s31, 12
  s_add_u32 s30, s30, s31
  s_add_u32 s30, s30, 0x4800000
  s_add_u32 s48, s30, s29
  s_mul_i32 s28, s46, 3
  s_add_u32 s28, s28, 1
  s_cmp_ge_u32 s28, 24
  s_cselect_b32 s29, 0x1800000, 0
  s_cselect_b32 s30, 24, 0
  s_sub_u32 s28, s28, s30
  s_mul_i32 s30, s28, 43
  s_lshr_b32 s30, s30, 7
  s_mul_i32 s31, s30, 3
  s_sub_u32 s31, s28, s31
  s_lshl_b32 s28, s20, 3
  s_add_u32 s30, s30, s28
  s_mul_i32 s30, s30, 786432
  s_lshl_b32 s31, s31, 12
  s_add_u32 s30, s30, s31
  s_add_u32 s30, s30, 0x4800000
  s_add_u32 s49, s30, s29
  s_mul_i32 s28, s46, 3
  s_add_u32 s28, s28, 2
  s_cmp_ge_u32 s28, 24
  s_cselect_b32 s29, 0x1800000, 0
  s_cselect_b32 s30, 24, 0
  s_sub_u32 s28, s28, s30
  s_mul_i32 s30, s28, 43
  s_lshr_b32 s30, s30, 7
  s_mul_i32 s31, s30, 3
  s_sub_u32 s31, s28, s31
  s_lshl_b32 s28, s20, 3
  s_add_u32 s30, s30, s28
  s_mul_i32 s30, s30, 786432
  s_lshl_b32 s31, s31, 12
  s_add_u32 s30, s30, s31
  s_add_u32 s30, s30, 0x4800000
  s_add_u32 s50, s30, s29
  s_mul_i32 s28, s20, 327680
  s_add_u32 s28, s28, 0x700000
  s_lshl_b32 s29, s46, 12
  s_add_u32 s51, s28, s29
  s_mov_b32 s52, 5120
  s_cmp_ge_u32 s46, 2
  s_cbranch_scc0 ka_pf1
  s_mul_i32 s28, s20, 655360
  s_add_u32 s28, s28, 0x402800
  s_sub_u32 s29, s46, 2
  s_lshl_b32 s29, s29, 12
  s_add_u32 s51, s28, s29
  s_mov_b32 s52, 10240
  s_cmp_ge_u32 s46, 5
  s_cbranch_scc0 ka_pf1
  s_mul_i32 s28, s20, 1310720
  s_add_u32 s28, s28, 0xe00000
  s_sub_u32 s29, s46, 5
  s_lshl_b32 s29, s29, 12
  s_add_u32 s51, s28, s29
  s_mov_b32 s52, 20480
ka_pf1:
  s_mul_i32 s53, s20, 655360
  s_add_u32 s53, s53, 0x400000
  s_mov_b32 s54, 0
  s_mov_b32 s55, 0
  s_mov_b32 s56, 0
  v_mov_b32 v7, 0
ka_pfl:
  s_cmp_gt_u32 s54, 3
  s_cbranch_scc0 ka_pfgo
  s_sub_u32 s28, s54, 3
  s_mul_i32 s28, s28, 10240
  s_add_u32 s28, s28, s53
  s_mov_b32 s45, 0
ka_pfw:
  buffer_load_dword v8, v7, s[8:11], s28 offen sc1
  s_add_u32 s45, s45, 1
  s_waitcnt vmcnt(0)
  v_readfirstlane_b32 s29, v8
  s_cmp_lg_u32 s29, -1
  s_cbranch_scc1 ka_pfgo
  s_sleep 4
  s_cmp_lt_u32 s45, 400000
  s_cbranch_scc1 ka_pfw
  s_branch ka_exit
ka_pfgo:
  s_cmp_lt_u32 s46, 10
  s_cbranch_scc0 ka_pf2
  buffer_load_dword v9, v4, s[8:11], s51 offen sc1
ka_pf2:
  s_cmp_gt_u32 s55, s54
  s_cbranch_scc1 ka_wp_43_ok
  s_mov_b32 s45, 0
ka_wp_43_spin:
  buffer_load_dword v2, v5, s[8:11], 0 offen sc1
  s_add_u32 s45, s45, 1
  s_waitcnt vmcnt(0)
  v_min_u32_dpp v3, v2, v2 quad_perm:[1,0,3,2] row_mask:0xf bank_mask:0xf
  s_nop 1
  v_min_u32_dpp v2, v3, v3 quad_perm:[2,3,0,1] row_mask:0xf bank_mask:0xf
  s_nop 1
  v_min_u32_dpp v3, v2, v2 row_half_mirror row_mask:0xf bank_mask:0xf
  s_nop 1
  v_min_u32_dpp v2, v3, v3 row_mirror row_mask:0xf bank_mask:0xf
  s_nop 0
  v_readfirstlane_b32 s55, v2
  s_cmp_gt_u32 s55, s54
  s_cbranch_scc1 ka_wp_43_ok
  s_cmp_lt_u32 s45, 400000
  s_cbranch_scc1 ka_wp_43_spin
  s_branch ka_abort
ka_wp_43_ok:
  buffer_load_dword v10, v4, s[8:11], s48 offen sc1
  buffer_load_dword v11, v4, s[8:11], s49 offen sc1
  buffer_load_dword v12, v4, s[8:11], s50 offen sc1
  s_cmp_gt_u32 s56, s54
  s_cbranch_scc1 ka_wp_44_ok
  s_mov_b32 s45, 0
ka_wp_44_spin:
  buffer_load_dword v2, v6, s[8:11], 0 offen sc1
  s_add_u32 s45, s45, 1
  s_waitcnt vmcnt(0)
  v_min_u32_dpp v3, v2, v2 quad_perm:[1,0,3,2] row_mask:0xf bank_mask:0xf
  s_nop 1
  v_min_u32_dpp v2, v3, v3 quad_perm:[2,3,0,1] row_mask:0xf bank_mask:0xf
  s_nop 1
  v_min_u32_dpp v3, v2, v2 row_half_mirror row_mask:0xf bank_mask:0xf
  s_nop 1
  v_min_u32_dpp v2, v3, v3 quad_perm:[0,1,2,3] row_mask:0xf bank_mask:0xf
  s_nop 0
  v_readfirstlane_b32 s56, v2
  s_cmp_gt_u32 s56, s54
  s_cbranch_scc1 ka_wp_44_ok
  s_cmp_lt_u32 s45, 400000
  s_cbranch_scc1 ka_wp_44_spin
  s_branch ka_abort
ka_wp_44_ok:
  s_add_u32 s28, s47, 0
  buffer_load_dword v13, v4, s[8:11], s28 offen sc1
  s_add_u32 s28, s47, 4096
  buffer_load_dword v14, v4, s[8:11], s28 offen sc1
  s_add_u32 s28, s47, 8192
  buffer_load_dword v15, v4, s[8:11], s28 offen sc1
  s_add_u32 s28, s47, 12288
  buffer_load_dword v16, v4, s[8:11], s28 offen sc1
  s_add_u32 s28, s47, 16384
  buffer_load_dword v17, v4, s[8:11], s28 offen sc1
  s_add_u32 s47, s47, 1310720
  s_add_u32 s48, s48, 12288
  s_add_u32 s49, s49, 12288
  s_add_u32 s50, s50, 12288
  s_add_u32 s51, s51, s52
  s_add_u32 s54, s54, 1
  s_waitcnt vmcnt(0)
  s_cmp_lt_u32 s54, 64
  s_cbranch_scc1 ka_pfl
  s_branch ka_exit
ka_qkv:
  s_mul_i32 s26, s23, 43
  s_lshr_b32 s26, s26, 10
  s_mul_i32 s27, s26, 24
  s_sub_u32 s27, s23, s27
  s_cmp_eq_u32 s26, 0
  s_cselect_b32 s28, s36, s38
  s_cselect_b32 s29, s37, s39
  s_cmp_eq_u32 s26, 2
  s_cselect_b32 s28, s40, s28
  s_cselect_b32 s29, s41, s29
  s_mov_b32 s12, s28
  s_and_b32 s13, s29, 0xffff
  s_mov_b32 s14, 0x780000
  s_mov_b32 s15, 0x20000
  s_mul_i32 s46, s26, 0x1800000
  s_add_u32 s46, s46, 0x4800000
  s_lshl_b32 s47, s26, 10
  s_lshl_b32 s28, s27, 2
  s_add_u32 s47, s47, s28
  s_add_u32 s47, s47, 0
  s_lshl_b32 s28, s27, 3
  s_lshl_b32 s29, s21, 1
  s_add_u32 s28, s28, s29
  s_add_u32 s29, s28, 0
  s_mul_i32 s30, s29, 171
  s_lshr_b32 s30, s30, 10
  s_mul_i32 s31, s30, 6
  s_sub_u32 s31, s29, s31
  s_mul_i32 s30, s30, 786432
  s_lshl_b32 s31, s31, 11
  s_add_u32 s30, s30, s31
  s_add_u32 s48, s30, s46
  s_add_u32 s29, s28, 1
  s_mul_i32 s30, s29, 171
  s_lshr_b32 s30, s30, 10
  s_mul_i32 s31, s30, 6
  s_sub_u32 s31, s29, s31
  s_mul_i32 s30, s30, 786432
  s_lshl_b32 s31, s31, 11
  s_add_u32 s30, s30, s31
  s_add_u32 s49, s30, s46
  v_and_b32 v1, 63, v0
  v_lshrrev_b32 v2, 4, v1
  v_bfe_u32 v3, v1, 2, 2
  v_and_b32 v4, 3, v1
  s_lshr_b32 s28, s21, 1
  s_lshl_b32 s28, s28, 2
  v_add_u32 v5, s28, v3
  v_mul_u32_u24 v5, 12288, v5
  s_and_b32 s28, s21, 1
  s_lshl_b32 s28, s28, 8
  s_lshl_b32 s29, s27, 9
  s_add_u32 s28, s28, s29
  v_add_u32 v5, s28, v5
  v_lshlrev_b32 v6, 6, v2
  v_add_u32 v5, v5, v6
  v_lshlrev_b32 v6, 4, v4
  v_add_u32 v5, v5, v6
  v_lshrrev_b32 v6, 1, v2
  v_lshlrev_b32 v7, 12, v6
  v_lshlrev_b32 v6, 6, v3
  v_add_u32 v7, v7, v6
  v_and_b32 v6, 1, v2
  v_lshlrev_b32 v6, 5, v6
  v_add_u32 v7, v7, v6
  v_lshrrev_b32 v6, 1, v4
  v_lshlrev_b32 v6, 4, v6
  v_add_u32 v7, v7, v6
  v_and_b32 v6, 1, v4
  v_lshlrev_b32 v6, 3, v6
  v_add_u32 v7, v7, v6
  s_lshl_b32 s28, s21, 9
  v_add_u32 v7, s28, v7
  s_lshl_b32 s29, s21, 10
  s_add_u32 m0, s29, 0
  s_mov_b32 s28, 0
  buffer_load_dwordx4 v5, s[12:15], s28 offen lds
  s_lshl_b32 s29, s21, 10
  s_add_u32 m0, s29, 4096
  s_mov_b32 s28, 98304
  buffer_load_dwordx4 v5, s[12:15], s28 offen lds
  s_lshl_b32 s29, s21, 10
  s_add_u32 m0, s29, 8192
  s_mov_b32 s28, 196608
  buffer_load_dwordx4 v5, s[12:15], s28 offen lds
  s_lshl_b32 s29, s21, 10
  s_add_u32 m0, s29, 12288
  s_mov_b32 s28, 294912
  buffer_load_dwordx4 v5, s[12:15], s28 offen lds
  s_lshl_b32 s29, s21, 10
  s_add_u32 m0, s29, 16384
  s_mov_b32 s28, 393216
  buffer_load_dwordx4 v5, s[12:15], s28 offen lds
  s_lshl_b32 s29, s21, 10
  s_add_u32 m0, s29, 20480
  s_mov_b32 s28, 491520
  buffer_load_dwordx4 v5, s[12:15], s28 offen lds
  s_lshl_b32 s29, s21, 10
  s_add_u32 m0, s29, 24576
  s_mov_b32 s28, 589824
  buffer_load_dwordx4 v5, s[12:15], s28 offen lds
  s_lshl_b32 s29, s21, 10
  s_add_u32 m0, s29, 28672
  s_mov_b32 s28, 688128
  buffer_load_dwordx4 v5, s[12:15], s28 offen lds
  s_lshl_b32 s29, s21, 10
  s_add_u32 m0, s29, 32768
  s_mov_b32 s28, 786432
  buffer_load_dwordx4 v5, s[12:15], s28 offen lds
  s_lshl_b32 s29, s21, 10
  s_add_u32 m0, s29, 36864
  s_mov_b32 s28, 884736
  buffer_load_dwordx4 v5, s[12:15], s28 offen lds
  s_lshl_b32 s29, s21, 10
  s_add_u32 m0, s29, 40960
  s_mov_b32 s28, 983040
  buffer_load_dwordx4 v5, s[12:15], s28 offen lds
  s_lshl_b32 s29, s21, 10
  s_add_u32 m0, s29, 45056
  s_mov_b32 s28, 1081344
  buffer_load_dwordx4 v5, s[12:15], s28 offen lds
  s_lshl_b32 s29, s21, 10
  s_add_u32 m0, s29, 49152
  s_mov_b32 s28, 1179648
  buffer_load_dwordx4 v5, s[12:15], s28 offen lds
  s_lshl_b32 s29, s21, 10
  s_add_u32 m0, s29, 53248
  s_mov_b32 s28, 1277952
  buffer_load_dwordx4 v5, s[12:15], s28 offen lds
  s_lshl_b32 s29, s21, 10
  s_add_u32 m0, s29, 57344
  s_mov_b32 s28, 1376256
  buffer_load_dwordx4 v5, s[12:15], s28 offen lds
  s_lshl_b32 s29, s21, 10
  s_add_u32 m0, s29, 61440
  s_mov_b32 s28, 1474560
  buffer_load_dwordx4 v5, s[12:15], s28 offen lds
  s_lshl_b32 s29, s21, 10
  s_add_u32 m0, s29, 65536
  s_mov_b32 s28, 1572864
  buffer_load_dwordx4 v5, s[12:15], s28 offen lds
  s_lshl_b32 s29, s21, 10
  s_add_u32 m0, s29, 69632
  s_mov_b32 s28, 1671168
  buffer_load_dwordx4 v5, s[12:15], s28 offen lds
  s_lshl_b32 s29, s21, 10
  s_add_u32 m0, s29, 73728
  s_mov_b32 s28, 1769472
  buffer_load_dwordx4 v5, s[12:15], s28 offen lds
  s_lshl_b32 s29, s21, 10
  s_add_u32 m0, s29, 77824
  s_mov_b32 s28, 1867776
  buffer_load_dwordx4 v5, s[12:15], s28 offen lds
  s_lshl_b32 s29, s21, 10
  s_add_u32 m0, s29, 81920
  s_mov_b32 s28, 1966080
  buffer_load_dwordx4 v5, s[12:15], s28 offen lds
  s_lshl_b32 s29, s21, 10
  s_add_u32 m0, s29, 86016
  s_mov_b32 s28, 2064384
  buffer_load_dwordx4 v5, s[12:15], s28 offen lds
  s_lshl_b32 s29, s21, 10
  s_add_u32 m0, s29, 90112
  s_mov_b32 s28, 2162688
  buffer_load_dwordx4 v5, s[12:15], s28 offen lds
  s_lshl_b32 s29, s21, 10
  s_add_u32 m0, s29, 94208
  s_mov_b32 s28, 2260992
  buffer_load_dwordx4 v5, s[12:15], s28 offen lds
  s_waitcnt vmcnt(20)
  s_barrier
  s_lshl_b32 s29, s21, 10
  s_add_u32 m0, s29, 98304
  s_mov_b32 s28, 2359296
  buffer_load_dwordx4 v5, s[12:15], s28 offen lds
  s_lshl_b32 s29, s21, 10
  s_add_u32 m0, s29, 102400
  s_mov_b32 s28, 2457600
  buffer_load_dwordx4 v5, s[12:15], s28 offen lds
  s_lshl_b32 s29, s21, 10
  s_add_u32 m0, s29, 106496
  s_mov_b32 s28, 2555904
  buffer_load_dwordx4 v5, s[12:15], s28 offen lds
  s_lshl_b32 s29, s21, 10
  s_add_u32 m0, s29, 110592
  s_mov_b32 s28, 2654208
  buffer_load_dwordx4 v5, s[12:15], s28 offen lds
  v_add_u32 v8, 0, v7
  ds_read_b64_tr_b16 a[0:1], v8 offset:0
  ds_read_b64_tr_b16 a[2:3], v8 offset:2048
  ds_read_b64_tr_b16 a[4:5], v8 offset:8192
  ds_read_b64_tr_b16 a[6:7], v8 offset:10240
  ds_read_b64_tr_b16 a[160:161], v8 offset:256
  ds_read_b64_tr_b16 a[162:163], v8 offset:2304
  ds_read_b64_tr_b16 a[164:165], v8 offset:8448
  ds_read_b64_tr_b16 a[166:167], v8 offset:10496
  s_waitcnt lgkmcnt(0)
  s_waitcnt vmcnt(20)
  s_barrier
  s_lshl_b32 s29, s21, 10
  s_add_u32 m0, s29, 114688
  s_mov_b32 s28, 2752512
  buffer_load_dwordx4 v5, s[12:15], s28 offen lds
  s_lshl_b32 s29, s21, 10
  s_add_u32 m0, s29, 118784
  s_mov_b32 s28, 2850816
  buffer_load_dwordx4 v5, s[12:15], s28 offen lds
  s_lshl_b32 s29, s21, 10
  s_add_u32 m0, s29, 122880
  s_mov_b32 s28, 2949120
  buffer_load_dwordx4 v5, s[12:15], s28 offen lds
  s_lshl_b32 s29, s21, 10
  s_add_u32 m0, s29, 126976
  s_mov_b32 s28, 3047424
  buffer_load_dwordx4 v5, s[12:15], s28 offen lds
  v_add_u32 v8, 16384, v7
  ds_read_b64_tr_b16 a[8:9], v8 offset:0
  ds_read_b64_tr_b16 a[10:11], v8 offset:2048
  ds_read_b64_tr_b16 a[12:13], v8 offset:8192
  ds_read_b64_tr_b16 a[14:15], v8 offset:10240
  ds_read_b64_tr_b16 a[168:169], v8 offset:256
  ds_read_b64_tr_b16 a[170:171], v8 offset:2304
  ds_read_b64_tr_b16 a[172:173], v8 offset:8448
  ds_read_b64_tr_b16 a[174:175], v8 offset:10496
  s_waitcnt lgkmcnt(0)
  s_waitcnt vmcnt(20)
  s_barrier
  s_lshl_b32 s29, s21, 10
  s_add_u32 m0, s29, 0
  s_mov_b32 s28, 3145728
  buffer_load_dwordx4 v5, s[12:15], s28 offen lds
  s_lshl_b32 s29, s21, 10
  s_add_u32 m0, s29, 4096
  s_mov_b32 s28, 3244032
  buffer_load_dwordx4 v5, s[12:15], s28 offen lds
  s_lshl_b32 s29, s21, 10
  s_add_u32 m0, s29, 8192
  s_mov_b32 s28, 3342336
  buffer_load_dwordx4 v5, s[12:15], s28 offen lds
  s_lshl_b32 s29, s21, 10
  s_add_u32 m0, s29, 12288
  s_mov_b32 s28, 3440640
  buffer_load_dwordx4 v5, s[12:15], s28 offen lds
  v_add_u32 v8, 32768, v7
  ds_read_b64_tr_b16 a[16:17], v8 offset:0
  ds_read_b64_tr_b16 a[18:19], v8 offset:2048
  ds_read_b64_tr_b16 a[20:21], v8 offset:8192
  ds_read_b64_tr_b16 a[22:23], v8 offset:10240
  ds_read_b64_tr_b16 a[176:177], v8 offset:256
  ds_read_b64_tr_b16 a[178:179], v8 offset:2304
  ds_read_b64_tr_b16 a[180:181], v8 offset:8448
  ds_read_b64_tr_b16 a[182:183], v8 offset:10496
  s_waitcnt lgkmcnt(0)
  s_waitcnt vmcnt(20)
  s_barrier
  s_lshl_b32 s29, s21, 10
  s_add_u32 m0, s29, 16384
  s_mov_b32 s28, 3538944
  buffer_load_dwordx4 v5, s[12:15], s28 offen lds
  s_lshl_b32 s29, s21, 10
  s_add_u32 m0, s29, 20480
  s_mov_b32 s28, 3637248
  buffer_load_dwordx4 v5, s[12:15], s28 offen lds
  s_lshl_b32 s29, s21, 10
  s_add_u32 m0, s29, 24576
  s_mov_b32 s28, 3735552
  buffer_load_dwordx4 v5, s[12:15], s28 offen lds
  s_lshl_b32 s29, s21, 10
  s_add_u32 m0, s29, 28672
  s_mov_b32 s28, 3833856
  buffer_load_dwordx4 v5, s[12:15], s28 offen lds
  v_add_u32 v8, 49152, v7
  ds_read_b64_tr_b16 a[24:25], v8 offset:0
  ds_read_b64_tr_b16 a[26:27], v8 offset:2048
  ds_read_b64_tr_b16 a[28:29], v8 offset:8192
  ds_read_b64_tr_b16 a[30:31], v8 offset:10240
  ds_read_b64_tr_b16 a[184:185], v8 offset:256
  ds_read_b64_tr_b16 a[186:187], v8 offset:2304
  ds_read_b64_tr_b16 a[188:189], v8 offset:8448
  ds_read_b64_tr_b16 a[190:191], v8 offset:10496
  s_waitcnt lgkmcnt(0)
  s_waitcnt vmcnt(20)
  s_barrier
  s_lshl_b32 s29, s21, 10
  s_add_u32 m0, s29, 32768
  s_mov_b32 s28, 3932160
  buffer_load_dwordx4 v5, s[12:15], s28 offen lds
  s_lshl_b32 s29, s21, 10
  s_add_u32 m0, s29, 36864
  s_mov_b32 s28, 4030464
  buffer_load_dwordx4 v5, s[12:15], s28 offen lds
  s_lshl_b32 s29, s21, 10
  s_add_u32 m0, s29, 40960
  s_mov_b32 s28, 4128768
  buffer_load_dwordx4 v5, s[12:15], s28 offen lds
  s_lshl_b32 s29, s21, 10
  s_add_u32 m0, s29, 45056
  s_mov_b32 s28, 4227072
  buffer_load_dwordx4 v5, s[12:15], s28 offen lds
  v_add_u32 v8, 65536, v7
  ds_read_b64_tr_b16 a[32:33], v8 offset:0
  ds_read_b64_tr_b16 a[34:35], v8 offset:2048
  ds_read_b64_tr_b16 a[36:37], v8 offset:8192
  ds_read_b64_tr_b16 a[38:39], v8 offset:10240
  ds_read_b64_tr_b16 a[192:193], v8 offset:256
  ds_read_b64_tr_b16 a[194:195], v8 offset:2304
  ds_read_b64_tr_b16 a[196:197], v8 offset:8448
  ds_read_b64_tr_b16 a[198:199], v8 offset:10496
  s_waitcnt lgkmcnt(0)
  s_waitcnt vmcnt(20)
  s_barrier
  s_lshl_b32 s29, s21, 10
  s_add_u32 m0, s29, 49152
  s_mov_b32 s28, 4325376
  buffer_load_dwordx4 v5, s[12:15], s28 offen lds
  s_lshl_b32 s29, s21, 10
  s_add_u32 m0, s29, 53248
  s_mov_b32 s28, 4423680
  buffer_load_dwordx4 v5, s[12:15], s28 offen lds
  s_lshl_b32 s29, s21, 10
  s_add_u32 m0, s29, 57344
  s_mov_b32 s28, 4521984
  buffer_load_dwordx4 v5, s[12:15], s28 offen lds
  s_lshl_b32 s29, s21, 10
  s_add_u32 m0, s29, 61440
  s_mov_b32 s28, 4620288
  buffer_load_dwordx4 v5, s[12:15], s28 offen lds
  v_add_u32 v8, 81920, v7
  ds_read_b64_tr_b16 a[40:41], v8 offset:0
  ds_read_b64_tr_b16 a[42:43], v8 offset:2048
  ds_read_b64_tr_b16 a[44:45], v8 offset:8192
  ds_read_b64_tr_b16 a[46:47], v8 offset:10240
  ds_read_b64_tr_b16 a[200:201], v8 offset:256
  ds_read_b64_tr_b16 a[202:203], v8 offset:2304
  ds_read_b64_tr_b16 a[204:205], v8 offset:8448
  ds_read_b64_tr_b16 a[206:207], v8 offset:10496
  s_waitcnt lgkmcnt(0)
  s_waitcnt vmcnt(20)
  s_barrier
  s_lshl_b32 s29, s21, 10
  s_add_u32 m0, s29, 65536
  s_mov_b32 s28, 4718592
  buffer_load_dwordx4 v5, s[12:15], s28 offen lds
  s_lshl_b32 s29, s21, 10
  s_add_u32 m0, s29, 69632
  s_mov_b32 s28, 4816896
  buffer_load_dwordx4 v5, s[12:15], s28 offen lds
  s_lshl_b32 s29, s21, 10
  s_add_u32 m0, s29, 73728
  s_mov_b32 s28, 4915200
  buffer_load_dwordx4 v5, s[12:15], s28 offen lds
  s_lshl_b32 s29, s21, 10
  s_add_u32 m0, s29, 77824
  s_mov_b32 s28, 5013504
  buffer_load_dwordx4 v5, s[12:15], s28 offen lds
  v_add_u32 v8, 98304, v7
  ds_read_b64_tr_b16 a[48:49], v8 offset:0
  ds_read_b64_tr_b16 a[50:51], v8 offset:2048
  ds_read_b64_tr_b16 a[52:53], v8 offset:8192
  ds_read_b64_tr_b16 a[54:55], v8 offset:10240
  ds_read_b64_tr_b16 a[208:209], v8 offset:256
  ds_read_b64_tr_b16 a[210:211], v8 offset:2304
  ds_read_b64_tr_b16 a[212:213], v8 offset:8448
  ds_read_b64_tr_b16 a[214:215], v8 offset:10496
  s_waitcnt lgkmcnt(0)
  s_waitcnt vmcnt(20)
  s_barrier
  s_lshl_b32 s29, s21, 10
  s_add_u32 m0, s29, 81920
  s_mov_b32 s28, 5111808
  buffer_load_dwordx4 v5, s[12:15], s28 offen lds
  s_lshl_b32 s29, s21, 10
  s_add_u32 m0, s29, 86016
  s_mov_b32 s28, 5210112
  buffer_load_dwordx4 v5, s[12:15], s28 offen lds
  s_lshl_b32 s29, s21, 10
  s_add_u32 m0, s29, 90112
  s_mov_b32 s28, 5308416
  buffer_load_dwordx4 v5, s[12:15], s28 offen lds
  s_lshl_b32 s29, s21, 10
  s_add_u32 m0, s29, 94208
  s_mov_b32 s28, 5406720
  buffer_load_dwordx4 v5, s[12:15], s28 offen lds
  v_add_u32 v8, 114688, v7
  ds_read_b64_tr_b16 a[56:57], v8 offset:0
  ds_read_b64_tr_b16 a[58:59], v8 offset:2048
  ds_read_b64_tr_b16 a[60:61], v8 offset:8192
  ds_read_b64_tr_b16 a[62:63], v8 offset:10240
  ds_read_b64_tr_b16 a[216:217], v8 offset:256
  ds_read_b64_tr_b16 a[218:219], v8 offset:2304
  ds_read_b64_tr_b16 a[220:221], v8 offset:8448
  ds_read_b64_tr_b16 a[222:223], v8 offset:10496
  s_waitcnt lgkmcnt(0)
  s_waitcnt vmcnt(20)
  s_barrier
  s_lshl_b32 s29, s21, 10
  s_add_u32 m0, s29, 98304
  s_mov_b32 s28, 5505024
  buffer_load_dwordx4 v5, s[12:15], s28 offen lds
  s_lshl_b32 s29, s21, 10
  s_add_u32 m0, s29, 102400
  s_mov_b32 s28, 5603328
  buffer_load_dwordx4 v5, s[12:15], s28 offen lds
  s_lshl_b32 s29, s21, 10
  s_add_u32 m0, s29, 106496
  s_mov_b32 s28, 5701632
  buffer_load_dwordx4 v5, s[12:15], s28 offen lds
  s_lshl_b32 s29, s21, 10
  s_add_u32 m0, s29, 110592
  s_mov_b32 s28, 5799936
  buffer_load_dwordx4 v5, s[12:15], s28 offen lds
  v_add_u32 v8, 0, v7
  ds_read_b64_tr_b16 a[64:65], v8 offset:0
  ds_read_b64_tr_b16 a[66:67], v8 offset:2048
  ds_read_b64_tr_b16 a[68:69], v8 offset:8192
  ds_read_b64_tr_b16 a[70:71], v8 offset:10240
  ds_read_b64_tr_b16 a[224:225], v8 offset:256
  ds_read_b64_tr_b16 a[226:227], v8 offset:2304
  ds_read_b64_tr_b16 a[228:229], v8 offset:8448
  ds_read_b64_tr_b16 a[230:231], v8 offset:10496
  s_waitcnt lgkmcnt(0)
  s_waitcnt vmcnt(20)
  s_barrier
  s_lshl_b32 s29, s21, 10
  s_add_u32 m0, s29, 114688
  s_mov_b32 s28, 5898240
  buffer_load_dwordx4 v5, s[12:15], s28 offen lds
  s_lshl_b32 s29, s21, 10
  s_add_u32 m0, s29, 118784
  s_mov_b32 s28, 5996544
  buffer_load_dwordx4 v5, s[12:15], s28 offen lds
  s_lshl_b32 s29, s21, 10
  s_add_u32 m0, s29, 122880
  s_mov_b32 s28, 6094848
  buffer_load_dwordx4 v5, s[12:15], s28 offen lds
  s_lshl_b32 s29, s21, 10
  s_add_u32 m0, s29, 126976
  s_mov_b32 s28, 6193152
  buffer_load_dwordx4 v5, s[12:15], s28 offen lds
  v_add_u32 v8, 16384, v7
  ds_read_b64_tr_b16 a[72:73], v8 offset:0
  ds_read_b64_tr_b16 a[74:75], v8 offset:2048
  ds_read_b64_tr_b16 a[76:77], v8 offset:8192
  ds_read_b64_tr_b16 a[78:79], v8 offset:10240
  ds_read_b64_tr_b16 a[232:233], v8 offset:256
  ds_read_b64_tr_b16 a[234:235], v8 offset:2304
  ds_read_b64_tr_b16 a[236:237], v8 offset:8448
  ds_read_b64_tr_b16 a[238:239], v8 offset:10496
  s_waitcnt lgkmcnt(0)
  s_waitcnt vmcnt(20)
  s_barrier
  s_lshl_b32 s29, s21, 10
  s_add_u32 m0, s29, 0
  s_mov_b32 s28, 6291456
  buffer_load_dwordx4 v5, s[12:15], s28 offen lds
  s_lshl_b32 s29, s21, 10
  s_add_u32 m0, s29, 4096
  s_mov_b32 s28, 6389760
  buffer_load_dwordx4 v5, s[12:15], s28 offen lds
  s_lshl_b32 s29, s21, 10
  s_add_u32 m0, s29, 8192
  s_mov_b32 s28, 6488064
  buffer_load_dwordx4 v5, s[12:15], s28 offen lds
  s_lshl_b32 s29, s21, 10
  s_add_u32 m0, s29, 12288
  s_mov_b32 s28, 6586368
  buffer_load_dwordx4 v5, s[12:15], s28 offen lds
  v_add_u32 v8, 32768, v7
  ds_read_b64_tr_b16 a[80:81], v8 offset:0
  ds_read_b64_tr_b16 a[82:83], v8 offset:2048
  ds_read_b64_tr_b16 a[84:85], v8 offset:8192
  ds_read_b64_tr_b16 a[86:87], v8 offset:10240
  ds_read_b64_tr_b16 a[240:241], v8 offset:256
  ds_read_b64_tr_b16 a[242:243], v8 offset:2304
  ds_read_b64_tr_b16 a[244:245], v8 offset:8448
  ds_read_b64_tr_b16 a[246:247], v8 offset:10496
  s_waitcnt lgkmcnt(0)
  s_waitcnt vmcnt(20)
  s_barrier
  s_lshl_b32 s29, s21, 10
  s_add_u32 m0, s29, 16384
  s_mov_b32 s28, 6684672
  buffer_load_dwordx4 v5, s[12:15], s28 offen lds
  s_lshl_b32 s29, s21, 10
  s_add_u32 m0, s29, 20480
  s_mov_b32 s28, 6782976
  buffer_load_dwordx4 v5, s[12:15], s28 offen lds
  s_lshl_b32 s29, s21, 10
  s_add_u32 m0, s29, 24576
  s_mov_b32 s28, 6881280
  buffer_load_dwordx4 v5, s[12:15], s28 offen lds
  s_lshl_b32 s29, s21, 10
  s_add_u32 m0, s29, 28672
  s_mov_b32 s28, 6979584
  buffer_load_dwordx4 v5, s[12:15], s28 offen lds
  v_add_u32 v8, 49152, v7
  ds_read_b64_tr_b16 a[88:89], v8 offset:0
  ds_read_b64_tr_b16 a[90:91], v8 offset:2048
  ds_read_b64_tr_b16 a[92:93], v8 offset:8192
  ds_read_b64_tr_b16 a[94:95], v8 offset:10240
  ds_read_b64_tr_b16 a[248:249], v8 offset:256
  ds_read_b64_tr_b16 a[250:251], v8 offset:2304
  ds_read_b64_tr_b16 a[252:253], v8 offset:8448
  ds_read_b64_tr_b16 a[254:255], v8 offset:10496
  s_waitcnt lgkmcnt(0)
  s_waitcnt vmcnt(20)
  s_barrier
  s_lshl_b32 s29, s21, 10
  s_add_u32 m0, s29, 32768
  s_mov_b32 s28, 7077888
  buffer_load_dwordx4 v5, s[12:15], s28 offen lds
  s_lshl_b32 s29, s21, 10
  s_add_u32 m0, s29, 36864
  s_mov_b32 s28, 7176192
  buffer_load_dwordx4 v5, s[12:15], s28 offen lds
  s_lshl_b32 s29, s21, 10
  s_add_u32 m0, s29, 40960
  s_mov_b32 s28, 7274496
  buffer_load_dwordx4 v5, s[12:15], s28 offen lds
  s_lshl_b32 s29, s21, 10
  s_add_u32 m0, s29, 45056
  s_mov_b32 s28, 7372800
  buffer_load_dwordx4 v5, s[12:15], s28 offen lds
  v_add_u32 v8, 65536, v7
  ds_read_b64_tr_b16 a[96:97], v8 offset:0
  ds_read_b64_tr_b16 a[98:99], v8 offset:2048
  ds_read_b64_tr_b16 a[100:101], v8 offset:8192
  ds_read_b64_tr_b16 a[102:103], v8 offset:10240
  ds_read_b64_tr_b16 v[192:193], v8 offset:256
  ds_read_b64_tr_b16 v[194:195], v8 offset:2304
  ds_read_b64_tr_b16 v[196:197], v8 offset:8448
  ds_read_b64_tr_b16 v[198:199], v8 offset:10496
  s_waitcnt lgkmcnt(0)
  s_waitcnt vmcnt(20)
  s_barrier
  s_lshl_b32 s29, s21, 10
  s_add_u32 m0, s29, 49152
  s_mov_b32 s28, 7471104
  buffer_load_dwordx4 v5, s[12:15], s28 offen lds
  s_lshl_b32 s29, s21, 10
  s_add_u32 m0, s29, 53248
  s_mov_b32 s28, 7569408
  buffer_load_dwordx4 v5, s[12:15], s28 offen lds
  s_lshl_b32 s29, s21, 10
  s_add_u32 m0, s29, 57344
  s_mov_b32 s28, 7667712
  buffer_load_dwordx4 v5, s[12:15], s28 offen lds
  s_lshl_b32 s29, s21, 10
  s_add_u32 m0, s29, 61440
  s_mov_b32 s28, 7766016
  buffer_load_dwordx4 v5, s[12:15], s28 offen lds
  v_add_u32 v8, 81920, v7
  ds_read_b64_tr_b16 a[104:105], v8 offset:0
  ds_read_b64_tr_b16 a[106:107], v8 offset:2048
  ds_read_b64_tr_b16 a[108:109], v8 offset:8192
  ds_read_b64_tr_b16 a[110:111], v8 offset:10240
  ds_read_b64_tr_b16 v[200:201], v8 offset:256
  ds_read_b64_tr_b16 v[202:203], v8 offset:2304
  ds_read_b64_tr_b16 v[204:205], v8 offset:8448
  ds_read_b64_tr_b16 v[206:207], v8 offset:10496
  s_waitcnt lgkmcnt(0)
  s_waitcnt vmcnt(20)
  s_barrier
  v_add_u32 v8, 98304, v7
  ds_read_b64_tr_b16 a[112:113], v8 offset:0
  ds_read_b64_tr_b16 a[114:115], v8 offset:2048
  ds_read_b64_tr_b16 a[116:117], v8 offset:8192
  ds_read_b64_tr_b16 a[118:119], v8 offset:10240
  ds_read_b64_tr_b16 v[208:209], v8 offset:256
  ds_read_b64_tr_b16 v[210:211], v8 offset:2304
  ds_read_b64_tr_b16 v[212:213], v8 offset:8448
  ds_read_b64_tr_b16 v[214:215], v8 offset:10496
  s_waitcnt lgkmcnt(0)
  s_waitcnt vmcnt(16)
  s_barrier
  v_add_u32 v8, 114688, v7
  ds_read_b64_tr_b16 a[120:121], v8 offset:0
  ds_read_b64_tr_b16 a[122:123], v8 offset:2048
  ds_read_b64_tr_b16 a[124:125], v8 offset:8192
  ds_read_b64_tr_b16 a[126:127], v8 offset:10240
  ds_read_b64_tr_b16 v[216:217], v8 offset:256
  ds_read_b64_tr_b16 v[218:219], v8 offset:2304
  ds_read_b64_tr_b16 v[220:221], v8 offset:8448
  ds_read_b64_tr_b16 v[222:223], v8 offset:10496
  s_waitcnt lgkmcnt(0)
  s_waitcnt vmcnt(12)
  s_barrier
  v_add_u32 v8, 0, v7
  ds_read_b64_tr_b16 a[128:129], v8 offset:0
  ds_read_b64_tr_b16 a[130:131], v8 offset:2048
  ds_read_b64_tr_b16 a[132:133], v8 offset:8192
  ds_read_b64_tr_b16 a[134:135], v8 offset:10240
  ds_read_b64_tr_b16 v[224:225], v8 offset:256
  ds_read_b64_tr_b16 v[226:227], v8 offset:2304
  ds_read_b64_tr_b16 v[228:229], v8 offset:8448
  ds_read_b64_tr_b16 v[230:231], v8 offset:10496
  s_waitcnt lgkmcnt(0)
  s_waitcnt vmcnt(8)
  s_barrier
  v_add_u32 v8, 16384, v7
  ds_read_b64_tr_b16 a[136:137], v8 offset:0
  ds_read_b64_tr_b16 a[138:139], v8 offset:2048
  ds_read_b64_tr_b16 a[140:141], v8 offset:8192
  ds_read_b64_tr_b16 a[142:143], v8 offset:10240
  ds_read_b64_tr_b16 v[232:233], v8 offset:256
  ds_read_b64_tr_b16 v[234:235], v8 offset:2304
  ds_read_b64_tr_b16 v[236:237], v8 offset:8448
  ds_read_b64_tr_b16 v[238:239], v8 offset:10496
  s_waitcnt lgkmcnt(0)
  s_waitcnt vmcnt(4)
  s_barrier
  v_add_u32 v8, 32768, v7
  ds_read_b64_tr_b16 a[144:145], v8 offset:0
  ds_read_b64_tr_b16 a[146:147], v8 offset:2048
  ds_read_b64_tr_b16 a[148:149], v8 offset:8192
  ds_read_b64_tr_b16 a[150:151], v8 offset:10240
  ds_read_b64_tr_b16 v[240:241], v8 offset:256
  ds_read_b64_tr_b16 v[242:243], v8 offset:2304
  ds_read_b64_tr_b16 v[244:245], v8 offset:8448
  ds_read_b64_tr_b16 v[246:247], v8 offset:10496
  s_waitcnt lgkmcnt(0)
  s_waitcnt vmcnt(0)
  s_barrier
  v_add_u32 v8, 49152, v7
  ds_read_b64_tr_b16 a[152:153], v8 offset:0
  ds_read_b64_tr_b16 a[154:155], v8 offset:2048
  ds_read_b64_tr_b16 a[156:157], v8 offset:8192
  ds_read_b64_tr_b16 a[158:159], v8 offset:10240
  ds_read_b64_tr_b16 v[248:249], v8 offset:256
  ds_read_b64_tr_b16 v[250:251], v8 offset:2304
  ds_read_b64_tr_b16 v[252:253], v8 offset:8448
  ds_read_b64_tr_b16 v[254:255], v8 offset:10496
  s_waitcnt lgkmcnt(0)
  s_barrier
  v_lshlrev_b32 v5, 4, v1
  s_lshl_b32 s28, s21, 10
  v_add_u32 v6, s28, v5
  v_mov_b32 v9, v5
  v_add_u32 v10, 40960, v5
  v_bfe_u32 v2, v1, 4, 1
  v_lshlrev_b32 v11, 10, v2
  v_and_b32 v2, 15, v1
  v_lshlrev_b32 v2, 4, v2
  v_add_u32 v11, v11, v2
  v_lshrrev_b32 v2, 5, v1
  v_lshlrev_b32 v2, 9, v2
  v_add_u32 v11, v11, v2
  v_mov_b32 v12, s47
  s_mov_b32 s50, 0
  s_mov_b32 s51, 0x100000
  s_cmp_eq_u32 s99, 1
  s_cbranch_scc0 xw_45_ok
  s_mov_b32 s45, 0
  v_mov_b32 v2, 4992
xw_45:
  buffer_load_dword v3, v2, s[8:11], 0 offen sc1
  s_add_u32 s45, s45, 1
  s_waitcnt vmcnt(0)
  v_readfirstlane_b32 s28, v3
  s_cmp_ge_u32 s28, 256
  s_cbranch_scc1 xw_45_ok
  s_cmp_lt_u32 s45, 400000
  s_cbranch_scc1 xw_45
  s_branch ka_abort
xw_45_ok:
  s_lshl_b32 s29, s21, 10
  s_add_u32 m0, s29, 0
  s_add_u32 s28, s51, 0
  buffer_load_dwordx4 v6, s[8:11], s28 offen sc1 lds
  s_lshl_b32 s29, s21, 10
  s_add_u32 m0, s29, 4096
  s_add_u32 s28, s51, 4096
  buffer_load_dwordx4 v6, s[8:11], s28 offen sc1 lds
  s_lshl_b32 s29, s21, 10
  s_add_u32 m0, s29, 8192
  s_add_u32 s28, s51, 8192
  buffer_load_dwordx4 v6, s[8:11], s28 offen sc1 lds
  s_lshl_b32 s29, s21, 10
  s_add_u32 m0, s29, 12288
  s_add_u32 s28, s51, 12288
  buffer_load_dwordx4 v6, s[8:11], s28 offen sc1 lds
  s_lshl_b32 s29, s21, 10
  s_add_u32 m0, s29, 16384
  s_add_u32 s28, s51, 16384
  buffer_load_dwordx4 v6, s[8:11], s28 offen sc1 lds
  s_lshl_b32 s29, s21, 10
  s_add_u32 m0, s29, 20480
  s_add_u32 s28, s51, 20480
  buffer_load_dwordx4 v6, s[8:11], s28 offen sc1 lds
  s_lshl_b32 s29, s21, 10
  s_add_u32 m0, s29, 24576
  s_add_u32 s28, s51, 24576
  buffer_load_dwordx4 v6, s[8:11], s28 offen sc1 lds
  s_lshl_b32 s29, s21, 10
  s_add_u32 m0, s29, 28672
  s_add_u32 s28, s51, 28672
  buffer_load_dwordx4 v6, s[8:11], s28 offen sc1 lds
  s_lshl_b32 s29, s21, 10
  s_add_u32 m0, s29, 32768
  s_add_u32 s28, s51, 32768
  buffer_load_dwordx4 v6, s[8:11], s28 offen sc1 lds
  s_lshl_b32 s29, s21, 10
  s_add_u32 m0, s29, 36864
  s_add_u32 s28, s51, 36864
  buffer_load_dwordx4 v6, s[8:11], s28 offen sc1 lds
  s_add_u32 s51, s51, 40960
ka_qkv_loop:
  s_cmp_eq_u32 s50, 0
  s_cbranch_scc0 q0_46
  s_waitcnt vmcnt(0)
q0_46:
  s_waitcnt vmcnt(4)
  s_barrier
  s_cmp_ge_u32 s50, 63
  s_cbranch_scc1 qn_47_n
  s_lshl_b32 s29, s21, 10
  s_add_u32 m0, s29, 40960
  s_add_u32 s28, s51, 0
  buffer_load_dwordx4 v6, s[8:11], s28 offen sc1 lds
  s_lshl_b32 s29, s21, 10
  s_add_u32 m0, s29, 45056
  s_add_u32 s28, s51, 4096
  buffer_load_dwordx4 v6, s[8:11], s28 offen sc1 lds
  s_lshl_b32 s29, s21, 10
  s_add_u32 m0, s29, 49152
  s_add_u32 s28, s51, 8192
  buffer_load_dwordx4 v6, s[8:11], s28 offen sc1 lds
  s_lshl_b32 s29, s21, 10
  s_add_u32 m0, s29, 53248
  s_add_u32 s28, s51, 12288
  buffer_load_dwordx4 v6, s[8:11], s28 offen sc1 lds
  s_lshl_b32 s29, s21, 10
  s_add_u32 m0, s29, 57344
  s_add_u32 s28, s51, 16384
  buffer_load_dwordx4 v6, s[8:11], s28 offen sc1 lds
  s_lshl_b32 s29, s21, 10
  s_add_u32 m0, s29, 61440
  s_add_u32 s28, s51, 20480
  buffer_load_dwordx4 v6, s[8:11], s28 offen sc1 lds
  s_lshl_b32 s29, s21, 10
  s_add_u32 m0, s29, 65536
  s_add_u32 s28, s51, 24576
  buffer_load_dwordx4 v6, s[8:11], s28 offen sc1 lds
  s_lshl_b32 s29, s21, 10
  s_add_u32 m0, s29, 69632
  s_add_u32 s28, s51, 28672
  buffer_load_dwordx4 v6, s[8:11], s28 offen sc1 lds
  s_lshl_b32 s29, s21, 10
  s_add_u32 m0, s29, 73728
  s_add_u32 s28, s51, 32768
  buffer_load_dwordx4 v6, s[8:11], s28 offen sc1 lds
  s_lshl_b32 s29, s21, 10
  s_add_u32 m0, s29, 77824
  s_add_u32 s28, s51, 36864
  buffer_load_dwordx4 v6, s[8:11], s28 offen sc1 lds
  s_add_u32 s51, s51, 40960
  s_branch qn_47
qn_47_n:
  s_waitcnt vmcnt(0)
qn_47:
  ds_read_b128 v[128:131], v9 offset:0
  ds_read_b128 v[132:135], v9 offset:1024
  ds_read_b128 v[136:139], v9 offset:2048
  ds_read_b128 v[140:143], v9 offset:3072
  s_waitcnt lgkmcnt(3)
  v_mfma_f32_32x32x16_bf16 v[64:79], a[0:3], v[128:131], 0
  v_mfma_f32_32x32x16_bf16 v[80:95], a[160:163], v[128:131], 0
  ds_read_b128 v[128:131], v9 offset:4096
  s_waitcnt lgkmcnt(3)
  v_mfma_f32_32x32x16_bf16 v[64:79], a[4:7], v[132:135], v[64:79]
  v_mfma_f32_32x32x16_bf16 v[80:95], a[164:167], v[132:135], v[80:95]
  ds_read_b128 v[132:135], v9 offset:5120
  s_waitcnt lgkmcnt(3)
  v_mfma_f32_32x32x16_bf16 v[64:79], a[8:11], v[136:139], v[64:79]
  v_mfma_f32_32x32x16_bf16 v[80:95], a[168:171], v[136:139], v[80:95]
  ds_read_b128 v[136:139], v9 offset:6144
  s_waitcnt lgkmcnt(3)
  v_mfma_f32_32x32x16_bf16 v[64:79], a[12:15], v[140:143], v[64:79]
  v_mfma_f32_32x32x16_bf16 v[80:95], a[172:175], v[140:143], v[80:95]
  ds_read_b128 v[140:143], v9 offset:7168
  s_waitcnt lgkmcnt(3)
  v_mfma_f32_32x32x16_bf16 v[64:79], a[16:19], v[128:131], v[64:79]
  v_mfma_f32_32x32x16_bf16 v[80:95], a[176:179], v[128:131], v[80:95]
  ds_read_b128 v[128:131], v9 offset:8192
  s_waitcnt lgkmcnt(3)
  v_mfma_f32_32x32x16_bf16 v[64:79], a[20:23], v[132:135], v[64:79]
  v_mfma_f32_32x32x16_bf16 v[80:95], a[180:183], v[132:135], v[80:95]
  ds_read_b128 v[132:135], v9 offset:9216
  s_waitcnt lgkmcnt(3)
  v_mfma_f32_32x32x16_bf16 v[64:79], a[24:27], v[136:139], v[64:79]
  v_mfma_f32_32x32x16_bf16 v[80:95], a[184:187], v[136:139], v[80:95]
  ds_read_b128 v[136:139], v9 offset:10240
  s_waitcnt lgkmcnt(3)
  v_mfma_f32_32x32x16_bf16 v[64:79], a[28:31], v[140:143], v[64:79]
  v_mfma_f32_32x32x16_bf16 v[80:95], a[188:191], v[140:143], v[80:95]
  ds_read_b128 v[140:143], v9 offset:11264
  s_waitcnt lgkmcnt(3)
  v_mfma_f32_32x32x16_bf16 v[64:79], a[32:35], v[128:131], v[64:79]
  v_mfma_f32_32x32x16_bf16 v[80:95], a[192:195], v[128:131], v[80:95]
  ds_read_b128 v[128:131], v9 offset:12288
  s_waitcnt lgkmcnt(3)
  v_mfma_f32_32x32x16_bf16 v[64:79], a[36:39], v[132:135], v[64:79]
  v_mfma_f32_32x32x16_bf16 v[80:95], a[196:199], v[132:135], v[80:95]
  ds_read_b128 v[132:135], v9 offset:13312
  s_waitcnt lgkmcnt(3)
  v_mfma_f32_32x32x16_bf16 v[64:79], a[40:43], v[136:139], v[64:79]
  v_mfma_f32_32x32x16_bf16 v[80:95], a[200:203], v[136:139], v[80:95]
  ds_read_b128 v[136:139], v9 offset:14336
  s_waitcnt lgkmcnt(3)
  v_mfma_f32_32x32x16_bf16 v[64:79], a[44:47], v[140:143], v[64:79]
  v_mfma_f32_32x32x16_bf16 v[80:95], a[204:207], v[140:143], v[80:95]
  ds_read_b128 v[140:143], v9 offset:15360
  s_waitcnt lgkmcnt(3)
  v_mfma_f32_32x32x16_bf16 v[64:79], a[48:51], v[128:131], v[64:79]
  v_mfma_f32_32x32x16_bf16 v[80:95], a[208:211], v[128:131], v[80:95]
  ds_read_b128 v[128:131], v9 offset:16384
  s_waitcnt lgkmcnt(3)
  v_mfma_f32_32x32x16_bf16 v[64:79], a[52:55], v[132:135], v[64:79]
  v_mfma_f32_32x32x16_bf16 v[80:95], a[212:215], v[132:135], v[80:95]
  ds_read_b128 v[132:135], v9 offset:17408
  s_waitcnt lgkmcnt(3)
  v_mfma_f32_32x32x16_bf16 v[64:79], a[56:59], v[136:139], v[64:79]
  v_mfma_f32_32x32x16_bf16 v[80:95], a[216:219], v[136:139], v[80:95]
  ds_read_b128 v[136:139], v9 offset:18432
  s_waitcnt lgkmcnt(3)
  v_mfma_f32_32x32x16_bf16 v[64:79], a[60:63], v[140:143], v[64:79]
  v_mfma_f32_32x32x16_bf16 v[80:95], a[220:223], v[140:143], v[80:95]
  ds_read_b128 v[140:143], v9 offset:19456
  s_waitcnt lgkmcnt(3)
  v_mfma_f32_32x32x16_bf16 v[64:79], a[64:67], v[128:131], v[64:79]
  v_mfma_f32_32x32x16_bf16 v[80:95], a[224:227], v[128:131], v[80:95]
  ds_read_b128 v[128:131], v9 offset:20480
  s_waitcnt lgkmcnt(3)
  v_mfma_f32_32x32x16_bf16 v[64:79], a[68:71], v[132:135], v[64:79]
  v_mfma_f32_32x32x16_bf16 v[80:95], a[228:231], v[132:135], v[80:95]
  ds_read_b128 v[132:135], v9 offset:21504
  s_waitcnt lgkmcnt(3)
  v_mfma_f32_32x32x16_bf16 v[64:79], a[72:75], v[136:139], v[64:79]
  v_mfma_f32_32x32x16_bf16 v[80:95], a[232:235], v[136:139], v[80:95]
  ds_read_b128 v[136:139], v9 offset:22528
  s_waitcnt lgkmcnt(3)
  v_mfma_f32_32x32x16_bf16 v[64:79], a[76:79], v[140:143], v[64:79]
  v_mfma_f32_32x32x16_bf16 v[80:95], a[236:239], v[140:143], v[80:95]
  ds_read_b128 v[140:143], v9 offset:23552
  s_waitcnt lgkmcnt(3)
  v_mfma_f32_32x32x16_bf16 v[64:79], a[80:83], v[128:131], v[64:79]
  v_mfma_f32_32x32x16_bf16 v[80:95], a[240:243], v[128:131], v[80:95]
  ds_read_b128 v[128:131], v9 offset:24576
  s_waitcnt lgkmcnt(3)
  v_mfma_f32_32x32x16_bf16 v[64:79], a[84:87], v[132:135], v[64:79]
  v_mfma_f32_32x32x16_bf16 v[80:95], a[244:247], v[132:135], v[80:95]
  ds_read_b128 v[132:135], v9 offset:25600
  s_waitcnt lgkmcnt(3)
  v_mfma_f32_32x32x16_bf16 v[64:79], a[88:91], v[136:139], v[64:79]
  v_mfma_f32_32x32x16_bf16 v[80:95], a[248:251], v[136:139], v[80:95]
  ds_read_b128 v[136:139], v9 offset:26624
  s_waitcnt lgkmcnt(3)
  v_mfma_f32_32x32x16_bf16 v[64:79], a[92:95], v[140:143], v[64:79]
  v_mfma_f32_32x32x16_bf16 v[80:95], a[252:255], v[140:143], v[80:95]
  ds_read_b128 v[140:143], v9 offset:27648
  s_waitcnt vmcnt(10)
  s_barrier
  s_cmp_eq_u32 s21, 0
  s_cbranch_scc0 mp_48
  v_mov_b32 v13, s50
  s_mov_b64 s[24:25], exec
  s_mov_b64 exec, 1
  buffer_store_dword v13, v12, s[8:11], 0 offen sc1
  s_mov_b64 exec, s[24:25]
mp_48:
  s_waitcnt lgkmcnt(3)
  v_mfma_f32_32x32x16_bf16 v[64:79], a[96:99], v[128:131], v[64:79]
  v_mfma_f32_32x32x16_bf16 v[80:95], v[192:195], v[128:131], v[80:95]
  ds_read_b128 v[128:131], v9 offset:28672
  s_waitcnt lgkmcnt(3)
  v_mfma_f32_32x32x16_bf16 v[64:79], a[100:103], v[132:135], v[64:79]
  v_mfma_f32_32x32x16_bf16 v[80:95], v[196:199], v[132:135], v[80:95]
  ds_read_b128 v[132:135], v9 offset:29696
  s_waitcnt lgkmcnt(3)
  v_mfma_f32_32x32x16_bf16 v[64:79], a[104:107], v[136:139], v[64:79]
  v_mfma_f32_32x32x16_bf16 v[80:95], v[200:203], v[136:139], v[80:95]
  ds_read_b128 v[136:139], v9 offset:30720
  s_waitcnt lgkmcnt(3)
  v_mfma_f32_32x32x16_bf16 v[64:79], a[108:111], v[140:143], v[64:79]
  v_mfma_f32_32x32x16_bf16 v[80:95], v[204:207], v[140:143], v[80:95]
  ds_read_b128 v[140:143], v9 offset:31744
  s_waitcnt lgkmcnt(3)
  v_mfma_f32_32x32x16_bf16 v[64:79], a[112:115], v[128:131], v[64:79]
  v_mfma_f32_32x32x16_bf16 v[80:95], v[208:211], v[128:131], v[80:95]
  ds_read_b128 v[128:131], v9 offset:32768
  s_waitcnt lgkmcnt(3)
  v_mfma_f32_32x32x16_bf16 v[64:79], a[116:119], v[132:135], v[64:79]
  v_mfma_f32_32x32x16_bf16 v[80:95], v[212:215], v[132:135], v[80:95]
  ds_read_b128 v[132:135], v9 offset:33792
  s_waitcnt lgkmcnt(3)
  v_mfma_f32_32x32x16_bf16 v[64:79], a[120:123], v[136:139], v[64:79]
  v_mfma_f32_32x32x16_bf16 v[80:95], v[216:219], v[136:139], v[80:95]
  ds_read_b128 v[136:139], v9 offset:34816
  s_waitcnt lgkmcnt(3)
  v_mfma_f32_32x32x16_bf16 v[64:79], a[124:127], v[140:143], v[64:79]
  v_mfma_f32_32x32x16_bf16 v[80:95], v[220:223], v[140:143], v[80:95]
  ds_read_b128 v[140:143], v9 offset:35840
  s_waitcnt lgkmcnt(3)
  v_mfma_f32_32x32x16_bf16 v[64:79], a[128:131], v[128:131], v[64:79]
  v_mfma_f32_32x32x16_bf16 v[80:95], v[224:227], v[128:131], v[80:95]
  ds_read_b128 v[128:131], v9 offset:36864
  s_waitcnt lgkmcnt(3)
  v_mfma_f32_32x32x16_bf16 v[64:79], a[132:135], v[132:135], v[64:79]
  v_mfma_f32_32x32x16_bf16 v[80:95], v[228:231], v[132:135], v[80:95]
  ds_read_b128 v[132:135], v9 offset:37888
  s_waitcnt lgkmcnt(3)
  v_mfma_f32_32x32x16_bf16 v[64:79], a[136:139], v[136:139], v[64:79]
  v_mfma_f32_32x32x16_bf16 v[80:95], v[232:235], v[136:139], v[80:95]
  ds_read_b128 v[136:139], v9 offset:38912
  s_waitcnt lgkmcnt(3)
  v_mfma_f32_32x32x16_bf16 v[64:79], a[140:143], v[140:143], v[64:79]
  v_mfma_f32_32x32x16_bf16 v[80:95], v[236:239], v[140:143], v[80:95]
  ds_read_b128 v[140:143], v9 offset:39936
  s_waitcnt lgkmcnt(3)
  v_mfma_f32_32x32x16_bf16 v[64:79], a[144:147], v[128:131], v[64:79]
  v_mfma_f32_32x32x16_bf16 v[80:95], v[240:243], v[128:131], v[80:95]
  s_waitcnt lgkmcnt(2)
  v_mfma_f32_32x32x16_bf16 v[64:79], a[148:151], v[132:135], v[64:79]
  v_mfma_f32_32x32x16_bf16 v[80:95], v[244:247], v[132:135], v[80:95]
  s_waitcnt lgkmcnt(1)
  v_mfma_f32_32x32x16_bf16 v[64:79], a[152:155], v[136:139], v[64:79]
  v_mfma_f32_32x32x16_bf16 v[80:95], v[248:251], v[136:139], v[80:95]
  s_waitcnt lgkmcnt(0)
  v_mfma_f32_32x32x16_bf16 v[64:79], a[156:159], v[140:143], v[64:79]
  v_mfma_f32_32x32x16_bf16 v[80:95], v[252:255], v[140:143], v[80:95]
  s_nop 11
  v_cvt_pk_bf16_f32 v144, v64, v65
  v_cvt_pk_bf16_f32 v145, v66, v67
  v_cvt_pk_bf16_f32 v146, v68, v69
  v_cvt_pk_bf16_f32 v147, v70, v71
  v_cvt_pk_bf16_f32 v148, v72, v73
  v_cvt_pk_bf16_f32 v149, v74, v75
  v_cvt_pk_bf16_f32 v150, v76, v77
  v_cvt_pk_bf16_f32 v151, v78, v79
  v_cvt_pk_bf16_f32 v152, v80, v81
  v_cvt_pk_bf16_f32 v153, v82, v83
  v_cvt_pk_bf16_f32 v154, v84, v85
  v_cvt_pk_bf16_f32 v155, v86, v87
  v_cvt_pk_bf16_f32 v156, v88, v89
  v_cvt_pk_bf16_f32 v157, v90, v91
  v_cvt_pk_bf16_f32 v158, v92, v93
  v_cvt_pk_bf16_f32 v159, v94, v95
  s_mul_i32 s28, s50, 12288
  s_add_u32 s29, s28, s48
  buffer_store_dwordx4 v[144:147], v11, s[8:11], s29 offen offset:0 sc1
  buffer_store_dwordx4 v[148:151], v11, s[8:11], s29 offen offset:256 sc1
  s_add_u32 s29, s28, s49
  buffer_store_dwordx4 v[152:155], v11, s[8:11], s29 offen offset:0 sc1
  buffer_store_dwordx4 v[156:159], v11, s[8:11], s29 offen offset:256 sc1
  s_add_u32 s50, s50, 1
  s_waitcnt vmcnt(4)
  s_barrier
  s_cmp_ge_u32 s50, 63
  s_cbranch_scc1 qn_49_n
  s_lshl_b32 s29, s21, 10
  s_add_u32 m0, s29, 0
  s_add_u32 s28, s51, 0
  buffer_load_dwordx4 v6, s[8:11], s28 offen sc1 lds
  s_lshl_b32 s29, s21, 10
  s_add_u32 m0, s29, 4096
  s_add_u32 s28, s51, 4096
  buffer_load_dwordx4 v6, s[8:11], s28 offen sc1 lds
  s_lshl_b32 s29, s21, 10
  s_add_u32 m0, s29, 8192
  s_add_u32 s28, s51, 8192
  buffer_load_dwordx4 v6, s[8:11], s28 offen sc1 lds
  s_lshl_b32 s29, s21, 10
  s_add_u32 m0, s29, 12288
  s_add_u32 s28, s51, 12288
  buffer_load_dwordx4 v6, s[8:11], s28 offen sc1 lds
  s_lshl_b32 s29, s21, 10
  s_add_u32 m0, s29, 16384
  s_add_u32 s28, s51, 16384
  buffer_load_dwordx4 v6, s[8:11], s28 offen sc1 lds
  s_lshl_b32 s29, s21, 10
  s_add_u32 m0, s29, 20480
  s_add_u32 s28, s51, 20480
  buffer_load_dwordx4 v6, s[8:11], s28 offen sc1 lds
  s_lshl_b32 s29, s21, 10
  s_add_u32 m0, s29, 24576
  s_add_u32 s28, s51, 24576
  buffer_load_dwordx4 v6, s[8:11], s28 offen sc1 lds
  s_lshl_b32 s29, s21, 10
  s_add_u32 m0, s29, 28672
  s_add_u32 s28, s51, 28672
  buffer_load_dwordx4 v6, s[8:11], s28 offen sc1 lds
  s_lshl_b32 s29, s21, 10
  s_add_u32 m0, s29, 32768
  s_add_u32 s28, s51, 32768
  buffer_load_dwordx4 v6, s[8:11], s28 offen sc1 lds
  s_lshl_b32 s29, s21, 10
  s_add_u32 m0, s29, 36864
  s_add_u32 s28, s51, 36864
  buffer_load_dwordx4 v6, s[8:11], s28 offen sc1 lds
  s_add_u32 s51, s51, 40960
  s_branch qn_49
qn_49_n:
  s_waitcnt vmcnt(0)
qn_49:
  ds_read_b128 v[128:131], v10 offset:0
  ds_read_b128 v[132:135], v10 offset:1024
  ds_read_b128 v[136:139], v10 offset:2048
  ds_read_b128 v[140:143], v10 offset:3072
  s_waitcnt lgkmcnt(3)
  v_mfma_f32_32x32x16_bf16 v[64:79], a[0:3], v[128:131], 0
  v_mfma_f32_32x32x16_bf16 v[80:95], a[160:163], v[128:131], 0
  ds_read_b128 v[128:131], v10 offset:4096
  s_waitcnt lgkmcnt(3)
  v_mfma_f32_32x32x16_bf16 v[64:79], a[4:7], v[132:135], v[64:79]
  v_mfma_f32_32x32x16_bf16 v[80:95], a[164:167], v[132:135], v[80:95]
  ds_read_b128 v[132:135], v10 offset:5120
  s_waitcnt lgkmcnt(3)
  v_mfma_f32_32x32x16_bf16 v[64:79], a[8:11], v[136:139], v[64:79]
  v_mfma_f32_32x32x16_bf16 v[80:95], a[168:171], v[136:139], v[80:95]
  ds_read_b128 v[136:139], v10 offset:6144
  s_waitcnt lgkmcnt(3)
  v_mfma_f32_32x32x16_bf16 v[64:79], a[12:15], v[140:143], v[64:79]
  v_mfma_f32_32x32x16_bf16 v[80:95], a[172:175], v[140:143], v[80:95]
  ds_read_b128 v[140:143], v10 offset:7168
  s_waitcnt lgkmcnt(3)
  v_mfma_f32_32x32x16_bf16 v[64:79], a[16:19], v[128:131], v[64:79]
  v_mfma_f32_32x32x16_bf16 v[80:95], a[176:179], v[128:131], v[80:95]
  ds_read_b128 v[128:131], v10 offset:8192
  s_waitcnt lgkmcnt(3)
  v_mfma_f32_32x32x16_bf16 v[64:79], a[20:23], v[132:135], v[64:79]
  v_mfma_f32_32x32x16_bf16 v[80:95], a[180:183], v[132:135], v[80:95]
  ds_read_b128 v[132:135], v10 offset:9216
  s_waitcnt lgkmcnt(3)
  v_mfma_f32_32x32x16_bf16 v[64:79], a[24:27], v[136:139], v[64:79]
  v_mfma_f32_32x32x16_bf16 v[80:95], a[184:187], v[136:139], v[80:95]
  ds_read_b128 v[136:139], v10 offset:10240
  s_waitcnt lgkmcnt(3)
  v_mfma_f32_32x32x16_bf16 v[64:79], a[28:31], v[140:143], v[64:79]
  v_mfma_f32_32x32x16_bf16 v[80:95], a[188:191], v[140:143], v[80:95]
  ds_read_b128 v[140:143], v10 offset:11264
  s_waitcnt lgkmcnt(3)
  v_mfma_f32_32x32x16_bf16 v[64:79], a[32:35], v[128:131], v[64:79]
  v_mfma_f32_32x32x16_bf16 v[80:95], a[192:195], v[128:131], v[80:95]
  ds_read_b128 v[128:131], v10 offset:12288
  s_waitcnt lgkmcnt(3)
  v_mfma_f32_32x32x16_bf16 v[64:79], a[36:39], v[132:135], v[64:79]
  v_mfma_f32_32x32x16_bf16 v[80:95], a[196:199], v[132:135], v[80:95]
  ds_read_b128 v[132:135], v10 offset:13312
  s_waitcnt lgkmcnt(3)
  v_mfma_f32_32x32x16_bf16 v[64:79], a[40:43], v[136:139], v[64:79]
  v_mfma_f32_32x32x16_bf16 v[80:95], a[200:203], v[136:139], v[80:95]
  ds_read_b128 v[136:139], v10 offset:14336
  s_waitcnt lgkmcnt(3)
  v_mfma_f32_32x32x16_bf16 v[64:79], a[44:47], v[140:143], v[64:79]
  v_mfma_f32_32x32x16_bf16 v[80:95], a[204:207], v[140:143], v[80:95]
  ds_read_b128 v[140:143], v10 offset:15360
  s_waitcnt lgkmcnt(3)
  v_mfma_f32_32x32x16_bf16 v[64:79], a[48:51], v[128:131], v[64:79]
  v_mfma_f32_32x32x16_bf16 v[80:95], a[208:211], v[128:131], v[80:95]
  ds_read_b128 v[128:131], v10 offset:16384
  s_waitcnt lgkmcnt(3)
  v_mfma_f32_32x32x16_bf16 v[64:79], a[52:55], v[132:135], v[64:79]
  v_mfma_f32_32x32x16_bf16 v[80:95], a[212:215], v[132:135], v[80:95]
  ds_read_b128 v[132:135], v10 offset:17408
  s_waitcnt lgkmcnt(3)
  v_mfma_f32_32x32x16_bf16 v[64:79], a[56:59], v[136:139], v[64:79]
  v_mfma_f32_32x32x16_bf16 v[80:95], a[216:219], v[136:139], v[80:95]
  ds_read_b128 v[136:139], v10 offset:18432
  s_waitcnt lgkmcnt(3)
  v_mfma_f32_32x32x16_bf16 v[64:79], a[60:63], v[140:143], v[64:79]
  v_mfma_f32_32x32x16_bf16 v[80:95], a[220:223], v[140:143], v[80:95]
  ds_read_b128 v[140:143], v10 offset:19456
  s_waitcnt lgkmcnt(3)
  v_mfma_f32_32x32x16_bf16 v[64:79], a[64:67], v[128:131], v[64:79]
  v_mfma_f32_32x32x16_bf16 v[80:95], a[224:227], v[128:131], v[80:95]
  ds_read_b128 v[128:131], v10 offset:20480
  s_waitcnt lgkmcnt(3)
  v_mfma_f32_32x32x16_bf16 v[64:79], a[68:71], v[132:135], v[64:79]
  v_mfma_f32_32x32x16_bf16 v[80:95], a[228:231], v[132:135], v[80:95]
  ds_read_b128 v[132:135], v10 offset:21504
  s_waitcnt lgkmcnt(3)
  v_mfma_f32_32x32x16_bf16 v[64:79], a[72:75], v[136:139], v[64:79]
  v_mfma_f32_32x32x16_bf16 v[80:95], a[232:235], v[136:139], v[80:95]
  ds_read_b128 v[136:139], v10 offset:22528
  s_waitcnt lgkmcnt(3)
  v_mfma_f32_32x32x16_bf16 v[64:79], a[76:79], v[140:143], v[64:79]
  v_mfma_f32_32x32x16_bf16 v[80:95], a[236:239], v[140:143], v[80:95]
  ds_read_b128 v[140:143], v10 offset:23552
  s_waitcnt lgkmcnt(3)
  v_mfma_f32_32x32x16_bf16 v[64:79], a[80:83], v[128:131], v[64:79]
  v_mfma_f32_32x32x16_bf16 v[80:95], a[240:243], v[128:131], v[80:95]
  ds_read_b128 v[128:131], v10 offset:24576
  s_waitcnt lgkmcnt(3)
  v_mfma_f32_32x32x16_bf16 v[64:79], a[84:87], v[132:135], v[64:79]
  v_mfma_f32_32x32x16_bf16 v[80:95], a[244:247], v[132:135], v[80:95]
  ds_read_b128 v[132:135], v10 offset:25600
  s_waitcnt lgkmcnt(3)
  v_mfma_f32_32x32x16_bf16 v[64:79], a[88:91], v[136:139], v[64:79]
  v_mfma_f32_32x32x16_bf16 v[80:95], a[248:251], v[136:139], v[80:95]
  ds_read_b128 v[136:139], v10 offset:26624
  s_waitcnt lgkmcnt(3)
  v_mfma_f32_32x32x16_bf16 v[64:79], a[92:95], v[140:143], v[64:79]
  v_mfma_f32_32x32x16_bf16 v[80:95], a[252:255], v[140:143], v[80:95]
  ds_read_b128 v[140:143], v10 offset:27648
  s_waitcnt vmcnt(10)
  s_barrier
  s_cmp_eq_u32 s21, 0
  s_cbranch_scc0 mp_50
  v_mov_b32 v13, s50
  s_mov_b64 s[24:25], exec
  s_mov_b64 exec, 1
  buffer_store_dword v13, v12, s[8:11], 0 offen sc1
  s_mov_b64 exec, s[24:25]
mp_50:
  s_waitcnt lgkmcnt(3)
  v_mfma_f32_32x32x16_bf16 v[64:79], a[96:99], v[128:131], v[64:79]
  v_mfma_f32_32x32x16_bf16 v[80:95], v[192:195], v[128:131], v[80:95]
  ds_read_b128 v[128:131], v10 offset:28672
  s_waitcnt lgkmcnt(3)
  v_mfma_f32_32x32x16_bf16 v[64:79], a[100:103], v[132:135], v[64:79]
  v_mfma_f32_32x32x16_bf16 v[80:95], v[196:199], v[132:135], v[80:95]
  ds_read_b128 v[132:135], v10 offset:29696
  s_waitcnt lgkmcnt(3)
  v_mfma_f32_32x32x16_bf16 v[64:79], a[104:107], v[136:139], v[64:79]
  v_mfma_f32_32x32x16_bf16 v[80:95], v[200:203], v[136:139], v[80:95]
  ds_read_b128 v[136:139], v10 offset:30720
  s_waitcnt lgkmcnt(3)
  v_mfma_f32_32x32x16_bf16 v[64:79], a[108:111], v[140:143], v[64:79]
  v_mfma_f32_32x32x16_bf16 v[80:95], v[204:207], v[140:143], v[80:95]
  ds_read_b128 v[140:143], v10 offset:31744
  s_waitcnt lgkmcnt(3)
  v_mfma_f32_32x32x16_bf16 v[64:79], a[112:115], v[128:131], v[64:79]
  v_mfma_f32_32x32x16_bf16 v[80:95], v[208:211], v[128:131], v[80:95]
  ds_read_b128 v[128:131], v10 offset:32768
  s_waitcnt lgkmcnt(3)
  v_mfma_f32_32x32x16_bf16 v[64:79], a[116:119], v[132:135], v[64:79]
  v_mfma_f32_32x32x16_bf16 v[80:95], v[212:215], v[132:135], v[80:95]
  ds_read_b128 v[132:135], v10 offset:33792
  s_waitcnt lgkmcnt(3)
  v_mfma_f32_32x32x16_bf16 v[64:79], a[120:123], v[136:139], v[64:79]
  v_mfma_f32_32x32x16_bf16 v[80:95], v[216:219], v[136:139], v[80:95]
  ds_read_b128 v[136:139], v10 offset:34816
  s_waitcnt lgkmcnt(3)
  v_mfma_f32_32x32x16_bf16 v[64:79], a[124:127], v[140:143], v[64:79]
  v_mfma_f32_32x32x16_bf16 v[80:95], v[220:223], v[140:143], v[80:95]
  ds_read_b128 v[140:143], v10 offset:35840
  s_waitcnt lgkmcnt(3)
  v_mfma_f32_32x32x16_bf16 v[64:79], a[128:131], v[128:131], v[64:79]
  v_mfma_f32_32x32x16_bf16 v[80:95], v[224:227], v[128:131], v[80:95]
  ds_read_b128 v[128:131], v10 offset:36864
  s_waitcnt lgkmcnt(3)
  v_mfma_f32_32x32x16_bf16 v[64:79], a[132:135], v[132:135], v[64:79]
  v_mfma_f32_32x32x16_bf16 v[80:95], v[228:231], v[132:135], v[80:95]
  ds_read_b128 v[132:135], v10 offset:37888
  s_waitcnt lgkmcnt(3)
  v_mfma_f32_32x32x16_bf16 v[64:79], a[136:139], v[136:139], v[64:79]
  v_mfma_f32_32x32x16_bf16 v[80:95], v[232:235], v[136:139], v[80:95]
  ds_read_b128 v[136:139], v10 offset:38912
  s_waitcnt lgkmcnt(3)
  v_mfma_f32_32x32x16_bf16 v[64:79], a[140:143], v[140:143], v[64:79]
  v_mfma_f32_32x32x16_bf16 v[80:95], v[236:239], v[140:143], v[80:95]
  ds_read_b128 v[140:143], v10 offset:39936
  s_waitcnt lgkmcnt(3)
  v_mfma_f32_32x32x16_bf16 v[64:79], a[144:147], v[128:131], v[64:79]
  v_mfma_f32_32x32x16_bf16 v[80:95], v[240:243], v[128:131], v[80:95]
  s_waitcnt lgkmcnt(2)
  v_mfma_f32_32x32x16_bf16 v[64:79], a[148:151], v[132:135], v[64:79]
  v_mfma_f32_32x32x16_bf16 v[80:95], v[244:247], v[132:135], v[80:95]
  s_waitcnt lgkmcnt(1)
  v_mfma_f32_32x32x16_bf16 v[64:79], a[152:155], v[136:139], v[64:79]
  v_mfma_f32_32x32x16_bf16 v[80:95], v[248:251], v[136:139], v[80:95]
  s_waitcnt lgkmcnt(0)
  v_mfma_f32_32x32x16_bf16 v[64:79], a[156:159], v[140:143], v[64:79]
  v_mfma_f32_32x32x16_bf16 v[80:95], v[252:255], v[140:143], v[80:95]
  s_nop 11
  v_cvt_pk_bf16_f32 v144, v64, v65
  v_cvt_pk_bf16_f32 v145, v66, v67
  v_cvt_pk_bf16_f32 v146, v68, v69
  v_cvt_pk_bf16_f32 v147, v70, v71
  v_cvt_pk_bf16_f32 v148, v72, v73
  v_cvt_pk_bf16_f32 v149, v74, v75
  v_cvt_pk_bf16_f32 v150, v76, v77
  v_cvt_pk_bf16_f32 v151, v78, v79
  v_cvt_pk_bf16_f32 v152, v80, v81
  v_cvt_pk_bf16_f32 v153, v82, v83
  v_cvt_pk_bf16_f32 v154, v84, v85
  v_cvt_pk_bf16_f32 v155, v86, v87
  v_cvt_pk_bf16_f32 v156, v88, v89
  v_cvt_pk_bf16_f32 v157, v90, v91
  v_cvt_pk_bf16_f32 v158, v92, v93
  v_cvt_pk_bf16_f32 v159, v94, v95
  s_mul_i32 s28, s50, 12288
  s_add_u32 s29, s28, s48
  buffer_store_dwordx4 v[144:147], v11, s[8:11], s29 offen offset:0 sc1
  buffer_store_dwordx4 v[148:151], v11, s[8:11], s29 offen offset:256 sc1
  s_add_u32 s29, s28, s49
  buffer_store_dwordx4 v[152:155], v11, s[8:11], s29 offen offset:0 sc1
  buffer_store_dwordx4 v[156:159], v11, s[8:11], s29 offen offset:256 sc1
  s_add_u32 s50, s50, 1
  s_cmp_lt_u32 s50, 64
  s_cbranch_scc1 ka_qkv_loop
  s_waitcnt vmcnt(0)
  s_barrier
  s_cmp_eq_u32 s21, 0
  s_cbranch_scc0 ka_exit
  v_mov_b32 v13, 64
  s_mov_b64 exec, 1
  buffer_store_dword v13, v12, s[8:11], 0 offen sc1
  s_waitcnt vmcnt(0)
  s_branch ka_exit
ka_u:
  s_mov_b32 s12, s42
  s_and_b32 s13, s43, 0xffff
  s_mov_b32 s14, 0x780000
  s_mov_b32 s15, 0x20000
  v_and_b32 v1, 63, v0
  v_lshrrev_b32 v2, 4, v1
  v_bfe_u32 v3, v1, 2, 2
  v_and_b32 v4, 3, v1
  s_lshl_b32 s28, s21, 3
  v_add_u32 v5, s28, v3
  v_mul_u32_u24 v5, 1280, v5
  v_lshlrev_b32 v6, 6, v2
  v_add_u32 v5, v5, v6
  v_lshlrev_b32 v6, 4, v4
  v_add_u32 v5, v5, v6
  v_lshrrev_b32 v6, 1, v2
  v_mul_u32_u24 v7, 20480, v6
  v_lshlrev_b32 v6, 6, v3
  v_add_u32 v7, v7, v6
  v_and_b32 v6, 1, v2
  v_lshlrev_b32 v6, 5, v6
  v_add_u32 v7, v7, v6
  v_lshrrev_b32 v6, 1, v4
  v_lshlrev_b32 v6, 4, v6
  v_add_u32 v7, v7, v6
  v_and_b32 v6, 1, v4
  v_lshlrev_b32 v6, 3, v6
  v_add_u32 v7, v7, v6
  s_mul_i32 s28, s21, 1280
  v_add_u32 v7, s28, v7
  s_mul_i32 s46, s23, 245760
  s_mul_i32 s29, s21, 10240
  s_add_u32 m0, s29, 0
  s_add_u32 s28, s46, 0
  buffer_load_dwordx4 v5, s[12:15], s28 offen lds
  s_mul_i32 s29, s21, 10240
  s_add_u32 m0, s29, 1024
  s_add_u32 s28, s46, 256
  buffer_load_dwordx4 v5, s[12:15], s28 offen lds
  s_mul_i32 s29, s21, 10240
  s_add_u32 m0, s29, 2048
  s_add_u32 s28, s46, 512
  buffer_load_dwordx4 v5, s[12:15], s28 offen lds
  s_mul_i32 s29, s21, 10240
  s_add_u32 m0, s29, 3072
  s_add_u32 s28, s46, 768
  buffer_load_dwordx4 v5, s[12:15], s28 offen lds
  s_mul_i32 s29, s21, 10240
  s_add_u32 m0, s29, 4096
  s_add_u32 s28, s46, 1024
  buffer_load_dwordx4 v5, s[12:15], s28 offen lds
  s_mul_i32 s29, s21, 10240
  s_add_u32 m0, s29, 5120
  s_add_u32 s28, s46, 5120
  buffer_load_dwordx4 v5, s[12:15], s28 offen lds
  s_mul_i32 s29, s21, 10240
  s_add_u32 m0, s29, 6144
  s_add_u32 s28, s46, 5376
  buffer_load_dwordx4 v5, s[12:15], s28 offen lds
  s_mul_i32 s29, s21, 10240
  s_add_u32 m0, s29, 7168
  s_add_u32 s28, s46, 5632
  buffer_load_dwordx4 v5, s[12:15], s28 offen lds
  s_mul_i32 s29, s21, 10240
  s_add_u32 m0, s29, 8192
  s_add_u32 s28, s46, 5888
  buffer_load_dwordx4 v5, s[12:15], s28 offen lds
  s_mul_i32 s29, s21, 10240
  s_add_u32 m0, s29, 9216
  s_add_u32 s28, s46, 6144
  buffer_load_dwordx4 v5, s[12:15], s28 offen lds
  s_mul_i32 s29, s21, 10240
  s_add_u32 m0, s29, 40960
  s_add_u32 s28, s46, 40960
  buffer_load_dwordx4 v5, s[12:15], s28 offen lds
  s_mul_i32 s29, s21, 10240
  s_add_u32 m0, s29, 41984
  s_add_u32 s28, s46, 41216
  buffer_load_dwordx4 v5, s[12:15], s28 offen lds
  s_mul_i32 s29, s21, 10240
  s_add_u32 m0, s29, 43008
  s_add_u32 s28, s46, 41472
  buffer_load_dwordx4 v5, s[12:15], s28 offen lds
  s_mul_i32 s29, s21, 10240
  s_add_u32 m0, s29, 44032
  s_add_u32 s28, s46, 41728
  buffer_load_dwordx4 v5, s[12:15], s28 offen lds
  s_mul_i32 s29, s21, 10240
  s_add_u32 m0, s29, 45056
  s_add_u32 s28, s46, 41984
  buffer_load_dwordx4 v5, s[12:15], s28 offen lds
  s_mul_i32 s29, s21, 10240
  s_add_u32 m0, s29, 46080
  s_add_u32 s28, s46, 46080
  buffer_load_dwordx4 v5, s[12:15], s28 offen lds
  s_mul_i32 s29, s21, 10240
  s_add_u32 m0, s29, 47104
  s_add_u32 s28, s46, 46336
  buffer_load_dwordx4 v5, s[12:15], s28 offen lds
  s_mul_i32 s29, s21, 10240
  s_add_u32 m0, s29, 48128
  s_add_u32 s28, s46, 46592
  buffer_load_dwordx4 v5, s[12:15], s28 offen lds
  s_mul_i32 s29, s21, 10240
  s_add_u32 m0, s29, 49152
  s_add_u32 s28, s46, 46848
  buffer_load_dwordx4 v5, s[12:15], s28 offen lds
  s_mul_i32 s29, s21, 10240
  s_add_u32 m0, s29, 50176
  s_add_u32 s28, s46, 47104
  buffer_load_dwordx4 v5, s[12:15], s28 offen lds
  s_waitcnt vmcnt(10)
  s_barrier
  s_mul_i32 s29, s21, 10240
  s_add_u32 m0, s29, 81920
  s_add_u32 s28, s46, 81920
  buffer_load_dwordx4 v5, s[12:15], s28 offen lds
  s_mul_i32 s29, s21, 10240
  s_add_u32 m0, s29, 82944
  s_add_u32 s28, s46, 82176
  buffer_load_dwordx4 v5, s[12:15], s28 offen lds
  s_mul_i32 s29, s21, 10240
  s_add_u32 m0, s29, 83968
  s_add_u32 s28, s46, 82432
  buffer_load_dwordx4 v5, s[12:15], s28 offen lds
  s_mul_i32 s29, s21, 10240
  s_add_u32 m0, s29, 84992
  s_add_u32 s28, s46, 82688
  buffer_load_dwordx4 v5, s[12:15], s28 offen lds
  s_mul_i32 s29, s21, 10240
  s_add_u32 m0, s29, 86016
  s_add_u32 s28, s46, 82944
  buffer_load_dwordx4 v5, s[12:15], s28 offen lds
  s_mul_i32 s29, s21, 10240
  s_add_u32 m0, s29, 87040
  s_add_u32 s28, s46, 87040
  buffer_load_dwordx4 v5, s[12:15], s28 offen lds
  s_mul_i32 s29, s21, 10240
  s_add_u32 m0, s29, 88064
  s_add_u32 s28, s46, 87296
  buffer_load_dwordx4 v5, s[12:15], s28 offen lds
  s_mul_i32 s29, s21, 10240
  s_add_u32 m0, s29, 89088
  s_add_u32 s28, s46, 87552
  buffer_load_dwordx4 v5, s[12:15], s28 offen lds
  s_mul_i32 s29, s21, 10240
  s_add_u32 m0, s29, 90112
  s_add_u32 s28, s46, 87808
  buffer_load_dwordx4 v5, s[12:15], s28 offen lds
  s_mul_i32 s29, s21, 10240
  s_add_u32 m0, s29, 91136
  s_add_u32 s28, s46, 88064
  buffer_load_dwordx4 v5, s[12:15], s28 offen lds
  v_add_u32 v8, 0, v7
  ds_read_b64_tr_b16 a[0:1], v8 offset:0
  ds_read_b64_tr_b16 a[2:3], v8 offset:10240
  ds_read_b64_tr_b16 a[4:5], v8 offset:5120
  ds_read_b64_tr_b16 a[6:7], v8 offset:15360
  ds_read_b64_tr_b16 a[48:49], v8 offset:256
  ds_read_b64_tr_b16 a[50:51], v8 offset:10496
  ds_read_b64_tr_b16 a[52:53], v8 offset:5376
  ds_read_b64_tr_b16 a[54:55], v8 offset:15616
  ds_read_b64_tr_b16 a[96:97], v8 offset:512
  ds_read_b64_tr_b16 a[98:99], v8 offset:10752
  ds_read_b64_tr_b16 a[100:101], v8 offset:5632
  ds_read_b64_tr_b16 a[102:103], v8 offset:15872
  s_waitcnt lgkmcnt(0)
  ds_read_b64_tr_b16 a[144:145], v8 offset:768
  ds_read_b64_tr_b16 a[146:147], v8 offset:11008
  ds_read_b64_tr_b16 a[148:149], v8 offset:5888
  ds_read_b64_tr_b16 a[150:151], v8 offset:16128
  ds_read_b64_tr_b16 a[192:193], v8 offset:1024
  ds_read_b64_tr_b16 a[194:195], v8 offset:11264
  ds_read_b64_tr_b16 a[196:197], v8 offset:6144
  ds_read_b64_tr_b16 a[198:199], v8 offset:16384
  s_waitcnt lgkmcnt(0)
  s_waitcnt vmcnt(10)
  s_barrier
  s_mul_i32 s29, s21, 10240
  s_add_u32 m0, s29, 0
  s_add_u32 s28, s46, 122880
  buffer_load_dwordx4 v5, s[12:15], s28 offen lds
  s_mul_i32 s29, s21, 10240
  s_add_u32 m0, s29, 1024
  s_add_u32 s28, s46, 123136
  buffer_load_dwordx4 v5, s[12:15], s28 offen lds
  s_mul_i32 s29, s21, 10240
  s_add_u32 m0, s29, 2048
  s_add_u32 s28, s46, 123392
  buffer_load_dwordx4 v5, s[12:15], s28 offen lds
  s_mul_i32 s29, s21, 10240
  s_add_u32 m0, s29, 3072
  s_add_u32 s28, s46, 123648
  buffer_load_dwordx4 v5, s[12:15], s28 offen lds
  s_mul_i32 s29, s21, 10240
  s_add_u32 m0, s29, 4096
  s_add_u32 s28, s46, 123904
  buffer_load_dwordx4 v5, s[12:15], s28 offen lds
  s_mul_i32 s29, s21, 10240
  s_add_u32 m0, s29, 5120
  s_add_u32 s28, s46, 128000
  buffer_load_dwordx4 v5, s[12:15], s28 offen lds
  s_mul_i32 s29, s21, 10240
  s_add_u32 m0, s29, 6144
  s_add_u32 s28, s46, 128256
  buffer_load_dwordx4 v5, s[12:15], s28 offen lds
  s_mul_i32 s29, s21, 10240
  s_add_u32 m0, s29, 7168
  s_add_u32 s28, s46, 128512
  buffer_load_dwordx4 v5, s[12:15], s28 offen lds
  s_mul_i32 s29, s21, 10240
  s_add_u32 m0, s29, 8192
  s_add_u32 s28, s46, 128768
  buffer_load_dwordx4 v5, s[12:15], s28 offen lds
  s_mul_i32 s29, s21, 10240
  s_add_u32 m0, s29, 9216
  s_add_u32 s28, s46, 129024
  buffer_load_dwordx4 v5, s[12:15], s28 offen lds
  v_add_u32 v8, 40960, v7
  ds_read_b64_tr_b16 a[8:9], v8 offset:0
  ds_read_b64_tr_b16 a[10:11], v8 offset:10240
  ds_read_b64_tr_b16 a[12:13], v8 offset:5120
  ds_read_b64_tr_b16 a[14:15], v8 offset:15360
  ds_read_b64_tr_b16 a[56:57], v8 offset:256
  ds_read_b64_tr_b16 a[58:59], v8 offset:10496
  ds_read_b64_tr_b16 a[60:61], v8 offset:5376
  ds_read_b64_tr_b16 a[62:63], v8 offset:15616
  ds_read_b64_tr_b16 a[104:105], v8 offset:512
  ds_read_b64_tr_b16 a[106:107], v8 offset:10752
  ds_read_b64_tr_b16 a[108:109], v8 offset:5632
  ds_read_b64_tr_b16 a[110:111], v8 offset:15872
  s_waitcnt lgkmcnt(0)
  ds_read_b64_tr_b16 a[152:153], v8 offset:768
  ds_read_b64_tr_b16 a[154:155], v8 offset:11008
  ds_read_b64_tr_b16 a[156:157], v8 offset:5888
  ds_read_b64_tr_b16 a[158:159], v8 offset:16128
  ds_read_b64_tr_b16 a[200:201], v8 offset:1024
  ds_read_b64_tr_b16 a[202:203], v8 offset:11264
  ds_read_b64_tr_b16 a[204:205], v8 offset:6144
  ds_read_b64_tr_b16 a[206:207], v8 offset:16384
  s_waitcnt lgkmcnt(0)
  s_waitcnt vmcnt(10)
  s_barrier
  s_mul_i32 s29, s21, 10240
  s_add_u32 m0, s29, 40960
  s_add_u32 s28, s46, 163840
  buffer_load_dwordx4 v5, s[12:15], s28 offen lds
  s_mul_i32 s29, s21, 10240
  s_add_u32 m0, s29, 41984
  s_add_u32 s28, s46, 164096
  buffer_load_dwordx4 v5, s[12:15], s28 offen lds
  s_mul_i32 s29, s21, 10240
  s_add_u32 m0, s29, 43008
  s_add_u32 s28, s46, 164352
  buffer_load_dwordx4 v5, s[12:15], s28 offen lds
  s_mul_i32 s29, s21, 10240
  s_add_u32 m0, s29, 44032
  s_add_u32 s28, s46, 164608
  buffer_load_dwordx4 v5, s[12:15], s28 offen lds
  s_mul_i32 s29, s21, 10240
  s_add_u32 m0, s29, 45056
  s_add_u32 s28, s46, 164864
  buffer_load_dwordx4 v5, s[12:15], s28 offen lds
  s_mul_i32 s29, s21, 10240
  s_add_u32 m0, s29, 46080
  s_add_u32 s28, s46, 168960
  buffer_load_dwordx4 v5, s[12:15], s28 offen lds
  s_mul_i32 s29, s21, 10240
  s_add_u32 m0, s29, 47104
  s_add_u32 s28, s46, 169216
  buffer_load_dwordx4 v5, s[12:15], s28 offen lds
  s_mul_i32 s29, s21, 10240
  s_add_u32 m0, s29, 48128
  s_add_u32 s28, s46, 169472
  buffer_load_dwordx4 v5, s[12:15], s28 offen lds
  s_mul_i32 s29, s21, 10240
  s_add_u32 m0, s29, 49152
  s_add_u32 s28, s46, 169728
  buffer_load_dwordx4 v5, s[12:15], s28 offen lds
  s_mul_i32 s29, s21, 10240
  s_add_u32 m0, s29, 50176
  s_add_u32 s28, s46, 169984
  buffer_load_dwordx4 v5, s[12:15], s28 offen lds
  v_add_u32 v8, 81920, v7
  ds_read_b64_tr_b16 a[16:17], v8 offset:0
  ds_read_b64_tr_b16 a[18:19], v8 offset:10240
  ds_read_b64_tr_b16 a[20:21], v8 offset:5120
  ds_read_b64_tr_b16 a[22:23], v8 offset:15360
  ds_read_b64_tr_b16 a[64:65], v8 offset:256
  ds_read_b64_tr_b16 a[66:67], v8 offset:10496
  ds_read_b64_tr_b16 a[68:69], v8 offset:5376
  ds_read_b64_tr_b16 a[70:71], v8 offset:15616
  ds_read_b64_tr_b16 a[112:113], v8 offset:512
  ds_read_b64_tr_b16 a[114:115], v8 offset:10752
  ds_read_b64_tr_b16 a[116:117], v8 offset:5632
  ds_read_b64_tr_b16 a[118:119], v8 offset:15872
  s_waitcnt lgkmcnt(0)
  ds_read_b64_tr_b16 a[160:161], v8 offset:768
  ds_read_b64_tr_b16 a[162:163], v8 offset:11008
  ds_read_b64_tr_b16 a[164:165], v8 offset:5888
  ds_read_b64_tr_b16 a[166:167], v8 offset:16128
  ds_read_b64_tr_b16 a[208:209], v8 offset:1024
  ds_read_b64_tr_b16 a[210:211], v8 offset:11264
  ds_read_b64_tr_b16 a[212:213], v8 offset:6144
  ds_read_b64_tr_b16 a[214:215], v8 offset:16384
  s_waitcnt lgkmcnt(0)
  s_waitcnt vmcnt(10)
  s_barrier
  s_mul_i32 s29, s21, 10240
  s_add_u32 m0, s29, 81920
  s_add_u32 s28, s46, 204800
  buffer_load_dwordx4 v5, s[12:15], s28 offen lds
  s_mul_i32 s29, s21, 10240
  s_add_u32 m0, s29, 82944
  s_add_u32 s28, s46, 205056
  buffer_load_dwordx4 v5, s[12:15], s28 offen lds
  s_mul_i32 s29, s21, 10240
  s_add_u32 m0, s29, 83968
  s_add_u32 s28, s46, 205312
  buffer_load_dwordx4 v5, s[12:15], s28 offen lds
  s_mul_i32 s29, s21, 10240
  s_add_u32 m0, s29, 84992
  s_add_u32 s28, s46, 205568
  buffer_load_dwordx4 v5, s[12:15], s28 offen lds
  s_mul_i32 s29, s21, 10240
  s_add_u32 m0, s29, 86016
  s_add_u32 s28, s46, 205824
  buffer_load_dwordx4 v5, s[12:15], s28 offen lds
  s_mul_i32 s29, s21, 10240
  s_add_u32 m0, s29, 87040
  s_add_u32 s28, s46, 209920
  buffer_load_dwordx4 v5, s[12:15], s28 offen lds
  s_mul_i32 s29, s21, 10240
  s_add_u32 m0, s29, 88064
  s_add_u32 s28, s46, 210176
  buffer_load_dwordx4 v5, s[12:15], s28 offen lds
  s_mul_i32 s29, s21, 10240
  s_add_u32 m0, s29, 89088
  s_add_u32 s28, s46, 210432
  buffer_load_dwordx4 v5, s[12:15], s28 offen lds
  s_mul_i32 s29, s21, 10240
  s_add_u32 m0, s29, 90112
  s_add_u32 s28, s46, 210688
  buffer_load_dwordx4 v5, s[12:15], s28 offen lds
  s_mul_i32 s29, s21, 10240
  s_add_u32 m0, s29, 91136
  s_add_u32 s28, s46, 210944
  buffer_load_dwordx4 v5, s[12:15], s28 offen lds
  v_add_u32 v8, 0, v7
  ds_read_b64_tr_b16 a[24:25], v8 offset:0
  ds_read_b64_tr_b16 a[26:27], v8 offset:10240
  ds_read_b64_tr_b16 a[28:29], v8 offset:5120
  ds_read_b64_tr_b16 a[30:31], v8 offset:15360
  ds_read_b64_tr_b16 a[72:73], v8 offset:256
  ds_read_b64_tr_b16 a[74:75], v8 offset:10496
  ds_read_b64_tr_b16 a[76:77], v8 offset:5376
  ds_read_b64_tr_b16 a[78:79], v8 offset:15616
  ds_read_b64_tr_b16 a[120:121], v8 offset:512
  ds_read_b64_tr_b16 a[122:123], v8 offset:10752
  ds_read_b64_tr_b16 a[124:125], v8 offset:5632
  ds_read_b64_tr_b16 a[126:127], v8 offset:15872
  s_waitcnt lgkmcnt(0)
  ds_read_b64_tr_b16 a[168:169], v8 offset:768
  ds_read_b64_tr_b16 a[170:171], v8 offset:11008
  ds_read_b64_tr_b16 a[172:173], v8 offset:5888
  ds_read_b64_tr_b16 a[174:175], v8 offset:16128
  ds_read_b64_tr_b16 a[216:217], v8 offset:1024
  ds_read_b64_tr_b16 a[218:219], v8 offset:11264
  ds_read_b64_tr_b16 a[220:221], v8 offset:6144
  ds_read_b64_tr_b16 a[222:223], v8 offset:16384
  s_waitcnt lgkmcnt(0)
  s_waitcnt vmcnt(10)
  s_barrier
  v_add_u32 v8, 40960, v7
  ds_read_b64_tr_b16 a[32:33], v8 offset:0
  ds_read_b64_tr_b16 a[34:35], v8 offset:10240
  ds_read_b64_tr_b16 a[36:37], v8 offset:5120
  ds_read_b64_tr_b16 a[38:39], v8 offset:15360
  ds_read_b64_tr_b16 a[80:81], v8 offset:256
  ds_read_b64_tr_b16 a[82:83], v8 offset:10496
  ds_read_b64_tr_b16 a[84:85], v8 offset:5376
  ds_read_b64_tr_b16 a[86:87], v8 offset:15616
  ds_read_b64_tr_b16 a[128:129], v8 offset:512
  ds_read_b64_tr_b16 a[130:131], v8 offset:10752
  ds_read_b64_tr_b16 a[132:133], v8 offset:5632
  ds_read_b64_tr_b16 a[134:135], v8 offset:15872
  s_waitcnt lgkmcnt(0)
  ds_read_b64_tr_b16 a[176:177], v8 offset:768
  ds_read_b64_tr_b16 a[178:179], v8 offset:11008
  ds_read_b64_tr_b16 a[180:181], v8 offset:5888
  ds_read_b64_tr_b16 a[182:183], v8 offset:16128
  ds_read_b64_tr_b16 a[224:225], v8 offset:1024
  ds_read_b64_tr_b16 a[226:227], v8 offset:11264
  ds_read_b64_tr_b16 a[228:229], v8 offset:6144
  ds_read_b64_tr_b16 a[230:231], v8 offset:16384
  s_waitcnt lgkmcnt(0)
  s_waitcnt vmcnt(0)
  s_barrier
  v_add_u32 v8, 81920, v7
  ds_read_b64_tr_b16 a[40:41], v8 offset:0
  ds_read_b64_tr_b16 a[42:43], v8 offset:10240
  ds_read_b64_tr_b16 a[44:45], v8 offset:5120
  ds_read_b64_tr_b16 a[46:47], v8 offset:15360
  ds_read_b64_tr_b16 a[88:89], v8 offset:256
  ds_read_b64_tr_b16 a[90:91], v8 offset:10496
  ds_read_b64_tr_b16 a[92:93], v8 offset:5376
  ds_read_b64_tr_b16 a[94:95], v8 offset:15616
  ds_read_b64_tr_b16 a[136:137], v8 offset:512
  ds_read_b64_tr_b16 a[138:139], v8 offset:10752
  ds_read_b64_tr_b16 a[140:141], v8 offset:5632
  ds_read_b64_tr_b16 a[142:143], v8 offset:15872
  s_waitcnt lgkmcnt(0)
  ds_read_b64_tr_b16 a[184:185], v8 offset:768
  ds_read_b64_tr_b16 a[186:187], v8 offset:11008
  ds_read_b64_tr_b16 a[188:189], v8 offset:5888
  ds_read_b64_tr_b16 a[190:191], v8 offset:16128
  ds_read_b64_tr_b16 a[232:233], v8 offset:1024
  ds_read_b64_tr_b16 a[234:235], v8 offset:11264
  ds_read_b64_tr_b16 a[236:237], v8 offset:6144
  ds_read_b64_tr_b16 a[238:239], v8 offset:16384
  s_waitcnt lgkmcnt(0)
  s_barrier
  v_lshlrev_b32 v5, 4, v1
  s_lshl_b32 s28, s21, 10
  v_add_u32 v6, s28, v5
  v_bfe_u32 v2, v1, 4, 1
  v_lshlrev_b32 v9, 10, v2
  v_and_b32 v2, 15, v1
  v_lshlrev_b32 v2, 4, v2
  v_add_u32 v9, v9, v2
  v_lshrrev_b32 v3, 5, v1
  v_lshlrev_b32 v3, 8, v3
  v_add_u32 v9, v9, v3
  v_add_u32 v10, 12288, v9
  v_bfe_u32 v3, v1, 4, 1
  v_lshlrev_b32 v11, 10, v3
  v_add_u32 v11, v11, v2
  v_lshrrev_b32 v3, 5, v1
  v_lshlrev_b32 v3, 9, v3
  v_add_u32 v11, v11, v3
  s_mul_i32 s28, s23, 6
  s_lshr_b32 s29, s28, 3
  s_add_u32 s28, s28, 5
  s_lshr_b32 s28, s28, 3
  v_and_b32 v2, 1, v1
  v_mov_b32 v12, s29
  v_mov_b32 v13, s28
  v_cmp_eq_u32 vcc, 1, v2
  s_nop 1
  v_cndmask_b32 v12, v12, v13, vcc
  v_lshlrev_b32 v12, 2, v12
  v_add_u32 v12, 2048, v12
  s_lshl_b32 s28, s23, 2
  s_add_u32 s28, s28, 3072
  v_mov_b32 v14, s28
  s_mul_i32 s47, s23, 786432
  s_add_u32 s47, s47, 0x7800000
  s_mul_i32 s48, s23, 40960
  s_mul_i32 s28, s21, 10240
  s_add_u32 s48, s48, s28
  s_add_u32 s48, s48, 0x9000000
  s_mov_b32 s50, 0
  s_mov_b32 s52, 0
  s_mov_b32 s54, 0
  s_mov_b32 s53, 0
  s_cmp_gt_u32 s52, s53
  s_cbranch_scc1 ka_wp_51_ok
  s_mov_b32 s45, 0
ka_wp_51_spin:
  buffer_load_dword v2, v12, s[8:11], 0 offen sc1
  s_add_u32 s45, s45, 1
  s_waitcnt vmcnt(0)
  v_min_u32_dpp v3, v2, v2 quad_perm:[1,0,3,2] row_mask:0xf bank_mask:0xf
  s_nop 1
  v_min_u32_dpp v2, v3, v3 quad_perm:[2,3,0,1] row_mask:0xf bank_mask:0xf
  s_nop 1
  v_min_u32_dpp v3, v2, v2 row_half_mirror row_mask:0xf bank_mask:0xf
  s_nop 1
  v_min_u32_dpp v2, v3, v3 quad_perm:[0,1,2,3] row_mask:0xf bank_mask:0xf
  s_nop 0
  v_readfirstlane_b32 s52, v2
  s_cmp_gt_u32 s52, s53
  s_cbranch_scc1 ka_wp_51_ok
  s_cmp_lt_u32 s45, 400000
  s_cbranch_scc1 ka_wp_51_spin
  s_branch ka_abort
ka_wp_51_ok:
  s_lshl_b32 s29, s21, 10
  s_add_u32 m0, s29, 0
  s_add_u32 s28, s47, 0
  buffer_load_dwordx4 v6, s[8:11], s28 offen sc1 lds
  s_lshl_b32 s29, s21, 10
  s_add_u32 m0, s29, 4096
  s_add_u32 s28, s47, 4096
  buffer_load_dwordx4 v6, s[8:11], s28 offen sc1 lds
  s_lshl_b32 s29, s21, 10
  s_add_u32 m0, s29, 8192
  s_add_u32 s28, s47, 8192
  buffer_load_dwordx4 v6, s[8:11], s28 offen sc1 lds
  s_add_u32 s47, s47, 12288
ka_u_loop:
  s_cmp_eq_u32 s50, 0
  s_cbranch_scc0 u0_52
  s_waitcnt vmcnt(0)
u0_52:
  s_waitcnt vmcnt(10)
  s_cmp_eq_u32 s54, 0
  s_cbranch_scc1 ud_53
  s_waitcnt vmcnt(0)
ud_53:
  s_barrier
  ds_read_b128 v[16:19], v9 offset:0
  ds_read_b128 v[20:23], v9 offset:512
  ds_read_b128 v[24:27], v9 offset:2048
  ds_read_b128 v[28:31], v9 offset:2560
  ds_read_b128 v[32:35], v9 offset:4096
  ds_read_b128 v[36:39], v9 offset:4608
  ds_read_b128 v[40:43], v9 offset:6144
  ds_read_b128 v[44:47], v9 offset:6656
  ds_read_b128 v[48:51], v9 offset:8192
  ds_read_b128 v[52:55], v9 offset:8704
  ds_read_b128 v[56:59], v9 offset:10240
  ds_read_b128 v[60:63], v9 offset:10752
  s_mov_b32 s54, 0
  s_cmp_ge_u32 s50, 63
  s_cbranch_scc1 un_54_n
  s_add_u32 s53, s50, 1
  s_cmp_gt_u32 s52, s53
  s_cbranch_scc1 un_54_go
  buffer_load_dword v2, v12, s[8:11], 0 offen sc1
  s_waitcnt vmcnt(0)
  v_min_u32_dpp v3, v2, v2 quad_perm:[1,0,3,2] row_mask:0xf bank_mask:0xf
  s_nop 0
  v_readfirstlane_b32 s52, v3
  s_cmp_gt_u32 s52, s53
  s_cbranch_scc1 un_54_go2
  s_mov_b32 s54, 1
  s_branch un_54
un_54_go2:
un_54_go:
  s_lshl_b32 s29, s21, 10
  s_add_u32 m0, s29, 12288
  s_add_u32 s28, s47, 0
  buffer_load_dwordx4 v6, s[8:11], s28 offen sc1 lds
  s_lshl_b32 s29, s21, 10
  s_add_u32 m0, s29, 16384
  s_add_u32 s28, s47, 4096
  buffer_load_dwordx4 v6, s[8:11], s28 offen sc1 lds
  s_lshl_b32 s29, s21, 10
  s_add_u32 m0, s29, 20480
  s_add_u32 s28, s47, 8192
  buffer_load_dwordx4 v6, s[8:11], s28 offen sc1 lds
  s_add_u32 s47, s47, 12288
  s_branch un_54
un_54_n:
  s_waitcnt vmcnt(0)
un_54:
  s_mul_i32 s30, s50, 1310720
  s_add_u32 s30, s30, s48
  s_waitcnt lgkmcnt(11)
  v_mfma_f32_32x32x16_bf16 v[64:79], v[16:19], a[0:3], 0
  s_waitcnt lgkmcnt(10)
  v_mfma_f32_32x32x16_bf16 v[64:79], v[20:23], a[4:7], v[64:79]
  s_waitcnt lgkmcnt(9)
  v_mfma_f32_32x32x16_bf16 v[64:79], v[24:27], a[8:11], v[64:79]
  s_waitcnt lgkmcnt(8)
  v_mfma_f32_32x32x16_bf16 v[64:79], v[28:31], a[12:15], v[64:79]
  s_waitcnt lgkmcnt(7)
  v_mfma_f32_32x32x16_bf16 v[64:79], v[32:35], a[16:19], v[64:79]
  s_waitcnt lgkmcnt(6)
  v_mfma_f32_32x32x16_bf16 v[64:79], v[36:39], a[20:23], v[64:79]
  s_waitcnt lgkmcnt(5)
  v_mfma_f32_32x32x16_bf16 v[64:79], v[40:43], a[24:27], v[64:79]
  s_waitcnt lgkmcnt(4)
  v_mfma_f32_32x32x16_bf16 v[64:79], v[44:47], a[28:31], v[64:79]
  s_waitcnt lgkmcnt(3)
  v_mfma_f32_32x32x16_bf16 v[64:79], v[48:51], a[32:35], v[64:79]
  s_waitcnt lgkmcnt(2)
  v_mfma_f32_32x32x16_bf16 v[64:79], v[52:55], a[36:39], v[64:79]
  s_waitcnt lgkmcnt(1)
  v_mfma_f32_32x32x16_bf16 v[64:79], v[56:59], a[40:43], v[64:79]
  s_waitcnt lgkmcnt(0)
  v_mfma_f32_32x32x16_bf16 v[64:79], v[60:63], a[44:47], v[64:79]
  v_mfma_f32_32x32x16_bf16 v[80:95], v[16:19], a[48:51], 0
  v_mfma_f32_32x32x16_bf16 v[80:95], v[20:23], a[52:55], v[80:95]
  v_mfma_f32_32x32x16_bf16 v[80:95], v[24:27], a[56:59], v[80:95]
  v_cvt_pk_bf16_f32 v96, v64, v65
  v_cvt_pk_bf16_f32 v97, v66, v67
  v_mfma_f32_32x32x16_bf16 v[80:95], v[28:31], a[60:63], v[80:95]
  v_cvt_pk_bf16_f32 v98, v68, v69
  v_cvt_pk_bf16_f32 v99, v70, v71
  v_mfma_f32_32x32x16_bf16 v[80:95], v[32:35], a[64:67], v[80:95]
  v_cvt_pk_bf16_f32 v100, v72, v73
  v_cvt_pk_bf16_f32 v101, v74, v75
  v_mfma_f32_32x32x16_bf16 v[80:95], v[36:39], a[68:71], v[80:95]
  v_cvt_pk_bf16_f32 v102, v76, v77
  v_cvt_pk_bf16_f32 v103, v78, v79
  v_mfma_f32_32x32x16_bf16 v[80:95], v[40:43], a[72:75], v[80:95]
  s_add_u32 s29, s30, 0
  buffer_store_dwordx4 v[96:99], v11, s[8:11], s29 offen offset:0 sc1
  v_mfma_f32_32x32x16_bf16 v[80:95], v[44:47], a[76:79], v[80:95]
  buffer_store_dwordx4 v[100:103], v11, s[8:11], s29 offen offset:256 sc1
  v_mfma_f32_32x32x16_bf16 v[80:95], v[48:51], a[80:83], v[80:95]
  v_mfma_f32_32x32x16_bf16 v[80:95], v[52:55], a[84:87], v[80:95]
  v_mfma_f32_32x32x16_bf16 v[80:95], v[56:59], a[88:91], v[80:95]
  v_mfma_f32_32x32x16_bf16 v[80:95], v[60:63], a[92:95], v[80:95]
  v_mfma_f32_32x32x16_bf16 v[64:79], v[16:19], a[96:99], 0
  v_mfma_f32_32x32x16_bf16 v[64:79], v[20:23], a[100:103], v[64:79]
  v_mfma_f32_32x32x16_bf16 v[64:79], v[24:27], a[104:107], v[64:79]
  v_cvt_pk_bf16_f32 v96, v80, v81
  v_cvt_pk_bf16_f32 v97, v82, v83
  v_mfma_f32_32x32x16_bf16 v[64:79], v[28:31], a[108:111], v[64:79]
  v_cvt_pk_bf16_f32 v98, v84, v85
  v_cvt_pk_bf16_f32 v99, v86, v87
  v_mfma_f32_32x32x16_bf16 v[64:79], v[32:35], a[112:115], v[64:79]
  v_cvt_pk_bf16_f32 v100, v88, v89
  v_cvt_pk_bf16_f32 v101, v90, v91
  v_mfma_f32_32x32x16_bf16 v[64:79], v[36:39], a[116:119], v[64:79]
  v_cvt_pk_bf16_f32 v102, v92, v93
  v_cvt_pk_bf16_f32 v103, v94, v95
  v_mfma_f32_32x32x16_bf16 v[64:79], v[40:43], a[120:123], v[64:79]
  s_add_u32 s29, s30, 2048
  buffer_store_dwordx4 v[96:99], v11, s[8:11], s29 offen offset:0 sc1
  v_mfma_f32_32x32x16_bf16 v[64:79], v[44:47], a[124:127], v[64:79]
  buffer_store_dwordx4 v[100:103], v11, s[8:11], s29 offen offset:256 sc1
  v_mfma_f32_32x32x16_bf16 v[64:79], v[48:51], a[128:131], v[64:79]
  v_mfma_f32_32x32x16_bf16 v[64:79], v[52:55], a[132:135], v[64:79]
  v_mfma_f32_32x32x16_bf16 v[64:79], v[56:59], a[136:139], v[64:79]
  v_mfma_f32_32x32x16_bf16 v[64:79], v[60:63], a[140:143], v[64:79]
  s_waitcnt vmcnt(7)
  s_barrier
  s_cmp_eq_u32 s21, 0
  s_cbranch_scc0 mp_55
  v_mov_b32 v13, s50
  s_mov_b64 s[24:25], exec
  s_mov_b64 exec, 1
  buffer_store_dword v13, v14, s[8:11], 0 offen sc1
  s_mov_b64 exec, s[24:25]
mp_55:
  v_mfma_f32_32x32x16_bf16 v[80:95], v[16:19], a[144:147], 0
  v_mfma_f32_32x32x16_bf16 v[80:95], v[20:23], a[148:151], v[80:95]
  v_mfma_f32_32x32x16_bf16 v[80:95], v[24:27], a[152:155], v[80:95]
  v_cvt_pk_bf16_f32 v96, v64, v65
  v_cvt_pk_bf16_f32 v97, v66, v67
  v_mfma_f32_32x32x16_bf16 v[80:95], v[28:31], a[156:159], v[80:95]
  v_cvt_pk_bf16_f32 v98, v68, v69
  v_cvt_pk_bf16_f32 v99, v70, v71
  v_mfma_f32_32x32x16_bf16 v[80:95], v[32:35], a[160:163], v[80:95]
  v_cvt_pk_bf16_f32 v100, v72, v73
  v_cvt_pk_bf16_f32 v101, v74, v75
  v_mfma_f32_32x32x16_bf16 v[80:95], v[36:39], a[164:167], v[80:95]
  v_cvt_pk_bf16_f32 v102, v76, v77
  v_cvt_pk_bf16_f32 v103, v78, v79
  v_mfma_f32_32x32x16_bf16 v[80:95], v[40:43], a[168:171], v[80:95]
  s_add_u32 s29, s30, 4096
  buffer_store_dwordx4 v[96:99], v11, s[8:11], s29 offen offset:0 sc1
  v_mfma_f32_32x32x16_bf16 v[80:95], v[44:47], a[172:175], v[80:95]
  buffer_store_dwordx4 v[100:103], v11, s[8:11], s29 offen offset:256 sc1
  v_mfma_f32_32x32x16_bf16 v[80:95], v[48:51], a[176:179], v[80:95]
  v_mfma_f32_32x32x16_bf16 v[80:95], v[52:55], a[180:183], v[80:95]
  v_mfma_f32_32x32x16_bf16 v[80:95], v[56:59], a[184:187], v[80:95]
  v_mfma_f32_32x32x16_bf16 v[80:95], v[60:63], a[188:191], v[80:95]
  v_mfma_f32_32x32x16_bf16 v[64:79], v[16:19], a[192:195], 0
  v_mfma_f32_32x32x16_bf16 v[64:79], v[20:23], a[196:199], v[64:79]
  v_mfma_f32_32x32x16_bf16 v[64:79], v[24:27], a[200:203], v[64:79]
  v_cvt_pk_bf16_f32 v96, v80, v81
  v_cvt_pk_bf16_f32 v97, v82, v83
  v_mfma_f32_32x32x16_bf16 v[64:79], v[28:31], a[204:207], v[64:79]
  v_cvt_pk_bf16_f32 v98, v84, v85
  v_cvt_pk_bf16_f32 v99, v86, v87
  v_mfma_f32_32x32x16_bf16 v[64:79], v[32:35], a[208:211], v[64:79]
  v_cvt_pk_bf16_f32 v100, v88, v89
  v_cvt_pk_bf16_f32 v101, v90, v91
  v_mfma_f32_32x32x16_bf16 v[64:79], v[36:39], a[212:215], v[64:79]
  v_cvt_pk_bf16_f32 v102, v92, v93
  v_cvt_pk_bf16_f32 v103, v94, v95
  v_mfma_f32_32x32x16_bf16 v[64:79], v[40:43], a[216:219], v[64:79]
  s_add_u32 s29, s30, 6144
  buffer_store_dwordx4 v[96:99], v11, s[8:11], s29 offen offset:0 sc1
  v_mfma_f32_32x32x16_bf16 v[64:79], v[44:47], a[220:223], v[64:79]
  buffer_store_dwordx4 v[100:103], v11, s[8:11], s29 offen offset:256 sc1
  v_mfma_f32_32x32x16_bf16 v[64:79], v[48:51], a[224:227], v[64:79]
  v_mfma_f32_32x32x16_bf16 v[64:79], v[52:55], a[228:231], v[64:79]
  v_mfma_f32_32x32x16_bf16 v[64:79], v[56:59], a[232:235], v[64:79]
  v_mfma_f32_32x32x16_bf16 v[64:79], v[60:63], a[236:239], v[64:79]
  s_nop 11
  v_cvt_pk_bf16_f32 v96, v64, v65
  v_cvt_pk_bf16_f32 v97, v66, v67
  v_cvt_pk_bf16_f32 v98, v68, v69
  v_cvt_pk_bf16_f32 v99, v70, v71
  v_cvt_pk_bf16_f32 v100, v72, v73
  v_cvt_pk_bf16_f32 v101, v74, v75
  v_cvt_pk_bf16_f32 v102, v76, v77
  v_cvt_pk_bf16_f32 v103, v78, v79
  s_add_u32 s29, s30, 8192
  buffer_store_dwordx4 v[96:99], v11, s[8:11], s29 offen offset:0 sc1
  buffer_store_dwordx4 v[100:103], v11, s[8:11], s29 offen offset:256 sc1
  s_cmp_eq_u32 s54, 0
  s_cbranch_scc1 udf_56
  s_cmp_gt_u32 s52, s53
  s_cbranch_scc1 ka_wp_57_ok
  s_mov_b32 s45, 0
ka_wp_57_spin:
  buffer_load_dword v2, v12, s[8:11], 0 offen sc1
  s_add_u32 s45, s45, 1
  s_waitcnt vmcnt(0)
  v_min_u32_dpp v3, v2, v2 quad_perm:[1,0,3,2] row_mask:0xf bank_mask:0xf
  s_nop 1
  v_min_u32_dpp v2, v3, v3 quad_perm:[2,3,0,1] row_mask:0xf bank_mask:0xf
  s_nop 1
  v_min_u32_dpp v3, v2, v2 row_half_mirror row_mask:0xf bank_mask:0xf
  s_nop 1
  v_min_u32_dpp v2, v3, v3 quad_perm:[0,1,2,3] row_mask:0xf bank_mask:0xf
  s_nop 0
  v_readfirstlane_b32 s52, v2
  s_cmp_gt_u32 s52, s53
  s_cbranch_scc1 ka_wp_57_ok
  s_cmp_lt_u32 s45, 400000
  s_cbranch_scc1 ka_wp_57_spin
  s_branch ka_abort
ka_wp_57_ok:
  s_lshl_b32 s29, s21, 10
  s_add_u32 m0, s29, 12288
  s_add_u32 s28, s47, 0
  buffer_load_dwordx4 v6, s[8:11], s28 offen sc1 lds
  s_lshl_b32 s29, s21, 10
  s_add_u32 m0, s29, 16384
  s_add_u32 s28, s47, 4096
  buffer_load_dwordx4 v6, s[8:11], s28 offen sc1 lds
  s_lshl_b32 s29, s21, 10
  s_add_u32 m0, s29, 20480
  s_add_u32 s28, s47, 8192
  buffer_load_dwordx4 v6, s[8:11], s28 offen sc1 lds
  s_add_u32 s47, s47, 12288
udf_56:
  s_add_u32 s50, s50, 1
  s_waitcnt vmcnt(10)
  s_cmp_eq_u32 s54, 0
  s_cbranch_scc1 ud_58
  s_waitcnt vmcnt(0)
ud_58:
  s_barrier
  ds_read_b128 v[16:19], v10 offset:0
  ds_read_b128 v[20:23], v10 offset:512
  ds_read_b128 v[24:27], v10 offset:2048
  ds_read_b128 v[28:31], v10 offset:2560
  ds_read_b128 v[32:35], v10 offset:4096
  ds_read_b128 v[36:39], v10 offset:4608
  ds_read_b128 v[40:43], v10 offset:6144
  ds_read_b128 v[44:47], v10 offset:6656
  ds_read_b128 v[48:51], v10 offset:8192
  ds_read_b128 v[52:55], v10 offset:8704
  ds_read_b128 v[56:59], v10 offset:10240
  ds_read_b128 v[60:63], v10 offset:10752
  s_mov_b32 s54, 0
  s_cmp_ge_u32 s50, 63
  s_cbranch_scc1 un_59_n
  s_add_u32 s53, s50, 1
  s_cmp_gt_u32 s52, s53
  s_cbranch_scc1 un_59_go
  buffer_load_dword v2, v12, s[8:11], 0 offen sc1
  s_waitcnt vmcnt(0)
  v_min_u32_dpp v3, v2, v2 quad_perm:[1,0,3,2] row_mask:0xf bank_mask:0xf
  s_nop 0
  v_readfirstlane_b32 s52, v3
  s_cmp_gt_u32 s52, s53
  s_cbranch_scc1 un_59_go2
  s_mov_b32 s54, 1
  s_branch un_59
un_59_go2:
un_59_go:
  s_lshl_b32 s29, s21, 10
  s_add_u32 m0, s29, 0
  s_add_u32 s28, s47, 0
  buffer_load_dwordx4 v6, s[8:11], s28 offen sc1 lds
  s_lshl_b32 s29, s21, 10
  s_add_u32 m0, s29, 4096
  s_add_u32 s28, s47, 4096
  buffer_load_dwordx4 v6, s[8:11], s28 offen sc1 lds
  s_lshl_b32 s29, s21, 10
  s_add_u32 m0, s29, 8192
  s_add_u32 s28, s47, 8192
  buffer_load_dwordx4 v6, s[8:11], s28 offen sc1 lds
  s_add_u32 s47, s47, 12288
  s_branch un_59
un_59_n:
  s_waitcnt vmcnt(0)
un_59:
  s_mul_i32 s30, s50, 1310720
  s_add_u32 s30, s30, s48
  s_waitcnt lgkmcnt(11)
  v_mfma_f32_32x32x16_bf16 v[64:79], v[16:19], a[0:3], 0
  s_waitcnt lgkmcnt(10)
  v_mfma_f32_32x32x16_bf16 v[64:79], v[20:23], a[4:7], v[64:79]
  s_waitcnt lgkmcnt(9)
  v_mfma_f32_32x32x16_bf16 v[64:79], v[24:27], a[8:11], v[64:79]
  s_waitcnt lgkmcnt(8)
  v_mfma_f32_32x32x16_bf16 v[64:79], v[28:31], a[12:15], v[64:79]
  s_waitcnt lgkmcnt(7)
  v_mfma_f32_32x32x16_bf16 v[64:79], v[32:35], a[16:19], v[64:79]
  s_waitcnt lgkmcnt(6)
  v_mfma_f32_32x32x16_bf16 v[64:79], v[36:39], a[20:23], v[64:79]
  s_waitcnt lgkmcnt(5)
  v_mfma_f32_32x32x16_bf16 v[64:79], v[40:43], a[24:27], v[64:79]
  s_waitcnt lgkmcnt(4)
  v_mfma_f32_32x32x16_bf16 v[64:79], v[44:47], a[28:31], v[64:79]
  s_waitcnt lgkmcnt(3)
  v_mfma_f32_32x32x16_bf16 v[64:79], v[48:51], a[32:35], v[64:79]
  s_waitcnt lgkmcnt(2)
  v_mfma_f32_32x32x16_bf16 v[64:79], v[52:55], a[36:39], v[64:79]
  s_waitcnt lgkmcnt(1)
  v_mfma_f32_32x32x16_bf16 v[64:79], v[56:59], a[40:43], v[64:79]
  s_waitcnt lgkmcnt(0)
  v_mfma_f32_32x32x16_bf16 v[64:79], v[60:63], a[44:47], v[64:79]
  v_mfma_f32_32x32x16_bf16 v[80:95], v[16:19], a[48:51], 0
  v_mfma_f32_32x32x16_bf16 v[80:95], v[20:23], a[52:55], v[80:95]
  v_mfma_f32_32x32x16_bf16 v[80:95], v[24:27], a[56:59], v[80:95]
  v_cvt_pk_bf16_f32 v96, v64, v65
  v_cvt_pk_bf16_f32 v97, v66, v67
  v_mfma_f32_32x32x16_bf16 v[80:95], v[28:31], a[60:63], v[80:95]
  v_cvt_pk_bf16_f32 v98, v68, v69
  v_cvt_pk_bf16_f32 v99, v70, v71
  v_mfma_f32_32x32x16_bf16 v[80:95], v[32:35], a[64:67], v[80:95]
  v_cvt_pk_bf16_f32 v100, v72, v73
  v_cvt_pk_bf16_f32 v101, v74, v75
  v_mfma_f32_32x32x16_bf16 v[80:95], v[36:39], a[68:71], v[80:95]
  v_cvt_pk_bf16_f32 v102, v76, v77
  v_cvt_pk_bf16_f32 v103, v78, v79
  v_mfma_f32_32x32x16_bf16 v[80:95], v[40:43], a[72:75], v[80:95]
  s_add_u32 s29, s30, 0
  buffer_store_dwordx4 v[96:99], v11, s[8:11], s29 offen offset:0 sc1
  v_mfma_f32_32x32x16_bf16 v[80:95], v[44:47], a[76:79], v[80:95]
  buffer_store_dwordx4 v[100:103], v11, s[8:11], s29 offen offset:256 sc1
  v_mfma_f32_32x32x16_bf16 v[80:95], v[48:51], a[80:83], v[80:95]
  v_mfma_f32_32x32x16_bf16 v[80:95], v[52:55], a[84:87], v[80:95]
  v_mfma_f32_32x32x16_bf16 v[80:95], v[56:59], a[88:91], v[80:95]
  v_mfma_f32_32x32x16_bf16 v[80:95], v[60:63], a[92:95], v[80:95]
  v_mfma_f32_32x32x16_bf16 v[64:79], v[16:19], a[96:99], 0
  v_mfma_f32_32x32x16_bf16 v[64:79], v[20:23], a[100:103], v[64:79]
  v_mfma_f32_32x32x16_bf16 v[64:79], v[24:27], a[104:107], v[64:79]
  v_cvt_pk_bf16_f32 v96, v80, v81
  v_cvt_pk_bf16_f32 v97, v82, v83
  v_mfma_f32_32x32x16_bf16 v[64:79], v[28:31], a[108:111], v[64:79]
  v_cvt_pk_bf16_f32 v98, v84, v85
  v_cvt_pk_bf16_f32 v99, v86, v87
  v_mfma_f32_32x32x16_bf16 v[64:79], v[32:35], a[112:115], v[64:79]
  v_cvt_pk_bf16_f32 v100, v88, v89
  v_cvt_pk_bf16_f32 v101, v90, v91
  v_mfma_f32_32x32x16_bf16 v[64:79], v[36:39], a[116:119], v[64:79]
  v_cvt_pk_bf16_f32 v102, v92, v93
  v_cvt_pk_bf16_f32 v103, v94, v95
  v_mfma_f32_32x32x16_bf16 v[64:79], v[40:43], a[120:123], v[64:79]
  s_add_u32 s29, s30, 2048
  buffer_store_dwordx4 v[96:99], v11, s[8:11], s29 offen offset:0 sc1
  v_mfma_f32_32x32x16_bf16 v[64:79], v[44:47], a[124:127], v[64:79]
  buffer_store_dwordx4 v[100:103], v11, s[8:11], s29 offen offset:256 sc1
  v_mfma_f32_32x32x16_bf16 v[64:79], v[48:51], a[128:131], v[64:79]
  v_mfma_f32_32x32x16_bf16 v[64:79], v[52:55], a[132:135], v[64:79]
  v_mfma_f32_32x32x16_bf16 v[64:79], v[56:59], a[136:139], v[64:79]
  v_mfma_f32_32x32x16_bf16 v[64:79], v[60:63], a[140:143], v[64:79]
  s_waitcnt vmcnt(7)
  s_barrier
  s_cmp_eq_u32 s21, 0
  s_cbranch_scc0 mp_60
  v_mov_b32 v13, s50
  s_mov_b64 s[24:25], exec
  s_mov_b64 exec, 1
  buffer_store_dword v13, v14, s[8:11], 0 offen sc1
  s_mov_b64 exec, s[24:25]
mp_60:
  v_mfma_f32_32x32x16_bf16 v[80:95], v[16:19], a[144:147], 0
  v_mfma_f32_32x32x16_bf16 v[80:95], v[20:23], a[148:151], v[80:95]
  v_mfma_f32_32x32x16_bf16 v[80:95], v[24:27], a[152:155], v[80:95]
  v_cvt_pk_bf16_f32 v96, v64, v65
  v_cvt_pk_bf16_f32 v97, v66, v67
  v_mfma_f32_32x32x16_bf16 v[80:95], v[28:31], a[156:159], v[80:95]
  v_cvt_pk_bf16_f32 v98, v68, v69
  v_cvt_pk_bf16_f32 v99, v70, v71
  v_mfma_f32_32x32x16_bf16 v[80:95], v[32:35], a[160:163], v[80:95]
  v_cvt_pk_bf16_f32 v100, v72, v73
  v_cvt_pk_bf16_f32 v101, v74, v75
  v_mfma_f32_32x32x16_bf16 v[80:95], v[36:39], a[164:167], v[80:95]
  v_cvt_pk_bf16_f32 v102, v76, v77
  v_cvt_pk_bf16_f32 v103, v78, v79
  v_mfma_f32_32x32x16_bf16 v[80:95], v[40:43], a[168:171], v[80:95]
  s_add_u32 s29, s30, 4096
  buffer_store_dwordx4 v[96:99], v11, s[8:11], s29 offen offset:0 sc1
  v_mfma_f32_32x32x16_bf16 v[80:95], v[44:47], a[172:175], v[80:95]
  buffer_store_dwordx4 v[100:103], v11, s[8:11], s29 offen offset:256 sc1
  v_mfma_f32_32x32x16_bf16 v[80:95], v[48:51], a[176:179], v[80:95]
  v_mfma_f32_32x32x16_bf16 v[80:95], v[52:55], a[180:183], v[80:95]
  v_mfma_f32_32x32x16_bf16 v[80:95], v[56:59], a[184:187], v[80:95]
  v_mfma_f32_32x32x16_bf16 v[80:95], v[60:63], a[188:191], v[80:95]
  v_mfma_f32_32x32x16_bf16 v[64:79], v[16:19], a[192:195], 0
  v_mfma_f32_32x32x16_bf16 v[64:79], v[20:23], a[196:199], v[64:79]
  v_mfma_f32_32x32x16_bf16 v[64:79], v[24:27], a[200:203], v[64:79]
  v_cvt_pk_bf16_f32 v96, v80, v81
  v_cvt_pk_bf16_f32 v97, v82, v83
  v_mfma_f32_32x32x16_bf16 v[64:79], v[28:31], a[204:207], v[64:79]
  v_cvt_pk_bf16_f32 v98, v84, v85
  v_cvt_pk_bf16_f32 v99, v86, v87
  v_mfma_f32_32x32x16_bf16 v[64:79], v[32:35], a[208:211], v[64:79]
  v_cvt_pk_bf16_f32 v100, v88, v89
  v_cvt_pk_bf16_f32 v101, v90, v91
  v_mfma_f32_32x32x16_bf16 v[64:79], v[36:39], a[212:215], v[64:79]
  v_cvt_pk_bf16_f32 v102, v92, v93
  v_cvt_pk_bf16_f32 v103, v94, v95
  v_mfma_f32_32x32x16_bf16 v[64:79], v[40:43], a[216:219], v[64:79]
  s_add_u32 s29, s30, 6144
  buffer_store_dwordx4 v[96:99], v11, s[8:11], s29 offen offset:0 sc1
  v_mfma_f32_32x32x16_bf16 v[64:79], v[44:47], a[220:223], v[64:79]
  buffer_store_dwordx4 v[100:103], v11, s[8:11], s29 offen offset:256 sc1
  v_mfma_f32_32x32x16_bf16 v[64:79], v[48:51], a[224:227], v[64:79]
  v_mfma_f32_32x32x16_bf16 v[64:79], v[52:55], a[228:231], v[64:79]
  v_mfma_f32_32x32x16_bf16 v[64:79], v[56:59], a[232:235], v[64:79]
  v_mfma_f32_32x32x16_bf16 v[64:79], v[60:63], a[236:239], v[64:79]
  s_nop 11
  v_cvt_pk_bf16_f32 v96, v64, v65
  v_cvt_pk_bf16_f32 v97, v66, v67
  v_cvt_pk_bf16_f32 v98, v68, v69
  v_cvt_pk_bf16_f32 v99, v70, v71
  v_cvt_pk_bf16_f32 v100, v72, v73
  v_cvt_pk_bf16_f32 v101, v74, v75
  v_cvt_pk_bf16_f32 v102, v76, v77
  v_cvt_pk_bf16_f32 v103, v78, v79
  s_add_u32 s29, s30, 8192
  buffer_store_dwordx4 v[96:99], v11, s[8:11], s29 offen offset:0 sc1
  buffer_store_dwordx4 v[100:103], v11, s[8:11], s29 offen offset:256 sc1
  s_cmp_eq_u32 s54, 0
  s_cbranch_scc1 udf_61
  s_cmp_gt_u32 s52, s53
  s_cbranch_scc1 ka_wp_62_ok
  s_mov_b32 s45, 0
ka_wp_62_spin:
  buffer_load_dword v2, v12, s[8:11], 0 offen sc1
  s_add_u32 s45, s45, 1
  s_waitcnt vmcnt(0)
  v_min_u32_dpp v3, v2, v2 quad_perm:[1,0,3,2] row_mask:0xf bank_mask:0xf
  s_nop 1
  v_min_u32_dpp v2, v3, v3 quad_perm:[2,3,0,1] row_mask:0xf bank_mask:0xf
  s_nop 1
  v_min_u32_dpp v3, v2, v2 row_half_mirror row_mask:0xf bank_mask:0xf
  s_nop 1
  v_min_u32_dpp v2, v3, v3 quad_perm:[0,1,2,3] row_mask:0xf bank_mask:0xf
  s_nop 0
  v_readfirstlane_b32 s52, v2
  s_cmp_gt_u32 s52, s53
  s_cbranch_scc1 ka_wp_62_ok
  s_cmp_lt_u32 s45, 400000
  s_cbranch_scc1 ka_wp_62_spin
  s_branch ka_abort
ka_wp_62_ok:
  s_lshl_b32 s29, s21, 10
  s_add_u32 m0, s29, 0
  s_add_u32 s28, s47, 0
  buffer_load_dwordx4 v6, s[8:11], s28 offen sc1 lds
  s_lshl_b32 s29, s21, 10
  s_add_u32 m0, s29, 4096
  s_add_u32 s28, s47, 4096
  buffer_load_dwordx4 v6, s[8:11], s28 offen sc1 lds
  s_lshl_b32 s29, s21, 10
  s_add_u32 m0, s29, 8192
  s_add_u32 s28, s47, 8192
  buffer_load_dwordx4 v6, s[8:11], s28 offen sc1 lds
  s_add_u32 s47, s47, 12288
udf_61:
  s_add_u32 s50, s50, 1
  s_cmp_lt_u32 s50, 64
  s_cbranch_scc1 ka_u_loop
  s_waitcnt vmcnt(0)
  s_barrier
  s_cmp_eq_u32 s21, 0
  s_cbranch_scc0 ka_exit
  v_mov_b32 v13, 64
  s_mov_b64 exec, 1
  buffer_store_dword v13, v14, s[8:11], 0 offen sc1
  s_waitcnt vmcnt(0)
  s_branch ka_exit
kaf_x:
  s_mov_b32 s12, s36
  s_and_b32 s13, s37, 0xffff
  s_mov_b32 s14, 0x780000
  s_mov_b32 s15, 0x20000
  s_mov_b32 s16, s38
  s_and_b32 s17, s39, 0xffff
  s_mov_b32 s18, 0x780000
  s_mov_b32 s19, 0x20000
  v_and_b32 v1, 63, v0
  v_lshrrev_b32 v2, 4, v1
  v_bfe_u32 v3, v1, 3, 1
  v_bfe_u32 v4, v1, 1, 2
  v_and_b32 v5, 1, v1
  s_mul_i32 s46, s23, 384
  s_lshl_b32 s28, s21, 2
  s_add_u32 s28, s28, 0
  v_add_u32 v6, s28, v2
  v_mul_u32_u24 v7, 43, v6
  v_lshrrev_b32 v7, 9, v7
  v_mul_u32_u24 v8, 12, v7
  v_sub_u32 v8, v6, v8
  v_lshrrev_b32 v9, 1, v7
  v_lshlrev_b32 v9, 4, v9
  v_and_b32 v10, 1, v7
  v_lshlrev_b32 v10, 2, v10
  v_add_u32 v9, v9, v10
  v_lshlrev_b32 v10, 3, v3
  v_add_u32 v9, v9, v10
  v_add_u32 v9, v9, v4
  v_mul_u32_u24 v9, 12288, v9
  v_lshrrev_b32 v10, 1, v8
  v_lshlrev_b32 v10, 2, v10
  v_lshlrev_b32 v11, 1, v5
  v_add_u32 v10, v10, v11
  v_and_b32 v11, 1, v8
  v_add_u32 v10, v10, v11
  v_lshlrev_b32 v10, 4, v10
  v_add_u32 v9, v9, v10
  v_add_u32 v136, s46, v9
  s_lshl_b32 s28, s21, 2
  s_add_u32 s28, s28, 16
  v_add_u32 v6, s28, v2
  v_mul_u32_u24 v7, 43, v6
  v_lshrrev_b32 v7, 9, v7
  v_mul_u32_u24 v8, 12, v7
  v_sub_u32 v8, v6, v8
  v_lshrrev_b32 v9, 1, v7
  v_lshlrev_b32 v9, 4, v9
  v_and_b32 v10, 1, v7
  v_lshlrev_b32 v10, 2, v10
  v_add_u32 v9, v9, v10
  v_lshlrev_b32 v10, 3, v3
  v_add_u32 v9, v9, v10
  v_add_u32 v9, v9, v4
  v_mul_u32_u24 v9, 12288, v9
  v_lshrrev_b32 v10, 1, v8
  v_lshlrev_b32 v10, 2, v10
  v_lshlrev_b32 v11, 1, v5
  v_add_u32 v10, v10, v11
  v_and_b32 v11, 1, v8
  v_add_u32 v10, v10, v11
  v_lshlrev_b32 v10, 4, v10
  v_add_u32 v9, v9, v10
  v_add_u32 v137, s46, v9
  s_lshl_b32 s28, s21, 2
  s_add_u32 s28, s28, 32
  v_add_u32 v6, s28, v2
  v_mul_u32_u24 v7, 43, v6
  v_lshrrev_b32 v7, 9, v7
  v_mul_u32_u24 v8, 12, v7
  v_sub_u32 v8, v6, v8
  v_lshrrev_b32 v9, 1, v7
  v_lshlrev_b32 v9, 4, v9
  v_and_b32 v10, 1, v7
  v_lshlrev_b32 v10, 2, v10
  v_add_u32 v9, v9, v10
  v_lshlrev_b32 v10, 3, v3
  v_add_u32 v9, v9, v10
  v_add_u32 v9, v9, v4
  v_mul_u32_u24 v9, 12288, v9
  v_lshrrev_b32 v10, 1, v8
  v_lshlrev_b32 v10, 2, v10
  v_lshlrev_b32 v11, 1, v5
  v_add_u32 v10, v10, v11
  v_and_b32 v11, 1, v8
  v_add_u32 v10, v10, v11
  v_lshlrev_b32 v10, 4, v10
  v_add_u32 v9, v9, v10
  v_add_u32 v138, s46, v9
  s_lshl_b32 s28, s21, 2
  s_add_u32 s28, s28, 48
  v_add_u32 v6, s28, v2
  v_mul_u32_u24 v7, 43, v6
  v_lshrrev_b32 v7, 9, v7
  v_mul_u32_u24 v8, 12, v7
  v_sub_u32 v8, v6, v8
  v_lshrrev_b32 v9, 1, v7
  v_lshlrev_b32 v9, 4, v9
  v_and_b32 v10, 1, v7
  v_lshlrev_b32 v10, 2, v10
  v_add_u32 v9, v9, v10
  v_lshlrev_b32 v10, 3, v3
  v_add_u32 v9, v9, v10
  v_add_u32 v9, v9, v4
  v_mul_u32_u24 v9, 12288, v9
  v_lshrrev_b32 v10, 1, v8
  v_lshlrev_b32 v10, 2, v10
  v_lshlrev_b32 v11, 1, v5
  v_add_u32 v10, v10, v11
  v_and_b32 v11, 1, v8
  v_add_u32 v10, v10, v11
  v_lshlrev_b32 v10, 4, v10
  v_add_u32 v9, v9, v10
  v_add_u32 v139, s46, v9
  s_lshl_b32 s28, s21, 2
  s_add_u32 s28, s28, 64
  v_add_u32 v6, s28, v2
  v_mul_u32_u24 v7, 43, v6
  v_lshrrev_b32 v7, 9, v7
  v_mul_u32_u24 v8, 12, v7
  v_sub_u32 v8, v6, v8
  v_lshrrev_b32 v9, 1, v7
  v_lshlrev_b32 v9, 4, v9
  v_and_b32 v10, 1, v7
  v_lshlrev_b32 v10, 2, v10
  v_add_u32 v9, v9, v10
  v_lshlrev_b32 v10, 3, v3
  v_add_u32 v9, v9, v10
  v_add_u32 v9, v9, v4
  v_mul_u32_u24 v9, 12288, v9
  v_lshrrev_b32 v10, 1, v8
  v_lshlrev_b32 v10, 2, v10
  v_lshlrev_b32 v11, 1, v5
  v_add_u32 v10, v10, v11
  v_and_b32 v11, 1, v8
  v_add_u32 v10, v10, v11
  v_lshlrev_b32 v10, 4, v10
  v_add_u32 v9, v9, v10
  v_add_u32 v140, s46, v9
  s_lshl_b32 s28, s21, 2
  s_add_u32 s28, s28, 80
  v_add_u32 v6, s28, v2
  v_mul_u32_u24 v7, 43, v6
  v_lshrrev_b32 v7, 9, v7
  v_mul_u32_u24 v8, 12, v7
  v_sub_u32 v8, v6, v8
  v_lshrrev_b32 v9, 1, v7
  v_lshlrev_b32 v9, 4, v9
  v_and_b32 v10, 1, v7
  v_lshlrev_b32 v10, 2, v10
  v_add_u32 v9, v9, v10
  v_lshlrev_b32 v10, 3, v3
  v_add_u32 v9, v9, v10
  v_add_u32 v9, v9, v4
  v_mul_u32_u24 v9, 12288, v9
  v_lshrrev_b32 v10, 1, v8
  v_lshlrev_b32 v10, 2, v10
  v_lshlrev_b32 v11, 1, v5
  v_add_u32 v10, v10, v11
  v_and_b32 v11, 1, v8
  v_add_u32 v10, v10, v11
  v_lshlrev_b32 v10, 4, v10
  v_add_u32 v9, v9, v10
  v_add_u32 v141, s46, v9
  v_lshrrev_b32 v6, 1, v2
  v_mul_u32_u24 v142, 6144, v6
  v_and_b32 v6, 1, v2
  v_lshlrev_b32 v6, 7, v6
  v_add_u32 v142, v142, v6
  v_bfe_u32 v6, v1, 2, 2
  v_lshlrev_b32 v6, 5, v6
  v_add_u32 v142, v142, v6
  v_and_b32 v6, 1, v1
  v_lshlrev_b32 v6, 4, v6
  v_add_u32 v142, v142, v6
  v_bfe_u32 v6, v1, 1, 1
  v_lshlrev_b32 v6, 3, v6
  v_add_u32 v142, v142, v6
  s_mul_i32 s28, s21, 768
  v_add_u32 v142, s28, v142
  s_lshl_b32 s29, s21, 10
  s_add_u32 m0, s29, 0
  s_mov_b32 s28, 0
  buffer_load_dwordx4 v136, s[12:15], s28 offen lds
  s_lshl_b32 s29, s21, 10
  s_add_u32 m0, s29, 4096
  s_mov_b32 s28, 0
  buffer_load_dwordx4 v137, s[12:15], s28 offen lds
  s_lshl_b32 s29, s21, 10
  s_add_u32 m0, s29, 8192
  s_mov_b32 s28, 0
  buffer_load_dwordx4 v138, s[12:15], s28 offen lds
  s_lshl_b32 s29, s21, 10
  s_add_u32 m0, s29, 12288
  s_mov_b32 s28, 0
  buffer_load_dwordx4 v139, s[12:15], s28 offen lds
  s_lshl_b32 s29, s21, 10
  s_add_u32 m0, s29, 16384
  s_mov_b32 s28, 0
  buffer_load_dwordx4 v140, s[12:15], s28 offen lds
  s_lshl_b32 s29, s21, 10
  s_add_u32 m0, s29, 20480
  s_mov_b32 s28, 0
  buffer_load_dwordx4 v141, s[12:15], s28 offen lds
  s_lshl_b32 s29, s21, 10
  s_add_u32 m0, s29, 24576
  s_mov_b32 s28, 786432
  buffer_load_dwordx4 v136, s[12:15], s28 offen lds
  s_lshl_b32 s29, s21, 10
  s_add_u32 m0, s29, 28672
  s_mov_b32 s28, 786432
  buffer_load_dwordx4 v137, s[12:15], s28 offen lds
  s_lshl_b32 s29, s21, 10
  s_add_u32 m0, s29, 32768
  s_mov_b32 s28, 786432
  buffer_load_dwordx4 v138, s[12:15], s28 offen lds
  s_lshl_b32 s29, s21, 10
  s_add_u32 m0, s29, 36864
  s_mov_b32 s28, 786432
  buffer_load_dwordx4 v139, s[12:15], s28 offen lds
  s_lshl_b32 s29, s21, 10
  s_add_u32 m0, s29, 40960
  s_mov_b32 s28, 786432
  buffer_load_dwordx4 v140, s[12:15], s28 offen lds
  s_lshl_b32 s29, s21, 10
  s_add_u32 m0, s29, 45056
  s_mov_b32 s28, 786432
  buffer_load_dwordx4 v141, s[12:15], s28 offen lds
  s_lshl_b32 s29, s21, 10
  s_add_u32 m0, s29, 49152
  s_mov_b32 s28, 1572864
  buffer_load_dwordx4 v136, s[12:15], s28 offen lds
  s_lshl_b32 s29, s21, 10
  s_add_u32 m0, s29, 53248
  s_mov_b32 s28, 1572864
  buffer_load_dwordx4 v137, s[12:15], s28 offen lds
  s_lshl_b32 s29, s21, 10
  s_add_u32 m0, s29, 57344
  s_mov_b32 s28, 1572864
  buffer_load_dwordx4 v138, s[12:15], s28 offen lds
  s_lshl_b32 s29, s21, 10
  s_add_u32 m0, s29, 61440
  s_mov_b32 s28, 1572864
  buffer_load_dwordx4 v139, s[12:15], s28 offen lds
  s_lshl_b32 s29, s21, 10
  s_add_u32 m0, s29, 65536
  s_mov_b32 s28, 1572864
  buffer_load_dwordx4 v140, s[12:15], s28 offen lds
  s_lshl_b32 s29, s21, 10
  s_add_u32 m0, s29, 69632
  s_mov_b32 s28, 1572864
  buffer_load_dwordx4 v141, s[12:15], s28 offen lds
  s_lshl_b32 s29, s21, 10
  s_add_u32 m0, s29, 73728
  s_mov_b32 s28, 2359296
  buffer_load_dwordx4 v136, s[12:15], s28 offen lds
  s_lshl_b32 s29, s21, 10
  s_add_u32 m0, s29, 77824
  s_mov_b32 s28, 2359296
  buffer_load_dwordx4 v137, s[12:15], s28 offen lds
  s_lshl_b32 s29, s21, 10
  s_add_u32 m0, s29, 81920
  s_mov_b32 s28, 2359296
  buffer_load_dwordx4 v138, s[12:15], s28 offen lds
  s_lshl_b32 s29, s21, 10
  s_add_u32 m0, s29, 86016
  s_mov_b32 s28, 2359296
  buffer_load_dwordx4 v139, s[12:15], s28 offen lds
  s_lshl_b32 s29, s21, 10
  s_add_u32 m0, s29, 90112
  s_mov_b32 s28, 2359296
  buffer_load_dwordx4 v140, s[12:15], s28 offen lds
  s_lshl_b32 s29, s21, 10
  s_add_u32 m0, s29, 94208
  s_mov_b32 s28, 2359296
  buffer_load_dwordx4 v141, s[12:15], s28 offen lds
  s_lshl_b32 s29, s21, 10
  s_add_u32 m0, s29, 98304
  s_mov_b32 s28, 3145728
  buffer_load_dwordx4 v136, s[12:15], s28 offen lds
  s_lshl_b32 s29, s21, 10
  s_add_u32 m0, s29, 102400
  s_mov_b32 s28, 3145728
  buffer_load_dwordx4 v137, s[12:15], s28 offen lds
  s_lshl_b32 s29, s21, 10
  s_add_u32 m0, s29, 106496
  s_mov_b32 s28, 3145728
  buffer_load_dwordx4 v138, s[12:15], s28 offen lds
  s_lshl_b32 s29, s21, 10
  s_add_u32 m0, s29, 110592
  s_mov_b32 s28, 3145728
  buffer_load_dwordx4 v139, s[12:15], s28 offen lds
  s_lshl_b32 s29, s21, 10
  s_add_u32 m0, s29, 114688
  s_mov_b32 s28, 3145728
  buffer_load_dwordx4 v140, s[12:15], s28 offen lds
  s_lshl_b32 s29, s21, 10
  s_add_u32 m0, s29, 118784
  s_mov_b32 s28, 3145728
  buffer_load_dwordx4 v141, s[12:15], s28 offen lds
  s_waitcnt vmcnt(24)
  s_barrier
  s_lshl_b32 s29, s21, 10
  s_add_u32 m0, s29, 122880
  s_mov_b32 s28, 3932160
  buffer_load_dwordx4 v136, s[12:15], s28 offen lds
  s_lshl_b32 s29, s21, 10
  s_add_u32 m0, s29, 126976
  s_mov_b32 s28, 3932160
  buffer_load_dwordx4 v137, s[12:15], s28 offen lds
  s_lshl_b32 s29, s21, 10
  s_add_u32 m0, s29, 131072
  s_mov_b32 s28, 3932160
  buffer_load_dwordx4 v138, s[12:15], s28 offen lds
  s_lshl_b32 s29, s21, 10
  s_add_u32 m0, s29, 135168
  s_mov_b32 s28, 3932160
  buffer_load_dwordx4 v139, s[12:15], s28 offen lds
  s_lshl_b32 s29, s21, 10
  s_add_u32 m0, s29, 139264
  s_mov_b32 s28, 3932160
  buffer_load_dwordx4 v140, s[12:15], s28 offen lds
  s_lshl_b32 s29, s21, 10
  s_add_u32 m0, s29, 143360
  s_mov_b32 s28, 3932160
  buffer_load_dwordx4 v141, s[12:15], s28 offen lds
  v_add_u32 v143, 0, v142
  ds_read_b64_tr_b16 a[0:1], v143 offset:0
  ds_read_b64_tr_b16 a[2:3], v143 offset:3072
  ds_read_b64_tr_b16 a[4:5], v143 offset:12288
  ds_read_b64_tr_b16 a[6:7], v143 offset:15360
  ds_read_b64_tr_b16 a[80:81], v143 offset:256
  ds_read_b64_tr_b16 a[82:83], v143 offset:3328
  ds_read_b64_tr_b16 a[84:85], v143 offset:12544
  ds_read_b64_tr_b16 a[86:87], v143 offset:15616
  ds_read_b64_tr_b16 a[160:161], v143 offset:512
  ds_read_b64_tr_b16 a[162:163], v143 offset:3584
  ds_read_b64_tr_b16 a[164:165], v143 offset:12800
  ds_read_b64_tr_b16 a[166:167], v143 offset:15872
  s_waitcnt lgkmcnt(0)
  s_waitcnt vmcnt(24)
  s_barrier
  s_lshl_b32 s29, s21, 10
  s_add_u32 m0, s29, 0
  s_mov_b32 s28, 4718592
  buffer_load_dwordx4 v136, s[12:15], s28 offen lds
  s_lshl_b32 s29, s21, 10
  s_add_u32 m0, s29, 4096
  s_mov_b32 s28, 4718592
  buffer_load_dwordx4 v137, s[12:15], s28 offen lds
  s_lshl_b32 s29, s21, 10
  s_add_u32 m0, s29, 8192
  s_mov_b32 s28, 4718592
  buffer_load_dwordx4 v138, s[12:15], s28 offen lds
  s_lshl_b32 s29, s21, 10
  s_add_u32 m0, s29, 12288
  s_mov_b32 s28, 4718592
  buffer_load_dwordx4 v139, s[12:15], s28 offen lds
  s_lshl_b32 s29, s21, 10
  s_add_u32 m0, s29, 16384
  s_mov_b32 s28, 4718592
  buffer_load_dwordx4 v140, s[12:15], s28 offen lds
  s_lshl_b32 s29, s21, 10
  s_add_u32 m0, s29, 20480
  s_mov_b32 s28, 4718592
  buffer_load_dwordx4 v141, s[12:15], s28 offen lds
  v_add_u32 v143, 24576, v142
  ds_read_b64_tr_b16 a[8:9], v143 offset:0
  ds_read_b64_tr_b16 a[10:11], v143 offset:3072
  ds_read_b64_tr_b16 a[12:13], v143 offset:12288
  ds_read_b64_tr_b16 a[14:15], v143 offset:15360
  ds_read_b64_tr_b16 a[88:89], v143 offset:256
  ds_read_b64_tr_b16 a[90:91], v143 offset:3328
  ds_read_b64_tr_b16 a[92:93], v143 offset:12544
  ds_read_b64_tr_b16 a[94:95], v143 offset:15616
  ds_read_b64_tr_b16 a[168:169], v143 offset:512
  ds_read_b64_tr_b16 a[170:171], v143 offset:3584
  ds_read_b64_tr_b16 a[172:173], v143 offset:12800
  ds_read_b64_tr_b16 a[174:175], v143 offset:15872
  s_waitcnt lgkmcnt(0)
  s_waitcnt vmcnt(24)
  s_barrier
  s_lshl_b32 s29, s21, 10
  s_add_u32 m0, s29, 24576
  s_mov_b32 s28, 5505024
  buffer_load_dwordx4 v136, s[12:15], s28 offen lds
  s_lshl_b32 s29, s21, 10
  s_add_u32 m0, s29, 28672
  s_mov_b32 s28, 5505024
  buffer_load_dwordx4 v137, s[12:15], s28 offen lds
  s_lshl_b32 s29, s21, 10
  s_add_u32 m0, s29, 32768
  s_mov_b32 s28, 5505024
  buffer_load_dwordx4 v138, s[12:15], s28 offen lds
  s_lshl_b32 s29, s21, 10
  s_add_u32 m0, s29, 36864
  s_mov_b32 s28, 5505024
  buffer_load_dwordx4 v139, s[12:15], s28 offen lds
  s_lshl_b32 s29, s21, 10
  s_add_u32 m0, s29, 40960
  s_mov_b32 s28, 5505024
  buffer_load_dwordx4 v140, s[12:15], s28 offen lds
  s_lshl_b32 s29, s21, 10
  s_add_u32 m0, s29, 45056
  s_mov_b32 s28, 5505024
  buffer_load_dwordx4 v141, s[12:15], s28 offen lds
  v_add_u32 v143, 49152, v142
  ds_read_b64_tr_b16 a[16:17], v143 offset:0
  ds_read_b64_tr_b16 a[18:19], v143 offset:3072
  ds_read_b64_tr_b16 a[20:21], v143 offset:12288
  ds_read_b64_tr_b16 a[22:23], v143 offset:15360
  ds_read_b64_tr_b16 a[96:97], v143 offset:256
  ds_read_b64_tr_b16 a[98:99], v143 offset:3328
  ds_read_b64_tr_b16 a[100:101], v143 offset:12544
  ds_read_b64_tr_b16 a[102:103], v143 offset:15616
  ds_read_b64_tr_b16 a[176:177], v143 offset:512
  ds_read_b64_tr_b16 a[178:179], v143 offset:3584
  ds_read_b64_tr_b16 a[180:181], v143 offset:12800
  ds_read_b64_tr_b16 a[182:183], v143 offset:15872
  s_waitcnt lgkmcnt(0)
  s_waitcnt vmcnt(24)
  s_barrier
  s_lshl_b32 s29, s21, 10
  s_add_u32 m0, s29, 49152
  s_mov_b32 s28, 6291456
  buffer_load_dwordx4 v136, s[12:15], s28 offen lds
  s_lshl_b32 s29, s21, 10
  s_add_u32 m0, s29, 53248
  s_mov_b32 s28, 6291456
  buffer_load_dwordx4 v137, s[12:15], s28 offen lds
  s_lshl_b32 s29, s21, 10
  s_add_u32 m0, s29, 57344
  s_mov_b32 s28, 6291456
  buffer_load_dwordx4 v138, s[12:15], s28 offen lds
  s_lshl_b32 s29, s21, 10
  s_add_u32 m0, s29, 61440
  s_mov_b32 s28, 6291456
  buffer_load_dwordx4 v139, s[12:15], s28 offen lds
  s_lshl_b32 s29, s21, 10
  s_add_u32 m0, s29, 65536
  s_mov_b32 s28, 6291456
  buffer_load_dwordx4 v140, s[12:15], s28 offen lds
  s_lshl_b32 s29, s21, 10
  s_add_u32 m0, s29, 69632
  s_mov_b32 s28, 6291456
  buffer_load_dwordx4 v141, s[12:15], s28 offen lds
  v_add_u32 v143, 73728, v142
  ds_read_b64_tr_b16 a[24:25], v143 offset:0
  ds_read_b64_tr_b16 a[26:27], v143 offset:3072
  ds_read_b64_tr_b16 a[28:29], v143 offset:12288
  ds_read_b64_tr_b16 a[30:31], v143 offset:15360
  ds_read_b64_tr_b16 a[104:105], v143 offset:256
  ds_read_b64_tr_b16 a[106:107], v143 offset:3328
  ds_read_b64_tr_b16 a[108:109], v143 offset:12544
  ds_read_b64_tr_b16 a[110:111], v143 offset:15616
  ds_read_b64_tr_b16 a[184:185], v143 offset:512
  ds_read_b64_tr_b16 a[186:187], v143 offset:3584
  ds_read_b64_tr_b16 a[188:189], v143 offset:12800
  ds_read_b64_tr_b16 a[190:191], v143 offset:15872
  s_waitcnt lgkmcnt(0)
  s_waitcnt vmcnt(24)
  s_barrier
  s_lshl_b32 s29, s21, 10
  s_add_u32 m0, s29, 73728
  s_mov_b32 s28, 7077888
  buffer_load_dwordx4 v136, s[12:15], s28 offen lds
  s_lshl_b32 s29, s21, 10
  s_add_u32 m0, s29, 77824
  s_mov_b32 s28, 7077888
  buffer_load_dwordx4 v137, s[12:15], s28 offen lds
  s_lshl_b32 s29, s21, 10
  s_add_u32 m0, s29, 81920
  s_mov_b32 s28, 7077888
  buffer_load_dwordx4 v138, s[12:15], s28 offen lds
  s_lshl_b32 s29, s21, 10
  s_add_u32 m0, s29, 86016
  s_mov_b32 s28, 7077888
  buffer_load_dwordx4 v139, s[12:15], s28 offen lds
  s_lshl_b32 s29, s21, 10
  s_add_u32 m0, s29, 90112
  s_mov_b32 s28, 7077888
  buffer_load_dwordx4 v140, s[12:15], s28 offen lds
  s_lshl_b32 s29, s21, 10
  s_add_u32 m0, s29, 94208
  s_mov_b32 s28, 7077888
  buffer_load_dwordx4 v141, s[12:15], s28 offen lds
  v_add_u32 v143, 98304, v142
  ds_read_b64_tr_b16 a[32:33], v143 offset:0
  ds_read_b64_tr_b16 a[34:35], v143 offset:3072
  ds_read_b64_tr_b16 a[36:37], v143 offset:12288
  ds_read_b64_tr_b16 a[38:39], v143 offset:15360
  ds_read_b64_tr_b16 a[112:113], v143 offset:256
  ds_read_b64_tr_b16 a[114:115], v143 offset:3328
  ds_read_b64_tr_b16 a[116:117], v143 offset:12544
  ds_read_b64_tr_b16 a[118:119], v143 offset:15616
  ds_read_b64_tr_b16 a[192:193], v143 offset:512
  ds_read_b64_tr_b16 a[194:195], v143 offset:3584
  ds_read_b64_tr_b16 a[196:197], v143 offset:12800
  ds_read_b64_tr_b16 a[198:199], v143 offset:15872
  s_waitcnt lgkmcnt(0)
  s_waitcnt vmcnt(24)
  s_barrier
  s_lshl_b32 s29, s21, 10
  s_add_u32 m0, s29, 98304
  s_mov_b32 s28, 0
  buffer_load_dwordx4 v136, s[16:19], s28 offen lds
  s_lshl_b32 s29, s21, 10
  s_add_u32 m0, s29, 102400
  s_mov_b32 s28, 0
  buffer_load_dwordx4 v137, s[16:19], s28 offen lds
  s_lshl_b32 s29, s21, 10
  s_add_u32 m0, s29, 106496
  s_mov_b32 s28, 0
  buffer_load_dwordx4 v138, s[16:19], s28 offen lds
  s_lshl_b32 s29, s21, 10
  s_add_u32 m0, s29, 110592
  s_mov_b32 s28, 0
  buffer_load_dwordx4 v139, s[16:19], s28 offen lds
  s_lshl_b32 s29, s21, 10
  s_add_u32 m0, s29, 114688
  s_mov_b32 s28, 0
  buffer_load_dwordx4 v140, s[16:19], s28 offen lds
  s_lshl_b32 s29, s21, 10
  s_add_u32 m0, s29, 118784
  s_mov_b32 s28, 0
  buffer_load_dwordx4 v141, s[16:19], s28 offen lds
  v_add_u32 v143, 122880, v142
  ds_read_b64_tr_b16 a[40:41], v143 offset:0
  ds_read_b64_tr_b16 a[42:43], v143 offset:3072
  ds_read_b64_tr_b16 a[44:45], v143 offset:12288
  ds_read_b64_tr_b16 a[46:47], v143 offset:15360
  ds_read_b64_tr_b16 a[120:121], v143 offset:256
  ds_read_b64_tr_b16 a[122:123], v143 offset:3328
  ds_read_b64_tr_b16 a[124:125], v143 offset:12544
  ds_read_b64_tr_b16 a[126:127], v143 offset:15616
  ds_read_b64_tr_b16 a[200:201], v143 offset:512
  ds_read_b64_tr_b16 a[202:203], v143 offset:3584
  ds_read_b64_tr_b16 a[204:205], v143 offset:12800
  ds_read_b64_tr_b16 a[206:207], v143 offset:15872
  s_waitcnt lgkmcnt(0)
  s_waitcnt vmcnt(24)
  s_barrier
  s_lshl_b32 s29, s21, 10
  s_add_u32 m0, s29, 122880
  s_mov_b32 s28, 1572864
  buffer_load_dwordx4 v136, s[16:19], s28 offen lds
  s_lshl_b32 s29, s21, 10
  s_add_u32 m0, s29, 126976
  s_mov_b32 s28, 1572864
  buffer_load_dwordx4 v137, s[16:19], s28 offen lds
  s_lshl_b32 s29, s21, 10
  s_add_u32 m0, s29, 131072
  s_mov_b32 s28, 1572864
  buffer_load_dwordx4 v138, s[16:19], s28 offen lds
  s_lshl_b32 s29, s21, 10
  s_add_u32 m0, s29, 135168
  s_mov_b32 s28, 1572864
  buffer_load_dwordx4 v139, s[16:19], s28 offen lds
  s_lshl_b32 s29, s21, 10
  s_add_u32 m0, s29, 139264
  s_mov_b32 s28, 1572864
  buffer_load_dwordx4 v140, s[16:19], s28 offen lds
  s_lshl_b32 s29, s21, 10
  s_add_u32 m0, s29, 143360
  s_mov_b32 s28, 1572864
  buffer_load_dwordx4 v141, s[16:19], s28 offen lds
  v_add_u32 v143, 0, v142
  ds_read_b64_tr_b16 a[48:49], v143 offset:0
  ds_read_b64_tr_b16 a[50:51], v143 offset:3072
  ds_read_b64_tr_b16 a[52:53], v143 offset:12288
  ds_read_b64_tr_b16 a[54:55], v143 offset:15360
  ds_read_b64_tr_b16 a[128:129], v143 offset:256
  ds_read_b64_tr_b16 a[130:131], v143 offset:3328
  ds_read_b64_tr_b16 a[132:133], v143 offset:12544
  ds_read_b64_tr_b16 a[134:135], v143 offset:15616
  ds_read_b64_tr_b16 a[208:209], v143 offset:512
  ds_read_b64_tr_b16 a[210:211], v143 offset:3584
  ds_read_b64_tr_b16 a[212:213], v143 offset:12800
  ds_read_b64_tr_b16 a[214:215], v143 offset:15872
  s_waitcnt lgkmcnt(0)
  s_waitcnt vmcnt(24)
  s_barrier
  s_lshl_b32 s29, s21, 10
  s_add_u32 m0, s29, 0
  s_mov_b32 s28, 3145728
  buffer_load_dwordx4 v136, s[16:19], s28 offen lds
  s_lshl_b32 s29, s21, 10
  s_add_u32 m0, s29, 4096
  s_mov_b32 s28, 3145728
  buffer_load_dwordx4 v137, s[16:19], s28 offen lds
  s_lshl_b32 s29, s21, 10
  s_add_u32 m0, s29, 8192
  s_mov_b32 s28, 3145728
  buffer_load_dwordx4 v138, s[16:19], s28 offen lds
  s_lshl_b32 s29, s21, 10
  s_add_u32 m0, s29, 12288
  s_mov_b32 s28, 3145728
  buffer_load_dwordx4 v139, s[16:19], s28 offen lds
  s_lshl_b32 s29, s21, 10
  s_add_u32 m0, s29, 16384
  s_mov_b32 s28, 3145728
  buffer_load_dwordx4 v140, s[16:19], s28 offen lds
  s_lshl_b32 s29, s21, 10
  s_add_u32 m0, s29, 20480
  s_mov_b32 s28, 3145728
  buffer_load_dwordx4 v141, s[16:19], s28 offen lds
  v_add_u32 v143, 24576, v142
  ds_read_b64_tr_b16 a[56:57], v143 offset:0
  ds_read_b64_tr_b16 a[58:59], v143 offset:3072
  ds_read_b64_tr_b16 a[60:61], v143 offset:12288
  ds_read_b64_tr_b16 a[62:63], v143 offset:15360
  ds_read_b64_tr_b16 a[136:137], v143 offset:256
  ds_read_b64_tr_b16 a[138:139], v143 offset:3328
  ds_read_b64_tr_b16 a[140:141], v143 offset:12544
  ds_read_b64_tr_b16 a[142:143], v143 offset:15616
  ds_read_b64_tr_b16 a[216:217], v143 offset:512
  ds_read_b64_tr_b16 a[218:219], v143 offset:3584
  ds_read_b64_tr_b16 a[220:221], v143 offset:12800
  ds_read_b64_tr_b16 a[222:223], v143 offset:15872
  s_waitcnt lgkmcnt(0)
  s_waitcnt vmcnt(24)
  s_barrier
  s_lshl_b32 s29, s21, 10
  s_add_u32 m0, s29, 24576
  s_mov_b32 s28, 4718592
  buffer_load_dwordx4 v136, s[16:19], s28 offen lds
  s_lshl_b32 s29, s21, 10
  s_add_u32 m0, s29, 28672
  s_mov_b32 s28, 4718592
  buffer_load_dwordx4 v137, s[16:19], s28 offen lds
  s_lshl_b32 s29, s21, 10
  s_add_u32 m0, s29, 32768
  s_mov_b32 s28, 4718592
  buffer_load_dwordx4 v138, s[16:19], s28 offen lds
  s_lshl_b32 s29, s21, 10
  s_add_u32 m0, s29, 36864
  s_mov_b32 s28, 4718592
  buffer_load_dwordx4 v139, s[16:19], s28 offen lds
  s_lshl_b32 s29, s21, 10
  s_add_u32 m0, s29, 40960
  s_mov_b32 s28, 4718592
  buffer_load_dwordx4 v140, s[16:19], s28 offen lds
  s_lshl_b32 s29, s21, 10
  s_add_u32 m0, s29, 45056
  s_mov_b32 s28, 4718592
  buffer_load_dwordx4 v141, s[16:19], s28 offen lds
  v_add_u32 v143, 49152, v142
  ds_read_b64_tr_b16 a[64:65], v143 offset:0
  ds_read_b64_tr_b16 a[66:67], v143 offset:3072
  ds_read_b64_tr_b16 a[68:69], v143 offset:12288
  ds_read_b64_tr_b16 a[70:71], v143 offset:15360
  ds_read_b64_tr_b16 a[144:145], v143 offset:256
  ds_read_b64_tr_b16 a[146:147], v143 offset:3328
  ds_read_b64_tr_b16 a[148:149], v143 offset:12544
  ds_read_b64_tr_b16 a[150:151], v143 offset:15616
  ds_read_b64_tr_b16 a[224:225], v143 offset:512
  ds_read_b64_tr_b16 a[226:227], v143 offset:3584
  ds_read_b64_tr_b16 a[228:229], v143 offset:12800
  ds_read_b64_tr_b16 a[230:231], v143 offset:15872
  s_waitcnt lgkmcnt(0)
  s_waitcnt vmcnt(24)
  s_barrier
  s_lshl_b32 s29, s21, 10
  s_add_u32 m0, s29, 49152
  s_mov_b32 s28, 6291456
  buffer_load_dwordx4 v136, s[16:19], s28 offen lds
  s_lshl_b32 s29, s21, 10
  s_add_u32 m0, s29, 53248
  s_mov_b32 s28, 6291456
  buffer_load_dwordx4 v137, s[16:19], s28 offen lds
  s_lshl_b32 s29, s21, 10
  s_add_u32 m0, s29, 57344
  s_mov_b32 s28, 6291456
  buffer_load_dwordx4 v138, s[16:19], s28 offen lds
  s_lshl_b32 s29, s21, 10
  s_add_u32 m0, s29, 61440
  s_mov_b32 s28, 6291456
  buffer_load_dwordx4 v139, s[16:19], s28 offen lds
  s_lshl_b32 s29, s21, 10
  s_add_u32 m0, s29, 65536
  s_mov_b32 s28, 6291456
  buffer_load_dwordx4 v140, s[16:19], s28 offen lds
  s_lshl_b32 s29, s21, 10
  s_add_u32 m0, s29, 69632
  s_mov_b32 s28, 6291456
  buffer_load_dwordx4 v141, s[16:19], s28 offen lds
  v_add_u32 v143, 73728, v142
  ds_read_b64_tr_b16 a[72:73], v143 offset:0
  ds_read_b64_tr_b16 a[74:75], v143 offset:3072
  ds_read_b64_tr_b16 a[76:77], v143 offset:12288
  ds_read_b64_tr_b16 a[78:79], v143 offset:15360
  ds_read_b64_tr_b16 a[152:153], v143 offset:256
  ds_read_b64_tr_b16 a[154:155], v143 offset:3328
  ds_read_b64_tr_b16 a[156:157], v143 offset:12544
  ds_read_b64_tr_b16 a[158:159], v143 offset:15616
  ds_read_b64_tr_b16 a[232:233], v143 offset:512
  ds_read_b64_tr_b16 a[234:235], v143 offset:3584
  ds_read_b64_tr_b16 a[236:237], v143 offset:12800
  ds_read_b64_tr_b16 a[238:239], v143 offset:15872
  s_waitcnt lgkmcnt(0)
  s_waitcnt vmcnt(24)
  s_barrier
  s_lshl_b32 s29, s21, 10
  s_add_u32 m0, s29, 73728
  s_mov_b32 s28, 786432
  buffer_load_dwordx4 v136, s[16:19], s28 offen lds
  s_lshl_b32 s29, s21, 10
  s_add_u32 m0, s29, 77824
  s_mov_b32 s28, 786432
  buffer_load_dwordx4 v137, s[16:19], s28 offen lds
  s_lshl_b32 s29, s21, 10
  s_add_u32 m0, s29, 81920
  s_mov_b32 s28, 786432
  buffer_load_dwordx4 v138, s[16:19], s28 offen lds
  s_lshl_b32 s29, s21, 10
  s_add_u32 m0, s29, 86016
  s_mov_b32 s28, 786432
  buffer_load_dwordx4 v139, s[16:19], s28 offen lds
  s_lshl_b32 s29, s21, 10
  s_add_u32 m0, s29, 90112
  s_mov_b32 s28, 786432
  buffer_load_dwordx4 v140, s[16:19], s28 offen lds
  s_lshl_b32 s29, s21, 10
  s_add_u32 m0, s29, 94208
  s_mov_b32 s28, 786432
  buffer_load_dwordx4 v141, s[16:19], s28 offen lds
  v_add_u32 v143, 98304, v142
  ds_read_b64_tr_b16 a[240:241], v143 offset:0
  ds_read_b64_tr_b16 a[242:243], v143 offset:3072
  ds_read_b64_tr_b16 a[244:245], v143 offset:12288
  ds_read_b64_tr_b16 a[246:247], v143 offset:15360
  ds_read_b64_tr_b16 v[176:177], v143 offset:256
  ds_read_b64_tr_b16 v[178:179], v143 offset:3328
  ds_read_b64_tr_b16 v[180:181], v143 offset:12544
  ds_read_b64_tr_b16 v[182:183], v143 offset:15616
  ds_read_b64_tr_b16 v[216:217], v143 offset:512
  ds_read_b64_tr_b16 v[218:219], v143 offset:3584
  ds_read_b64_tr_b16 v[220:221], v143 offset:12800
  ds_read_b64_tr_b16 v[222:223], v143 offset:15872
  s_waitcnt lgkmcnt(0)
  s_waitcnt vmcnt(24)
  s_barrier
  s_lshl_b32 s29, s21, 10
  s_add_u32 m0, s29, 98304
  s_mov_b32 s28, 2359296
  buffer_load_dwordx4 v136, s[16:19], s28 offen lds
  s_lshl_b32 s29, s21, 10
  s_add_u32 m0, s29, 102400
  s_mov_b32 s28, 2359296
  buffer_load_dwordx4 v137, s[16:19], s28 offen lds
  s_lshl_b32 s29, s21, 10
  s_add_u32 m0, s29, 106496
  s_mov_b32 s28, 2359296
  buffer_load_dwordx4 v138, s[16:19], s28 offen lds
  s_lshl_b32 s29, s21, 10
  s_add_u32 m0, s29, 110592
  s_mov_b32 s28, 2359296
  buffer_load_dwordx4 v139, s[16:19], s28 offen lds
  s_lshl_b32 s29, s21, 10
  s_add_u32 m0, s29, 114688
  s_mov_b32 s28, 2359296
  buffer_load_dwordx4 v140, s[16:19], s28 offen lds
  s_lshl_b32 s29, s21, 10
  s_add_u32 m0, s29, 118784
  s_mov_b32 s28, 2359296
  buffer_load_dwordx4 v141, s[16:19], s28 offen lds
  v_add_u32 v143, 122880, v142
  ds_read_b64_tr_b16 a[248:249], v143 offset:0
  ds_read_b64_tr_b16 a[250:251], v143 offset:3072
  ds_read_b64_tr_b16 a[252:253], v143 offset:12288
  ds_read_b64_tr_b16 a[254:255], v143 offset:15360
  ds_read_b64_tr_b16 v[184:185], v143 offset:256
  ds_read_b64_tr_b16 v[186:187], v143 offset:3328
  ds_read_b64_tr_b16 v[188:189], v143 offset:12544
  ds_read_b64_tr_b16 v[190:191], v143 offset:15616
  ds_read_b64_tr_b16 v[224:225], v143 offset:512
  ds_read_b64_tr_b16 v[226:227], v143 offset:3584
  ds_read_b64_tr_b16 v[228:229], v143 offset:12800
  ds_read_b64_tr_b16 v[230:231], v143 offset:15872
  s_waitcnt lgkmcnt(0)
  s_waitcnt vmcnt(24)
  s_barrier
  s_lshl_b32 s29, s21, 10
  s_add_u32 m0, s29, 122880
  s_mov_b32 s28, 3932160
  buffer_load_dwordx4 v136, s[16:19], s28 offen lds
  s_lshl_b32 s29, s21, 10
  s_add_u32 m0, s29, 126976
  s_mov_b32 s28, 3932160
  buffer_load_dwordx4 v137, s[16:19], s28 offen lds
  s_lshl_b32 s29, s21, 10
  s_add_u32 m0, s29, 131072
  s_mov_b32 s28, 3932160
  buffer_load_dwordx4 v138, s[16:19], s28 offen lds
  s_lshl_b32 s29, s21, 10
  s_add_u32 m0, s29, 135168
  s_mov_b32 s28, 3932160
  buffer_load_dwordx4 v139, s[16:19], s28 offen lds
  s_lshl_b32 s29, s21, 10
  s_add_u32 m0, s29, 139264
  s_mov_b32 s28, 3932160
  buffer_load_dwordx4 v140, s[16:19], s28 offen lds
  s_lshl_b32 s29, s21, 10
  s_add_u32 m0, s29, 143360
  s_mov_b32 s28, 3932160
  buffer_load_dwordx4 v141, s[16:19], s28 offen lds
  v_add_u32 v143, 0, v142
  ds_read_b64_tr_b16 v[152:153], v143 offset:0
  ds_read_b64_tr_b16 v[154:155], v143 offset:3072
  ds_read_b64_tr_b16 v[156:157], v143 offset:12288
  ds_read_b64_tr_b16 v[158:159], v143 offset:15360
  ds_read_b64_tr_b16 v[192:193], v143 offset:256
  ds_read_b64_tr_b16 v[194:195], v143 offset:3328
  ds_read_b64_tr_b16 v[196:197], v143 offset:12544
  ds_read_b64_tr_b16 v[198:199], v143 offset:15616
  ds_read_b64_tr_b16 v[232:233], v143 offset:512
  ds_read_b64_tr_b16 v[234:235], v143 offset:3584
  ds_read_b64_tr_b16 v[236:237], v143 offset:12800
  ds_read_b64_tr_b16 v[238:239], v143 offset:15872
  s_waitcnt lgkmcnt(0)
  s_waitcnt vmcnt(24)
  s_barrier
  s_lshl_b32 s29, s21, 10
  s_add_u32 m0, s29, 0
  s_mov_b32 s28, 5505024
  buffer_load_dwordx4 v136, s[16:19], s28 offen lds
  s_lshl_b32 s29, s21, 10
  s_add_u32 m0, s29, 4096
  s_mov_b32 s28, 5505024
  buffer_load_dwordx4 v137, s[16:19], s28 offen lds
  s_lshl_b32 s29, s21, 10
  s_add_u32 m0, s29, 8192
  s_mov_b32 s28, 5505024
  buffer_load_dwordx4 v138, s[16:19], s28 offen lds
  s_lshl_b32 s29, s21, 10
  s_add_u32 m0, s29, 12288
  s_mov_b32 s28, 5505024
  buffer_load_dwordx4 v139, s[16:19], s28 offen lds
  s_lshl_b32 s29, s21, 10
  s_add_u32 m0, s29, 16384
  s_mov_b32 s28, 5505024
  buffer_load_dwordx4 v140, s[16:19], s28 offen lds
  s_lshl_b32 s29, s21, 10
  s_add_u32 m0, s29, 20480
  s_mov_b32 s28, 5505024
  buffer_load_dwordx4 v141, s[16:19], s28 offen lds
  v_add_u32 v143, 24576, v142
  ds_read_b64_tr_b16 v[160:161], v143 offset:0
  ds_read_b64_tr_b16 v[162:163], v143 offset:3072
  ds_read_b64_tr_b16 v[164:165], v143 offset:12288
  ds_read_b64_tr_b16 v[166:167], v143 offset:15360
  ds_read_b64_tr_b16 v[200:201], v143 offset:256
  ds_read_b64_tr_b16 v[202:203], v143 offset:3328
  ds_read_b64_tr_b16 v[204:205], v143 offset:12544
  ds_read_b64_tr_b16 v[206:207], v143 offset:15616
  ds_read_b64_tr_b16 v[240:241], v143 offset:512
  ds_read_b64_tr_b16 v[242:243], v143 offset:3584
  ds_read_b64_tr_b16 v[244:245], v143 offset:12800
  ds_read_b64_tr_b16 v[246:247], v143 offset:15872
  s_waitcnt lgkmcnt(0)
  s_waitcnt vmcnt(24)
  s_barrier
  s_lshl_b32 s29, s21, 10
  s_add_u32 m0, s29, 24576
  s_mov_b32 s28, 7077888
  buffer_load_dwordx4 v136, s[16:19], s28 offen lds
  s_lshl_b32 s29, s21, 10
  s_add_u32 m0, s29, 28672
  s_mov_b32 s28, 7077888
  buffer_load_dwordx4 v137, s[16:19], s28 offen lds
  s_lshl_b32 s29, s21, 10
  s_add_u32 m0, s29, 32768
  s_mov_b32 s28, 7077888
  buffer_load_dwordx4 v138, s[16:19], s28 offen lds
  s_lshl_b32 s29, s21, 10
  s_add_u32 m0, s29, 36864
  s_mov_b32 s28, 7077888
  buffer_load_dwordx4 v139, s[16:19], s28 offen lds
  s_lshl_b32 s29, s21, 10
  s_add_u32 m0, s29, 40960
  s_mov_b32 s28, 7077888
  buffer_load_dwordx4 v140, s[16:19], s28 offen lds
  s_lshl_b32 s29, s21, 10
  s_add_u32 m0, s29, 45056
  s_mov_b32 s28, 7077888
  buffer_load_dwordx4 v141, s[16:19], s28 offen lds
  v_add_u32 v143, 49152, v142
  ds_read_b64_tr_b16 v[168:169], v143 offset:0
  ds_read_b64_tr_b16 v[170:171], v143 offset:3072
  ds_read_b64_tr_b16 v[172:173], v143 offset:12288
  ds_read_b64_tr_b16 v[174:175], v143 offset:15360
  ds_read_b64_tr_b16 v[208:209], v143 offset:256
  ds_read_b64_tr_b16 v[210:211], v143 offset:3328
  ds_read_b64_tr_b16 v[212:213], v143 offset:12544
  ds_read_b64_tr_b16 v[214:215], v143 offset:15616
  ds_read_b64_tr_b16 v[248:249], v143 offset:512
  ds_read_b64_tr_b16 v[250:251], v143 offset:3584
  ds_read_b64_tr_b16 v[252:253], v143 offset:12800
  ds_read_b64_tr_b16 v[254:255], v143 offset:15872
  s_waitcnt lgkmcnt(0)
  s_waitcnt vmcnt(24)
  s_barrier
  v_add_u32 v143, 73728, v142
  ds_read_b64_tr_b16 v[16:17], v143 offset:0
  ds_read_b64_tr_b16 v[18:19], v143 offset:3072
  ds_read_b64_tr_b16 v[20:21], v143 offset:12288
  ds_read_b64_tr_b16 v[22:23], v143 offset:15360
  ds_read_b64_tr_b16 v[24:25], v143 offset:256
  ds_read_b64_tr_b16 v[26:27], v143 offset:3328
  ds_read_b64_tr_b16 v[28:29], v143 offset:12544
  ds_read_b64_tr_b16 v[30:31], v143 offset:15616
  ds_read_b64_tr_b16 v[32:33], v143 offset:512
  ds_read_b64_tr_b16 v[34:35], v143 offset:3584
  ds_read_b64_tr_b16 v[36:37], v143 offset:12800
  ds_read_b64_tr_b16 v[38:39], v143 offset:15872
  s_waitcnt lgkmcnt(0)
  s_waitcnt vmcnt(18)
  s_barrier
  v_add_u32 v143, 98304, v142
  ds_read_b64_tr_b16 v[40:41], v143 offset:0
  ds_read_b64_tr_b16 v[42:43], v143 offset:3072
  ds_read_b64_tr_b16 v[44:45], v143 offset:12288
  ds_read_b64_tr_b16 v[46:47], v143 offset:15360
  ds_read_b64_tr_b16 v[48:49], v143 offset:256
  ds_read_b64_tr_b16 v[50:51], v143 offset:3328
  ds_read_b64_tr_b16 v[52:53], v143 offset:12544
  ds_read_b64_tr_b16 v[54:55], v143 offset:15616
  ds_read_b64_tr_b16 v[56:57], v143 offset:512
  ds_read_b64_tr_b16 v[58:59], v143 offset:3584
  ds_read_b64_tr_b16 v[60:61], v143 offset:12800
  ds_read_b64_tr_b16 v[62:63], v143 offset:15872
  s_waitcnt lgkmcnt(0)
  s_waitcnt vmcnt(12)
  s_barrier
  v_add_u32 v143, 122880, v142
  ds_read_b64_tr_b16 v[64:65], v143 offset:0
  ds_read_b64_tr_b16 v[66:67], v143 offset:3072
  ds_read_b64_tr_b16 v[68:69], v143 offset:12288
  ds_read_b64_tr_b16 v[70:71], v143 offset:15360
  ds_read_b64_tr_b16 v[72:73], v143 offset:256
  ds_read_b64_tr_b16 v[74:75], v143 offset:3328
  ds_read_b64_tr_b16 v[76:77], v143 offset:12544
  ds_read_b64_tr_b16 v[78:79], v143 offset:15616
  ds_read_b64_tr_b16 v[80:81], v143 offset:512
  ds_read_b64_tr_b16 v[82:83], v143 offset:3584
  ds_read_b64_tr_b16 v[84:85], v143 offset:12800
  ds_read_b64_tr_b16 v[86:87], v143 offset:15872
  s_waitcnt lgkmcnt(0)
  s_waitcnt vmcnt(6)
  s_barrier
  v_add_u32 v143, 0, v142
  ds_read_b64_tr_b16 v[88:89], v143 offset:0
  ds_read_b64_tr_b16 v[90:91], v143 offset:3072
  ds_read_b64_tr_b16 v[92:93], v143 offset:12288
  ds_read_b64_tr_b16 v[94:95], v143 offset:15360
  ds_read_b64_tr_b16 v[96:97], v143 offset:256
  ds_read_b64_tr_b16 v[98:99], v143 offset:3328
  ds_read_b64_tr_b16 v[100:101], v143 offset:12544
  ds_read_b64_tr_b16 v[102:103], v143 offset:15616
  ds_read_b64_tr_b16 v[104:105], v143 offset:512
  ds_read_b64_tr_b16 v[106:107], v143 offset:3584
  ds_read_b64_tr_b16 v[108:109], v143 offset:12800
  ds_read_b64_tr_b16 v[110:111], v143 offset:15872
  s_waitcnt lgkmcnt(0)
  s_waitcnt vmcnt(0)
  s_barrier
  v_add_u32 v143, 24576, v142
  ds_read_b64_tr_b16 v[112:113], v143 offset:0
  ds_read_b64_tr_b16 v[114:115], v143 offset:3072
  ds_read_b64_tr_b16 v[116:117], v143 offset:12288
  ds_read_b64_tr_b16 v[118:119], v143 offset:15360
  ds_read_b64_tr_b16 v[120:121], v143 offset:256
  ds_read_b64_tr_b16 v[122:123], v143 offset:3328
  ds_read_b64_tr_b16 v[124:125], v143 offset:12544
  ds_read_b64_tr_b16 v[126:127], v143 offset:15616
  ds_read_b64_tr_b16 v[128:129], v143 offset:512
  ds_read_b64_tr_b16 v[130:131], v143 offset:3584
  ds_read_b64_tr_b16 v[132:133], v143 offset:12800
  ds_read_b64_tr_b16 v[134:135], v143 offset:15872
  s_waitcnt lgkmcnt(0)
  s_barrier
  v_lshlrev_b32 v2, 4, v1
  s_mul_i32 s28, s21, 30720
  v_add_u32 v143, s28, v2
  ds_write_b128 v143, v[16:19] offset:0
  ds_write_b128 v143, v[20:23] offset:1024
  ds_write_b128 v143, v[24:27] offset:10240
  ds_write_b128 v143, v[28:31] offset:11264
  ds_write_b128 v143, v[32:35] offset:20480
  ds_write_b128 v143, v[36:39] offset:21504
  ds_write_b128 v143, v[40:43] offset:2048
  ds_write_b128 v143, v[44:47] offset:3072
  ds_write_b128 v143, v[48:51] offset:12288
  ds_write_b128 v143, v[52:55] offset:13312
  ds_write_b128 v143, v[56:59] offset:22528
  ds_write_b128 v143, v[60:63] offset:23552
  ds_write_b128 v143, v[64:67] offset:4096
  ds_write_b128 v143, v[68:71] offset:5120
  ds_write_b128 v143, v[72:75] offset:14336
  ds_write_b128 v143, v[76:79] offset:15360
  ds_write_b128 v143, v[80:83] offset:24576
  ds_write_b128 v143, v[84:87] offset:25600
  ds_write_b128 v143, v[88:91] offset:6144
  ds_write_b128 v143, v[92:95] offset:7168
  ds_write_b128 v143, v[96:99] offset:16384
  ds_write_b128 v143, v[100:103] offset:17408
  ds_write_b128 v143, v[104:107] offset:26624
  ds_write_b128 v143, v[108:111] offset:27648
  ds_write_b128 v143, v[112:115] offset:8192
  ds_write_b128 v143, v[116:119] offset:9216
  ds_write_b128 v143, v[120:123] offset:18432
  ds_write_b128 v143, v[124:127] offset:19456
  ds_write_b128 v143, v[128:131] offset:28672
  ds_write_b128 v143, v[132:135] offset:29696
  s_waitcnt lgkmcnt(0)
  v_and_b32 v1, 63, v0
  v_lshlrev_b32 v132, 4, v1
  s_mul_i32 s28, s21, 30720
  v_add_u32 v129, s28, v132
  s_lshl_b32 s28, s21, 10
  v_add_u32 v124, s28, v132
  v_add_u32 v125, 4096, v124
  v_add_u32 v126, 8192, v124
  v_add_u32 v127, 122880, v124
  v_add_u32 v128, 122880, v132
  s_mul_i32 s28, s21, 3072
  s_add_u32 s28, s28, 133120
  v_add_u32 v130, s28, v132
  s_mul_i32 s28, s21, 1536
  s_add_u32 s28, s28, 145408
  v_lshlrev_b32 v2, 3, v1
  v_add_u32 v131, s28, v2
  v_mov_b32 v110, 0x44444444
  v_mov_b32 v2, 0xeeeeeeee
  v_and_b32 v3, 8, v1
  v_cmp_ne_u32 vcc, 0, v3
  s_nop 1
  v_cndmask_b32 v110, v110, v2, vcc
  v_and_b32 v4, 15, v1
  v_lshrrev_b32 v5, 4, v1
  v_lshlrev_b32 v6, 2, v5
  v_sub_u32 v6, v4, v6
  v_mov_b32 v7, 0x3f80
  v_mov_b32 v8, 0x3f800000
  v_mov_b32 v108, 0
  v_mov_b32 v109, 0
  v_cmp_eq_u32 vcc, 0, v6
  s_nop 1
  v_cndmask_b32 v108, v108, v7, vcc
  v_cmp_eq_u32 vcc, 1, v6
  s_nop 1
  v_cndmask_b32 v108, v108, v8, vcc
  v_cmp_eq_u32 vcc, 2, v6
  s_nop 1
  v_cndmask_b32 v109, v109, v7, vcc
  v_cmp_eq_u32 vcc, 3, v6
  s_nop 1
  v_cndmask_b32 v109, v109, v8, vcc
  s_mul_i32 s28, s23, 6
  s_lshr_b32 s29, s28, 3
  s_add_u32 s28, s28, 5
  s_lshr_b32 s28, s28, 3
  v_mov_b32 v6, s29
  v_mov_b32 v7, s28
  v_and_b32 v8, 1, v1
  v_cmp_eq_u32 vcc, 1, v8
  s_nop 1
  v_cndmask_b32 v6, v6, v7, vcc
  v_lshlrev_b32 v6, 2, v6
  v_bfe_u32 v8, v1, 1, 1
  v_lshlrev_b32 v8, 10, v8
  v_add_u32 v6, v6, v8
  v_add_u32 v138, 0, v6
  s_mul_i32 s97, s20, 655360
  s_add_u32 s97, s97, 0x400000
  s_mov_b32 s48, 0x4000
  s_mul_i32 s49, s20, 327680
  s_add_u32 s49, s49, 0x700000
  s_mul_i32 s50, s23, 786432
  s_add_u32 s63, s50, 0x4800000
  s_add_u32 s50, s50, 0x6000000
  s_mov_b32 s51, 0
  s_mov_b32 s52, 0
  s_mul_i32 s28, s21, 3
  s_add_u32 s28, s28, 0
  s_lshr_b32 s29, s28, 1
  s_lshl_b32 s29, s29, 11
  s_and_b32 s28, s28, 1
  s_lshl_b32 s28, s28, 3
  s_add_u32 s53, s29, s28
  s_mul_i32 s28, s21, 3
  s_add_u32 s28, s28, 1
  s_lshr_b32 s29, s28, 1
  s_lshl_b32 s29, s29, 11
  s_and_b32 s28, s28, 1
  s_lshl_b32 s28, s28, 3
  s_add_u32 s54, s29, s28
  s_mul_i32 s28, s21, 3
  s_add_u32 s28, s28, 2
  s_lshr_b32 s29, s28, 1
  s_lshl_b32 s29, s29, 11
  s_and_b32 s28, s28, 1
  s_lshl_b32 s28, s28, 3
  s_add_u32 s55, s29, s28
  v_mov_b32 v60, 0
  v_mov_b32 v61, 0
  v_mov_b32 v62, 0
  v_mov_b32 v63, 0
  v_mov_b32 v64, 0
  v_mov_b32 v65, 0
  v_mov_b32 v66, 0
  v_mov_b32 v67, 0
  v_mov_b32 v68, 0
  v_mov_b32 v69, 0
  v_mov_b32 v70, 0
  v_mov_b32 v71, 0
  v_mov_b32 v72, 0
  v_mov_b32 v73, 0
  v_mov_b32 v74, 0
  v_mov_b32 v75, 0
  v_mov_b32 v36, 0
  v_mov_b32 v37, 0
  v_mov_b32 v38, 0
  v_mov_b32 v39, 0
  v_mov_b32 v40, 0
  v_mov_b32 v41, 0
  v_mov_b32 v42, 0
  v_mov_b32 v43, 0
  s_barrier
  s_cmp_gt_u32 s52, s51
  s_cbranch_scc1 kaf_x_wp_63_ok
  s_mov_b32 s45, 0
kaf_x_wp_63_spin:
  buffer_load_dword v2, v138, s[8:11], 0 offen sc1
  s_add_u32 s45, s45, 1
  s_waitcnt vmcnt(0)
  v_min_u32_dpp v3, v2, v2 quad_perm:[1,0,3,2] row_mask:0xf bank_mask:0xf
  s_nop 1
  v_min_u32_dpp v2, v3, v3 quad_perm:[2,3,0,1] row_mask:0xf bank_mask:0xf
  s_nop 1
  v_min_u32_dpp v3, v2, v2 row_half_mirror row_mask:0xf bank_mask:0xf
  s_nop 1
  v_min_u32_dpp v2, v3, v3 quad_perm:[0,1,2,3] row_mask:0xf bank_mask:0xf
  s_nop 0
  v_readfirstlane_b32 s52, v2
  s_cmp_gt_u32 s52, s51
  s_cbranch_scc1 kaf_x_wp_63_ok
  s_cmp_lt_u32 s45, 400000
  s_cbranch_scc1 kaf_x_wp_63_spin
  s_branch kaf_abort
kaf_x_wp_63_ok:
  s_add_u32 s28, s50, s53
  buffer_load_dwordx2 v[88:89], v132, s[8:11], s28 offen offset:0 sc1
  buffer_load_dwordx2 v[92:93], v132, s[8:11], s28 offen offset:1024 sc1
  s_add_u32 s28, s50, s54
  buffer_load_dwordx2 v[90:91], v132, s[8:11], s28 offen offset:0 sc1
  buffer_load_dwordx2 v[94:95], v132, s[8:11], s28 offen offset:1024 sc1
  s_add_u32 s28, s50, s55
  buffer_load_dwordx2 v[96:97], v132, s[8:11], s28 offen offset:0 sc1
  buffer_load_dwordx2 v[98:99], v132, s[8:11], s28 offen offset:1024 sc1
  s_cmp_eq_u32 s21, 0
  s_cbranch_scc1 kaf_x_w0
  s_cmp_eq_u32 s21, 1
  s_cbranch_scc1 kaf_x_w1
  s_branch kaf_x_w23
kaf_x_w0:
  v_lshrrev_b32 v4, 3, v1
  v_and_b32 v5, 7, v1
  v_lshrrev_b32 v6, 2, v5
  v_and_b32 v7, 3, v5
  v_lshlrev_b32 v8, 10, v6
  v_lshlrev_b32 v9, 4, v7
  v_add_u32 v9, v9, v4
  v_lshlrev_b32 v9, 4, v9
  v_add_u32 v8, v8, v9
  v_add_u32 v133, 134144, v8
  v_add_u32 v8, 2, v6
  v_lshlrev_b32 v8, 4, v8
  v_add_u32 v8, v8, v4
  v_lshlrev_b32 v8, 4, v8
  v_lshlrev_b32 v9, 2, v7
  v_add_u32 v8, v8, v9
  v_add_u32 v134, 133120, v8
  s_and_b32 s26, s23, 7
  v_and_b32 v8, 1, v7
  v_lshlrev_b32 v8, 1, v8
  v_add_u32 v8, v8, v6
  v_lshlrev_b32 v8, 4, v8
  v_add_u32 v8, v8, v4
  v_lshlrev_b32 v8, 4, v8
  v_lshrrev_b32 v9, 1, v7
  v_lshlrev_b32 v9, 3, v9
  v_add_u32 v8, v8, v9
  s_lshr_b32 s28, s26, 1
  s_lshl_b32 s28, s28, 10
  s_and_b32 s29, s26, 1
  s_lshl_b32 s29, s29, 7
  s_add_u32 s28, s28, s29
  v_add_u32 v135, s28, v8
  v_lshlrev_b32 v8, 4, v6
  v_add_u32 v8, v8, v4
  v_lshlrev_b32 v8, 4, v8
  v_lshlrev_b32 v9, 1, v7
  v_add_u32 v8, v8, v9
  s_lshr_b32 s28, s26, 2
  s_lshl_b32 s28, s28, 7
  s_and_b32 s29, s26, 1
  s_lshl_b32 s29, s29, 9
  s_add_u32 s28, s28, s29
  s_bfe_u32 s29, s26, 0x10001
  s_lshl_b32 s29, s29, 3
  s_add_u32 s28, s28, s29
  s_add_u32 s28, s28, 4096
  v_add_u32 v8, s28, v8
  v_mov_b32 v9, 0x40000000
  v_and_b32 v10, 1, v5
  v_cmp_eq_u32 vcc, 0, v10
  s_nop 1
  v_cndmask_b32 v136, v9, v8, vcc
  s_mov_b32 s64, 0x3dd53b95
  s_mov_b32 s65, 0x3dd53b95
kaf_x_w0l:
  ds_read_b128 v[44:47], v129 offset:0
  ds_read_b128 v[48:51], v129 offset:1024
  ds_read_b128 v[52:55], v129 offset:2048
  ds_read_b128 v[56:59], v129 offset:3072
  s_waitcnt lgkmcnt(0)
  s_mov_b32 s45, 0
kaf_x_pf_64:
  buffer_load_dwordx4 v[112:115], v124, s[8:11], s48 offen sc1
  buffer_load_dwordx4 v[116:119], v125, s[8:11], s48 offen sc1
  buffer_load_dwordx4 v[120:123], v126, s[8:11], s48 offen sc1
  s_add_u32 s45, s45, 1
  s_waitcnt vmcnt(2)
  ds_write_b128 v127, v[112:115] offset:0
  v_max3_u32 v139, v112, v113, v114
  v_max_u32 v139, v139, v115
  s_waitcnt vmcnt(1)
  ds_write_b128 v127, v[116:119] offset:4096
  v_max3_u32 v139, v139, v116, v117
  v_max3_u32 v139, v139, v118, v119
  s_waitcnt vmcnt(0)
  ds_write_b128 v127, v[120:123] offset:8192
  v_max3_u32 v139, v139, v120, v121
  v_max3_u32 v139, v139, v122, v123
  v_cmp_eq_u32 vcc, -1, v139
  s_cbranch_vccz kaf_x_pf_64_ok
  s_cmp_lt_u32 s45, 400000
  s_cbranch_scc1 kaf_x_pf_64
  s_branch kaf_abort
kaf_x_pf_64_ok:
  v_smfmac_f32_16x16x64_bf16 v[60:63], v[112:115], a[0:7], v110
  v_smfmac_f32_16x16x64_bf16 v[64:67], v[112:115], a[240:247], v110
  v_smfmac_f32_16x16x64_bf16 v[68:71], v[112:115], a[80:87], v110
  v_smfmac_f32_16x16x64_bf16 v[72:75], v[112:115], v[176:183], v110
  s_waitcnt lgkmcnt(0)
  s_barrier
  v_smfmac_f32_16x16x64_bf16 v[36:39], v[112:115], a[160:167], v110
  ds_read_b128 v[4:7], v128 offset:1024
  v_smfmac_f32_16x16x64_bf16 v[40:43], v[112:115], v[216:223], v110
  ds_read_b128 v[8:11], v128 offset:2048
  v_smfmac_f32_16x16x64_bf16 v[60:63], v[116:119], a[32:39], v110
  ds_read_b128 v[12:15], v128 offset:3072
  v_smfmac_f32_16x16x64_bf16 v[64:67], v[116:119], v[152:159], v110
  ds_read_b128 v[16:19], v128 offset:5120
  v_smfmac_f32_16x16x64_bf16 v[68:71], v[116:119], a[112:119], v110
  ds_read_b128 v[20:23], v128 offset:6144
  v_smfmac_f32_16x16x64_bf16 v[72:75], v[116:119], v[192:199], v110
  ds_read_b128 v[24:27], v128 offset:7168
  v_smfmac_f32_16x16x64_bf16 v[36:39], v[116:119], a[192:199], v110
  ds_read_b128 v[28:31], v128 offset:9216
  v_smfmac_f32_16x16x64_bf16 v[40:43], v[116:119], v[232:239], v110
  v_smfmac_f32_16x16x64_bf16 v[60:63], v[120:123], a[64:71], v110
  v_smfmac_f32_16x16x64_bf16 v[64:67], v[120:123], v[168:175], v110
  v_smfmac_f32_16x16x64_bf16 v[68:71], v[120:123], a[144:151], v110
  v_smfmac_f32_16x16x64_bf16 v[72:75], v[120:123], v[208:215], v110
  v_smfmac_f32_16x16x64_bf16 v[36:39], v[120:123], a[224:231], v110
  v_smfmac_f32_16x16x64_bf16 v[40:43], v[120:123], v[248:255], v110
  s_waitcnt lgkmcnt(6)
  v_smfmac_f32_16x16x64_bf16 v[60:63], v[4:7], a[8:15], v110
  v_smfmac_f32_16x16x64_bf16 v[64:67], v[4:7], v[44:51], v110
  ds_read_b128 v[44:47], v129 offset:4096
  s_waitcnt lgkmcnt(6)
  v_smfmac_f32_16x16x64_bf16 v[60:63], v[8:11], a[16:23], v110
  ds_read_b128 v[48:51], v129 offset:5120
  v_smfmac_f32_16x16x64_bf16 v[64:67], v[8:11], a[248:255], v110
  s_waitcnt lgkmcnt(6)
  v_smfmac_f32_16x16x64_bf16 v[60:63], v[12:15], a[24:31], v110
  v_smfmac_f32_16x16x64_bf16 v[64:67], v[12:15], v[52:59], v110
  ds_read_b128 v[52:55], v129 offset:6144
  s_waitcnt lgkmcnt(6)
  v_smfmac_f32_16x16x64_bf16 v[60:63], v[16:19], a[40:47], v110
  ds_read_b128 v[56:59], v129 offset:7168
  s_waitcnt lgkmcnt(2)
  v_smfmac_f32_16x16x64_bf16 v[64:67], v[16:19], v[44:51], v110
  ds_read_b128 v[44:47], v129 offset:8192
  v_smfmac_f32_16x16x64_bf16 v[60:63], v[20:23], a[48:55], v110
  ds_read_b128 v[48:51], v129 offset:9216
  v_smfmac_f32_16x16x64_bf16 v[64:67], v[20:23], v[160:167], v110
  v_smfmac_f32_16x16x64_bf16 v[60:63], v[24:27], a[56:63], v110
  s_waitcnt lgkmcnt(2)
  v_smfmac_f32_16x16x64_bf16 v[64:67], v[24:27], v[52:59], v110
  ds_read_b128 v[52:55], v129 offset:10240
  v_smfmac_f32_16x16x64_bf16 v[60:63], v[28:31], a[72:79], v110
  ds_read_b128 v[56:59], v129 offset:11264
  s_waitcnt lgkmcnt(2)
  v_smfmac_f32_16x16x64_bf16 v[64:67], v[28:31], v[44:51], v110
  ds_read_b128 v[44:47], v129 offset:12288
  v_smfmac_f32_16x16x64_bf16 v[68:71], v[4:7], a[88:95], v110
  ds_read_b128 v[48:51], v129 offset:13312
  s_waitcnt lgkmcnt(2)
  v_smfmac_f32_16x16x64_bf16 v[72:75], v[4:7], v[52:59], v110
  ds_read_b128 v[52:55], v129 offset:14336
  v_permlane32_swap_b32 v60, v64
  v_smfmac_f32_16x16x64_bf16 v[68:71], v[8:11], a[96:103], v110
  ds_read_b128 v[56:59], v129 offset:15360
  v_smfmac_f32_16x16x64_bf16 v[72:75], v[8:11], v[184:191], v110
  v_permlane32_swap_b32 v61, v65
  v_smfmac_f32_16x16x64_bf16 v[68:71], v[12:15], a[104:111], v110
  s_waitcnt lgkmcnt(2)
  v_smfmac_f32_16x16x64_bf16 v[72:75], v[12:15], v[44:51], v110
  ds_read_b128 v[44:47], v129 offset:16384
  v_permlane32_swap_b32 v62, v66
  v_smfmac_f32_16x16x64_bf16 v[68:71], v[16:19], a[120:127], v110
  ds_read_b128 v[48:51], v129 offset:17408
  v_permlane32_swap_b32 v63, v67
  s_waitcnt lgkmcnt(2)
  v_smfmac_f32_16x16x64_bf16 v[72:75], v[16:19], v[52:59], v110
  ds_read_b128 v[52:55], v129 offset:18432
  v_add_f32 v60, v60, v64
  v_smfmac_f32_16x16x64_bf16 v[68:71], v[20:23], a[128:135], v110
  ds_read_b128 v[56:59], v129 offset:19456
  v_add_f32 v61, v61, v65
  v_smfmac_f32_16x16x64_bf16 v[72:75], v[20:23], v[200:207], v110
  v_add_f32 v62, v62, v66
  v_smfmac_f32_16x16x64_bf16 v[68:71], v[24:27], a[136:143], v110
  v_add_f32 v63, v63, v67
  s_waitcnt lgkmcnt(2)
  v_smfmac_f32_16x16x64_bf16 v[72:75], v[24:27], v[44:51], v110
  ds_read_b128 v[44:47], v129 offset:20480
  v_cvt_pk_bf16_f32 v100, v60, v61
  v_smfmac_f32_16x16x64_bf16 v[68:71], v[28:31], a[152:159], v110
  ds_read_b128 v[48:51], v129 offset:21504
  v_cvt_pk_bf16_f32 v101, v62, v63
  s_waitcnt lgkmcnt(2)
  v_smfmac_f32_16x16x64_bf16 v[72:75], v[28:31], v[52:59], v110
  ds_read_b128 v[52:55], v129 offset:22528
  v_smfmac_f32_16x16x64_bf16 v[36:39], v[4:7], a[168:175], v110
  ds_read_b128 v[56:59], v129 offset:23552
  s_waitcnt lgkmcnt(2)
  v_smfmac_f32_16x16x64_bf16 v[40:43], v[4:7], v[44:51], v110
  ds_read_b128 v[44:47], v129 offset:24576
  v_permlane32_swap_b32 v68, v72
  v_smfmac_f32_16x16x64_bf16 v[36:39], v[8:11], a[176:183], v110
  ds_read_b128 v[48:51], v129 offset:25600
  v_smfmac_f32_16x16x64_bf16 v[40:43], v[8:11], v[224:231], v110
  v_permlane32_swap_b32 v69, v73
  v_smfmac_f32_16x16x64_bf16 v[36:39], v[12:15], a[184:191], v110
  s_waitcnt lgkmcnt(2)
  v_smfmac_f32_16x16x64_bf16 v[40:43], v[12:15], v[52:59], v110
  ds_read_b128 v[52:55], v129 offset:26624
  v_permlane32_swap_b32 v70, v74
  v_smfmac_f32_16x16x64_bf16 v[36:39], v[16:19], a[200:207], v110
  ds_read_b128 v[56:59], v129 offset:27648
  v_permlane32_swap_b32 v71, v75
  s_waitcnt lgkmcnt(2)
  v_smfmac_f32_16x16x64_bf16 v[40:43], v[16:19], v[44:51], v110
  ds_read_b128 v[44:47], v129 offset:28672
  v_add_f32 v68, v68, v72
  v_smfmac_f32_16x16x64_bf16 v[36:39], v[20:23], a[208:215], v110
  ds_read_b128 v[48:51], v129 offset:29696
  v_add_f32 v69, v69, v73
  v_smfmac_f32_16x16x64_bf16 v[40:43], v[20:23], v[240:247], v110
  v_add_f32 v70, v70, v74
  v_smfmac_f32_16x16x64_bf16 v[36:39], v[24:27], a[216:223], v110
  v_add_f32 v71, v71, v75
  s_waitcnt lgkmcnt(2)
  v_smfmac_f32_16x16x64_bf16 v[40:43], v[24:27], v[52:59], v110
  v_cvt_pk_bf16_f32 v102, v68, v69
  v_smfmac_f32_16x16x64_bf16 v[36:39], v[28:31], a[232:239], v110
  v_cvt_pk_bf16_f32 v103, v70, v71
  s_waitcnt lgkmcnt(0)
  v_smfmac_f32_16x16x64_bf16 v[40:43], v[28:31], v[44:51], v110
  v_mfma_f32_16x16x16_bf16 v[142:145], v[100:101], v[108:109], 0
  v_mfma_f32_16x16x16_bf16 v[146:149], v[102:103], v[108:109], 0
  s_nop 1
  v_permlane32_swap_b32 v36, v40
  v_permlane32_swap_b32 v37, v41
  v_permlane32_swap_b32 v38, v42
  v_permlane32_swap_b32 v39, v43
  v_add_f32 v36, v36, v40
  v_add_f32 v37, v37, v41
  v_add_f32 v38, v38, v42
  v_add_f32 v39, v39, v43
  v_cvt_pk_bf16_f32 v104, v36, v37
  v_cvt_pk_bf16_f32 v105, v38, v39
  v_cvt_pk_bf16_f32 v44, v142, v143
  v_cvt_pk_bf16_f32 v45, v144, v145
  v_mfma_f32_16x16x16_bf16 v[142:145], v[104:105], v[108:109], 0
  v_cvt_pk_bf16_f32 v46, v146, v147
  v_cvt_pk_bf16_f32 v47, v148, v149
  ds_write_b64 v131, v[44:45]
  ds_write_b64 v131, v[46:47] offset:512
  v_mfma_f32_16x16x32_bf16 v[76:79], v[44:47], v[44:47], 0
  v_mfma_f32_16x16x32_bf16 v[80:83], v[88:91], v[44:47], 0
  v_mfma_f32_16x16x32_bf16 v[84:87], v[92:95], v[44:47], 0
  v_cvt_pk_bf16_f32 v106, v142, v143
  v_cvt_pk_bf16_f32 v107, v144, v145
  ds_write_b64 v131, v[106:107] offset:1024
  s_nop 0
  v_mfma_f32_16x16x16_bf16 v[76:79], v[106:107], v[106:107], v[76:79]
  v_mfma_f32_16x16x16_bf16 v[80:83], v[96:97], v[106:107], v[80:83]
  v_mfma_f32_16x16x16_bf16 v[84:87], v[98:99], v[106:107], v[84:87]
  s_nop 6
  ds_write_b128 v130, v[76:79] offset:0
  ds_write_b128 v130, v[80:83] offset:1024
  s_nop 0
  ds_write_b128 v130, v[84:87] offset:2048
  s_waitcnt lgkmcnt(0)
  s_barrier
  s_cmp_ge_u32 s51, 63
  s_cbranch_scc1 kaf_x_done
  ds_read_b128 v[4:7], v133 offset:0
  ds_read_b32 v20, v134 offset:0
  ds_read_b128 v[8:11], v133 offset:3072
  ds_read_b32 v21, v134 offset:3072
  ds_read_b128 v[12:15], v133 offset:6144
  ds_read_b32 v22, v134 offset:6144
  ds_read_b128 v[16:19], v133 offset:9216
  ds_read_b32 v23, v134 offset:9216
  s_waitcnt lgkmcnt(4)
  v_pk_add_f32 v[4:5], v[4:5], v[8:9]
  v_pk_add_f32 v[6:7], v[6:7], v[10:11]
  v_add_f32 v20, v20, v21
  s_waitcnt lgkmcnt(0)
  v_pk_add_f32 v[12:13], v[12:13], v[16:17]
  v_pk_add_f32 v[14:15], v[14:15], v[18:19]
  v_add_f32 v22, v22, v23
  v_pk_add_f32 v[4:5], v[4:5], v[12:13]
  v_pk_add_f32 v[6:7], v[6:7], v[14:15]
  v_add_f32 v8, v20, v22
  v_max3_f32 v24, v4, v5, v6
  v_max3_f32 v24, v24, v7, v8
  s_nop 1
  v_max_f32_dpp v25, v24, v24 quad_perm:[1,0,3,2] row_mask:0xf bank_mask:0xf
  s_nop 1
  v_max_f32_dpp v24, v25, v25 quad_perm:[2,3,0,1] row_mask:0xf bank_mask:0xf
  s_nop 1
  v_max_f32_dpp v25, v24, v24 row_half_mirror row_mask:0xf bank_mask:0xf
  v_mul_f32 v24, s64, v25
  v_fma_f32 v4, v4, s64, -v24
  v_fma_f32 v5, v5, s64, -v24
  v_fma_f32 v6, v6, s64, -v24
  v_fma_f32 v7, v7, s64, -v24
  v_fma_f32 v8, v8, s64, -v24
  v_exp_f32 v4, v4
  v_exp_f32 v5, v5
  v_exp_f32 v6, v6
  v_exp_f32 v7, v7
  v_exp_f32 v8, v8
  v_add_f32 v24, v4, v5
  v_add_f32 v25, v6, v7
  v_add_f32 v24, v24, v25
  v_add_f32 v24, v24, v8
  s_nop 1
  v_add_f32_dpp v25, v24, v24 quad_perm:[1,0,3,2] row_mask:0xf bank_mask:0xf
  s_nop 1
  v_add_f32_dpp v24, v25, v25 quad_perm:[2,3,0,1] row_mask:0xf bank_mask:0xf
  s_nop 1
  v_add_f32_dpp v25, v24, v24 row_half_mirror row_mask:0xf bank_mask:0xf
  s_nop 0
  v_rcp_f32 v24, v25
  s_nop 0
  v_mul_f32 v8, v8, v24
  v_mul_f32 v4, v4, v24
  v_mul_f32 v5, v5, v24
  v_mov_b32_dpp v9, v8 quad_perm:[1,0,3,2] row_mask:0xf bank_mask:0xf
  v_mul_f32 v6, v6, v24
  v_mul_f32 v7, v7, v24
  v_cvt_pk_bf16_f32 v10, v4, v5
  v_cvt_pk_bf16_f32 v11, v6, v7
  v_cvt_pk_bf16_f32 v12, v8, v9
  buffer_store_dwordx2 v[10:11], v135, s[8:11], s49 offen
  buffer_store_dword v12, v136, s[8:11], s49 offen
  v_mov_b32 v60, 0
  v_mov_b32 v61, 0
  v_mov_b32 v62, 0
  v_mov_b32 v63, 0
  v_mov_b32 v64, 0
  v_mov_b32 v65, 0
  v_mov_b32 v66, 0
  v_mov_b32 v67, 0
  v_mov_b32 v68, 0
  v_mov_b32 v69, 0
  v_mov_b32 v70, 0
  v_mov_b32 v71, 0
  v_mov_b32 v72, 0
  v_mov_b32 v73, 0
  v_mov_b32 v74, 0
  v_mov_b32 v75, 0
  v_mov_b32 v36, 0
  v_mov_b32 v37, 0
  v_mov_b32 v38, 0
  v_mov_b32 v39, 0
  v_mov_b32 v40, 0
  v_mov_b32 v41, 0
  v_mov_b32 v42, 0
  v_mov_b32 v43, 0
  s_add_u32 s97, s97, 10240
  s_mov_b32 s48, s97
  s_add_u32 s49, s49, 5120
  s_add_u32 s50, s50, 12288
  s_add_u32 s63, s63, 12288
  s_add_u32 s51, s51, 1
  s_cmp_gt_u32 s52, s51
  s_cbranch_scc1 kaf_x_wp_65_ok
  s_mov_b32 s45, 0
kaf_x_wp_65_spin:
  buffer_load_dword v2, v138, s[8:11], 0 offen sc1
  s_add_u32 s45, s45, 1
  s_waitcnt vmcnt(0)
  v_min_u32_dpp v3, v2, v2 quad_perm:[1,0,3,2] row_mask:0xf bank_mask:0xf
  s_nop 1
  v_min_u32_dpp v2, v3, v3 quad_perm:[2,3,0,1] row_mask:0xf bank_mask:0xf
  s_nop 1
  v_min_u32_dpp v3, v2, v2 row_half_mirror row_mask:0xf bank_mask:0xf
  s_nop 1
  v_min_u32_dpp v2, v3, v3 quad_perm:[0,1,2,3] row_mask:0xf bank_mask:0xf
  s_nop 0
  v_readfirstlane_b32 s52, v2
  s_cmp_gt_u32 s52, s51
  s_cbranch_scc1 kaf_x_wp_65_ok
  s_cmp_lt_u32 s45, 400000
  s_cbranch_scc1 kaf_x_wp_65_spin
  s_branch kaf_abort
kaf_x_wp_65_ok:
  s_add_u32 s28, s50, s53
  buffer_load_dwordx2 v[88:89], v132, s[8:11], s28 offen offset:0 sc1
  buffer_load_dwordx2 v[92:93], v132, s[8:11], s28 offen offset:1024 sc1
  s_add_u32 s28, s50, s54
  buffer_load_dwordx2 v[90:91], v132, s[8:11], s28 offen offset:0 sc1
  buffer_load_dwordx2 v[94:95], v132, s[8:11], s28 offen offset:1024 sc1
  s_add_u32 s28, s50, s55
  buffer_load_dwordx2 v[96:97], v132, s[8:11], s28 offen offset:0 sc1
  buffer_load_dwordx2 v[98:99], v132, s[8:11], s28 offen offset:1024 sc1
  s_branch kaf_x_w0l
kaf_x_w1:
kaf_x_w1l:
  ds_read_b128 v[44:47], v129 offset:0
  ds_read_b128 v[48:51], v129 offset:1024
  ds_read_b128 v[52:55], v129 offset:10240
  ds_read_b128 v[56:59], v129 offset:11264
  s_waitcnt lgkmcnt(0)
  s_mov_b32 s45, 0
kaf_x_pf_66:
  buffer_load_dwordx4 v[112:115], v124, s[8:11], s48 offen sc1
  buffer_load_dwordx4 v[116:119], v125, s[8:11], s48 offen sc1
  buffer_load_dwordx4 v[120:123], v126, s[8:11], s48 offen sc1
  s_add_u32 s45, s45, 1
  s_waitcnt vmcnt(2)
  ds_write_b128 v127, v[112:115] offset:0
  v_max3_u32 v139, v112, v113, v114
  v_max_u32 v139, v139, v115
  s_waitcnt vmcnt(1)
  ds_write_b128 v127, v[116:119] offset:4096
  v_max3_u32 v139, v139, v116, v117
  v_max3_u32 v139, v139, v118, v119
  s_waitcnt vmcnt(0)
  ds_write_b128 v127, v[120:123] offset:8192
  v_max3_u32 v139, v139, v120, v121
  v_max3_u32 v139, v139, v122, v123
  v_cmp_eq_u32 vcc, -1, v139
  s_cbranch_vccz kaf_x_pf_66_ok
  s_cmp_lt_u32 s45, 400000
  s_cbranch_scc1 kaf_x_pf_66
  s_branch kaf_abort
kaf_x_pf_66_ok:
  v_smfmac_f32_16x16x64_bf16 v[60:63], v[112:115], a[8:15], v110
  v_smfmac_f32_16x16x64_bf16 v[64:67], v[112:115], v[44:51], v110
  ds_read_b128 v[44:47], v129 offset:20480
  v_smfmac_f32_16x16x64_bf16 v[68:71], v[112:115], a[88:95], v110
  ds_read_b128 v[48:51], v129 offset:21504
  v_smfmac_f32_16x16x64_bf16 v[72:75], v[112:115], v[52:59], v110
  ds_read_b128 v[52:55], v129 offset:4096
  s_waitcnt lgkmcnt(3)
  s_barrier
  v_smfmac_f32_16x16x64_bf16 v[36:39], v[112:115], a[168:175], v110
  ds_read_b128 v[56:59], v129 offset:5120
  ds_read_b128 v[4:7], v128 offset:0
  s_waitcnt lgkmcnt(3)
  v_smfmac_f32_16x16x64_bf16 v[40:43], v[112:115], v[44:51], v110
  ds_read_b128 v[44:47], v129 offset:14336
  ds_read_b128 v[8:11], v128 offset:2048
  v_smfmac_f32_16x16x64_bf16 v[60:63], v[116:119], a[40:47], v110
  ds_read_b128 v[48:51], v129 offset:15360
  ds_read_b128 v[12:15], v128 offset:3072
  s_waitcnt lgkmcnt(5)
  v_smfmac_f32_16x16x64_bf16 v[64:67], v[116:119], v[52:59], v110
  ds_read_b128 v[52:55], v129 offset:24576
  ds_read_b128 v[16:19], v128 offset:4096
  v_smfmac_f32_16x16x64_bf16 v[68:71], v[116:119], a[120:127], v110
  ds_read_b128 v[56:59], v129 offset:25600
  ds_read_b128 v[20:23], v128 offset:6144
  s_waitcnt lgkmcnt(5)
  v_smfmac_f32_16x16x64_bf16 v[72:75], v[116:119], v[44:51], v110
  ds_read_b128 v[44:47], v129 offset:8192
  ds_read_b128 v[24:27], v128 offset:7168
  v_smfmac_f32_16x16x64_bf16 v[36:39], v[116:119], a[200:207], v110
  ds_read_b128 v[48:51], v129 offset:9216
  ds_read_b128 v[28:31], v128 offset:8192
  s_waitcnt lgkmcnt(5)
  v_smfmac_f32_16x16x64_bf16 v[40:43], v[116:119], v[52:59], v110
  ds_read_b128 v[52:55], v129 offset:18432
  v_smfmac_f32_16x16x64_bf16 v[60:63], v[120:123], a[72:79], v110
  ds_read_b128 v[56:59], v129 offset:19456
  s_waitcnt lgkmcnt(3)
  v_smfmac_f32_16x16x64_bf16 v[64:67], v[120:123], v[44:51], v110
  ds_read_b128 v[44:47], v129 offset:28672
  v_smfmac_f32_16x16x64_bf16 v[68:71], v[120:123], a[152:159], v110
  ds_read_b128 v[48:51], v129 offset:29696
  s_waitcnt lgkmcnt(2)
  v_smfmac_f32_16x16x64_bf16 v[72:75], v[120:123], v[52:59], v110
  ds_read_b128 v[52:55], v129 offset:2048
  v_smfmac_f32_16x16x64_bf16 v[36:39], v[120:123], a[232:239], v110
  ds_read_b128 v[56:59], v129 offset:3072
  s_waitcnt lgkmcnt(2)
  v_smfmac_f32_16x16x64_bf16 v[40:43], v[120:123], v[44:51], v110
  ds_read_b128 v[44:47], v129 offset:6144
  v_smfmac_f32_16x16x64_bf16 v[60:63], v[4:7], a[0:7], v110
  ds_read_b128 v[48:51], v129 offset:7168
  v_smfmac_f32_16x16x64_bf16 v[64:67], v[4:7], a[240:247], v110
  v_smfmac_f32_16x16x64_bf16 v[60:63], v[8:11], a[16:23], v110
  v_smfmac_f32_16x16x64_bf16 v[64:67], v[8:11], a[248:255], v110
  v_smfmac_f32_16x16x64_bf16 v[60:63], v[12:15], a[24:31], v110
  s_waitcnt lgkmcnt(2)
  v_smfmac_f32_16x16x64_bf16 v[64:67], v[12:15], v[52:59], v110
  ds_read_b128 v[52:55], v129 offset:12288
  v_smfmac_f32_16x16x64_bf16 v[60:63], v[16:19], a[32:39], v110
  ds_read_b128 v[56:59], v129 offset:13312
  v_smfmac_f32_16x16x64_bf16 v[64:67], v[16:19], v[152:159], v110
  v_smfmac_f32_16x16x64_bf16 v[60:63], v[20:23], a[48:55], v110
  v_smfmac_f32_16x16x64_bf16 v[64:67], v[20:23], v[160:167], v110
  v_smfmac_f32_16x16x64_bf16 v[60:63], v[24:27], a[56:63], v110
  s_waitcnt lgkmcnt(2)
  v_smfmac_f32_16x16x64_bf16 v[64:67], v[24:27], v[44:51], v110
  ds_read_b128 v[44:47], v129 offset:16384
  v_smfmac_f32_16x16x64_bf16 v[60:63], v[28:31], a[64:71], v110
  ds_read_b128 v[48:51], v129 offset:17408
  v_smfmac_f32_16x16x64_bf16 v[64:67], v[28:31], v[168:175], v110
  v_smfmac_f32_16x16x64_bf16 v[68:71], v[4:7], a[80:87], v110
  v_smfmac_f32_16x16x64_bf16 v[72:75], v[4:7], v[176:183], v110
  v_permlane32_swap_b32 v60, v64
  v_smfmac_f32_16x16x64_bf16 v[68:71], v[8:11], a[96:103], v110
  v_smfmac_f32_16x16x64_bf16 v[72:75], v[8:11], v[184:191], v110
  v_permlane32_swap_b32 v61, v65
  v_smfmac_f32_16x16x64_bf16 v[68:71], v[12:15], a[104:111], v110
  s_waitcnt lgkmcnt(2)
  v_smfmac_f32_16x16x64_bf16 v[72:75], v[12:15], v[52:59], v110
  ds_read_b128 v[52:55], v129 offset:22528
  v_permlane32_swap_b32 v62, v66
  v_smfmac_f32_16x16x64_bf16 v[68:71], v[16:19], a[112:119], v110
  ds_read_b128 v[56:59], v129 offset:23552
  v_permlane32_swap_b32 v63, v67
  v_smfmac_f32_16x16x64_bf16 v[72:75], v[16:19], v[192:199], v110
  v_add_f32 v60, v60, v64
  v_smfmac_f32_16x16x64_bf16 v[68:71], v[20:23], a[128:135], v110
  v_add_f32 v61, v61, v65
  v_smfmac_f32_16x16x64_bf16 v[72:75], v[20:23], v[200:207], v110
  v_add_f32 v62, v62, v66
  v_smfmac_f32_16x16x64_bf16 v[68:71], v[24:27], a[136:143], v110
  v_add_f32 v63, v63, v67
  s_waitcnt lgkmcnt(2)
  v_smfmac_f32_16x16x64_bf16 v[72:75], v[24:27], v[44:51], v110
  ds_read_b128 v[44:47], v129 offset:26624
  v_cvt_pk_bf16_f32 v100, v60, v61
  v_smfmac_f32_16x16x64_bf16 v[68:71], v[28:31], a[144:151], v110
  ds_read_b128 v[48:51], v129 offset:27648
  v_cvt_pk_bf16_f32 v101, v62, v63
  v_smfmac_f32_16x16x64_bf16 v[72:75], v[28:31], v[208:215], v110
  v_smfmac_f32_16x16x64_bf16 v[36:39], v[4:7], a[160:167], v110
  v_smfmac_f32_16x16x64_bf16 v[40:43], v[4:7], v[216:223], v110
  v_permlane32_swap_b32 v68, v72
  v_smfmac_f32_16x16x64_bf16 v[36:39], v[8:11], a[176:183], v110
  v_smfmac_f32_16x16x64_bf16 v[40:43], v[8:11], v[224:231], v110
  v_permlane32_swap_b32 v69, v73
  v_smfmac_f32_16x16x64_bf16 v[36:39], v[12:15], a[184:191], v110
  s_waitcnt lgkmcnt(2)
  v_smfmac_f32_16x16x64_bf16 v[40:43], v[12:15], v[52:59], v110
  v_permlane32_swap_b32 v70, v74
  v_smfmac_f32_16x16x64_bf16 v[36:39], v[16:19], a[192:199], v110
  v_permlane32_swap_b32 v71, v75
  v_smfmac_f32_16x16x64_bf16 v[40:43], v[16:19], v[232:239], v110
  v_add_f32 v68, v68, v72
  v_smfmac_f32_16x16x64_bf16 v[36:39], v[20:23], a[208:215], v110
  v_add_f32 v69, v69, v73
  v_smfmac_f32_16x16x64_bf16 v[40:43], v[20:23], v[240:247], v110
  v_add_f32 v70, v70, v74
  v_smfmac_f32_16x16x64_bf16 v[36:39], v[24:27], a[216:223], v110
  v_add_f32 v71, v71, v75
  s_waitcnt lgkmcnt(0)
  v_smfmac_f32_16x16x64_bf16 v[40:43], v[24:27], v[44:51], v110
  v_cvt_pk_bf16_f32 v102, v68, v69
  v_smfmac_f32_16x16x64_bf16 v[36:39], v[28:31], a[224:231], v110
  v_cvt_pk_bf16_f32 v103, v70, v71
  v_smfmac_f32_16x16x64_bf16 v[40:43], v[28:31], v[248:255], v110
  v_mfma_f32_16x16x16_bf16 v[142:145], v[100:101], v[108:109], 0
  v_mfma_f32_16x16x16_bf16 v[146:149], v[102:103], v[108:109], 0
  s_nop 1
  v_permlane32_swap_b32 v36, v40
  v_permlane32_swap_b32 v37, v41
  v_permlane32_swap_b32 v38, v42
  v_permlane32_swap_b32 v39, v43
  v_add_f32 v36, v36, v40
  v_add_f32 v37, v37, v41
  v_add_f32 v38, v38, v42
  v_add_f32 v39, v39, v43
  v_cvt_pk_bf16_f32 v104, v36, v37
  v_cvt_pk_bf16_f32 v105, v38, v39
  v_cvt_pk_bf16_f32 v44, v142, v143
  v_cvt_pk_bf16_f32 v45, v144, v145
  v_mfma_f32_16x16x16_bf16 v[142:145], v[104:105], v[108:109], 0
  v_cvt_pk_bf16_f32 v46, v146, v147
  v_cvt_pk_bf16_f32 v47, v148, v149
  ds_write_b64 v131, v[44:45]
  ds_write_b64 v131, v[46:47] offset:512
  v_mfma_f32_16x16x32_bf16 v[76:79], v[44:47], v[44:47], 0
  v_mfma_f32_16x16x32_bf16 v[80:83], v[88:91], v[44:47], 0
  v_mfma_f32_16x16x32_bf16 v[84:87], v[92:95], v[44:47], 0
  v_cvt_pk_bf16_f32 v106, v142, v143
  v_cvt_pk_bf16_f32 v107, v144, v145
  ds_write_b64 v131, v[106:107] offset:1024
  s_nop 0
  v_mfma_f32_16x16x16_bf16 v[76:79], v[106:107], v[106:107], v[76:79]
  v_mfma_f32_16x16x16_bf16 v[80:83], v[96:97], v[106:107], v[80:83]
  v_mfma_f32_16x16x16_bf16 v[84:87], v[98:99], v[106:107], v[84:87]
  s_nop 6
  ds_write_b128 v130, v[76:79] offset:0
  ds_write_b128 v130, v[80:83] offset:1024
  s_nop 0
  ds_write_b128 v130, v[84:87] offset:2048
  s_waitcnt lgkmcnt(0)
  s_barrier
  s_cmp_ge_u32 s51, 63
  s_cbranch_scc1 kaf_x_done
  v_mov_b32 v60, 0
  v_mov_b32 v61, 0
  v_mov_b32 v62, 0
  v_mov_b32 v63, 0
  v_mov_b32 v64, 0
  v_mov_b32 v65, 0
  v_mov_b32 v66, 0
  v_mov_b32 v67, 0
  v_mov_b32 v68, 0
  v_mov_b32 v69, 0
  v_mov_b32 v70, 0
  v_mov_b32 v71, 0
  v_mov_b32 v72, 0
  v_mov_b32 v73, 0
  v_mov_b32 v74, 0
  v_mov_b32 v75, 0
  v_mov_b32 v36, 0
  v_mov_b32 v37, 0
  v_mov_b32 v38, 0
  v_mov_b32 v39, 0
  v_mov_b32 v40, 0
  v_mov_b32 v41, 0
  v_mov_b32 v42, 0
  v_mov_b32 v43, 0
  s_add_u32 s97, s97, 10240
  s_mov_b32 s48, s97
  s_add_u32 s49, s49, 5120
  s_add_u32 s50, s50, 12288
  s_add_u32 s63, s63, 12288
  s_add_u32 s51, s51, 1
  s_cmp_gt_u32 s52, s51
  s_cbranch_scc1 kaf_x_wp_67_ok
  s_mov_b32 s45, 0
kaf_x_wp_67_spin:
  buffer_load_dword v2, v138, s[8:11], 0 offen sc1
  s_add_u32 s45, s45, 1
  s_waitcnt vmcnt(0)
  v_min_u32_dpp v3, v2, v2 quad_perm:[1,0,3,2] row_mask:0xf bank_mask:0xf
  s_nop 1
  v_min_u32_dpp v2, v3, v3 quad_perm:[2,3,0,1] row_mask:0xf bank_mask:0xf
  s_nop 1
  v_min_u32_dpp v3, v2, v2 row_half_mirror row_mask:0xf bank_mask:0xf
  s_nop 1
  v_min_u32_dpp v2, v3, v3 quad_perm:[0,1,2,3] row_mask:0xf bank_mask:0xf
  s_nop 0
  v_readfirstlane_b32 s52, v2
  s_cmp_gt_u32 s52, s51
  s_cbranch_scc1 kaf_x_wp_67_ok
  s_cmp_lt_u32 s45, 400000
  s_cbranch_scc1 kaf_x_wp_67_spin
  s_branch kaf_abort
kaf_x_wp_67_ok:
  s_add_u32 s28, s50, s53
  buffer_load_dwordx2 v[88:89], v132, s[8:11], s28 offen offset:0 sc1
  buffer_load_dwordx2 v[92:93], v132, s[8:11], s28 offen offset:1024 sc1
  s_add_u32 s28, s50, s54
  buffer_load_dwordx2 v[90:91], v132, s[8:11], s28 offen offset:0 sc1
  buffer_load_dwordx2 v[94:95], v132, s[8:11], s28 offen offset:1024 sc1
  s_add_u32 s28, s50, s55
  buffer_load_dwordx2 v[96:97], v132, s[8:11], s28 offen offset:0 sc1
  buffer_load_dwordx2 v[98:99], v132, s[8:11], s28 offen offset:1024 sc1
  s_branch kaf_x_w1l
kaf_x_w23:
  s_sub_u32 s65, s21, 2
  s_and_b32 s26, s23, 7
  v_and_b32 v4, 15, v1
  v_lshrrev_b32 v5, 4, v1
  v_and_b32 v6, 1, v5
  v_lshlrev_b32 v6, 5, v6
  v_add_u32 v6, v6, v4
  v_lshlrev_b32 v6, 4, v6
  v_lshrrev_b32 v7, 1, v5
  v_lshlrev_b32 v7, 3, v7
  v_add_u32 v6, v6, v7
  s_lshl_b32 s28, s26, 1
  s_add_u32 s28, s28, s65
  s_lshl_b32 s28, s28, 10
  v_add_u32 v133, s28, v6
  s_lshr_b32 s28, s26, 2
  s_lshl_b32 s28, s28, 1
  s_add_u32 s28, s28, s65
  s_lshl_b32 s28, s28, 10
  s_and_b32 s29, s26, 1
  s_lshl_b32 s29, s29, 9
  s_add_u32 s28, s28, s29
  s_bfe_u32 s29, s26, 0x10001
  s_lshl_b32 s29, s29, 3
  s_add_u32 s28, s28, s29
  s_add_u32 s28, s28, 15872
  v_lshlrev_b32 v6, 4, v5
  v_add_u32 v6, v6, v4
  v_lshlrev_b32 v6, 4, v6
  v_add_u32 v6, s28, v6
  v_mov_b32 v7, 0x40000000
  v_cmp_le_u32 vcc, 2, v5
  s_nop 1
  v_cndmask_b32 v134, v7, v6, vcc
  v_mov_b32 v135, 0xf149f2ca
  v_lshlrev_b32 v6, 3, v1
  v_add_u32 v136, 145408, v6
  s_mul_i32 s94, s65, 6144
  s_add_u32 s94, s94, 151552
  v_add_u32 v137, s94, v132
  v_cmp_le_u32 s[66:67], 2, v5
  v_lshlrev_b32 v6, 2, v5
  v_sub_u32 v6, v4, v6
  v_cmp_le_i32 s[68:69], 0, v6
  v_cmp_le_i32 s[70:71], 1, v6
  v_cmp_le_i32 s[72:73], 2, v6
  v_cmp_le_i32 s[74:75], 3, v6
  s_nop 1
  s_cmp_eq_u32 s65, 0
  s_cselect_b64 s[76:77], s[68:69], -1
  s_cselect_b64 s[84:85], 0, s[68:69]
  s_cselect_b64 s[78:79], s[70:71], -1
  s_cselect_b64 s[86:87], 0, s[70:71]
  s_cselect_b64 s[80:81], s[72:73], -1
  s_cselect_b64 s[88:89], 0, s[72:73]
  s_cselect_b64 s[82:83], s[74:75], -1
  s_cselect_b64 s[90:91], 0, s[74:75]
  s_mul_i32 s92, s20, 1310720
  s_add_u32 s92, s92, 0xe00000
  s_lshl_b32 s93, s65, 10
  s_mov_b32 s64, 0x3dd53b95
  s_add_u32 s95, s63, s93
  s_add_u32 m0, s94, 0
  s_add_u32 s28, s95, 0
  buffer_load_dwordx4 v132, s[8:11], s28 offen sc1 lds
  s_add_u32 m0, s94, 1024
  s_add_u32 s28, s95, 2048
  buffer_load_dwordx4 v132, s[8:11], s28 offen sc1 lds
  s_add_u32 m0, s94, 2048
  s_add_u32 s28, s95, 4096
  buffer_load_dwordx4 v132, s[8:11], s28 offen sc1 lds
  s_add_u32 m0, s94, 3072
  s_add_u32 s28, s95, 6144
  buffer_load_dwordx4 v132, s[8:11], s28 offen sc1 lds
  s_add_u32 m0, s94, 4096
  s_add_u32 s28, s95, 8192
  buffer_load_dwordx4 v132, s[8:11], s28 offen sc1 lds
  s_add_u32 m0, s94, 5120
  s_add_u32 s28, s95, 10240
  buffer_load_dwordx4 v132, s[8:11], s28 offen sc1 lds
  s_cmp_eq_u32 s21, 3
  s_cbranch_scc1 kaf_x_w3l
kaf_x_w2l:
  ds_read_b128 v[44:47], v129 offset:0
  ds_read_b128 v[48:51], v129 offset:1024
  ds_read_b128 v[52:55], v129 offset:2048
  ds_read_b128 v[56:59], v129 offset:3072
  s_waitcnt lgkmcnt(0)
  s_mov_b32 s45, 0
kaf_x_pf_68:
  buffer_load_dwordx4 v[112:115], v124, s[8:11], s48 offen sc1
  buffer_load_dwordx4 v[116:119], v125, s[8:11], s48 offen sc1
  s_add_u32 s45, s45, 1
  s_waitcnt vmcnt(1)
  ds_write_b128 v127, v[112:115] offset:0
  v_max3_u32 v139, v112, v113, v114
  v_max_u32 v139, v139, v115
  s_waitcnt vmcnt(0)
  ds_write_b128 v127, v[116:119] offset:4096
  v_max3_u32 v139, v139, v116, v117
  v_max3_u32 v139, v139, v118, v119
  v_cmp_eq_u32 vcc, -1, v139
  s_cbranch_vccz kaf_x_pf_68_ok
  s_cmp_lt_u32 s45, 400000
  s_cbranch_scc1 kaf_x_pf_68
  s_branch kaf_abort
kaf_x_pf_68_ok:
  v_smfmac_f32_16x16x64_bf16 v[60:63], v[112:115], a[16:23], v110
  v_smfmac_f32_16x16x64_bf16 v[64:67], v[112:115], a[248:255], v110
  v_smfmac_f32_16x16x64_bf16 v[68:71], v[112:115], a[96:103], v110
  v_smfmac_f32_16x16x64_bf16 v[72:75], v[112:115], v[184:191], v110
  s_waitcnt lgkmcnt(0)
  s_barrier
  v_smfmac_f32_16x16x64_bf16 v[36:39], v[112:115], a[176:183], v110
  ds_read_b128 v[4:7], v128 offset:0
  v_smfmac_f32_16x16x64_bf16 v[40:43], v[112:115], v[224:231], v110
  ds_read_b128 v[8:11], v128 offset:1024
  v_smfmac_f32_16x16x64_bf16 v[60:63], v[116:119], a[48:55], v110
  ds_read_b128 v[12:15], v128 offset:3072
  v_smfmac_f32_16x16x64_bf16 v[64:67], v[116:119], v[160:167], v110
  ds_read_b128 v[16:19], v128 offset:4096
  v_smfmac_f32_16x16x64_bf16 v[68:71], v[116:119], a[128:135], v110
  ds_read_b128 v[20:23], v128 offset:5120
  v_smfmac_f32_16x16x64_bf16 v[72:75], v[116:119], v[200:207], v110
  ds_read_b128 v[24:27], v128 offset:7168
  v_smfmac_f32_16x16x64_bf16 v[36:39], v[116:119], a[208:215], v110
  ds_read_b128 v[28:31], v128 offset:8192
  v_smfmac_f32_16x16x64_bf16 v[40:43], v[116:119], v[240:247], v110
  ds_read_b128 v[32:35], v128 offset:9216
  s_waitcnt lgkmcnt(7)
  v_smfmac_f32_16x16x64_bf16 v[60:63], v[4:7], a[0:7], v110
  v_smfmac_f32_16x16x64_bf16 v[64:67], v[4:7], a[240:247], v110
  s_waitcnt lgkmcnt(6)
  v_smfmac_f32_16x16x64_bf16 v[60:63], v[8:11], a[8:15], v110
  v_smfmac_f32_16x16x64_bf16 v[64:67], v[8:11], v[44:51], v110
  ds_read_b128 v[44:47], v129 offset:4096
  s_waitcnt lgkmcnt(6)
  v_smfmac_f32_16x16x64_bf16 v[60:63], v[12:15], a[24:31], v110
  ds_read_b128 v[48:51], v129 offset:5120
  v_smfmac_f32_16x16x64_bf16 v[64:67], v[12:15], v[52:59], v110
  ds_read_b128 v[52:55], v129 offset:6144
  s_waitcnt lgkmcnt(7)
  v_smfmac_f32_16x16x64_bf16 v[60:63], v[16:19], a[32:39], v110
  ds_read_b128 v[56:59], v129 offset:7168
  v_smfmac_f32_16x16x64_bf16 v[64:67], v[16:19], v[152:159], v110
  s_waitcnt lgkmcnt(7)
  v_smfmac_f32_16x16x64_bf16 v[60:63], v[20:23], a[40:47], v110
  s_waitcnt lgkmcnt(2)
  v_smfmac_f32_16x16x64_bf16 v[64:67], v[20:23], v[44:51], v110
  ds_read_b128 v[44:47], v129 offset:8192
  v_smfmac_f32_16x16x64_bf16 v[60:63], v[24:27], a[56:63], v110
  ds_read_b128 v[48:51], v129 offset:9216
  s_waitcnt lgkmcnt(2)
  v_smfmac_f32_16x16x64_bf16 v[64:67], v[24:27], v[52:59], v110
  ds_read_b128 v[52:55], v129 offset:10240
  v_smfmac_f32_16x16x64_bf16 v[60:63], v[28:31], a[64:71], v110
  ds_read_b128 v[56:59], v129 offset:11264
  v_smfmac_f32_16x16x64_bf16 v[64:67], v[28:31], v[168:175], v110
  v_smfmac_f32_16x16x64_bf16 v[60:63], v[32:35], a[72:79], v110
  s_waitcnt lgkmcnt(2)
  v_smfmac_f32_16x16x64_bf16 v[64:67], v[32:35], v[44:51], v110
  ds_read_b128 v[44:47], v129 offset:12288
  v_smfmac_f32_16x16x64_bf16 v[68:71], v[4:7], a[80:87], v110
  ds_read_b128 v[48:51], v129 offset:13312
  v_smfmac_f32_16x16x64_bf16 v[72:75], v[4:7], v[176:183], v110
  v_permlane32_swap_b32 v60, v64
  v_smfmac_f32_16x16x64_bf16 v[68:71], v[8:11], a[88:95], v110
  s_waitcnt lgkmcnt(2)
  v_smfmac_f32_16x16x64_bf16 v[72:75], v[8:11], v[52:59], v110
  ds_read_b128 v[52:55], v129 offset:14336
  v_permlane32_swap_b32 v61, v65
  v_smfmac_f32_16x16x64_bf16 v[68:71], v[12:15], a[104:111], v110
  ds_read_b128 v[56:59], v129 offset:15360
  s_waitcnt lgkmcnt(2)
  v_smfmac_f32_16x16x64_bf16 v[72:75], v[12:15], v[44:51], v110
  ds_read_b128 v[44:47], v129 offset:16384
  v_permlane32_swap_b32 v62, v66
  v_smfmac_f32_16x16x64_bf16 v[68:71], v[16:19], a[112:119], v110
  ds_read_b128 v[48:51], v129 offset:17408
  v_permlane32_swap_b32 v63, v67
  v_smfmac_f32_16x16x64_bf16 v[72:75], v[16:19], v[192:199], v110
  v_add_f32 v60, v60, v64
  v_smfmac_f32_16x16x64_bf16 v[68:71], v[20:23], a[120:127], v110
  v_add_f32 v61, v61, v65
  s_waitcnt lgkmcnt(2)
  v_smfmac_f32_16x16x64_bf16 v[72:75], v[20:23], v[52:59], v110
  ds_read_b128 v[52:55], v129 offset:18432
  v_add_f32 v62, v62, v66
  v_smfmac_f32_16x16x64_bf16 v[68:71], v[24:27], a[136:143], v110
  ds_read_b128 v[56:59], v129 offset:19456
  v_add_f32 v63, v63, v67
  s_waitcnt lgkmcnt(2)
  v_smfmac_f32_16x16x64_bf16 v[72:75], v[24:27], v[44:51], v110
  ds_read_b128 v[44:47], v129 offset:20480
  v_cvt_pk_bf16_f32 v100, v60, v61
  v_smfmac_f32_16x16x64_bf16 v[68:71], v[28:31], a[144:151], v110
  ds_read_b128 v[48:51], v129 offset:21504
  v_cvt_pk_bf16_f32 v101, v62, v63
  v_smfmac_f32_16x16x64_bf16 v[72:75], v[28:31], v[208:215], v110
  v_smfmac_f32_16x16x64_bf16 v[68:71], v[32:35], a[152:159], v110
  s_waitcnt lgkmcnt(2)
  v_smfmac_f32_16x16x64_bf16 v[72:75], v[32:35], v[52:59], v110
  ds_read_b128 v[52:55], v129 offset:22528
  v_smfmac_f32_16x16x64_bf16 v[36:39], v[4:7], a[160:167], v110
  ds_read_b128 v[56:59], v129 offset:23552
  v_smfmac_f32_16x16x64_bf16 v[40:43], v[4:7], v[216:223], v110
  v_permlane32_swap_b32 v68, v72
  v_smfmac_f32_16x16x64_bf16 v[36:39], v[8:11], a[168:175], v110
  s_waitcnt lgkmcnt(2)
  v_smfmac_f32_16x16x64_bf16 v[40:43], v[8:11], v[44:51], v110
  ds_read_b128 v[44:47], v129 offset:24576
  v_permlane32_swap_b32 v69, v73
  v_smfmac_f32_16x16x64_bf16 v[36:39], v[12:15], a[184:191], v110
  ds_read_b128 v[48:51], v129 offset:25600
  s_waitcnt lgkmcnt(2)
  v_smfmac_f32_16x16x64_bf16 v[40:43], v[12:15], v[52:59], v110
  ds_read_b128 v[52:55], v129 offset:26624
  v_permlane32_swap_b32 v70, v74
  v_smfmac_f32_16x16x64_bf16 v[36:39], v[16:19], a[192:199], v110
  ds_read_b128 v[56:59], v129 offset:27648
  v_permlane32_swap_b32 v71, v75
  v_smfmac_f32_16x16x64_bf16 v[40:43], v[16:19], v[232:239], v110
  v_add_f32 v68, v68, v72
  v_smfmac_f32_16x16x64_bf16 v[36:39], v[20:23], a[200:207], v110
  v_add_f32 v69, v69, v73
  s_waitcnt lgkmcnt(2)
  v_smfmac_f32_16x16x64_bf16 v[40:43], v[20:23], v[44:51], v110
  ds_read_b128 v[44:47], v129 offset:28672
  v_add_f32 v70, v70, v74
  v_smfmac_f32_16x16x64_bf16 v[36:39], v[24:27], a[216:223], v110
  ds_read_b128 v[48:51], v129 offset:29696
  v_add_f32 v71, v71, v75
  s_waitcnt lgkmcnt(2)
  v_smfmac_f32_16x16x64_bf16 v[40:43], v[24:27], v[52:59], v110
  v_cvt_pk_bf16_f32 v102, v68, v69
  v_smfmac_f32_16x16x64_bf16 v[36:39], v[28:31], a[224:231], v110
  v_cvt_pk_bf16_f32 v103, v70, v71
  v_smfmac_f32_16x16x64_bf16 v[40:43], v[28:31], v[248:255], v110
  v_smfmac_f32_16x16x64_bf16 v[36:39], v[32:35], a[232:239], v110
  s_waitcnt lgkmcnt(0)
  v_smfmac_f32_16x16x64_bf16 v[40:43], v[32:35], v[44:51], v110
  v_mfma_f32_16x16x16_bf16 v[142:145], v[100:101], v[108:109], 0
  v_mfma_f32_16x16x16_bf16 v[146:149], v[102:103], v[108:109], 0
  s_nop 1
  v_permlane32_swap_b32 v36, v40
  v_permlane32_swap_b32 v37, v41
  v_permlane32_swap_b32 v38, v42
  v_permlane32_swap_b32 v39, v43
  v_add_f32 v36, v36, v40
  v_add_f32 v37, v37, v41
  v_add_f32 v38, v38, v42
  v_add_f32 v39, v39, v43
  v_cvt_pk_bf16_f32 v104, v36, v37
  v_cvt_pk_bf16_f32 v105, v38, v39
  v_cvt_pk_bf16_f32 v44, v142, v143
  v_cvt_pk_bf16_f32 v45, v144, v145
  v_mfma_f32_16x16x16_bf16 v[142:145], v[104:105], v[108:109], 0
  v_cvt_pk_bf16_f32 v46, v146, v147
  v_cvt_pk_bf16_f32 v47, v148, v149
  ds_write_b64 v131, v[44:45]
  ds_write_b64 v131, v[46:47] offset:512
  v_mfma_f32_16x16x32_bf16 v[76:79], v[44:47], v[44:47], 0
  v_mfma_f32_16x16x32_bf16 v[80:83], v[88:91], v[44:47], 0
  v_mfma_f32_16x16x32_bf16 v[84:87], v[92:95], v[44:47], 0
  v_cvt_pk_bf16_f32 v106, v142, v143
  v_cvt_pk_bf16_f32 v107, v144, v145
  ds_write_b64 v131, v[106:107] offset:1024
  s_nop 0
  v_mfma_f32_16x16x16_bf16 v[76:79], v[106:107], v[106:107], v[76:79]
  v_mfma_f32_16x16x16_bf16 v[80:83], v[96:97], v[106:107], v[80:83]
  v_mfma_f32_16x16x16_bf16 v[84:87], v[98:99], v[106:107], v[84:87]
  s_nop 6
  ds_write_b128 v130, v[76:79] offset:0
  ds_write_b128 v130, v[80:83] offset:1024
  s_nop 0
  ds_write_b128 v130, v[84:87] offset:2048
  s_mov_b32 s28, s50
  buffer_load_dwordx4 v[4:7], v132, s[8:11], s28 offen sc1
  buffer_load_dwordx4 v[8:11], v132, s[8:11], s28 offen offset:1024 sc1
  s_add_u32 s28, s28, 2048
  buffer_load_dwordx4 v[12:15], v132, s[8:11], s28 offen sc1
  buffer_load_dwordx4 v[16:19], v132, s[8:11], s28 offen offset:1024 sc1
  s_add_u32 s28, s28, 2048
  buffer_load_dwordx4 v[20:23], v132, s[8:11], s28 offen sc1
  buffer_load_dwordx4 v[24:27], v132, s[8:11], s28 offen offset:1024 sc1
  s_add_u32 s28, s28, 2048
  buffer_load_dwordx4 v[28:31], v132, s[8:11], s28 offen sc1
  buffer_load_dwordx4 v[32:35], v132, s[8:11], s28 offen offset:1024 sc1
  s_add_u32 s28, s28, 2048
  buffer_load_dwordx4 v[36:39], v132, s[8:11], s28 offen sc1
  buffer_load_dwordx4 v[40:43], v132, s[8:11], s28 offen offset:1024 sc1
  s_add_u32 s28, s28, 2048
  buffer_load_dwordx4 v[60:63], v132, s[8:11], s28 offen sc1
  buffer_load_dwordx4 v[64:67], v132, s[8:11], s28 offen offset:1024 sc1
  s_add_u32 s28, s28, 2048
  s_waitcnt lgkmcnt(0)
  s_barrier
  ds_read_b64 v[76:77], v136 offset:0
  ds_read_b64 v[78:79], v136 offset:512
  ds_read_b64 v[80:81], v136 offset:1024
  ds_read_b64 v[82:83], v136 offset:1536
  ds_read_b64 v[84:85], v136 offset:2048
  ds_read_b64 v[86:87], v136 offset:2560
  ds_read_b64 v[88:89], v136 offset:3072
  ds_read_b64 v[90:91], v136 offset:3584
  ds_read_b64 v[92:93], v136 offset:4096
  ds_read_b64 v[94:95], v136 offset:4608
  ds_read_b64 v[96:97], v136 offset:5120
  ds_read_b64 v[98:99], v136 offset:5632
  ds_read_b128 v[44:47], v137 offset:0
  ds_read_b128 v[48:51], v137 offset:1024
  ds_read_b128 v[52:55], v137 offset:2048
  s_waitcnt lgkmcnt(3)
  ds_read_b128 v[56:59], v137 offset:3072
  ds_read_b128 v[68:71], v137 offset:4096
  ds_read_b128 v[72:75], v137 offset:5120
  s_waitcnt lgkmcnt(0)
  s_cmp_ge_u32 s51, 63
  s_cbranch_scc1 xq_69
  s_add_u32 s96, s51, 1
  s_cmp_gt_u32 s52, s96
  s_cbranch_scc1 kaf_x_wp_70_ok
  s_mov_b32 s45, 0
kaf_x_wp_70_spin:
  buffer_load_dword v2, v138, s[8:11], 0 offen sc1
  s_add_u32 s45, s45, 1
  s_waitcnt vmcnt(0)
  v_min_u32_dpp v3, v2, v2 quad_perm:[1,0,3,2] row_mask:0xf bank_mask:0xf
  s_nop 1
  v_min_u32_dpp v2, v3, v3 quad_perm:[2,3,0,1] row_mask:0xf bank_mask:0xf
  s_nop 1
  v_min_u32_dpp v3, v2, v2 row_half_mirror row_mask:0xf bank_mask:0xf
  s_nop 1
  v_min_u32_dpp v2, v3, v3 quad_perm:[0,1,2,3] row_mask:0xf bank_mask:0xf
  s_nop 0
  v_readfirstlane_b32 s52, v2
  s_cmp_gt_u32 s52, s96
  s_cbranch_scc1 kaf_x_wp_70_ok
  s_cmp_lt_u32 s45, 400000
  s_cbranch_scc1 kaf_x_wp_70_spin
  s_branch kaf_abort
kaf_x_wp_70_ok:
  s_add_u32 s95, s63, s93
  s_add_u32 s95, s95, 12288
  s_add_u32 m0, s94, 0
  s_add_u32 s28, s95, 0
  buffer_load_dwordx4 v132, s[8:11], s28 offen sc1 lds
  s_add_u32 m0, s94, 1024
  s_add_u32 s28, s95, 2048
  buffer_load_dwordx4 v132, s[8:11], s28 offen sc1 lds
  s_add_u32 m0, s94, 2048
  s_add_u32 s28, s95, 4096
  buffer_load_dwordx4 v132, s[8:11], s28 offen sc1 lds
  s_add_u32 m0, s94, 3072
  s_add_u32 s28, s95, 6144
  buffer_load_dwordx4 v132, s[8:11], s28 offen sc1 lds
  s_add_u32 m0, s94, 4096
  s_add_u32 s28, s95, 8192
  buffer_load_dwordx4 v132, s[8:11], s28 offen sc1 lds
  s_add_u32 m0, s94, 5120
  s_add_u32 s28, s95, 10240
  buffer_load_dwordx4 v132, s[8:11], s28 offen sc1 lds
  s_branch xq_69_j
xq_69:
  s_waitcnt vmcnt(0)
xq_69_j:
  s_waitcnt vmcnt(16)
  v_mfma_f32_16x16x32_bf16 v[112:115], v[76:79], v[44:47], 0
  v_mfma_f32_16x16x32_bf16 v[116:119], v[4:7], v[44:47], 0
  v_mfma_f32_16x16x32_bf16 v[120:123], v[8:11], v[44:47], 0
  s_waitcnt vmcnt(14)
  v_mfma_f32_16x16x32_bf16 v[112:115], v[80:83], v[48:51], v[112:115]
  v_mfma_f32_16x16x32_bf16 v[116:119], v[12:15], v[48:51], v[116:119]
  v_mfma_f32_16x16x32_bf16 v[120:123], v[16:19], v[48:51], v[120:123]
  s_waitcnt vmcnt(12)
  v_mfma_f32_16x16x32_bf16 v[112:115], v[84:87], v[52:55], v[112:115]
  v_mfma_f32_16x16x32_bf16 v[116:119], v[20:23], v[52:55], v[116:119]
  v_mfma_f32_16x16x32_bf16 v[120:123], v[24:27], v[52:55], v[120:123]
  s_waitcnt vmcnt(10)
  v_mfma_f32_16x16x32_bf16 v[112:115], v[88:91], v[56:59], v[112:115]
  v_mfma_f32_16x16x32_bf16 v[116:119], v[28:31], v[56:59], v[116:119]
  v_mfma_f32_16x16x32_bf16 v[120:123], v[32:35], v[56:59], v[120:123]
  s_waitcnt vmcnt(8)
  v_mfma_f32_16x16x32_bf16 v[112:115], v[92:95], v[68:71], v[112:115]
  v_mfma_f32_16x16x32_bf16 v[116:119], v[36:39], v[68:71], v[116:119]
  v_mfma_f32_16x16x32_bf16 v[120:123], v[40:43], v[68:71], v[120:123]
  s_waitcnt vmcnt(6)
  v_mfma_f32_16x16x32_bf16 v[112:115], v[96:99], v[72:75], v[112:115]
  v_mfma_f32_16x16x32_bf16 v[116:119], v[60:63], v[72:75], v[116:119]
  v_mfma_f32_16x16x32_bf16 v[120:123], v[64:67], v[72:75], v[120:123]
  s_nop 8
  v_cndmask_b32 v112, v135, v112, s[66:67]
  v_cndmask_b32 v113, v135, v113, s[66:67]
  v_cndmask_b32 v114, v135, v114, s[66:67]
  v_cndmask_b32 v115, v135, v115, s[66:67]
  v_cndmask_b32 v116, v135, v116, s[76:77]
  v_cndmask_b32 v120, v135, v120, s[84:85]
  v_cndmask_b32 v117, v135, v117, s[78:79]
  v_cndmask_b32 v121, v135, v121, s[86:87]
  v_cndmask_b32 v118, v135, v118, s[80:81]
  v_cndmask_b32 v122, v135, v122, s[88:89]
  v_cndmask_b32 v119, v135, v119, s[82:83]
  v_cndmask_b32 v123, v135, v123, s[90:91]
  v_max3_f32 v4, v112, v113, v114
  v_max3_f32 v5, v115, v116, v117
  v_max3_f32 v6, v118, v119, v120
  v_max3_f32 v7, v121, v122, v123
  v_max3_f32 v4, v4, v5, v6
  v_max_f32 v4, v4, v7
  v_mov_b32 v5, v4
  s_nop 1
  v_permlane16_swap_b32 v4, v5
  v_max_f32 v4, v4, v5
  v_mov_b32 v5, v4
  s_nop 1
  v_permlane32_swap_b32 v4, v5
  v_max_f32 v4, v4, v5
  v_mul_f32 v4, s64, v4
  v_fma_f32 v112, v112, s64, -v4
  v_fma_f32 v113, v113, s64, -v4
  v_fma_f32 v114, v114, s64, -v4
  v_fma_f32 v115, v115, s64, -v4
  v_fma_f32 v116, v116, s64, -v4
  v_fma_f32 v117, v117, s64, -v4
  v_fma_f32 v118, v118, s64, -v4
  v_fma_f32 v119, v119, s64, -v4
  v_fma_f32 v120, v120, s64, -v4
  v_fma_f32 v121, v121, s64, -v4
  v_fma_f32 v122, v122, s64, -v4
  v_fma_f32 v123, v123, s64, -v4
  v_exp_f32 v112, v112
  v_exp_f32 v113, v113
  v_exp_f32 v114, v114
  v_exp_f32 v115, v115
  v_exp_f32 v116, v116
  v_exp_f32 v117, v117
  v_exp_f32 v118, v118
  v_exp_f32 v119, v119
  v_exp_f32 v120, v120
  v_exp_f32 v121, v121
  v_exp_f32 v122, v122
  v_exp_f32 v123, v123
  v_add_f32 v5, v112, v113
  v_add_f32 v6, v114, v115
  v_add_f32 v7, v116, v117
  v_add_f32 v8, v118, v119
  v_add_f32 v9, v120, v121
  v_add_f32 v10, v122, v123
  v_add_f32 v5, v5, v6
  v_add_f32 v7, v7, v8
  v_add_f32 v9, v9, v10
  v_add_f32 v5, v5, v7
  v_add_f32 v5, v5, v9
  v_mov_b32 v6, v5
  s_nop 1
  v_permlane16_swap_b32 v5, v6
  v_add_f32 v5, v5, v6
  v_mov_b32 v6, v5
  s_nop 1
  v_permlane32_swap_b32 v5, v6
  v_add_f32 v5, v5, v6
  v_rcp_f32 v5, v5
  s_nop 0
  v_mul_f32 v112, v112, v5
  v_mul_f32 v113, v113, v5
  v_mul_f32 v114, v114, v5
  v_mul_f32 v115, v115, v5
  v_mul_f32 v116, v116, v5
  v_mul_f32 v117, v117, v5
  v_mul_f32 v118, v118, v5
  v_mul_f32 v119, v119, v5
  v_mul_f32 v120, v120, v5
  v_mul_f32 v121, v121, v5
  v_mul_f32 v122, v122, v5
  v_mul_f32 v123, v123, v5
  v_cvt_pk_bf16_f32 v8, v112, v113
  v_cvt_pk_bf16_f32 v9, v114, v115
  v_cvt_pk_bf16_f32 v10, v116, v117
  v_cvt_pk_bf16_f32 v11, v118, v119
  v_cvt_pk_bf16_f32 v12, v120, v121
  v_cvt_pk_bf16_f32 v13, v122, v123
  buffer_store_dwordx2 v[10:11], v133, s[8:11], s92 offen
  buffer_store_dwordx2 v[12:13], v133, s[8:11], s92 offen offset:256
  buffer_store_dwordx2 v[8:9], v134, s[8:11], s92 offen
  s_add_u32 s92, s92, 20480
  s_cmp_ge_u32 s51, 63
  s_cbranch_scc1 kaf_x_done
  v_mov_b32 v60, 0
  v_mov_b32 v61, 0
  v_mov_b32 v62, 0
  v_mov_b32 v63, 0
  v_mov_b32 v64, 0
  v_mov_b32 v65, 0
  v_mov_b32 v66, 0
  v_mov_b32 v67, 0
  v_mov_b32 v68, 0
  v_mov_b32 v69, 0
  v_mov_b32 v70, 0
  v_mov_b32 v71, 0
  v_mov_b32 v72, 0
  v_mov_b32 v73, 0
  v_mov_b32 v74, 0
  v_mov_b32 v75, 0
  v_mov_b32 v36, 0
  v_mov_b32 v37, 0
  v_mov_b32 v38, 0
  v_mov_b32 v39, 0
  v_mov_b32 v40, 0
  v_mov_b32 v41, 0
  v_mov_b32 v42, 0
  v_mov_b32 v43, 0
  s_add_u32 s97, s97, 10240
  s_mov_b32 s48, s97
  s_add_u32 s49, s49, 5120
  s_add_u32 s50, s50, 12288
  s_add_u32 s63, s63, 12288
  s_add_u32 s51, s51, 1
  s_cmp_gt_u32 s52, s51
  s_cbranch_scc1 kaf_x_wp_71_ok
  s_mov_b32 s45, 0
kaf_x_wp_71_spin:
  buffer_load_dword v2, v138, s[8:11], 0 offen sc1
  s_add_u32 s45, s45, 1
  s_waitcnt vmcnt(0)
  v_min_u32_dpp v3, v2, v2 quad_perm:[1,0,3,2] row_mask:0xf bank_mask:0xf
  s_nop 1
  v_min_u32_dpp v2, v3, v3 quad_perm:[2,3,0,1] row_mask:0xf bank_mask:0xf
  s_nop 1
  v_min_u32_dpp v3, v2, v2 row_half_mirror row_mask:0xf bank_mask:0xf
  s_nop 1
  v_min_u32_dpp v2, v3, v3 quad_perm:[0,1,2,3] row_mask:0xf bank_mask:0xf
  s_nop 0
  v_readfirstlane_b32 s52, v2
  s_cmp_gt_u32 s52, s51
  s_cbranch_scc1 kaf_x_wp_71_ok
  s_cmp_lt_u32 s45, 400000
  s_cbranch_scc1 kaf_x_wp_71_spin
  s_branch kaf_abort
kaf_x_wp_71_ok:
  s_add_u32 s28, s50, s53
  buffer_load_dwordx2 v[88:89], v132, s[8:11], s28 offen offset:0 sc1
  buffer_load_dwordx2 v[92:93], v132, s[8:11], s28 offen offset:1024 sc1
  s_add_u32 s28, s50, s54
  buffer_load_dwordx2 v[90:91], v132, s[8:11], s28 offen offset:0 sc1
  buffer_load_dwordx2 v[94:95], v132, s[8:11], s28 offen offset:1024 sc1
  s_add_u32 s28, s50, s55
  buffer_load_dwordx2 v[96:97], v132, s[8:11], s28 offen offset:0 sc1
  buffer_load_dwordx2 v[98:99], v132, s[8:11], s28 offen offset:1024 sc1
  s_branch kaf_x_w2l
kaf_x_w3l:
  ds_read_b128 v[44:47], v129 offset:2048
  ds_read_b128 v[48:51], v129 offset:3072
  ds_read_b128 v[52:55], v129 offset:12288
  ds_read_b128 v[56:59], v129 offset:13312
  s_waitcnt lgkmcnt(0)
  s_mov_b32 s45, 0
kaf_x_pf_72:
  buffer_load_dwordx4 v[112:115], v124, s[8:11], s48 offen sc1
  buffer_load_dwordx4 v[116:119], v125, s[8:11], s48 offen sc1
  s_add_u32 s45, s45, 1
  s_waitcnt vmcnt(1)
  ds_write_b128 v127, v[112:115] offset:0
  v_max3_u32 v139, v112, v113, v114
  v_max_u32 v139, v139, v115
  s_waitcnt vmcnt(0)
  ds_write_b128 v127, v[116:119] offset:4096
  v_max3_u32 v139, v139, v116, v117
  v_max3_u32 v139, v139, v118, v119
  v_cmp_eq_u32 vcc, -1, v139
  s_cbranch_vccz kaf_x_pf_72_ok
  s_cmp_lt_u32 s45, 400000
  s_cbranch_scc1 kaf_x_pf_72
  s_branch kaf_abort
kaf_x_pf_72_ok:
  v_smfmac_f32_16x16x64_bf16 v[60:63], v[112:115], a[24:31], v110
  v_smfmac_f32_16x16x64_bf16 v[64:67], v[112:115], v[44:51], v110
  ds_read_b128 v[44:47], v129 offset:22528
  v_smfmac_f32_16x16x64_bf16 v[68:71], v[112:115], a[104:111], v110
  ds_read_b128 v[48:51], v129 offset:23552
  v_smfmac_f32_16x16x64_bf16 v[72:75], v[112:115], v[52:59], v110
  ds_read_b128 v[52:55], v129 offset:6144
  s_waitcnt lgkmcnt(3)
  s_barrier
  v_smfmac_f32_16x16x64_bf16 v[36:39], v[112:115], a[184:191], v110
  ds_read_b128 v[56:59], v129 offset:7168
  ds_read_b128 v[4:7], v128 offset:0
  s_waitcnt lgkmcnt(3)
  v_smfmac_f32_16x16x64_bf16 v[40:43], v[112:115], v[44:51], v110
  ds_read_b128 v[44:47], v129 offset:16384
  ds_read_b128 v[8:11], v128 offset:1024
  v_smfmac_f32_16x16x64_bf16 v[60:63], v[116:119], a[56:63], v110
  ds_read_b128 v[48:51], v129 offset:17408
  ds_read_b128 v[12:15], v128 offset:2048
  s_waitcnt lgkmcnt(5)
  v_smfmac_f32_16x16x64_bf16 v[64:67], v[116:119], v[52:59], v110
  ds_read_b128 v[52:55], v129 offset:26624
  ds_read_b128 v[16:19], v128 offset:4096
  v_smfmac_f32_16x16x64_bf16 v[68:71], v[116:119], a[136:143], v110
  ds_read_b128 v[56:59], v129 offset:27648
  ds_read_b128 v[20:23], v128 offset:5120
  s_waitcnt lgkmcnt(5)
  v_smfmac_f32_16x16x64_bf16 v[72:75], v[116:119], v[44:51], v110
  ds_read_b128 v[44:47], v129 offset:0
  ds_read_b128 v[24:27], v128 offset:6144
  v_smfmac_f32_16x16x64_bf16 v[36:39], v[116:119], a[216:223], v110
  ds_read_b128 v[48:51], v129 offset:1024
  ds_read_b128 v[28:31], v128 offset:8192
  s_waitcnt lgkmcnt(5)
  v_smfmac_f32_16x16x64_bf16 v[40:43], v[116:119], v[52:59], v110
  ds_read_b128 v[52:55], v129 offset:4096
  ds_read_b128 v[32:35], v128 offset:9216
  v_smfmac_f32_16x16x64_bf16 v[60:63], v[4:7], a[0:7], v110
  ds_read_b128 v[56:59], v129 offset:5120
  v_smfmac_f32_16x16x64_bf16 v[64:67], v[4:7], a[240:247], v110
  v_smfmac_f32_16x16x64_bf16 v[60:63], v[8:11], a[8:15], v110
  s_waitcnt lgkmcnt(4)
  v_smfmac_f32_16x16x64_bf16 v[64:67], v[8:11], v[44:51], v110
  ds_read_b128 v[44:47], v129 offset:8192
  v_smfmac_f32_16x16x64_bf16 v[60:63], v[12:15], a[16:23], v110
  ds_read_b128 v[48:51], v129 offset:9216
  v_smfmac_f32_16x16x64_bf16 v[64:67], v[12:15], a[248:255], v110
  v_smfmac_f32_16x16x64_bf16 v[60:63], v[16:19], a[32:39], v110
  v_smfmac_f32_16x16x64_bf16 v[64:67], v[16:19], v[152:159], v110
  v_smfmac_f32_16x16x64_bf16 v[60:63], v[20:23], a[40:47], v110
  s_waitcnt lgkmcnt(2)
  v_smfmac_f32_16x16x64_bf16 v[64:67], v[20:23], v[52:59], v110
  ds_read_b128 v[52:55], v129 offset:10240
  v_smfmac_f32_16x16x64_bf16 v[60:63], v[24:27], a[48:55], v110
  ds_read_b128 v[56:59], v129 offset:11264
  v_smfmac_f32_16x16x64_bf16 v[64:67], v[24:27], v[160:167], v110
  v_smfmac_f32_16x16x64_bf16 v[60:63], v[28:31], a[64:71], v110
  v_smfmac_f32_16x16x64_bf16 v[64:67], v[28:31], v[168:175], v110
  v_smfmac_f32_16x16x64_bf16 v[60:63], v[32:35], a[72:79], v110
  s_waitcnt lgkmcnt(2)
  v_smfmac_f32_16x16x64_bf16 v[64:67], v[32:35], v[44:51], v110
  ds_read_b128 v[44:47], v129 offset:14336
  v_smfmac_f32_16x16x64_bf16 v[68:71], v[4:7], a[80:87], v110
  ds_read_b128 v[48:51], v129 offset:15360
  v_smfmac_f32_16x16x64_bf16 v[72:75], v[4:7], v[176:183], v110
  v_permlane32_swap_b32 v60, v64
  v_smfmac_f32_16x16x64_bf16 v[68:71], v[8:11], a[88:95], v110
  s_waitcnt lgkmcnt(2)
  v_smfmac_f32_16x16x64_bf16 v[72:75], v[8:11], v[52:59], v110
  ds_read_b128 v[52:55], v129 offset:18432
  v_permlane32_swap_b32 v61, v65
  v_smfmac_f32_16x16x64_bf16 v[68:71], v[12:15], a[96:103], v110
  ds_read_b128 v[56:59], v129 offset:19456
  v_smfmac_f32_16x16x64_bf16 v[72:75], v[12:15], v[184:191], v110
  v_permlane32_swap_b32 v62, v66
  v_smfmac_f32_16x16x64_bf16 v[68:71], v[16:19], a[112:119], v110
  v_permlane32_swap_b32 v63, v67
  v_smfmac_f32_16x16x64_bf16 v[72:75], v[16:19], v[192:199], v110
  v_add_f32 v60, v60, v64
  v_smfmac_f32_16x16x64_bf16 v[68:71], v[20:23], a[120:127], v110
  v_add_f32 v61, v61, v65
  s_waitcnt lgkmcnt(2)
  v_smfmac_f32_16x16x64_bf16 v[72:75], v[20:23], v[44:51], v110
  ds_read_b128 v[44:47], v129 offset:20480
  v_add_f32 v62, v62, v66
  v_smfmac_f32_16x16x64_bf16 v[68:71], v[24:27], a[128:135], v110
  ds_read_b128 v[48:51], v129 offset:21504
  v_add_f32 v63, v63, v67
  v_smfmac_f32_16x16x64_bf16 v[72:75], v[24:27], v[200:207], v110
  v_cvt_pk_bf16_f32 v100, v60, v61
  v_smfmac_f32_16x16x64_bf16 v[68:71], v[28:31], a[144:151], v110
  v_cvt_pk_bf16_f32 v101, v62, v63
  v_smfmac_f32_16x16x64_bf16 v[72:75], v[28:31], v[208:215], v110
  v_smfmac_f32_16x16x64_bf16 v[68:71], v[32:35], a[152:159], v110
  s_waitcnt lgkmcnt(2)
  v_smfmac_f32_16x16x64_bf16 v[72:75], v[32:35], v[52:59], v110
  ds_read_b128 v[52:55], v129 offset:24576
  v_smfmac_f32_16x16x64_bf16 v[36:39], v[4:7], a[160:167], v110
  ds_read_b128 v[56:59], v129 offset:25600
  v_smfmac_f32_16x16x64_bf16 v[40:43], v[4:7], v[216:223], v110
  v_permlane32_swap_b32 v68, v72
  v_smfmac_f32_16x16x64_bf16 v[36:39], v[8:11], a[168:175], v110
  s_waitcnt lgkmcnt(2)
  v_smfmac_f32_16x16x64_bf16 v[40:43], v[8:11], v[44:51], v110
  ds_read_b128 v[44:47], v129 offset:28672
  v_permlane32_swap_b32 v69, v73
  v_smfmac_f32_16x16x64_bf16 v[36:39], v[12:15], a[176:183], v110
  ds_read_b128 v[48:51], v129 offset:29696
  v_smfmac_f32_16x16x64_bf16 v[40:43], v[12:15], v[224:231], v110
  v_permlane32_swap_b32 v70, v74
  v_smfmac_f32_16x16x64_bf16 v[36:39], v[16:19], a[192:199], v110
  v_permlane32_swap_b32 v71, v75
  v_smfmac_f32_16x16x64_bf16 v[40:43], v[16:19], v[232:239], v110
  v_add_f32 v68, v68, v72
  v_smfmac_f32_16x16x64_bf16 v[36:39], v[20:23], a[200:207], v110
  v_add_f32 v69, v69, v73
  s_waitcnt lgkmcnt(2)
  v_smfmac_f32_16x16x64_bf16 v[40:43], v[20:23], v[52:59], v110
  v_add_f32 v70, v70, v74
  v_smfmac_f32_16x16x64_bf16 v[36:39], v[24:27], a[208:215], v110
  v_add_f32 v71, v71, v75
  v_smfmac_f32_16x16x64_bf16 v[40:43], v[24:27], v[240:247], v110
  v_cvt_pk_bf16_f32 v102, v68, v69
  v_smfmac_f32_16x16x64_bf16 v[36:39], v[28:31], a[224:231], v110
  v_cvt_pk_bf16_f32 v103, v70, v71
  v_smfmac_f32_16x16x64_bf16 v[40:43], v[28:31], v[248:255], v110
  v_smfmac_f32_16x16x64_bf16 v[36:39], v[32:35], a[232:239], v110
  s_waitcnt lgkmcnt(0)
  v_smfmac_f32_16x16x64_bf16 v[40:43], v[32:35], v[44:51], v110
  v_mfma_f32_16x16x16_bf16 v[142:145], v[100:101], v[108:109], 0
  v_mfma_f32_16x16x16_bf16 v[146:149], v[102:103], v[108:109], 0
  s_nop 1
  v_permlane32_swap_b32 v36, v40
  v_permlane32_swap_b32 v37, v41
  v_permlane32_swap_b32 v38, v42
  v_permlane32_swap_b32 v39, v43
  v_add_f32 v36, v36, v40
  v_add_f32 v37, v37, v41
  v_add_f32 v38, v38, v42
  v_add_f32 v39, v39, v43
  v_cvt_pk_bf16_f32 v104, v36, v37
  v_cvt_pk_bf16_f32 v105, v38, v39
  v_cvt_pk_bf16_f32 v44, v142, v143
  v_cvt_pk_bf16_f32 v45, v144, v145
  v_mfma_f32_16x16x16_bf16 v[142:145], v[104:105], v[108:109], 0
  v_cvt_pk_bf16_f32 v46, v146, v147
  v_cvt_pk_bf16_f32 v47, v148, v149
  ds_write_b64 v131, v[44:45]
  ds_write_b64 v131, v[46:47] offset:512
  v_mfma_f32_16x16x32_bf16 v[76:79], v[44:47], v[44:47], 0
  v_mfma_f32_16x16x32_bf16 v[80:83], v[88:91], v[44:47], 0
  v_mfma_f32_16x16x32_bf16 v[84:87], v[92:95], v[44:47], 0
  v_cvt_pk_bf16_f32 v106, v142, v143
  v_cvt_pk_bf16_f32 v107, v144, v145
  ds_write_b64 v131, v[106:107] offset:1024
  s_nop 0
  v_mfma_f32_16x16x16_bf16 v[76:79], v[106:107], v[106:107], v[76:79]
  v_mfma_f32_16x16x16_bf16 v[80:83], v[96:97], v[106:107], v[80:83]
  v_mfma_f32_16x16x16_bf16 v[84:87], v[98:99], v[106:107], v[84:87]
  s_nop 6
  ds_write_b128 v130, v[76:79] offset:0
  ds_write_b128 v130, v[80:83] offset:1024
  s_nop 0
  ds_write_b128 v130, v[84:87] offset:2048
  s_mov_b32 s28, s50
  buffer_load_dwordx4 v[4:7], v132, s[8:11], s28 offen sc1
  buffer_load_dwordx4 v[8:11], v132, s[8:11], s28 offen offset:1024 sc1
  s_add_u32 s28, s28, 2048
  buffer_load_dwordx4 v[12:15], v132, s[8:11], s28 offen sc1
  buffer_load_dwordx4 v[16:19], v132, s[8:11], s28 offen offset:1024 sc1
  s_add_u32 s28, s28, 2048
  buffer_load_dwordx4 v[20:23], v132, s[8:11], s28 offen sc1
  buffer_load_dwordx4 v[24:27], v132, s[8:11], s28 offen offset:1024 sc1
  s_add_u32 s28, s28, 2048
  buffer_load_dwordx4 v[28:31], v132, s[8:11], s28 offen sc1
  buffer_load_dwordx4 v[32:35], v132, s[8:11], s28 offen offset:1024 sc1
  s_add_u32 s28, s28, 2048
  buffer_load_dwordx4 v[36:39], v132, s[8:11], s28 offen sc1
  buffer_load_dwordx4 v[40:43], v132, s[8:11], s28 offen offset:1024 sc1
  s_add_u32 s28, s28, 2048
  buffer_load_dwordx4 v[60:63], v132, s[8:11], s28 offen sc1
  buffer_load_dwordx4 v[64:67], v132, s[8:11], s28 offen offset:1024 sc1
  s_add_u32 s28, s28, 2048
  s_waitcnt lgkmcnt(0)
  s_barrier
  ds_read_b64 v[76:77], v136 offset:0
  ds_read_b64 v[78:79], v136 offset:512
  ds_read_b64 v[80:81], v136 offset:1024
  ds_read_b64 v[82:83], v136 offset:1536
  ds_read_b64 v[84:85], v136 offset:2048
  ds_read_b64 v[86:87], v136 offset:2560
  ds_read_b64 v[88:89], v136 offset:3072
  ds_read_b64 v[90:91], v136 offset:3584
  ds_read_b64 v[92:93], v136 offset:4096
  ds_read_b64 v[94:95], v136 offset:4608
  ds_read_b64 v[96:97], v136 offset:5120
  ds_read_b64 v[98:99], v136 offset:5632
  ds_read_b128 v[44:47], v137 offset:0
  ds_read_b128 v[48:51], v137 offset:1024
  ds_read_b128 v[52:55], v137 offset:2048
  s_waitcnt lgkmcnt(3)
  ds_read_b128 v[56:59], v137 offset:3072
  ds_read_b128 v[68:71], v137 offset:4096
  ds_read_b128 v[72:75], v137 offset:5120
  s_waitcnt lgkmcnt(0)
  s_cmp_ge_u32 s51, 63
  s_cbranch_scc1 xq_73
  s_add_u32 s96, s51, 1
  s_cmp_gt_u32 s52, s96
  s_cbranch_scc1 kaf_x_wp_74_ok
  s_mov_b32 s45, 0
kaf_x_wp_74_spin:
  buffer_load_dword v2, v138, s[8:11], 0 offen sc1
  s_add_u32 s45, s45, 1
  s_waitcnt vmcnt(0)
  v_min_u32_dpp v3, v2, v2 quad_perm:[1,0,3,2] row_mask:0xf bank_mask:0xf
  s_nop 1
  v_min_u32_dpp v2, v3, v3 quad_perm:[2,3,0,1] row_mask:0xf bank_mask:0xf
  s_nop 1
  v_min_u32_dpp v3, v2, v2 row_half_mirror row_mask:0xf bank_mask:0xf
  s_nop 1
  v_min_u32_dpp v2, v3, v3 quad_perm:[0,1,2,3] row_mask:0xf bank_mask:0xf
  s_nop 0
  v_readfirstlane_b32 s52, v2
  s_cmp_gt_u32 s52, s96
  s_cbranch_scc1 kaf_x_wp_74_ok
  s_cmp_lt_u32 s45, 400000
  s_cbranch_scc1 kaf_x_wp_74_spin
  s_branch kaf_abort
kaf_x_wp_74_ok:
  s_add_u32 s95, s63, s93
  s_add_u32 s95, s95, 12288
  s_add_u32 m0, s94, 0
  s_add_u32 s28, s95, 0
  buffer_load_dwordx4 v132, s[8:11], s28 offen sc1 lds
  s_add_u32 m0, s94, 1024
  s_add_u32 s28, s95, 2048
  buffer_load_dwordx4 v132, s[8:11], s28 offen sc1 lds
  s_add_u32 m0, s94, 2048
  s_add_u32 s28, s95, 4096
  buffer_load_dwordx4 v132, s[8:11], s28 offen sc1 lds
  s_add_u32 m0, s94, 3072
  s_add_u32 s28, s95, 6144
  buffer_load_dwordx4 v132, s[8:11], s28 offen sc1 lds
  s_add_u32 m0, s94, 4096
  s_add_u32 s28, s95, 8192
  buffer_load_dwordx4 v132, s[8:11], s28 offen sc1 lds
  s_add_u32 m0, s94, 5120
  s_add_u32 s28, s95, 10240
  buffer_load_dwordx4 v132, s[8:11], s28 offen sc1 lds
  s_branch xq_73_j
xq_73:
  s_waitcnt vmcnt(0)
xq_73_j:
  s_waitcnt vmcnt(16)
  v_mfma_f32_16x16x32_bf16 v[112:115], v[76:79], v[44:47], 0
  v_mfma_f32_16x16x32_bf16 v[116:119], v[4:7], v[44:47], 0
  v_mfma_f32_16x16x32_bf16 v[120:123], v[8:11], v[44:47], 0
  s_waitcnt vmcnt(14)
  v_mfma_f32_16x16x32_bf16 v[112:115], v[80:83], v[48:51], v[112:115]
  v_mfma_f32_16x16x32_bf16 v[116:119], v[12:15], v[48:51], v[116:119]
  v_mfma_f32_16x16x32_bf16 v[120:123], v[16:19], v[48:51], v[120:123]
  s_waitcnt vmcnt(12)
  v_mfma_f32_16x16x32_bf16 v[112:115], v[84:87], v[52:55], v[112:115]
  v_mfma_f32_16x16x32_bf16 v[116:119], v[20:23], v[52:55], v[116:119]
  v_mfma_f32_16x16x32_bf16 v[120:123], v[24:27], v[52:55], v[120:123]
  s_waitcnt vmcnt(10)
  v_mfma_f32_16x16x32_bf16 v[112:115], v[88:91], v[56:59], v[112:115]
  v_mfma_f32_16x16x32_bf16 v[116:119], v[28:31], v[56:59], v[116:119]
  v_mfma_f32_16x16x32_bf16 v[120:123], v[32:35], v[56:59], v[120:123]
  s_waitcnt vmcnt(8)
  v_mfma_f32_16x16x32_bf16 v[112:115], v[92:95], v[68:71], v[112:115]
  v_mfma_f32_16x16x32_bf16 v[116:119], v[36:39], v[68:71], v[116:119]
  v_mfma_f32_16x16x32_bf16 v[120:123], v[40:43], v[68:71], v[120:123]
  s_waitcnt vmcnt(6)
  v_mfma_f32_16x16x32_bf16 v[112:115], v[96:99], v[72:75], v[112:115]
  v_mfma_f32_16x16x32_bf16 v[116:119], v[60:63], v[72:75], v[116:119]
  v_mfma_f32_16x16x32_bf16 v[120:123], v[64:67], v[72:75], v[120:123]
  s_nop 8
  v_cndmask_b32 v112, v135, v112, s[66:67]
  v_cndmask_b32 v113, v135, v113, s[66:67]
  v_cndmask_b32 v114, v135, v114, s[66:67]
  v_cndmask_b32 v115, v135, v115, s[66:67]
  v_cndmask_b32 v116, v135, v116, s[76:77]
  v_cndmask_b32 v120, v135, v120, s[84:85]
  v_cndmask_b32 v117, v135, v117, s[78:79]
  v_cndmask_b32 v121, v135, v121, s[86:87]
  v_cndmask_b32 v118, v135, v118, s[80:81]
  v_cndmask_b32 v122, v135, v122, s[88:89]
  v_cndmask_b32 v119, v135, v119, s[82:83]
  v_cndmask_b32 v123, v135, v123, s[90:91]
  v_max3_f32 v4, v112, v113, v114
  v_max3_f32 v5, v115, v116, v117
  v_max3_f32 v6, v118, v119, v120
  v_max3_f32 v7, v121, v122, v123
  v_max3_f32 v4, v4, v5, v6
  v_max_f32 v4, v4, v7
  v_mov_b32 v5, v4
  s_nop 1
  v_permlane16_swap_b32 v4, v5
  v_max_f32 v4, v4, v5
  v_mov_b32 v5, v4
  s_nop 1
  v_permlane32_swap_b32 v4, v5
  v_max_f32 v4, v4, v5
  v_mul_f32 v4, s64, v4
  v_fma_f32 v112, v112, s64, -v4
  v_fma_f32 v113, v113, s64, -v4
  v_fma_f32 v114, v114, s64, -v4
  v_fma_f32 v115, v115, s64, -v4
  v_fma_f32 v116, v116, s64, -v4
  v_fma_f32 v117, v117, s64, -v4
  v_fma_f32 v118, v118, s64, -v4
  v_fma_f32 v119, v119, s64, -v4
  v_fma_f32 v120, v120, s64, -v4
  v_fma_f32 v121, v121, s64, -v4
  v_fma_f32 v122, v122, s64, -v4
  v_fma_f32 v123, v123, s64, -v4
  v_exp_f32 v112, v112
  v_exp_f32 v113, v113
  v_exp_f32 v114, v114
  v_exp_f32 v115, v115
  v_exp_f32 v116, v116
  v_exp_f32 v117, v117
  v_exp_f32 v118, v118
  v_exp_f32 v119, v119
  v_exp_f32 v120, v120
  v_exp_f32 v121, v121
  v_exp_f32 v122, v122
  v_exp_f32 v123, v123
  v_add_f32 v5, v112, v113
  v_add_f32 v6, v114, v115
  v_add_f32 v7, v116, v117
  v_add_f32 v8, v118, v119
  v_add_f32 v9, v120, v121
  v_add_f32 v10, v122, v123
  v_add_f32 v5, v5, v6
  v_add_f32 v7, v7, v8
  v_add_f32 v9, v9, v10
  v_add_f32 v5, v5, v7
  v_add_f32 v5, v5, v9
  v_mov_b32 v6, v5
  s_nop 1
  v_permlane16_swap_b32 v5, v6
  v_add_f32 v5, v5, v6
  v_mov_b32 v6, v5
  s_nop 1
  v_permlane32_swap_b32 v5, v6
  v_add_f32 v5, v5, v6
  v_rcp_f32 v5, v5
  s_nop 0
  v_mul_f32 v112, v112, v5
  v_mul_f32 v113, v113, v5
  v_mul_f32 v114, v114, v5
  v_mul_f32 v115, v115, v5
  v_mul_f32 v116, v116, v5
  v_mul_f32 v117, v117, v5
  v_mul_f32 v118, v118, v5
  v_mul_f32 v119, v119, v5
  v_mul_f32 v120, v120, v5
  v_mul_f32 v121, v121, v5
  v_mul_f32 v122, v122, v5
  v_mul_f32 v123, v123, v5
  v_cvt_pk_bf16_f32 v8, v112, v113
  v_cvt_pk_bf16_f32 v9, v114, v115
  v_cvt_pk_bf16_f32 v10, v116, v117
  v_cvt_pk_bf16_f32 v11, v118, v119
  v_cvt_pk_bf16_f32 v12, v120, v121
  v_cvt_pk_bf16_f32 v13, v122, v123
  buffer_store_dwordx2 v[10:11], v133, s[8:11], s92 offen
  buffer_store_dwordx2 v[12:13], v133, s[8:11], s92 offen offset:256
  buffer_store_dwordx2 v[8:9], v134, s[8:11], s92 offen
  s_add_u32 s92, s92, 20480
  s_cmp_ge_u32 s51, 63
  s_cbranch_scc1 kaf_x_done
  v_mov_b32 v60, 0
  v_mov_b32 v61, 0
  v_mov_b32 v62, 0
  v_mov_b32 v63, 0
  v_mov_b32 v64, 0
  v_mov_b32 v65, 0
  v_mov_b32 v66, 0
  v_mov_b32 v67, 0
  v_mov_b32 v68, 0
  v_mov_b32 v69, 0
  v_mov_b32 v70, 0
  v_mov_b32 v71, 0
  v_mov_b32 v72, 0
  v_mov_b32 v73, 0
  v_mov_b32 v74, 0
  v_mov_b32 v75, 0
  v_mov_b32 v36, 0
  v_mov_b32 v37, 0
  v_mov_b32 v38, 0
  v_mov_b32 v39, 0
  v_mov_b32 v40, 0
  v_mov_b32 v41, 0
  v_mov_b32 v42, 0
  v_mov_b32 v43, 0
  s_add_u32 s97, s97, 10240
  s_mov_b32 s48, s97
  s_add_u32 s49, s49, 5120
  s_add_u32 s50, s50, 12288
  s_add_u32 s63, s63, 12288
  s_add_u32 s51, s51, 1
  s_cmp_gt_u32 s52, s51
  s_cbranch_scc1 kaf_x_wp_75_ok
  s_mov_b32 s45, 0
kaf_x_wp_75_spin:
  buffer_load_dword v2, v138, s[8:11], 0 offen sc1
  s_add_u32 s45, s45, 1
  s_waitcnt vmcnt(0)
  v_min_u32_dpp v3, v2, v2 quad_perm:[1,0,3,2] row_mask:0xf bank_mask:0xf
  s_nop 1
  v_min_u32_dpp v2, v3, v3 quad_perm:[2,3,0,1] row_mask:0xf bank_mask:0xf
  s_nop 1
  v_min_u32_dpp v3, v2, v2 row_half_mirror row_mask:0xf bank_mask:0xf
  s_nop 1
  v_min_u32_dpp v2, v3, v3 quad_perm:[0,1,2,3] row_mask:0xf bank_mask:0xf
  s_nop 0
  v_readfirstlane_b32 s52, v2
  s_cmp_gt_u32 s52, s51
  s_cbranch_scc1 kaf_x_wp_75_ok
  s_cmp_lt_u32 s45, 400000
  s_cbranch_scc1 kaf_x_wp_75_spin
  s_branch kaf_abort
kaf_x_wp_75_ok:
  s_add_u32 s28, s50, s53
  buffer_load_dwordx2 v[88:89], v132, s[8:11], s28 offen offset:0 sc1
  buffer_load_dwordx2 v[92:93], v132, s[8:11], s28 offen offset:1024 sc1
  s_add_u32 s28, s50, s54
  buffer_load_dwordx2 v[90:91], v132, s[8:11], s28 offen offset:0 sc1
  buffer_load_dwordx2 v[94:95], v132, s[8:11], s28 offen offset:1024 sc1
  s_add_u32 s28, s50, s55
  buffer_load_dwordx2 v[96:97], v132, s[8:11], s28 offen offset:0 sc1
  buffer_load_dwordx2 v[98:99], v132, s[8:11], s28 offen offset:1024 sc1
  s_branch kaf_x_w3l
kaf_x_done:
  s_waitcnt vmcnt(0) lgkmcnt(0)
  s_branch kaf_exit
kaf_y:
  v_and_b32 v1, 63, v0
  v_lshlrev_b32 v178, 4, v1
  s_and_b32 s28, s21, 1
  s_lshl_b32 s46, s23, 1
  s_add_u32 s46, s46, s28
  s_lshr_b32 s28, s21, 1
  s_lshl_b32 s28, s28, 2
  s_lshl_b32 s47, s20, 3
  s_add_u32 s47, s47, s28
  s_mul_i32 s28, s47, 40
  s_add_u32 s28, s28, s46
  s_mul_i32 s28, s28, 20480
  s_add_u32 s28, s28, 0x2e00000
  s_add_u32 s29, s28, 0
  buffer_load_dwordx4 a[0:3], v178, s[8:11], s29 offen
  buffer_load_dwordx4 a[4:7], v178, s[8:11], s29 offen offset:1024
  s_add_u32 s29, s28, 2048
  buffer_load_dwordx4 a[8:11], v178, s[8:11], s29 offen
  buffer_load_dwordx4 a[12:15], v178, s[8:11], s29 offen offset:1024
  s_add_u32 s29, s28, 4096
  buffer_load_dwordx4 a[16:19], v178, s[8:11], s29 offen
  buffer_load_dwordx4 a[20:23], v178, s[8:11], s29 offen offset:1024
  s_add_u32 s29, s28, 6144
  buffer_load_dwordx4 a[24:27], v178, s[8:11], s29 offen
  buffer_load_dwordx4 a[28:31], v178, s[8:11], s29 offen offset:1024
  s_add_u32 s29, s28, 8192
  buffer_load_dwordx4 a[32:35], v178, s[8:11], s29 offen
  buffer_load_dwordx4 a[36:39], v178, s[8:11], s29 offen offset:1024
  s_add_u32 s29, s28, 10240
  buffer_load_dwordx4 a[40:43], v178, s[8:11], s29 offen
  buffer_load_dwordx4 a[44:47], v178, s[8:11], s29 offen offset:1024
  s_add_u32 s29, s28, 12288
  buffer_load_dwordx4 a[48:51], v178, s[8:11], s29 offen
  buffer_load_dwordx4 a[52:55], v178, s[8:11], s29 offen offset:1024
  s_add_u32 s29, s28, 14336
  buffer_load_dwordx4 a[56:59], v178, s[8:11], s29 offen
  buffer_load_dwordx4 a[60:63], v178, s[8:11], s29 offen offset:1024
  s_add_u32 s29, s28, 16384
  buffer_load_dwordx4 a[64:67], v178, s[8:11], s29 offen
  buffer_load_dwordx4 a[68:71], v178, s[8:11], s29 offen offset:1024
  s_add_u32 s29, s28, 18432
  buffer_load_dwordx4 a[72:75], v178, s[8:11], s29 offen
  buffer_load_dwordx4 a[76:79], v178, s[8:11], s29 offen offset:1024
  s_add_u32 s29, s28, 819200
  buffer_load_dwordx4 a[80:83], v178, s[8:11], s29 offen
  buffer_load_dwordx4 a[84:87], v178, s[8:11], s29 offen offset:1024
  s_add_u32 s29, s28, 821248
  buffer_load_dwordx4 a[88:91], v178, s[8:11], s29 offen
  buffer_load_dwordx4 a[92:95], v178, s[8:11], s29 offen offset:1024
  s_add_u32 s29, s28, 823296
  buffer_load_dwordx4 a[96:99], v178, s[8:11], s29 offen
  buffer_load_dwordx4 a[100:103], v178, s[8:11], s29 offen offset:1024
  s_add_u32 s29, s28, 825344
  buffer_load_dwordx4 a[104:107], v178, s[8:11], s29 offen
  buffer_load_dwordx4 a[108:111], v178, s[8:11], s29 offen offset:1024
  s_add_u32 s29, s28, 827392
  buffer_load_dwordx4 a[112:115], v178, s[8:11], s29 offen
  buffer_load_dwordx4 a[116:119], v178, s[8:11], s29 offen offset:1024
  s_add_u32 s29, s28, 829440
  buffer_load_dwordx4 a[120:123], v178, s[8:11], s29 offen
  buffer_load_dwordx4 a[124:127], v178, s[8:11], s29 offen offset:1024
  s_add_u32 s29, s28, 831488
  buffer_load_dwordx4 a[128:131], v178, s[8:11], s29 offen
  buffer_load_dwordx4 a[132:135], v178, s[8:11], s29 offen offset:1024
  s_add_u32 s29, s28, 833536
  buffer_load_dwordx4 a[136:139], v178, s[8:11], s29 offen
  buffer_load_dwordx4 a[140:143], v178, s[8:11], s29 offen offset:1024
  s_add_u32 s29, s28, 835584
  buffer_load_dwordx4 a[144:147], v178, s[8:11], s29 offen
  buffer_load_dwordx4 a[148:151], v178, s[8:11], s29 offen offset:1024
  s_add_u32 s29, s28, 837632
  buffer_load_dwordx4 a[152:155], v178, s[8:11], s29 offen
  buffer_load_dwordx4 a[156:159], v178, s[8:11], s29 offen offset:1024
  s_waitcnt vmcnt(30)
  s_add_u32 s29, s28, 1638400
  buffer_load_dwordx4 a[160:163], v178, s[8:11], s29 offen
  buffer_load_dwordx4 a[164:167], v178, s[8:11], s29 offen offset:1024
  s_add_u32 s29, s28, 1640448
  buffer_load_dwordx4 a[168:171], v178, s[8:11], s29 offen
  buffer_load_dwordx4 a[172:175], v178, s[8:11], s29 offen offset:1024
  s_add_u32 s29, s28, 1642496
  buffer_load_dwordx4 a[176:179], v178, s[8:11], s29 offen
  buffer_load_dwordx4 a[180:183], v178, s[8:11], s29 offen offset:1024
  s_add_u32 s29, s28, 1644544
  buffer_load_dwordx4 a[184:187], v178, s[8:11], s29 offen
  buffer_load_dwordx4 a[188:191], v178, s[8:11], s29 offen offset:1024
  s_add_u32 s29, s28, 1646592
  buffer_load_dwordx4 a[192:195], v178, s[8:11], s29 offen
  buffer_load_dwordx4 a[196:199], v178, s[8:11], s29 offen offset:1024
  s_add_u32 s29, s28, 1648640
  buffer_load_dwordx4 a[200:203], v178, s[8:11], s29 offen
  buffer_load_dwordx4 a[204:207], v178, s[8:11], s29 offen offset:1024
  s_add_u32 s29, s28, 1650688
  buffer_load_dwordx4 a[208:211], v178, s[8:11], s29 offen
  buffer_load_dwordx4 a[212:215], v178, s[8:11], s29 offen offset:1024
  s_add_u32 s29, s28, 1652736
  buffer_load_dwordx4 a[216:219], v178, s[8:11], s29 offen
  buffer_load_dwordx4 a[220:223], v178, s[8:11], s29 offen offset:1024
  s_add_u32 s29, s28, 1654784
  buffer_load_dwordx4 a[224:227], v178, s[8:11], s29 offen
  buffer_load_dwordx4 a[228:231], v178, s[8:11], s29 offen offset:1024
  s_add_u32 s29, s28, 1656832
  buffer_load_dwordx4 a[232:235], v178, s[8:11], s29 offen
  buffer_load_dwordx4 a[236:239], v178, s[8:11], s29 offen offset:1024
  s_waitcnt vmcnt(30)
  s_add_u32 s29, s28, 2457600
  buffer_load_dwordx4 a[240:243], v178, s[8:11], s29 offen
  buffer_load_dwordx4 a[244:247], v178, s[8:11], s29 offen offset:1024
  s_add_u32 s29, s28, 2459648
  buffer_load_dwordx4 a[248:251], v178, s[8:11], s29 offen
  buffer_load_dwordx4 a[252:255], v178, s[8:11], s29 offen offset:1024
  s_add_u32 s29, s28, 2461696
  buffer_load_dwordx4 v[192:195], v178, s[8:11], s29 offen
  buffer_load_dwordx4 v[196:199], v178, s[8:11], s29 offen offset:1024
  s_add_u32 s29, s28, 2463744
  buffer_load_dwordx4 v[200:203], v178, s[8:11], s29 offen
  buffer_load_dwordx4 v[204:207], v178, s[8:11], s29 offen offset:1024
  s_add_u32 s29, s28, 2465792
  buffer_load_dwordx4 v[208:211], v178, s[8:11], s29 offen
  buffer_load_dwordx4 v[212:215], v178, s[8:11], s29 offen offset:1024
  s_add_u32 s29, s28, 2467840
  buffer_load_dwordx4 v[216:219], v178, s[8:11], s29 offen
  buffer_load_dwordx4 v[220:223], v178, s[8:11], s29 offen offset:1024
  s_add_u32 s29, s28, 2469888
  buffer_load_dwordx4 v[224:227], v178, s[8:11], s29 offen
  buffer_load_dwordx4 v[228:231], v178, s[8:11], s29 offen offset:1024
  s_add_u32 s29, s28, 2471936
  buffer_load_dwordx4 v[232:235], v178, s[8:11], s29 offen
  buffer_load_dwordx4 v[236:239], v178, s[8:11], s29 offen offset:1024
  s_add_u32 s29, s28, 2473984
  buffer_load_dwordx4 v[240:243], v178, s[8:11], s29 offen
  buffer_load_dwordx4 v[244:247], v178, s[8:11], s29 offen offset:1024
  s_add_u32 s29, s28, 2476032
  buffer_load_dwordx4 v[248:251], v178, s[8:11], s29 offen
  buffer_load_dwordx4 v[252:255], v178, s[8:11], s29 offen offset:1024
  s_waitcnt vmcnt(30)
  v_mov_b32 v172, 0x44444444
  v_mov_b32 v2, 0xeeeeeeee
  v_and_b32 v3, 8, v1
  v_cmp_ne_u32 vcc, 0, v3
  s_nop 1
  v_cndmask_b32 v172, v172, v2, vcc
  s_lshl_b32 s28, s21, 10
  v_add_u32 v173, s28, v178
  v_add_u32 v174, 4096, v173
  v_add_u32 v175, 8192, v173
  v_add_u32 v176, 0, v173
  v_add_u32 v177, 0, v178
  v_add_u32 v179, 10240, v173
  s_xor_b32 s28, s21, 2
  s_lshl_b32 s28, s28, 10
  s_add_u32 s28, s28, 10240
  v_add_u32 v180, s28, v178
  v_and_b32 v4, 15, v1
  v_lshrrev_b32 v5, 4, v1
  v_and_b32 v6, 7, v1
  v_lshlrev_b32 v7, 3, v5
  v_add_u32 v7, v7, v6
  v_lshlrev_b32 v185, 4, v7
  v_add_u32 v182, 4096, v178
  v_mov_b32 v8, 0x40000000
  v_cmp_gt_u32 vcc, 8, v4
  s_nop 1
  v_cndmask_b32 v184, v8, v185, vcc
  v_lshlrev_b32 v7, 4, v4
  v_lshlrev_b32 v9, 2, v5
  v_add_u32 v7, v7, v9
  v_cndmask_b32 v186, v8, v7, vcc
  s_lshl_b32 s28, s20, 5
  s_add_u32 s28, s28, 3072
  v_lshlrev_b32 v7, 2, v6
  v_add_u32 v187, s28, v7
  v_and_b32 v7, 1, v5
  v_lshlrev_b32 v7, 10, v7
  v_lshrrev_b32 v9, 1, v5
  v_lshlrev_b32 v9, 5, v9
  v_add_u32 v9, v9, v4
  v_lshlrev_b32 v9, 4, v9
  v_add_u32 v189, v7, v9
  v_mov_b32 v44, 0
  v_mov_b32 v45, 0
  v_mov_b32 v46, 0
  v_mov_b32 v47, 0
  v_mov_b32 v48, 0
  v_mov_b32 v49, 0
  v_mov_b32 v50, 0
  v_mov_b32 v51, 0
  v_mov_b32 v52, 0
  v_mov_b32 v53, 0
  v_mov_b32 v54, 0
  v_mov_b32 v55, 0
  v_mov_b32 v56, 0
  v_mov_b32 v57, 0
  v_mov_b32 v58, 0
  v_mov_b32 v59, 0
  s_mul_i32 s97, s20, 655360
  s_add_u32 s97, s97, 0x400000
  s_mov_b32 s48, 0x4000
  s_mul_i32 s49, s20, 327680
  s_add_u32 s49, s49, 0x700000
  s_mul_i32 s50, s20, 327680
  s_lshl_b32 s28, s46, 10
  s_add_u32 s50, s50, s28
  s_add_u32 s50, s50, 0x9000000
  s_mov_b32 s51, 0
  s_mov_b32 s52, 0
  s_mov_b32 s53, 0
  v_mov_b32 v2, 5056
  s_mov_b32 s45, 0
kaf_y_sel:
  buffer_load_dword v3, v2, s[8:11], 0 offen sc1
  s_add_u32 s45, s45, 1
  s_waitcnt vmcnt(0)
  v_readfirstlane_b32 s61, v3
  s_cmp_lg_u32 s61, 0
  s_cbranch_scc1 kaf_y_selok
  s_cmp_lt_u32 s45, 20000
  s_cbranch_scc1 kaf_y_sel
kaf_y_selok:
  s_and_b32 s61, s61, 2
  s_lshl_b32 s61, s61, 12
  s_add_u32 s29, s20, 0
  s_and_b32 s29, s29, 3
  s_mul_i32 s29, s29, 20
  s_add_u32 s29, s29, s23
  s_lshr_b32 s28, s29, 3
  s_lshl_b32 s28, s28, 14
  s_and_b32 s29, s29, 7
  s_lshl_b32 s29, s29, 10
  s_add_u32 s28, s28, s29
  s_and_b32 s29, s21, 1
  s_lshl_b32 s29, s29, 9
  s_add_u32 s28, s28, s29
  s_add_u32 s28, s28, s61
  s_add_u32 s56, s28, 0xa00000
  s_mov_b32 s66, s56
  s_add_u32 s29, s20, 1
  s_and_b32 s29, s29, 3
  s_mul_i32 s29, s29, 20
  s_add_u32 s29, s29, s23
  s_lshr_b32 s28, s29, 3
  s_lshl_b32 s28, s28, 14
  s_and_b32 s29, s29, 7
  s_lshl_b32 s29, s29, 10
  s_add_u32 s28, s28, s29
  s_and_b32 s29, s21, 1
  s_lshl_b32 s29, s29, 9
  s_add_u32 s28, s28, s29
  s_add_u32 s28, s28, s61
  s_add_u32 s57, s28, 0xa00000
  s_mov_b32 s67, s57
  s_add_u32 s29, s20, 2
  s_and_b32 s29, s29, 3
  s_mul_i32 s29, s29, 20
  s_add_u32 s29, s29, s23
  s_lshr_b32 s28, s29, 3
  s_lshl_b32 s28, s28, 14
  s_and_b32 s29, s29, 7
  s_lshl_b32 s29, s29, 10
  s_add_u32 s28, s28, s29
  s_and_b32 s29, s21, 1
  s_lshl_b32 s29, s29, 9
  s_add_u32 s28, s28, s29
  s_add_u32 s28, s28, s61
  s_add_u32 s58, s28, 0xa00000
  s_mov_b32 s68, s58
  s_add_u32 s29, s20, 3
  s_and_b32 s29, s29, 3
  s_mul_i32 s29, s29, 20
  s_add_u32 s29, s29, s23
  s_lshr_b32 s28, s29, 3
  s_lshl_b32 s28, s28, 14
  s_and_b32 s29, s29, 7
  s_lshl_b32 s29, s29, 10
  s_add_u32 s28, s28, s29
  s_and_b32 s29, s21, 1
  s_lshl_b32 s29, s29, 9
  s_add_u32 s28, s28, s29
  s_add_u32 s28, s28, s61
  s_add_u32 s59, s28, 0xa00000
  s_mov_b32 s69, s59
  v_mov_b32 v124, -1
  v_mov_b32 v125, -1
  v_mov_b32 v126, -1
  v_mov_b32 v127, -1
  s_lshr_b32 s28, s46, 2
  s_lshl_b32 s28, s28, 10
  s_and_b32 s29, s46, 3
  s_lshl_b32 s29, s29, 8
  s_add_u32 s28, s28, s29
  s_add_u32 s60, s28, s97
  s_add_u32 s60, s60, 10240
  s_and_b32 s28, s21, 1
  s_lshl_b32 s28, s28, 10
  s_add_u32 s28, s28, 32768
  v_add_u32 v181, s28, v178
  v_add_u32 v183, 65536, v178
  s_waitcnt vmcnt(0)
  s_cmp_ge_u32 s21, 2
  s_cbranch_scc1 kaf_y_tok
kaf_y_crit:
  s_mov_b32 s45, 0
kaf_y_pf_76:
  buffer_load_dwordx4 v[160:163], v173, s[8:11], s48 offen sc1
  buffer_load_dwordx4 v[164:167], v174, s[8:11], s48 offen sc1
  buffer_load_dwordx4 v[168:171], v175, s[8:11], s48 offen sc1
  s_add_u32 s45, s45, 1
  s_waitcnt vmcnt(2)
  ds_write_b128 v176, v[160:163] offset:0
  v_max3_u32 v190, v160, v161, v162
  v_max_u32 v190, v190, v163
  s_waitcnt vmcnt(1)
  ds_write_b128 v176, v[164:167] offset:4096
  v_max3_u32 v190, v190, v164, v165
  v_max3_u32 v190, v190, v166, v167
  s_waitcnt vmcnt(0)
  ds_write_b128 v176, v[168:171] offset:8192
  v_max3_u32 v190, v190, v168, v169
  v_max3_u32 v190, v190, v170, v171
  v_cmp_eq_u32 vcc, -1, v190
  s_cbranch_vccz kaf_y_pf_76_ok
  s_cmp_lt_u32 s45, 400000
  s_cbranch_scc1 kaf_y_pf_76
  s_branch kaf_abort
kaf_y_pf_76_ok:
  s_waitcnt lgkmcnt(0)
  s_barrier
  ds_read_b128 v[4:7], v177 offset:0
  ds_read_b128 v[8:11], v177 offset:1024
  ds_read_b128 v[12:15], v177 offset:2048
  ds_read_b128 v[16:19], v177 offset:3072
  ds_read_b128 v[20:23], v177 offset:4096
  ds_read_b128 v[24:27], v177 offset:5120
  ds_read_b128 v[28:31], v177 offset:6144
  ds_read_b128 v[32:35], v177 offset:7168
  ds_read_b128 v[36:39], v177 offset:8192
  ds_read_b128 v[40:43], v177 offset:9216
  s_cmp_lt_u32 s51, 2
  s_cbranch_scc1 kaf_y_norst
  s_sub_u32 s28, s51, 2
  s_and_b32 s28, s28, 3
  s_mul_i32 s28, s28, 163840
  s_add_u32 s28, s28, s56
  buffer_store_dwordx4 v[124:127], v184, s[8:11], s28 offen sc1
kaf_y_norst:
  s_waitcnt lgkmcnt(9)
  v_smfmac_f32_16x16x64_bf16 v[44:47], v[4:7], a[0:7], v172
  v_smfmac_f32_16x16x64_bf16 v[48:51], v[4:7], a[80:87], v172
  v_smfmac_f32_16x16x64_bf16 v[52:55], v[4:7], a[160:167], v172
  v_smfmac_f32_16x16x64_bf16 v[56:59], v[4:7], a[240:247], v172
  s_waitcnt lgkmcnt(8)
  v_smfmac_f32_16x16x64_bf16 v[44:47], v[8:11], a[8:15], v172
  v_smfmac_f32_16x16x64_bf16 v[48:51], v[8:11], a[88:95], v172
  v_smfmac_f32_16x16x64_bf16 v[52:55], v[8:11], a[168:175], v172
  v_smfmac_f32_16x16x64_bf16 v[56:59], v[8:11], a[248:255], v172
  s_waitcnt lgkmcnt(7)
  v_smfmac_f32_16x16x64_bf16 v[44:47], v[12:15], a[16:23], v172
  v_smfmac_f32_16x16x64_bf16 v[48:51], v[12:15], a[96:103], v172
  v_smfmac_f32_16x16x64_bf16 v[52:55], v[12:15], a[176:183], v172
  v_smfmac_f32_16x16x64_bf16 v[56:59], v[12:15], v[192:199], v172
  s_waitcnt lgkmcnt(6)
  v_smfmac_f32_16x16x64_bf16 v[44:47], v[16:19], a[24:31], v172
  v_smfmac_f32_16x16x64_bf16 v[48:51], v[16:19], a[104:111], v172
  v_smfmac_f32_16x16x64_bf16 v[52:55], v[16:19], a[184:191], v172
  v_smfmac_f32_16x16x64_bf16 v[56:59], v[16:19], v[200:207], v172
  s_waitcnt lgkmcnt(5)
  v_smfmac_f32_16x16x64_bf16 v[44:47], v[20:23], a[32:39], v172
  v_smfmac_f32_16x16x64_bf16 v[48:51], v[20:23], a[112:119], v172
  v_smfmac_f32_16x16x64_bf16 v[52:55], v[20:23], a[192:199], v172
  v_smfmac_f32_16x16x64_bf16 v[56:59], v[20:23], v[208:215], v172
  s_waitcnt lgkmcnt(4)
  v_smfmac_f32_16x16x64_bf16 v[44:47], v[24:27], a[40:47], v172
  v_smfmac_f32_16x16x64_bf16 v[48:51], v[24:27], a[120:127], v172
  v_smfmac_f32_16x16x64_bf16 v[52:55], v[24:27], a[200:207], v172
  v_smfmac_f32_16x16x64_bf16 v[56:59], v[24:27], v[216:223], v172
  s_waitcnt lgkmcnt(3)
  v_smfmac_f32_16x16x64_bf16 v[44:47], v[28:31], a[48:55], v172
  v_smfmac_f32_16x16x64_bf16 v[48:51], v[28:31], a[128:135], v172
  v_smfmac_f32_16x16x64_bf16 v[52:55], v[28:31], a[208:215], v172
  v_smfmac_f32_16x16x64_bf16 v[56:59], v[28:31], v[224:231], v172
  s_waitcnt lgkmcnt(2)
  v_smfmac_f32_16x16x64_bf16 v[44:47], v[32:35], a[56:63], v172
  v_smfmac_f32_16x16x64_bf16 v[48:51], v[32:35], a[136:143], v172
  v_smfmac_f32_16x16x64_bf16 v[52:55], v[32:35], a[216:223], v172
  v_smfmac_f32_16x16x64_bf16 v[56:59], v[32:35], v[232:239], v172
  s_waitcnt lgkmcnt(1)
  v_smfmac_f32_16x16x64_bf16 v[44:47], v[36:39], a[64:71], v172
  v_smfmac_f32_16x16x64_bf16 v[48:51], v[36:39], a[144:151], v172
  v_smfmac_f32_16x16x64_bf16 v[52:55], v[36:39], a[224:231], v172
  v_smfmac_f32_16x16x64_bf16 v[56:59], v[36:39], v[240:247], v172
  s_waitcnt lgkmcnt(0)
  v_smfmac_f32_16x16x64_bf16 v[44:47], v[40:43], a[72:79], v172
  v_smfmac_f32_16x16x64_bf16 v[48:51], v[40:43], a[152:159], v172
  v_smfmac_f32_16x16x64_bf16 v[52:55], v[40:43], a[232:239], v172
  v_smfmac_f32_16x16x64_bf16 v[56:59], v[40:43], v[248:255], v172
  s_nop 9
  v_permlane32_swap_b32 v44, v48
  v_permlane32_swap_b32 v45, v49
  v_permlane32_swap_b32 v46, v50
  v_permlane32_swap_b32 v47, v51
  v_permlane32_swap_b32 v52, v56
  v_permlane32_swap_b32 v53, v57
  v_permlane32_swap_b32 v54, v58
  v_permlane32_swap_b32 v55, v59
  v_add_f32 v44, v44, v48
  v_add_f32 v45, v45, v49
  v_add_f32 v46, v46, v50
  v_add_f32 v47, v47, v51
  v_add_f32 v52, v52, v56
  v_add_f32 v53, v53, v57
  v_add_f32 v54, v54, v58
  v_add_f32 v55, v55, v59
  v_cvt_pk_bf16_f32 v60, v44, v45
  v_cvt_pk_bf16_f32 v61, v46, v47
  v_cvt_pk_bf16_f32 v62, v52, v53
  v_cvt_pk_bf16_f32 v63, v54, v55
  ds_write_b128 v179, v[60:63]
  v_mov_b32 v44, 0
  v_mov_b32 v45, 0
  v_mov_b32 v46, 0
  v_mov_b32 v47, 0
  v_mov_b32 v48, 0
  v_mov_b32 v49, 0
  v_mov_b32 v50, 0
  v_mov_b32 v51, 0
  v_mov_b32 v52, 0
  v_mov_b32 v53, 0
  v_mov_b32 v54, 0
  v_mov_b32 v55, 0
  v_mov_b32 v56, 0
  v_mov_b32 v57, 0
  v_mov_b32 v58, 0
  v_mov_b32 v59, 0
  s_waitcnt lgkmcnt(0)
  s_barrier
  s_cmp_ge_u32 s51, 63
  s_cbranch_scc1 kaf_y_crit_end
  ds_read_b128 v[64:67], v180
  ds_read_b128 v[68:71], v181 offset:0
  ds_read_b128 v[72:75], v181 offset:2048
  ds_read_b128 v[76:79], v181 offset:4096
  ds_read_b128 v[80:83], v181 offset:6144
  ds_read_b128 v[84:87], v181 offset:8192
  ds_read_b128 v[88:91], v181 offset:10240
  ds_read_b128 v[92:95], v181 offset:12288
  ds_read_b128 v[96:99], v181 offset:14336
  v_xor_b32 v181, 0x4000, v181
  s_mov_b32 s45, 0
yp_77:
  buffer_load_dwordx4 v[100:103], v178, s[8:11], s49 offen offset:0 sc1
  buffer_load_dwordx4 v[104:107], v178, s[8:11], s49 offen offset:1024 sc1
  buffer_load_dwordx4 v[108:111], v178, s[8:11], s49 offen offset:2048 sc1
  buffer_load_dwordx4 v[112:115], v178, s[8:11], s49 offen offset:3072 sc1
  buffer_load_dwordx4 v[116:119], v182, s[8:11], s49 offen sc1
  s_add_u32 s45, s45, 1
  s_waitcnt vmcnt(4) lgkmcnt(0)
  v_mfma_f32_16x16x32_bf16 v[140:143], v[68:71], v[100:103], 0
  v_max_u32 v190, v100, v102
  v_mfma_f32_16x16x32_bf16 v[144:147], v[72:75], v[100:103], 0
  s_waitcnt vmcnt(3)
  v_mfma_f32_16x16x32_bf16 v[140:143], v[76:79], v[104:107], v[140:143]
  v_max3_u32 v190, v190, v104, v106
  v_mfma_f32_16x16x32_bf16 v[144:147], v[80:83], v[104:107], v[144:147]
  s_waitcnt vmcnt(2)
  v_mfma_f32_16x16x32_bf16 v[140:143], v[84:87], v[108:111], v[140:143]
  v_max3_u32 v190, v190, v108, v110
  v_mfma_f32_16x16x32_bf16 v[144:147], v[88:91], v[108:111], v[144:147]
  s_waitcnt vmcnt(1)
  v_mfma_f32_16x16x32_bf16 v[140:143], v[92:95], v[112:115], v[140:143]
  v_max3_u32 v190, v190, v112, v114
  v_mfma_f32_16x16x32_bf16 v[144:147], v[96:99], v[112:115], v[144:147]
  s_waitcnt vmcnt(0)
  v_mfma_f32_16x16x32_bf16 v[140:143], v[60:63], v[116:119], v[140:143]
  v_max3_u32 v190, v190, v116, v117
  v_mfma_f32_16x16x32_bf16 v[144:147], v[64:67], v[116:119], v[144:147]
  v_max3_u32 v190, v190, v118, v119
  v_cmp_eq_u32 vcc, -1, v190
  s_cbranch_vccz yp_77_ok
  s_cmp_lt_u32 s45, 400000
  s_cbranch_scc1 yp_77
  s_branch kaf_abort
yp_77_ok:
  buffer_load_dwordx4 v[148:151], v185, s[8:11], s67 offen sc1
  buffer_load_dwordx4 v[152:155], v185, s[8:11], s68 offen sc1
  buffer_load_dwordx4 v[156:159], v185, s[8:11], s69 offen sc1
  s_nop 1
  v_add_f32_dpp v140, v144, v140 row_ror:8 row_mask:0xf bank_mask:0xf
  v_add_f32_dpp v141, v145, v141 row_ror:8 row_mask:0xf bank_mask:0xf
  v_add_f32_dpp v142, v146, v142 row_ror:8 row_mask:0xf bank_mask:0xf
  v_add_f32_dpp v143, v147, v143 row_ror:8 row_mask:0xf bank_mask:0xf
  buffer_store_dwordx4 v[140:143], v184, s[8:11], s66 offen sc1
  s_mov_b32 s45, 0
  s_waitcnt vmcnt(1)
  s_branch yc_78_chk
yc_78:
  buffer_load_dwordx4 v[148:151], v185, s[8:11], s67 offen sc1
  buffer_load_dwordx4 v[152:155], v185, s[8:11], s68 offen sc1
  buffer_load_dwordx4 v[156:159], v185, s[8:11], s69 offen sc1
  s_add_u32 s45, s45, 1
  s_waitcnt vmcnt(0)
yc_78_chk:
  v_max3_u32 v190, v148, v151, v152
  v_max3_u32 v190, v190, v155, v156
  v_max_u32 v190, v190, v159
  v_add_f32 v160, v140, v148
  v_add_f32 v161, v141, v149
  v_add_f32 v162, v142, v150
  v_add_f32 v163, v143, v151
  v_cmp_eq_u32 vcc, -1, v190
  v_add_f32 v152, v152, v156
  v_add_f32 v153, v153, v157
  v_add_f32 v154, v154, v158
  v_add_f32 v155, v155, v159
  s_cbranch_vccz yc_78_ok
  s_cmp_lt_u32 s45, 400000
  s_cbranch_scc1 yc_78
  s_branch kaf_abort
yc_78_ok:
  v_add_f32 v160, v160, v152
  v_add_f32 v161, v161, v153
  v_add_f32 v162, v162, v154
  v_add_f32 v163, v163, v155
  v_cvt_pk_bf16_f32 v164, v160, v161
  v_cvt_pk_bf16_f32 v165, v162, v163
  buffer_store_dword v164, v186, s[8:11], s60 offen
  buffer_store_dword v165, v186, s[8:11], s60 offen offset:128
  s_add_u32 s97, s97, 10240
  s_mov_b32 s48, s97
  s_add_u32 s60, s60, 10240
  s_add_u32 s49, s49, 5120
  s_add_u32 s28, s51, 1
  s_and_b32 s28, s28, 3
  s_mul_i32 s28, s28, 163840
  s_add_u32 s66, s56, s28
  s_add_u32 s67, s57, s28
  s_add_u32 s68, s58, s28
  s_add_u32 s69, s59, s28
  s_add_u32 s51, s51, 1
  s_branch kaf_y_crit
kaf_y_crit_end:
  s_waitcnt vmcnt(0) lgkmcnt(0)
  s_branch kaf_exit
kaf_y_tok:
  s_mul_i32 s61, s20, 1310720
  s_add_u32 s61, s61, 0xe00000
  s_mul_i32 s62, s20, 5242880
  s_lshl_b32 s28, s46, 11
  s_add_u32 s62, s62, s28
  s_add_u32 s62, s62, 0x1a00000
  s_mov_b32 s54, 0
  s_and_b32 s63, s21, 1
  s_lshl_b32 s63, s63, 10
  s_add_u32 s63, s63, 32768
  s_and_b32 s64, s21, 1
  s_mul_i32 s64, s64, 10240
kaf_y_tokl:
  s_mov_b32 s45, 0
kaf_y_pf_79:
  buffer_load_dwordx4 v[160:163], v173, s[8:11], s48 offen sc1
  buffer_load_dwordx4 v[164:167], v174, s[8:11], s48 offen sc1
  s_add_u32 s45, s45, 1
  s_waitcnt vmcnt(1)
  ds_write_b128 v176, v[160:163] offset:0
  v_max3_u32 v190, v160, v161, v162
  v_max_u32 v190, v190, v163
  s_waitcnt vmcnt(0)
  ds_write_b128 v176, v[164:167] offset:4096
  v_max3_u32 v190, v190, v164, v165
  v_max3_u32 v190, v190, v166, v167
  v_cmp_eq_u32 vcc, -1, v190
  s_cbranch_vccz kaf_y_pf_79_ok
  s_cmp_lt_u32 s45, 400000
  s_cbranch_scc1 kaf_y_pf_79
  s_branch kaf_abort
kaf_y_pf_79_ok:
  s_waitcnt lgkmcnt(0)
  s_barrier
  ds_read_b128 v[4:7], v177 offset:0
  ds_read_b128 v[8:11], v177 offset:1024
  ds_read_b128 v[12:15], v177 offset:2048
  ds_read_b128 v[16:19], v177 offset:3072
  ds_read_b128 v[20:23], v177 offset:4096
  ds_read_b128 v[24:27], v177 offset:5120
  ds_read_b128 v[28:31], v177 offset:6144
  ds_read_b128 v[32:35], v177 offset:7168
  ds_read_b128 v[36:39], v177 offset:8192
  ds_read_b128 v[40:43], v177 offset:9216
  s_cmp_gt_u32 s52, s51
  s_cbranch_scc1 kaf_y_wp_80_ok
  s_mov_b32 s45, 0
kaf_y_wp_80_spin:
  buffer_load_dword v2, v187, s[8:11], 0 offen sc1
  s_add_u32 s45, s45, 1
  s_waitcnt vmcnt(0)
  v_min_u32_dpp v3, v2, v2 quad_perm:[1,0,3,2] row_mask:0xf bank_mask:0xf
  s_nop 1
  v_min_u32_dpp v2, v3, v3 quad_perm:[2,3,0,1] row_mask:0xf bank_mask:0xf
  s_nop 1
  v_min_u32_dpp v3, v2, v2 row_half_mirror row_mask:0xf bank_mask:0xf
  s_nop 1
  v_min_u32_dpp v2, v3, v3 quad_perm:[0,1,2,3] row_mask:0xf bank_mask:0xf
  s_nop 0
  v_readfirstlane_b32 s52, v2
  s_cmp_gt_u32 s52, s51
  s_cbranch_scc1 kaf_y_wp_80_ok
  s_cmp_lt_u32 s45, 400000
  s_cbranch_scc1 kaf_y_wp_80_spin
  s_branch kaf_abort
kaf_y_wp_80_ok:
  s_add_u32 s65, s61, s64
  s_waitcnt lgkmcnt(9)
  v_smfmac_f32_16x16x64_bf16 v[44:47], v[4:7], a[0:7], v172
  s_add_u32 m0, s63, 0
  s_add_u32 s28, s50, 0
  buffer_load_dwordx4 v178, s[8:11], s28 offen sc1 lds
  v_smfmac_f32_16x16x64_bf16 v[48:51], v[4:7], a[80:87], v172
  v_smfmac_f32_16x16x64_bf16 v[52:55], v[4:7], a[160:167], v172
  s_add_u32 m0, s63, 2048
  s_add_u32 s28, s50, 40960
  buffer_load_dwordx4 v178, s[8:11], s28 offen sc1 lds
  v_smfmac_f32_16x16x64_bf16 v[56:59], v[4:7], a[240:247], v172
  s_waitcnt lgkmcnt(8)
  v_smfmac_f32_16x16x64_bf16 v[44:47], v[8:11], a[8:15], v172
  s_add_u32 m0, s63, 4096
  s_add_u32 s28, s50, 81920
  buffer_load_dwordx4 v178, s[8:11], s28 offen sc1 lds
  v_smfmac_f32_16x16x64_bf16 v[48:51], v[8:11], a[88:95], v172
  v_smfmac_f32_16x16x64_bf16 v[52:55], v[8:11], a[168:175], v172
  s_add_u32 m0, s63, 6144
  s_add_u32 s28, s50, 122880
  buffer_load_dwordx4 v178, s[8:11], s28 offen sc1 lds
  v_smfmac_f32_16x16x64_bf16 v[56:59], v[8:11], a[248:255], v172
  s_waitcnt lgkmcnt(7)
  v_smfmac_f32_16x16x64_bf16 v[44:47], v[12:15], a[16:23], v172
  s_add_u32 m0, s63, 8192
  s_add_u32 s28, s50, 163840
  buffer_load_dwordx4 v178, s[8:11], s28 offen sc1 lds
  v_smfmac_f32_16x16x64_bf16 v[48:51], v[12:15], a[96:103], v172
  v_smfmac_f32_16x16x64_bf16 v[52:55], v[12:15], a[176:183], v172
  s_add_u32 m0, s63, 10240
  s_add_u32 s28, s50, 204800
  buffer_load_dwordx4 v178, s[8:11], s28 offen sc1 lds
  v_smfmac_f32_16x16x64_bf16 v[56:59], v[12:15], v[192:199], v172
  s_waitcnt lgkmcnt(6)
  v_smfmac_f32_16x16x64_bf16 v[44:47], v[16:19], a[24:31], v172
  s_add_u32 m0, s63, 12288
  s_add_u32 s28, s50, 245760
  buffer_load_dwordx4 v178, s[8:11], s28 offen sc1 lds
  v_smfmac_f32_16x16x64_bf16 v[48:51], v[16:19], a[104:111], v172
  v_smfmac_f32_16x16x64_bf16 v[52:55], v[16:19], a[184:191], v172
  s_add_u32 m0, s63, 14336
  s_add_u32 s28, s50, 286720
  buffer_load_dwordx4 v178, s[8:11], s28 offen sc1 lds
  v_smfmac_f32_16x16x64_bf16 v[56:59], v[16:19], v[200:207], v172
  s_waitcnt lgkmcnt(5)
  v_smfmac_f32_16x16x64_bf16 v[44:47], v[20:23], a[32:39], v172
  s_add_u32 m0, s64, 65536
  s_add_u32 s28, s65, 0
  buffer_load_dwordx4 v178, s[8:11], s28 offen sc1 lds
  v_smfmac_f32_16x16x64_bf16 v[48:51], v[20:23], a[112:119], v172
  v_smfmac_f32_16x16x64_bf16 v[52:55], v[20:23], a[192:199], v172
  s_add_u32 m0, s64, 66560
  s_add_u32 s28, s65, 1024
  buffer_load_dwordx4 v178, s[8:11], s28 offen sc1 lds
  v_smfmac_f32_16x16x64_bf16 v[56:59], v[20:23], v[208:215], v172
  s_waitcnt lgkmcnt(4)
  v_smfmac_f32_16x16x64_bf16 v[44:47], v[24:27], a[40:47], v172
  s_add_u32 m0, s64, 67584
  s_add_u32 s28, s65, 2048
  buffer_load_dwordx4 v178, s[8:11], s28 offen sc1 lds
  v_smfmac_f32_16x16x64_bf16 v[48:51], v[24:27], a[120:127], v172
  v_smfmac_f32_16x16x64_bf16 v[52:55], v[24:27], a[200:207], v172
  s_add_u32 m0, s64, 68608
  s_add_u32 s28, s65, 3072
  buffer_load_dwordx4 v178, s[8:11], s28 offen sc1 lds
  v_smfmac_f32_16x16x64_bf16 v[56:59], v[24:27], v[216:223], v172
  s_waitcnt lgkmcnt(3)
  v_smfmac_f32_16x16x64_bf16 v[44:47], v[28:31], a[48:55], v172
  s_add_u32 m0, s64, 69632
  s_add_u32 s28, s65, 4096
  buffer_load_dwordx4 v178, s[8:11], s28 offen sc1 lds
  v_smfmac_f32_16x16x64_bf16 v[48:51], v[28:31], a[128:135], v172
  v_smfmac_f32_16x16x64_bf16 v[52:55], v[28:31], a[208:215], v172
  s_add_u32 m0, s64, 70656
  s_add_u32 s28, s65, 5120
  buffer_load_dwordx4 v178, s[8:11], s28 offen sc1 lds
  v_smfmac_f32_16x16x64_bf16 v[56:59], v[28:31], v[224:231], v172
  s_waitcnt lgkmcnt(2)
  v_smfmac_f32_16x16x64_bf16 v[44:47], v[32:35], a[56:63], v172
  s_add_u32 m0, s64, 71680
  s_add_u32 s28, s65, 6144
  buffer_load_dwordx4 v178, s[8:11], s28 offen sc1 lds
  v_smfmac_f32_16x16x64_bf16 v[48:51], v[32:35], a[136:143], v172
  v_smfmac_f32_16x16x64_bf16 v[52:55], v[32:35], a[216:223], v172
  s_add_u32 m0, s64, 72704
  s_add_u32 s28, s65, 7168
  buffer_load_dwordx4 v178, s[8:11], s28 offen sc1 lds
  v_smfmac_f32_16x16x64_bf16 v[56:59], v[32:35], v[232:239], v172
  s_waitcnt lgkmcnt(1)
  v_smfmac_f32_16x16x64_bf16 v[44:47], v[36:39], a[64:71], v172
  s_add_u32 m0, s64, 73728
  s_add_u32 s28, s65, 8192
  buffer_load_dwordx4 v178, s[8:11], s28 offen sc1 lds
  v_smfmac_f32_16x16x64_bf16 v[48:51], v[36:39], a[144:151], v172
  v_smfmac_f32_16x16x64_bf16 v[52:55], v[36:39], a[224:231], v172
  s_add_u32 m0, s64, 74752
  s_add_u32 s28, s65, 9216
  buffer_load_dwordx4 v178, s[8:11], s28 offen sc1 lds
  v_smfmac_f32_16x16x64_bf16 v[56:59], v[36:39], v[240:247], v172
  s_waitcnt lgkmcnt(0)
  v_smfmac_f32_16x16x64_bf16 v[44:47], v[40:43], a[72:79], v172
  v_smfmac_f32_16x16x64_bf16 v[48:51], v[40:43], a[152:159], v172
  v_smfmac_f32_16x16x64_bf16 v[52:55], v[40:43], a[232:239], v172
  v_smfmac_f32_16x16x64_bf16 v[56:59], v[40:43], v[248:255], v172
  s_xor_b32 s63, s63, 0x4000
  s_add_u32 s50, s50, 1310720
  s_nop 9
  v_permlane32_swap_b32 v44, v48
  v_permlane32_swap_b32 v45, v49
  v_permlane32_swap_b32 v46, v50
  v_permlane32_swap_b32 v47, v51
  v_permlane32_swap_b32 v52, v56
  v_permlane32_swap_b32 v53, v57
  v_permlane32_swap_b32 v54, v58
  v_permlane32_swap_b32 v55, v59
  v_add_f32 v44, v44, v48
  v_add_f32 v45, v45, v49
  v_add_f32 v46, v46, v50
  v_add_f32 v47, v47, v51
  v_add_f32 v52, v52, v56
  v_add_f32 v53, v53, v57
  v_add_f32 v54, v54, v58
  v_add_f32 v55, v55, v59
  v_cvt_pk_bf16_f32 v64, v44, v45
  v_cvt_pk_bf16_f32 v65, v46, v47
  v_cvt_pk_bf16_f32 v66, v52, v53
  v_cvt_pk_bf16_f32 v67, v54, v55
  ds_write_b128 v179, v[64:67]
  v_mov_b32 v44, 0
  v_mov_b32 v45, 0
  v_mov_b32 v46, 0
  v_mov_b32 v47, 0
  v_mov_b32 v48, 0
  v_mov_b32 v49, 0
  v_mov_b32 v50, 0
  v_mov_b32 v51, 0
  v_mov_b32 v52, 0
  v_mov_b32 v53, 0
  v_mov_b32 v54, 0
  v_mov_b32 v55, 0
  v_mov_b32 v56, 0
  v_mov_b32 v57, 0
  v_mov_b32 v58, 0
  v_mov_b32 v59, 0
  s_waitcnt vmcnt(0) lgkmcnt(0)
  s_barrier
  ds_read_b128 v[60:63], v180
  s_cmp_eq_u32 s51, 0
  s_cbranch_scc1 yt_81
  ds_read_b128 v[68:71], v181 offset:0
  ds_read_b128 v[72:75], v181 offset:2048
  ds_read_b128 v[76:79], v181 offset:4096
  ds_read_b128 v[80:83], v181 offset:6144
  ds_read_b128 v[84:87], v181 offset:8192
  ds_read_b128 v[88:91], v181 offset:10240
  ds_read_b128 v[92:95], v181 offset:12288
  ds_read_b128 v[96:99], v181 offset:14336
  s_mov_b32 s45, 0
ytp_82:
  s_waitcnt lgkmcnt(0)
  ds_read_b128 v[100:103], v183 offset:0
  ds_read_b128 v[104:107], v183 offset:2048
  ds_read_b128 v[108:111], v183 offset:4096
  ds_read_b128 v[112:115], v183 offset:6144
  ds_read_b128 v[116:119], v183 offset:8192
  ds_read_b128 v[120:123], v183 offset:10240
  ds_read_b128 v[124:127], v183 offset:12288
  ds_read_b128 v[128:131], v183 offset:14336
  ds_read_b128 v[132:135], v183 offset:16384
  ds_read_b128 v[136:139], v183 offset:18432
  s_waitcnt lgkmcnt(0)
  v_max_u32 v190, v100, v102
  v_max3_u32 v190, v190, v104, v106
  v_max3_u32 v190, v190, v108, v110
  v_max3_u32 v190, v190, v112, v114
  v_max3_u32 v190, v190, v116, v118
  v_max3_u32 v190, v190, v120, v122
  v_max3_u32 v190, v190, v124, v126
  v_max3_u32 v190, v190, v128, v130
  v_max3_u32 v190, v190, v132, v134
  v_max3_u32 v190, v190, v136, v138
  v_cmp_eq_u32 vcc, -1, v190
  s_cbranch_vccz ytp_82_ok
  s_add_u32 s45, s45, 1
  s_cmp_lt_u32 s45, 400000
  s_cbranch_scc0 kaf_abort
ytp_82_dma:
  s_mov_b32 m0, 65536
  s_add_u32 s28, s61, 0
  buffer_load_dwordx4 v178, s[8:11], s28 offen sc1 lds
  s_mov_b32 m0, 66560
  s_add_u32 s28, s61, 1024
  buffer_load_dwordx4 v178, s[8:11], s28 offen sc1 lds
  s_mov_b32 m0, 67584
  s_add_u32 s28, s61, 2048
  buffer_load_dwordx4 v178, s[8:11], s28 offen sc1 lds
  s_mov_b32 m0, 68608
  s_add_u32 s28, s61, 3072
  buffer_load_dwordx4 v178, s[8:11], s28 offen sc1 lds
  s_mov_b32 m0, 69632
  s_add_u32 s28, s61, 4096
  buffer_load_dwordx4 v178, s[8:11], s28 offen sc1 lds
  s_mov_b32 m0, 70656
  s_add_u32 s28, s61, 5120
  buffer_load_dwordx4 v178, s[8:11], s28 offen sc1 lds
  s_mov_b32 m0, 71680
  s_add_u32 s28, s61, 6144
  buffer_load_dwordx4 v178, s[8:11], s28 offen sc1 lds
  s_mov_b32 m0, 72704
  s_add_u32 s28, s61, 7168
  buffer_load_dwordx4 v178, s[8:11], s28 offen sc1 lds
  s_mov_b32 m0, 73728
  s_add_u32 s28, s61, 8192
  buffer_load_dwordx4 v178, s[8:11], s28 offen sc1 lds
  s_mov_b32 m0, 74752
  s_add_u32 s28, s61, 9216
  buffer_load_dwordx4 v178, s[8:11], s28 offen sc1 lds
  s_mov_b32 m0, 75776
  s_add_u32 s28, s61, 10240
  buffer_load_dwordx4 v178, s[8:11], s28 offen sc1 lds
  s_mov_b32 m0, 76800
  s_add_u32 s28, s61, 11264
  buffer_load_dwordx4 v178, s[8:11], s28 offen sc1 lds
  s_mov_b32 m0, 77824
  s_add_u32 s28, s61, 12288
  buffer_load_dwordx4 v178, s[8:11], s28 offen sc1 lds
  s_mov_b32 m0, 78848
  s_add_u32 s28, s61, 13312
  buffer_load_dwordx4 v178, s[8:11], s28 offen sc1 lds
  s_mov_b32 m0, 79872
  s_add_u32 s28, s61, 14336
  buffer_load_dwordx4 v178, s[8:11], s28 offen sc1 lds
  s_mov_b32 m0, 80896
  s_add_u32 s28, s61, 15360
  buffer_load_dwordx4 v178, s[8:11], s28 offen sc1 lds
  s_mov_b32 m0, 81920
  s_add_u32 s28, s61, 16384
  buffer_load_dwordx4 v178, s[8:11], s28 offen sc1 lds
  s_mov_b32 m0, 82944
  s_add_u32 s28, s61, 17408
  buffer_load_dwordx4 v178, s[8:11], s28 offen sc1 lds
  s_mov_b32 m0, 83968
  s_add_u32 s28, s61, 18432
  buffer_load_dwordx4 v178, s[8:11], s28 offen sc1 lds
  s_mov_b32 m0, 84992
  s_add_u32 s28, s61, 19456
  buffer_load_dwordx4 v178, s[8:11], s28 offen sc1 lds
  s_waitcnt vmcnt(0)
  s_branch ytp_82
ytp_82_ok:
  v_mfma_f32_16x16x32_bf16 v[140:143], v[68:71], v[100:103], 0
  v_mfma_f32_16x16x32_bf16 v[140:143], v[72:75], v[104:107], v[140:143]
  v_mfma_f32_16x16x32_bf16 v[140:143], v[76:79], v[108:111], v[140:143]
  v_mfma_f32_16x16x32_bf16 v[140:143], v[80:83], v[112:115], v[140:143]
  v_mfma_f32_16x16x32_bf16 v[140:143], v[84:87], v[116:119], v[140:143]
  v_mfma_f32_16x16x32_bf16 v[140:143], v[88:91], v[120:123], v[140:143]
  v_mfma_f32_16x16x32_bf16 v[140:143], v[92:95], v[124:127], v[140:143]
  v_mfma_f32_16x16x32_bf16 v[140:143], v[96:99], v[128:131], v[140:143]
  v_mfma_f32_16x16x32_bf16 v[140:143], v[148:151], v[132:135], v[140:143]
  v_mfma_f32_16x16x32_bf16 v[140:143], v[152:155], v[136:139], v[140:143]
  s_nop 8
  s_add_u32 s28, s62, 0
  buffer_store_dwordx4 v[140:143], v189, s[8:11], s28 offen
  s_nop 1
  s_mov_b32 s45, 0
ytp_83:
  s_waitcnt lgkmcnt(0)
  ds_read_b128 v[100:103], v183 offset:1024
  ds_read_b128 v[104:107], v183 offset:3072
  ds_read_b128 v[108:111], v183 offset:5120
  ds_read_b128 v[112:115], v183 offset:7168
  ds_read_b128 v[116:119], v183 offset:9216
  ds_read_b128 v[120:123], v183 offset:11264
  ds_read_b128 v[124:127], v183 offset:13312
  ds_read_b128 v[128:131], v183 offset:15360
  ds_read_b128 v[132:135], v183 offset:17408
  ds_read_b128 v[136:139], v183 offset:19456
  s_waitcnt lgkmcnt(0)
  v_max_u32 v190, v100, v102
  v_max3_u32 v190, v190, v104, v106
  v_max3_u32 v190, v190, v108, v110
  v_max3_u32 v190, v190, v112, v114
  v_max3_u32 v190, v190, v116, v118
  v_max3_u32 v190, v190, v120, v122
  v_max3_u32 v190, v190, v124, v126
  v_max3_u32 v190, v190, v128, v130
  v_max3_u32 v190, v190, v132, v134
  v_max3_u32 v190, v190, v136, v138
  v_cmp_eq_u32 vcc, -1, v190
  s_cbranch_vccz ytp_83_ok
  s_add_u32 s45, s45, 1
  s_cmp_lt_u32 s45, 400000
  s_cbranch_scc0 kaf_abort
ytp_83_dma:
  s_mov_b32 m0, 65536
  s_add_u32 s28, s61, 0
  buffer_load_dwordx4 v178, s[8:11], s28 offen sc1 lds
  s_mov_b32 m0, 66560
  s_add_u32 s28, s61, 1024
  buffer_load_dwordx4 v178, s[8:11], s28 offen sc1 lds
  s_mov_b32 m0, 67584
  s_add_u32 s28, s61, 2048
  buffer_load_dwordx4 v178, s[8:11], s28 offen sc1 lds
  s_mov_b32 m0, 68608
  s_add_u32 s28, s61, 3072
  buffer_load_dwordx4 v178, s[8:11], s28 offen sc1 lds
  s_mov_b32 m0, 69632
  s_add_u32 s28, s61, 4096
  buffer_load_dwordx4 v178, s[8:11], s28 offen sc1 lds
  s_mov_b32 m0, 70656
  s_add_u32 s28, s61, 5120
  buffer_load_dwordx4 v178, s[8:11], s28 offen sc1 lds
  s_mov_b32 m0, 71680
  s_add_u32 s28, s61, 6144
  buffer_load_dwordx4 v178, s[8:11], s28 offen sc1 lds
  s_mov_b32 m0, 72704
  s_add_u32 s28, s61, 7168
  buffer_load_dwordx4 v178, s[8:11], s28 offen sc1 lds
  s_mov_b32 m0, 73728
  s_add_u32 s28, s61, 8192
  buffer_load_dwordx4 v178, s[8:11], s28 offen sc1 lds
  s_mov_b32 m0, 74752
  s_add_u32 s28, s61, 9216
  buffer_load_dwordx4 v178, s[8:11], s28 offen sc1 lds
  s_mov_b32 m0, 75776
  s_add_u32 s28, s61, 10240
  buffer_load_dwordx4 v178, s[8:11], s28 offen sc1 lds
  s_mov_b32 m0, 76800
  s_add_u32 s28, s61, 11264
  buffer_load_dwordx4 v178, s[8:11], s28 offen sc1 lds
  s_mov_b32 m0, 77824
  s_add_u32 s28, s61, 12288
  buffer_load_dwordx4 v178, s[8:11], s28 offen sc1 lds
  s_mov_b32 m0, 78848
  s_add_u32 s28, s61, 13312
  buffer_load_dwordx4 v178, s[8:11], s28 offen sc1 lds
  s_mov_b32 m0, 79872
  s_add_u32 s28, s61, 14336
  buffer_load_dwordx4 v178, s[8:11], s28 offen sc1 lds
  s_mov_b32 m0, 80896
  s_add_u32 s28, s61, 15360
  buffer_load_dwordx4 v178, s[8:11], s28 offen sc1 lds
  s_mov_b32 m0, 81920
  s_add_u32 s28, s61, 16384
  buffer_load_dwordx4 v178, s[8:11], s28 offen sc1 lds
  s_mov_b32 m0, 82944
  s_add_u32 s28, s61, 17408
  buffer_load_dwordx4 v178, s[8:11], s28 offen sc1 lds
  s_mov_b32 m0, 83968
  s_add_u32 s28, s61, 18432
  buffer_load_dwordx4 v178, s[8:11], s28 offen sc1 lds
  s_mov_b32 m0, 84992
  s_add_u32 s28, s61, 19456
  buffer_load_dwordx4 v178, s[8:11], s28 offen sc1 lds
  s_waitcnt vmcnt(0)
  s_branch ytp_83
ytp_83_ok:
  v_mfma_f32_16x16x32_bf16 v[140:143], v[68:71], v[100:103], 0
  v_mfma_f32_16x16x32_bf16 v[140:143], v[72:75], v[104:107], v[140:143]
  v_mfma_f32_16x16x32_bf16 v[140:143], v[76:79], v[108:111], v[140:143]
  v_mfma_f32_16x16x32_bf16 v[140:143], v[80:83], v[112:115], v[140:143]
  v_mfma_f32_16x16x32_bf16 v[140:143], v[84:87], v[116:119], v[140:143]
  v_mfma_f32_16x16x32_bf16 v[140:143], v[88:91], v[120:123], v[140:143]
  v_mfma_f32_16x16x32_bf16 v[140:143], v[92:95], v[124:127], v[140:143]
  v_mfma_f32_16x16x32_bf16 v[140:143], v[96:99], v[128:131], v[140:143]
  v_mfma_f32_16x16x32_bf16 v[140:143], v[148:151], v[132:135], v[140:143]
  v_mfma_f32_16x16x32_bf16 v[140:143], v[152:155], v[136:139], v[140:143]
  s_nop 8
  s_add_u32 s28, s62, 256
  buffer_store_dwordx4 v[140:143], v189, s[8:11], s28 offen
  s_nop 1
  s_add_u32 s61, s61, 20480
  s_add_u32 s62, s62, 81920
  s_add_u32 s54, s54, 1
  v_xor_b32 v181, 0x4000, v181
yt_81:
  s_waitcnt lgkmcnt(0)
  v_mov_b32 v148, v60
  v_mov_b32 v149, v61
  v_mov_b32 v150, v62
  v_mov_b32 v151, v63
  v_mov_b32 v152, v64
  v_mov_b32 v153, v65
  v_mov_b32 v154, v66
  v_mov_b32 v155, v67
  s_add_u32 s97, s97, 10240
  s_mov_b32 s48, s97
  s_add_u32 s51, s51, 1
  s_cmp_lt_u32 s51, 64
  s_cbranch_scc1 kaf_y_tokl
  s_barrier
  ds_read_b128 v[68:71], v181 offset:0
  ds_read_b128 v[72:75], v181 offset:2048
  ds_read_b128 v[76:79], v181 offset:4096
  ds_read_b128 v[80:83], v181 offset:6144
  ds_read_b128 v[84:87], v181 offset:8192
  ds_read_b128 v[88:91], v181 offset:10240
  ds_read_b128 v[92:95], v181 offset:12288
  ds_read_b128 v[96:99], v181 offset:14336
  s_mov_b32 s45, 0
  s_branch ytp_84_dma
ytp_84:
  s_waitcnt lgkmcnt(0)
  ds_read_b128 v[100:103], v183 offset:0
  ds_read_b128 v[104:107], v183 offset:2048
  ds_read_b128 v[108:111], v183 offset:4096
  ds_read_b128 v[112:115], v183 offset:6144
  ds_read_b128 v[116:119], v183 offset:8192
  ds_read_b128 v[120:123], v183 offset:10240
  ds_read_b128 v[124:127], v183 offset:12288
  ds_read_b128 v[128:131], v183 offset:14336
  ds_read_b128 v[132:135], v183 offset:16384
  ds_read_b128 v[136:139], v183 offset:18432
  s_waitcnt lgkmcnt(0)
  v_max_u32 v190, v100, v102
  v_max3_u32 v190, v190, v104, v106
  v_max3_u32 v190, v190, v108, v110
  v_max3_u32 v190, v190, v112, v114
  v_max3_u32 v190, v190, v116, v118
  v_max3_u32 v190, v190, v120, v122
  v_max3_u32 v190, v190, v124, v126
  v_max3_u32 v190, v190, v128, v130
  v_max3_u32 v190, v190, v132, v134
  v_max3_u32 v190, v190, v136, v138
  v_cmp_eq_u32 vcc, -1, v190
  s_cbranch_vccz ytp_84_ok
  s_add_u32 s45, s45, 1
  s_cmp_lt_u32 s45, 400000
  s_cbranch_scc0 kaf_abort
ytp_84_dma:
  s_mov_b32 m0, 65536
  s_add_u32 s28, s61, 0
  buffer_load_dwordx4 v178, s[8:11], s28 offen sc1 lds
  s_mov_b32 m0, 66560
  s_add_u32 s28, s61, 1024
  buffer_load_dwordx4 v178, s[8:11], s28 offen sc1 lds
  s_mov_b32 m0, 67584
  s_add_u32 s28, s61, 2048
  buffer_load_dwordx4 v178, s[8:11], s28 offen sc1 lds
  s_mov_b32 m0, 68608
  s_add_u32 s28, s61, 3072
  buffer_load_dwordx4 v178, s[8:11], s28 offen sc1 lds
  s_mov_b32 m0, 69632
  s_add_u32 s28, s61, 4096
  buffer_load_dwordx4 v178, s[8:11], s28 offen sc1 lds
  s_mov_b32 m0, 70656
  s_add_u32 s28, s61, 5120
  buffer_load_dwordx4 v178, s[8:11], s28 offen sc1 lds
  s_mov_b32 m0, 71680
  s_add_u32 s28, s61, 6144
  buffer_load_dwordx4 v178, s[8:11], s28 offen sc1 lds
  s_mov_b32 m0, 72704
  s_add_u32 s28, s61, 7168
  buffer_load_dwordx4 v178, s[8:11], s28 offen sc1 lds
  s_mov_b32 m0, 73728
  s_add_u32 s28, s61, 8192
  buffer_load_dwordx4 v178, s[8:11], s28 offen sc1 lds
  s_mov_b32 m0, 74752
  s_add_u32 s28, s61, 9216
  buffer_load_dwordx4 v178, s[8:11], s28 offen sc1 lds
  s_mov_b32 m0, 75776
  s_add_u32 s28, s61, 10240
  buffer_load_dwordx4 v178, s[8:11], s28 offen sc1 lds
  s_mov_b32 m0, 76800
  s_add_u32 s28, s61, 11264
  buffer_load_dwordx4 v178, s[8:11], s28 offen sc1 lds
  s_mov_b32 m0, 77824
  s_add_u32 s28, s61, 12288
  buffer_load_dwordx4 v178, s[8:11], s28 offen sc1 lds
  s_mov_b32 m0, 78848
  s_add_u32 s28, s61, 13312
  buffer_load_dwordx4 v178, s[8:11], s28 offen sc1 lds
  s_mov_b32 m0, 79872
  s_add_u32 s28, s61, 14336
  buffer_load_dwordx4 v178, s[8:11], s28 offen sc1 lds
  s_mov_b32 m0, 80896
  s_add_u32 s28, s61, 15360
  buffer_load_dwordx4 v178, s[8:11], s28 offen sc1 lds
  s_mov_b32 m0, 81920
  s_add_u32 s28, s61, 16384
  buffer_load_dwordx4 v178, s[8:11], s28 offen sc1 lds
  s_mov_b32 m0, 82944
  s_add_u32 s28, s61, 17408
  buffer_load_dwordx4 v178, s[8:11], s28 offen sc1 lds
  s_mov_b32 m0, 83968
  s_add_u32 s28, s61, 18432
  buffer_load_dwordx4 v178, s[8:11], s28 offen sc1 lds
  s_mov_b32 m0, 84992
  s_add_u32 s28, s61, 19456
  buffer_load_dwordx4 v178, s[8:11], s28 offen sc1 lds
  s_waitcnt vmcnt(0)
  s_branch ytp_84
ytp_84_ok:
  v_mfma_f32_16x16x32_bf16 v[140:143], v[68:71], v[100:103], 0
  v_mfma_f32_16x16x32_bf16 v[140:143], v[72:75], v[104:107], v[140:143]
  v_mfma_f32_16x16x32_bf16 v[140:143], v[76:79], v[108:111], v[140:143]
  v_mfma_f32_16x16x32_bf16 v[140:143], v[80:83], v[112:115], v[140:143]
  v_mfma_f32_16x16x32_bf16 v[140:143], v[84:87], v[116:119], v[140:143]
  v_mfma_f32_16x16x32_bf16 v[140:143], v[88:91], v[120:123], v[140:143]
  v_mfma_f32_16x16x32_bf16 v[140:143], v[92:95], v[124:127], v[140:143]
  v_mfma_f32_16x16x32_bf16 v[140:143], v[96:99], v[128:131], v[140:143]
  v_mfma_f32_16x16x32_bf16 v[140:143], v[148:151], v[132:135], v[140:143]
  v_mfma_f32_16x16x32_bf16 v[140:143], v[152:155], v[136:139], v[140:143]
  s_nop 8
  s_add_u32 s28, s62, 0
  buffer_store_dwordx4 v[140:143], v189, s[8:11], s28 offen
  s_nop 1
  s_mov_b32 s45, 0
ytp_85:
  s_waitcnt lgkmcnt(0)
  ds_read_b128 v[100:103], v183 offset:1024
  ds_read_b128 v[104:107], v183 offset:3072
  ds_read_b128 v[108:111], v183 offset:5120
  ds_read_b128 v[112:115], v183 offset:7168
  ds_read_b128 v[116:119], v183 offset:9216
  ds_read_b128 v[120:123], v183 offset:11264
  ds_read_b128 v[124:127], v183 offset:13312
  ds_read_b128 v[128:131], v183 offset:15360
  ds_read_b128 v[132:135], v183 offset:17408
  ds_read_b128 v[136:139], v183 offset:19456
  s_waitcnt lgkmcnt(0)
  v_max_u32 v190, v100, v102
  v_max3_u32 v190, v190, v104, v106
  v_max3_u32 v190, v190, v108, v110
  v_max3_u32 v190, v190, v112, v114
  v_max3_u32 v190, v190, v116, v118
  v_max3_u32 v190, v190, v120, v122
  v_max3_u32 v190, v190, v124, v126
  v_max3_u32 v190, v190, v128, v130
  v_max3_u32 v190, v190, v132, v134
  v_max3_u32 v190, v190, v136, v138
  v_cmp_eq_u32 vcc, -1, v190
  s_cbranch_vccz ytp_85_ok
  s_add_u32 s45, s45, 1
  s_cmp_lt_u32 s45, 400000
  s_cbranch_scc0 kaf_abort
ytp_85_dma:
  s_mov_b32 m0, 65536
  s_add_u32 s28, s61, 0
  buffer_load_dwordx4 v178, s[8:11], s28 offen sc1 lds
  s_mov_b32 m0, 66560
  s_add_u32 s28, s61, 1024
  buffer_load_dwordx4 v178, s[8:11], s28 offen sc1 lds
  s_mov_b32 m0, 67584
  s_add_u32 s28, s61, 2048
  buffer_load_dwordx4 v178, s[8:11], s28 offen sc1 lds
  s_mov_b32 m0, 68608
  s_add_u32 s28, s61, 3072
  buffer_load_dwordx4 v178, s[8:11], s28 offen sc1 lds
  s_mov_b32 m0, 69632
  s_add_u32 s28, s61, 4096
  buffer_load_dwordx4 v178, s[8:11], s28 offen sc1 lds
  s_mov_b32 m0, 70656
  s_add_u32 s28, s61, 5120
  buffer_load_dwordx4 v178, s[8:11], s28 offen sc1 lds
  s_mov_b32 m0, 71680
  s_add_u32 s28, s61, 6144
  buffer_load_dwordx4 v178, s[8:11], s28 offen sc1 lds
  s_mov_b32 m0, 72704
  s_add_u32 s28, s61, 7168
  buffer_load_dwordx4 v178, s[8:11], s28 offen sc1 lds
  s_mov_b32 m0, 73728
  s_add_u32 s28, s61, 8192
  buffer_load_dwordx4 v178, s[8:11], s28 offen sc1 lds
  s_mov_b32 m0, 74752
  s_add_u32 s28, s61, 9216
  buffer_load_dwordx4 v178, s[8:11], s28 offen sc1 lds
  s_mov_b32 m0, 75776
  s_add_u32 s28, s61, 10240
  buffer_load_dwordx4 v178, s[8:11], s28 offen sc1 lds
  s_mov_b32 m0, 76800
  s_add_u32 s28, s61, 11264
  buffer_load_dwordx4 v178, s[8:11], s28 offen sc1 lds
  s_mov_b32 m0, 77824
  s_add_u32 s28, s61, 12288
  buffer_load_dwordx4 v178, s[8:11], s28 offen sc1 lds
  s_mov_b32 m0, 78848
  s_add_u32 s28, s61, 13312
  buffer_load_dwordx4 v178, s[8:11], s28 offen sc1 lds
  s_mov_b32 m0, 79872
  s_add_u32 s28, s61, 14336
  buffer_load_dwordx4 v178, s[8:11], s28 offen sc1 lds
  s_mov_b32 m0, 80896
  s_add_u32 s28, s61, 15360
  buffer_load_dwordx4 v178, s[8:11], s28 offen sc1 lds
  s_mov_b32 m0, 81920
  s_add_u32 s28, s61, 16384
  buffer_load_dwordx4 v178, s[8:11], s28 offen sc1 lds
  s_mov_b32 m0, 82944
  s_add_u32 s28, s61, 17408
  buffer_load_dwordx4 v178, s[8:11], s28 offen sc1 lds
  s_mov_b32 m0, 83968
  s_add_u32 s28, s61, 18432
  buffer_load_dwordx4 v178, s[8:11], s28 offen sc1 lds
  s_mov_b32 m0, 84992
  s_add_u32 s28, s61, 19456
  buffer_load_dwordx4 v178, s[8:11], s28 offen sc1 lds
  s_waitcnt vmcnt(0)
  s_branch ytp_85
ytp_85_ok:
  v_mfma_f32_16x16x32_bf16 v[140:143], v[68:71], v[100:103], 0
  v_mfma_f32_16x16x32_bf16 v[140:143], v[72:75], v[104:107], v[140:143]
  v_mfma_f32_16x16x32_bf16 v[140:143], v[76:79], v[108:111], v[140:143]
  v_mfma_f32_16x16x32_bf16 v[140:143], v[80:83], v[112:115], v[140:143]
  v_mfma_f32_16x16x32_bf16 v[140:143], v[84:87], v[116:119], v[140:143]
  v_mfma_f32_16x16x32_bf16 v[140:143], v[88:91], v[120:123], v[140:143]
  v_mfma_f32_16x16x32_bf16 v[140:143], v[92:95], v[124:127], v[140:143]
  v_mfma_f32_16x16x32_bf16 v[140:143], v[96:99], v[128:131], v[140:143]
  v_mfma_f32_16x16x32_bf16 v[140:143], v[148:151], v[132:135], v[140:143]
  v_mfma_f32_16x16x32_bf16 v[140:143], v[152:155], v[136:139], v[140:143]
  s_nop 8
  s_add_u32 s28, s62, 256
  buffer_store_dwordx4 v[140:143], v189, s[8:11], s28 offen
  s_nop 1
  s_add_u32 s61, s61, 20480
  s_add_u32 s62, s62, 81920
  s_add_u32 s54, s54, 1
  v_xor_b32 v181, 0x4000, v181
  s_waitcnt vmcnt(0)
  s_branch kaf_exit
kaf_abort:
  s_branch ka_abort
kaf_exit:
  s_branch ka_exit
kas_x:
  s_mov_b32 s12, s36
  s_and_b32 s13, s37, 0xffff
  s_mov_b32 s14, 0x780000
  s_mov_b32 s15, 0x20000
  s_mov_b32 s16, s38
  s_and_b32 s17, s39, 0xffff
  s_mov_b32 s18, 0x780000
  s_mov_b32 s19, 0x20000
  v_and_b32 v1, 63, v0
  v_lshrrev_b32 v2, 4, v1
  v_bfe_u32 v3, v1, 3, 1
  v_bfe_u32 v4, v1, 1, 2
  v_and_b32 v5, 1, v1
  s_mul_i32 s46, s23, 384
  s_lshl_b32 s28, s21, 2
  s_add_u32 s28, s28, 0
  v_add_u32 v6, s28, v2
  v_mul_u32_u24 v7, 43, v6
  v_lshrrev_b32 v7, 9, v7
  v_mul_u32_u24 v8, 12, v7
  v_sub_u32 v8, v6, v8
  v_lshrrev_b32 v9, 1, v7
  v_lshlrev_b32 v9, 4, v9
  v_and_b32 v10, 1, v7
  v_lshlrev_b32 v10, 2, v10
  v_add_u32 v9, v9, v10
  v_lshlrev_b32 v10, 3, v3
  v_add_u32 v9, v9, v10
  v_add_u32 v9, v9, v4
  v_mul_u32_u24 v9, 12288, v9
  v_lshrrev_b32 v10, 1, v8
  v_lshlrev_b32 v10, 2, v10
  v_lshlrev_b32 v11, 1, v5
  v_add_u32 v10, v10, v11
  v_and_b32 v11, 1, v8
  v_add_u32 v10, v10, v11
  v_lshlrev_b32 v10, 4, v10
  v_add_u32 v9, v9, v10
  v_add_u32 v136, s46, v9
  s_lshl_b32 s28, s21, 2
  s_add_u32 s28, s28, 16
  v_add_u32 v6, s28, v2
  v_mul_u32_u24 v7, 43, v6
  v_lshrrev_b32 v7, 9, v7
  v_mul_u32_u24 v8, 12, v7
  v_sub_u32 v8, v6, v8
  v_lshrrev_b32 v9, 1, v7
  v_lshlrev_b32 v9, 4, v9
  v_and_b32 v10, 1, v7
  v_lshlrev_b32 v10, 2, v10
  v_add_u32 v9, v9, v10
  v_lshlrev_b32 v10, 3, v3
  v_add_u32 v9, v9, v10
  v_add_u32 v9, v9, v4
  v_mul_u32_u24 v9, 12288, v9
  v_lshrrev_b32 v10, 1, v8
  v_lshlrev_b32 v10, 2, v10
  v_lshlrev_b32 v11, 1, v5
  v_add_u32 v10, v10, v11
  v_and_b32 v11, 1, v8
  v_add_u32 v10, v10, v11
  v_lshlrev_b32 v10, 4, v10
  v_add_u32 v9, v9, v10
  v_add_u32 v137, s46, v9
  s_lshl_b32 s28, s21, 2
  s_add_u32 s28, s28, 32
  v_add_u32 v6, s28, v2
  v_mul_u32_u24 v7, 43, v6
  v_lshrrev_b32 v7, 9, v7
  v_mul_u32_u24 v8, 12, v7
  v_sub_u32 v8, v6, v8
  v_lshrrev_b32 v9, 1, v7
  v_lshlrev_b32 v9, 4, v9
  v_and_b32 v10, 1, v7
  v_lshlrev_b32 v10, 2, v10
  v_add_u32 v9, v9, v10
  v_lshlrev_b32 v10, 3, v3
  v_add_u32 v9, v9, v10
  v_add_u32 v9, v9, v4
  v_mul_u32_u24 v9, 12288, v9
  v_lshrrev_b32 v10, 1, v8
  v_lshlrev_b32 v10, 2, v10
  v_lshlrev_b32 v11, 1, v5
  v_add_u32 v10, v10, v11
  v_and_b32 v11, 1, v8
  v_add_u32 v10, v10, v11
  v_lshlrev_b32 v10, 4, v10
  v_add_u32 v9, v9, v10
  v_add_u32 v138, s46, v9
  s_lshl_b32 s28, s21, 2
  s_add_u32 s28, s28, 48
  v_add_u32 v6, s28, v2
  v_mul_u32_u24 v7, 43, v6
  v_lshrrev_b32 v7, 9, v7
  v_mul_u32_u24 v8, 12, v7
  v_sub_u32 v8, v6, v8
  v_lshrrev_b32 v9, 1, v7
  v_lshlrev_b32 v9, 4, v9
  v_and_b32 v10, 1, v7
  v_lshlrev_b32 v10, 2, v10
  v_add_u32 v9, v9, v10
  v_lshlrev_b32 v10, 3, v3
  v_add_u32 v9, v9, v10
  v_add_u32 v9, v9, v4
  v_mul_u32_u24 v9, 12288, v9
  v_lshrrev_b32 v10, 1, v8
  v_lshlrev_b32 v10, 2, v10
  v_lshlrev_b32 v11, 1, v5
  v_add_u32 v10, v10, v11
  v_and_b32 v11, 1, v8
  v_add_u32 v10, v10, v11
  v_lshlrev_b32 v10, 4, v10
  v_add_u32 v9, v9, v10
  v_add_u32 v139, s46, v9
  s_lshl_b32 s28, s21, 2
  s_add_u32 s28, s28, 64
  v_add_u32 v6, s28, v2
  v_mul_u32_u24 v7, 43, v6
  v_lshrrev_b32 v7, 9, v7
  v_mul_u32_u24 v8, 12, v7
  v_sub_u32 v8, v6, v8
  v_lshrrev_b32 v9, 1, v7
  v_lshlrev_b32 v9, 4, v9
  v_and_b32 v10, 1, v7
  v_lshlrev_b32 v10, 2, v10
  v_add_u32 v9, v9, v10
  v_lshlrev_b32 v10, 3, v3
  v_add_u32 v9, v9, v10
  v_add_u32 v9, v9, v4
  v_mul_u32_u24 v9, 12288, v9
  v_lshrrev_b32 v10, 1, v8
  v_lshlrev_b32 v10, 2, v10
  v_lshlrev_b32 v11, 1, v5
  v_add_u32 v10, v10, v11
  v_and_b32 v11, 1, v8
  v_add_u32 v10, v10, v11
  v_lshlrev_b32 v10, 4, v10
  v_add_u32 v9, v9, v10
  v_add_u32 v140, s46, v9
  s_lshl_b32 s28, s21, 2
  s_add_u32 s28, s28, 80
  v_add_u32 v6, s28, v2
  v_mul_u32_u24 v7, 43, v6
  v_lshrrev_b32 v7, 9, v7
  v_mul_u32_u24 v8, 12, v7
  v_sub_u32 v8, v6, v8
  v_lshrrev_b32 v9, 1, v7
  v_lshlrev_b32 v9, 4, v9
  v_and_b32 v10, 1, v7
  v_lshlrev_b32 v10, 2, v10
  v_add_u32 v9, v9, v10
  v_lshlrev_b32 v10, 3, v3
  v_add_u32 v9, v9, v10
  v_add_u32 v9, v9, v4
  v_mul_u32_u24 v9, 12288, v9
  v_lshrrev_b32 v10, 1, v8
  v_lshlrev_b32 v10, 2, v10
  v_lshlrev_b32 v11, 1, v5
  v_add_u32 v10, v10, v11
  v_and_b32 v11, 1, v8
  v_add_u32 v10, v10, v11
  v_lshlrev_b32 v10, 4, v10
  v_add_u32 v9, v9, v10
  v_add_u32 v141, s46, v9
  v_lshrrev_b32 v6, 1, v2
  v_mul_u32_u24 v142, 6144, v6
  v_and_b32 v6, 1, v2
  v_lshlrev_b32 v6, 7, v6
  v_add_u32 v142, v142, v6
  v_bfe_u32 v6, v1, 2, 2
  v_lshlrev_b32 v6, 5, v6
  v_add_u32 v142, v142, v6
  v_and_b32 v6, 1, v1
  v_lshlrev_b32 v6, 4, v6
  v_add_u32 v142, v142, v6
  v_bfe_u32 v6, v1, 1, 1
  v_lshlrev_b32 v6, 3, v6
  v_add_u32 v142, v142, v6
  s_mul_i32 s28, s21, 768
  v_add_u32 v142, s28, v142
  s_lshl_b32 s29, s21, 10
  s_add_u32 m0, s29, 0
  s_mov_b32 s28, 0
  buffer_load_dwordx4 v136, s[12:15], s28 offen lds
  s_lshl_b32 s29, s21, 10
  s_add_u32 m0, s29, 4096
  s_mov_b32 s28, 0
  buffer_load_dwordx4 v137, s[12:15], s28 offen lds
  s_lshl_b32 s29, s21, 10
  s_add_u32 m0, s29, 8192
  s_mov_b32 s28, 0
  buffer_load_dwordx4 v138, s[12:15], s28 offen lds
  s_lshl_b32 s29, s21, 10
  s_add_u32 m0, s29, 12288
  s_mov_b32 s28, 0
  buffer_load_dwordx4 v139, s[12:15], s28 offen lds
  s_lshl_b32 s29, s21, 10
  s_add_u32 m0, s29, 16384
  s_mov_b32 s28, 0
  buffer_load_dwordx4 v140, s[12:15], s28 offen lds
  s_lshl_b32 s29, s21, 10
  s_add_u32 m0, s29, 20480
  s_mov_b32 s28, 0
  buffer_load_dwordx4 v141, s[12:15], s28 offen lds
  s_lshl_b32 s29, s21, 10
  s_add_u32 m0, s29, 24576
  s_mov_b32 s28, 786432
  buffer_load_dwordx4 v136, s[12:15], s28 offen lds
  s_lshl_b32 s29, s21, 10
  s_add_u32 m0, s29, 28672
  s_mov_b32 s28, 786432
  buffer_load_dwordx4 v137, s[12:15], s28 offen lds
  s_lshl_b32 s29, s21, 10
  s_add_u32 m0, s29, 32768
  s_mov_b32 s28, 786432
  buffer_load_dwordx4 v138, s[12:15], s28 offen lds
  s_lshl_b32 s29, s21, 10
  s_add_u32 m0, s29, 36864
  s_mov_b32 s28, 786432
  buffer_load_dwordx4 v139, s[12:15], s28 offen lds
  s_lshl_b32 s29, s21, 10
  s_add_u32 m0, s29, 40960
  s_mov_b32 s28, 786432
  buffer_load_dwordx4 v140, s[12:15], s28 offen lds
  s_lshl_b32 s29, s21, 10
  s_add_u32 m0, s29, 45056
  s_mov_b32 s28, 786432
  buffer_load_dwordx4 v141, s[12:15], s28 offen lds
  s_lshl_b32 s29, s21, 10
  s_add_u32 m0, s29, 49152
  s_mov_b32 s28, 1572864
  buffer_load_dwordx4 v136, s[12:15], s28 offen lds
  s_lshl_b32 s29, s21, 10
  s_add_u32 m0, s29, 53248
  s_mov_b32 s28, 1572864
  buffer_load_dwordx4 v137, s[12:15], s28 offen lds
  s_lshl_b32 s29, s21, 10
  s_add_u32 m0, s29, 57344
  s_mov_b32 s28, 1572864
  buffer_load_dwordx4 v138, s[12:15], s28 offen lds
  s_lshl_b32 s29, s21, 10
  s_add_u32 m0, s29, 61440
  s_mov_b32 s28, 1572864
  buffer_load_dwordx4 v139, s[12:15], s28 offen lds
  s_lshl_b32 s29, s21, 10
  s_add_u32 m0, s29, 65536
  s_mov_b32 s28, 1572864
  buffer_load_dwordx4 v140, s[12:15], s28 offen lds
  s_lshl_b32 s29, s21, 10
  s_add_u32 m0, s29, 69632
  s_mov_b32 s28, 1572864
  buffer_load_dwordx4 v141, s[12:15], s28 offen lds
  s_lshl_b32 s29, s21, 10
  s_add_u32 m0, s29, 73728
  s_mov_b32 s28, 2359296
  buffer_load_dwordx4 v136, s[12:15], s28 offen lds
  s_lshl_b32 s29, s21, 10
  s_add_u32 m0, s29, 77824
  s_mov_b32 s28, 2359296
  buffer_load_dwordx4 v137, s[12:15], s28 offen lds
  s_lshl_b32 s29, s21, 10
  s_add_u32 m0, s29, 81920
  s_mov_b32 s28, 2359296
  buffer_load_dwordx4 v138, s[12:15], s28 offen lds
  s_lshl_b32 s29, s21, 10
  s_add_u32 m0, s29, 86016
  s_mov_b32 s28, 2359296
  buffer_load_dwordx4 v139, s[12:15], s28 offen lds
  s_lshl_b32 s29, s21, 10
  s_add_u32 m0, s29, 90112
  s_mov_b32 s28, 2359296
  buffer_load_dwordx4 v140, s[12:15], s28 offen lds
  s_lshl_b32 s29, s21, 10
  s_add_u32 m0, s29, 94208
  s_mov_b32 s28, 2359296
  buffer_load_dwordx4 v141, s[12:15], s28 offen lds
  s_lshl_b32 s29, s21, 10
  s_add_u32 m0, s29, 98304
  s_mov_b32 s28, 3145728
  buffer_load_dwordx4 v136, s[12:15], s28 offen lds
  s_lshl_b32 s29, s21, 10
  s_add_u32 m0, s29, 102400
  s_mov_b32 s28, 3145728
  buffer_load_dwordx4 v137, s[12:15], s28 offen lds
  s_lshl_b32 s29, s21, 10
  s_add_u32 m0, s29, 106496
  s_mov_b32 s28, 3145728
  buffer_load_dwordx4 v138, s[12:15], s28 offen lds
  s_lshl_b32 s29, s21, 10
  s_add_u32 m0, s29, 110592
  s_mov_b32 s28, 3145728
  buffer_load_dwordx4 v139, s[12:15], s28 offen lds
  s_lshl_b32 s29, s21, 10
  s_add_u32 m0, s29, 114688
  s_mov_b32 s28, 3145728
  buffer_load_dwordx4 v140, s[12:15], s28 offen lds
  s_lshl_b32 s29, s21, 10
  s_add_u32 m0, s29, 118784
  s_mov_b32 s28, 3145728
  buffer_load_dwordx4 v141, s[12:15], s28 offen lds
  s_waitcnt vmcnt(24)
  s_barrier
  s_lshl_b32 s29, s21, 10
  s_add_u32 m0, s29, 122880
  s_mov_b32 s28, 3932160
  buffer_load_dwordx4 v136, s[12:15], s28 offen lds
  s_lshl_b32 s29, s21, 10
  s_add_u32 m0, s29, 126976
  s_mov_b32 s28, 3932160
  buffer_load_dwordx4 v137, s[12:15], s28 offen lds
  s_lshl_b32 s29, s21, 10
  s_add_u32 m0, s29, 131072
  s_mov_b32 s28, 3932160
  buffer_load_dwordx4 v138, s[12:15], s28 offen lds
  s_lshl_b32 s29, s21, 10
  s_add_u32 m0, s29, 135168
  s_mov_b32 s28, 3932160
  buffer_load_dwordx4 v139, s[12:15], s28 offen lds
  s_lshl_b32 s29, s21, 10
  s_add_u32 m0, s29, 139264
  s_mov_b32 s28, 3932160
  buffer_load_dwordx4 v140, s[12:15], s28 offen lds
  s_lshl_b32 s29, s21, 10
  s_add_u32 m0, s29, 143360
  s_mov_b32 s28, 3932160
  buffer_load_dwordx4 v141, s[12:15], s28 offen lds
  v_add_u32 v143, 0, v142
  ds_read_b64_tr_b16 a[0:1], v143 offset:0
  ds_read_b64_tr_b16 a[2:3], v143 offset:3072
  ds_read_b64_tr_b16 a[4:5], v143 offset:12288
  ds_read_b64_tr_b16 a[6:7], v143 offset:15360
  ds_read_b64_tr_b16 a[80:81], v143 offset:256
  ds_read_b64_tr_b16 a[82:83], v143 offset:3328
  ds_read_b64_tr_b16 a[84:85], v143 offset:12544
  ds_read_b64_tr_b16 a[86:87], v143 offset:15616
  ds_read_b64_tr_b16 a[160:161], v143 offset:512
  ds_read_b64_tr_b16 a[162:163], v143 offset:3584
  ds_read_b64_tr_b16 a[164:165], v143 offset:12800
  ds_read_b64_tr_b16 a[166:167], v143 offset:15872
  s_waitcnt lgkmcnt(0)
  s_waitcnt vmcnt(24)
  s_barrier
  s_lshl_b32 s29, s21, 10
  s_add_u32 m0, s29, 0
  s_mov_b32 s28, 4718592
  buffer_load_dwordx4 v136, s[12:15], s28 offen lds
  s_lshl_b32 s29, s21, 10
  s_add_u32 m0, s29, 4096
  s_mov_b32 s28, 4718592
  buffer_load_dwordx4 v137, s[12:15], s28 offen lds
  s_lshl_b32 s29, s21, 10
  s_add_u32 m0, s29, 8192
  s_mov_b32 s28, 4718592
  buffer_load_dwordx4 v138, s[12:15], s28 offen lds
  s_lshl_b32 s29, s21, 10
  s_add_u32 m0, s29, 12288
  s_mov_b32 s28, 4718592
  buffer_load_dwordx4 v139, s[12:15], s28 offen lds
  s_lshl_b32 s29, s21, 10
  s_add_u32 m0, s29, 16384
  s_mov_b32 s28, 4718592
  buffer_load_dwordx4 v140, s[12:15], s28 offen lds
  s_lshl_b32 s29, s21, 10
  s_add_u32 m0, s29, 20480
  s_mov_b32 s28, 4718592
  buffer_load_dwordx4 v141, s[12:15], s28 offen lds
  v_add_u32 v143, 24576, v142
  ds_read_b64_tr_b16 a[8:9], v143 offset:0
  ds_read_b64_tr_b16 a[10:11], v143 offset:3072
  ds_read_b64_tr_b16 a[12:13], v143 offset:12288
  ds_read_b64_tr_b16 a[14:15], v143 offset:15360
  ds_read_b64_tr_b16 a[88:89], v143 offset:256
  ds_read_b64_tr_b16 a[90:91], v143 offset:3328
  ds_read_b64_tr_b16 a[92:93], v143 offset:12544
  ds_read_b64_tr_b16 a[94:95], v143 offset:15616
  ds_read_b64_tr_b16 a[168:169], v143 offset:512
  ds_read_b64_tr_b16 a[170:171], v143 offset:3584
  ds_read_b64_tr_b16 a[172:173], v143 offset:12800
  ds_read_b64_tr_b16 a[174:175], v143 offset:15872
  s_waitcnt lgkmcnt(0)
  s_waitcnt vmcnt(24)
  s_barrier
  s_lshl_b32 s29, s21, 10
  s_add_u32 m0, s29, 24576
  s_mov_b32 s28, 5505024
  buffer_load_dwordx4 v136, s[12:15], s28 offen lds
  s_lshl_b32 s29, s21, 10
  s_add_u32 m0, s29, 28672
  s_mov_b32 s28, 5505024
  buffer_load_dwordx4 v137, s[12:15], s28 offen lds
  s_lshl_b32 s29, s21, 10
  s_add_u32 m0, s29, 32768
  s_mov_b32 s28, 5505024
  buffer_load_dwordx4 v138, s[12:15], s28 offen lds
  s_lshl_b32 s29, s21, 10
  s_add_u32 m0, s29, 36864
  s_mov_b32 s28, 5505024
  buffer_load_dwordx4 v139, s[12:15], s28 offen lds
  s_lshl_b32 s29, s21, 10
  s_add_u32 m0, s29, 40960
  s_mov_b32 s28, 5505024
  buffer_load_dwordx4 v140, s[12:15], s28 offen lds
  s_lshl_b32 s29, s21, 10
  s_add_u32 m0, s29, 45056
  s_mov_b32 s28, 5505024
  buffer_load_dwordx4 v141, s[12:15], s28 offen lds
  v_add_u32 v143, 49152, v142
  ds_read_b64_tr_b16 a[16:17], v143 offset:0
  ds_read_b64_tr_b16 a[18:19], v143 offset:3072
  ds_read_b64_tr_b16 a[20:21], v143 offset:12288
  ds_read_b64_tr_b16 a[22:23], v143 offset:15360
  ds_read_b64_tr_b16 a[96:97], v143 offset:256
  ds_read_b64_tr_b16 a[98:99], v143 offset:3328
  ds_read_b64_tr_b16 a[100:101], v143 offset:12544
  ds_read_b64_tr_b16 a[102:103], v143 offset:15616
  ds_read_b64_tr_b16 a[176:177], v143 offset:512
  ds_read_b64_tr_b16 a[178:179], v143 offset:3584
  ds_read_b64_tr_b16 a[180:181], v143 offset:12800
  ds_read_b64_tr_b16 a[182:183], v143 offset:15872
  s_waitcnt lgkmcnt(0)
  s_waitcnt vmcnt(24)
  s_barrier
  s_lshl_b32 s29, s21, 10
  s_add_u32 m0, s29, 49152
  s_mov_b32 s28, 6291456
  buffer_load_dwordx4 v136, s[12:15], s28 offen lds
  s_lshl_b32 s29, s21, 10
  s_add_u32 m0, s29, 53248
  s_mov_b32 s28, 6291456
  buffer_load_dwordx4 v137, s[12:15], s28 offen lds
  s_lshl_b32 s29, s21, 10
  s_add_u32 m0, s29, 57344
  s_mov_b32 s28, 6291456
  buffer_load_dwordx4 v138, s[12:15], s28 offen lds
  s_lshl_b32 s29, s21, 10
  s_add_u32 m0, s29, 61440
  s_mov_b32 s28, 6291456
  buffer_load_dwordx4 v139, s[12:15], s28 offen lds
  s_lshl_b32 s29, s21, 10
  s_add_u32 m0, s29, 65536
  s_mov_b32 s28, 6291456
  buffer_load_dwordx4 v140, s[12:15], s28 offen lds
  s_lshl_b32 s29, s21, 10
  s_add_u32 m0, s29, 69632
  s_mov_b32 s28, 6291456
  buffer_load_dwordx4 v141, s[12:15], s28 offen lds
  v_add_u32 v143, 73728, v142
  ds_read_b64_tr_b16 a[24:25], v143 offset:0
  ds_read_b64_tr_b16 a[26:27], v143 offset:3072
  ds_read_b64_tr_b16 a[28:29], v143 offset:12288
  ds_read_b64_tr_b16 a[30:31], v143 offset:15360
  ds_read_b64_tr_b16 a[104:105], v143 offset:256
  ds_read_b64_tr_b16 a[106:107], v143 offset:3328
  ds_read_b64_tr_b16 a[108:109], v143 offset:12544
  ds_read_b64_tr_b16 a[110:111], v143 offset:15616
  ds_read_b64_tr_b16 a[184:185], v143 offset:512
  ds_read_b64_tr_b16 a[186:187], v143 offset:3584
  ds_read_b64_tr_b16 a[188:189], v143 offset:12800
  ds_read_b64_tr_b16 a[190:191], v143 offset:15872
  s_waitcnt lgkmcnt(0)
  s_waitcnt vmcnt(24)
  s_barrier
  s_lshl_b32 s29, s21, 10
  s_add_u32 m0, s29, 73728
  s_mov_b32 s28, 7077888
  buffer_load_dwordx4 v136, s[12:15], s28 offen lds
  s_lshl_b32 s29, s21, 10
  s_add_u32 m0, s29, 77824
  s_mov_b32 s28, 7077888
  buffer_load_dwordx4 v137, s[12:15], s28 offen lds
  s_lshl_b32 s29, s21, 10
  s_add_u32 m0, s29, 81920
  s_mov_b32 s28, 7077888
  buffer_load_dwordx4 v138, s[12:15], s28 offen lds
  s_lshl_b32 s29, s21, 10
  s_add_u32 m0, s29, 86016
  s_mov_b32 s28, 7077888
  buffer_load_dwordx4 v139, s[12:15], s28 offen lds
  s_lshl_b32 s29, s21, 10
  s_add_u32 m0, s29, 90112
  s_mov_b32 s28, 7077888
  buffer_load_dwordx4 v140, s[12:15], s28 offen lds
  s_lshl_b32 s29, s21, 10
  s_add_u32 m0, s29, 94208
  s_mov_b32 s28, 7077888
  buffer_load_dwordx4 v141, s[12:15], s28 offen lds
  v_add_u32 v143, 98304, v142
  ds_read_b64_tr_b16 a[32:33], v143 offset:0
  ds_read_b64_tr_b16 a[34:35], v143 offset:3072
  ds_read_b64_tr_b16 a[36:37], v143 offset:12288
  ds_read_b64_tr_b16 a[38:39], v143 offset:15360
  ds_read_b64_tr_b16 a[112:113], v143 offset:256
  ds_read_b64_tr_b16 a[114:115], v143 offset:3328
  ds_read_b64_tr_b16 a[116:117], v143 offset:12544
  ds_read_b64_tr_b16 a[118:119], v143 offset:15616
  ds_read_b64_tr_b16 a[192:193], v143 offset:512
  ds_read_b64_tr_b16 a[194:195], v143 offset:3584
  ds_read_b64_tr_b16 a[196:197], v143 offset:12800
  ds_read_b64_tr_b16 a[198:199], v143 offset:15872
  s_waitcnt lgkmcnt(0)
  s_waitcnt vmcnt(24)
  s_barrier
  s_lshl_b32 s29, s21, 10
  s_add_u32 m0, s29, 98304
  s_mov_b32 s28, 0
  buffer_load_dwordx4 v136, s[16:19], s28 offen lds
  s_lshl_b32 s29, s21, 10
  s_add_u32 m0, s29, 102400
  s_mov_b32 s28, 0
  buffer_load_dwordx4 v137, s[16:19], s28 offen lds
  s_lshl_b32 s29, s21, 10
  s_add_u32 m0, s29, 106496
  s_mov_b32 s28, 0
  buffer_load_dwordx4 v138, s[16:19], s28 offen lds
  s_lshl_b32 s29, s21, 10
  s_add_u32 m0, s29, 110592
  s_mov_b32 s28, 0
  buffer_load_dwordx4 v139, s[16:19], s28 offen lds
  s_lshl_b32 s29, s21, 10
  s_add_u32 m0, s29, 114688
  s_mov_b32 s28, 0
  buffer_load_dwordx4 v140, s[16:19], s28 offen lds
  s_lshl_b32 s29, s21, 10
  s_add_u32 m0, s29, 118784
  s_mov_b32 s28, 0
  buffer_load_dwordx4 v141, s[16:19], s28 offen lds
  v_add_u32 v143, 122880, v142
  ds_read_b64_tr_b16 a[40:41], v143 offset:0
  ds_read_b64_tr_b16 a[42:43], v143 offset:3072
  ds_read_b64_tr_b16 a[44:45], v143 offset:12288
  ds_read_b64_tr_b16 a[46:47], v143 offset:15360
  ds_read_b64_tr_b16 a[120:121], v143 offset:256
  ds_read_b64_tr_b16 a[122:123], v143 offset:3328
  ds_read_b64_tr_b16 a[124:125], v143 offset:12544
  ds_read_b64_tr_b16 a[126:127], v143 offset:15616
  ds_read_b64_tr_b16 a[200:201], v143 offset:512
  ds_read_b64_tr_b16 a[202:203], v143 offset:3584
  ds_read_b64_tr_b16 a[204:205], v143 offset:12800
  ds_read_b64_tr_b16 a[206:207], v143 offset:15872
  s_waitcnt lgkmcnt(0)
  s_waitcnt vmcnt(24)
  s_barrier
  s_lshl_b32 s29, s21, 10
  s_add_u32 m0, s29, 122880
  s_mov_b32 s28, 1572864
  buffer_load_dwordx4 v136, s[16:19], s28 offen lds
  s_lshl_b32 s29, s21, 10
  s_add_u32 m0, s29, 126976
  s_mov_b32 s28, 1572864
  buffer_load_dwordx4 v137, s[16:19], s28 offen lds
  s_lshl_b32 s29, s21, 10
  s_add_u32 m0, s29, 131072
  s_mov_b32 s28, 1572864
  buffer_load_dwordx4 v138, s[16:19], s28 offen lds
  s_lshl_b32 s29, s21, 10
  s_add_u32 m0, s29, 135168
  s_mov_b32 s28, 1572864
  buffer_load_dwordx4 v139, s[16:19], s28 offen lds
  s_lshl_b32 s29, s21, 10
  s_add_u32 m0, s29, 139264
  s_mov_b32 s28, 1572864
  buffer_load_dwordx4 v140, s[16:19], s28 offen lds
  s_lshl_b32 s29, s21, 10
  s_add_u32 m0, s29, 143360
  s_mov_b32 s28, 1572864
  buffer_load_dwordx4 v141, s[16:19], s28 offen lds
  v_add_u32 v143, 0, v142
  ds_read_b64_tr_b16 a[48:49], v143 offset:0
  ds_read_b64_tr_b16 a[50:51], v143 offset:3072
  ds_read_b64_tr_b16 a[52:53], v143 offset:12288
  ds_read_b64_tr_b16 a[54:55], v143 offset:15360
  ds_read_b64_tr_b16 a[128:129], v143 offset:256
  ds_read_b64_tr_b16 a[130:131], v143 offset:3328
  ds_read_b64_tr_b16 a[132:133], v143 offset:12544
  ds_read_b64_tr_b16 a[134:135], v143 offset:15616
  ds_read_b64_tr_b16 a[208:209], v143 offset:512
  ds_read_b64_tr_b16 a[210:211], v143 offset:3584
  ds_read_b64_tr_b16 a[212:213], v143 offset:12800
  ds_read_b64_tr_b16 a[214:215], v143 offset:15872
  s_waitcnt lgkmcnt(0)
  s_waitcnt vmcnt(24)
  s_barrier
  s_lshl_b32 s29, s21, 10
  s_add_u32 m0, s29, 0
  s_mov_b32 s28, 3145728
  buffer_load_dwordx4 v136, s[16:19], s28 offen lds
  s_lshl_b32 s29, s21, 10
  s_add_u32 m0, s29, 4096
  s_mov_b32 s28, 3145728
  buffer_load_dwordx4 v137, s[16:19], s28 offen lds
  s_lshl_b32 s29, s21, 10
  s_add_u32 m0, s29, 8192
  s_mov_b32 s28, 3145728
  buffer_load_dwordx4 v138, s[16:19], s28 offen lds
  s_lshl_b32 s29, s21, 10
  s_add_u32 m0, s29, 12288
  s_mov_b32 s28, 3145728
  buffer_load_dwordx4 v139, s[16:19], s28 offen lds
  s_lshl_b32 s29, s21, 10
  s_add_u32 m0, s29, 16384
  s_mov_b32 s28, 3145728
  buffer_load_dwordx4 v140, s[16:19], s28 offen lds
  s_lshl_b32 s29, s21, 10
  s_add_u32 m0, s29, 20480
  s_mov_b32 s28, 3145728
  buffer_load_dwordx4 v141, s[16:19], s28 offen lds
  v_add_u32 v143, 24576, v142
  ds_read_b64_tr_b16 a[56:57], v143 offset:0
  ds_read_b64_tr_b16 a[58:59], v143 offset:3072
  ds_read_b64_tr_b16 a[60:61], v143 offset:12288
  ds_read_b64_tr_b16 a[62:63], v143 offset:15360
  ds_read_b64_tr_b16 a[136:137], v143 offset:256
  ds_read_b64_tr_b16 a[138:139], v143 offset:3328
  ds_read_b64_tr_b16 a[140:141], v143 offset:12544
  ds_read_b64_tr_b16 a[142:143], v143 offset:15616
  ds_read_b64_tr_b16 a[216:217], v143 offset:512
  ds_read_b64_tr_b16 a[218:219], v143 offset:3584
  ds_read_b64_tr_b16 a[220:221], v143 offset:12800
  ds_read_b64_tr_b16 a[222:223], v143 offset:15872
  s_waitcnt lgkmcnt(0)
  s_waitcnt vmcnt(24)
  s_barrier
  s_lshl_b32 s29, s21, 10
  s_add_u32 m0, s29, 24576
  s_mov_b32 s28, 4718592
  buffer_load_dwordx4 v136, s[16:19], s28 offen lds
  s_lshl_b32 s29, s21, 10
  s_add_u32 m0, s29, 28672
  s_mov_b32 s28, 4718592
  buffer_load_dwordx4 v137, s[16:19], s28 offen lds
  s_lshl_b32 s29, s21, 10
  s_add_u32 m0, s29, 32768
  s_mov_b32 s28, 4718592
  buffer_load_dwordx4 v138, s[16:19], s28 offen lds
  s_lshl_b32 s29, s21, 10
  s_add_u32 m0, s29, 36864
  s_mov_b32 s28, 4718592
  buffer_load_dwordx4 v139, s[16:19], s28 offen lds
  s_lshl_b32 s29, s21, 10
  s_add_u32 m0, s29, 40960
  s_mov_b32 s28, 4718592
  buffer_load_dwordx4 v140, s[16:19], s28 offen lds
  s_lshl_b32 s29, s21, 10
  s_add_u32 m0, s29, 45056
  s_mov_b32 s28, 4718592
  buffer_load_dwordx4 v141, s[16:19], s28 offen lds
  v_add_u32 v143, 49152, v142
  ds_read_b64_tr_b16 a[64:65], v143 offset:0
  ds_read_b64_tr_b16 a[66:67], v143 offset:3072
  ds_read_b64_tr_b16 a[68:69], v143 offset:12288
  ds_read_b64_tr_b16 a[70:71], v143 offset:15360
  ds_read_b64_tr_b16 a[144:145], v143 offset:256
  ds_read_b64_tr_b16 a[146:147], v143 offset:3328
  ds_read_b64_tr_b16 a[148:149], v143 offset:12544
  ds_read_b64_tr_b16 a[150:151], v143 offset:15616
  ds_read_b64_tr_b16 a[224:225], v143 offset:512
  ds_read_b64_tr_b16 a[226:227], v143 offset:3584
  ds_read_b64_tr_b16 a[228:229], v143 offset:12800
  ds_read_b64_tr_b16 a[230:231], v143 offset:15872
  s_waitcnt lgkmcnt(0)
  s_waitcnt vmcnt(24)
  s_barrier
  s_lshl_b32 s29, s21, 10
  s_add_u32 m0, s29, 49152
  s_mov_b32 s28, 6291456
  buffer_load_dwordx4 v136, s[16:19], s28 offen lds
  s_lshl_b32 s29, s21, 10
  s_add_u32 m0, s29, 53248
  s_mov_b32 s28, 6291456
  buffer_load_dwordx4 v137, s[16:19], s28 offen lds
  s_lshl_b32 s29, s21, 10
  s_add_u32 m0, s29, 57344
  s_mov_b32 s28, 6291456
  buffer_load_dwordx4 v138, s[16:19], s28 offen lds
  s_lshl_b32 s29, s21, 10
  s_add_u32 m0, s29, 61440
  s_mov_b32 s28, 6291456
  buffer_load_dwordx4 v139, s[16:19], s28 offen lds
  s_lshl_b32 s29, s21, 10
  s_add_u32 m0, s29, 65536
  s_mov_b32 s28, 6291456
  buffer_load_dwordx4 v140, s[16:19], s28 offen lds
  s_lshl_b32 s29, s21, 10
  s_add_u32 m0, s29, 69632
  s_mov_b32 s28, 6291456
  buffer_load_dwordx4 v141, s[16:19], s28 offen lds
  v_add_u32 v143, 73728, v142
  ds_read_b64_tr_b16 a[72:73], v143 offset:0
  ds_read_b64_tr_b16 a[74:75], v143 offset:3072
  ds_read_b64_tr_b16 a[76:77], v143 offset:12288
  ds_read_b64_tr_b16 a[78:79], v143 offset:15360
  ds_read_b64_tr_b16 a[152:153], v143 offset:256
  ds_read_b64_tr_b16 a[154:155], v143 offset:3328
  ds_read_b64_tr_b16 a[156:157], v143 offset:12544
  ds_read_b64_tr_b16 a[158:159], v143 offset:15616
  ds_read_b64_tr_b16 a[232:233], v143 offset:512
  ds_read_b64_tr_b16 a[234:235], v143 offset:3584
  ds_read_b64_tr_b16 a[236:237], v143 offset:12800
  ds_read_b64_tr_b16 a[238:239], v143 offset:15872
  s_waitcnt lgkmcnt(0)
  s_waitcnt vmcnt(24)
  s_barrier
  s_lshl_b32 s29, s21, 10
  s_add_u32 m0, s29, 73728
  s_mov_b32 s28, 786432
  buffer_load_dwordx4 v136, s[16:19], s28 offen lds
  s_lshl_b32 s29, s21, 10
  s_add_u32 m0, s29, 77824
  s_mov_b32 s28, 786432
  buffer_load_dwordx4 v137, s[16:19], s28 offen lds
  s_lshl_b32 s29, s21, 10
  s_add_u32 m0, s29, 81920
  s_mov_b32 s28, 786432
  buffer_load_dwordx4 v138, s[16:19], s28 offen lds
  s_lshl_b32 s29, s21, 10
  s_add_u32 m0, s29, 86016
  s_mov_b32 s28, 786432
  buffer_load_dwordx4 v139, s[16:19], s28 offen lds
  s_lshl_b32 s29, s21, 10
  s_add_u32 m0, s29, 90112
  s_mov_b32 s28, 786432
  buffer_load_dwordx4 v140, s[16:19], s28 offen lds
  s_lshl_b32 s29, s21, 10
  s_add_u32 m0, s29, 94208
  s_mov_b32 s28, 786432
  buffer_load_dwordx4 v141, s[16:19], s28 offen lds
  v_add_u32 v143, 98304, v142
  ds_read_b64_tr_b16 a[240:241], v143 offset:0
  ds_read_b64_tr_b16 a[242:243], v143 offset:3072
  ds_read_b64_tr_b16 a[244:245], v143 offset:12288
  ds_read_b64_tr_b16 a[246:247], v143 offset:15360
  ds_read_b64_tr_b16 v[176:177], v143 offset:256
  ds_read_b64_tr_b16 v[178:179], v143 offset:3328
  ds_read_b64_tr_b16 v[180:181], v143 offset:12544
  ds_read_b64_tr_b16 v[182:183], v143 offset:15616
  ds_read_b64_tr_b16 v[216:217], v143 offset:512
  ds_read_b64_tr_b16 v[218:219], v143 offset:3584
  ds_read_b64_tr_b16 v[220:221], v143 offset:12800
  ds_read_b64_tr_b16 v[222:223], v143 offset:15872
  s_waitcnt lgkmcnt(0)
  s_waitcnt vmcnt(24)
  s_barrier
  s_lshl_b32 s29, s21, 10
  s_add_u32 m0, s29, 98304
  s_mov_b32 s28, 2359296
  buffer_load_dwordx4 v136, s[16:19], s28 offen lds
  s_lshl_b32 s29, s21, 10
  s_add_u32 m0, s29, 102400
  s_mov_b32 s28, 2359296
  buffer_load_dwordx4 v137, s[16:19], s28 offen lds
  s_lshl_b32 s29, s21, 10
  s_add_u32 m0, s29, 106496
  s_mov_b32 s28, 2359296
  buffer_load_dwordx4 v138, s[16:19], s28 offen lds
  s_lshl_b32 s29, s21, 10
  s_add_u32 m0, s29, 110592
  s_mov_b32 s28, 2359296
  buffer_load_dwordx4 v139, s[16:19], s28 offen lds
  s_lshl_b32 s29, s21, 10
  s_add_u32 m0, s29, 114688
  s_mov_b32 s28, 2359296
  buffer_load_dwordx4 v140, s[16:19], s28 offen lds
  s_lshl_b32 s29, s21, 10
  s_add_u32 m0, s29, 118784
  s_mov_b32 s28, 2359296
  buffer_load_dwordx4 v141, s[16:19], s28 offen lds
  v_add_u32 v143, 122880, v142
  ds_read_b64_tr_b16 a[248:249], v143 offset:0
  ds_read_b64_tr_b16 a[250:251], v143 offset:3072
  ds_read_b64_tr_b16 a[252:253], v143 offset:12288
  ds_read_b64_tr_b16 a[254:255], v143 offset:15360
  ds_read_b64_tr_b16 v[184:185], v143 offset:256
  ds_read_b64_tr_b16 v[186:187], v143 offset:3328
  ds_read_b64_tr_b16 v[188:189], v143 offset:12544
  ds_read_b64_tr_b16 v[190:191], v143 offset:15616
  ds_read_b64_tr_b16 v[224:225], v143 offset:512
  ds_read_b64_tr_b16 v[226:227], v143 offset:3584
  ds_read_b64_tr_b16 v[228:229], v143 offset:12800
  ds_read_b64_tr_b16 v[230:231], v143 offset:15872
  s_waitcnt lgkmcnt(0)
  s_waitcnt vmcnt(24)
  s_barrier
  s_lshl_b32 s29, s21, 10
  s_add_u32 m0, s29, 122880
  s_mov_b32 s28, 3932160
  buffer_load_dwordx4 v136, s[16:19], s28 offen lds
  s_lshl_b32 s29, s21, 10
  s_add_u32 m0, s29, 126976
  s_mov_b32 s28, 3932160
  buffer_load_dwordx4 v137, s[16:19], s28 offen lds
  s_lshl_b32 s29, s21, 10
  s_add_u32 m0, s29, 131072
  s_mov_b32 s28, 3932160
  buffer_load_dwordx4 v138, s[16:19], s28 offen lds
  s_lshl_b32 s29, s21, 10
  s_add_u32 m0, s29, 135168
  s_mov_b32 s28, 3932160
  buffer_load_dwordx4 v139, s[16:19], s28 offen lds
  s_lshl_b32 s29, s21, 10
  s_add_u32 m0, s29, 139264
  s_mov_b32 s28, 3932160
  buffer_load_dwordx4 v140, s[16:19], s28 offen lds
  s_lshl_b32 s29, s21, 10
  s_add_u32 m0, s29, 143360
  s_mov_b32 s28, 3932160
  buffer_load_dwordx4 v141, s[16:19], s28 offen lds
  v_add_u32 v143, 0, v142
  ds_read_b64_tr_b16 v[152:153], v143 offset:0
  ds_read_b64_tr_b16 v[154:155], v143 offset:3072
  ds_read_b64_tr_b16 v[156:157], v143 offset:12288
  ds_read_b64_tr_b16 v[158:159], v143 offset:15360
  ds_read_b64_tr_b16 v[192:193], v143 offset:256
  ds_read_b64_tr_b16 v[194:195], v143 offset:3328
  ds_read_b64_tr_b16 v[196:197], v143 offset:12544
  ds_read_b64_tr_b16 v[198:199], v143 offset:15616
  ds_read_b64_tr_b16 v[232:233], v143 offset:512
  ds_read_b64_tr_b16 v[234:235], v143 offset:3584
  ds_read_b64_tr_b16 v[236:237], v143 offset:12800
  ds_read_b64_tr_b16 v[238:239], v143 offset:15872
  s_waitcnt lgkmcnt(0)
  s_waitcnt vmcnt(24)
  s_barrier
  s_lshl_b32 s29, s21, 10
  s_add_u32 m0, s29, 0
  s_mov_b32 s28, 5505024
  buffer_load_dwordx4 v136, s[16:19], s28 offen lds
  s_lshl_b32 s29, s21, 10
  s_add_u32 m0, s29, 4096
  s_mov_b32 s28, 5505024
  buffer_load_dwordx4 v137, s[16:19], s28 offen lds
  s_lshl_b32 s29, s21, 10
  s_add_u32 m0, s29, 8192
  s_mov_b32 s28, 5505024
  buffer_load_dwordx4 v138, s[16:19], s28 offen lds
  s_lshl_b32 s29, s21, 10
  s_add_u32 m0, s29, 12288
  s_mov_b32 s28, 5505024
  buffer_load_dwordx4 v139, s[16:19], s28 offen lds
  s_lshl_b32 s29, s21, 10
  s_add_u32 m0, s29, 16384
  s_mov_b32 s28, 5505024
  buffer_load_dwordx4 v140, s[16:19], s28 offen lds
  s_lshl_b32 s29, s21, 10
  s_add_u32 m0, s29, 20480
  s_mov_b32 s28, 5505024
  buffer_load_dwordx4 v141, s[16:19], s28 offen lds
  v_add_u32 v143, 24576, v142
  ds_read_b64_tr_b16 v[160:161], v143 offset:0
  ds_read_b64_tr_b16 v[162:163], v143 offset:3072
  ds_read_b64_tr_b16 v[164:165], v143 offset:12288
  ds_read_b64_tr_b16 v[166:167], v143 offset:15360
  ds_read_b64_tr_b16 v[200:201], v143 offset:256
  ds_read_b64_tr_b16 v[202:203], v143 offset:3328
  ds_read_b64_tr_b16 v[204:205], v143 offset:12544
  ds_read_b64_tr_b16 v[206:207], v143 offset:15616
  ds_read_b64_tr_b16 v[240:241], v143 offset:512
  ds_read_b64_tr_b16 v[242:243], v143 offset:3584
  ds_read_b64_tr_b16 v[244:245], v143 offset:12800
  ds_read_b64_tr_b16 v[246:247], v143 offset:15872
  s_waitcnt lgkmcnt(0)
  s_waitcnt vmcnt(24)
  s_barrier
  s_lshl_b32 s29, s21, 10
  s_add_u32 m0, s29, 24576
  s_mov_b32 s28, 7077888
  buffer_load_dwordx4 v136, s[16:19], s28 offen lds
  s_lshl_b32 s29, s21, 10
  s_add_u32 m0, s29, 28672
  s_mov_b32 s28, 7077888
  buffer_load_dwordx4 v137, s[16:19], s28 offen lds
  s_lshl_b32 s29, s21, 10
  s_add_u32 m0, s29, 32768
  s_mov_b32 s28, 7077888
  buffer_load_dwordx4 v138, s[16:19], s28 offen lds
  s_lshl_b32 s29, s21, 10
  s_add_u32 m0, s29, 36864
  s_mov_b32 s28, 7077888
  buffer_load_dwordx4 v139, s[16:19], s28 offen lds
  s_lshl_b32 s29, s21, 10
  s_add_u32 m0, s29, 40960
  s_mov_b32 s28, 7077888
  buffer_load_dwordx4 v140, s[16:19], s28 offen lds
  s_lshl_b32 s29, s21, 10
  s_add_u32 m0, s29, 45056
  s_mov_b32 s28, 7077888
  buffer_load_dwordx4 v141, s[16:19], s28 offen lds
  v_add_u32 v143, 49152, v142
  ds_read_b64_tr_b16 v[168:169], v143 offset:0
  ds_read_b64_tr_b16 v[170:171], v143 offset:3072
  ds_read_b64_tr_b16 v[172:173], v143 offset:12288
  ds_read_b64_tr_b16 v[174:175], v143 offset:15360
  ds_read_b64_tr_b16 v[208:209], v143 offset:256
  ds_read_b64_tr_b16 v[210:211], v143 offset:3328
  ds_read_b64_tr_b16 v[212:213], v143 offset:12544
  ds_read_b64_tr_b16 v[214:215], v143 offset:15616
  ds_read_b64_tr_b16 v[248:249], v143 offset:512
  ds_read_b64_tr_b16 v[250:251], v143 offset:3584
  ds_read_b64_tr_b16 v[252:253], v143 offset:12800
  ds_read_b64_tr_b16 v[254:255], v143 offset:15872
  s_waitcnt lgkmcnt(0)
  s_waitcnt vmcnt(24)
  s_barrier
  v_add_u32 v143, 73728, v142
  ds_read_b64_tr_b16 v[16:17], v143 offset:0
  ds_read_b64_tr_b16 v[18:19], v143 offset:3072
  ds_read_b64_tr_b16 v[20:21], v143 offset:12288
  ds_read_b64_tr_b16 v[22:23], v143 offset:15360
  ds_read_b64_tr_b16 v[24:25], v143 offset:256
  ds_read_b64_tr_b16 v[26:27], v143 offset:3328
  ds_read_b64_tr_b16 v[28:29], v143 offset:12544
  ds_read_b64_tr_b16 v[30:31], v143 offset:15616
  ds_read_b64_tr_b16 v[32:33], v143 offset:512
  ds_read_b64_tr_b16 v[34:35], v143 offset:3584
  ds_read_b64_tr_b16 v[36:37], v143 offset:12800
  ds_read_b64_tr_b16 v[38:39], v143 offset:15872
  s_waitcnt lgkmcnt(0)
  s_waitcnt vmcnt(18)
  s_barrier
  v_add_u32 v143, 98304, v142
  ds_read_b64_tr_b16 v[40:41], v143 offset:0
  ds_read_b64_tr_b16 v[42:43], v143 offset:3072
  ds_read_b64_tr_b16 v[44:45], v143 offset:12288
  ds_read_b64_tr_b16 v[46:47], v143 offset:15360
  ds_read_b64_tr_b16 v[48:49], v143 offset:256
  ds_read_b64_tr_b16 v[50:51], v143 offset:3328
  ds_read_b64_tr_b16 v[52:53], v143 offset:12544
  ds_read_b64_tr_b16 v[54:55], v143 offset:15616
  ds_read_b64_tr_b16 v[56:57], v143 offset:512
  ds_read_b64_tr_b16 v[58:59], v143 offset:3584
  ds_read_b64_tr_b16 v[60:61], v143 offset:12800
  ds_read_b64_tr_b16 v[62:63], v143 offset:15872
  s_waitcnt lgkmcnt(0)
  s_waitcnt vmcnt(12)
  s_barrier
  v_add_u32 v143, 122880, v142
  ds_read_b64_tr_b16 v[64:65], v143 offset:0
  ds_read_b64_tr_b16 v[66:67], v143 offset:3072
  ds_read_b64_tr_b16 v[68:69], v143 offset:12288
  ds_read_b64_tr_b16 v[70:71], v143 offset:15360
  ds_read_b64_tr_b16 v[72:73], v143 offset:256
  ds_read_b64_tr_b16 v[74:75], v143 offset:3328
  ds_read_b64_tr_b16 v[76:77], v143 offset:12544
  ds_read_b64_tr_b16 v[78:79], v143 offset:15616
  ds_read_b64_tr_b16 v[80:81], v143 offset:512
  ds_read_b64_tr_b16 v[82:83], v143 offset:3584
  ds_read_b64_tr_b16 v[84:85], v143 offset:12800
  ds_read_b64_tr_b16 v[86:87], v143 offset:15872
  s_waitcnt lgkmcnt(0)
  s_waitcnt vmcnt(6)
  s_barrier
  v_add_u32 v143, 0, v142
  ds_read_b64_tr_b16 v[88:89], v143 offset:0
  ds_read_b64_tr_b16 v[90:91], v143 offset:3072
  ds_read_b64_tr_b16 v[92:93], v143 offset:12288
  ds_read_b64_tr_b16 v[94:95], v143 offset:15360
  ds_read_b64_tr_b16 v[96:97], v143 offset:256
  ds_read_b64_tr_b16 v[98:99], v143 offset:3328
  ds_read_b64_tr_b16 v[100:101], v143 offset:12544
  ds_read_b64_tr_b16 v[102:103], v143 offset:15616
  ds_read_b64_tr_b16 v[104:105], v143 offset:512
  ds_read_b64_tr_b16 v[106:107], v143 offset:3584
  ds_read_b64_tr_b16 v[108:109], v143 offset:12800
  ds_read_b64_tr_b16 v[110:111], v143 offset:15872
  s_waitcnt lgkmcnt(0)
  s_waitcnt vmcnt(0)
  s_barrier
  v_add_u32 v143, 24576, v142
  ds_read_b64_tr_b16 v[112:113], v143 offset:0
  ds_read_b64_tr_b16 v[114:115], v143 offset:3072
  ds_read_b64_tr_b16 v[116:117], v143 offset:12288
  ds_read_b64_tr_b16 v[118:119], v143 offset:15360
  ds_read_b64_tr_b16 v[120:121], v143 offset:256
  ds_read_b64_tr_b16 v[122:123], v143 offset:3328
  ds_read_b64_tr_b16 v[124:125], v143 offset:12544
  ds_read_b64_tr_b16 v[126:127], v143 offset:15616
  ds_read_b64_tr_b16 v[128:129], v143 offset:512
  ds_read_b64_tr_b16 v[130:131], v143 offset:3584
  ds_read_b64_tr_b16 v[132:133], v143 offset:12800
  ds_read_b64_tr_b16 v[134:135], v143 offset:15872
  s_waitcnt lgkmcnt(0)
  s_barrier
  v_lshlrev_b32 v2, 4, v1
  s_mul_i32 s28, s21, 30720
  v_add_u32 v143, s28, v2
  ds_write_b128 v143, v[16:19] offset:0
  ds_write_b128 v143, v[20:23] offset:1024
  ds_write_b128 v143, v[24:27] offset:10240
  ds_write_b128 v143, v[28:31] offset:11264
  ds_write_b128 v143, v[32:35] offset:20480
  ds_write_b128 v143, v[36:39] offset:21504
  ds_write_b128 v143, v[40:43] offset:2048
  ds_write_b128 v143, v[44:47] offset:3072
  ds_write_b128 v143, v[48:51] offset:12288
  ds_write_b128 v143, v[52:55] offset:13312
  ds_write_b128 v143, v[56:59] offset:22528
  ds_write_b128 v143, v[60:63] offset:23552
  ds_write_b128 v143, v[64:67] offset:4096
  ds_write_b128 v143, v[68:71] offset:5120
  ds_write_b128 v143, v[72:75] offset:14336
  ds_write_b128 v143, v[76:79] offset:15360
  ds_write_b128 v143, v[80:83] offset:24576
  ds_write_b128 v143, v[84:87] offset:25600
  ds_write_b128 v143, v[88:91] offset:6144
  ds_write_b128 v143, v[92:95] offset:7168
  ds_write_b128 v143, v[96:99] offset:16384
  ds_write_b128 v143, v[100:103] offset:17408
  ds_write_b128 v143, v[104:107] offset:26624
  ds_write_b128 v143, v[108:111] offset:27648
  ds_write_b128 v143, v[112:115] offset:8192
  ds_write_b128 v143, v[116:119] offset:9216
  ds_write_b128 v143, v[120:123] offset:18432
  ds_write_b128 v143, v[124:127] offset:19456
  ds_write_b128 v143, v[128:131] offset:28672
  ds_write_b128 v143, v[132:135] offset:29696
  s_waitcnt lgkmcnt(0)
  v_and_b32 v1, 63, v0
  v_lshlrev_b32 v132, 4, v1
  s_mul_i32 s28, s21, 30720
  v_add_u32 v129, s28, v132
  s_lshl_b32 s28, s21, 10
  v_add_u32 v124, s28, v132
  v_add_u32 v125, 4096, v124
  v_add_u32 v126, 8192, v124
  v_add_u32 v127, 122880, v124
  v_add_u32 v128, 122880, v132
  s_mul_i32 s28, s21, 3072
  s_add_u32 s28, s28, 133120
  v_add_u32 v130, s28, v132
  s_mul_i32 s28, s21, 1536
  s_add_u32 s28, s28, 145408
  v_lshlrev_b32 v2, 3, v1
  v_add_u32 v131, s28, v2
  v_mov_b32 v110, 0x44444444
  v_mov_b32 v2, 0xeeeeeeee
  v_and_b32 v3, 8, v1
  v_cmp_ne_u32 vcc, 0, v3
  s_nop 1
  v_cndmask_b32 v110, v110, v2, vcc
  v_and_b32 v4, 15, v1
  v_lshrrev_b32 v5, 4, v1
  v_lshlrev_b32 v6, 2, v5
  v_sub_u32 v6, v4, v6
  v_mov_b32 v7, 0x3f80
  v_mov_b32 v8, 0x3f800000
  v_mov_b32 v108, 0
  v_mov_b32 v109, 0
  v_cmp_eq_u32 vcc, 0, v6
  s_nop 1
  v_cndmask_b32 v108, v108, v7, vcc
  v_cmp_eq_u32 vcc, 1, v6
  s_nop 1
  v_cndmask_b32 v108, v108, v8, vcc
  v_cmp_eq_u32 vcc, 2, v6
  s_nop 1
  v_cndmask_b32 v109, v109, v7, vcc
  v_cmp_eq_u32 vcc, 3, v6
  s_nop 1
  v_cndmask_b32 v109, v109, v8, vcc
  s_mul_i32 s28, s23, 6
  s_lshr_b32 s29, s28, 3
  s_add_u32 s28, s28, 5
  s_lshr_b32 s28, s28, 3
  v_mov_b32 v6, s29
  v_mov_b32 v7, s28
  v_and_b32 v8, 1, v1
  v_cmp_eq_u32 vcc, 1, v8
  s_nop 1
  v_cndmask_b32 v6, v6, v7, vcc
  v_lshlrev_b32 v6, 2, v6
  v_bfe_u32 v8, v1, 1, 1
  v_lshlrev_b32 v8, 10, v8
  v_add_u32 v6, v6, v8
  v_add_u32 v138, 0, v6
  s_mul_i32 s97, s20, 655360
  s_add_u32 s97, s97, 0x400000
  s_mov_b32 s48, 0x4000
  s_mul_i32 s49, s20, 327680
  s_add_u32 s49, s49, 0x700000
  s_mul_i32 s50, s23, 786432
  s_add_u32 s63, s50, 0x4800000
  s_add_u32 s50, s50, 0x6000000
  s_mov_b32 s51, 0
  s_mov_b32 s52, 0
  s_mul_i32 s28, s21, 3
  s_add_u32 s28, s28, 0
  s_lshr_b32 s29, s28, 1
  s_lshl_b32 s29, s29, 11
  s_and_b32 s28, s28, 1
  s_lshl_b32 s28, s28, 3
  s_add_u32 s53, s29, s28
  s_mul_i32 s28, s21, 3
  s_add_u32 s28, s28, 1
  s_lshr_b32 s29, s28, 1
  s_lshl_b32 s29, s29, 11
  s_and_b32 s28, s28, 1
  s_lshl_b32 s28, s28, 3
  s_add_u32 s54, s29, s28
  s_mul_i32 s28, s21, 3
  s_add_u32 s28, s28, 2
  s_lshr_b32 s29, s28, 1
  s_lshl_b32 s29, s29, 11
  s_and_b32 s28, s28, 1
  s_lshl_b32 s28, s28, 3
  s_add_u32 s55, s29, s28
  v_mov_b32 v60, 0
  v_mov_b32 v61, 0
  v_mov_b32 v62, 0
  v_mov_b32 v63, 0
  v_mov_b32 v64, 0
  v_mov_b32 v65, 0
  v_mov_b32 v66, 0
  v_mov_b32 v67, 0
  v_mov_b32 v68, 0
  v_mov_b32 v69, 0
  v_mov_b32 v70, 0
  v_mov_b32 v71, 0
  v_mov_b32 v72, 0
  v_mov_b32 v73, 0
  v_mov_b32 v74, 0
  v_mov_b32 v75, 0
  v_mov_b32 v36, 0
  v_mov_b32 v37, 0
  v_mov_b32 v38, 0
  v_mov_b32 v39, 0
  v_mov_b32 v40, 0
  v_mov_b32 v41, 0
  v_mov_b32 v42, 0
  v_mov_b32 v43, 0
  s_barrier
  s_cmp_gt_u32 s52, s51
  s_cbranch_scc1 kas_x_wp_86_ok
  s_mov_b32 s45, 0
kas_x_wp_86_spin:
  buffer_load_dword v2, v138, s[8:11], 0 offen sc1
  s_add_u32 s45, s45, 1
  s_waitcnt vmcnt(0)
  v_min_u32_dpp v3, v2, v2 quad_perm:[1,0,3,2] row_mask:0xf bank_mask:0xf
  s_nop 1
  v_min_u32_dpp v2, v3, v3 quad_perm:[2,3,0,1] row_mask:0xf bank_mask:0xf
  s_nop 1
  v_min_u32_dpp v3, v2, v2 row_half_mirror row_mask:0xf bank_mask:0xf
  s_nop 1
  v_min_u32_dpp v2, v3, v3 quad_perm:[0,1,2,3] row_mask:0xf bank_mask:0xf
  s_nop 0
  v_readfirstlane_b32 s52, v2
  s_cmp_gt_u32 s52, s51
  s_cbranch_scc1 kas_x_wp_86_ok
  s_cmp_lt_u32 s45, 400000
  s_cbranch_scc1 kas_x_wp_86_spin
  s_branch kas_abort
kas_x_wp_86_ok:
  s_add_u32 s28, s50, s53
  buffer_load_dwordx2 v[88:89], v132, s[8:11], s28 offen offset:0 sc1
  buffer_load_dwordx2 v[92:93], v132, s[8:11], s28 offen offset:1024 sc1
  s_add_u32 s28, s50, s54
  buffer_load_dwordx2 v[90:91], v132, s[8:11], s28 offen offset:0 sc1
  buffer_load_dwordx2 v[94:95], v132, s[8:11], s28 offen offset:1024 sc1
  s_add_u32 s28, s50, s55
  buffer_load_dwordx2 v[96:97], v132, s[8:11], s28 offen offset:0 sc1
  buffer_load_dwordx2 v[98:99], v132, s[8:11], s28 offen offset:1024 sc1
  s_cmp_eq_u32 s21, 0
  s_cbranch_scc1 kas_x_w0
  s_cmp_eq_u32 s21, 1
  s_cbranch_scc1 kas_x_w1
  s_branch kas_x_w23
kas_x_w0:
  v_lshrrev_b32 v4, 3, v1
  v_and_b32 v5, 7, v1
  v_lshrrev_b32 v6, 2, v5
  v_and_b32 v7, 3, v5
  v_lshlrev_b32 v8, 10, v6
  v_lshlrev_b32 v9, 4, v7
  v_add_u32 v9, v9, v4
  v_lshlrev_b32 v9, 4, v9
  v_add_u32 v8, v8, v9
  v_add_u32 v133, 134144, v8
  v_add_u32 v8, 2, v6
  v_lshlrev_b32 v8, 4, v8
  v_add_u32 v8, v8, v4
  v_lshlrev_b32 v8, 4, v8
  v_lshlrev_b32 v9, 2, v7
  v_add_u32 v8, v8, v9
  v_add_u32 v134, 133120, v8
  s_and_b32 s26, s23, 7
  v_and_b32 v8, 1, v7
  v_lshlrev_b32 v8, 1, v8
  v_add_u32 v8, v8, v6
  v_lshlrev_b32 v8, 4, v8
  v_add_u32 v8, v8, v4
  v_lshlrev_b32 v8, 4, v8
  v_lshrrev_b32 v9, 1, v7
  v_lshlrev_b32 v9, 3, v9
  v_add_u32 v8, v8, v9
  s_lshr_b32 s28, s26, 1
  s_lshl_b32 s28, s28, 10
  s_and_b32 s29, s26, 1
  s_lshl_b32 s29, s29, 7
  s_add_u32 s28, s28, s29
  v_add_u32 v135, s28, v8
  v_lshlrev_b32 v8, 4, v6
  v_add_u32 v8, v8, v4
  v_lshlrev_b32 v8, 4, v8
  v_lshlrev_b32 v9, 1, v7
  v_add_u32 v8, v8, v9
  s_lshr_b32 s28, s26, 2
  s_lshl_b32 s28, s28, 7
  s_and_b32 s29, s26, 1
  s_lshl_b32 s29, s29, 9
  s_add_u32 s28, s28, s29
  s_bfe_u32 s29, s26, 0x10001
  s_lshl_b32 s29, s29, 3
  s_add_u32 s28, s28, s29
  s_add_u32 s28, s28, 4096
  v_add_u32 v8, s28, v8
  v_mov_b32 v9, 0x40000000
  v_and_b32 v10, 1, v5
  v_cmp_eq_u32 vcc, 0, v10
  s_nop 1
  v_cndmask_b32 v136, v9, v8, vcc
  s_mov_b32 s64, 0x3dd53b95
  s_mov_b32 s65, 0x3dd53b95
kas_x_w0l:
  ds_read_b128 v[44:47], v129 offset:0
  ds_read_b128 v[48:51], v129 offset:1024
  ds_read_b128 v[52:55], v129 offset:2048
  ds_read_b128 v[56:59], v129 offset:3072
  s_waitcnt lgkmcnt(0)
  s_mov_b32 s45, 0
kas_x_pf_87:
  buffer_load_dwordx4 v[112:115], v124, s[8:11], s48 offen sc1
  buffer_load_dwordx4 v[116:119], v125, s[8:11], s48 offen sc1
  buffer_load_dwordx4 v[120:123], v126, s[8:11], s48 offen sc1
  s_add_u32 s45, s45, 1
  s_waitcnt vmcnt(2)
  ds_write_b128 v127, v[112:115] offset:0
  v_max3_u32 v139, v112, v113, v114
  v_max_u32 v139, v139, v115
  s_waitcnt vmcnt(1)
  ds_write_b128 v127, v[116:119] offset:4096
  v_max3_u32 v139, v139, v116, v117
  v_max3_u32 v139, v139, v118, v119
  s_waitcnt vmcnt(0)
  ds_write_b128 v127, v[120:123] offset:8192
  v_max3_u32 v139, v139, v120, v121
  v_max3_u32 v139, v139, v122, v123
  v_cmp_eq_u32 vcc, -1, v139
  s_cbranch_vccz kas_x_pf_87_ok
  s_cmp_lt_u32 s45, 400000
  s_cbranch_scc1 kas_x_pf_87
  s_branch kas_abort
kas_x_pf_87_ok:
  v_smfmac_f32_16x16x64_bf16 v[60:63], v[112:115], a[0:7], v110
  v_smfmac_f32_16x16x64_bf16 v[64:67], v[112:115], a[240:247], v110
  v_smfmac_f32_16x16x64_bf16 v[68:71], v[112:115], a[80:87], v110
  v_smfmac_f32_16x16x64_bf16 v[72:75], v[112:115], v[176:183], v110
  s_waitcnt lgkmcnt(0)
  s_barrier
  v_smfmac_f32_16x16x64_bf16 v[36:39], v[112:115], a[160:167], v110
  ds_read_b128 v[4:7], v128 offset:1024
  v_smfmac_f32_16x16x64_bf16 v[40:43], v[112:115], v[216:223], v110
  ds_read_b128 v[8:11], v128 offset:2048
  v_smfmac_f32_16x16x64_bf16 v[60:63], v[116:119], a[32:39], v110
  ds_read_b128 v[12:15], v128 offset:3072
  v_smfmac_f32_16x16x64_bf16 v[64:67], v[116:119], v[152:159], v110
  ds_read_b128 v[16:19], v128 offset:5120
  v_smfmac_f32_16x16x64_bf16 v[68:71], v[116:119], a[112:119], v110
  ds_read_b128 v[20:23], v128 offset:6144
  v_smfmac_f32_16x16x64_bf16 v[72:75], v[116:119], v[192:199], v110
  ds_read_b128 v[24:27], v128 offset:7168
  v_smfmac_f32_16x16x64_bf16 v[36:39], v[116:119], a[192:199], v110
  ds_read_b128 v[28:31], v128 offset:9216
  v_smfmac_f32_16x16x64_bf16 v[40:43], v[116:119], v[232:239], v110
  v_smfmac_f32_16x16x64_bf16 v[60:63], v[120:123], a[64:71], v110
  v_smfmac_f32_16x16x64_bf16 v[64:67], v[120:123], v[168:175], v110
  v_smfmac_f32_16x16x64_bf16 v[68:71], v[120:123], a[144:151], v110
  v_smfmac_f32_16x16x64_bf16 v[72:75], v[120:123], v[208:215], v110
  v_smfmac_f32_16x16x64_bf16 v[36:39], v[120:123], a[224:231], v110
  v_smfmac_f32_16x16x64_bf16 v[40:43], v[120:123], v[248:255], v110
  s_waitcnt lgkmcnt(6)
  v_smfmac_f32_16x16x64_bf16 v[60:63], v[4:7], a[8:15], v110
  v_smfmac_f32_16x16x64_bf16 v[64:67], v[4:7], v[44:51], v110
  ds_read_b128 v[44:47], v129 offset:4096
  s_waitcnt lgkmcnt(6)
  v_smfmac_f32_16x16x64_bf16 v[60:63], v[8:11], a[16:23], v110
  ds_read_b128 v[48:51], v129 offset:5120
  v_smfmac_f32_16x16x64_bf16 v[64:67], v[8:11], a[248:255], v110
  s_waitcnt lgkmcnt(6)
  v_smfmac_f32_16x16x64_bf16 v[60:63], v[12:15], a[24:31], v110
  v_smfmac_f32_16x16x64_bf16 v[64:67], v[12:15], v[52:59], v110
  ds_read_b128 v[52:55], v129 offset:6144
  s_waitcnt lgkmcnt(6)
  v_smfmac_f32_16x16x64_bf16 v[60:63], v[16:19], a[40:47], v110
  ds_read_b128 v[56:59], v129 offset:7168
  s_waitcnt lgkmcnt(2)
  v_smfmac_f32_16x16x64_bf16 v[64:67], v[16:19], v[44:51], v110
  ds_read_b128 v[44:47], v129 offset:8192
  v_smfmac_f32_16x16x64_bf16 v[60:63], v[20:23], a[48:55], v110
  ds_read_b128 v[48:51], v129 offset:9216
  v_smfmac_f32_16x16x64_bf16 v[64:67], v[20:23], v[160:167], v110
  v_smfmac_f32_16x16x64_bf16 v[60:63], v[24:27], a[56:63], v110
  s_waitcnt lgkmcnt(2)
  v_smfmac_f32_16x16x64_bf16 v[64:67], v[24:27], v[52:59], v110
  ds_read_b128 v[52:55], v129 offset:10240
  v_smfmac_f32_16x16x64_bf16 v[60:63], v[28:31], a[72:79], v110
  ds_read_b128 v[56:59], v129 offset:11264
  s_waitcnt lgkmcnt(2)
  v_smfmac_f32_16x16x64_bf16 v[64:67], v[28:31], v[44:51], v110
  ds_read_b128 v[44:47], v129 offset:12288
  v_smfmac_f32_16x16x64_bf16 v[68:71], v[4:7], a[88:95], v110
  ds_read_b128 v[48:51], v129 offset:13312
  s_waitcnt lgkmcnt(2)
  v_smfmac_f32_16x16x64_bf16 v[72:75], v[4:7], v[52:59], v110
  ds_read_b128 v[52:55], v129 offset:14336
  v_permlane32_swap_b32 v60, v64
  v_smfmac_f32_16x16x64_bf16 v[68:71], v[8:11], a[96:103], v110
  ds_read_b128 v[56:59], v129 offset:15360
  v_smfmac_f32_16x16x64_bf16 v[72:75], v[8:11], v[184:191], v110
  v_permlane32_swap_b32 v61, v65
  v_smfmac_f32_16x16x64_bf16 v[68:71], v[12:15], a[104:111], v110
  s_waitcnt lgkmcnt(2)
  v_smfmac_f32_16x16x64_bf16 v[72:75], v[12:15], v[44:51], v110
  ds_read_b128 v[44:47], v129 offset:16384
  v_permlane32_swap_b32 v62, v66
  v_smfmac_f32_16x16x64_bf16 v[68:71], v[16:19], a[120:127], v110
  ds_read_b128 v[48:51], v129 offset:17408
  v_permlane32_swap_b32 v63, v67
  s_waitcnt lgkmcnt(2)
  v_smfmac_f32_16x16x64_bf16 v[72:75], v[16:19], v[52:59], v110
  ds_read_b128 v[52:55], v129 offset:18432
  v_add_f32 v60, v60, v64
  v_smfmac_f32_16x16x64_bf16 v[68:71], v[20:23], a[128:135], v110
  ds_read_b128 v[56:59], v129 offset:19456
  v_add_f32 v61, v61, v65
  v_smfmac_f32_16x16x64_bf16 v[72:75], v[20:23], v[200:207], v110
  v_add_f32 v62, v62, v66
  v_smfmac_f32_16x16x64_bf16 v[68:71], v[24:27], a[136:143], v110
  v_add_f32 v63, v63, v67
  s_waitcnt lgkmcnt(2)
  v_smfmac_f32_16x16x64_bf16 v[72:75], v[24:27], v[44:51], v110
  ds_read_b128 v[44:47], v129 offset:20480
  v_cvt_pk_bf16_f32 v100, v60, v61
  v_smfmac_f32_16x16x64_bf16 v[68:71], v[28:31], a[152:159], v110
  ds_read_b128 v[48:51], v129 offset:21504
  v_cvt_pk_bf16_f32 v101, v62, v63
  s_waitcnt lgkmcnt(2)
  v_smfmac_f32_16x16x64_bf16 v[72:75], v[28:31], v[52:59], v110
  ds_read_b128 v[52:55], v129 offset:22528
  v_smfmac_f32_16x16x64_bf16 v[36:39], v[4:7], a[168:175], v110
  ds_read_b128 v[56:59], v129 offset:23552
  s_waitcnt lgkmcnt(2)
  v_smfmac_f32_16x16x64_bf16 v[40:43], v[4:7], v[44:51], v110
  ds_read_b128 v[44:47], v129 offset:24576
  v_permlane32_swap_b32 v68, v72
  v_smfmac_f32_16x16x64_bf16 v[36:39], v[8:11], a[176:183], v110
  ds_read_b128 v[48:51], v129 offset:25600
  v_smfmac_f32_16x16x64_bf16 v[40:43], v[8:11], v[224:231], v110
  v_permlane32_swap_b32 v69, v73
  v_smfmac_f32_16x16x64_bf16 v[36:39], v[12:15], a[184:191], v110
  s_waitcnt lgkmcnt(2)
  v_smfmac_f32_16x16x64_bf16 v[40:43], v[12:15], v[52:59], v110
  ds_read_b128 v[52:55], v129 offset:26624
  v_permlane32_swap_b32 v70, v74
  v_smfmac_f32_16x16x64_bf16 v[36:39], v[16:19], a[200:207], v110
  ds_read_b128 v[56:59], v129 offset:27648
  v_permlane32_swap_b32 v71, v75
  s_waitcnt lgkmcnt(2)
  v_smfmac_f32_16x16x64_bf16 v[40:43], v[16:19], v[44:51], v110
  ds_read_b128 v[44:47], v129 offset:28672
  v_add_f32 v68, v68, v72
  v_smfmac_f32_16x16x64_bf16 v[36:39], v[20:23], a[208:215], v110
  ds_read_b128 v[48:51], v129 offset:29696
  v_add_f32 v69, v69, v73
  v_smfmac_f32_16x16x64_bf16 v[40:43], v[20:23], v[240:247], v110
  v_add_f32 v70, v70, v74
  v_smfmac_f32_16x16x64_bf16 v[36:39], v[24:27], a[216:223], v110
  v_add_f32 v71, v71, v75
  s_waitcnt lgkmcnt(2)
  v_smfmac_f32_16x16x64_bf16 v[40:43], v[24:27], v[52:59], v110
  v_cvt_pk_bf16_f32 v102, v68, v69
  v_smfmac_f32_16x16x64_bf16 v[36:39], v[28:31], a[232:239], v110
  v_cvt_pk_bf16_f32 v103, v70, v71
  s_waitcnt lgkmcnt(0)
  v_smfmac_f32_16x16x64_bf16 v[40:43], v[28:31], v[44:51], v110
  v_mfma_f32_16x16x16_bf16 v[142:145], v[100:101], v[108:109], 0
  v_mfma_f32_16x16x16_bf16 v[146:149], v[102:103], v[108:109], 0
  s_nop 1
  v_permlane32_swap_b32 v36, v40
  v_permlane32_swap_b32 v37, v41
  v_permlane32_swap_b32 v38, v42
  v_permlane32_swap_b32 v39, v43
  v_add_f32 v36, v36, v40
  v_add_f32 v37, v37, v41
  v_add_f32 v38, v38, v42
  v_add_f32 v39, v39, v43
  v_cvt_pk_bf16_f32 v104, v36, v37
  v_cvt_pk_bf16_f32 v105, v38, v39
  v_cvt_pk_bf16_f32 v44, v142, v143
  v_cvt_pk_bf16_f32 v45, v144, v145
  v_mfma_f32_16x16x16_bf16 v[142:145], v[104:105], v[108:109], 0
  v_cvt_pk_bf16_f32 v46, v146, v147
  v_cvt_pk_bf16_f32 v47, v148, v149
  ds_write_b64 v131, v[44:45]
  ds_write_b64 v131, v[46:47] offset:512
  v_mfma_f32_16x16x32_bf16 v[76:79], v[44:47], v[44:47], 0
  v_mfma_f32_16x16x32_bf16 v[80:83], v[88:91], v[44:47], 0
  v_mfma_f32_16x16x32_bf16 v[84:87], v[92:95], v[44:47], 0
  v_cvt_pk_bf16_f32 v106, v142, v143
  v_cvt_pk_bf16_f32 v107, v144, v145
  ds_write_b64 v131, v[106:107] offset:1024
  s_nop 0
  v_mfma_f32_16x16x16_bf16 v[76:79], v[106:107], v[106:107], v[76:79]
  v_mfma_f32_16x16x16_bf16 v[80:83], v[96:97], v[106:107], v[80:83]
  v_mfma_f32_16x16x16_bf16 v[84:87], v[98:99], v[106:107], v[84:87]
  s_nop 6
  ds_write_b128 v130, v[76:79] offset:0
  ds_write_b128 v130, v[80:83] offset:1024
  s_nop 0
  ds_write_b128 v130, v[84:87] offset:2048
  s_waitcnt lgkmcnt(0)
  s_barrier
  s_cmp_ge_u32 s51, 63
  s_cbranch_scc1 kas_x_done
  ds_read_b128 v[4:7], v133 offset:0
  ds_read_b32 v20, v134 offset:0
  ds_read_b128 v[8:11], v133 offset:3072
  ds_read_b32 v21, v134 offset:3072
  ds_read_b128 v[12:15], v133 offset:6144
  ds_read_b32 v22, v134 offset:6144
  ds_read_b128 v[16:19], v133 offset:9216
  ds_read_b32 v23, v134 offset:9216
  s_waitcnt lgkmcnt(4)
  v_pk_add_f32 v[4:5], v[4:5], v[8:9]
  v_pk_add_f32 v[6:7], v[6:7], v[10:11]
  v_add_f32 v20, v20, v21
  s_waitcnt lgkmcnt(0)
  v_pk_add_f32 v[12:13], v[12:13], v[16:17]
  v_pk_add_f32 v[14:15], v[14:15], v[18:19]
  v_add_f32 v22, v22, v23
  v_pk_add_f32 v[4:5], v[4:5], v[12:13]
  v_pk_add_f32 v[6:7], v[6:7], v[14:15]
  v_add_f32 v8, v20, v22
  v_max3_f32 v24, v4, v5, v6
  v_max3_f32 v24, v24, v7, v8
  s_nop 1
  v_max_f32_dpp v25, v24, v24 quad_perm:[1,0,3,2] row_mask:0xf bank_mask:0xf
  s_nop 1
  v_max_f32_dpp v24, v25, v25 quad_perm:[2,3,0,1] row_mask:0xf bank_mask:0xf
  s_nop 1
  v_max_f32_dpp v25, v24, v24 row_half_mirror row_mask:0xf bank_mask:0xf
  v_mul_f32 v24, s64, v25
  v_fma_f32 v4, v4, s64, -v24
  v_fma_f32 v5, v5, s64, -v24
  v_fma_f32 v6, v6, s64, -v24
  v_fma_f32 v7, v7, s64, -v24
  v_fma_f32 v8, v8, s64, -v24
  v_exp_f32 v4, v4
  v_exp_f32 v5, v5
  v_exp_f32 v6, v6
  v_exp_f32 v7, v7
  v_exp_f32 v8, v8
  v_add_f32 v24, v4, v5
  v_add_f32 v25, v6, v7
  v_add_f32 v24, v24, v25
  v_add_f32 v24, v24, v8
  s_nop 1
  v_add_f32_dpp v25, v24, v24 quad_perm:[1,0,3,2] row_mask:0xf bank_mask:0xf
  s_nop 1
  v_add_f32_dpp v24, v25, v25 quad_perm:[2,3,0,1] row_mask:0xf bank_mask:0xf
  s_nop 1
  v_add_f32_dpp v25, v24, v24 row_half_mirror row_mask:0xf bank_mask:0xf
  s_nop 0
  v_rcp_f32 v24, v25
  s_nop 0
  v_mul_f32 v8, v8, v24
  v_mul_f32 v4, v4, v24
  v_mul_f32 v5, v5, v24
  v_mov_b32_dpp v9, v8 quad_perm:[1,0,3,2] row_mask:0xf bank_mask:0xf
  v_mul_f32 v6, v6, v24
  v_mul_f32 v7, v7, v24
  v_cvt_pk_bf16_f32 v10, v4, v5
  v_cvt_pk_bf16_f32 v11, v6, v7
  v_cvt_pk_bf16_f32 v12, v8, v9
  buffer_store_dwordx2 v[10:11], v135, s[8:11], s49 offen sc1
  buffer_store_dword v12, v136, s[8:11], s49 offen sc1
  v_mov_b32 v60, 0
  v_mov_b32 v61, 0
  v_mov_b32 v62, 0
  v_mov_b32 v63, 0
  v_mov_b32 v64, 0
  v_mov_b32 v65, 0
  v_mov_b32 v66, 0
  v_mov_b32 v67, 0
  v_mov_b32 v68, 0
  v_mov_b32 v69, 0
  v_mov_b32 v70, 0
  v_mov_b32 v71, 0
  v_mov_b32 v72, 0
  v_mov_b32 v73, 0
  v_mov_b32 v74, 0
  v_mov_b32 v75, 0
  v_mov_b32 v36, 0
  v_mov_b32 v37, 0
  v_mov_b32 v38, 0
  v_mov_b32 v39, 0
  v_mov_b32 v40, 0
  v_mov_b32 v41, 0
  v_mov_b32 v42, 0
  v_mov_b32 v43, 0
  s_add_u32 s97, s97, 10240
  s_mov_b32 s48, s97
  s_add_u32 s49, s49, 5120
  s_add_u32 s50, s50, 12288
  s_add_u32 s63, s63, 12288
  s_add_u32 s51, s51, 1
  s_cmp_gt_u32 s52, s51
  s_cbranch_scc1 kas_x_wp_88_ok
  s_mov_b32 s45, 0
kas_x_wp_88_spin:
  buffer_load_dword v2, v138, s[8:11], 0 offen sc1
  s_add_u32 s45, s45, 1
  s_waitcnt vmcnt(0)
  v_min_u32_dpp v3, v2, v2 quad_perm:[1,0,3,2] row_mask:0xf bank_mask:0xf
  s_nop 1
  v_min_u32_dpp v2, v3, v3 quad_perm:[2,3,0,1] row_mask:0xf bank_mask:0xf
  s_nop 1
  v_min_u32_dpp v3, v2, v2 row_half_mirror row_mask:0xf bank_mask:0xf
  s_nop 1
  v_min_u32_dpp v2, v3, v3 quad_perm:[0,1,2,3] row_mask:0xf bank_mask:0xf
  s_nop 0
  v_readfirstlane_b32 s52, v2
  s_cmp_gt_u32 s52, s51
  s_cbranch_scc1 kas_x_wp_88_ok
  s_cmp_lt_u32 s45, 400000
  s_cbranch_scc1 kas_x_wp_88_spin
  s_branch kas_abort
kas_x_wp_88_ok:
  s_add_u32 s28, s50, s53
  buffer_load_dwordx2 v[88:89], v132, s[8:11], s28 offen offset:0 sc1
  buffer_load_dwordx2 v[92:93], v132, s[8:11], s28 offen offset:1024 sc1
  s_add_u32 s28, s50, s54
  buffer_load_dwordx2 v[90:91], v132, s[8:11], s28 offen offset:0 sc1
  buffer_load_dwordx2 v[94:95], v132, s[8:11], s28 offen offset:1024 sc1
  s_add_u32 s28, s50, s55
  buffer_load_dwordx2 v[96:97], v132, s[8:11], s28 offen offset:0 sc1
  buffer_load_dwordx2 v[98:99], v132, s[8:11], s28 offen offset:1024 sc1
  s_branch kas_x_w0l
kas_x_w1:
kas_x_w1l:
  ds_read_b128 v[44:47], v129 offset:0
  ds_read_b128 v[48:51], v129 offset:1024
  ds_read_b128 v[52:55], v129 offset:10240
  ds_read_b128 v[56:59], v129 offset:11264
  s_waitcnt lgkmcnt(0)
  s_mov_b32 s45, 0
kas_x_pf_89:
  buffer_load_dwordx4 v[112:115], v124, s[8:11], s48 offen sc1
  buffer_load_dwordx4 v[116:119], v125, s[8:11], s48 offen sc1
  buffer_load_dwordx4 v[120:123], v126, s[8:11], s48 offen sc1
  s_add_u32 s45, s45, 1
  s_waitcnt vmcnt(2)
  ds_write_b128 v127, v[112:115] offset:0
  v_max3_u32 v139, v112, v113, v114
  v_max_u32 v139, v139, v115
  s_waitcnt vmcnt(1)
  ds_write_b128 v127, v[116:119] offset:4096
  v_max3_u32 v139, v139, v116, v117
  v_max3_u32 v139, v139, v118, v119
  s_waitcnt vmcnt(0)
  ds_write_b128 v127, v[120:123] offset:8192
  v_max3_u32 v139, v139, v120, v121
  v_max3_u32 v139, v139, v122, v123
  v_cmp_eq_u32 vcc, -1, v139
  s_cbranch_vccz kas_x_pf_89_ok
  s_cmp_lt_u32 s45, 400000
  s_cbranch_scc1 kas_x_pf_89
  s_branch kas_abort
kas_x_pf_89_ok:
  v_smfmac_f32_16x16x64_bf16 v[60:63], v[112:115], a[8:15], v110
  v_smfmac_f32_16x16x64_bf16 v[64:67], v[112:115], v[44:51], v110
  ds_read_b128 v[44:47], v129 offset:20480
  v_smfmac_f32_16x16x64_bf16 v[68:71], v[112:115], a[88:95], v110
  ds_read_b128 v[48:51], v129 offset:21504
  v_smfmac_f32_16x16x64_bf16 v[72:75], v[112:115], v[52:59], v110
  ds_read_b128 v[52:55], v129 offset:4096
  s_waitcnt lgkmcnt(3)
  s_barrier
  v_smfmac_f32_16x16x64_bf16 v[36:39], v[112:115], a[168:175], v110
  ds_read_b128 v[56:59], v129 offset:5120
  ds_read_b128 v[4:7], v128 offset:0
  s_waitcnt lgkmcnt(3)
  v_smfmac_f32_16x16x64_bf16 v[40:43], v[112:115], v[44:51], v110
  ds_read_b128 v[44:47], v129 offset:14336
  ds_read_b128 v[8:11], v128 offset:2048
  v_smfmac_f32_16x16x64_bf16 v[60:63], v[116:119], a[40:47], v110
  ds_read_b128 v[48:51], v129 offset:15360
  ds_read_b128 v[12:15], v128 offset:3072
  s_waitcnt lgkmcnt(5)
  v_smfmac_f32_16x16x64_bf16 v[64:67], v[116:119], v[52:59], v110
  ds_read_b128 v[52:55], v129 offset:24576
  ds_read_b128 v[16:19], v128 offset:4096
  v_smfmac_f32_16x16x64_bf16 v[68:71], v[116:119], a[120:127], v110
  ds_read_b128 v[56:59], v129 offset:25600
  ds_read_b128 v[20:23], v128 offset:6144
  s_waitcnt lgkmcnt(5)
  v_smfmac_f32_16x16x64_bf16 v[72:75], v[116:119], v[44:51], v110
  ds_read_b128 v[44:47], v129 offset:8192
  ds_read_b128 v[24:27], v128 offset:7168
  v_smfmac_f32_16x16x64_bf16 v[36:39], v[116:119], a[200:207], v110
  ds_read_b128 v[48:51], v129 offset:9216
  ds_read_b128 v[28:31], v128 offset:8192
  s_waitcnt lgkmcnt(5)
  v_smfmac_f32_16x16x64_bf16 v[40:43], v[116:119], v[52:59], v110
  ds_read_b128 v[52:55], v129 offset:18432
  v_smfmac_f32_16x16x64_bf16 v[60:63], v[120:123], a[72:79], v110
  ds_read_b128 v[56:59], v129 offset:19456
  s_waitcnt lgkmcnt(3)
  v_smfmac_f32_16x16x64_bf16 v[64:67], v[120:123], v[44:51], v110
  ds_read_b128 v[44:47], v129 offset:28672
  v_smfmac_f32_16x16x64_bf16 v[68:71], v[120:123], a[152:159], v110
  ds_read_b128 v[48:51], v129 offset:29696
  s_waitcnt lgkmcnt(2)
  v_smfmac_f32_16x16x64_bf16 v[72:75], v[120:123], v[52:59], v110
  ds_read_b128 v[52:55], v129 offset:2048
  v_smfmac_f32_16x16x64_bf16 v[36:39], v[120:123], a[232:239], v110
  ds_read_b128 v[56:59], v129 offset:3072
  s_waitcnt lgkmcnt(2)
  v_smfmac_f32_16x16x64_bf16 v[40:43], v[120:123], v[44:51], v110
  ds_read_b128 v[44:47], v129 offset:6144
  v_smfmac_f32_16x16x64_bf16 v[60:63], v[4:7], a[0:7], v110
  ds_read_b128 v[48:51], v129 offset:7168
  v_smfmac_f32_16x16x64_bf16 v[64:67], v[4:7], a[240:247], v110
  v_smfmac_f32_16x16x64_bf16 v[60:63], v[8:11], a[16:23], v110
  v_smfmac_f32_16x16x64_bf16 v[64:67], v[8:11], a[248:255], v110
  v_smfmac_f32_16x16x64_bf16 v[60:63], v[12:15], a[24:31], v110
  s_waitcnt lgkmcnt(2)
  v_smfmac_f32_16x16x64_bf16 v[64:67], v[12:15], v[52:59], v110
  ds_read_b128 v[52:55], v129 offset:12288
  v_smfmac_f32_16x16x64_bf16 v[60:63], v[16:19], a[32:39], v110
  ds_read_b128 v[56:59], v129 offset:13312
  v_smfmac_f32_16x16x64_bf16 v[64:67], v[16:19], v[152:159], v110
  v_smfmac_f32_16x16x64_bf16 v[60:63], v[20:23], a[48:55], v110
  v_smfmac_f32_16x16x64_bf16 v[64:67], v[20:23], v[160:167], v110
  v_smfmac_f32_16x16x64_bf16 v[60:63], v[24:27], a[56:63], v110
  s_waitcnt lgkmcnt(2)
  v_smfmac_f32_16x16x64_bf16 v[64:67], v[24:27], v[44:51], v110
  ds_read_b128 v[44:47], v129 offset:16384
  v_smfmac_f32_16x16x64_bf16 v[60:63], v[28:31], a[64:71], v110
  ds_read_b128 v[48:51], v129 offset:17408
  v_smfmac_f32_16x16x64_bf16 v[64:67], v[28:31], v[168:175], v110
  v_smfmac_f32_16x16x64_bf16 v[68:71], v[4:7], a[80:87], v110
  v_smfmac_f32_16x16x64_bf16 v[72:75], v[4:7], v[176:183], v110
  v_permlane32_swap_b32 v60, v64
  v_smfmac_f32_16x16x64_bf16 v[68:71], v[8:11], a[96:103], v110
  v_smfmac_f32_16x16x64_bf16 v[72:75], v[8:11], v[184:191], v110
  v_permlane32_swap_b32 v61, v65
  v_smfmac_f32_16x16x64_bf16 v[68:71], v[12:15], a[104:111], v110
  s_waitcnt lgkmcnt(2)
  v_smfmac_f32_16x16x64_bf16 v[72:75], v[12:15], v[52:59], v110
  ds_read_b128 v[52:55], v129 offset:22528
  v_permlane32_swap_b32 v62, v66
  v_smfmac_f32_16x16x64_bf16 v[68:71], v[16:19], a[112:119], v110
  ds_read_b128 v[56:59], v129 offset:23552
  v_permlane32_swap_b32 v63, v67
  v_smfmac_f32_16x16x64_bf16 v[72:75], v[16:19], v[192:199], v110
  v_add_f32 v60, v60, v64
  v_smfmac_f32_16x16x64_bf16 v[68:71], v[20:23], a[128:135], v110
  v_add_f32 v61, v61, v65
  v_smfmac_f32_16x16x64_bf16 v[72:75], v[20:23], v[200:207], v110
  v_add_f32 v62, v62, v66
  v_smfmac_f32_16x16x64_bf16 v[68:71], v[24:27], a[136:143], v110
  v_add_f32 v63, v63, v67
  s_waitcnt lgkmcnt(2)
  v_smfmac_f32_16x16x64_bf16 v[72:75], v[24:27], v[44:51], v110
  ds_read_b128 v[44:47], v129 offset:26624
  v_cvt_pk_bf16_f32 v100, v60, v61
  v_smfmac_f32_16x16x64_bf16 v[68:71], v[28:31], a[144:151], v110
  ds_read_b128 v[48:51], v129 offset:27648
  v_cvt_pk_bf16_f32 v101, v62, v63
  v_smfmac_f32_16x16x64_bf16 v[72:75], v[28:31], v[208:215], v110
  v_smfmac_f32_16x16x64_bf16 v[36:39], v[4:7], a[160:167], v110
  v_smfmac_f32_16x16x64_bf16 v[40:43], v[4:7], v[216:223], v110
  v_permlane32_swap_b32 v68, v72
  v_smfmac_f32_16x16x64_bf16 v[36:39], v[8:11], a[176:183], v110
  v_smfmac_f32_16x16x64_bf16 v[40:43], v[8:11], v[224:231], v110
  v_permlane32_swap_b32 v69, v73
  v_smfmac_f32_16x16x64_bf16 v[36:39], v[12:15], a[184:191], v110
  s_waitcnt lgkmcnt(2)
  v_smfmac_f32_16x16x64_bf16 v[40:43], v[12:15], v[52:59], v110
  v_permlane32_swap_b32 v70, v74
  v_smfmac_f32_16x16x64_bf16 v[36:39], v[16:19], a[192:199], v110
  v_permlane32_swap_b32 v71, v75
  v_smfmac_f32_16x16x64_bf16 v[40:43], v[16:19], v[232:239], v110
  v_add_f32 v68, v68, v72
  v_smfmac_f32_16x16x64_bf16 v[36:39], v[20:23], a[208:215], v110
  v_add_f32 v69, v69, v73
  v_smfmac_f32_16x16x64_bf16 v[40:43], v[20:23], v[240:247], v110
  v_add_f32 v70, v70, v74
  v_smfmac_f32_16x16x64_bf16 v[36:39], v[24:27], a[216:223], v110
  v_add_f32 v71, v71, v75
  s_waitcnt lgkmcnt(0)
  v_smfmac_f32_16x16x64_bf16 v[40:43], v[24:27], v[44:51], v110
  v_cvt_pk_bf16_f32 v102, v68, v69
  v_smfmac_f32_16x16x64_bf16 v[36:39], v[28:31], a[224:231], v110
  v_cvt_pk_bf16_f32 v103, v70, v71
  v_smfmac_f32_16x16x64_bf16 v[40:43], v[28:31], v[248:255], v110
  v_mfma_f32_16x16x16_bf16 v[142:145], v[100:101], v[108:109], 0
  v_mfma_f32_16x16x16_bf16 v[146:149], v[102:103], v[108:109], 0
  s_nop 1
  v_permlane32_swap_b32 v36, v40
  v_permlane32_swap_b32 v37, v41
  v_permlane32_swap_b32 v38, v42
  v_permlane32_swap_b32 v39, v43
  v_add_f32 v36, v36, v40
  v_add_f32 v37, v37, v41
  v_add_f32 v38, v38, v42
  v_add_f32 v39, v39, v43
  v_cvt_pk_bf16_f32 v104, v36, v37
  v_cvt_pk_bf16_f32 v105, v38, v39
  v_cvt_pk_bf16_f32 v44, v142, v143
  v_cvt_pk_bf16_f32 v45, v144, v145
  v_mfma_f32_16x16x16_bf16 v[142:145], v[104:105], v[108:109], 0
  v_cvt_pk_bf16_f32 v46, v146, v147
  v_cvt_pk_bf16_f32 v47, v148, v149
  ds_write_b64 v131, v[44:45]
  ds_write_b64 v131, v[46:47] offset:512
  v_mfma_f32_16x16x32_bf16 v[76:79], v[44:47], v[44:47], 0
  v_mfma_f32_16x16x32_bf16 v[80:83], v[88:91], v[44:47], 0
  v_mfma_f32_16x16x32_bf16 v[84:87], v[92:95], v[44:47], 0
  v_cvt_pk_bf16_f32 v106, v142, v143
  v_cvt_pk_bf16_f32 v107, v144, v145
  ds_write_b64 v131, v[106:107] offset:1024
  s_nop 0
  v_mfma_f32_16x16x16_bf16 v[76:79], v[106:107], v[106:107], v[76:79]
  v_mfma_f32_16x16x16_bf16 v[80:83], v[96:97], v[106:107], v[80:83]
  v_mfma_f32_16x16x16_bf16 v[84:87], v[98:99], v[106:107], v[84:87]
  s_nop 6
  ds_write_b128 v130, v[76:79] offset:0
  ds_write_b128 v130, v[80:83] offset:1024
  s_nop 0
  ds_write_b128 v130, v[84:87] offset:2048
  s_waitcnt lgkmcnt(0)
  s_barrier
  s_cmp_ge_u32 s51, 63
  s_cbranch_scc1 kas_x_done
  v_mov_b32 v60, 0
  v_mov_b32 v61, 0
  v_mov_b32 v62, 0
  v_mov_b32 v63, 0
  v_mov_b32 v64, 0
  v_mov_b32 v65, 0
  v_mov_b32 v66, 0
  v_mov_b32 v67, 0
  v_mov_b32 v68, 0
  v_mov_b32 v69, 0
  v_mov_b32 v70, 0
  v_mov_b32 v71, 0
  v_mov_b32 v72, 0
  v_mov_b32 v73, 0
  v_mov_b32 v74, 0
  v_mov_b32 v75, 0
  v_mov_b32 v36, 0
  v_mov_b32 v37, 0
  v_mov_b32 v38, 0
  v_mov_b32 v39, 0
  v_mov_b32 v40, 0
  v_mov_b32 v41, 0
  v_mov_b32 v42, 0
  v_mov_b32 v43, 0
  s_add_u32 s97, s97, 10240
  s_mov_b32 s48, s97
  s_add_u32 s49, s49, 5120
  s_add_u32 s50, s50, 12288
  s_add_u32 s63, s63, 12288
  s_add_u32 s51, s51, 1
  s_cmp_gt_u32 s52, s51
  s_cbranch_scc1 kas_x_wp_90_ok
  s_mov_b32 s45, 0
kas_x_wp_90_spin:
  buffer_load_dword v2, v138, s[8:11], 0 offen sc1
  s_add_u32 s45, s45, 1
  s_waitcnt vmcnt(0)
  v_min_u32_dpp v3, v2, v2 quad_perm:[1,0,3,2] row_mask:0xf bank_mask:0xf
  s_nop 1
  v_min_u32_dpp v2, v3, v3 quad_perm:[2,3,0,1] row_mask:0xf bank_mask:0xf
  s_nop 1
  v_min_u32_dpp v3, v2, v2 row_half_mirror row_mask:0xf bank_mask:0xf
  s_nop 1
  v_min_u32_dpp v2, v3, v3 quad_perm:[0,1,2,3] row_mask:0xf bank_mask:0xf
  s_nop 0
  v_readfirstlane_b32 s52, v2
  s_cmp_gt_u32 s52, s51
  s_cbranch_scc1 kas_x_wp_90_ok
  s_cmp_lt_u32 s45, 400000
  s_cbranch_scc1 kas_x_wp_90_spin
  s_branch kas_abort
kas_x_wp_90_ok:
  s_add_u32 s28, s50, s53
  buffer_load_dwordx2 v[88:89], v132, s[8:11], s28 offen offset:0 sc1
  buffer_load_dwordx2 v[92:93], v132, s[8:11], s28 offen offset:1024 sc1
  s_add_u32 s28, s50, s54
  buffer_load_dwordx2 v[90:91], v132, s[8:11], s28 offen offset:0 sc1
  buffer_load_dwordx2 v[94:95], v132, s[8:11], s28 offen offset:1024 sc1
  s_add_u32 s28, s50, s55
  buffer_load_dwordx2 v[96:97], v132, s[8:11], s28 offen offset:0 sc1
  buffer_load_dwordx2 v[98:99], v132, s[8:11], s28 offen offset:1024 sc1
  s_branch kas_x_w1l
kas_x_w23:
  s_sub_u32 s65, s21, 2
  s_and_b32 s26, s23, 7
  v_and_b32 v4, 15, v1
  v_lshrrev_b32 v5, 4, v1
  v_and_b32 v6, 1, v5
  v_lshlrev_b32 v6, 5, v6
  v_add_u32 v6, v6, v4
  v_lshlrev_b32 v6, 4, v6
  v_lshrrev_b32 v7, 1, v5
  v_lshlrev_b32 v7, 3, v7
  v_add_u32 v6, v6, v7
  s_lshl_b32 s28, s26, 1
  s_add_u32 s28, s28, s65
  s_lshl_b32 s28, s28, 10
  v_add_u32 v133, s28, v6
  s_lshr_b32 s28, s26, 2
  s_lshl_b32 s28, s28, 1
  s_add_u32 s28, s28, s65
  s_lshl_b32 s28, s28, 10
  s_and_b32 s29, s26, 1
  s_lshl_b32 s29, s29, 9
  s_add_u32 s28, s28, s29
  s_bfe_u32 s29, s26, 0x10001
  s_lshl_b32 s29, s29, 3
  s_add_u32 s28, s28, s29
  s_add_u32 s28, s28, 15872
  v_lshlrev_b32 v6, 4, v5
  v_add_u32 v6, v6, v4
  v_lshlrev_b32 v6, 4, v6
  v_add_u32 v6, s28, v6
  v_mov_b32 v7, 0x40000000
  v_cmp_le_u32 vcc, 2, v5
  s_nop 1
  v_cndmask_b32 v134, v7, v6, vcc
  v_mov_b32 v135, 0xf149f2ca
  v_lshlrev_b32 v6, 3, v1
  v_add_u32 v136, 145408, v6
  s_mul_i32 s94, s65, 6144
  s_add_u32 s94, s94, 151552
  v_add_u32 v137, s94, v132
  v_cmp_le_u32 s[66:67], 2, v5
  v_lshlrev_b32 v6, 2, v5
  v_sub_u32 v6, v4, v6
  v_cmp_le_i32 s[68:69], 0, v6
  v_cmp_le_i32 s[70:71], 1, v6
  v_cmp_le_i32 s[72:73], 2, v6
  v_cmp_le_i32 s[74:75], 3, v6
  s_nop 1
  s_cmp_eq_u32 s65, 0
  s_cselect_b64 s[76:77], s[68:69], -1
  s_cselect_b64 s[84:85], 0, s[68:69]
  s_cselect_b64 s[78:79], s[70:71], -1
  s_cselect_b64 s[86:87], 0, s[70:71]
  s_cselect_b64 s[80:81], s[72:73], -1
  s_cselect_b64 s[88:89], 0, s[72:73]
  s_cselect_b64 s[82:83], s[74:75], -1
  s_cselect_b64 s[90:91], 0, s[74:75]
  s_mul_i32 s92, s20, 1310720
  s_add_u32 s92, s92, 0xe00000
  s_lshl_b32 s93, s65, 10
  s_mov_b32 s64, 0x3dd53b95
  s_add_u32 s95, s63, s93
  s_add_u32 m0, s94, 0
  s_add_u32 s28, s95, 0
  buffer_load_dwordx4 v132, s[8:11], s28 offen sc1 lds
  s_add_u32 m0, s94, 1024
  s_add_u32 s28, s95, 2048
  buffer_load_dwordx4 v132, s[8:11], s28 offen sc1 lds
  s_add_u32 m0, s94, 2048
  s_add_u32 s28, s95, 4096
  buffer_load_dwordx4 v132, s[8:11], s28 offen sc1 lds
  s_add_u32 m0, s94, 3072
  s_add_u32 s28, s95, 6144
  buffer_load_dwordx4 v132, s[8:11], s28 offen sc1 lds
  s_add_u32 m0, s94, 4096
  s_add_u32 s28, s95, 8192
  buffer_load_dwordx4 v132, s[8:11], s28 offen sc1 lds
  s_add_u32 m0, s94, 5120
  s_add_u32 s28, s95, 10240
  buffer_load_dwordx4 v132, s[8:11], s28 offen sc1 lds
  s_cmp_eq_u32 s21, 3
  s_cbranch_scc1 kas_x_w3l
kas_x_w2l:
  ds_read_b128 v[44:47], v129 offset:0
  ds_read_b128 v[48:51], v129 offset:1024
  ds_read_b128 v[52:55], v129 offset:2048
  ds_read_b128 v[56:59], v129 offset:3072
  s_waitcnt lgkmcnt(0)
  s_mov_b32 s45, 0
kas_x_pf_91:
  buffer_load_dwordx4 v[112:115], v124, s[8:11], s48 offen sc1
  buffer_load_dwordx4 v[116:119], v125, s[8:11], s48 offen sc1
  s_add_u32 s45, s45, 1
  s_waitcnt vmcnt(1)
  ds_write_b128 v127, v[112:115] offset:0
  v_max3_u32 v139, v112, v113, v114
  v_max_u32 v139, v139, v115
  s_waitcnt vmcnt(0)
  ds_write_b128 v127, v[116:119] offset:4096
  v_max3_u32 v139, v139, v116, v117
  v_max3_u32 v139, v139, v118, v119
  v_cmp_eq_u32 vcc, -1, v139
  s_cbranch_vccz kas_x_pf_91_ok
  s_cmp_lt_u32 s45, 400000
  s_cbranch_scc1 kas_x_pf_91
  s_branch kas_abort
kas_x_pf_91_ok:
  v_smfmac_f32_16x16x64_bf16 v[60:63], v[112:115], a[16:23], v110
  v_smfmac_f32_16x16x64_bf16 v[64:67], v[112:115], a[248:255], v110
  v_smfmac_f32_16x16x64_bf16 v[68:71], v[112:115], a[96:103], v110
  v_smfmac_f32_16x16x64_bf16 v[72:75], v[112:115], v[184:191], v110
  s_waitcnt lgkmcnt(0)
  s_barrier
  v_smfmac_f32_16x16x64_bf16 v[36:39], v[112:115], a[176:183], v110
  ds_read_b128 v[4:7], v128 offset:0
  v_smfmac_f32_16x16x64_bf16 v[40:43], v[112:115], v[224:231], v110
  ds_read_b128 v[8:11], v128 offset:1024
  v_smfmac_f32_16x16x64_bf16 v[60:63], v[116:119], a[48:55], v110
  ds_read_b128 v[12:15], v128 offset:3072
  v_smfmac_f32_16x16x64_bf16 v[64:67], v[116:119], v[160:167], v110
  ds_read_b128 v[16:19], v128 offset:4096
  v_smfmac_f32_16x16x64_bf16 v[68:71], v[116:119], a[128:135], v110
  ds_read_b128 v[20:23], v128 offset:5120
  v_smfmac_f32_16x16x64_bf16 v[72:75], v[116:119], v[200:207], v110
  ds_read_b128 v[24:27], v128 offset:7168
  v_smfmac_f32_16x16x64_bf16 v[36:39], v[116:119], a[208:215], v110
  ds_read_b128 v[28:31], v128 offset:8192
  v_smfmac_f32_16x16x64_bf16 v[40:43], v[116:119], v[240:247], v110
  ds_read_b128 v[32:35], v128 offset:9216
  s_waitcnt lgkmcnt(7)
  v_smfmac_f32_16x16x64_bf16 v[60:63], v[4:7], a[0:7], v110
  v_smfmac_f32_16x16x64_bf16 v[64:67], v[4:7], a[240:247], v110
  s_waitcnt lgkmcnt(6)
  v_smfmac_f32_16x16x64_bf16 v[60:63], v[8:11], a[8:15], v110
  v_smfmac_f32_16x16x64_bf16 v[64:67], v[8:11], v[44:51], v110
  ds_read_b128 v[44:47], v129 offset:4096
  s_waitcnt lgkmcnt(6)
  v_smfmac_f32_16x16x64_bf16 v[60:63], v[12:15], a[24:31], v110
  ds_read_b128 v[48:51], v129 offset:5120
  v_smfmac_f32_16x16x64_bf16 v[64:67], v[12:15], v[52:59], v110
  ds_read_b128 v[52:55], v129 offset:6144
  s_waitcnt lgkmcnt(7)
  v_smfmac_f32_16x16x64_bf16 v[60:63], v[16:19], a[32:39], v110
  ds_read_b128 v[56:59], v129 offset:7168
  v_smfmac_f32_16x16x64_bf16 v[64:67], v[16:19], v[152:159], v110
  s_waitcnt lgkmcnt(7)
  v_smfmac_f32_16x16x64_bf16 v[60:63], v[20:23], a[40:47], v110
  s_waitcnt lgkmcnt(2)
  v_smfmac_f32_16x16x64_bf16 v[64:67], v[20:23], v[44:51], v110
  ds_read_b128 v[44:47], v129 offset:8192
  v_smfmac_f32_16x16x64_bf16 v[60:63], v[24:27], a[56:63], v110
  ds_read_b128 v[48:51], v129 offset:9216
  s_waitcnt lgkmcnt(2)
  v_smfmac_f32_16x16x64_bf16 v[64:67], v[24:27], v[52:59], v110
  ds_read_b128 v[52:55], v129 offset:10240
  v_smfmac_f32_16x16x64_bf16 v[60:63], v[28:31], a[64:71], v110
  ds_read_b128 v[56:59], v129 offset:11264
  v_smfmac_f32_16x16x64_bf16 v[64:67], v[28:31], v[168:175], v110
  v_smfmac_f32_16x16x64_bf16 v[60:63], v[32:35], a[72:79], v110
  s_waitcnt lgkmcnt(2)
  v_smfmac_f32_16x16x64_bf16 v[64:67], v[32:35], v[44:51], v110
  ds_read_b128 v[44:47], v129 offset:12288
  v_smfmac_f32_16x16x64_bf16 v[68:71], v[4:7], a[80:87], v110
  ds_read_b128 v[48:51], v129 offset:13312
  v_smfmac_f32_16x16x64_bf16 v[72:75], v[4:7], v[176:183], v110
  v_permlane32_swap_b32 v60, v64
  v_smfmac_f32_16x16x64_bf16 v[68:71], v[8:11], a[88:95], v110
  s_waitcnt lgkmcnt(2)
  v_smfmac_f32_16x16x64_bf16 v[72:75], v[8:11], v[52:59], v110
  ds_read_b128 v[52:55], v129 offset:14336
  v_permlane32_swap_b32 v61, v65
  v_smfmac_f32_16x16x64_bf16 v[68:71], v[12:15], a[104:111], v110
  ds_read_b128 v[56:59], v129 offset:15360
  s_waitcnt lgkmcnt(2)
  v_smfmac_f32_16x16x64_bf16 v[72:75], v[12:15], v[44:51], v110
  ds_read_b128 v[44:47], v129 offset:16384
  v_permlane32_swap_b32 v62, v66
  v_smfmac_f32_16x16x64_bf16 v[68:71], v[16:19], a[112:119], v110
  ds_read_b128 v[48:51], v129 offset:17408
  v_permlane32_swap_b32 v63, v67
  v_smfmac_f32_16x16x64_bf16 v[72:75], v[16:19], v[192:199], v110
  v_add_f32 v60, v60, v64
  v_smfmac_f32_16x16x64_bf16 v[68:71], v[20:23], a[120:127], v110
  v_add_f32 v61, v61, v65
  s_waitcnt lgkmcnt(2)
  v_smfmac_f32_16x16x64_bf16 v[72:75], v[20:23], v[52:59], v110
  ds_read_b128 v[52:55], v129 offset:18432
  v_add_f32 v62, v62, v66
  v_smfmac_f32_16x16x64_bf16 v[68:71], v[24:27], a[136:143], v110
  ds_read_b128 v[56:59], v129 offset:19456
  v_add_f32 v63, v63, v67
  s_waitcnt lgkmcnt(2)
  v_smfmac_f32_16x16x64_bf16 v[72:75], v[24:27], v[44:51], v110
  ds_read_b128 v[44:47], v129 offset:20480
  v_cvt_pk_bf16_f32 v100, v60, v61
  v_smfmac_f32_16x16x64_bf16 v[68:71], v[28:31], a[144:151], v110
  ds_read_b128 v[48:51], v129 offset:21504
  v_cvt_pk_bf16_f32 v101, v62, v63
  v_smfmac_f32_16x16x64_bf16 v[72:75], v[28:31], v[208:215], v110
  v_smfmac_f32_16x16x64_bf16 v[68:71], v[32:35], a[152:159], v110
  s_waitcnt lgkmcnt(2)
  v_smfmac_f32_16x16x64_bf16 v[72:75], v[32:35], v[52:59], v110
  ds_read_b128 v[52:55], v129 offset:22528
  v_smfmac_f32_16x16x64_bf16 v[36:39], v[4:7], a[160:167], v110
  ds_read_b128 v[56:59], v129 offset:23552
  v_smfmac_f32_16x16x64_bf16 v[40:43], v[4:7], v[216:223], v110
  v_permlane32_swap_b32 v68, v72
  v_smfmac_f32_16x16x64_bf16 v[36:39], v[8:11], a[168:175], v110
  s_waitcnt lgkmcnt(2)
  v_smfmac_f32_16x16x64_bf16 v[40:43], v[8:11], v[44:51], v110
  ds_read_b128 v[44:47], v129 offset:24576
  v_permlane32_swap_b32 v69, v73
  v_smfmac_f32_16x16x64_bf16 v[36:39], v[12:15], a[184:191], v110
  ds_read_b128 v[48:51], v129 offset:25600
  s_waitcnt lgkmcnt(2)
  v_smfmac_f32_16x16x64_bf16 v[40:43], v[12:15], v[52:59], v110
  ds_read_b128 v[52:55], v129 offset:26624
  v_permlane32_swap_b32 v70, v74
  v_smfmac_f32_16x16x64_bf16 v[36:39], v[16:19], a[192:199], v110
  ds_read_b128 v[56:59], v129 offset:27648
  v_permlane32_swap_b32 v71, v75
  v_smfmac_f32_16x16x64_bf16 v[40:43], v[16:19], v[232:239], v110
  v_add_f32 v68, v68, v72
  v_smfmac_f32_16x16x64_bf16 v[36:39], v[20:23], a[200:207], v110
  v_add_f32 v69, v69, v73
  s_waitcnt lgkmcnt(2)
  v_smfmac_f32_16x16x64_bf16 v[40:43], v[20:23], v[44:51], v110
  ds_read_b128 v[44:47], v129 offset:28672
  v_add_f32 v70, v70, v74
  v_smfmac_f32_16x16x64_bf16 v[36:39], v[24:27], a[216:223], v110
  ds_read_b128 v[48:51], v129 offset:29696
  v_add_f32 v71, v71, v75
  s_waitcnt lgkmcnt(2)
  v_smfmac_f32_16x16x64_bf16 v[40:43], v[24:27], v[52:59], v110
  v_cvt_pk_bf16_f32 v102, v68, v69
  v_smfmac_f32_16x16x64_bf16 v[36:39], v[28:31], a[224:231], v110
  v_cvt_pk_bf16_f32 v103, v70, v71
  v_smfmac_f32_16x16x64_bf16 v[40:43], v[28:31], v[248:255], v110
  v_smfmac_f32_16x16x64_bf16 v[36:39], v[32:35], a[232:239], v110
  s_waitcnt lgkmcnt(0)
  v_smfmac_f32_16x16x64_bf16 v[40:43], v[32:35], v[44:51], v110
  v_mfma_f32_16x16x16_bf16 v[142:145], v[100:101], v[108:109], 0
  v_mfma_f32_16x16x16_bf16 v[146:149], v[102:103], v[108:109], 0
  s_nop 1
  v_permlane32_swap_b32 v36, v40
  v_permlane32_swap_b32 v37, v41
  v_permlane32_swap_b32 v38, v42
  v_permlane32_swap_b32 v39, v43
  v_add_f32 v36, v36, v40
  v_add_f32 v37, v37, v41
  v_add_f32 v38, v38, v42
  v_add_f32 v39, v39, v43
  v_cvt_pk_bf16_f32 v104, v36, v37
  v_cvt_pk_bf16_f32 v105, v38, v39
  v_cvt_pk_bf16_f32 v44, v142, v143
  v_cvt_pk_bf16_f32 v45, v144, v145
  v_mfma_f32_16x16x16_bf16 v[142:145], v[104:105], v[108:109], 0
  v_cvt_pk_bf16_f32 v46, v146, v147
  v_cvt_pk_bf16_f32 v47, v148, v149
  ds_write_b64 v131, v[44:45]
  ds_write_b64 v131, v[46:47] offset:512
  v_mfma_f32_16x16x32_bf16 v[76:79], v[44:47], v[44:47], 0
  v_mfma_f32_16x16x32_bf16 v[80:83], v[88:91], v[44:47], 0
  v_mfma_f32_16x16x32_bf16 v[84:87], v[92:95], v[44:47], 0
  v_cvt_pk_bf16_f32 v106, v142, v143
  v_cvt_pk_bf16_f32 v107, v144, v145
  ds_write_b64 v131, v[106:107] offset:1024
  s_nop 0
  v_mfma_f32_16x16x16_bf16 v[76:79], v[106:107], v[106:107], v[76:79]
  v_mfma_f32_16x16x16_bf16 v[80:83], v[96:97], v[106:107], v[80:83]
  v_mfma_f32_16x16x16_bf16 v[84:87], v[98:99], v[106:107], v[84:87]
  s_nop 6
  ds_write_b128 v130, v[76:79] offset:0
  ds_write_b128 v130, v[80:83] offset:1024
  s_nop 0
  ds_write_b128 v130, v[84:87] offset:2048
  s_mov_b32 s28, s50
  buffer_load_dwordx4 v[4:7], v132, s[8:11], s28 offen sc1
  buffer_load_dwordx4 v[8:11], v132, s[8:11], s28 offen offset:1024 sc1
  s_add_u32 s28, s28, 2048
  buffer_load_dwordx4 v[12:15], v132, s[8:11], s28 offen sc1
  buffer_load_dwordx4 v[16:19], v132, s[8:11], s28 offen offset:1024 sc1
  s_add_u32 s28, s28, 2048
  buffer_load_dwordx4 v[20:23], v132, s[8:11], s28 offen sc1
  buffer_load_dwordx4 v[24:27], v132, s[8:11], s28 offen offset:1024 sc1
  s_add_u32 s28, s28, 2048
  buffer_load_dwordx4 v[28:31], v132, s[8:11], s28 offen sc1
  buffer_load_dwordx4 v[32:35], v132, s[8:11], s28 offen offset:1024 sc1
  s_add_u32 s28, s28, 2048
  buffer_load_dwordx4 v[36:39], v132, s[8:11], s28 offen sc1
  buffer_load_dwordx4 v[40:43], v132, s[8:11], s28 offen offset:1024 sc1
  s_add_u32 s28, s28, 2048
  buffer_load_dwordx4 v[60:63], v132, s[8:11], s28 offen sc1
  buffer_load_dwordx4 v[64:67], v132, s[8:11], s28 offen offset:1024 sc1
  s_add_u32 s28, s28, 2048
  s_waitcnt lgkmcnt(0)
  s_barrier
  ds_read_b64 v[76:77], v136 offset:0
  ds_read_b64 v[78:79], v136 offset:512
  ds_read_b64 v[80:81], v136 offset:1024
  ds_read_b64 v[82:83], v136 offset:1536
  ds_read_b64 v[84:85], v136 offset:2048
  ds_read_b64 v[86:87], v136 offset:2560
  ds_read_b64 v[88:89], v136 offset:3072
  ds_read_b64 v[90:91], v136 offset:3584
  ds_read_b64 v[92:93], v136 offset:4096
  ds_read_b64 v[94:95], v136 offset:4608
  ds_read_b64 v[96:97], v136 offset:5120
  ds_read_b64 v[98:99], v136 offset:5632
  ds_read_b128 v[44:47], v137 offset:0
  ds_read_b128 v[48:51], v137 offset:1024
  ds_read_b128 v[52:55], v137 offset:2048
  s_waitcnt lgkmcnt(3)
  ds_read_b128 v[56:59], v137 offset:3072
  ds_read_b128 v[68:71], v137 offset:4096
  ds_read_b128 v[72:75], v137 offset:5120
  s_waitcnt lgkmcnt(0)
  s_cmp_ge_u32 s51, 63
  s_cbranch_scc1 xq_92
  s_add_u32 s96, s51, 1
  s_cmp_gt_u32 s52, s96
  s_cbranch_scc1 kas_x_wp_93_ok
  s_mov_b32 s45, 0
kas_x_wp_93_spin:
  buffer_load_dword v2, v138, s[8:11], 0 offen sc1
  s_add_u32 s45, s45, 1
  s_waitcnt vmcnt(0)
  v_min_u32_dpp v3, v2, v2 quad_perm:[1,0,3,2] row_mask:0xf bank_mask:0xf
  s_nop 1
  v_min_u32_dpp v2, v3, v3 quad_perm:[2,3,0,1] row_mask:0xf bank_mask:0xf
  s_nop 1
  v_min_u32_dpp v3, v2, v2 row_half_mirror row_mask:0xf bank_mask:0xf
  s_nop 1
  v_min_u32_dpp v2, v3, v3 quad_perm:[0,1,2,3] row_mask:0xf bank_mask:0xf
  s_nop 0
  v_readfirstlane_b32 s52, v2
  s_cmp_gt_u32 s52, s96
  s_cbranch_scc1 kas_x_wp_93_ok
  s_cmp_lt_u32 s45, 400000
  s_cbranch_scc1 kas_x_wp_93_spin
  s_branch kas_abort
kas_x_wp_93_ok:
  s_add_u32 s95, s63, s93
  s_add_u32 s95, s95, 12288
  s_add_u32 m0, s94, 0
  s_add_u32 s28, s95, 0
  buffer_load_dwordx4 v132, s[8:11], s28 offen sc1 lds
  s_add_u32 m0, s94, 1024
  s_add_u32 s28, s95, 2048
  buffer_load_dwordx4 v132, s[8:11], s28 offen sc1 lds
  s_add_u32 m0, s94, 2048
  s_add_u32 s28, s95, 4096
  buffer_load_dwordx4 v132, s[8:11], s28 offen sc1 lds
  s_add_u32 m0, s94, 3072
  s_add_u32 s28, s95, 6144
  buffer_load_dwordx4 v132, s[8:11], s28 offen sc1 lds
  s_add_u32 m0, s94, 4096
  s_add_u32 s28, s95, 8192
  buffer_load_dwordx4 v132, s[8:11], s28 offen sc1 lds
  s_add_u32 m0, s94, 5120
  s_add_u32 s28, s95, 10240
  buffer_load_dwordx4 v132, s[8:11], s28 offen sc1 lds
  s_branch xq_92_j
xq_92:
  s_waitcnt vmcnt(0)
xq_92_j:
  s_waitcnt vmcnt(16)
  v_mfma_f32_16x16x32_bf16 v[112:115], v[76:79], v[44:47], 0
  v_mfma_f32_16x16x32_bf16 v[116:119], v[4:7], v[44:47], 0
  v_mfma_f32_16x16x32_bf16 v[120:123], v[8:11], v[44:47], 0
  s_waitcnt vmcnt(14)
  v_mfma_f32_16x16x32_bf16 v[112:115], v[80:83], v[48:51], v[112:115]
  v_mfma_f32_16x16x32_bf16 v[116:119], v[12:15], v[48:51], v[116:119]
  v_mfma_f32_16x16x32_bf16 v[120:123], v[16:19], v[48:51], v[120:123]
  s_waitcnt vmcnt(12)
  v_mfma_f32_16x16x32_bf16 v[112:115], v[84:87], v[52:55], v[112:115]
  v_mfma_f32_16x16x32_bf16 v[116:119], v[20:23], v[52:55], v[116:119]
  v_mfma_f32_16x16x32_bf16 v[120:123], v[24:27], v[52:55], v[120:123]
  s_waitcnt vmcnt(10)
  v_mfma_f32_16x16x32_bf16 v[112:115], v[88:91], v[56:59], v[112:115]
  v_mfma_f32_16x16x32_bf16 v[116:119], v[28:31], v[56:59], v[116:119]
  v_mfma_f32_16x16x32_bf16 v[120:123], v[32:35], v[56:59], v[120:123]
  s_waitcnt vmcnt(8)
  v_mfma_f32_16x16x32_bf16 v[112:115], v[92:95], v[68:71], v[112:115]
  v_mfma_f32_16x16x32_bf16 v[116:119], v[36:39], v[68:71], v[116:119]
  v_mfma_f32_16x16x32_bf16 v[120:123], v[40:43], v[68:71], v[120:123]
  s_waitcnt vmcnt(6)
  v_mfma_f32_16x16x32_bf16 v[112:115], v[96:99], v[72:75], v[112:115]
  v_mfma_f32_16x16x32_bf16 v[116:119], v[60:63], v[72:75], v[116:119]
  v_mfma_f32_16x16x32_bf16 v[120:123], v[64:67], v[72:75], v[120:123]
  s_nop 8
  v_cndmask_b32 v112, v135, v112, s[66:67]
  v_cndmask_b32 v113, v135, v113, s[66:67]
  v_cndmask_b32 v114, v135, v114, s[66:67]
  v_cndmask_b32 v115, v135, v115, s[66:67]
  v_cndmask_b32 v116, v135, v116, s[76:77]
  v_cndmask_b32 v120, v135, v120, s[84:85]
  v_cndmask_b32 v117, v135, v117, s[78:79]
  v_cndmask_b32 v121, v135, v121, s[86:87]
  v_cndmask_b32 v118, v135, v118, s[80:81]
  v_cndmask_b32 v122, v135, v122, s[88:89]
  v_cndmask_b32 v119, v135, v119, s[82:83]
  v_cndmask_b32 v123, v135, v123, s[90:91]
  v_max3_f32 v4, v112, v113, v114
  v_max3_f32 v5, v115, v116, v117
  v_max3_f32 v6, v118, v119, v120
  v_max3_f32 v7, v121, v122, v123
  v_max3_f32 v4, v4, v5, v6
  v_max_f32 v4, v4, v7
  v_mov_b32 v5, v4
  s_nop 1
  v_permlane16_swap_b32 v4, v5
  v_max_f32 v4, v4, v5
  v_mov_b32 v5, v4
  s_nop 1
  v_permlane32_swap_b32 v4, v5
  v_max_f32 v4, v4, v5
  v_mul_f32 v4, s64, v4
  v_fma_f32 v112, v112, s64, -v4
  v_fma_f32 v113, v113, s64, -v4
  v_fma_f32 v114, v114, s64, -v4
  v_fma_f32 v115, v115, s64, -v4
  v_fma_f32 v116, v116, s64, -v4
  v_fma_f32 v117, v117, s64, -v4
  v_fma_f32 v118, v118, s64, -v4
  v_fma_f32 v119, v119, s64, -v4
  v_fma_f32 v120, v120, s64, -v4
  v_fma_f32 v121, v121, s64, -v4
  v_fma_f32 v122, v122, s64, -v4
  v_fma_f32 v123, v123, s64, -v4
  v_exp_f32 v112, v112
  v_exp_f32 v113, v113
  v_exp_f32 v114, v114
  v_exp_f32 v115, v115
  v_exp_f32 v116, v116
  v_exp_f32 v117, v117
  v_exp_f32 v118, v118
  v_exp_f32 v119, v119
  v_exp_f32 v120, v120
  v_exp_f32 v121, v121
  v_exp_f32 v122, v122
  v_exp_f32 v123, v123
  v_add_f32 v5, v112, v113
  v_add_f32 v6, v114, v115
  v_add_f32 v7, v116, v117
  v_add_f32 v8, v118, v119
  v_add_f32 v9, v120, v121
  v_add_f32 v10, v122, v123
  v_add_f32 v5, v5, v6
  v_add_f32 v7, v7, v8
  v_add_f32 v9, v9, v10
  v_add_f32 v5, v5, v7
  v_add_f32 v5, v5, v9
  v_mov_b32 v6, v5
  s_nop 1
  v_permlane16_swap_b32 v5, v6
  v_add_f32 v5, v5, v6
  v_mov_b32 v6, v5
  s_nop 1
  v_permlane32_swap_b32 v5, v6
  v_add_f32 v5, v5, v6
  v_rcp_f32 v5, v5
  s_nop 0
  v_mul_f32 v112, v112, v5
  v_mul_f32 v113, v113, v5
  v_mul_f32 v114, v114, v5
  v_mul_f32 v115, v115, v5
  v_mul_f32 v116, v116, v5
  v_mul_f32 v117, v117, v5
  v_mul_f32 v118, v118, v5
  v_mul_f32 v119, v119, v5
  v_mul_f32 v120, v120, v5
  v_mul_f32 v121, v121, v5
  v_mul_f32 v122, v122, v5
  v_mul_f32 v123, v123, v5
  v_cvt_pk_bf16_f32 v8, v112, v113
  v_cvt_pk_bf16_f32 v9, v114, v115
  v_cvt_pk_bf16_f32 v10, v116, v117
  v_cvt_pk_bf16_f32 v11, v118, v119
  v_cvt_pk_bf16_f32 v12, v120, v121
  v_cvt_pk_bf16_f32 v13, v122, v123
  buffer_store_dwordx2 v[10:11], v133, s[8:11], s92 offen sc1
  buffer_store_dwordx2 v[12:13], v133, s[8:11], s92 offen offset:256 sc1
  buffer_store_dwordx2 v[8:9], v134, s[8:11], s92 offen sc1
  s_add_u32 s92, s92, 20480
  s_cmp_ge_u32 s51, 63
  s_cbranch_scc1 kas_x_done
  v_mov_b32 v60, 0
  v_mov_b32 v61, 0
  v_mov_b32 v62, 0
  v_mov_b32 v63, 0
  v_mov_b32 v64, 0
  v_mov_b32 v65, 0
  v_mov_b32 v66, 0
  v_mov_b32 v67, 0
  v_mov_b32 v68, 0
  v_mov_b32 v69, 0
  v_mov_b32 v70, 0
  v_mov_b32 v71, 0
  v_mov_b32 v72, 0
  v_mov_b32 v73, 0
  v_mov_b32 v74, 0
  v_mov_b32 v75, 0
  v_mov_b32 v36, 0
  v_mov_b32 v37, 0
  v_mov_b32 v38, 0
  v_mov_b32 v39, 0
  v_mov_b32 v40, 0
  v_mov_b32 v41, 0
  v_mov_b32 v42, 0
  v_mov_b32 v43, 0
  s_add_u32 s97, s97, 10240
  s_mov_b32 s48, s97
  s_add_u32 s49, s49, 5120
  s_add_u32 s50, s50, 12288
  s_add_u32 s63, s63, 12288
  s_add_u32 s51, s51, 1
  s_cmp_gt_u32 s52, s51
  s_cbranch_scc1 kas_x_wp_94_ok
  s_mov_b32 s45, 0
kas_x_wp_94_spin:
  buffer_load_dword v2, v138, s[8:11], 0 offen sc1
  s_add_u32 s45, s45, 1
  s_waitcnt vmcnt(0)
  v_min_u32_dpp v3, v2, v2 quad_perm:[1,0,3,2] row_mask:0xf bank_mask:0xf
  s_nop 1
  v_min_u32_dpp v2, v3, v3 quad_perm:[2,3,0,1] row_mask:0xf bank_mask:0xf
  s_nop 1
  v_min_u32_dpp v3, v2, v2 row_half_mirror row_mask:0xf bank_mask:0xf
  s_nop 1
  v_min_u32_dpp v2, v3, v3 quad_perm:[0,1,2,3] row_mask:0xf bank_mask:0xf
  s_nop 0
  v_readfirstlane_b32 s52, v2
  s_cmp_gt_u32 s52, s51
  s_cbranch_scc1 kas_x_wp_94_ok
  s_cmp_lt_u32 s45, 400000
  s_cbranch_scc1 kas_x_wp_94_spin
  s_branch kas_abort
kas_x_wp_94_ok:
  s_add_u32 s28, s50, s53
  buffer_load_dwordx2 v[88:89], v132, s[8:11], s28 offen offset:0 sc1
  buffer_load_dwordx2 v[92:93], v132, s[8:11], s28 offen offset:1024 sc1
  s_add_u32 s28, s50, s54
  buffer_load_dwordx2 v[90:91], v132, s[8:11], s28 offen offset:0 sc1
  buffer_load_dwordx2 v[94:95], v132, s[8:11], s28 offen offset:1024 sc1
  s_add_u32 s28, s50, s55
  buffer_load_dwordx2 v[96:97], v132, s[8:11], s28 offen offset:0 sc1
  buffer_load_dwordx2 v[98:99], v132, s[8:11], s28 offen offset:1024 sc1
  s_branch kas_x_w2l
kas_x_w3l:
  ds_read_b128 v[44:47], v129 offset:2048
  ds_read_b128 v[48:51], v129 offset:3072
  ds_read_b128 v[52:55], v129 offset:12288
  ds_read_b128 v[56:59], v129 offset:13312
  s_waitcnt lgkmcnt(0)
  s_mov_b32 s45, 0
kas_x_pf_95:
  buffer_load_dwordx4 v[112:115], v124, s[8:11], s48 offen sc1
  buffer_load_dwordx4 v[116:119], v125, s[8:11], s48 offen sc1
  s_add_u32 s45, s45, 1
  s_waitcnt vmcnt(1)
  ds_write_b128 v127, v[112:115] offset:0
  v_max3_u32 v139, v112, v113, v114
  v_max_u32 v139, v139, v115
  s_waitcnt vmcnt(0)
  ds_write_b128 v127, v[116:119] offset:4096
  v_max3_u32 v139, v139, v116, v117
  v_max3_u32 v139, v139, v118, v119
  v_cmp_eq_u32 vcc, -1, v139
  s_cbranch_vccz kas_x_pf_95_ok
  s_cmp_lt_u32 s45, 400000
  s_cbranch_scc1 kas_x_pf_95
  s_branch kas_abort
kas_x_pf_95_ok:
  v_smfmac_f32_16x16x64_bf16 v[60:63], v[112:115], a[24:31], v110
  v_smfmac_f32_16x16x64_bf16 v[64:67], v[112:115], v[44:51], v110
  ds_read_b128 v[44:47], v129 offset:22528
  v_smfmac_f32_16x16x64_bf16 v[68:71], v[112:115], a[104:111], v110
  ds_read_b128 v[48:51], v129 offset:23552
  v_smfmac_f32_16x16x64_bf16 v[72:75], v[112:115], v[52:59], v110
  ds_read_b128 v[52:55], v129 offset:6144
  s_waitcnt lgkmcnt(3)
  s_barrier
  v_smfmac_f32_16x16x64_bf16 v[36:39], v[112:115], a[184:191], v110
  ds_read_b128 v[56:59], v129 offset:7168
  ds_read_b128 v[4:7], v128 offset:0
  s_waitcnt lgkmcnt(3)
  v_smfmac_f32_16x16x64_bf16 v[40:43], v[112:115], v[44:51], v110
  ds_read_b128 v[44:47], v129 offset:16384
  ds_read_b128 v[8:11], v128 offset:1024
  v_smfmac_f32_16x16x64_bf16 v[60:63], v[116:119], a[56:63], v110
  ds_read_b128 v[48:51], v129 offset:17408
  ds_read_b128 v[12:15], v128 offset:2048
  s_waitcnt lgkmcnt(5)
  v_smfmac_f32_16x16x64_bf16 v[64:67], v[116:119], v[52:59], v110
  ds_read_b128 v[52:55], v129 offset:26624
  ds_read_b128 v[16:19], v128 offset:4096
  v_smfmac_f32_16x16x64_bf16 v[68:71], v[116:119], a[136:143], v110
  ds_read_b128 v[56:59], v129 offset:27648
  ds_read_b128 v[20:23], v128 offset:5120
  s_waitcnt lgkmcnt(5)
  v_smfmac_f32_16x16x64_bf16 v[72:75], v[116:119], v[44:51], v110
  ds_read_b128 v[44:47], v129 offset:0
  ds_read_b128 v[24:27], v128 offset:6144
  v_smfmac_f32_16x16x64_bf16 v[36:39], v[116:119], a[216:223], v110
  ds_read_b128 v[48:51], v129 offset:1024
  ds_read_b128 v[28:31], v128 offset:8192
  s_waitcnt lgkmcnt(5)
  v_smfmac_f32_16x16x64_bf16 v[40:43], v[116:119], v[52:59], v110
  ds_read_b128 v[52:55], v129 offset:4096
  ds_read_b128 v[32:35], v128 offset:9216
  v_smfmac_f32_16x16x64_bf16 v[60:63], v[4:7], a[0:7], v110
  ds_read_b128 v[56:59], v129 offset:5120
  v_smfmac_f32_16x16x64_bf16 v[64:67], v[4:7], a[240:247], v110
  v_smfmac_f32_16x16x64_bf16 v[60:63], v[8:11], a[8:15], v110
  s_waitcnt lgkmcnt(4)
  v_smfmac_f32_16x16x64_bf16 v[64:67], v[8:11], v[44:51], v110
  ds_read_b128 v[44:47], v129 offset:8192
  v_smfmac_f32_16x16x64_bf16 v[60:63], v[12:15], a[16:23], v110
  ds_read_b128 v[48:51], v129 offset:9216
  v_smfmac_f32_16x16x64_bf16 v[64:67], v[12:15], a[248:255], v110
  v_smfmac_f32_16x16x64_bf16 v[60:63], v[16:19], a[32:39], v110
  v_smfmac_f32_16x16x64_bf16 v[64:67], v[16:19], v[152:159], v110
  v_smfmac_f32_16x16x64_bf16 v[60:63], v[20:23], a[40:47], v110
  s_waitcnt lgkmcnt(2)
  v_smfmac_f32_16x16x64_bf16 v[64:67], v[20:23], v[52:59], v110
  ds_read_b128 v[52:55], v129 offset:10240
  v_smfmac_f32_16x16x64_bf16 v[60:63], v[24:27], a[48:55], v110
  ds_read_b128 v[56:59], v129 offset:11264
  v_smfmac_f32_16x16x64_bf16 v[64:67], v[24:27], v[160:167], v110
  v_smfmac_f32_16x16x64_bf16 v[60:63], v[28:31], a[64:71], v110
  v_smfmac_f32_16x16x64_bf16 v[64:67], v[28:31], v[168:175], v110
  v_smfmac_f32_16x16x64_bf16 v[60:63], v[32:35], a[72:79], v110
  s_waitcnt lgkmcnt(2)
  v_smfmac_f32_16x16x64_bf16 v[64:67], v[32:35], v[44:51], v110
  ds_read_b128 v[44:47], v129 offset:14336
  v_smfmac_f32_16x16x64_bf16 v[68:71], v[4:7], a[80:87], v110
  ds_read_b128 v[48:51], v129 offset:15360
  v_smfmac_f32_16x16x64_bf16 v[72:75], v[4:7], v[176:183], v110
  v_permlane32_swap_b32 v60, v64
  v_smfmac_f32_16x16x64_bf16 v[68:71], v[8:11], a[88:95], v110
  s_waitcnt lgkmcnt(2)
  v_smfmac_f32_16x16x64_bf16 v[72:75], v[8:11], v[52:59], v110
  ds_read_b128 v[52:55], v129 offset:18432
  v_permlane32_swap_b32 v61, v65
  v_smfmac_f32_16x16x64_bf16 v[68:71], v[12:15], a[96:103], v110
  ds_read_b128 v[56:59], v129 offset:19456
  v_smfmac_f32_16x16x64_bf16 v[72:75], v[12:15], v[184:191], v110
  v_permlane32_swap_b32 v62, v66
  v_smfmac_f32_16x16x64_bf16 v[68:71], v[16:19], a[112:119], v110
  v_permlane32_swap_b32 v63, v67
  v_smfmac_f32_16x16x64_bf16 v[72:75], v[16:19], v[192:199], v110
  v_add_f32 v60, v60, v64
  v_smfmac_f32_16x16x64_bf16 v[68:71], v[20:23], a[120:127], v110
  v_add_f32 v61, v61, v65
  s_waitcnt lgkmcnt(2)
  v_smfmac_f32_16x16x64_bf16 v[72:75], v[20:23], v[44:51], v110
  ds_read_b128 v[44:47], v129 offset:20480
  v_add_f32 v62, v62, v66
  v_smfmac_f32_16x16x64_bf16 v[68:71], v[24:27], a[128:135], v110
  ds_read_b128 v[48:51], v129 offset:21504
  v_add_f32 v63, v63, v67
  v_smfmac_f32_16x16x64_bf16 v[72:75], v[24:27], v[200:207], v110
  v_cvt_pk_bf16_f32 v100, v60, v61
  v_smfmac_f32_16x16x64_bf16 v[68:71], v[28:31], a[144:151], v110
  v_cvt_pk_bf16_f32 v101, v62, v63
  v_smfmac_f32_16x16x64_bf16 v[72:75], v[28:31], v[208:215], v110
  v_smfmac_f32_16x16x64_bf16 v[68:71], v[32:35], a[152:159], v110
  s_waitcnt lgkmcnt(2)
  v_smfmac_f32_16x16x64_bf16 v[72:75], v[32:35], v[52:59], v110
  ds_read_b128 v[52:55], v129 offset:24576
  v_smfmac_f32_16x16x64_bf16 v[36:39], v[4:7], a[160:167], v110
  ds_read_b128 v[56:59], v129 offset:25600
  v_smfmac_f32_16x16x64_bf16 v[40:43], v[4:7], v[216:223], v110
  v_permlane32_swap_b32 v68, v72
  v_smfmac_f32_16x16x64_bf16 v[36:39], v[8:11], a[168:175], v110
  s_waitcnt lgkmcnt(2)
  v_smfmac_f32_16x16x64_bf16 v[40:43], v[8:11], v[44:51], v110
  ds_read_b128 v[44:47], v129 offset:28672
  v_permlane32_swap_b32 v69, v73
  v_smfmac_f32_16x16x64_bf16 v[36:39], v[12:15], a[176:183], v110
  ds_read_b128 v[48:51], v129 offset:29696
  v_smfmac_f32_16x16x64_bf16 v[40:43], v[12:15], v[224:231], v110
  v_permlane32_swap_b32 v70, v74
  v_smfmac_f32_16x16x64_bf16 v[36:39], v[16:19], a[192:199], v110
  v_permlane32_swap_b32 v71, v75
  v_smfmac_f32_16x16x64_bf16 v[40:43], v[16:19], v[232:239], v110
  v_add_f32 v68, v68, v72
  v_smfmac_f32_16x16x64_bf16 v[36:39], v[20:23], a[200:207], v110
  v_add_f32 v69, v69, v73
  s_waitcnt lgkmcnt(2)
  v_smfmac_f32_16x16x64_bf16 v[40:43], v[20:23], v[52:59], v110
  v_add_f32 v70, v70, v74
  v_smfmac_f32_16x16x64_bf16 v[36:39], v[24:27], a[208:215], v110
  v_add_f32 v71, v71, v75
  v_smfmac_f32_16x16x64_bf16 v[40:43], v[24:27], v[240:247], v110
  v_cvt_pk_bf16_f32 v102, v68, v69
  v_smfmac_f32_16x16x64_bf16 v[36:39], v[28:31], a[224:231], v110
  v_cvt_pk_bf16_f32 v103, v70, v71
  v_smfmac_f32_16x16x64_bf16 v[40:43], v[28:31], v[248:255], v110
  v_smfmac_f32_16x16x64_bf16 v[36:39], v[32:35], a[232:239], v110
  s_waitcnt lgkmcnt(0)
  v_smfmac_f32_16x16x64_bf16 v[40:43], v[32:35], v[44:51], v110
  v_mfma_f32_16x16x16_bf16 v[142:145], v[100:101], v[108:109], 0
  v_mfma_f32_16x16x16_bf16 v[146:149], v[102:103], v[108:109], 0
  s_nop 1
  v_permlane32_swap_b32 v36, v40
  v_permlane32_swap_b32 v37, v41
  v_permlane32_swap_b32 v38, v42
  v_permlane32_swap_b32 v39, v43
  v_add_f32 v36, v36, v40
  v_add_f32 v37, v37, v41
  v_add_f32 v38, v38, v42
  v_add_f32 v39, v39, v43
  v_cvt_pk_bf16_f32 v104, v36, v37
  v_cvt_pk_bf16_f32 v105, v38, v39
  v_cvt_pk_bf16_f32 v44, v142, v143
  v_cvt_pk_bf16_f32 v45, v144, v145
  v_mfma_f32_16x16x16_bf16 v[142:145], v[104:105], v[108:109], 0
  v_cvt_pk_bf16_f32 v46, v146, v147
  v_cvt_pk_bf16_f32 v47, v148, v149
  ds_write_b64 v131, v[44:45]
  ds_write_b64 v131, v[46:47] offset:512
  v_mfma_f32_16x16x32_bf16 v[76:79], v[44:47], v[44:47], 0
  v_mfma_f32_16x16x32_bf16 v[80:83], v[88:91], v[44:47], 0
  v_mfma_f32_16x16x32_bf16 v[84:87], v[92:95], v[44:47], 0
  v_cvt_pk_bf16_f32 v106, v142, v143
  v_cvt_pk_bf16_f32 v107, v144, v145
  ds_write_b64 v131, v[106:107] offset:1024
  s_nop 0
  v_mfma_f32_16x16x16_bf16 v[76:79], v[106:107], v[106:107], v[76:79]
  v_mfma_f32_16x16x16_bf16 v[80:83], v[96:97], v[106:107], v[80:83]
  v_mfma_f32_16x16x16_bf16 v[84:87], v[98:99], v[106:107], v[84:87]
  s_nop 6
  ds_write_b128 v130, v[76:79] offset:0
  ds_write_b128 v130, v[80:83] offset:1024
  s_nop 0
  ds_write_b128 v130, v[84:87] offset:2048
  s_mov_b32 s28, s50
  buffer_load_dwordx4 v[4:7], v132, s[8:11], s28 offen sc1
  buffer_load_dwordx4 v[8:11], v132, s[8:11], s28 offen offset:1024 sc1
  s_add_u32 s28, s28, 2048
  buffer_load_dwordx4 v[12:15], v132, s[8:11], s28 offen sc1
  buffer_load_dwordx4 v[16:19], v132, s[8:11], s28 offen offset:1024 sc1
  s_add_u32 s28, s28, 2048
  buffer_load_dwordx4 v[20:23], v132, s[8:11], s28 offen sc1
  buffer_load_dwordx4 v[24:27], v132, s[8:11], s28 offen offset:1024 sc1
  s_add_u32 s28, s28, 2048
  buffer_load_dwordx4 v[28:31], v132, s[8:11], s28 offen sc1
  buffer_load_dwordx4 v[32:35], v132, s[8:11], s28 offen offset:1024 sc1
  s_add_u32 s28, s28, 2048
  buffer_load_dwordx4 v[36:39], v132, s[8:11], s28 offen sc1
  buffer_load_dwordx4 v[40:43], v132, s[8:11], s28 offen offset:1024 sc1
  s_add_u32 s28, s28, 2048
  buffer_load_dwordx4 v[60:63], v132, s[8:11], s28 offen sc1
  buffer_load_dwordx4 v[64:67], v132, s[8:11], s28 offen offset:1024 sc1
  s_add_u32 s28, s28, 2048
  s_waitcnt lgkmcnt(0)
  s_barrier
  ds_read_b64 v[76:77], v136 offset:0
  ds_read_b64 v[78:79], v136 offset:512
  ds_read_b64 v[80:81], v136 offset:1024
  ds_read_b64 v[82:83], v136 offset:1536
  ds_read_b64 v[84:85], v136 offset:2048
  ds_read_b64 v[86:87], v136 offset:2560
  ds_read_b64 v[88:89], v136 offset:3072
  ds_read_b64 v[90:91], v136 offset:3584
  ds_read_b64 v[92:93], v136 offset:4096
  ds_read_b64 v[94:95], v136 offset:4608
  ds_read_b64 v[96:97], v136 offset:5120
  ds_read_b64 v[98:99], v136 offset:5632
  ds_read_b128 v[44:47], v137 offset:0
  ds_read_b128 v[48:51], v137 offset:1024
  ds_read_b128 v[52:55], v137 offset:2048
  s_waitcnt lgkmcnt(3)
  ds_read_b128 v[56:59], v137 offset:3072
  ds_read_b128 v[68:71], v137 offset:4096
  ds_read_b128 v[72:75], v137 offset:5120
  s_waitcnt lgkmcnt(0)
  s_cmp_ge_u32 s51, 63
  s_cbranch_scc1 xq_96
  s_add_u32 s96, s51, 1
  s_cmp_gt_u32 s52, s96
  s_cbranch_scc1 kas_x_wp_97_ok
  s_mov_b32 s45, 0
kas_x_wp_97_spin:
  buffer_load_dword v2, v138, s[8:11], 0 offen sc1
  s_add_u32 s45, s45, 1
  s_waitcnt vmcnt(0)
  v_min_u32_dpp v3, v2, v2 quad_perm:[1,0,3,2] row_mask:0xf bank_mask:0xf
  s_nop 1
  v_min_u32_dpp v2, v3, v3 quad_perm:[2,3,0,1] row_mask:0xf bank_mask:0xf
  s_nop 1
  v_min_u32_dpp v3, v2, v2 row_half_mirror row_mask:0xf bank_mask:0xf
  s_nop 1
  v_min_u32_dpp v2, v3, v3 quad_perm:[0,1,2,3] row_mask:0xf bank_mask:0xf
  s_nop 0
  v_readfirstlane_b32 s52, v2
  s_cmp_gt_u32 s52, s96
  s_cbranch_scc1 kas_x_wp_97_ok
  s_cmp_lt_u32 s45, 400000
  s_cbranch_scc1 kas_x_wp_97_spin
  s_branch kas_abort
kas_x_wp_97_ok:
  s_add_u32 s95, s63, s93
  s_add_u32 s95, s95, 12288
  s_add_u32 m0, s94, 0
  s_add_u32 s28, s95, 0
  buffer_load_dwordx4 v132, s[8:11], s28 offen sc1 lds
  s_add_u32 m0, s94, 1024
  s_add_u32 s28, s95, 2048
  buffer_load_dwordx4 v132, s[8:11], s28 offen sc1 lds
  s_add_u32 m0, s94, 2048
  s_add_u32 s28, s95, 4096
  buffer_load_dwordx4 v132, s[8:11], s28 offen sc1 lds
  s_add_u32 m0, s94, 3072
  s_add_u32 s28, s95, 6144
  buffer_load_dwordx4 v132, s[8:11], s28 offen sc1 lds
  s_add_u32 m0, s94, 4096
  s_add_u32 s28, s95, 8192
  buffer_load_dwordx4 v132, s[8:11], s28 offen sc1 lds
  s_add_u32 m0, s94, 5120
  s_add_u32 s28, s95, 10240
  buffer_load_dwordx4 v132, s[8:11], s28 offen sc1 lds
  s_branch xq_96_j
xq_96:
  s_waitcnt vmcnt(0)
xq_96_j:
  s_waitcnt vmcnt(16)
  v_mfma_f32_16x16x32_bf16 v[112:115], v[76:79], v[44:47], 0
  v_mfma_f32_16x16x32_bf16 v[116:119], v[4:7], v[44:47], 0
  v_mfma_f32_16x16x32_bf16 v[120:123], v[8:11], v[44:47], 0
  s_waitcnt vmcnt(14)
  v_mfma_f32_16x16x32_bf16 v[112:115], v[80:83], v[48:51], v[112:115]
  v_mfma_f32_16x16x32_bf16 v[116:119], v[12:15], v[48:51], v[116:119]
  v_mfma_f32_16x16x32_bf16 v[120:123], v[16:19], v[48:51], v[120:123]
  s_waitcnt vmcnt(12)
  v_mfma_f32_16x16x32_bf16 v[112:115], v[84:87], v[52:55], v[112:115]
  v_mfma_f32_16x16x32_bf16 v[116:119], v[20:23], v[52:55], v[116:119]
  v_mfma_f32_16x16x32_bf16 v[120:123], v[24:27], v[52:55], v[120:123]
  s_waitcnt vmcnt(10)
  v_mfma_f32_16x16x32_bf16 v[112:115], v[88:91], v[56:59], v[112:115]
  v_mfma_f32_16x16x32_bf16 v[116:119], v[28:31], v[56:59], v[116:119]
  v_mfma_f32_16x16x32_bf16 v[120:123], v[32:35], v[56:59], v[120:123]
  s_waitcnt vmcnt(8)
  v_mfma_f32_16x16x32_bf16 v[112:115], v[92:95], v[68:71], v[112:115]
  v_mfma_f32_16x16x32_bf16 v[116:119], v[36:39], v[68:71], v[116:119]
  v_mfma_f32_16x16x32_bf16 v[120:123], v[40:43], v[68:71], v[120:123]
  s_waitcnt vmcnt(6)
  v_mfma_f32_16x16x32_bf16 v[112:115], v[96:99], v[72:75], v[112:115]
  v_mfma_f32_16x16x32_bf16 v[116:119], v[60:63], v[72:75], v[116:119]
  v_mfma_f32_16x16x32_bf16 v[120:123], v[64:67], v[72:75], v[120:123]
  s_nop 8
  v_cndmask_b32 v112, v135, v112, s[66:67]
  v_cndmask_b32 v113, v135, v113, s[66:67]
  v_cndmask_b32 v114, v135, v114, s[66:67]
  v_cndmask_b32 v115, v135, v115, s[66:67]
  v_cndmask_b32 v116, v135, v116, s[76:77]
  v_cndmask_b32 v120, v135, v120, s[84:85]
  v_cndmask_b32 v117, v135, v117, s[78:79]
  v_cndmask_b32 v121, v135, v121, s[86:87]
  v_cndmask_b32 v118, v135, v118, s[80:81]
  v_cndmask_b32 v122, v135, v122, s[88:89]
  v_cndmask_b32 v119, v135, v119, s[82:83]
  v_cndmask_b32 v123, v135, v123, s[90:91]
  v_max3_f32 v4, v112, v113, v114
  v_max3_f32 v5, v115, v116, v117
  v_max3_f32 v6, v118, v119, v120
  v_max3_f32 v7, v121, v122, v123
  v_max3_f32 v4, v4, v5, v6
  v_max_f32 v4, v4, v7
  v_mov_b32 v5, v4
  s_nop 1
  v_permlane16_swap_b32 v4, v5
  v_max_f32 v4, v4, v5
  v_mov_b32 v5, v4
  s_nop 1
  v_permlane32_swap_b32 v4, v5
  v_max_f32 v4, v4, v5
  v_mul_f32 v4, s64, v4
  v_fma_f32 v112, v112, s64, -v4
  v_fma_f32 v113, v113, s64, -v4
  v_fma_f32 v114, v114, s64, -v4
  v_fma_f32 v115, v115, s64, -v4
  v_fma_f32 v116, v116, s64, -v4
  v_fma_f32 v117, v117, s64, -v4
  v_fma_f32 v118, v118, s64, -v4
  v_fma_f32 v119, v119, s64, -v4
  v_fma_f32 v120, v120, s64, -v4
  v_fma_f32 v121, v121, s64, -v4
  v_fma_f32 v122, v122, s64, -v4
  v_fma_f32 v123, v123, s64, -v4
  v_exp_f32 v112, v112
  v_exp_f32 v113, v113
  v_exp_f32 v114, v114
  v_exp_f32 v115, v115
  v_exp_f32 v116, v116
  v_exp_f32 v117, v117
  v_exp_f32 v118, v118
  v_exp_f32 v119, v119
  v_exp_f32 v120, v120
  v_exp_f32 v121, v121
  v_exp_f32 v122, v122
  v_exp_f32 v123, v123
  v_add_f32 v5, v112, v113
  v_add_f32 v6, v114, v115
  v_add_f32 v7, v116, v117
  v_add_f32 v8, v118, v119
  v_add_f32 v9, v120, v121
  v_add_f32 v10, v122, v123
  v_add_f32 v5, v5, v6
  v_add_f32 v7, v7, v8
  v_add_f32 v9, v9, v10
  v_add_f32 v5, v5, v7
  v_add_f32 v5, v5, v9
  v_mov_b32 v6, v5
  s_nop 1
  v_permlane16_swap_b32 v5, v6
  v_add_f32 v5, v5, v6
  v_mov_b32 v6, v5
  s_nop 1
  v_permlane32_swap_b32 v5, v6
  v_add_f32 v5, v5, v6
  v_rcp_f32 v5, v5
  s_nop 0
  v_mul_f32 v112, v112, v5
  v_mul_f32 v113, v113, v5
  v_mul_f32 v114, v114, v5
  v_mul_f32 v115, v115, v5
  v_mul_f32 v116, v116, v5
  v_mul_f32 v117, v117, v5
  v_mul_f32 v118, v118, v5
  v_mul_f32 v119, v119, v5
  v_mul_f32 v120, v120, v5
  v_mul_f32 v121, v121, v5
  v_mul_f32 v122, v122, v5
  v_mul_f32 v123, v123, v5
  v_cvt_pk_bf16_f32 v8, v112, v113
  v_cvt_pk_bf16_f32 v9, v114, v115
  v_cvt_pk_bf16_f32 v10, v116, v117
  v_cvt_pk_bf16_f32 v11, v118, v119
  v_cvt_pk_bf16_f32 v12, v120, v121
  v_cvt_pk_bf16_f32 v13, v122, v123
  buffer_store_dwordx2 v[10:11], v133, s[8:11], s92 offen sc1
  buffer_store_dwordx2 v[12:13], v133, s[8:11], s92 offen offset:256 sc1
  buffer_store_dwordx2 v[8:9], v134, s[8:11], s92 offen sc1
  s_add_u32 s92, s92, 20480
  s_cmp_ge_u32 s51, 63
  s_cbranch_scc1 kas_x_done
  v_mov_b32 v60, 0
  v_mov_b32 v61, 0
  v_mov_b32 v62, 0
  v_mov_b32 v63, 0
  v_mov_b32 v64, 0
  v_mov_b32 v65, 0
  v_mov_b32 v66, 0
  v_mov_b32 v67, 0
  v_mov_b32 v68, 0
  v_mov_b32 v69, 0
  v_mov_b32 v70, 0
  v_mov_b32 v71, 0
  v_mov_b32 v72, 0
  v_mov_b32 v73, 0
  v_mov_b32 v74, 0
  v_mov_b32 v75, 0
  v_mov_b32 v36, 0
  v_mov_b32 v37, 0
  v_mov_b32 v38, 0
  v_mov_b32 v39, 0
  v_mov_b32 v40, 0
  v_mov_b32 v41, 0
  v_mov_b32 v42, 0
  v_mov_b32 v43, 0
  s_add_u32 s97, s97, 10240
  s_mov_b32 s48, s97
  s_add_u32 s49, s49, 5120
  s_add_u32 s50, s50, 12288
  s_add_u32 s63, s63, 12288
  s_add_u32 s51, s51, 1
  s_cmp_gt_u32 s52, s51
  s_cbranch_scc1 kas_x_wp_98_ok
  s_mov_b32 s45, 0
kas_x_wp_98_spin:
  buffer_load_dword v2, v138, s[8:11], 0 offen sc1
  s_add_u32 s45, s45, 1
  s_waitcnt vmcnt(0)
  v_min_u32_dpp v3, v2, v2 quad_perm:[1,0,3,2] row_mask:0xf bank_mask:0xf
  s_nop 1
  v_min_u32_dpp v2, v3, v3 quad_perm:[2,3,0,1] row_mask:0xf bank_mask:0xf
  s_nop 1
  v_min_u32_dpp v3, v2, v2 row_half_mirror row_mask:0xf bank_mask:0xf
  s_nop 1
  v_min_u32_dpp v2, v3, v3 quad_perm:[0,1,2,3] row_mask:0xf bank_mask:0xf
  s_nop 0
  v_readfirstlane_b32 s52, v2
  s_cmp_gt_u32 s52, s51
  s_cbranch_scc1 kas_x_wp_98_ok
  s_cmp_lt_u32 s45, 400000
  s_cbranch_scc1 kas_x_wp_98_spin
  s_branch kas_abort
kas_x_wp_98_ok:
  s_add_u32 s28, s50, s53
  buffer_load_dwordx2 v[88:89], v132, s[8:11], s28 offen offset:0 sc1
  buffer_load_dwordx2 v[92:93], v132, s[8:11], s28 offen offset:1024 sc1
  s_add_u32 s28, s50, s54
  buffer_load_dwordx2 v[90:91], v132, s[8:11], s28 offen offset:0 sc1
  buffer_load_dwordx2 v[94:95], v132, s[8:11], s28 offen offset:1024 sc1
  s_add_u32 s28, s50, s55
  buffer_load_dwordx2 v[96:97], v132, s[8:11], s28 offen offset:0 sc1
  buffer_load_dwordx2 v[98:99], v132, s[8:11], s28 offen offset:1024 sc1
  s_branch kas_x_w3l
kas_x_done:
  s_waitcnt vmcnt(0) lgkmcnt(0)
  s_branch kas_exit
kas_y:
  v_and_b32 v1, 63, v0
  v_lshlrev_b32 v178, 4, v1
  s_and_b32 s28, s21, 1
  s_lshl_b32 s46, s23, 1
  s_add_u32 s46, s46, s28
  s_lshr_b32 s28, s21, 1
  s_lshl_b32 s28, s28, 2
  s_lshl_b32 s47, s20, 3
  s_add_u32 s47, s47, s28
  s_mul_i32 s28, s47, 40
  s_add_u32 s28, s28, s46
  s_mul_i32 s28, s28, 20480
  s_add_u32 s28, s28, 0x2e00000
  s_add_u32 s29, s28, 0
  buffer_load_dwordx4 a[0:3], v178, s[8:11], s29 offen
  buffer_load_dwordx4 a[4:7], v178, s[8:11], s29 offen offset:1024
  s_add_u32 s29, s28, 2048
  buffer_load_dwordx4 a[8:11], v178, s[8:11], s29 offen
  buffer_load_dwordx4 a[12:15], v178, s[8:11], s29 offen offset:1024
  s_add_u32 s29, s28, 4096
  buffer_load_dwordx4 a[16:19], v178, s[8:11], s29 offen
  buffer_load_dwordx4 a[20:23], v178, s[8:11], s29 offen offset:1024
  s_add_u32 s29, s28, 6144
  buffer_load_dwordx4 a[24:27], v178, s[8:11], s29 offen
  buffer_load_dwordx4 a[28:31], v178, s[8:11], s29 offen offset:1024
  s_add_u32 s29, s28, 8192
  buffer_load_dwordx4 a[32:35], v178, s[8:11], s29 offen
  buffer_load_dwordx4 a[36:39], v178, s[8:11], s29 offen offset:1024
  s_add_u32 s29, s28, 10240
  buffer_load_dwordx4 a[40:43], v178, s[8:11], s29 offen
  buffer_load_dwordx4 a[44:47], v178, s[8:11], s29 offen offset:1024
  s_add_u32 s29, s28, 12288
  buffer_load_dwordx4 a[48:51], v178, s[8:11], s29 offen
  buffer_load_dwordx4 a[52:55], v178, s[8:11], s29 offen offset:1024
  s_add_u32 s29, s28, 14336
  buffer_load_dwordx4 a[56:59], v178, s[8:11], s29 offen
  buffer_load_dwordx4 a[60:63], v178, s[8:11], s29 offen offset:1024
  s_add_u32 s29, s28, 16384
  buffer_load_dwordx4 a[64:67], v178, s[8:11], s29 offen
  buffer_load_dwordx4 a[68:71], v178, s[8:11], s29 offen offset:1024
  s_add_u32 s29, s28, 18432
  buffer_load_dwordx4 a[72:75], v178, s[8:11], s29 offen
  buffer_load_dwordx4 a[76:79], v178, s[8:11], s29 offen offset:1024
  s_add_u32 s29, s28, 819200
  buffer_load_dwordx4 a[80:83], v178, s[8:11], s29 offen
  buffer_load_dwordx4 a[84:87], v178, s[8:11], s29 offen offset:1024
  s_add_u32 s29, s28, 821248
  buffer_load_dwordx4 a[88:91], v178, s[8:11], s29 offen
  buffer_load_dwordx4 a[92:95], v178, s[8:11], s29 offen offset:1024
  s_add_u32 s29, s28, 823296
  buffer_load_dwordx4 a[96:99], v178, s[8:11], s29 offen
  buffer_load_dwordx4 a[100:103], v178, s[8:11], s29 offen offset:1024
  s_add_u32 s29, s28, 825344
  buffer_load_dwordx4 a[104:107], v178, s[8:11], s29 offen
  buffer_load_dwordx4 a[108:111], v178, s[8:11], s29 offen offset:1024
  s_add_u32 s29, s28, 827392
  buffer_load_dwordx4 a[112:115], v178, s[8:11], s29 offen
  buffer_load_dwordx4 a[116:119], v178, s[8:11], s29 offen offset:1024
  s_add_u32 s29, s28, 829440
  buffer_load_dwordx4 a[120:123], v178, s[8:11], s29 offen
  buffer_load_dwordx4 a[124:127], v178, s[8:11], s29 offen offset:1024
  s_add_u32 s29, s28, 831488
  buffer_load_dwordx4 a[128:131], v178, s[8:11], s29 offen
  buffer_load_dwordx4 a[132:135], v178, s[8:11], s29 offen offset:1024
  s_add_u32 s29, s28, 833536
  buffer_load_dwordx4 a[136:139], v178, s[8:11], s29 offen
  buffer_load_dwordx4 a[140:143], v178, s[8:11], s29 offen offset:1024
  s_add_u32 s29, s28, 835584
  buffer_load_dwordx4 a[144:147], v178, s[8:11], s29 offen
  buffer_load_dwordx4 a[148:151], v178, s[8:11], s29 offen offset:1024
  s_add_u32 s29, s28, 837632
  buffer_load_dwordx4 a[152:155], v178, s[8:11], s29 offen
  buffer_load_dwordx4 a[156:159], v178, s[8:11], s29 offen offset:1024
  s_waitcnt vmcnt(30)
  s_add_u32 s29, s28, 1638400
  buffer_load_dwordx4 a[160:163], v178, s[8:11], s29 offen
  buffer_load_dwordx4 a[164:167], v178, s[8:11], s29 offen offset:1024
  s_add_u32 s29, s28, 1640448
  buffer_load_dwordx4 a[168:171], v178, s[8:11], s29 offen
  buffer_load_dwordx4 a[172:175], v178, s[8:11], s29 offen offset:1024
  s_add_u32 s29, s28, 1642496
  buffer_load_dwordx4 a[176:179], v178, s[8:11], s29 offen
  buffer_load_dwordx4 a[180:183], v178, s[8:11], s29 offen offset:1024
  s_add_u32 s29, s28, 1644544
  buffer_load_dwordx4 a[184:187], v178, s[8:11], s29 offen
  buffer_load_dwordx4 a[188:191], v178, s[8:11], s29 offen offset:1024
  s_add_u32 s29, s28, 1646592
  buffer_load_dwordx4 a[192:195], v178, s[8:11], s29 offen
  buffer_load_dwordx4 a[196:199], v178, s[8:11], s29 offen offset:1024
  s_add_u32 s29, s28, 1648640
  buffer_load_dwordx4 a[200:203], v178, s[8:11], s29 offen
  buffer_load_dwordx4 a[204:207], v178, s[8:11], s29 offen offset:1024
  s_add_u32 s29, s28, 1650688
  buffer_load_dwordx4 a[208:211], v178, s[8:11], s29 offen
  buffer_load_dwordx4 a[212:215], v178, s[8:11], s29 offen offset:1024
  s_add_u32 s29, s28, 1652736
  buffer_load_dwordx4 a[216:219], v178, s[8:11], s29 offen
  buffer_load_dwordx4 a[220:223], v178, s[8:11], s29 offen offset:1024
  s_add_u32 s29, s28, 1654784
  buffer_load_dwordx4 a[224:227], v178, s[8:11], s29 offen
  buffer_load_dwordx4 a[228:231], v178, s[8:11], s29 offen offset:1024
  s_add_u32 s29, s28, 1656832
  buffer_load_dwordx4 a[232:235], v178, s[8:11], s29 offen
  buffer_load_dwordx4 a[236:239], v178, s[8:11], s29 offen offset:1024
  s_waitcnt vmcnt(30)
  s_add_u32 s29, s28, 2457600
  buffer_load_dwordx4 a[240:243], v178, s[8:11], s29 offen
  buffer_load_dwordx4 a[244:247], v178, s[8:11], s29 offen offset:1024
  s_add_u32 s29, s28, 2459648
  buffer_load_dwordx4 a[248:251], v178, s[8:11], s29 offen
  buffer_load_dwordx4 a[252:255], v178, s[8:11], s29 offen offset:1024
  s_add_u32 s29, s28, 2461696
  buffer_load_dwordx4 v[192:195], v178, s[8:11], s29 offen
  buffer_load_dwordx4 v[196:199], v178, s[8:11], s29 offen offset:1024
  s_add_u32 s29, s28, 2463744
  buffer_load_dwordx4 v[200:203], v178, s[8:11], s29 offen
  buffer_load_dwordx4 v[204:207], v178, s[8:11], s29 offen offset:1024
  s_add_u32 s29, s28, 2465792
  buffer_load_dwordx4 v[208:211], v178, s[8:11], s29 offen
  buffer_load_dwordx4 v[212:215], v178, s[8:11], s29 offen offset:1024
  s_add_u32 s29, s28, 2467840
  buffer_load_dwordx4 v[216:219], v178, s[8:11], s29 offen
  buffer_load_dwordx4 v[220:223], v178, s[8:11], s29 offen offset:1024
  s_add_u32 s29, s28, 2469888
  buffer_load_dwordx4 v[224:227], v178, s[8:11], s29 offen
  buffer_load_dwordx4 v[228:231], v178, s[8:11], s29 offen offset:1024
  s_add_u32 s29, s28, 2471936
  buffer_load_dwordx4 v[232:235], v178, s[8:11], s29 offen
  buffer_load_dwordx4 v[236:239], v178, s[8:11], s29 offen offset:1024
  s_add_u32 s29, s28, 2473984
  buffer_load_dwordx4 v[240:243], v178, s[8:11], s29 offen
  buffer_load_dwordx4 v[244:247], v178, s[8:11], s29 offen offset:1024
  s_add_u32 s29, s28, 2476032
  buffer_load_dwordx4 v[248:251], v178, s[8:11], s29 offen
  buffer_load_dwordx4 v[252:255], v178, s[8:11], s29 offen offset:1024
  s_waitcnt vmcnt(30)
  v_mov_b32 v172, 0x44444444
  v_mov_b32 v2, 0xeeeeeeee
  v_and_b32 v3, 8, v1
  v_cmp_ne_u32 vcc, 0, v3
  s_nop 1
  v_cndmask_b32 v172, v172, v2, vcc
  s_lshl_b32 s28, s21, 10
  v_add_u32 v173, s28, v178
  v_add_u32 v174, 4096, v173
  v_add_u32 v175, 8192, v173
  v_add_u32 v176, 0, v173
  v_add_u32 v177, 0, v178
  v_add_u32 v179, 10240, v173
  s_xor_b32 s28, s21, 2
  s_lshl_b32 s28, s28, 10
  s_add_u32 s28, s28, 10240
  v_add_u32 v180, s28, v178
  v_and_b32 v4, 15, v1
  v_lshrrev_b32 v5, 4, v1
  v_and_b32 v6, 7, v1
  v_lshlrev_b32 v7, 3, v5
  v_add_u32 v7, v7, v6
  v_lshlrev_b32 v185, 4, v7
  v_add_u32 v182, 4096, v178
  v_mov_b32 v8, 0x40000000
  v_cmp_gt_u32 vcc, 8, v4
  s_nop 1
  v_cndmask_b32 v184, v8, v185, vcc
  v_lshlrev_b32 v7, 4, v4
  v_lshlrev_b32 v9, 2, v5
  v_add_u32 v7, v7, v9
  v_cndmask_b32 v186, v8, v7, vcc
  s_lshl_b32 s28, s20, 5
  s_add_u32 s28, s28, 3072
  v_lshlrev_b32 v7, 2, v6
  v_add_u32 v187, s28, v7
  v_and_b32 v7, 1, v5
  v_lshlrev_b32 v7, 10, v7
  v_lshrrev_b32 v9, 1, v5
  v_lshlrev_b32 v9, 5, v9
  v_add_u32 v9, v9, v4
  v_lshlrev_b32 v9, 4, v9
  v_add_u32 v189, v7, v9
  v_mov_b32 v44, 0
  v_mov_b32 v45, 0
  v_mov_b32 v46, 0
  v_mov_b32 v47, 0
  v_mov_b32 v48, 0
  v_mov_b32 v49, 0
  v_mov_b32 v50, 0
  v_mov_b32 v51, 0
  v_mov_b32 v52, 0
  v_mov_b32 v53, 0
  v_mov_b32 v54, 0
  v_mov_b32 v55, 0
  v_mov_b32 v56, 0
  v_mov_b32 v57, 0
  v_mov_b32 v58, 0
  v_mov_b32 v59, 0
  s_mul_i32 s97, s20, 655360
  s_add_u32 s97, s97, 0x400000
  s_mov_b32 s48, 0x4000
  s_mul_i32 s49, s20, 327680
  s_add_u32 s49, s49, 0x700000
  s_mul_i32 s50, s20, 327680
  s_lshl_b32 s28, s46, 10
  s_add_u32 s50, s50, s28
  s_add_u32 s50, s50, 0x9000000
  s_mov_b32 s51, 0
  s_mov_b32 s52, 0
  s_mov_b32 s53, 0
  v_mov_b32 v2, 5056
  s_mov_b32 s45, 0
kas_y_sel:
  buffer_load_dword v3, v2, s[8:11], 0 offen sc1
  s_add_u32 s45, s45, 1
  s_waitcnt vmcnt(0)
  v_readfirstlane_b32 s61, v3
  s_cmp_lg_u32 s61, 0
  s_cbranch_scc1 kas_y_selok
  s_cmp_lt_u32 s45, 20000
  s_cbranch_scc1 kas_y_sel
kas_y_selok:
  s_and_b32 s61, s61, 2
  s_lshl_b32 s61, s61, 12
  s_add_u32 s29, s20, 0
  s_and_b32 s29, s29, 3
  s_mul_i32 s29, s29, 20
  s_add_u32 s29, s29, s23
  s_lshr_b32 s28, s29, 3
  s_lshl_b32 s28, s28, 14
  s_and_b32 s29, s29, 7
  s_lshl_b32 s29, s29, 10
  s_add_u32 s28, s28, s29
  s_and_b32 s29, s21, 1
  s_lshl_b32 s29, s29, 9
  s_add_u32 s28, s28, s29
  s_add_u32 s28, s28, s61
  s_add_u32 s56, s28, 0xa00000
  s_mov_b32 s66, s56
  s_add_u32 s29, s20, 1
  s_and_b32 s29, s29, 3
  s_mul_i32 s29, s29, 20
  s_add_u32 s29, s29, s23
  s_lshr_b32 s28, s29, 3
  s_lshl_b32 s28, s28, 14
  s_and_b32 s29, s29, 7
  s_lshl_b32 s29, s29, 10
  s_add_u32 s28, s28, s29
  s_and_b32 s29, s21, 1
  s_lshl_b32 s29, s29, 9
  s_add_u32 s28, s28, s29
  s_add_u32 s28, s28, s61
  s_add_u32 s57, s28, 0xa00000
  s_mov_b32 s67, s57
  s_add_u32 s29, s20, 2
  s_and_b32 s29, s29, 3
  s_mul_i32 s29, s29, 20
  s_add_u32 s29, s29, s23
  s_lshr_b32 s28, s29, 3
  s_lshl_b32 s28, s28, 14
  s_and_b32 s29, s29, 7
  s_lshl_b32 s29, s29, 10
  s_add_u32 s28, s28, s29
  s_and_b32 s29, s21, 1
  s_lshl_b32 s29, s29, 9
  s_add_u32 s28, s28, s29
  s_add_u32 s28, s28, s61
  s_add_u32 s58, s28, 0xa00000
  s_mov_b32 s68, s58
  s_add_u32 s29, s20, 3
  s_and_b32 s29, s29, 3
  s_mul_i32 s29, s29, 20
  s_add_u32 s29, s29, s23
  s_lshr_b32 s28, s29, 3
  s_lshl_b32 s28, s28, 14
  s_and_b32 s29, s29, 7
  s_lshl_b32 s29, s29, 10
  s_add_u32 s28, s28, s29
  s_and_b32 s29, s21, 1
  s_lshl_b32 s29, s29, 9
  s_add_u32 s28, s28, s29
  s_add_u32 s28, s28, s61
  s_add_u32 s59, s28, 0xa00000
  s_mov_b32 s69, s59
  v_mov_b32 v124, -1
  v_mov_b32 v125, -1
  v_mov_b32 v126, -1
  v_mov_b32 v127, -1
  s_lshr_b32 s28, s46, 2
  s_lshl_b32 s28, s28, 10
  s_and_b32 s29, s46, 3
  s_lshl_b32 s29, s29, 8
  s_add_u32 s28, s28, s29
  s_add_u32 s60, s28, s97
  s_add_u32 s60, s60, 10240
  s_and_b32 s28, s21, 1
  s_lshl_b32 s28, s28, 10
  s_add_u32 s28, s28, 32768
  v_add_u32 v181, s28, v178
  v_add_u32 v183, 65536, v178
  s_waitcnt vmcnt(0)
  s_cmp_ge_u32 s21, 2
  s_cbranch_scc1 kas_y_tok
kas_y_crit:
  s_mov_b32 s45, 0
kas_y_pf_99:
  buffer_load_dwordx4 v[160:163], v173, s[8:11], s48 offen sc1
  buffer_load_dwordx4 v[164:167], v174, s[8:11], s48 offen sc1
  buffer_load_dwordx4 v[168:171], v175, s[8:11], s48 offen sc1
  s_add_u32 s45, s45, 1
  s_waitcnt vmcnt(2)
  ds_write_b128 v176, v[160:163] offset:0
  v_max3_u32 v190, v160, v161, v162
  v_max_u32 v190, v190, v163
  s_waitcnt vmcnt(1)
  ds_write_b128 v176, v[164:167] offset:4096
  v_max3_u32 v190, v190, v164, v165
  v_max3_u32 v190, v190, v166, v167
  s_waitcnt vmcnt(0)
  ds_write_b128 v176, v[168:171] offset:8192
  v_max3_u32 v190, v190, v168, v169
  v_max3_u32 v190, v190, v170, v171
  v_cmp_eq_u32 vcc, -1, v190
  s_cbranch_vccz kas_y_pf_99_ok
  s_cmp_lt_u32 s45, 400000
  s_cbranch_scc1 kas_y_pf_99
  s_branch kas_abort
kas_y_pf_99_ok:
  s_waitcnt lgkmcnt(0)
  s_barrier
  ds_read_b128 v[4:7], v177 offset:0
  ds_read_b128 v[8:11], v177 offset:1024
  ds_read_b128 v[12:15], v177 offset:2048
  ds_read_b128 v[16:19], v177 offset:3072
  ds_read_b128 v[20:23], v177 offset:4096
  ds_read_b128 v[24:27], v177 offset:5120
  ds_read_b128 v[28:31], v177 offset:6144
  ds_read_b128 v[32:35], v177 offset:7168
  ds_read_b128 v[36:39], v177 offset:8192
  ds_read_b128 v[40:43], v177 offset:9216
  s_cmp_lt_u32 s51, 2
  s_cbranch_scc1 kas_y_norst
  s_sub_u32 s28, s51, 2
  s_and_b32 s28, s28, 3
  s_mul_i32 s28, s28, 163840
  s_add_u32 s28, s28, s56
  buffer_store_dwordx4 v[124:127], v184, s[8:11], s28 offen sc1
kas_y_norst:
  s_waitcnt lgkmcnt(9)
  v_smfmac_f32_16x16x64_bf16 v[44:47], v[4:7], a[0:7], v172
  v_smfmac_f32_16x16x64_bf16 v[48:51], v[4:7], a[80:87], v172
  v_smfmac_f32_16x16x64_bf16 v[52:55], v[4:7], a[160:167], v172
  v_smfmac_f32_16x16x64_bf16 v[56:59], v[4:7], a[240:247], v172
  s_waitcnt lgkmcnt(8)
  v_smfmac_f32_16x16x64_bf16 v[44:47], v[8:11], a[8:15], v172
  v_smfmac_f32_16x16x64_bf16 v[48:51], v[8:11], a[88:95], v172
  v_smfmac_f32_16x16x64_bf16 v[52:55], v[8:11], a[168:175], v172
  v_smfmac_f32_16x16x64_bf16 v[56:59], v[8:11], a[248:255], v172
  s_waitcnt lgkmcnt(7)
  v_smfmac_f32_16x16x64_bf16 v[44:47], v[12:15], a[16:23], v172
  v_smfmac_f32_16x16x64_bf16 v[48:51], v[12:15], a[96:103], v172
  v_smfmac_f32_16x16x64_bf16 v[52:55], v[12:15], a[176:183], v172
  v_smfmac_f32_16x16x64_bf16 v[56:59], v[12:15], v[192:199], v172
  s_waitcnt lgkmcnt(6)
  v_smfmac_f32_16x16x64_bf16 v[44:47], v[16:19], a[24:31], v172
  v_smfmac_f32_16x16x64_bf16 v[48:51], v[16:19], a[104:111], v172
  v_smfmac_f32_16x16x64_bf16 v[52:55], v[16:19], a[184:191], v172
  v_smfmac_f32_16x16x64_bf16 v[56:59], v[16:19], v[200:207], v172
  s_waitcnt lgkmcnt(5)
  v_smfmac_f32_16x16x64_bf16 v[44:47], v[20:23], a[32:39], v172
  v_smfmac_f32_16x16x64_bf16 v[48:51], v[20:23], a[112:119], v172
  v_smfmac_f32_16x16x64_bf16 v[52:55], v[20:23], a[192:199], v172
  v_smfmac_f32_16x16x64_bf16 v[56:59], v[20:23], v[208:215], v172
  s_waitcnt lgkmcnt(4)
  v_smfmac_f32_16x16x64_bf16 v[44:47], v[24:27], a[40:47], v172
  v_smfmac_f32_16x16x64_bf16 v[48:51], v[24:27], a[120:127], v172
  v_smfmac_f32_16x16x64_bf16 v[52:55], v[24:27], a[200:207], v172
  v_smfmac_f32_16x16x64_bf16 v[56:59], v[24:27], v[216:223], v172
  s_waitcnt lgkmcnt(3)
  v_smfmac_f32_16x16x64_bf16 v[44:47], v[28:31], a[48:55], v172
  v_smfmac_f32_16x16x64_bf16 v[48:51], v[28:31], a[128:135], v172
  v_smfmac_f32_16x16x64_bf16 v[52:55], v[28:31], a[208:215], v172
  v_smfmac_f32_16x16x64_bf16 v[56:59], v[28:31], v[224:231], v172
  s_waitcnt lgkmcnt(2)
  v_smfmac_f32_16x16x64_bf16 v[44:47], v[32:35], a[56:63], v172
  v_smfmac_f32_16x16x64_bf16 v[48:51], v[32:35], a[136:143], v172
  v_smfmac_f32_16x16x64_bf16 v[52:55], v[32:35], a[216:223], v172
  v_smfmac_f32_16x16x64_bf16 v[56:59], v[32:35], v[232:239], v172
  s_waitcnt lgkmcnt(1)
  v_smfmac_f32_16x16x64_bf16 v[44:47], v[36:39], a[64:71], v172
  v_smfmac_f32_16x16x64_bf16 v[48:51], v[36:39], a[144:151], v172
  v_smfmac_f32_16x16x64_bf16 v[52:55], v[36:39], a[224:231], v172
  v_smfmac_f32_16x16x64_bf16 v[56:59], v[36:39], v[240:247], v172
  s_waitcnt lgkmcnt(0)
  v_smfmac_f32_16x16x64_bf16 v[44:47], v[40:43], a[72:79], v172
  v_smfmac_f32_16x16x64_bf16 v[48:51], v[40:43], a[152:159], v172
  v_smfmac_f32_16x16x64_bf16 v[52:55], v[40:43], a[232:239], v172
  v_smfmac_f32_16x16x64_bf16 v[56:59], v[40:43], v[248:255], v172
  s_nop 9
  v_permlane32_swap_b32 v44, v48
  v_permlane32_swap_b32 v45, v49
  v_permlane32_swap_b32 v46, v50
  v_permlane32_swap_b32 v47, v51
  v_permlane32_swap_b32 v52, v56
  v_permlane32_swap_b32 v53, v57
  v_permlane32_swap_b32 v54, v58
  v_permlane32_swap_b32 v55, v59
  v_add_f32 v44, v44, v48
  v_add_f32 v45, v45, v49
  v_add_f32 v46, v46, v50
  v_add_f32 v47, v47, v51
  v_add_f32 v52, v52, v56
  v_add_f32 v53, v53, v57
  v_add_f32 v54, v54, v58
  v_add_f32 v55, v55, v59
  v_cvt_pk_bf16_f32 v60, v44, v45
  v_cvt_pk_bf16_f32 v61, v46, v47
  v_cvt_pk_bf16_f32 v62, v52, v53
  v_cvt_pk_bf16_f32 v63, v54, v55
  ds_write_b128 v179, v[60:63]
  v_mov_b32 v44, 0
  v_mov_b32 v45, 0
  v_mov_b32 v46, 0
  v_mov_b32 v47, 0
  v_mov_b32 v48, 0
  v_mov_b32 v49, 0
  v_mov_b32 v50, 0
  v_mov_b32 v51, 0
  v_mov_b32 v52, 0
  v_mov_b32 v53, 0
  v_mov_b32 v54, 0
  v_mov_b32 v55, 0
  v_mov_b32 v56, 0
  v_mov_b32 v57, 0
  v_mov_b32 v58, 0
  v_mov_b32 v59, 0
  s_waitcnt lgkmcnt(0)
  s_barrier
  s_cmp_ge_u32 s51, 63
  s_cbranch_scc1 kas_y_crit_end
  ds_read_b128 v[64:67], v180
  ds_read_b128 v[68:71], v181 offset:0
  ds_read_b128 v[72:75], v181 offset:2048
  ds_read_b128 v[76:79], v181 offset:4096
  ds_read_b128 v[80:83], v181 offset:6144
  ds_read_b128 v[84:87], v181 offset:8192
  ds_read_b128 v[88:91], v181 offset:10240
  ds_read_b128 v[92:95], v181 offset:12288
  ds_read_b128 v[96:99], v181 offset:14336
  v_xor_b32 v181, 0x4000, v181
  s_mov_b32 s45, 0
yp_100:
  buffer_load_dwordx4 v[100:103], v178, s[8:11], s49 offen offset:0 sc1
  buffer_load_dwordx4 v[104:107], v178, s[8:11], s49 offen offset:1024 sc1
  buffer_load_dwordx4 v[108:111], v178, s[8:11], s49 offen offset:2048 sc1
  buffer_load_dwordx4 v[112:115], v178, s[8:11], s49 offen offset:3072 sc1
  buffer_load_dwordx4 v[116:119], v182, s[8:11], s49 offen sc1
  s_add_u32 s45, s45, 1
  s_waitcnt vmcnt(4) lgkmcnt(0)
  v_mfma_f32_16x16x32_bf16 v[140:143], v[68:71], v[100:103], 0
  v_max_u32 v190, v100, v102
  v_mfma_f32_16x16x32_bf16 v[144:147], v[72:75], v[100:103], 0
  s_waitcnt vmcnt(3)
  v_mfma_f32_16x16x32_bf16 v[140:143], v[76:79], v[104:107], v[140:143]
  v_max3_u32 v190, v190, v104, v106
  v_mfma_f32_16x16x32_bf16 v[144:147], v[80:83], v[104:107], v[144:147]
  s_waitcnt vmcnt(2)
  v_mfma_f32_16x16x32_bf16 v[140:143], v[84:87], v[108:111], v[140:143]
  v_max3_u32 v190, v190, v108, v110
  v_mfma_f32_16x16x32_bf16 v[144:147], v[88:91], v[108:111], v[144:147]
  s_waitcnt vmcnt(1)
  v_mfma_f32_16x16x32_bf16 v[140:143], v[92:95], v[112:115], v[140:143]
  v_max3_u32 v190, v190, v112, v114
  v_mfma_f32_16x16x32_bf16 v[144:147], v[96:99], v[112:115], v[144:147]
  s_waitcnt vmcnt(0)
  v_mfma_f32_16x16x32_bf16 v[140:143], v[60:63], v[116:119], v[140:143]
  v_max3_u32 v190, v190, v116, v117
  v_mfma_f32_16x16x32_bf16 v[144:147], v[64:67], v[116:119], v[144:147]
  v_max3_u32 v190, v190, v118, v119
  v_cmp_eq_u32 vcc, -1, v190
  s_cbranch_vccz yp_100_ok
  s_cmp_lt_u32 s45, 400000
  s_cbranch_scc1 yp_100
  s_branch kas_abort
yp_100_ok:
  buffer_load_dwordx4 v[148:151], v185, s[8:11], s67 offen sc1
  buffer_load_dwordx4 v[152:155], v185, s[8:11], s68 offen sc1
  buffer_load_dwordx4 v[156:159], v185, s[8:11], s69 offen sc1
  s_nop 1
  v_add_f32_dpp v140, v144, v140 row_ror:8 row_mask:0xf bank_mask:0xf
  v_add_f32_dpp v141, v145, v141 row_ror:8 row_mask:0xf bank_mask:0xf
  v_add_f32_dpp v142, v146, v142 row_ror:8 row_mask:0xf bank_mask:0xf
  v_add_f32_dpp v143, v147, v143 row_ror:8 row_mask:0xf bank_mask:0xf
  buffer_store_dwordx4 v[140:143], v184, s[8:11], s66 offen sc1
  s_mov_b32 s45, 0
  s_waitcnt vmcnt(1)
  s_branch yc_101_chk
yc_101:
  buffer_load_dwordx4 v[148:151], v185, s[8:11], s67 offen sc1
  buffer_load_dwordx4 v[152:155], v185, s[8:11], s68 offen sc1
  buffer_load_dwordx4 v[156:159], v185, s[8:11], s69 offen sc1
  s_add_u32 s45, s45, 1
  s_waitcnt vmcnt(0)
yc_101_chk:
  v_max3_u32 v190, v148, v151, v152
  v_max3_u32 v190, v190, v155, v156
  v_max_u32 v190, v190, v159
  v_add_f32 v160, v140, v148
  v_add_f32 v161, v141, v149
  v_add_f32 v162, v142, v150
  v_add_f32 v163, v143, v151
  v_cmp_eq_u32 vcc, -1, v190
  v_add_f32 v152, v152, v156
  v_add_f32 v153, v153, v157
  v_add_f32 v154, v154, v158
  v_add_f32 v155, v155, v159
  s_cbranch_vccz yc_101_ok
  s_cmp_lt_u32 s45, 400000
  s_cbranch_scc1 yc_101
  s_branch kas_abort
yc_101_ok:
  v_add_f32 v160, v160, v152
  v_add_f32 v161, v161, v153
  v_add_f32 v162, v162, v154
  v_add_f32 v163, v163, v155
  v_cvt_pk_bf16_f32 v164, v160, v161
  v_cvt_pk_bf16_f32 v165, v162, v163
  buffer_store_dword v164, v186, s[8:11], s60 offen sc1
  buffer_store_dword v165, v186, s[8:11], s60 offen offset:128 sc1
  s_add_u32 s97, s97, 10240
  s_mov_b32 s48, s97
  s_add_u32 s60, s60, 10240
  s_add_u32 s49, s49, 5120
  s_add_u32 s28, s51, 1
  s_and_b32 s28, s28, 3
  s_mul_i32 s28, s28, 163840
  s_add_u32 s66, s56, s28
  s_add_u32 s67, s57, s28
  s_add_u32 s68, s58, s28
  s_add_u32 s69, s59, s28
  s_add_u32 s51, s51, 1
  s_branch kas_y_crit
kas_y_crit_end:
  s_waitcnt vmcnt(0) lgkmcnt(0)
  s_branch kas_exit
kas_y_tok:
  s_mul_i32 s61, s20, 1310720
  s_add_u32 s61, s61, 0xe00000
  s_mul_i32 s62, s20, 5242880
  s_lshl_b32 s28, s46, 11
  s_add_u32 s62, s62, s28
  s_add_u32 s62, s62, 0x1a00000
  s_mov_b32 s54, 0
  s_and_b32 s63, s21, 1
  s_lshl_b32 s63, s63, 10
  s_add_u32 s63, s63, 32768
  s_and_b32 s64, s21, 1
  s_mul_i32 s64, s64, 10240
kas_y_tokl:
  s_mov_b32 s45, 0
kas_y_pf_102:
  buffer_load_dwordx4 v[160:163], v173, s[8:11], s48 offen sc1
  buffer_load_dwordx4 v[164:167], v174, s[8:11], s48 offen sc1
  s_add_u32 s45, s45, 1
  s_waitcnt vmcnt(1)
  ds_write_b128 v176, v[160:163] offset:0
  v_max3_u32 v190, v160, v161, v162
  v_max_u32 v190, v190, v163
  s_waitcnt vmcnt(0)
  ds_write_b128 v176, v[164:167] offset:4096
  v_max3_u32 v190, v190, v164, v165
  v_max3_u32 v190, v190, v166, v167
  v_cmp_eq_u32 vcc, -1, v190
  s_cbranch_vccz kas_y_pf_102_ok
  s_cmp_lt_u32 s45, 400000
  s_cbranch_scc1 kas_y_pf_102
  s_branch kas_abort
kas_y_pf_102_ok:
  s_waitcnt lgkmcnt(0)
  s_barrier
  ds_read_b128 v[4:7], v177 offset:0
  ds_read_b128 v[8:11], v177 offset:1024
  ds_read_b128 v[12:15], v177 offset:2048
  ds_read_b128 v[16:19], v177 offset:3072
  ds_read_b128 v[20:23], v177 offset:4096
  ds_read_b128 v[24:27], v177 offset:5120
  ds_read_b128 v[28:31], v177 offset:6144
  ds_read_b128 v[32:35], v177 offset:7168
  ds_read_b128 v[36:39], v177 offset:8192
  ds_read_b128 v[40:43], v177 offset:9216
  s_cmp_gt_u32 s52, s51
  s_cbranch_scc1 kas_y_wp_103_ok
  s_mov_b32 s45, 0
kas_y_wp_103_spin:
  buffer_load_dword v2, v187, s[8:11], 0 offen sc1
  s_add_u32 s45, s45, 1
  s_waitcnt vmcnt(0)
  v_min_u32_dpp v3, v2, v2 quad_perm:[1,0,3,2] row_mask:0xf bank_mask:0xf
  s_nop 1
  v_min_u32_dpp v2, v3, v3 quad_perm:[2,3,0,1] row_mask:0xf bank_mask:0xf
  s_nop 1
  v_min_u32_dpp v3, v2, v2 row_half_mirror row_mask:0xf bank_mask:0xf
  s_nop 1
  v_min_u32_dpp v2, v3, v3 quad_perm:[0,1,2,3] row_mask:0xf bank_mask:0xf
  s_nop 0
  v_readfirstlane_b32 s52, v2
  s_cmp_gt_u32 s52, s51
  s_cbranch_scc1 kas_y_wp_103_ok
  s_cmp_lt_u32 s45, 400000
  s_cbranch_scc1 kas_y_wp_103_spin
  s_branch kas_abort
kas_y_wp_103_ok:
  s_add_u32 s65, s61, s64
  s_waitcnt lgkmcnt(9)
  v_smfmac_f32_16x16x64_bf16 v[44:47], v[4:7], a[0:7], v172
  s_add_u32 m0, s63, 0
  s_add_u32 s28, s50, 0
  buffer_load_dwordx4 v178, s[8:11], s28 offen sc1 lds
  v_smfmac_f32_16x16x64_bf16 v[48:51], v[4:7], a[80:87], v172
  v_smfmac_f32_16x16x64_bf16 v[52:55], v[4:7], a[160:167], v172
  s_add_u32 m0, s63, 2048
  s_add_u32 s28, s50, 40960
  buffer_load_dwordx4 v178, s[8:11], s28 offen sc1 lds
  v_smfmac_f32_16x16x64_bf16 v[56:59], v[4:7], a[240:247], v172
  s_waitcnt lgkmcnt(8)
  v_smfmac_f32_16x16x64_bf16 v[44:47], v[8:11], a[8:15], v172
  s_add_u32 m0, s63, 4096
  s_add_u32 s28, s50, 81920
  buffer_load_dwordx4 v178, s[8:11], s28 offen sc1 lds
  v_smfmac_f32_16x16x64_bf16 v[48:51], v[8:11], a[88:95], v172
  v_smfmac_f32_16x16x64_bf16 v[52:55], v[8:11], a[168:175], v172
  s_add_u32 m0, s63, 6144
  s_add_u32 s28, s50, 122880
  buffer_load_dwordx4 v178, s[8:11], s28 offen sc1 lds
  v_smfmac_f32_16x16x64_bf16 v[56:59], v[8:11], a[248:255], v172
  s_waitcnt lgkmcnt(7)
  v_smfmac_f32_16x16x64_bf16 v[44:47], v[12:15], a[16:23], v172
  s_add_u32 m0, s63, 8192
  s_add_u32 s28, s50, 163840
  buffer_load_dwordx4 v178, s[8:11], s28 offen sc1 lds
  v_smfmac_f32_16x16x64_bf16 v[48:51], v[12:15], a[96:103], v172
  v_smfmac_f32_16x16x64_bf16 v[52:55], v[12:15], a[176:183], v172
  s_add_u32 m0, s63, 10240
  s_add_u32 s28, s50, 204800
  buffer_load_dwordx4 v178, s[8:11], s28 offen sc1 lds
  v_smfmac_f32_16x16x64_bf16 v[56:59], v[12:15], v[192:199], v172
  s_waitcnt lgkmcnt(6)
  v_smfmac_f32_16x16x64_bf16 v[44:47], v[16:19], a[24:31], v172
  s_add_u32 m0, s63, 12288
  s_add_u32 s28, s50, 245760
  buffer_load_dwordx4 v178, s[8:11], s28 offen sc1 lds
  v_smfmac_f32_16x16x64_bf16 v[48:51], v[16:19], a[104:111], v172
  v_smfmac_f32_16x16x64_bf16 v[52:55], v[16:19], a[184:191], v172
  s_add_u32 m0, s63, 14336
  s_add_u32 s28, s50, 286720
  buffer_load_dwordx4 v178, s[8:11], s28 offen sc1 lds
  v_smfmac_f32_16x16x64_bf16 v[56:59], v[16:19], v[200:207], v172
  s_waitcnt lgkmcnt(5)
  v_smfmac_f32_16x16x64_bf16 v[44:47], v[20:23], a[32:39], v172
  s_add_u32 m0, s64, 65536
  s_add_u32 s28, s65, 0
  buffer_load_dwordx4 v178, s[8:11], s28 offen sc1 lds
  v_smfmac_f32_16x16x64_bf16 v[48:51], v[20:23], a[112:119], v172
  v_smfmac_f32_16x16x64_bf16 v[52:55], v[20:23], a[192:199], v172
  s_add_u32 m0, s64, 66560
  s_add_u32 s28, s65, 1024
  buffer_load_dwordx4 v178, s[8:11], s28 offen sc1 lds
  v_smfmac_f32_16x16x64_bf16 v[56:59], v[20:23], v[208:215], v172
  s_waitcnt lgkmcnt(4)
  v_smfmac_f32_16x16x64_bf16 v[44:47], v[24:27], a[40:47], v172
  s_add_u32 m0, s64, 67584
  s_add_u32 s28, s65, 2048
  buffer_load_dwordx4 v178, s[8:11], s28 offen sc1 lds
  v_smfmac_f32_16x16x64_bf16 v[48:51], v[24:27], a[120:127], v172
  v_smfmac_f32_16x16x64_bf16 v[52:55], v[24:27], a[200:207], v172
  s_add_u32 m0, s64, 68608
  s_add_u32 s28, s65, 3072
  buffer_load_dwordx4 v178, s[8:11], s28 offen sc1 lds
  v_smfmac_f32_16x16x64_bf16 v[56:59], v[24:27], v[216:223], v172
  s_waitcnt lgkmcnt(3)
  v_smfmac_f32_16x16x64_bf16 v[44:47], v[28:31], a[48:55], v172
  s_add_u32 m0, s64, 69632
  s_add_u32 s28, s65, 4096
  buffer_load_dwordx4 v178, s[8:11], s28 offen sc1 lds
  v_smfmac_f32_16x16x64_bf16 v[48:51], v[28:31], a[128:135], v172
  v_smfmac_f32_16x16x64_bf16 v[52:55], v[28:31], a[208:215], v172
  s_add_u32 m0, s64, 70656
  s_add_u32 s28, s65, 5120
  buffer_load_dwordx4 v178, s[8:11], s28 offen sc1 lds
  v_smfmac_f32_16x16x64_bf16 v[56:59], v[28:31], v[224:231], v172
  s_waitcnt lgkmcnt(2)
  v_smfmac_f32_16x16x64_bf16 v[44:47], v[32:35], a[56:63], v172
  s_add_u32 m0, s64, 71680
  s_add_u32 s28, s65, 6144
  buffer_load_dwordx4 v178, s[8:11], s28 offen sc1 lds
  v_smfmac_f32_16x16x64_bf16 v[48:51], v[32:35], a[136:143], v172
  v_smfmac_f32_16x16x64_bf16 v[52:55], v[32:35], a[216:223], v172
  s_add_u32 m0, s64, 72704
  s_add_u32 s28, s65, 7168
  buffer_load_dwordx4 v178, s[8:11], s28 offen sc1 lds
  v_smfmac_f32_16x16x64_bf16 v[56:59], v[32:35], v[232:239], v172
  s_waitcnt lgkmcnt(1)
  v_smfmac_f32_16x16x64_bf16 v[44:47], v[36:39], a[64:71], v172
  s_add_u32 m0, s64, 73728
  s_add_u32 s28, s65, 8192
  buffer_load_dwordx4 v178, s[8:11], s28 offen sc1 lds
  v_smfmac_f32_16x16x64_bf16 v[48:51], v[36:39], a[144:151], v172
  v_smfmac_f32_16x16x64_bf16 v[52:55], v[36:39], a[224:231], v172
  s_add_u32 m0, s64, 74752
  s_add_u32 s28, s65, 9216
  buffer_load_dwordx4 v178, s[8:11], s28 offen sc1 lds
  v_smfmac_f32_16x16x64_bf16 v[56:59], v[36:39], v[240:247], v172
  s_waitcnt lgkmcnt(0)
  v_smfmac_f32_16x16x64_bf16 v[44:47], v[40:43], a[72:79], v172
  v_smfmac_f32_16x16x64_bf16 v[48:51], v[40:43], a[152:159], v172
  v_smfmac_f32_16x16x64_bf16 v[52:55], v[40:43], a[232:239], v172
  v_smfmac_f32_16x16x64_bf16 v[56:59], v[40:43], v[248:255], v172
  s_xor_b32 s63, s63, 0x4000
  s_add_u32 s50, s50, 1310720
  s_nop 9
  v_permlane32_swap_b32 v44, v48
  v_permlane32_swap_b32 v45, v49
  v_permlane32_swap_b32 v46, v50
  v_permlane32_swap_b32 v47, v51
  v_permlane32_swap_b32 v52, v56
  v_permlane32_swap_b32 v53, v57
  v_permlane32_swap_b32 v54, v58
  v_permlane32_swap_b32 v55, v59
  v_add_f32 v44, v44, v48
  v_add_f32 v45, v45, v49
  v_add_f32 v46, v46, v50
  v_add_f32 v47, v47, v51
  v_add_f32 v52, v52, v56
  v_add_f32 v53, v53, v57
  v_add_f32 v54, v54, v58
  v_add_f32 v55, v55, v59
  v_cvt_pk_bf16_f32 v64, v44, v45
  v_cvt_pk_bf16_f32 v65, v46, v47
  v_cvt_pk_bf16_f32 v66, v52, v53
  v_cvt_pk_bf16_f32 v67, v54, v55
  ds_write_b128 v179, v[64:67]
  v_mov_b32 v44, 0
  v_mov_b32 v45, 0
  v_mov_b32 v46, 0
  v_mov_b32 v47, 0
  v_mov_b32 v48, 0
  v_mov_b32 v49, 0
  v_mov_b32 v50, 0
  v_mov_b32 v51, 0
  v_mov_b32 v52, 0
  v_mov_b32 v53, 0
  v_mov_b32 v54, 0
  v_mov_b32 v55, 0
  v_mov_b32 v56, 0
  v_mov_b32 v57, 0
  v_mov_b32 v58, 0
  v_mov_b32 v59, 0
  s_waitcnt vmcnt(0) lgkmcnt(0)
  s_barrier
  ds_read_b128 v[60:63], v180
  s_cmp_eq_u32 s51, 0
  s_cbranch_scc1 yt_104
  ds_read_b128 v[68:71], v181 offset:0
  ds_read_b128 v[72:75], v181 offset:2048
  ds_read_b128 v[76:79], v181 offset:4096
  ds_read_b128 v[80:83], v181 offset:6144
  ds_read_b128 v[84:87], v181 offset:8192
  ds_read_b128 v[88:91], v181 offset:10240
  ds_read_b128 v[92:95], v181 offset:12288
  ds_read_b128 v[96:99], v181 offset:14336
  s_mov_b32 s45, 0
ytp_105:
  s_waitcnt lgkmcnt(0)
  ds_read_b128 v[100:103], v183 offset:0
  ds_read_b128 v[104:107], v183 offset:2048
  ds_read_b128 v[108:111], v183 offset:4096
  ds_read_b128 v[112:115], v183 offset:6144
  ds_read_b128 v[116:119], v183 offset:8192
  ds_read_b128 v[120:123], v183 offset:10240
  ds_read_b128 v[124:127], v183 offset:12288
  ds_read_b128 v[128:131], v183 offset:14336
  ds_read_b128 v[132:135], v183 offset:16384
  ds_read_b128 v[136:139], v183 offset:18432
  s_waitcnt lgkmcnt(0)
  v_max_u32 v190, v100, v102
  v_max3_u32 v190, v190, v104, v106
  v_max3_u32 v190, v190, v108, v110
  v_max3_u32 v190, v190, v112, v114
  v_max3_u32 v190, v190, v116, v118
  v_max3_u32 v190, v190, v120, v122
  v_max3_u32 v190, v190, v124, v126
  v_max3_u32 v190, v190, v128, v130
  v_max3_u32 v190, v190, v132, v134
  v_max3_u32 v190, v190, v136, v138
  v_cmp_eq_u32 vcc, -1, v190
  s_cbranch_vccz ytp_105_ok
  s_add_u32 s45, s45, 1
  s_cmp_lt_u32 s45, 400000
  s_cbranch_scc0 kas_abort
ytp_105_dma:
  s_mov_b32 m0, 65536
  s_add_u32 s28, s61, 0
  buffer_load_dwordx4 v178, s[8:11], s28 offen sc1 lds
  s_mov_b32 m0, 66560
  s_add_u32 s28, s61, 1024
  buffer_load_dwordx4 v178, s[8:11], s28 offen sc1 lds
  s_mov_b32 m0, 67584
  s_add_u32 s28, s61, 2048
  buffer_load_dwordx4 v178, s[8:11], s28 offen sc1 lds
  s_mov_b32 m0, 68608
  s_add_u32 s28, s61, 3072
  buffer_load_dwordx4 v178, s[8:11], s28 offen sc1 lds
  s_mov_b32 m0, 69632
  s_add_u32 s28, s61, 4096
  buffer_load_dwordx4 v178, s[8:11], s28 offen sc1 lds
  s_mov_b32 m0, 70656
  s_add_u32 s28, s61, 5120
  buffer_load_dwordx4 v178, s[8:11], s28 offen sc1 lds
  s_mov_b32 m0, 71680
  s_add_u32 s28, s61, 6144
  buffer_load_dwordx4 v178, s[8:11], s28 offen sc1 lds
  s_mov_b32 m0, 72704
  s_add_u32 s28, s61, 7168
  buffer_load_dwordx4 v178, s[8:11], s28 offen sc1 lds
  s_mov_b32 m0, 73728
  s_add_u32 s28, s61, 8192
  buffer_load_dwordx4 v178, s[8:11], s28 offen sc1 lds
  s_mov_b32 m0, 74752
  s_add_u32 s28, s61, 9216
  buffer_load_dwordx4 v178, s[8:11], s28 offen sc1 lds
  s_mov_b32 m0, 75776
  s_add_u32 s28, s61, 10240
  buffer_load_dwordx4 v178, s[8:11], s28 offen sc1 lds
  s_mov_b32 m0, 76800
  s_add_u32 s28, s61, 11264
  buffer_load_dwordx4 v178, s[8:11], s28 offen sc1 lds
  s_mov_b32 m0, 77824
  s_add_u32 s28, s61, 12288
  buffer_load_dwordx4 v178, s[8:11], s28 offen sc1 lds
  s_mov_b32 m0, 78848
  s_add_u32 s28, s61, 13312
  buffer_load_dwordx4 v178, s[8:11], s28 offen sc1 lds
  s_mov_b32 m0, 79872
  s_add_u32 s28, s61, 14336
  buffer_load_dwordx4 v178, s[8:11], s28 offen sc1 lds
  s_mov_b32 m0, 80896
  s_add_u32 s28, s61, 15360
  buffer_load_dwordx4 v178, s[8:11], s28 offen sc1 lds
  s_mov_b32 m0, 81920
  s_add_u32 s28, s61, 16384
  buffer_load_dwordx4 v178, s[8:11], s28 offen sc1 lds
  s_mov_b32 m0, 82944
  s_add_u32 s28, s61, 17408
  buffer_load_dwordx4 v178, s[8:11], s28 offen sc1 lds
  s_mov_b32 m0, 83968
  s_add_u32 s28, s61, 18432
  buffer_load_dwordx4 v178, s[8:11], s28 offen sc1 lds
  s_mov_b32 m0, 84992
  s_add_u32 s28, s61, 19456
  buffer_load_dwordx4 v178, s[8:11], s28 offen sc1 lds
  s_waitcnt vmcnt(0)
  s_branch ytp_105
ytp_105_ok:
  v_mfma_f32_16x16x32_bf16 v[140:143], v[68:71], v[100:103], 0
  v_mfma_f32_16x16x32_bf16 v[140:143], v[72:75], v[104:107], v[140:143]
  v_mfma_f32_16x16x32_bf16 v[140:143], v[76:79], v[108:111], v[140:143]
  v_mfma_f32_16x16x32_bf16 v[140:143], v[80:83], v[112:115], v[140:143]
  v_mfma_f32_16x16x32_bf16 v[140:143], v[84:87], v[116:119], v[140:143]
  v_mfma_f32_16x16x32_bf16 v[140:143], v[88:91], v[120:123], v[140:143]
  v_mfma_f32_16x16x32_bf16 v[140:143], v[92:95], v[124:127], v[140:143]
  v_mfma_f32_16x16x32_bf16 v[140:143], v[96:99], v[128:131], v[140:143]
  v_mfma_f32_16x16x32_bf16 v[140:143], v[148:151], v[132:135], v[140:143]
  v_mfma_f32_16x16x32_bf16 v[140:143], v[152:155], v[136:139], v[140:143]
  s_nop 8
  s_add_u32 s28, s62, 0
  buffer_store_dwordx4 v[140:143], v189, s[8:11], s28 offen
  s_nop 1
  s_mov_b32 s45, 0
ytp_106:
  s_waitcnt lgkmcnt(0)
  ds_read_b128 v[100:103], v183 offset:1024
  ds_read_b128 v[104:107], v183 offset:3072
  ds_read_b128 v[108:111], v183 offset:5120
  ds_read_b128 v[112:115], v183 offset:7168
  ds_read_b128 v[116:119], v183 offset:9216
  ds_read_b128 v[120:123], v183 offset:11264
  ds_read_b128 v[124:127], v183 offset:13312
  ds_read_b128 v[128:131], v183 offset:15360
  ds_read_b128 v[132:135], v183 offset:17408
  ds_read_b128 v[136:139], v183 offset:19456
  s_waitcnt lgkmcnt(0)
  v_max_u32 v190, v100, v102
  v_max3_u32 v190, v190, v104, v106
  v_max3_u32 v190, v190, v108, v110
  v_max3_u32 v190, v190, v112, v114
  v_max3_u32 v190, v190, v116, v118
  v_max3_u32 v190, v190, v120, v122
  v_max3_u32 v190, v190, v124, v126
  v_max3_u32 v190, v190, v128, v130
  v_max3_u32 v190, v190, v132, v134
  v_max3_u32 v190, v190, v136, v138
  v_cmp_eq_u32 vcc, -1, v190
  s_cbranch_vccz ytp_106_ok
  s_add_u32 s45, s45, 1
  s_cmp_lt_u32 s45, 400000
  s_cbranch_scc0 kas_abort
ytp_106_dma:
  s_mov_b32 m0, 65536
  s_add_u32 s28, s61, 0
  buffer_load_dwordx4 v178, s[8:11], s28 offen sc1 lds
  s_mov_b32 m0, 66560
  s_add_u32 s28, s61, 1024
  buffer_load_dwordx4 v178, s[8:11], s28 offen sc1 lds
  s_mov_b32 m0, 67584
  s_add_u32 s28, s61, 2048
  buffer_load_dwordx4 v178, s[8:11], s28 offen sc1 lds
  s_mov_b32 m0, 68608
  s_add_u32 s28, s61, 3072
  buffer_load_dwordx4 v178, s[8:11], s28 offen sc1 lds
  s_mov_b32 m0, 69632
  s_add_u32 s28, s61, 4096
  buffer_load_dwordx4 v178, s[8:11], s28 offen sc1 lds
  s_mov_b32 m0, 70656
  s_add_u32 s28, s61, 5120
  buffer_load_dwordx4 v178, s[8:11], s28 offen sc1 lds
  s_mov_b32 m0, 71680
  s_add_u32 s28, s61, 6144
  buffer_load_dwordx4 v178, s[8:11], s28 offen sc1 lds
  s_mov_b32 m0, 72704
  s_add_u32 s28, s61, 7168
  buffer_load_dwordx4 v178, s[8:11], s28 offen sc1 lds
  s_mov_b32 m0, 73728
  s_add_u32 s28, s61, 8192
  buffer_load_dwordx4 v178, s[8:11], s28 offen sc1 lds
  s_mov_b32 m0, 74752
  s_add_u32 s28, s61, 9216
  buffer_load_dwordx4 v178, s[8:11], s28 offen sc1 lds
  s_mov_b32 m0, 75776
  s_add_u32 s28, s61, 10240
  buffer_load_dwordx4 v178, s[8:11], s28 offen sc1 lds
  s_mov_b32 m0, 76800
  s_add_u32 s28, s61, 11264
  buffer_load_dwordx4 v178, s[8:11], s28 offen sc1 lds
  s_mov_b32 m0, 77824
  s_add_u32 s28, s61, 12288
  buffer_load_dwordx4 v178, s[8:11], s28 offen sc1 lds
  s_mov_b32 m0, 78848
  s_add_u32 s28, s61, 13312
  buffer_load_dwordx4 v178, s[8:11], s28 offen sc1 lds
  s_mov_b32 m0, 79872
  s_add_u32 s28, s61, 14336
  buffer_load_dwordx4 v178, s[8:11], s28 offen sc1 lds
  s_mov_b32 m0, 80896
  s_add_u32 s28, s61, 15360
  buffer_load_dwordx4 v178, s[8:11], s28 offen sc1 lds
  s_mov_b32 m0, 81920
  s_add_u32 s28, s61, 16384
  buffer_load_dwordx4 v178, s[8:11], s28 offen sc1 lds
  s_mov_b32 m0, 82944
  s_add_u32 s28, s61, 17408
  buffer_load_dwordx4 v178, s[8:11], s28 offen sc1 lds
  s_mov_b32 m0, 83968
  s_add_u32 s28, s61, 18432
  buffer_load_dwordx4 v178, s[8:11], s28 offen sc1 lds
  s_mov_b32 m0, 84992
  s_add_u32 s28, s61, 19456
  buffer_load_dwordx4 v178, s[8:11], s28 offen sc1 lds
  s_waitcnt vmcnt(0)
  s_branch ytp_106
ytp_106_ok:
  v_mfma_f32_16x16x32_bf16 v[140:143], v[68:71], v[100:103], 0
  v_mfma_f32_16x16x32_bf16 v[140:143], v[72:75], v[104:107], v[140:143]
  v_mfma_f32_16x16x32_bf16 v[140:143], v[76:79], v[108:111], v[140:143]
  v_mfma_f32_16x16x32_bf16 v[140:143], v[80:83], v[112:115], v[140:143]
  v_mfma_f32_16x16x32_bf16 v[140:143], v[84:87], v[116:119], v[140:143]
  v_mfma_f32_16x16x32_bf16 v[140:143], v[88:91], v[120:123], v[140:143]
  v_mfma_f32_16x16x32_bf16 v[140:143], v[92:95], v[124:127], v[140:143]
  v_mfma_f32_16x16x32_bf16 v[140:143], v[96:99], v[128:131], v[140:143]
  v_mfma_f32_16x16x32_bf16 v[140:143], v[148:151], v[132:135], v[140:143]
  v_mfma_f32_16x16x32_bf16 v[140:143], v[152:155], v[136:139], v[140:143]
  s_nop 8
  s_add_u32 s28, s62, 256
  buffer_store_dwordx4 v[140:143], v189, s[8:11], s28 offen
  s_nop 1
  s_add_u32 s61, s61, 20480
  s_add_u32 s62, s62, 81920
  s_add_u32 s54, s54, 1
  v_xor_b32 v181, 0x4000, v181
yt_104:
  s_waitcnt lgkmcnt(0)
  v_mov_b32 v148, v60
  v_mov_b32 v149, v61
  v_mov_b32 v150, v62
  v_mov_b32 v151, v63
  v_mov_b32 v152, v64
  v_mov_b32 v153, v65
  v_mov_b32 v154, v66
  v_mov_b32 v155, v67
  s_add_u32 s97, s97, 10240
  s_mov_b32 s48, s97
  s_add_u32 s51, s51, 1
  s_cmp_lt_u32 s51, 64
  s_cbranch_scc1 kas_y_tokl
  s_barrier
  ds_read_b128 v[68:71], v181 offset:0
  ds_read_b128 v[72:75], v181 offset:2048
  ds_read_b128 v[76:79], v181 offset:4096
  ds_read_b128 v[80:83], v181 offset:6144
  ds_read_b128 v[84:87], v181 offset:8192
  ds_read_b128 v[88:91], v181 offset:10240
  ds_read_b128 v[92:95], v181 offset:12288
  ds_read_b128 v[96:99], v181 offset:14336
  s_mov_b32 s45, 0
  s_branch ytp_107_dma
ytp_107:
  s_waitcnt lgkmcnt(0)
  ds_read_b128 v[100:103], v183 offset:0
  ds_read_b128 v[104:107], v183 offset:2048
  ds_read_b128 v[108:111], v183 offset:4096
  ds_read_b128 v[112:115], v183 offset:6144
  ds_read_b128 v[116:119], v183 offset:8192
  ds_read_b128 v[120:123], v183 offset:10240
  ds_read_b128 v[124:127], v183 offset:12288
  ds_read_b128 v[128:131], v183 offset:14336
  ds_read_b128 v[132:135], v183 offset:16384
  ds_read_b128 v[136:139], v183 offset:18432
  s_waitcnt lgkmcnt(0)
  v_max_u32 v190, v100, v102
  v_max3_u32 v190, v190, v104, v106
  v_max3_u32 v190, v190, v108, v110
  v_max3_u32 v190, v190, v112, v114
  v_max3_u32 v190, v190, v116, v118
  v_max3_u32 v190, v190, v120, v122
  v_max3_u32 v190, v190, v124, v126
  v_max3_u32 v190, v190, v128, v130
  v_max3_u32 v190, v190, v132, v134
  v_max3_u32 v190, v190, v136, v138
  v_cmp_eq_u32 vcc, -1, v190
  s_cbranch_vccz ytp_107_ok
  s_add_u32 s45, s45, 1
  s_cmp_lt_u32 s45, 400000
  s_cbranch_scc0 kas_abort
ytp_107_dma:
  s_mov_b32 m0, 65536
  s_add_u32 s28, s61, 0
  buffer_load_dwordx4 v178, s[8:11], s28 offen sc1 lds
  s_mov_b32 m0, 66560
  s_add_u32 s28, s61, 1024
  buffer_load_dwordx4 v178, s[8:11], s28 offen sc1 lds
  s_mov_b32 m0, 67584
  s_add_u32 s28, s61, 2048
  buffer_load_dwordx4 v178, s[8:11], s28 offen sc1 lds
  s_mov_b32 m0, 68608
  s_add_u32 s28, s61, 3072
  buffer_load_dwordx4 v178, s[8:11], s28 offen sc1 lds
  s_mov_b32 m0, 69632
  s_add_u32 s28, s61, 4096
  buffer_load_dwordx4 v178, s[8:11], s28 offen sc1 lds
  s_mov_b32 m0, 70656
  s_add_u32 s28, s61, 5120
  buffer_load_dwordx4 v178, s[8:11], s28 offen sc1 lds
  s_mov_b32 m0, 71680
  s_add_u32 s28, s61, 6144
  buffer_load_dwordx4 v178, s[8:11], s28 offen sc1 lds
  s_mov_b32 m0, 72704
  s_add_u32 s28, s61, 7168
  buffer_load_dwordx4 v178, s[8:11], s28 offen sc1 lds
  s_mov_b32 m0, 73728
  s_add_u32 s28, s61, 8192
  buffer_load_dwordx4 v178, s[8:11], s28 offen sc1 lds
  s_mov_b32 m0, 74752
  s_add_u32 s28, s61, 9216
  buffer_load_dwordx4 v178, s[8:11], s28 offen sc1 lds
  s_mov_b32 m0, 75776
  s_add_u32 s28, s61, 10240
  buffer_load_dwordx4 v178, s[8:11], s28 offen sc1 lds
  s_mov_b32 m0, 76800
  s_add_u32 s28, s61, 11264
  buffer_load_dwordx4 v178, s[8:11], s28 offen sc1 lds
  s_mov_b32 m0, 77824
  s_add_u32 s28, s61, 12288
  buffer_load_dwordx4 v178, s[8:11], s28 offen sc1 lds
  s_mov_b32 m0, 78848
  s_add_u32 s28, s61, 13312
  buffer_load_dwordx4 v178, s[8:11], s28 offen sc1 lds
  s_mov_b32 m0, 79872
  s_add_u32 s28, s61, 14336
  buffer_load_dwordx4 v178, s[8:11], s28 offen sc1 lds
  s_mov_b32 m0, 80896
  s_add_u32 s28, s61, 15360
  buffer_load_dwordx4 v178, s[8:11], s28 offen sc1 lds
  s_mov_b32 m0, 81920
  s_add_u32 s28, s61, 16384
  buffer_load_dwordx4 v178, s[8:11], s28 offen sc1 lds
  s_mov_b32 m0, 82944
  s_add_u32 s28, s61, 17408
  buffer_load_dwordx4 v178, s[8:11], s28 offen sc1 lds
  s_mov_b32 m0, 83968
  s_add_u32 s28, s61, 18432
  buffer_load_dwordx4 v178, s[8:11], s28 offen sc1 lds
  s_mov_b32 m0, 84992
  s_add_u32 s28, s61, 19456
  buffer_load_dwordx4 v178, s[8:11], s28 offen sc1 lds
  s_waitcnt vmcnt(0)
  s_branch ytp_107
ytp_107_ok:
  v_mfma_f32_16x16x32_bf16 v[140:143], v[68:71], v[100:103], 0
  v_mfma_f32_16x16x32_bf16 v[140:143], v[72:75], v[104:107], v[140:143]
  v_mfma_f32_16x16x32_bf16 v[140:143], v[76:79], v[108:111], v[140:143]
  v_mfma_f32_16x16x32_bf16 v[140:143], v[80:83], v[112:115], v[140:143]
  v_mfma_f32_16x16x32_bf16 v[140:143], v[84:87], v[116:119], v[140:143]
  v_mfma_f32_16x16x32_bf16 v[140:143], v[88:91], v[120:123], v[140:143]
  v_mfma_f32_16x16x32_bf16 v[140:143], v[92:95], v[124:127], v[140:143]
  v_mfma_f32_16x16x32_bf16 v[140:143], v[96:99], v[128:131], v[140:143]
  v_mfma_f32_16x16x32_bf16 v[140:143], v[148:151], v[132:135], v[140:143]
  v_mfma_f32_16x16x32_bf16 v[140:143], v[152:155], v[136:139], v[140:143]
  s_nop 8
  s_add_u32 s28, s62, 0
  buffer_store_dwordx4 v[140:143], v189, s[8:11], s28 offen
  s_nop 1
  s_mov_b32 s45, 0
ytp_108:
  s_waitcnt lgkmcnt(0)
  ds_read_b128 v[100:103], v183 offset:1024
  ds_read_b128 v[104:107], v183 offset:3072
  ds_read_b128 v[108:111], v183 offset:5120
  ds_read_b128 v[112:115], v183 offset:7168
  ds_read_b128 v[116:119], v183 offset:9216
  ds_read_b128 v[120:123], v183 offset:11264
  ds_read_b128 v[124:127], v183 offset:13312
  ds_read_b128 v[128:131], v183 offset:15360
  ds_read_b128 v[132:135], v183 offset:17408
  ds_read_b128 v[136:139], v183 offset:19456
  s_waitcnt lgkmcnt(0)
  v_max_u32 v190, v100, v102
  v_max3_u32 v190, v190, v104, v106
  v_max3_u32 v190, v190, v108, v110
  v_max3_u32 v190, v190, v112, v114
  v_max3_u32 v190, v190, v116, v118
  v_max3_u32 v190, v190, v120, v122
  v_max3_u32 v190, v190, v124, v126
  v_max3_u32 v190, v190, v128, v130
  v_max3_u32 v190, v190, v132, v134
  v_max3_u32 v190, v190, v136, v138
  v_cmp_eq_u32 vcc, -1, v190
  s_cbranch_vccz ytp_108_ok
  s_add_u32 s45, s45, 1
  s_cmp_lt_u32 s45, 400000
  s_cbranch_scc0 kas_abort
ytp_108_dma:
  s_mov_b32 m0, 65536
  s_add_u32 s28, s61, 0
  buffer_load_dwordx4 v178, s[8:11], s28 offen sc1 lds
  s_mov_b32 m0, 66560
  s_add_u32 s28, s61, 1024
  buffer_load_dwordx4 v178, s[8:11], s28 offen sc1 lds
  s_mov_b32 m0, 67584
  s_add_u32 s28, s61, 2048
  buffer_load_dwordx4 v178, s[8:11], s28 offen sc1 lds
  s_mov_b32 m0, 68608
  s_add_u32 s28, s61, 3072
  buffer_load_dwordx4 v178, s[8:11], s28 offen sc1 lds
  s_mov_b32 m0, 69632
  s_add_u32 s28, s61, 4096
  buffer_load_dwordx4 v178, s[8:11], s28 offen sc1 lds
  s_mov_b32 m0, 70656
  s_add_u32 s28, s61, 5120
  buffer_load_dwordx4 v178, s[8:11], s28 offen sc1 lds
  s_mov_b32 m0, 71680
  s_add_u32 s28, s61, 6144
  buffer_load_dwordx4 v178, s[8:11], s28 offen sc1 lds
  s_mov_b32 m0, 72704
  s_add_u32 s28, s61, 7168
  buffer_load_dwordx4 v178, s[8:11], s28 offen sc1 lds
  s_mov_b32 m0, 73728
  s_add_u32 s28, s61, 8192
  buffer_load_dwordx4 v178, s[8:11], s28 offen sc1 lds
  s_mov_b32 m0, 74752
  s_add_u32 s28, s61, 9216
  buffer_load_dwordx4 v178, s[8:11], s28 offen sc1 lds
  s_mov_b32 m0, 75776
  s_add_u32 s28, s61, 10240
  buffer_load_dwordx4 v178, s[8:11], s28 offen sc1 lds
  s_mov_b32 m0, 76800
  s_add_u32 s28, s61, 11264
  buffer_load_dwordx4 v178, s[8:11], s28 offen sc1 lds
  s_mov_b32 m0, 77824
  s_add_u32 s28, s61, 12288
  buffer_load_dwordx4 v178, s[8:11], s28 offen sc1 lds
  s_mov_b32 m0, 78848
  s_add_u32 s28, s61, 13312
  buffer_load_dwordx4 v178, s[8:11], s28 offen sc1 lds
  s_mov_b32 m0, 79872
  s_add_u32 s28, s61, 14336
  buffer_load_dwordx4 v178, s[8:11], s28 offen sc1 lds
  s_mov_b32 m0, 80896
  s_add_u32 s28, s61, 15360
  buffer_load_dwordx4 v178, s[8:11], s28 offen sc1 lds
  s_mov_b32 m0, 81920
  s_add_u32 s28, s61, 16384
  buffer_load_dwordx4 v178, s[8:11], s28 offen sc1 lds
  s_mov_b32 m0, 82944
  s_add_u32 s28, s61, 17408
  buffer_load_dwordx4 v178, s[8:11], s28 offen sc1 lds
  s_mov_b32 m0, 83968
  s_add_u32 s28, s61, 18432
  buffer_load_dwordx4 v178, s[8:11], s28 offen sc1 lds
  s_mov_b32 m0, 84992
  s_add_u32 s28, s61, 19456
  buffer_load_dwordx4 v178, s[8:11], s28 offen sc1 lds
  s_waitcnt vmcnt(0)
  s_branch ytp_108
ytp_108_ok:
  v_mfma_f32_16x16x32_bf16 v[140:143], v[68:71], v[100:103], 0
  v_mfma_f32_16x16x32_bf16 v[140:143], v[72:75], v[104:107], v[140:143]
  v_mfma_f32_16x16x32_bf16 v[140:143], v[76:79], v[108:111], v[140:143]
  v_mfma_f32_16x16x32_bf16 v[140:143], v[80:83], v[112:115], v[140:143]
  v_mfma_f32_16x16x32_bf16 v[140:143], v[84:87], v[116:119], v[140:143]
  v_mfma_f32_16x16x32_bf16 v[140:143], v[88:91], v[120:123], v[140:143]
  v_mfma_f32_16x16x32_bf16 v[140:143], v[92:95], v[124:127], v[140:143]
  v_mfma_f32_16x16x32_bf16 v[140:143], v[96:99], v[128:131], v[140:143]
  v_mfma_f32_16x16x32_bf16 v[140:143], v[148:151], v[132:135], v[140:143]
  v_mfma_f32_16x16x32_bf16 v[140:143], v[152:155], v[136:139], v[140:143]
  s_nop 8
  s_add_u32 s28, s62, 256
  buffer_store_dwordx4 v[140:143], v189, s[8:11], s28 offen
  s_nop 1
  s_add_u32 s61, s61, 20480
  s_add_u32 s62, s62, 81920
  s_add_u32 s54, s54, 1
  v_xor_b32 v181, 0x4000, v181
  s_waitcnt vmcnt(0)
  s_branch kas_exit
kas_abort:
  s_branch ka_abort
kas_exit:
  s_branch ka_exit
ka_abort:
  s_load_dwordx2 s[6:7], s[0:1], 88
  v_mov_b32 v2, 80
  v_mov_b32 v3, 1
  s_waitcnt lgkmcnt(0)
  s_mov_b64 exec, 1
  global_atomic_add v2, v3, s[6:7]
  s_waitcnt vmcnt(0)
ka_exit:
  s_endpgm

.section .rodata,"a"
.p2align 6
.amdhsa_kernel ka2_kernel
  .amdhsa_next_free_vgpr 512
  .amdhsa_next_free_sgpr 102
  .amdhsa_accum_offset 256
  .amdhsa_group_segment_fixed_size 0
  .amdhsa_kernarg_size 104
  .amdhsa_user_sgpr_count 2
  .amdhsa_user_sgpr_kernarg_segment_ptr 1
  .amdhsa_system_sgpr_workgroup_id_x 1
.end_amdhsa_kernel
.text
.globl kb2_kernel
.p2align 8
.type kb2_kernel,@function
kb2_kernel:
  s_cmp_ge_u32 s2, 256
  s_cbranch_scc1 kb2_exit
  s_load_dwordx2 s[36:37], s[0:1], 0
  s_load_dwordx2 s[38:39], s[0:1], 80
  s_load_dwordx2 s[4:5], s[0:1], 96
  v_lshrrev_b32 v1, 6, v0
  s_nop 0
  v_readfirstlane_b32 s21, v1
  v_and_b32 v1, 63, v0
  v_lshlrev_b32 v2, 4, v1
  s_waitcnt lgkmcnt(0)
  s_mov_b32 s8, s4
  s_and_b32 s9, s5, 0xffff
  s_mov_b32 s10, 0x10000000
  s_mov_b32 s11, 0x20000
  s_mov_b32 s12, s36
  s_and_b32 s13, s37, 0xffff
  s_mov_b32 s14, 0x280000
  s_mov_b32 s15, 0x20000
  s_mov_b32 s16, s38
  s_and_b32 s17, s39, 0xffff
  s_mov_b32 s18, 0x280000
  s_mov_b32 s19, 0x20000
  s_and_b32 s22, s2, 7
  s_lshl_b32 s22, s22, 2
  s_bfe_u32 s23, s2, 0x20003
  s_add_u32 s22, s22, s23
  s_lshr_b32 s23, s2, 5
  s_lshl_b32 s46, s23, 7
  s_add_u32 s46, s46, 0xa000
  s_add_u32 s48, s46, 0x1400
  s_lshl_b32 s47, s22, 7
  s_add_u32 s47, s47, 0xa400
  s_lshr_b32 s26, s2, 2
  s_and_b32 s27, s2, 3
  s_lshl_b32 s27, s27, 3
  v_and_b32 v5, 7, v1
  v_bfe_u32 v6, v1, 3, 1
  v_lshrrev_b32 v7, 4, v1
  v_lshlrev_b32 v8, 5, v6
  v_add_u32 v8, v8, v5
  v_add_u32 v8, s27, v8
  v_lshlrev_b32 v8, 4, v8
  v_lshlrev_b32 v9, 11, v7
  v_add_u32 v9, v9, v8
  v_lshlrev_b32 v10, 10, v7
  v_add_u32 v10, v10, v8
  s_mul_i32 s28, s26, 81920
  s_lshl_b32 s29, s21, 13
  s_add_u32 s28, s28, s29
  s_cmp_lt_u32 s21, 2
  s_cselect_b32 s49, 3, 2
  v_mov_b32 v32, 0
  v_mov_b32 v33, 0
  v_mov_b32 v34, 0
  v_mov_b32 v35, 0
  v_mov_b32 v36, 0
  v_mov_b32 v37, 0
  v_mov_b32 v38, 0
  v_mov_b32 v39, 0
  v_mov_b32 v64, 0
  v_mov_b32 v65, 0
  v_mov_b32 v66, 0
  v_mov_b32 v67, 0
  v_mov_b32 v68, 0
  v_mov_b32 v69, 0
  v_mov_b32 v70, 0
  v_mov_b32 v71, 0
  v_mov_b32 v88, 0
  v_mov_b32 v89, 0
  v_mov_b32 v90, 0
  v_mov_b32 v91, 0
  v_mov_b32 v92, 0
  v_mov_b32 v93, 0
  v_mov_b32 v94, 0
  v_mov_b32 v95, 0
  v_mov_b32 v112, 0
  v_mov_b32 v113, 0
  v_mov_b32 v114, 0
  v_mov_b32 v115, 0
  v_mov_b32 v116, 0
  v_mov_b32 v117, 0
  v_mov_b32 v118, 0
  v_mov_b32 v119, 0
  v_mov_b32 v136, 0
  v_mov_b32 v137, 0
  v_mov_b32 v138, 0
  v_mov_b32 v139, 0
  v_mov_b32 v140, 0
  v_mov_b32 v141, 0
  v_mov_b32 v142, 0
  v_mov_b32 v143, 0
  s_add_u32 s30, s28, 27262976
  buffer_load_dwordx4 v[48:51], v9, s[8:11], s30 offen
  s_add_u32 s30, s28, 27264000
  buffer_load_dwordx4 v[52:55], v9, s[8:11], s30 offen
  s_add_u32 s30, s28, 32505856
  buffer_load_dwordx4 v[72:75], v9, s[8:11], s30 offen
  s_add_u32 s30, s28, 32506880
  buffer_load_dwordx4 v[76:79], v9, s[8:11], s30 offen
  s_add_u32 s30, s28, 37748736
  buffer_load_dwordx4 v[96:99], v9, s[8:11], s30 offen
  s_add_u32 s30, s28, 37749760
  buffer_load_dwordx4 v[100:103], v9, s[8:11], s30 offen
  s_add_u32 s30, s28, 42991616
  buffer_load_dwordx4 v[120:123], v9, s[8:11], s30 offen
  s_add_u32 s30, s28, 42992640
  buffer_load_dwordx4 v[124:127], v9, s[8:11], s30 offen
  s_add_u32 s30, s28, 20971520
  buffer_load_dwordx4 v[16:19], v9, s[8:11], s30 offen
  s_add_u32 s30, s28, 20972544
  buffer_load_dwordx4 v[20:23], v9, s[8:11], s30 offen
  s_add_u32 s30, s28, 27295744
  buffer_load_dwordx4 v[56:59], v9, s[8:11], s30 offen
  s_add_u32 s30, s28, 27296768
  buffer_load_dwordx4 v[60:63], v9, s[8:11], s30 offen
  s_add_u32 s30, s28, 32538624
  buffer_load_dwordx4 v[80:83], v9, s[8:11], s30 offen
  s_add_u32 s30, s28, 32539648
  buffer_load_dwordx4 v[84:87], v9, s[8:11], s30 offen
  s_add_u32 s30, s28, 37781504
  buffer_load_dwordx4 v[104:107], v9, s[8:11], s30 offen
  s_add_u32 s30, s28, 37782528
  buffer_load_dwordx4 v[108:111], v9, s[8:11], s30 offen
  s_add_u32 s30, s28, 43024384
  buffer_load_dwordx4 v[128:131], v9, s[8:11], s30 offen
  s_add_u32 s30, s28, 43025408
  buffer_load_dwordx4 v[132:135], v9, s[8:11], s30 offen
  s_add_u32 s30, s28, 21004288
  buffer_load_dwordx4 v[24:27], v9, s[8:11], s30 offen
  s_add_u32 s30, s28, 21005312
  buffer_load_dwordx4 v[28:31], v9, s[8:11], s30 offen
  s_cmp_lt_u32 s21, 2
  s_cbranch_scc0 g3_109
  s_add_u32 s30, s28, 27328512
  buffer_load_dwordx4 v[64:67], v9, s[8:11], s30 offen
  s_add_u32 s30, s28, 27329536
  buffer_load_dwordx4 v[68:71], v9, s[8:11], s30 offen
  s_add_u32 s30, s28, 32571392
  buffer_load_dwordx4 v[88:91], v9, s[8:11], s30 offen
  s_add_u32 s30, s28, 32572416
  buffer_load_dwordx4 v[92:95], v9, s[8:11], s30 offen
  s_add_u32 s30, s28, 37814272
  buffer_load_dwordx4 v[112:115], v9, s[8:11], s30 offen
  s_add_u32 s30, s28, 37815296
  buffer_load_dwordx4 v[116:119], v9, s[8:11], s30 offen
  s_add_u32 s30, s28, 43057152
  buffer_load_dwordx4 v[136:139], v9, s[8:11], s30 offen
  s_add_u32 s30, s28, 43058176
  buffer_load_dwordx4 v[140:143], v9, s[8:11], s30 offen
  s_add_u32 s30, s28, 21037056
  buffer_load_dwordx4 v[32:35], v9, s[8:11], s30 offen
  s_add_u32 s30, s28, 21038080
  buffer_load_dwordx4 v[36:39], v9, s[8:11], s30 offen
g3_109:
  s_mul_i32 s30, s22, 122880
  s_mul_i32 s31, s21, 30720
  s_add_u32 s30, s30, s31
  s_add_u32 s30, s30, 0xe100000
  s_add_u32 m0, s31, 0
  s_add_u32 s29, s30, 0
  buffer_load_dwordx4 v2, s[8:11], s29 offen lds
  s_add_u32 m0, s31, 1024
  s_add_u32 s29, s30, 1024
  buffer_load_dwordx4 v2, s[8:11], s29 offen lds
  s_add_u32 m0, s31, 2048
  s_add_u32 s29, s30, 2048
  buffer_load_dwordx4 v2, s[8:11], s29 offen lds
  s_add_u32 m0, s31, 3072
  s_add_u32 s29, s30, 3072
  buffer_load_dwordx4 v2, s[8:11], s29 offen lds
  s_add_u32 m0, s31, 4096
  s_add_u32 s29, s30, 4096
  buffer_load_dwordx4 v2, s[8:11], s29 offen lds
  s_add_u32 m0, s31, 5120
  s_add_u32 s29, s30, 5120
  buffer_load_dwordx4 v2, s[8:11], s29 offen lds
  s_add_u32 m0, s31, 6144
  s_add_u32 s29, s30, 6144
  buffer_load_dwordx4 v2, s[8:11], s29 offen lds
  s_add_u32 m0, s31, 7168
  s_add_u32 s29, s30, 7168
  buffer_load_dwordx4 v2, s[8:11], s29 offen lds
  s_add_u32 m0, s31, 8192
  s_add_u32 s29, s30, 8192
  buffer_load_dwordx4 v2, s[8:11], s29 offen lds
  s_add_u32 m0, s31, 9216
  s_add_u32 s29, s30, 9216
  buffer_load_dwordx4 v2, s[8:11], s29 offen lds
  s_add_u32 m0, s31, 10240
  s_add_u32 s29, s30, 10240
  buffer_load_dwordx4 v2, s[8:11], s29 offen lds
  s_add_u32 m0, s31, 11264
  s_add_u32 s29, s30, 11264
  buffer_load_dwordx4 v2, s[8:11], s29 offen lds
  s_add_u32 m0, s31, 12288
  s_add_u32 s29, s30, 12288
  buffer_load_dwordx4 v2, s[8:11], s29 offen lds
  s_add_u32 m0, s31, 13312
  s_add_u32 s29, s30, 13312
  buffer_load_dwordx4 v2, s[8:11], s29 offen lds
  s_add_u32 m0, s31, 14336
  s_add_u32 s29, s30, 14336
  buffer_load_dwordx4 v2, s[8:11], s29 offen lds
  s_add_u32 m0, s31, 15360
  s_add_u32 s29, s30, 15360
  buffer_load_dwordx4 v2, s[8:11], s29 offen lds
  s_add_u32 m0, s31, 16384
  s_add_u32 s29, s30, 16384
  buffer_load_dwordx4 v2, s[8:11], s29 offen lds
  s_add_u32 m0, s31, 17408
  s_add_u32 s29, s30, 17408
  buffer_load_dwordx4 v2, s[8:11], s29 offen lds
  s_add_u32 m0, s31, 18432
  s_add_u32 s29, s30, 18432
  buffer_load_dwordx4 v2, s[8:11], s29 offen lds
  s_add_u32 m0, s31, 19456
  s_add_u32 s29, s30, 19456
  buffer_load_dwordx4 v2, s[8:11], s29 offen lds
  s_add_u32 m0, s31, 20480
  s_add_u32 s29, s30, 20480
  buffer_load_dwordx4 v2, s[8:11], s29 offen lds
  s_add_u32 m0, s31, 21504
  s_add_u32 s29, s30, 21504
  buffer_load_dwordx4 v2, s[8:11], s29 offen lds
  s_add_u32 m0, s31, 22528
  s_add_u32 s29, s30, 22528
  buffer_load_dwordx4 v2, s[8:11], s29 offen lds
  s_add_u32 m0, s31, 23552
  s_add_u32 s29, s30, 23552
  buffer_load_dwordx4 v2, s[8:11], s29 offen lds
  s_add_u32 m0, s31, 24576
  s_add_u32 s29, s30, 24576
  buffer_load_dwordx4 v2, s[8:11], s29 offen lds
  s_add_u32 m0, s31, 25600
  s_add_u32 s29, s30, 25600
  buffer_load_dwordx4 v2, s[8:11], s29 offen lds
  s_add_u32 m0, s31, 26624
  s_add_u32 s29, s30, 26624
  buffer_load_dwordx4 v2, s[8:11], s29 offen lds
  s_add_u32 m0, s31, 27648
  s_add_u32 s29, s30, 27648
  buffer_load_dwordx4 v2, s[8:11], s29 offen lds
  s_add_u32 m0, s31, 28672
  s_add_u32 s29, s30, 28672
  buffer_load_dwordx4 v2, s[8:11], s29 offen lds
  s_add_u32 m0, s31, 29696
  s_add_u32 s29, s30, 29696
  buffer_load_dwordx4 v2, s[8:11], s29 offen lds
  s_waitcnt vmcnt(30)
  v_add_f32 v48, v48, v72
  v_add_f32 v96, v96, v120
  v_add_f32 v49, v49, v73
  v_add_f32 v97, v97, v121
  v_add_f32 v50, v50, v74
  v_add_f32 v98, v98, v122
  v_add_f32 v51, v51, v75
  v_add_f32 v99, v99, v123
  v_add_f32 v52, v52, v76
  v_add_f32 v100, v100, v124
  v_add_f32 v53, v53, v77
  v_add_f32 v101, v101, v125
  v_add_f32 v54, v54, v78
  v_add_f32 v102, v102, v126
  v_add_f32 v55, v55, v79
  v_add_f32 v103, v103, v127
  v_add_f32 v56, v56, v80
  v_add_f32 v104, v104, v128
  v_add_f32 v57, v57, v81
  v_add_f32 v105, v105, v129
  v_add_f32 v58, v58, v82
  v_add_f32 v106, v106, v130
  v_add_f32 v59, v59, v83
  v_add_f32 v107, v107, v131
  v_add_f32 v60, v60, v84
  v_add_f32 v108, v108, v132
  v_add_f32 v61, v61, v85
  v_add_f32 v109, v109, v133
  v_add_f32 v62, v62, v86
  v_add_f32 v110, v110, v134
  v_add_f32 v63, v63, v87
  v_add_f32 v111, v111, v135
  v_add_f32 v64, v64, v88
  v_add_f32 v112, v112, v136
  v_add_f32 v65, v65, v89
  v_add_f32 v113, v113, v137
  v_add_f32 v66, v66, v90
  v_add_f32 v114, v114, v138
  v_add_f32 v67, v67, v91
  v_add_f32 v115, v115, v139
  v_add_f32 v68, v68, v92
  v_add_f32 v116, v116, v140
  v_add_f32 v69, v69, v93
  v_add_f32 v117, v117, v141
  v_add_f32 v70, v70, v94
  v_add_f32 v118, v118, v142
  v_add_f32 v71, v71, v95
  v_add_f32 v119, v119, v143
  v_add_f32 v48, v48, v96
  v_add_f32 v16, v16, v48
  v_add_f32 v49, v49, v97
  v_add_f32 v17, v17, v49
  v_add_f32 v50, v50, v98
  v_add_f32 v18, v18, v50
  v_add_f32 v51, v51, v99
  v_add_f32 v19, v19, v51
  v_add_f32 v52, v52, v100
  v_add_f32 v20, v20, v52
  v_add_f32 v53, v53, v101
  v_add_f32 v21, v21, v53
  v_add_f32 v54, v54, v102
  v_add_f32 v22, v22, v54
  v_add_f32 v55, v55, v103
  v_add_f32 v23, v23, v55
  v_add_f32 v56, v56, v104
  v_add_f32 v24, v24, v56
  v_add_f32 v57, v57, v105
  v_add_f32 v25, v25, v57
  v_add_f32 v58, v58, v106
  v_add_f32 v26, v26, v58
  v_add_f32 v59, v59, v107
  v_add_f32 v27, v27, v59
  v_add_f32 v60, v60, v108
  v_add_f32 v28, v28, v60
  v_add_f32 v61, v61, v109
  v_add_f32 v29, v29, v61
  v_add_f32 v62, v62, v110
  v_add_f32 v30, v30, v62
  v_add_f32 v63, v63, v111
  v_add_f32 v31, v31, v63
  v_add_f32 v64, v64, v112
  v_add_f32 v32, v32, v64
  v_add_f32 v65, v65, v113
  v_add_f32 v33, v33, v65
  v_add_f32 v66, v66, v114
  v_add_f32 v34, v34, v66
  v_add_f32 v67, v67, v115
  v_add_f32 v35, v35, v67
  v_add_f32 v68, v68, v116
  v_add_f32 v36, v36, v68
  v_add_f32 v69, v69, v117
  v_add_f32 v37, v37, v69
  v_add_f32 v70, v70, v118
  v_add_f32 v38, v38, v70
  v_add_f32 v71, v71, v119
  v_add_f32 v39, v39, v71
  s_add_u32 s30, s28, 20971520
  buffer_store_dwordx4 v[16:19], v9, s[8:11], s30 offen sc1
  s_add_u32 s30, s28, 20972544
  buffer_store_dwordx4 v[20:23], v9, s[8:11], s30 offen sc1
  s_add_u32 s30, s28, 21004288
  buffer_store_dwordx4 v[24:27], v9, s[8:11], s30 offen sc1
  s_add_u32 s30, s28, 21005312
  buffer_store_dwordx4 v[28:31], v9, s[8:11], s30 offen sc1
  s_cmp_lt_u32 s21, 2
  s_cbranch_scc0 g3_110
  s_add_u32 s30, s28, 21037056
  buffer_store_dwordx4 v[32:35], v9, s[8:11], s30 offen sc1
  s_add_u32 s30, s28, 21038080
  buffer_store_dwordx4 v[36:39], v9, s[8:11], s30 offen sc1
g3_110:
  v_add_f32 v12, v16, v17
  v_add_f32 v12, v12, v18
  v_add_f32 v12, v12, v19
  v_add_f32 v12, v12, v20
  v_add_f32 v12, v12, v21
  v_add_f32 v12, v12, v22
  v_add_f32 v12, v12, v23
  v_add_f32 v12, v12, v24
  v_add_f32 v12, v12, v25
  v_add_f32 v12, v12, v26
  v_add_f32 v12, v12, v27
  v_add_f32 v12, v12, v28
  v_add_f32 v12, v12, v29
  v_add_f32 v12, v12, v30
  v_add_f32 v12, v12, v31
  v_add_f32 v12, v12, v32
  v_add_f32 v12, v12, v33
  v_add_f32 v12, v12, v34
  v_add_f32 v12, v12, v35
  v_add_f32 v12, v12, v36
  v_add_f32 v12, v12, v37
  v_add_f32 v12, v12, v38
  v_add_f32 v12, v12, v39
  s_nop 1
  v_add_f32_dpp v12, v12, v12 row_ror:8 row_mask:0xf bank_mask:0xf
  v_mov_b32 v13, v12
  s_nop 1
  v_permlane16_swap_b32 v12, v13
  v_add_f32 v12, v12, v13
  v_mov_b32 v13, v12
  s_nop 1
  v_permlane32_swap_b32 v12, v13
  v_add_f32 v12, v12, v13
  v_lshlrev_b32 v14, 2, v5
  v_add_u32 v14, 131072, v14
  s_lshl_b32 s30, s21, 5
  v_add_u32 v15, s30, v14
  ds_write_b32 v15, v12
  s_waitcnt lgkmcnt(0)
  s_barrier
  ds_read_b32 v48, v14
  ds_read_b32 v49, v14 offset:32
  ds_read_b32 v50, v14 offset:64
  ds_read_b32 v51, v14 offset:96
  s_waitcnt lgkmcnt(0)
  v_add_f32 v48, v48, v49
  v_add_f32 v50, v50, v51
  v_add_f32 v48, v48, v50
  v_mul_f32 v48, 0x3acccccd, v48
  v_sub_f32 v56, v16, v48
  v_sub_f32 v57, v17, v48
  v_sub_f32 v58, v18, v48
  v_sub_f32 v59, v19, v48
  v_sub_f32 v60, v20, v48
  v_sub_f32 v61, v21, v48
  v_sub_f32 v62, v22, v48
  v_sub_f32 v63, v23, v48
  v_sub_f32 v64, v24, v48
  v_sub_f32 v65, v25, v48
  v_sub_f32 v66, v26, v48
  v_sub_f32 v67, v27, v48
  v_sub_f32 v68, v28, v48
  v_sub_f32 v69, v29, v48
  v_sub_f32 v70, v30, v48
  v_sub_f32 v71, v31, v48
  v_sub_f32 v72, v32, v48
  v_sub_f32 v73, v33, v48
  v_sub_f32 v74, v34, v48
  v_sub_f32 v75, v35, v48
  v_sub_f32 v76, v36, v48
  v_sub_f32 v77, v37, v48
  v_sub_f32 v78, v38, v48
  v_sub_f32 v79, v39, v48
  s_cmp_lt_u32 s21, 2
  s_cbranch_scc1 g3z_111
  v_mov_b32 v72, 0
  v_mov_b32 v73, 0
  v_mov_b32 v74, 0
  v_mov_b32 v75, 0
  v_mov_b32 v76, 0
  v_mov_b32 v77, 0
  v_mov_b32 v78, 0
  v_mov_b32 v79, 0
g3z_111:
  v_mul_f32 v12, v56, v56
  v_fmac_f32 v12, v57, v57
  v_fmac_f32 v12, v58, v58
  v_fmac_f32 v12, v59, v59
  v_fmac_f32 v12, v60, v60
  v_fmac_f32 v12, v61, v61
  v_fmac_f32 v12, v62, v62
  v_fmac_f32 v12, v63, v63
  v_fmac_f32 v12, v64, v64
  v_fmac_f32 v12, v65, v65
  v_fmac_f32 v12, v66, v66
  v_fmac_f32 v12, v67, v67
  v_fmac_f32 v12, v68, v68
  v_fmac_f32 v12, v69, v69
  v_fmac_f32 v12, v70, v70
  v_fmac_f32 v12, v71, v71
  v_fmac_f32 v12, v72, v72
  v_fmac_f32 v12, v73, v73
  v_fmac_f32 v12, v74, v74
  v_fmac_f32 v12, v75, v75
  v_fmac_f32 v12, v76, v76
  v_fmac_f32 v12, v77, v77
  v_fmac_f32 v12, v78, v78
  v_fmac_f32 v12, v79, v79
  s_nop 1
  v_add_f32_dpp v12, v12, v12 row_ror:8 row_mask:0xf bank_mask:0xf
  v_mov_b32 v13, v12
  s_nop 1
  v_permlane16_swap_b32 v12, v13
  v_add_f32 v12, v12, v13
  v_mov_b32 v13, v12
  s_nop 1
  v_permlane32_swap_b32 v12, v13
  v_add_f32 v12, v12, v13
  v_lshlrev_b32 v14, 2, v5
  v_add_u32 v14, 131328, v14
  s_lshl_b32 s30, s21, 5
  v_add_u32 v15, s30, v14
  ds_write_b32 v15, v12
  s_waitcnt lgkmcnt(0)
  s_barrier
  ds_read_b32 v48, v14
  ds_read_b32 v49, v14 offset:32
  ds_read_b32 v50, v14 offset:64
  ds_read_b32 v51, v14 offset:96
  s_waitcnt lgkmcnt(0)
  v_add_f32 v48, v48, v49
  v_add_f32 v50, v50, v51
  v_add_f32 v48, v48, v50
  v_mov_b32 v49, 0x3727c5ac
  v_fmac_f32 v49, 0x3acccccd, v48
  v_rsq_f32 v49, v49
  s_nop 0
  v_mul_f32 v56, v56, v49
  v_mul_f32 v57, v57, v49
  v_mul_f32 v58, v58, v49
  v_mul_f32 v59, v59, v49
  v_mul_f32 v60, v60, v49
  v_mul_f32 v61, v61, v49
  v_mul_f32 v62, v62, v49
  v_mul_f32 v63, v63, v49
  v_mul_f32 v64, v64, v49
  v_mul_f32 v65, v65, v49
  v_mul_f32 v66, v66, v49
  v_mul_f32 v67, v67, v49
  v_mul_f32 v68, v68, v49
  v_mul_f32 v69, v69, v49
  v_mul_f32 v70, v70, v49
  v_mul_f32 v71, v71, v49
  v_mul_f32 v72, v72, v49
  v_mul_f32 v73, v73, v49
  v_mul_f32 v74, v74, v49
  v_mul_f32 v75, v75, v49
  v_mul_f32 v76, v76, v49
  v_mul_f32 v77, v77, v49
  v_mul_f32 v78, v78, v49
  v_mul_f32 v79, v79, v49
  v_cvt_pk_bf16_f32 v80, v56, v57
  v_cvt_pk_bf16_f32 v81, v58, v59
  v_cvt_pk_bf16_f32 v82, v60, v61
  v_cvt_pk_bf16_f32 v83, v62, v63
  v_cvt_pk_bf16_f32 v84, v64, v65
  v_cvt_pk_bf16_f32 v85, v66, v67
  v_cvt_pk_bf16_f32 v86, v68, v69
  v_cvt_pk_bf16_f32 v87, v70, v71
  v_cvt_pk_bf16_f32 v88, v72, v73
  v_cvt_pk_bf16_f32 v89, v74, v75
  v_cvt_pk_bf16_f32 v90, v76, v77
  v_cvt_pk_bf16_f32 v91, v78, v79
  s_mul_i32 s30, s26, 40960
  s_lshl_b32 s31, s21, 12
  s_add_u32 s30, s30, s31
  s_add_u32 s30, s30, 0x100000
  s_add_u32 s31, s30, 0
  buffer_store_dwordx4 v[80:83], v10, s[8:11], s31 offen sc1
  s_add_u32 s31, s30, 16384
  buffer_store_dwordx4 v[84:87], v10, s[8:11], s31 offen sc1
  s_cmp_lt_u32 s21, 2
  s_cbranch_scc0 g3_112
  s_add_u32 s31, s30, 32768
  buffer_store_dwordx4 v[88:91], v10, s[8:11], s31 offen sc1
g3_112:
  s_waitcnt vmcnt(0)
  s_barrier
  s_cmp_eq_u32 s21, 0
  s_cbranch_scc0 arr_113
  s_mov_b64 s[24:25], exec
  s_mov_b64 exec, 1
  v_mov_b32 v3, 0
  v_mov_b32 v4, 1
  buffer_atomic_add v4, v3, s[8:11], s46 offen
  s_mov_b64 exec, s[24:25]
arr_113:
  s_mov_b32 s45, 0
  v_mov_b32 v3, 0
aw_114:
  buffer_load_dword v4, v3, s[8:11], s46 offen sc1
  s_add_u32 s45, s45, 1
  s_waitcnt vmcnt(0)
  v_readfirstlane_b32 s29, v4
  s_cmp_ge_u32 s29, 32
  s_cbranch_scc1 aw_114_ok
  s_cmp_lt_u32 s45, 400000
  s_cbranch_scc1 aw_114
  s_branch kb2_abort
aw_114_ok:
  s_barrier
  s_lshl_b32 s26, s23, 3
  s_lshl_b32 s27, s21, 1
  s_add_u32 s24, s26, s27
  s_mul_i32 s27, s24, 40960
  s_add_u32 s27, s27, 0x100000
  s_add_u32 s28, s27, 40960
  v_mov_b32 v3, v2
  v_add_u32 v4, 65536, v2
  v_lshlrev_b32 v5, 7, v1
  s_add_u32 s29, s27, 0
  buffer_load_dword v6, v5, s[8:11], s29 offen sc1
  s_add_u32 s29, s27, 8192
  buffer_load_dword v6, v5, s[8:11], s29 offen sc1
  s_add_u32 s29, s27, 16384
  buffer_load_dword v6, v5, s[8:11], s29 offen sc1
  s_add_u32 s29, s27, 24576
  buffer_load_dword v6, v5, s[8:11], s29 offen sc1
  s_add_u32 s29, s27, 32768
  buffer_load_dword v6, v5, s[8:11], s29 offen sc1
  s_add_u32 s29, s27, 40960
  buffer_load_dword v6, v5, s[8:11], s29 offen sc1
  s_add_u32 s29, s27, 49152
  buffer_load_dword v6, v5, s[8:11], s29 offen sc1
  s_add_u32 s29, s27, 57344
  buffer_load_dword v6, v5, s[8:11], s29 offen sc1
  s_add_u32 s29, s27, 65536
  buffer_load_dword v6, v5, s[8:11], s29 offen sc1
  s_add_u32 s29, s27, 73728
  buffer_load_dword v6, v5, s[8:11], s29 offen sc1
  s_add_u32 s29, s27, 0
  buffer_load_dwordx4 v[16:19], v2, s[8:11], s29 offen sc1
  s_add_u32 s29, s28, 0
  buffer_load_dwordx4 v[20:23], v2, s[8:11], s29 offen sc1
  s_add_u32 s29, s27, 1024
  buffer_load_dwordx4 v[24:27], v2, s[8:11], s29 offen sc1
  s_add_u32 s29, s28, 1024
  buffer_load_dwordx4 v[28:31], v2, s[8:11], s29 offen sc1
  s_add_u32 s29, s27, 2048
  buffer_load_dwordx4 v[32:35], v2, s[8:11], s29 offen sc1
  s_add_u32 s29, s28, 2048
  buffer_load_dwordx4 v[36:39], v2, s[8:11], s29 offen sc1
  s_add_u32 s29, s27, 3072
  buffer_load_dwordx4 v[40:43], v2, s[8:11], s29 offen sc1
  s_add_u32 s29, s28, 3072
  buffer_load_dwordx4 v[44:47], v2, s[8:11], s29 offen sc1
  s_add_u32 s29, s27, 4096
  buffer_load_dwordx4 v[48:51], v2, s[8:11], s29 offen sc1
  s_add_u32 s29, s28, 4096
  buffer_load_dwordx4 v[52:55], v2, s[8:11], s29 offen sc1
  s_add_u32 s29, s27, 5120
  buffer_load_dwordx4 v[56:59], v2, s[8:11], s29 offen sc1
  s_add_u32 s29, s28, 5120
  buffer_load_dwordx4 v[60:63], v2, s[8:11], s29 offen sc1
  s_add_u32 s29, s27, 6144
  buffer_load_dwordx4 v[64:67], v2, s[8:11], s29 offen sc1
  s_add_u32 s29, s28, 6144
  buffer_load_dwordx4 v[68:71], v2, s[8:11], s29 offen sc1
  ds_read_b128 v[208:211], v3 offset:0
  ds_read_b128 v[212:215], v3 offset:40960
  ds_read_b128 v[216:219], v4 offset:16384
  s_add_u32 s29, s27, 7168
  buffer_load_dwordx4 v[72:75], v2, s[8:11], s29 offen sc1
  s_add_u32 s29, s28, 7168
  buffer_load_dwordx4 v[76:79], v2, s[8:11], s29 offen sc1
  ds_read_b128 v[220:223], v3 offset:1024
  ds_read_b128 v[224:227], v3 offset:41984
  ds_read_b128 v[228:231], v4 offset:17408
  s_waitcnt lgkmcnt(3)
  s_waitcnt vmcnt(14)
  v_mfma_f32_32x32x16_bf16 v[80:95], v[208:211], v[16:19], 0
  v_mfma_f32_32x32x16_bf16 v[96:111], v[212:215], v[16:19], 0
  v_mfma_f32_32x32x16_bf16 v[112:127], v[16:19], v[216:219], 0
  v_mfma_f32_32x32x16_bf16 v[128:143], v[208:211], v[20:23], 0
  v_mfma_f32_32x32x16_bf16 v[144:159], v[212:215], v[20:23], 0
  v_mfma_f32_32x32x16_bf16 v[160:175], v[20:23], v[216:219], 0
  s_add_u32 s29, s27, 8192
  buffer_load_dwordx4 v[16:19], v2, s[8:11], s29 offen sc1
  s_add_u32 s29, s28, 8192
  buffer_load_dwordx4 v[20:23], v2, s[8:11], s29 offen sc1
  ds_read_b128 v[208:211], v3 offset:2048
  ds_read_b128 v[212:215], v3 offset:43008
  ds_read_b128 v[216:219], v4 offset:18432
  s_waitcnt lgkmcnt(3)
  s_waitcnt vmcnt(14)
  v_mfma_f32_32x32x16_bf16 v[80:95], v[220:223], v[24:27], v[80:95]
  v_mfma_f32_32x32x16_bf16 v[96:111], v[224:227], v[24:27], v[96:111]
  v_mfma_f32_32x32x16_bf16 v[112:127], v[24:27], v[228:231], v[112:127]
  v_mfma_f32_32x32x16_bf16 v[128:143], v[220:223], v[28:31], v[128:143]
  v_mfma_f32_32x32x16_bf16 v[144:159], v[224:227], v[28:31], v[144:159]
  v_mfma_f32_32x32x16_bf16 v[160:175], v[28:31], v[228:231], v[160:175]
  s_add_u32 s29, s27, 9216
  buffer_load_dwordx4 v[24:27], v2, s[8:11], s29 offen sc1
  s_add_u32 s29, s28, 9216
  buffer_load_dwordx4 v[28:31], v2, s[8:11], s29 offen sc1
  ds_read_b128 v[220:223], v3 offset:3072
  ds_read_b128 v[224:227], v3 offset:44032
  ds_read_b128 v[228:231], v4 offset:19456
  s_waitcnt lgkmcnt(3)
  s_waitcnt vmcnt(14)
  v_mfma_f32_32x32x16_bf16 v[80:95], v[208:211], v[32:35], v[80:95]
  v_mfma_f32_32x32x16_bf16 v[96:111], v[212:215], v[32:35], v[96:111]
  v_mfma_f32_32x32x16_bf16 v[112:127], v[32:35], v[216:219], v[112:127]
  v_mfma_f32_32x32x16_bf16 v[128:143], v[208:211], v[36:39], v[128:143]
  v_mfma_f32_32x32x16_bf16 v[144:159], v[212:215], v[36:39], v[144:159]
  v_mfma_f32_32x32x16_bf16 v[160:175], v[36:39], v[216:219], v[160:175]
  s_add_u32 s29, s27, 10240
  buffer_load_dwordx4 v[32:35], v2, s[8:11], s29 offen sc1
  s_add_u32 s29, s28, 10240
  buffer_load_dwordx4 v[36:39], v2, s[8:11], s29 offen sc1
  ds_read_b128 v[208:211], v3 offset:4096
  ds_read_b128 v[212:215], v3 offset:45056
  ds_read_b128 v[216:219], v4 offset:20480
  s_waitcnt lgkmcnt(3)
  s_waitcnt vmcnt(14)
  v_mfma_f32_32x32x16_bf16 v[80:95], v[220:223], v[40:43], v[80:95]
  v_mfma_f32_32x32x16_bf16 v[96:111], v[224:227], v[40:43], v[96:111]
  v_mfma_f32_32x32x16_bf16 v[112:127], v[40:43], v[228:231], v[112:127]
  v_mfma_f32_32x32x16_bf16 v[128:143], v[220:223], v[44:47], v[128:143]
  v_mfma_f32_32x32x16_bf16 v[144:159], v[224:227], v[44:47], v[144:159]
  v_mfma_f32_32x32x16_bf16 v[160:175], v[44:47], v[228:231], v[160:175]
  s_add_u32 s29, s27, 11264
  buffer_load_dwordx4 v[40:43], v2, s[8:11], s29 offen sc1
  s_add_u32 s29, s28, 11264
  buffer_load_dwordx4 v[44:47], v2, s[8:11], s29 offen sc1
  ds_read_b128 v[220:223], v3 offset:5120
  ds_read_b128 v[224:227], v3 offset:46080
  ds_read_b128 v[228:231], v4 offset:21504
  s_waitcnt lgkmcnt(3)
  s_waitcnt vmcnt(14)
  v_mfma_f32_32x32x16_bf16 v[80:95], v[208:211], v[48:51], v[80:95]
  v_mfma_f32_32x32x16_bf16 v[96:111], v[212:215], v[48:51], v[96:111]
  v_mfma_f32_32x32x16_bf16 v[112:127], v[48:51], v[216:219], v[112:127]
  v_mfma_f32_32x32x16_bf16 v[128:143], v[208:211], v[52:55], v[128:143]
  v_mfma_f32_32x32x16_bf16 v[144:159], v[212:215], v[52:55], v[144:159]
  v_mfma_f32_32x32x16_bf16 v[160:175], v[52:55], v[216:219], v[160:175]
  s_add_u32 s29, s27, 12288
  buffer_load_dwordx4 v[48:51], v2, s[8:11], s29 offen sc1
  s_add_u32 s29, s28, 12288
  buffer_load_dwordx4 v[52:55], v2, s[8:11], s29 offen sc1
  ds_read_b128 v[208:211], v3 offset:6144
  ds_read_b128 v[212:215], v3 offset:47104
  ds_read_b128 v[216:219], v4 offset:22528
  s_waitcnt lgkmcnt(3)
  s_waitcnt vmcnt(14)
  v_mfma_f32_32x32x16_bf16 v[80:95], v[220:223], v[56:59], v[80:95]
  v_mfma_f32_32x32x16_bf16 v[96:111], v[224:227], v[56:59], v[96:111]
  v_mfma_f32_32x32x16_bf16 v[112:127], v[56:59], v[228:231], v[112:127]
  v_mfma_f32_32x32x16_bf16 v[128:143], v[220:223], v[60:63], v[128:143]
  v_mfma_f32_32x32x16_bf16 v[144:159], v[224:227], v[60:63], v[144:159]
  v_mfma_f32_32x32x16_bf16 v[160:175], v[60:63], v[228:231], v[160:175]
  s_add_u32 s29, s27, 13312
  buffer_load_dwordx4 v[56:59], v2, s[8:11], s29 offen sc1
  s_add_u32 s29, s28, 13312
  buffer_load_dwordx4 v[60:63], v2, s[8:11], s29 offen sc1
  ds_read_b128 v[220:223], v3 offset:7168
  ds_read_b128 v[224:227], v3 offset:48128
  ds_read_b128 v[228:231], v4 offset:23552
  s_waitcnt lgkmcnt(3)
  s_waitcnt vmcnt(14)
  v_mfma_f32_32x32x16_bf16 v[80:95], v[208:211], v[64:67], v[80:95]
  v_mfma_f32_32x32x16_bf16 v[96:111], v[212:215], v[64:67], v[96:111]
  v_mfma_f32_32x32x16_bf16 v[112:127], v[64:67], v[216:219], v[112:127]
  v_mfma_f32_32x32x16_bf16 v[128:143], v[208:211], v[68:71], v[128:143]
  v_mfma_f32_32x32x16_bf16 v[144:159], v[212:215], v[68:71], v[144:159]
  v_mfma_f32_32x32x16_bf16 v[160:175], v[68:71], v[216:219], v[160:175]
  s_add_u32 s29, s27, 14336
  buffer_load_dwordx4 v[64:67], v2, s[8:11], s29 offen sc1
  s_add_u32 s29, s28, 14336
  buffer_load_dwordx4 v[68:71], v2, s[8:11], s29 offen sc1
  ds_read_b128 v[208:211], v3 offset:8192
  ds_read_b128 v[212:215], v3 offset:49152
  ds_read_b128 v[216:219], v4 offset:24576
  s_waitcnt lgkmcnt(3)
  s_waitcnt vmcnt(14)
  v_mfma_f32_32x32x16_bf16 v[80:95], v[220:223], v[72:75], v[80:95]
  v_mfma_f32_32x32x16_bf16 v[96:111], v[224:227], v[72:75], v[96:111]
  v_mfma_f32_32x32x16_bf16 v[112:127], v[72:75], v[228:231], v[112:127]
  v_mfma_f32_32x32x16_bf16 v[128:143], v[220:223], v[76:79], v[128:143]
  v_mfma_f32_32x32x16_bf16 v[144:159], v[224:227], v[76:79], v[144:159]
  v_mfma_f32_32x32x16_bf16 v[160:175], v[76:79], v[228:231], v[160:175]
  s_add_u32 s29, s27, 15360
  buffer_load_dwordx4 v[72:75], v2, s[8:11], s29 offen sc1
  s_add_u32 s29, s28, 15360
  buffer_load_dwordx4 v[76:79], v2, s[8:11], s29 offen sc1
  ds_read_b128 v[220:223], v3 offset:9216
  ds_read_b128 v[224:227], v3 offset:50176
  ds_read_b128 v[228:231], v4 offset:25600
  s_waitcnt lgkmcnt(3)
  s_waitcnt vmcnt(14)
  v_mfma_f32_32x32x16_bf16 v[80:95], v[208:211], v[16:19], v[80:95]
  v_mfma_f32_32x32x16_bf16 v[96:111], v[212:215], v[16:19], v[96:111]
  v_mfma_f32_32x32x16_bf16 v[112:127], v[16:19], v[216:219], v[112:127]
  v_mfma_f32_32x32x16_bf16 v[128:143], v[208:211], v[20:23], v[128:143]
  v_mfma_f32_32x32x16_bf16 v[144:159], v[212:215], v[20:23], v[144:159]
  v_mfma_f32_32x32x16_bf16 v[160:175], v[20:23], v[216:219], v[160:175]
  s_add_u32 s29, s27, 16384
  buffer_load_dwordx4 v[16:19], v2, s[8:11], s29 offen sc1
  s_add_u32 s29, s28, 16384
  buffer_load_dwordx4 v[20:23], v2, s[8:11], s29 offen sc1
  ds_read_b128 v[208:211], v3 offset:10240
  ds_read_b128 v[212:215], v3 offset:51200
  ds_read_b128 v[216:219], v4 offset:26624
  s_waitcnt lgkmcnt(3)
  s_waitcnt vmcnt(14)
  v_mfma_f32_32x32x16_bf16 v[80:95], v[220:223], v[24:27], v[80:95]
  v_mfma_f32_32x32x16_bf16 v[96:111], v[224:227], v[24:27], v[96:111]
  v_mfma_f32_32x32x16_bf16 v[112:127], v[24:27], v[228:231], v[112:127]
  v_mfma_f32_32x32x16_bf16 v[128:143], v[220:223], v[28:31], v[128:143]
  v_mfma_f32_32x32x16_bf16 v[144:159], v[224:227], v[28:31], v[144:159]
  v_mfma_f32_32x32x16_bf16 v[160:175], v[28:31], v[228:231], v[160:175]
  s_add_u32 s29, s27, 17408
  buffer_load_dwordx4 v[24:27], v2, s[8:11], s29 offen sc1
  s_add_u32 s29, s28, 17408
  buffer_load_dwordx4 v[28:31], v2, s[8:11], s29 offen sc1
  ds_read_b128 v[220:223], v3 offset:11264
  ds_read_b128 v[224:227], v3 offset:52224
  ds_read_b128 v[228:231], v4 offset:27648
  s_waitcnt lgkmcnt(3)
  s_waitcnt vmcnt(14)
  v_mfma_f32_32x32x16_bf16 v[80:95], v[208:211], v[32:35], v[80:95]
  v_mfma_f32_32x32x16_bf16 v[96:111], v[212:215], v[32:35], v[96:111]
  v_mfma_f32_32x32x16_bf16 v[112:127], v[32:35], v[216:219], v[112:127]
  v_mfma_f32_32x32x16_bf16 v[128:143], v[208:211], v[36:39], v[128:143]
  v_mfma_f32_32x32x16_bf16 v[144:159], v[212:215], v[36:39], v[144:159]
  v_mfma_f32_32x32x16_bf16 v[160:175], v[36:39], v[216:219], v[160:175]
  s_add_u32 s29, s27, 18432
  buffer_load_dwordx4 v[32:35], v2, s[8:11], s29 offen sc1
  s_add_u32 s29, s28, 18432
  buffer_load_dwordx4 v[36:39], v2, s[8:11], s29 offen sc1
  ds_read_b128 v[208:211], v3 offset:12288
  ds_read_b128 v[212:215], v3 offset:53248
  ds_read_b128 v[216:219], v4 offset:28672
  s_waitcnt lgkmcnt(3)
  s_waitcnt vmcnt(14)
  v_mfma_f32_32x32x16_bf16 v[80:95], v[220:223], v[40:43], v[80:95]
  v_mfma_f32_32x32x16_bf16 v[96:111], v[224:227], v[40:43], v[96:111]
  v_mfma_f32_32x32x16_bf16 v[112:127], v[40:43], v[228:231], v[112:127]
  v_mfma_f32_32x32x16_bf16 v[128:143], v[220:223], v[44:47], v[128:143]
  v_mfma_f32_32x32x16_bf16 v[144:159], v[224:227], v[44:47], v[144:159]
  v_mfma_f32_32x32x16_bf16 v[160:175], v[44:47], v[228:231], v[160:175]
  s_add_u32 s29, s27, 19456
  buffer_load_dwordx4 v[40:43], v2, s[8:11], s29 offen sc1
  s_add_u32 s29, s28, 19456
  buffer_load_dwordx4 v[44:47], v2, s[8:11], s29 offen sc1
  ds_read_b128 v[220:223], v3 offset:13312
  ds_read_b128 v[224:227], v3 offset:54272
  ds_read_b128 v[228:231], v4 offset:29696
  s_waitcnt lgkmcnt(3)
  s_waitcnt vmcnt(14)
  v_mfma_f32_32x32x16_bf16 v[80:95], v[208:211], v[48:51], v[80:95]
  v_mfma_f32_32x32x16_bf16 v[96:111], v[212:215], v[48:51], v[96:111]
  v_mfma_f32_32x32x16_bf16 v[112:127], v[48:51], v[216:219], v[112:127]
  v_mfma_f32_32x32x16_bf16 v[128:143], v[208:211], v[52:55], v[128:143]
  v_mfma_f32_32x32x16_bf16 v[144:159], v[212:215], v[52:55], v[144:159]
  v_mfma_f32_32x32x16_bf16 v[160:175], v[52:55], v[216:219], v[160:175]
  s_add_u32 s29, s27, 20480
  buffer_load_dwordx4 v[48:51], v2, s[8:11], s29 offen sc1
  s_add_u32 s29, s28, 20480
  buffer_load_dwordx4 v[52:55], v2, s[8:11], s29 offen sc1
  ds_read_b128 v[208:211], v3 offset:14336
  ds_read_b128 v[212:215], v3 offset:55296
  ds_read_b128 v[216:219], v4 offset:30720
  s_waitcnt lgkmcnt(3)
  s_waitcnt vmcnt(14)
  v_mfma_f32_32x32x16_bf16 v[80:95], v[220:223], v[56:59], v[80:95]
  v_mfma_f32_32x32x16_bf16 v[96:111], v[224:227], v[56:59], v[96:111]
  v_mfma_f32_32x32x16_bf16 v[112:127], v[56:59], v[228:231], v[112:127]
  v_mfma_f32_32x32x16_bf16 v[128:143], v[220:223], v[60:63], v[128:143]
  v_mfma_f32_32x32x16_bf16 v[144:159], v[224:227], v[60:63], v[144:159]
  v_mfma_f32_32x32x16_bf16 v[160:175], v[60:63], v[228:231], v[160:175]
  s_add_u32 s29, s27, 21504
  buffer_load_dwordx4 v[56:59], v2, s[8:11], s29 offen sc1
  s_add_u32 s29, s28, 21504
  buffer_load_dwordx4 v[60:63], v2, s[8:11], s29 offen sc1
  ds_read_b128 v[220:223], v3 offset:15360
  ds_read_b128 v[224:227], v3 offset:56320
  ds_read_b128 v[228:231], v4 offset:31744
  s_waitcnt lgkmcnt(3)
  s_waitcnt vmcnt(14)
  v_mfma_f32_32x32x16_bf16 v[80:95], v[208:211], v[64:67], v[80:95]
  v_mfma_f32_32x32x16_bf16 v[96:111], v[212:215], v[64:67], v[96:111]
  v_mfma_f32_32x32x16_bf16 v[112:127], v[64:67], v[216:219], v[112:127]
  v_mfma_f32_32x32x16_bf16 v[128:143], v[208:211], v[68:71], v[128:143]
  v_mfma_f32_32x32x16_bf16 v[144:159], v[212:215], v[68:71], v[144:159]
  v_mfma_f32_32x32x16_bf16 v[160:175], v[68:71], v[216:219], v[160:175]
  s_add_u32 s29, s27, 22528
  buffer_load_dwordx4 v[64:67], v2, s[8:11], s29 offen sc1
  s_add_u32 s29, s28, 22528
  buffer_load_dwordx4 v[68:71], v2, s[8:11], s29 offen sc1
  ds_read_b128 v[208:211], v3 offset:16384
  ds_read_b128 v[212:215], v3 offset:57344
  ds_read_b128 v[216:219], v4 offset:32768
  s_waitcnt lgkmcnt(3)
  s_waitcnt vmcnt(14)
  v_mfma_f32_32x32x16_bf16 v[80:95], v[220:223], v[72:75], v[80:95]
  v_mfma_f32_32x32x16_bf16 v[96:111], v[224:227], v[72:75], v[96:111]
  v_mfma_f32_32x32x16_bf16 v[112:127], v[72:75], v[228:231], v[112:127]
  v_mfma_f32_32x32x16_bf16 v[128:143], v[220:223], v[76:79], v[128:143]
  v_mfma_f32_32x32x16_bf16 v[144:159], v[224:227], v[76:79], v[144:159]
  v_mfma_f32_32x32x16_bf16 v[160:175], v[76:79], v[228:231], v[160:175]
  s_add_u32 s29, s27, 23552
  buffer_load_dwordx4 v[72:75], v2, s[8:11], s29 offen sc1
  s_add_u32 s29, s28, 23552
  buffer_load_dwordx4 v[76:79], v2, s[8:11], s29 offen sc1
  ds_read_b128 v[220:223], v3 offset:17408
  ds_read_b128 v[224:227], v3 offset:58368
  ds_read_b128 v[228:231], v4 offset:33792
  s_waitcnt lgkmcnt(3)
  s_waitcnt vmcnt(14)
  v_mfma_f32_32x32x16_bf16 v[80:95], v[208:211], v[16:19], v[80:95]
  v_mfma_f32_32x32x16_bf16 v[96:111], v[212:215], v[16:19], v[96:111]
  v_mfma_f32_32x32x16_bf16 v[112:127], v[16:19], v[216:219], v[112:127]
  v_mfma_f32_32x32x16_bf16 v[128:143], v[208:211], v[20:23], v[128:143]
  v_mfma_f32_32x32x16_bf16 v[144:159], v[212:215], v[20:23], v[144:159]
  v_mfma_f32_32x32x16_bf16 v[160:175], v[20:23], v[216:219], v[160:175]
  s_add_u32 s29, s27, 24576
  buffer_load_dwordx4 v[16:19], v2, s[8:11], s29 offen sc1
  s_add_u32 s29, s28, 24576
  buffer_load_dwordx4 v[20:23], v2, s[8:11], s29 offen sc1
  ds_read_b128 v[208:211], v3 offset:18432
  ds_read_b128 v[212:215], v3 offset:59392
  ds_read_b128 v[216:219], v4 offset:34816
  s_waitcnt lgkmcnt(3)
  s_waitcnt vmcnt(14)
  v_mfma_f32_32x32x16_bf16 v[80:95], v[220:223], v[24:27], v[80:95]
  v_mfma_f32_32x32x16_bf16 v[96:111], v[224:227], v[24:27], v[96:111]
  v_mfma_f32_32x32x16_bf16 v[112:127], v[24:27], v[228:231], v[112:127]
  v_mfma_f32_32x32x16_bf16 v[128:143], v[220:223], v[28:31], v[128:143]
  v_mfma_f32_32x32x16_bf16 v[144:159], v[224:227], v[28:31], v[144:159]
  v_mfma_f32_32x32x16_bf16 v[160:175], v[28:31], v[228:231], v[160:175]
  s_add_u32 s29, s27, 25600
  buffer_load_dwordx4 v[24:27], v2, s[8:11], s29 offen sc1
  s_add_u32 s29, s28, 25600
  buffer_load_dwordx4 v[28:31], v2, s[8:11], s29 offen sc1
  ds_read_b128 v[220:223], v3 offset:19456
  ds_read_b128 v[224:227], v3 offset:60416
  ds_read_b128 v[228:231], v4 offset:35840
  s_waitcnt lgkmcnt(3)
  s_waitcnt vmcnt(14)
  v_mfma_f32_32x32x16_bf16 v[80:95], v[208:211], v[32:35], v[80:95]
  v_mfma_f32_32x32x16_bf16 v[96:111], v[212:215], v[32:35], v[96:111]
  v_mfma_f32_32x32x16_bf16 v[112:127], v[32:35], v[216:219], v[112:127]
  v_mfma_f32_32x32x16_bf16 v[128:143], v[208:211], v[36:39], v[128:143]
  v_mfma_f32_32x32x16_bf16 v[144:159], v[212:215], v[36:39], v[144:159]
  v_mfma_f32_32x32x16_bf16 v[160:175], v[36:39], v[216:219], v[160:175]
  s_add_u32 s29, s27, 26624
  buffer_load_dwordx4 v[32:35], v2, s[8:11], s29 offen sc1
  s_add_u32 s29, s28, 26624
  buffer_load_dwordx4 v[36:39], v2, s[8:11], s29 offen sc1
  ds_read_b128 v[208:211], v3 offset:20480
  ds_read_b128 v[212:215], v3 offset:61440
  ds_read_b128 v[216:219], v4 offset:36864
  s_waitcnt lgkmcnt(3)
  s_waitcnt vmcnt(14)
  v_mfma_f32_32x32x16_bf16 v[80:95], v[220:223], v[40:43], v[80:95]
  v_mfma_f32_32x32x16_bf16 v[96:111], v[224:227], v[40:43], v[96:111]
  v_mfma_f32_32x32x16_bf16 v[112:127], v[40:43], v[228:231], v[112:127]
  v_mfma_f32_32x32x16_bf16 v[128:143], v[220:223], v[44:47], v[128:143]
  v_mfma_f32_32x32x16_bf16 v[144:159], v[224:227], v[44:47], v[144:159]
  v_mfma_f32_32x32x16_bf16 v[160:175], v[44:47], v[228:231], v[160:175]
  s_add_u32 s29, s27, 27648
  buffer_load_dwordx4 v[40:43], v2, s[8:11], s29 offen sc1
  s_add_u32 s29, s28, 27648
  buffer_load_dwordx4 v[44:47], v2, s[8:11], s29 offen sc1
  ds_read_b128 v[220:223], v3 offset:21504
  ds_read_b128 v[224:227], v3 offset:62464
  ds_read_b128 v[228:231], v4 offset:37888
  s_waitcnt lgkmcnt(3)
  s_waitcnt vmcnt(14)
  v_mfma_f32_32x32x16_bf16 v[80:95], v[208:211], v[48:51], v[80:95]
  v_mfma_f32_32x32x16_bf16 v[96:111], v[212:215], v[48:51], v[96:111]
  v_mfma_f32_32x32x16_bf16 v[112:127], v[48:51], v[216:219], v[112:127]
  v_mfma_f32_32x32x16_bf16 v[128:143], v[208:211], v[52:55], v[128:143]
  v_mfma_f32_32x32x16_bf16 v[144:159], v[212:215], v[52:55], v[144:159]
  v_mfma_f32_32x32x16_bf16 v[160:175], v[52:55], v[216:219], v[160:175]
  s_add_u32 s29, s27, 28672
  buffer_load_dwordx4 v[48:51], v2, s[8:11], s29 offen sc1
  s_add_u32 s29, s28, 28672
  buffer_load_dwordx4 v[52:55], v2, s[8:11], s29 offen sc1
  ds_read_b128 v[208:211], v3 offset:22528
  ds_read_b128 v[212:215], v3 offset:63488
  ds_read_b128 v[216:219], v4 offset:38912
  s_waitcnt lgkmcnt(3)
  s_waitcnt vmcnt(14)
  v_mfma_f32_32x32x16_bf16 v[80:95], v[220:223], v[56:59], v[80:95]
  v_mfma_f32_32x32x16_bf16 v[96:111], v[224:227], v[56:59], v[96:111]
  v_mfma_f32_32x32x16_bf16 v[112:127], v[56:59], v[228:231], v[112:127]
  v_mfma_f32_32x32x16_bf16 v[128:143], v[220:223], v[60:63], v[128:143]
  v_mfma_f32_32x32x16_bf16 v[144:159], v[224:227], v[60:63], v[144:159]
  v_mfma_f32_32x32x16_bf16 v[160:175], v[60:63], v[228:231], v[160:175]
  s_add_u32 s29, s27, 29696
  buffer_load_dwordx4 v[56:59], v2, s[8:11], s29 offen sc1
  s_add_u32 s29, s28, 29696
  buffer_load_dwordx4 v[60:63], v2, s[8:11], s29 offen sc1
  ds_read_b128 v[220:223], v3 offset:23552
  ds_read_b128 v[224:227], v3 offset:64512
  ds_read_b128 v[228:231], v4 offset:39936
  s_waitcnt lgkmcnt(3)
  s_waitcnt vmcnt(14)
  v_mfma_f32_32x32x16_bf16 v[80:95], v[208:211], v[64:67], v[80:95]
  v_mfma_f32_32x32x16_bf16 v[96:111], v[212:215], v[64:67], v[96:111]
  v_mfma_f32_32x32x16_bf16 v[112:127], v[64:67], v[216:219], v[112:127]
  v_mfma_f32_32x32x16_bf16 v[128:143], v[208:211], v[68:71], v[128:143]
  v_mfma_f32_32x32x16_bf16 v[144:159], v[212:215], v[68:71], v[144:159]
  v_mfma_f32_32x32x16_bf16 v[160:175], v[68:71], v[216:219], v[160:175]
  s_add_u32 s29, s27, 30720
  buffer_load_dwordx4 v[64:67], v2, s[8:11], s29 offen sc1
  s_add_u32 s29, s28, 30720
  buffer_load_dwordx4 v[68:71], v2, s[8:11], s29 offen sc1
  ds_read_b128 v[208:211], v3 offset:24576
  ds_read_b128 v[212:215], v4 offset:0
  ds_read_b128 v[216:219], v4 offset:40960
  s_waitcnt lgkmcnt(3)
  s_waitcnt vmcnt(14)
  v_mfma_f32_32x32x16_bf16 v[80:95], v[220:223], v[72:75], v[80:95]
  v_mfma_f32_32x32x16_bf16 v[96:111], v[224:227], v[72:75], v[96:111]
  v_mfma_f32_32x32x16_bf16 v[112:127], v[72:75], v[228:231], v[112:127]
  v_mfma_f32_32x32x16_bf16 v[128:143], v[220:223], v[76:79], v[128:143]
  v_mfma_f32_32x32x16_bf16 v[144:159], v[224:227], v[76:79], v[144:159]
  v_mfma_f32_32x32x16_bf16 v[160:175], v[76:79], v[228:231], v[160:175]
  s_add_u32 s29, s27, 31744
  buffer_load_dwordx4 v[72:75], v2, s[8:11], s29 offen sc1
  s_add_u32 s29, s28, 31744
  buffer_load_dwordx4 v[76:79], v2, s[8:11], s29 offen sc1
  ds_read_b128 v[220:223], v3 offset:25600
  ds_read_b128 v[224:227], v4 offset:1024
  ds_read_b128 v[228:231], v4 offset:41984
  s_waitcnt lgkmcnt(3)
  s_waitcnt vmcnt(14)
  v_mfma_f32_32x32x16_bf16 v[80:95], v[208:211], v[16:19], v[80:95]
  v_mfma_f32_32x32x16_bf16 v[96:111], v[212:215], v[16:19], v[96:111]
  v_mfma_f32_32x32x16_bf16 v[112:127], v[16:19], v[216:219], v[112:127]
  v_mfma_f32_32x32x16_bf16 v[128:143], v[208:211], v[20:23], v[128:143]
  v_mfma_f32_32x32x16_bf16 v[144:159], v[212:215], v[20:23], v[144:159]
  v_mfma_f32_32x32x16_bf16 v[160:175], v[20:23], v[216:219], v[160:175]
  s_add_u32 s29, s27, 32768
  buffer_load_dwordx4 v[16:19], v2, s[8:11], s29 offen sc1
  s_add_u32 s29, s28, 32768
  buffer_load_dwordx4 v[20:23], v2, s[8:11], s29 offen sc1
  ds_read_b128 v[208:211], v3 offset:26624
  ds_read_b128 v[212:215], v4 offset:2048
  ds_read_b128 v[216:219], v4 offset:43008
  s_waitcnt lgkmcnt(3)
  s_waitcnt vmcnt(14)
  v_mfma_f32_32x32x16_bf16 v[80:95], v[220:223], v[24:27], v[80:95]
  v_mfma_f32_32x32x16_bf16 v[96:111], v[224:227], v[24:27], v[96:111]
  v_mfma_f32_32x32x16_bf16 v[112:127], v[24:27], v[228:231], v[112:127]
  v_mfma_f32_32x32x16_bf16 v[128:143], v[220:223], v[28:31], v[128:143]
  v_mfma_f32_32x32x16_bf16 v[144:159], v[224:227], v[28:31], v[144:159]
  v_mfma_f32_32x32x16_bf16 v[160:175], v[28:31], v[228:231], v[160:175]
  s_add_u32 s29, s27, 33792
  buffer_load_dwordx4 v[24:27], v2, s[8:11], s29 offen sc1
  s_add_u32 s29, s28, 33792
  buffer_load_dwordx4 v[28:31], v2, s[8:11], s29 offen sc1
  ds_read_b128 v[220:223], v3 offset:27648
  ds_read_b128 v[224:227], v4 offset:3072
  ds_read_b128 v[228:231], v4 offset:44032
  s_waitcnt lgkmcnt(3)
  s_waitcnt vmcnt(14)
  v_mfma_f32_32x32x16_bf16 v[80:95], v[208:211], v[32:35], v[80:95]
  v_mfma_f32_32x32x16_bf16 v[96:111], v[212:215], v[32:35], v[96:111]
  v_mfma_f32_32x32x16_bf16 v[112:127], v[32:35], v[216:219], v[112:127]
  v_mfma_f32_32x32x16_bf16 v[128:143], v[208:211], v[36:39], v[128:143]
  v_mfma_f32_32x32x16_bf16 v[144:159], v[212:215], v[36:39], v[144:159]
  v_mfma_f32_32x32x16_bf16 v[160:175], v[36:39], v[216:219], v[160:175]
  s_add_u32 s29, s27, 34816
  buffer_load_dwordx4 v[32:35], v2, s[8:11], s29 offen sc1
  s_add_u32 s29, s28, 34816
  buffer_load_dwordx4 v[36:39], v2, s[8:11], s29 offen sc1
  ds_read_b128 v[208:211], v3 offset:28672
  ds_read_b128 v[212:215], v4 offset:4096
  ds_read_b128 v[216:219], v4 offset:45056
  s_waitcnt lgkmcnt(3)
  s_waitcnt vmcnt(14)
  v_mfma_f32_32x32x16_bf16 v[80:95], v[220:223], v[40:43], v[80:95]
  v_mfma_f32_32x32x16_bf16 v[96:111], v[224:227], v[40:43], v[96:111]
  v_mfma_f32_32x32x16_bf16 v[112:127], v[40:43], v[228:231], v[112:127]
  v_mfma_f32_32x32x16_bf16 v[128:143], v[220:223], v[44:47], v[128:143]
  v_mfma_f32_32x32x16_bf16 v[144:159], v[224:227], v[44:47], v[144:159]
  v_mfma_f32_32x32x16_bf16 v[160:175], v[44:47], v[228:231], v[160:175]
  s_add_u32 s29, s27, 35840
  buffer_load_dwordx4 v[40:43], v2, s[8:11], s29 offen sc1
  s_add_u32 s29, s28, 35840
  buffer_load_dwordx4 v[44:47], v2, s[8:11], s29 offen sc1
  ds_read_b128 v[220:223], v3 offset:29696
  ds_read_b128 v[224:227], v4 offset:5120
  ds_read_b128 v[228:231], v4 offset:46080
  s_waitcnt lgkmcnt(3)
  s_waitcnt vmcnt(14)
  v_mfma_f32_32x32x16_bf16 v[80:95], v[208:211], v[48:51], v[80:95]
  v_mfma_f32_32x32x16_bf16 v[96:111], v[212:215], v[48:51], v[96:111]
  v_mfma_f32_32x32x16_bf16 v[112:127], v[48:51], v[216:219], v[112:127]
  v_mfma_f32_32x32x16_bf16 v[128:143], v[208:211], v[52:55], v[128:143]
  v_mfma_f32_32x32x16_bf16 v[144:159], v[212:215], v[52:55], v[144:159]
  v_mfma_f32_32x32x16_bf16 v[160:175], v[52:55], v[216:219], v[160:175]
  s_add_u32 s29, s27, 36864
  buffer_load_dwordx4 v[48:51], v2, s[8:11], s29 offen sc1
  s_add_u32 s29, s28, 36864
  buffer_load_dwordx4 v[52:55], v2, s[8:11], s29 offen sc1
  ds_read_b128 v[208:211], v3 offset:30720
  ds_read_b128 v[212:215], v4 offset:6144
  ds_read_b128 v[216:219], v4 offset:47104
  s_waitcnt lgkmcnt(3)
  s_waitcnt vmcnt(14)
  v_mfma_f32_32x32x16_bf16 v[80:95], v[220:223], v[56:59], v[80:95]
  v_mfma_f32_32x32x16_bf16 v[96:111], v[224:227], v[56:59], v[96:111]
  v_mfma_f32_32x32x16_bf16 v[112:127], v[56:59], v[228:231], v[112:127]
  v_mfma_f32_32x32x16_bf16 v[128:143], v[220:223], v[60:63], v[128:143]
  v_mfma_f32_32x32x16_bf16 v[144:159], v[224:227], v[60:63], v[144:159]
  v_mfma_f32_32x32x16_bf16 v[160:175], v[60:63], v[228:231], v[160:175]
  s_add_u32 s29, s27, 37888
  buffer_load_dwordx4 v[56:59], v2, s[8:11], s29 offen sc1
  s_add_u32 s29, s28, 37888
  buffer_load_dwordx4 v[60:63], v2, s[8:11], s29 offen sc1
  ds_read_b128 v[220:223], v3 offset:31744
  ds_read_b128 v[224:227], v4 offset:7168
  ds_read_b128 v[228:231], v4 offset:48128
  s_waitcnt lgkmcnt(3)
  s_waitcnt vmcnt(14)
  v_mfma_f32_32x32x16_bf16 v[80:95], v[208:211], v[64:67], v[80:95]
  v_mfma_f32_32x32x16_bf16 v[96:111], v[212:215], v[64:67], v[96:111]
  v_mfma_f32_32x32x16_bf16 v[112:127], v[64:67], v[216:219], v[112:127]
  v_mfma_f32_32x32x16_bf16 v[128:143], v[208:211], v[68:71], v[128:143]
  v_mfma_f32_32x32x16_bf16 v[144:159], v[212:215], v[68:71], v[144:159]
  v_mfma_f32_32x32x16_bf16 v[160:175], v[68:71], v[216:219], v[160:175]
  s_add_u32 s29, s27, 38912
  buffer_load_dwordx4 v[64:67], v2, s[8:11], s29 offen sc1
  s_add_u32 s29, s28, 38912
  buffer_load_dwordx4 v[68:71], v2, s[8:11], s29 offen sc1
  ds_read_b128 v[208:211], v3 offset:32768
  ds_read_b128 v[212:215], v4 offset:8192
  ds_read_b128 v[216:219], v4 offset:49152
  s_waitcnt lgkmcnt(3)
  s_waitcnt vmcnt(14)
  v_mfma_f32_32x32x16_bf16 v[80:95], v[220:223], v[72:75], v[80:95]
  v_mfma_f32_32x32x16_bf16 v[96:111], v[224:227], v[72:75], v[96:111]
  v_mfma_f32_32x32x16_bf16 v[112:127], v[72:75], v[228:231], v[112:127]
  v_mfma_f32_32x32x16_bf16 v[128:143], v[220:223], v[76:79], v[128:143]
  v_mfma_f32_32x32x16_bf16 v[144:159], v[224:227], v[76:79], v[144:159]
  v_mfma_f32_32x32x16_bf16 v[160:175], v[76:79], v[228:231], v[160:175]
  s_add_u32 s29, s27, 39936
  buffer_load_dwordx4 v[72:75], v2, s[8:11], s29 offen sc1
  s_add_u32 s29, s28, 39936
  buffer_load_dwordx4 v[76:79], v2, s[8:11], s29 offen sc1
  ds_read_b128 v[220:223], v3 offset:33792
  ds_read_b128 v[224:227], v4 offset:9216
  ds_read_b128 v[228:231], v4 offset:50176
  s_waitcnt lgkmcnt(3)
  s_waitcnt vmcnt(14)
  v_mfma_f32_32x32x16_bf16 v[80:95], v[208:211], v[16:19], v[80:95]
  v_mfma_f32_32x32x16_bf16 v[96:111], v[212:215], v[16:19], v[96:111]
  v_mfma_f32_32x32x16_bf16 v[112:127], v[16:19], v[216:219], v[112:127]
  v_mfma_f32_32x32x16_bf16 v[128:143], v[208:211], v[20:23], v[128:143]
  v_mfma_f32_32x32x16_bf16 v[144:159], v[212:215], v[20:23], v[144:159]
  v_mfma_f32_32x32x16_bf16 v[160:175], v[20:23], v[216:219], v[160:175]
  ds_read_b128 v[208:211], v3 offset:34816
  ds_read_b128 v[212:215], v4 offset:10240
  ds_read_b128 v[216:219], v4 offset:51200
  s_waitcnt lgkmcnt(3)
  s_waitcnt vmcnt(12)
  v_mfma_f32_32x32x16_bf16 v[80:95], v[220:223], v[24:27], v[80:95]
  v_mfma_f32_32x32x16_bf16 v[96:111], v[224:227], v[24:27], v[96:111]
  v_mfma_f32_32x32x16_bf16 v[112:127], v[24:27], v[228:231], v[112:127]
  v_mfma_f32_32x32x16_bf16 v[128:143], v[220:223], v[28:31], v[128:143]
  v_mfma_f32_32x32x16_bf16 v[144:159], v[224:227], v[28:31], v[144:159]
  v_mfma_f32_32x32x16_bf16 v[160:175], v[28:31], v[228:231], v[160:175]
  ds_read_b128 v[220:223], v3 offset:35840
  ds_read_b128 v[224:227], v4 offset:11264
  ds_read_b128 v[228:231], v4 offset:52224
  s_waitcnt lgkmcnt(3)
  s_waitcnt vmcnt(10)
  v_mfma_f32_32x32x16_bf16 v[80:95], v[208:211], v[32:35], v[80:95]
  v_mfma_f32_32x32x16_bf16 v[96:111], v[212:215], v[32:35], v[96:111]
  v_mfma_f32_32x32x16_bf16 v[112:127], v[32:35], v[216:219], v[112:127]
  v_mfma_f32_32x32x16_bf16 v[128:143], v[208:211], v[36:39], v[128:143]
  v_mfma_f32_32x32x16_bf16 v[144:159], v[212:215], v[36:39], v[144:159]
  v_mfma_f32_32x32x16_bf16 v[160:175], v[36:39], v[216:219], v[160:175]
  ds_read_b128 v[208:211], v3 offset:36864
  ds_read_b128 v[212:215], v4 offset:12288
  ds_read_b128 v[216:219], v4 offset:53248
  s_waitcnt lgkmcnt(3)
  s_waitcnt vmcnt(8)
  v_mfma_f32_32x32x16_bf16 v[80:95], v[220:223], v[40:43], v[80:95]
  v_mfma_f32_32x32x16_bf16 v[96:111], v[224:227], v[40:43], v[96:111]
  v_mfma_f32_32x32x16_bf16 v[112:127], v[40:43], v[228:231], v[112:127]
  v_mfma_f32_32x32x16_bf16 v[128:143], v[220:223], v[44:47], v[128:143]
  v_mfma_f32_32x32x16_bf16 v[144:159], v[224:227], v[44:47], v[144:159]
  v_mfma_f32_32x32x16_bf16 v[160:175], v[44:47], v[228:231], v[160:175]
  ds_read_b128 v[220:223], v3 offset:37888
  ds_read_b128 v[224:227], v4 offset:13312
  ds_read_b128 v[228:231], v4 offset:54272
  s_waitcnt lgkmcnt(3)
  s_waitcnt vmcnt(6)
  v_mfma_f32_32x32x16_bf16 v[80:95], v[208:211], v[48:51], v[80:95]
  v_mfma_f32_32x32x16_bf16 v[96:111], v[212:215], v[48:51], v[96:111]
  v_mfma_f32_32x32x16_bf16 v[112:127], v[48:51], v[216:219], v[112:127]
  v_mfma_f32_32x32x16_bf16 v[128:143], v[208:211], v[52:55], v[128:143]
  v_mfma_f32_32x32x16_bf16 v[144:159], v[212:215], v[52:55], v[144:159]
  v_mfma_f32_32x32x16_bf16 v[160:175], v[52:55], v[216:219], v[160:175]
  ds_read_b128 v[208:211], v3 offset:38912
  ds_read_b128 v[212:215], v4 offset:14336
  ds_read_b128 v[216:219], v4 offset:55296
  s_waitcnt lgkmcnt(3)
  s_waitcnt vmcnt(4)
  v_mfma_f32_32x32x16_bf16 v[80:95], v[220:223], v[56:59], v[80:95]
  v_mfma_f32_32x32x16_bf16 v[96:111], v[224:227], v[56:59], v[96:111]
  v_mfma_f32_32x32x16_bf16 v[112:127], v[56:59], v[228:231], v[112:127]
  v_mfma_f32_32x32x16_bf16 v[128:143], v[220:223], v[60:63], v[128:143]
  v_mfma_f32_32x32x16_bf16 v[144:159], v[224:227], v[60:63], v[144:159]
  v_mfma_f32_32x32x16_bf16 v[160:175], v[60:63], v[228:231], v[160:175]
  ds_read_b128 v[220:223], v3 offset:39936
  ds_read_b128 v[224:227], v4 offset:15360
  ds_read_b128 v[228:231], v4 offset:56320
  s_waitcnt lgkmcnt(3)
  s_waitcnt vmcnt(2)
  v_mfma_f32_32x32x16_bf16 v[80:95], v[208:211], v[64:67], v[80:95]
  v_mfma_f32_32x32x16_bf16 v[96:111], v[212:215], v[64:67], v[96:111]
  v_mfma_f32_32x32x16_bf16 v[112:127], v[64:67], v[216:219], v[112:127]
  v_mfma_f32_32x32x16_bf16 v[128:143], v[208:211], v[68:71], v[128:143]
  v_mfma_f32_32x32x16_bf16 v[144:159], v[212:215], v[68:71], v[144:159]
  v_mfma_f32_32x32x16_bf16 v[160:175], v[68:71], v[216:219], v[160:175]
  s_waitcnt lgkmcnt(0)
  s_waitcnt vmcnt(0)
  v_mfma_f32_32x32x16_bf16 v[80:95], v[220:223], v[72:75], v[80:95]
  v_mfma_f32_32x32x16_bf16 v[96:111], v[224:227], v[72:75], v[96:111]
  v_mfma_f32_32x32x16_bf16 v[112:127], v[72:75], v[228:231], v[112:127]
  v_mfma_f32_32x32x16_bf16 v[128:143], v[220:223], v[76:79], v[128:143]
  v_mfma_f32_32x32x16_bf16 v[144:159], v[224:227], v[76:79], v[144:159]
  v_mfma_f32_32x32x16_bf16 v[160:175], v[76:79], v[228:231], v[160:175]
  s_nop 11
  s_mov_b32 s30, 0x3ea52b5c
  v_mov_b32 v5, 0
  v_cmp_gt_u32 s[34:35], 32, v1
  v_mov_b32 v6, 1.0
  v_and_b32 v7, 31, v1
  v_cndmask_b32 v6, v5, v6, s[34:35]
  v_cmp_eq_u32 s[32:33], 20, v7
  v_mov_b32 v8, 1.0
  s_lshl_b32 s31, s22, 6
  s_add_u32 s31, s31, s24
  s_lshl_b32 s31, s31, 11
  v_mov_b32 v9, 0
  v_max3_f32 v9, v9, abs(v96), abs(v97)
  v_max3_f32 v9, v9, abs(v98), abs(v99)
  v_max3_f32 v9, v9, abs(v100), abs(v101)
  v_max3_f32 v9, v9, abs(v102), abs(v103)
  v_max3_f32 v9, v9, abs(v104), abs(v105)
  v_max3_f32 v9, v9, abs(v106), abs(v107)
  v_max3_f32 v9, v9, abs(v108), abs(v109)
  v_max3_f32 v9, v9, abs(v110), abs(v111)
  v_add_f32 v108, v108, v6
  v_cndmask_b32 v112, v112, v8, s[32:33]
  v_cndmask_b32 v113, v113, v8, s[32:33]
  v_cndmask_b32 v114, v114, v8, s[32:33]
  v_cndmask_b32 v115, v115, v8, s[32:33]
  v_cndmask_b32 v116, v116, v8, s[32:33]
  v_cndmask_b32 v117, v117, v8, s[32:33]
  v_cndmask_b32 v118, v118, v8, s[32:33]
  v_cndmask_b32 v119, v119, v8, s[32:33]
  v_cndmask_b32 v120, v120, v8, s[32:33]
  v_cndmask_b32 v121, v121, v8, s[32:33]
  v_cndmask_b32 v122, v122, v8, s[32:33]
  v_cndmask_b32 v123, v123, v8, s[32:33]
  v_cndmask_b32 v124, v124, v8, s[32:33]
  v_cndmask_b32 v125, v125, v8, s[32:33]
  v_cndmask_b32 v126, v126, v8, s[32:33]
  v_cndmask_b32 v127, v127, v8, s[32:33]
  v_cvt_pk_bf16_f32 v16, v96, v97
  v_cvt_pk_bf16_f32 v17, v98, v99
  v_cvt_pk_bf16_f32 v18, v100, v101
  v_cvt_pk_bf16_f32 v19, v102, v103
  v_cvt_pk_bf16_f32 v20, v104, v105
  v_cvt_pk_bf16_f32 v21, v106, v107
  v_cvt_pk_bf16_f32 v22, v108, v109
  v_cvt_pk_bf16_f32 v23, v110, v111
  s_add_u32 s29, s31, 245366784
  buffer_store_dwordx4 v[16:19], v2, s[8:11], s29 offen sc1
  buffer_store_dwordx4 v[20:23], v2, s[8:11], s29 offen offset:1024 sc1
  v_cvt_pk_bf16_f32 v24, v112, v113
  v_cvt_pk_bf16_f32 v25, v114, v115
  v_cvt_pk_bf16_f32 v26, v116, v117
  v_cvt_pk_bf16_f32 v27, v118, v119
  v_cvt_pk_bf16_f32 v28, v120, v121
  v_cvt_pk_bf16_f32 v29, v122, v123
  v_cvt_pk_bf16_f32 v30, v124, v125
  v_cvt_pk_bf16_f32 v31, v126, v127
  s_add_u32 s29, s31, 249561088
  buffer_store_dwordx4 v[24:27], v2, s[8:11], s29 offen sc1
  buffer_store_dwordx4 v[28:31], v2, s[8:11], s29 offen offset:1024 sc1
  v_mul_f32 v80, s30, v80
  v_mul_f32 v81, s30, v81
  v_mul_f32 v82, s30, v82
  v_mul_f32 v83, s30, v83
  v_mul_f32 v84, s30, v84
  v_mul_f32 v85, s30, v85
  v_mul_f32 v86, s30, v86
  v_mul_f32 v87, s30, v87
  v_mul_f32 v88, s30, v88
  v_mul_f32 v89, s30, v89
  v_mul_f32 v90, s30, v90
  v_mul_f32 v91, s30, v91
  v_mul_f32 v92, s30, v92
  v_mul_f32 v93, s30, v93
  v_mul_f32 v94, s30, v94
  v_mul_f32 v95, s30, v95
  v_cvt_pk_bf16_f32 v192, v80, v81
  v_cvt_pk_bf16_f32 v193, v82, v83
  v_cvt_pk_bf16_f32 v194, v84, v85
  v_cvt_pk_bf16_f32 v195, v86, v87
  v_cvt_pk_bf16_f32 v196, v88, v89
  v_cvt_pk_bf16_f32 v197, v90, v91
  v_cvt_pk_bf16_f32 v198, v92, v93
  v_cvt_pk_bf16_f32 v199, v94, v95
  v_max3_f32 v9, v9, abs(v144), abs(v145)
  v_max3_f32 v9, v9, abs(v146), abs(v147)
  v_max3_f32 v9, v9, abs(v148), abs(v149)
  v_max3_f32 v9, v9, abs(v150), abs(v151)
  v_max3_f32 v9, v9, abs(v152), abs(v153)
  v_max3_f32 v9, v9, abs(v154), abs(v155)
  v_max3_f32 v9, v9, abs(v156), abs(v157)
  v_max3_f32 v9, v9, abs(v158), abs(v159)
  v_add_f32 v156, v156, v6
  v_cndmask_b32 v160, v160, v8, s[32:33]
  v_cndmask_b32 v161, v161, v8, s[32:33]
  v_cndmask_b32 v162, v162, v8, s[32:33]
  v_cndmask_b32 v163, v163, v8, s[32:33]
  v_cndmask_b32 v164, v164, v8, s[32:33]
  v_cndmask_b32 v165, v165, v8, s[32:33]
  v_cndmask_b32 v166, v166, v8, s[32:33]
  v_cndmask_b32 v167, v167, v8, s[32:33]
  v_cndmask_b32 v168, v168, v8, s[32:33]
  v_cndmask_b32 v169, v169, v8, s[32:33]
  v_cndmask_b32 v170, v170, v8, s[32:33]
  v_cndmask_b32 v171, v171, v8, s[32:33]
  v_cndmask_b32 v172, v172, v8, s[32:33]
  v_cndmask_b32 v173, v173, v8, s[32:33]
  v_cndmask_b32 v174, v174, v8, s[32:33]
  v_cndmask_b32 v175, v175, v8, s[32:33]
  v_cvt_pk_bf16_f32 v32, v144, v145
  v_cvt_pk_bf16_f32 v33, v146, v147
  v_cvt_pk_bf16_f32 v34, v148, v149
  v_cvt_pk_bf16_f32 v35, v150, v151
  v_cvt_pk_bf16_f32 v36, v152, v153
  v_cvt_pk_bf16_f32 v37, v154, v155
  v_cvt_pk_bf16_f32 v38, v156, v157
  v_cvt_pk_bf16_f32 v39, v158, v159
  s_add_u32 s29, s31, 245368832
  buffer_store_dwordx4 v[32:35], v2, s[8:11], s29 offen sc1
  buffer_store_dwordx4 v[36:39], v2, s[8:11], s29 offen offset:1024 sc1
  v_cvt_pk_bf16_f32 v40, v160, v161
  v_cvt_pk_bf16_f32 v41, v162, v163
  v_cvt_pk_bf16_f32 v42, v164, v165
  v_cvt_pk_bf16_f32 v43, v166, v167
  v_cvt_pk_bf16_f32 v44, v168, v169
  v_cvt_pk_bf16_f32 v45, v170, v171
  v_cvt_pk_bf16_f32 v46, v172, v173
  v_cvt_pk_bf16_f32 v47, v174, v175
  s_add_u32 s29, s31, 249563136
  buffer_store_dwordx4 v[40:43], v2, s[8:11], s29 offen sc1
  buffer_store_dwordx4 v[44:47], v2, s[8:11], s29 offen offset:1024 sc1
  v_mul_f32 v128, s30, v128
  v_mul_f32 v129, s30, v129
  v_mul_f32 v130, s30, v130
  v_mul_f32 v131, s30, v131
  v_mul_f32 v132, s30, v132
  v_mul_f32 v133, s30, v133
  v_mul_f32 v134, s30, v134
  v_mul_f32 v135, s30, v135
  v_mul_f32 v136, s30, v136
  v_mul_f32 v137, s30, v137
  v_mul_f32 v138, s30, v138
  v_mul_f32 v139, s30, v139
  v_mul_f32 v140, s30, v140
  v_mul_f32 v141, s30, v141
  v_mul_f32 v142, s30, v142
  v_mul_f32 v143, s30, v143
  v_cvt_pk_bf16_f32 v200, v128, v129
  v_cvt_pk_bf16_f32 v201, v130, v131
  v_cvt_pk_bf16_f32 v202, v132, v133
  v_cvt_pk_bf16_f32 v203, v134, v135
  v_cvt_pk_bf16_f32 v204, v136, v137
  v_cvt_pk_bf16_f32 v205, v138, v139
  v_cvt_pk_bf16_f32 v206, v140, v141
  v_cvt_pk_bf16_f32 v207, v142, v143
  s_nop 1
  v_max_f32_dpp v10, v9, v9 quad_perm:[1,0,3,2] row_mask:0xf bank_mask:0xf
  s_nop 1
  v_max_f32_dpp v9, v10, v10 quad_perm:[2,3,0,1] row_mask:0xf bank_mask:0xf
  s_nop 1
  v_max_f32_dpp v10, v9, v9 row_half_mirror row_mask:0xf bank_mask:0xf
  s_nop 1
  v_max_f32_dpp v9, v10, v10 row_mirror row_mask:0xf bank_mask:0xf
  v_mov_b32 v10, v9
  s_nop 1
  v_permlane16_swap_b32 v9, v10
  v_max_f32 v9, v9, v10
  v_mov_b32 v10, v9
  s_nop 1
  v_permlane32_swap_b32 v9, v10
  v_max_f32 v9, v9, v10
  s_lshl_b32 s51, s22, 2
  s_add_u32 s51, s51, 0xb800
  v_mov_b32 v11, 0
  s_mov_b64 s[40:41], exec
  s_mov_b64 exec, 1
  buffer_atomic_umax v9, v11, s[8:11], s51 offen
  s_mov_b64 exec, s[40:41]
  s_mov_b32 s52, s24
  s_waitcnt vmcnt(0)
  s_barrier
  s_cmp_eq_u32 s21, 0
  s_cbranch_scc0 arr_115
  s_mov_b64 s[24:25], exec
  s_mov_b64 exec, 1
  v_mov_b32 v3, 0
  v_mov_b32 v4, 1
  buffer_atomic_add v4, v3, s[8:11], s47 offen
  s_mov_b64 exec, s[24:25]
arr_115:
  s_and_b32 s26, s2, 3
  s_mul_i32 s26, s26, 10
  s_mul_i32 s27, s21, 3
  s_cmp_eq_u32 s21, 3
  s_cselect_b32 s27, 8, s27
  s_add_u32 s50, s26, s27
  s_mul_i32 s26, s50, 20480
  s_add_u32 s26, s26, 0xe000000
  s_add_u32 s27, s26, 0
  buffer_load_dwordx4 a[0:3], v2, s[8:11], s27 offen
  s_add_u32 s27, s26, 1024
  buffer_load_dwordx4 a[4:7], v2, s[8:11], s27 offen
  s_add_u32 s27, s26, 2048
  buffer_load_dwordx4 a[8:11], v2, s[8:11], s27 offen
  s_add_u32 s27, s26, 3072
  buffer_load_dwordx4 a[12:15], v2, s[8:11], s27 offen
  s_add_u32 s27, s26, 4096
  buffer_load_dwordx4 a[16:19], v2, s[8:11], s27 offen
  s_add_u32 s27, s26, 5120
  buffer_load_dwordx4 a[20:23], v2, s[8:11], s27 offen
  s_add_u32 s27, s26, 6144
  buffer_load_dwordx4 a[24:27], v2, s[8:11], s27 offen
  s_add_u32 s27, s26, 7168
  buffer_load_dwordx4 a[28:31], v2, s[8:11], s27 offen
  s_add_u32 s27, s26, 8192
  buffer_load_dwordx4 a[32:35], v2, s[8:11], s27 offen
  s_add_u32 s27, s26, 9216
  buffer_load_dwordx4 a[36:39], v2, s[8:11], s27 offen
  s_add_u32 s27, s26, 10240
  buffer_load_dwordx4 a[40:43], v2, s[8:11], s27 offen
  s_add_u32 s27, s26, 11264
  buffer_load_dwordx4 a[44:47], v2, s[8:11], s27 offen
  s_add_u32 s27, s26, 12288
  buffer_load_dwordx4 a[48:51], v2, s[8:11], s27 offen
  s_add_u32 s27, s26, 13312
  buffer_load_dwordx4 a[52:55], v2, s[8:11], s27 offen
  s_add_u32 s27, s26, 14336
  buffer_load_dwordx4 a[56:59], v2, s[8:11], s27 offen
  s_add_u32 s27, s26, 15360
  buffer_load_dwordx4 a[60:63], v2, s[8:11], s27 offen
  s_add_u32 s27, s26, 16384
  buffer_load_dwordx4 a[64:67], v2, s[8:11], s27 offen
  s_add_u32 s27, s26, 17408
  buffer_load_dwordx4 a[68:71], v2, s[8:11], s27 offen
  s_add_u32 s27, s26, 18432
  buffer_load_dwordx4 a[72:75], v2, s[8:11], s27 offen
  s_add_u32 s27, s26, 19456
  buffer_load_dwordx4 a[76:79], v2, s[8:11], s27 offen
  s_add_u32 s27, s26, 20480
  buffer_load_dwordx4 a[80:83], v2, s[8:11], s27 offen
  s_add_u32 s27, s26, 21504
  buffer_load_dwordx4 a[84:87], v2, s[8:11], s27 offen
  s_add_u32 s27, s26, 22528
  buffer_load_dwordx4 a[88:91], v2, s[8:11], s27 offen
  s_add_u32 s27, s26, 23552
  buffer_load_dwordx4 a[92:95], v2, s[8:11], s27 offen
  s_add_u32 s27, s26, 24576
  buffer_load_dwordx4 a[96:99], v2, s[8:11], s27 offen
  s_add_u32 s27, s26, 25600
  buffer_load_dwordx4 a[100:103], v2, s[8:11], s27 offen
  s_add_u32 s27, s26, 26624
  buffer_load_dwordx4 a[104:107], v2, s[8:11], s27 offen
  s_add_u32 s27, s26, 27648
  buffer_load_dwordx4 a[108:111], v2, s[8:11], s27 offen
  s_add_u32 s27, s26, 28672
  buffer_load_dwordx4 a[112:115], v2, s[8:11], s27 offen
  s_add_u32 s27, s26, 29696
  buffer_load_dwordx4 a[116:119], v2, s[8:11], s27 offen
  s_add_u32 s27, s26, 30720
  buffer_load_dwordx4 a[120:123], v2, s[8:11], s27 offen
  s_add_u32 s27, s26, 31744
  buffer_load_dwordx4 a[124:127], v2, s[8:11], s27 offen
  s_add_u32 s27, s26, 32768
  buffer_load_dwordx4 a[128:131], v2, s[8:11], s27 offen
  s_add_u32 s27, s26, 33792
  buffer_load_dwordx4 a[132:135], v2, s[8:11], s27 offen
  s_add_u32 s27, s26, 34816
  buffer_load_dwordx4 a[136:139], v2, s[8:11], s27 offen
  s_add_u32 s27, s26, 35840
  buffer_load_dwordx4 a[140:143], v2, s[8:11], s27 offen
  s_add_u32 s27, s26, 36864
  buffer_load_dwordx4 a[144:147], v2, s[8:11], s27 offen
  s_add_u32 s27, s26, 37888
  buffer_load_dwordx4 a[148:151], v2, s[8:11], s27 offen
  s_add_u32 s27, s26, 38912
  buffer_load_dwordx4 a[152:155], v2, s[8:11], s27 offen
  s_add_u32 s27, s26, 39936
  buffer_load_dwordx4 a[156:159], v2, s[8:11], s27 offen
  s_cmp_lt_u32 s21, 2
  s_cbranch_scc0 g3_116
  s_add_u32 s27, s26, 40960
  buffer_load_dwordx4 a[160:163], v2, s[8:11], s27 offen
  s_add_u32 s27, s26, 41984
  buffer_load_dwordx4 a[164:167], v2, s[8:11], s27 offen
  s_add_u32 s27, s26, 43008
  buffer_load_dwordx4 a[168:171], v2, s[8:11], s27 offen
  s_add_u32 s27, s26, 44032
  buffer_load_dwordx4 a[172:175], v2, s[8:11], s27 offen
  s_add_u32 s27, s26, 45056
  buffer_load_dwordx4 a[176:179], v2, s[8:11], s27 offen
  s_add_u32 s27, s26, 46080
  buffer_load_dwordx4 a[180:183], v2, s[8:11], s27 offen
  s_add_u32 s27, s26, 47104
  buffer_load_dwordx4 a[184:187], v2, s[8:11], s27 offen
  s_add_u32 s27, s26, 48128
  buffer_load_dwordx4 a[188:191], v2, s[8:11], s27 offen
  s_add_u32 s27, s26, 49152
  buffer_load_dwordx4 a[192:195], v2, s[8:11], s27 offen
  s_add_u32 s27, s26, 50176
  buffer_load_dwordx4 a[196:199], v2, s[8:11], s27 offen
  s_add_u32 s27, s26, 51200
  buffer_load_dwordx4 a[200:203], v2, s[8:11], s27 offen
  s_add_u32 s27, s26, 52224
  buffer_load_dwordx4 a[204:207], v2, s[8:11], s27 offen
  s_add_u32 s27, s26, 53248
  buffer_load_dwordx4 a[208:211], v2, s[8:11], s27 offen
  s_add_u32 s27, s26, 54272
  buffer_load_dwordx4 a[212:215], v2, s[8:11], s27 offen
  s_add_u32 s27, s26, 55296
  buffer_load_dwordx4 a[216:219], v2, s[8:11], s27 offen
  s_add_u32 s27, s26, 56320
  buffer_load_dwordx4 a[220:223], v2, s[8:11], s27 offen
  s_add_u32 s27, s26, 57344
  buffer_load_dwordx4 a[224:227], v2, s[8:11], s27 offen
  s_add_u32 s27, s26, 58368
  buffer_load_dwordx4 a[228:231], v2, s[8:11], s27 offen
  s_add_u32 s27, s26, 59392
  buffer_load_dwordx4 a[232:235], v2, s[8:11], s27 offen
  s_add_u32 s27, s26, 60416
  buffer_load_dwordx4 a[236:239], v2, s[8:11], s27 offen
g3_116:
  v_mov_b32 v12, 0
  v_lshlrev_b32 v6, 16, v192
  v_and_b32 v7, 0xffff0000, v192
  v_add_f32_e64 v12, v12, abs(v6)
  v_add_f32_e64 v12, v12, abs(v7)
  v_lshlrev_b32 v6, 16, v193
  v_and_b32 v7, 0xffff0000, v193
  v_add_f32_e64 v12, v12, abs(v6)
  v_add_f32_e64 v12, v12, abs(v7)
  v_lshlrev_b32 v6, 16, v194
  v_and_b32 v7, 0xffff0000, v194
  v_add_f32_e64 v12, v12, abs(v6)
  v_add_f32_e64 v12, v12, abs(v7)
  v_lshlrev_b32 v6, 16, v195
  v_and_b32 v7, 0xffff0000, v195
  v_add_f32_e64 v12, v12, abs(v6)
  v_add_f32_e64 v12, v12, abs(v7)
  v_lshlrev_b32 v6, 16, v196
  v_and_b32 v7, 0xffff0000, v196
  v_add_f32_e64 v12, v12, abs(v6)
  v_add_f32_e64 v12, v12, abs(v7)
  v_lshlrev_b32 v6, 16, v197
  v_and_b32 v7, 0xffff0000, v197
  v_add_f32_e64 v12, v12, abs(v6)
  v_add_f32_e64 v12, v12, abs(v7)
  v_lshlrev_b32 v6, 16, v198
  v_and_b32 v7, 0xffff0000, v198
  v_add_f32_e64 v12, v12, abs(v6)
  v_add_f32_e64 v12, v12, abs(v7)
  v_lshlrev_b32 v6, 16, v199
  v_and_b32 v7, 0xffff0000, v199
  v_add_f32_e64 v12, v12, abs(v6)
  v_add_f32_e64 v12, v12, abs(v7)
  v_mov_b32 v6, v12
  s_nop 1
  v_permlane32_swap_b32 v12, v6
  v_add_f32 v12, v12, v6
  v_mov_b32 v13, 0
  v_lshlrev_b32 v6, 16, v200
  v_and_b32 v7, 0xffff0000, v200
  v_add_f32_e64 v13, v13, abs(v6)
  v_add_f32_e64 v13, v13, abs(v7)
  v_lshlrev_b32 v6, 16, v201
  v_and_b32 v7, 0xffff0000, v201
  v_add_f32_e64 v13, v13, abs(v6)
  v_add_f32_e64 v13, v13, abs(v7)
  v_lshlrev_b32 v6, 16, v202
  v_and_b32 v7, 0xffff0000, v202
  v_add_f32_e64 v13, v13, abs(v6)
  v_add_f32_e64 v13, v13, abs(v7)
  v_lshlrev_b32 v6, 16, v203
  v_and_b32 v7, 0xffff0000, v203
  v_add_f32_e64 v13, v13, abs(v6)
  v_add_f32_e64 v13, v13, abs(v7)
  v_lshlrev_b32 v6, 16, v204
  v_and_b32 v7, 0xffff0000, v204
  v_add_f32_e64 v13, v13, abs(v6)
  v_add_f32_e64 v13, v13, abs(v7)
  v_lshlrev_b32 v6, 16, v205
  v_and_b32 v7, 0xffff0000, v205
  v_add_f32_e64 v13, v13, abs(v6)
  v_add_f32_e64 v13, v13, abs(v7)
  v_lshlrev_b32 v6, 16, v206
  v_and_b32 v7, 0xffff0000, v206
  v_add_f32_e64 v13, v13, abs(v6)
  v_add_f32_e64 v13, v13, abs(v7)
  v_lshlrev_b32 v6, 16, v207
  v_and_b32 v7, 0xffff0000, v207
  v_add_f32_e64 v13, v13, abs(v6)
  v_add_f32_e64 v13, v13, abs(v7)
  v_mov_b32 v6, v13
  s_nop 1
  v_permlane32_swap_b32 v13, v6
  v_add_f32 v13, v13, v6
  s_mov_b32 s45, 0
  v_mov_b32 v3, 0
aw_117:
  buffer_load_dword v4, v3, s[8:11], s47 offen sc1
  s_add_u32 s45, s45, 1
  s_waitcnt vmcnt(0)
  v_readfirstlane_b32 s29, v4
  s_cmp_ge_u32 s29, 8
  s_cbranch_scc1 aw_117_ok
  s_cmp_lt_u32 s45, 400000
  s_cbranch_scc1 aw_117
  s_branch kb2_abort
aw_117_ok:
  v_mov_b32 v3, 0
  buffer_load_dword v4, v3, s[8:11], s51 offen sc1
  s_lshl_b32 s25, s22, 6
  s_lshl_b32 s27, s25, 11
  s_add_u32 s28, s27, 0xee00000
  s_add_u32 s27, s27, 0xea00000
  s_mov_b32 s41, 0
  s_mul_i32 s53, s41, 32768
  s_lshl_b32 s31, s21, 13
  s_add_u32 s53, s53, s31
  s_add_u32 m0, s31, 0
  s_add_u32 s29, s53, s27
  s_add_u32 s29, s29, 0
  buffer_load_dwordx4 v2, s[8:11], s29 offen sc1 lds
  s_add_u32 m0, s31, 1024
  s_add_u32 s29, s53, s27
  s_add_u32 s29, s29, 1024
  buffer_load_dwordx4 v2, s[8:11], s29 offen sc1 lds
  s_add_u32 m0, s31, 2048
  s_add_u32 s29, s53, s27
  s_add_u32 s29, s29, 2048
  buffer_load_dwordx4 v2, s[8:11], s29 offen sc1 lds
  s_add_u32 m0, s31, 3072
  s_add_u32 s29, s53, s27
  s_add_u32 s29, s29, 3072
  buffer_load_dwordx4 v2, s[8:11], s29 offen sc1 lds
  s_add_u32 m0, s31, 4096
  s_add_u32 s29, s53, s27
  s_add_u32 s29, s29, 4096
  buffer_load_dwordx4 v2, s[8:11], s29 offen sc1 lds
  s_add_u32 m0, s31, 5120
  s_add_u32 s29, s53, s27
  s_add_u32 s29, s29, 5120
  buffer_load_dwordx4 v2, s[8:11], s29 offen sc1 lds
  s_add_u32 m0, s31, 6144
  s_add_u32 s29, s53, s27
  s_add_u32 s29, s29, 6144
  buffer_load_dwordx4 v2, s[8:11], s29 offen sc1 lds
  s_add_u32 m0, s31, 7168
  s_add_u32 s29, s53, s27
  s_add_u32 s29, s29, 7168
  buffer_load_dwordx4 v2, s[8:11], s29 offen sc1 lds
  s_add_u32 m0, s31, 32768
  s_add_u32 s29, s53, s28
  s_add_u32 s29, s29, 0
  buffer_load_dwordx4 v2, s[8:11], s29 offen sc1 lds
  s_add_u32 m0, s31, 33792
  s_add_u32 s29, s53, s28
  s_add_u32 s29, s29, 1024
  buffer_load_dwordx4 v2, s[8:11], s29 offen sc1 lds
  s_add_u32 m0, s31, 34816
  s_add_u32 s29, s53, s28
  s_add_u32 s29, s29, 2048
  buffer_load_dwordx4 v2, s[8:11], s29 offen sc1 lds
  s_add_u32 m0, s31, 35840
  s_add_u32 s29, s53, s28
  s_add_u32 s29, s29, 3072
  buffer_load_dwordx4 v2, s[8:11], s29 offen sc1 lds
  s_add_u32 m0, s31, 36864
  s_add_u32 s29, s53, s28
  s_add_u32 s29, s29, 4096
  buffer_load_dwordx4 v2, s[8:11], s29 offen sc1 lds
  s_add_u32 m0, s31, 37888
  s_add_u32 s29, s53, s28
  s_add_u32 s29, s29, 5120
  buffer_load_dwordx4 v2, s[8:11], s29 offen sc1 lds
  s_add_u32 m0, s31, 38912
  s_add_u32 s29, s53, s28
  s_add_u32 s29, s29, 6144
  buffer_load_dwordx4 v2, s[8:11], s29 offen sc1 lds
  s_add_u32 m0, s31, 39936
  s_add_u32 s29, s53, s28
  s_add_u32 s29, s29, 7168
  buffer_load_dwordx4 v2, s[8:11], s29 offen sc1 lds
  s_waitcnt vmcnt(16)
  v_mul_f32 v12, v12, v4
  v_mul_f32 v12, 0x3f820000, v12
  v_mul_f32 v13, v13, v4
  v_mul_f32 v13, 0x3f820000, v13
  s_mov_b32 s40, 0
kb2_main:
  v_lshrrev_b32 v5, 16, v12
  v_or_b32 v5, 0x8000, v5
  v_and_b32 v6, 0xffff0000, v198
  v_or_b32 v5, v5, v6
  v_cndmask_b32 v198, v198, v5, s[34:35]
  v_lshrrev_b32 v5, 16, v13
  v_or_b32 v5, 0x8000, v5
  v_and_b32 v6, 0xffff0000, v206
  v_or_b32 v5, v5, v6
  v_cndmask_b32 v206, v206, v5, s[34:35]
kb2_main2:
  v_mov_b32 v112, 0
  v_mov_b32 v113, 0
  v_mov_b32 v114, 0
  v_mov_b32 v115, 0
  v_mov_b32 v116, 0
  v_mov_b32 v117, 0
  v_mov_b32 v118, 0
  v_mov_b32 v119, 0
  v_mov_b32 v120, 0
  v_mov_b32 v121, 0
  v_mov_b32 v122, 0
  v_mov_b32 v123, 0
  v_mov_b32 v124, 0
  v_mov_b32 v125, 0
  v_mov_b32 v126, 0
  v_mov_b32 v127, 0
  v_mov_b32 v128, 0
  v_mov_b32 v129, 0
  v_mov_b32 v130, 0
  v_mov_b32 v131, 0
  v_mov_b32 v132, 0
  v_mov_b32 v133, 0
  v_mov_b32 v134, 0
  v_mov_b32 v135, 0
  v_mov_b32 v136, 0
  v_mov_b32 v137, 0
  v_mov_b32 v138, 0
  v_mov_b32 v139, 0
  v_mov_b32 v140, 0
  v_mov_b32 v141, 0
  v_mov_b32 v142, 0
  v_mov_b32 v143, 0
  v_mov_b32 v3, v2
  v_add_u32 v4, 65536, v2
kb2_chunk2:
  s_waitcnt vmcnt(0)
  s_barrier
  s_add_u32 s41, s41, 1
  s_min_u32 s29, s41, 3
  s_mul_i32 s53, s29, 32768
  s_lshl_b32 s31, s21, 13
  s_add_u32 s53, s53, s31
  ds_read_b128 v[32:35], v3 offset:0
  ds_read_b128 v[36:39], v3 offset:1024
  ds_read_b128 v[48:51], v3 offset:32768
  ds_read_b128 v[52:55], v3 offset:33792
  ds_read_b128 v[40:43], v3 offset:2048
  ds_read_b128 v[44:47], v3 offset:3072
  s_waitcnt lgkmcnt(4)
  v_mfma_f32_32x32x16_bf16 v[64:79], v[32:35], v[192:195], 0
  v_mfma_f32_32x32x16_bf16 v[64:79], v[36:39], v[196:199], v[64:79]
  s_nop 11
  v_exp_f32 v64, v64
  v_exp_f32 v65, v65
  v_exp_f32 v66, v66
  v_exp_f32 v67, v67
  v_cvt_pk_bf16_f32 v96, v64, v65
  v_exp_f32 v68, v68
  v_exp_f32 v69, v69
  v_cvt_pk_bf16_f32 v97, v66, v67
  v_exp_f32 v70, v70
  v_mfma_f32_32x32x16_bf16 v[80:95], v[32:35], v[200:203], 0
  v_exp_f32 v71, v71
  v_cvt_pk_bf16_f32 v98, v68, v69
  v_exp_f32 v72, v72
  v_exp_f32 v73, v73
  v_cvt_pk_bf16_f32 v99, v70, v71
  v_mfma_f32_32x32x16_bf16 v[80:95], v[36:39], v[204:207], v[80:95]
  v_exp_f32 v74, v74
  v_exp_f32 v75, v75
  ds_read_b128 v[56:59], v3 offset:34816
  v_cvt_pk_bf16_f32 v100, v72, v73
  v_exp_f32 v76, v76
  v_exp_f32 v77, v77
  ds_read_b128 v[60:63], v3 offset:35840
  v_cvt_pk_bf16_f32 v101, v74, v75
  v_exp_f32 v78, v78
  s_add_u32 m0, s31, 65536
  s_add_u32 s29, s53, s27
  s_add_u32 s29, s29, 0
  buffer_load_dwordx4 v2, s[8:11], s29 offen sc1 lds
  v_exp_f32 v79, v79
  v_cvt_pk_bf16_f32 v102, v76, v77
  v_cvt_pk_bf16_f32 v103, v78, v79
  s_waitcnt lgkmcnt(4)
  v_mfma_f32_32x32x16_bf16 v[112:127], v[48:51], v[96:99], v[112:127]
  v_exp_f32 v80, v80
  v_exp_f32 v81, v81
  v_exp_f32 v82, v82
  v_exp_f32 v83, v83
  v_mfma_f32_32x32x16_bf16 v[112:127], v[52:55], v[100:103], v[112:127]
  v_cvt_pk_bf16_f32 v104, v80, v81
  v_exp_f32 v84, v84
  v_exp_f32 v85, v85
  v_cvt_pk_bf16_f32 v105, v82, v83
  v_exp_f32 v86, v86
  s_waitcnt lgkmcnt(2)
  v_mfma_f32_32x32x16_bf16 v[64:79], v[40:43], v[192:195], 0
  v_exp_f32 v87, v87
  v_cvt_pk_bf16_f32 v106, v84, v85
  v_exp_f32 v88, v88
  v_exp_f32 v89, v89
  v_cvt_pk_bf16_f32 v107, v86, v87
  v_mfma_f32_32x32x16_bf16 v[64:79], v[44:47], v[196:199], v[64:79]
  v_exp_f32 v90, v90
  v_exp_f32 v91, v91
  ds_read_b128 v[32:35], v3 offset:4096
  v_cvt_pk_bf16_f32 v108, v88, v89
  v_exp_f32 v92, v92
  v_exp_f32 v93, v93
  ds_read_b128 v[36:39], v3 offset:5120
  v_cvt_pk_bf16_f32 v109, v90, v91
  v_exp_f32 v94, v94
  v_exp_f32 v95, v95
  v_cvt_pk_bf16_f32 v110, v92, v93
  v_cvt_pk_bf16_f32 v111, v94, v95
  v_mfma_f32_32x32x16_bf16 v[128:143], v[48:51], v[104:107], v[128:143]
  v_exp_f32 v64, v64
  v_exp_f32 v65, v65
  v_exp_f32 v66, v66
  v_exp_f32 v67, v67
  v_mfma_f32_32x32x16_bf16 v[128:143], v[52:55], v[108:111], v[128:143]
  v_cvt_pk_bf16_f32 v96, v64, v65
  v_exp_f32 v68, v68
  v_exp_f32 v69, v69
  v_cvt_pk_bf16_f32 v97, v66, v67
  v_exp_f32 v70, v70
  v_mfma_f32_32x32x16_bf16 v[80:95], v[40:43], v[200:203], 0
  v_exp_f32 v71, v71
  v_cvt_pk_bf16_f32 v98, v68, v69
  v_exp_f32 v72, v72
  v_exp_f32 v73, v73
  v_cvt_pk_bf16_f32 v99, v70, v71
  v_mfma_f32_32x32x16_bf16 v[80:95], v[44:47], v[204:207], v[80:95]
  v_exp_f32 v74, v74
  v_exp_f32 v75, v75
  ds_read_b128 v[48:51], v3 offset:36864
  v_cvt_pk_bf16_f32 v100, v72, v73
  v_exp_f32 v76, v76
  v_exp_f32 v77, v77
  ds_read_b128 v[52:55], v3 offset:37888
  v_cvt_pk_bf16_f32 v101, v74, v75
  v_exp_f32 v78, v78
  s_add_u32 m0, s31, 66560
  s_add_u32 s29, s53, s27
  s_add_u32 s29, s29, 1024
  buffer_load_dwordx4 v2, s[8:11], s29 offen sc1 lds
  v_exp_f32 v79, v79
  v_cvt_pk_bf16_f32 v102, v76, v77
  v_cvt_pk_bf16_f32 v103, v78, v79
  s_waitcnt lgkmcnt(4)
  v_mfma_f32_32x32x16_bf16 v[112:127], v[56:59], v[96:99], v[112:127]
  v_exp_f32 v80, v80
  v_exp_f32 v81, v81
  v_exp_f32 v82, v82
  v_exp_f32 v83, v83
  v_mfma_f32_32x32x16_bf16 v[112:127], v[60:63], v[100:103], v[112:127]
  v_cvt_pk_bf16_f32 v104, v80, v81
  v_exp_f32 v84, v84
  v_exp_f32 v85, v85
  v_cvt_pk_bf16_f32 v105, v82, v83
  v_exp_f32 v86, v86
  s_waitcnt lgkmcnt(2)
  v_mfma_f32_32x32x16_bf16 v[64:79], v[32:35], v[192:195], 0
  v_exp_f32 v87, v87
  v_cvt_pk_bf16_f32 v106, v84, v85
  v_exp_f32 v88, v88
  v_exp_f32 v89, v89
  v_cvt_pk_bf16_f32 v107, v86, v87
  v_mfma_f32_32x32x16_bf16 v[64:79], v[36:39], v[196:199], v[64:79]
  v_exp_f32 v90, v90
  v_exp_f32 v91, v91
  ds_read_b128 v[40:43], v3 offset:6144
  v_cvt_pk_bf16_f32 v108, v88, v89
  v_exp_f32 v92, v92
  v_exp_f32 v93, v93
  ds_read_b128 v[44:47], v3 offset:7168
  v_cvt_pk_bf16_f32 v109, v90, v91
  v_exp_f32 v94, v94
  v_exp_f32 v95, v95
  v_cvt_pk_bf16_f32 v110, v92, v93
  v_cvt_pk_bf16_f32 v111, v94, v95
  v_mfma_f32_32x32x16_bf16 v[128:143], v[56:59], v[104:107], v[128:143]
  v_exp_f32 v64, v64
  v_exp_f32 v65, v65
  v_exp_f32 v66, v66
  v_exp_f32 v67, v67
  v_mfma_f32_32x32x16_bf16 v[128:143], v[60:63], v[108:111], v[128:143]
  v_cvt_pk_bf16_f32 v96, v64, v65
  v_exp_f32 v68, v68
  v_exp_f32 v69, v69
  v_cvt_pk_bf16_f32 v97, v66, v67
  v_exp_f32 v70, v70
  v_mfma_f32_32x32x16_bf16 v[80:95], v[32:35], v[200:203], 0
  v_exp_f32 v71, v71
  v_cvt_pk_bf16_f32 v98, v68, v69
  v_exp_f32 v72, v72
  v_exp_f32 v73, v73
  v_cvt_pk_bf16_f32 v99, v70, v71
  v_mfma_f32_32x32x16_bf16 v[80:95], v[36:39], v[204:207], v[80:95]
  v_exp_f32 v74, v74
  v_exp_f32 v75, v75
  ds_read_b128 v[56:59], v3 offset:38912
  v_cvt_pk_bf16_f32 v100, v72, v73
  v_exp_f32 v76, v76
  v_exp_f32 v77, v77
  ds_read_b128 v[60:63], v3 offset:39936
  v_cvt_pk_bf16_f32 v101, v74, v75
  v_exp_f32 v78, v78
  s_add_u32 m0, s31, 67584
  s_add_u32 s29, s53, s27
  s_add_u32 s29, s29, 2048
  buffer_load_dwordx4 v2, s[8:11], s29 offen sc1 lds
  v_exp_f32 v79, v79
  v_cvt_pk_bf16_f32 v102, v76, v77
  v_cvt_pk_bf16_f32 v103, v78, v79
  s_waitcnt lgkmcnt(4)
  v_mfma_f32_32x32x16_bf16 v[112:127], v[48:51], v[96:99], v[112:127]
  v_exp_f32 v80, v80
  v_exp_f32 v81, v81
  v_exp_f32 v82, v82
  v_exp_f32 v83, v83
  v_mfma_f32_32x32x16_bf16 v[112:127], v[52:55], v[100:103], v[112:127]
  v_cvt_pk_bf16_f32 v104, v80, v81
  v_exp_f32 v84, v84
  v_exp_f32 v85, v85
  v_cvt_pk_bf16_f32 v105, v82, v83
  v_exp_f32 v86, v86
  s_waitcnt lgkmcnt(2)
  v_mfma_f32_32x32x16_bf16 v[64:79], v[40:43], v[192:195], 0
  v_exp_f32 v87, v87
  v_cvt_pk_bf16_f32 v106, v84, v85
  v_exp_f32 v88, v88
  v_exp_f32 v89, v89
  v_cvt_pk_bf16_f32 v107, v86, v87
  v_mfma_f32_32x32x16_bf16 v[64:79], v[44:47], v[196:199], v[64:79]
  v_exp_f32 v90, v90
  v_exp_f32 v91, v91
  ds_read_b128 v[32:35], v3 offset:8192
  v_cvt_pk_bf16_f32 v108, v88, v89
  v_exp_f32 v92, v92
  v_exp_f32 v93, v93
  ds_read_b128 v[36:39], v3 offset:9216
  v_cvt_pk_bf16_f32 v109, v90, v91
  v_exp_f32 v94, v94
  v_exp_f32 v95, v95
  v_cvt_pk_bf16_f32 v110, v92, v93
  v_cvt_pk_bf16_f32 v111, v94, v95
  v_mfma_f32_32x32x16_bf16 v[128:143], v[48:51], v[104:107], v[128:143]
  v_exp_f32 v64, v64
  v_exp_f32 v65, v65
  v_exp_f32 v66, v66
  v_exp_f32 v67, v67
  v_mfma_f32_32x32x16_bf16 v[128:143], v[52:55], v[108:111], v[128:143]
  v_cvt_pk_bf16_f32 v96, v64, v65
  v_exp_f32 v68, v68
  v_exp_f32 v69, v69
  v_cvt_pk_bf16_f32 v97, v66, v67
  v_exp_f32 v70, v70
  v_mfma_f32_32x32x16_bf16 v[80:95], v[40:43], v[200:203], 0
  v_exp_f32 v71, v71
  v_cvt_pk_bf16_f32 v98, v68, v69
  v_exp_f32 v72, v72
  v_exp_f32 v73, v73
  v_cvt_pk_bf16_f32 v99, v70, v71
  v_mfma_f32_32x32x16_bf16 v[80:95], v[44:47], v[204:207], v[80:95]
  v_exp_f32 v74, v74
  v_exp_f32 v75, v75
  ds_read_b128 v[48:51], v3 offset:40960
  v_cvt_pk_bf16_f32 v100, v72, v73
  v_exp_f32 v76, v76
  v_exp_f32 v77, v77
  ds_read_b128 v[52:55], v3 offset:41984
  v_cvt_pk_bf16_f32 v101, v74, v75
  v_exp_f32 v78, v78
  s_add_u32 m0, s31, 68608
  s_add_u32 s29, s53, s27
  s_add_u32 s29, s29, 3072
  buffer_load_dwordx4 v2, s[8:11], s29 offen sc1 lds
  v_exp_f32 v79, v79
  v_cvt_pk_bf16_f32 v102, v76, v77
  v_cvt_pk_bf16_f32 v103, v78, v79
  s_waitcnt lgkmcnt(4)
  v_mfma_f32_32x32x16_bf16 v[112:127], v[56:59], v[96:99], v[112:127]
  v_exp_f32 v80, v80
  v_exp_f32 v81, v81
  v_exp_f32 v82, v82
  v_exp_f32 v83, v83
  v_mfma_f32_32x32x16_bf16 v[112:127], v[60:63], v[100:103], v[112:127]
  v_cvt_pk_bf16_f32 v104, v80, v81
  v_exp_f32 v84, v84
  v_exp_f32 v85, v85
  v_cvt_pk_bf16_f32 v105, v82, v83
  v_exp_f32 v86, v86
  s_waitcnt lgkmcnt(2)
  v_mfma_f32_32x32x16_bf16 v[64:79], v[32:35], v[192:195], 0
  v_exp_f32 v87, v87
  v_cvt_pk_bf16_f32 v106, v84, v85
  v_exp_f32 v88, v88
  v_exp_f32 v89, v89
  v_cvt_pk_bf16_f32 v107, v86, v87
  v_mfma_f32_32x32x16_bf16 v[64:79], v[36:39], v[196:199], v[64:79]
  v_exp_f32 v90, v90
  v_exp_f32 v91, v91
  ds_read_b128 v[40:43], v3 offset:10240
  v_cvt_pk_bf16_f32 v108, v88, v89
  v_exp_f32 v92, v92
  v_exp_f32 v93, v93
  ds_read_b128 v[44:47], v3 offset:11264
  v_cvt_pk_bf16_f32 v109, v90, v91
  v_exp_f32 v94, v94
  v_exp_f32 v95, v95
  v_cvt_pk_bf16_f32 v110, v92, v93
  v_cvt_pk_bf16_f32 v111, v94, v95
  v_mfma_f32_32x32x16_bf16 v[128:143], v[56:59], v[104:107], v[128:143]
  v_exp_f32 v64, v64
  v_exp_f32 v65, v65
  v_exp_f32 v66, v66
  v_exp_f32 v67, v67
  v_mfma_f32_32x32x16_bf16 v[128:143], v[60:63], v[108:111], v[128:143]
  v_cvt_pk_bf16_f32 v96, v64, v65
  v_exp_f32 v68, v68
  v_exp_f32 v69, v69
  v_cvt_pk_bf16_f32 v97, v66, v67
  v_exp_f32 v70, v70
  v_mfma_f32_32x32x16_bf16 v[80:95], v[32:35], v[200:203], 0
  v_exp_f32 v71, v71
  v_cvt_pk_bf16_f32 v98, v68, v69
  v_exp_f32 v72, v72
  v_exp_f32 v73, v73
  v_cvt_pk_bf16_f32 v99, v70, v71
  v_mfma_f32_32x32x16_bf16 v[80:95], v[36:39], v[204:207], v[80:95]
  v_exp_f32 v74, v74
  v_exp_f32 v75, v75
  ds_read_b128 v[56:59], v3 offset:43008
  v_cvt_pk_bf16_f32 v100, v72, v73
  v_exp_f32 v76, v76
  v_exp_f32 v77, v77
  ds_read_b128 v[60:63], v3 offset:44032
  v_cvt_pk_bf16_f32 v101, v74, v75
  v_exp_f32 v78, v78
  s_add_u32 m0, s31, 69632
  s_add_u32 s29, s53, s27
  s_add_u32 s29, s29, 4096
  buffer_load_dwordx4 v2, s[8:11], s29 offen sc1 lds
  v_exp_f32 v79, v79
  v_cvt_pk_bf16_f32 v102, v76, v77
  v_cvt_pk_bf16_f32 v103, v78, v79
  s_waitcnt lgkmcnt(4)
  v_mfma_f32_32x32x16_bf16 v[112:127], v[48:51], v[96:99], v[112:127]
  v_exp_f32 v80, v80
  v_exp_f32 v81, v81
  v_exp_f32 v82, v82
  v_exp_f32 v83, v83
  v_mfma_f32_32x32x16_bf16 v[112:127], v[52:55], v[100:103], v[112:127]
  v_cvt_pk_bf16_f32 v104, v80, v81
  v_exp_f32 v84, v84
  v_exp_f32 v85, v85
  v_cvt_pk_bf16_f32 v105, v82, v83
  v_exp_f32 v86, v86
  s_waitcnt lgkmcnt(2)
  v_mfma_f32_32x32x16_bf16 v[64:79], v[40:43], v[192:195], 0
  v_exp_f32 v87, v87
  v_cvt_pk_bf16_f32 v106, v84, v85
  v_exp_f32 v88, v88
  v_exp_f32 v89, v89
  v_cvt_pk_bf16_f32 v107, v86, v87
  v_mfma_f32_32x32x16_bf16 v[64:79], v[44:47], v[196:199], v[64:79]
  v_exp_f32 v90, v90
  v_exp_f32 v91, v91
  ds_read_b128 v[32:35], v3 offset:12288
  v_cvt_pk_bf16_f32 v108, v88, v89
  v_exp_f32 v92, v92
  v_exp_f32 v93, v93
  ds_read_b128 v[36:39], v3 offset:13312
  v_cvt_pk_bf16_f32 v109, v90, v91
  v_exp_f32 v94, v94
  v_exp_f32 v95, v95
  v_cvt_pk_bf16_f32 v110, v92, v93
  v_cvt_pk_bf16_f32 v111, v94, v95
  v_mfma_f32_32x32x16_bf16 v[128:143], v[48:51], v[104:107], v[128:143]
  v_exp_f32 v64, v64
  v_exp_f32 v65, v65
  v_exp_f32 v66, v66
  v_exp_f32 v67, v67
  v_mfma_f32_32x32x16_bf16 v[128:143], v[52:55], v[108:111], v[128:143]
  v_cvt_pk_bf16_f32 v96, v64, v65
  v_exp_f32 v68, v68
  v_exp_f32 v69, v69
  v_cvt_pk_bf16_f32 v97, v66, v67
  v_exp_f32 v70, v70
  v_mfma_f32_32x32x16_bf16 v[80:95], v[40:43], v[200:203], 0
  v_exp_f32 v71, v71
  v_cvt_pk_bf16_f32 v98, v68, v69
  v_exp_f32 v72, v72
  v_exp_f32 v73, v73
  v_cvt_pk_bf16_f32 v99, v70, v71
  v_mfma_f32_32x32x16_bf16 v[80:95], v[44:47], v[204:207], v[80:95]
  v_exp_f32 v74, v74
  v_exp_f32 v75, v75
  ds_read_b128 v[48:51], v3 offset:45056
  v_cvt_pk_bf16_f32 v100, v72, v73
  v_exp_f32 v76, v76
  v_exp_f32 v77, v77
  ds_read_b128 v[52:55], v3 offset:46080
  v_cvt_pk_bf16_f32 v101, v74, v75
  v_exp_f32 v78, v78
  s_add_u32 m0, s31, 70656
  s_add_u32 s29, s53, s27
  s_add_u32 s29, s29, 5120
  buffer_load_dwordx4 v2, s[8:11], s29 offen sc1 lds
  v_exp_f32 v79, v79
  v_cvt_pk_bf16_f32 v102, v76, v77
  v_cvt_pk_bf16_f32 v103, v78, v79
  s_waitcnt lgkmcnt(4)
  v_mfma_f32_32x32x16_bf16 v[112:127], v[56:59], v[96:99], v[112:127]
  v_exp_f32 v80, v80
  v_exp_f32 v81, v81
  v_exp_f32 v82, v82
  v_exp_f32 v83, v83
  v_mfma_f32_32x32x16_bf16 v[112:127], v[60:63], v[100:103], v[112:127]
  v_cvt_pk_bf16_f32 v104, v80, v81
  v_exp_f32 v84, v84
  v_exp_f32 v85, v85
  v_cvt_pk_bf16_f32 v105, v82, v83
  v_exp_f32 v86, v86
  s_waitcnt lgkmcnt(2)
  v_mfma_f32_32x32x16_bf16 v[64:79], v[32:35], v[192:195], 0
  v_exp_f32 v87, v87
  v_cvt_pk_bf16_f32 v106, v84, v85
  v_exp_f32 v88, v88
  v_exp_f32 v89, v89
  v_cvt_pk_bf16_f32 v107, v86, v87
  v_mfma_f32_32x32x16_bf16 v[64:79], v[36:39], v[196:199], v[64:79]
  v_exp_f32 v90, v90
  v_exp_f32 v91, v91
  ds_read_b128 v[40:43], v3 offset:14336
  v_cvt_pk_bf16_f32 v108, v88, v89
  v_exp_f32 v92, v92
  v_exp_f32 v93, v93
  ds_read_b128 v[44:47], v3 offset:15360
  v_cvt_pk_bf16_f32 v109, v90, v91
  v_exp_f32 v94, v94
  v_exp_f32 v95, v95
  v_cvt_pk_bf16_f32 v110, v92, v93
  v_cvt_pk_bf16_f32 v111, v94, v95
  v_mfma_f32_32x32x16_bf16 v[128:143], v[56:59], v[104:107], v[128:143]
  v_exp_f32 v64, v64
  v_exp_f32 v65, v65
  v_exp_f32 v66, v66
  v_exp_f32 v67, v67
  v_mfma_f32_32x32x16_bf16 v[128:143], v[60:63], v[108:111], v[128:143]
  v_cvt_pk_bf16_f32 v96, v64, v65
  v_exp_f32 v68, v68
  v_exp_f32 v69, v69
  v_cvt_pk_bf16_f32 v97, v66, v67
  v_exp_f32 v70, v70
  v_mfma_f32_32x32x16_bf16 v[80:95], v[32:35], v[200:203], 0
  v_exp_f32 v71, v71
  v_cvt_pk_bf16_f32 v98, v68, v69
  v_exp_f32 v72, v72
  v_exp_f32 v73, v73
  v_cvt_pk_bf16_f32 v99, v70, v71
  v_mfma_f32_32x32x16_bf16 v[80:95], v[36:39], v[204:207], v[80:95]
  v_exp_f32 v74, v74
  v_exp_f32 v75, v75
  ds_read_b128 v[56:59], v3 offset:47104
  v_cvt_pk_bf16_f32 v100, v72, v73
  v_exp_f32 v76, v76
  v_exp_f32 v77, v77
  ds_read_b128 v[60:63], v3 offset:48128
  v_cvt_pk_bf16_f32 v101, v74, v75
  v_exp_f32 v78, v78
  s_add_u32 m0, s31, 71680
  s_add_u32 s29, s53, s27
  s_add_u32 s29, s29, 6144
  buffer_load_dwordx4 v2, s[8:11], s29 offen sc1 lds
  v_exp_f32 v79, v79
  v_cvt_pk_bf16_f32 v102, v76, v77
  v_cvt_pk_bf16_f32 v103, v78, v79
  s_waitcnt lgkmcnt(4)
  v_mfma_f32_32x32x16_bf16 v[112:127], v[48:51], v[96:99], v[112:127]
  v_exp_f32 v80, v80
  v_exp_f32 v81, v81
  v_exp_f32 v82, v82
  v_exp_f32 v83, v83
  v_mfma_f32_32x32x16_bf16 v[112:127], v[52:55], v[100:103], v[112:127]
  v_cvt_pk_bf16_f32 v104, v80, v81
  v_exp_f32 v84, v84
  v_exp_f32 v85, v85
  v_cvt_pk_bf16_f32 v105, v82, v83
  v_exp_f32 v86, v86
  s_waitcnt lgkmcnt(2)
  v_mfma_f32_32x32x16_bf16 v[64:79], v[40:43], v[192:195], 0
  v_exp_f32 v87, v87
  v_cvt_pk_bf16_f32 v106, v84, v85
  v_exp_f32 v88, v88
  v_exp_f32 v89, v89
  v_cvt_pk_bf16_f32 v107, v86, v87
  v_mfma_f32_32x32x16_bf16 v[64:79], v[44:47], v[196:199], v[64:79]
  v_exp_f32 v90, v90
  v_exp_f32 v91, v91
  ds_read_b128 v[32:35], v3 offset:16384
  v_cvt_pk_bf16_f32 v108, v88, v89
  v_exp_f32 v92, v92
  v_exp_f32 v93, v93
  ds_read_b128 v[36:39], v3 offset:17408
  v_cvt_pk_bf16_f32 v109, v90, v91
  v_exp_f32 v94, v94
  v_exp_f32 v95, v95
  v_cvt_pk_bf16_f32 v110, v92, v93
  v_cvt_pk_bf16_f32 v111, v94, v95
  v_mfma_f32_32x32x16_bf16 v[128:143], v[48:51], v[104:107], v[128:143]
  v_exp_f32 v64, v64
  v_exp_f32 v65, v65
  v_exp_f32 v66, v66
  v_exp_f32 v67, v67
  v_mfma_f32_32x32x16_bf16 v[128:143], v[52:55], v[108:111], v[128:143]
  v_cvt_pk_bf16_f32 v96, v64, v65
  v_exp_f32 v68, v68
  v_exp_f32 v69, v69
  v_cvt_pk_bf16_f32 v97, v66, v67
  v_exp_f32 v70, v70
  v_mfma_f32_32x32x16_bf16 v[80:95], v[40:43], v[200:203], 0
  v_exp_f32 v71, v71
  v_cvt_pk_bf16_f32 v98, v68, v69
  v_exp_f32 v72, v72
  v_exp_f32 v73, v73
  v_cvt_pk_bf16_f32 v99, v70, v71
  v_mfma_f32_32x32x16_bf16 v[80:95], v[44:47], v[204:207], v[80:95]
  v_exp_f32 v74, v74
  v_exp_f32 v75, v75
  ds_read_b128 v[48:51], v3 offset:49152
  v_cvt_pk_bf16_f32 v100, v72, v73
  v_exp_f32 v76, v76
  v_exp_f32 v77, v77
  ds_read_b128 v[52:55], v3 offset:50176
  v_cvt_pk_bf16_f32 v101, v74, v75
  v_exp_f32 v78, v78
  s_add_u32 m0, s31, 72704
  s_add_u32 s29, s53, s27
  s_add_u32 s29, s29, 7168
  buffer_load_dwordx4 v2, s[8:11], s29 offen sc1 lds
  v_exp_f32 v79, v79
  v_cvt_pk_bf16_f32 v102, v76, v77
  v_cvt_pk_bf16_f32 v103, v78, v79
  s_waitcnt lgkmcnt(4)
  v_mfma_f32_32x32x16_bf16 v[112:127], v[56:59], v[96:99], v[112:127]
  v_exp_f32 v80, v80
  v_exp_f32 v81, v81
  v_exp_f32 v82, v82
  v_exp_f32 v83, v83
  v_mfma_f32_32x32x16_bf16 v[112:127], v[60:63], v[100:103], v[112:127]
  v_cvt_pk_bf16_f32 v104, v80, v81
  v_exp_f32 v84, v84
  v_exp_f32 v85, v85
  v_cvt_pk_bf16_f32 v105, v82, v83
  v_exp_f32 v86, v86
  s_waitcnt lgkmcnt(2)
  v_mfma_f32_32x32x16_bf16 v[64:79], v[32:35], v[192:195], 0
  v_exp_f32 v87, v87
  v_cvt_pk_bf16_f32 v106, v84, v85
  v_exp_f32 v88, v88
  v_exp_f32 v89, v89
  v_cvt_pk_bf16_f32 v107, v86, v87
  v_mfma_f32_32x32x16_bf16 v[64:79], v[36:39], v[196:199], v[64:79]
  v_exp_f32 v90, v90
  v_exp_f32 v91, v91
  ds_read_b128 v[40:43], v3 offset:18432
  v_cvt_pk_bf16_f32 v108, v88, v89
  v_exp_f32 v92, v92
  v_exp_f32 v93, v93
  ds_read_b128 v[44:47], v3 offset:19456
  v_cvt_pk_bf16_f32 v109, v90, v91
  v_exp_f32 v94, v94
  v_exp_f32 v95, v95
  v_cvt_pk_bf16_f32 v110, v92, v93
  v_cvt_pk_bf16_f32 v111, v94, v95
  v_mfma_f32_32x32x16_bf16 v[128:143], v[56:59], v[104:107], v[128:143]
  v_exp_f32 v64, v64
  v_exp_f32 v65, v65
  v_exp_f32 v66, v66
  v_exp_f32 v67, v67
  v_mfma_f32_32x32x16_bf16 v[128:143], v[60:63], v[108:111], v[128:143]
  v_cvt_pk_bf16_f32 v96, v64, v65
  v_exp_f32 v68, v68
  v_exp_f32 v69, v69
  v_cvt_pk_bf16_f32 v97, v66, v67
  v_exp_f32 v70, v70
  v_mfma_f32_32x32x16_bf16 v[80:95], v[32:35], v[200:203], 0
  v_exp_f32 v71, v71
  v_cvt_pk_bf16_f32 v98, v68, v69
  v_exp_f32 v72, v72
  v_exp_f32 v73, v73
  v_cvt_pk_bf16_f32 v99, v70, v71
  v_mfma_f32_32x32x16_bf16 v[80:95], v[36:39], v[204:207], v[80:95]
  v_exp_f32 v74, v74
  v_exp_f32 v75, v75
  ds_read_b128 v[56:59], v3 offset:51200
  v_cvt_pk_bf16_f32 v100, v72, v73
  v_exp_f32 v76, v76
  v_exp_f32 v77, v77
  ds_read_b128 v[60:63], v3 offset:52224
  v_cvt_pk_bf16_f32 v101, v74, v75
  v_exp_f32 v78, v78
  s_add_u32 m0, s31, 98304
  s_add_u32 s29, s53, s28
  s_add_u32 s29, s29, 0
  buffer_load_dwordx4 v2, s[8:11], s29 offen sc1 lds
  v_exp_f32 v79, v79
  v_cvt_pk_bf16_f32 v102, v76, v77
  v_cvt_pk_bf16_f32 v103, v78, v79
  s_waitcnt lgkmcnt(4)
  v_mfma_f32_32x32x16_bf16 v[112:127], v[48:51], v[96:99], v[112:127]
  v_exp_f32 v80, v80
  v_exp_f32 v81, v81
  v_exp_f32 v82, v82
  v_exp_f32 v83, v83
  v_mfma_f32_32x32x16_bf16 v[112:127], v[52:55], v[100:103], v[112:127]
  v_cvt_pk_bf16_f32 v104, v80, v81
  v_exp_f32 v84, v84
  v_exp_f32 v85, v85
  v_cvt_pk_bf16_f32 v105, v82, v83
  v_exp_f32 v86, v86
  s_waitcnt lgkmcnt(2)
  v_mfma_f32_32x32x16_bf16 v[64:79], v[40:43], v[192:195], 0
  v_exp_f32 v87, v87
  v_cvt_pk_bf16_f32 v106, v84, v85
  v_exp_f32 v88, v88
  v_exp_f32 v89, v89
  v_cvt_pk_bf16_f32 v107, v86, v87
  v_mfma_f32_32x32x16_bf16 v[64:79], v[44:47], v[196:199], v[64:79]
  v_exp_f32 v90, v90
  v_exp_f32 v91, v91
  ds_read_b128 v[32:35], v3 offset:20480
  v_cvt_pk_bf16_f32 v108, v88, v89
  v_exp_f32 v92, v92
  v_exp_f32 v93, v93
  ds_read_b128 v[36:39], v3 offset:21504
  v_cvt_pk_bf16_f32 v109, v90, v91
  v_exp_f32 v94, v94
  v_exp_f32 v95, v95
  v_cvt_pk_bf16_f32 v110, v92, v93
  v_cvt_pk_bf16_f32 v111, v94, v95
  v_mfma_f32_32x32x16_bf16 v[128:143], v[48:51], v[104:107], v[128:143]
  v_exp_f32 v64, v64
  v_exp_f32 v65, v65
  v_exp_f32 v66, v66
  v_exp_f32 v67, v67
  v_mfma_f32_32x32x16_bf16 v[128:143], v[52:55], v[108:111], v[128:143]
  v_cvt_pk_bf16_f32 v96, v64, v65
  v_exp_f32 v68, v68
  v_exp_f32 v69, v69
  v_cvt_pk_bf16_f32 v97, v66, v67
  v_exp_f32 v70, v70
  v_mfma_f32_32x32x16_bf16 v[80:95], v[40:43], v[200:203], 0
  v_exp_f32 v71, v71
  v_cvt_pk_bf16_f32 v98, v68, v69
  v_exp_f32 v72, v72
  v_exp_f32 v73, v73
  v_cvt_pk_bf16_f32 v99, v70, v71
  v_mfma_f32_32x32x16_bf16 v[80:95], v[44:47], v[204:207], v[80:95]
  v_exp_f32 v74, v74
  v_exp_f32 v75, v75
  ds_read_b128 v[48:51], v3 offset:53248
  v_cvt_pk_bf16_f32 v100, v72, v73
  v_exp_f32 v76, v76
  v_exp_f32 v77, v77
  ds_read_b128 v[52:55], v3 offset:54272
  v_cvt_pk_bf16_f32 v101, v74, v75
  v_exp_f32 v78, v78
  s_add_u32 m0, s31, 99328
  s_add_u32 s29, s53, s28
  s_add_u32 s29, s29, 1024
  buffer_load_dwordx4 v2, s[8:11], s29 offen sc1 lds
  v_exp_f32 v79, v79
  v_cvt_pk_bf16_f32 v102, v76, v77
  v_cvt_pk_bf16_f32 v103, v78, v79
  s_waitcnt lgkmcnt(4)
  v_mfma_f32_32x32x16_bf16 v[112:127], v[56:59], v[96:99], v[112:127]
  v_exp_f32 v80, v80
  v_exp_f32 v81, v81
  v_exp_f32 v82, v82
  v_exp_f32 v83, v83
  v_mfma_f32_32x32x16_bf16 v[112:127], v[60:63], v[100:103], v[112:127]
  v_cvt_pk_bf16_f32 v104, v80, v81
  v_exp_f32 v84, v84
  v_exp_f32 v85, v85
  v_cvt_pk_bf16_f32 v105, v82, v83
  v_exp_f32 v86, v86
  s_waitcnt lgkmcnt(2)
  v_mfma_f32_32x32x16_bf16 v[64:79], v[32:35], v[192:195], 0
  v_exp_f32 v87, v87
  v_cvt_pk_bf16_f32 v106, v84, v85
  v_exp_f32 v88, v88
  v_exp_f32 v89, v89
  v_cvt_pk_bf16_f32 v107, v86, v87
  v_mfma_f32_32x32x16_bf16 v[64:79], v[36:39], v[196:199], v[64:79]
  v_exp_f32 v90, v90
  v_exp_f32 v91, v91
  ds_read_b128 v[40:43], v3 offset:22528
  v_cvt_pk_bf16_f32 v108, v88, v89
  v_exp_f32 v92, v92
  v_exp_f32 v93, v93
  ds_read_b128 v[44:47], v3 offset:23552
  v_cvt_pk_bf16_f32 v109, v90, v91
  v_exp_f32 v94, v94
  v_exp_f32 v95, v95
  v_cvt_pk_bf16_f32 v110, v92, v93
  v_cvt_pk_bf16_f32 v111, v94, v95
  v_mfma_f32_32x32x16_bf16 v[128:143], v[56:59], v[104:107], v[128:143]
  v_exp_f32 v64, v64
  v_exp_f32 v65, v65
  v_exp_f32 v66, v66
  v_exp_f32 v67, v67
  v_mfma_f32_32x32x16_bf16 v[128:143], v[60:63], v[108:111], v[128:143]
  v_cvt_pk_bf16_f32 v96, v64, v65
  v_exp_f32 v68, v68
  v_exp_f32 v69, v69
  v_cvt_pk_bf16_f32 v97, v66, v67
  v_exp_f32 v70, v70
  v_mfma_f32_32x32x16_bf16 v[80:95], v[32:35], v[200:203], 0
  v_exp_f32 v71, v71
  v_cvt_pk_bf16_f32 v98, v68, v69
  v_exp_f32 v72, v72
  v_exp_f32 v73, v73
  v_cvt_pk_bf16_f32 v99, v70, v71
  v_mfma_f32_32x32x16_bf16 v[80:95], v[36:39], v[204:207], v[80:95]
  v_exp_f32 v74, v74
  v_exp_f32 v75, v75
  ds_read_b128 v[56:59], v3 offset:55296
  v_cvt_pk_bf16_f32 v100, v72, v73
  v_exp_f32 v76, v76
  v_exp_f32 v77, v77
  ds_read_b128 v[60:63], v3 offset:56320
  v_cvt_pk_bf16_f32 v101, v74, v75
  v_exp_f32 v78, v78
  s_add_u32 m0, s31, 100352
  s_add_u32 s29, s53, s28
  s_add_u32 s29, s29, 2048
  buffer_load_dwordx4 v2, s[8:11], s29 offen sc1 lds
  v_exp_f32 v79, v79
  v_cvt_pk_bf16_f32 v102, v76, v77
  v_cvt_pk_bf16_f32 v103, v78, v79
  s_waitcnt lgkmcnt(4)
  v_mfma_f32_32x32x16_bf16 v[112:127], v[48:51], v[96:99], v[112:127]
  v_exp_f32 v80, v80
  v_exp_f32 v81, v81
  v_exp_f32 v82, v82
  v_exp_f32 v83, v83
  v_mfma_f32_32x32x16_bf16 v[112:127], v[52:55], v[100:103], v[112:127]
  v_cvt_pk_bf16_f32 v104, v80, v81
  v_exp_f32 v84, v84
  v_exp_f32 v85, v85
  v_cvt_pk_bf16_f32 v105, v82, v83
  v_exp_f32 v86, v86
  s_waitcnt lgkmcnt(2)
  v_mfma_f32_32x32x16_bf16 v[64:79], v[40:43], v[192:195], 0
  v_exp_f32 v87, v87
  v_cvt_pk_bf16_f32 v106, v84, v85
  v_exp_f32 v88, v88
  v_exp_f32 v89, v89
  v_cvt_pk_bf16_f32 v107, v86, v87
  v_mfma_f32_32x32x16_bf16 v[64:79], v[44:47], v[196:199], v[64:79]
  v_exp_f32 v90, v90
  v_exp_f32 v91, v91
  ds_read_b128 v[32:35], v3 offset:24576
  v_cvt_pk_bf16_f32 v108, v88, v89
  v_exp_f32 v92, v92
  v_exp_f32 v93, v93
  ds_read_b128 v[36:39], v3 offset:25600
  v_cvt_pk_bf16_f32 v109, v90, v91
  v_exp_f32 v94, v94
  v_exp_f32 v95, v95
  v_cvt_pk_bf16_f32 v110, v92, v93
  v_cvt_pk_bf16_f32 v111, v94, v95
  v_mfma_f32_32x32x16_bf16 v[128:143], v[48:51], v[104:107], v[128:143]
  v_exp_f32 v64, v64
  v_exp_f32 v65, v65
  v_exp_f32 v66, v66
  v_exp_f32 v67, v67
  v_mfma_f32_32x32x16_bf16 v[128:143], v[52:55], v[108:111], v[128:143]
  v_cvt_pk_bf16_f32 v96, v64, v65
  v_exp_f32 v68, v68
  v_exp_f32 v69, v69
  v_cvt_pk_bf16_f32 v97, v66, v67
  v_exp_f32 v70, v70
  v_mfma_f32_32x32x16_bf16 v[80:95], v[40:43], v[200:203], 0
  v_exp_f32 v71, v71
  v_cvt_pk_bf16_f32 v98, v68, v69
  v_exp_f32 v72, v72
  v_exp_f32 v73, v73
  v_cvt_pk_bf16_f32 v99, v70, v71
  v_mfma_f32_32x32x16_bf16 v[80:95], v[44:47], v[204:207], v[80:95]
  v_exp_f32 v74, v74
  v_exp_f32 v75, v75
  ds_read_b128 v[48:51], v3 offset:57344
  v_cvt_pk_bf16_f32 v100, v72, v73
  v_exp_f32 v76, v76
  v_exp_f32 v77, v77
  ds_read_b128 v[52:55], v3 offset:58368
  v_cvt_pk_bf16_f32 v101, v74, v75
  v_exp_f32 v78, v78
  s_add_u32 m0, s31, 101376
  s_add_u32 s29, s53, s28
  s_add_u32 s29, s29, 3072
  buffer_load_dwordx4 v2, s[8:11], s29 offen sc1 lds
  v_exp_f32 v79, v79
  v_cvt_pk_bf16_f32 v102, v76, v77
  v_cvt_pk_bf16_f32 v103, v78, v79
  s_waitcnt lgkmcnt(4)
  v_mfma_f32_32x32x16_bf16 v[112:127], v[56:59], v[96:99], v[112:127]
  v_exp_f32 v80, v80
  v_exp_f32 v81, v81
  v_exp_f32 v82, v82
  v_exp_f32 v83, v83
  v_mfma_f32_32x32x16_bf16 v[112:127], v[60:63], v[100:103], v[112:127]
  v_cvt_pk_bf16_f32 v104, v80, v81
  v_exp_f32 v84, v84
  v_exp_f32 v85, v85
  v_cvt_pk_bf16_f32 v105, v82, v83
  v_exp_f32 v86, v86
  s_waitcnt lgkmcnt(2)
  v_mfma_f32_32x32x16_bf16 v[64:79], v[32:35], v[192:195], 0
  v_exp_f32 v87, v87
  v_cvt_pk_bf16_f32 v106, v84, v85
  v_exp_f32 v88, v88
  v_exp_f32 v89, v89
  v_cvt_pk_bf16_f32 v107, v86, v87
  v_mfma_f32_32x32x16_bf16 v[64:79], v[36:39], v[196:199], v[64:79]
  v_exp_f32 v90, v90
  v_exp_f32 v91, v91
  ds_read_b128 v[40:43], v3 offset:26624
  v_cvt_pk_bf16_f32 v108, v88, v89
  v_exp_f32 v92, v92
  v_exp_f32 v93, v93
  ds_read_b128 v[44:47], v3 offset:27648
  v_cvt_pk_bf16_f32 v109, v90, v91
  v_exp_f32 v94, v94
  v_exp_f32 v95, v95
  v_cvt_pk_bf16_f32 v110, v92, v93
  v_cvt_pk_bf16_f32 v111, v94, v95
  v_mfma_f32_32x32x16_bf16 v[128:143], v[56:59], v[104:107], v[128:143]
  v_exp_f32 v64, v64
  v_exp_f32 v65, v65
  v_exp_f32 v66, v66
  v_exp_f32 v67, v67
  v_mfma_f32_32x32x16_bf16 v[128:143], v[60:63], v[108:111], v[128:143]
  v_cvt_pk_bf16_f32 v96, v64, v65
  v_exp_f32 v68, v68
  v_exp_f32 v69, v69
  v_cvt_pk_bf16_f32 v97, v66, v67
  v_exp_f32 v70, v70
  v_mfma_f32_32x32x16_bf16 v[80:95], v[32:35], v[200:203], 0
  v_exp_f32 v71, v71
  v_cvt_pk_bf16_f32 v98, v68, v69
  v_exp_f32 v72, v72
  v_exp_f32 v73, v73
  v_cvt_pk_bf16_f32 v99, v70, v71
  v_mfma_f32_32x32x16_bf16 v[80:95], v[36:39], v[204:207], v[80:95]
  v_exp_f32 v74, v74
  v_exp_f32 v75, v75
  ds_read_b128 v[56:59], v3 offset:59392
  v_cvt_pk_bf16_f32 v100, v72, v73
  v_exp_f32 v76, v76
  v_exp_f32 v77, v77
  ds_read_b128 v[60:63], v3 offset:60416
  v_cvt_pk_bf16_f32 v101, v74, v75
  v_exp_f32 v78, v78
  s_add_u32 m0, s31, 102400
  s_add_u32 s29, s53, s28
  s_add_u32 s29, s29, 4096
  buffer_load_dwordx4 v2, s[8:11], s29 offen sc1 lds
  v_exp_f32 v79, v79
  v_cvt_pk_bf16_f32 v102, v76, v77
  v_cvt_pk_bf16_f32 v103, v78, v79
  s_waitcnt lgkmcnt(4)
  v_mfma_f32_32x32x16_bf16 v[112:127], v[48:51], v[96:99], v[112:127]
  v_exp_f32 v80, v80
  v_exp_f32 v81, v81
  v_exp_f32 v82, v82
  v_exp_f32 v83, v83
  v_mfma_f32_32x32x16_bf16 v[112:127], v[52:55], v[100:103], v[112:127]
  v_cvt_pk_bf16_f32 v104, v80, v81
  v_exp_f32 v84, v84
  v_exp_f32 v85, v85
  v_cvt_pk_bf16_f32 v105, v82, v83
  v_exp_f32 v86, v86
  s_waitcnt lgkmcnt(2)
  v_mfma_f32_32x32x16_bf16 v[64:79], v[40:43], v[192:195], 0
  v_exp_f32 v87, v87
  v_cvt_pk_bf16_f32 v106, v84, v85
  v_exp_f32 v88, v88
  v_exp_f32 v89, v89
  v_cvt_pk_bf16_f32 v107, v86, v87
  v_mfma_f32_32x32x16_bf16 v[64:79], v[44:47], v[196:199], v[64:79]
  v_exp_f32 v90, v90
  v_exp_f32 v91, v91
  ds_read_b128 v[32:35], v3 offset:28672
  v_cvt_pk_bf16_f32 v108, v88, v89
  v_exp_f32 v92, v92
  v_exp_f32 v93, v93
  ds_read_b128 v[36:39], v3 offset:29696
  v_cvt_pk_bf16_f32 v109, v90, v91
  v_exp_f32 v94, v94
  v_exp_f32 v95, v95
  v_cvt_pk_bf16_f32 v110, v92, v93
  v_cvt_pk_bf16_f32 v111, v94, v95
  v_mfma_f32_32x32x16_bf16 v[128:143], v[48:51], v[104:107], v[128:143]
  v_exp_f32 v64, v64
  v_exp_f32 v65, v65
  v_exp_f32 v66, v66
  v_exp_f32 v67, v67
  v_mfma_f32_32x32x16_bf16 v[128:143], v[52:55], v[108:111], v[128:143]
  v_cvt_pk_bf16_f32 v96, v64, v65
  v_exp_f32 v68, v68
  v_exp_f32 v69, v69
  v_cvt_pk_bf16_f32 v97, v66, v67
  v_exp_f32 v70, v70
  v_mfma_f32_32x32x16_bf16 v[80:95], v[40:43], v[200:203], 0
  v_exp_f32 v71, v71
  v_cvt_pk_bf16_f32 v98, v68, v69
  v_exp_f32 v72, v72
  v_exp_f32 v73, v73
  v_cvt_pk_bf16_f32 v99, v70, v71
  v_mfma_f32_32x32x16_bf16 v[80:95], v[44:47], v[204:207], v[80:95]
  v_exp_f32 v74, v74
  v_exp_f32 v75, v75
  ds_read_b128 v[48:51], v3 offset:61440
  v_cvt_pk_bf16_f32 v100, v72, v73
  v_exp_f32 v76, v76
  v_exp_f32 v77, v77
  ds_read_b128 v[52:55], v3 offset:62464
  v_cvt_pk_bf16_f32 v101, v74, v75
  v_exp_f32 v78, v78
  s_add_u32 m0, s31, 103424
  s_add_u32 s29, s53, s28
  s_add_u32 s29, s29, 5120
  buffer_load_dwordx4 v2, s[8:11], s29 offen sc1 lds
  v_exp_f32 v79, v79
  v_cvt_pk_bf16_f32 v102, v76, v77
  v_cvt_pk_bf16_f32 v103, v78, v79
  s_waitcnt lgkmcnt(4)
  v_mfma_f32_32x32x16_bf16 v[112:127], v[56:59], v[96:99], v[112:127]
  v_exp_f32 v80, v80
  v_exp_f32 v81, v81
  v_exp_f32 v82, v82
  v_exp_f32 v83, v83
  v_mfma_f32_32x32x16_bf16 v[112:127], v[60:63], v[100:103], v[112:127]
  v_cvt_pk_bf16_f32 v104, v80, v81
  v_exp_f32 v84, v84
  v_exp_f32 v85, v85
  v_cvt_pk_bf16_f32 v105, v82, v83
  v_exp_f32 v86, v86
  s_waitcnt lgkmcnt(2)
  v_mfma_f32_32x32x16_bf16 v[64:79], v[32:35], v[192:195], 0
  v_exp_f32 v87, v87
  v_cvt_pk_bf16_f32 v106, v84, v85
  v_exp_f32 v88, v88
  v_exp_f32 v89, v89
  v_cvt_pk_bf16_f32 v107, v86, v87
  v_mfma_f32_32x32x16_bf16 v[64:79], v[36:39], v[196:199], v[64:79]
  v_exp_f32 v90, v90
  v_exp_f32 v91, v91
  ds_read_b128 v[40:43], v3 offset:30720
  v_cvt_pk_bf16_f32 v108, v88, v89
  v_exp_f32 v92, v92
  v_exp_f32 v93, v93
  ds_read_b128 v[44:47], v3 offset:31744
  v_cvt_pk_bf16_f32 v109, v90, v91
  v_exp_f32 v94, v94
  v_exp_f32 v95, v95
  v_cvt_pk_bf16_f32 v110, v92, v93
  v_cvt_pk_bf16_f32 v111, v94, v95
  v_mfma_f32_32x32x16_bf16 v[128:143], v[56:59], v[104:107], v[128:143]
  v_exp_f32 v64, v64
  v_exp_f32 v65, v65
  v_exp_f32 v66, v66
  v_exp_f32 v67, v67
  v_mfma_f32_32x32x16_bf16 v[128:143], v[60:63], v[108:111], v[128:143]
  v_cvt_pk_bf16_f32 v96, v64, v65
  v_exp_f32 v68, v68
  v_exp_f32 v69, v69
  v_cvt_pk_bf16_f32 v97, v66, v67
  v_exp_f32 v70, v70
  v_mfma_f32_32x32x16_bf16 v[80:95], v[32:35], v[200:203], 0
  v_exp_f32 v71, v71
  v_cvt_pk_bf16_f32 v98, v68, v69
  v_exp_f32 v72, v72
  v_exp_f32 v73, v73
  v_cvt_pk_bf16_f32 v99, v70, v71
  v_mfma_f32_32x32x16_bf16 v[80:95], v[36:39], v[204:207], v[80:95]
  v_exp_f32 v74, v74
  v_exp_f32 v75, v75
  ds_read_b128 v[56:59], v3 offset:63488
  v_cvt_pk_bf16_f32 v100, v72, v73
  v_exp_f32 v76, v76
  v_exp_f32 v77, v77
  ds_read_b128 v[60:63], v3 offset:64512
  v_cvt_pk_bf16_f32 v101, v74, v75
  v_exp_f32 v78, v78
  s_add_u32 m0, s31, 104448
  s_add_u32 s29, s53, s28
  s_add_u32 s29, s29, 6144
  buffer_load_dwordx4 v2, s[8:11], s29 offen sc1 lds
  v_exp_f32 v79, v79
  v_cvt_pk_bf16_f32 v102, v76, v77
  v_cvt_pk_bf16_f32 v103, v78, v79
  s_waitcnt lgkmcnt(4)
  v_mfma_f32_32x32x16_bf16 v[112:127], v[48:51], v[96:99], v[112:127]
  v_exp_f32 v80, v80
  v_exp_f32 v81, v81
  v_exp_f32 v82, v82
  v_exp_f32 v83, v83
  v_mfma_f32_32x32x16_bf16 v[112:127], v[52:55], v[100:103], v[112:127]
  v_cvt_pk_bf16_f32 v104, v80, v81
  v_exp_f32 v84, v84
  v_exp_f32 v85, v85
  v_cvt_pk_bf16_f32 v105, v82, v83
  v_exp_f32 v86, v86
  s_waitcnt lgkmcnt(2)
  v_mfma_f32_32x32x16_bf16 v[64:79], v[40:43], v[192:195], 0
  v_exp_f32 v87, v87
  v_cvt_pk_bf16_f32 v106, v84, v85
  v_exp_f32 v88, v88
  v_exp_f32 v89, v89
  v_cvt_pk_bf16_f32 v107, v86, v87
  v_mfma_f32_32x32x16_bf16 v[64:79], v[44:47], v[196:199], v[64:79]
  v_exp_f32 v90, v90
  v_exp_f32 v91, v91
  v_cvt_pk_bf16_f32 v108, v88, v89
  v_exp_f32 v92, v92
  v_exp_f32 v93, v93
  v_cvt_pk_bf16_f32 v109, v90, v91
  v_exp_f32 v94, v94
  v_exp_f32 v95, v95
  v_cvt_pk_bf16_f32 v110, v92, v93
  v_cvt_pk_bf16_f32 v111, v94, v95
  v_mfma_f32_32x32x16_bf16 v[128:143], v[48:51], v[104:107], v[128:143]
  v_exp_f32 v64, v64
  v_exp_f32 v65, v65
  v_exp_f32 v66, v66
  v_exp_f32 v67, v67
  v_mfma_f32_32x32x16_bf16 v[128:143], v[52:55], v[108:111], v[128:143]
  v_cvt_pk_bf16_f32 v96, v64, v65
  v_exp_f32 v68, v68
  v_exp_f32 v69, v69
  v_cvt_pk_bf16_f32 v97, v66, v67
  v_exp_f32 v70, v70
  v_mfma_f32_32x32x16_bf16 v[80:95], v[40:43], v[200:203], 0
  v_exp_f32 v71, v71
  v_cvt_pk_bf16_f32 v98, v68, v69
  v_exp_f32 v72, v72
  v_exp_f32 v73, v73
  v_cvt_pk_bf16_f32 v99, v70, v71
  v_mfma_f32_32x32x16_bf16 v[80:95], v[44:47], v[204:207], v[80:95]
  v_exp_f32 v74, v74
  v_exp_f32 v75, v75
  v_cvt_pk_bf16_f32 v100, v72, v73
  v_exp_f32 v76, v76
  v_exp_f32 v77, v77
  v_cvt_pk_bf16_f32 v101, v74, v75
  v_exp_f32 v78, v78
  s_add_u32 m0, s31, 105472
  s_add_u32 s29, s53, s28
  s_add_u32 s29, s29, 7168
  buffer_load_dwordx4 v2, s[8:11], s29 offen sc1 lds
  v_exp_f32 v79, v79
  v_cvt_pk_bf16_f32 v102, v76, v77
  v_cvt_pk_bf16_f32 v103, v78, v79
  s_waitcnt lgkmcnt(0)
  v_mfma_f32_32x32x16_bf16 v[112:127], v[56:59], v[96:99], v[112:127]
  v_exp_f32 v80, v80
  v_exp_f32 v81, v81
  v_exp_f32 v82, v82
  v_exp_f32 v83, v83
  v_mfma_f32_32x32x16_bf16 v[112:127], v[60:63], v[100:103], v[112:127]
  v_cvt_pk_bf16_f32 v104, v80, v81
  v_exp_f32 v84, v84
  v_exp_f32 v85, v85
  v_cvt_pk_bf16_f32 v105, v82, v83
  v_exp_f32 v86, v86
  v_exp_f32 v87, v87
  v_cvt_pk_bf16_f32 v106, v84, v85
  v_exp_f32 v88, v88
  v_exp_f32 v89, v89
  v_cvt_pk_bf16_f32 v107, v86, v87
  v_exp_f32 v90, v90
  v_exp_f32 v91, v91
  v_cvt_pk_bf16_f32 v108, v88, v89
  v_exp_f32 v92, v92
  v_exp_f32 v93, v93
  v_cvt_pk_bf16_f32 v109, v90, v91
  v_exp_f32 v94, v94
  v_exp_f32 v95, v95
  v_cvt_pk_bf16_f32 v110, v92, v93
  v_cvt_pk_bf16_f32 v111, v94, v95
  s_nop 1
  v_mfma_f32_32x32x16_bf16 v[128:143], v[56:59], v[104:107], v[128:143]
  v_mfma_f32_32x32x16_bf16 v[128:143], v[60:63], v[108:111], v[128:143]
  s_waitcnt vmcnt(0)
  s_barrier
  s_add_u32 s41, s41, 1
  s_min_u32 s29, s41, 3
  s_mul_i32 s53, s29, 32768
  s_lshl_b32 s31, s21, 13
  s_add_u32 s53, s53, s31
  ds_read_b128 v[32:35], v4 offset:0
  ds_read_b128 v[36:39], v4 offset:1024
  ds_read_b128 v[48:51], v4 offset:32768
  ds_read_b128 v[52:55], v4 offset:33792
  ds_read_b128 v[40:43], v4 offset:2048
  ds_read_b128 v[44:47], v4 offset:3072
  s_waitcnt lgkmcnt(4)
  v_mfma_f32_32x32x16_bf16 v[64:79], v[32:35], v[192:195], 0
  v_mfma_f32_32x32x16_bf16 v[64:79], v[36:39], v[196:199], v[64:79]
  s_nop 11
  v_exp_f32 v64, v64
  v_exp_f32 v65, v65
  v_exp_f32 v66, v66
  v_exp_f32 v67, v67
  v_cvt_pk_bf16_f32 v96, v64, v65
  v_exp_f32 v68, v68
  v_exp_f32 v69, v69
  v_cvt_pk_bf16_f32 v97, v66, v67
  v_exp_f32 v70, v70
  v_mfma_f32_32x32x16_bf16 v[80:95], v[32:35], v[200:203], 0
  v_exp_f32 v71, v71
  v_cvt_pk_bf16_f32 v98, v68, v69
  v_exp_f32 v72, v72
  v_exp_f32 v73, v73
  v_cvt_pk_bf16_f32 v99, v70, v71
  v_mfma_f32_32x32x16_bf16 v[80:95], v[36:39], v[204:207], v[80:95]
  v_exp_f32 v74, v74
  v_exp_f32 v75, v75
  ds_read_b128 v[56:59], v4 offset:34816
  v_cvt_pk_bf16_f32 v100, v72, v73
  v_exp_f32 v76, v76
  v_exp_f32 v77, v77
  ds_read_b128 v[60:63], v4 offset:35840
  v_cvt_pk_bf16_f32 v101, v74, v75
  v_exp_f32 v78, v78
  s_add_u32 m0, s31, 0
  s_add_u32 s29, s53, s27
  s_add_u32 s29, s29, 0
  buffer_load_dwordx4 v2, s[8:11], s29 offen sc1 lds
  v_exp_f32 v79, v79
  v_cvt_pk_bf16_f32 v102, v76, v77
  v_cvt_pk_bf16_f32 v103, v78, v79
  s_waitcnt lgkmcnt(4)
  v_mfma_f32_32x32x16_bf16 v[112:127], v[48:51], v[96:99], v[112:127]
  v_exp_f32 v80, v80
  v_exp_f32 v81, v81
  v_exp_f32 v82, v82
  v_exp_f32 v83, v83
  v_mfma_f32_32x32x16_bf16 v[112:127], v[52:55], v[100:103], v[112:127]
  v_cvt_pk_bf16_f32 v104, v80, v81
  v_exp_f32 v84, v84
  v_exp_f32 v85, v85
  v_cvt_pk_bf16_f32 v105, v82, v83
  v_exp_f32 v86, v86
  s_waitcnt lgkmcnt(2)
  v_mfma_f32_32x32x16_bf16 v[64:79], v[40:43], v[192:195], 0
  v_exp_f32 v87, v87
  v_cvt_pk_bf16_f32 v106, v84, v85
  v_exp_f32 v88, v88
  v_exp_f32 v89, v89
  v_cvt_pk_bf16_f32 v107, v86, v87
  v_mfma_f32_32x32x16_bf16 v[64:79], v[44:47], v[196:199], v[64:79]
  v_exp_f32 v90, v90
  v_exp_f32 v91, v91
  ds_read_b128 v[32:35], v4 offset:4096
  v_cvt_pk_bf16_f32 v108, v88, v89
  v_exp_f32 v92, v92
  v_exp_f32 v93, v93
  ds_read_b128 v[36:39], v4 offset:5120
  v_cvt_pk_bf16_f32 v109, v90, v91
  v_exp_f32 v94, v94
  v_exp_f32 v95, v95
  v_cvt_pk_bf16_f32 v110, v92, v93
  v_cvt_pk_bf16_f32 v111, v94, v95
  v_mfma_f32_32x32x16_bf16 v[128:143], v[48:51], v[104:107], v[128:143]
  v_exp_f32 v64, v64
  v_exp_f32 v65, v65
  v_exp_f32 v66, v66
  v_exp_f32 v67, v67
  v_mfma_f32_32x32x16_bf16 v[128:143], v[52:55], v[108:111], v[128:143]
  v_cvt_pk_bf16_f32 v96, v64, v65
  v_exp_f32 v68, v68
  v_exp_f32 v69, v69
  v_cvt_pk_bf16_f32 v97, v66, v67
  v_exp_f32 v70, v70
  v_mfma_f32_32x32x16_bf16 v[80:95], v[40:43], v[200:203], 0
  v_exp_f32 v71, v71
  v_cvt_pk_bf16_f32 v98, v68, v69
  v_exp_f32 v72, v72
  v_exp_f32 v73, v73
  v_cvt_pk_bf16_f32 v99, v70, v71
  v_mfma_f32_32x32x16_bf16 v[80:95], v[44:47], v[204:207], v[80:95]
  v_exp_f32 v74, v74
  v_exp_f32 v75, v75
  ds_read_b128 v[48:51], v4 offset:36864
  v_cvt_pk_bf16_f32 v100, v72, v73
  v_exp_f32 v76, v76
  v_exp_f32 v77, v77
  ds_read_b128 v[52:55], v4 offset:37888
  v_cvt_pk_bf16_f32 v101, v74, v75
  v_exp_f32 v78, v78
  s_add_u32 m0, s31, 1024
  s_add_u32 s29, s53, s27
  s_add_u32 s29, s29, 1024
  buffer_load_dwordx4 v2, s[8:11], s29 offen sc1 lds
  v_exp_f32 v79, v79
  v_cvt_pk_bf16_f32 v102, v76, v77
  v_cvt_pk_bf16_f32 v103, v78, v79
  s_waitcnt lgkmcnt(4)
  v_mfma_f32_32x32x16_bf16 v[112:127], v[56:59], v[96:99], v[112:127]
  v_exp_f32 v80, v80
  v_exp_f32 v81, v81
  v_exp_f32 v82, v82
  v_exp_f32 v83, v83
  v_mfma_f32_32x32x16_bf16 v[112:127], v[60:63], v[100:103], v[112:127]
  v_cvt_pk_bf16_f32 v104, v80, v81
  v_exp_f32 v84, v84
  v_exp_f32 v85, v85
  v_cvt_pk_bf16_f32 v105, v82, v83
  v_exp_f32 v86, v86
  s_waitcnt lgkmcnt(2)
  v_mfma_f32_32x32x16_bf16 v[64:79], v[32:35], v[192:195], 0
  v_exp_f32 v87, v87
  v_cvt_pk_bf16_f32 v106, v84, v85
  v_exp_f32 v88, v88
  v_exp_f32 v89, v89
  v_cvt_pk_bf16_f32 v107, v86, v87
  v_mfma_f32_32x32x16_bf16 v[64:79], v[36:39], v[196:199], v[64:79]
  v_exp_f32 v90, v90
  v_exp_f32 v91, v91
  ds_read_b128 v[40:43], v4 offset:6144
  v_cvt_pk_bf16_f32 v108, v88, v89
  v_exp_f32 v92, v92
  v_exp_f32 v93, v93
  ds_read_b128 v[44:47], v4 offset:7168
  v_cvt_pk_bf16_f32 v109, v90, v91
  v_exp_f32 v94, v94
  v_exp_f32 v95, v95
  v_cvt_pk_bf16_f32 v110, v92, v93
  v_cvt_pk_bf16_f32 v111, v94, v95
  v_mfma_f32_32x32x16_bf16 v[128:143], v[56:59], v[104:107], v[128:143]
  v_exp_f32 v64, v64
  v_exp_f32 v65, v65
  v_exp_f32 v66, v66
  v_exp_f32 v67, v67
  v_mfma_f32_32x32x16_bf16 v[128:143], v[60:63], v[108:111], v[128:143]
  v_cvt_pk_bf16_f32 v96, v64, v65
  v_exp_f32 v68, v68
  v_exp_f32 v69, v69
  v_cvt_pk_bf16_f32 v97, v66, v67
  v_exp_f32 v70, v70
  v_mfma_f32_32x32x16_bf16 v[80:95], v[32:35], v[200:203], 0
  v_exp_f32 v71, v71
  v_cvt_pk_bf16_f32 v98, v68, v69
  v_exp_f32 v72, v72
  v_exp_f32 v73, v73
  v_cvt_pk_bf16_f32 v99, v70, v71
  v_mfma_f32_32x32x16_bf16 v[80:95], v[36:39], v[204:207], v[80:95]
  v_exp_f32 v74, v74
  v_exp_f32 v75, v75
  ds_read_b128 v[56:59], v4 offset:38912
  v_cvt_pk_bf16_f32 v100, v72, v73
  v_exp_f32 v76, v76
  v_exp_f32 v77, v77
  ds_read_b128 v[60:63], v4 offset:39936
  v_cvt_pk_bf16_f32 v101, v74, v75
  v_exp_f32 v78, v78
  s_add_u32 m0, s31, 2048
  s_add_u32 s29, s53, s27
  s_add_u32 s29, s29, 2048
  buffer_load_dwordx4 v2, s[8:11], s29 offen sc1 lds
  v_exp_f32 v79, v79
  v_cvt_pk_bf16_f32 v102, v76, v77
  v_cvt_pk_bf16_f32 v103, v78, v79
  s_waitcnt lgkmcnt(4)
  v_mfma_f32_32x32x16_bf16 v[112:127], v[48:51], v[96:99], v[112:127]
  v_exp_f32 v80, v80
  v_exp_f32 v81, v81
  v_exp_f32 v82, v82
  v_exp_f32 v83, v83
  v_mfma_f32_32x32x16_bf16 v[112:127], v[52:55], v[100:103], v[112:127]
  v_cvt_pk_bf16_f32 v104, v80, v81
  v_exp_f32 v84, v84
  v_exp_f32 v85, v85
  v_cvt_pk_bf16_f32 v105, v82, v83
  v_exp_f32 v86, v86
  s_waitcnt lgkmcnt(2)
  v_mfma_f32_32x32x16_bf16 v[64:79], v[40:43], v[192:195], 0
  v_exp_f32 v87, v87
  v_cvt_pk_bf16_f32 v106, v84, v85
  v_exp_f32 v88, v88
  v_exp_f32 v89, v89
  v_cvt_pk_bf16_f32 v107, v86, v87
  v_mfma_f32_32x32x16_bf16 v[64:79], v[44:47], v[196:199], v[64:79]
  v_exp_f32 v90, v90
  v_exp_f32 v91, v91
  ds_read_b128 v[32:35], v4 offset:8192
  v_cvt_pk_bf16_f32 v108, v88, v89
  v_exp_f32 v92, v92
  v_exp_f32 v93, v93
  ds_read_b128 v[36:39], v4 offset:9216
  v_cvt_pk_bf16_f32 v109, v90, v91
  v_exp_f32 v94, v94
  v_exp_f32 v95, v95
  v_cvt_pk_bf16_f32 v110, v92, v93
  v_cvt_pk_bf16_f32 v111, v94, v95
  v_mfma_f32_32x32x16_bf16 v[128:143], v[48:51], v[104:107], v[128:143]
  v_exp_f32 v64, v64
  v_exp_f32 v65, v65
  v_exp_f32 v66, v66
  v_exp_f32 v67, v67
  v_mfma_f32_32x32x16_bf16 v[128:143], v[52:55], v[108:111], v[128:143]
  v_cvt_pk_bf16_f32 v96, v64, v65
  v_exp_f32 v68, v68
  v_exp_f32 v69, v69
  v_cvt_pk_bf16_f32 v97, v66, v67
  v_exp_f32 v70, v70
  v_mfma_f32_32x32x16_bf16 v[80:95], v[40:43], v[200:203], 0
  v_exp_f32 v71, v71
  v_cvt_pk_bf16_f32 v98, v68, v69
  v_exp_f32 v72, v72
  v_exp_f32 v73, v73
  v_cvt_pk_bf16_f32 v99, v70, v71
  v_mfma_f32_32x32x16_bf16 v[80:95], v[44:47], v[204:207], v[80:95]
  v_exp_f32 v74, v74
  v_exp_f32 v75, v75
  ds_read_b128 v[48:51], v4 offset:40960
  v_cvt_pk_bf16_f32 v100, v72, v73
  v_exp_f32 v76, v76
  v_exp_f32 v77, v77
  ds_read_b128 v[52:55], v4 offset:41984
  v_cvt_pk_bf16_f32 v101, v74, v75
  v_exp_f32 v78, v78
  s_add_u32 m0, s31, 3072
  s_add_u32 s29, s53, s27
  s_add_u32 s29, s29, 3072
  buffer_load_dwordx4 v2, s[8:11], s29 offen sc1 lds
  v_exp_f32 v79, v79
  v_cvt_pk_bf16_f32 v102, v76, v77
  v_cvt_pk_bf16_f32 v103, v78, v79
  s_waitcnt lgkmcnt(4)
  v_mfma_f32_32x32x16_bf16 v[112:127], v[56:59], v[96:99], v[112:127]
  v_exp_f32 v80, v80
  v_exp_f32 v81, v81
  v_exp_f32 v82, v82
  v_exp_f32 v83, v83
  v_mfma_f32_32x32x16_bf16 v[112:127], v[60:63], v[100:103], v[112:127]
  v_cvt_pk_bf16_f32 v104, v80, v81
  v_exp_f32 v84, v84
  v_exp_f32 v85, v85
  v_cvt_pk_bf16_f32 v105, v82, v83
  v_exp_f32 v86, v86
  s_waitcnt lgkmcnt(2)
  v_mfma_f32_32x32x16_bf16 v[64:79], v[32:35], v[192:195], 0
  v_exp_f32 v87, v87
  v_cvt_pk_bf16_f32 v106, v84, v85
  v_exp_f32 v88, v88
  v_exp_f32 v89, v89
  v_cvt_pk_bf16_f32 v107, v86, v87
  v_mfma_f32_32x32x16_bf16 v[64:79], v[36:39], v[196:199], v[64:79]
  v_exp_f32 v90, v90
  v_exp_f32 v91, v91
  ds_read_b128 v[40:43], v4 offset:10240
  v_cvt_pk_bf16_f32 v108, v88, v89
  v_exp_f32 v92, v92
  v_exp_f32 v93, v93
  ds_read_b128 v[44:47], v4 offset:11264
  v_cvt_pk_bf16_f32 v109, v90, v91
  v_exp_f32 v94, v94
  v_exp_f32 v95, v95
  v_cvt_pk_bf16_f32 v110, v92, v93
  v_cvt_pk_bf16_f32 v111, v94, v95
  v_mfma_f32_32x32x16_bf16 v[128:143], v[56:59], v[104:107], v[128:143]
  v_exp_f32 v64, v64
  v_exp_f32 v65, v65
  v_exp_f32 v66, v66
  v_exp_f32 v67, v67
  v_mfma_f32_32x32x16_bf16 v[128:143], v[60:63], v[108:111], v[128:143]
  v_cvt_pk_bf16_f32 v96, v64, v65
  v_exp_f32 v68, v68
  v_exp_f32 v69, v69
  v_cvt_pk_bf16_f32 v97, v66, v67
  v_exp_f32 v70, v70
  v_mfma_f32_32x32x16_bf16 v[80:95], v[32:35], v[200:203], 0
  v_exp_f32 v71, v71
  v_cvt_pk_bf16_f32 v98, v68, v69
  v_exp_f32 v72, v72
  v_exp_f32 v73, v73
  v_cvt_pk_bf16_f32 v99, v70, v71
  v_mfma_f32_32x32x16_bf16 v[80:95], v[36:39], v[204:207], v[80:95]
  v_exp_f32 v74, v74
  v_exp_f32 v75, v75
  ds_read_b128 v[56:59], v4 offset:43008
  v_cvt_pk_bf16_f32 v100, v72, v73
  v_exp_f32 v76, v76
  v_exp_f32 v77, v77
  ds_read_b128 v[60:63], v4 offset:44032
  v_cvt_pk_bf16_f32 v101, v74, v75
  v_exp_f32 v78, v78
  s_add_u32 m0, s31, 4096
  s_add_u32 s29, s53, s27
  s_add_u32 s29, s29, 4096
  buffer_load_dwordx4 v2, s[8:11], s29 offen sc1 lds
  v_exp_f32 v79, v79
  v_cvt_pk_bf16_f32 v102, v76, v77
  v_cvt_pk_bf16_f32 v103, v78, v79
  s_waitcnt lgkmcnt(4)
  v_mfma_f32_32x32x16_bf16 v[112:127], v[48:51], v[96:99], v[112:127]
  v_exp_f32 v80, v80
  v_exp_f32 v81, v81
  v_exp_f32 v82, v82
  v_exp_f32 v83, v83
  v_mfma_f32_32x32x16_bf16 v[112:127], v[52:55], v[100:103], v[112:127]
  v_cvt_pk_bf16_f32 v104, v80, v81
  v_exp_f32 v84, v84
  v_exp_f32 v85, v85
  v_cvt_pk_bf16_f32 v105, v82, v83
  v_exp_f32 v86, v86
  s_waitcnt lgkmcnt(2)
  v_mfma_f32_32x32x16_bf16 v[64:79], v[40:43], v[192:195], 0
  v_exp_f32 v87, v87
  v_cvt_pk_bf16_f32 v106, v84, v85
  v_exp_f32 v88, v88
  v_exp_f32 v89, v89
  v_cvt_pk_bf16_f32 v107, v86, v87
  v_mfma_f32_32x32x16_bf16 v[64:79], v[44:47], v[196:199], v[64:79]
  v_exp_f32 v90, v90
  v_exp_f32 v91, v91
  ds_read_b128 v[32:35], v4 offset:12288
  v_cvt_pk_bf16_f32 v108, v88, v89
  v_exp_f32 v92, v92
  v_exp_f32 v93, v93
  ds_read_b128 v[36:39], v4 offset:13312
  v_cvt_pk_bf16_f32 v109, v90, v91
  v_exp_f32 v94, v94
  v_exp_f32 v95, v95
  v_cvt_pk_bf16_f32 v110, v92, v93
  v_cvt_pk_bf16_f32 v111, v94, v95
  v_mfma_f32_32x32x16_bf16 v[128:143], v[48:51], v[104:107], v[128:143]
  v_exp_f32 v64, v64
  v_exp_f32 v65, v65
  v_exp_f32 v66, v66
  v_exp_f32 v67, v67
  v_mfma_f32_32x32x16_bf16 v[128:143], v[52:55], v[108:111], v[128:143]
  v_cvt_pk_bf16_f32 v96, v64, v65
  v_exp_f32 v68, v68
  v_exp_f32 v69, v69
  v_cvt_pk_bf16_f32 v97, v66, v67
  v_exp_f32 v70, v70
  v_mfma_f32_32x32x16_bf16 v[80:95], v[40:43], v[200:203], 0
  v_exp_f32 v71, v71
  v_cvt_pk_bf16_f32 v98, v68, v69
  v_exp_f32 v72, v72
  v_exp_f32 v73, v73
  v_cvt_pk_bf16_f32 v99, v70, v71
  v_mfma_f32_32x32x16_bf16 v[80:95], v[44:47], v[204:207], v[80:95]
  v_exp_f32 v74, v74
  v_exp_f32 v75, v75
  ds_read_b128 v[48:51], v4 offset:45056
  v_cvt_pk_bf16_f32 v100, v72, v73
  v_exp_f32 v76, v76
  v_exp_f32 v77, v77
  ds_read_b128 v[52:55], v4 offset:46080
  v_cvt_pk_bf16_f32 v101, v74, v75
  v_exp_f32 v78, v78
  s_add_u32 m0, s31, 5120
  s_add_u32 s29, s53, s27
  s_add_u32 s29, s29, 5120
  buffer_load_dwordx4 v2, s[8:11], s29 offen sc1 lds
  v_exp_f32 v79, v79
  v_cvt_pk_bf16_f32 v102, v76, v77
  v_cvt_pk_bf16_f32 v103, v78, v79
  s_waitcnt lgkmcnt(4)
  v_mfma_f32_32x32x16_bf16 v[112:127], v[56:59], v[96:99], v[112:127]
  v_exp_f32 v80, v80
  v_exp_f32 v81, v81
  v_exp_f32 v82, v82
  v_exp_f32 v83, v83
  v_mfma_f32_32x32x16_bf16 v[112:127], v[60:63], v[100:103], v[112:127]
  v_cvt_pk_bf16_f32 v104, v80, v81
  v_exp_f32 v84, v84
  v_exp_f32 v85, v85
  v_cvt_pk_bf16_f32 v105, v82, v83
  v_exp_f32 v86, v86
  s_waitcnt lgkmcnt(2)
  v_mfma_f32_32x32x16_bf16 v[64:79], v[32:35], v[192:195], 0
  v_exp_f32 v87, v87
  v_cvt_pk_bf16_f32 v106, v84, v85
  v_exp_f32 v88, v88
  v_exp_f32 v89, v89
  v_cvt_pk_bf16_f32 v107, v86, v87
  v_mfma_f32_32x32x16_bf16 v[64:79], v[36:39], v[196:199], v[64:79]
  v_exp_f32 v90, v90
  v_exp_f32 v91, v91
  ds_read_b128 v[40:43], v4 offset:14336
  v_cvt_pk_bf16_f32 v108, v88, v89
  v_exp_f32 v92, v92
  v_exp_f32 v93, v93
  ds_read_b128 v[44:47], v4 offset:15360
  v_cvt_pk_bf16_f32 v109, v90, v91
  v_exp_f32 v94, v94
  v_exp_f32 v95, v95
  v_cvt_pk_bf16_f32 v110, v92, v93
  v_cvt_pk_bf16_f32 v111, v94, v95
  v_mfma_f32_32x32x16_bf16 v[128:143], v[56:59], v[104:107], v[128:143]
  v_exp_f32 v64, v64
  v_exp_f32 v65, v65
  v_exp_f32 v66, v66
  v_exp_f32 v67, v67
  v_mfma_f32_32x32x16_bf16 v[128:143], v[60:63], v[108:111], v[128:143]
  v_cvt_pk_bf16_f32 v96, v64, v65
  v_exp_f32 v68, v68
  v_exp_f32 v69, v69
  v_cvt_pk_bf16_f32 v97, v66, v67
  v_exp_f32 v70, v70
  v_mfma_f32_32x32x16_bf16 v[80:95], v[32:35], v[200:203], 0
  v_exp_f32 v71, v71
  v_cvt_pk_bf16_f32 v98, v68, v69
  v_exp_f32 v72, v72
  v_exp_f32 v73, v73
  v_cvt_pk_bf16_f32 v99, v70, v71
  v_mfma_f32_32x32x16_bf16 v[80:95], v[36:39], v[204:207], v[80:95]
  v_exp_f32 v74, v74
  v_exp_f32 v75, v75
  ds_read_b128 v[56:59], v4 offset:47104
  v_cvt_pk_bf16_f32 v100, v72, v73
  v_exp_f32 v76, v76
  v_exp_f32 v77, v77
  ds_read_b128 v[60:63], v4 offset:48128
  v_cvt_pk_bf16_f32 v101, v74, v75
  v_exp_f32 v78, v78
  s_add_u32 m0, s31, 6144
  s_add_u32 s29, s53, s27
  s_add_u32 s29, s29, 6144
  buffer_load_dwordx4 v2, s[8:11], s29 offen sc1 lds
  v_exp_f32 v79, v79
  v_cvt_pk_bf16_f32 v102, v76, v77
  v_cvt_pk_bf16_f32 v103, v78, v79
  s_waitcnt lgkmcnt(4)
  v_mfma_f32_32x32x16_bf16 v[112:127], v[48:51], v[96:99], v[112:127]
  v_exp_f32 v80, v80
  v_exp_f32 v81, v81
  v_exp_f32 v82, v82
  v_exp_f32 v83, v83
  v_mfma_f32_32x32x16_bf16 v[112:127], v[52:55], v[100:103], v[112:127]
  v_cvt_pk_bf16_f32 v104, v80, v81
  v_exp_f32 v84, v84
  v_exp_f32 v85, v85
  v_cvt_pk_bf16_f32 v105, v82, v83
  v_exp_f32 v86, v86
  s_waitcnt lgkmcnt(2)
  v_mfma_f32_32x32x16_bf16 v[64:79], v[40:43], v[192:195], 0
  v_exp_f32 v87, v87
  v_cvt_pk_bf16_f32 v106, v84, v85
  v_exp_f32 v88, v88
  v_exp_f32 v89, v89
  v_cvt_pk_bf16_f32 v107, v86, v87
  v_mfma_f32_32x32x16_bf16 v[64:79], v[44:47], v[196:199], v[64:79]
  v_exp_f32 v90, v90
  v_exp_f32 v91, v91
  ds_read_b128 v[32:35], v4 offset:16384
  v_cvt_pk_bf16_f32 v108, v88, v89
  v_exp_f32 v92, v92
  v_exp_f32 v93, v93
  ds_read_b128 v[36:39], v4 offset:17408
  v_cvt_pk_bf16_f32 v109, v90, v91
  v_exp_f32 v94, v94
  v_exp_f32 v95, v95
  v_cvt_pk_bf16_f32 v110, v92, v93
  v_cvt_pk_bf16_f32 v111, v94, v95
  v_mfma_f32_32x32x16_bf16 v[128:143], v[48:51], v[104:107], v[128:143]
  v_exp_f32 v64, v64
  v_exp_f32 v65, v65
  v_exp_f32 v66, v66
  v_exp_f32 v67, v67
  v_mfma_f32_32x32x16_bf16 v[128:143], v[52:55], v[108:111], v[128:143]
  v_cvt_pk_bf16_f32 v96, v64, v65
  v_exp_f32 v68, v68
  v_exp_f32 v69, v69
  v_cvt_pk_bf16_f32 v97, v66, v67
  v_exp_f32 v70, v70
  v_mfma_f32_32x32x16_bf16 v[80:95], v[40:43], v[200:203], 0
  v_exp_f32 v71, v71
  v_cvt_pk_bf16_f32 v98, v68, v69
  v_exp_f32 v72, v72
  v_exp_f32 v73, v73
  v_cvt_pk_bf16_f32 v99, v70, v71
  v_mfma_f32_32x32x16_bf16 v[80:95], v[44:47], v[204:207], v[80:95]
  v_exp_f32 v74, v74
  v_exp_f32 v75, v75
  ds_read_b128 v[48:51], v4 offset:49152
  v_cvt_pk_bf16_f32 v100, v72, v73
  v_exp_f32 v76, v76
  v_exp_f32 v77, v77
  ds_read_b128 v[52:55], v4 offset:50176
  v_cvt_pk_bf16_f32 v101, v74, v75
  v_exp_f32 v78, v78
  s_add_u32 m0, s31, 7168
  s_add_u32 s29, s53, s27
  s_add_u32 s29, s29, 7168
  buffer_load_dwordx4 v2, s[8:11], s29 offen sc1 lds
  v_exp_f32 v79, v79
  v_cvt_pk_bf16_f32 v102, v76, v77
  v_cvt_pk_bf16_f32 v103, v78, v79
  s_waitcnt lgkmcnt(4)
  v_mfma_f32_32x32x16_bf16 v[112:127], v[56:59], v[96:99], v[112:127]
  v_exp_f32 v80, v80
  v_exp_f32 v81, v81
  v_exp_f32 v82, v82
  v_exp_f32 v83, v83
  v_mfma_f32_32x32x16_bf16 v[112:127], v[60:63], v[100:103], v[112:127]
  v_cvt_pk_bf16_f32 v104, v80, v81
  v_exp_f32 v84, v84
  v_exp_f32 v85, v85
  v_cvt_pk_bf16_f32 v105, v82, v83
  v_exp_f32 v86, v86
  s_waitcnt lgkmcnt(2)
  v_mfma_f32_32x32x16_bf16 v[64:79], v[32:35], v[192:195], 0
  v_exp_f32 v87, v87
  v_cvt_pk_bf16_f32 v106, v84, v85
  v_exp_f32 v88, v88
  v_exp_f32 v89, v89
  v_cvt_pk_bf16_f32 v107, v86, v87
  v_mfma_f32_32x32x16_bf16 v[64:79], v[36:39], v[196:199], v[64:79]
  v_exp_f32 v90, v90
  v_exp_f32 v91, v91
  ds_read_b128 v[40:43], v4 offset:18432
  v_cvt_pk_bf16_f32 v108, v88, v89
  v_exp_f32 v92, v92
  v_exp_f32 v93, v93
  ds_read_b128 v[44:47], v4 offset:19456
  v_cvt_pk_bf16_f32 v109, v90, v91
  v_exp_f32 v94, v94
  v_exp_f32 v95, v95
  v_cvt_pk_bf16_f32 v110, v92, v93
  v_cvt_pk_bf16_f32 v111, v94, v95
  v_mfma_f32_32x32x16_bf16 v[128:143], v[56:59], v[104:107], v[128:143]
  v_exp_f32 v64, v64
  v_exp_f32 v65, v65
  v_exp_f32 v66, v66
  v_exp_f32 v67, v67
  v_mfma_f32_32x32x16_bf16 v[128:143], v[60:63], v[108:111], v[128:143]
  v_cvt_pk_bf16_f32 v96, v64, v65
  v_exp_f32 v68, v68
  v_exp_f32 v69, v69
  v_cvt_pk_bf16_f32 v97, v66, v67
  v_exp_f32 v70, v70
  v_mfma_f32_32x32x16_bf16 v[80:95], v[32:35], v[200:203], 0
  v_exp_f32 v71, v71
  v_cvt_pk_bf16_f32 v98, v68, v69
  v_exp_f32 v72, v72
  v_exp_f32 v73, v73
  v_cvt_pk_bf16_f32 v99, v70, v71
  v_mfma_f32_32x32x16_bf16 v[80:95], v[36:39], v[204:207], v[80:95]
  v_exp_f32 v74, v74
  v_exp_f32 v75, v75
  ds_read_b128 v[56:59], v4 offset:51200
  v_cvt_pk_bf16_f32 v100, v72, v73
  v_exp_f32 v76, v76
  v_exp_f32 v77, v77
  ds_read_b128 v[60:63], v4 offset:52224
  v_cvt_pk_bf16_f32 v101, v74, v75
  v_exp_f32 v78, v78
  s_add_u32 m0, s31, 32768
  s_add_u32 s29, s53, s28
  s_add_u32 s29, s29, 0
  buffer_load_dwordx4 v2, s[8:11], s29 offen sc1 lds
  v_exp_f32 v79, v79
  v_cvt_pk_bf16_f32 v102, v76, v77
  v_cvt_pk_bf16_f32 v103, v78, v79
  s_waitcnt lgkmcnt(4)
  v_mfma_f32_32x32x16_bf16 v[112:127], v[48:51], v[96:99], v[112:127]
  v_exp_f32 v80, v80
  v_exp_f32 v81, v81
  v_exp_f32 v82, v82
  v_exp_f32 v83, v83
  v_mfma_f32_32x32x16_bf16 v[112:127], v[52:55], v[100:103], v[112:127]
  v_cvt_pk_bf16_f32 v104, v80, v81
  v_exp_f32 v84, v84
  v_exp_f32 v85, v85
  v_cvt_pk_bf16_f32 v105, v82, v83
  v_exp_f32 v86, v86
  s_waitcnt lgkmcnt(2)
  v_mfma_f32_32x32x16_bf16 v[64:79], v[40:43], v[192:195], 0
  v_exp_f32 v87, v87
  v_cvt_pk_bf16_f32 v106, v84, v85
  v_exp_f32 v88, v88
  v_exp_f32 v89, v89
  v_cvt_pk_bf16_f32 v107, v86, v87
  v_mfma_f32_32x32x16_bf16 v[64:79], v[44:47], v[196:199], v[64:79]
  v_exp_f32 v90, v90
  v_exp_f32 v91, v91
  ds_read_b128 v[32:35], v4 offset:20480
  v_cvt_pk_bf16_f32 v108, v88, v89
  v_exp_f32 v92, v92
  v_exp_f32 v93, v93
  ds_read_b128 v[36:39], v4 offset:21504
  v_cvt_pk_bf16_f32 v109, v90, v91
  v_exp_f32 v94, v94
  v_exp_f32 v95, v95
  v_cvt_pk_bf16_f32 v110, v92, v93
  v_cvt_pk_bf16_f32 v111, v94, v95
  v_mfma_f32_32x32x16_bf16 v[128:143], v[48:51], v[104:107], v[128:143]
  v_exp_f32 v64, v64
  v_exp_f32 v65, v65
  v_exp_f32 v66, v66
  v_exp_f32 v67, v67
  v_mfma_f32_32x32x16_bf16 v[128:143], v[52:55], v[108:111], v[128:143]
  v_cvt_pk_bf16_f32 v96, v64, v65
  v_exp_f32 v68, v68
  v_exp_f32 v69, v69
  v_cvt_pk_bf16_f32 v97, v66, v67
  v_exp_f32 v70, v70
  v_mfma_f32_32x32x16_bf16 v[80:95], v[40:43], v[200:203], 0
  v_exp_f32 v71, v71
  v_cvt_pk_bf16_f32 v98, v68, v69
  v_exp_f32 v72, v72
  v_exp_f32 v73, v73
  v_cvt_pk_bf16_f32 v99, v70, v71
  v_mfma_f32_32x32x16_bf16 v[80:95], v[44:47], v[204:207], v[80:95]
  v_exp_f32 v74, v74
  v_exp_f32 v75, v75
  ds_read_b128 v[48:51], v4 offset:53248
  v_cvt_pk_bf16_f32 v100, v72, v73
  v_exp_f32 v76, v76
  v_exp_f32 v77, v77
  ds_read_b128 v[52:55], v4 offset:54272
  v_cvt_pk_bf16_f32 v101, v74, v75
  v_exp_f32 v78, v78
  s_add_u32 m0, s31, 33792
  s_add_u32 s29, s53, s28
  s_add_u32 s29, s29, 1024
  buffer_load_dwordx4 v2, s[8:11], s29 offen sc1 lds
  v_exp_f32 v79, v79
  v_cvt_pk_bf16_f32 v102, v76, v77
  v_cvt_pk_bf16_f32 v103, v78, v79
  s_waitcnt lgkmcnt(4)
  v_mfma_f32_32x32x16_bf16 v[112:127], v[56:59], v[96:99], v[112:127]
  v_exp_f32 v80, v80
  v_exp_f32 v81, v81
  v_exp_f32 v82, v82
  v_exp_f32 v83, v83
  v_mfma_f32_32x32x16_bf16 v[112:127], v[60:63], v[100:103], v[112:127]
  v_cvt_pk_bf16_f32 v104, v80, v81
  v_exp_f32 v84, v84
  v_exp_f32 v85, v85
  v_cvt_pk_bf16_f32 v105, v82, v83
  v_exp_f32 v86, v86
  s_waitcnt lgkmcnt(2)
  v_mfma_f32_32x32x16_bf16 v[64:79], v[32:35], v[192:195], 0
  v_exp_f32 v87, v87
  v_cvt_pk_bf16_f32 v106, v84, v85
  v_exp_f32 v88, v88
  v_exp_f32 v89, v89
  v_cvt_pk_bf16_f32 v107, v86, v87
  v_mfma_f32_32x32x16_bf16 v[64:79], v[36:39], v[196:199], v[64:79]
  v_exp_f32 v90, v90
  v_exp_f32 v91, v91
  ds_read_b128 v[40:43], v4 offset:22528
  v_cvt_pk_bf16_f32 v108, v88, v89
  v_exp_f32 v92, v92
  v_exp_f32 v93, v93
  ds_read_b128 v[44:47], v4 offset:23552
  v_cvt_pk_bf16_f32 v109, v90, v91
  v_exp_f32 v94, v94
  v_exp_f32 v95, v95
  v_cvt_pk_bf16_f32 v110, v92, v93
  v_cvt_pk_bf16_f32 v111, v94, v95
  v_mfma_f32_32x32x16_bf16 v[128:143], v[56:59], v[104:107], v[128:143]
  v_exp_f32 v64, v64
  v_exp_f32 v65, v65
  v_exp_f32 v66, v66
  v_exp_f32 v67, v67
  v_mfma_f32_32x32x16_bf16 v[128:143], v[60:63], v[108:111], v[128:143]
  v_cvt_pk_bf16_f32 v96, v64, v65
  v_exp_f32 v68, v68
  v_exp_f32 v69, v69
  v_cvt_pk_bf16_f32 v97, v66, v67
  v_exp_f32 v70, v70
  v_mfma_f32_32x32x16_bf16 v[80:95], v[32:35], v[200:203], 0
  v_exp_f32 v71, v71
  v_cvt_pk_bf16_f32 v98, v68, v69
  v_exp_f32 v72, v72
  v_exp_f32 v73, v73
  v_cvt_pk_bf16_f32 v99, v70, v71
  v_mfma_f32_32x32x16_bf16 v[80:95], v[36:39], v[204:207], v[80:95]
  v_exp_f32 v74, v74
  v_exp_f32 v75, v75
  ds_read_b128 v[56:59], v4 offset:55296
  v_cvt_pk_bf16_f32 v100, v72, v73
  v_exp_f32 v76, v76
  v_exp_f32 v77, v77
  ds_read_b128 v[60:63], v4 offset:56320
  v_cvt_pk_bf16_f32 v101, v74, v75
  v_exp_f32 v78, v78
  s_add_u32 m0, s31, 34816
  s_add_u32 s29, s53, s28
  s_add_u32 s29, s29, 2048
  buffer_load_dwordx4 v2, s[8:11], s29 offen sc1 lds
  v_exp_f32 v79, v79
  v_cvt_pk_bf16_f32 v102, v76, v77
  v_cvt_pk_bf16_f32 v103, v78, v79
  s_waitcnt lgkmcnt(4)
  v_mfma_f32_32x32x16_bf16 v[112:127], v[48:51], v[96:99], v[112:127]
  v_exp_f32 v80, v80
  v_exp_f32 v81, v81
  v_exp_f32 v82, v82
  v_exp_f32 v83, v83
  v_mfma_f32_32x32x16_bf16 v[112:127], v[52:55], v[100:103], v[112:127]
  v_cvt_pk_bf16_f32 v104, v80, v81
  v_exp_f32 v84, v84
  v_exp_f32 v85, v85
  v_cvt_pk_bf16_f32 v105, v82, v83
  v_exp_f32 v86, v86
  s_waitcnt lgkmcnt(2)
  v_mfma_f32_32x32x16_bf16 v[64:79], v[40:43], v[192:195], 0
  v_exp_f32 v87, v87
  v_cvt_pk_bf16_f32 v106, v84, v85
  v_exp_f32 v88, v88
  v_exp_f32 v89, v89
  v_cvt_pk_bf16_f32 v107, v86, v87
  v_mfma_f32_32x32x16_bf16 v[64:79], v[44:47], v[196:199], v[64:79]
  v_exp_f32 v90, v90
  v_exp_f32 v91, v91
  ds_read_b128 v[32:35], v4 offset:24576
  v_cvt_pk_bf16_f32 v108, v88, v89
  v_exp_f32 v92, v92
  v_exp_f32 v93, v93
  ds_read_b128 v[36:39], v4 offset:25600
  v_cvt_pk_bf16_f32 v109, v90, v91
  v_exp_f32 v94, v94
  v_exp_f32 v95, v95
  v_cvt_pk_bf16_f32 v110, v92, v93
  v_cvt_pk_bf16_f32 v111, v94, v95
  v_mfma_f32_32x32x16_bf16 v[128:143], v[48:51], v[104:107], v[128:143]
  v_exp_f32 v64, v64
  v_exp_f32 v65, v65
  v_exp_f32 v66, v66
  v_exp_f32 v67, v67
  v_mfma_f32_32x32x16_bf16 v[128:143], v[52:55], v[108:111], v[128:143]
  v_cvt_pk_bf16_f32 v96, v64, v65
  v_exp_f32 v68, v68
  v_exp_f32 v69, v69
  v_cvt_pk_bf16_f32 v97, v66, v67
  v_exp_f32 v70, v70
  v_mfma_f32_32x32x16_bf16 v[80:95], v[40:43], v[200:203], 0
  v_exp_f32 v71, v71
  v_cvt_pk_bf16_f32 v98, v68, v69
  v_exp_f32 v72, v72
  v_exp_f32 v73, v73
  v_cvt_pk_bf16_f32 v99, v70, v71
  v_mfma_f32_32x32x16_bf16 v[80:95], v[44:47], v[204:207], v[80:95]
  v_exp_f32 v74, v74
  v_exp_f32 v75, v75
  ds_read_b128 v[48:51], v4 offset:57344
  v_cvt_pk_bf16_f32 v100, v72, v73
  v_exp_f32 v76, v76
  v_exp_f32 v77, v77
  ds_read_b128 v[52:55], v4 offset:58368
  v_cvt_pk_bf16_f32 v101, v74, v75
  v_exp_f32 v78, v78
  s_add_u32 m0, s31, 35840
  s_add_u32 s29, s53, s28
  s_add_u32 s29, s29, 3072
  buffer_load_dwordx4 v2, s[8:11], s29 offen sc1 lds
  v_exp_f32 v79, v79
  v_cvt_pk_bf16_f32 v102, v76, v77
  v_cvt_pk_bf16_f32 v103, v78, v79
  s_waitcnt lgkmcnt(4)
  v_mfma_f32_32x32x16_bf16 v[112:127], v[56:59], v[96:99], v[112:127]
  v_exp_f32 v80, v80
  v_exp_f32 v81, v81
  v_exp_f32 v82, v82
  v_exp_f32 v83, v83
  v_mfma_f32_32x32x16_bf16 v[112:127], v[60:63], v[100:103], v[112:127]
  v_cvt_pk_bf16_f32 v104, v80, v81
  v_exp_f32 v84, v84
  v_exp_f32 v85, v85
  v_cvt_pk_bf16_f32 v105, v82, v83
  v_exp_f32 v86, v86
  s_waitcnt lgkmcnt(2)
  v_mfma_f32_32x32x16_bf16 v[64:79], v[32:35], v[192:195], 0
  v_exp_f32 v87, v87
  v_cvt_pk_bf16_f32 v106, v84, v85
  v_exp_f32 v88, v88
  v_exp_f32 v89, v89
  v_cvt_pk_bf16_f32 v107, v86, v87
  v_mfma_f32_32x32x16_bf16 v[64:79], v[36:39], v[196:199], v[64:79]
  v_exp_f32 v90, v90
  v_exp_f32 v91, v91
  ds_read_b128 v[40:43], v4 offset:26624
  v_cvt_pk_bf16_f32 v108, v88, v89
  v_exp_f32 v92, v92
  v_exp_f32 v93, v93
  ds_read_b128 v[44:47], v4 offset:27648
  v_cvt_pk_bf16_f32 v109, v90, v91
  v_exp_f32 v94, v94
  v_exp_f32 v95, v95
  v_cvt_pk_bf16_f32 v110, v92, v93
  v_cvt_pk_bf16_f32 v111, v94, v95
  v_mfma_f32_32x32x16_bf16 v[128:143], v[56:59], v[104:107], v[128:143]
  v_exp_f32 v64, v64
  v_exp_f32 v65, v65
  v_exp_f32 v66, v66
  v_exp_f32 v67, v67
  v_mfma_f32_32x32x16_bf16 v[128:143], v[60:63], v[108:111], v[128:143]
  v_cvt_pk_bf16_f32 v96, v64, v65
  v_exp_f32 v68, v68
  v_exp_f32 v69, v69
  v_cvt_pk_bf16_f32 v97, v66, v67
  v_exp_f32 v70, v70
  v_mfma_f32_32x32x16_bf16 v[80:95], v[32:35], v[200:203], 0
  v_exp_f32 v71, v71
  v_cvt_pk_bf16_f32 v98, v68, v69
  v_exp_f32 v72, v72
  v_exp_f32 v73, v73
  v_cvt_pk_bf16_f32 v99, v70, v71
  v_mfma_f32_32x32x16_bf16 v[80:95], v[36:39], v[204:207], v[80:95]
  v_exp_f32 v74, v74
  v_exp_f32 v75, v75
  ds_read_b128 v[56:59], v4 offset:59392
  v_cvt_pk_bf16_f32 v100, v72, v73
  v_exp_f32 v76, v76
  v_exp_f32 v77, v77
  ds_read_b128 v[60:63], v4 offset:60416
  v_cvt_pk_bf16_f32 v101, v74, v75
  v_exp_f32 v78, v78
  s_add_u32 m0, s31, 36864
  s_add_u32 s29, s53, s28
  s_add_u32 s29, s29, 4096
  buffer_load_dwordx4 v2, s[8:11], s29 offen sc1 lds
  v_exp_f32 v79, v79
  v_cvt_pk_bf16_f32 v102, v76, v77
  v_cvt_pk_bf16_f32 v103, v78, v79
  s_waitcnt lgkmcnt(4)
  v_mfma_f32_32x32x16_bf16 v[112:127], v[48:51], v[96:99], v[112:127]
  v_exp_f32 v80, v80
  v_exp_f32 v81, v81
  v_exp_f32 v82, v82
  v_exp_f32 v83, v83
  v_mfma_f32_32x32x16_bf16 v[112:127], v[52:55], v[100:103], v[112:127]
  v_cvt_pk_bf16_f32 v104, v80, v81
  v_exp_f32 v84, v84
  v_exp_f32 v85, v85
  v_cvt_pk_bf16_f32 v105, v82, v83
  v_exp_f32 v86, v86
  s_waitcnt lgkmcnt(2)
  v_mfma_f32_32x32x16_bf16 v[64:79], v[40:43], v[192:195], 0
  v_exp_f32 v87, v87
  v_cvt_pk_bf16_f32 v106, v84, v85
  v_exp_f32 v88, v88
  v_exp_f32 v89, v89
  v_cvt_pk_bf16_f32 v107, v86, v87
  v_mfma_f32_32x32x16_bf16 v[64:79], v[44:47], v[196:199], v[64:79]
  v_exp_f32 v90, v90
  v_exp_f32 v91, v91
  ds_read_b128 v[32:35], v4 offset:28672
  v_cvt_pk_bf16_f32 v108, v88, v89
  v_exp_f32 v92, v92
  v_exp_f32 v93, v93
  ds_read_b128 v[36:39], v4 offset:29696
  v_cvt_pk_bf16_f32 v109, v90, v91
  v_exp_f32 v94, v94
  v_exp_f32 v95, v95
  v_cvt_pk_bf16_f32 v110, v92, v93
  v_cvt_pk_bf16_f32 v111, v94, v95
  v_mfma_f32_32x32x16_bf16 v[128:143], v[48:51], v[104:107], v[128:143]
  v_exp_f32 v64, v64
  v_exp_f32 v65, v65
  v_exp_f32 v66, v66
  v_exp_f32 v67, v67
  v_mfma_f32_32x32x16_bf16 v[128:143], v[52:55], v[108:111], v[128:143]
  v_cvt_pk_bf16_f32 v96, v64, v65
  v_exp_f32 v68, v68
  v_exp_f32 v69, v69
  v_cvt_pk_bf16_f32 v97, v66, v67
  v_exp_f32 v70, v70
  v_mfma_f32_32x32x16_bf16 v[80:95], v[40:43], v[200:203], 0
  v_exp_f32 v71, v71
  v_cvt_pk_bf16_f32 v98, v68, v69
  v_exp_f32 v72, v72
  v_exp_f32 v73, v73
  v_cvt_pk_bf16_f32 v99, v70, v71
  v_mfma_f32_32x32x16_bf16 v[80:95], v[44:47], v[204:207], v[80:95]
  v_exp_f32 v74, v74
  v_exp_f32 v75, v75
  ds_read_b128 v[48:51], v4 offset:61440
  v_cvt_pk_bf16_f32 v100, v72, v73
  v_exp_f32 v76, v76
  v_exp_f32 v77, v77
  ds_read_b128 v[52:55], v4 offset:62464
  v_cvt_pk_bf16_f32 v101, v74, v75
  v_exp_f32 v78, v78
  s_add_u32 m0, s31, 37888
  s_add_u32 s29, s53, s28
  s_add_u32 s29, s29, 5120
  buffer_load_dwordx4 v2, s[8:11], s29 offen sc1 lds
  v_exp_f32 v79, v79
  v_cvt_pk_bf16_f32 v102, v76, v77
  v_cvt_pk_bf16_f32 v103, v78, v79
  s_waitcnt lgkmcnt(4)
  v_mfma_f32_32x32x16_bf16 v[112:127], v[56:59], v[96:99], v[112:127]
  v_exp_f32 v80, v80
  v_exp_f32 v81, v81
  v_exp_f32 v82, v82
  v_exp_f32 v83, v83
  v_mfma_f32_32x32x16_bf16 v[112:127], v[60:63], v[100:103], v[112:127]
  v_cvt_pk_bf16_f32 v104, v80, v81
  v_exp_f32 v84, v84
  v_exp_f32 v85, v85
  v_cvt_pk_bf16_f32 v105, v82, v83
  v_exp_f32 v86, v86
  s_waitcnt lgkmcnt(2)
  v_mfma_f32_32x32x16_bf16 v[64:79], v[32:35], v[192:195], 0
  v_exp_f32 v87, v87
  v_cvt_pk_bf16_f32 v106, v84, v85
  v_exp_f32 v88, v88
  v_exp_f32 v89, v89
  v_cvt_pk_bf16_f32 v107, v86, v87
  v_mfma_f32_32x32x16_bf16 v[64:79], v[36:39], v[196:199], v[64:79]
  v_exp_f32 v90, v90
  v_exp_f32 v91, v91
  ds_read_b128 v[40:43], v4 offset:30720
  v_cvt_pk_bf16_f32 v108, v88, v89
  v_exp_f32 v92, v92
  v_exp_f32 v93, v93
  ds_read_b128 v[44:47], v4 offset:31744
  v_cvt_pk_bf16_f32 v109, v90, v91
  v_exp_f32 v94, v94
  v_exp_f32 v95, v95
  v_cvt_pk_bf16_f32 v110, v92, v93
  v_cvt_pk_bf16_f32 v111, v94, v95
  v_mfma_f32_32x32x16_bf16 v[128:143], v[56:59], v[104:107], v[128:143]
  v_exp_f32 v64, v64
  v_exp_f32 v65, v65
  v_exp_f32 v66, v66
  v_exp_f32 v67, v67
  v_mfma_f32_32x32x16_bf16 v[128:143], v[60:63], v[108:111], v[128:143]
  v_cvt_pk_bf16_f32 v96, v64, v65
  v_exp_f32 v68, v68
  v_exp_f32 v69, v69
  v_cvt_pk_bf16_f32 v97, v66, v67
  v_exp_f32 v70, v70
  v_mfma_f32_32x32x16_bf16 v[80:95], v[32:35], v[200:203], 0
  v_exp_f32 v71, v71
  v_cvt_pk_bf16_f32 v98, v68, v69
  v_exp_f32 v72, v72
  v_exp_f32 v73, v73
  v_cvt_pk_bf16_f32 v99, v70, v71
  v_mfma_f32_32x32x16_bf16 v[80:95], v[36:39], v[204:207], v[80:95]
  v_exp_f32 v74, v74
  v_exp_f32 v75, v75
  ds_read_b128 v[56:59], v4 offset:63488
  v_cvt_pk_bf16_f32 v100, v72, v73
  v_exp_f32 v76, v76
  v_exp_f32 v77, v77
  ds_read_b128 v[60:63], v4 offset:64512
  v_cvt_pk_bf16_f32 v101, v74, v75
  v_exp_f32 v78, v78
  s_add_u32 m0, s31, 38912
  s_add_u32 s29, s53, s28
  s_add_u32 s29, s29, 6144
  buffer_load_dwordx4 v2, s[8:11], s29 offen sc1 lds
  v_exp_f32 v79, v79
  v_cvt_pk_bf16_f32 v102, v76, v77
  v_cvt_pk_bf16_f32 v103, v78, v79
  s_waitcnt lgkmcnt(4)
  v_mfma_f32_32x32x16_bf16 v[112:127], v[48:51], v[96:99], v[112:127]
  v_exp_f32 v80, v80
  v_exp_f32 v81, v81
  v_exp_f32 v82, v82
  v_exp_f32 v83, v83
  v_mfma_f32_32x32x16_bf16 v[112:127], v[52:55], v[100:103], v[112:127]
  v_cvt_pk_bf16_f32 v104, v80, v81
  v_exp_f32 v84, v84
  v_exp_f32 v85, v85
  v_cvt_pk_bf16_f32 v105, v82, v83
  v_exp_f32 v86, v86
  s_waitcnt lgkmcnt(2)
  v_mfma_f32_32x32x16_bf16 v[64:79], v[40:43], v[192:195], 0
  v_exp_f32 v87, v87
  v_cvt_pk_bf16_f32 v106, v84, v85
  v_exp_f32 v88, v88
  v_exp_f32 v89, v89
  v_cvt_pk_bf16_f32 v107, v86, v87
  v_mfma_f32_32x32x16_bf16 v[64:79], v[44:47], v[196:199], v[64:79]
  v_exp_f32 v90, v90
  v_exp_f32 v91, v91
  v_cvt_pk_bf16_f32 v108, v88, v89
  v_exp_f32 v92, v92
  v_exp_f32 v93, v93
  v_cvt_pk_bf16_f32 v109, v90, v91
  v_exp_f32 v94, v94
  v_exp_f32 v95, v95
  v_cvt_pk_bf16_f32 v110, v92, v93
  v_cvt_pk_bf16_f32 v111, v94, v95
  v_mfma_f32_32x32x16_bf16 v[128:143], v[48:51], v[104:107], v[128:143]
  v_exp_f32 v64, v64
  v_exp_f32 v65, v65
  v_exp_f32 v66, v66
  v_exp_f32 v67, v67
  v_mfma_f32_32x32x16_bf16 v[128:143], v[52:55], v[108:111], v[128:143]
  v_cvt_pk_bf16_f32 v96, v64, v65
  v_exp_f32 v68, v68
  v_exp_f32 v69, v69
  v_cvt_pk_bf16_f32 v97, v66, v67
  v_exp_f32 v70, v70
  v_mfma_f32_32x32x16_bf16 v[80:95], v[40:43], v[200:203], 0
  v_exp_f32 v71, v71
  v_cvt_pk_bf16_f32 v98, v68, v69
  v_exp_f32 v72, v72
  v_exp_f32 v73, v73
  v_cvt_pk_bf16_f32 v99, v70, v71
  v_mfma_f32_32x32x16_bf16 v[80:95], v[44:47], v[204:207], v[80:95]
  v_exp_f32 v74, v74
  v_exp_f32 v75, v75
  v_cvt_pk_bf16_f32 v100, v72, v73
  v_exp_f32 v76, v76
  v_exp_f32 v77, v77
  v_cvt_pk_bf16_f32 v101, v74, v75
  v_exp_f32 v78, v78
  s_add_u32 m0, s31, 39936
  s_add_u32 s29, s53, s28
  s_add_u32 s29, s29, 7168
  buffer_load_dwordx4 v2, s[8:11], s29 offen sc1 lds
  v_exp_f32 v79, v79
  v_cvt_pk_bf16_f32 v102, v76, v77
  v_cvt_pk_bf16_f32 v103, v78, v79
  s_waitcnt lgkmcnt(0)
  v_mfma_f32_32x32x16_bf16 v[112:127], v[56:59], v[96:99], v[112:127]
  v_exp_f32 v80, v80
  v_exp_f32 v81, v81
  v_exp_f32 v82, v82
  v_exp_f32 v83, v83
  v_mfma_f32_32x32x16_bf16 v[112:127], v[60:63], v[100:103], v[112:127]
  v_cvt_pk_bf16_f32 v104, v80, v81
  v_exp_f32 v84, v84
  v_exp_f32 v85, v85
  v_cvt_pk_bf16_f32 v105, v82, v83
  v_exp_f32 v86, v86
  v_exp_f32 v87, v87
  v_cvt_pk_bf16_f32 v106, v84, v85
  v_exp_f32 v88, v88
  v_exp_f32 v89, v89
  v_cvt_pk_bf16_f32 v107, v86, v87
  v_exp_f32 v90, v90
  v_exp_f32 v91, v91
  v_cvt_pk_bf16_f32 v108, v88, v89
  v_exp_f32 v92, v92
  v_exp_f32 v93, v93
  v_cvt_pk_bf16_f32 v109, v90, v91
  v_exp_f32 v94, v94
  v_exp_f32 v95, v95
  v_cvt_pk_bf16_f32 v110, v92, v93
  v_cvt_pk_bf16_f32 v111, v94, v95
  s_nop 1
  v_mfma_f32_32x32x16_bf16 v[128:143], v[56:59], v[104:107], v[128:143]
  v_mfma_f32_32x32x16_bf16 v[128:143], v[60:63], v[108:111], v[128:143]
  s_cmp_lt_u32 s41, 4
  s_cbranch_scc1 kb2_chunk2
  s_nop 11
  v_mov_b32 v5, v120
  v_mov_b32 v6, v120
  s_nop 1
  v_permlane32_swap_b32 v5, v6
  v_mov_b32 v14, v6
  v_mov_b32 v5, v136
  v_mov_b32 v6, v136
  s_nop 1
  v_permlane32_swap_b32 v5, v6
  v_mov_b32 v15, v6
  s_cmp_eq_u32 s40, 0
  s_cbranch_scc0 kb2_fin
  v_min_f32 v5, v14, v15
  v_cmp_gt_f32 vcc, 0x12800000, v5
  v_cmp_u_f32 s[36:37], v5, v5
  s_nop 1
  s_or_b64 vcc, vcc, s[36:37]
  s_cmp_lg_u64 vcc, 0
  s_cselect_b32 s42, 1, 0
  v_mov_b32 v5, s42
  s_lshl_b32 s30, s21, 2
  s_add_u32 s30, s30, 131584
  v_mov_b32 v6, s30
  ds_write_b32 v6, v5
  s_waitcnt vmcnt(0) lgkmcnt(0)
  s_barrier
  v_mov_b32 v6, 131584
  ds_read_b128 v[8:11], v6
  s_waitcnt lgkmcnt(0)
  v_or_b32 v8, v8, v9
  v_or_b32 v10, v10, v11
  v_or_b32 v8, v8, v10
  s_nop 0
  v_readfirstlane_b32 s42, v8
  s_cmp_eq_u32 s42, 0
  s_cbranch_scc1 kb2_fin
  s_mov_b32 s40, 1
  v_and_b32 v5, 0xffff0000, v198
  v_cndmask_b32 v198, v198, v5, s[34:35]
  v_mov_b32 v12, 0xff7fffff
  v_and_b32 v5, 0xffff0000, v206
  v_cndmask_b32 v206, v206, v5, s[34:35]
  v_mov_b32 v13, 0xff7fffff
  s_mov_b32 s41, 0
kb2_mx:
  s_lshl_b32 s30, s41, 11
  s_add_u32 s30, s30, s27
  buffer_load_dwordx4 v[32:35], v2, s[8:11], s30 offen sc1
  buffer_load_dwordx4 v[36:39], v2, s[8:11], s30 offen offset:1024 sc1
  s_waitcnt vmcnt(0)
  v_mfma_f32_32x32x16_bf16 v[64:79], v[32:35], v[192:195], 0
  v_mfma_f32_32x32x16_bf16 v[64:79], v[36:39], v[196:199], v[64:79]
  v_mfma_f32_32x32x16_bf16 v[80:95], v[32:35], v[200:203], 0
  v_mfma_f32_32x32x16_bf16 v[80:95], v[36:39], v[204:207], v[80:95]
  s_nop 11
  v_max3_f32 v12, v12, v64, v65
  v_max3_f32 v12, v12, v66, v67
  v_max3_f32 v12, v12, v68, v69
  v_max3_f32 v12, v12, v70, v71
  v_max3_f32 v12, v12, v72, v73
  v_max3_f32 v12, v12, v74, v75
  v_max3_f32 v12, v12, v76, v77
  v_max3_f32 v12, v12, v78, v79
  v_max3_f32 v13, v13, v80, v81
  v_max3_f32 v13, v13, v82, v83
  v_max3_f32 v13, v13, v84, v85
  v_max3_f32 v13, v13, v86, v87
  v_max3_f32 v13, v13, v88, v89
  v_max3_f32 v13, v13, v90, v91
  v_max3_f32 v13, v13, v92, v93
  v_max3_f32 v13, v13, v94, v95
  s_add_u32 s41, s41, 1
  s_cmp_lt_u32 s41, 64
  s_cbranch_scc1 kb2_mx
  v_mov_b32 v5, v12
  s_nop 1
  v_permlane32_swap_b32 v12, v5
  v_max_f32 v12, v12, v5
  v_cvt_pk_bf16_f32 v5, v12, v12
  v_and_b32 v5, 0xffff, v5
  v_xor_b32 v5, 0x8000, v5
  v_and_b32 v6, 0xffff0000, v198
  v_or_b32 v5, v5, v6
  v_cndmask_b32 v198, v198, v5, s[34:35]
  v_mov_b32 v5, v13
  s_nop 1
  v_permlane32_swap_b32 v13, v5
  v_max_f32 v13, v13, v5
  v_cvt_pk_bf16_f32 v5, v13, v13
  v_and_b32 v5, 0xffff, v5
  v_xor_b32 v5, 0x8000, v5
  v_and_b32 v6, 0xffff0000, v206
  v_or_b32 v5, v5, v6
  v_cndmask_b32 v206, v206, v5, s[34:35]
  s_barrier
  s_mov_b32 s41, 0
  s_mul_i32 s53, s41, 32768
  s_lshl_b32 s31, s21, 13
  s_add_u32 s53, s53, s31
  s_add_u32 m0, s31, 0
  s_add_u32 s29, s53, s27
  s_add_u32 s29, s29, 0
  buffer_load_dwordx4 v2, s[8:11], s29 offen sc1 lds
  s_add_u32 m0, s31, 1024
  s_add_u32 s29, s53, s27
  s_add_u32 s29, s29, 1024
  buffer_load_dwordx4 v2, s[8:11], s29 offen sc1 lds
  s_add_u32 m0, s31, 2048
  s_add_u32 s29, s53, s27
  s_add_u32 s29, s29, 2048
  buffer_load_dwordx4 v2, s[8:11], s29 offen sc1 lds
  s_add_u32 m0, s31, 3072
  s_add_u32 s29, s53, s27
  s_add_u32 s29, s29, 3072
  buffer_load_dwordx4 v2, s[8:11], s29 offen sc1 lds
  s_add_u32 m0, s31, 4096
  s_add_u32 s29, s53, s27
  s_add_u32 s29, s29, 4096
  buffer_load_dwordx4 v2, s[8:11], s29 offen sc1 lds
  s_add_u32 m0, s31, 5120
  s_add_u32 s29, s53, s27
  s_add_u32 s29, s29, 5120
  buffer_load_dwordx4 v2, s[8:11], s29 offen sc1 lds
  s_add_u32 m0, s31, 6144
  s_add_u32 s29, s53, s27
  s_add_u32 s29, s29, 6144
  buffer_load_dwordx4 v2, s[8:11], s29 offen sc1 lds
  s_add_u32 m0, s31, 7168
  s_add_u32 s29, s53, s27
  s_add_u32 s29, s29, 7168
  buffer_load_dwordx4 v2, s[8:11], s29 offen sc1 lds
  s_add_u32 m0, s31, 32768
  s_add_u32 s29, s53, s28
  s_add_u32 s29, s29, 0
  buffer_load_dwordx4 v2, s[8:11], s29 offen sc1 lds
  s_add_u32 m0, s31, 33792
  s_add_u32 s29, s53, s28
  s_add_u32 s29, s29, 1024
  buffer_load_dwordx4 v2, s[8:11], s29 offen sc1 lds
  s_add_u32 m0, s31, 34816
  s_add_u32 s29, s53, s28
  s_add_u32 s29, s29, 2048
  buffer_load_dwordx4 v2, s[8:11], s29 offen sc1 lds
  s_add_u32 m0, s31, 35840
  s_add_u32 s29, s53, s28
  s_add_u32 s29, s29, 3072
  buffer_load_dwordx4 v2, s[8:11], s29 offen sc1 lds
  s_add_u32 m0, s31, 36864
  s_add_u32 s29, s53, s28
  s_add_u32 s29, s29, 4096
  buffer_load_dwordx4 v2, s[8:11], s29 offen sc1 lds
  s_add_u32 m0, s31, 37888
  s_add_u32 s29, s53, s28
  s_add_u32 s29, s29, 5120
  buffer_load_dwordx4 v2, s[8:11], s29 offen sc1 lds
  s_add_u32 m0, s31, 38912
  s_add_u32 s29, s53, s28
  s_add_u32 s29, s29, 6144
  buffer_load_dwordx4 v2, s[8:11], s29 offen sc1 lds
  s_add_u32 m0, s31, 39936
  s_add_u32 s29, s53, s28
  s_add_u32 s29, s29, 7168
  buffer_load_dwordx4 v2, s[8:11], s29 offen sc1 lds
  s_branch kb2_main2
kb2_fin:
  v_and_b32 v3, 15, v1
  v_bfe_u32 v11, v1, 4, 1
  v_mul_u32_u24 v11, 20480, v11
  v_lshrrev_b32 v4, 5, v1
  s_mul_i32 s30, s22, 20
  v_lshlrev_b32 v5, 2, v4
  v_add_u32 v5, 0, v5
  v_add_u32 v5, s30, v5
  v_lshrrev_b32 v6, 5, v5
  v_lshlrev_b32 v6, 10, v6
  v_bfe_u32 v7, v5, 3, 2
  v_lshlrev_b32 v7, 4, v7
  v_add_u32 v7, v7, v3
  v_lshlrev_b32 v7, 4, v7
  v_add_u32 v6, v6, v7
  v_bfe_u32 v7, v5, 2, 1
  v_lshlrev_b32 v7, 3, v7
  v_add_u32 v6, v6, v7
  v_add_u32 v32, v6, v11
  v_lshlrev_b32 v5, 2, v4
  v_add_u32 v5, 8, v5
  v_add_u32 v5, s30, v5
  v_lshrrev_b32 v6, 5, v5
  v_lshlrev_b32 v6, 10, v6
  v_bfe_u32 v7, v5, 3, 2
  v_lshlrev_b32 v7, 4, v7
  v_add_u32 v7, v7, v3
  v_lshlrev_b32 v7, 4, v7
  v_add_u32 v6, v6, v7
  v_bfe_u32 v7, v5, 2, 1
  v_lshlrev_b32 v7, 3, v7
  v_add_u32 v6, v6, v7
  v_add_u32 v33, v6, v11
  v_lshlrev_b32 v5, 2, v4
  v_add_u32 v5, 16, v5
  v_add_u32 v5, s30, v5
  v_lshrrev_b32 v6, 5, v5
  v_lshlrev_b32 v6, 10, v6
  v_bfe_u32 v7, v5, 3, 2
  v_lshlrev_b32 v7, 4, v7
  v_add_u32 v7, v7, v3
  v_lshlrev_b32 v7, 4, v7
  v_add_u32 v6, v6, v7
  v_bfe_u32 v7, v5, 2, 1
  v_lshlrev_b32 v7, 3, v7
  v_add_u32 v6, v6, v7
  v_add_u32 v34, v6, v11
  v_mov_b32 v5, 0x40000000
  v_cndmask_b32 v34, v5, v34, s[34:35]
  v_rcp_f32 v5, v14
  s_nop 0
  v_mul_f32 v112, v112, v5
  v_mul_f32 v113, v113, v5
  v_mul_f32 v114, v114, v5
  v_mul_f32 v115, v115, v5
  v_mul_f32 v116, v116, v5
  v_mul_f32 v117, v117, v5
  v_mul_f32 v118, v118, v5
  v_mul_f32 v119, v119, v5
  v_mul_f32 v120, v120, v5
  v_mul_f32 v121, v121, v5
  v_mul_f32 v122, v122, v5
  v_mul_f32 v123, v123, v5
  v_cvt_pk_bf16_f32 v40, v112, v113
  v_cvt_pk_bf16_f32 v41, v114, v115
  v_cvt_pk_bf16_f32 v42, v116, v117
  v_cvt_pk_bf16_f32 v43, v118, v119
  v_cvt_pk_bf16_f32 v44, v120, v121
  v_cvt_pk_bf16_f32 v45, v122, v123
  s_add_u32 s31, s52, 0
  s_mul_i32 s31, s31, 40960
  s_add_u32 s31, s31, 0xf200000
  buffer_store_dwordx2 v[40:41], v32, s[8:11], s31 offen sc1
  buffer_store_dwordx2 v[42:43], v33, s[8:11], s31 offen sc1
  buffer_store_dwordx2 v[44:45], v34, s[8:11], s31 offen sc1
  v_rcp_f32 v5, v15
  s_nop 0
  v_mul_f32 v128, v128, v5
  v_mul_f32 v129, v129, v5
  v_mul_f32 v130, v130, v5
  v_mul_f32 v131, v131, v5
  v_mul_f32 v132, v132, v5
  v_mul_f32 v133, v133, v5
  v_mul_f32 v134, v134, v5
  v_mul_f32 v135, v135, v5
  v_mul_f32 v136, v136, v5
  v_mul_f32 v137, v137, v5
  v_mul_f32 v138, v138, v5
  v_mul_f32 v139, v139, v5
  v_cvt_pk_bf16_f32 v48, v128, v129
  v_cvt_pk_bf16_f32 v49, v130, v131
  v_cvt_pk_bf16_f32 v50, v132, v133
  v_cvt_pk_bf16_f32 v51, v134, v135
  v_cvt_pk_bf16_f32 v52, v136, v137
  v_cvt_pk_bf16_f32 v53, v138, v139
  s_add_u32 s31, s52, 1
  s_mul_i32 s31, s31, 40960
  s_add_u32 s31, s31, 0xf200000
  buffer_store_dwordx2 v[48:49], v32, s[8:11], s31 offen sc1
  buffer_store_dwordx2 v[50:51], v33, s[8:11], s31 offen sc1
  buffer_store_dwordx2 v[52:53], v34, s[8:11], s31 offen sc1
  s_waitcnt vmcnt(0)
  s_barrier
  s_cmp_eq_u32 s21, 0
  s_cbranch_scc0 arr_118
  s_mov_b64 s[24:25], exec
  s_mov_b64 exec, 1
  v_mov_b32 v3, 0
  v_mov_b32 v4, 1
  buffer_atomic_add v4, v3, s[8:11], s48 offen
  s_mov_b64 exec, s[24:25]
arr_118:
  v_and_b32 v5, 15, v1
  v_lshrrev_b32 v6, 4, v1
  v_and_b32 v7, 1, v6
  v_lshlrev_b32 v7, 10, v7
  v_lshrrev_b32 v8, 1, v6
  v_lshlrev_b32 v8, 5, v8
  v_add_u32 v8, v8, v5
  v_lshlrev_b32 v8, 4, v8
  v_add_u32 v9, v7, v8
  s_lshr_b32 s26, s2, 2
  s_mul_i32 s27, s26, 81920
  s_lshl_b32 s28, s50, 11
  s_add_u32 s27, s27, s28
  s_add_u32 s27, s27, 0x1400000
  s_add_u32 s28, s27, 0
  buffer_load_dwordx4 v[16:19], v9, s[8:11], s28 offen sc1
  s_add_u32 s28, s27, 256
  buffer_load_dwordx4 v[20:23], v9, s[8:11], s28 offen sc1
  s_add_u32 s28, s27, 2048
  buffer_load_dwordx4 v[24:27], v9, s[8:11], s28 offen sc1
  s_add_u32 s28, s27, 2304
  buffer_load_dwordx4 v[28:31], v9, s[8:11], s28 offen sc1
  s_cmp_lt_u32 s21, 2
  s_cbranch_scc0 g3_119
  s_add_u32 s28, s27, 4096
  buffer_load_dwordx4 v[32:35], v9, s[8:11], s28 offen sc1
  s_add_u32 s28, s27, 4352
  buffer_load_dwordx4 v[36:39], v9, s[8:11], s28 offen sc1
g3_119:
  s_mov_b32 s45, 0
  v_mov_b32 v3, 0
aw_120:
  buffer_load_dword v4, v3, s[8:11], s48 offen sc1
  s_add_u32 s45, s45, 1
  s_waitcnt vmcnt(0)
  v_readfirstlane_b32 s29, v4
  s_cmp_ge_u32 s29, 32
  s_cbranch_scc1 aw_120_ok
  s_cmp_lt_u32 s45, 400000
  s_cbranch_scc1 aw_120
  s_branch kb2_abort
aw_120_ok:
  s_mul_i32 s28, s26, 40960
  s_mul_i32 s31, s21, 10240
  s_add_u32 s28, s28, s31
  s_add_u32 s28, s28, 0xf200000
  s_add_u32 m0, s31, 0
  s_add_u32 s29, s28, 0
  buffer_load_dwordx4 v2, s[8:11], s29 offen sc1 lds
  s_add_u32 m0, s31, 1024
  s_add_u32 s29, s28, 1024
  buffer_load_dwordx4 v2, s[8:11], s29 offen sc1 lds
  s_add_u32 m0, s31, 2048
  s_add_u32 s29, s28, 2048
  buffer_load_dwordx4 v2, s[8:11], s29 offen sc1 lds
  s_add_u32 m0, s31, 3072
  s_add_u32 s29, s28, 3072
  buffer_load_dwordx4 v2, s[8:11], s29 offen sc1 lds
  s_add_u32 m0, s31, 4096
  s_add_u32 s29, s28, 4096
  buffer_load_dwordx4 v2, s[8:11], s29 offen sc1 lds
  s_add_u32 m0, s31, 5120
  s_add_u32 s29, s28, 5120
  buffer_load_dwordx4 v2, s[8:11], s29 offen sc1 lds
  s_add_u32 m0, s31, 6144
  s_add_u32 s29, s28, 6144
  buffer_load_dwordx4 v2, s[8:11], s29 offen sc1 lds
  s_add_u32 m0, s31, 7168
  s_add_u32 s29, s28, 7168
  buffer_load_dwordx4 v2, s[8:11], s29 offen sc1 lds
  s_add_u32 m0, s31, 8192
  s_add_u32 s29, s28, 8192
  buffer_load_dwordx4 v2, s[8:11], s29 offen sc1 lds
  s_add_u32 m0, s31, 9216
  s_add_u32 s29, s28, 9216
  buffer_load_dwordx4 v2, s[8:11], s29 offen sc1 lds
  s_waitcnt vmcnt(0)
  s_barrier
  ds_read_b128 v[80:83], v2 offset:0
  ds_read_b128 v[84:87], v2 offset:20480
  ds_read_b128 v[88:91], v2 offset:1024
  ds_read_b128 v[92:95], v2 offset:21504
  ds_read_b128 v[96:99], v2 offset:2048
  ds_read_b128 v[100:103], v2 offset:22528
  s_waitcnt lgkmcnt(4)
  v_mfma_f32_16x16x32_bf16 v[48:51], a[0:3], v[80:83], 0
  v_mfma_f32_16x16x32_bf16 v[52:55], a[0:3], v[84:87], 0
  v_mfma_f32_16x16x32_bf16 v[56:59], a[80:83], v[80:83], 0
  v_mfma_f32_16x16x32_bf16 v[60:63], a[80:83], v[84:87], 0
  v_mfma_f32_16x16x32_bf16 v[64:67], a[160:163], v[80:83], 0
  v_mfma_f32_16x16x32_bf16 v[68:71], a[160:163], v[84:87], 0
  ds_read_b128 v[80:83], v2 offset:3072
  ds_read_b128 v[84:87], v2 offset:23552
  s_waitcnt lgkmcnt(4)
  v_mfma_f32_16x16x32_bf16 v[48:51], a[4:7], v[88:91], v[48:51]
  v_mfma_f32_16x16x32_bf16 v[52:55], a[4:7], v[92:95], v[52:55]
  v_mfma_f32_16x16x32_bf16 v[56:59], a[84:87], v[88:91], v[56:59]
  v_mfma_f32_16x16x32_bf16 v[60:63], a[84:87], v[92:95], v[60:63]
  v_mfma_f32_16x16x32_bf16 v[64:67], a[164:167], v[88:91], v[64:67]
  v_mfma_f32_16x16x32_bf16 v[68:71], a[164:167], v[92:95], v[68:71]
  ds_read_b128 v[88:91], v2 offset:4096
  ds_read_b128 v[92:95], v2 offset:24576
  s_waitcnt lgkmcnt(4)
  v_mfma_f32_16x16x32_bf16 v[48:51], a[8:11], v[96:99], v[48:51]
  v_mfma_f32_16x16x32_bf16 v[52:55], a[8:11], v[100:103], v[52:55]
  v_mfma_f32_16x16x32_bf16 v[56:59], a[88:91], v[96:99], v[56:59]
  v_mfma_f32_16x16x32_bf16 v[60:63], a[88:91], v[100:103], v[60:63]
  v_mfma_f32_16x16x32_bf16 v[64:67], a[168:171], v[96:99], v[64:67]
  v_mfma_f32_16x16x32_bf16 v[68:71], a[168:171], v[100:103], v[68:71]
  ds_read_b128 v[96:99], v2 offset:5120
  ds_read_b128 v[100:103], v2 offset:25600
  s_waitcnt lgkmcnt(4)
  v_mfma_f32_16x16x32_bf16 v[48:51], a[12:15], v[80:83], v[48:51]
  v_mfma_f32_16x16x32_bf16 v[52:55], a[12:15], v[84:87], v[52:55]
  v_mfma_f32_16x16x32_bf16 v[56:59], a[92:95], v[80:83], v[56:59]
  v_mfma_f32_16x16x32_bf16 v[60:63], a[92:95], v[84:87], v[60:63]
  v_mfma_f32_16x16x32_bf16 v[64:67], a[172:175], v[80:83], v[64:67]
  v_mfma_f32_16x16x32_bf16 v[68:71], a[172:175], v[84:87], v[68:71]
  ds_read_b128 v[80:83], v2 offset:6144
  ds_read_b128 v[84:87], v2 offset:26624
  s_waitcnt lgkmcnt(4)
  v_mfma_f32_16x16x32_bf16 v[48:51], a[16:19], v[88:91], v[48:51]
  v_mfma_f32_16x16x32_bf16 v[52:55], a[16:19], v[92:95], v[52:55]
  v_mfma_f32_16x16x32_bf16 v[56:59], a[96:99], v[88:91], v[56:59]
  v_mfma_f32_16x16x32_bf16 v[60:63], a[96:99], v[92:95], v[60:63]
  v_mfma_f32_16x16x32_bf16 v[64:67], a[176:179], v[88:91], v[64:67]
  v_mfma_f32_16x16x32_bf16 v[68:71], a[176:179], v[92:95], v[68:71]
  ds_read_b128 v[88:91], v2 offset:7168
  ds_read_b128 v[92:95], v2 offset:27648
  s_waitcnt lgkmcnt(4)
  v_mfma_f32_16x16x32_bf16 v[48:51], a[20:23], v[96:99], v[48:51]
  v_mfma_f32_16x16x32_bf16 v[52:55], a[20:23], v[100:103], v[52:55]
  v_mfma_f32_16x16x32_bf16 v[56:59], a[100:103], v[96:99], v[56:59]
  v_mfma_f32_16x16x32_bf16 v[60:63], a[100:103], v[100:103], v[60:63]
  v_mfma_f32_16x16x32_bf16 v[64:67], a[180:183], v[96:99], v[64:67]
  v_mfma_f32_16x16x32_bf16 v[68:71], a[180:183], v[100:103], v[68:71]
  ds_read_b128 v[96:99], v2 offset:8192
  ds_read_b128 v[100:103], v2 offset:28672
  s_waitcnt lgkmcnt(4)
  v_mfma_f32_16x16x32_bf16 v[48:51], a[24:27], v[80:83], v[48:51]
  v_mfma_f32_16x16x32_bf16 v[52:55], a[24:27], v[84:87], v[52:55]
  v_mfma_f32_16x16x32_bf16 v[56:59], a[104:107], v[80:83], v[56:59]
  v_mfma_f32_16x16x32_bf16 v[60:63], a[104:107], v[84:87], v[60:63]
  v_mfma_f32_16x16x32_bf16 v[64:67], a[184:187], v[80:83], v[64:67]
  v_mfma_f32_16x16x32_bf16 v[68:71], a[184:187], v[84:87], v[68:71]
  ds_read_b128 v[80:83], v2 offset:9216
  ds_read_b128 v[84:87], v2 offset:29696
  s_waitcnt lgkmcnt(4)
  v_mfma_f32_16x16x32_bf16 v[48:51], a[28:31], v[88:91], v[48:51]
  v_mfma_f32_16x16x32_bf16 v[52:55], a[28:31], v[92:95], v[52:55]
  v_mfma_f32_16x16x32_bf16 v[56:59], a[108:111], v[88:91], v[56:59]
  v_mfma_f32_16x16x32_bf16 v[60:63], a[108:111], v[92:95], v[60:63]
  v_mfma_f32_16x16x32_bf16 v[64:67], a[188:191], v[88:91], v[64:67]
  v_mfma_f32_16x16x32_bf16 v[68:71], a[188:191], v[92:95], v[68:71]
  ds_read_b128 v[88:91], v2 offset:10240
  ds_read_b128 v[92:95], v2 offset:30720
  s_waitcnt lgkmcnt(4)
  v_mfma_f32_16x16x32_bf16 v[48:51], a[32:35], v[96:99], v[48:51]
  v_mfma_f32_16x16x32_bf16 v[52:55], a[32:35], v[100:103], v[52:55]
  v_mfma_f32_16x16x32_bf16 v[56:59], a[112:115], v[96:99], v[56:59]
  v_mfma_f32_16x16x32_bf16 v[60:63], a[112:115], v[100:103], v[60:63]
  v_mfma_f32_16x16x32_bf16 v[64:67], a[192:195], v[96:99], v[64:67]
  v_mfma_f32_16x16x32_bf16 v[68:71], a[192:195], v[100:103], v[68:71]
  ds_read_b128 v[96:99], v2 offset:11264
  ds_read_b128 v[100:103], v2 offset:31744
  s_waitcnt lgkmcnt(4)
  v_mfma_f32_16x16x32_bf16 v[48:51], a[36:39], v[80:83], v[48:51]
  v_mfma_f32_16x16x32_bf16 v[52:55], a[36:39], v[84:87], v[52:55]
  v_mfma_f32_16x16x32_bf16 v[56:59], a[116:119], v[80:83], v[56:59]
  v_mfma_f32_16x16x32_bf16 v[60:63], a[116:119], v[84:87], v[60:63]
  v_mfma_f32_16x16x32_bf16 v[64:67], a[196:199], v[80:83], v[64:67]
  v_mfma_f32_16x16x32_bf16 v[68:71], a[196:199], v[84:87], v[68:71]
  ds_read_b128 v[80:83], v2 offset:12288
  ds_read_b128 v[84:87], v2 offset:32768
  s_waitcnt lgkmcnt(4)
  v_mfma_f32_16x16x32_bf16 v[48:51], a[40:43], v[88:91], v[48:51]
  v_mfma_f32_16x16x32_bf16 v[52:55], a[40:43], v[92:95], v[52:55]
  v_mfma_f32_16x16x32_bf16 v[56:59], a[120:123], v[88:91], v[56:59]
  v_mfma_f32_16x16x32_bf16 v[60:63], a[120:123], v[92:95], v[60:63]
  v_mfma_f32_16x16x32_bf16 v[64:67], a[200:203], v[88:91], v[64:67]
  v_mfma_f32_16x16x32_bf16 v[68:71], a[200:203], v[92:95], v[68:71]
  ds_read_b128 v[88:91], v2 offset:13312
  ds_read_b128 v[92:95], v2 offset:33792
  s_waitcnt lgkmcnt(4)
  v_mfma_f32_16x16x32_bf16 v[48:51], a[44:47], v[96:99], v[48:51]
  v_mfma_f32_16x16x32_bf16 v[52:55], a[44:47], v[100:103], v[52:55]
  v_mfma_f32_16x16x32_bf16 v[56:59], a[124:127], v[96:99], v[56:59]
  v_mfma_f32_16x16x32_bf16 v[60:63], a[124:127], v[100:103], v[60:63]
  v_mfma_f32_16x16x32_bf16 v[64:67], a[204:207], v[96:99], v[64:67]
  v_mfma_f32_16x16x32_bf16 v[68:71], a[204:207], v[100:103], v[68:71]
  ds_read_b128 v[96:99], v2 offset:14336
  ds_read_b128 v[100:103], v2 offset:34816
  s_waitcnt lgkmcnt(4)
  v_mfma_f32_16x16x32_bf16 v[48:51], a[48:51], v[80:83], v[48:51]
  v_mfma_f32_16x16x32_bf16 v[52:55], a[48:51], v[84:87], v[52:55]
  v_mfma_f32_16x16x32_bf16 v[56:59], a[128:131], v[80:83], v[56:59]
  v_mfma_f32_16x16x32_bf16 v[60:63], a[128:131], v[84:87], v[60:63]
  v_mfma_f32_16x16x32_bf16 v[64:67], a[208:211], v[80:83], v[64:67]
  v_mfma_f32_16x16x32_bf16 v[68:71], a[208:211], v[84:87], v[68:71]
  ds_read_b128 v[80:83], v2 offset:15360
  ds_read_b128 v[84:87], v2 offset:35840
  s_waitcnt lgkmcnt(4)
  v_mfma_f32_16x16x32_bf16 v[48:51], a[52:55], v[88:91], v[48:51]
  v_mfma_f32_16x16x32_bf16 v[52:55], a[52:55], v[92:95], v[52:55]
  v_mfma_f32_16x16x32_bf16 v[56:59], a[132:135], v[88:91], v[56:59]
  v_mfma_f32_16x16x32_bf16 v[60:63], a[132:135], v[92:95], v[60:63]
  v_mfma_f32_16x16x32_bf16 v[64:67], a[212:215], v[88:91], v[64:67]
  v_mfma_f32_16x16x32_bf16 v[68:71], a[212:215], v[92:95], v[68:71]
  ds_read_b128 v[88:91], v2 offset:16384
  ds_read_b128 v[92:95], v2 offset:36864
  s_waitcnt lgkmcnt(4)
  v_mfma_f32_16x16x32_bf16 v[48:51], a[56:59], v[96:99], v[48:51]
  v_mfma_f32_16x16x32_bf16 v[52:55], a[56:59], v[100:103], v[52:55]
  v_mfma_f32_16x16x32_bf16 v[56:59], a[136:139], v[96:99], v[56:59]
  v_mfma_f32_16x16x32_bf16 v[60:63], a[136:139], v[100:103], v[60:63]
  v_mfma_f32_16x16x32_bf16 v[64:67], a[216:219], v[96:99], v[64:67]
  v_mfma_f32_16x16x32_bf16 v[68:71], a[216:219], v[100:103], v[68:71]
  ds_read_b128 v[96:99], v2 offset:17408
  ds_read_b128 v[100:103], v2 offset:37888
  s_waitcnt lgkmcnt(4)
  v_mfma_f32_16x16x32_bf16 v[48:51], a[60:63], v[80:83], v[48:51]
  v_mfma_f32_16x16x32_bf16 v[52:55], a[60:63], v[84:87], v[52:55]
  v_mfma_f32_16x16x32_bf16 v[56:59], a[140:143], v[80:83], v[56:59]
  v_mfma_f32_16x16x32_bf16 v[60:63], a[140:143], v[84:87], v[60:63]
  v_mfma_f32_16x16x32_bf16 v[64:67], a[220:223], v[80:83], v[64:67]
  v_mfma_f32_16x16x32_bf16 v[68:71], a[220:223], v[84:87], v[68:71]
  ds_read_b128 v[80:83], v2 offset:18432
  ds_read_b128 v[84:87], v2 offset:38912
  s_waitcnt lgkmcnt(4)
  v_mfma_f32_16x16x32_bf16 v[48:51], a[64:67], v[88:91], v[48:51]
  v_mfma_f32_16x16x32_bf16 v[52:55], a[64:67], v[92:95], v[52:55]
  v_mfma_f32_16x16x32_bf16 v[56:59], a[144:147], v[88:91], v[56:59]
  v_mfma_f32_16x16x32_bf16 v[60:63], a[144:147], v[92:95], v[60:63]
  v_mfma_f32_16x16x32_bf16 v[64:67], a[224:227], v[88:91], v[64:67]
  v_mfma_f32_16x16x32_bf16 v[68:71], a[224:227], v[92:95], v[68:71]
  ds_read_b128 v[88:91], v2 offset:19456
  ds_read_b128 v[92:95], v2 offset:39936
  s_waitcnt lgkmcnt(4)
  v_mfma_f32_16x16x32_bf16 v[48:51], a[68:71], v[96:99], v[48:51]
  v_mfma_f32_16x16x32_bf16 v[52:55], a[68:71], v[100:103], v[52:55]
  v_mfma_f32_16x16x32_bf16 v[56:59], a[148:151], v[96:99], v[56:59]
  v_mfma_f32_16x16x32_bf16 v[60:63], a[148:151], v[100:103], v[60:63]
  v_mfma_f32_16x16x32_bf16 v[64:67], a[228:231], v[96:99], v[64:67]
  v_mfma_f32_16x16x32_bf16 v[68:71], a[228:231], v[100:103], v[68:71]
  s_waitcnt lgkmcnt(2)
  v_mfma_f32_16x16x32_bf16 v[48:51], a[72:75], v[80:83], v[48:51]
  v_mfma_f32_16x16x32_bf16 v[52:55], a[72:75], v[84:87], v[52:55]
  v_mfma_f32_16x16x32_bf16 v[56:59], a[152:155], v[80:83], v[56:59]
  v_mfma_f32_16x16x32_bf16 v[60:63], a[152:155], v[84:87], v[60:63]
  v_mfma_f32_16x16x32_bf16 v[64:67], a[232:235], v[80:83], v[64:67]
  v_mfma_f32_16x16x32_bf16 v[68:71], a[232:235], v[84:87], v[68:71]
  s_waitcnt lgkmcnt(0)
  v_mfma_f32_16x16x32_bf16 v[48:51], a[76:79], v[88:91], v[48:51]
  v_mfma_f32_16x16x32_bf16 v[52:55], a[76:79], v[92:95], v[52:55]
  v_mfma_f32_16x16x32_bf16 v[56:59], a[156:159], v[88:91], v[56:59]
  v_mfma_f32_16x16x32_bf16 v[60:63], a[156:159], v[92:95], v[60:63]
  v_mfma_f32_16x16x32_bf16 v[64:67], a[236:239], v[88:91], v[64:67]
  v_mfma_f32_16x16x32_bf16 v[68:71], a[236:239], v[92:95], v[68:71]
  s_nop 7
  v_mul_u32_u24 v10, 1280, v5
  v_lshlrev_b32 v11, 3, v6
  v_add_u32 v10, v10, v11
  s_mul_i32 s30, s26, 40960
  s_lshl_b32 s31, s50, 5
  s_add_u32 s30, s30, s31
  v_add_f32 v48, v48, v16
  v_add_f32 v49, v49, v17
  v_add_f32 v50, v50, v18
  v_add_f32 v51, v51, v19
  v_cvt_pk_bf16_f32 v48, v48, v49
  v_cvt_pk_bf16_f32 v49, v50, v51
  s_add_u32 s28, s30, 0
  buffer_store_dwordx2 v[48:49], v10, s[16:19], s28 offen
  v_add_f32 v52, v52, v20
  v_add_f32 v53, v53, v21
  v_add_f32 v54, v54, v22
  v_add_f32 v55, v55, v23
  v_cvt_pk_bf16_f32 v52, v52, v53
  v_cvt_pk_bf16_f32 v53, v54, v55
  s_add_u32 s28, s30, 20480
  buffer_store_dwordx2 v[52:53], v10, s[16:19], s28 offen
  v_add_f32 v56, v56, v24
  v_add_f32 v57, v57, v25
  v_add_f32 v58, v58, v26
  v_add_f32 v59, v59, v27
  v_cvt_pk_bf16_f32 v56, v56, v57
  v_cvt_pk_bf16_f32 v57, v58, v59
  s_add_u32 s28, s30, 32
  buffer_store_dwordx2 v[56:57], v10, s[16:19], s28 offen
  v_add_f32 v60, v60, v28
  v_add_f32 v61, v61, v29
  v_add_f32 v62, v62, v30
  v_add_f32 v63, v63, v31
  v_cvt_pk_bf16_f32 v60, v60, v61
  v_cvt_pk_bf16_f32 v61, v62, v63
  s_add_u32 s28, s30, 20512
  buffer_store_dwordx2 v[60:61], v10, s[16:19], s28 offen
  s_cmp_lt_u32 s21, 2
  s_cbranch_scc0 g3_121
  v_add_f32 v64, v64, v32
  v_add_f32 v65, v65, v33
  v_add_f32 v66, v66, v34
  v_add_f32 v67, v67, v35
  v_cvt_pk_bf16_f32 v64, v64, v65
  v_cvt_pk_bf16_f32 v65, v66, v67
  s_add_u32 s28, s30, 64
  buffer_store_dwordx2 v[64:65], v10, s[16:19], s28 offen
  v_add_f32 v68, v68, v36
  v_add_f32 v69, v69, v37
  v_add_f32 v70, v70, v38
  v_add_f32 v71, v71, v39
  v_cvt_pk_bf16_f32 v68, v68, v69
  v_cvt_pk_bf16_f32 v69, v70, v71
  s_add_u32 s28, s30, 20544
  buffer_store_dwordx2 v[68:69], v10, s[16:19], s28 offen
g3_121:
  s_endpgm
kb2_abort:
  s_load_dwordx2 s[6:7], s[0:1], 88
  v_mov_b32 v2, 80
  v_mov_b32 v3, 1
  s_waitcnt lgkmcnt(0)
  s_mov_b64 exec, 1
  global_atomic_add v2, v3, s[6:7]
  s_waitcnt vmcnt(0)
kb2_exit:
  s_endpgm

.section .rodata,"a"
.p2align 6
.amdhsa_kernel kb2_kernel
  .amdhsa_next_free_vgpr 512
  .amdhsa_next_free_sgpr 102
  .amdhsa_accum_offset 256
  .amdhsa_group_segment_fixed_size 0
  .amdhsa_kernarg_size 104
  .amdhsa_user_sgpr_count 2
  .amdhsa_user_sgpr_kernarg_segment_ptr 1
  .amdhsa_system_sgpr_workgroup_id_x 1
.end_amdhsa_kernel
```

```asm
; @launch kernel=prep_kernel grid=(256,1,1) block=(256,1,1) lds=32768
; @launch kernel=ka1_kernel grid=(256,1,1) block=(256,1,1) lds=163840
; @launch kernel=kb1_kernel grid=(256,1,1) block=(256,1,1) lds=135168
; @launch kernel=ka2_kernel grid=(256,1,1) block=(256,1,1) lds=163840
; @launch kernel=kb2_kernel grid=(256,1,1) block=(256,1,1) lds=135168
.amdgcn_target "amdgcn-amd-amdhsa--gfx950"
.text
.globl prep_kernel
.p2align 8
.type prep_kernel,@function
prep_kernel:
  s_cmp_ge_u32 s2, 256
  s_cbranch_scc1 k0_exit
  s_load_dwordx4 s[36:39], s[0:1], 0
  s_load_dwordx4 s[40:43], s[0:1], 32
  s_load_dwordx4 s[44:47], s[0:1], 64
  s_load_dwordx2 s[4:5], s[0:1], 96
  v_lshrrev_b32 v1, 6, v0
  s_nop 0
  v_readfirstlane_b32 s21, v1
  v_and_b32 v1, 63, v0
  v_lshlrev_b32 v2, 4, v1
  s_waitcnt lgkmcnt(0)
  s_mov_b32 s8, s4
  s_and_b32 s9, s5, 0xffff
  s_mov_b32 s10, 0x10000000
  s_mov_b32 s11, 0x20000
  v_mov_b32 v4, -1
  v_mov_b32 v5, -1
  v_mov_b32 v6, -1
  v_mov_b32 v7, -1
  s_mul_i32 s26, s2, 61440
  s_mul_i32 s27, s21, 15360
  s_add_u32 s26, s26, s27
  s_add_u32 s26, s26, 0x400000
  buffer_store_dwordx4 v[4:7], v2, s[8:11], s26 offen
  s_add_u32 s26, s26, 1024
  buffer_store_dwordx4 v[4:7], v2, s[8:11], s26 offen
  s_add_u32 s26, s26, 1024
  buffer_store_dwordx4 v[4:7], v2, s[8:11], s26 offen
  s_add_u32 s26, s26, 1024
  buffer_store_dwordx4 v[4:7], v2, s[8:11], s26 offen
  s_add_u32 s26, s26, 1024
  buffer_store_dwordx4 v[4:7], v2, s[8:11], s26 offen
  s_add_u32 s26, s26, 1024
  buffer_store_dwordx4 v[4:7], v2, s[8:11], s26 offen
  s_add_u32 s26, s26, 1024
  buffer_store_dwordx4 v[4:7], v2, s[8:11], s26 offen
  s_add_u32 s26, s26, 1024
  buffer_store_dwordx4 v[4:7], v2, s[8:11], s26 offen
  s_add_u32 s26, s26, 1024
  buffer_store_dwordx4 v[4:7], v2, s[8:11], s26 offen
  s_add_u32 s26, s26, 1024
  buffer_store_dwordx4 v[4:7], v2, s[8:11], s26 offen
  s_add_u32 s26, s26, 1024
  buffer_store_dwordx4 v[4:7], v2, s[8:11], s26 offen
  s_add_u32 s26, s26, 1024
  buffer_store_dwordx4 v[4:7], v2, s[8:11], s26 offen
  s_add_u32 s26, s26, 1024
  buffer_store_dwordx4 v[4:7], v2, s[8:11], s26 offen
  s_add_u32 s26, s26, 1024
  buffer_store_dwordx4 v[4:7], v2, s[8:11], s26 offen
  s_add_u32 s26, s26, 1024
  buffer_store_dwordx4 v[4:7], v2, s[8:11], s26 offen
  s_add_u32 s26, s26, 1024
  s_cmp_eq_u32 s2, 0
  s_cbranch_scc0 z_1
  s_cmp_eq_u32 s21, 0
  s_cbranch_scc0 z_1
  v_mov_b32 v8, 0
  v_mov_b32 v9, 0
  v_mov_b32 v10, 0
  v_mov_b32 v11, 0
  s_mov_b32 s26, 0x0
  buffer_store_dwordx4 v[8:11], v2, s[8:11], s26 offen
  s_add_u32 s26, s26, 1024
  buffer_store_dwordx4 v[8:11], v2, s[8:11], s26 offen
  s_add_u32 s26, s26, 1024
  buffer_store_dwordx4 v[8:11], v2, s[8:11], s26 offen
  s_add_u32 s26, s26, 1024
  buffer_store_dwordx4 v[8:11], v2, s[8:11], s26 offen
  s_add_u32 s26, s26, 1024
  buffer_store_dwordx4 v[8:11], v2, s[8:11], s26 offen
  s_add_u32 s26, s26, 1024
  buffer_store_dwordx4 v[8:11], v2, s[8:11], s26 offen
  s_add_u32 s26, s26, 1024
  s_mov_b32 s26, 0x8000
  buffer_store_dwordx4 v[8:11], v2, s[8:11], s26 offen
  s_add_u32 s26, s26, 1024
  buffer_store_dwordx4 v[8:11], v2, s[8:11], s26 offen
  s_add_u32 s26, s26, 1024
  buffer_store_dwordx4 v[8:11], v2, s[8:11], s26 offen
  s_add_u32 s26, s26, 1024
  buffer_store_dwordx4 v[8:11], v2, s[8:11], s26 offen
  s_add_u32 s26, s26, 1024
  buffer_store_dwordx4 v[8:11], v2, s[8:11], s26 offen
  s_add_u32 s26, s26, 1024
  buffer_store_dwordx4 v[8:11], v2, s[8:11], s26 offen
  s_add_u32 s26, s26, 1024
  buffer_store_dwordx4 v[8:11], v2, s[8:11], s26 offen
  s_add_u32 s26, s26, 1024
  buffer_store_dwordx4 v[8:11], v2, s[8:11], s26 offen
  s_add_u32 s26, s26, 1024
  buffer_store_dwordx4 v[8:11], v2, s[8:11], s26 offen
  s_add_u32 s26, s26, 1024
  buffer_store_dwordx4 v[8:11], v2, s[8:11], s26 offen
  s_add_u32 s26, s26, 1024
  buffer_store_dwordx4 v[8:11], v2, s[8:11], s26 offen
  s_add_u32 s26, s26, 1024
  buffer_store_dwordx4 v[8:11], v2, s[8:11], s26 offen
  s_add_u32 s26, s26, 1024
  buffer_store_dwordx4 v[8:11], v2, s[8:11], s26 offen
  s_add_u32 s26, s26, 1024
  buffer_store_dwordx4 v[8:11], v2, s[8:11], s26 offen
  s_add_u32 s26, s26, 1024
  buffer_store_dwordx4 v[8:11], v2, s[8:11], s26 offen
  s_add_u32 s26, s26, 1024
  buffer_store_dwordx4 v[8:11], v2, s[8:11], s26 offen
  s_add_u32 s26, s26, 1024
z_1:
  s_cmp_eq_u32 s2, 1
  s_cbranch_scc0 m0_2
  s_cmp_eq_u32 s21, 0
  s_cbranch_scc0 m0_2
  s_mov_b32 s12, s38
  s_and_b32 s13, s39, 0xffff
  s_mov_b32 s14, 0x2800
  s_mov_b32 s15, 0x20000
  v_and_b32 v8, 7, v1
  v_mul_u32_u24 v8, 1280, v8
  v_lshrrev_b32 v9, 4, v1
  v_lshlrev_b32 v9, 5, v9
  v_add_u32 v8, v8, v9
  v_bfe_u32 v9, v1, 3, 1
  v_lshlrev_b32 v9, 2, v9
  v_add_u32 v8, v8, v9
  s_mov_b32 s26, 0x4000
  buffer_load_dword v12, v8, s[12:15], 0 offen offset:0
  buffer_load_dword v13, v8, s[12:15], 0 offen offset:8
  buffer_load_dword v14, v8, s[12:15], 0 offen offset:16
  buffer_load_dword v15, v8, s[12:15], 0 offen offset:24
  s_waitcnt vmcnt(0)
  buffer_store_dwordx4 v[12:15], v2, s[8:11], s26 offen
  s_add_u32 s26, s26, 1024
  s_nop 1
  buffer_load_dword v12, v8, s[12:15], 0 offen offset:128
  buffer_load_dword v13, v8, s[12:15], 0 offen offset:136
  buffer_load_dword v14, v8, s[12:15], 0 offen offset:144
  buffer_load_dword v15, v8, s[12:15], 0 offen offset:152
  s_waitcnt vmcnt(0)
  buffer_store_dwordx4 v[12:15], v2, s[8:11], s26 offen
  s_add_u32 s26, s26, 1024
  s_nop 1
  buffer_load_dword v12, v8, s[12:15], 0 offen offset:256
  buffer_load_dword v13, v8, s[12:15], 0 offen offset:264
  buffer_load_dword v14, v8, s[12:15], 0 offen offset:272
  buffer_load_dword v15, v8, s[12:15], 0 offen offset:280
  s_waitcnt vmcnt(0)
  buffer_store_dwordx4 v[12:15], v2, s[8:11], s26 offen
  s_add_u32 s26, s26, 1024
  s_nop 1
  buffer_load_dword v12, v8, s[12:15], 0 offen offset:384
  buffer_load_dword v13, v8, s[12:15], 0 offen offset:392
  buffer_load_dword v14, v8, s[12:15], 0 offen offset:400
  buffer_load_dword v15, v8, s[12:15], 0 offen offset:408
  s_waitcnt vmcnt(0)
  buffer_store_dwordx4 v[12:15], v2, s[8:11], s26 offen
  s_add_u32 s26, s26, 1024
  s_nop 1
  buffer_load_dword v12, v8, s[12:15], 0 offen offset:512
  buffer_load_dword v13, v8, s[12:15], 0 offen offset:520
  buffer_load_dword v14, v8, s[12:15], 0 offen offset:528
  buffer_load_dword v15, v8, s[12:15], 0 offen offset:536
  s_waitcnt vmcnt(0)
  buffer_store_dwordx4 v[12:15], v2, s[8:11], s26 offen
  s_add_u32 s26, s26, 1024
  s_nop 1
  buffer_load_dword v12, v8, s[12:15], 0 offen offset:640
  buffer_load_dword v13, v8, s[12:15], 0 offen offset:648
  buffer_load_dword v14, v8, s[12:15], 0 offen offset:656
  buffer_load_dword v15, v8, s[12:15], 0 offen offset:664
  s_waitcnt vmcnt(0)
  buffer_store_dwordx4 v[12:15], v2, s[8:11], s26 offen
  s_add_u32 s26, s26, 1024
  s_nop 1
  buffer_load_dword v12, v8, s[12:15], 0 offen offset:768
  buffer_load_dword v13, v8, s[12:15], 0 offen offset:776
  buffer_load_dword v14, v8, s[12:15], 0 offen offset:784
  buffer_load_dword v15, v8, s[12:15], 0 offen offset:792
  s_waitcnt vmcnt(0)
  buffer_store_dwordx4 v[12:15], v2, s[8:11], s26 offen
  s_add_u32 s26, s26, 1024
  s_nop 1
  buffer_load_dword v12, v8, s[12:15], 0 offen offset:896
  buffer_load_dword v13, v8, s[12:15], 0 offen offset:904
  buffer_load_dword v14, v8, s[12:15], 0 offen offset:912
  buffer_load_dword v15, v8, s[12:15], 0 offen offset:920
  s_waitcnt vmcnt(0)
  buffer_store_dwordx4 v[12:15], v2, s[8:11], s26 offen
  s_add_u32 s26, s26, 1024
  s_nop 1
  buffer_load_dword v12, v8, s[12:15], 0 offen offset:1024
  buffer_load_dword v13, v8, s[12:15], 0 offen offset:1032
  buffer_load_dword v14, v8, s[12:15], 0 offen offset:1040
  buffer_load_dword v15, v8, s[12:15], 0 offen offset:1048
  s_waitcnt vmcnt(0)
  buffer_store_dwordx4 v[12:15], v2, s[8:11], s26 offen
  s_add_u32 s26, s26, 1024
  s_nop 1
  buffer_load_dword v12, v8, s[12:15], 0 offen offset:1152
  buffer_load_dword v13, v8, s[12:15], 0 offen offset:1160
  buffer_load_dword v14, v8, s[12:15], 0 offen offset:1168
  buffer_load_dword v15, v8, s[12:15], 0 offen offset:1176
  s_waitcnt vmcnt(0)
  buffer_store_dwordx4 v[12:15], v2, s[8:11], s26 offen
  s_add_u32 s26, s26, 1024
  s_nop 1
m0_2:
  s_cmp_eq_u32 s21, 3
  s_cbranch_scc0 ln_3
  s_mov_b32 s12, s36
  s_and_b32 s13, s37, 0xffff
  s_mov_b32 s14, 0x280000
  s_mov_b32 s15, 0x20000
  v_lshrrev_b32 v8, 3, v1
  v_and_b32 v9, 7, v1
  s_lshl_b32 s26, s2, 3
  v_add_u32 v10, s26, v8
  v_mul_u32_u24 v11, 1280, v10
  v_lshlrev_b32 v12, 4, v9
  v_add_u32 v11, v11, v12
  buffer_load_dwordx4 v[16:19], v11, s[12:15], 0 offen offset:0
  buffer_load_dwordx4 v[20:23], v11, s[12:15], 0 offen offset:128
  buffer_load_dwordx4 v[24:27], v11, s[12:15], 0 offen offset:256
  buffer_load_dwordx4 v[28:31], v11, s[12:15], 0 offen offset:384
  buffer_load_dwordx4 v[32:35], v11, s[12:15], 0 offen offset:512
  buffer_load_dwordx4 v[36:39], v11, s[12:15], 0 offen offset:640
  buffer_load_dwordx4 v[40:43], v11, s[12:15], 0 offen offset:768
  buffer_load_dwordx4 v[44:47], v11, s[12:15], 0 offen offset:896
  buffer_load_dwordx4 v[48:51], v11, s[12:15], 0 offen offset:1024
  buffer_load_dwordx4 v[52:55], v11, s[12:15], 0 offen offset:1152
  v_lshrrev_b32 v12, 5, v10
  v_mul_u32_u24 v12, 40960, v12
  v_lshrrev_b32 v13, 1, v9
  v_lshlrev_b32 v13, 10, v13
  v_add_u32 v12, v12, v13
  v_and_b32 v13, 1, v9
  v_lshlrev_b32 v13, 5, v13
  v_and_b32 v14, 31, v10
  v_add_u32 v13, v13, v14
  v_lshlrev_b32 v13, 4, v13
  v_add_u32 v12, v12, v13
  s_waitcnt vmcnt(0)
  v_lshlrev_b32 v64, 16, v16
  v_and_b32 v65, 0xffff0000, v16
  v_lshlrev_b32 v66, 16, v17
  v_and_b32 v67, 0xffff0000, v17
  v_lshlrev_b32 v68, 16, v18
  v_and_b32 v69, 0xffff0000, v18
  v_lshlrev_b32 v70, 16, v19
  v_and_b32 v71, 0xffff0000, v19
  v_lshlrev_b32 v72, 16, v20
  v_and_b32 v73, 0xffff0000, v20
  v_lshlrev_b32 v74, 16, v21
  v_and_b32 v75, 0xffff0000, v21
  v_lshlrev_b32 v76, 16, v22
  v_and_b32 v77, 0xffff0000, v22
  v_lshlrev_b32 v78, 16, v23
  v_and_b32 v79, 0xffff0000, v23
  v_lshlrev_b32 v80, 16, v24
  v_and_b32 v81, 0xffff0000, v24
  v_lshlrev_b32 v82, 16, v25
  v_and_b32 v83, 0xffff0000, v25
  v_lshlrev_b32 v84, 16, v26
  v_and_b32 v85, 0xffff0000, v26
  v_lshlrev_b32 v86, 16, v27
  v_and_b32 v87, 0xffff0000, v27
  v_lshlrev_b32 v88, 16, v28
  v_and_b32 v89, 0xffff0000, v28
  v_lshlrev_b32 v90, 16, v29
  v_and_b32 v91, 0xffff0000, v29
  v_lshlrev_b32 v92, 16, v30
  v_and_b32 v93, 0xffff0000, v30
  v_lshlrev_b32 v94, 16, v31
  v_and_b32 v95, 0xffff0000, v31
  v_lshlrev_b32 v96, 16, v32
  v_and_b32 v97, 0xffff0000, v32
  v_lshlrev_b32 v98, 16, v33
  v_and_b32 v99, 0xffff0000, v33
  v_lshlrev_b32 v100, 16, v34
  v_and_b32 v101, 0xffff0000, v34
  v_lshlrev_b32 v102, 16, v35
  v_and_b32 v103, 0xffff0000, v35
  v_lshlrev_b32 v104, 16, v36
  v_and_b32 v105, 0xffff0000, v36
  v_lshlrev_b32 v106, 16, v37
  v_and_b32 v107, 0xffff0000, v37
  v_lshlrev_b32 v108, 16, v38
  v_and_b32 v109, 0xffff0000, v38
  v_lshlrev_b32 v110, 16, v39
  v_and_b32 v111, 0xffff0000, v39
  v_lshlrev_b32 v112, 16, v40
  v_and_b32 v113, 0xffff0000, v40
  v_lshlrev_b32 v114, 16, v41
  v_and_b32 v115, 0xffff0000, v41
  v_lshlrev_b32 v116, 16, v42
  v_and_b32 v117, 0xffff0000, v42
  v_lshlrev_b32 v118, 16, v43
  v_and_b32 v119, 0xffff0000, v43
  v_lshlrev_b32 v120, 16, v44
  v_and_b32 v121, 0xffff0000, v44
  v_lshlrev_b32 v122, 16, v45
  v_and_b32 v123, 0xffff0000, v45
  v_lshlrev_b32 v124, 16, v46
  v_and_b32 v125, 0xffff0000, v46
  v_lshlrev_b32 v126, 16, v47
  v_and_b32 v127, 0xffff0000, v47
  v_lshlrev_b32 v128, 16, v48
  v_and_b32 v129, 0xffff0000, v48
  v_lshlrev_b32 v130, 16, v49
  v_and_b32 v131, 0xffff0000, v49
  v_lshlrev_b32 v132, 16, v50
  v_and_b32 v133, 0xffff0000, v50
  v_lshlrev_b32 v134, 16, v51
  v_and_b32 v135, 0xffff0000, v51
  v_lshlrev_b32 v136, 16, v52
  v_and_b32 v137, 0xffff0000, v52
  v_lshlrev_b32 v138, 16, v53
  v_and_b32 v139, 0xffff0000, v53
  v_lshlrev_b32 v140, 16, v54
  v_and_b32 v141, 0xffff0000, v54
  v_lshlrev_b32 v142, 16, v55
  v_and_b32 v143, 0xffff0000, v55
  v_add_f32 v14, v64, v65
  v_add_f32 v14, v14, v66
  v_add_f32 v14, v14, v67
  v_add_f32 v14, v14, v68
  v_add_f32 v14, v14, v69
  v_add_f32 v14, v14, v70
  v_add_f32 v14, v14, v71
  v_add_f32 v14, v14, v72
  v_add_f32 v14, v14, v73
  v_add_f32 v14, v14, v74
  v_add_f32 v14, v14, v75
  v_add_f32 v14, v14, v76
  v_add_f32 v14, v14, v77
  v_add_f32 v14, v14, v78
  v_add_f32 v14, v14, v79
  v_add_f32 v14, v14, v80
  v_add_f32 v14, v14, v81
  v_add_f32 v14, v14, v82
  v_add_f32 v14, v14, v83
  v_add_f32 v14, v14, v84
  v_add_f32 v14, v14, v85
  v_add_f32 v14, v14, v86
  v_add_f32 v14, v14, v87
  v_add_f32 v14, v14, v88
  v_add_f32 v14, v14, v89
  v_add_f32 v14, v14, v90
  v_add_f32 v14, v14, v91
  v_add_f32 v14, v14, v92
  v_add_f32 v14, v14, v93
  v_add_f32 v14, v14, v94
  v_add_f32 v14, v14, v95
  v_add_f32 v14, v14, v96
  v_add_f32 v14, v14, v97
  v_add_f32 v14, v14, v98
  v_add_f32 v14, v14, v99
  v_add_f32 v14, v14, v100
  v_add_f32 v14, v14, v101
  v_add_f32 v14, v14, v102
  v_add_f32 v14, v14, v103
  v_add_f32 v14, v14, v104
  v_add_f32 v14, v14, v105
  v_add_f32 v14, v14, v106
  v_add_f32 v14, v14, v107
  v_add_f32 v14, v14, v108
  v_add_f32 v14, v14, v109
  v_add_f32 v14, v14, v110
  v_add_f32 v14, v14, v111
  v_add_f32 v14, v14, v112
  v_add_f32 v14, v14, v113
  v_add_f32 v14, v14, v114
  v_add_f32 v14, v14, v115
  v_add_f32 v14, v14, v116
  v_add_f32 v14, v14, v117
  v_add_f32 v14, v14, v118
  v_add_f32 v14, v14, v119
  v_add_f32 v14, v14, v120
  v_add_f32 v14, v14, v121
  v_add_f32 v14, v14, v122
  v_add_f32 v14, v14, v123
  v_add_f32 v14, v14, v124
  v_add_f32 v14, v14, v125
  v_add_f32 v14, v14, v126
  v_add_f32 v14, v14, v127
  v_add_f32 v14, v14, v128
  v_add_f32 v14, v14, v129
  v_add_f32 v14, v14, v130
  v_add_f32 v14, v14, v131
  v_add_f32 v14, v14, v132
  v_add_f32 v14, v14, v133
  v_add_f32 v14, v14, v134
  v_add_f32 v14, v14, v135
  v_add_f32 v14, v14, v136
  v_add_f32 v14, v14, v137
  v_add_f32 v14, v14, v138
  v_add_f32 v14, v14, v139
  v_add_f32 v14, v14, v140
  v_add_f32 v14, v14, v141
  v_add_f32 v14, v14, v142
  v_add_f32 v14, v14, v143
  s_nop 1
  v_add_f32_dpp v15, v14, v14 quad_perm:[1,0,3,2] row_mask:0xf bank_mask:0xf
  s_nop 1
  v_add_f32_dpp v14, v15, v15 quad_perm:[2,3,0,1] row_mask:0xf bank_mask:0xf
  s_nop 1
  v_add_f32_dpp v15, v14, v14 row_half_mirror row_mask:0xf bank_mask:0xf
  v_mov_b32 v14, v15
  v_mul_f32 v14, 0x3acccccd, v14
  v_sub_f32 v64, v64, v14
  v_sub_f32 v65, v65, v14
  v_sub_f32 v66, v66, v14
  v_sub_f32 v67, v67, v14
  v_sub_f32 v68, v68, v14
  v_sub_f32 v69, v69, v14
  v_sub_f32 v70, v70, v14
  v_sub_f32 v71, v71, v14
  v_sub_f32 v72, v72, v14
  v_sub_f32 v73, v73, v14
  v_sub_f32 v74, v74, v14
  v_sub_f32 v75, v75, v14
  v_sub_f32 v76, v76, v14
  v_sub_f32 v77, v77, v14
  v_sub_f32 v78, v78, v14
  v_sub_f32 v79, v79, v14
  v_sub_f32 v80, v80, v14
  v_sub_f32 v81, v81, v14
  v_sub_f32 v82, v82, v14
  v_sub_f32 v83, v83, v14
  v_sub_f32 v84, v84, v14
  v_sub_f32 v85, v85, v14
  v_sub_f32 v86, v86, v14
  v_sub_f32 v87, v87, v14
  v_sub_f32 v88, v88, v14
  v_sub_f32 v89, v89, v14
  v_sub_f32 v90, v90, v14
  v_sub_f32 v91, v91, v14
  v_sub_f32 v92, v92, v14
  v_sub_f32 v93, v93, v14
  v_sub_f32 v94, v94, v14
  v_sub_f32 v95, v95, v14
  v_sub_f32 v96, v96, v14
  v_sub_f32 v97, v97, v14
  v_sub_f32 v98, v98, v14
  v_sub_f32 v99, v99, v14
  v_sub_f32 v100, v100, v14
  v_sub_f32 v101, v101, v14
  v_sub_f32 v102, v102, v14
  v_sub_f32 v103, v103, v14
  v_sub_f32 v104, v104, v14
  v_sub_f32 v105, v105, v14
  v_sub_f32 v106, v106, v14
  v_sub_f32 v107, v107, v14
  v_sub_f32 v108, v108, v14
  v_sub_f32 v109, v109, v14
  v_sub_f32 v110, v110, v14
  v_sub_f32 v111, v111, v14
  v_sub_f32 v112, v112, v14
  v_sub_f32 v113, v113, v14
  v_sub_f32 v114, v114, v14
  v_sub_f32 v115, v115, v14
  v_sub_f32 v116, v116, v14
  v_sub_f32 v117, v117, v14
  v_sub_f32 v118, v118, v14
  v_sub_f32 v119, v119, v14
  v_sub_f32 v120, v120, v14
  v_sub_f32 v121, v121, v14
  v_sub_f32 v122, v122, v14
  v_sub_f32 v123, v123, v14
  v_sub_f32 v124, v124, v14
  v_sub_f32 v125, v125, v14
  v_sub_f32 v126, v126, v14
  v_sub_f32 v127, v127, v14
  v_sub_f32 v128, v128, v14
  v_sub_f32 v129, v129, v14
  v_sub_f32 v130, v130, v14
  v_sub_f32 v131, v131, v14
  v_sub_f32 v132, v132, v14
  v_sub_f32 v133, v133, v14
  v_sub_f32 v134, v134, v14
  v_sub_f32 v135, v135, v14
  v_sub_f32 v136, v136, v14
  v_sub_f32 v137, v137, v14
  v_sub_f32 v138, v138, v14
  v_sub_f32 v139, v139, v14
  v_sub_f32 v140, v140, v14
  v_sub_f32 v141, v141, v14
  v_sub_f32 v142, v142, v14
  v_sub_f32 v143, v143, v14
  v_mul_f32 v15, v64, v64
  v_fmac_f32 v15, v65, v65
  v_fmac_f32 v15, v66, v66
  v_fmac_f32 v15, v67, v67
  v_fmac_f32 v15, v68, v68
  v_fmac_f32 v15, v69, v69
  v_fmac_f32 v15, v70, v70
  v_fmac_f32 v15, v71, v71
  v_fmac_f32 v15, v72, v72
  v_fmac_f32 v15, v73, v73
  v_fmac_f32 v15, v74, v74
  v_fmac_f32 v15, v75, v75
  v_fmac_f32 v15, v76, v76
  v_fmac_f32 v15, v77, v77
  v_fmac_f32 v15, v78, v78
  v_fmac_f32 v15, v79, v79
  v_fmac_f32 v15, v80, v80
  v_fmac_f32 v15, v81, v81
  v_fmac_f32 v15, v82, v82
  v_fmac_f32 v15, v83, v83
  v_fmac_f32 v15, v84, v84
  v_fmac_f32 v15, v85, v85
  v_fmac_f32 v15, v86, v86
  v_fmac_f32 v15, v87, v87
  v_fmac_f32 v15, v88, v88
  v_fmac_f32 v15, v89, v89
  v_fmac_f32 v15, v90, v90
  v_fmac_f32 v15, v91, v91
  v_fmac_f32 v15, v92, v92
  v_fmac_f32 v15, v93, v93
  v_fmac_f32 v15, v94, v94
  v_fmac_f32 v15, v95, v95
  v_fmac_f32 v15, v96, v96
  v_fmac_f32 v15, v97, v97
  v_fmac_f32 v15, v98, v98
  v_fmac_f32 v15, v99, v99
  v_fmac_f32 v15, v100, v100
  v_fmac_f32 v15, v101, v101
  v_fmac_f32 v15, v102, v102
  v_fmac_f32 v15, v103, v103
  v_fmac_f32 v15, v104, v104
  v_fmac_f32 v15, v105, v105
  v_fmac_f32 v15, v106, v106
  v_fmac_f32 v15, v107, v107
  v_fmac_f32 v15, v108, v108
  v_fmac_f32 v15, v109, v109
  v_fmac_f32 v15, v110, v110
  v_fmac_f32 v15, v111, v111
  v_fmac_f32 v15, v112, v112
  v_fmac_f32 v15, v113, v113
  v_fmac_f32 v15, v114, v114
  v_fmac_f32 v15, v115, v115
  v_fmac_f32 v15, v116, v116
  v_fmac_f32 v15, v117, v117
  v_fmac_f32 v15, v118, v118
  v_fmac_f32 v15, v119, v119
  v_fmac_f32 v15, v120, v120
  v_fmac_f32 v15, v121, v121
  v_fmac_f32 v15, v122, v122
  v_fmac_f32 v15, v123, v123
  v_fmac_f32 v15, v124, v124
  v_fmac_f32 v15, v125, v125
  v_fmac_f32 v15, v126, v126
  v_fmac_f32 v15, v127, v127
  v_fmac_f32 v15, v128, v128
  v_fmac_f32 v15, v129, v129
  v_fmac_f32 v15, v130, v130
  v_fmac_f32 v15, v131, v131
  v_fmac_f32 v15, v132, v132
  v_fmac_f32 v15, v133, v133
  v_fmac_f32 v15, v134, v134
  v_fmac_f32 v15, v135, v135
  v_fmac_f32 v15, v136, v136
  v_fmac_f32 v15, v137, v137
  v_fmac_f32 v15, v138, v138
  v_fmac_f32 v15, v139, v139
  v_fmac_f32 v15, v140, v140
  v_fmac_f32 v15, v141, v141
  v_fmac_f32 v15, v142, v142
  v_fmac_f32 v15, v143, v143
  s_nop 1
  v_add_f32_dpp v14, v15, v15 quad_perm:[1,0,3,2] row_mask:0xf bank_mask:0xf
  s_nop 1
  v_add_f32_dpp v15, v14, v14 quad_perm:[2,3,0,1] row_mask:0xf bank_mask:0xf
  s_nop 1
  v_add_f32_dpp v14, v15, v15 row_half_mirror row_mask:0xf bank_mask:0xf
  v_mov_b32 v15, v14
  v_mov_b32 v14, 0x3727c5ac
  v_fmac_f32 v14, 0x3acccccd, v15
  v_rsq_f32 v14, v14
  s_nop 0
  v_mul_f32 v64, v64, v14
  v_mul_f32 v65, v65, v14
  v_cvt_pk_bf16_f32 v16, v64, v65
  v_mul_f32 v66, v66, v14
  v_mul_f32 v67, v67, v14
  v_cvt_pk_bf16_f32 v17, v66, v67
  v_mul_f32 v68, v68, v14
  v_mul_f32 v69, v69, v14
  v_cvt_pk_bf16_f32 v18, v68, v69
  v_mul_f32 v70, v70, v14
  v_mul_f32 v71, v71, v14
  v_cvt_pk_bf16_f32 v19, v70, v71
  v_mul_f32 v72, v72, v14
  v_mul_f32 v73, v73, v14
  v_cvt_pk_bf16_f32 v20, v72, v73
  v_mul_f32 v74, v74, v14
  v_mul_f32 v75, v75, v14
  v_cvt_pk_bf16_f32 v21, v74, v75
  v_mul_f32 v76, v76, v14
  v_mul_f32 v77, v77, v14
  v_cvt_pk_bf16_f32 v22, v76, v77
  v_mul_f32 v78, v78, v14
  v_mul_f32 v79, v79, v14
  v_cvt_pk_bf16_f32 v23, v78, v79
  v_mul_f32 v80, v80, v14
  v_mul_f32 v81, v81, v14
  v_cvt_pk_bf16_f32 v24, v80, v81
  v_mul_f32 v82, v82, v14
  v_mul_f32 v83, v83, v14
  v_cvt_pk_bf16_f32 v25, v82, v83
  v_mul_f32 v84, v84, v14
  v_mul_f32 v85, v85, v14
  v_cvt_pk_bf16_f32 v26, v84, v85
  v_mul_f32 v86, v86, v14
  v_mul_f32 v87, v87, v14
  v_cvt_pk_bf16_f32 v27, v86, v87
  v_mul_f32 v88, v88, v14
  v_mul_f32 v89, v89, v14
  v_cvt_pk_bf16_f32 v28, v88, v89
  v_mul_f32 v90, v90, v14
  v_mul_f32 v91, v91, v14
  v_cvt_pk_bf16_f32 v29, v90, v91
  v_mul_f32 v92, v92, v14
  v_mul_f32 v93, v93, v14
  v_cvt_pk_bf16_f32 v30, v92, v93
  v_mul_f32 v94, v94, v14
  v_mul_f32 v95, v95, v14
  v_cvt_pk_bf16_f32 v31, v94, v95
  v_mul_f32 v96, v96, v14
  v_mul_f32 v97, v97, v14
  v_cvt_pk_bf16_f32 v32, v96, v97
  v_mul_f32 v98, v98, v14
  v_mul_f32 v99, v99, v14
  v_cvt_pk_bf16_f32 v33, v98, v99
  v_mul_f32 v100, v100, v14
  v_mul_f32 v101, v101, v14
  v_cvt_pk_bf16_f32 v34, v100, v101
  v_mul_f32 v102, v102, v14
  v_mul_f32 v103, v103, v14
  v_cvt_pk_bf16_f32 v35, v102, v103
  v_mul_f32 v104, v104, v14
  v_mul_f32 v105, v105, v14
  v_cvt_pk_bf16_f32 v36, v104, v105
  v_mul_f32 v106, v106, v14
  v_mul_f32 v107, v107, v14
  v_cvt_pk_bf16_f32 v37, v106, v107
  v_mul_f32 v108, v108, v14
  v_mul_f32 v109, v109, v14
  v_cvt_pk_bf16_f32 v38, v108, v109
  v_mul_f32 v110, v110, v14
  v_mul_f32 v111, v111, v14
  v_cvt_pk_bf16_f32 v39, v110, v111
  v_mul_f32 v112, v112, v14
  v_mul_f32 v113, v113, v14
  v_cvt_pk_bf16_f32 v40, v112, v113
  v_mul_f32 v114, v114, v14
  v_mul_f32 v115, v115, v14
  v_cvt_pk_bf16_f32 v41, v114, v115
  v_mul_f32 v116, v116, v14
  v_mul_f32 v117, v117, v14
  v_cvt_pk_bf16_f32 v42, v116, v117
  v_mul_f32 v118, v118, v14
  v_mul_f32 v119, v119, v14
  v_cvt_pk_bf16_f32 v43, v118, v119
  v_mul_f32 v120, v120, v14
  v_mul_f32 v121, v121, v14
  v_cvt_pk_bf16_f32 v44, v120, v121
  v_mul_f32 v122, v122, v14
  v_mul_f32 v123, v123, v14
  v_cvt_pk_bf16_f32 v45, v122, v123
  v_mul_f32 v124, v124, v14
  v_mul_f32 v125, v125, v14
  v_cvt_pk_bf16_f32 v46, v124, v125
  v_mul_f32 v126, v126, v14
  v_mul_f32 v127, v127, v14
  v_cvt_pk_bf16_f32 v47, v126, v127
  v_mul_f32 v128, v128, v14
  v_mul_f32 v129, v129, v14
  v_cvt_pk_bf16_f32 v48, v128, v129
  v_mul_f32 v130, v130, v14
  v_mul_f32 v131, v131, v14
  v_cvt_pk_bf16_f32 v49, v130, v131
  v_mul_f32 v132, v132, v14
  v_mul_f32 v133, v133, v14
  v_cvt_pk_bf16_f32 v50, v132, v133
  v_mul_f32 v134, v134, v14
  v_mul_f32 v135, v135, v14
  v_cvt_pk_bf16_f32 v51, v134, v135
  v_mul_f32 v136, v136, v14
  v_mul_f32 v137, v137, v14
  v_cvt_pk_bf16_f32 v52, v136, v137
  v_mul_f32 v138, v138, v14
  v_mul_f32 v139, v139, v14
  v_cvt_pk_bf16_f32 v53, v138, v139
  v_mul_f32 v140, v140, v14
  v_mul_f32 v141, v141, v14
  v_cvt_pk_bf16_f32 v54, v140, v141
  v_mul_f32 v142, v142, v14
  v_mul_f32 v143, v143, v14
  v_cvt_pk_bf16_f32 v55, v142, v143
  s_mov_b32 s26, 0x100000
  buffer_store_dwordx4 v[16:19], v12, s[8:11], s26 offen
  s_add_u32 s26, s26, 4096
  buffer_store_dwordx4 v[20:23], v12, s[8:11], s26 offen
  s_add_u32 s26, s26, 4096
  buffer_store_dwordx4 v[24:27], v12, s[8:11], s26 offen
  s_add_u32 s26, s26, 4096
  buffer_store_dwordx4 v[28:31], v12, s[8:11], s26 offen
  s_add_u32 s26, s26, 4096
  buffer_store_dwordx4 v[32:35], v12, s[8:11], s26 offen
  s_add_u32 s26, s26, 4096
  buffer_store_dwordx4 v[36:39], v12, s[8:11], s26 offen
  s_add_u32 s26, s26, 4096
  buffer_store_dwordx4 v[40:43], v12, s[8:11], s26 offen
  s_add_u32 s26, s26, 4096
  buffer_store_dwordx4 v[44:47], v12, s[8:11], s26 offen
  s_add_u32 s26, s26, 4096
  buffer_store_dwordx4 v[48:51], v12, s[8:11], s26 offen
  s_add_u32 s26, s26, 4096
  buffer_store_dwordx4 v[52:55], v12, s[8:11], s26 offen
  s_add_u32 s26, s26, 4096
ln_3:
  s_mov_b32 s12, s46
  s_and_b32 s13, s47, 0xffff
  s_mov_b32 s14, 0xc8000
  s_mov_b32 s15, 0x20000
  s_mov_b32 s16, s44
  s_and_b32 s17, s45, 0xffff
  s_mov_b32 s18, 0x258000
  s_mov_b32 s19, 0x20000
  s_lshl_b32 s26, s2, 2
  s_add_u32 s26, s26, s21
  v_and_b32 v8, 31, v1
  v_lshrrev_b32 v9, 5, v1
  v_lshrrev_b32 v10, 4, v8
  v_lshlrev_b32 v10, 4, v10
  v_bfe_u32 v11, v8, 2, 1
  v_lshlrev_b32 v11, 3, v11
  v_add_u32 v10, v10, v11
  v_bfe_u32 v11, v8, 3, 1
  v_lshlrev_b32 v11, 2, v11
  v_add_u32 v10, v10, v11
  v_and_b32 v11, 3, v8
  v_add_u32 v10, v10, v11
  v_mov_b32 v15, 0x40000000
  s_add_u32 s27, s26, 0
  s_cmp_lt_u32 s27, 800
  s_cbranch_scc0 gq_5
  s_mul_i32 s28, s27, 3277
  s_lshr_b32 s28, s28, 16
  s_mul_i32 s29, s28, 20
  s_sub_u32 s29, s27, s29
  s_lshl_b32 s30, s28, 5
  s_mul_i32 s31, s29, 40960
  s_add_u32 s30, s30, s31
  v_lshrrev_b32 v12, 4, v1
  v_mul_u32_u24 v12, 10240, v12
  v_and_b32 v13, 15, v1
  v_lshlrev_b32 v13, 1, v13
  v_add_u32 v12, v12, v13
  s_add_u32 s31, s30, 0
  buffer_load_ushort v20, v12, s[12:15], s31 offen
  s_add_u32 s31, s30, 1280
  buffer_load_ushort v21, v12, s[12:15], s31 offen
  s_add_u32 s31, s30, 2560
  buffer_load_ushort v22, v12, s[12:15], s31 offen
  s_add_u32 s31, s30, 3840
  buffer_load_ushort v23, v12, s[12:15], s31 offen
  s_add_u32 s31, s30, 5120
  buffer_load_ushort v24, v12, s[12:15], s31 offen
  s_add_u32 s31, s30, 6400
  buffer_load_ushort v25, v12, s[12:15], s31 offen
  s_add_u32 s31, s30, 7680
  buffer_load_ushort v26, v12, s[12:15], s31 offen
  s_add_u32 s31, s30, 8960
  buffer_load_ushort v27, v12, s[12:15], s31 offen
  s_lshl_b32 s28, s27, 10
  s_add_u32 s28, s28, 0xe000000
  s_branch gd_6
gq_5:
  s_sub_u32 s27, s27, 800
  s_cmp_lt_u32 s27, 3840
  s_cbranch_scc0 g_4
  s_mul_i32 s28, s27, 6554
  s_lshr_b32 s28, s28, 18
  s_mul_i32 s29, s28, 40
  s_sub_u32 s29, s27, s29
  s_mul_i32 s30, s28, 21846
  s_lshr_b32 s30, s30, 16
  s_mul_i32 s31, s30, 3
  s_sub_u32 s31, s28, s31
  s_cmp_lt_u32 s31, 2
  s_cselect_b64 vcc, -1, 0
  v_cndmask_b32 v12, v8, v10, vcc
  v_cmp_gt_u32 vcc, 20, v12
  v_lshlrev_b32 v12, 1, v12
  v_mul_u32_u24 v13, 30720, v9
  v_add_u32 v12, v12, v13
  v_cndmask_b32 v12, v15, v12, vcc
  s_mul_i32 s31, s31, 1280
  s_mul_i32 s30, s30, 40
  s_add_u32 s30, s30, s31
  s_mul_i32 s31, s29, 61440
  s_add_u32 s30, s30, s31
  s_add_u32 s31, s30, 0
  buffer_load_ushort v20, v12, s[16:19], s31 offen
  s_add_u32 s31, s30, 3840
  buffer_load_ushort v21, v12, s[16:19], s31 offen
  s_add_u32 s31, s30, 7680
  buffer_load_ushort v22, v12, s[16:19], s31 offen
  s_add_u32 s31, s30, 11520
  buffer_load_ushort v23, v12, s[16:19], s31 offen
  s_add_u32 s31, s30, 15360
  buffer_load_ushort v24, v12, s[16:19], s31 offen
  s_add_u32 s31, s30, 19200
  buffer_load_ushort v25, v12, s[16:19], s31 offen
  s_add_u32 s31, s30, 23040
  buffer_load_ushort v26, v12, s[16:19], s31 offen
  s_add_u32 s31, s30, 26880
  buffer_load_ushort v27, v12, s[16:19], s31 offen
  s_lshl_b32 s28, s27, 10
  s_add_u32 s28, s28, 0xe100000
gd_6:
  s_waitcnt vmcnt(0)
  v_lshl_or_b32 v28, v21, 16, v20
  v_lshl_or_b32 v29, v23, 16, v22
  v_lshl_or_b32 v30, v25, 16, v24
  v_lshl_or_b32 v31, v27, 16, v26
  buffer_store_dwordx4 v[28:31], v2, s[8:11], s28 offen
  s_nop 1
g_4:
  s_add_u32 s27, s26, 1024
  s_cmp_lt_u32 s27, 800
  s_cbranch_scc0 gq_8
  s_mul_i32 s28, s27, 3277
  s_lshr_b32 s28, s28, 16
  s_mul_i32 s29, s28, 20
  s_sub_u32 s29, s27, s29
  s_lshl_b32 s30, s28, 5
  s_mul_i32 s31, s29, 40960
  s_add_u32 s30, s30, s31
  v_lshrrev_b32 v12, 4, v1
  v_mul_u32_u24 v12, 10240, v12
  v_and_b32 v13, 15, v1
  v_lshlrev_b32 v13, 1, v13
  v_add_u32 v12, v12, v13
  s_add_u32 s31, s30, 0
  buffer_load_ushort v20, v12, s[12:15], s31 offen
  s_add_u32 s31, s30, 1280
  buffer_load_ushort v21, v12, s[12:15], s31 offen
  s_add_u32 s31, s30, 2560
  buffer_load_ushort v22, v12, s[12:15], s31 offen
  s_add_u32 s31, s30, 3840
  buffer_load_ushort v23, v12, s[12:15], s31 offen
  s_add_u32 s31, s30, 5120
  buffer_load_ushort v24, v12, s[12:15], s31 offen
  s_add_u32 s31, s30, 6400
  buffer_load_ushort v25, v12, s[12:15], s31 offen
  s_add_u32 s31, s30, 7680
  buffer_load_ushort v26, v12, s[12:15], s31 offen
  s_add_u32 s31, s30, 8960
  buffer_load_ushort v27, v12, s[12:15], s31 offen
  s_lshl_b32 s28, s27, 10
  s_add_u32 s28, s28, 0xe000000
  s_branch gd_9
gq_8:
  s_sub_u32 s27, s27, 800
  s_cmp_lt_u32 s27, 3840
  s_cbranch_scc0 g_7
  s_mul_i32 s28, s27, 6554
  s_lshr_b32 s28, s28, 18
  s_mul_i32 s29, s28, 40
  s_sub_u32 s29, s27, s29
  s_mul_i32 s30, s28, 21846
  s_lshr_b32 s30, s30, 16
  s_mul_i32 s31, s30, 3
  s_sub_u32 s31, s28, s31
  s_cmp_lt_u32 s31, 2
  s_cselect_b64 vcc, -1, 0
  v_cndmask_b32 v12, v8, v10, vcc
  v_cmp_gt_u32 vcc, 20, v12
  v_lshlrev_b32 v12, 1, v12
  v_mul_u32_u24 v13, 30720, v9
  v_add_u32 v12, v12, v13
  v_cndmask_b32 v12, v15, v12, vcc
  s_mul_i32 s31, s31, 1280
  s_mul_i32 s30, s30, 40
  s_add_u32 s30, s30, s31
  s_mul_i32 s31, s29, 61440
  s_add_u32 s30, s30, s31
  s_add_u32 s31, s30, 0
  buffer_load_ushort v20, v12, s[16:19], s31 offen
  s_add_u32 s31, s30, 3840
  buffer_load_ushort v21, v12, s[16:19], s31 offen
  s_add_u32 s31, s30, 7680
  buffer_load_ushort v22, v12, s[16:19], s31 offen
  s_add_u32 s31, s30, 11520
  buffer_load_ushort v23, v12, s[16:19], s31 offen
  s_add_u32 s31, s30, 15360
  buffer_load_ushort v24, v12, s[16:19], s31 offen
  s_add_u32 s31, s30, 19200
  buffer_load_ushort v25, v12, s[16:19], s31 offen
  s_add_u32 s31, s30, 23040
  buffer_load_ushort v26, v12, s[16:19], s31 offen
  s_add_u32 s31, s30, 26880
  buffer_load_ushort v27, v12, s[16:19], s31 offen
  s_lshl_b32 s28, s27, 10
  s_add_u32 s28, s28, 0xe100000
gd_9:
  s_waitcnt vmcnt(0)
  v_lshl_or_b32 v28, v21, 16, v20
  v_lshl_or_b32 v29, v23, 16, v22
  v_lshl_or_b32 v30, v25, 16, v24
  v_lshl_or_b32 v31, v27, 16, v26
  buffer_store_dwordx4 v[28:31], v2, s[8:11], s28 offen
  s_nop 1
g_7:
  s_add_u32 s27, s26, 2048
  s_cmp_lt_u32 s27, 800
  s_cbranch_scc0 gq_11
  s_mul_i32 s28, s27, 3277
  s_lshr_b32 s28, s28, 16
  s_mul_i32 s29, s28, 20
  s_sub_u32 s29, s27, s29
  s_lshl_b32 s30, s28, 5
  s_mul_i32 s31, s29, 40960
  s_add_u32 s30, s30, s31
  v_lshrrev_b32 v12, 4, v1
  v_mul_u32_u24 v12, 10240, v12
  v_and_b32 v13, 15, v1
  v_lshlrev_b32 v13, 1, v13
  v_add_u32 v12, v12, v13
  s_add_u32 s31, s30, 0
  buffer_load_ushort v20, v12, s[12:15], s31 offen
  s_add_u32 s31, s30, 1280
  buffer_load_ushort v21, v12, s[12:15], s31 offen
  s_add_u32 s31, s30, 2560
  buffer_load_ushort v22, v12, s[12:15], s31 offen
  s_add_u32 s31, s30, 3840
  buffer_load_ushort v23, v12, s[12:15], s31 offen
  s_add_u32 s31, s30, 5120
  buffer_load_ushort v24, v12, s[12:15], s31 offen
  s_add_u32 s31, s30, 6400
  buffer_load_ushort v25, v12, s[12:15], s31 offen
  s_add_u32 s31, s30, 7680
  buffer_load_ushort v26, v12, s[12:15], s31 offen
  s_add_u32 s31, s30, 8960
  buffer_load_ushort v27, v12, s[12:15], s31 offen
  s_lshl_b32 s28, s27, 10
  s_add_u32 s28, s28, 0xe000000
  s_branch gd_12
gq_11:
  s_sub_u32 s27, s27, 800
  s_cmp_lt_u32 s27, 3840
  s_cbranch_scc0 g_10
  s_mul_i32 s28, s27, 6554
  s_lshr_b32 s28, s28, 18
  s_mul_i32 s29, s28, 40
  s_sub_u32 s29, s27, s29
  s_mul_i32 s30, s28, 21846
  s_lshr_b32 s30, s30, 16
  s_mul_i32 s31, s30, 3
  s_sub_u32 s31, s28, s31
  s_cmp_lt_u32 s31, 2
  s_cselect_b64 vcc, -1, 0
  v_cndmask_b32 v12, v8, v10, vcc
  v_cmp_gt_u32 vcc, 20, v12
  v_lshlrev_b32 v12, 1, v12
  v_mul_u32_u24 v13, 30720, v9
  v_add_u32 v12, v12, v13
  v_cndmask_b32 v12, v15, v12, vcc
  s_mul_i32 s31, s31, 1280
  s_mul_i32 s30, s30, 40
  s_add_u32 s30, s30, s31
  s_mul_i32 s31, s29, 61440
  s_add_u32 s30, s30, s31
  s_add_u32 s31, s30, 0
  buffer_load_ushort v20, v12, s[16:19], s31 offen
  s_add_u32 s31, s30, 3840
  buffer_load_ushort v21, v12, s[16:19], s31 offen
  s_add_u32 s31, s30, 7680
  buffer_load_ushort v22, v12, s[16:19], s31 offen
  s_add_u32 s31, s30, 11520
  buffer_load_ushort v23, v12, s[16:19], s31 offen
  s_add_u32 s31, s30, 15360
  buffer_load_ushort v24, v12, s[16:19], s31 offen
  s_add_u32 s31, s30, 19200
  buffer_load_ushort v25, v12, s[16:19], s31 offen
  s_add_u32 s31, s30, 23040
  buffer_load_ushort v26, v12, s[16:19], s31 offen
  s_add_u32 s31, s30, 26880
  buffer_load_ushort v27, v12, s[16:19], s31 offen
  s_lshl_b32 s28, s27, 10
  s_add_u32 s28, s28, 0xe100000
gd_12:
  s_waitcnt vmcnt(0)
  v_lshl_or_b32 v28, v21, 16, v20
  v_lshl_or_b32 v29, v23, 16, v22
  v_lshl_or_b32 v30, v25, 16, v24
  v_lshl_or_b32 v31, v27, 16, v26
  buffer_store_dwordx4 v[28:31], v2, s[8:11], s28 offen
  s_nop 1
g_10:
  s_add_u32 s27, s26, 3072
  s_cmp_lt_u32 s27, 800
  s_cbranch_scc0 gq_14
  s_mul_i32 s28, s27, 3277
  s_lshr_b32 s28, s28, 16
  s_mul_i32 s29, s28, 20
  s_sub_u32 s29, s27, s29
  s_lshl_b32 s30, s28, 5
  s_mul_i32 s31, s29, 40960
  s_add_u32 s30, s30, s31
  v_lshrrev_b32 v12, 4, v1
  v_mul_u32_u24 v12, 10240, v12
  v_and_b32 v13, 15, v1
  v_lshlrev_b32 v13, 1, v13
  v_add_u32 v12, v12, v13
  s_add_u32 s31, s30, 0
  buffer_load_ushort v20, v12, s[12:15], s31 offen
  s_add_u32 s31, s30, 1280
  buffer_load_ushort v21, v12, s[12:15], s31 offen
  s_add_u32 s31, s30, 2560
  buffer_load_ushort v22, v12, s[12:15], s31 offen
  s_add_u32 s31, s30, 3840
  buffer_load_ushort v23, v12, s[12:15], s31 offen
  s_add_u32 s31, s30, 5120
  buffer_load_ushort v24, v12, s[12:15], s31 offen
  s_add_u32 s31, s30, 6400
  buffer_load_ushort v25, v12, s[12:15], s31 offen
  s_add_u32 s31, s30, 7680
  buffer_load_ushort v26, v12, s[12:15], s31 offen
  s_add_u32 s31, s30, 8960
  buffer_load_ushort v27, v12, s[12:15], s31 offen
  s_lshl_b32 s28, s27, 10
  s_add_u32 s28, s28, 0xe000000
  s_branch gd_15
gq_14:
  s_sub_u32 s27, s27, 800
  s_cmp_lt_u32 s27, 3840
  s_cbranch_scc0 g_13
  s_mul_i32 s28, s27, 6554
  s_lshr_b32 s28, s28, 18
  s_mul_i32 s29, s28, 40
  s_sub_u32 s29, s27, s29
  s_mul_i32 s30, s28, 21846
  s_lshr_b32 s30, s30, 16
  s_mul_i32 s31, s30, 3
  s_sub_u32 s31, s28, s31
  s_cmp_lt_u32 s31, 2
  s_cselect_b64 vcc, -1, 0
  v_cndmask_b32 v12, v8, v10, vcc
  v_cmp_gt_u32 vcc, 20, v12
  v_lshlrev_b32 v12, 1, v12
  v_mul_u32_u24 v13, 30720, v9
  v_add_u32 v12, v12, v13
  v_cndmask_b32 v12, v15, v12, vcc
  s_mul_i32 s31, s31, 1280
  s_mul_i32 s30, s30, 40
  s_add_u32 s30, s30, s31
  s_mul_i32 s31, s29, 61440
  s_add_u32 s30, s30, s31
  s_add_u32 s31, s30, 0
  buffer_load_ushort v20, v12, s[16:19], s31 offen
  s_add_u32 s31, s30, 3840
  buffer_load_ushort v21, v12, s[16:19], s31 offen
  s_add_u32 s31, s30, 7680
  buffer_load_ushort v22, v12, s[16:19], s31 offen
  s_add_u32 s31, s30, 11520
  buffer_load_ushort v23, v12, s[16:19], s31 offen
  s_add_u32 s31, s30, 15360
  buffer_load_ushort v24, v12, s[16:19], s31 offen
  s_add_u32 s31, s30, 19200
  buffer_load_ushort v25, v12, s[16:19], s31 offen
  s_add_u32 s31, s30, 23040
  buffer_load_ushort v26, v12, s[16:19], s31 offen
  s_add_u32 s31, s30, 26880
  buffer_load_ushort v27, v12, s[16:19], s31 offen
  s_lshl_b32 s28, s27, 10
  s_add_u32 s28, s28, 0xe100000
gd_15:
  s_waitcnt vmcnt(0)
  v_lshl_or_b32 v28, v21, 16, v20
  v_lshl_or_b32 v29, v23, 16, v22
  v_lshl_or_b32 v30, v25, 16, v24
  v_lshl_or_b32 v31, v27, 16, v26
  buffer_store_dwordx4 v[28:31], v2, s[8:11], s28 offen
  s_nop 1
g_13:
  s_add_u32 s27, s26, 4096
  s_cmp_lt_u32 s27, 800
  s_cbranch_scc0 gq_17
  s_mul_i32 s28, s27, 3277
  s_lshr_b32 s28, s28, 16
  s_mul_i32 s29, s28, 20
  s_sub_u32 s29, s27, s29
  s_lshl_b32 s30, s28, 5
  s_mul_i32 s31, s29, 40960
  s_add_u32 s30, s30, s31
  v_lshrrev_b32 v12, 4, v1
  v_mul_u32_u24 v12, 10240, v12
  v_and_b32 v13, 15, v1
  v_lshlrev_b32 v13, 1, v13
  v_add_u32 v12, v12, v13
  s_add_u32 s31, s30, 0
  buffer_load_ushort v20, v12, s[12:15], s31 offen
  s_add_u32 s31, s30, 1280
  buffer_load_ushort v21, v12, s[12:15], s31 offen
  s_add_u32 s31, s30, 2560
  buffer_load_ushort v22, v12, s[12:15], s31 offen
  s_add_u32 s31, s30, 3840
  buffer_load_ushort v23, v12, s[12:15], s31 offen
  s_add_u32 s31, s30, 5120
  buffer_load_ushort v24, v12, s[12:15], s31 offen
  s_add_u32 s31, s30, 6400
  buffer_load_ushort v25, v12, s[12:15], s31 offen
  s_add_u32 s31, s30, 7680
  buffer_load_ushort v26, v12, s[12:15], s31 offen
  s_add_u32 s31, s30, 8960
  buffer_load_ushort v27, v12, s[12:15], s31 offen
  s_lshl_b32 s28, s27, 10
  s_add_u32 s28, s28, 0xe000000
  s_branch gd_18
gq_17:
  s_sub_u32 s27, s27, 800
  s_cmp_lt_u32 s27, 3840
  s_cbranch_scc0 g_16
  s_mul_i32 s28, s27, 6554
  s_lshr_b32 s28, s28, 18
  s_mul_i32 s29, s28, 40
  s_sub_u32 s29, s27, s29
  s_mul_i32 s30, s28, 21846
  s_lshr_b32 s30, s30, 16
  s_mul_i32 s31, s30, 3
  s_sub_u32 s31, s28, s31
  s_cmp_lt_u32 s31, 2
  s_cselect_b64 vcc, -1, 0
  v_cndmask_b32 v12, v8, v10, vcc
  v_cmp_gt_u32 vcc, 20, v12
  v_lshlrev_b32 v12, 1, v12
  v_mul_u32_u24 v13, 30720, v9
  v_add_u32 v12, v12, v13
  v_cndmask_b32 v12, v15, v12, vcc
  s_mul_i32 s31, s31, 1280
  s_mul_i32 s30, s30, 40
  s_add_u32 s30, s30, s31
  s_mul_i32 s31, s29, 61440
  s_add_u32 s30, s30, s31
  s_add_u32 s31, s30, 0
  buffer_load_ushort v20, v12, s[16:19], s31 offen
  s_add_u32 s31, s30, 3840
  buffer_load_ushort v21, v12, s[16:19], s31 offen
  s_add_u32 s31, s30, 7680
  buffer_load_ushort v22, v12, s[16:19], s31 offen
  s_add_u32 s31, s30, 11520
  buffer_load_ushort v23, v12, s[16:19], s31 offen
  s_add_u32 s31, s30, 15360
  buffer_load_ushort v24, v12, s[16:19], s31 offen
  s_add_u32 s31, s30, 19200
  buffer_load_ushort v25, v12, s[16:19], s31 offen
  s_add_u32 s31, s30, 23040
  buffer_load_ushort v26, v12, s[16:19], s31 offen
  s_add_u32 s31, s30, 26880
  buffer_load_ushort v27, v12, s[16:19], s31 offen
  s_lshl_b32 s28, s27, 10
  s_add_u32 s28, s28, 0xe100000
gd_18:
  s_waitcnt vmcnt(0)
  v_lshl_or_b32 v28, v21, 16, v20
  v_lshl_or_b32 v29, v23, 16, v22
  v_lshl_or_b32 v30, v25, 16, v24
  v_lshl_or_b32 v31, v27, 16, v26
  buffer_store_dwordx4 v[28:31], v2, s[8:11], s28 offen
  s_nop 1
g_16:
  s_mov_b32 s12, s40
  s_and_b32 s13, s41, 0xffff
  s_mov_b32 s14, 0x780000
  s_mov_b32 s15, 0x20000
  s_mov_b32 s16, s42
  s_and_b32 s17, s43, 0xffff
  s_mov_b32 s18, 0x780000
  s_mov_b32 s19, 0x20000
  s_and_b32 s22, s2, 7
  s_lshl_b32 s22, s22, 2
  s_lshr_b32 s23, s2, 6
  s_add_u32 s22, s22, s23
  s_bfe_u32 s23, s2, 0x30003
  s_waitcnt vmcnt(0)
  v_lshrrev_b32 v8, 3, v1
  v_bfe_u32 v9, v1, 1, 2
  v_and_b32 v10, 1, v1
  s_mul_i32 s24, s22, 245760
  s_mul_i32 s25, s23, 160
  s_add_u32 s24, s24, s25
  s_add_u32 s26, s21, 0
  s_cmp_lt_u32 s26, 30
  s_cbranch_scc0 wd_19
  s_lshl_b32 s27, s26, 3
  v_add_u32 v11, s27, v8
  v_mul_u32_u24 v12, 52429, v11
  v_lshrrev_b32 v12, 18, v12
  v_mul_u32_u24 v13, 5, v12
  v_sub_u32 v13, v11, v13
  v_lshlrev_b32 v12, 2, v12
  v_add_u32 v12, v12, v9
  v_mul_u32_u24 v12, 1280, v12
  v_lshlrev_b32 v13, 5, v13
  v_add_u32 v12, v12, v13
  v_lshlrev_b32 v13, 4, v10
  v_add_u32 v12, v12, v13
  s_lshl_b32 m0, s26, 10
  s_nop 0
  buffer_load_dwordx4 v12, s[16:19], s24 offen lds
wd_19:
  s_add_u32 s26, s21, 4
  s_cmp_lt_u32 s26, 30
  s_cbranch_scc0 wd_20
  s_lshl_b32 s27, s26, 3
  v_add_u32 v11, s27, v8
  v_mul_u32_u24 v12, 52429, v11
  v_lshrrev_b32 v12, 18, v12
  v_mul_u32_u24 v13, 5, v12
  v_sub_u32 v13, v11, v13
  v_lshlrev_b32 v12, 2, v12
  v_add_u32 v12, v12, v9
  v_mul_u32_u24 v12, 1280, v12
  v_lshlrev_b32 v13, 5, v13
  v_add_u32 v12, v12, v13
  v_lshlrev_b32 v13, 4, v10
  v_add_u32 v12, v12, v13
  s_lshl_b32 m0, s26, 10
  s_nop 0
  buffer_load_dwordx4 v12, s[16:19], s24 offen lds
wd_20:
  s_add_u32 s26, s21, 8
  s_cmp_lt_u32 s26, 30
  s_cbranch_scc0 wd_21
  s_lshl_b32 s27, s26, 3
  v_add_u32 v11, s27, v8
  v_mul_u32_u24 v12, 52429, v11
  v_lshrrev_b32 v12, 18, v12
  v_mul_u32_u24 v13, 5, v12
  v_sub_u32 v13, v11, v13
  v_lshlrev_b32 v12, 2, v12
  v_add_u32 v12, v12, v9
  v_mul_u32_u24 v12, 1280, v12
  v_lshlrev_b32 v13, 5, v13
  v_add_u32 v12, v12, v13
  v_lshlrev_b32 v13, 4, v10
  v_add_u32 v12, v12, v13
  s_lshl_b32 m0, s26, 10
  s_nop 0
  buffer_load_dwordx4 v12, s[16:19], s24 offen lds
wd_21:
  s_add_u32 s26, s21, 12
  s_cmp_lt_u32 s26, 30
  s_cbranch_scc0 wd_22
  s_lshl_b32 s27, s26, 3
  v_add_u32 v11, s27, v8
  v_mul_u32_u24 v12, 52429, v11
  v_lshrrev_b32 v12, 18, v12
  v_mul_u32_u24 v13, 5, v12
  v_sub_u32 v13, v11, v13
  v_lshlrev_b32 v12, 2, v12
  v_add_u32 v12, v12, v9
  v_mul_u32_u24 v12, 1280, v12
  v_lshlrev_b32 v13, 5, v13
  v_add_u32 v12, v12, v13
  v_lshlrev_b32 v13, 4, v10
  v_add_u32 v12, v12, v13
  s_lshl_b32 m0, s26, 10
  s_nop 0
  buffer_load_dwordx4 v12, s[16:19], s24 offen lds
wd_22:
  s_add_u32 s26, s21, 16
  s_cmp_lt_u32 s26, 30
  s_cbranch_scc0 wd_23
  s_lshl_b32 s27, s26, 3
  v_add_u32 v11, s27, v8
  v_mul_u32_u24 v12, 52429, v11
  v_lshrrev_b32 v12, 18, v12
  v_mul_u32_u24 v13, 5, v12
  v_sub_u32 v13, v11, v13
  v_lshlrev_b32 v12, 2, v12
  v_add_u32 v12, v12, v9
  v_mul_u32_u24 v12, 1280, v12
  v_lshlrev_b32 v13, 5, v13
  v_add_u32 v12, v12, v13
  v_lshlrev_b32 v13, 4, v10
  v_add_u32 v12, v12, v13
  s_lshl_b32 m0, s26, 10
  s_nop 0
  buffer_load_dwordx4 v12, s[16:19], s24 offen lds
wd_23:
  s_add_u32 s26, s21, 20
  s_cmp_lt_u32 s26, 30
  s_cbranch_scc0 wd_24
  s_lshl_b32 s27, s26, 3
  v_add_u32 v11, s27, v8
  v_mul_u32_u24 v12, 52429, v11
  v_lshrrev_b32 v12, 18, v12
  v_mul_u32_u24 v13, 5, v12
  v_sub_u32 v13, v11, v13
  v_lshlrev_b32 v12, 2, v12
  v_add_u32 v12, v12, v9
  v_mul_u32_u24 v12, 1280, v12
  v_lshlrev_b32 v13, 5, v13
  v_add_u32 v12, v12, v13
  v_lshlrev_b32 v13, 4, v10
  v_add_u32 v12, v12, v13
  s_lshl_b32 m0, s26, 10
  s_nop 0
  buffer_load_dwordx4 v12, s[16:19], s24 offen lds
wd_24:
  s_add_u32 s26, s21, 24
  s_cmp_lt_u32 s26, 30
  s_cbranch_scc0 wd_25
  s_lshl_b32 s27, s26, 3
  v_add_u32 v11, s27, v8
  v_mul_u32_u24 v12, 52429, v11
  v_lshrrev_b32 v12, 18, v12
  v_mul_u32_u24 v13, 5, v12
  v_sub_u32 v13, v11, v13
  v_lshlrev_b32 v12, 2, v12
  v_add_u32 v12, v12, v9
  v_mul_u32_u24 v12, 1280, v12
  v_lshlrev_b32 v13, 5, v13
  v_add_u32 v12, v12, v13
  v_lshlrev_b32 v13, 4, v10
  v_add_u32 v12, v12, v13
  s_lshl_b32 m0, s26, 10
  s_nop 0
  buffer_load_dwordx4 v12, s[16:19], s24 offen lds
wd_25:
  s_add_u32 s26, s21, 28
  s_cmp_lt_u32 s26, 30
  s_cbranch_scc0 wd_26
  s_lshl_b32 s27, s26, 3
  v_add_u32 v11, s27, v8
  v_mul_u32_u24 v12, 52429, v11
  v_lshrrev_b32 v12, 18, v12
  v_mul_u32_u24 v13, 5, v12
  v_sub_u32 v13, v11, v13
  v_lshlrev_b32 v12, 2, v12
  v_add_u32 v12, v12, v9
  v_mul_u32_u24 v12, 1280, v12
  v_lshlrev_b32 v13, 5, v13
  v_add_u32 v12, v12, v13
  v_lshlrev_b32 v13, 4, v10
  v_add_u32 v12, v12, v13
  s_lshl_b32 m0, s26, 10
  s_nop 0
  buffer_load_dwordx4 v12, s[16:19], s24 offen lds
wd_26:
  v_lshrrev_b32 v8, 4, v1
  v_mul_u32_u24 v8, 1280, v8
  v_bfe_u32 v9, v1, 2, 2
  v_lshlrev_b32 v9, 5, v9
  v_add_u32 v8, v8, v9
  v_bfe_u32 v9, v1, 1, 1
  v_lshlrev_b32 v9, 4, v9
  v_add_u32 v8, v8, v9
  v_and_b32 v9, 1, v1
  v_lshlrev_b32 v9, 3, v9
  v_add_u32 v8, v8, v9
  s_waitcnt vmcnt(0)
  s_barrier
  ds_read_b64_tr_b16 a[0:1], v8 offset:0
  ds_read_b64_tr_b16 a[2:3], v8 offset:640
  ds_read_b64_tr_b16 a[4:5], v8 offset:128
  ds_read_b64_tr_b16 a[6:7], v8 offset:768
  ds_read_b64_tr_b16 a[8:9], v8 offset:256
  ds_read_b64_tr_b16 a[10:11], v8 offset:896
  ds_read_b64_tr_b16 a[12:13], v8 offset:384
  ds_read_b64_tr_b16 a[14:15], v8 offset:1024
  ds_read_b64_tr_b16 a[16:17], v8 offset:512
  ds_read_b64_tr_b16 a[18:19], v8 offset:1152
  ds_read_b64_tr_b16 a[20:21], v8 offset:5120
  ds_read_b64_tr_b16 a[22:23], v8 offset:5760
  s_waitcnt lgkmcnt(0)
  ds_read_b64_tr_b16 a[24:25], v8 offset:5248
  ds_read_b64_tr_b16 a[26:27], v8 offset:5888
  ds_read_b64_tr_b16 a[28:29], v8 offset:5376
  ds_read_b64_tr_b16 a[30:31], v8 offset:6016
  ds_read_b64_tr_b16 a[32:33], v8 offset:5504
  ds_read_b64_tr_b16 a[34:35], v8 offset:6144
  ds_read_b64_tr_b16 a[36:37], v8 offset:5632
  ds_read_b64_tr_b16 a[38:39], v8 offset:6272
  ds_read_b64_tr_b16 a[40:41], v8 offset:10240
  ds_read_b64_tr_b16 a[42:43], v8 offset:10880
  ds_read_b64_tr_b16 a[44:45], v8 offset:10368
  ds_read_b64_tr_b16 a[46:47], v8 offset:11008
  s_waitcnt lgkmcnt(0)
  ds_read_b64_tr_b16 a[48:49], v8 offset:10496
  ds_read_b64_tr_b16 a[50:51], v8 offset:11136
  ds_read_b64_tr_b16 a[52:53], v8 offset:10624
  ds_read_b64_tr_b16 a[54:55], v8 offset:11264
  ds_read_b64_tr_b16 a[56:57], v8 offset:10752
  ds_read_b64_tr_b16 a[58:59], v8 offset:11392
  ds_read_b64_tr_b16 a[60:61], v8 offset:15360
  ds_read_b64_tr_b16 a[62:63], v8 offset:16000
  ds_read_b64_tr_b16 a[64:65], v8 offset:15488
  ds_read_b64_tr_b16 a[66:67], v8 offset:16128
  ds_read_b64_tr_b16 a[68:69], v8 offset:15616
  ds_read_b64_tr_b16 a[70:71], v8 offset:16256
  s_waitcnt lgkmcnt(0)
  ds_read_b64_tr_b16 a[72:73], v8 offset:15744
  ds_read_b64_tr_b16 a[74:75], v8 offset:16384
  ds_read_b64_tr_b16 a[76:77], v8 offset:15872
  ds_read_b64_tr_b16 a[78:79], v8 offset:16512
  ds_read_b64_tr_b16 a[80:81], v8 offset:20480
  ds_read_b64_tr_b16 a[82:83], v8 offset:21120
  ds_read_b64_tr_b16 a[84:85], v8 offset:20608
  ds_read_b64_tr_b16 a[86:87], v8 offset:21248
  ds_read_b64_tr_b16 a[88:89], v8 offset:20736
  ds_read_b64_tr_b16 a[90:91], v8 offset:21376
  ds_read_b64_tr_b16 a[92:93], v8 offset:20864
  ds_read_b64_tr_b16 a[94:95], v8 offset:21504
  s_waitcnt lgkmcnt(0)
  ds_read_b64_tr_b16 a[96:97], v8 offset:20992
  ds_read_b64_tr_b16 a[98:99], v8 offset:21632
  ds_read_b64_tr_b16 a[100:101], v8 offset:25600
  ds_read_b64_tr_b16 a[102:103], v8 offset:26240
  ds_read_b64_tr_b16 a[104:105], v8 offset:25728
  ds_read_b64_tr_b16 a[106:107], v8 offset:26368
  ds_read_b64_tr_b16 a[108:109], v8 offset:25856
  ds_read_b64_tr_b16 a[110:111], v8 offset:26496
  ds_read_b64_tr_b16 a[112:113], v8 offset:25984
  ds_read_b64_tr_b16 a[114:115], v8 offset:26624
  ds_read_b64_tr_b16 a[116:117], v8 offset:26112
  ds_read_b64_tr_b16 a[118:119], v8 offset:26752
  s_waitcnt lgkmcnt(0)
  s_waitcnt lgkmcnt(0)
  v_and_b32 v8, 15, v1
  v_lshrrev_b32 v9, 2, v8
  v_lshlrev_b32 v9, 3, v9
  v_and_b32 v10, 3, v8
  v_add_u32 v9, v9, v10
  v_mul_u32_u24 v9, 12288, v9
  v_lshrrev_b32 v10, 4, v1
  v_lshlrev_b32 v10, 4, v10
  v_add_u32 v9, v9, v10
  v_add_u32 v10, 49152, v9
  s_mul_i32 s24, s22, 384
  s_mul_i32 s25, s21, 1966080
  s_add_u32 s24, s24, s25
  s_mul_i32 s26, s22, 40
  s_mul_i32 s27, s23, 5
  s_add_u32 s26, s26, s27
  s_mul_i32 s26, s26, 20
  s_mul_i32 s27, s21, 5
  s_add_u32 s26, s26, s27
  s_lshl_b32 s26, s26, 10
  s_add_u32 s26, s26, 0x2e00000
  s_add_u32 s27, s24, 0
  buffer_load_dwordx4 v[16:19], v9, s[12:15], s27 offen offset:0
  buffer_load_dwordx4 v[20:23], v9, s[12:15], s27 offen offset:64
  buffer_load_dwordx4 v[24:27], v9, s[12:15], s27 offen offset:128
  buffer_load_dwordx4 v[28:31], v9, s[12:15], s27 offen offset:192
  buffer_load_dwordx4 v[32:35], v9, s[12:15], s27 offen offset:256
  buffer_load_dwordx4 v[36:39], v9, s[12:15], s27 offen offset:320
  buffer_load_dwordx4 v[40:43], v10, s[12:15], s27 offen offset:0
  buffer_load_dwordx4 v[44:47], v10, s[12:15], s27 offen offset:64
  buffer_load_dwordx4 v[48:51], v10, s[12:15], s27 offen offset:128
  buffer_load_dwordx4 v[52:55], v10, s[12:15], s27 offen offset:192
  buffer_load_dwordx4 v[56:59], v10, s[12:15], s27 offen offset:256
  buffer_load_dwordx4 v[60:63], v10, s[12:15], s27 offen offset:320
  s_add_u32 s27, s24, 393216
  buffer_load_dwordx4 v[64:67], v9, s[12:15], s27 offen offset:0
  buffer_load_dwordx4 v[68:71], v9, s[12:15], s27 offen offset:64
  buffer_load_dwordx4 v[72:75], v9, s[12:15], s27 offen offset:128
  buffer_load_dwordx4 v[76:79], v9, s[12:15], s27 offen offset:192
  buffer_load_dwordx4 v[80:83], v9, s[12:15], s27 offen offset:256
  buffer_load_dwordx4 v[84:87], v9, s[12:15], s27 offen offset:320
  buffer_load_dwordx4 v[88:91], v10, s[12:15], s27 offen offset:0
  buffer_load_dwordx4 v[92:95], v10, s[12:15], s27 offen offset:64
  buffer_load_dwordx4 v[96:99], v10, s[12:15], s27 offen offset:128
  buffer_load_dwordx4 v[100:103], v10, s[12:15], s27 offen offset:192
  buffer_load_dwordx4 v[104:107], v10, s[12:15], s27 offen offset:256
  buffer_load_dwordx4 v[108:111], v10, s[12:15], s27 offen offset:320
  s_waitcnt vmcnt(12)
  v_mfma_f32_16x16x32_bf16 v[112:115], v[16:19], a[0:3], 0
  v_mfma_f32_16x16x32_bf16 v[116:119], v[16:19], a[4:7], 0
  v_mfma_f32_16x16x32_bf16 v[120:123], v[16:19], a[8:11], 0
  v_mfma_f32_16x16x32_bf16 v[124:127], v[16:19], a[12:15], 0
  v_mfma_f32_16x16x32_bf16 v[128:131], v[16:19], a[16:19], 0
  v_mfma_f32_16x16x32_bf16 v[132:135], v[40:43], a[0:3], 0
  v_mfma_f32_16x16x32_bf16 v[136:139], v[40:43], a[4:7], 0
  v_mfma_f32_16x16x32_bf16 v[140:143], v[40:43], a[8:11], 0
  v_mfma_f32_16x16x32_bf16 v[144:147], v[40:43], a[12:15], 0
  v_mfma_f32_16x16x32_bf16 v[148:151], v[40:43], a[16:19], 0
  v_mfma_f32_16x16x32_bf16 v[112:115], v[20:23], a[20:23], v[112:115]
  v_mfma_f32_16x16x32_bf16 v[116:119], v[20:23], a[24:27], v[116:119]
  v_mfma_f32_16x16x32_bf16 v[120:123], v[20:23], a[28:31], v[120:123]
  v_mfma_f32_16x16x32_bf16 v[124:127], v[20:23], a[32:35], v[124:127]
  v_mfma_f32_16x16x32_bf16 v[128:131], v[20:23], a[36:39], v[128:131]
  v_mfma_f32_16x16x32_bf16 v[132:135], v[44:47], a[20:23], v[132:135]
  v_mfma_f32_16x16x32_bf16 v[136:139], v[44:47], a[24:27], v[136:139]
  v_mfma_f32_16x16x32_bf16 v[140:143], v[44:47], a[28:31], v[140:143]
  v_mfma_f32_16x16x32_bf16 v[144:147], v[44:47], a[32:35], v[144:147]
  v_mfma_f32_16x16x32_bf16 v[148:151], v[44:47], a[36:39], v[148:151]
  v_mfma_f32_16x16x32_bf16 v[112:115], v[24:27], a[40:43], v[112:115]
  v_mfma_f32_16x16x32_bf16 v[116:119], v[24:27], a[44:47], v[116:119]
  v_mfma_f32_16x16x32_bf16 v[120:123], v[24:27], a[48:51], v[120:123]
  v_mfma_f32_16x16x32_bf16 v[124:127], v[24:27], a[52:55], v[124:127]
  v_mfma_f32_16x16x32_bf16 v[128:131], v[24:27], a[56:59], v[128:131]
  v_mfma_f32_16x16x32_bf16 v[132:135], v[48:51], a[40:43], v[132:135]
  v_mfma_f32_16x16x32_bf16 v[136:139], v[48:51], a[44:47], v[136:139]
  v_mfma_f32_16x16x32_bf16 v[140:143], v[48:51], a[48:51], v[140:143]
  v_mfma_f32_16x16x32_bf16 v[144:147], v[48:51], a[52:55], v[144:147]
  v_mfma_f32_16x16x32_bf16 v[148:151], v[48:51], a[56:59], v[148:151]
  v_mfma_f32_16x16x32_bf16 v[112:115], v[28:31], a[60:63], v[112:115]
  v_mfma_f32_16x16x32_bf16 v[116:119], v[28:31], a[64:67], v[116:119]
  v_mfma_f32_16x16x32_bf16 v[120:123], v[28:31], a[68:71], v[120:123]
  v_mfma_f32_16x16x32_bf16 v[124:127], v[28:31], a[72:75], v[124:127]
  v_mfma_f32_16x16x32_bf16 v[128:131], v[28:31], a[76:79], v[128:131]
  v_mfma_f32_16x16x32_bf16 v[132:135], v[52:55], a[60:63], v[132:135]
  v_mfma_f32_16x16x32_bf16 v[136:139], v[52:55], a[64:67], v[136:139]
  v_mfma_f32_16x16x32_bf16 v[140:143], v[52:55], a[68:71], v[140:143]
  v_mfma_f32_16x16x32_bf16 v[144:147], v[52:55], a[72:75], v[144:147]
  v_mfma_f32_16x16x32_bf16 v[148:151], v[52:55], a[76:79], v[148:151]
  v_mfma_f32_16x16x32_bf16 v[112:115], v[32:35], a[80:83], v[112:115]
  v_mfma_f32_16x16x32_bf16 v[116:119], v[32:35], a[84:87], v[116:119]
  v_mfma_f32_16x16x32_bf16 v[120:123], v[32:35], a[88:91], v[120:123]
  v_mfma_f32_16x16x32_bf16 v[124:127], v[32:35], a[92:95], v[124:127]
  v_mfma_f32_16x16x32_bf16 v[128:131], v[32:35], a[96:99], v[128:131]
  v_mfma_f32_16x16x32_bf16 v[132:135], v[56:59], a[80:83], v[132:135]
  v_mfma_f32_16x16x32_bf16 v[136:139], v[56:59], a[84:87], v[136:139]
  v_mfma_f32_16x16x32_bf16 v[140:143], v[56:59], a[88:91], v[140:143]
  v_mfma_f32_16x16x32_bf16 v[144:147], v[56:59], a[92:95], v[144:147]
  v_mfma_f32_16x16x32_bf16 v[148:151], v[56:59], a[96:99], v[148:151]
  v_mfma_f32_16x16x32_bf16 v[112:115], v[36:39], a[100:103], v[112:115]
  v_mfma_f32_16x16x32_bf16 v[116:119], v[36:39], a[104:107], v[116:119]
  v_mfma_f32_16x16x32_bf16 v[120:123], v[36:39], a[108:111], v[120:123]
  v_mfma_f32_16x16x32_bf16 v[124:127], v[36:39], a[112:115], v[124:127]
  v_mfma_f32_16x16x32_bf16 v[128:131], v[36:39], a[116:119], v[128:131]
  v_mfma_f32_16x16x32_bf16 v[132:135], v[60:63], a[100:103], v[132:135]
  v_mfma_f32_16x16x32_bf16 v[136:139], v[60:63], a[104:107], v[136:139]
  v_mfma_f32_16x16x32_bf16 v[140:143], v[60:63], a[108:111], v[140:143]
  v_mfma_f32_16x16x32_bf16 v[144:147], v[60:63], a[112:115], v[144:147]
  v_mfma_f32_16x16x32_bf16 v[148:151], v[60:63], a[116:119], v[148:151]
  s_nop 7
  v_cvt_pk_bf16_f32 v160, v112, v113
  v_cvt_pk_bf16_f32 v161, v114, v115
  v_cvt_pk_bf16_f32 v162, v132, v133
  v_cvt_pk_bf16_f32 v163, v134, v135
  s_add_u32 s27, s26, 0
  buffer_store_dwordx4 v[160:163], v2, s[8:11], s27 offen
  v_cvt_pk_bf16_f32 v164, v116, v117
  v_cvt_pk_bf16_f32 v165, v118, v119
  v_cvt_pk_bf16_f32 v166, v136, v137
  v_cvt_pk_bf16_f32 v167, v138, v139
  s_add_u32 s27, s26, 20480
  buffer_store_dwordx4 v[164:167], v2, s[8:11], s27 offen
  v_cvt_pk_bf16_f32 v160, v120, v121
  v_cvt_pk_bf16_f32 v161, v122, v123
  v_cvt_pk_bf16_f32 v162, v140, v141
  v_cvt_pk_bf16_f32 v163, v142, v143
  s_add_u32 s27, s26, 40960
  buffer_store_dwordx4 v[160:163], v2, s[8:11], s27 offen
  v_cvt_pk_bf16_f32 v164, v124, v125
  v_cvt_pk_bf16_f32 v165, v126, v127
  v_cvt_pk_bf16_f32 v166, v144, v145
  v_cvt_pk_bf16_f32 v167, v146, v147
  s_add_u32 s27, s26, 61440
  buffer_store_dwordx4 v[164:167], v2, s[8:11], s27 offen
  v_cvt_pk_bf16_f32 v160, v128, v129
  v_cvt_pk_bf16_f32 v161, v130, v131
  v_cvt_pk_bf16_f32 v162, v148, v149
  v_cvt_pk_bf16_f32 v163, v150, v151
  s_add_u32 s27, s26, 81920
  buffer_store_dwordx4 v[160:163], v2, s[8:11], s27 offen
  s_add_u32 s27, s24, 786432
  buffer_load_dwordx4 v[16:19], v9, s[12:15], s27 offen offset:0
  buffer_load_dwordx4 v[20:23], v9, s[12:15], s27 offen offset:64
  buffer_load_dwordx4 v[24:27], v9, s[12:15], s27 offen offset:128
  buffer_load_dwordx4 v[28:31], v9, s[12:15], s27 offen offset:192
  buffer_load_dwordx4 v[32:35], v9, s[12:15], s27 offen offset:256
  buffer_load_dwordx4 v[36:39], v9, s[12:15], s27 offen offset:320
  buffer_load_dwordx4 v[40:43], v10, s[12:15], s27 offen offset:0
  buffer_load_dwordx4 v[44:47], v10, s[12:15], s27 offen offset:64
  buffer_load_dwordx4 v[48:51], v10, s[12:15], s27 offen offset:128
  buffer_load_dwordx4 v[52:55], v10, s[12:15], s27 offen offset:192
  buffer_load_dwordx4 v[56:59], v10, s[12:15], s27 offen offset:256
  buffer_load_dwordx4 v[60:63], v10, s[12:15], s27 offen offset:320
  s_waitcnt vmcnt(17)
  v_mfma_f32_16x16x32_bf16 v[112:115], v[64:67], a[0:3], 0
  v_mfma_f32_16x16x32_bf16 v[116:119], v[64:67], a[4:7], 0
  v_mfma_f32_16x16x32_bf16 v[120:123], v[64:67], a[8:11], 0
  v_mfma_f32_16x16x32_bf16 v[124:127], v[64:67], a[12:15], 0
  v_mfma_f32_16x16x32_bf16 v[128:131], v[64:67], a[16:19], 0
  v_mfma_f32_16x16x32_bf16 v[132:135], v[88:91], a[0:3], 0
  v_mfma_f32_16x16x32_bf16 v[136:139], v[88:91], a[4:7], 0
  v_mfma_f32_16x16x32_bf16 v[140:143], v[88:91], a[8:11], 0
  v_mfma_f32_16x16x32_bf16 v[144:147], v[88:91], a[12:15], 0
  v_mfma_f32_16x16x32_bf16 v[148:151], v[88:91], a[16:19], 0
  v_mfma_f32_16x16x32_bf16 v[112:115], v[68:71], a[20:23], v[112:115]
  v_mfma_f32_16x16x32_bf16 v[116:119], v[68:71], a[24:27], v[116:119]
  v_mfma_f32_16x16x32_bf16 v[120:123], v[68:71], a[28:31], v[120:123]
  v_mfma_f32_16x16x32_bf16 v[124:127], v[68:71], a[32:35], v[124:127]
  v_mfma_f32_16x16x32_bf16 v[128:131], v[68:71], a[36:39], v[128:131]
  v_mfma_f32_16x16x32_bf16 v[132:135], v[92:95], a[20:23], v[132:135]
  v_mfma_f32_16x16x32_bf16 v[136:139], v[92:95], a[24:27], v[136:139]
  v_mfma_f32_16x16x32_bf16 v[140:143], v[92:95], a[28:31], v[140:143]
  v_mfma_f32_16x16x32_bf16 v[144:147], v[92:95], a[32:35], v[144:147]
  v_mfma_f32_16x16x32_bf16 v[148:151], v[92:95], a[36:39], v[148:151]
  v_mfma_f32_16x16x32_bf16 v[112:115], v[72:75], a[40:43], v[112:115]
  v_mfma_f32_16x16x32_bf16 v[116:119], v[72:75], a[44:47], v[116:119]
  v_mfma_f32_16x16x32_bf16 v[120:123], v[72:75], a[48:51], v[120:123]
  v_mfma_f32_16x16x32_bf16 v[124:127], v[72:75], a[52:55], v[124:127]
  v_mfma_f32_16x16x32_bf16 v[128:131], v[72:75], a[56:59], v[128:131]
  v_mfma_f32_16x16x32_bf16 v[132:135], v[96:99], a[40:43], v[132:135]
  v_mfma_f32_16x16x32_bf16 v[136:139], v[96:99], a[44:47], v[136:139]
  v_mfma_f32_16x16x32_bf16 v[140:143], v[96:99], a[48:51], v[140:143]
  v_mfma_f32_16x16x32_bf16 v[144:147], v[96:99], a[52:55], v[144:147]
  v_mfma_f32_16x16x32_bf16 v[148:151], v[96:99], a[56:59], v[148:151]
  v_mfma_f32_16x16x32_bf16 v[112:115], v[76:79], a[60:63], v[112:115]
  v_mfma_f32_16x16x32_bf16 v[116:119], v[76:79], a[64:67], v[116:119]
  v_mfma_f32_16x16x32_bf16 v[120:123], v[76:79], a[68:71], v[120:123]
  v_mfma_f32_16x16x32_bf16 v[124:127], v[76:79], a[72:75], v[124:127]
  v_mfma_f32_16x16x32_bf16 v[128:131], v[76:79], a[76:79], v[128:131]
  v_mfma_f32_16x16x32_bf16 v[132:135], v[100:103], a[60:63], v[132:135]
  v_mfma_f32_16x16x32_bf16 v[136:139], v[100:103], a[64:67], v[136:139]
  v_mfma_f32_16x16x32_bf16 v[140:143], v[100:103], a[68:71], v[140:143]
  v_mfma_f32_16x16x32_bf16 v[144:147], v[100:103], a[72:75], v[144:147]
  v_mfma_f32_16x16x32_bf16 v[148:151], v[100:103], a[76:79], v[148:151]
  v_mfma_f32_16x16x32_bf16 v[112:115], v[80:83], a[80:83], v[112:115]
  v_mfma_f32_16x16x32_bf16 v[116:119], v[80:83], a[84:87], v[116:119]
  v_mfma_f32_16x16x32_bf16 v[120:123], v[80:83], a[88:91], v[120:123]
  v_mfma_f32_16x16x32_bf16 v[124:127], v[80:83], a[92:95], v[124:127]
  v_mfma_f32_16x16x32_bf16 v[128:131], v[80:83], a[96:99], v[128:131]
  v_mfma_f32_16x16x32_bf16 v[132:135], v[104:107], a[80:83], v[132:135]
  v_mfma_f32_16x16x32_bf16 v[136:139], v[104:107], a[84:87], v[136:139]
  v_mfma_f32_16x16x32_bf16 v[140:143], v[104:107], a[88:91], v[140:143]
  v_mfma_f32_16x16x32_bf16 v[144:147], v[104:107], a[92:95], v[144:147]
  v_mfma_f32_16x16x32_bf16 v[148:151], v[104:107], a[96:99], v[148:151]
  v_mfma_f32_16x16x32_bf16 v[112:115], v[84:87], a[100:103], v[112:115]
  v_mfma_f32_16x16x32_bf16 v[116:119], v[84:87], a[104:107], v[116:119]
  v_mfma_f32_16x16x32_bf16 v[120:123], v[84:87], a[108:111], v[120:123]
  v_mfma_f32_16x16x32_bf16 v[124:127], v[84:87], a[112:115], v[124:127]
  v_mfma_f32_16x16x32_bf16 v[128:131], v[84:87], a[116:119], v[128:131]
  v_mfma_f32_16x16x32_bf16 v[132:135], v[108:111], a[100:103], v[132:135]
  v_mfma_f32_16x16x32_bf16 v[136:139], v[108:111], a[104:107], v[136:139]
  v_mfma_f32_16x16x32_bf16 v[140:143], v[108:111], a[108:111], v[140:143]
  v_mfma_f32_16x16x32_bf16 v[144:147], v[108:111], a[112:115], v[144:147]
  v_mfma_f32_16x16x32_bf16 v[148:151], v[108:111], a[116:119], v[148:151]
  s_nop 7
  v_cvt_pk_bf16_f32 v160, v112, v113
  v_cvt_pk_bf16_f32 v161, v114, v115
  v_cvt_pk_bf16_f32 v162, v132, v133
  v_cvt_pk_bf16_f32 v163, v134, v135
  s_add_u32 s27, s26, 1024
  buffer_store_dwordx4 v[160:163], v2, s[8:11], s27 offen
  v_cvt_pk_bf16_f32 v164, v116, v117
  v_cvt_pk_bf16_f32 v165, v118, v119
  v_cvt_pk_bf16_f32 v166, v136, v137
  v_cvt_pk_bf16_f32 v167, v138, v139
  s_add_u32 s27, s26, 21504
  buffer_store_dwordx4 v[164:167], v2, s[8:11], s27 offen
  v_cvt_pk_bf16_f32 v160, v120, v121
  v_cvt_pk_bf16_f32 v161, v122, v123
  v_cvt_pk_bf16_f32 v162, v140, v141
  v_cvt_pk_bf16_f32 v163, v142, v143
  s_add_u32 s27, s26, 41984
  buffer_store_dwordx4 v[160:163], v2, s[8:11], s27 offen
  v_cvt_pk_bf16_f32 v164, v124, v125
  v_cvt_pk_bf16_f32 v165, v126, v127
  v_cvt_pk_bf16_f32 v166, v144, v145
  v_cvt_pk_bf16_f32 v167, v146, v147
  s_add_u32 s27, s26, 62464
  buffer_store_dwordx4 v[164:167], v2, s[8:11], s27 offen
  v_cvt_pk_bf16_f32 v160, v128, v129
  v_cvt_pk_bf16_f32 v161, v130, v131
  v_cvt_pk_bf16_f32 v162, v148, v149
  v_cvt_pk_bf16_f32 v163, v150, v151
  s_add_u32 s27, s26, 82944
  buffer_store_dwordx4 v[160:163], v2, s[8:11], s27 offen
  s_add_u32 s27, s24, 1179648
  buffer_load_dwordx4 v[64:67], v9, s[12:15], s27 offen offset:0
  buffer_load_dwordx4 v[68:71], v9, s[12:15], s27 offen offset:64
  buffer_load_dwordx4 v[72:75], v9, s[12:15], s27 offen offset:128
  buffer_load_dwordx4 v[76:79], v9, s[12:15], s27 offen offset:192
  buffer_load_dwordx4 v[80:83], v9, s[12:15], s27 offen offset:256
  buffer_load_dwordx4 v[84:87], v9, s[12:15], s27 offen offset:320
  buffer_load_dwordx4 v[88:91], v10, s[12:15], s27 offen offset:0
  buffer_load_dwordx4 v[92:95], v10, s[12:15], s27 offen offset:64
  buffer_load_dwordx4 v[96:99], v10, s[12:15], s27 offen offset:128
  buffer_load_dwordx4 v[100:103], v10, s[12:15], s27 offen offset:192
  buffer_load_dwordx4 v[104:107], v10, s[12:15], s27 offen offset:256
  buffer_load_dwordx4 v[108:111], v10, s[12:15], s27 offen offset:320
  s_waitcnt vmcnt(17)
  v_mfma_f32_16x16x32_bf16 v[112:115], v[16:19], a[0:3], 0
  v_mfma_f32_16x16x32_bf16 v[116:119], v[16:19], a[4:7], 0
  v_mfma_f32_16x16x32_bf16 v[120:123], v[16:19], a[8:11], 0
  v_mfma_f32_16x16x32_bf16 v[124:127], v[16:19], a[12:15], 0
  v_mfma_f32_16x16x32_bf16 v[128:131], v[16:19], a[16:19], 0
  v_mfma_f32_16x16x32_bf16 v[132:135], v[40:43], a[0:3], 0
  v_mfma_f32_16x16x32_bf16 v[136:139], v[40:43], a[4:7], 0
  v_mfma_f32_16x16x32_bf16 v[140:143], v[40:43], a[8:11], 0
  v_mfma_f32_16x16x32_bf16 v[144:147], v[40:43], a[12:15], 0
  v_mfma_f32_16x16x32_bf16 v[148:151], v[40:43], a[16:19], 0
  v_mfma_f32_16x16x32_bf16 v[112:115], v[20:23], a[20:23], v[112:115]
  v_mfma_f32_16x16x32_bf16 v[116:119], v[20:23], a[24:27], v[116:119]
  v_mfma_f32_16x16x32_bf16 v[120:123], v[20:23], a[28:31], v[120:123]
  v_mfma_f32_16x16x32_bf16 v[124:127], v[20:23], a[32:35], v[124:127]
  v_mfma_f32_16x16x32_bf16 v[128:131], v[20:23], a[36:39], v[128:131]
  v_mfma_f32_16x16x32_bf16 v[132:135], v[44:47], a[20:23], v[132:135]
  v_mfma_f32_16x16x32_bf16 v[136:139], v[44:47], a[24:27], v[136:139]
  v_mfma_f32_16x16x32_bf16 v[140:143], v[44:47], a[28:31], v[140:143]
  v_mfma_f32_16x16x32_bf16 v[144:147], v[44:47], a[32:35], v[144:147]
  v_mfma_f32_16x16x32_bf16 v[148:151], v[44:47], a[36:39], v[148:151]
  v_mfma_f32_16x16x32_bf16 v[112:115], v[24:27], a[40:43], v[112:115]
  v_mfma_f32_16x16x32_bf16 v[116:119], v[24:27], a[44:47], v[116:119]
  v_mfma_f32_16x16x32_bf16 v[120:123], v[24:27], a[48:51], v[120:123]
  v_mfma_f32_16x16x32_bf16 v[124:127], v[24:27], a[52:55], v[124:127]
  v_mfma_f32_16x16x32_bf16 v[128:131], v[24:27], a[56:59], v[128:131]
  v_mfma_f32_16x16x32_bf16 v[132:135], v[48:51], a[40:43], v[132:135]
  v_mfma_f32_16x16x32_bf16 v[136:139], v[48:51], a[44:47], v[136:139]
  v_mfma_f32_16x16x32_bf16 v[140:143], v[48:51], a[48:51], v[140:143]
  v_mfma_f32_16x16x32_bf16 v[144:147], v[48:51], a[52:55], v[144:147]
  v_mfma_f32_16x16x32_bf16 v[148:151], v[48:51], a[56:59], v[148:151]
  v_mfma_f32_16x16x32_bf16 v[112:115], v[28:31], a[60:63], v[112:115]
  v_mfma_f32_16x16x32_bf16 v[116:119], v[28:31], a[64:67], v[116:119]
  v_mfma_f32_16x16x32_bf16 v[120:123], v[28:31], a[68:71], v[120:123]
  v_mfma_f32_16x16x32_bf16 v[124:127], v[28:31], a[72:75], v[124:127]
  v_mfma_f32_16x16x32_bf16 v[128:131], v[28:31], a[76:79], v[128:131]
  v_mfma_f32_16x16x32_bf16 v[132:135], v[52:55], a[60:63], v[132:135]
  v_mfma_f32_16x16x32_bf16 v[136:139], v[52:55], a[64:67], v[136:139]
  v_mfma_f32_16x16x32_bf16 v[140:143], v[52:55], a[68:71], v[140:143]
  v_mfma_f32_16x16x32_bf16 v[144:147], v[52:55], a[72:75], v[144:147]
  v_mfma_f32_16x16x32_bf16 v[148:151], v[52:55], a[76:79], v[148:151]
  v_mfma_f32_16x16x32_bf16 v[112:115], v[32:35], a[80:83], v[112:115]
  v_mfma_f32_16x16x32_bf16 v[116:119], v[32:35], a[84:87], v[116:119]
  v_mfma_f32_16x16x32_bf16 v[120:123], v[32:35], a[88:91], v[120:123]
  v_mfma_f32_16x16x32_bf16 v[124:127], v[32:35], a[92:95], v[124:127]
  v_mfma_f32_16x16x32_bf16 v[128:131], v[32:35], a[96:99], v[128:131]
  v_mfma_f32_16x16x32_bf16 v[132:135], v[56:59], a[80:83], v[132:135]
  v_mfma_f32_16x16x32_bf16 v[136:139], v[56:59], a[84:87], v[136:139]
  v_mfma_f32_16x16x32_bf16 v[140:143], v[56:59], a[88:91], v[140:143]
  v_mfma_f32_16x16x32_bf16 v[144:147], v[56:59], a[92:95], v[144:147]
  v_mfma_f32_16x16x32_bf16 v[148:151], v[56:59], a[96:99], v[148:151]
  v_mfma_f32_16x16x32_bf16 v[112:115], v[36:39], a[100:103], v[112:115]
  v_mfma_f32_16x16x32_bf16 v[116:119], v[36:39], a[104:107], v[116:119]
  v_mfma_f32_16x16x32_bf16 v[120:123], v[36:39], a[108:111], v[120:123]
  v_mfma_f32_16x16x32_bf16 v[124:127], v[36:39], a[112:115], v[124:127]
  v_mfma_f32_16x16x32_bf16 v[128:131], v[36:39], a[116:119], v[128:131]
  v_mfma_f32_16x16x32_bf16 v[132:135], v[60:63], a[100:103], v[132:135]
  v_mfma_f32_16x16x32_bf16 v[136:139], v[60:63], a[104:107], v[136:139]
  v_mfma_f32_16x16x32_bf16 v[140:143], v[60:63], a[108:111], v[140:143]
  v_mfma_f32_16x16x32_bf16 v[144:147], v[60:63], a[112:115], v[144:147]
  v_mfma_f32_16x16x32_bf16 v[148:151], v[60:63], a[116:119], v[148:151]
  s_nop 7
  v_cvt_pk_bf16_f32 v160, v112, v113
  v_cvt_pk_bf16_f32 v161, v114, v115
  v_cvt_pk_bf16_f32 v162, v132, v133
  v_cvt_pk_bf16_f32 v163, v134, v135
  s_add_u32 s27, s26, 2048
  buffer_store_dwordx4 v[160:163], v2, s[8:11], s27 offen
  v_cvt_pk_bf16_f32 v164, v116, v117
  v_cvt_pk_bf16_f32 v165, v118, v119
  v_cvt_pk_bf16_f32 v166, v136, v137
  v_cvt_pk_bf16_f32 v167, v138, v139
  s_add_u32 s27, s26, 22528
  buffer_store_dwordx4 v[164:167], v2, s[8:11], s27 offen
  v_cvt_pk_bf16_f32 v160, v120, v121
  v_cvt_pk_bf16_f32 v161, v122, v123
  v_cvt_pk_bf16_f32 v162, v140, v141
  v_cvt_pk_bf16_f32 v163, v142, v143
  s_add_u32 s27, s26, 43008
  buffer_store_dwordx4 v[160:163], v2, s[8:11], s27 offen
  v_cvt_pk_bf16_f32 v164, v124, v125
  v_cvt_pk_bf16_f32 v165, v126, v127
  v_cvt_pk_bf16_f32 v166, v144, v145
  v_cvt_pk_bf16_f32 v167, v146, v147
  s_add_u32 s27, s26, 63488
  buffer_store_dwordx4 v[164:167], v2, s[8:11], s27 offen
  v_cvt_pk_bf16_f32 v160, v128, v129
  v_cvt_pk_bf16_f32 v161, v130, v131
  v_cvt_pk_bf16_f32 v162, v148, v149
  v_cvt_pk_bf16_f32 v163, v150, v151
  s_add_u32 s27, s26, 83968
  buffer_store_dwordx4 v[160:163], v2, s[8:11], s27 offen
  s_add_u32 s27, s24, 1572864
  buffer_load_dwordx4 v[16:19], v9, s[12:15], s27 offen offset:0
  buffer_load_dwordx4 v[20:23], v9, s[12:15], s27 offen offset:64
  buffer_load_dwordx4 v[24:27], v9, s[12:15], s27 offen offset:128
  buffer_load_dwordx4 v[28:31], v9, s[12:15], s27 offen offset:192
  buffer_load_dwordx4 v[32:35], v9, s[12:15], s27 offen offset:256
  buffer_load_dwordx4 v[36:39], v9, s[12:15], s27 offen offset:320
  buffer_load_dwordx4 v[40:43], v10, s[12:15], s27 offen offset:0
  buffer_load_dwordx4 v[44:47], v10, s[12:15], s27 offen offset:64
  buffer_load_dwordx4 v[48:51], v10, s[12:15], s27 offen offset:128
  buffer_load_dwordx4 v[52:55], v10, s[12:15], s27 offen offset:192
  buffer_load_dwordx4 v[56:59], v10, s[12:15], s27 offen offset:256
  buffer_load_dwordx4 v[60:63], v10, s[12:15], s27 offen offset:320
  s_waitcnt vmcnt(17)
  v_mfma_f32_16x16x32_bf16 v[112:115], v[64:67], a[0:3], 0
  v_mfma_f32_16x16x32_bf16 v[116:119], v[64:67], a[4:7], 0
  v_mfma_f32_16x16x32_bf16 v[120:123], v[64:67], a[8:11], 0
  v_mfma_f32_16x16x32_bf16 v[124:127], v[64:67], a[12:15], 0
  v_mfma_f32_16x16x32_bf16 v[128:131], v[64:67], a[16:19], 0
  v_mfma_f32_16x16x32_bf16 v[132:135], v[88:91], a[0:3], 0
  v_mfma_f32_16x16x32_bf16 v[136:139], v[88:91], a[4:7], 0
  v_mfma_f32_16x16x32_bf16 v[140:143], v[88:91], a[8:11], 0
  v_mfma_f32_16x16x32_bf16 v[144:147], v[88:91], a[12:15], 0
  v_mfma_f32_16x16x32_bf16 v[148:151], v[88:91], a[16:19], 0
  v_mfma_f32_16x16x32_bf16 v[112:115], v[68:71], a[20:23], v[112:115]
  v_mfma_f32_16x16x32_bf16 v[116:119], v[68:71], a[24:27], v[116:119]
  v_mfma_f32_16x16x32_bf16 v[120:123], v[68:71], a[28:31], v[120:123]
  v_mfma_f32_16x16x32_bf16 v[124:127], v[68:71], a[32:35], v[124:127]
  v_mfma_f32_16x16x32_bf16 v[128:131], v[68:71], a[36:39], v[128:131]
  v_mfma_f32_16x16x32_bf16 v[132:135], v[92:95], a[20:23], v[132:135]
  v_mfma_f32_16x16x32_bf16 v[136:139], v[92:95], a[24:27], v[136:139]
  v_mfma_f32_16x16x32_bf16 v[140:143], v[92:95], a[28:31], v[140:143]
  v_mfma_f32_16x16x32_bf16 v[144:147], v[92:95], a[32:35], v[144:147]
  v_mfma_f32_16x16x32_bf16 v[148:151], v[92:95], a[36:39], v[148:151]
  v_mfma_f32_16x16x32_bf16 v[112:115], v[72:75], a[40:43], v[112:115]
  v_mfma_f32_16x16x32_bf16 v[116:119], v[72:75], a[44:47], v[116:119]
  v_mfma_f32_16x16x32_bf16 v[120:123], v[72:75], a[48:51], v[120:123]
  v_mfma_f32_16x16x32_bf16 v[124:127], v[72:75], a[52:55], v[124:127]
  v_mfma_f32_16x16x32_bf16 v[128:131], v[72:75], a[56:59], v[128:131]
  v_mfma_f32_16x16x32_bf16 v[132:135], v[96:99], a[40:43], v[132:135]
  v_mfma_f32_16x16x32_bf16 v[136:139], v[96:99], a[44:47], v[136:139]
  v_mfma_f32_16x16x32_bf16 v[140:143], v[96:99], a[48:51], v[140:143]
  v_mfma_f32_16x16x32_bf16 v[144:147], v[96:99], a[52:55], v[144:147]
  v_mfma_f32_16x16x32_bf16 v[148:151], v[96:99], a[56:59], v[148:151]
  v_mfma_f32_16x16x32_bf16 v[112:115], v[76:79], a[60:63], v[112:115]
  v_mfma_f32_16x16x32_bf16 v[116:119], v[76:79], a[64:67], v[116:119]
  v_mfma_f32_16x16x32_bf16 v[120:123], v[76:79], a[68:71], v[120:123]
  v_mfma_f32_16x16x32_bf16 v[124:127], v[76:79], a[72:75], v[124:127]
  v_mfma_f32_16x16x32_bf16 v[128:131], v[76:79], a[76:79], v[128:131]
  v_mfma_f32_16x16x32_bf16 v[132:135], v[100:103], a[60:63], v[132:135]
  v_mfma_f32_16x16x32_bf16 v[136:139], v[100:103], a[64:67], v[136:139]
  v_mfma_f32_16x16x32_bf16 v[140:143], v[100:103], a[68:71], v[140:143]
  v_mfma_f32_16x16x32_bf16 v[144:147], v[100:103], a[72:75], v[144:147]
  v_mfma_f32_16x16x32_bf16 v[148:151], v[100:103], a[76:79], v[148:151]
  v_mfma_f32_16x16x32_bf16 v[112:115], v[80:83], a[80:83], v[112:115]
  v_mfma_f32_16x16x32_bf16 v[116:119], v[80:83], a[84:87], v[116:119]
  v_mfma_f32_16x16x32_bf16 v[120:123], v[80:83], a[88:91], v[120:123]
  v_mfma_f32_16x16x32_bf16 v[124:127], v[80:83], a[92:95], v[124:127]
  v_mfma_f32_16x16x32_bf16 v[128:131], v[80:83], a[96:99], v[128:131]
  v_mfma_f32_16x16x32_bf16 v[132:135], v[104:107], a[80:83], v[132:135]
  v_mfma_f32_16x16x32_bf16 v[136:139], v[104:107], a[84:87], v[136:139]
  v_mfma_f32_16x16x32_bf16 v[140:143], v[104:107], a[88:91], v[140:143]
  v_mfma_f32_16x16x32_bf16 v[144:147], v[104:107], a[92:95], v[144:147]
  v_mfma_f32_16x16x32_bf16 v[148:151], v[104:107], a[96:99], v[148:151]
  v_mfma_f32_16x16x32_bf16 v[112:115], v[84:87], a[100:103], v[112:115]
  v_mfma_f32_16x16x32_bf16 v[116:119], v[84:87], a[104:107], v[116:119]
  v_mfma_f32_16x16x32_bf16 v[120:123], v[84:87], a[108:111], v[120:123]
  v_mfma_f32_16x16x32_bf16 v[124:127], v[84:87], a[112:115], v[124:127]
  v_mfma_f32_16x16x32_bf16 v[128:131], v[84:87], a[116:119], v[128:131]
  v_mfma_f32_16x16x32_bf16 v[132:135], v[108:111], a[100:103], v[132:135]
  v_mfma_f32_16x16x32_bf16 v[136:139], v[108:111], a[104:107], v[136:139]
  v_mfma_f32_16x16x32_bf16 v[140:143], v[108:111], a[108:111], v[140:143]
  v_mfma_f32_16x16x32_bf16 v[144:147], v[108:111], a[112:115], v[144:147]
  v_mfma_f32_16x16x32_bf16 v[148:151], v[108:111], a[116:119], v[148:151]
  s_nop 7
  v_cvt_pk_bf16_f32 v160, v112, v113
  v_cvt_pk_bf16_f32 v161, v114, v115
  v_cvt_pk_bf16_f32 v162, v132, v133
  v_cvt_pk_bf16_f32 v163, v134, v135
  s_add_u32 s27, s26, 3072
  buffer_store_dwordx4 v[160:163], v2, s[8:11], s27 offen
  v_cvt_pk_bf16_f32 v164, v116, v117
  v_cvt_pk_bf16_f32 v165, v118, v119
  v_cvt_pk_bf16_f32 v166, v136, v137
  v_cvt_pk_bf16_f32 v167, v138, v139
  s_add_u32 s27, s26, 23552
  buffer_store_dwordx4 v[164:167], v2, s[8:11], s27 offen
  v_cvt_pk_bf16_f32 v160, v120, v121
  v_cvt_pk_bf16_f32 v161, v122, v123
  v_cvt_pk_bf16_f32 v162, v140, v141
  v_cvt_pk_bf16_f32 v163, v142, v143
  s_add_u32 s27, s26, 44032
  buffer_store_dwordx4 v[160:163], v2, s[8:11], s27 offen
  v_cvt_pk_bf16_f32 v164, v124, v125
  v_cvt_pk_bf16_f32 v165, v126, v127
  v_cvt_pk_bf16_f32 v166, v144, v145
  v_cvt_pk_bf16_f32 v167, v146, v147
  s_add_u32 s27, s26, 64512
  buffer_store_dwordx4 v[164:167], v2, s[8:11], s27 offen
  v_cvt_pk_bf16_f32 v160, v128, v129
  v_cvt_pk_bf16_f32 v161, v130, v131
  v_cvt_pk_bf16_f32 v162, v148, v149
  v_cvt_pk_bf16_f32 v163, v150, v151
  s_add_u32 s27, s26, 84992
  buffer_store_dwordx4 v[160:163], v2, s[8:11], s27 offen
  s_waitcnt vmcnt(5)
  v_mfma_f32_16x16x32_bf16 v[112:115], v[16:19], a[0:3], 0
  v_mfma_f32_16x16x32_bf16 v[116:119], v[16:19], a[4:7], 0
  v_mfma_f32_16x16x32_bf16 v[120:123], v[16:19], a[8:11], 0
  v_mfma_f32_16x16x32_bf16 v[124:127], v[16:19], a[12:15], 0
  v_mfma_f32_16x16x32_bf16 v[128:131], v[16:19], a[16:19], 0
  v_mfma_f32_16x16x32_bf16 v[132:135], v[40:43], a[0:3], 0
  v_mfma_f32_16x16x32_bf16 v[136:139], v[40:43], a[4:7], 0
  v_mfma_f32_16x16x32_bf16 v[140:143], v[40:43], a[8:11], 0
  v_mfma_f32_16x16x32_bf16 v[144:147], v[40:43], a[12:15], 0
  v_mfma_f32_16x16x32_bf16 v[148:151], v[40:43], a[16:19], 0
  v_mfma_f32_16x16x32_bf16 v[112:115], v[20:23], a[20:23], v[112:115]
  v_mfma_f32_16x16x32_bf16 v[116:119], v[20:23], a[24:27], v[116:119]
  v_mfma_f32_16x16x32_bf16 v[120:123], v[20:23], a[28:31], v[120:123]
  v_mfma_f32_16x16x32_bf16 v[124:127], v[20:23], a[32:35], v[124:127]
  v_mfma_f32_16x16x32_bf16 v[128:131], v[20:23], a[36:39], v[128:131]
  v_mfma_f32_16x16x32_bf16 v[132:135], v[44:47], a[20:23], v[132:135]
  v_mfma_f32_16x16x32_bf16 v[136:139], v[44:47], a[24:27], v[136:139]
  v_mfma_f32_16x16x32_bf16 v[140:143], v[44:47], a[28:31], v[140:143]
  v_mfma_f32_16x16x32_bf16 v[144:147], v[44:47], a[32:35], v[144:147]
  v_mfma_f32_16x16x32_bf16 v[148:151], v[44:47], a[36:39], v[148:151]
  v_mfma_f32_16x16x32_bf16 v[112:115], v[24:27], a[40:43], v[112:115]
  v_mfma_f32_16x16x32_bf16 v[116:119], v[24:27], a[44:47], v[116:119]
  v_mfma_f32_16x16x32_bf16 v[120:123], v[24:27], a[48:51], v[120:123]
  v_mfma_f32_16x16x32_bf16 v[124:127], v[24:27], a[52:55], v[124:127]
  v_mfma_f32_16x16x32_bf16 v[128:131], v[24:27], a[56:59], v[128:131]
  v_mfma_f32_16x16x32_bf16 v[132:135], v[48:51], a[40:43], v[132:135]
  v_mfma_f32_16x16x32_bf16 v[136:139], v[48:51], a[44:47], v[136:139]
  v_mfma_f32_16x16x32_bf16 v[140:143], v[48:51], a[48:51], v[140:143]
  v_mfma_f32_16x16x32_bf16 v[144:147], v[48:51], a[52:55], v[144:147]
  v_mfma_f32_16x16x32_bf16 v[148:151], v[48:51], a[56:59], v[148:151]
  v_mfma_f32_16x16x32_bf16 v[112:115], v[28:31], a[60:63], v[112:115]
  v_mfma_f32_16x16x32_bf16 v[116:119], v[28:31], a[64:67], v[116:119]
  v_mfma_f32_16x16x32_bf16 v[120:123], v[28:31], a[68:71], v[120:123]
  v_mfma_f32_16x16x32_bf16 v[124:127], v[28:31], a[72:75], v[124:127]
  v_mfma_f32_16x16x32_bf16 v[128:131], v[28:31], a[76:79], v[128:131]
  v_mfma_f32_16x16x32_bf16 v[132:135], v[52:55], a[60:63], v[132:135]
  v_mfma_f32_16x16x32_bf16 v[136:139], v[52:55], a[64:67], v[136:139]
  v_mfma_f32_16x16x32_bf16 v[140:143], v[52:55], a[68:71], v[140:143]
  v_mfma_f32_16x16x32_bf16 v[144:147], v[52:55], a[72:75], v[144:147]
  v_mfma_f32_16x16x32_bf16 v[148:151], v[52:55], a[76:79], v[148:151]
  v_mfma_f32_16x16x32_bf16 v[112:115], v[32:35], a[80:83], v[112:115]
  v_mfma_f32_16x16x32_bf16 v[116:119], v[32:35], a[84:87], v[116:119]
  v_mfma_f32_16x16x32_bf16 v[120:123], v[32:35], a[88:91], v[120:123]
  v_mfma_f32_16x16x32_bf16 v[124:127], v[32:35], a[92:95], v[124:127]
  v_mfma_f32_16x16x32_bf16 v[128:131], v[32:35], a[96:99], v[128:131]
  v_mfma_f32_16x16x32_bf16 v[132:135], v[56:59], a[80:83], v[132:135]
  v_mfma_f32_16x16x32_bf16 v[136:139], v[56:59], a[84:87], v[136:139]
  v_mfma_f32_16x16x32_bf16 v[140:143], v[56:59], a[88:91], v[140:143]
  v_mfma_f32_16x16x32_bf16 v[144:147], v[56:59], a[92:95], v[144:147]
  v_mfma_f32_16x16x32_bf16 v[148:151], v[56:59], a[96:99], v[148:151]
  v_mfma_f32_16x16x32_bf16 v[112:115], v[36:39], a[100:103], v[112:115]
  v_mfma_f32_16x16x32_bf16 v[116:119], v[36:39], a[104:107], v[116:119]
  v_mfma_f32_16x16x32_bf16 v[120:123], v[36:39], a[108:111], v[120:123]
  v_mfma_f32_16x16x32_bf16 v[124:127], v[36:39], a[112:115], v[124:127]
  v_mfma_f32_16x16x32_bf16 v[128:131], v[36:39], a[116:119], v[128:131]
  v_mfma_f32_16x16x32_bf16 v[132:135], v[60:63], a[100:103], v[132:135]
  v_mfma_f32_16x16x32_bf16 v[136:139], v[60:63], a[104:107], v[136:139]
  v_mfma_f32_16x16x32_bf16 v[140:143], v[60:63], a[108:111], v[140:143]
  v_mfma_f32_16x16x32_bf16 v[144:147], v[60:63], a[112:115], v[144:147]
  v_mfma_f32_16x16x32_bf16 v[148:151], v[60:63], a[116:119], v[148:151]
  s_nop 7
  v_cvt_pk_bf16_f32 v160, v112, v113
  v_cvt_pk_bf16_f32 v161, v114, v115
  v_cvt_pk_bf16_f32 v162, v132, v133
  v_cvt_pk_bf16_f32 v163, v134, v135
  s_add_u32 s27, s26, 4096
  buffer_store_dwordx4 v[160:163], v2, s[8:11], s27 offen
  v_cvt_pk_bf16_f32 v164, v116, v117
  v_cvt_pk_bf16_f32 v165, v118, v119
  v_cvt_pk_bf16_f32 v166, v136, v137
  v_cvt_pk_bf16_f32 v167, v138, v139
  s_add_u32 s27, s26, 24576
  buffer_store_dwordx4 v[164:167], v2, s[8:11], s27 offen
  v_cvt_pk_bf16_f32 v160, v120, v121
  v_cvt_pk_bf16_f32 v161, v122, v123
  v_cvt_pk_bf16_f32 v162, v140, v141
  v_cvt_pk_bf16_f32 v163, v142, v143
  s_add_u32 s27, s26, 45056
  buffer_store_dwordx4 v[160:163], v2, s[8:11], s27 offen
  v_cvt_pk_bf16_f32 v164, v124, v125
  v_cvt_pk_bf16_f32 v165, v126, v127
  v_cvt_pk_bf16_f32 v166, v144, v145
  v_cvt_pk_bf16_f32 v167, v146, v147
  s_add_u32 s27, s26, 65536
  buffer_store_dwordx4 v[164:167], v2, s[8:11], s27 offen
  v_cvt_pk_bf16_f32 v160, v128, v129
  v_cvt_pk_bf16_f32 v161, v130, v131
  v_cvt_pk_bf16_f32 v162, v148, v149
  v_cvt_pk_bf16_f32 v163, v150, v151
  s_add_u32 s27, s26, 86016
  buffer_store_dwordx4 v[160:163], v2, s[8:11], s27 offen
k0_exit:
  s_endpgm

.section .rodata,"a"
.p2align 6
.amdhsa_kernel prep_kernel
  .amdhsa_next_free_vgpr 512
  .amdhsa_next_free_sgpr 102
  .amdhsa_accum_offset 256
  .amdhsa_group_segment_fixed_size 0
  .amdhsa_kernarg_size 104
  .amdhsa_user_sgpr_count 2
  .amdhsa_user_sgpr_kernarg_segment_ptr 1
  .amdhsa_system_sgpr_workgroup_id_x 1
.end_amdhsa_kernel
.text
.globl ka1_kernel
.p2align 8
.type ka1_kernel,@function
ka1_kernel:
  s_mov_b32 s99, 0
  s_branch ka_body

.section .rodata,"a"
.p2align 6
.amdhsa_kernel ka1_kernel
  .amdhsa_next_free_vgpr 512
  .amdhsa_next_free_sgpr 102
  .amdhsa_accum_offset 256
  .amdhsa_group_segment_fixed_size 0
  .amdhsa_kernarg_size 104
  .amdhsa_user_sgpr_count 2
  .amdhsa_user_sgpr_kernarg_segment_ptr 1
  .amdhsa_system_sgpr_workgroup_id_x 1
.end_amdhsa_kernel
.text
.globl kb1_kernel
.p2align 8
.type kb1_kernel,@function
kb1_kernel:
  s_cmp_ge_u32 s2, 256
  s_cbranch_scc1 kb1_exit
  s_load_dwordx2 s[36:37], s[0:1], 0
  s_load_dwordx2 s[38:39], s[0:1], 80
  s_load_dwordx2 s[4:5], s[0:1], 96
  v_lshrrev_b32 v1, 6, v0
  s_nop 0
  v_readfirstlane_b32 s21, v1
  v_and_b32 v1, 63, v0
  v_lshlrev_b32 v2, 4, v1
  s_waitcnt lgkmcnt(0)
  s_mov_b32 s8, s4
  s_and_b32 s9, s5, 0xffff
  s_mov_b32 s10, 0x10000000
  s_mov_b32 s11, 0x20000
  s_mov_b32 s12, s36
  s_and_b32 s13, s37, 0xffff
  s_mov_b32 s14, 0x280000
  s_mov_b32 s15, 0x20000
  s_mov_b32 s16, s38
  s_and_b32 s17, s39, 0xffff
  s_mov_b32 s18, 0x280000
  s_mov_b32 s19, 0x20000
  s_and_b32 s22, s2, 7
  s_lshl_b32 s22, s22, 2
  s_bfe_u32 s23, s2, 0x20003
  s_add_u32 s22, s22, s23
  s_lshr_b32 s23, s2, 5
  s_lshl_b32 s46, s23, 7
  s_add_u32 s46, s46, 0x8000
  s_add_u32 s48, s46, 0x1400
  s_lshl_b32 s47, s22, 7
  s_add_u32 s47, s47, 0x8400
  s_lshr_b32 s26, s2, 2
  s_and_b32 s27, s2, 3
  s_lshl_b32 s27, s27, 3
  v_and_b32 v5, 7, v1
  v_bfe_u32 v6, v1, 3, 1
  v_lshrrev_b32 v7, 4, v1
  v_lshlrev_b32 v8, 5, v6
  v_add_u32 v8, v8, v5
  v_add_u32 v8, s27, v8
  v_lshlrev_b32 v8, 4, v8
  v_lshlrev_b32 v9, 11, v7
  v_add_u32 v9, v9, v8
  v_lshlrev_b32 v10, 10, v7
  v_add_u32 v10, v10, v8
  s_mul_i32 s28, s26, 81920
  s_lshl_b32 s29, s21, 13
  s_add_u32 s28, s28, s29
  s_cmp_lt_u32 s21, 2
  s_cselect_b32 s49, 3, 2
  v_mov_b32 v32, 0
  v_mov_b32 v33, 0
  v_mov_b32 v34, 0
  v_mov_b32 v35, 0
  v_mov_b32 v36, 0
  v_mov_b32 v37, 0
  v_mov_b32 v38, 0
  v_mov_b32 v39, 0
  v_mov_b32 v64, 0
  v_mov_b32 v65, 0
  v_mov_b32 v66, 0
  v_mov_b32 v67, 0
  v_mov_b32 v68, 0
  v_mov_b32 v69, 0
  v_mov_b32 v70, 0
  v_mov_b32 v71, 0
  v_mov_b32 v88, 0
  v_mov_b32 v89, 0
  v_mov_b32 v90, 0
  v_mov_b32 v91, 0
  v_mov_b32 v92, 0
  v_mov_b32 v93, 0
  v_mov_b32 v94, 0
  v_mov_b32 v95, 0
  v_mov_b32 v112, 0
  v_mov_b32 v113, 0
  v_mov_b32 v114, 0
  v_mov_b32 v115, 0
  v_mov_b32 v116, 0
  v_mov_b32 v117, 0
  v_mov_b32 v118, 0
  v_mov_b32 v119, 0
  v_mov_b32 v136, 0
  v_mov_b32 v137, 0
  v_mov_b32 v138, 0
  v_mov_b32 v139, 0
  v_mov_b32 v140, 0
  v_mov_b32 v141, 0
  v_mov_b32 v142, 0
  v_mov_b32 v143, 0
  s_add_u32 s30, s28, 27262976
  buffer_load_dwordx4 v[48:51], v9, s[8:11], s30 offen
  s_add_u32 s30, s28, 27264000
  buffer_load_dwordx4 v[52:55], v9, s[8:11], s30 offen
  s_add_u32 s30, s28, 32505856
  buffer_load_dwordx4 v[72:75], v9, s[8:11], s30 offen
  s_add_u32 s30, s28, 32506880
  buffer_load_dwordx4 v[76:79], v9, s[8:11], s30 offen
  s_add_u32 s30, s28, 37748736
  buffer_load_dwordx4 v[96:99], v9, s[8:11], s30 offen
  s_add_u32 s30, s28, 37749760
  buffer_load_dwordx4 v[100:103], v9, s[8:11], s30 offen
  s_add_u32 s30, s28, 42991616
  buffer_load_dwordx4 v[120:123], v9, s[8:11], s30 offen
  s_add_u32 s30, s28, 42992640
  buffer_load_dwordx4 v[124:127], v9, s[8:11], s30 offen
  s_add_u32 s30, s28, 27295744
  buffer_load_dwordx4 v[56:59], v9, s[8:11], s30 offen
  s_add_u32 s30, s28, 27296768
  buffer_load_dwordx4 v[60:63], v9, s[8:11], s30 offen
  s_add_u32 s30, s28, 32538624
  buffer_load_dwordx4 v[80:83], v9, s[8:11], s30 offen
  s_add_u32 s30, s28, 32539648
  buffer_load_dwordx4 v[84:87], v9, s[8:11], s30 offen
  s_add_u32 s30, s28, 37781504
  buffer_load_dwordx4 v[104:107], v9, s[8:11], s30 offen
  s_add_u32 s30, s28, 37782528
  buffer_load_dwordx4 v[108:111], v9, s[8:11], s30 offen
  s_add_u32 s30, s28, 43024384
  buffer_load_dwordx4 v[128:131], v9, s[8:11], s30 offen
  s_add_u32 s30, s28, 43025408
  buffer_load_dwordx4 v[132:135], v9, s[8:11], s30 offen
  s_cmp_lt_u32 s21, 2
  s_cbranch_scc0 g3_27
  s_add_u32 s30, s28, 27328512
  buffer_load_dwordx4 v[64:67], v9, s[8:11], s30 offen
  s_add_u32 s30, s28, 27329536
  buffer_load_dwordx4 v[68:71], v9, s[8:11], s30 offen
  s_add_u32 s30, s28, 32571392
  buffer_load_dwordx4 v[88:91], v9, s[8:11], s30 offen
  s_add_u32 s30, s28, 32572416
  buffer_load_dwordx4 v[92:95], v9, s[8:11], s30 offen
  s_add_u32 s30, s28, 37814272
  buffer_load_dwordx4 v[112:115], v9, s[8:11], s30 offen
  s_add_u32 s30, s28, 37815296
  buffer_load_dwordx4 v[116:119], v9, s[8:11], s30 offen
  s_add_u32 s30, s28, 43057152
  buffer_load_dwordx4 v[136:139], v9, s[8:11], s30 offen
  s_add_u32 s30, s28, 43058176
  buffer_load_dwordx4 v[140:143], v9, s[8:11], s30 offen
g3_27:
  s_lshl_b32 s30, s26, 5
  s_add_u32 s30, s30, s27
  v_add_u32 v11, s30, v5
  v_mul_u32_u24 v11, 1280, v11
  v_lshlrev_b32 v12, 5, v7
  v_add_u32 v11, v11, v12
  v_lshlrev_b32 v12, 4, v6
  v_add_u32 v11, v11, v12
  s_lshl_b32 s30, s21, 7
  buffer_load_dwordx4 v[144:147], v11, s[12:15], s30 offen offset:0
  buffer_load_dwordx4 v[148:151], v11, s[12:15], s30 offen offset:512
  s_cmp_lt_u32 s21, 2
  s_cbranch_scc0 g3_28
  buffer_load_dwordx4 v[152:155], v11, s[12:15], s30 offen offset:1024
g3_28:
  s_mul_i32 s30, s22, 122880
  s_mul_i32 s31, s21, 30720
  s_add_u32 s30, s30, s31
  s_add_u32 s30, s30, 0xe100000
  s_add_u32 m0, s31, 0
  s_add_u32 s29, s30, 0
  buffer_load_dwordx4 v2, s[8:11], s29 offen lds
  s_add_u32 m0, s31, 1024
  s_add_u32 s29, s30, 1024
  buffer_load_dwordx4 v2, s[8:11], s29 offen lds
  s_add_u32 m0, s31, 2048
  s_add_u32 s29, s30, 2048
  buffer_load_dwordx4 v2, s[8:11], s29 offen lds
  s_add_u32 m0, s31, 3072
  s_add_u32 s29, s30, 3072
  buffer_load_dwordx4 v2, s[8:11], s29 offen lds
  s_add_u32 m0, s31, 4096
  s_add_u32 s29, s30, 4096
  buffer_load_dwordx4 v2, s[8:11], s29 offen lds
  s_add_u32 m0, s31, 5120
  s_add_u32 s29, s30, 5120
  buffer_load_dwordx4 v2, s[8:11], s29 offen lds
  s_add_u32 m0, s31, 6144
  s_add_u32 s29, s30, 6144
  buffer_load_dwordx4 v2, s[8:11], s29 offen lds
  s_add_u32 m0, s31, 7168
  s_add_u32 s29, s30, 7168
  buffer_load_dwordx4 v2, s[8:11], s29 offen lds
  s_add_u32 m0, s31, 8192
  s_add_u32 s29, s30, 8192
  buffer_load_dwordx4 v2, s[8:11], s29 offen lds
  s_add_u32 m0, s31, 9216
  s_add_u32 s29, s30, 9216
  buffer_load_dwordx4 v2, s[8:11], s29 offen lds
  s_add_u32 m0, s31, 10240
  s_add_u32 s29, s30, 10240
  buffer_load_dwordx4 v2, s[8:11], s29 offen lds
  s_add_u32 m0, s31, 11264
  s_add_u32 s29, s30, 11264
  buffer_load_dwordx4 v2, s[8:11], s29 offen lds
  s_add_u32 m0, s31, 12288
  s_add_u32 s29, s30, 12288
  buffer_load_dwordx4 v2, s[8:11], s29 offen lds
  s_add_u32 m0, s31, 13312
  s_add_u32 s29, s30, 13312
  buffer_load_dwordx4 v2, s[8:11], s29 offen lds
  s_add_u32 m0, s31, 14336
  s_add_u32 s29, s30, 14336
  buffer_load_dwordx4 v2, s[8:11], s29 offen lds
  s_add_u32 m0, s31, 15360
  s_add_u32 s29, s30, 15360
  buffer_load_dwordx4 v2, s[8:11], s29 offen lds
  s_add_u32 m0, s31, 16384
  s_add_u32 s29, s30, 16384
  buffer_load_dwordx4 v2, s[8:11], s29 offen lds
  s_add_u32 m0, s31, 17408
  s_add_u32 s29, s30, 17408
  buffer_load_dwordx4 v2, s[8:11], s29 offen lds
  s_add_u32 m0, s31, 18432
  s_add_u32 s29, s30, 18432
  buffer_load_dwordx4 v2, s[8:11], s29 offen lds
  s_add_u32 m0, s31, 19456
  s_add_u32 s29, s30, 19456
  buffer_load_dwordx4 v2, s[8:11], s29 offen lds
  s_add_u32 m0, s31, 20480
  s_add_u32 s29, s30, 20480
  buffer_load_dwordx4 v2, s[8:11], s29 offen lds
  s_add_u32 m0, s31, 21504
  s_add_u32 s29, s30, 21504
  buffer_load_dwordx4 v2, s[8:11], s29 offen lds
  s_add_u32 m0, s31, 22528
  s_add_u32 s29, s30, 22528
  buffer_load_dwordx4 v2, s[8:11], s29 offen lds
  s_add_u32 m0, s31, 23552
  s_add_u32 s29, s30, 23552
  buffer_load_dwordx4 v2, s[8:11], s29 offen lds
  s_add_u32 m0, s31, 24576
  s_add_u32 s29, s30, 24576
  buffer_load_dwordx4 v2, s[8:11], s29 offen lds
  s_add_u32 m0, s31, 25600
  s_add_u32 s29, s30, 25600
  buffer_load_dwordx4 v2, s[8:11], s29 offen lds
  s_add_u32 m0, s31, 26624
  s_add_u32 s29, s30, 26624
  buffer_load_dwordx4 v2, s[8:11], s29 offen lds
  s_add_u32 m0, s31, 27648
  s_add_u32 s29, s30, 27648
  buffer_load_dwordx4 v2, s[8:11], s29 offen lds
  s_add_u32 m0, s31, 28672
  s_add_u32 s29, s30, 28672
  buffer_load_dwordx4 v2, s[8:11], s29 offen lds
  s_add_u32 m0, s31, 29696
  s_add_u32 s29, s30, 29696
  buffer_load_dwordx4 v2, s[8:11], s29 offen lds
  s_waitcnt vmcnt(30)
  v_lshlrev_b32 v16, 16, v144
  v_and_b32 v17, 0xffff0000, v144
  v_lshlrev_b32 v18, 16, v145
  v_and_b32 v19, 0xffff0000, v145
  v_lshlrev_b32 v20, 16, v146
  v_and_b32 v21, 0xffff0000, v146
  v_lshlrev_b32 v22, 16, v147
  v_and_b32 v23, 0xffff0000, v147
  v_lshlrev_b32 v24, 16, v148
  v_and_b32 v25, 0xffff0000, v148
  v_lshlrev_b32 v26, 16, v149
  v_and_b32 v27, 0xffff0000, v149
  v_lshlrev_b32 v28, 16, v150
  v_and_b32 v29, 0xffff0000, v150
  v_lshlrev_b32 v30, 16, v151
  v_and_b32 v31, 0xffff0000, v151
  s_cmp_lt_u32 s21, 2
  s_cbranch_scc0 g3_29
  v_lshlrev_b32 v32, 16, v152
  v_and_b32 v33, 0xffff0000, v152
  v_lshlrev_b32 v34, 16, v153
  v_and_b32 v35, 0xffff0000, v153
  v_lshlrev_b32 v36, 16, v154
  v_and_b32 v37, 0xffff0000, v154
  v_lshlrev_b32 v38, 16, v155
  v_and_b32 v39, 0xffff0000, v155
g3_29:
  v_add_f32 v48, v48, v72
  v_add_f32 v96, v96, v120
  v_add_f32 v49, v49, v73
  v_add_f32 v97, v97, v121
  v_add_f32 v50, v50, v74
  v_add_f32 v98, v98, v122
  v_add_f32 v51, v51, v75
  v_add_f32 v99, v99, v123
  v_add_f32 v52, v52, v76
  v_add_f32 v100, v100, v124
  v_add_f32 v53, v53, v77
  v_add_f32 v101, v101, v125
  v_add_f32 v54, v54, v78
  v_add_f32 v102, v102, v126
  v_add_f32 v55, v55, v79
  v_add_f32 v103, v103, v127
  v_add_f32 v56, v56, v80
  v_add_f32 v104, v104, v128
  v_add_f32 v57, v57, v81
  v_add_f32 v105, v105, v129
  v_add_f32 v58, v58, v82
  v_add_f32 v106, v106, v130
  v_add_f32 v59, v59, v83
  v_add_f32 v107, v107, v131
  v_add_f32 v60, v60, v84
  v_add_f32 v108, v108, v132
  v_add_f32 v61, v61, v85
  v_add_f32 v109, v109, v133
  v_add_f32 v62, v62, v86
  v_add_f32 v110, v110, v134
  v_add_f32 v63, v63, v87
  v_add_f32 v111, v111, v135
  v_add_f32 v64, v64, v88
  v_add_f32 v112, v112, v136
  v_add_f32 v65, v65, v89
  v_add_f32 v113, v113, v137
  v_add_f32 v66, v66, v90
  v_add_f32 v114, v114, v138
  v_add_f32 v67, v67, v91
  v_add_f32 v115, v115, v139
  v_add_f32 v68, v68, v92
  v_add_f32 v116, v116, v140
  v_add_f32 v69, v69, v93
  v_add_f32 v117, v117, v141
  v_add_f32 v70, v70, v94
  v_add_f32 v118, v118, v142
  v_add_f32 v71, v71, v95
  v_add_f32 v119, v119, v143
  v_add_f32 v48, v48, v96
  v_add_f32 v16, v16, v48
  v_add_f32 v49, v49, v97
  v_add_f32 v17, v17, v49
  v_add_f32 v50, v50, v98
  v_add_f32 v18, v18, v50
  v_add_f32 v51, v51, v99
  v_add_f32 v19, v19, v51
  v_add_f32 v52, v52, v100
  v_add_f32 v20, v20, v52
  v_add_f32 v53, v53, v101
  v_add_f32 v21, v21, v53
  v_add_f32 v54, v54, v102
  v_add_f32 v22, v22, v54
  v_add_f32 v55, v55, v103
  v_add_f32 v23, v23, v55
  v_add_f32 v56, v56, v104
  v_add_f32 v24, v24, v56
  v_add_f32 v57, v57, v105
  v_add_f32 v25, v25, v57
  v_add_f32 v58, v58, v106
  v_add_f32 v26, v26, v58
  v_add_f32 v59, v59, v107
  v_add_f32 v27, v27, v59
  v_add_f32 v60, v60, v108
  v_add_f32 v28, v28, v60
  v_add_f32 v61, v61, v109
  v_add_f32 v29, v29, v61
  v_add_f32 v62, v62, v110
  v_add_f32 v30, v30, v62
  v_add_f32 v63, v63, v111
  v_add_f32 v31, v31, v63
  v_add_f32 v64, v64, v112
  v_add_f32 v32, v32, v64
  v_add_f32 v65, v65, v113
  v_add_f32 v33, v33, v65
  v_add_f32 v66, v66, v114
  v_add_f32 v34, v34, v66
  v_add_f32 v67, v67, v115
  v_add_f32 v35, v35, v67
  v_add_f32 v68, v68, v116
  v_add_f32 v36, v36, v68
  v_add_f32 v69, v69, v117
  v_add_f32 v37, v37, v69
  v_add_f32 v70, v70, v118
  v_add_f32 v38, v38, v70
  v_add_f32 v71, v71, v119
  v_add_f32 v39, v39, v71
  s_add_u32 s30, s28, 20971520
  buffer_store_dwordx4 v[16:19], v9, s[8:11], s30 offen sc1
  s_add_u32 s30, s28, 20972544
  buffer_store_dwordx4 v[20:23], v9, s[8:11], s30 offen sc1
  s_add_u32 s30, s28, 21004288
  buffer_store_dwordx4 v[24:27], v9, s[8:11], s30 offen sc1
  s_add_u32 s30, s28, 21005312
  buffer_store_dwordx4 v[28:31], v9, s[8:11], s30 offen sc1
  s_cmp_lt_u32 s21, 2
  s_cbranch_scc0 g3_30
  s_add_u32 s30, s28, 21037056
  buffer_store_dwordx4 v[32:35], v9, s[8:11], s30 offen sc1
  s_add_u32 s30, s28, 21038080
  buffer_store_dwordx4 v[36:39], v9, s[8:11], s30 offen sc1
g3_30:
  v_add_f32 v12, v16, v17
  v_add_f32 v12, v12, v18
  v_add_f32 v12, v12, v19
  v_add_f32 v12, v12, v20
  v_add_f32 v12, v12, v21
  v_add_f32 v12, v12, v22
  v_add_f32 v12, v12, v23
  v_add_f32 v12, v12, v24
  v_add_f32 v12, v12, v25
  v_add_f32 v12, v12, v26
  v_add_f32 v12, v12, v27
  v_add_f32 v12, v12, v28
  v_add_f32 v12, v12, v29
  v_add_f32 v12, v12, v30
  v_add_f32 v12, v12, v31
  v_add_f32 v12, v12, v32
  v_add_f32 v12, v12, v33
  v_add_f32 v12, v12, v34
  v_add_f32 v12, v12, v35
  v_add_f32 v12, v12, v36
  v_add_f32 v12, v12, v37
  v_add_f32 v12, v12, v38
  v_add_f32 v12, v12, v39
  s_nop 1
  v_add_f32_dpp v12, v12, v12 row_ror:8 row_mask:0xf bank_mask:0xf
  v_mov_b32 v13, v12
  s_nop 1
  v_permlane16_swap_b32 v12, v13
  v_add_f32 v12, v12, v13
  v_mov_b32 v13, v12
  s_nop 1
  v_permlane32_swap_b32 v12, v13
  v_add_f32 v12, v12, v13
  v_lshlrev_b32 v14, 2, v5
  v_add_u32 v14, 131072, v14
  s_lshl_b32 s30, s21, 5
  v_add_u32 v15, s30, v14
  ds_write_b32 v15, v12
  s_waitcnt lgkmcnt(0)
  s_barrier
  ds_read_b32 v48, v14
  ds_read_b32 v49, v14 offset:32
  ds_read_b32 v50, v14 offset:64
  ds_read_b32 v51, v14 offset:96
  s_waitcnt lgkmcnt(0)
  v_add_f32 v48, v48, v49
  v_add_f32 v50, v50, v51
  v_add_f32 v48, v48, v50
  v_mul_f32 v48, 0x3acccccd, v48
  v_sub_f32 v56, v16, v48
  v_sub_f32 v57, v17, v48
  v_sub_f32 v58, v18, v48
  v_sub_f32 v59, v19, v48
  v_sub_f32 v60, v20, v48
  v_sub_f32 v61, v21, v48
  v_sub_f32 v62, v22, v48
  v_sub_f32 v63, v23, v48
  v_sub_f32 v64, v24, v48
  v_sub_f32 v65, v25, v48
  v_sub_f32 v66, v26, v48
  v_sub_f32 v67, v27, v48
  v_sub_f32 v68, v28, v48
  v_sub_f32 v69, v29, v48
  v_sub_f32 v70, v30, v48
  v_sub_f32 v71, v31, v48
  v_sub_f32 v72, v32, v48
  v_sub_f32 v73, v33, v48
  v_sub_f32 v74, v34, v48
  v_sub_f32 v75, v35, v48
  v_sub_f32 v76, v36, v48
  v_sub_f32 v77, v37, v48
  v_sub_f32 v78, v38, v48
  v_sub_f32 v79, v39, v48
  s_cmp_lt_u32 s21, 2
  s_cbranch_scc1 g3z_31
  v_mov_b32 v72, 0
  v_mov_b32 v73, 0
  v_mov_b32 v74, 0
  v_mov_b32 v75, 0
  v_mov_b32 v76, 0
  v_mov_b32 v77, 0
  v_mov_b32 v78, 0
  v_mov_b32 v79, 0
g3z_31:
  v_mul_f32 v12, v56, v56
  v_fmac_f32 v12, v57, v57
  v_fmac_f32 v12, v58, v58
  v_fmac_f32 v12, v59, v59
  v_fmac_f32 v12, v60, v60
  v_fmac_f32 v12, v61, v61
  v_fmac_f32 v12, v62, v62
  v_fmac_f32 v12, v63, v63
  v_fmac_f32 v12, v64, v64
  v_fmac_f32 v12, v65, v65
  v_fmac_f32 v12, v66, v66
  v_fmac_f32 v12, v67, v67
  v_fmac_f32 v12, v68, v68
  v_fmac_f32 v12, v69, v69
  v_fmac_f32 v12, v70, v70
  v_fmac_f32 v12, v71, v71
  v_fmac_f32 v12, v72, v72
  v_fmac_f32 v12, v73, v73
  v_fmac_f32 v12, v74, v74
  v_fmac_f32 v12, v75, v75
  v_fmac_f32 v12, v76, v76
  v_fmac_f32 v12, v77, v77
  v_fmac_f32 v12, v78, v78
  v_fmac_f32 v12, v79, v79
  s_nop 1
  v_add_f32_dpp v12, v12, v12 row_ror:8 row_mask:0xf bank_mask:0xf
  v_mov_b32 v13, v12
  s_nop 1
  v_permlane16_swap_b32 v12, v13
  v_add_f32 v12, v12, v13
  v_mov_b32 v13, v12
  s_nop 1
  v_permlane32_swap_b32 v12, v13
  v_add_f32 v12, v12, v13
  v_lshlrev_b32 v14, 2, v5
  v_add_u32 v14, 131328, v14
  s_lshl_b32 s30, s21, 5
  v_add_u32 v15, s30, v14
  ds_write_b32 v15, v12
  s_waitcnt lgkmcnt(0)
  s_barrier
  ds_read_b32 v48, v14
  ds_read_b32 v49, v14 offset:32
  ds_read_b32 v50, v14 offset:64
  ds_read_b32 v51, v14 offset:96
  s_waitcnt lgkmcnt(0)
  v_add_f32 v48, v48, v49
  v_add_f32 v50, v50, v51
  v_add_f32 v48, v48, v50
  v_mov_b32 v49, 0x3727c5ac
  v_fmac_f32 v49, 0x3acccccd, v48
  v_rsq_f32 v49, v49
  s_nop 0
  v_mul_f32 v56, v56, v49
  v_mul_f32 v57, v57, v49
  v_mul_f32 v58, v58, v49
  v_mul_f32 v59, v59, v49
  v_mul_f32 v60, v60, v49
  v_mul_f32 v61, v61, v49
  v_mul_f32 v62, v62, v49
  v_mul_f32 v63, v63, v49
  v_mul_f32 v64, v64, v49
  v_mul_f32 v65, v65, v49
  v_mul_f32 v66, v66, v49
  v_mul_f32 v67, v67, v49
  v_mul_f32 v68, v68, v49
  v_mul_f32 v69, v69, v49
  v_mul_f32 v70, v70, v49
  v_mul_f32 v71, v71, v49
  v_mul_f32 v72, v72, v49
  v_mul_f32 v73, v73, v49
  v_mul_f32 v74, v74, v49
  v_mul_f32 v75, v75, v49
  v_mul_f32 v76, v76, v49
  v_mul_f32 v77, v77, v49
  v_mul_f32 v78, v78, v49
  v_mul_f32 v79, v79, v49
  v_cvt_pk_bf16_f32 v80, v56, v57
  v_cvt_pk_bf16_f32 v81, v58, v59
  v_cvt_pk_bf16_f32 v82, v60, v61
  v_cvt_pk_bf16_f32 v83, v62, v63
  v_cvt_pk_bf16_f32 v84, v64, v65
  v_cvt_pk_bf16_f32 v85, v66, v67
  v_cvt_pk_bf16_f32 v86, v68, v69
  v_cvt_pk_bf16_f32 v87, v70, v71
  v_cvt_pk_bf16_f32 v88, v72, v73
  v_cvt_pk_bf16_f32 v89, v74, v75
  v_cvt_pk_bf16_f32 v90, v76, v77
  v_cvt_pk_bf16_f32 v91, v78, v79
  s_mul_i32 s30, s26, 40960
  s_lshl_b32 s31, s21, 12
  s_add_u32 s30, s30, s31
  s_add_u32 s30, s30, 0x100000
  s_add_u32 s31, s30, 0
  buffer_store_dwordx4 v[80:83], v10, s[8:11], s31 offen sc1
  s_add_u32 s31, s30, 16384
  buffer_store_dwordx4 v[84:87], v10, s[8:11], s31 offen sc1
  s_cmp_lt_u32 s21, 2
  s_cbranch_scc0 g3_32
  s_add_u32 s31, s30, 32768
  buffer_store_dwordx4 v[88:91], v10, s[8:11], s31 offen sc1
g3_32:
  s_waitcnt vmcnt(0)
  s_barrier
  s_cmp_eq_u32 s21, 0
  s_cbranch_scc0 arr_33
  s_mov_b64 s[24:25], exec
  s_mov_b64 exec, 1
  v_mov_b32 v3, 0
  v_mov_b32 v4, 1
  buffer_atomic_add v4, v3, s[8:11], s46 offen
  s_mov_b64 exec, s[24:25]
arr_33:
  s_mov_b32 s45, 0
  v_mov_b32 v3, 0
aw_34:
  buffer_load_dword v4, v3, s[8:11], s46 offen sc1
  s_add_u32 s45, s45, 1
  s_waitcnt vmcnt(0)
  v_readfirstlane_b32 s29, v4
  s_cmp_ge_u32 s29, 32
  s_cbranch_scc1 aw_34_ok
  s_cmp_lt_u32 s45, 400000
  s_cbranch_scc1 aw_34
  s_branch kb1_abort
aw_34_ok:
  s_barrier
  s_lshl_b32 s26, s23, 3
  s_lshl_b32 s27, s21, 1
  s_add_u32 s24, s26, s27
  s_mul_i32 s27, s24, 40960
  s_add_u32 s27, s27, 0x100000
  s_add_u32 s28, s27, 40960
  v_mov_b32 v3, v2
  v_add_u32 v4, 65536, v2
  v_lshlrev_b32 v5, 7, v1
  s_add_u32 s29, s27, 0
  buffer_load_dword v6, v5, s[8:11], s29 offen sc1
  s_add_u32 s29, s27, 8192
  buffer_load_dword v6, v5, s[8:11], s29 offen sc1
  s_add_u32 s29, s27, 16384
  buffer_load_dword v6, v5, s[8:11], s29 offen sc1
  s_add_u32 s29, s27, 24576
  buffer_load_dword v6, v5, s[8:11], s29 offen sc1
  s_add_u32 s29, s27, 32768
  buffer_load_dword v6, v5, s[8:11], s29 offen sc1
  s_add_u32 s29, s27, 40960
  buffer_load_dword v6, v5, s[8:11], s29 offen sc1
  s_add_u32 s29, s27, 49152
  buffer_load_dword v6, v5, s[8:11], s29 offen sc1
  s_add_u32 s29, s27, 57344
  buffer_load_dword v6, v5, s[8:11], s29 offen sc1
  s_add_u32 s29, s27, 65536
  buffer_load_dword v6, v5, s[8:11], s29 offen sc1
  s_add_u32 s29, s27, 73728
  buffer_load_dword v6, v5, s[8:11], s29 offen sc1
  s_add_u32 s29, s27, 0
  buffer_load_dwordx4 v[16:19], v2, s[8:11], s29 offen sc1
  s_add_u32 s29, s28, 0
  buffer_load_dwordx4 v[20:23], v2, s[8:11], s29 offen sc1
  s_add_u32 s29, s27, 1024
  buffer_load_dwordx4 v[24:27], v2, s[8:11], s29 offen sc1
  s_add_u32 s29, s28, 1024
  buffer_load_dwordx4 v[28:31], v2, s[8:11], s29 offen sc1
  s_add_u32 s29, s27, 2048
  buffer_load_dwordx4 v[32:35], v2, s[8:11], s29 offen sc1
  s_add_u32 s29, s28, 2048
  buffer_load_dwordx4 v[36:39], v2, s[8:11], s29 offen sc1
  s_add_u32 s29, s27, 3072
  buffer_load_dwordx4 v[40:43], v2, s[8:11], s29 offen sc1
  s_add_u32 s29, s28, 3072
  buffer_load_dwordx4 v[44:47], v2, s[8:11], s29 offen sc1
  s_add_u32 s29, s27, 4096
  buffer_load_dwordx4 v[48:51], v2, s[8:11], s29 offen sc1
  s_add_u32 s29, s28, 4096
  buffer_load_dwordx4 v[52:55], v2, s[8:11], s29 offen sc1
  s_add_u32 s29, s27, 5120
  buffer_load_dwordx4 v[56:59], v2, s[8:11], s29 offen sc1
  s_add_u32 s29, s28, 5120
  buffer_load_dwordx4 v[60:63], v2, s[8:11], s29 offen sc1
  s_add_u32 s29, s27, 6144
  buffer_load_dwordx4 v[64:67], v2, s[8:11], s29 offen sc1
  s_add_u32 s29, s28, 6144
  buffer_load_dwordx4 v[68:71], v2, s[8:11], s29 offen sc1
  ds_read_b128 v[208:211], v3 offset:0
  ds_read_b128 v[212:215], v3 offset:40960
  ds_read_b128 v[216:219], v4 offset:16384
  s_add_u32 s29, s27, 7168
  buffer_load_dwordx4 v[72:75], v2, s[8:11], s29 offen sc1
  s_add_u32 s29, s28, 7168
  buffer_load_dwordx4 v[76:79], v2, s[8:11], s29 offen sc1
  ds_read_b128 v[220:223], v3 offset:1024
  ds_read_b128 v[224:227], v3 offset:41984
  ds_read_b128 v[228:231], v4 offset:17408
  s_waitcnt lgkmcnt(3)
  s_waitcnt vmcnt(14)
  v_mfma_f32_32x32x16_bf16 v[80:95], v[208:211], v[16:19], 0
  v_mfma_f32_32x32x16_bf16 v[96:111], v[212:215], v[16:19], 0
  v_mfma_f32_32x32x16_bf16 v[112:127], v[16:19], v[216:219], 0
  v_mfma_f32_32x32x16_bf16 v[128:143], v[208:211], v[20:23], 0
  v_mfma_f32_32x32x16_bf16 v[144:159], v[212:215], v[20:23], 0
  v_mfma_f32_32x32x16_bf16 v[160:175], v[20:23], v[216:219], 0
  s_add_u32 s29, s27, 8192
  buffer_load_dwordx4 v[16:19], v2, s[8:11], s29 offen sc1
  s_add_u32 s29, s28, 8192
  buffer_load_dwordx4 v[20:23], v2, s[8:11], s29 offen sc1
  ds_read_b128 v[208:211], v3 offset:2048
  ds_read_b128 v[212:215], v3 offset:43008
  ds_read_b128 v[216:219], v4 offset:18432
  s_waitcnt lgkmcnt(3)
  s_waitcnt vmcnt(14)
  v_mfma_f32_32x32x16_bf16 v[80:95], v[220:223], v[24:27], v[80:95]
  v_mfma_f32_32x32x16_bf16 v[96:111], v[224:227], v[24:27], v[96:111]
  v_mfma_f32_32x32x16_bf16 v[112:127], v[24:27], v[228:231], v[112:127]
  v_mfma_f32_32x32x16_bf16 v[128:143], v[220:223], v[28:31], v[128:143]
  v_mfma_f32_32x32x16_bf16 v[144:159], v[224:227], v[28:31], v[144:159]
  v_mfma_f32_32x32x16_bf16 v[160:175], v[28:31], v[228:231], v[160:175]
  s_add_u32 s29, s27, 9216
  buffer_load_dwordx4 v[24:27], v2, s[8:11], s29 offen sc1
  s_add_u32 s29, s28, 9216
  buffer_load_dwordx4 v[28:31], v2, s[8:11], s29 offen sc1
  ds_read_b128 v[220:223], v3 offset:3072
  ds_read_b128 v[224:227], v3 offset:44032
  ds_read_b128 v[228:231], v4 offset:19456
  s_waitcnt lgkmcnt(3)
  s_waitcnt vmcnt(14)
  v_mfma_f32_32x32x16_bf16 v[80:95], v[208:211], v[32:35], v[80:95]
  v_mfma_f32_32x32x16_bf16 v[96:111], v[212:215], v[32:35], v[96:111]
  v_mfma_f32_32x32x16_bf16 v[112:127], v[32:35], v[216:219], v[112:127]
  v_mfma_f32_32x32x16_bf16 v[128:143], v[208:211], v[36:39], v[128:143]
  v_mfma_f32_32x32x16_bf16 v[144:159], v[212:215], v[36:39], v[144:159]
  v_mfma_f32_32x32x16_bf16 v[160:175], v[36:39], v[216:219], v[160:175]
  s_add_u32 s29, s27, 10240
  buffer_load_dwordx4 v[32:35], v2, s[8:11], s29 offen sc1
  s_add_u32 s29, s28, 10240
  buffer_load_dwordx4 v[36:39], v2, s[8:11], s29 offen sc1
  ds_read_b128 v[208:211], v3 offset:4096
  ds_read_b128 v[212:215], v3 offset:45056
  ds_read_b128 v[216:219], v4 offset:20480
  s_waitcnt lgkmcnt(3)
  s_waitcnt vmcnt(14)
  v_mfma_f32_32x32x16_bf16 v[80:95], v[220:223], v[40:43], v[80:95]
  v_mfma_f32_32x32x16_bf16 v[96:111], v[224:227], v[40:43], v[96:111]
  v_mfma_f32_32x32x16_bf16 v[112:127], v[40:43], v[228:231], v[112:127]
  v_mfma_f32_32x32x16_bf16 v[128:143], v[220:223], v[44:47], v[128:143]
  v_mfma_f32_32x32x16_bf16 v[144:159], v[224:227], v[44:47], v[144:159]
  v_mfma_f32_32x32x16_bf16 v[160:175], v[44:47], v[228:231], v[160:175]
  s_add_u32 s29, s27, 11264
  buffer_load_dwordx4 v[40:43], v2, s[8:11], s29 offen sc1
  s_add_u32 s29, s28, 11264
  buffer_load_dwordx4 v[44:47], v2, s[8:11], s29 offen sc1
  ds_read_b128 v[220:223], v3 offset:5120
  ds_read_b128 v[224:227], v3 offset:46080
  ds_read_b128 v[228:231], v4 offset:21504
  s_waitcnt lgkmcnt(3)
  s_waitcnt vmcnt(14)
  v_mfma_f32_32x32x16_bf16 v[80:95], v[208:211], v[48:51], v[80:95]
  v_mfma_f32_32x32x16_bf16 v[96:111], v[212:215], v[48:51], v[96:111]
  v_mfma_f32_32x32x16_bf16 v[112:127], v[48:51], v[216:219], v[112:127]
  v_mfma_f32_32x32x16_bf16 v[128:143], v[208:211], v[52:55], v[128:143]
  v_mfma_f32_32x32x16_bf16 v[144:159], v[212:215], v[52:55], v[144:159]
  v_mfma_f32_32x32x16_bf16 v[160:175], v[52:55], v[216:219], v[160:175]
  s_add_u32 s29, s27, 12288
  buffer_load_dwordx4 v[48:51], v2, s[8:11], s29 offen sc1
  s_add_u32 s29, s28, 12288
  buffer_load_dwordx4 v[52:55], v2, s[8:11], s29 offen sc1
  ds_read_b128 v[208:211], v3 offset:6144
  ds_read_b128 v[212:215], v3 offset:47104
  ds_read_b128 v[216:219], v4 offset:22528
  s_waitcnt lgkmcnt(3)
  s_waitcnt vmcnt(14)
  v_mfma_f32_32x32x16_bf16 v[80:95], v[220:223], v[56:59], v[80:95]
  v_mfma_f32_32x32x16_bf16 v[96:111], v[224:227], v[56:59], v[96:111]
  v_mfma_f32_32x32x16_bf16 v[112:127], v[56:59], v[228:231], v[112:127]
  v_mfma_f32_32x32x16_bf16 v[128:143], v[220:223], v[60:63], v[128:143]
  v_mfma_f32_32x32x16_bf16 v[144:159], v[224:227], v[60:63], v[144:159]
  v_mfma_f32_32x32x16_bf16 v[160:175], v[60:63], v[228:231], v[160:175]
  s_add_u32 s29, s27, 13312
  buffer_load_dwordx4 v[56:59], v2, s[8:11], s29 offen sc1
  s_add_u32 s29, s28, 13312
  buffer_load_dwordx4 v[60:63], v2, s[8:11], s29 offen sc1
  ds_read_b128 v[220:223], v3 offset:7168
  ds_read_b128 v[224:227], v3 offset:48128
  ds_read_b128 v[228:231], v4 offset:23552
  s_waitcnt lgkmcnt(3)
  s_waitcnt vmcnt(14)
  v_mfma_f32_32x32x16_bf16 v[80:95], v[208:211], v[64:67], v[80:95]
  v_mfma_f32_32x32x16_bf16 v[96:111], v[212:215], v[64:67], v[96:111]
  v_mfma_f32_32x32x16_bf16 v[112:127], v[64:67], v[216:219], v[112:127]
  v_mfma_f32_32x32x16_bf16 v[128:143], v[208:211], v[68:71], v[128:143]
  v_mfma_f32_32x32x16_bf16 v[144:159], v[212:215], v[68:71], v[144:159]
  v_mfma_f32_32x32x16_bf16 v[160:175], v[68:71], v[216:219], v[160:175]
  s_add_u32 s29, s27, 14336
  buffer_load_dwordx4 v[64:67], v2, s[8:11], s29 offen sc1
  s_add_u32 s29, s28, 14336
  buffer_load_dwordx4 v[68:71], v2, s[8:11], s29 offen sc1
  ds_read_b128 v[208:211], v3 offset:8192
  ds_read_b128 v[212:215], v3 offset:49152
  ds_read_b128 v[216:219], v4 offset:24576
  s_waitcnt lgkmcnt(3)
  s_waitcnt vmcnt(14)
  v_mfma_f32_32x32x16_bf16 v[80:95], v[220:223], v[72:75], v[80:95]
  v_mfma_f32_32x32x16_bf16 v[96:111], v[224:227], v[72:75], v[96:111]
  v_mfma_f32_32x32x16_bf16 v[112:127], v[72:75], v[228:231], v[112:127]
  v_mfma_f32_32x32x16_bf16 v[128:143], v[220:223], v[76:79], v[128:143]
  v_mfma_f32_32x32x16_bf16 v[144:159], v[224:227], v[76:79], v[144:159]
  v_mfma_f32_32x32x16_bf16 v[160:175], v[76:79], v[228:231], v[160:175]
  s_add_u32 s29, s27, 15360
  buffer_load_dwordx4 v[72:75], v2, s[8:11], s29 offen sc1
  s_add_u32 s29, s28, 15360
  buffer_load_dwordx4 v[76:79], v2, s[8:11], s29 offen sc1
  ds_read_b128 v[220:223], v3 offset:9216
  ds_read_b128 v[224:227], v3 offset:50176
  ds_read_b128 v[228:231], v4 offset:25600
  s_waitcnt lgkmcnt(3)
  s_waitcnt vmcnt(14)
  v_mfma_f32_32x32x16_bf16 v[80:95], v[208:211], v[16:19], v[80:95]
  v_mfma_f32_32x32x16_bf16 v[96:111], v[212:215], v[16:19], v[96:111]
  v_mfma_f32_32x32x16_bf16 v[112:127], v[16:19], v[216:219], v[112:127]
  v_mfma_f32_32x32x16_bf16 v[128:143], v[208:211], v[20:23], v[128:143]
  v_mfma_f32_32x32x16_bf16 v[144:159], v[212:215], v[20:23], v[144:159]
  v_mfma_f32_32x32x16_bf16 v[160:175], v[20:23], v[216:219], v[160:175]
  s_add_u32 s29, s27, 16384
  buffer_load_dwordx4 v[16:19], v2, s[8:11], s29 offen sc1
  s_add_u32 s29, s28, 16384
  buffer_load_dwordx4 v[20:23], v2, s[8:11], s29 offen sc1
  ds_read_b128 v[208:211], v3 offset:10240
  ds_read_b128 v[212:215], v3 offset:51200
  ds_read_b128 v[216:219], v4 offset:26624
  s_waitcnt lgkmcnt(3)
  s_waitcnt vmcnt(14)
  v_mfma_f32_32x32x16_bf16 v[80:95], v[220:223], v[24:27], v[80:95]
  v_mfma_f32_32x32x16_bf16 v[96:111], v[224:227], v[24:27], v[96:111]
  v_mfma_f32_32x32x16_bf16 v[112:127], v[24:27], v[228:231], v[112:127]
  v_mfma_f32_32x32x16_bf16 v[128:143], v[220:223], v[28:31], v[128:143]
  v_mfma_f32_32x32x16_bf16 v[144:159], v[224:227], v[28:31], v[144:159]
  v_mfma_f32_32x32x16_bf16 v[160:175], v[28:31], v[228:231], v[160:175]
  s_add_u32 s29, s27, 17408
  buffer_load_dwordx4 v[24:27], v2, s[8:11], s29 offen sc1
  s_add_u32 s29, s28, 17408
  buffer_load_dwordx4 v[28:31], v2, s[8:11], s29 offen sc1
  ds_read_b128 v[220:223], v3 offset:11264
  ds_read_b128 v[224:227], v3 offset:52224
  ds_read_b128 v[228:231], v4 offset:27648
  s_waitcnt lgkmcnt(3)
  s_waitcnt vmcnt(14)
  v_mfma_f32_32x32x16_bf16 v[80:95], v[208:211], v[32:35], v[80:95]
  v_mfma_f32_32x32x16_bf16 v[96:111], v[212:215], v[32:35], v[96:111]
  v_mfma_f32_32x32x16_bf16 v[112:127], v[32:35], v[216:219], v[112:127]
  v_mfma_f32_32x32x16_bf16 v[128:143], v[208:211], v[36:39], v[128:143]
  v_mfma_f32_32x32x16_bf16 v[144:159], v[212:215], v[36:39], v[144:159]
  v_mfma_f32_32x32x16_bf16 v[160:175], v[36:39], v[216:219], v[160:175]
  s_add_u32 s29, s27, 18432
  buffer_load_dwordx4 v[32:35], v2, s[8:11], s29 offen sc1
  s_add_u32 s29, s28, 18432
  buffer_load_dwordx4 v[36:39], v2, s[8:11], s29 offen sc1
  ds_read_b128 v[208:211], v3 offset:12288
  ds_read_b128 v[212:215], v3 offset:53248
  ds_read_b128 v[216:219], v4 offset:28672
  s_waitcnt lgkmcnt(3)
  s_waitcnt vmcnt(14)
  v_mfma_f32_32x32x16_bf16 v[80:95], v[220:223], v[40:43], v[80:95]
  v_mfma_f32_32x32x16_bf16 v[96:111], v[224:227], v[40:43], v[96:111]
  v_mfma_f32_32x32x16_bf16 v[112:127], v[40:43], v[228:231], v[112:127]
  v_mfma_f32_32x32x16_bf16 v[128:143], v[220:223], v[44:47], v[128:143]
  v_mfma_f32_32x32x16_bf16 v[144:159], v[224:227], v[44:47], v[144:159]
  v_mfma_f32_32x32x16_bf16 v[160:175], v[44:47], v[228:231], v[160:175]
  s_add_u32 s29, s27, 19456
  buffer_load_dwordx4 v[40:43], v2, s[8:11], s29 offen sc1
  s_add_u32 s29, s28, 19456
  buffer_load_dwordx4 v[44:47], v2, s[8:11], s29 offen sc1
  ds_read_b128 v[220:223], v3 offset:13312
  ds_read_b128 v[224:227], v3 offset:54272
  ds_read_b128 v[228:231], v4 offset:29696
  s_waitcnt lgkmcnt(3)
  s_waitcnt vmcnt(14)
  v_mfma_f32_32x32x16_bf16 v[80:95], v[208:211], v[48:51], v[80:95]
  v_mfma_f32_32x32x16_bf16 v[96:111], v[212:215], v[48:51], v[96:111]
  v_mfma_f32_32x32x16_bf16 v[112:127], v[48:51], v[216:219], v[112:127]
  v_mfma_f32_32x32x16_bf16 v[128:143], v[208:211], v[52:55], v[128:143]
  v_mfma_f32_32x32x16_bf16 v[144:159], v[212:215], v[52:55], v[144:159]
  v_mfma_f32_32x32x16_bf16 v[160:175], v[52:55], v[216:219], v[160:175]
  s_add_u32 s29, s27, 20480
  buffer_load_dwordx4 v[48:51], v2, s[8:11], s29 offen sc1
  s_add_u32 s29, s28, 20480
  buffer_load_dwordx4 v[52:55], v2, s[8:11], s29 offen sc1
  ds_read_b128 v[208:211], v3 offset:14336
  ds_read_b128 v[212:215], v3 offset:55296
  ds_read_b128 v[216:219], v4 offset:30720
  s_waitcnt lgkmcnt(3)
  s_waitcnt vmcnt(14)
  v_mfma_f32_32x32x16_bf16 v[80:95], v[220:223], v[56:59], v[80:95]
  v_mfma_f32_32x32x16_bf16 v[96:111], v[224:227], v[56:59], v[96:111]
  v_mfma_f32_32x32x16_bf16 v[112:127], v[56:59], v[228:231], v[112:127]
  v_mfma_f32_32x32x16_bf16 v[128:143], v[220:223], v[60:63], v[128:143]
  v_mfma_f32_32x32x16_bf16 v[144:159], v[224:227], v[60:63], v[144:159]
  v_mfma_f32_32x32x16_bf16 v[160:175], v[60:63], v[228:231], v[160:175]
  s_add_u32 s29, s27, 21504
  buffer_load_dwordx4 v[56:59], v2, s[8:11], s29 offen sc1
  s_add_u32 s29, s28, 21504
  buffer_load_dwordx4 v[60:63], v2, s[8:11], s29 offen sc1
  ds_read_b128 v[220:223], v3 offset:15360
  ds_read_b128 v[224:227], v3 offset:56320
  ds_read_b128 v[228:231], v4 offset:31744
  s_waitcnt lgkmcnt(3)
  s_waitcnt vmcnt(14)
  v_mfma_f32_32x32x16_bf16 v[80:95], v[208:211], v[64:67], v[80:95]
  v_mfma_f32_32x32x16_bf16 v[96:111], v[212:215], v[64:67], v[96:111]
  v_mfma_f32_32x32x16_bf16 v[112:127], v[64:67], v[216:219], v[112:127]
  v_mfma_f32_32x32x16_bf16 v[128:143], v[208:211], v[68:71], v[128:143]
  v_mfma_f32_32x32x16_bf16 v[144:159], v[212:215], v[68:71], v[144:159]
  v_mfma_f32_32x32x16_bf16 v[160:175], v[68:71], v[216:219], v[160:175]
  s_add_u32 s29, s27, 22528
  buffer_load_dwordx4 v[64:67], v2, s[8:11], s29 offen sc1
  s_add_u32 s29, s28, 22528
  buffer_load_dwordx4 v[68:71], v2, s[8:11], s29 offen sc1
  ds_read_b128 v[208:211], v3 offset:16384
  ds_read_b128 v[212:215], v3 offset:57344
  ds_read_b128 v[216:219], v4 offset:32768
  s_waitcnt lgkmcnt(3)
  s_waitcnt vmcnt(14)
  v_mfma_f32_32x32x16_bf16 v[80:95], v[220:223], v[72:75], v[80:95]
  v_mfma_f32_32x32x16_bf16 v[96:111], v[224:227], v[72:75], v[96:111]
  v_mfma_f32_32x32x16_bf16 v[112:127], v[72:75], v[228:231], v[112:127]
  v_mfma_f32_32x32x16_bf16 v[128:143], v[220:223], v[76:79], v[128:143]
  v_mfma_f32_32x32x16_bf16 v[144:159], v[224:227], v[76:79], v[144:159]
  v_mfma_f32_32x32x16_bf16 v[160:175], v[76:79], v[228:231], v[160:175]
  s_add_u32 s29, s27, 23552
  buffer_load_dwordx4 v[72:75], v2, s[8:11], s29 offen sc1
  s_add_u32 s29, s28, 23552
  buffer_load_dwordx4 v[76:79], v2, s[8:11], s29 offen sc1
  ds_read_b128 v[220:223], v3 offset:17408
  ds_read_b128 v[224:227], v3 offset:58368
  ds_read_b128 v[228:231], v4 offset:33792
  s_waitcnt lgkmcnt(3)
  s_waitcnt vmcnt(14)
  v_mfma_f32_32x32x16_bf16 v[80:95], v[208:211], v[16:19], v[80:95]
  v_mfma_f32_32x32x16_bf16 v[96:111], v[212:215], v[16:19], v[96:111]
  v_mfma_f32_32x32x16_bf16 v[112:127], v[16:19], v[216:219], v[112:127]
  v_mfma_f32_32x32x16_bf16 v[128:143], v[208:211], v[20:23], v[128:143]
  v_mfma_f32_32x32x16_bf16 v[144:159], v[212:215], v[20:23], v[144:159]
  v_mfma_f32_32x32x16_bf16 v[160:175], v[20:23], v[216:219], v[160:175]
  s_add_u32 s29, s27, 24576
  buffer_load_dwordx4 v[16:19], v2, s[8:11], s29 offen sc1
  s_add_u32 s29, s28, 24576
  buffer_load_dwordx4 v[20:23], v2, s[8:11], s29 offen sc1
  ds_read_b128 v[208:211], v3 offset:18432
  ds_read_b128 v[212:215], v3 offset:59392
  ds_read_b128 v[216:219], v4 offset:34816
  s_waitcnt lgkmcnt(3)
  s_waitcnt vmcnt(14)
  v_mfma_f32_32x32x16_bf16 v[80:95], v[220:223], v[24:27], v[80:95]
  v_mfma_f32_32x32x16_bf16 v[96:111], v[224:227], v[24:27], v[96:111]
  v_mfma_f32_32x32x16_bf16 v[112:127], v[24:27], v[228:231], v[112:127]
  v_mfma_f32_32x32x16_bf16 v[128:143], v[220:223], v[28:31], v[128:143]
  v_mfma_f32_32x32x16_bf16 v[144:159], v[224:227], v[28:31], v[144:159]
  v_mfma_f32_32x32x16_bf16 v[160:175], v[28:31], v[228:231], v[160:175]
  s_add_u32 s29, s27, 25600
  buffer_load_dwordx4 v[24:27], v2, s[8:11], s29 offen sc1
  s_add_u32 s29, s28, 25600
  buffer_load_dwordx4 v[28:31], v2, s[8:11], s29 offen sc1
  ds_read_b128 v[220:223], v3 offset:19456
  ds_read_b128 v[224:227], v3 offset:60416
  ds_read_b128 v[228:231], v4 offset:35840
  s_waitcnt lgkmcnt(3)
  s_waitcnt vmcnt(14)
  v_mfma_f32_32x32x16_bf16 v[80:95], v[208:211], v[32:35], v[80:95]
  v_mfma_f32_32x32x16_bf16 v[96:111], v[212:215], v[32:35], v[96:111]
  v_mfma_f32_32x32x16_bf16 v[112:127], v[32:35], v[216:219], v[112:127]
  v_mfma_f32_32x32x16_bf16 v[128:143], v[208:211], v[36:39], v[128:143]
  v_mfma_f32_32x32x16_bf16 v[144:159], v[212:215], v[36:39], v[144:159]
  v_mfma_f32_32x32x16_bf16 v[160:175], v[36:39], v[216:219], v[160:175]
  s_add_u32 s29, s27, 26624
  buffer_load_dwordx4 v[32:35], v2, s[8:11], s29 offen sc1
  s_add_u32 s29, s28, 26624
  buffer_load_dwordx4 v[36:39], v2, s[8:11], s29 offen sc1
  ds_read_b128 v[208:211], v3 offset:20480
  ds_read_b128 v[212:215], v3 offset:61440
  ds_read_b128 v[216:219], v4 offset:36864
  s_waitcnt lgkmcnt(3)
  s_waitcnt vmcnt(14)
  v_mfma_f32_32x32x16_bf16 v[80:95], v[220:223], v[40:43], v[80:95]
  v_mfma_f32_32x32x16_bf16 v[96:111], v[224:227], v[40:43], v[96:111]
  v_mfma_f32_32x32x16_bf16 v[112:127], v[40:43], v[228:231], v[112:127]
  v_mfma_f32_32x32x16_bf16 v[128:143], v[220:223], v[44:47], v[128:143]
  v_mfma_f32_32x32x16_bf16 v[144:159], v[224:227], v[44:47], v[144:159]
  v_mfma_f32_32x32x16_bf16 v[160:175], v[44:47], v[228:231], v[160:175]
  s_add_u32 s29, s27, 27648
  buffer_load_dwordx4 v[40:43], v2, s[8:11], s29 offen sc1
  s_add_u32 s29, s28, 27648
  buffer_load_dwordx4 v[44:47], v2, s[8:11], s29 offen sc1
  ds_read_b128 v[220:223], v3 offset:21504
  ds_read_b128 v[224:227], v3 offset:62464
  ds_read_b128 v[228:231], v4 offset:37888
  s_waitcnt lgkmcnt(3)
  s_waitcnt vmcnt(14)
  v_mfma_f32_32x32x16_bf16 v[80:95], v[208:211], v[48:51], v[80:95]
  v_mfma_f32_32x32x16_bf16 v[96:111], v[212:215], v[48:51], v[96:111]
  v_mfma_f32_32x32x16_bf16 v[112:127], v[48:51], v[216:219], v[112:127]
  v_mfma_f32_32x32x16_bf16 v[128:143], v[208:211], v[52:55], v[128:143]
  v_mfma_f32_32x32x16_bf16 v[144:159], v[212:215], v[52:55], v[144:159]
  v_mfma_f32_32x32x16_bf16 v[160:175], v[52:55], v[216:219], v[160:175]
  s_add_u32 s29, s27, 28672
  buffer_load_dwordx4 v[48:51], v2, s[8:11], s29 offen sc1
  s_add_u32 s29, s28, 28672
  buffer_load_dwordx4 v[52:55], v2, s[8:11], s29 offen sc1
  ds_read_b128 v[208:211], v3 offset:22528
  ds_read_b128 v[212:215], v3 offset:63488
  ds_read_b128 v[216:219], v4 offset:38912
  s_waitcnt lgkmcnt(3)
  s_waitcnt vmcnt(14)
  v_mfma_f32_32x32x16_bf16 v[80:95], v[220:223], v[56:59], v[80:95]
  v_mfma_f32_32x32x16_bf16 v[96:111], v[224:227], v[56:59], v[96:111]
  v_mfma_f32_32x32x16_bf16 v[112:127], v[56:59], v[228:231], v[112:127]
  v_mfma_f32_32x32x16_bf16 v[128:143], v[220:223], v[60:63], v[128:143]
  v_mfma_f32_32x32x16_bf16 v[144:159], v[224:227], v[60:63], v[144:159]
  v_mfma_f32_32x32x16_bf16 v[160:175], v[60:63], v[228:231], v[160:175]
  s_add_u32 s29, s27, 29696
  buffer_load_dwordx4 v[56:59], v2, s[8:11], s29 offen sc1
  s_add_u32 s29, s28, 29696
  buffer_load_dwordx4 v[60:63], v2, s[8:11], s29 offen sc1
  ds_read_b128 v[220:223], v3 offset:23552
  ds_read_b128 v[224:227], v3 offset:64512
  ds_read_b128 v[228:231], v4 offset:39936
  s_waitcnt lgkmcnt(3)
  s_waitcnt vmcnt(14)
  v_mfma_f32_32x32x16_bf16 v[80:95], v[208:211], v[64:67], v[80:95]
  v_mfma_f32_32x32x16_bf16 v[96:111], v[212:215], v[64:67], v[96:111]
  v_mfma_f32_32x32x16_bf16 v[112:127], v[64:67], v[216:219], v[112:127]
  v_mfma_f32_32x32x16_bf16 v[128:143], v[208:211], v[68:71], v[128:143]
  v_mfma_f32_32x32x16_bf16 v[144:159], v[212:215], v[68:71], v[144:159]
  v_mfma_f32_32x32x16_bf16 v[160:175], v[68:71], v[216:219], v[160:175]
  s_add_u32 s29, s27, 30720
  buffer_load_dwordx4 v[64:67], v2, s[8:11], s29 offen sc1
  s_add_u32 s29, s28, 30720
  buffer_load_dwordx4 v[68:71], v2, s[8:11], s29 offen sc1
  ds_read_b128 v[208:211], v3 offset:24576
  ds_read_b128 v[212:215], v4 offset:0
  ds_read_b128 v[216:219], v4 offset:40960
  s_waitcnt lgkmcnt(3)
  s_waitcnt vmcnt(14)
  v_mfma_f32_32x32x16_bf16 v[80:95], v[220:223], v[72:75], v[80:95]
  v_mfma_f32_32x32x16_bf16 v[96:111], v[224:227], v[72:75], v[96:111]
  v_mfma_f32_32x32x16_bf16 v[112:127], v[72:75], v[228:231], v[112:127]
  v_mfma_f32_32x32x16_bf16 v[128:143], v[220:223], v[76:79], v[128:143]
  v_mfma_f32_32x32x16_bf16 v[144:159], v[224:227], v[76:79], v[144:159]
  v_mfma_f32_32x32x16_bf16 v[160:175], v[76:79], v[228:231], v[160:175]
  s_add_u32 s29, s27, 31744
  buffer_load_dwordx4 v[72:75], v2, s[8:11], s29 offen sc1
  s_add_u32 s29, s28, 31744
  buffer_load_dwordx4 v[76:79], v2, s[8:11], s29 offen sc1
  ds_read_b128 v[220:223], v3 offset:25600
  ds_read_b128 v[224:227], v4 offset:1024
  ds_read_b128 v[228:231], v4 offset:41984
  s_waitcnt lgkmcnt(3)
  s_waitcnt vmcnt(14)
  v_mfma_f32_32x32x16_bf16 v[80:95], v[208:211], v[16:19], v[80:95]
  v_mfma_f32_32x32x16_bf16 v[96:111], v[212:215], v[16:19], v[96:111]
  v_mfma_f32_32x32x16_bf16 v[112:127], v[16:19], v[216:219], v[112:127]
  v_mfma_f32_32x32x16_bf16 v[128:143], v[208:211], v[20:23], v[128:143]
  v_mfma_f32_32x32x16_bf16 v[144:159], v[212:215], v[20:23], v[144:159]
  v_mfma_f32_32x32x16_bf16 v[160:175], v[20:23], v[216:219], v[160:175]
  s_add_u32 s29, s27, 32768
  buffer_load_dwordx4 v[16:19], v2, s[8:11], s29 offen sc1
  s_add_u32 s29, s28, 32768
  buffer_load_dwordx4 v[20:23], v2, s[8:11], s29 offen sc1
  ds_read_b128 v[208:211], v3 offset:26624
  ds_read_b128 v[212:215], v4 offset:2048
  ds_read_b128 v[216:219], v4 offset:43008
  s_waitcnt lgkmcnt(3)
  s_waitcnt vmcnt(14)
  v_mfma_f32_32x32x16_bf16 v[80:95], v[220:223], v[24:27], v[80:95]
  v_mfma_f32_32x32x16_bf16 v[96:111], v[224:227], v[24:27], v[96:111]
  v_mfma_f32_32x32x16_bf16 v[112:127], v[24:27], v[228:231], v[112:127]
  v_mfma_f32_32x32x16_bf16 v[128:143], v[220:223], v[28:31], v[128:143]
  v_mfma_f32_32x32x16_bf16 v[144:159], v[224:227], v[28:31], v[144:159]
  v_mfma_f32_32x32x16_bf16 v[160:175], v[28:31], v[228:231], v[160:175]
  s_add_u32 s29, s27, 33792
  buffer_load_dwordx4 v[24:27], v2, s[8:11], s29 offen sc1
  s_add_u32 s29, s28, 33792
  buffer_load_dwordx4 v[28:31], v2, s[8:11], s29 offen sc1
  ds_read_b128 v[220:223], v3 offset:27648
  ds_read_b128 v[224:227], v4 offset:3072
  ds_read_b128 v[228:231], v4 offset:44032
  s_waitcnt lgkmcnt(3)
  s_waitcnt vmcnt(14)
  v_mfma_f32_32x32x16_bf16 v[80:95], v[208:211], v[32:35], v[80:95]
  v_mfma_f32_32x32x16_bf16 v[96:111], v[212:215], v[32:35], v[96:111]
  v_mfma_f32_32x32x16_bf16 v[112:127], v[32:35], v[216:219], v[112:127]
  v_mfma_f32_32x32x16_bf16 v[128:143], v[208:211], v[36:39], v[128:143]
  v_mfma_f32_32x32x16_bf16 v[144:159], v[212:215], v[36:39], v[144:159]
  v_mfma_f32_32x32x16_bf16 v[160:175], v[36:39], v[216:219], v[160:175]
  s_add_u32 s29, s27, 34816
  buffer_load_dwordx4 v[32:35], v2, s[8:11], s29 offen sc1
  s_add_u32 s29, s28, 34816
  buffer_load_dwordx4 v[36:39], v2, s[8:11], s29 offen sc1
  ds_read_b128 v[208:211], v3 offset:28672
  ds_read_b128 v[212:215], v4 offset:4096
  ds_read_b128 v[216:219], v4 offset:45056
  s_waitcnt lgkmcnt(3)
  s_waitcnt vmcnt(14)
  v_mfma_f32_32x32x16_bf16 v[80:95], v[220:223], v[40:43], v[80:95]
  v_mfma_f32_32x32x16_bf16 v[96:111], v[224:227], v[40:43], v[96:111]
  v_mfma_f32_32x32x16_bf16 v[112:127], v[40:43], v[228:231], v[112:127]
  v_mfma_f32_32x32x16_bf16 v[128:143], v[220:223], v[44:47], v[128:143]
  v_mfma_f32_32x32x16_bf16 v[144:159], v[224:227], v[44:47], v[144:159]
  v_mfma_f32_32x32x16_bf16 v[160:175], v[44:47], v[228:231], v[160:175]
  s_add_u32 s29, s27, 35840
  buffer_load_dwordx4 v[40:43], v2, s[8:11], s29 offen sc1
  s_add_u32 s29, s28, 35840
  buffer_load_dwordx4 v[44:47], v2, s[8:11], s29 offen sc1
  ds_read_b128 v[220:223], v3 offset:29696
  ds_read_b128 v[224:227], v4 offset:5120
  ds_read_b128 v[228:231], v4 offset:46080
  s_waitcnt lgkmcnt(3)
  s_waitcnt vmcnt(14)
  v_mfma_f32_32x32x16_bf16 v[80:95], v[208:211], v[48:51], v[80:95]
  v_mfma_f32_32x32x16_bf16 v[96:111], v[212:215], v[48:51], v[96:111]
  v_mfma_f32_32x32x16_bf16 v[112:127], v[48:51], v[216:219], v[112:127]
  v_mfma_f32_32x32x16_bf16 v[128:143], v[208:211], v[52:55], v[128:143]
  v_mfma_f32_32x32x16_bf16 v[144:159], v[212:215], v[52:55], v[144:159]
  v_mfma_f32_32x32x16_bf16 v[160:175], v[52:55], v[216:219], v[160:175]
  s_add_u32 s29, s27, 36864
  buffer_load_dwordx4 v[48:51], v2, s[8:11], s29 offen sc1
  s_add_u32 s29, s28, 36864
  buffer_load_dwordx4 v[52:55], v2, s[8:11], s29 offen sc1
  ds_read_b128 v[208:211], v3 offset:30720
  ds_read_b128 v[212:215], v4 offset:6144
  ds_read_b128 v[216:219], v4 offset:47104
  s_waitcnt lgkmcnt(3)
  s_waitcnt vmcnt(14)
  v_mfma_f32_32x32x16_bf16 v[80:95], v[220:223], v[56:59], v[80:95]
  v_mfma_f32_32x32x16_bf16 v[96:111], v[224:227], v[56:59], v[96:111]
  v_mfma_f32_32x32x16_bf16 v[112:127], v[56:59], v[228:231], v[112:127]
  v_mfma_f32_32x32x16_bf16 v[128:143], v[220:223], v[60:63], v[128:143]
  v_mfma_f32_32x32x16_bf16 v[144:159], v[224:227], v[60:63], v[144:159]
  v_mfma_f32_32x32x16_bf16 v[160:175], v[60:63], v[228:231], v[160:175]
  s_add_u32 s29, s27, 37888
  buffer_load_dwordx4 v[56:59], v2, s[8:11], s29 offen sc1
  s_add_u32 s29, s28, 37888
  buffer_load_dwordx4 v[60:63], v2, s[8:11], s29 offen sc1
  ds_read_b128 v[220:223], v3 offset:31744
  ds_read_b128 v[224:227], v4 offset:7168
  ds_read_b128 v[228:231], v4 offset:48128
  s_waitcnt lgkmcnt(3)
  s_waitcnt vmcnt(14)
  v_mfma_f32_32x32x16_bf16 v[80:95], v[208:211], v[64:67], v[80:95]
  v_mfma_f32_32x32x16_bf16 v[96:111], v[212:215], v[64:67], v[96:111]
  v_mfma_f32_32x32x16_bf16 v[112:127], v[64:67], v[216:219], v[112:127]
  v_mfma_f32_32x32x16_bf16 v[128:143], v[208:211], v[68:71], v[128:143]
  v_mfma_f32_32x32x16_bf16 v[144:159], v[212:215], v[68:71], v[144:159]
  v_mfma_f32_32x32x16_bf16 v[160:175], v[68:71], v[216:219], v[160:175]
  s_add_u32 s29, s27, 38912
  buffer_load_dwordx4 v[64:67], v2, s[8:11], s29 offen sc1
  s_add_u32 s29, s28, 38912
  buffer_load_dwordx4 v[68:71], v2, s[8:11], s29 offen sc1
  ds_read_b128 v[208:211], v3 offset:32768
  ds_read_b128 v[212:215], v4 offset:8192
  ds_read_b128 v[216:219], v4 offset:49152
  s_waitcnt lgkmcnt(3)
  s_waitcnt vmcnt(14)
  v_mfma_f32_32x32x16_bf16 v[80:95], v[220:223], v[72:75], v[80:95]
  v_mfma_f32_32x32x16_bf16 v[96:111], v[224:227], v[72:75], v[96:111]
  v_mfma_f32_32x32x16_bf16 v[112:127], v[72:75], v[228:231], v[112:127]
  v_mfma_f32_32x32x16_bf16 v[128:143], v[220:223], v[76:79], v[128:143]
  v_mfma_f32_32x32x16_bf16 v[144:159], v[224:227], v[76:79], v[144:159]
  v_mfma_f32_32x32x16_bf16 v[160:175], v[76:79], v[228:231], v[160:175]
  s_add_u32 s29, s27, 39936
  buffer_load_dwordx4 v[72:75], v2, s[8:11], s29 offen sc1
  s_add_u32 s29, s28, 39936
  buffer_load_dwordx4 v[76:79], v2, s[8:11], s29 offen sc1
  ds_read_b128 v[220:223], v3 offset:33792
  ds_read_b128 v[224:227], v4 offset:9216
  ds_read_b128 v[228:231], v4 offset:50176
  s_waitcnt lgkmcnt(3)
  s_waitcnt vmcnt(14)
  v_mfma_f32_32x32x16_bf16 v[80:95], v[208:211], v[16:19], v[80:95]
  v_mfma_f32_32x32x16_bf16 v[96:111], v[212:215], v[16:19], v[96:111]
  v_mfma_f32_32x32x16_bf16 v[112:127], v[16:19], v[216:219], v[112:127]
  v_mfma_f32_32x32x16_bf16 v[128:143], v[208:211], v[20:23], v[128:143]
  v_mfma_f32_32x32x16_bf16 v[144:159], v[212:215], v[20:23], v[144:159]
  v_mfma_f32_32x32x16_bf16 v[160:175], v[20:23], v[216:219], v[160:175]
  ds_read_b128 v[208:211], v3 offset:34816
  ds_read_b128 v[212:215], v4 offset:10240
  ds_read_b128 v[216:219], v4 offset:51200
  s_waitcnt lgkmcnt(3)
  s_waitcnt vmcnt(12)
  v_mfma_f32_32x32x16_bf16 v[80:95], v[220:223], v[24:27], v[80:95]
  v_mfma_f32_32x32x16_bf16 v[96:111], v[224:227], v[24:27], v[96:111]
  v_mfma_f32_32x32x16_bf16 v[112:127], v[24:27], v[228:231], v[112:127]
  v_mfma_f32_32x32x16_bf16 v[128:143], v[220:223], v[28:31], v[128:143]
  v_mfma_f32_32x32x16_bf16 v[144:159], v[224:227], v[28:31], v[144:159]
  v_mfma_f32_32x32x16_bf16 v[160:175], v[28:31], v[228:231], v[160:175]
  ds_read_b128 v[220:223], v3 offset:35840
  ds_read_b128 v[224:227], v4 offset:11264
  ds_read_b128 v[228:231], v4 offset:52224
  s_waitcnt lgkmcnt(3)
  s_waitcnt vmcnt(10)
  v_mfma_f32_32x32x16_bf16 v[80:95], v[208:211], v[32:35], v[80:95]
  v_mfma_f32_32x32x16_bf16 v[96:111], v[212:215], v[32:35], v[96:111]
  v_mfma_f32_32x32x16_bf16 v[112:127], v[32:35], v[216:219], v[112:127]
  v_mfma_f32_32x32x16_bf16 v[128:143], v[208:211], v[36:39], v[128:143]
  v_mfma_f32_32x32x16_bf16 v[144:159], v[212:215], v[36:39], v[144:159]
  v_mfma_f32_32x32x16_bf16 v[160:175], v[36:39], v[216:219], v[160:175]
  ds_read_b128 v[208:211], v3 offset:36864
  ds_read_b128 v[212:215], v4 offset:12288
  ds_read_b128 v[216:219], v4 offset:53248
  s_waitcnt lgkmcnt(3)
  s_waitcnt vmcnt(8)
  v_mfma_f32_32x32x16_bf16 v[80:95], v[220:223], v[40:43], v[80:95]
  v_mfma_f32_32x32x16_bf16 v[96:111], v[224:227], v[40:43], v[96:111]
  v_mfma_f32_32x32x16_bf16 v[112:127], v[40:43], v[228:231], v[112:127]
  v_mfma_f32_32x32x16_bf16 v[128:143], v[220:223], v[44:47], v[128:143]
  v_mfma_f32_32x32x16_bf16 v[144:159], v[224:227], v[44:47], v[144:159]
  v_mfma_f32_32x32x16_bf16 v[160:175], v[44:47], v[228:231], v[160:175]
  ds_read_b128 v[220:223], v3 offset:37888
  ds_read_b128 v[224:227], v4 offset:13312
  ds_read_b128 v[228:231], v4 offset:54272
  s_waitcnt lgkmcnt(3)
  s_waitcnt vmcnt(6)
  v_mfma_f32_32x32x16_bf16 v[80:95], v[208:211], v[48:51], v[80:95]
  v_mfma_f32_32x32x16_bf16 v[96:111], v[212:215], v[48:51], v[96:111]
  v_mfma_f32_32x32x16_bf16 v[112:127], v[48:51], v[216:219], v[112:127]
  v_mfma_f32_32x32x16_bf16 v[128:143], v[208:211], v[52:55], v[128:143]
  v_mfma_f32_32x32x16_bf16 v[144:159], v[212:215], v[52:55], v[144:159]
  v_mfma_f32_32x32x16_bf16 v[160:175], v[52:55], v[216:219], v[160:175]
  ds_read_b128 v[208:211], v3 offset:38912
  ds_read_b128 v[212:215], v4 offset:14336
  ds_read_b128 v[216:219], v4 offset:55296
  s_waitcnt lgkmcnt(3)
  s_waitcnt vmcnt(4)
  v_mfma_f32_32x32x16_bf16 v[80:95], v[220:223], v[56:59], v[80:95]
  v_mfma_f32_32x32x16_bf16 v[96:111], v[224:227], v[56:59], v[96:111]
  v_mfma_f32_32x32x16_bf16 v[112:127], v[56:59], v[228:231], v[112:127]
  v_mfma_f32_32x32x16_bf16 v[128:143], v[220:223], v[60:63], v[128:143]
  v_mfma_f32_32x32x16_bf16 v[144:159], v[224:227], v[60:63], v[144:159]
  v_mfma_f32_32x32x16_bf16 v[160:175], v[60:63], v[228:231], v[160:175]
  ds_read_b128 v[220:223], v3 offset:39936
  ds_read_b128 v[224:227], v4 offset:15360
  ds_read_b128 v[228:231], v4 offset:56320
  s_waitcnt lgkmcnt(3)
  s_waitcnt vmcnt(2)
  v_mfma_f32_32x32x16_bf16 v[80:95], v[208:211], v[64:67], v[80:95]
  v_mfma_f32_32x32x16_bf16 v[96:111], v[212:215], v[64:67], v[96:111]
  v_mfma_f32_32x32x16_bf16 v[112:127], v[64:67], v[216:219], v[112:127]
  v_mfma_f32_32x32x16_bf16 v[128:143], v[208:211], v[68:71], v[128:143]
  v_mfma_f32_32x32x16_bf16 v[144:159], v[212:215], v[68:71], v[144:159]
  v_mfma_f32_32x32x16_bf16 v[160:175], v[68:71], v[216:219], v[160:175]
  s_waitcnt lgkmcnt(0)
  s_waitcnt vmcnt(0)
  v_mfma_f32_32x32x16_bf16 v[80:95], v[220:223], v[72:75], v[80:95]
  v_mfma_f32_32x32x16_bf16 v[96:111], v[224:227], v[72:75], v[96:111]
  v_mfma_f32_32x32x16_bf16 v[112:127], v[72:75], v[228:231], v[112:127]
  v_mfma_f32_32x32x16_bf16 v[128:143], v[220:223], v[76:79], v[128:143]
  v_mfma_f32_32x32x16_bf16 v[144:159], v[224:227], v[76:79], v[144:159]
  v_mfma_f32_32x32x16_bf16 v[160:175], v[76:79], v[228:231], v[160:175]
  s_nop 11
  s_mov_b32 s30, 0x3ea52b5c
  v_mov_b32 v5, 0
  v_cmp_gt_u32 s[34:35], 32, v1
  v_mov_b32 v6, 1.0
  v_and_b32 v7, 31, v1
  v_cndmask_b32 v6, v5, v6, s[34:35]
  v_cmp_eq_u32 s[32:33], 20, v7
  v_mov_b32 v8, 1.0
  s_lshl_b32 s31, s22, 6
  s_add_u32 s31, s31, s24
  s_lshl_b32 s31, s31, 11
  v_mov_b32 v9, 0
  v_max3_f32 v9, v9, abs(v96), abs(v97)
  v_max3_f32 v9, v9, abs(v98), abs(v99)
  v_max3_f32 v9, v9, abs(v100), abs(v101)
  v_max3_f32 v9, v9, abs(v102), abs(v103)
  v_max3_f32 v9, v9, abs(v104), abs(v105)
  v_max3_f32 v9, v9, abs(v106), abs(v107)
  v_max3_f32 v9, v9, abs(v108), abs(v109)
  v_max3_f32 v9, v9, abs(v110), abs(v111)
  v_add_f32 v108, v108, v6
  v_cndmask_b32 v112, v112, v8, s[32:33]
  v_cndmask_b32 v113, v113, v8, s[32:33]
  v_cndmask_b32 v114, v114, v8, s[32:33]
  v_cndmask_b32 v115, v115, v8, s[32:33]
  v_cndmask_b32 v116, v116, v8, s[32:33]
  v_cndmask_b32 v117, v117, v8, s[32:33]
  v_cndmask_b32 v118, v118, v8, s[32:33]
  v_cndmask_b32 v119, v119, v8, s[32:33]
  v_cndmask_b32 v120, v120, v8, s[32:33]
  v_cndmask_b32 v121, v121, v8, s[32:33]
  v_cndmask_b32 v122, v122, v8, s[32:33]
  v_cndmask_b32 v123, v123, v8, s[32:33]
  v_cndmask_b32 v124, v124, v8, s[32:33]
  v_cndmask_b32 v125, v125, v8, s[32:33]
  v_cndmask_b32 v126, v126, v8, s[32:33]
  v_cndmask_b32 v127, v127, v8, s[32:33]
  v_cvt_pk_bf16_f32 v16, v96, v97
  v_cvt_pk_bf16_f32 v17, v98, v99
  v_cvt_pk_bf16_f32 v18, v100, v101
  v_cvt_pk_bf16_f32 v19, v102, v103
  v_cvt_pk_bf16_f32 v20, v104, v105
  v_cvt_pk_bf16_f32 v21, v106, v107
  v_cvt_pk_bf16_f32 v22, v108, v109
  v_cvt_pk_bf16_f32 v23, v110, v111
  s_add_u32 s29, s31, 245366784
  buffer_store_dwordx4 v[16:19], v2, s[8:11], s29 offen sc1
  buffer_store_dwordx4 v[20:23], v2, s[8:11], s29 offen offset:1024 sc1
  v_cvt_pk_bf16_f32 v24, v112, v113
  v_cvt_pk_bf16_f32 v25, v114, v115
  v_cvt_pk_bf16_f32 v26, v116, v117
  v_cvt_pk_bf16_f32 v27, v118, v119
  v_cvt_pk_bf16_f32 v28, v120, v121
  v_cvt_pk_bf16_f32 v29, v122, v123
  v_cvt_pk_bf16_f32 v30, v124, v125
  v_cvt_pk_bf16_f32 v31, v126, v127
  s_add_u32 s29, s31, 249561088
  buffer_store_dwordx4 v[24:27], v2, s[8:11], s29 offen sc1
  buffer_store_dwordx4 v[28:31], v2, s[8:11], s29 offen offset:1024 sc1
  v_mul_f32 v80, s30, v80
  v_mul_f32 v81, s30, v81
  v_mul_f32 v82, s30, v82
  v_mul_f32 v83, s30, v83
  v_mul_f32 v84, s30, v84
  v_mul_f32 v85, s30, v85
  v_mul_f32 v86, s30, v86
  v_mul_f32 v87, s30, v87
  v_mul_f32 v88, s30, v88
  v_mul_f32 v89, s30, v89
  v_mul_f32 v90, s30, v90
  v_mul_f32 v91, s30, v91
  v_mul_f32 v92, s30, v92
  v_mul_f32 v93, s30, v93
  v_mul_f32 v94, s30, v94
  v_mul_f32 v95, s30, v95
  v_cvt_pk_bf16_f32 v192, v80, v81
  v_cvt_pk_bf16_f32 v193, v82, v83
  v_cvt_pk_bf16_f32 v194, v84, v85
  v_cvt_pk_bf16_f32 v195, v86, v87
  v_cvt_pk_bf16_f32 v196, v88, v89
  v_cvt_pk_bf16_f32 v197, v90, v91
  v_cvt_pk_bf16_f32 v198, v92, v93
  v_cvt_pk_bf16_f32 v199, v94, v95
  v_max3_f32 v9, v9, abs(v144), abs(v145)
  v_max3_f32 v9, v9, abs(v146), abs(v147)
  v_max3_f32 v9, v9, abs(v148), abs(v149)
  v_max3_f32 v9, v9, abs(v150), abs(v151)
  v_max3_f32 v9, v9, abs(v152), abs(v153)
  v_max3_f32 v9, v9, abs(v154), abs(v155)
  v_max3_f32 v9, v9, abs(v156), abs(v157)
  v_max3_f32 v9, v9, abs(v158), abs(v159)
  v_add_f32 v156, v156, v6
  v_cndmask_b32 v160, v160, v8, s[32:33]
  v_cndmask_b32 v161, v161, v8, s[32:33]
  v_cndmask_b32 v162, v162, v8, s[32:33]
  v_cndmask_b32 v163, v163, v8, s[32:33]
  v_cndmask_b32 v164, v164, v8, s[32:33]
  v_cndmask_b32 v165, v165, v8, s[32:33]
  v_cndmask_b32 v166, v166, v8, s[32:33]
  v_cndmask_b32 v167, v167, v8, s[32:33]
  v_cndmask_b32 v168, v168, v8, s[32:33]
  v_cndmask_b32 v169, v169, v8, s[32:33]
  v_cndmask_b32 v170, v170, v8, s[32:33]
  v_cndmask_b32 v171, v171, v8, s[32:33]
  v_cndmask_b32 v172, v172, v8, s[32:33]
  v_cndmask_b32 v173, v173, v8, s[32:33]
  v_cndmask_b32 v174, v174, v8, s[32:33]
  v_cndmask_b32 v175, v175, v8, s[32:33]
  v_cvt_pk_bf16_f32 v32, v144, v145
  v_cvt_pk_bf16_f32 v33, v146, v147
  v_cvt_pk_bf16_f32 v34, v148, v149
  v_cvt_pk_bf16_f32 v35, v150, v151
  v_cvt_pk_bf16_f32 v36, v152, v153
  v_cvt_pk_bf16_f32 v37, v154, v155
  v_cvt_pk_bf16_f32 v38, v156, v157
  v_cvt_pk_bf16_f32 v39, v158, v159
  s_add_u32 s29, s31, 245368832
  buffer_store_dwordx4 v[32:35], v2, s[8:11], s29 offen sc1
  buffer_store_dwordx4 v[36:39], v2, s[8:11], s29 offen offset:1024 sc1
  v_cvt_pk_bf16_f32 v40, v160, v161
  v_cvt_pk_bf16_f32 v41, v162, v163
  v_cvt_pk_bf16_f32 v42, v164, v165
  v_cvt_pk_bf16_f32 v43, v166, v167
  v_cvt_pk_bf16_f32 v44, v168, v169
  v_cvt_pk_bf16_f32 v45, v170, v171
  v_cvt_pk_bf16_f32 v46, v172, v173
  v_cvt_pk_bf16_f32 v47, v174, v175
  s_add_u32 s29, s31, 249563136
  buffer_store_dwordx4 v[40:43], v2, s[8:11], s29 offen sc1
  buffer_store_dwordx4 v[44:47], v2, s[8:11], s29 offen offset:1024 sc1
  v_mul_f32 v128, s30, v128
  v_mul_f32 v129, s30, v129
  v_mul_f32 v130, s30, v130
  v_mul_f32 v131, s30, v131
  v_mul_f32 v132, s30, v132
  v_mul_f32 v133, s30, v133
  v_mul_f32 v134, s30, v134
  v_mul_f32 v135, s30, v135
  v_mul_f32 v136, s30, v136
  v_mul_f32 v137, s30, v137
  v_mul_f32 v138, s30, v138
  v_mul_f32 v139, s30, v139
  v_mul_f32 v140, s30, v140
  v_mul_f32 v141, s30, v141
  v_mul_f32 v142, s30, v142
  v_mul_f32 v143, s30, v143
  v_cvt_pk_bf16_f32 v200, v128, v129
  v_cvt_pk_bf16_f32 v201, v130, v131
  v_cvt_pk_bf16_f32 v202, v132, v133
  v_cvt_pk_bf16_f32 v203, v134, v135
  v_cvt_pk_bf16_f32 v204, v136, v137
  v_cvt_pk_bf16_f32 v205, v138, v139
  v_cvt_pk_bf16_f32 v206, v140, v141
  v_cvt_pk_bf16_f32 v207, v142, v143
  s_nop 1
  v_max_f32_dpp v10, v9, v9 quad_perm:[1,0,3,2] row_mask:0xf bank_mask:0xf
  s_nop 1
  v_max_f32_dpp v9, v10, v10 quad_perm:[2,3,0,1] row_mask:0xf bank_mask:0xf
  s_nop 1
  v_max_f32_dpp v10, v9, v9 row_half_mirror row_mask:0xf bank_mask:0xf
  s_nop 1
  v_max_f32_dpp v9, v10, v10 row_mirror row_mask:0xf bank_mask:0xf
  v_mov_b32 v10, v9
  s_nop 1
  v_permlane16_swap_b32 v9, v10
  v_max_f32 v9, v9, v10
  v_mov_b32 v10, v9
  s_nop 1
  v_permlane32_swap_b32 v9, v10
  v_max_f32 v9, v9, v10
  s_lshl_b32 s51, s22, 2
  s_add_u32 s51, s51, 0x9800
  v_mov_b32 v11, 0
  s_mov_b64 s[40:41], exec
  s_mov_b64 exec, 1
  buffer_atomic_umax v9, v11, s[8:11], s51 offen
  s_mov_b64 exec, s[40:41]
  s_mov_b32 s52, s24
  s_waitcnt vmcnt(0)
  s_barrier
  s_cmp_eq_u32 s21, 0
  s_cbranch_scc0 arr_35
  s_mov_b64 s[24:25], exec
  s_mov_b64 exec, 1
  v_mov_b32 v3, 0
  v_mov_b32 v4, 1
  buffer_atomic_add v4, v3, s[8:11], s47 offen
  s_mov_b64 exec, s[24:25]
arr_35:
  s_and_b32 s26, s2, 3
  s_mul_i32 s26, s26, 10
  s_mul_i32 s27, s21, 3
  s_cmp_eq_u32 s21, 3
  s_cselect_b32 s27, 8, s27
  s_add_u32 s50, s26, s27
  s_mul_i32 s26, s50, 20480
  s_add_u32 s26, s26, 0xe000000
  s_add_u32 s27, s26, 0
  buffer_load_dwordx4 a[0:3], v2, s[8:11], s27 offen
  s_add_u32 s27, s26, 1024
  buffer_load_dwordx4 a[4:7], v2, s[8:11], s27 offen
  s_add_u32 s27, s26, 2048
  buffer_load_dwordx4 a[8:11], v2, s[8:11], s27 offen
  s_add_u32 s27, s26, 3072
  buffer_load_dwordx4 a[12:15], v2, s[8:11], s27 offen
  s_add_u32 s27, s26, 4096
  buffer_load_dwordx4 a[16:19], v2, s[8:11], s27 offen
  s_add_u32 s27, s26, 5120
  buffer_load_dwordx4 a[20:23], v2, s[8:11], s27 offen
  s_add_u32 s27, s26, 6144
  buffer_load_dwordx4 a[24:27], v2, s[8:11], s27 offen
  s_add_u32 s27, s26, 7168
  buffer_load_dwordx4 a[28:31], v2, s[8:11], s27 offen
  s_add_u32 s27, s26, 8192
  buffer_load_dwordx4 a[32:35], v2, s[8:11], s27 offen
  s_add_u32 s27, s26, 9216
  buffer_load_dwordx4 a[36:39], v2, s[8:11], s27 offen
  s_add_u32 s27, s26, 10240
  buffer_load_dwordx4 a[40:43], v2, s[8:11], s27 offen
  s_add_u32 s27, s26, 11264
  buffer_load_dwordx4 a[44:47], v2, s[8:11], s27 offen
  s_add_u32 s27, s26, 12288
  buffer_load_dwordx4 a[48:51], v2, s[8:11], s27 offen
  s_add_u32 s27, s26, 13312
  buffer_load_dwordx4 a[52:55], v2, s[8:11], s27 offen
  s_add_u32 s27, s26, 14336
  buffer_load_dwordx4 a[56:59], v2, s[8:11], s27 offen
  s_add_u32 s27, s26, 15360
  buffer_load_dwordx4 a[60:63], v2, s[8:11], s27 offen
  s_add_u32 s27, s26, 16384
  buffer_load_dwordx4 a[64:67], v2, s[8:11], s27 offen
  s_add_u32 s27, s26, 17408
  buffer_load_dwordx4 a[68:71], v2, s[8:11], s27 offen
  s_add_u32 s27, s26, 18432
  buffer_load_dwordx4 a[72:75], v2, s[8:11], s27 offen
  s_add_u32 s27, s26, 19456
  buffer_load_dwordx4 a[76:79], v2, s[8:11], s27 offen
  s_add_u32 s27, s26, 20480
  buffer_load_dwordx4 a[80:83], v2, s[8:11], s27 offen
  s_add_u32 s27, s26, 21504
  buffer_load_dwordx4 a[84:87], v2, s[8:11], s27 offen
  s_add_u32 s27, s26, 22528
  buffer_load_dwordx4 a[88:91], v2, s[8:11], s27 offen
  s_add_u32 s27, s26, 23552
  buffer_load_dwordx4 a[92:95], v2, s[8:11], s27 offen
  s_add_u32 s27, s26, 24576
  buffer_load_dwordx4 a[96:99], v2, s[8:11], s27 offen
  s_add_u32 s27, s26, 25600
  buffer_load_dwordx4 a[100:103], v2, s[8:11], s27 offen
  s_add_u32 s27, s26, 26624
  buffer_load_dwordx4 a[104:107], v2, s[8:11], s27 offen
  s_add_u32 s27, s26, 27648
  buffer_load_dwordx4 a[108:111], v2, s[8:11], s27 offen
  s_add_u32 s27, s26, 28672
  buffer_load_dwordx4 a[112:115], v2, s[8:11], s27 offen
  s_add_u32 s27, s26, 29696
  buffer_load_dwordx4 a[116:119], v2, s[8:11], s27 offen
  s_add_u32 s27, s26, 30720
  buffer_load_dwordx4 a[120:123], v2, s[8:11], s27 offen
  s_add_u32 s27, s26, 31744
  buffer_load_dwordx4 a[124:127], v2, s[8:11], s27 offen
  s_add_u32 s27, s26, 32768
  buffer_load_dwordx4 a[128:131], v2, s[8:11], s27 offen
  s_add_u32 s27, s26, 33792
  buffer_load_dwordx4 a[132:135], v2, s[8:11], s27 offen
  s_add_u32 s27, s26, 34816
  buffer_load_dwordx4 a[136:139], v2, s[8:11], s27 offen
  s_add_u32 s27, s26, 35840
  buffer_load_dwordx4 a[140:143], v2, s[8:11], s27 offen
  s_add_u32 s27, s26, 36864
  buffer_load_dwordx4 a[144:147], v2, s[8:11], s27 offen
  s_add_u32 s27, s26, 37888
  buffer_load_dwordx4 a[148:151], v2, s[8:11], s27 offen
  s_add_u32 s27, s26, 38912
  buffer_load_dwordx4 a[152:155], v2, s[8:11], s27 offen
  s_add_u32 s27, s26, 39936
  buffer_load_dwordx4 a[156:159], v2, s[8:11], s27 offen
  s_cmp_lt_u32 s21, 2
  s_cbranch_scc0 g3_36
  s_add_u32 s27, s26, 40960
  buffer_load_dwordx4 a[160:163], v2, s[8:11], s27 offen
  s_add_u32 s27, s26, 41984
  buffer_load_dwordx4 a[164:167], v2, s[8:11], s27 offen
  s_add_u32 s27, s26, 43008
  buffer_load_dwordx4 a[168:171], v2, s[8:11], s27 offen
  s_add_u32 s27, s26, 44032
  buffer_load_dwordx4 a[172:175], v2, s[8:11], s27 offen
  s_add_u32 s27, s26, 45056
  buffer_load_dwordx4 a[176:179], v2, s[8:11], s27 offen
  s_add_u32 s27, s26, 46080
  buffer_load_dwordx4 a[180:183], v2, s[8:11], s27 offen
  s_add_u32 s27, s26, 47104
  buffer_load_dwordx4 a[184:187], v2, s[8:11], s27 offen
  s_add_u32 s27, s26, 48128
  buffer_load_dwordx4 a[188:191], v2, s[8:11], s27 offen
  s_add_u32 s27, s26, 49152
  buffer_load_dwordx4 a[192:195], v2, s[8:11], s27 offen
  s_add_u32 s27, s26, 50176
  buffer_load_dwordx4 a[196:199], v2, s[8:11], s27 offen
  s_add_u32 s27, s26, 51200
  buffer_load_dwordx4 a[200:203], v2, s[8:11], s27 offen
  s_add_u32 s27, s26, 52224
  buffer_load_dwordx4 a[204:207], v2, s[8:11], s27 offen
  s_add_u32 s27, s26, 53248
  buffer_load_dwordx4 a[208:211], v2, s[8:11], s27 offen
  s_add_u32 s27, s26, 54272
  buffer_load_dwordx4 a[212:215], v2, s[8:11], s27 offen
  s_add_u32 s27, s26, 55296
  buffer_load_dwordx4 a[216:219], v2, s[8:11], s27 offen
  s_add_u32 s27, s26, 56320
  buffer_load_dwordx4 a[220:223], v2, s[8:11], s27 offen
  s_add_u32 s27, s26, 57344
  buffer_load_dwordx4 a[224:227], v2, s[8:11], s27 offen
  s_add_u32 s27, s26, 58368
  buffer_load_dwordx4 a[228:231], v2, s[8:11], s27 offen
  s_add_u32 s27, s26, 59392
  buffer_load_dwordx4 a[232:235], v2, s[8:11], s27 offen
  s_add_u32 s27, s26, 60416
  buffer_load_dwordx4 a[236:239], v2, s[8:11], s27 offen
g3_36:
  v_mov_b32 v12, 0
  v_lshlrev_b32 v6, 16, v192
  v_and_b32 v7, 0xffff0000, v192
  v_add_f32_e64 v12, v12, abs(v6)
  v_add_f32_e64 v12, v12, abs(v7)
  v_lshlrev_b32 v6, 16, v193
  v_and_b32 v7, 0xffff0000, v193
  v_add_f32_e64 v12, v12, abs(v6)
  v_add_f32_e64 v12, v12, abs(v7)
  v_lshlrev_b32 v6, 16, v194
  v_and_b32 v7, 0xffff0000, v194
  v_add_f32_e64 v12, v12, abs(v6)
  v_add_f32_e64 v12, v12, abs(v7)
  v_lshlrev_b32 v6, 16, v195
  v_and_b32 v7, 0xffff0000, v195
  v_add_f32_e64 v12, v12, abs(v6)
  v_add_f32_e64 v12, v12, abs(v7)
  v_lshlrev_b32 v6, 16, v196
  v_and_b32 v7, 0xffff0000, v196
  v_add_f32_e64 v12, v12, abs(v6)
  v_add_f32_e64 v12, v12, abs(v7)
  v_lshlrev_b32 v6, 16, v197
  v_and_b32 v7, 0xffff0000, v197
  v_add_f32_e64 v12, v12, abs(v6)
  v_add_f32_e64 v12, v12, abs(v7)
  v_lshlrev_b32 v6, 16, v198
  v_and_b32 v7, 0xffff0000, v198
  v_add_f32_e64 v12, v12, abs(v6)
  v_add_f32_e64 v12, v12, abs(v7)
  v_lshlrev_b32 v6, 16, v199
  v_and_b32 v7, 0xffff0000, v199
  v_add_f32_e64 v12, v12, abs(v6)
  v_add_f32_e64 v12, v12, abs(v7)
  v_mov_b32 v6, v12
  s_nop 1
  v_permlane32_swap_b32 v12, v6
  v_add_f32 v12, v12, v6
  v_mov_b32 v13, 0
  v_lshlrev_b32 v6, 16, v200
  v_and_b32 v7, 0xffff0000, v200
  v_add_f32_e64 v13, v13, abs(v6)
  v_add_f32_e64 v13, v13, abs(v7)
  v_lshlrev_b32 v6, 16, v201
  v_and_b32 v7, 0xffff0000, v201
  v_add_f32_e64 v13, v13, abs(v6)
  v_add_f32_e64 v13, v13, abs(v7)
  v_lshlrev_b32 v6, 16, v202
  v_and_b32 v7, 0xffff0000, v202
  v_add_f32_e64 v13, v13, abs(v6)
  v_add_f32_e64 v13, v13, abs(v7)
  v_lshlrev_b32 v6, 16, v203
  v_and_b32 v7, 0xffff0000, v203
  v_add_f32_e64 v13, v13, abs(v6)
  v_add_f32_e64 v13, v13, abs(v7)
  v_lshlrev_b32 v6, 16, v204
  v_and_b32 v7, 0xffff0000, v204
  v_add_f32_e64 v13, v13, abs(v6)
  v_add_f32_e64 v13, v13, abs(v7)
  v_lshlrev_b32 v6, 16, v205
  v_and_b32 v7, 0xffff0000, v205
  v_add_f32_e64 v13, v13, abs(v6)
  v_add_f32_e64 v13, v13, abs(v7)
  v_lshlrev_b32 v6, 16, v206
  v_and_b32 v7, 0xffff0000, v206
  v_add_f32_e64 v13, v13, abs(v6)
  v_add_f32_e64 v13, v13, abs(v7)
  v_lshlrev_b32 v6, 16, v207
  v_and_b32 v7, 0xffff0000, v207
  v_add_f32_e64 v13, v13, abs(v6)
  v_add_f32_e64 v13, v13, abs(v7)
  v_mov_b32 v6, v13
  s_nop 1
  v_permlane32_swap_b32 v13, v6
  v_add_f32 v13, v13, v6
  v_mov_b32 v8, -1
  v_mov_b32 v9, -1
  v_mov_b32 v10, -1
  v_mov_b32 v11, -1
  s_mul_i32 s30, s2, 61440
  s_mul_i32 s31, s21, 15360
  s_add_u32 s30, s30, s31
  s_add_u32 s30, s30, 0x400000
  buffer_store_dwordx4 v[8:11], v2, s[8:11], s30 offen
  s_add_u32 s30, s30, 1024
  buffer_store_dwordx4 v[8:11], v2, s[8:11], s30 offen
  s_add_u32 s30, s30, 1024
  buffer_store_dwordx4 v[8:11], v2, s[8:11], s30 offen
  s_add_u32 s30, s30, 1024
  buffer_store_dwordx4 v[8:11], v2, s[8:11], s30 offen
  s_add_u32 s30, s30, 1024
  buffer_store_dwordx4 v[8:11], v2, s[8:11], s30 offen
  s_add_u32 s30, s30, 1024
  buffer_store_dwordx4 v[8:11], v2, s[8:11], s30 offen
  s_add_u32 s30, s30, 1024
  buffer_store_dwordx4 v[8:11], v2, s[8:11], s30 offen
  s_add_u32 s30, s30, 1024
  buffer_store_dwordx4 v[8:11], v2, s[8:11], s30 offen
  s_add_u32 s30, s30, 1024
  buffer_store_dwordx4 v[8:11], v2, s[8:11], s30 offen
  s_add_u32 s30, s30, 1024
  buffer_store_dwordx4 v[8:11], v2, s[8:11], s30 offen
  s_add_u32 s30, s30, 1024
  buffer_store_dwordx4 v[8:11], v2, s[8:11], s30 offen
  s_add_u32 s30, s30, 1024
  buffer_store_dwordx4 v[8:11], v2, s[8:11], s30 offen
  s_add_u32 s30, s30, 1024
  buffer_store_dwordx4 v[8:11], v2, s[8:11], s30 offen
  s_add_u32 s30, s30, 1024
  buffer_store_dwordx4 v[8:11], v2, s[8:11], s30 offen
  s_add_u32 s30, s30, 1024
  buffer_store_dwordx4 v[8:11], v2, s[8:11], s30 offen
  s_add_u32 s30, s30, 1024
  s_cmp_eq_u32 s2, 0
  s_cbranch_scc0 z_37
  s_cmp_eq_u32 s21, 0
  s_cbranch_scc0 z_37
  v_mov_b32 v8, 0
  v_mov_b32 v9, 0
  v_mov_b32 v10, 0
  v_mov_b32 v11, 0
  s_mov_b32 s30, 0x0
  buffer_store_dwordx4 v[8:11], v2, s[8:11], s30 offen
  s_add_u32 s30, s30, 1024
  buffer_store_dwordx4 v[8:11], v2, s[8:11], s30 offen
  s_add_u32 s30, s30, 1024
  buffer_store_dwordx4 v[8:11], v2, s[8:11], s30 offen
  s_add_u32 s30, s30, 1024
  buffer_store_dwordx4 v[8:11], v2, s[8:11], s30 offen
  s_add_u32 s30, s30, 1024
  buffer_store_dwordx4 v[8:11], v2, s[8:11], s30 offen
  s_add_u32 s30, s30, 1024
z_37:
  s_mov_b32 s45, 0
  v_mov_b32 v3, 0
aw_38:
  buffer_load_dword v4, v3, s[8:11], s47 offen sc1
  s_add_u32 s45, s45, 1
  s_waitcnt vmcnt(0)
  v_readfirstlane_b32 s29, v4
  s_cmp_ge_u32 s29, 8
  s_cbranch_scc1 aw_38_ok
  s_cmp_lt_u32 s45, 400000
  s_cbranch_scc1 aw_38
  s_branch kb1_abort
aw_38_ok:
  v_mov_b32 v3, 0
  buffer_load_dword v4, v3, s[8:11], s51 offen sc1
  s_lshl_b32 s25, s22, 6
  s_lshl_b32 s27, s25, 11
  s_add_u32 s28, s27, 0xee00000
  s_add_u32 s27, s27, 0xea00000
  s_mov_b32 s41, 0
  s_mul_i32 s53, s41, 32768
  s_lshl_b32 s31, s21, 13
  s_add_u32 s53, s53, s31
  s_add_u32 m0, s31, 0
  s_add_u32 s29, s53, s27
  s_add_u32 s29, s29, 0
  buffer_load_dwordx4 v2, s[8:11], s29 offen sc1 lds
  s_add_u32 m0, s31, 1024
  s_add_u32 s29, s53, s27
  s_add_u32 s29, s29, 1024
  buffer_load_dwordx4 v2, s[8:11], s29 offen sc1 lds
  s_add_u32 m0, s31, 2048
  s_add_u32 s29, s53, s27
  s_add_u32 s29, s29, 2048
  buffer_load_dwordx4 v2, s[8:11], s29 offen sc1 lds
  s_add_u32 m0, s31, 3072
  s_add_u32 s29, s53, s27
  s_add_u32 s29, s29, 3072
  buffer_load_dwordx4 v2, s[8:11], s29 offen sc1 lds
  s_add_u32 m0, s31, 4096
  s_add_u32 s29, s53, s27
  s_add_u32 s29, s29, 4096
  buffer_load_dwordx4 v2, s[8:11], s29 offen sc1 lds
  s_add_u32 m0, s31, 5120
  s_add_u32 s29, s53, s27
  s_add_u32 s29, s29, 5120
  buffer_load_dwordx4 v2, s[8:11], s29 offen sc1 lds
  s_add_u32 m0, s31, 6144
  s_add_u32 s29, s53, s27
  s_add_u32 s29, s29, 6144
  buffer_load_dwordx4 v2, s[8:11], s29 offen sc1 lds
  s_add_u32 m0, s31, 7168
  s_add_u32 s29, s53, s27
  s_add_u32 s29, s29, 7168
  buffer_load_dwordx4 v2, s[8:11], s29 offen sc1 lds
  s_add_u32 m0, s31, 32768
  s_add_u32 s29, s53, s28
  s_add_u32 s29, s29, 0
  buffer_load_dwordx4 v2, s[8:11], s29 offen sc1 lds
  s_add_u32 m0, s31, 33792
  s_add_u32 s29, s53, s28
  s_add_u32 s29, s29, 1024
  buffer_load_dwordx4 v2, s[8:11], s29 offen sc1 lds
  s_add_u32 m0, s31, 34816
  s_add_u32 s29, s53, s28
  s_add_u32 s29, s29, 2048
  buffer_load_dwordx4 v2, s[8:11], s29 offen sc1 lds
  s_add_u32 m0, s31, 35840
  s_add_u32 s29, s53, s28
  s_add_u32 s29, s29, 3072
  buffer_load_dwordx4 v2, s[8:11], s29 offen sc1 lds
  s_add_u32 m0, s31, 36864
  s_add_u32 s29, s53, s28
  s_add_u32 s29, s29, 4096
  buffer_load_dwordx4 v2, s[8:11], s29 offen sc1 lds
  s_add_u32 m0, s31, 37888
  s_add_u32 s29, s53, s28
  s_add_u32 s29, s29, 5120
  buffer_load_dwordx4 v2, s[8:11], s29 offen sc1 lds
  s_add_u32 m0, s31, 38912
  s_add_u32 s29, s53, s28
  s_add_u32 s29, s29, 6144
  buffer_load_dwordx4 v2, s[8:11], s29 offen sc1 lds
  s_add_u32 m0, s31, 39936
  s_add_u32 s29, s53, s28
  s_add_u32 s29, s29, 7168
  buffer_load_dwordx4 v2, s[8:11], s29 offen sc1 lds
  s_waitcnt vmcnt(16)
  v_mul_f32 v12, v12, v4
  v_mul_f32 v12, 0x3f820000, v12
  v_mul_f32 v13, v13, v4
  v_mul_f32 v13, 0x3f820000, v13
  s_mov_b32 s40, 0
kb1_main:
  v_lshrrev_b32 v5, 16, v12
  v_or_b32 v5, 0x8000, v5
  v_and_b32 v6, 0xffff0000, v198
  v_or_b32 v5, v5, v6
  v_cndmask_b32 v198, v198, v5, s[34:35]
  v_lshrrev_b32 v5, 16, v13
  v_or_b32 v5, 0x8000, v5
  v_and_b32 v6, 0xffff0000, v206
  v_or_b32 v5, v5, v6
  v_cndmask_b32 v206, v206, v5, s[34:35]
kb1_main2:
  v_mov_b32 v112, 0
  v_mov_b32 v113, 0
  v_mov_b32 v114, 0
  v_mov_b32 v115, 0
  v_mov_b32 v116, 0
  v_mov_b32 v117, 0
  v_mov_b32 v118, 0
  v_mov_b32 v119, 0
  v_mov_b32 v120, 0
  v_mov_b32 v121, 0
  v_mov_b32 v122, 0
  v_mov_b32 v123, 0
  v_mov_b32 v124, 0
  v_mov_b32 v125, 0
  v_mov_b32 v126, 0
  v_mov_b32 v127, 0
  v_mov_b32 v128, 0
  v_mov_b32 v129, 0
  v_mov_b32 v130, 0
  v_mov_b32 v131, 0
  v_mov_b32 v132, 0
  v_mov_b32 v133, 0
  v_mov_b32 v134, 0
  v_mov_b32 v135, 0
  v_mov_b32 v136, 0
  v_mov_b32 v137, 0
  v_mov_b32 v138, 0
  v_mov_b32 v139, 0
  v_mov_b32 v140, 0
  v_mov_b32 v141, 0
  v_mov_b32 v142, 0
  v_mov_b32 v143, 0
  v_mov_b32 v3, v2
  v_add_u32 v4, 65536, v2
kb1_chunk2:
  s_waitcnt vmcnt(0)
  s_barrier
  s_add_u32 s41, s41, 1
  s_min_u32 s29, s41, 3
  s_mul_i32 s53, s29, 32768
  s_lshl_b32 s31, s21, 13
  s_add_u32 s53, s53, s31
  ds_read_b128 v[32:35], v3 offset:0
  ds_read_b128 v[36:39], v3 offset:1024
  ds_read_b128 v[48:51], v3 offset:32768
  ds_read_b128 v[52:55], v3 offset:33792
  ds_read_b128 v[40:43], v3 offset:2048
  ds_read_b128 v[44:47], v3 offset:3072
  s_waitcnt lgkmcnt(4)
  v_mfma_f32_32x32x16_bf16 v[64:79], v[32:35], v[192:195], 0
  v_mfma_f32_32x32x16_bf16 v[64:79], v[36:39], v[196:199], v[64:79]
  s_nop 11
  v_exp_f32 v64, v64
  v_exp_f32 v65, v65
  v_exp_f32 v66, v66
  v_exp_f32 v67, v67
  v_cvt_pk_bf16_f32 v96, v64, v65
  v_exp_f32 v68, v68
  v_exp_f32 v69, v69
  v_cvt_pk_bf16_f32 v97, v66, v67
  v_exp_f32 v70, v70
  v_mfma_f32_32x32x16_bf16 v[80:95], v[32:35], v[200:203], 0
  v_exp_f32 v71, v71
  v_cvt_pk_bf16_f32 v98, v68, v69
  v_exp_f32 v72, v72
  v_exp_f32 v73, v73
  v_cvt_pk_bf16_f32 v99, v70, v71
  v_mfma_f32_32x32x16_bf16 v[80:95], v[36:39], v[204:207], v[80:95]
  v_exp_f32 v74, v74
  v_exp_f32 v75, v75
  ds_read_b128 v[56:59], v3 offset:34816
  v_cvt_pk_bf16_f32 v100, v72, v73
  v_exp_f32 v76, v76
  v_exp_f32 v77, v77
  ds_read_b128 v[60:63], v3 offset:35840
  v_cvt_pk_bf16_f32 v101, v74, v75
  v_exp_f32 v78, v78
  s_add_u32 m0, s31, 65536
  s_add_u32 s29, s53, s27
  s_add_u32 s29, s29, 0
  buffer_load_dwordx4 v2, s[8:11], s29 offen sc1 lds
  v_exp_f32 v79, v79
  v_cvt_pk_bf16_f32 v102, v76, v77
  v_cvt_pk_bf16_f32 v103, v78, v79
  s_waitcnt lgkmcnt(4)
  v_mfma_f32_32x32x16_bf16 v[112:127], v[48:51], v[96:99], v[112:127]
  v_exp_f32 v80, v80
  v_exp_f32 v81, v81
  v_exp_f32 v82, v82
  v_exp_f32 v83, v83
  v_mfma_f32_32x32x16_bf16 v[112:127], v[52:55], v[100:103], v[112:127]
  v_cvt_pk_bf16_f32 v104, v80, v81
  v_exp_f32 v84, v84
  v_exp_f32 v85, v85
  v_cvt_pk_bf16_f32 v105, v82, v83
  v_exp_f32 v86, v86
  s_waitcnt lgkmcnt(2)
  v_mfma_f32_32x32x16_bf16 v[64:79], v[40:43], v[192:195], 0
  v_exp_f32 v87, v87
  v_cvt_pk_bf16_f32 v106, v84, v85
  v_exp_f32 v88, v88
  v_exp_f32 v89, v89
  v_cvt_pk_bf16_f32 v107, v86, v87
  v_mfma_f32_32x32x16_bf16 v[64:79], v[44:47], v[196:199], v[64:79]
  v_exp_f32 v90, v90
  v_exp_f32 v91, v91
  ds_read_b128 v[32:35], v3 offset:4096
  v_cvt_pk_bf16_f32 v108, v88, v89
  v_exp_f32 v92, v92
  v_exp_f32 v93, v93
  ds_read_b128 v[36:39], v3 offset:5120
  v_cvt_pk_bf16_f32 v109, v90, v91
  v_exp_f32 v94, v94
  v_exp_f32 v95, v95
  v_cvt_pk_bf16_f32 v110, v92, v93
  v_cvt_pk_bf16_f32 v111, v94, v95
  v_mfma_f32_32x32x16_bf16 v[128:143], v[48:51], v[104:107], v[128:143]
  v_exp_f32 v64, v64
  v_exp_f32 v65, v65
  v_exp_f32 v66, v66
  v_exp_f32 v67, v67
  v_mfma_f32_32x32x16_bf16 v[128:143], v[52:55], v[108:111], v[128:143]
  v_cvt_pk_bf16_f32 v96, v64, v65
  v_exp_f32 v68, v68
  v_exp_f32 v69, v69
  v_cvt_pk_bf16_f32 v97, v66, v67
  v_exp_f32 v70, v70
  v_mfma_f32_32x32x16_bf16 v[80:95], v[40:43], v[200:203], 0
  v_exp_f32 v71, v71
  v_cvt_pk_bf16_f32 v98, v68, v69
  v_exp_f32 v72, v72
  v_exp_f32 v73, v73
  v_cvt_pk_bf16_f32 v99, v70, v71
  v_mfma_f32_32x32x16_bf16 v[80:95], v[44:47], v[204:207], v[80:95]
  v_exp_f32 v74, v74
  v_exp_f32 v75, v75
  ds_read_b128 v[48:51], v3 offset:36864
  v_cvt_pk_bf16_f32 v100, v72, v73
  v_exp_f32 v76, v76
  v_exp_f32 v77, v77
  ds_read_b128 v[52:55], v3 offset:37888
  v_cvt_pk_bf16_f32 v101, v74, v75
  v_exp_f32 v78, v78
  s_add_u32 m0, s31, 66560
  s_add_u32 s29, s53, s27
  s_add_u32 s29, s29, 1024
  buffer_load_dwordx4 v2, s[8:11], s29 offen sc1 lds
  v_exp_f32 v79, v79
  v_cvt_pk_bf16_f32 v102, v76, v77
  v_cvt_pk_bf16_f32 v103, v78, v79
  s_waitcnt lgkmcnt(4)
  v_mfma_f32_32x32x16_bf16 v[112:127], v[56:59], v[96:99], v[112:127]
  v_exp_f32 v80, v80
  v_exp_f32 v81, v81
  v_exp_f32 v82, v82
  v_exp_f32 v83, v83
  v_mfma_f32_32x32x16_bf16 v[112:127], v[60:63], v[100:103], v[112:127]
  v_cvt_pk_bf16_f32 v104, v80, v81
  v_exp_f32 v84, v84
  v_exp_f32 v85, v85
  v_cvt_pk_bf16_f32 v105, v82, v83
  v_exp_f32 v86, v86
  s_waitcnt lgkmcnt(2)
  v_mfma_f32_32x32x16_bf16 v[64:79], v[32:35], v[192:195], 0
  v_exp_f32 v87, v87
  v_cvt_pk_bf16_f32 v106, v84, v85
  v_exp_f32 v88, v88
  v_exp_f32 v89, v89
  v_cvt_pk_bf16_f32 v107, v86, v87
  v_mfma_f32_32x32x16_bf16 v[64:79], v[36:39], v[196:199], v[64:79]
  v_exp_f32 v90, v90
  v_exp_f32 v91, v91
  ds_read_b128 v[40:43], v3 offset:6144
  v_cvt_pk_bf16_f32 v108, v88, v89
  v_exp_f32 v92, v92
  v_exp_f32 v93, v93
  ds_read_b128 v[44:47], v3 offset:7168
  v_cvt_pk_bf16_f32 v109, v90, v91
  v_exp_f32 v94, v94
  v_exp_f32 v95, v95
  v_cvt_pk_bf16_f32 v110, v92, v93
  v_cvt_pk_bf16_f32 v111, v94, v95
  v_mfma_f32_32x32x16_bf16 v[128:143], v[56:59], v[104:107], v[128:143]
  v_exp_f32 v64, v64
  v_exp_f32 v65, v65
  v_exp_f32 v66, v66
  v_exp_f32 v67, v67
  v_mfma_f32_32x32x16_bf16 v[128:143], v[60:63], v[108:111], v[128:143]
  v_cvt_pk_bf16_f32 v96, v64, v65
  v_exp_f32 v68, v68
  v_exp_f32 v69, v69
  v_cvt_pk_bf16_f32 v97, v66, v67
  v_exp_f32 v70, v70
  v_mfma_f32_32x32x16_bf16 v[80:95], v[32:35], v[200:203], 0
  v_exp_f32 v71, v71
  v_cvt_pk_bf16_f32 v98, v68, v69
  v_exp_f32 v72, v72
  v_exp_f32 v73, v73
  v_cvt_pk_bf16_f32 v99, v70, v71
  v_mfma_f32_32x32x16_bf16 v[80:95], v[36:39], v[204:207], v[80:95]
  v_exp_f32 v74, v74
  v_exp_f32 v75, v75
  ds_read_b128 v[56:59], v3 offset:38912
  v_cvt_pk_bf16_f32 v100, v72, v73
  v_exp_f32 v76, v76
  v_exp_f32 v77, v77
  ds_read_b128 v[60:63], v3 offset:39936
  v_cvt_pk_bf16_f32 v101, v74, v75
  v_exp_f32 v78, v78
  s_add_u32 m0, s31, 67584
  s_add_u32 s29, s53, s27
  s_add_u32 s29, s29, 2048
  buffer_load_dwordx4 v2, s[8:11], s29 offen sc1 lds
  v_exp_f32 v79, v79
  v_cvt_pk_bf16_f32 v102, v76, v77
  v_cvt_pk_bf16_f32 v103, v78, v79
  s_waitcnt lgkmcnt(4)
  v_mfma_f32_32x32x16_bf16 v[112:127], v[48:51], v[96:99], v[112:127]
  v_exp_f32 v80, v80
  v_exp_f32 v81, v81
  v_exp_f32 v82, v82
  v_exp_f32 v83, v83
  v_mfma_f32_32x32x16_bf16 v[112:127], v[52:55], v[100:103], v[112:127]
  v_cvt_pk_bf16_f32 v104, v80, v81
  v_exp_f32 v84, v84
  v_exp_f32 v85, v85
  v_cvt_pk_bf16_f32 v105, v82, v83
  v_exp_f32 v86, v86
  s_waitcnt lgkmcnt(2)
  v_mfma_f32_32x32x16_bf16 v[64:79], v[40:43], v[192:195], 0
  v_exp_f32 v87, v87
  v_cvt_pk_bf16_f32 v106, v84, v85
  v_exp_f32 v88, v88
  v_exp_f32 v89, v89
  v_cvt_pk_bf16_f32 v107, v86, v87
  v_mfma_f32_32x32x16_bf16 v[64:79], v[44:47], v[196:199], v[64:79]
  v_exp_f32 v90, v90
  v_exp_f32 v91, v91
  ds_read_b128 v[32:35], v3 offset:8192
  v_cvt_pk_bf16_f32 v108, v88, v89
  v_exp_f32 v92, v92
  v_exp_f32 v93, v93
  ds_read_b128 v[36:39], v3 offset:9216
  v_cvt_pk_bf16_f32 v109, v90, v91
  v_exp_f32 v94, v94
  v_exp_f32 v95, v95
  v_cvt_pk_bf16_f32 v110, v92, v93
  v_cvt_pk_bf16_f32 v111, v94, v95
  v_mfma_f32_32x32x16_bf16 v[128:143], v[48:51], v[104:107], v[128:143]
  v_exp_f32 v64, v64
  v_exp_f32 v65, v65
  v_exp_f32 v66, v66
  v_exp_f32 v67, v67
  v_mfma_f32_32x32x16_bf16 v[128:143], v[52:55], v[108:111], v[128:143]
  v_cvt_pk_bf16_f32 v96, v64, v65
  v_exp_f32 v68, v68
  v_exp_f32 v69, v69
  v_cvt_pk_bf16_f32 v97, v66, v67
  v_exp_f32 v70, v70
  v_mfma_f32_32x32x16_bf16 v[80:95], v[40:43], v[200:203], 0
  v_exp_f32 v71, v71
  v_cvt_pk_bf16_f32 v98, v68, v69
  v_exp_f32 v72, v72
  v_exp_f32 v73, v73
  v_cvt_pk_bf16_f32 v99, v70, v71
  v_mfma_f32_32x32x16_bf16 v[80:95], v[44:47], v[204:207], v[80:95]
  v_exp_f32 v74, v74
  v_exp_f32 v75, v75
  ds_read_b128 v[48:51], v3 offset:40960
  v_cvt_pk_bf16_f32 v100, v72, v73
  v_exp_f32 v76, v76
  v_exp_f32 v77, v77
  ds_read_b128 v[52:55], v3 offset:41984
  v_cvt_pk_bf16_f32 v101, v74, v75
  v_exp_f32 v78, v78
  s_add_u32 m0, s31, 68608
  s_add_u32 s29, s53, s27
  s_add_u32 s29, s29, 3072
  buffer_load_dwordx4 v2, s[8:11], s29 offen sc1 lds
  v_exp_f32 v79, v79
  v_cvt_pk_bf16_f32 v102, v76, v77
  v_cvt_pk_bf16_f32 v103, v78, v79
  s_waitcnt lgkmcnt(4)
  v_mfma_f32_32x32x16_bf16 v[112:127], v[56:59], v[96:99], v[112:127]
  v_exp_f32 v80, v80
  v_exp_f32 v81, v81
  v_exp_f32 v82, v82
  v_exp_f32 v83, v83
  v_mfma_f32_32x32x16_bf16 v[112:127], v[60:63], v[100:103], v[112:127]
  v_cvt_pk_bf16_f32 v104, v80, v81
  v_exp_f32 v84, v84
  v_exp_f32 v85, v85
  v_cvt_pk_bf16_f32 v105, v82, v83
  v_exp_f32 v86, v86
  s_waitcnt lgkmcnt(2)
  v_mfma_f32_32x32x16_bf16 v[64:79], v[32:35], v[192:195], 0
  v_exp_f32 v87, v87
  v_cvt_pk_bf16_f32 v106, v84, v85
  v_exp_f32 v88, v88
  v_exp_f32 v89, v89
  v_cvt_pk_bf16_f32 v107, v86, v87
  v_mfma_f32_32x32x16_bf16 v[64:79], v[36:39], v[196:199], v[64:79]
  v_exp_f32 v90, v90
  v_exp_f32 v91, v91
  ds_read_b128 v[40:43], v3 offset:10240
  v_cvt_pk_bf16_f32 v108, v88, v89
  v_exp_f32 v92, v92
  v_exp_f32 v93, v93
  ds_read_b128 v[44:47], v3 offset:11264
  v_cvt_pk_bf16_f32 v109, v90, v91
  v_exp_f32 v94, v94
  v_exp_f32 v95, v95
  v_cvt_pk_bf16_f32 v110, v92, v93
  v_cvt_pk_bf16_f32 v111, v94, v95
  v_mfma_f32_32x32x16_bf16 v[128:143], v[56:59], v[104:107], v[128:143]
  v_exp_f32 v64, v64
  v_exp_f32 v65, v65
  v_exp_f32 v66, v66
  v_exp_f32 v67, v67
  v_mfma_f32_32x32x16_bf16 v[128:143], v[60:63], v[108:111], v[128:143]
  v_cvt_pk_bf16_f32 v96, v64, v65
  v_exp_f32 v68, v68
  v_exp_f32 v69, v69
  v_cvt_pk_bf16_f32 v97, v66, v67
  v_exp_f32 v70, v70
  v_mfma_f32_32x32x16_bf16 v[80:95], v[32:35], v[200:203], 0
  v_exp_f32 v71, v71
  v_cvt_pk_bf16_f32 v98, v68, v69
  v_exp_f32 v72, v72
  v_exp_f32 v73, v73
  v_cvt_pk_bf16_f32 v99, v70, v71
  v_mfma_f32_32x32x16_bf16 v[80:95], v[36:39], v[204:207], v[80:95]
  v_exp_f32 v74, v74
  v_exp_f32 v75, v75
  ds_read_b128 v[56:59], v3 offset:43008
  v_cvt_pk_bf16_f32 v100, v72, v73
  v_exp_f32 v76, v76
  v_exp_f32 v77, v77
  ds_read_b128 v[60:63], v3 offset:44032
  v_cvt_pk_bf16_f32 v101, v74, v75
  v_exp_f32 v78, v78
  s_add_u32 m0, s31, 69632
  s_add_u32 s29, s53, s27
  s_add_u32 s29, s29, 4096
  buffer_load_dwordx4 v2, s[8:11], s29 offen sc1 lds
  v_exp_f32 v79, v79
  v_cvt_pk_bf16_f32 v102, v76, v77
  v_cvt_pk_bf16_f32 v103, v78, v79
  s_waitcnt lgkmcnt(4)
  v_mfma_f32_32x32x16_bf16 v[112:127], v[48:51], v[96:99], v[112:127]
  v_exp_f32 v80, v80
  v_exp_f32 v81, v81
  v_exp_f32 v82, v82
  v_exp_f32 v83, v83
  v_mfma_f32_32x32x16_bf16 v[112:127], v[52:55], v[100:103], v[112:127]
  v_cvt_pk_bf16_f32 v104, v80, v81
  v_exp_f32 v84, v84
  v_exp_f32 v85, v85
  v_cvt_pk_bf16_f32 v105, v82, v83
  v_exp_f32 v86, v86
  s_waitcnt lgkmcnt(2)
  v_mfma_f32_32x32x16_bf16 v[64:79], v[40:43], v[192:195], 0
  v_exp_f32 v87, v87
  v_cvt_pk_bf16_f32 v106, v84, v85
  v_exp_f32 v88, v88
  v_exp_f32 v89, v89
  v_cvt_pk_bf16_f32 v107, v86, v87
  v_mfma_f32_32x32x16_bf16 v[64:79], v[44:47], v[196:199], v[64:79]
  v_exp_f32 v90, v90
  v_exp_f32 v91, v91
  ds_read_b128 v[32:35], v3 offset:12288
  v_cvt_pk_bf16_f32 v108, v88, v89
  v_exp_f32 v92, v92
  v_exp_f32 v93, v93
  ds_read_b128 v[36:39], v3 offset:13312
  v_cvt_pk_bf16_f32 v109, v90, v91
  v_exp_f32 v94, v94
  v_exp_f32 v95, v95
  v_cvt_pk_bf16_f32 v110, v92, v93
  v_cvt_pk_bf16_f32 v111, v94, v95
  v_mfma_f32_32x32x16_bf16 v[128:143], v[48:51], v[104:107], v[128:143]
  v_exp_f32 v64, v64
  v_exp_f32 v65, v65
  v_exp_f32 v66, v66
  v_exp_f32 v67, v67
  v_mfma_f32_32x32x16_bf16 v[128:143], v[52:55], v[108:111], v[128:143]
  v_cvt_pk_bf16_f32 v96, v64, v65
  v_exp_f32 v68, v68
  v_exp_f32 v69, v69
  v_cvt_pk_bf16_f32 v97, v66, v67
  v_exp_f32 v70, v70
  v_mfma_f32_32x32x16_bf16 v[80:95], v[40:43], v[200:203], 0
  v_exp_f32 v71, v71
  v_cvt_pk_bf16_f32 v98, v68, v69
  v_exp_f32 v72, v72
  v_exp_f32 v73, v73
  v_cvt_pk_bf16_f32 v99, v70, v71
  v_mfma_f32_32x32x16_bf16 v[80:95], v[44:47], v[204:207], v[80:95]
  v_exp_f32 v74, v74
  v_exp_f32 v75, v75
  ds_read_b128 v[48:51], v3 offset:45056
  v_cvt_pk_bf16_f32 v100, v72, v73
  v_exp_f32 v76, v76
  v_exp_f32 v77, v77
  ds_read_b128 v[52:55], v3 offset:46080
  v_cvt_pk_bf16_f32 v101, v74, v75
  v_exp_f32 v78, v78
  s_add_u32 m0, s31, 70656
  s_add_u32 s29, s53, s27
  s_add_u32 s29, s29, 5120
  buffer_load_dwordx4 v2, s[8:11], s29 offen sc1 lds
  v_exp_f32 v79, v79
  v_cvt_pk_bf16_f32 v102, v76, v77
  v_cvt_pk_bf16_f32 v103, v78, v79
  s_waitcnt lgkmcnt(4)
  v_mfma_f32_32x32x16_bf16 v[112:127], v[56:59], v[96:99], v[112:127]
  v_exp_f32 v80, v80
  v_exp_f32 v81, v81
  v_exp_f32 v82, v82
  v_exp_f32 v83, v83
  v_mfma_f32_32x32x16_bf16 v[112:127], v[60:63], v[100:103], v[112:127]
  v_cvt_pk_bf16_f32 v104, v80, v81
  v_exp_f32 v84, v84
  v_exp_f32 v85, v85
  v_cvt_pk_bf16_f32 v105, v82, v83
  v_exp_f32 v86, v86
  s_waitcnt lgkmcnt(2)
  v_mfma_f32_32x32x16_bf16 v[64:79], v[32:35], v[192:195], 0
  v_exp_f32 v87, v87
  v_cvt_pk_bf16_f32 v106, v84, v85
  v_exp_f32 v88, v88
  v_exp_f32 v89, v89
  v_cvt_pk_bf16_f32 v107, v86, v87
  v_mfma_f32_32x32x16_bf16 v[64:79], v[36:39], v[196:199], v[64:79]
  v_exp_f32 v90, v90
  v_exp_f32 v91, v91
  ds_read_b128 v[40:43], v3 offset:14336
  v_cvt_pk_bf16_f32 v108, v88, v89
  v_exp_f32 v92, v92
  v_exp_f32 v93, v93
  ds_read_b128 v[44:47], v3 offset:15360
  v_cvt_pk_bf16_f32 v109, v90, v91
  v_exp_f32 v94, v94
  v_exp_f32 v95, v95
  v_cvt_pk_bf16_f32 v110, v92, v93
  v_cvt_pk_bf16_f32 v111, v94, v95
  v_mfma_f32_32x32x16_bf16 v[128:143], v[56:59], v[104:107], v[128:143]
  v_exp_f32 v64, v64
  v_exp_f32 v65, v65
  v_exp_f32 v66, v66
  v_exp_f32 v67, v67
  v_mfma_f32_32x32x16_bf16 v[128:143], v[60:63], v[108:111], v[128:143]
  v_cvt_pk_bf16_f32 v96, v64, v65
  v_exp_f32 v68, v68
  v_exp_f32 v69, v69
  v_cvt_pk_bf16_f32 v97, v66, v67
  v_exp_f32 v70, v70
  v_mfma_f32_32x32x16_bf16 v[80:95], v[32:35], v[200:203], 0
  v_exp_f32 v71, v71
  v_cvt_pk_bf16_f32 v98, v68, v69
  v_exp_f32 v72, v72
  v_exp_f32 v73, v73
  v_cvt_pk_bf16_f32 v99, v70, v71
  v_mfma_f32_32x32x16_bf16 v[80:95], v[36:39], v[204:207], v[80:95]
  v_exp_f32 v74, v74
  v_exp_f32 v75, v75
  ds_read_b128 v[56:59], v3 offset:47104
  v_cvt_pk_bf16_f32 v100, v72, v73
  v_exp_f32 v76, v76
  v_exp_f32 v77, v77
  ds_read_b128 v[60:63], v3 offset:48128
  v_cvt_pk_bf16_f32 v101, v74, v75
  v_exp_f32 v78, v78
  s_add_u32 m0, s31, 71680
  s_add_u32 s29, s53, s27
  s_add_u32 s29, s29, 6144
  buffer_load_dwordx4 v2, s[8:11], s29 offen sc1 lds
  v_exp_f32 v79, v79
  v_cvt_pk_bf16_f32 v102, v76, v77
  v_cvt_pk_bf16_f32 v103, v78, v79
  s_waitcnt lgkmcnt(4)
  v_mfma_f32_32x32x16_bf16 v[112:127], v[48:51], v[96:99], v[112:127]
  v_exp_f32 v80, v80
  v_exp_f32 v81, v81
  v_exp_f32 v82, v82
  v_exp_f32 v83, v83
  v_mfma_f32_32x32x16_bf16 v[112:127], v[52:55], v[100:103], v[112:127]
  v_cvt_pk_bf16_f32 v104, v80, v81
  v_exp_f32 v84, v84
  v_exp_f32 v85, v85
  v_cvt_pk_bf16_f32 v105, v82, v83
  v_exp_f32 v86, v86
  s_waitcnt lgkmcnt(2)
  v_mfma_f32_32x32x16_bf16 v[64:79], v[40:43], v[192:195], 0
  v_exp_f32 v87, v87
  v_cvt_pk_bf16_f32 v106, v84, v85
  v_exp_f32 v88, v88
  v_exp_f32 v89, v89
  v_cvt_pk_bf16_f32 v107, v86, v87
  v_mfma_f32_32x32x16_bf16 v[64:79], v[44:47], v[196:199], v[64:79]
  v_exp_f32 v90, v90
  v_exp_f32 v91, v91
  ds_read_b128 v[32:35], v3 offset:16384
  v_cvt_pk_bf16_f32 v108, v88, v89
  v_exp_f32 v92, v92
  v_exp_f32 v93, v93
  ds_read_b128 v[36:39], v3 offset:17408
  v_cvt_pk_bf16_f32 v109, v90, v91
  v_exp_f32 v94, v94
  v_exp_f32 v95, v95
  v_cvt_pk_bf16_f32 v110, v92, v93
  v_cvt_pk_bf16_f32 v111, v94, v95
  v_mfma_f32_32x32x16_bf16 v[128:143], v[48:51], v[104:107], v[128:143]
  v_exp_f32 v64, v64
  v_exp_f32 v65, v65
  v_exp_f32 v66, v66
  v_exp_f32 v67, v67
  v_mfma_f32_32x32x16_bf16 v[128:143], v[52:55], v[108:111], v[128:143]
  v_cvt_pk_bf16_f32 v96, v64, v65
  v_exp_f32 v68, v68
  v_exp_f32 v69, v69
  v_cvt_pk_bf16_f32 v97, v66, v67
  v_exp_f32 v70, v70
  v_mfma_f32_32x32x16_bf16 v[80:95], v[40:43], v[200:203], 0
  v_exp_f32 v71, v71
  v_cvt_pk_bf16_f32 v98, v68, v69
  v_exp_f32 v72, v72
  v_exp_f32 v73, v73
  v_cvt_pk_bf16_f32 v99, v70, v71
  v_mfma_f32_32x32x16_bf16 v[80:95], v[44:47], v[204:207], v[80:95]
  v_exp_f32 v74, v74
  v_exp_f32 v75, v75
  ds_read_b128 v[48:51], v3 offset:49152
  v_cvt_pk_bf16_f32 v100, v72, v73
  v_exp_f32 v76, v76
  v_exp_f32 v77, v77
  ds_read_b128 v[52:55], v3 offset:50176
  v_cvt_pk_bf16_f32 v101, v74, v75
  v_exp_f32 v78, v78
  s_add_u32 m0, s31, 72704
  s_add_u32 s29, s53, s27
  s_add_u32 s29, s29, 7168
  buffer_load_dwordx4 v2, s[8:11], s29 offen sc1 lds
  v_exp_f32 v79, v79
  v_cvt_pk_bf16_f32 v102, v76, v77
  v_cvt_pk_bf16_f32 v103, v78, v79
  s_waitcnt lgkmcnt(4)
  v_mfma_f32_32x32x16_bf16 v[112:127], v[56:59], v[96:99], v[112:127]
  v_exp_f32 v80, v80
  v_exp_f32 v81, v81
  v_exp_f32 v82, v82
  v_exp_f32 v83, v83
  v_mfma_f32_32x32x16_bf16 v[112:127], v[60:63], v[100:103], v[112:127]
  v_cvt_pk_bf16_f32 v104, v80, v81
  v_exp_f32 v84, v84
  v_exp_f32 v85, v85
  v_cvt_pk_bf16_f32 v105, v82, v83
  v_exp_f32 v86, v86
  s_waitcnt lgkmcnt(2)
  v_mfma_f32_32x32x16_bf16 v[64:79], v[32:35], v[192:195], 0
  v_exp_f32 v87, v87
  v_cvt_pk_bf16_f32 v106, v84, v85
  v_exp_f32 v88, v88
  v_exp_f32 v89, v89
  v_cvt_pk_bf16_f32 v107, v86, v87
  v_mfma_f32_32x32x16_bf16 v[64:79], v[36:39], v[196:199], v[64:79]
  v_exp_f32 v90, v90
  v_exp_f32 v91, v91
  ds_read_b128 v[40:43], v3 offset:18432
  v_cvt_pk_bf16_f32 v108, v88, v89
  v_exp_f32 v92, v92
  v_exp_f32 v93, v93
  ds_read_b128 v[44:47], v3 offset:19456
  v_cvt_pk_bf16_f32 v109, v90, v91
  v_exp_f32 v94, v94
  v_exp_f32 v95, v95
  v_cvt_pk_bf16_f32 v110, v92, v93
  v_cvt_pk_bf16_f32 v111, v94, v95
  v_mfma_f32_32x32x16_bf16 v[128:143], v[56:59], v[104:107], v[128:143]
  v_exp_f32 v64, v64
  v_exp_f32 v65, v65
  v_exp_f32 v66, v66
  v_exp_f32 v67, v67
  v_mfma_f32_32x32x16_bf16 v[128:143], v[60:63], v[108:111], v[128:143]
  v_cvt_pk_bf16_f32 v96, v64, v65
  v_exp_f32 v68, v68
  v_exp_f32 v69, v69
  v_cvt_pk_bf16_f32 v97, v66, v67
  v_exp_f32 v70, v70
  v_mfma_f32_32x32x16_bf16 v[80:95], v[32:35], v[200:203], 0
  v_exp_f32 v71, v71
  v_cvt_pk_bf16_f32 v98, v68, v69
  v_exp_f32 v72, v72
  v_exp_f32 v73, v73
  v_cvt_pk_bf16_f32 v99, v70, v71
  v_mfma_f32_32x32x16_bf16 v[80:95], v[36:39], v[204:207], v[80:95]
  v_exp_f32 v74, v74
  v_exp_f32 v75, v75
  ds_read_b128 v[56:59], v3 offset:51200
  v_cvt_pk_bf16_f32 v100, v72, v73
  v_exp_f32 v76, v76
  v_exp_f32 v77, v77
  ds_read_b128 v[60:63], v3 offset:52224
  v_cvt_pk_bf16_f32 v101, v74, v75
  v_exp_f32 v78, v78
  s_add_u32 m0, s31, 98304
  s_add_u32 s29, s53, s28
  s_add_u32 s29, s29, 0
  buffer_load_dwordx4 v2, s[8:11], s29 offen sc1 lds
  v_exp_f32 v79, v79
  v_cvt_pk_bf16_f32 v102, v76, v77
  v_cvt_pk_bf16_f32 v103, v78, v79
  s_waitcnt lgkmcnt(4)
  v_mfma_f32_32x32x16_bf16 v[112:127], v[48:51], v[96:99], v[112:127]
  v_exp_f32 v80, v80
  v_exp_f32 v81, v81
  v_exp_f32 v82, v82
  v_exp_f32 v83, v83
  v_mfma_f32_32x32x16_bf16 v[112:127], v[52:55], v[100:103], v[112:127]
  v_cvt_pk_bf16_f32 v104, v80, v81
  v_exp_f32 v84, v84
  v_exp_f32 v85, v85
  v_cvt_pk_bf16_f32 v105, v82, v83
  v_exp_f32 v86, v86
  s_waitcnt lgkmcnt(2)
  v_mfma_f32_32x32x16_bf16 v[64:79], v[40:43], v[192:195], 0
  v_exp_f32 v87, v87
  v_cvt_pk_bf16_f32 v106, v84, v85
  v_exp_f32 v88, v88
  v_exp_f32 v89, v89
  v_cvt_pk_bf16_f32 v107, v86, v87
  v_mfma_f32_32x32x16_bf16 v[64:79], v[44:47], v[196:199], v[64:79]
  v_exp_f32 v90, v90
  v_exp_f32 v91, v91
  ds_read_b128 v[32:35], v3 offset:20480
  v_cvt_pk_bf16_f32 v108, v88, v89
  v_exp_f32 v92, v92
  v_exp_f32 v93, v93
  ds_read_b128 v[36:39], v3 offset:21504
  v_cvt_pk_bf16_f32 v109, v90, v91
  v_exp_f32 v94, v94
  v_exp_f32 v95, v95
  v_cvt_pk_bf16_f32 v110, v92, v93
  v_cvt_pk_bf16_f32 v111, v94, v95
  v_mfma_f32_32x32x16_bf16 v[128:143], v[48:51], v[104:107], v[128:143]
  v_exp_f32 v64, v64
  v_exp_f32 v65, v65
  v_exp_f32 v66, v66
  v_exp_f32 v67, v67
  v_mfma_f32_32x32x16_bf16 v[128:143], v[52:55], v[108:111], v[128:143]
  v_cvt_pk_bf16_f32 v96, v64, v65
  v_exp_f32 v68, v68
  v_exp_f32 v69, v69
  v_cvt_pk_bf16_f32 v97, v66, v67
  v_exp_f32 v70, v70
  v_mfma_f32_32x32x16_bf16 v[80:95], v[40:43], v[200:203], 0
  v_exp_f32 v71, v71
  v_cvt_pk_bf16_f32 v98, v68, v69
  v_exp_f32 v72, v72
  v_exp_f32 v73, v73
  v_cvt_pk_bf16_f32 v99, v70, v71
  v_mfma_f32_32x32x16_bf16 v[80:95], v[44:47], v[204:207], v[80:95]
  v_exp_f32 v74, v74
  v_exp_f32 v75, v75
  ds_read_b128 v[48:51], v3 offset:53248
  v_cvt_pk_bf16_f32 v100, v72, v73
  v_exp_f32 v76, v76
  v_exp_f32 v77, v77
  ds_read_b128 v[52:55], v3 offset:54272
  v_cvt_pk_bf16_f32 v101, v74, v75
  v_exp_f32 v78, v78
  s_add_u32 m0, s31, 99328
  s_add_u32 s29, s53, s28
  s_add_u32 s29, s29, 1024
  buffer_load_dwordx4 v2, s[8:11], s29 offen sc1 lds
  v_exp_f32 v79, v79
  v_cvt_pk_bf16_f32 v102, v76, v77
  v_cvt_pk_bf16_f32 v103, v78, v79
  s_waitcnt lgkmcnt(4)
  v_mfma_f32_32x32x16_bf16 v[112:127], v[56:59], v[96:99], v[112:127]
  v_exp_f32 v80, v80
  v_exp_f32 v81, v81
  v_exp_f32 v82, v82
  v_exp_f32 v83, v83
  v_mfma_f32_32x32x16_bf16 v[112:127], v[60:63], v[100:103], v[112:127]
  v_cvt_pk_bf16_f32 v104, v80, v81
  v_exp_f32 v84, v84
  v_exp_f32 v85, v85
  v_cvt_pk_bf16_f32 v105, v82, v83
  v_exp_f32 v86, v86
  s_waitcnt lgkmcnt(2)
  v_mfma_f32_32x32x16_bf16 v[64:79], v[32:35], v[192:195], 0
  v_exp_f32 v87, v87
  v_cvt_pk_bf16_f32 v106, v84, v85
  v_exp_f32 v88, v88
  v_exp_f32 v89, v89
  v_cvt_pk_bf16_f32 v107, v86, v87
  v_mfma_f32_32x32x16_bf16 v[64:79], v[36:39], v[196:199], v[64:79]
  v_exp_f32 v90, v90
  v_exp_f32 v91, v91
  ds_read_b128 v[40:43], v3 offset:22528
  v_cvt_pk_bf16_f32 v108, v88, v89
  v_exp_f32 v92, v92
  v_exp_f32 v93, v93
  ds_read_b128 v[44:47], v3 offset:23552
  v_cvt_pk_bf16_f32 v109, v90, v91
  v_exp_f32 v94, v94
  v_exp_f32 v95, v95
  v_cvt_pk_bf16_f32 v110, v92, v93
  v_cvt_pk_bf16_f32 v111, v94, v95
  v_mfma_f32_32x32x16_bf16 v[128:143], v[56:59], v[104:107], v[128:143]
  v_exp_f32 v64, v64
  v_exp_f32 v65, v65
  v_exp_f32 v66, v66
  v_exp_f32 v67, v67
  v_mfma_f32_32x32x16_bf16 v[128:143], v[60:63], v[108:111], v[128:143]
  v_cvt_pk_bf16_f32 v96, v64, v65
  v_exp_f32 v68, v68
  v_exp_f32 v69, v69
  v_cvt_pk_bf16_f32 v97, v66, v67
  v_exp_f32 v70, v70
  v_mfma_f32_32x32x16_bf16 v[80:95], v[32:35], v[200:203], 0
  v_exp_f32 v71, v71
  v_cvt_pk_bf16_f32 v98, v68, v69
  v_exp_f32 v72, v72
  v_exp_f32 v73, v73
  v_cvt_pk_bf16_f32 v99, v70, v71
  v_mfma_f32_32x32x16_bf16 v[80:95], v[36:39], v[204:207], v[80:95]
  v_exp_f32 v74, v74
  v_exp_f32 v75, v75
  ds_read_b128 v[56:59], v3 offset:55296
  v_cvt_pk_bf16_f32 v100, v72, v73
  v_exp_f32 v76, v76
  v_exp_f32 v77, v77
  ds_read_b128 v[60:63], v3 offset:56320
  v_cvt_pk_bf16_f32 v101, v74, v75
  v_exp_f32 v78, v78
  s_add_u32 m0, s31, 100352
  s_add_u32 s29, s53, s28
  s_add_u32 s29, s29, 2048
  buffer_load_dwordx4 v2, s[8:11], s29 offen sc1 lds
  v_exp_f32 v79, v79
  v_cvt_pk_bf16_f32 v102, v76, v77
  v_cvt_pk_bf16_f32 v103, v78, v79
  s_waitcnt lgkmcnt(4)
  v_mfma_f32_32x32x16_bf16 v[112:127], v[48:51], v[96:99], v[112:127]
  v_exp_f32 v80, v80
  v_exp_f32 v81, v81
  v_exp_f32 v82, v82
  v_exp_f32 v83, v83
  v_mfma_f32_32x32x16_bf16 v[112:127], v[52:55], v[100:103], v[112:127]
  v_cvt_pk_bf16_f32 v104, v80, v81
  v_exp_f32 v84, v84
  v_exp_f32 v85, v85
  v_cvt_pk_bf16_f32 v105, v82, v83
  v_exp_f32 v86, v86
  s_waitcnt lgkmcnt(2)
  v_mfma_f32_32x32x16_bf16 v[64:79], v[40:43], v[192:195], 0
  v_exp_f32 v87, v87
  v_cvt_pk_bf16_f32 v106, v84, v85
  v_exp_f32 v88, v88
  v_exp_f32 v89, v89
  v_cvt_pk_bf16_f32 v107, v86, v87
  v_mfma_f32_32x32x16_bf16 v[64:79], v[44:47], v[196:199], v[64:79]
  v_exp_f32 v90, v90
  v_exp_f32 v91, v91
  ds_read_b128 v[32:35], v3 offset:24576
  v_cvt_pk_bf16_f32 v108, v88, v89
  v_exp_f32 v92, v92
  v_exp_f32 v93, v93
  ds_read_b128 v[36:39], v3 offset:25600
  v_cvt_pk_bf16_f32 v109, v90, v91
  v_exp_f32 v94, v94
  v_exp_f32 v95, v95
  v_cvt_pk_bf16_f32 v110, v92, v93
  v_cvt_pk_bf16_f32 v111, v94, v95
  v_mfma_f32_32x32x16_bf16 v[128:143], v[48:51], v[104:107], v[128:143]
  v_exp_f32 v64, v64
  v_exp_f32 v65, v65
  v_exp_f32 v66, v66
  v_exp_f32 v67, v67
  v_mfma_f32_32x32x16_bf16 v[128:143], v[52:55], v[108:111], v[128:143]
  v_cvt_pk_bf16_f32 v96, v64, v65
  v_exp_f32 v68, v68
  v_exp_f32 v69, v69
  v_cvt_pk_bf16_f32 v97, v66, v67
  v_exp_f32 v70, v70
  v_mfma_f32_32x32x16_bf16 v[80:95], v[40:43], v[200:203], 0
  v_exp_f32 v71, v71
  v_cvt_pk_bf16_f32 v98, v68, v69
  v_exp_f32 v72, v72
  v_exp_f32 v73, v73
  v_cvt_pk_bf16_f32 v99, v70, v71
  v_mfma_f32_32x32x16_bf16 v[80:95], v[44:47], v[204:207], v[80:95]
  v_exp_f32 v74, v74
  v_exp_f32 v75, v75
  ds_read_b128 v[48:51], v3 offset:57344
  v_cvt_pk_bf16_f32 v100, v72, v73
  v_exp_f32 v76, v76
  v_exp_f32 v77, v77
  ds_read_b128 v[52:55], v3 offset:58368
  v_cvt_pk_bf16_f32 v101, v74, v75
  v_exp_f32 v78, v78
  s_add_u32 m0, s31, 101376
  s_add_u32 s29, s53, s28
  s_add_u32 s29, s29, 3072
  buffer_load_dwordx4 v2, s[8:11], s29 offen sc1 lds
  v_exp_f32 v79, v79
  v_cvt_pk_bf16_f32 v102, v76, v77
  v_cvt_pk_bf16_f32 v103, v78, v79
  s_waitcnt lgkmcnt(4)
  v_mfma_f32_32x32x16_bf16 v[112:127], v[56:59], v[96:99], v[112:127]
  v_exp_f32 v80, v80
  v_exp_f32 v81, v81
  v_exp_f32 v82, v82
  v_exp_f32 v83, v83
  v_mfma_f32_32x32x16_bf16 v[112:127], v[60:63], v[100:103], v[112:127]
  v_cvt_pk_bf16_f32 v104, v80, v81
  v_exp_f32 v84, v84
  v_exp_f32 v85, v85
  v_cvt_pk_bf16_f32 v105, v82, v83
  v_exp_f32 v86, v86
  s_waitcnt lgkmcnt(2)
  v_mfma_f32_32x32x16_bf16 v[64:79], v[32:35], v[192:195], 0
  v_exp_f32 v87, v87
  v_cvt_pk_bf16_f32 v106, v84, v85
  v_exp_f32 v88, v88
  v_exp_f32 v89, v89
  v_cvt_pk_bf16_f32 v107, v86, v87
  v_mfma_f32_32x32x16_bf16 v[64:79], v[36:39], v[196:199], v[64:79]
  v_exp_f32 v90, v90
  v_exp_f32 v91, v91
  ds_read_b128 v[40:43], v3 offset:26624
  v_cvt_pk_bf16_f32 v108, v88, v89
  v_exp_f32 v92, v92
  v_exp_f32 v93, v93
  ds_read_b128 v[44:47], v3 offset:27648
  v_cvt_pk_bf16_f32 v109, v90, v91
  v_exp_f32 v94, v94
  v_exp_f32 v95, v95
  v_cvt_pk_bf16_f32 v110, v92, v93
  v_cvt_pk_bf16_f32 v111, v94, v95
  v_mfma_f32_32x32x16_bf16 v[128:143], v[56:59], v[104:107], v[128:143]
  v_exp_f32 v64, v64
  v_exp_f32 v65, v65
  v_exp_f32 v66, v66
  v_exp_f32 v67, v67
  v_mfma_f32_32x32x16_bf16 v[128:143], v[60:63], v[108:111], v[128:143]
  v_cvt_pk_bf16_f32 v96, v64, v65
  v_exp_f32 v68, v68
  v_exp_f32 v69, v69
  v_cvt_pk_bf16_f32 v97, v66, v67
  v_exp_f32 v70, v70
  v_mfma_f32_32x32x16_bf16 v[80:95], v[32:35], v[200:203], 0
  v_exp_f32 v71, v71
  v_cvt_pk_bf16_f32 v98, v68, v69
  v_exp_f32 v72, v72
  v_exp_f32 v73, v73
  v_cvt_pk_bf16_f32 v99, v70, v71
  v_mfma_f32_32x32x16_bf16 v[80:95], v[36:39], v[204:207], v[80:95]
  v_exp_f32 v74, v74
  v_exp_f32 v75, v75
  ds_read_b128 v[56:59], v3 offset:59392
  v_cvt_pk_bf16_f32 v100, v72, v73
  v_exp_f32 v76, v76
  v_exp_f32 v77, v77
  ds_read_b128 v[60:63], v3 offset:60416
  v_cvt_pk_bf16_f32 v101, v74, v75
  v_exp_f32 v78, v78
  s_add_u32 m0, s31, 102400
  s_add_u32 s29, s53, s28
  s_add_u32 s29, s29, 4096
  buffer_load_dwordx4 v2, s[8:11], s29 offen sc1 lds
  v_exp_f32 v79, v79
  v_cvt_pk_bf16_f32 v102, v76, v77
  v_cvt_pk_bf16_f32 v103, v78, v79
  s_waitcnt lgkmcnt(4)
  v_mfma_f32_32x32x16_bf16 v[112:127], v[48:51], v[96:99], v[112:127]
  v_exp_f32 v80, v80
  v_exp_f32 v81, v81
  v_exp_f32 v82, v82
  v_exp_f32 v83, v83
  v_mfma_f32_32x32x16_bf16 v[112:127], v[52:55], v[100:103], v[112:127]
  v_cvt_pk_bf16_f32 v104, v80, v81
  v_exp_f32 v84, v84
  v_exp_f32 v85, v85
  v_cvt_pk_bf16_f32 v105, v82, v83
  v_exp_f32 v86, v86
  s_waitcnt lgkmcnt(2)
  v_mfma_f32_32x32x16_bf16 v[64:79], v[40:43], v[192:195], 0
  v_exp_f32 v87, v87
  v_cvt_pk_bf16_f32 v106, v84, v85
  v_exp_f32 v88, v88
  v_exp_f32 v89, v89
  v_cvt_pk_bf16_f32 v107, v86, v87
  v_mfma_f32_32x32x16_bf16 v[64:79], v[44:47], v[196:199], v[64:79]
  v_exp_f32 v90, v90
  v_exp_f32 v91, v91
  ds_read_b128 v[32:35], v3 offset:28672
  v_cvt_pk_bf16_f32 v108, v88, v89
  v_exp_f32 v92, v92
  v_exp_f32 v93, v93
  ds_read_b128 v[36:39], v3 offset:29696
  v_cvt_pk_bf16_f32 v109, v90, v91
  v_exp_f32 v94, v94
  v_exp_f32 v95, v95
  v_cvt_pk_bf16_f32 v110, v92, v93
  v_cvt_pk_bf16_f32 v111, v94, v95
  v_mfma_f32_32x32x16_bf16 v[128:143], v[48:51], v[104:107], v[128:143]
  v_exp_f32 v64, v64
  v_exp_f32 v65, v65
  v_exp_f32 v66, v66
  v_exp_f32 v67, v67
  v_mfma_f32_32x32x16_bf16 v[128:143], v[52:55], v[108:111], v[128:143]
  v_cvt_pk_bf16_f32 v96, v64, v65
  v_exp_f32 v68, v68
  v_exp_f32 v69, v69
  v_cvt_pk_bf16_f32 v97, v66, v67
  v_exp_f32 v70, v70
  v_mfma_f32_32x32x16_bf16 v[80:95], v[40:43], v[200:203], 0
  v_exp_f32 v71, v71
  v_cvt_pk_bf16_f32 v98, v68, v69
  v_exp_f32 v72, v72
  v_exp_f32 v73, v73
  v_cvt_pk_bf16_f32 v99, v70, v71
  v_mfma_f32_32x32x16_bf16 v[80:95], v[44:47], v[204:207], v[80:95]
  v_exp_f32 v74, v74
  v_exp_f32 v75, v75
  ds_read_b128 v[48:51], v3 offset:61440
  v_cvt_pk_bf16_f32 v100, v72, v73
  v_exp_f32 v76, v76
  v_exp_f32 v77, v77
  ds_read_b128 v[52:55], v3 offset:62464
  v_cvt_pk_bf16_f32 v101, v74, v75
  v_exp_f32 v78, v78
  s_add_u32 m0, s31, 103424
  s_add_u32 s29, s53, s28
  s_add_u32 s29, s29, 5120
  buffer_load_dwordx4 v2, s[8:11], s29 offen sc1 lds
  v_exp_f32 v79, v79
  v_cvt_pk_bf16_f32 v102, v76, v77
  v_cvt_pk_bf16_f32 v103, v78, v79
  s_waitcnt lgkmcnt(4)
  v_mfma_f32_32x32x16_bf16 v[112:127], v[56:59], v[96:99], v[112:127]
  v_exp_f32 v80, v80
  v_exp_f32 v81, v81
  v_exp_f32 v82, v82
  v_exp_f32 v83, v83
  v_mfma_f32_32x32x16_bf16 v[112:127], v[60:63], v[100:103], v[112:127]
  v_cvt_pk_bf16_f32 v104, v80, v81
  v_exp_f32 v84, v84
  v_exp_f32 v85, v85
  v_cvt_pk_bf16_f32 v105, v82, v83
  v_exp_f32 v86, v86
  s_waitcnt lgkmcnt(2)
  v_mfma_f32_32x32x16_bf16 v[64:79], v[32:35], v[192:195], 0
  v_exp_f32 v87, v87
  v_cvt_pk_bf16_f32 v106, v84, v85
  v_exp_f32 v88, v88
  v_exp_f32 v89, v89
  v_cvt_pk_bf16_f32 v107, v86, v87
  v_mfma_f32_32x32x16_bf16 v[64:79], v[36:39], v[196:199], v[64:79]
  v_exp_f32 v90, v90
  v_exp_f32 v91, v91
  ds_read_b128 v[40:43], v3 offset:30720
  v_cvt_pk_bf16_f32 v108, v88, v89
  v_exp_f32 v92, v92
  v_exp_f32 v93, v93
  ds_read_b128 v[44:47], v3 offset:31744
  v_cvt_pk_bf16_f32 v109, v90, v91
  v_exp_f32 v94, v94
  v_exp_f32 v95, v95
  v_cvt_pk_bf16_f32 v110, v92, v93
  v_cvt_pk_bf16_f32 v111, v94, v95
  v_mfma_f32_32x32x16_bf16 v[128:143], v[56:59], v[104:107], v[128:143]
  v_exp_f32 v64, v64
  v_exp_f32 v65, v65
  v_exp_f32 v66, v66
  v_exp_f32 v67, v67
  v_mfma_f32_32x32x16_bf16 v[128:143], v[60:63], v[108:111], v[128:143]
  v_cvt_pk_bf16_f32 v96, v64, v65
  v_exp_f32 v68, v68
  v_exp_f32 v69, v69
  v_cvt_pk_bf16_f32 v97, v66, v67
  v_exp_f32 v70, v70
  v_mfma_f32_32x32x16_bf16 v[80:95], v[32:35], v[200:203], 0
  v_exp_f32 v71, v71
  v_cvt_pk_bf16_f32 v98, v68, v69
  v_exp_f32 v72, v72
  v_exp_f32 v73, v73
  v_cvt_pk_bf16_f32 v99, v70, v71
  v_mfma_f32_32x32x16_bf16 v[80:95], v[36:39], v[204:207], v[80:95]
  v_exp_f32 v74, v74
  v_exp_f32 v75, v75
  ds_read_b128 v[56:59], v3 offset:63488
  v_cvt_pk_bf16_f32 v100, v72, v73
  v_exp_f32 v76, v76
  v_exp_f32 v77, v77
  ds_read_b128 v[60:63], v3 offset:64512
  v_cvt_pk_bf16_f32 v101, v74, v75
  v_exp_f32 v78, v78
  s_add_u32 m0, s31, 104448
  s_add_u32 s29, s53, s28
  s_add_u32 s29, s29, 6144
  buffer_load_dwordx4 v2, s[8:11], s29 offen sc1 lds
  v_exp_f32 v79, v79
  v_cvt_pk_bf16_f32 v102, v76, v77
  v_cvt_pk_bf16_f32 v103, v78, v79
  s_waitcnt lgkmcnt(4)
  v_mfma_f32_32x32x16_bf16 v[112:127], v[48:51], v[96:99], v[112:127]
  v_exp_f32 v80, v80
  v_exp_f32 v81, v81
  v_exp_f32 v82, v82
  v_exp_f32 v83, v83
  v_mfma_f32_32x32x16_bf16 v[112:127], v[52:55], v[100:103], v[112:127]
  v_cvt_pk_bf16_f32 v104, v80, v81
  v_exp_f32 v84, v84
  v_exp_f32 v85, v85
  v_cvt_pk_bf16_f32 v105, v82, v83
  v_exp_f32 v86, v86
  s_waitcnt lgkmcnt(2)
  v_mfma_f32_32x32x16_bf16 v[64:79], v[40:43], v[192:195], 0
  v_exp_f32 v87, v87
  v_cvt_pk_bf16_f32 v106, v84, v85
  v_exp_f32 v88, v88
  v_exp_f32 v89, v89
  v_cvt_pk_bf16_f32 v107, v86, v87
  v_mfma_f32_32x32x16_bf16 v[64:79], v[44:47], v[196:199], v[64:79]
  v_exp_f32 v90, v90
  v_exp_f32 v91, v91
  v_cvt_pk_bf16_f32 v108, v88, v89
  v_exp_f32 v92, v92
  v_exp_f32 v93, v93
  v_cvt_pk_bf16_f32 v109, v90, v91
  v_exp_f32 v94, v94
  v_exp_f32 v95, v95
  v_cvt_pk_bf16_f32 v110, v92, v93
  v_cvt_pk_bf16_f32 v111, v94, v95
  v_mfma_f32_32x32x16_bf16 v[128:143], v[48:51], v[104:107], v[128:143]
  v_exp_f32 v64, v64
  v_exp_f32 v65, v65
  v_exp_f32 v66, v66
  v_exp_f32 v67, v67
  v_mfma_f32_32x32x16_bf16 v[128:143], v[52:55], v[108:111], v[128:143]
  v_cvt_pk_bf16_f32 v96, v64, v65
  v_exp_f32 v68, v68
  v_exp_f32 v69, v69
  v_cvt_pk_bf16_f32 v97, v66, v67
  v_exp_f32 v70, v70
  v_mfma_f32_32x32x16_bf16 v[80:95], v[40:43], v[200:203], 0
  v_exp_f32 v71, v71
  v_cvt_pk_bf16_f32 v98, v68, v69
  v_exp_f32 v72, v72
  v_exp_f32 v73, v73
  v_cvt_pk_bf16_f32 v99, v70, v71
  v_mfma_f32_32x32x16_bf16 v[80:95], v[44:47], v[204:207], v[80:95]
  v_exp_f32 v74, v74
  v_exp_f32 v75, v75
  v_cvt_pk_bf16_f32 v100, v72, v73
  v_exp_f32 v76, v76
  v_exp_f32 v77, v77
  v_cvt_pk_bf16_f32 v101, v74, v75
  v_exp_f32 v78, v78
  s_add_u32 m0, s31, 105472
  s_add_u32 s29, s53, s28
  s_add_u32 s29, s29, 7168
  buffer_load_dwordx4 v2, s[8:11], s29 offen sc1 lds
  v_exp_f32 v79, v79
  v_cvt_pk_bf16_f32 v102, v76, v77
  v_cvt_pk_bf16_f32 v103, v78, v79
  s_waitcnt lgkmcnt(0)
  v_mfma_f32_32x32x16_bf16 v[112:127], v[56:59], v[96:99], v[112:127]
  v_exp_f32 v80, v80
  v_exp_f32 v81, v81
  v_exp_f32 v82, v82
  v_exp_f32 v83, v83
  v_mfma_f32_32x32x16_bf16 v[112:127], v[60:63], v[100:103], v[112:127]
  v_cvt_pk_bf16_f32 v104, v80, v81
  v_exp_f32 v84, v84
  v_exp_f32 v85, v85
  v_cvt_pk_bf16_f32 v105, v82, v83
  v_exp_f32 v86, v86
  v_exp_f32 v87, v87
  v_cvt_pk_bf16_f32 v106, v84, v85
  v_exp_f32 v88, v88
  v_exp_f32 v89, v89
  v_cvt_pk_bf16_f32 v107, v86, v87
  v_exp_f32 v90, v90
  v_exp_f32 v91, v91
  v_cvt_pk_bf16_f32 v108, v88, v89
  v_exp_f32 v92, v92
  v_exp_f32 v93, v93
  v_cvt_pk_bf16_f32 v109, v90, v91
  v_exp_f32 v94, v94
  v_exp_f32 v95, v95
  v_cvt_pk_bf16_f32 v110, v92, v93
  v_cvt_pk_bf16_f32 v111, v94, v95
  s_nop 1
  v_mfma_f32_32x32x16_bf16 v[128:143], v[56:59], v[104:107], v[128:143]
  v_mfma_f32_32x32x16_bf16 v[128:143], v[60:63], v[108:111], v[128:143]
  s_waitcnt vmcnt(0)
  s_barrier
  s_add_u32 s41, s41, 1
  s_min_u32 s29, s41, 3
  s_mul_i32 s53, s29, 32768
  s_lshl_b32 s31, s21, 13
  s_add_u32 s53, s53, s31
  ds_read_b128 v[32:35], v4 offset:0
  ds_read_b128 v[36:39], v4 offset:1024
  ds_read_b128 v[48:51], v4 offset:32768
  ds_read_b128 v[52:55], v4 offset:33792
  ds_read_b128 v[40:43], v4 offset:2048
  ds_read_b128 v[44:47], v4 offset:3072
  s_waitcnt lgkmcnt(4)
  v_mfma_f32_32x32x16_bf16 v[64:79], v[32:35], v[192:195], 0
  v_mfma_f32_32x32x16_bf16 v[64:79], v[36:39], v[196:199], v[64:79]
  s_nop 11
  v_exp_f32 v64, v64
  v_exp_f32 v65, v65
  v_exp_f32 v66, v66
  v_exp_f32 v67, v67
  v_cvt_pk_bf16_f32 v96, v64, v65
  v_exp_f32 v68, v68
  v_exp_f32 v69, v69
  v_cvt_pk_bf16_f32 v97, v66, v67
  v_exp_f32 v70, v70
  v_mfma_f32_32x32x16_bf16 v[80:95], v[32:35], v[200:203], 0
  v_exp_f32 v71, v71
  v_cvt_pk_bf16_f32 v98, v68, v69
  v_exp_f32 v72, v72
  v_exp_f32 v73, v73
  v_cvt_pk_bf16_f32 v99, v70, v71
  v_mfma_f32_32x32x16_bf16 v[80:95], v[36:39], v[204:207], v[80:95]
  v_exp_f32 v74, v74
  v_exp_f32 v75, v75
  ds_read_b128 v[56:59], v4 offset:34816
  v_cvt_pk_bf16_f32 v100, v72, v73
  v_exp_f32 v76, v76
  v_exp_f32 v77, v77
  ds_read_b128 v[60:63], v4 offset:35840
  v_cvt_pk_bf16_f32 v101, v74, v75
  v_exp_f32 v78, v78
  s_add_u32 m0, s31, 0
  s_add_u32 s29, s53, s27
  s_add_u32 s29, s29, 0
  buffer_load_dwordx4 v2, s[8:11], s29 offen sc1 lds
  v_exp_f32 v79, v79
  v_cvt_pk_bf16_f32 v102, v76, v77
  v_cvt_pk_bf16_f32 v103, v78, v79
  s_waitcnt lgkmcnt(4)
  v_mfma_f32_32x32x16_bf16 v[112:127], v[48:51], v[96:99], v[112:127]
  v_exp_f32 v80, v80
  v_exp_f32 v81, v81
  v_exp_f32 v82, v82
  v_exp_f32 v83, v83
  v_mfma_f32_32x32x16_bf16 v[112:127], v[52:55], v[100:103], v[112:127]
  v_cvt_pk_bf16_f32 v104, v80, v81
  v_exp_f32 v84, v84
  v_exp_f32 v85, v85
  v_cvt_pk_bf16_f32 v105, v82, v83
  v_exp_f32 v86, v86
  s_waitcnt lgkmcnt(2)
  v_mfma_f32_32x32x16_bf16 v[64:79], v[40:43], v[192:195], 0
  v_exp_f32 v87, v87
  v_cvt_pk_bf16_f32 v106, v84, v85
  v_exp_f32 v88, v88
  v_exp_f32 v89, v89
  v_cvt_pk_bf16_f32 v107, v86, v87
  v_mfma_f32_32x32x16_bf16 v[64:79], v[44:47], v[196:199], v[64:79]
  v_exp_f32 v90, v90
  v_exp_f32 v91, v91
  ds_read_b128 v[32:35], v4 offset:4096
  v_cvt_pk_bf16_f32 v108, v88, v89
  v_exp_f32 v92, v92
  v_exp_f32 v93, v93
  ds_read_b128 v[36:39], v4 offset:5120
  v_cvt_pk_bf16_f32 v109, v90, v91
  v_exp_f32 v94, v94
  v_exp_f32 v95, v95
  v_cvt_pk_bf16_f32 v110, v92, v93
  v_cvt_pk_bf16_f32 v111, v94, v95
  v_mfma_f32_32x32x16_bf16 v[128:143], v[48:51], v[104:107], v[128:143]
  v_exp_f32 v64, v64
  v_exp_f32 v65, v65
  v_exp_f32 v66, v66
  v_exp_f32 v67, v67
  v_mfma_f32_32x32x16_bf16 v[128:143], v[52:55], v[108:111], v[128:143]
  v_cvt_pk_bf16_f32 v96, v64, v65
  v_exp_f32 v68, v68
  v_exp_f32 v69, v69
  v_cvt_pk_bf16_f32 v97, v66, v67
  v_exp_f32 v70, v70
  v_mfma_f32_32x32x16_bf16 v[80:95], v[40:43], v[200:203], 0
  v_exp_f32 v71, v71
  v_cvt_pk_bf16_f32 v98, v68, v69
  v_exp_f32 v72, v72
  v_exp_f32 v73, v73
  v_cvt_pk_bf16_f32 v99, v70, v71
  v_mfma_f32_32x32x16_bf16 v[80:95], v[44:47], v[204:207], v[80:95]
  v_exp_f32 v74, v74
  v_exp_f32 v75, v75
  ds_read_b128 v[48:51], v4 offset:36864
  v_cvt_pk_bf16_f32 v100, v72, v73
  v_exp_f32 v76, v76
  v_exp_f32 v77, v77
  ds_read_b128 v[52:55], v4 offset:37888
  v_cvt_pk_bf16_f32 v101, v74, v75
  v_exp_f32 v78, v78
  s_add_u32 m0, s31, 1024
  s_add_u32 s29, s53, s27
  s_add_u32 s29, s29, 1024
  buffer_load_dwordx4 v2, s[8:11], s29 offen sc1 lds
  v_exp_f32 v79, v79
  v_cvt_pk_bf16_f32 v102, v76, v77
  v_cvt_pk_bf16_f32 v103, v78, v79
  s_waitcnt lgkmcnt(4)
  v_mfma_f32_32x32x16_bf16 v[112:127], v[56:59], v[96:99], v[112:127]
  v_exp_f32 v80, v80
  v_exp_f32 v81, v81
  v_exp_f32 v82, v82
  v_exp_f32 v83, v83
  v_mfma_f32_32x32x16_bf16 v[112:127], v[60:63], v[100:103], v[112:127]
  v_cvt_pk_bf16_f32 v104, v80, v81
  v_exp_f32 v84, v84
  v_exp_f32 v85, v85
  v_cvt_pk_bf16_f32 v105, v82, v83
  v_exp_f32 v86, v86
  s_waitcnt lgkmcnt(2)
  v_mfma_f32_32x32x16_bf16 v[64:79], v[32:35], v[192:195], 0
  v_exp_f32 v87, v87
  v_cvt_pk_bf16_f32 v106, v84, v85
  v_exp_f32 v88, v88
  v_exp_f32 v89, v89
  v_cvt_pk_bf16_f32 v107, v86, v87
  v_mfma_f32_32x32x16_bf16 v[64:79], v[36:39], v[196:199], v[64:79]
  v_exp_f32 v90, v90
  v_exp_f32 v91, v91
  ds_read_b128 v[40:43], v4 offset:6144
  v_cvt_pk_bf16_f32 v108, v88, v89
  v_exp_f32 v92, v92
  v_exp_f32 v93, v93
  ds_read_b128 v[44:47], v4 offset:7168
  v_cvt_pk_bf16_f32 v109, v90, v91
  v_exp_f32 v94, v94
  v_exp_f32 v95, v95
  v_cvt_pk_bf16_f32 v110, v92, v93
  v_cvt_pk_bf16_f32 v111, v94, v95
  v_mfma_f32_32x32x16_bf16 v[128:143], v[56:59], v[104:107], v[128:143]
  v_exp_f32 v64, v64
  v_exp_f32 v65, v65
  v_exp_f32 v66, v66
  v_exp_f32 v67, v67
  v_mfma_f32_32x32x16_bf16 v[128:143], v[60:63], v[108:111], v[128:143]
  v_cvt_pk_bf16_f32 v96, v64, v65
  v_exp_f32 v68, v68
  v_exp_f32 v69, v69
  v_cvt_pk_bf16_f32 v97, v66, v67
  v_exp_f32 v70, v70
  v_mfma_f32_32x32x16_bf16 v[80:95], v[32:35], v[200:203], 0
  v_exp_f32 v71, v71
  v_cvt_pk_bf16_f32 v98, v68, v69
  v_exp_f32 v72, v72
  v_exp_f32 v73, v73
  v_cvt_pk_bf16_f32 v99, v70, v71
  v_mfma_f32_32x32x16_bf16 v[80:95], v[36:39], v[204:207], v[80:95]
  v_exp_f32 v74, v74
  v_exp_f32 v75, v75
  ds_read_b128 v[56:59], v4 offset:38912
  v_cvt_pk_bf16_f32 v100, v72, v73
  v_exp_f32 v76, v76
  v_exp_f32 v77, v77
  ds_read_b128 v[60:63], v4 offset:39936
  v_cvt_pk_bf16_f32 v101, v74, v75
  v_exp_f32 v78, v78
  s_add_u32 m0, s31, 2048
  s_add_u32 s29, s53, s27
  s_add_u32 s29, s29, 2048
  buffer_load_dwordx4 v2, s[8:11], s29 offen sc1 lds
  v_exp_f32 v79, v79
  v_cvt_pk_bf16_f32 v102, v76, v77
  v_cvt_pk_bf16_f32 v103, v78, v79
  s_waitcnt lgkmcnt(4)
  v_mfma_f32_32x32x16_bf16 v[112:127], v[48:51], v[96:99], v[112:127]
  v_exp_f32 v80, v80
  v_exp_f32 v81, v81
  v_exp_f32 v82, v82
  v_exp_f32 v83, v83
  v_mfma_f32_32x32x16_bf16 v[112:127], v[52:55], v[100:103], v[112:127]
  v_cvt_pk_bf16_f32 v104, v80, v81
  v_exp_f32 v84, v84
  v_exp_f32 v85, v85
  v_cvt_pk_bf16_f32 v105, v82, v83
  v_exp_f32 v86, v86
  s_waitcnt lgkmcnt(2)
  v_mfma_f32_32x32x16_bf16 v[64:79], v[40:43], v[192:195], 0
  v_exp_f32 v87, v87
  v_cvt_pk_bf16_f32 v106, v84, v85
  v_exp_f32 v88, v88
  v_exp_f32 v89, v89
  v_cvt_pk_bf16_f32 v107, v86, v87
  v_mfma_f32_32x32x16_bf16 v[64:79], v[44:47], v[196:199], v[64:79]
  v_exp_f32 v90, v90
  v_exp_f32 v91, v91
  ds_read_b128 v[32:35], v4 offset:8192
  v_cvt_pk_bf16_f32 v108, v88, v89
  v_exp_f32 v92, v92
  v_exp_f32 v93, v93
  ds_read_b128 v[36:39], v4 offset:9216
  v_cvt_pk_bf16_f32 v109, v90, v91
  v_exp_f32 v94, v94
  v_exp_f32 v95, v95
  v_cvt_pk_bf16_f32 v110, v92, v93
  v_cvt_pk_bf16_f32 v111, v94, v95
  v_mfma_f32_32x32x16_bf16 v[128:143], v[48:51], v[104:107], v[128:143]
  v_exp_f32 v64, v64
  v_exp_f32 v65, v65
  v_exp_f32 v66, v66
  v_exp_f32 v67, v67
  v_mfma_f32_32x32x16_bf16 v[128:143], v[52:55], v[108:111], v[128:143]
  v_cvt_pk_bf16_f32 v96, v64, v65
  v_exp_f32 v68, v68
  v_exp_f32 v69, v69
  v_cvt_pk_bf16_f32 v97, v66, v67
  v_exp_f32 v70, v70
  v_mfma_f32_32x32x16_bf16 v[80:95], v[40:43], v[200:203], 0
  v_exp_f32 v71, v71
  v_cvt_pk_bf16_f32 v98, v68, v69
  v_exp_f32 v72, v72
  v_exp_f32 v73, v73
  v_cvt_pk_bf16_f32 v99, v70, v71
  v_mfma_f32_32x32x16_bf16 v[80:95], v[44:47], v[204:207], v[80:95]
  v_exp_f32 v74, v74
  v_exp_f32 v75, v75
  ds_read_b128 v[48:51], v4 offset:40960
  v_cvt_pk_bf16_f32 v100, v72, v73
  v_exp_f32 v76, v76
  v_exp_f32 v77, v77
  ds_read_b128 v[52:55], v4 offset:41984
  v_cvt_pk_bf16_f32 v101, v74, v75
  v_exp_f32 v78, v78
  s_add_u32 m0, s31, 3072
  s_add_u32 s29, s53, s27
  s_add_u32 s29, s29, 3072
  buffer_load_dwordx4 v2, s[8:11], s29 offen sc1 lds
  v_exp_f32 v79, v79
  v_cvt_pk_bf16_f32 v102, v76, v77
  v_cvt_pk_bf16_f32 v103, v78, v79
  s_waitcnt lgkmcnt(4)
  v_mfma_f32_32x32x16_bf16 v[112:127], v[56:59], v[96:99], v[112:127]
  v_exp_f32 v80, v80
  v_exp_f32 v81, v81
  v_exp_f32 v82, v82
  v_exp_f32 v83, v83
  v_mfma_f32_32x32x16_bf16 v[112:127], v[60:63], v[100:103], v[112:127]
  v_cvt_pk_bf16_f32 v104, v80, v81
  v_exp_f32 v84, v84
  v_exp_f32 v85, v85
  v_cvt_pk_bf16_f32 v105, v82, v83
  v_exp_f32 v86, v86
  s_waitcnt lgkmcnt(2)
  v_mfma_f32_32x32x16_bf16 v[64:79], v[32:35], v[192:195], 0
  v_exp_f32 v87, v87
  v_cvt_pk_bf16_f32 v106, v84, v85
  v_exp_f32 v88, v88
  v_exp_f32 v89, v89
  v_cvt_pk_bf16_f32 v107, v86, v87
  v_mfma_f32_32x32x16_bf16 v[64:79], v[36:39], v[196:199], v[64:79]
  v_exp_f32 v90, v90
  v_exp_f32 v91, v91
  ds_read_b128 v[40:43], v4 offset:10240
  v_cvt_pk_bf16_f32 v108, v88, v89
  v_exp_f32 v92, v92
  v_exp_f32 v93, v93
  ds_read_b128 v[44:47], v4 offset:11264
  v_cvt_pk_bf16_f32 v109, v90, v91
  v_exp_f32 v94, v94
  v_exp_f32 v95, v95
  v_cvt_pk_bf16_f32 v110, v92, v93
  v_cvt_pk_bf16_f32 v111, v94, v95
  v_mfma_f32_32x32x16_bf16 v[128:143], v[56:59], v[104:107], v[128:143]
  v_exp_f32 v64, v64
  v_exp_f32 v65, v65
  v_exp_f32 v66, v66
  v_exp_f32 v67, v67
  v_mfma_f32_32x32x16_bf16 v[128:143], v[60:63], v[108:111], v[128:143]
  v_cvt_pk_bf16_f32 v96, v64, v65
  v_exp_f32 v68, v68
  v_exp_f32 v69, v69
  v_cvt_pk_bf16_f32 v97, v66, v67
  v_exp_f32 v70, v70
  v_mfma_f32_32x32x16_bf16 v[80:95], v[32:35], v[200:203], 0
  v_exp_f32 v71, v71
  v_cvt_pk_bf16_f32 v98, v68, v69
  v_exp_f32 v72, v72
  v_exp_f32 v73, v73
  v_cvt_pk_bf16_f32 v99, v70, v71
  v_mfma_f32_32x32x16_bf16 v[80:95], v[36:39], v[204:207], v[80:95]
  v_exp_f32 v74, v74
  v_exp_f32 v75, v75
  ds_read_b128 v[56:59], v4 offset:43008
  v_cvt_pk_bf16_f32 v100, v72, v73
  v_exp_f32 v76, v76
  v_exp_f32 v77, v77
  ds_read_b128 v[60:63], v4 offset:44032
  v_cvt_pk_bf16_f32 v101, v74, v75
  v_exp_f32 v78, v78
  s_add_u32 m0, s31, 4096
  s_add_u32 s29, s53, s27
  s_add_u32 s29, s29, 4096
  buffer_load_dwordx4 v2, s[8:11], s29 offen sc1 lds
  v_exp_f32 v79, v79
  v_cvt_pk_bf16_f32 v102, v76, v77
  v_cvt_pk_bf16_f32 v103, v78, v79
  s_waitcnt lgkmcnt(4)
  v_mfma_f32_32x32x16_bf16 v[112:127], v[48:51], v[96:99], v[112:127]
  v_exp_f32 v80, v80
  v_exp_f32 v81, v81
  v_exp_f32 v82, v82
  v_exp_f32 v83, v83
  v_mfma_f32_32x32x16_bf16 v[112:127], v[52:55], v[100:103], v[112:127]
  v_cvt_pk_bf16_f32 v104, v80, v81
  v_exp_f32 v84, v84
  v_exp_f32 v85, v85
  v_cvt_pk_bf16_f32 v105, v82, v83
  v_exp_f32 v86, v86
  s_waitcnt lgkmcnt(2)
  v_mfma_f32_32x32x16_bf16 v[64:79], v[40:43], v[192:195], 0
  v_exp_f32 v87, v87
  v_cvt_pk_bf16_f32 v106, v84, v85
  v_exp_f32 v88, v88
  v_exp_f32 v89, v89
  v_cvt_pk_bf16_f32 v107, v86, v87
  v_mfma_f32_32x32x16_bf16 v[64:79], v[44:47], v[196:199], v[64:79]
  v_exp_f32 v90, v90
  v_exp_f32 v91, v91
  ds_read_b128 v[32:35], v4 offset:12288
  v_cvt_pk_bf16_f32 v108, v88, v89
  v_exp_f32 v92, v92
  v_exp_f32 v93, v93
  ds_read_b128 v[36:39], v4 offset:13312
  v_cvt_pk_bf16_f32 v109, v90, v91
  v_exp_f32 v94, v94
  v_exp_f32 v95, v95
  v_cvt_pk_bf16_f32 v110, v92, v93
  v_cvt_pk_bf16_f32 v111, v94, v95
  v_mfma_f32_32x32x16_bf16 v[128:143], v[48:51], v[104:107], v[128:143]
  v_exp_f32 v64, v64
  v_exp_f32 v65, v65
  v_exp_f32 v66, v66
  v_exp_f32 v67, v67
  v_mfma_f32_32x32x16_bf16 v[128:143], v[52:55], v[108:111], v[128:143]
  v_cvt_pk_bf16_f32 v96, v64, v65
  v_exp_f32 v68, v68
  v_exp_f32 v69, v69
  v_cvt_pk_bf16_f32 v97, v66, v67
  v_exp_f32 v70, v70
  v_mfma_f32_32x32x16_bf16 v[80:95], v[40:43], v[200:203], 0
  v_exp_f32 v71, v71
  v_cvt_pk_bf16_f32 v98, v68, v69
  v_exp_f32 v72, v72
  v_exp_f32 v73, v73
  v_cvt_pk_bf16_f32 v99, v70, v71
  v_mfma_f32_32x32x16_bf16 v[80:95], v[44:47], v[204:207], v[80:95]
  v_exp_f32 v74, v74
  v_exp_f32 v75, v75
  ds_read_b128 v[48:51], v4 offset:45056
  v_cvt_pk_bf16_f32 v100, v72, v73
  v_exp_f32 v76, v76
  v_exp_f32 v77, v77
  ds_read_b128 v[52:55], v4 offset:46080
  v_cvt_pk_bf16_f32 v101, v74, v75
  v_exp_f32 v78, v78
  s_add_u32 m0, s31, 5120
  s_add_u32 s29, s53, s27
  s_add_u32 s29, s29, 5120
  buffer_load_dwordx4 v2, s[8:11], s29 offen sc1 lds
  v_exp_f32 v79, v79
  v_cvt_pk_bf16_f32 v102, v76, v77
  v_cvt_pk_bf16_f32 v103, v78, v79
  s_waitcnt lgkmcnt(4)
  v_mfma_f32_32x32x16_bf16 v[112:127], v[56:59], v[96:99], v[112:127]
  v_exp_f32 v80, v80
  v_exp_f32 v81, v81
  v_exp_f32 v82, v82
  v_exp_f32 v83, v83
  v_mfma_f32_32x32x16_bf16 v[112:127], v[60:63], v[100:103], v[112:127]
  v_cvt_pk_bf16_f32 v104, v80, v81
  v_exp_f32 v84, v84
  v_exp_f32 v85, v85
  v_cvt_pk_bf16_f32 v105, v82, v83
  v_exp_f32 v86, v86
  s_waitcnt lgkmcnt(2)
  v_mfma_f32_32x32x16_bf16 v[64:79], v[32:35], v[192:195], 0
  v_exp_f32 v87, v87
  v_cvt_pk_bf16_f32 v106, v84, v85
  v_exp_f32 v88, v88
  v_exp_f32 v89, v89
  v_cvt_pk_bf16_f32 v107, v86, v87
  v_mfma_f32_32x32x16_bf16 v[64:79], v[36:39], v[196:199], v[64:79]
  v_exp_f32 v90, v90
  v_exp_f32 v91, v91
  ds_read_b128 v[40:43], v4 offset:14336
  v_cvt_pk_bf16_f32 v108, v88, v89
  v_exp_f32 v92, v92
  v_exp_f32 v93, v93
  ds_read_b128 v[44:47], v4 offset:15360
  v_cvt_pk_bf16_f32 v109, v90, v91
  v_exp_f32 v94, v94
  v_exp_f32 v95, v95
  v_cvt_pk_bf16_f32 v110, v92, v93
  v_cvt_pk_bf16_f32 v111, v94, v95
  v_mfma_f32_32x32x16_bf16 v[128:143], v[56:59], v[104:107], v[128:143]
  v_exp_f32 v64, v64
  v_exp_f32 v65, v65
  v_exp_f32 v66, v66
  v_exp_f32 v67, v67
  v_mfma_f32_32x32x16_bf16 v[128:143], v[60:63], v[108:111], v[128:143]
  v_cvt_pk_bf16_f32 v96, v64, v65
  v_exp_f32 v68, v68
  v_exp_f32 v69, v69
  v_cvt_pk_bf16_f32 v97, v66, v67
  v_exp_f32 v70, v70
  v_mfma_f32_32x32x16_bf16 v[80:95], v[32:35], v[200:203], 0
  v_exp_f32 v71, v71
  v_cvt_pk_bf16_f32 v98, v68, v69
  v_exp_f32 v72, v72
  v_exp_f32 v73, v73
  v_cvt_pk_bf16_f32 v99, v70, v71
  v_mfma_f32_32x32x16_bf16 v[80:95], v[36:39], v[204:207], v[80:95]
  v_exp_f32 v74, v74
  v_exp_f32 v75, v75
  ds_read_b128 v[56:59], v4 offset:47104
  v_cvt_pk_bf16_f32 v100, v72, v73
  v_exp_f32 v76, v76
  v_exp_f32 v77, v77
  ds_read_b128 v[60:63], v4 offset:48128
  v_cvt_pk_bf16_f32 v101, v74, v75
  v_exp_f32 v78, v78
  s_add_u32 m0, s31, 6144
  s_add_u32 s29, s53, s27
  s_add_u32 s29, s29, 6144
  buffer_load_dwordx4 v2, s[8:11], s29 offen sc1 lds
  v_exp_f32 v79, v79
  v_cvt_pk_bf16_f32 v102, v76, v77
  v_cvt_pk_bf16_f32 v103, v78, v79
  s_waitcnt lgkmcnt(4)
  v_mfma_f32_32x32x16_bf16 v[112:127], v[48:51], v[96:99], v[112:127]
  v_exp_f32 v80, v80
  v_exp_f32 v81, v81
  v_exp_f32 v82, v82
  v_exp_f32 v83, v83
  v_mfma_f32_32x32x16_bf16 v[112:127], v[52:55], v[100:103], v[112:127]
  v_cvt_pk_bf16_f32 v104, v80, v81
  v_exp_f32 v84, v84
  v_exp_f32 v85, v85
  v_cvt_pk_bf16_f32 v105, v82, v83
  v_exp_f32 v86, v86
  s_waitcnt lgkmcnt(2)
  v_mfma_f32_32x32x16_bf16 v[64:79], v[40:43], v[192:195], 0
  v_exp_f32 v87, v87
  v_cvt_pk_bf16_f32 v106, v84, v85
  v_exp_f32 v88, v88
  v_exp_f32 v89, v89
  v_cvt_pk_bf16_f32 v107, v86, v87
  v_mfma_f32_32x32x16_bf16 v[64:79], v[44:47], v[196:199], v[64:79]
  v_exp_f32 v90, v90
  v_exp_f32 v91, v91
  ds_read_b128 v[32:35], v4 offset:16384
  v_cvt_pk_bf16_f32 v108, v88, v89
  v_exp_f32 v92, v92
  v_exp_f32 v93, v93
  ds_read_b128 v[36:39], v4 offset:17408
  v_cvt_pk_bf16_f32 v109, v90, v91
  v_exp_f32 v94, v94
  v_exp_f32 v95, v95
  v_cvt_pk_bf16_f32 v110, v92, v93
  v_cvt_pk_bf16_f32 v111, v94, v95
  v_mfma_f32_32x32x16_bf16 v[128:143], v[48:51], v[104:107], v[128:143]
  v_exp_f32 v64, v64
  v_exp_f32 v65, v65
  v_exp_f32 v66, v66
  v_exp_f32 v67, v67
  v_mfma_f32_32x32x16_bf16 v[128:143], v[52:55], v[108:111], v[128:143]
  v_cvt_pk_bf16_f32 v96, v64, v65
  v_exp_f32 v68, v68
  v_exp_f32 v69, v69
  v_cvt_pk_bf16_f32 v97, v66, v67
  v_exp_f32 v70, v70
  v_mfma_f32_32x32x16_bf16 v[80:95], v[40:43], v[200:203], 0
  v_exp_f32 v71, v71
  v_cvt_pk_bf16_f32 v98, v68, v69
  v_exp_f32 v72, v72
  v_exp_f32 v73, v73
  v_cvt_pk_bf16_f32 v99, v70, v71
  v_mfma_f32_32x32x16_bf16 v[80:95], v[44:47], v[204:207], v[80:95]
  v_exp_f32 v74, v74
  v_exp_f32 v75, v75
  ds_read_b128 v[48:51], v4 offset:49152
  v_cvt_pk_bf16_f32 v100, v72, v73
  v_exp_f32 v76, v76
  v_exp_f32 v77, v77
  ds_read_b128 v[52:55], v4 offset:50176
  v_cvt_pk_bf16_f32 v101, v74, v75
  v_exp_f32 v78, v78
  s_add_u32 m0, s31, 7168
  s_add_u32 s29, s53, s27
  s_add_u32 s29, s29, 7168
  buffer_load_dwordx4 v2, s[8:11], s29 offen sc1 lds
  v_exp_f32 v79, v79
  v_cvt_pk_bf16_f32 v102, v76, v77
  v_cvt_pk_bf16_f32 v103, v78, v79
  s_waitcnt lgkmcnt(4)
  v_mfma_f32_32x32x16_bf16 v[112:127], v[56:59], v[96:99], v[112:127]
  v_exp_f32 v80, v80
  v_exp_f32 v81, v81
  v_exp_f32 v82, v82
  v_exp_f32 v83, v83
  v_mfma_f32_32x32x16_bf16 v[112:127], v[60:63], v[100:103], v[112:127]
  v_cvt_pk_bf16_f32 v104, v80, v81
  v_exp_f32 v84, v84
  v_exp_f32 v85, v85
  v_cvt_pk_bf16_f32 v105, v82, v83
  v_exp_f32 v86, v86
  s_waitcnt lgkmcnt(2)
  v_mfma_f32_32x32x16_bf16 v[64:79], v[32:35], v[192:195], 0
  v_exp_f32 v87, v87
  v_cvt_pk_bf16_f32 v106, v84, v85
  v_exp_f32 v88, v88
  v_exp_f32 v89, v89
  v_cvt_pk_bf16_f32 v107, v86, v87
  v_mfma_f32_32x32x16_bf16 v[64:79], v[36:39], v[196:199], v[64:79]
  v_exp_f32 v90, v90
  v_exp_f32 v91, v91
  ds_read_b128 v[40:43], v4 offset:18432
  v_cvt_pk_bf16_f32 v108, v88, v89
  v_exp_f32 v92, v92
  v_exp_f32 v93, v93
  ds_read_b128 v[44:47], v4 offset:19456
  v_cvt_pk_bf16_f32 v109, v90, v91
  v_exp_f32 v94, v94
  v_exp_f32 v95, v95
  v_cvt_pk_bf16_f32 v110, v92, v93
  v_cvt_pk_bf16_f32 v111, v94, v95
  v_mfma_f32_32x32x16_bf16 v[128:143], v[56:59], v[104:107], v[128:143]
  v_exp_f32 v64, v64
  v_exp_f32 v65, v65
  v_exp_f32 v66, v66
  v_exp_f32 v67, v67
  v_mfma_f32_32x32x16_bf16 v[128:143], v[60:63], v[108:111], v[128:143]
  v_cvt_pk_bf16_f32 v96, v64, v65
  v_exp_f32 v68, v68
  v_exp_f32 v69, v69
  v_cvt_pk_bf16_f32 v97, v66, v67
  v_exp_f32 v70, v70
  v_mfma_f32_32x32x16_bf16 v[80:95], v[32:35], v[200:203], 0
  v_exp_f32 v71, v71
  v_cvt_pk_bf16_f32 v98, v68, v69
  v_exp_f32 v72, v72
  v_exp_f32 v73, v73
  v_cvt_pk_bf16_f32 v99, v70, v71
  v_mfma_f32_32x32x16_bf16 v[80:95], v[36:39], v[204:207], v[80:95]
  v_exp_f32 v74, v74
  v_exp_f32 v75, v75
  ds_read_b128 v[56:59], v4 offset:51200
  v_cvt_pk_bf16_f32 v100, v72, v73
  v_exp_f32 v76, v76
  v_exp_f32 v77, v77
  ds_read_b128 v[60:63], v4 offset:52224
  v_cvt_pk_bf16_f32 v101, v74, v75
  v_exp_f32 v78, v78
  s_add_u32 m0, s31, 32768
  s_add_u32 s29, s53, s28
  s_add_u32 s29, s29, 0
  buffer_load_dwordx4 v2, s[8:11], s29 offen sc1 lds
  v_exp_f32 v79, v79
  v_cvt_pk_bf16_f32 v102, v76, v77
  v_cvt_pk_bf16_f32 v103, v78, v79
  s_waitcnt lgkmcnt(4)
  v_mfma_f32_32x32x16_bf16 v[112:127], v[48:51], v[96:99], v[112:127]
  v_exp_f32 v80, v80
  v_exp_f32 v81, v81
  v_exp_f32 v82, v82
  v_exp_f32 v83, v83
  v_mfma_f32_32x32x16_bf16 v[112:127], v[52:55], v[100:103], v[112:127]
  v_cvt_pk_bf16_f32 v104, v80, v81
  v_exp_f32 v84, v84
  v_exp_f32 v85, v85
  v_cvt_pk_bf16_f32 v105, v82, v83
  v_exp_f32 v86, v86
  s_waitcnt lgkmcnt(2)
  v_mfma_f32_32x32x16_bf16 v[64:79], v[40:43], v[192:195], 0
  v_exp_f32 v87, v87
  v_cvt_pk_bf16_f32 v106, v84, v85
  v_exp_f32 v88, v88
  v_exp_f32 v89, v89
  v_cvt_pk_bf16_f32 v107, v86, v87
  v_mfma_f32_32x32x16_bf16 v[64:79], v[44:47], v[196:199], v[64:79]
  v_exp_f32 v90, v90
  v_exp_f32 v91, v91
  ds_read_b128 v[32:35], v4 offset:20480
  v_cvt_pk_bf16_f32 v108, v88, v89
  v_exp_f32 v92, v92
  v_exp_f32 v93, v93
  ds_read_b128 v[36:39], v4 offset:21504
  v_cvt_pk_bf16_f32 v109, v90, v91
  v_exp_f32 v94, v94
  v_exp_f32 v95, v95
  v_cvt_pk_bf16_f32 v110, v92, v93
  v_cvt_pk_bf16_f32 v111, v94, v95
  v_mfma_f32_32x32x16_bf16 v[128:143], v[48:51], v[104:107], v[128:143]
  v_exp_f32 v64, v64
  v_exp_f32 v65, v65
  v_exp_f32 v66, v66
  v_exp_f32 v67, v67
  v_mfma_f32_32x32x16_bf16 v[128:143], v[52:55], v[108:111], v[128:143]
  v_cvt_pk_bf16_f32 v96, v64, v65
  v_exp_f32 v68, v68
  v_exp_f32 v69, v69
  v_cvt_pk_bf16_f32 v97, v66, v67
  v_exp_f32 v70, v70
  v_mfma_f32_32x32x16_bf16 v[80:95], v[40:43], v[200:203], 0
  v_exp_f32 v71, v71
  v_cvt_pk_bf16_f32 v98, v68, v69
  v_exp_f32 v72, v72
  v_exp_f32 v73, v73
  v_cvt_pk_bf16_f32 v99, v70, v71
  v_mfma_f32_32x32x16_bf16 v[80:95], v[44:47], v[204:207], v[80:95]
  v_exp_f32 v74, v74
  v_exp_f32 v75, v75
  ds_read_b128 v[48:51], v4 offset:53248
  v_cvt_pk_bf16_f32 v100, v72, v73
  v_exp_f32 v76, v76
  v_exp_f32 v77, v77
  ds_read_b128 v[52:55], v4 offset:54272
  v_cvt_pk_bf16_f32 v101, v74, v75
  v_exp_f32 v78, v78
  s_add_u32 m0, s31, 33792
  s_add_u32 s29, s53, s28
  s_add_u32 s29, s29, 1024
  buffer_load_dwordx4 v2, s[8:11], s29 offen sc1 lds
  v_exp_f32 v79, v79
  v_cvt_pk_bf16_f32 v102, v76, v77
  v_cvt_pk_bf16_f32 v103, v78, v79
  s_waitcnt lgkmcnt(4)
  v_mfma_f32_32x32x16_bf16 v[112:127], v[56:59], v[96:99], v[112:127]
  v_exp_f32 v80, v80
  v_exp_f32 v81, v81
  v_exp_f32 v82, v82
  v_exp_f32 v83, v83
  v_mfma_f32_32x32x16_bf16 v[112:127], v[60:63], v[100:103], v[112:127]
  v_cvt_pk_bf16_f32 v104, v80, v81
  v_exp_f32 v84, v84
  v_exp_f32 v85, v85
  v_cvt_pk_bf16_f32 v105, v82, v83
  v_exp_f32 v86, v86
  s_waitcnt lgkmcnt(2)
  v_mfma_f32_32x32x16_bf16 v[64:79], v[32:35], v[192:195], 0
  v_exp_f32 v87, v87
  v_cvt_pk_bf16_f32 v106, v84, v85
  v_exp_f32 v88, v88
  v_exp_f32 v89, v89
  v_cvt_pk_bf16_f32 v107, v86, v87
  v_mfma_f32_32x32x16_bf16 v[64:79], v[36:39], v[196:199], v[64:79]
  v_exp_f32 v90, v90
  v_exp_f32 v91, v91
  ds_read_b128 v[40:43], v4 offset:22528
  v_cvt_pk_bf16_f32 v108, v88, v89
  v_exp_f32 v92, v92
  v_exp_f32 v93, v93
  ds_read_b128 v[44:47], v4 offset:23552
  v_cvt_pk_bf16_f32 v109, v90, v91
  v_exp_f32 v94, v94
  v_exp_f32 v95, v95
  v_cvt_pk_bf16_f32 v110, v92, v93
  v_cvt_pk_bf16_f32 v111, v94, v95
  v_mfma_f32_32x32x16_bf16 v[128:143], v[56:59], v[104:107], v[128:143]
  v_exp_f32 v64, v64
  v_exp_f32 v65, v65
  v_exp_f32 v66, v66
  v_exp_f32 v67, v67
  v_mfma_f32_32x32x16_bf16 v[128:143], v[60:63], v[108:111], v[128:143]
  v_cvt_pk_bf16_f32 v96, v64, v65
  v_exp_f32 v68, v68
  v_exp_f32 v69, v69
  v_cvt_pk_bf16_f32 v97, v66, v67
  v_exp_f32 v70, v70
  v_mfma_f32_32x32x16_bf16 v[80:95], v[32:35], v[200:203], 0
  v_exp_f32 v71, v71
  v_cvt_pk_bf16_f32 v98, v68, v69
  v_exp_f32 v72, v72
  v_exp_f32 v73, v73
  v_cvt_pk_bf16_f32 v99, v70, v71
  v_mfma_f32_32x32x16_bf16 v[80:95], v[36:39], v[204:207], v[80:95]
  v_exp_f32 v74, v74
  v_exp_f32 v75, v75
  ds_read_b128 v[56:59], v4 offset:55296
  v_cvt_pk_bf16_f32 v100, v72, v73
  v_exp_f32 v76, v76
  v_exp_f32 v77, v77
  ds_read_b128 v[60:63], v4 offset:56320
  v_cvt_pk_bf16_f32 v101, v74, v75
  v_exp_f32 v78, v78
  s_add_u32 m0, s31, 34816
  s_add_u32 s29, s53, s28
  s_add_u32 s29, s29, 2048
  buffer_load_dwordx4 v2, s[8:11], s29 offen sc1 lds
  v_exp_f32 v79, v79
  v_cvt_pk_bf16_f32 v102, v76, v77
  v_cvt_pk_bf16_f32 v103, v78, v79
  s_waitcnt lgkmcnt(4)
  v_mfma_f32_32x32x16_bf16 v[112:127], v[48:51], v[96:99], v[112:127]
  v_exp_f32 v80, v80
  v_exp_f32 v81, v81
  v_exp_f32 v82, v82
  v_exp_f32 v83, v83
  v_mfma_f32_32x32x16_bf16 v[112:127], v[52:55], v[100:103], v[112:127]
  v_cvt_pk_bf16_f32 v104, v80, v81
  v_exp_f32 v84, v84
  v_exp_f32 v85, v85
  v_cvt_pk_bf16_f32 v105, v82, v83
  v_exp_f32 v86, v86
  s_waitcnt lgkmcnt(2)
  v_mfma_f32_32x32x16_bf16 v[64:79], v[40:43], v[192:195], 0
  v_exp_f32 v87, v87
  v_cvt_pk_bf16_f32 v106, v84, v85
  v_exp_f32 v88, v88
  v_exp_f32 v89, v89
  v_cvt_pk_bf16_f32 v107, v86, v87
  v_mfma_f32_32x32x16_bf16 v[64:79], v[44:47], v[196:199], v[64:79]
  v_exp_f32 v90, v90
  v_exp_f32 v91, v91
  ds_read_b128 v[32:35], v4 offset:24576
  v_cvt_pk_bf16_f32 v108, v88, v89
  v_exp_f32 v92, v92
  v_exp_f32 v93, v93
  ds_read_b128 v[36:39], v4 offset:25600
  v_cvt_pk_bf16_f32 v109, v90, v91
  v_exp_f32 v94, v94
  v_exp_f32 v95, v95
  v_cvt_pk_bf16_f32 v110, v92, v93
  v_cvt_pk_bf16_f32 v111, v94, v95
  v_mfma_f32_32x32x16_bf16 v[128:143], v[48:51], v[104:107], v[128:143]
  v_exp_f32 v64, v64
  v_exp_f32 v65, v65
  v_exp_f32 v66, v66
  v_exp_f32 v67, v67
  v_mfma_f32_32x32x16_bf16 v[128:143], v[52:55], v[108:111], v[128:143]
  v_cvt_pk_bf16_f32 v96, v64, v65
  v_exp_f32 v68, v68
  v_exp_f32 v69, v69
  v_cvt_pk_bf16_f32 v97, v66, v67
  v_exp_f32 v70, v70
  v_mfma_f32_32x32x16_bf16 v[80:95], v[40:43], v[200:203], 0
  v_exp_f32 v71, v71
  v_cvt_pk_bf16_f32 v98, v68, v69
  v_exp_f32 v72, v72
  v_exp_f32 v73, v73
  v_cvt_pk_bf16_f32 v99, v70, v71
  v_mfma_f32_32x32x16_bf16 v[80:95], v[44:47], v[204:207], v[80:95]
  v_exp_f32 v74, v74
  v_exp_f32 v75, v75
  ds_read_b128 v[48:51], v4 offset:57344
  v_cvt_pk_bf16_f32 v100, v72, v73
  v_exp_f32 v76, v76
  v_exp_f32 v77, v77
  ds_read_b128 v[52:55], v4 offset:58368
  v_cvt_pk_bf16_f32 v101, v74, v75
  v_exp_f32 v78, v78
  s_add_u32 m0, s31, 35840
  s_add_u32 s29, s53, s28
  s_add_u32 s29, s29, 3072
  buffer_load_dwordx4 v2, s[8:11], s29 offen sc1 lds
  v_exp_f32 v79, v79
  v_cvt_pk_bf16_f32 v102, v76, v77
  v_cvt_pk_bf16_f32 v103, v78, v79
  s_waitcnt lgkmcnt(4)
  v_mfma_f32_32x32x16_bf16 v[112:127], v[56:59], v[96:99], v[112:127]
  v_exp_f32 v80, v80
  v_exp_f32 v81, v81
  v_exp_f32 v82, v82
  v_exp_f32 v83, v83
  v_mfma_f32_32x32x16_bf16 v[112:127], v[60:63], v[100:103], v[112:127]
  v_cvt_pk_bf16_f32 v104, v80, v81
  v_exp_f32 v84, v84
  v_exp_f32 v85, v85
  v_cvt_pk_bf16_f32 v105, v82, v83
  v_exp_f32 v86, v86
  s_waitcnt lgkmcnt(2)
  v_mfma_f32_32x32x16_bf16 v[64:79], v[32:35], v[192:195], 0
  v_exp_f32 v87, v87
  v_cvt_pk_bf16_f32 v106, v84, v85
  v_exp_f32 v88, v88
  v_exp_f32 v89, v89
  v_cvt_pk_bf16_f32 v107, v86, v87
  v_mfma_f32_32x32x16_bf16 v[64:79], v[36:39], v[196:199], v[64:79]
  v_exp_f32 v90, v90
  v_exp_f32 v91, v91
  ds_read_b128 v[40:43], v4 offset:26624
  v_cvt_pk_bf16_f32 v108, v88, v89
  v_exp_f32 v92, v92
  v_exp_f32 v93, v93
  ds_read_b128 v[44:47], v4 offset:27648
  v_cvt_pk_bf16_f32 v109, v90, v91
  v_exp_f32 v94, v94
  v_exp_f32 v95, v95
  v_cvt_pk_bf16_f32 v110, v92, v93
  v_cvt_pk_bf16_f32 v111, v94, v95
  v_mfma_f32_32x32x16_bf16 v[128:143], v[56:59], v[104:107], v[128:143]
  v_exp_f32 v64, v64
  v_exp_f32 v65, v65
  v_exp_f32 v66, v66
  v_exp_f32 v67, v67
  v_mfma_f32_32x32x16_bf16 v[128:143], v[60:63], v[108:111], v[128:143]
  v_cvt_pk_bf16_f32 v96, v64, v65
  v_exp_f32 v68, v68
  v_exp_f32 v69, v69
  v_cvt_pk_bf16_f32 v97, v66, v67
  v_exp_f32 v70, v70
  v_mfma_f32_32x32x16_bf16 v[80:95], v[32:35], v[200:203], 0
  v_exp_f32 v71, v71
  v_cvt_pk_bf16_f32 v98, v68, v69
  v_exp_f32 v72, v72
  v_exp_f32 v73, v73
  v_cvt_pk_bf16_f32 v99, v70, v71
  v_mfma_f32_32x32x16_bf16 v[80:95], v[36:39], v[204:207], v[80:95]
  v_exp_f32 v74, v74
  v_exp_f32 v75, v75
  ds_read_b128 v[56:59], v4 offset:59392
  v_cvt_pk_bf16_f32 v100, v72, v73
  v_exp_f32 v76, v76
  v_exp_f32 v77, v77
  ds_read_b128 v[60:63], v4 offset:60416
  v_cvt_pk_bf16_f32 v101, v74, v75
  v_exp_f32 v78, v78
  s_add_u32 m0, s31, 36864
  s_add_u32 s29, s53, s28
  s_add_u32 s29, s29, 4096
  buffer_load_dwordx4 v2, s[8:11], s29 offen sc1 lds
  v_exp_f32 v79, v79
  v_cvt_pk_bf16_f32 v102, v76, v77
  v_cvt_pk_bf16_f32 v103, v78, v79
  s_waitcnt lgkmcnt(4)
  v_mfma_f32_32x32x16_bf16 v[112:127], v[48:51], v[96:99], v[112:127]
  v_exp_f32 v80, v80
  v_exp_f32 v81, v81
  v_exp_f32 v82, v82
  v_exp_f32 v83, v83
  v_mfma_f32_32x32x16_bf16 v[112:127], v[52:55], v[100:103], v[112:127]
  v_cvt_pk_bf16_f32 v104, v80, v81
  v_exp_f32 v84, v84
  v_exp_f32 v85, v85
  v_cvt_pk_bf16_f32 v105, v82, v83
  v_exp_f32 v86, v86
  s_waitcnt lgkmcnt(2)
  v_mfma_f32_32x32x16_bf16 v[64:79], v[40:43], v[192:195], 0
  v_exp_f32 v87, v87
  v_cvt_pk_bf16_f32 v106, v84, v85
  v_exp_f32 v88, v88
  v_exp_f32 v89, v89
  v_cvt_pk_bf16_f32 v107, v86, v87
  v_mfma_f32_32x32x16_bf16 v[64:79], v[44:47], v[196:199], v[64:79]
  v_exp_f32 v90, v90
  v_exp_f32 v91, v91
  ds_read_b128 v[32:35], v4 offset:28672
  v_cvt_pk_bf16_f32 v108, v88, v89
  v_exp_f32 v92, v92
  v_exp_f32 v93, v93
  ds_read_b128 v[36:39], v4 offset:29696
  v_cvt_pk_bf16_f32 v109, v90, v91
  v_exp_f32 v94, v94
  v_exp_f32 v95, v95
  v_cvt_pk_bf16_f32 v110, v92, v93
  v_cvt_pk_bf16_f32 v111, v94, v95
  v_mfma_f32_32x32x16_bf16 v[128:143], v[48:51], v[104:107], v[128:143]
  v_exp_f32 v64, v64
  v_exp_f32 v65, v65
  v_exp_f32 v66, v66
  v_exp_f32 v67, v67
  v_mfma_f32_32x32x16_bf16 v[128:143], v[52:55], v[108:111], v[128:143]
  v_cvt_pk_bf16_f32 v96, v64, v65
  v_exp_f32 v68, v68
  v_exp_f32 v69, v69
  v_cvt_pk_bf16_f32 v97, v66, v67
  v_exp_f32 v70, v70
  v_mfma_f32_32x32x16_bf16 v[80:95], v[40:43], v[200:203], 0
  v_exp_f32 v71, v71
  v_cvt_pk_bf16_f32 v98, v68, v69
  v_exp_f32 v72, v72
  v_exp_f32 v73, v73
  v_cvt_pk_bf16_f32 v99, v70, v71
  v_mfma_f32_32x32x16_bf16 v[80:95], v[44:47], v[204:207], v[80:95]
  v_exp_f32 v74, v74
  v_exp_f32 v75, v75
  ds_read_b128 v[48:51], v4 offset:61440
  v_cvt_pk_bf16_f32 v100, v72, v73
  v_exp_f32 v76, v76
  v_exp_f32 v77, v77
  ds_read_b128 v[52:55], v4 offset:62464
  v_cvt_pk_bf16_f32 v101, v74, v75
  v_exp_f32 v78, v78
  s_add_u32 m0, s31, 37888
  s_add_u32 s29, s53, s28
  s_add_u32 s29, s29, 5120
  buffer_load_dwordx4 v2, s[8:11], s29 offen sc1 lds
  v_exp_f32 v79, v79
  v_cvt_pk_bf16_f32 v102, v76, v77
  v_cvt_pk_bf16_f32 v103, v78, v79
  s_waitcnt lgkmcnt(4)
  v_mfma_f32_32x32x16_bf16 v[112:127], v[56:59], v[96:99], v[112:127]
  v_exp_f32 v80, v80
  v_exp_f32 v81, v81
  v_exp_f32 v82, v82
  v_exp_f32 v83, v83
  v_mfma_f32_32x32x16_bf16 v[112:127], v[60:63], v[100:103], v[112:127]
  v_cvt_pk_bf16_f32 v104, v80, v81
  v_exp_f32 v84, v84
  v_exp_f32 v85, v85
  v_cvt_pk_bf16_f32 v105, v82, v83
  v_exp_f32 v86, v86
  s_waitcnt lgkmcnt(2)
  v_mfma_f32_32x32x16_bf16 v[64:79], v[32:35], v[192:195], 0
  v_exp_f32 v87, v87
  v_cvt_pk_bf16_f32 v106, v84, v85
  v_exp_f32 v88, v88
  v_exp_f32 v89, v89
  v_cvt_pk_bf16_f32 v107, v86, v87
  v_mfma_f32_32x32x16_bf16 v[64:79], v[36:39], v[196:199], v[64:79]
  v_exp_f32 v90, v90
  v_exp_f32 v91, v91
  ds_read_b128 v[40:43], v4 offset:30720
  v_cvt_pk_bf16_f32 v108, v88, v89
  v_exp_f32 v92, v92
  v_exp_f32 v93, v93
  ds_read_b128 v[44:47], v4 offset:31744
  v_cvt_pk_bf16_f32 v109, v90, v91
  v_exp_f32 v94, v94
  v_exp_f32 v95, v95
  v_cvt_pk_bf16_f32 v110, v92, v93
  v_cvt_pk_bf16_f32 v111, v94, v95
  v_mfma_f32_32x32x16_bf16 v[128:143], v[56:59], v[104:107], v[128:143]
  v_exp_f32 v64, v64
  v_exp_f32 v65, v65
  v_exp_f32 v66, v66
  v_exp_f32 v67, v67
  v_mfma_f32_32x32x16_bf16 v[128:143], v[60:63], v[108:111], v[128:143]
  v_cvt_pk_bf16_f32 v96, v64, v65
  v_exp_f32 v68, v68
  v_exp_f32 v69, v69
  v_cvt_pk_bf16_f32 v97, v66, v67
  v_exp_f32 v70, v70
  v_mfma_f32_32x32x16_bf16 v[80:95], v[32:35], v[200:203], 0
  v_exp_f32 v71, v71
  v_cvt_pk_bf16_f32 v98, v68, v69
  v_exp_f32 v72, v72
  v_exp_f32 v73, v73
  v_cvt_pk_bf16_f32 v99, v70, v71
  v_mfma_f32_32x32x16_bf16 v[80:95], v[36:39], v[204:207], v[80:95]
  v_exp_f32 v74, v74
  v_exp_f32 v75, v75
  ds_read_b128 v[56:59], v4 offset:63488
  v_cvt_pk_bf16_f32 v100, v72, v73
  v_exp_f32 v76, v76
  v_exp_f32 v77, v77
  ds_read_b128 v[60:63], v4 offset:64512
  v_cvt_pk_bf16_f32 v101, v74, v75
  v_exp_f32 v78, v78
  s_add_u32 m0, s31, 38912
  s_add_u32 s29, s53, s28
  s_add_u32 s29, s29, 6144
  buffer_load_dwordx4 v2, s[8:11], s29 offen sc1 lds
  v_exp_f32 v79, v79
  v_cvt_pk_bf16_f32 v102, v76, v77
  v_cvt_pk_bf16_f32 v103, v78, v79
  s_waitcnt lgkmcnt(4)
  v_mfma_f32_32x32x16_bf16 v[112:127], v[48:51], v[96:99], v[112:127]
  v_exp_f32 v80, v80
  v_exp_f32 v81, v81
  v_exp_f32 v82, v82
  v_exp_f32 v83, v83
  v_mfma_f32_32x32x16_bf16 v[112:127], v[52:55], v[100:103], v[112:127]
  v_cvt_pk_bf16_f32 v104, v80, v81
  v_exp_f32 v84, v84
  v_exp_f32 v85, v85
  v_cvt_pk_bf16_f32 v105, v82, v83
  v_exp_f32 v86, v86
  s_waitcnt lgkmcnt(2)
  v_mfma_f32_32x32x16_bf16 v[64:79], v[40:43], v[192:195], 0
  v_exp_f32 v87, v87
  v_cvt_pk_bf16_f32 v106, v84, v85
  v_exp_f32 v88, v88
  v_exp_f32 v89, v89
  v_cvt_pk_bf16_f32 v107, v86, v87
  v_mfma_f32_32x32x16_bf16 v[64:79], v[44:47], v[196:199], v[64:79]
  v_exp_f32 v90, v90
  v_exp_f32 v91, v91
  v_cvt_pk_bf16_f32 v108, v88, v89
  v_exp_f32 v92, v92
  v_exp_f32 v93, v93
  v_cvt_pk_bf16_f32 v109, v90, v91
  v_exp_f32 v94, v94
  v_exp_f32 v95, v95
  v_cvt_pk_bf16_f32 v110, v92, v93
  v_cvt_pk_bf16_f32 v111, v94, v95
  v_mfma_f32_32x32x16_bf16 v[128:143], v[48:51], v[104:107], v[128:143]
  v_exp_f32 v64, v64
  v_exp_f32 v65, v65
  v_exp_f32 v66, v66
  v_exp_f32 v67, v67
  v_mfma_f32_32x32x16_bf16 v[128:143], v[52:55], v[108:111], v[128:143]
  v_cvt_pk_bf16_f32 v96, v64, v65
  v_exp_f32 v68, v68
  v_exp_f32 v69, v69
  v_cvt_pk_bf16_f32 v97, v66, v67
  v_exp_f32 v70, v70
  v_mfma_f32_32x32x16_bf16 v[80:95], v[40:43], v[200:203], 0
  v_exp_f32 v71, v71
  v_cvt_pk_bf16_f32 v98, v68, v69
  v_exp_f32 v72, v72
  v_exp_f32 v73, v73
  v_cvt_pk_bf16_f32 v99, v70, v71
  v_mfma_f32_32x32x16_bf16 v[80:95], v[44:47], v[204:207], v[80:95]
  v_exp_f32 v74, v74
  v_exp_f32 v75, v75
  v_cvt_pk_bf16_f32 v100, v72, v73
  v_exp_f32 v76, v76
  v_exp_f32 v77, v77
  v_cvt_pk_bf16_f32 v101, v74, v75
  v_exp_f32 v78, v78
  s_add_u32 m0, s31, 39936
  s_add_u32 s29, s53, s28
  s_add_u32 s29, s29, 7168
  buffer_load_dwordx4 v2, s[8:11], s29 offen sc1 lds
  v_exp_f32 v79, v79
  v_cvt_pk_bf16_f32 v102, v76, v77
  v_cvt_pk_bf16_f32 v103, v78, v79
  s_waitcnt lgkmcnt(0)
  v_mfma_f32_32x32x16_bf16 v[112:127], v[56:59], v[96:99], v[112:127]
  v_exp_f32 v80, v80
  v_exp_f32 v81, v81
  v_exp_f32 v82, v82
  v_exp_f32 v83, v83
  v_mfma_f32_32x32x16_bf16 v[112:127], v[60:63], v[100:103], v[112:127]
  v_cvt_pk_bf16_f32 v104, v80, v81
  v_exp_f32 v84, v84
  v_exp_f32 v85, v85
  v_cvt_pk_bf16_f32 v105, v82, v83
  v_exp_f32 v86, v86
  v_exp_f32 v87, v87
  v_cvt_pk_bf16_f32 v106, v84, v85
  v_exp_f32 v88, v88
  v_exp_f32 v89, v89
  v_cvt_pk_bf16_f32 v107, v86, v87
  v_exp_f32 v90, v90
  v_exp_f32 v91, v91
  v_cvt_pk_bf16_f32 v108, v88, v89
  v_exp_f32 v92, v92
  v_exp_f32 v93, v93
  v_cvt_pk_bf16_f32 v109, v90, v91
  v_exp_f32 v94, v94
  v_exp_f32 v95, v95
  v_cvt_pk_bf16_f32 v110, v92, v93
  v_cvt_pk_bf16_f32 v111, v94, v95
  s_nop 1
  v_mfma_f32_32x32x16_bf16 v[128:143], v[56:59], v[104:107], v[128:143]
  v_mfma_f32_32x32x16_bf16 v[128:143], v[60:63], v[108:111], v[128:143]
  s_cmp_lt_u32 s41, 4
  s_cbranch_scc1 kb1_chunk2
  s_nop 11
  v_mov_b32 v5, v120
  v_mov_b32 v6, v120
  s_nop 1
  v_permlane32_swap_b32 v5, v6
  v_mov_b32 v14, v6
  v_mov_b32 v5, v136
  v_mov_b32 v6, v136
  s_nop 1
  v_permlane32_swap_b32 v5, v6
  v_mov_b32 v15, v6
  s_cmp_eq_u32 s40, 0
  s_cbranch_scc0 kb1_fin
  v_min_f32 v5, v14, v15
  v_cmp_gt_f32 vcc, 0x12800000, v5
  v_cmp_u_f32 s[36:37], v5, v5
  s_nop 1
  s_or_b64 vcc, vcc, s[36:37]
  s_cmp_lg_u64 vcc, 0
  s_cselect_b32 s42, 1, 0
  v_mov_b32 v5, s42
  s_lshl_b32 s30, s21, 2
  s_add_u32 s30, s30, 131584
  v_mov_b32 v6, s30
  ds_write_b32 v6, v5
  s_waitcnt vmcnt(0) lgkmcnt(0)
  s_barrier
  v_mov_b32 v6, 131584
  ds_read_b128 v[8:11], v6
  s_waitcnt lgkmcnt(0)
  v_or_b32 v8, v8, v9
  v_or_b32 v10, v10, v11
  v_or_b32 v8, v8, v10
  s_nop 0
  v_readfirstlane_b32 s42, v8
  s_cmp_eq_u32 s42, 0
  s_cbranch_scc1 kb1_fin
  s_mov_b32 s40, 1
  v_and_b32 v5, 0xffff0000, v198
  v_cndmask_b32 v198, v198, v5, s[34:35]
  v_mov_b32 v12, 0xff7fffff
  v_and_b32 v5, 0xffff0000, v206
  v_cndmask_b32 v206, v206, v5, s[34:35]
  v_mov_b32 v13, 0xff7fffff
  s_mov_b32 s41, 0
kb1_mx:
  s_lshl_b32 s30, s41, 11
  s_add_u32 s30, s30, s27
  buffer_load_dwordx4 v[32:35], v2, s[8:11], s30 offen sc1
  buffer_load_dwordx4 v[36:39], v2, s[8:11], s30 offen offset:1024 sc1
  s_waitcnt vmcnt(0)
  v_mfma_f32_32x32x16_bf16 v[64:79], v[32:35], v[192:195], 0
  v_mfma_f32_32x32x16_bf16 v[64:79], v[36:39], v[196:199], v[64:79]
  v_mfma_f32_32x32x16_bf16 v[80:95], v[32:35], v[200:203], 0
  v_mfma_f32_32x32x16_bf16 v[80:95], v[36:39], v[204:207], v[80:95]
  s_nop 11
  v_max3_f32 v12, v12, v64, v65
  v_max3_f32 v12, v12, v66, v67
  v_max3_f32 v12, v12, v68, v69
  v_max3_f32 v12, v12, v70, v71
  v_max3_f32 v12, v12, v72, v73
  v_max3_f32 v12, v12, v74, v75
  v_max3_f32 v12, v12, v76, v77
  v_max3_f32 v12, v12, v78, v79
  v_max3_f32 v13, v13, v80, v81
  v_max3_f32 v13, v13, v82, v83
  v_max3_f32 v13, v13, v84, v85
  v_max3_f32 v13, v13, v86, v87
  v_max3_f32 v13, v13, v88, v89
  v_max3_f32 v13, v13, v90, v91
  v_max3_f32 v13, v13, v92, v93
  v_max3_f32 v13, v13, v94, v95
  s_add_u32 s41, s41, 1
  s_cmp_lt_u32 s41, 64
  s_cbranch_scc1 kb1_mx
  v_mov_b32 v5, v12
  s_nop 1
  v_permlane32_swap_b32 v12, v5
  v_max_f32 v12, v12, v5
  v_cvt_pk_bf16_f32 v5, v12, v12
  v_and_b32 v5, 0xffff, v5
  v_xor_b32 v5, 0x8000, v5
  v_and_b32 v6, 0xffff0000, v198
  v_or_b32 v5, v5, v6
  v_cndmask_b32 v198, v198, v5, s[34:35]
  v_mov_b32 v5, v13
  s_nop 1
  v_permlane32_swap_b32 v13, v5
  v_max_f32 v13, v13, v5
  v_cvt_pk_bf16_f32 v5, v13, v13
  v_and_b32 v5, 0xffff, v5
  v_xor_b32 v5, 0x8000, v5
  v_and_b32 v6, 0xffff0000, v206
  v_or_b32 v5, v5, v6
  v_cndmask_b32 v206, v206, v5, s[34:35]
  s_barrier
  s_mov_b32 s41, 0
  s_mul_i32 s53, s41, 32768
  s_lshl_b32 s31, s21, 13
  s_add_u32 s53, s53, s31
  s_add_u32 m0, s31, 0
  s_add_u32 s29, s53, s27
  s_add_u32 s29, s29, 0
  buffer_load_dwordx4 v2, s[8:11], s29 offen sc1 lds
  s_add_u32 m0, s31, 1024
  s_add_u32 s29, s53, s27
  s_add_u32 s29, s29, 1024
  buffer_load_dwordx4 v2, s[8:11], s29 offen sc1 lds
  s_add_u32 m0, s31, 2048
  s_add_u32 s29, s53, s27
  s_add_u32 s29, s29, 2048
  buffer_load_dwordx4 v2, s[8:11], s29 offen sc1 lds
  s_add_u32 m0, s31, 3072
  s_add_u32 s29, s53, s27
  s_add_u32 s29, s29, 3072
  buffer_load_dwordx4 v2, s[8:11], s29 offen sc1 lds
  s_add_u32 m0, s31, 4096
  s_add_u32 s29, s53, s27
  s_add_u32 s29, s29, 4096
  buffer_load_dwordx4 v2, s[8:11], s29 offen sc1 lds
  s_add_u32 m0, s31, 5120
  s_add_u32 s29, s53, s27
  s_add_u32 s29, s29, 5120
  buffer_load_dwordx4 v2, s[8:11], s29 offen sc1 lds
  s_add_u32 m0, s31, 6144
  s_add_u32 s29, s53, s27
  s_add_u32 s29, s29, 6144
  buffer_load_dwordx4 v2, s[8:11], s29 offen sc1 lds
  s_add_u32 m0, s31, 7168
  s_add_u32 s29, s53, s27
  s_add_u32 s29, s29, 7168
  buffer_load_dwordx4 v2, s[8:11], s29 offen sc1 lds
  s_add_u32 m0, s31, 32768
  s_add_u32 s29, s53, s28
  s_add_u32 s29, s29, 0
  buffer_load_dwordx4 v2, s[8:11], s29 offen sc1 lds
  s_add_u32 m0, s31, 33792
  s_add_u32 s29, s53, s28
  s_add_u32 s29, s29, 1024
  buffer_load_dwordx4 v2, s[8:11], s29 offen sc1 lds
  s_add_u32 m0, s31, 34816
  s_add_u32 s29, s53, s28
  s_add_u32 s29, s29, 2048
  buffer_load_dwordx4 v2, s[8:11], s29 offen sc1 lds
  s_add_u32 m0, s31, 35840
  s_add_u32 s29, s53, s28
  s_add_u32 s29, s29, 3072
  buffer_load_dwordx4 v2, s[8:11], s29 offen sc1 lds
  s_add_u32 m0, s31, 36864
  s_add_u32 s29, s53, s28
  s_add_u32 s29, s29, 4096
  buffer_load_dwordx4 v2, s[8:11], s29 offen sc1 lds
  s_add_u32 m0, s31, 37888
  s_add_u32 s29, s53, s28
  s_add_u32 s29, s29, 5120
  buffer_load_dwordx4 v2, s[8:11], s29 offen sc1 lds
  s_add_u32 m0, s31, 38912
  s_add_u32 s29, s53, s28
  s_add_u32 s29, s29, 6144
  buffer_load_dwordx4 v2, s[8:11], s29 offen sc1 lds
  s_add_u32 m0, s31, 39936
  s_add_u32 s29, s53, s28
  s_add_u32 s29, s29, 7168
  buffer_load_dwordx4 v2, s[8:11], s29 offen sc1 lds
  s_branch kb1_main2
kb1_fin:
  v_and_b32 v3, 15, v1
  v_bfe_u32 v11, v1, 4, 1
  v_mul_u32_u24 v11, 20480, v11
  v_lshrrev_b32 v4, 5, v1
  s_mul_i32 s30, s22, 20
  v_lshlrev_b32 v5, 2, v4
  v_add_u32 v5, 0, v5
  v_add_u32 v5, s30, v5
  v_lshrrev_b32 v6, 5, v5
  v_lshlrev_b32 v6, 10, v6
  v_bfe_u32 v7, v5, 3, 2
  v_lshlrev_b32 v7, 4, v7
  v_add_u32 v7, v7, v3
  v_lshlrev_b32 v7, 4, v7
  v_add_u32 v6, v6, v7
  v_bfe_u32 v7, v5, 2, 1
  v_lshlrev_b32 v7, 3, v7
  v_add_u32 v6, v6, v7
  v_add_u32 v32, v6, v11
  v_lshlrev_b32 v5, 2, v4
  v_add_u32 v5, 8, v5
  v_add_u32 v5, s30, v5
  v_lshrrev_b32 v6, 5, v5
  v_lshlrev_b32 v6, 10, v6
  v_bfe_u32 v7, v5, 3, 2
  v_lshlrev_b32 v7, 4, v7
  v_add_u32 v7, v7, v3
  v_lshlrev_b32 v7, 4, v7
  v_add_u32 v6, v6, v7
  v_bfe_u32 v7, v5, 2, 1
  v_lshlrev_b32 v7, 3, v7
  v_add_u32 v6, v6, v7
  v_add_u32 v33, v6, v11
  v_lshlrev_b32 v5, 2, v4
  v_add_u32 v5, 16, v5
  v_add_u32 v5, s30, v5
  v_lshrrev_b32 v6, 5, v5
  v_lshlrev_b32 v6, 10, v6
  v_bfe_u32 v7, v5, 3, 2
  v_lshlrev_b32 v7, 4, v7
  v_add_u32 v7, v7, v3
  v_lshlrev_b32 v7, 4, v7
  v_add_u32 v6, v6, v7
  v_bfe_u32 v7, v5, 2, 1
  v_lshlrev_b32 v7, 3, v7
  v_add_u32 v6, v6, v7
  v_add_u32 v34, v6, v11
  v_mov_b32 v5, 0x40000000
  v_cndmask_b32 v34, v5, v34, s[34:35]
  v_rcp_f32 v5, v14
  s_nop 0
  v_mul_f32 v112, v112, v5
  v_mul_f32 v113, v113, v5
  v_mul_f32 v114, v114, v5
  v_mul_f32 v115, v115, v5
  v_mul_f32 v116, v116, v5
  v_mul_f32 v117, v117, v5
  v_mul_f32 v118, v118, v5
  v_mul_f32 v119, v119, v5
  v_mul_f32 v120, v120, v5
  v_mul_f32 v121, v121, v5
  v_mul_f32 v122, v122, v5
  v_mul_f32 v123, v123, v5
  v_cvt_pk_bf16_f32 v40, v112, v113
  v_cvt_pk_bf16_f32 v41, v114, v115
  v_cvt_pk_bf16_f32 v42, v116, v117
  v_cvt_pk_bf16_f32 v43, v118, v119
  v_cvt_pk_bf16_f32 v44, v120, v121
  v_cvt_pk_bf16_f32 v45, v122, v123
  s_add_u32 s31, s52, 0
  s_mul_i32 s31, s31, 40960
  s_add_u32 s31, s31, 0xf200000
  buffer_store_dwordx2 v[40:41], v32, s[8:11], s31 offen sc1
  buffer_store_dwordx2 v[42:43], v33, s[8:11], s31 offen sc1
  buffer_store_dwordx2 v[44:45], v34, s[8:11], s31 offen sc1
  v_rcp_f32 v5, v15
  s_nop 0
  v_mul_f32 v128, v128, v5
  v_mul_f32 v129, v129, v5
  v_mul_f32 v130, v130, v5
  v_mul_f32 v131, v131, v5
  v_mul_f32 v132, v132, v5
  v_mul_f32 v133, v133, v5
  v_mul_f32 v134, v134, v5
  v_mul_f32 v135, v135, v5
  v_mul_f32 v136, v136, v5
  v_mul_f32 v137, v137, v5
  v_mul_f32 v138, v138, v5
  v_mul_f32 v139, v139, v5
  v_cvt_pk_bf16_f32 v48, v128, v129
  v_cvt_pk_bf16_f32 v49, v130, v131
  v_cvt_pk_bf16_f32 v50, v132, v133
  v_cvt_pk_bf16_f32 v51, v134, v135
  v_cvt_pk_bf16_f32 v52, v136, v137
  v_cvt_pk_bf16_f32 v53, v138, v139
  s_add_u32 s31, s52, 1
  s_mul_i32 s31, s31, 40960
  s_add_u32 s31, s31, 0xf200000
  buffer_store_dwordx2 v[48:49], v32, s[8:11], s31 offen sc1
  buffer_store_dwordx2 v[50:51], v33, s[8:11], s31 offen sc1
  buffer_store_dwordx2 v[52:53], v34, s[8:11], s31 offen sc1
  s_waitcnt vmcnt(0)
  s_barrier
  s_cmp_eq_u32 s21, 0
  s_cbranch_scc0 arr_39
  s_mov_b64 s[24:25], exec
  s_mov_b64 exec, 1
  v_mov_b32 v3, 0
  v_mov_b32 v4, 1
  buffer_atomic_add v4, v3, s[8:11], s48 offen
  s_mov_b64 exec, s[24:25]
arr_39:
  v_and_b32 v5, 15, v1
  v_lshrrev_b32 v6, 4, v1
  v_and_b32 v7, 1, v6
  v_lshlrev_b32 v7, 10, v7
  v_lshrrev_b32 v8, 1, v6
  v_lshlrev_b32 v8, 5, v8
  v_add_u32 v8, v8, v5
  v_lshlrev_b32 v8, 4, v8
  v_add_u32 v9, v7, v8
  s_lshr_b32 s26, s2, 2
  s_mul_i32 s27, s26, 81920
  s_lshl_b32 s28, s50, 11
  s_add_u32 s27, s27, s28
  s_add_u32 s27, s27, 0x1400000
  s_add_u32 s28, s27, 0
  buffer_load_dwordx4 v[16:19], v9, s[8:11], s28 offen sc1
  s_add_u32 s28, s27, 256
  buffer_load_dwordx4 v[20:23], v9, s[8:11], s28 offen sc1
  s_add_u32 s28, s27, 2048
  buffer_load_dwordx4 v[24:27], v9, s[8:11], s28 offen sc1
  s_add_u32 s28, s27, 2304
  buffer_load_dwordx4 v[28:31], v9, s[8:11], s28 offen sc1
  s_cmp_lt_u32 s21, 2
  s_cbranch_scc0 g3_40
  s_add_u32 s28, s27, 4096
  buffer_load_dwordx4 v[32:35], v9, s[8:11], s28 offen sc1
  s_add_u32 s28, s27, 4352
  buffer_load_dwordx4 v[36:39], v9, s[8:11], s28 offen sc1
g3_40:
  s_mov_b32 s45, 0
  v_mov_b32 v3, 0
aw_41:
  buffer_load_dword v4, v3, s[8:11], s48 offen sc1
  s_add_u32 s45, s45, 1
  s_waitcnt vmcnt(0)
  v_readfirstlane_b32 s29, v4
  s_cmp_ge_u32 s29, 32
  s_cbranch_scc1 aw_41_ok
  s_cmp_lt_u32 s45, 400000
  s_cbranch_scc1 aw_41
  s_branch kb1_abort
aw_41_ok:
  s_mul_i32 s28, s26, 40960
  s_mul_i32 s31, s21, 10240
  s_add_u32 s28, s28, s31
  s_add_u32 s28, s28, 0xf200000
  s_add_u32 m0, s31, 0
  s_add_u32 s29, s28, 0
  buffer_load_dwordx4 v2, s[8:11], s29 offen sc1 lds
  s_add_u32 m0, s31, 1024
  s_add_u32 s29, s28, 1024
  buffer_load_dwordx4 v2, s[8:11], s29 offen sc1 lds
  s_add_u32 m0, s31, 2048
  s_add_u32 s29, s28, 2048
  buffer_load_dwordx4 v2, s[8:11], s29 offen sc1 lds
  s_add_u32 m0, s31, 3072
  s_add_u32 s29, s28, 3072
  buffer_load_dwordx4 v2, s[8:11], s29 offen sc1 lds
  s_add_u32 m0, s31, 4096
  s_add_u32 s29, s28, 4096
  buffer_load_dwordx4 v2, s[8:11], s29 offen sc1 lds
  s_add_u32 m0, s31, 5120
  s_add_u32 s29, s28, 5120
  buffer_load_dwordx4 v2, s[8:11], s29 offen sc1 lds
  s_add_u32 m0, s31, 6144
  s_add_u32 s29, s28, 6144
  buffer_load_dwordx4 v2, s[8:11], s29 offen sc1 lds
  s_add_u32 m0, s31, 7168
  s_add_u32 s29, s28, 7168
  buffer_load_dwordx4 v2, s[8:11], s29 offen sc1 lds
  s_add_u32 m0, s31, 8192
  s_add_u32 s29, s28, 8192
  buffer_load_dwordx4 v2, s[8:11], s29 offen sc1 lds
  s_add_u32 m0, s31, 9216
  s_add_u32 s29, s28, 9216
  buffer_load_dwordx4 v2, s[8:11], s29 offen sc1 lds
  s_waitcnt vmcnt(0)
  s_barrier
  ds_read_b128 v[80:83], v2 offset:0
  ds_read_b128 v[84:87], v2 offset:20480
  ds_read_b128 v[88:91], v2 offset:1024
  ds_read_b128 v[92:95], v2 offset:21504
  ds_read_b128 v[96:99], v2 offset:2048
  ds_read_b128 v[100:103], v2 offset:22528
  s_waitcnt lgkmcnt(4)
  v_mfma_f32_16x16x32_bf16 v[48:51], a[0:3], v[80:83], 0
  v_mfma_f32_16x16x32_bf16 v[52:55], a[0:3], v[84:87], 0
  v_mfma_f32_16x16x32_bf16 v[56:59], a[80:83], v[80:83], 0
  v_mfma_f32_16x16x32_bf16 v[60:63], a[80:83], v[84:87], 0
  v_mfma_f32_16x16x32_bf16 v[64:67], a[160:163], v[80:83], 0
  v_mfma_f32_16x16x32_bf16 v[68:71], a[160:163], v[84:87], 0
  ds_read_b128 v[80:83], v2 offset:3072
  ds_read_b128 v[84:87], v2 offset:23552
  s_waitcnt lgkmcnt(4)
  v_mfma_f32_16x16x32_bf16 v[48:51], a[4:7], v[88:91], v[48:51]
  v_mfma_f32_16x16x32_bf16 v[52:55], a[4:7], v[92:95], v[52:55]
  v_mfma_f32_16x16x32_bf16 v[56:59], a[84:87], v[88:91], v[56:59]
  v_mfma_f32_16x16x32_bf16 v[60:63], a[84:87], v[92:95], v[60:63]
  v_mfma_f32_16x16x32_bf16 v[64:67], a[164:167], v[88:91], v[64:67]
  v_mfma_f32_16x16x32_bf16 v[68:71], a[164:167], v[92:95], v[68:71]
  ds_read_b128 v[88:91], v2 offset:4096
  ds_read_b128 v[92:95], v2 offset:24576
  s_waitcnt lgkmcnt(4)
  v_mfma_f32_16x16x32_bf16 v[48:51], a[8:11], v[96:99], v[48:51]
  v_mfma_f32_16x16x32_bf16 v[52:55], a[8:11], v[100:103], v[52:55]
  v_mfma_f32_16x16x32_bf16 v[56:59], a[88:91], v[96:99], v[56:59]
  v_mfma_f32_16x16x32_bf16 v[60:63], a[88:91], v[100:103], v[60:63]
  v_mfma_f32_16x16x32_bf16 v[64:67], a[168:171], v[96:99], v[64:67]
  v_mfma_f32_16x16x32_bf16 v[68:71], a[168:171], v[100:103], v[68:71]
  ds_read_b128 v[96:99], v2 offset:5120
  ds_read_b128 v[100:103], v2 offset:25600
  s_waitcnt lgkmcnt(4)
  v_mfma_f32_16x16x32_bf16 v[48:51], a[12:15], v[80:83], v[48:51]
  v_mfma_f32_16x16x32_bf16 v[52:55], a[12:15], v[84:87], v[52:55]
  v_mfma_f32_16x16x32_bf16 v[56:59], a[92:95], v[80:83], v[56:59]
  v_mfma_f32_16x16x32_bf16 v[60:63], a[92:95], v[84:87], v[60:63]
  v_mfma_f32_16x16x32_bf16 v[64:67], a[172:175], v[80:83], v[64:67]
  v_mfma_f32_16x16x32_bf16 v[68:71], a[172:175], v[84:87], v[68:71]
  ds_read_b128 v[80:83], v2 offset:6144
  ds_read_b128 v[84:87], v2 offset:26624
  s_waitcnt lgkmcnt(4)
  v_mfma_f32_16x16x32_bf16 v[48:51], a[16:19], v[88:91], v[48:51]
  v_mfma_f32_16x16x32_bf16 v[52:55], a[16:19], v[92:95], v[52:55]
  v_mfma_f32_16x16x32_bf16 v[56:59], a[96:99], v[88:91], v[56:59]
  v_mfma_f32_16x16x32_bf16 v[60:63], a[96:99], v[92:95], v[60:63]
  v_mfma_f32_16x16x32_bf16 v[64:67], a[176:179], v[88:91], v[64:67]
  v_mfma_f32_16x16x32_bf16 v[68:71], a[176:179], v[92:95], v[68:71]
  ds_read_b128 v[88:91], v2 offset:7168
  ds_read_b128 v[92:95], v2 offset:27648
  s_waitcnt lgkmcnt(4)
  v_mfma_f32_16x16x32_bf16 v[48:51], a[20:23], v[96:99], v[48:51]
  v_mfma_f32_16x16x32_bf16 v[52:55], a[20:23], v[100:103], v[52:55]
  v_mfma_f32_16x16x32_bf16 v[56:59], a[100:103], v[96:99], v[56:59]
  v_mfma_f32_16x16x32_bf16 v[60:63], a[100:103], v[100:103], v[60:63]
  v_mfma_f32_16x16x32_bf16 v[64:67], a[180:183], v[96:99], v[64:67]
  v_mfma_f32_16x16x32_bf16 v[68:71], a[180:183], v[100:103], v[68:71]
  ds_read_b128 v[96:99], v2 offset:8192
  ds_read_b128 v[100:103], v2 offset:28672
  s_waitcnt lgkmcnt(4)
  v_mfma_f32_16x16x32_bf16 v[48:51], a[24:27], v[80:83], v[48:51]
  v_mfma_f32_16x16x32_bf16 v[52:55], a[24:27], v[84:87], v[52:55]
  v_mfma_f32_16x16x32_bf16 v[56:59], a[104:107], v[80:83], v[56:59]
  v_mfma_f32_16x16x32_bf16 v[60:63], a[104:107], v[84:87], v[60:63]
  v_mfma_f32_16x16x32_bf16 v[64:67], a[184:187], v[80:83], v[64:67]
  v_mfma_f32_16x16x32_bf16 v[68:71], a[184:187], v[84:87], v[68:71]
  ds_read_b128 v[80:83], v2 offset:9216
  ds_read_b128 v[84:87], v2 offset:29696
  s_waitcnt lgkmcnt(4)
  v_mfma_f32_16x16x32_bf16 v[48:51], a[28:31], v[88:91], v[48:51]
  v_mfma_f32_16x16x32_bf16 v[52:55], a[28:31], v[92:95], v[52:55]
  v_mfma_f32_16x16x32_bf16 v[56:59], a[108:111], v[88:91], v[56:59]
  v_mfma_f32_16x16x32_bf16 v[60:63], a[108:111], v[92:95], v[60:63]
  v_mfma_f32_16x16x32_bf16 v[64:67], a[188:191], v[88:91], v[64:67]
  v_mfma_f32_16x16x32_bf16 v[68:71], a[188:191], v[92:95], v[68:71]
  ds_read_b128 v[88:91], v2 offset:10240
  ds_read_b128 v[92:95], v2 offset:30720
  s_waitcnt lgkmcnt(4)
  v_mfma_f32_16x16x32_bf16 v[48:51], a[32:35], v[96:99], v[48:51]
  v_mfma_f32_16x16x32_bf16 v[52:55], a[32:35], v[100:103], v[52:55]
  v_mfma_f32_16x16x32_bf16 v[56:59], a[112:115], v[96:99], v[56:59]
  v_mfma_f32_16x16x32_bf16 v[60:63], a[112:115], v[100:103], v[60:63]
  v_mfma_f32_16x16x32_bf16 v[64:67], a[192:195], v[96:99], v[64:67]
  v_mfma_f32_16x16x32_bf16 v[68:71], a[192:195], v[100:103], v[68:71]
  ds_read_b128 v[96:99], v2 offset:11264
  ds_read_b128 v[100:103], v2 offset:31744
  s_waitcnt lgkmcnt(4)
  v_mfma_f32_16x16x32_bf16 v[48:51], a[36:39], v[80:83], v[48:51]
  v_mfma_f32_16x16x32_bf16 v[52:55], a[36:39], v[84:87], v[52:55]
  v_mfma_f32_16x16x32_bf16 v[56:59], a[116:119], v[80:83], v[56:59]
  v_mfma_f32_16x16x32_bf16 v[60:63], a[116:119], v[84:87], v[60:63]
  v_mfma_f32_16x16x32_bf16 v[64:67], a[196:199], v[80:83], v[64:67]
  v_mfma_f32_16x16x32_bf16 v[68:71], a[196:199], v[84:87], v[68:71]
  ds_read_b128 v[80:83], v2 offset:12288
  ds_read_b128 v[84:87], v2 offset:32768
  s_waitcnt lgkmcnt(4)
  v_mfma_f32_16x16x32_bf16 v[48:51], a[40:43], v[88:91], v[48:51]
  v_mfma_f32_16x16x32_bf16 v[52:55], a[40:43], v[92:95], v[52:55]
  v_mfma_f32_16x16x32_bf16 v[56:59], a[120:123], v[88:91], v[56:59]
  v_mfma_f32_16x16x32_bf16 v[60:63], a[120:123], v[92:95], v[60:63]
  v_mfma_f32_16x16x32_bf16 v[64:67], a[200:203], v[88:91], v[64:67]
  v_mfma_f32_16x16x32_bf16 v[68:71], a[200:203], v[92:95], v[68:71]
  ds_read_b128 v[88:91], v2 offset:13312
  ds_read_b128 v[92:95], v2 offset:33792
  s_waitcnt lgkmcnt(4)
  v_mfma_f32_16x16x32_bf16 v[48:51], a[44:47], v[96:99], v[48:51]
  v_mfma_f32_16x16x32_bf16 v[52:55], a[44:47], v[100:103], v[52:55]
  v_mfma_f32_16x16x32_bf16 v[56:59], a[124:127], v[96:99], v[56:59]
  v_mfma_f32_16x16x32_bf16 v[60:63], a[124:127], v[100:103], v[60:63]
  v_mfma_f32_16x16x32_bf16 v[64:67], a[204:207], v[96:99], v[64:67]
  v_mfma_f32_16x16x32_bf16 v[68:71], a[204:207], v[100:103], v[68:71]
  ds_read_b128 v[96:99], v2 offset:14336
  ds_read_b128 v[100:103], v2 offset:34816
  s_waitcnt lgkmcnt(4)
  v_mfma_f32_16x16x32_bf16 v[48:51], a[48:51], v[80:83], v[48:51]
  v_mfma_f32_16x16x32_bf16 v[52:55], a[48:51], v[84:87], v[52:55]
  v_mfma_f32_16x16x32_bf16 v[56:59], a[128:131], v[80:83], v[56:59]
  v_mfma_f32_16x16x32_bf16 v[60:63], a[128:131], v[84:87], v[60:63]
  v_mfma_f32_16x16x32_bf16 v[64:67], a[208:211], v[80:83], v[64:67]
  v_mfma_f32_16x16x32_bf16 v[68:71], a[208:211], v[84:87], v[68:71]
  ds_read_b128 v[80:83], v2 offset:15360
  ds_read_b128 v[84:87], v2 offset:35840
  s_waitcnt lgkmcnt(4)
  v_mfma_f32_16x16x32_bf16 v[48:51], a[52:55], v[88:91], v[48:51]
  v_mfma_f32_16x16x32_bf16 v[52:55], a[52:55], v[92:95], v[52:55]
  v_mfma_f32_16x16x32_bf16 v[56:59], a[132:135], v[88:91], v[56:59]
  v_mfma_f32_16x16x32_bf16 v[60:63], a[132:135], v[92:95], v[60:63]
  v_mfma_f32_16x16x32_bf16 v[64:67], a[212:215], v[88:91], v[64:67]
  v_mfma_f32_16x16x32_bf16 v[68:71], a[212:215], v[92:95], v[68:71]
  ds_read_b128 v[88:91], v2 offset:16384
  ds_read_b128 v[92:95], v2 offset:36864
  s_waitcnt lgkmcnt(4)
  v_mfma_f32_16x16x32_bf16 v[48:51], a[56:59], v[96:99], v[48:51]
  v_mfma_f32_16x16x32_bf16 v[52:55], a[56:59], v[100:103], v[52:55]
  v_mfma_f32_16x16x32_bf16 v[56:59], a[136:139], v[96:99], v[56:59]
  v_mfma_f32_16x16x32_bf16 v[60:63], a[136:139], v[100:103], v[60:63]
  v_mfma_f32_16x16x32_bf16 v[64:67], a[216:219], v[96:99], v[64:67]
  v_mfma_f32_16x16x32_bf16 v[68:71], a[216:219], v[100:103], v[68:71]
  ds_read_b128 v[96:99], v2 offset:17408
  ds_read_b128 v[100:103], v2 offset:37888
  s_waitcnt lgkmcnt(4)
  v_mfma_f32_16x16x32_bf16 v[48:51], a[60:63], v[80:83], v[48:51]
  v_mfma_f32_16x16x32_bf16 v[52:55], a[60:63], v[84:87], v[52:55]
  v_mfma_f32_16x16x32_bf16 v[56:59], a[140:143], v[80:83], v[56:59]
  v_mfma_f32_16x16x32_bf16 v[60:63], a[140:143], v[84:87], v[60:63]
  v_mfma_f32_16x16x32_bf16 v[64:67], a[220:223], v[80:83], v[64:67]
  v_mfma_f32_16x16x32_bf16 v[68:71], a[220:223], v[84:87], v[68:71]
  ds_read_b128 v[80:83], v2 offset:18432
  ds_read_b128 v[84:87], v2 offset:38912
  s_waitcnt lgkmcnt(4)
  v_mfma_f32_16x16x32_bf16 v[48:51], a[64:67], v[88:91], v[48:51]
  v_mfma_f32_16x16x32_bf16 v[52:55], a[64:67], v[92:95], v[52:55]
  v_mfma_f32_16x16x32_bf16 v[56:59], a[144:147], v[88:91], v[56:59]
  v_mfma_f32_16x16x32_bf16 v[60:63], a[144:147], v[92:95], v[60:63]
  v_mfma_f32_16x16x32_bf16 v[64:67], a[224:227], v[88:91], v[64:67]
  v_mfma_f32_16x16x32_bf16 v[68:71], a[224:227], v[92:95], v[68:71]
  ds_read_b128 v[88:91], v2 offset:19456
  ds_read_b128 v[92:95], v2 offset:39936
  s_waitcnt lgkmcnt(4)
  v_mfma_f32_16x16x32_bf16 v[48:51], a[68:71], v[96:99], v[48:51]
  v_mfma_f32_16x16x32_bf16 v[52:55], a[68:71], v[100:103], v[52:55]
  v_mfma_f32_16x16x32_bf16 v[56:59], a[148:151], v[96:99], v[56:59]
  v_mfma_f32_16x16x32_bf16 v[60:63], a[148:151], v[100:103], v[60:63]
  v_mfma_f32_16x16x32_bf16 v[64:67], a[228:231], v[96:99], v[64:67]
  v_mfma_f32_16x16x32_bf16 v[68:71], a[228:231], v[100:103], v[68:71]
  s_waitcnt lgkmcnt(2)
  v_mfma_f32_16x16x32_bf16 v[48:51], a[72:75], v[80:83], v[48:51]
  v_mfma_f32_16x16x32_bf16 v[52:55], a[72:75], v[84:87], v[52:55]
  v_mfma_f32_16x16x32_bf16 v[56:59], a[152:155], v[80:83], v[56:59]
  v_mfma_f32_16x16x32_bf16 v[60:63], a[152:155], v[84:87], v[60:63]
  v_mfma_f32_16x16x32_bf16 v[64:67], a[232:235], v[80:83], v[64:67]
  v_mfma_f32_16x16x32_bf16 v[68:71], a[232:235], v[84:87], v[68:71]
  s_waitcnt lgkmcnt(0)
  v_mfma_f32_16x16x32_bf16 v[48:51], a[76:79], v[88:91], v[48:51]
  v_mfma_f32_16x16x32_bf16 v[52:55], a[76:79], v[92:95], v[52:55]
  v_mfma_f32_16x16x32_bf16 v[56:59], a[156:159], v[88:91], v[56:59]
  v_mfma_f32_16x16x32_bf16 v[60:63], a[156:159], v[92:95], v[60:63]
  v_mfma_f32_16x16x32_bf16 v[64:67], a[236:239], v[88:91], v[64:67]
  v_mfma_f32_16x16x32_bf16 v[68:71], a[236:239], v[92:95], v[68:71]
  s_nop 7
  v_add_f32 v48, v48, v16
  v_add_f32 v49, v49, v17
  v_add_f32 v50, v50, v18
  v_add_f32 v51, v51, v19
  s_add_u32 s28, s27, 0
  buffer_store_dwordx4 v[48:51], v9, s[8:11], s28 offen
  v_add_f32 v52, v52, v20
  v_add_f32 v53, v53, v21
  v_add_f32 v54, v54, v22
  v_add_f32 v55, v55, v23
  s_add_u32 s28, s27, 256
  buffer_store_dwordx4 v[52:55], v9, s[8:11], s28 offen
  v_add_f32 v56, v56, v24
  v_add_f32 v57, v57, v25
  v_add_f32 v58, v58, v26
  v_add_f32 v59, v59, v27
  s_add_u32 s28, s27, 2048
  buffer_store_dwordx4 v[56:59], v9, s[8:11], s28 offen
  v_add_f32 v60, v60, v28
  v_add_f32 v61, v61, v29
  v_add_f32 v62, v62, v30
  v_add_f32 v63, v63, v31
  s_add_u32 s28, s27, 2304
  buffer_store_dwordx4 v[60:63], v9, s[8:11], s28 offen
  s_cmp_lt_u32 s21, 2
  s_cbranch_scc0 g3_42
  v_add_f32 v64, v64, v32
  v_add_f32 v65, v65, v33
  v_add_f32 v66, v66, v34
  v_add_f32 v67, v67, v35
  s_add_u32 s28, s27, 4096
  buffer_store_dwordx4 v[64:67], v9, s[8:11], s28 offen
  v_add_f32 v68, v68, v36
  v_add_f32 v69, v69, v37
  v_add_f32 v70, v70, v38
  v_add_f32 v71, v71, v39
  s_add_u32 s28, s27, 4352
  buffer_store_dwordx4 v[68:71], v9, s[8:11], s28 offen
g3_42:
  s_endpgm
kb1_abort:
  s_load_dwordx2 s[6:7], s[0:1], 88
  v_mov_b32 v2, 80
  v_mov_b32 v3, 1
  s_waitcnt lgkmcnt(0)
  s_mov_b64 exec, 1
  global_atomic_add v2, v3, s[6:7]
  s_waitcnt vmcnt(0)
kb1_exit:
  s_endpgm

.section .rodata,"a"
.p2align 6
.amdhsa_kernel kb1_kernel
  .amdhsa_next_free_vgpr 512
  .amdhsa_next_free_sgpr 102
  .amdhsa_accum_offset 256
  .amdhsa_group_segment_fixed_size 0
  .amdhsa_kernarg_size 104
  .amdhsa_user_sgpr_count 2
  .amdhsa_user_sgpr_kernarg_segment_ptr 1
  .amdhsa_system_sgpr_workgroup_id_x 1
.end_amdhsa_kernel
.text
.globl ka2_kernel
.p2align 8
.type ka2_kernel,@function
ka2_kernel:
  s_mov_b32 s99, 1
ka_body:
  s_cmp_ge_u32 s2, 256
  s_cbranch_scc1 ka_exit

  s_load_dwordx2 s[4:5], s[0:1], 96
  s_load_dwordx2 s[6:7], s[0:1], 88
  s_load_dwordx4 s[36:39], s[0:1], 16
  s_load_dwordx4 s[40:43], s[0:1], 32
  s_getreg_b32 s26, hwreg(HW_REG_XCC_ID)
  s_and_b32 s26, s26, 15
  v_lshrrev_b32 v1, 6, v0
  s_nop 0
  v_readfirstlane_b32 s21, v1
  s_waitcnt lgkmcnt(0)
  s_mov_b32 s8, s4
  s_and_b32 s9, s5, 0xffff
  s_mov_b32 s10, 0x10000000
  s_mov_b32 s11, 0x20000
  s_cmp_eq_u32 s21, 0
  s_cbranch_scc0 ka_cen_done
  s_mov_b64 s[24:25], exec
  s_mov_b64 exec, 1
  v_mov_b32 v3, 1
  s_lshl_b32 s27, s26, 2
  v_mov_b32 v4, s27
  global_atomic_add v5, v4, v3, s[6:7] sc0
  v_mov_b32 v4, 64
  s_waitcnt vmcnt(0)
  global_atomic_add v6, v4, v3, s[6:7] sc0
  s_mov_b32 s45, 0
  s_waitcnt vmcnt(0)
ka_cen_spin:
  global_load_dword v7, v4, s[6:7] sc1
  s_add_u32 s45, s45, 1
  s_waitcnt vmcnt(0)
  v_readfirstlane_b32 s27, v7
  s_cmp_ge_u32 s27, 256
  s_cbranch_scc1 ka_cen_ok
  s_cmp_lt_u32 s45, 400000
  s_cbranch_scc1 ka_cen_spin
ka_cen_ok:
  s_mov_b64 exec, 0xff
  v_lshlrev_b32 v4, 2, v0
  global_load_dword v7, v4, s[6:7] sc1
  s_waitcnt vmcnt(0)
  v_cmp_ne_u32 vcc, 32, v7
  s_nop 1
  s_cmp_eq_u64 vcc, 0
  s_cselect_b32 s27, 1, 0
  s_cmp_ge_u32 s27, 1
  s_cselect_b32 s27, 1, 0
  s_mov_b64 exec, 1
  v_mov_b32 v8, s27
  v_mov_b32 v4, 0
  v_mov_b32 v9, 0
  ds_write_b128 v4, v[6:9]
  ds_write_b32 v4, v5 offset:16
  s_waitcnt lgkmcnt(0)
  s_mov_b64 exec, s[24:25]
ka_cen_done:
  s_barrier
  v_mov_b32 v4, 0
  ds_read_b128 v[6:9], v4
  ds_read_b32 v5, v4 offset:16
  s_waitcnt lgkmcnt(0)
  v_readfirstlane_b32 s27, v6
  v_readfirstlane_b32 s44, v8
  v_readfirstlane_b32 s28, v5
  s_barrier
  s_cmp_eq_u32 s44, 1
  s_cbranch_scc1 ka_cen_fast
  s_lshr_b32 s20, s27, 5
  s_and_b32 s22, s27, 31
  s_branch ka_cen_end
ka_cen_fast:
  s_mov_b32 s20, s26
  s_mov_b32 s22, s28
ka_cen_end:
  s_and_b32 s20, s20, 7
  s_and_b32 s22, s22, 31
  s_cmp_lt_u32 s20, 4
  s_cbranch_scc0 ka_bulk
  s_cmp_lt_u32 s22, 8
  s_cbranch_scc0 ka_noty
  s_lshl_b32 s23, s20, 3
  s_add_u32 s23, s23, s22
  s_cmp_eq_u32 s44, 1
  s_cbranch_scc1 kaf_x
  s_branch kas_x
ka_noty:
  s_cmp_lt_u32 s22, 28
  s_cbranch_scc0 ka_spare
  s_sub_u32 s23, s22, 8
  s_cmp_eq_u32 s44, 1
  s_cbranch_scc1 kaf_y
  s_branch kas_y
ka_bulk:
  s_sub_u32 s28, s20, 4
  s_lshl_b32 s23, s22, 2
  s_add_u32 s23, s23, s28
  s_cmp_lt_u32 s23, 72
  s_cbranch_scc1 ka_qkv
  s_sub_u32 s23, s23, 72
  s_cmp_lt_u32 s23, 32
  s_cbranch_scc1 ka_u
  s_sub_u32 s23, s23, 32
  s_cmp_eq_u32 s99, 1
  s_cbranch_scc1 ka_ln
  s_branch ka_exit
ka_ln:
  v_and_b32 v1, 63, v0
  s_lshl_b32 s46, s23, 2
  s_add_u32 s46, s46, s21
  v_and_b32 v5, 7, v1
  v_bfe_u32 v6, v1, 3, 1
  v_lshrrev_b32 v7, 4, v1
  v_lshlrev_b32 v8, 5, v6
  v_add_u32 v8, v8, v5
  v_lshlrev_b32 v8, 4, v8
  v_lshlrev_b32 v9, 11, v7
  v_add_u32 v9, v9, v8
  v_lshlrev_b32 v10, 10, v7
  v_add_u32 v10, v10, v8
ka_lnl:
  s_lshr_b32 s26, s46, 2
  s_and_b32 s27, s46, 3
  s_lshl_b32 s27, s27, 7
  s_mul_i32 s28, s26, 81920
  s_add_u32 s28, s28, s27
  s_add_u32 s28, s28, 0x1400000
  s_add_u32 s29, s28, 0
  buffer_load_dwordx4 v[16:19], v9, s[8:11], s29 offen
  s_add_u32 s29, s28, 1024
  buffer_load_dwordx4 v[20:23], v9, s[8:11], s29 offen
  s_add_u32 s29, s28, 8192
  buffer_load_dwordx4 v[24:27], v9, s[8:11], s29 offen
  s_add_u32 s29, s28, 9216
  buffer_load_dwordx4 v[28:31], v9, s[8:11], s29 offen
  s_add_u32 s29, s28, 16384
  buffer_load_dwordx4 v[32:35], v9, s[8:11], s29 offen
  s_add_u32 s29, s28, 17408
  buffer_load_dwordx4 v[36:39], v9, s[8:11], s29 offen
  s_add_u32 s29, s28, 24576
  buffer_load_dwordx4 v[40:43], v9, s[8:11], s29 offen
  s_add_u32 s29, s28, 25600
  buffer_load_dwordx4 v[44:47], v9, s[8:11], s29 offen
  s_add_u32 s29, s28, 32768
  buffer_load_dwordx4 v[48:51], v9, s[8:11], s29 offen
  s_add_u32 s29, s28, 33792
  buffer_load_dwordx4 v[52:55], v9, s[8:11], s29 offen
  s_add_u32 s29, s28, 40960
  buffer_load_dwordx4 v[56:59], v9, s[8:11], s29 offen
  s_add_u32 s29, s28, 41984
  buffer_load_dwordx4 v[60:63], v9, s[8:11], s29 offen
  s_add_u32 s29, s28, 49152
  buffer_load_dwordx4 v[64:67], v9, s[8:11], s29 offen
  s_add_u32 s29, s28, 50176
  buffer_load_dwordx4 v[68:71], v9, s[8:11], s29 offen
  s_add_u32 s29, s28, 57344
  buffer_load_dwordx4 v[72:75], v9, s[8:11], s29 offen
  s_add_u32 s29, s28, 58368
  buffer_load_dwordx4 v[76:79], v9, s[8:11], s29 offen
  s_add_u32 s29, s28, 65536
  buffer_load_dwordx4 v[80:83], v9, s[8:11], s29 offen
  s_add_u32 s29, s28, 66560
  buffer_load_dwordx4 v[84:87], v9, s[8:11], s29 offen
  s_add_u32 s29, s28, 73728
  buffer_load_dwordx4 v[88:91], v9, s[8:11], s29 offen
  s_add_u32 s29, s28, 74752
  buffer_load_dwordx4 v[92:95], v9, s[8:11], s29 offen
  s_waitcnt vmcnt(0)
  v_add_f32 v12, v16, v17
  v_add_f32 v12, v12, v18
  v_add_f32 v12, v12, v19
  v_add_f32 v12, v12, v20
  v_add_f32 v12, v12, v21
  v_add_f32 v12, v12, v22
  v_add_f32 v12, v12, v23
  v_add_f32 v12, v12, v24
  v_add_f32 v12, v12, v25
  v_add_f32 v12, v12, v26
  v_add_f32 v12, v12, v27
  v_add_f32 v12, v12, v28
  v_add_f32 v12, v12, v29
  v_add_f32 v12, v12, v30
  v_add_f32 v12, v12, v31
  v_add_f32 v12, v12, v32
  v_add_f32 v12, v12, v33
  v_add_f32 v12, v12, v34
  v_add_f32 v12, v12, v35
  v_add_f32 v12, v12, v36
  v_add_f32 v12, v12, v37
  v_add_f32 v12, v12, v38
  v_add_f32 v12, v12, v39
  v_add_f32 v12, v12, v40
  v_add_f32 v12, v12, v41
  v_add_f32 v12, v12, v42
  v_add_f32 v12, v12, v43
  v_add_f32 v12, v12, v44
  v_add_f32 v12, v12, v45
  v_add_f32 v12, v12, v46
  v_add_f32 v12, v12, v47
  v_add_f32 v12, v12, v48
  v_add_f32 v12, v12, v49
  v_add_f32 v12, v12, v50
  v_add_f32 v12, v12, v51
  v_add_f32 v12, v12, v52
  v_add_f32 v12, v12, v53
  v_add_f32 v12, v12, v54
  v_add_f32 v12, v12, v55
  v_add_f32 v12, v12, v56
  v_add_f32 v12, v12, v57
  v_add_f32 v12, v12, v58
  v_add_f32 v12, v12, v59
  v_add_f32 v12, v12, v60
  v_add_f32 v12, v12, v61
  v_add_f32 v12, v12, v62
  v_add_f32 v12, v12, v63
  v_add_f32 v12, v12, v64
  v_add_f32 v12, v12, v65
  v_add_f32 v12, v12, v66
  v_add_f32 v12, v12, v67
  v_add_f32 v12, v12, v68
  v_add_f32 v12, v12, v69
  v_add_f32 v12, v12, v70
  v_add_f32 v12, v12, v71
  v_add_f32 v12, v12, v72
  v_add_f32 v12, v12, v73
  v_add_f32 v12, v12, v74
  v_add_f32 v12, v12, v75
  v_add_f32 v12, v12, v76
  v_add_f32 v12, v12, v77
  v_add_f32 v12, v12, v78
  v_add_f32 v12, v12, v79
  v_add_f32 v12, v12, v80
  v_add_f32 v12, v12, v81
  v_add_f32 v12, v12, v82
  v_add_f32 v12, v12, v83
  v_add_f32 v12, v12, v84
  v_add_f32 v12, v12, v85
  v_add_f32 v12, v12, v86
  v_add_f32 v12, v12, v87
  v_add_f32 v12, v12, v88
  v_add_f32 v12, v12, v89
  v_add_f32 v12, v12, v90
  v_add_f32 v12, v12, v91
  v_add_f32 v12, v12, v92
  v_add_f32 v12, v12, v93
  v_add_f32 v12, v12, v94
  v_add_f32 v12, v12, v95
  s_nop 1
  v_add_f32_dpp v12, v12, v12 row_ror:8 row_mask:0xf bank_mask:0xf
  v_mov_b32 v13, v12
  s_nop 1
  v_permlane16_swap_b32 v12, v13
  v_add_f32 v12, v12, v13
  v_mov_b32 v13, v12
  s_nop 1
  v_permlane32_swap_b32 v12, v13
  v_add_f32 v12, v12, v13
  v_mul_f32 v12, 0x3acccccd, v12
  v_sub_f32 v16, v16, v12
  v_sub_f32 v17, v17, v12
  v_sub_f32 v18, v18, v12
  v_sub_f32 v19, v19, v12
  v_sub_f32 v20, v20, v12
  v_sub_f32 v21, v21, v12
  v_sub_f32 v22, v22, v12
  v_sub_f32 v23, v23, v12
  v_sub_f32 v24, v24, v12
  v_sub_f32 v25, v25, v12
  v_sub_f32 v26, v26, v12
  v_sub_f32 v27, v27, v12
  v_sub_f32 v28, v28, v12
  v_sub_f32 v29, v29, v12
  v_sub_f32 v30, v30, v12
  v_sub_f32 v31, v31, v12
  v_sub_f32 v32, v32, v12
  v_sub_f32 v33, v33, v12
  v_sub_f32 v34, v34, v12
  v_sub_f32 v35, v35, v12
  v_sub_f32 v36, v36, v12
  v_sub_f32 v37, v37, v12
  v_sub_f32 v38, v38, v12
  v_sub_f32 v39, v39, v12
  v_sub_f32 v40, v40, v12
  v_sub_f32 v41, v41, v12
  v_sub_f32 v42, v42, v12
  v_sub_f32 v43, v43, v12
  v_sub_f32 v44, v44, v12
  v_sub_f32 v45, v45, v12
  v_sub_f32 v46, v46, v12
  v_sub_f32 v47, v47, v12
  v_sub_f32 v48, v48, v12
  v_sub_f32 v49, v49, v12
  v_sub_f32 v50, v50, v12
  v_sub_f32 v51, v51, v12
  v_sub_f32 v52, v52, v12
  v_sub_f32 v53, v53, v12
  v_sub_f32 v54, v54, v12
  v_sub_f32 v55, v55, v12
  v_sub_f32 v56, v56, v12
  v_sub_f32 v57, v57, v12
  v_sub_f32 v58, v58, v12
  v_sub_f32 v59, v59, v12
  v_sub_f32 v60, v60, v12
  v_sub_f32 v61, v61, v12
  v_sub_f32 v62, v62, v12
  v_sub_f32 v63, v63, v12
  v_sub_f32 v64, v64, v12
  v_sub_f32 v65, v65, v12
  v_sub_f32 v66, v66, v12
  v_sub_f32 v67, v67, v12
  v_sub_f32 v68, v68, v12
  v_sub_f32 v69, v69, v12
  v_sub_f32 v70, v70, v12
  v_sub_f32 v71, v71, v12
  v_sub_f32 v72, v72, v12
  v_sub_f32 v73, v73, v12
  v_sub_f32 v74, v74, v12
  v_sub_f32 v75, v75, v12
  v_sub_f32 v76, v76, v12
  v_sub_f32 v77, v77, v12
  v_sub_f32 v78, v78, v12
  v_sub_f32 v79, v79, v12
  v_sub_f32 v80, v80, v12
  v_sub_f32 v81, v81, v12
  v_sub_f32 v82, v82, v12
  v_sub_f32 v83, v83, v12
  v_sub_f32 v84, v84, v12
  v_sub_f32 v85, v85, v12
  v_sub_f32 v86, v86, v12
  v_sub_f32 v87, v87, v12
  v_sub_f32 v88, v88, v12
  v_sub_f32 v89, v89, v12
  v_sub_f32 v90, v90, v12
  v_sub_f32 v91, v91, v12
  v_sub_f32 v92, v92, v12
  v_sub_f32 v93, v93, v12
  v_sub_f32 v94, v94, v12
  v_sub_f32 v95, v95, v12
  v_mul_f32 v12, v16, v16
  v_fmac_f32 v12, v17, v17
  v_fmac_f32 v12, v18, v18
  v_fmac_f32 v12, v19, v19
  v_fmac_f32 v12, v20, v20
  v_fmac_f32 v12, v21, v21
  v_fmac_f32 v12, v22, v22
  v_fmac_f32 v12, v23, v23
  v_fmac_f32 v12, v24, v24
  v_fmac_f32 v12, v25, v25
  v_fmac_f32 v12, v26, v26
  v_fmac_f32 v12, v27, v27
  v_fmac_f32 v12, v28, v28
  v_fmac_f32 v12, v29, v29
  v_fmac_f32 v12, v30, v30
  v_fmac_f32 v12, v31, v31
  v_fmac_f32 v12, v32, v32
  v_fmac_f32 v12, v33, v33
  v_fmac_f32 v12, v34, v34
  v_fmac_f32 v12, v35, v35
  v_fmac_f32 v12, v36, v36
  v_fmac_f32 v12, v37, v37
  v_fmac_f32 v12, v38, v38
  v_fmac_f32 v12, v39, v39
  v_fmac_f32 v12, v40, v40
  v_fmac_f32 v12, v41, v41
  v_fmac_f32 v12, v42, v42
  v_fmac_f32 v12, v43, v43
  v_fmac_f32 v12, v44, v44
  v_fmac_f32 v12, v45, v45
  v_fmac_f32 v12, v46, v46
  v_fmac_f32 v12, v47, v47
  v_fmac_f32 v12, v48, v48
  v_fmac_f32 v12, v49, v49
  v_fmac_f32 v12, v50, v50
  v_fmac_f32 v12, v51, v51
  v_fmac_f32 v12, v52, v52
  v_fmac_f32 v12, v53, v53
  v_fmac_f32 v12, v54, v54
  v_fmac_f32 v12, v55, v55
  v_fmac_f32 v12, v56, v56
  v_fmac_f32 v12, v57, v57
  v_fmac_f32 v12, v58, v58
  v_fmac_f32 v12, v59, v59
  v_fmac_f32 v12, v60, v60
  v_fmac_f32 v12, v61, v61
  v_fmac_f32 v12, v62, v62
  v_fmac_f32 v12, v63, v63
  v_fmac_f32 v12, v64, v64
  v_fmac_f32 v12, v65, v65
  v_fmac_f32 v12, v66, v66
  v_fmac_f32 v12, v67, v67
  v_fmac_f32 v12, v68, v68
  v_fmac_f32 v12, v69, v69
  v_fmac_f32 v12, v70, v70
  v_fmac_f32 v12, v71, v71
  v_fmac_f32 v12, v72, v72
  v_fmac_f32 v12, v73, v73
  v_fmac_f32 v12, v74, v74
  v_fmac_f32 v12, v75, v75
  v_fmac_f32 v12, v76, v76
  v_fmac_f32 v12, v77, v77
  v_fmac_f32 v12, v78, v78
  v_fmac_f32 v12, v79, v79
  v_fmac_f32 v12, v80, v80
  v_fmac_f32 v12, v81, v81
  v_fmac_f32 v12, v82, v82
  v_fmac_f32 v12, v83, v83
  v_fmac_f32 v12, v84, v84
  v_fmac_f32 v12, v85, v85
  v_fmac_f32 v12, v86, v86
  v_fmac_f32 v12, v87, v87
  v_fmac_f32 v12, v88, v88
  v_fmac_f32 v12, v89, v89
  v_fmac_f32 v12, v90, v90
  v_fmac_f32 v12, v91, v91
  v_fmac_f32 v12, v92, v92
  v_fmac_f32 v12, v93, v93
  v_fmac_f32 v12, v94, v94
  v_fmac_f32 v12, v95, v95
  s_nop 1
  v_add_f32_dpp v12, v12, v12 row_ror:8 row_mask:0xf bank_mask:0xf
  v_mov_b32 v13, v12
  s_nop 1
  v_permlane16_swap_b32 v12, v13
  v_add_f32 v12, v12, v13
  v_mov_b32 v13, v12
  s_nop 1
  v_permlane32_swap_b32 v12, v13
  v_add_f32 v12, v12, v13
  v_mov_b32 v13, 0x3727c5ac
  v_fmac_f32 v13, 0x3acccccd, v12
  v_rsq_f32 v13, v13
  s_nop 0
  v_mul_f32 v16, v16, v13
  v_mul_f32 v17, v17, v13
  v_mul_f32 v18, v18, v13
  v_mul_f32 v19, v19, v13
  v_mul_f32 v20, v20, v13
  v_mul_f32 v21, v21, v13
  v_mul_f32 v22, v22, v13
  v_mul_f32 v23, v23, v13
  v_mul_f32 v24, v24, v13
  v_mul_f32 v25, v25, v13
  v_mul_f32 v26, v26, v13
  v_mul_f32 v27, v27, v13
  v_mul_f32 v28, v28, v13
  v_mul_f32 v29, v29, v13
  v_mul_f32 v30, v30, v13
  v_mul_f32 v31, v31, v13
  v_mul_f32 v32, v32, v13
  v_mul_f32 v33, v33, v13
  v_mul_f32 v34, v34, v13
  v_mul_f32 v35, v35, v13
  v_mul_f32 v36, v36, v13
  v_mul_f32 v37, v37, v13
  v_mul_f32 v38, v38, v13
  v_mul_f32 v39, v39, v13
  v_mul_f32 v40, v40, v13
  v_mul_f32 v41, v41, v13
  v_mul_f32 v42, v42, v13
  v_mul_f32 v43, v43, v13
  v_mul_f32 v44, v44, v13
  v_mul_f32 v45, v45, v13
  v_mul_f32 v46, v46, v13
  v_mul_f32 v47, v47, v13
  v_mul_f32 v48, v48, v13
  v_mul_f32 v49, v49, v13
  v_mul_f32 v50, v50, v13
  v_mul_f32 v51, v51, v13
  v_mul_f32 v52, v52, v13
  v_mul_f32 v53, v53, v13
  v_mul_f32 v54, v54, v13
  v_mul_f32 v55, v55, v13
  v_mul_f32 v56, v56, v13
  v_mul_f32 v57, v57, v13
  v_mul_f32 v58, v58, v13
  v_mul_f32 v59, v59, v13
  v_mul_f32 v60, v60, v13
  v_mul_f32 v61, v61, v13
  v_mul_f32 v62, v62, v13
  v_mul_f32 v63, v63, v13
  v_mul_f32 v64, v64, v13
  v_mul_f32 v65, v65, v13
  v_mul_f32 v66, v66, v13
  v_mul_f32 v67, v67, v13
  v_mul_f32 v68, v68, v13
  v_mul_f32 v69, v69, v13
  v_mul_f32 v70, v70, v13
  v_mul_f32 v71, v71, v13
  v_mul_f32 v72, v72, v13
  v_mul_f32 v73, v73, v13
  v_mul_f32 v74, v74, v13
  v_mul_f32 v75, v75, v13
  v_mul_f32 v76, v76, v13
  v_mul_f32 v77, v77, v13
  v_mul_f32 v78, v78, v13
  v_mul_f32 v79, v79, v13
  v_mul_f32 v80, v80, v13
  v_mul_f32 v81, v81, v13
  v_mul_f32 v82, v82, v13
  v_mul_f32 v83, v83, v13
  v_mul_f32 v84, v84, v13
  v_mul_f32 v85, v85, v13
  v_mul_f32 v86, v86, v13
  v_mul_f32 v87, v87, v13
  v_mul_f32 v88, v88, v13
  v_mul_f32 v89, v89, v13
  v_mul_f32 v90, v90, v13
  v_mul_f32 v91, v91, v13
  v_mul_f32 v92, v92, v13
  v_mul_f32 v93, v93, v13
  v_mul_f32 v94, v94, v13
  v_mul_f32 v95, v95, v13
  v_cvt_pk_bf16_f32 v16, v16, v17
  v_cvt_pk_bf16_f32 v17, v18, v19
  v_cvt_pk_bf16_f32 v18, v20, v21
  v_cvt_pk_bf16_f32 v19, v22, v23
  v_cvt_pk_bf16_f32 v20, v24, v25
  v_cvt_pk_bf16_f32 v21, v26, v27
  v_cvt_pk_bf16_f32 v22, v28, v29
  v_cvt_pk_bf16_f32 v23, v30, v31
  v_cvt_pk_bf16_f32 v24, v32, v33
  v_cvt_pk_bf16_f32 v25, v34, v35
  v_cvt_pk_bf16_f32 v26, v36, v37
  v_cvt_pk_bf16_f32 v27, v38, v39
  v_cvt_pk_bf16_f32 v28, v40, v41
  v_cvt_pk_bf16_f32 v29, v42, v43
  v_cvt_pk_bf16_f32 v30, v44, v45
  v_cvt_pk_bf16_f32 v31, v46, v47
  v_cvt_pk_bf16_f32 v32, v48, v49
  v_cvt_pk_bf16_f32 v33, v50, v51
  v_cvt_pk_bf16_f32 v34, v52, v53
  v_cvt_pk_bf16_f32 v35, v54, v55
  v_cvt_pk_bf16_f32 v36, v56, v57
  v_cvt_pk_bf16_f32 v37, v58, v59
  v_cvt_pk_bf16_f32 v38, v60, v61
  v_cvt_pk_bf16_f32 v39, v62, v63
  v_cvt_pk_bf16_f32 v40, v64, v65
  v_cvt_pk_bf16_f32 v41, v66, v67
  v_cvt_pk_bf16_f32 v42, v68, v69
  v_cvt_pk_bf16_f32 v43, v70, v71
  v_cvt_pk_bf16_f32 v44, v72, v73
  v_cvt_pk_bf16_f32 v45, v74, v75
  v_cvt_pk_bf16_f32 v46, v76, v77
  v_cvt_pk_bf16_f32 v47, v78, v79
  v_cvt_pk_bf16_f32 v48, v80, v81
  v_cvt_pk_bf16_f32 v49, v82, v83
  v_cvt_pk_bf16_f32 v50, v84, v85
  v_cvt_pk_bf16_f32 v51, v86, v87
  v_cvt_pk_bf16_f32 v52, v88, v89
  v_cvt_pk_bf16_f32 v53, v90, v91
  v_cvt_pk_bf16_f32 v54, v92, v93
  v_cvt_pk_bf16_f32 v55, v94, v95
  s_mul_i32 s28, s26, 40960
  s_add_u32 s28, s28, s27
  s_add_u32 s28, s28, 0x100000
  s_add_u32 s29, s28, 0
  buffer_store_dwordx4 v[16:19], v10, s[8:11], s29 offen sc1
  s_add_u32 s29, s28, 4096
  buffer_store_dwordx4 v[20:23], v10, s[8:11], s29 offen sc1
  s_add_u32 s29, s28, 8192
  buffer_store_dwordx4 v[24:27], v10, s[8:11], s29 offen sc1
  s_add_u32 s29, s28, 12288
  buffer_store_dwordx4 v[28:31], v10, s[8:11], s29 offen sc1
  s_add_u32 s29, s28, 16384
  buffer_store_dwordx4 v[32:35], v10, s[8:11], s29 offen sc1
  s_add_u32 s29, s28, 20480
  buffer_store_dwordx4 v[36:39], v10, s[8:11], s29 offen sc1
  s_add_u32 s29, s28, 24576
  buffer_store_dwordx4 v[40:43], v10, s[8:11], s29 offen sc1
  s_add_u32 s29, s28, 28672
  buffer_store_dwordx4 v[44:47], v10, s[8:11], s29 offen sc1
  s_add_u32 s29, s28, 32768
  buffer_store_dwordx4 v[48:51], v10, s[8:11], s29 offen sc1
  s_add_u32 s29, s28, 36864
  buffer_store_dwordx4 v[52:55], v10, s[8:11], s29 offen sc1
  s_waitcnt vmcnt(0)
  s_mov_b64 s[24:25], exec
  s_mov_b64 exec, 1
  v_mov_b32 v3, 4992
  v_mov_b32 v4, 1
  buffer_atomic_add v4, v3, s[8:11], 0 offen
  s_mov_b64 exec, s[24:25]
  s_add_u32 s46, s46, 96
  s_cmp_lt_u32 s46, 256
  s_cbranch_scc1 ka_lnl
  s_waitcnt vmcnt(0)
  s_branch ka_exit
ka_spare:
  s_cmp_eq_u32 s20, 0
  s_cbranch_scc0 ka_pf
  s_cmp_eq_u32 s22, 28
  s_cbranch_scc0 ka_pf
  s_cmp_eq_u32 s21, 0
  s_cbranch_scc0 ka_pf
  s_mov_b64 s[24:25], exec
  s_mov_b64 exec, 1
  v_mov_b32 v2, 0
  v_mov_b32 v3, 0
  s_mov_b32 s30, -1
  s_mov_b32 s31, -1
  s_mov_b32 s28, 0xb00000
  buffer_store_dword v3, v2, s[8:11], s28 offen sc1
  s_waitcnt vmcnt(0)
  s_memtime s[32:33]
  s_waitcnt lgkmcnt(0)
  buffer_load_dword v4, v2, s[8:11], s28 offen sc1
  s_waitcnt vmcnt(0)
  s_memtime s[34:35]
  s_waitcnt lgkmcnt(0)
  s_sub_u32 s34, s34, s32
  s_min_u32 s30, s30, s34
  s_mov_b32 s28, 0xb02000
  buffer_store_dword v3, v2, s[8:11], s28 offen sc1
  s_waitcnt vmcnt(0)
  s_memtime s[32:33]
  s_waitcnt lgkmcnt(0)
  buffer_load_dword v4, v2, s[8:11], s28 offen sc1
  s_waitcnt vmcnt(0)
  s_memtime s[34:35]
  s_waitcnt lgkmcnt(0)
  s_sub_u32 s34, s34, s32
  s_min_u32 s31, s31, s34
  s_mov_b32 s28, 0xb00100
  buffer_store_dword v3, v2, s[8:11], s28 offen sc1
  s_waitcnt vmcnt(0)
  s_memtime s[32:33]
  s_waitcnt lgkmcnt(0)
  buffer_load_dword v4, v2, s[8:11], s28 offen sc1
  s_waitcnt vmcnt(0)
  s_memtime s[34:35]
  s_waitcnt lgkmcnt(0)
  s_sub_u32 s34, s34, s32
  s_min_u32 s30, s30, s34
  s_mov_b32 s28, 0xb02100
  buffer_store_dword v3, v2, s[8:11], s28 offen sc1
  s_waitcnt vmcnt(0)
  s_memtime s[32:33]
  s_waitcnt lgkmcnt(0)
  buffer_load_dword v4, v2, s[8:11], s28 offen sc1
  s_waitcnt vmcnt(0)
  s_memtime s[34:35]
  s_waitcnt lgkmcnt(0)
  s_sub_u32 s34, s34, s32
  s_min_u32 s31, s31, s34
  s_mov_b32 s28, 0xb00200
  buffer_store_dword v3, v2, s[8:11], s28 offen sc1
  s_waitcnt vmcnt(0)
  s_memtime s[32:33]
  s_waitcnt lgkmcnt(0)
  buffer_load_dword v4, v2, s[8:11], s28 offen sc1
  s_waitcnt vmcnt(0)
  s_memtime s[34:35]
  s_waitcnt lgkmcnt(0)
  s_sub_u32 s34, s34, s32
  s_min_u32 s30, s30, s34
  s_mov_b32 s28, 0xb02200
  buffer_store_dword v3, v2, s[8:11], s28 offen sc1
  s_waitcnt vmcnt(0)
  s_memtime s[32:33]
  s_waitcnt lgkmcnt(0)
  buffer_load_dword v4, v2, s[8:11], s28 offen sc1
  s_waitcnt vmcnt(0)
  s_memtime s[34:35]
  s_waitcnt lgkmcnt(0)
  s_sub_u32 s34, s34, s32
  s_min_u32 s31, s31, s34
  s_mov_b32 s28, 0xb00300
  buffer_store_dword v3, v2, s[8:11], s28 offen sc1
  s_waitcnt vmcnt(0)
  s_memtime s[32:33]
  s_waitcnt lgkmcnt(0)
  buffer_load_dword v4, v2, s[8:11], s28 offen sc1
  s_waitcnt vmcnt(0)
  s_memtime s[34:35]
  s_waitcnt lgkmcnt(0)
  s_sub_u32 s34, s34, s32
  s_min_u32 s30, s30, s34
  s_mov_b32 s28, 0xb02300
  buffer_store_dword v3, v2, s[8:11], s28 offen sc1
  s_waitcnt vmcnt(0)
  s_memtime s[32:33]
  s_waitcnt lgkmcnt(0)
  buffer_load_dword v4, v2, s[8:11], s28 offen sc1
  s_waitcnt vmcnt(0)
  s_memtime s[34:35]
  s_waitcnt lgkmcnt(0)
  s_sub_u32 s34, s34, s32
  s_min_u32 s31, s31, s34
  s_cmp_lt_u32 s30, s31
  s_cselect_b32 s28, 1, 2
  v_mov_b32 v3, s28
  v_mov_b32 v2, 5056
  buffer_store_dword v3, v2, s[8:11], 0 offen sc1
  v_mov_b32 v3, s30
  buffer_store_dword v3, v2, s[8:11], 0 offen offset:4 sc1
  v_mov_b32 v3, s31
  buffer_store_dword v3, v2, s[8:11], 0 offen offset:8 sc1
  s_waitcnt vmcnt(0)
  s_mov_b64 exec, s[24:25]
ka_pf:
  v_and_b32 v1, 63, v0
  v_lshlrev_b32 v4, 6, v1
  s_sub_u32 s46, s22, 28
  s_lshl_b32 s46, s46, 2
  s_add_u32 s46, s46, s21
  s_mul_i32 s28, s20, 24
  v_and_b32 v5, 15, v1
  v_min_u32 v5, 11, v5
  v_cmp_le_u32 vcc, 6, v5
  v_subrev_u32 v6, 6, v5
  v_mov_b32 v7, 0x400
  v_cndmask_b32 v5, v5, v6, vcc
  v_cndmask_b32 v7, 0, v7, vcc
  v_lshlrev_b32 v5, 2, v5
  v_add_u32 v5, v5, v7
  s_add_u32 s28, s28, 0
  v_add_u32 v5, s28, v5
  v_and_b32 v6, 7, v1
  v_lshlrev_b32 v6, 2, v6
  s_lshl_b32 s28, s20, 5
  s_add_u32 s28, s28, 3072
  v_add_u32 v6, s28, v6
  s_mul_i32 s47, s20, 327680
  s_mul_i32 s28, s46, 20480
  s_add_u32 s47, s47, s28
  s_add_u32 s47, s47, 0x9000000
  s_mul_i32 s28, s46, 3
  s_add_u32 s28, s28, 0
  s_cmp_ge_u32 s28, 24
  s_cselect_b32 s29, 0x1800000, 0
  s_cselect_b32 s30, 24, 0
  s_sub_u32 s28, s28, s30
  s_mul_i32 s30, s28, 43
  s_lshr_b32 s30, s30, 7
  s_mul_i32 s31, s30, 3
  s_sub_u32 s31, s28, s31
  s_lshl_b32 s28, s20, 3
  s_add_u32 s30, s30, s28
  s_mul_i32 s30, s30, 786432
  s_lshl_b32 s31, s31, 12
  s_add_u32 s30, s30, s31
  s_add_u32 s30, s30, 0x4800000
  s_add_u32 s48, s30, s29
  s_mul_i32 s28, s46, 3
  s_add_u32 s28, s28, 1
  s_cmp_ge_u32 s28, 24
  s_cselect_b32 s29, 0x1800000, 0
  s_cselect_b32 s30, 24, 0
  s_sub_u32 s28, s28, s30
  s_mul_i32 s30, s28, 43
  s_lshr_b32 s30, s30, 7
  s_mul_i32 s31, s30, 3
  s_sub_u32 s31, s28, s31
  s_lshl_b32 s28, s20, 3
  s_add_u32 s30, s30, s28
  s_mul_i32 s30, s30, 786432
  s_lshl_b32 s31, s31, 12
  s_add_u32 s30, s30, s31
  s_add_u32 s30, s30, 0x4800000
  s_add_u32 s49, s30, s29
  s_mul_i32 s28, s46, 3
  s_add_u32 s28, s28, 2
  s_cmp_ge_u32 s28, 24
  s_cselect_b32 s29, 0x1800000, 0
  s_cselect_b32 s30, 24, 0
  s_sub_u32 s28, s28, s30
  s_mul_i32 s30, s28, 43
  s_lshr_b32 s30, s30, 7
  s_mul_i32 s31, s30, 3
  s_sub_u32 s31, s28, s31
  s_lshl_b32 s28, s20, 3
  s_add_u32 s30, s30, s28
  s_mul_i32 s30, s30, 786432
  s_lshl_b32 s31, s31, 12
  s_add_u32 s30, s30, s31
  s_add_u32 s30, s30, 0x4800000
  s_add_u32 s50, s30, s29
  s_mul_i32 s28, s20, 327680
  s_add_u32 s28, s28, 0x700000
  s_lshl_b32 s29, s46, 12
  s_add_u32 s51, s28, s29
  s_mov_b32 s52, 5120
  s_cmp_ge_u32 s46, 2
  s_cbranch_scc0 ka_pf1
  s_mul_i32 s28, s20, 655360
  s_add_u32 s28, s28, 0x402800
  s_sub_u32 s29, s46, 2
  s_lshl_b32 s29, s29, 12
  s_add_u32 s51, s28, s29
  s_mov_b32 s52, 10240
  s_cmp_ge_u32 s46, 5
  s_cbranch_scc0 ka_pf1
  s_mul_i32 s28, s20, 1310720
  s_add_u32 s28, s28, 0xe00000
  s_sub_u32 s29, s46, 5
  s_lshl_b32 s29, s29, 12
  s_add_u32 s51, s28, s29
  s_mov_b32 s52, 20480
ka_pf1:
  s_mul_i32 s53, s20, 655360
  s_add_u32 s53, s53, 0x400000
  s_mov_b32 s54, 0
  s_mov_b32 s55, 0
  s_mov_b32 s56, 0
  v_mov_b32 v7, 0
ka_pfl:
  s_cmp_gt_u32 s54, 3
  s_cbranch_scc0 ka_pfgo
  s_sub_u32 s28, s54, 3
  s_mul_i32 s28, s28, 10240
  s_add_u32 s28, s28, s53
  s_mov_b32 s45, 0
ka_pfw:
  buffer_load_dword v8, v7, s[8:11], s28 offen sc1
  s_add_u32 s45, s45, 1
  s_waitcnt vmcnt(0)
  v_readfirstlane_b32 s29, v8
  s_cmp_lg_u32 s29, -1
  s_cbranch_scc1 ka_pfgo
  s_sleep 4
  s_cmp_lt_u32 s45, 400000
  s_cbranch_scc1 ka_pfw
  s_branch ka_exit
ka_pfgo:
  s_cmp_lt_u32 s46, 10
  s_cbranch_scc0 ka_pf2
  buffer_load_dword v9, v4, s[8:11], s51 offen sc1
ka_pf2:
  s_cmp_gt_u32 s55, s54
  s_cbranch_scc1 ka_wp_43_ok
  s_mov_b32 s45, 0
ka_wp_43_spin:
  buffer_load_dword v2, v5, s[8:11], 0 offen sc1
  s_add_u32 s45, s45, 1
  s_waitcnt vmcnt(0)
  v_min_u32_dpp v3, v2, v2 quad_perm:[1,0,3,2] row_mask:0xf bank_mask:0xf
  s_nop 1
  v_min_u32_dpp v2, v3, v3 quad_perm:[2,3,0,1] row_mask:0xf bank_mask:0xf
  s_nop 1
  v_min_u32_dpp v3, v2, v2 row_half_mirror row_mask:0xf bank_mask:0xf
  s_nop 1
  v_min_u32_dpp v2, v3, v3 row_mirror row_mask:0xf bank_mask:0xf
  s_nop 0
  v_readfirstlane_b32 s55, v2
  s_cmp_gt_u32 s55, s54
  s_cbranch_scc1 ka_wp_43_ok
  s_cmp_lt_u32 s45, 400000
  s_cbranch_scc1 ka_wp_43_spin
  s_branch ka_abort
ka_wp_43_ok:
  buffer_load_dword v10, v4, s[8:11], s48 offen sc1
  buffer_load_dword v11, v4, s[8:11], s49 offen sc1
  buffer_load_dword v12, v4, s[8:11], s50 offen sc1
  s_cmp_gt_u32 s56, s54
  s_cbranch_scc1 ka_wp_44_ok
  s_mov_b32 s45, 0
ka_wp_44_spin:
  buffer_load_dword v2, v6, s[8:11], 0 offen sc1
  s_add_u32 s45, s45, 1
  s_waitcnt vmcnt(0)
  v_min_u32_dpp v3, v2, v2 quad_perm:[1,0,3,2] row_mask:0xf bank_mask:0xf
  s_nop 1
  v_min_u32_dpp v2, v3, v3 quad_perm:[2,3,0,1] row_mask:0xf bank_mask:0xf
  s_nop 1
  v_min_u32_dpp v3, v2, v2 row_half_mirror row_mask:0xf bank_mask:0xf
  s_nop 1
  v_min_u32_dpp v2, v3, v3 quad_perm:[0,1,2,3] row_mask:0xf bank_mask:0xf
  s_nop 0
  v_readfirstlane_b32 s56, v2
  s_cmp_gt_u32 s56, s54
  s_cbranch_scc1 ka_wp_44_ok
  s_cmp_lt_u32 s45, 400000
  s_cbranch_scc1 ka_wp_44_spin
  s_branch ka_abort
ka_wp_44_ok:
  s_add_u32 s28, s47, 0
  buffer_load_dword v13, v4, s[8:11], s28 offen sc1
  s_add_u32 s28, s47, 4096
  buffer_load_dword v14, v4, s[8:11], s28 offen sc1
  s_add_u32 s28, s47, 8192
  buffer_load_dword v15, v4, s[8:11], s28 offen sc1
  s_add_u32 s28, s47, 12288
  buffer_load_dword v16, v4, s[8:11], s28 offen sc1
  s_add_u32 s28, s47, 16384
  buffer_load_dword v17, v4, s[8:11], s28 offen sc1
  s_add_u32 s47, s47, 1310720
  s_add_u32 s48, s48, 12288
  s_add_u32 s49, s49, 12288
  s_add_u32 s50, s50, 12288
  s_add_u32 s51, s51, s52
  s_add_u32 s54, s54, 1
  s_waitcnt vmcnt(0)
  s_cmp_lt_u32 s54, 64
  s_cbranch_scc1 ka_pfl
  s_branch ka_exit
ka_qkv:
  s_mul_i32 s26, s23, 43
  s_lshr_b32 s26, s26, 10
  s_mul_i32 s27, s26, 24
  s_sub_u32 s27, s23, s27
  s_cmp_eq_u32 s26, 0
  s_cselect_b32 s28, s36, s38
  s_cselect_b32 s29, s37, s39
  s_cmp_eq_u32 s26, 2
  s_cselect_b32 s28, s40, s28
  s_cselect_b32 s29, s41, s29
  s_mov_b32 s12, s28
  s_and_b32 s13, s29, 0xffff
  s_mov_b32 s14, 0x780000
  s_mov_b32 s15, 0x20000
  s_mul_i32 s46, s26, 0x1800000
  s_add_u32 s46, s46, 0x4800000
  s_lshl_b32 s47, s26, 10
  s_lshl_b32 s28, s27, 2
  s_add_u32 s47, s47, s28
  s_add_u32 s47, s47, 0
  s_lshl_b32 s28, s27, 3
  s_lshl_b32 s29, s21, 1
  s_add_u32 s28, s28, s29
  s_add_u32 s29, s28, 0
  s_mul_i32 s30, s29, 171
  s_lshr_b32 s30, s30, 10
  s_mul_i32 s31, s30, 6
  s_sub_u32 s31, s29, s31
  s_mul_i32 s30, s30, 786432
  s_lshl_b32 s31, s31, 11
  s_add_u32 s30, s30, s31
  s_add_u32 s48, s30, s46
  s_add_u32 s29, s28, 1
  s_mul_i32 s30, s29, 171
  s_lshr_b32 s30, s30, 10
  s_mul_i32 s31, s30, 6
  s_sub_u32 s31, s29, s31
  s_mul_i32 s30, s30, 786432
  s_lshl_b32 s31, s31, 11
  s_add_u32 s30, s30, s31
  s_add_u32 s49, s30, s46
  v_and_b32 v1, 63, v0
  v_lshrrev_b32 v2, 4, v1
  v_bfe_u32 v3, v1, 2, 2
  v_and_b32 v4, 3, v1
  s_lshr_b32 s28, s21, 1
  s_lshl_b32 s28, s28, 2
  v_add_u32 v5, s28, v3
  v_mul_u32_u24 v5, 12288, v5
  s_and_b32 s28, s21, 1
  s_lshl_b32 s28, s28, 8
  s_lshl_b32 s29, s27, 9
  s_add_u32 s28, s28, s29
  v_add_u32 v5, s28, v5
  v_lshlrev_b32 v6, 6, v2
  v_add_u32 v5, v5, v6
  v_lshlrev_b32 v6, 4, v4
  v_add_u32 v5, v5, v6
  v_lshrrev_b32 v6, 1, v2
  v_lshlrev_b32 v7, 12, v6
  v_lshlrev_b32 v6, 6, v3
  v_add_u32 v7, v7, v6
  v_and_b32 v6, 1, v2
  v_lshlrev_b32 v6, 5, v6
  v_add_u32 v7, v7, v6
  v_lshrrev_b32 v6, 1, v4
  v_lshlrev_b32 v6, 4, v6
  v_add_u32 v7, v7, v6
  v_and_b32 v6, 1, v4
  v_lshlrev_b32 v6, 3, v6
  v_add_u32 v7, v7, v6
  s_lshl_b32 s28, s21, 9
  v_add_u32 v7, s28, v7
  s_lshl_b32 s29, s21, 10
  s_add_u32 m0, s29, 0
  s_mov_b32 s28, 0
  buffer_load_dwordx4 v5, s[12:15], s28 offen lds
  s_lshl_b32 s29, s21, 10
  s_add_u32 m0, s29, 4096
  s_mov_b32 s28, 98304
  buffer_load_dwordx4 v5, s[12:15], s28 offen lds
  s_lshl_b32 s29, s21, 10
  s_add_u32 m0, s29, 8192
  s_mov_b32 s28, 196608
  buffer_load_dwordx4 v5, s[12:15], s28 offen lds
  s_lshl_b32 s29, s21, 10
  s_add_u32 m0, s29, 12288
  s_mov_b32 s28, 294912
  buffer_load_dwordx4 v5, s[12:15], s28 offen lds
  s_lshl_b32 s29, s21, 10
  s_add_u32 m0, s29, 16384
  s_mov_b32 s28, 393216
  buffer_load_dwordx4 v5, s[12:15], s28 offen lds
  s_lshl_b32 s29, s21, 10
  s_add_u32 m0, s29, 20480
  s_mov_b32 s28, 491520
  buffer_load_dwordx4 v5, s[12:15], s28 offen lds
  s_lshl_b32 s29, s21, 10
  s_add_u32 m0, s29, 24576
  s_mov_b32 s28, 589824
  buffer_load_dwordx4 v5, s[12:15], s28 offen lds
  s_lshl_b32 s29, s21, 10
  s_add_u32 m0, s29, 28672
  s_mov_b32 s28, 688128
  buffer_load_dwordx4 v5, s[12:15], s28 offen lds
  s_lshl_b32 s29, s21, 10
  s_add_u32 m0, s29, 32768
  s_mov_b32 s28, 786432
  buffer_load_dwordx4 v5, s[12:15], s28 offen lds
  s_lshl_b32 s29, s21, 10
  s_add_u32 m0, s29, 36864
  s_mov_b32 s28, 884736
  buffer_load_dwordx4 v5, s[12:15], s28 offen lds
  s_lshl_b32 s29, s21, 10
  s_add_u32 m0, s29, 40960
  s_mov_b32 s28, 983040
  buffer_load_dwordx4 v5, s[12:15], s28 offen lds
  s_lshl_b32 s29, s21, 10
  s_add_u32 m0, s29, 45056
  s_mov_b32 s28, 1081344
  buffer_load_dwordx4 v5, s[12:15], s28 offen lds
  s_lshl_b32 s29, s21, 10
  s_add_u32 m0, s29, 49152
  s_mov_b32 s28, 1179648
  buffer_load_dwordx4 v5, s[12:15], s28 offen lds
  s_lshl_b32 s29, s21, 10
  s_add_u32 m0, s29, 53248
  s_mov_b32 s28, 1277952
  buffer_load_dwordx4 v5, s[12:15], s28 offen lds
  s_lshl_b32 s29, s21, 10
  s_add_u32 m0, s29, 57344
  s_mov_b32 s28, 1376256
  buffer_load_dwordx4 v5, s[12:15], s28 offen lds
  s_lshl_b32 s29, s21, 10
  s_add_u32 m0, s29, 61440
  s_mov_b32 s28, 1474560
  buffer_load_dwordx4 v5, s[12:15], s28 offen lds
  s_lshl_b32 s29, s21, 10
  s_add_u32 m0, s29, 65536
  s_mov_b32 s28, 1572864
  buffer_load_dwordx4 v5, s[12:15], s28 offen lds
  s_lshl_b32 s29, s21, 10
  s_add_u32 m0, s29, 69632
  s_mov_b32 s28, 1671168
  buffer_load_dwordx4 v5, s[12:15], s28 offen lds
  s_lshl_b32 s29, s21, 10
  s_add_u32 m0, s29, 73728
  s_mov_b32 s28, 1769472
  buffer_load_dwordx4 v5, s[12:15], s28 offen lds
  s_lshl_b32 s29, s21, 10
  s_add_u32 m0, s29, 77824
  s_mov_b32 s28, 1867776
  buffer_load_dwordx4 v5, s[12:15], s28 offen lds
  s_lshl_b32 s29, s21, 10
  s_add_u32 m0, s29, 81920
  s_mov_b32 s28, 1966080
  buffer_load_dwordx4 v5, s[12:15], s28 offen lds
  s_lshl_b32 s29, s21, 10
  s_add_u32 m0, s29, 86016
  s_mov_b32 s28, 2064384
  buffer_load_dwordx4 v5, s[12:15], s28 offen lds
  s_lshl_b32 s29, s21, 10
  s_add_u32 m0, s29, 90112
  s_mov_b32 s28, 2162688
  buffer_load_dwordx4 v5, s[12:15], s28 offen lds
  s_lshl_b32 s29, s21, 10
  s_add_u32 m0, s29, 94208
  s_mov_b32 s28, 2260992
  buffer_load_dwordx4 v5, s[12:15], s28 offen lds
  s_waitcnt vmcnt(20)
  s_barrier
  s_lshl_b32 s29, s21, 10
  s_add_u32 m0, s29, 98304
  s_mov_b32 s28, 2359296
  buffer_load_dwordx4 v5, s[12:15], s28 offen lds
  s_lshl_b32 s29, s21, 10
  s_add_u32 m0, s29, 102400
  s_mov_b32 s28, 2457600
  buffer_load_dwordx4 v5, s[12:15], s28 offen lds
  s_lshl_b32 s29, s21, 10
  s_add_u32 m0, s29, 106496
  s_mov_b32 s28, 2555904
  buffer_load_dwordx4 v5, s[12:15], s28 offen lds
  s_lshl_b32 s29, s21, 10
  s_add_u32 m0, s29, 110592
  s_mov_b32 s28, 2654208
  buffer_load_dwordx4 v5, s[12:15], s28 offen lds
  v_add_u32 v8, 0, v7
  ds_read_b64_tr_b16 a[0:1], v8 offset:0
  ds_read_b64_tr_b16 a[2:3], v8 offset:2048
  ds_read_b64_tr_b16 a[4:5], v8 offset:8192
  ds_read_b64_tr_b16 a[6:7], v8 offset:10240
  ds_read_b64_tr_b16 a[160:161], v8 offset:256
  ds_read_b64_tr_b16 a[162:163], v8 offset:2304
  ds_read_b64_tr_b16 a[164:165], v8 offset:8448
  ds_read_b64_tr_b16 a[166:167], v8 offset:10496
  s_waitcnt lgkmcnt(0)
  s_waitcnt vmcnt(20)
  s_barrier
  s_lshl_b32 s29, s21, 10
  s_add_u32 m0, s29, 114688
  s_mov_b32 s28, 2752512
  buffer_load_dwordx4 v5, s[12:15], s28 offen lds
  s_lshl_b32 s29, s21, 10
  s_add_u32 m0, s29, 118784
  s_mov_b32 s28, 2850816
  buffer_load_dwordx4 v5, s[12:15], s28 offen lds
  s_lshl_b32 s29, s21, 10
  s_add_u32 m0, s29, 122880
  s_mov_b32 s28, 2949120
  buffer_load_dwordx4 v5, s[12:15], s28 offen lds
  s_lshl_b32 s29, s21, 10
  s_add_u32 m0, s29, 126976
  s_mov_b32 s28, 3047424
  buffer_load_dwordx4 v5, s[12:15], s28 offen lds
  v_add_u32 v8, 16384, v7
  ds_read_b64_tr_b16 a[8:9], v8 offset:0
  ds_read_b64_tr_b16 a[10:11], v8 offset:2048
  ds_read_b64_tr_b16 a[12:13], v8 offset:8192
  ds_read_b64_tr_b16 a[14:15], v8 offset:10240
  ds_read_b64_tr_b16 a[168:169], v8 offset:256
  ds_read_b64_tr_b16 a[170:171], v8 offset:2304
  ds_read_b64_tr_b16 a[172:173], v8 offset:8448
  ds_read_b64_tr_b16 a[174:175], v8 offset:10496
  s_waitcnt lgkmcnt(0)
  s_waitcnt vmcnt(20)
  s_barrier
  s_lshl_b32 s29, s21, 10
  s_add_u32 m0, s29, 0
  s_mov_b32 s28, 3145728
  buffer_load_dwordx4 v5, s[12:15], s28 offen lds
  s_lshl_b32 s29, s21, 10
  s_add_u32 m0, s29, 4096
  s_mov_b32 s28, 3244032
  buffer_load_dwordx4 v5, s[12:15], s28 offen lds
  s_lshl_b32 s29, s21, 10
  s_add_u32 m0, s29, 8192
  s_mov_b32 s28, 3342336
  buffer_load_dwordx4 v5, s[12:15], s28 offen lds
  s_lshl_b32 s29, s21, 10
  s_add_u32 m0, s29, 12288
  s_mov_b32 s28, 3440640
  buffer_load_dwordx4 v5, s[12:15], s28 offen lds
  v_add_u32 v8, 32768, v7
  ds_read_b64_tr_b16 a[16:17], v8 offset:0
  ds_read_b64_tr_b16 a[18:19], v8 offset:2048
  ds_read_b64_tr_b16 a[20:21], v8 offset:8192
  ds_read_b64_tr_b16 a[22:23], v8 offset:10240
  ds_read_b64_tr_b16 a[176:177], v8 offset:256
  ds_read_b64_tr_b16 a[178:179], v8 offset:2304
  ds_read_b64_tr_b16 a[180:181], v8 offset:8448
  ds_read_b64_tr_b16 a[182:183], v8 offset:10496
  s_waitcnt lgkmcnt(0)
  s_waitcnt vmcnt(20)
  s_barrier
  s_lshl_b32 s29, s21, 10
  s_add_u32 m0, s29, 16384
  s_mov_b32 s28, 3538944
  buffer_load_dwordx4 v5, s[12:15], s28 offen lds
  s_lshl_b32 s29, s21, 10
  s_add_u32 m0, s29, 20480
  s_mov_b32 s28, 3637248
  buffer_load_dwordx4 v5, s[12:15], s28 offen lds
  s_lshl_b32 s29, s21, 10
  s_add_u32 m0, s29, 24576
  s_mov_b32 s28, 3735552
  buffer_load_dwordx4 v5, s[12:15], s28 offen lds
  s_lshl_b32 s29, s21, 10
  s_add_u32 m0, s29, 28672
  s_mov_b32 s28, 3833856
  buffer_load_dwordx4 v5, s[12:15], s28 offen lds
  v_add_u32 v8, 49152, v7
  ds_read_b64_tr_b16 a[24:25], v8 offset:0
  ds_read_b64_tr_b16 a[26:27], v8 offset:2048
  ds_read_b64_tr_b16 a[28:29], v8 offset:8192
  ds_read_b64_tr_b16 a[30:31], v8 offset:10240
  ds_read_b64_tr_b16 a[184:185], v8 offset:256
  ds_read_b64_tr_b16 a[186:187], v8 offset:2304
  ds_read_b64_tr_b16 a[188:189], v8 offset:8448
  ds_read_b64_tr_b16 a[190:191], v8 offset:10496
  s_waitcnt lgkmcnt(0)
  s_waitcnt vmcnt(20)
  s_barrier
  s_lshl_b32 s29, s21, 10
  s_add_u32 m0, s29, 32768
  s_mov_b32 s28, 3932160
  buffer_load_dwordx4 v5, s[12:15], s28 offen lds
  s_lshl_b32 s29, s21, 10
  s_add_u32 m0, s29, 36864
  s_mov_b32 s28, 4030464
  buffer_load_dwordx4 v5, s[12:15], s28 offen lds
  s_lshl_b32 s29, s21, 10
  s_add_u32 m0, s29, 40960
  s_mov_b32 s28, 4128768
  buffer_load_dwordx4 v5, s[12:15], s28 offen lds
  s_lshl_b32 s29, s21, 10
  s_add_u32 m0, s29, 45056
  s_mov_b32 s28, 4227072
  buffer_load_dwordx4 v5, s[12:15], s28 offen lds
  v_add_u32 v8, 65536, v7
  ds_read_b64_tr_b16 a[32:33], v8 offset:0
  ds_read_b64_tr_b16 a[34:35], v8 offset:2048
  ds_read_b64_tr_b16 a[36:37], v8 offset:8192
  ds_read_b64_tr_b16 a[38:39], v8 offset:10240
  ds_read_b64_tr_b16 a[192:193], v8 offset:256
  ds_read_b64_tr_b16 a[194:195], v8 offset:2304
  ds_read_b64_tr_b16 a[196:197], v8 offset:8448
  ds_read_b64_tr_b16 a[198:199], v8 offset:10496
  s_waitcnt lgkmcnt(0)
  s_waitcnt vmcnt(20)
  s_barrier
  s_lshl_b32 s29, s21, 10
  s_add_u32 m0, s29, 49152
  s_mov_b32 s28, 4325376
  buffer_load_dwordx4 v5, s[12:15], s28 offen lds
  s_lshl_b32 s29, s21, 10
  s_add_u32 m0, s29, 53248
  s_mov_b32 s28, 4423680
  buffer_load_dwordx4 v5, s[12:15], s28 offen lds
  s_lshl_b32 s29, s21, 10
  s_add_u32 m0, s29, 57344
  s_mov_b32 s28, 4521984
  buffer_load_dwordx4 v5, s[12:15], s28 offen lds
  s_lshl_b32 s29, s21, 10
  s_add_u32 m0, s29, 61440
  s_mov_b32 s28, 4620288
  buffer_load_dwordx4 v5, s[12:15], s28 offen lds
  v_add_u32 v8, 81920, v7
  ds_read_b64_tr_b16 a[40:41], v8 offset:0
  ds_read_b64_tr_b16 a[42:43], v8 offset:2048
  ds_read_b64_tr_b16 a[44:45], v8 offset:8192
  ds_read_b64_tr_b16 a[46:47], v8 offset:10240
  ds_read_b64_tr_b16 a[200:201], v8 offset:256
  ds_read_b64_tr_b16 a[202:203], v8 offset:2304
  ds_read_b64_tr_b16 a[204:205], v8 offset:8448
  ds_read_b64_tr_b16 a[206:207], v8 offset:10496
  s_waitcnt lgkmcnt(0)
  s_waitcnt vmcnt(20)
  s_barrier
  s_lshl_b32 s29, s21, 10
  s_add_u32 m0, s29, 65536
  s_mov_b32 s28, 4718592
  buffer_load_dwordx4 v5, s[12:15], s28 offen lds
  s_lshl_b32 s29, s21, 10
  s_add_u32 m0, s29, 69632
  s_mov_b32 s28, 4816896
  buffer_load_dwordx4 v5, s[12:15], s28 offen lds
  s_lshl_b32 s29, s21, 10
  s_add_u32 m0, s29, 73728
  s_mov_b32 s28, 4915200
  buffer_load_dwordx4 v5, s[12:15], s28 offen lds
  s_lshl_b32 s29, s21, 10
  s_add_u32 m0, s29, 77824
  s_mov_b32 s28, 5013504
  buffer_load_dwordx4 v5, s[12:15], s28 offen lds
  v_add_u32 v8, 98304, v7
  ds_read_b64_tr_b16 a[48:49], v8 offset:0
  ds_read_b64_tr_b16 a[50:51], v8 offset:2048
  ds_read_b64_tr_b16 a[52:53], v8 offset:8192
  ds_read_b64_tr_b16 a[54:55], v8 offset:10240
  ds_read_b64_tr_b16 a[208:209], v8 offset:256
  ds_read_b64_tr_b16 a[210:211], v8 offset:2304
  ds_read_b64_tr_b16 a[212:213], v8 offset:8448
  ds_read_b64_tr_b16 a[214:215], v8 offset:10496
  s_waitcnt lgkmcnt(0)
  s_waitcnt vmcnt(20)
  s_barrier
  s_lshl_b32 s29, s21, 10
  s_add_u32 m0, s29, 81920
  s_mov_b32 s28, 5111808
  buffer_load_dwordx4 v5, s[12:15], s28 offen lds
  s_lshl_b32 s29, s21, 10
  s_add_u32 m0, s29, 86016
  s_mov_b32 s28, 5210112
  buffer_load_dwordx4 v5, s[12:15], s28 offen lds
  s_lshl_b32 s29, s21, 10
  s_add_u32 m0, s29, 90112
  s_mov_b32 s28, 5308416
  buffer_load_dwordx4 v5, s[12:15], s28 offen lds
  s_lshl_b32 s29, s21, 10
  s_add_u32 m0, s29, 94208
  s_mov_b32 s28, 5406720
  buffer_load_dwordx4 v5, s[12:15], s28 offen lds
  v_add_u32 v8, 114688, v7
  ds_read_b64_tr_b16 a[56:57], v8 offset:0
  ds_read_b64_tr_b16 a[58:59], v8 offset:2048
  ds_read_b64_tr_b16 a[60:61], v8 offset:8192
  ds_read_b64_tr_b16 a[62:63], v8 offset:10240
  ds_read_b64_tr_b16 a[216:217], v8 offset:256
  ds_read_b64_tr_b16 a[218:219], v8 offset:2304
  ds_read_b64_tr_b16 a[220:221], v8 offset:8448
  ds_read_b64_tr_b16 a[222:223], v8 offset:10496
  s_waitcnt lgkmcnt(0)
  s_waitcnt vmcnt(20)
  s_barrier
  s_lshl_b32 s29, s21, 10
  s_add_u32 m0, s29, 98304
  s_mov_b32 s28, 5505024
  buffer_load_dwordx4 v5, s[12:15], s28 offen lds
  s_lshl_b32 s29, s21, 10
  s_add_u32 m0, s29, 102400
  s_mov_b32 s28, 5603328
  buffer_load_dwordx4 v5, s[12:15], s28 offen lds
  s_lshl_b32 s29, s21, 10
  s_add_u32 m0, s29, 106496
  s_mov_b32 s28, 5701632
  buffer_load_dwordx4 v5, s[12:15], s28 offen lds
  s_lshl_b32 s29, s21, 10
  s_add_u32 m0, s29, 110592
  s_mov_b32 s28, 5799936
  buffer_load_dwordx4 v5, s[12:15], s28 offen lds
  v_add_u32 v8, 0, v7
  ds_read_b64_tr_b16 a[64:65], v8 offset:0
  ds_read_b64_tr_b16 a[66:67], v8 offset:2048
  ds_read_b64_tr_b16 a[68:69], v8 offset:8192
  ds_read_b64_tr_b16 a[70:71], v8 offset:10240
  ds_read_b64_tr_b16 a[224:225], v8 offset:256
  ds_read_b64_tr_b16 a[226:227], v8 offset:2304
  ds_read_b64_tr_b16 a[228:229], v8 offset:8448
  ds_read_b64_tr_b16 a[230:231], v8 offset:10496
  s_waitcnt lgkmcnt(0)
  s_waitcnt vmcnt(20)
  s_barrier
  s_lshl_b32 s29, s21, 10
  s_add_u32 m0, s29, 114688
  s_mov_b32 s28, 5898240
  buffer_load_dwordx4 v5, s[12:15], s28 offen lds
  s_lshl_b32 s29, s21, 10
  s_add_u32 m0, s29, 118784
  s_mov_b32 s28, 5996544
  buffer_load_dwordx4 v5, s[12:15], s28 offen lds
  s_lshl_b32 s29, s21, 10
  s_add_u32 m0, s29, 122880
  s_mov_b32 s28, 6094848
  buffer_load_dwordx4 v5, s[12:15], s28 offen lds
  s_lshl_b32 s29, s21, 10
  s_add_u32 m0, s29, 126976
  s_mov_b32 s28, 6193152
  buffer_load_dwordx4 v5, s[12:15], s28 offen lds
  v_add_u32 v8, 16384, v7
  ds_read_b64_tr_b16 a[72:73], v8 offset:0
  ds_read_b64_tr_b16 a[74:75], v8 offset:2048
  ds_read_b64_tr_b16 a[76:77], v8 offset:8192
  ds_read_b64_tr_b16 a[78:79], v8 offset:10240
  ds_read_b64_tr_b16 a[232:233], v8 offset:256
  ds_read_b64_tr_b16 a[234:235], v8 offset:2304
  ds_read_b64_tr_b16 a[236:237], v8 offset:8448
  ds_read_b64_tr_b16 a[238:239], v8 offset:10496
  s_waitcnt lgkmcnt(0)
  s_waitcnt vmcnt(20)
  s_barrier
  s_lshl_b32 s29, s21, 10
  s_add_u32 m0, s29, 0
  s_mov_b32 s28, 6291456
  buffer_load_dwordx4 v5, s[12:15], s28 offen lds
  s_lshl_b32 s29, s21, 10
  s_add_u32 m0, s29, 4096
  s_mov_b32 s28, 6389760
  buffer_load_dwordx4 v5, s[12:15], s28 offen lds
  s_lshl_b32 s29, s21, 10
  s_add_u32 m0, s29, 8192
  s_mov_b32 s28, 6488064
  buffer_load_dwordx4 v5, s[12:15], s28 offen lds
  s_lshl_b32 s29, s21, 10
  s_add_u32 m0, s29, 12288
  s_mov_b32 s28, 6586368
  buffer_load_dwordx4 v5, s[12:15], s28 offen lds
  v_add_u32 v8, 32768, v7
  ds_read_b64_tr_b16 a[80:81], v8 offset:0
  ds_read_b64_tr_b16 a[82:83], v8 offset:2048
  ds_read_b64_tr_b16 a[84:85], v8 offset:8192
  ds_read_b64_tr_b16 a[86:87], v8 offset:10240
  ds_read_b64_tr_b16 a[240:241], v8 offset:256
  ds_read_b64_tr_b16 a[242:243], v8 offset:2304
  ds_read_b64_tr_b16 a[244:245], v8 offset:8448
  ds_read_b64_tr_b16 a[246:247], v8 offset:10496
  s_waitcnt lgkmcnt(0)
  s_waitcnt vmcnt(20)
  s_barrier
  s_lshl_b32 s29, s21, 10
  s_add_u32 m0, s29, 16384
  s_mov_b32 s28, 6684672
  buffer_load_dwordx4 v5, s[12:15], s28 offen lds
  s_lshl_b32 s29, s21, 10
  s_add_u32 m0, s29, 20480
  s_mov_b32 s28, 6782976
  buffer_load_dwordx4 v5, s[12:15], s28 offen lds
  s_lshl_b32 s29, s21, 10
  s_add_u32 m0, s29, 24576
  s_mov_b32 s28, 6881280
  buffer_load_dwordx4 v5, s[12:15], s28 offen lds
  s_lshl_b32 s29, s21, 10
  s_add_u32 m0, s29, 28672
  s_mov_b32 s28, 6979584
  buffer_load_dwordx4 v5, s[12:15], s28 offen lds
  v_add_u32 v8, 49152, v7
  ds_read_b64_tr_b16 a[88:89], v8 offset:0
  ds_read_b64_tr_b16 a[90:91], v8 offset:2048
  ds_read_b64_tr_b16 a[92:93], v8 offset:8192
  ds_read_b64_tr_b16 a[94:95], v8 offset:10240
  ds_read_b64_tr_b16 a[248:249], v8 offset:256
  ds_read_b64_tr_b16 a[250:251], v8 offset:2304
  ds_read_b64_tr_b16 a[252:253], v8 offset:8448
  ds_read_b64_tr_b16 a[254:255], v8 offset:10496
  s_waitcnt lgkmcnt(0)
  s_waitcnt vmcnt(20)
  s_barrier
  s_lshl_b32 s29, s21, 10
  s_add_u32 m0, s29, 32768
  s_mov_b32 s28, 7077888
  buffer_load_dwordx4 v5, s[12:15], s28 offen lds
  s_lshl_b32 s29, s21, 10
  s_add_u32 m0, s29, 36864
  s_mov_b32 s28, 7176192
  buffer_load_dwordx4 v5, s[12:15], s28 offen lds
  s_lshl_b32 s29, s21, 10
  s_add_u32 m0, s29, 40960
  s_mov_b32 s28, 7274496
  buffer_load_dwordx4 v5, s[12:15], s28 offen lds
  s_lshl_b32 s29, s21, 10
  s_add_u32 m0, s29, 45056
  s_mov_b32 s28, 7372800
  buffer_load_dwordx4 v5, s[12:15], s28 offen lds
  v_add_u32 v8, 65536, v7
  ds_read_b64_tr_b16 a[96:97], v8 offset:0
  ds_read_b64_tr_b16 a[98:99], v8 offset:2048
  ds_read_b64_tr_b16 a[100:101], v8 offset:8192
  ds_read_b64_tr_b16 a[102:103], v8 offset:10240
  ds_read_b64_tr_b16 v[192:193], v8 offset:256
  ds_read_b64_tr_b16 v[194:195], v8 offset:2304
  ds_read_b64_tr_b16 v[196:197], v8 offset:8448
  ds_read_b64_tr_b16 v[198:199], v8 offset:10496
  s_waitcnt lgkmcnt(0)
  s_waitcnt vmcnt(20)
  s_barrier
  s_lshl_b32 s29, s21, 10
  s_add_u32 m0, s29, 49152
  s_mov_b32 s28, 7471104
  buffer_load_dwordx4 v5, s[12:15], s28 offen lds
  s_lshl_b32 s29, s21, 10
  s_add_u32 m0, s29, 53248
  s_mov_b32 s28, 7569408
  buffer_load_dwordx4 v5, s[12:15], s28 offen lds
  s_lshl_b32 s29, s21, 10
  s_add_u32 m0, s29, 57344
  s_mov_b32 s28, 7667712
  buffer_load_dwordx4 v5, s[12:15], s28 offen lds
  s_lshl_b32 s29, s21, 10
  s_add_u32 m0, s29, 61440
  s_mov_b32 s28, 7766016
  buffer_load_dwordx4 v5, s[12:15], s28 offen lds
  v_add_u32 v8, 81920, v7
  ds_read_b64_tr_b16 a[104:105], v8 offset:0
  ds_read_b64_tr_b16 a[106:107], v8 offset:2048
  ds_read_b64_tr_b16 a[108:109], v8 offset:8192
  ds_read_b64_tr_b16 a[110:111], v8 offset:10240
  ds_read_b64_tr_b16 v[200:201], v8 offset:256
  ds_read_b64_tr_b16 v[202:203], v8 offset:2304
  ds_read_b64_tr_b16 v[204:205], v8 offset:8448
  ds_read_b64_tr_b16 v[206:207], v8 offset:10496
  s_waitcnt lgkmcnt(0)
  s_waitcnt vmcnt(20)
  s_barrier
  v_add_u32 v8, 98304, v7
  ds_read_b64_tr_b16 a[112:113], v8 offset:0
  ds_read_b64_tr_b16 a[114:115], v8 offset:2048
  ds_read_b64_tr_b16 a[116:117], v8 offset:8192
  ds_read_b64_tr_b16 a[118:119], v8 offset:10240
  ds_read_b64_tr_b16 v[208:209], v8 offset:256
  ds_read_b64_tr_b16 v[210:211], v8 offset:2304
  ds_read_b64_tr_b16 v[212:213], v8 offset:8448
  ds_read_b64_tr_b16 v[214:215], v8 offset:10496
  s_waitcnt lgkmcnt(0)
  s_waitcnt vmcnt(16)
  s_barrier
  v_add_u32 v8, 114688, v7
  ds_read_b64_tr_b16 a[120:121], v8 offset:0
  ds_read_b64_tr_b16 a[122:123], v8 offset:2048
  ds_read_b64_tr_b16 a[124:125], v8 offset:8192
  ds_read_b64_tr_b16 a[126:127], v8 offset:10240
  ds_read_b64_tr_b16 v[216:217], v8 offset:256
  ds_read_b64_tr_b16 v[218:219], v8 offset:2304
  ds_read_b64_tr_b16 v[220:221], v8 offset:8448
  ds_read_b64_tr_b16 v[222:223], v8 offset:10496
  s_waitcnt lgkmcnt(0)
  s_waitcnt vmcnt(12)
  s_barrier
  v_add_u32 v8, 0, v7
  ds_read_b64_tr_b16 a[128:129], v8 offset:0
  ds_read_b64_tr_b16 a[130:131], v8 offset:2048
  ds_read_b64_tr_b16 a[132:133], v8 offset:8192
  ds_read_b64_tr_b16 a[134:135], v8 offset:10240
  ds_read_b64_tr_b16 v[224:225], v8 offset:256
  ds_read_b64_tr_b16 v[226:227], v8 offset:2304
  ds_read_b64_tr_b16 v[228:229], v8 offset:8448
  ds_read_b64_tr_b16 v[230:231], v8 offset:10496
  s_waitcnt lgkmcnt(0)
  s_waitcnt vmcnt(8)
  s_barrier
  v_add_u32 v8, 16384, v7
  ds_read_b64_tr_b16 a[136:137], v8 offset:0
  ds_read_b64_tr_b16 a[138:139], v8 offset:2048
  ds_read_b64_tr_b16 a[140:141], v8 offset:8192
  ds_read_b64_tr_b16 a[142:143], v8 offset:10240
  ds_read_b64_tr_b16 v[232:233], v8 offset:256
  ds_read_b64_tr_b16 v[234:235], v8 offset:2304
  ds_read_b64_tr_b16 v[236:237], v8 offset:8448
  ds_read_b64_tr_b16 v[238:239], v8 offset:10496
  s_waitcnt lgkmcnt(0)
  s_waitcnt vmcnt(4)
  s_barrier
  v_add_u32 v8, 32768, v7
  ds_read_b64_tr_b16 a[144:145], v8 offset:0
  ds_read_b64_tr_b16 a[146:147], v8 offset:2048
  ds_read_b64_tr_b16 a[148:149], v8 offset:8192
  ds_read_b64_tr_b16 a[150:151], v8 offset:10240
  ds_read_b64_tr_b16 v[240:241], v8 offset:256
  ds_read_b64_tr_b16 v[242:243], v8 offset:2304
  ds_read_b64_tr_b16 v[244:245], v8 offset:8448
  ds_read_b64_tr_b16 v[246:247], v8 offset:10496
  s_waitcnt lgkmcnt(0)
  s_waitcnt vmcnt(0)
  s_barrier
  v_add_u32 v8, 49152, v7
  ds_read_b64_tr_b16 a[152:153], v8 offset:0
  ds_read_b64_tr_b16 a[154:155], v8 offset:2048
  ds_read_b64_tr_b16 a[156:157], v8 offset:8192
  ds_read_b64_tr_b16 a[158:159], v8 offset:10240
  ds_read_b64_tr_b16 v[248:249], v8 offset:256
  ds_read_b64_tr_b16 v[250:251], v8 offset:2304
  ds_read_b64_tr_b16 v[252:253], v8 offset:8448
  ds_read_b64_tr_b16 v[254:255], v8 offset:10496
  s_waitcnt lgkmcnt(0)
  s_barrier
  v_lshlrev_b32 v5, 4, v1
  s_lshl_b32 s28, s21, 10
  v_add_u32 v6, s28, v5
  v_mov_b32 v9, v5
  v_add_u32 v10, 40960, v5
  v_bfe_u32 v2, v1, 4, 1
  v_lshlrev_b32 v11, 10, v2
  v_and_b32 v2, 15, v1
  v_lshlrev_b32 v2, 4, v2
  v_add_u32 v11, v11, v2
  v_lshrrev_b32 v2, 5, v1
  v_lshlrev_b32 v2, 9, v2
  v_add_u32 v11, v11, v2
  v_mov_b32 v12, s47
  s_mov_b32 s50, 0
  s_mov_b32 s51, 0x100000
  s_cmp_eq_u32 s99, 1
  s_cbranch_scc0 xw_45_ok
  s_mov_b32 s45, 0
  v_mov_b32 v2, 4992
xw_45:
  buffer_load_dword v3, v2, s[8:11], 0 offen sc1
  s_add_u32 s45, s45, 1
  s_waitcnt vmcnt(0)
  v_readfirstlane_b32 s28, v3
  s_cmp_ge_u32 s28, 256
  s_cbranch_scc1 xw_45_ok
  s_cmp_lt_u32 s45, 400000
  s_cbranch_scc1 xw_45
  s_branch ka_abort
xw_45_ok:
  s_lshl_b32 s29, s21, 10
  s_add_u32 m0, s29, 0
  s_add_u32 s28, s51, 0
  buffer_load_dwordx4 v6, s[8:11], s28 offen sc1 lds
  s_lshl_b32 s29, s21, 10
  s_add_u32 m0, s29, 4096
  s_add_u32 s28, s51, 4096
  buffer_load_dwordx4 v6, s[8:11], s28 offen sc1 lds
  s_lshl_b32 s29, s21, 10
  s_add_u32 m0, s29, 8192
  s_add_u32 s28, s51, 8192
  buffer_load_dwordx4 v6, s[8:11], s28 offen sc1 lds
  s_lshl_b32 s29, s21, 10
  s_add_u32 m0, s29, 12288
  s_add_u32 s28, s51, 12288
  buffer_load_dwordx4 v6, s[8:11], s28 offen sc1 lds
  s_lshl_b32 s29, s21, 10
  s_add_u32 m0, s29, 16384
  s_add_u32 s28, s51, 16384
  buffer_load_dwordx4 v6, s[8:11], s28 offen sc1 lds
  s_lshl_b32 s29, s21, 10
  s_add_u32 m0, s29, 20480
  s_add_u32 s28, s51, 20480
  buffer_load_dwordx4 v6, s[8:11], s28 offen sc1 lds
  s_lshl_b32 s29, s21, 10
  s_add_u32 m0, s29, 24576
  s_add_u32 s28, s51, 24576
  buffer_load_dwordx4 v6, s[8:11], s28 offen sc1 lds
  s_lshl_b32 s29, s21, 10
  s_add_u32 m0, s29, 28672
  s_add_u32 s28, s51, 28672
  buffer_load_dwordx4 v6, s[8:11], s28 offen sc1 lds
  s_lshl_b32 s29, s21, 10
  s_add_u32 m0, s29, 32768
  s_add_u32 s28, s51, 32768
  buffer_load_dwordx4 v6, s[8:11], s28 offen sc1 lds
  s_lshl_b32 s29, s21, 10
  s_add_u32 m0, s29, 36864
  s_add_u32 s28, s51, 36864
  buffer_load_dwordx4 v6, s[8:11], s28 offen sc1 lds
  s_add_u32 s51, s51, 40960
ka_qkv_loop:
  s_cmp_eq_u32 s50, 0
  s_cbranch_scc0 q0_46
  s_waitcnt vmcnt(0)
q0_46:
  s_waitcnt vmcnt(4)
  s_barrier
  s_cmp_ge_u32 s50, 63
  s_cbranch_scc1 qn_47_n
  s_lshl_b32 s29, s21, 10
  s_add_u32 m0, s29, 40960
  s_add_u32 s28, s51, 0
  buffer_load_dwordx4 v6, s[8:11], s28 offen sc1 lds
  s_lshl_b32 s29, s21, 10
  s_add_u32 m0, s29, 45056
  s_add_u32 s28, s51, 4096
  buffer_load_dwordx4 v6, s[8:11], s28 offen sc1 lds
  s_lshl_b32 s29, s21, 10
  s_add_u32 m0, s29, 49152
  s_add_u32 s28, s51, 8192
  buffer_load_dwordx4 v6, s[8:11], s28 offen sc1 lds
  s_lshl_b32 s29, s21, 10
  s_add_u32 m0, s29, 53248
  s_add_u32 s28, s51, 12288
  buffer_load_dwordx4 v6, s[8:11], s28 offen sc1 lds
  s_lshl_b32 s29, s21, 10
  s_add_u32 m0, s29, 57344
  s_add_u32 s28, s51, 16384
  buffer_load_dwordx4 v6, s[8:11], s28 offen sc1 lds
  s_lshl_b32 s29, s21, 10
  s_add_u32 m0, s29, 61440
  s_add_u32 s28, s51, 20480
  buffer_load_dwordx4 v6, s[8:11], s28 offen sc1 lds
  s_lshl_b32 s29, s21, 10
  s_add_u32 m0, s29, 65536
  s_add_u32 s28, s51, 24576
  buffer_load_dwordx4 v6, s[8:11], s28 offen sc1 lds
  s_lshl_b32 s29, s21, 10
  s_add_u32 m0, s29, 69632
  s_add_u32 s28, s51, 28672
  buffer_load_dwordx4 v6, s[8:11], s28 offen sc1 lds
  s_lshl_b32 s29, s21, 10
  s_add_u32 m0, s29, 73728
  s_add_u32 s28, s51, 32768
  buffer_load_dwordx4 v6, s[8:11], s28 offen sc1 lds
  s_lshl_b32 s29, s21, 10
  s_add_u32 m0, s29, 77824
  s_add_u32 s28, s51, 36864
  buffer_load_dwordx4 v6, s[8:11], s28 offen sc1 lds
  s_add_u32 s51, s51, 40960
  s_branch qn_47
qn_47_n:
  s_waitcnt vmcnt(0)
qn_47:
  ds_read_b128 v[128:131], v9 offset:0
  ds_read_b128 v[132:135], v9 offset:1024
  ds_read_b128 v[136:139], v9 offset:2048
  ds_read_b128 v[140:143], v9 offset:3072
  s_waitcnt lgkmcnt(3)
  v_mfma_f32_32x32x16_bf16 v[64:79], a[0:3], v[128:131], 0
  v_mfma_f32_32x32x16_bf16 v[80:95], a[160:163], v[128:131], 0
  ds_read_b128 v[128:131], v9 offset:4096
  s_waitcnt lgkmcnt(3)
  v_mfma_f32_32x32x16_bf16 v[64:79], a[4:7], v[132:135], v[64:79]
  v_mfma_f32_32x32x16_bf16 v[80:95], a[164:167], v[132:135], v[80:95]
  ds_read_b128 v[132:135], v9 offset:5120
  s_waitcnt lgkmcnt(3)
  v_mfma_f32_32x32x16_bf16 v[64:79], a[8:11], v[136:139], v[64:79]
  v_mfma_f32_32x32x16_bf16 v[80:95], a[168:171], v[136:139], v[80:95]
  ds_read_b128 v[136:139], v9 offset:6144
  s_waitcnt lgkmcnt(3)
  v_mfma_f32_32x32x16_bf16 v[64:79], a[12:15], v[140:143], v[64:79]
  v_mfma_f32_32x32x16_bf16 v[80:95], a[172:175], v[140:143], v[80:95]
  ds_read_b128 v[140:143], v9 offset:7168
  s_waitcnt lgkmcnt(3)
  v_mfma_f32_32x32x16_bf16 v[64:79], a[16:19], v[128:131], v[64:79]
  v_mfma_f32_32x32x16_bf16 v[80:95], a[176:179], v[128:131], v[80:95]
  ds_read_b128 v[128:131], v9 offset:8192
  s_waitcnt lgkmcnt(3)
  v_mfma_f32_32x32x16_bf16 v[64:79], a[20:23], v[132:135], v[64:79]
  v_mfma_f32_32x32x16_bf16 v[80:95], a[180:183], v[132:135], v[80:95]
  ds_read_b128 v[132:135], v9 offset:9216
  s_waitcnt lgkmcnt(3)
  v_mfma_f32_32x32x16_bf16 v[64:79], a[24:27], v[136:139], v[64:79]
  v_mfma_f32_32x32x16_bf16 v[80:95], a[184:187], v[136:139], v[80:95]
  ds_read_b128 v[136:139], v9 offset:10240
  s_waitcnt lgkmcnt(3)
  v_mfma_f32_32x32x16_bf16 v[64:79], a[28:31], v[140:143], v[64:79]
  v_mfma_f32_32x32x16_bf16 v[80:95], a[188:191], v[140:143], v[80:95]
  ds_read_b128 v[140:143], v9 offset:11264
  s_waitcnt lgkmcnt(3)
  v_mfma_f32_32x32x16_bf16 v[64:79], a[32:35], v[128:131], v[64:79]
  v_mfma_f32_32x32x16_bf16 v[80:95], a[192:195], v[128:131], v[80:95]
  ds_read_b128 v[128:131], v9 offset:12288
  s_waitcnt lgkmcnt(3)
  v_mfma_f32_32x32x16_bf16 v[64:79], a[36:39], v[132:135], v[64:79]
  v_mfma_f32_32x32x16_bf16 v[80:95], a[196:199], v[132:135], v[80:95]
  ds_read_b128 v[132:135], v9 offset:13312
  s_waitcnt lgkmcnt(3)
  v_mfma_f32_32x32x16_bf16 v[64:79], a[40:43], v[136:139], v[64:79]
  v_mfma_f32_32x32x16_bf16 v[80:95], a[200:203], v[136:139], v[80:95]
  ds_read_b128 v[136:139], v9 offset:14336
  s_waitcnt lgkmcnt(3)
  v_mfma_f32_32x32x16_bf16 v[64:79], a[44:47], v[140:143], v[64:79]
  v_mfma_f32_32x32x16_bf16 v[80:95], a[204:207], v[140:143], v[80:95]
  ds_read_b128 v[140:143], v9 offset:15360
  s_waitcnt lgkmcnt(3)
  v_mfma_f32_32x32x16_bf16 v[64:79], a[48:51], v[128:131], v[64:79]
  v_mfma_f32_32x32x16_bf16 v[80:95], a[208:211], v[128:131], v[80:95]
  ds_read_b128 v[128:131], v9 offset:16384
  s_waitcnt lgkmcnt(3)
  v_mfma_f32_32x32x16_bf16 v[64:79], a[52:55], v[132:135], v[64:79]
  v_mfma_f32_32x32x16_bf16 v[80:95], a[212:215], v[132:135], v[80:95]
  ds_read_b128 v[132:135], v9 offset:17408
  s_waitcnt lgkmcnt(3)
  v_mfma_f32_32x32x16_bf16 v[64:79], a[56:59], v[136:139], v[64:79]
  v_mfma_f32_32x32x16_bf16 v[80:95], a[216:219], v[136:139], v[80:95]
  ds_read_b128 v[136:139], v9 offset:18432
  s_waitcnt lgkmcnt(3)
  v_mfma_f32_32x32x16_bf16 v[64:79], a[60:63], v[140:143], v[64:79]
  v_mfma_f32_32x32x16_bf16 v[80:95], a[220:223], v[140:143], v[80:95]
  ds_read_b128 v[140:143], v9 offset:19456
  s_waitcnt lgkmcnt(3)
  v_mfma_f32_32x32x16_bf16 v[64:79], a[64:67], v[128:131], v[64:79]
  v_mfma_f32_32x32x16_bf16 v[80:95], a[224:227], v[128:131], v[80:95]
  ds_read_b128 v[128:131], v9 offset:20480
  s_waitcnt lgkmcnt(3)
  v_mfma_f32_32x32x16_bf16 v[64:79], a[68:71], v[132:135], v[64:79]
  v_mfma_f32_32x32x16_bf16 v[80:95], a[228:231], v[132:135], v[80:95]
  ds_read_b128 v[132:135], v9 offset:21504
  s_waitcnt lgkmcnt(3)
  v_mfma_f32_32x32x16_bf16 v[64:79], a[72:75], v[136:139], v[64:79]
  v_mfma_f32_32x32x16_bf16 v[80:95], a[232:235], v[136:139], v[80:95]
  ds_read_b128 v[136:139], v9 offset:22528
  s_waitcnt lgkmcnt(3)
  v_mfma_f32_32x32x16_bf16 v[64:79], a[76:79], v[140:143], v[64:79]
  v_mfma_f32_32x32x16_bf16 v[80:95], a[236:239], v[140:143], v[80:95]
  ds_read_b128 v[140:143], v9 offset:23552
  s_waitcnt lgkmcnt(3)
  v_mfma_f32_32x32x16_bf16 v[64:79], a[80:83], v[128:131], v[64:79]
  v_mfma_f32_32x32x16_bf16 v[80:95], a[240:243], v[128:131], v[80:95]
  ds_read_b128 v[128:131], v9 offset:24576
  s_waitcnt lgkmcnt(3)
  v_mfma_f32_32x32x16_bf16 v[64:79], a[84:87], v[132:135], v[64:79]
  v_mfma_f32_32x32x16_bf16 v[80:95], a[244:247], v[132:135], v[80:95]
  ds_read_b128 v[132:135], v9 offset:25600
  s_waitcnt lgkmcnt(3)
  v_mfma_f32_32x32x16_bf16 v[64:79], a[88:91], v[136:139], v[64:79]
  v_mfma_f32_32x32x16_bf16 v[80:95], a[248:251], v[136:139], v[80:95]
  ds_read_b128 v[136:139], v9 offset:26624
  s_waitcnt lgkmcnt(3)
  v_mfma_f32_32x32x16_bf16 v[64:79], a[92:95], v[140:143], v[64:79]
  v_mfma_f32_32x32x16_bf16 v[80:95], a[252:255], v[140:143], v[80:95]
  ds_read_b128 v[140:143], v9 offset:27648
  s_waitcnt vmcnt(10)
  s_barrier
  s_cmp_eq_u32 s21, 0
  s_cbranch_scc0 mp_48
  v_mov_b32 v13, s50
  s_mov_b64 s[24:25], exec
  s_mov_b64 exec, 1
  buffer_store_dword v13, v12, s[8:11], 0 offen sc1
  s_mov_b64 exec, s[24:25]
mp_48:
  s_waitcnt lgkmcnt(3)
  v_mfma_f32_32x32x16_bf16 v[64:79], a[96:99], v[128:131], v[64:79]
  v_mfma_f32_32x32x16_bf16 v[80:95], v[192:195], v[128:131], v[80:95]
  ds_read_b128 v[128:131], v9 offset:28672
  s_waitcnt lgkmcnt(3)
  v_mfma_f32_32x32x16_bf16 v[64:79], a[100:103], v[132:135], v[64:79]
  v_mfma_f32_32x32x16_bf16 v[80:95], v[196:199], v[132:135], v[80:95]
  ds_read_b128 v[132:135], v9 offset:29696
  s_waitcnt lgkmcnt(3)
  v_mfma_f32_32x32x16_bf16 v[64:79], a[104:107], v[136:139], v[64:79]
  v_mfma_f32_32x32x16_bf16 v[80:95], v[200:203], v[136:139], v[80:95]
  ds_read_b128 v[136:139], v9 offset:30720
  s_waitcnt lgkmcnt(3)
  v_mfma_f32_32x32x16_bf16 v[64:79], a[108:111], v[140:143], v[64:79]
  v_mfma_f32_32x32x16_bf16 v[80:95], v[204:207], v[140:143], v[80:95]
  ds_read_b128 v[140:143], v9 offset:31744
  s_waitcnt lgkmcnt(3)
  v_mfma_f32_32x32x16_bf16 v[64:79], a[112:115], v[128:131], v[64:79]
  v_mfma_f32_32x32x16_bf16 v[80:95], v[208:211], v[128:131], v[80:95]
  ds_read_b128 v[128:131], v9 offset:32768
  s_waitcnt lgkmcnt(3)
  v_mfma_f32_32x32x16_bf16 v[64:79], a[116:119], v[132:135], v[64:79]
  v_mfma_f32_32x32x16_bf16 v[80:95], v[212:215], v[132:135], v[80:95]
  ds_read_b128 v[132:135], v9 offset:33792
  s_waitcnt lgkmcnt(3)
  v_mfma_f32_32x32x16_bf16 v[64:79], a[120:123], v[136:139], v[64:79]
  v_mfma_f32_32x32x16_bf16 v[80:95], v[216:219], v[136:139], v[80:95]
  ds_read_b128 v[136:139], v9 offset:34816
  s_waitcnt lgkmcnt(3)
  v_mfma_f32_32x32x16_bf16 v[64:79], a[124:127], v[140:143], v[64:79]
  v_mfma_f32_32x32x16_bf16 v[80:95], v[220:223], v[140:143], v[80:95]
  ds_read_b128 v[140:143], v9 offset:35840
  s_waitcnt lgkmcnt(3)
  v_mfma_f32_32x32x16_bf16 v[64:79], a[128:131], v[128:131], v[64:79]
  v_mfma_f32_32x32x16_bf16 v[80:95], v[224:227], v[128:131], v[80:95]
  ds_read_b128 v[128:131], v9 offset:36864
  s_waitcnt lgkmcnt(3)
  v_mfma_f32_32x32x16_bf16 v[64:79], a[132:135], v[132:135], v[64:79]
  v_mfma_f32_32x32x16_bf16 v[80:95], v[228:231], v[132:135], v[80:95]
  ds_read_b128 v[132:135], v9 offset:37888
  s_waitcnt lgkmcnt(3)
  v_mfma_f32_32x32x16_bf16 v[64:79], a[136:139], v[136:139], v[64:79]
  v_mfma_f32_32x32x16_bf16 v[80:95], v[232:235], v[136:139], v[80:95]
  ds_read_b128 v[136:139], v9 offset:38912
  s_waitcnt lgkmcnt(3)
  v_mfma_f32_32x32x16_bf16 v[64:79], a[140:143], v[140:143], v[64:79]
  v_mfma_f32_32x32x16_bf16 v[80:95], v[236:239], v[140:143], v[80:95]
  ds_read_b128 v[140:143], v9 offset:39936
  s_waitcnt lgkmcnt(3)
  v_mfma_f32_32x32x16_bf16 v[64:79], a[144:147], v[128:131], v[64:79]
  v_mfma_f32_32x32x16_bf16 v[80:95], v[240:243], v[128:131], v[80:95]
  s_waitcnt lgkmcnt(2)
  v_mfma_f32_32x32x16_bf16 v[64:79], a[148:151], v[132:135], v[64:79]
  v_mfma_f32_32x32x16_bf16 v[80:95], v[244:247], v[132:135], v[80:95]
  s_waitcnt lgkmcnt(1)
  v_mfma_f32_32x32x16_bf16 v[64:79], a[152:155], v[136:139], v[64:79]
  v_mfma_f32_32x32x16_bf16 v[80:95], v[248:251], v[136:139], v[80:95]
  s_waitcnt lgkmcnt(0)
  v_mfma_f32_32x32x16_bf16 v[64:79], a[156:159], v[140:143], v[64:79]
  v_mfma_f32_32x32x16_bf16 v[80:95], v[252:255], v[140:143], v[80:95]
  s_nop 11
  v_cvt_pk_bf16_f32 v144, v64, v65
  v_cvt_pk_bf16_f32 v145, v66, v67
  v_cvt_pk_bf16_f32 v146, v68, v69
  v_cvt_pk_bf16_f32 v147, v70, v71
  v_cvt_pk_bf16_f32 v148, v72, v73
  v_cvt_pk_bf16_f32 v149, v74, v75
  v_cvt_pk_bf16_f32 v150, v76, v77
  v_cvt_pk_bf16_f32 v151, v78, v79
  v_cvt_pk_bf16_f32 v152, v80, v81
  v_cvt_pk_bf16_f32 v153, v82, v83
  v_cvt_pk_bf16_f32 v154, v84, v85
  v_cvt_pk_bf16_f32 v155, v86, v87
  v_cvt_pk_bf16_f32 v156, v88, v89
  v_cvt_pk_bf16_f32 v157, v90, v91
  v_cvt_pk_bf16_f32 v158, v92, v93
  v_cvt_pk_bf16_f32 v159, v94, v95
  s_mul_i32 s28, s50, 12288
  s_add_u32 s29, s28, s48
  buffer_store_dwordx4 v[144:147], v11, s[8:11], s29 offen offset:0 sc1
  buffer_store_dwordx4 v[148:151], v11, s[8:11], s29 offen offset:256 sc1
  s_add_u32 s29, s28, s49
  buffer_store_dwordx4 v[152:155], v11, s[8:11], s29 offen offset:0 sc1
  buffer_store_dwordx4 v[156:159], v11, s[8:11], s29 offen offset:256 sc1
  s_add_u32 s50, s50, 1
  s_waitcnt vmcnt(4)
  s_barrier
  s_cmp_ge_u32 s50, 63
  s_cbranch_scc1 qn_49_n
  s_lshl_b32 s29, s21, 10
  s_add_u32 m0, s29, 0
  s_add_u32 s28, s51, 0
  buffer_load_dwordx4 v6, s[8:11], s28 offen sc1 lds
  s_lshl_b32 s29, s21, 10
  s_add_u32 m0, s29, 4096
  s_add_u32 s28, s51, 4096
  buffer_load_dwordx4 v6, s[8:11], s28 offen sc1 lds
  s_lshl_b32 s29, s21, 10
  s_add_u32 m0, s29, 8192
  s_add_u32 s28, s51, 8192
  buffer_load_dwordx4 v6, s[8:11], s28 offen sc1 lds
  s_lshl_b32 s29, s21, 10
  s_add_u32 m0, s29, 12288
  s_add_u32 s28, s51, 12288
  buffer_load_dwordx4 v6, s[8:11], s28 offen sc1 lds
  s_lshl_b32 s29, s21, 10
  s_add_u32 m0, s29, 16384
  s_add_u32 s28, s51, 16384
  buffer_load_dwordx4 v6, s[8:11], s28 offen sc1 lds
  s_lshl_b32 s29, s21, 10
  s_add_u32 m0, s29, 20480
  s_add_u32 s28, s51, 20480
  buffer_load_dwordx4 v6, s[8:11], s28 offen sc1 lds
  s_lshl_b32 s29, s21, 10
  s_add_u32 m0, s29, 24576
  s_add_u32 s28, s51, 24576
  buffer_load_dwordx4 v6, s[8:11], s28 offen sc1 lds
  s_lshl_b32 s29, s21, 10
  s_add_u32 m0, s29, 28672
  s_add_u32 s28, s51, 28672
  buffer_load_dwordx4 v6, s[8:11], s28 offen sc1 lds
  s_lshl_b32 s29, s21, 10
  s_add_u32 m0, s29, 32768
  s_add_u32 s28, s51, 32768
  buffer_load_dwordx4 v6, s[8:11], s28 offen sc1 lds
  s_lshl_b32 s29, s21, 10
  s_add_u32 m0, s29, 36864
  s_add_u32 s28, s51, 36864
  buffer_load_dwordx4 v6, s[8:11], s28 offen sc1 lds
  s_add_u32 s51, s51, 40960
  s_branch qn_49
qn_49_n:
  s_waitcnt vmcnt(0)
qn_49:
  ds_read_b128 v[128:131], v10 offset:0
  ds_read_b128 v[132:135], v10 offset:1024
  ds_read_b128 v[136:139], v10 offset:2048
  ds_read_b128 v[140:143], v10 offset:3072
  s_waitcnt lgkmcnt(3)
  v_mfma_f32_32x32x16_bf16 v[64:79], a[0:3], v[128:131], 0
  v_mfma_f32_32x32x16_bf16 v[80:95], a[160:163], v[128:131], 0
  ds_read_b128 v[128:131], v10 offset:4096
  s_waitcnt lgkmcnt(3)
  v_mfma_f32_32x32x16_bf16 v[64:79], a[4:7], v[132:135], v[64:79]
  v_mfma_f32_32x32x16_bf16 v[80:95], a[164:167], v[132:135], v[80:95]
  ds_read_b128 v[132:135], v10 offset:5120
  s_waitcnt lgkmcnt(3)
  v_mfma_f32_32x32x16_bf16 v[64:79], a[8:11], v[136:139], v[64:79]
  v_mfma_f32_32x32x16_bf16 v[80:95], a[168:171], v[136:139], v[80:95]
  ds_read_b128 v[136:139], v10 offset:6144
  s_waitcnt lgkmcnt(3)
  v_mfma_f32_32x32x16_bf16 v[64:79], a[12:15], v[140:143], v[64:79]
  v_mfma_f32_32x32x16_bf16 v[80:95], a[172:175], v[140:143], v[80:95]
  ds_read_b128 v[140:143], v10 offset:7168
  s_waitcnt lgkmcnt(3)
  v_mfma_f32_32x32x16_bf16 v[64:79], a[16:19], v[128:131], v[64:79]
  v_mfma_f32_32x32x16_bf16 v[80:95], a[176:179], v[128:131], v[80:95]
  ds_read_b128 v[128:131], v10 offset:8192
  s_waitcnt lgkmcnt(3)
  v_mfma_f32_32x32x16_bf16 v[64:79], a[20:23], v[132:135], v[64:79]
  v_mfma_f32_32x32x16_bf16 v[80:95], a[180:183], v[132:135], v[80:95]
  ds_read_b128 v[132:135], v10 offset:9216
  s_waitcnt lgkmcnt(3)
  v_mfma_f32_32x32x16_bf16 v[64:79], a[24:27], v[136:139], v[64:79]
  v_mfma_f32_32x32x16_bf16 v[80:95], a[184:187], v[136:139], v[80:95]
  ds_read_b128 v[136:139], v10 offset:10240
  s_waitcnt lgkmcnt(3)
  v_mfma_f32_32x32x16_bf16 v[64:79], a[28:31], v[140:143], v[64:79]
  v_mfma_f32_32x32x16_bf16 v[80:95], a[188:191], v[140:143], v[80:95]
  ds_read_b128 v[140:143], v10 offset:11264
  s_waitcnt lgkmcnt(3)
  v_mfma_f32_32x32x16_bf16 v[64:79], a[32:35], v[128:131], v[64:79]
  v_mfma_f32_32x32x16_bf16 v[80:95], a[192:195], v[128:131], v[80:95]
  ds_read_b128 v[128:131], v10 offset:12288
  s_waitcnt lgkmcnt(3)
  v_mfma_f32_32x32x16_bf16 v[64:79], a[36:39], v[132:135], v[64:79]
  v_mfma_f32_32x32x16_bf16 v[80:95], a[196:199], v[132:135], v[80:95]
  ds_read_b128 v[132:135], v10 offset:13312
  s_waitcnt lgkmcnt(3)
  v_mfma_f32_32x32x16_bf16 v[64:79], a[40:43], v[136:139], v[64:79]
  v_mfma_f32_32x32x16_bf16 v[80:95], a[200:203], v[136:139], v[80:95]
  ds_read_b128 v[136:139], v10 offset:14336
  s_waitcnt lgkmcnt(3)
  v_mfma_f32_32x32x16_bf16 v[64:79], a[44:47], v[140:143], v[64:79]
  v_mfma_f32_32x32x16_bf16 v[80:95], a[204:207], v[140:143], v[80:95]
  ds_read_b128 v[140:143], v10 offset:15360
  s_waitcnt lgkmcnt(3)
  v_mfma_f32_32x32x16_bf16 v[64:79], a[48:51], v[128:131], v[64:79]
  v_mfma_f32_32x32x16_bf16 v[80:95], a[208:211], v[128:131], v[80:95]
  ds_read_b128 v[128:131], v10 offset:16384
  s_waitcnt lgkmcnt(3)
  v_mfma_f32_32x32x16_bf16 v[64:79], a[52:55], v[132:135], v[64:79]
  v_mfma_f32_32x32x16_bf16 v[80:95], a[212:215], v[132:135], v[80:95]
  ds_read_b128 v[132:135], v10 offset:17408
  s_waitcnt lgkmcnt(3)
  v_mfma_f32_32x32x16_bf16 v[64:79], a[56:59], v[136:139], v[64:79]
  v_mfma_f32_32x32x16_bf16 v[80:95], a[216:219], v[136:139], v[80:95]
  ds_read_b128 v[136:139], v10 offset:18432
  s_waitcnt lgkmcnt(3)
  v_mfma_f32_32x32x16_bf16 v[64:79], a[60:63], v[140:143], v[64:79]
  v_mfma_f32_32x32x16_bf16 v[80:95], a[220:223], v[140:143], v[80:95]
  ds_read_b128 v[140:143], v10 offset:19456
  s_waitcnt lgkmcnt(3)
  v_mfma_f32_32x32x16_bf16 v[64:79], a[64:67], v[128:131], v[64:79]
  v_mfma_f32_32x32x16_bf16 v[80:95], a[224:227], v[128:131], v[80:95]
  ds_read_b128 v[128:131], v10 offset:20480
  s_waitcnt lgkmcnt(3)
  v_mfma_f32_32x32x16_bf16 v[64:79], a[68:71], v[132:135], v[64:79]
  v_mfma_f32_32x32x16_bf16 v[80:95], a[228:231], v[132:135], v[80:95]
  ds_read_b128 v[132:135], v10 offset:21504
  s_waitcnt lgkmcnt(3)
  v_mfma_f32_32x32x16_bf16 v[64:79], a[72:75], v[136:139], v[64:79]
  v_mfma_f32_32x32x16_bf16 v[80:95], a[232:235], v[136:139], v[80:95]
  ds_read_b128 v[136:139], v10 offset:22528
  s_waitcnt lgkmcnt(3)
  v_mfma_f32_32x32x16_bf16 v[64:79], a[76:79], v[140:143], v[64:79]
  v_mfma_f32_32x32x16_bf16 v[80:95], a[236:239], v[140:143], v[80:95]
  ds_read_b128 v[140:143], v10 offset:23552
  s_waitcnt lgkmcnt(3)
  v_mfma_f32_32x32x16_bf16 v[64:79], a[80:83], v[128:131], v[64:79]
  v_mfma_f32_32x32x16_bf16 v[80:95], a[240:243], v[128:131], v[80:95]
  ds_read_b128 v[128:131], v10 offset:24576
  s_waitcnt lgkmcnt(3)
  v_mfma_f32_32x32x16_bf16 v[64:79], a[84:87], v[132:135], v[64:79]
  v_mfma_f32_32x32x16_bf16 v[80:95], a[244:247], v[132:135], v[80:95]
  ds_read_b128 v[132:135], v10 offset:25600
  s_waitcnt lgkmcnt(3)
  v_mfma_f32_32x32x16_bf16 v[64:79], a[88:91], v[136:139], v[64:79]
  v_mfma_f32_32x32x16_bf16 v[80:95], a[248:251], v[136:139], v[80:95]
  ds_read_b128 v[136:139], v10 offset:26624
  s_waitcnt lgkmcnt(3)
  v_mfma_f32_32x32x16_bf16 v[64:79], a[92:95], v[140:143], v[64:79]
  v_mfma_f32_32x32x16_bf16 v[80:95], a[252:255], v[140:143], v[80:95]
  ds_read_b128 v[140:143], v10 offset:27648
  s_waitcnt vmcnt(10)
  s_barrier
  s_cmp_eq_u32 s21, 0
  s_cbranch_scc0 mp_50
  v_mov_b32 v13, s50
  s_mov_b64 s[24:25], exec
  s_mov_b64 exec, 1
  buffer_store_dword v13, v12, s[8:11], 0 offen sc1
  s_mov_b64 exec, s[24:25]
mp_50:
  s_waitcnt lgkmcnt(3)
  v_mfma_f32_32x32x16_bf16 v[64:79], a[96:99], v[128:131], v[64:79]
  v_mfma_f32_32x32x16_bf16 v[80:95], v[192:195], v[128:131], v[80:95]
  ds_read_b128 v[128:131], v10 offset:28672
  s_waitcnt lgkmcnt(3)
  v_mfma_f32_32x32x16_bf16 v[64:79], a[100:103], v[132:135], v[64:79]
  v_mfma_f32_32x32x16_bf16 v[80:95], v[196:199], v[132:135], v[80:95]
  ds_read_b128 v[132:135], v10 offset:29696
  s_waitcnt lgkmcnt(3)
  v_mfma_f32_32x32x16_bf16 v[64:79], a[104:107], v[136:139], v[64:79]
  v_mfma_f32_32x32x16_bf16 v[80:95], v[200:203], v[136:139], v[80:95]
  ds_read_b128 v[136:139], v10 offset:30720
  s_waitcnt lgkmcnt(3)
  v_mfma_f32_32x32x16_bf16 v[64:79], a[108:111], v[140:143], v[64:79]
  v_mfma_f32_32x32x16_bf16 v[80:95], v[204:207], v[140:143], v[80:95]
  ds_read_b128 v[140:143], v10 offset:31744
  s_waitcnt lgkmcnt(3)
  v_mfma_f32_32x32x16_bf16 v[64:79], a[112:115], v[128:131], v[64:79]
  v_mfma_f32_32x32x16_bf16 v[80:95], v[208:211], v[128:131], v[80:95]
  ds_read_b128 v[128:131], v10 offset:32768
  s_waitcnt lgkmcnt(3)
  v_mfma_f32_32x32x16_bf16 v[64:79], a[116:119], v[132:135], v[64:79]
  v_mfma_f32_32x32x16_bf16 v[80:95], v[212:215], v[132:135], v[80:95]
  ds_read_b128 v[132:135], v10 offset:33792
  s_waitcnt lgkmcnt(3)
  v_mfma_f32_32x32x16_bf16 v[64:79], a[120:123], v[136:139], v[64:79]
  v_mfma_f32_32x32x16_bf16 v[80:95], v[216:219], v[136:139], v[80:95]
  ds_read_b128 v[136:139], v10 offset:34816
  s_waitcnt lgkmcnt(3)
  v_mfma_f32_32x32x16_bf16 v[64:79], a[124:127], v[140:143], v[64:79]
  v_mfma_f32_32x32x16_bf16 v[80:95], v[220:223], v[140:143], v[80:95]
  ds_read_b128 v[140:143], v10 offset:35840
  s_waitcnt lgkmcnt(3)
  v_mfma_f32_32x32x16_bf16 v[64:79], a[128:131], v[128:131], v[64:79]
  v_mfma_f32_32x32x16_bf16 v[80:95], v[224:227], v[128:131], v[80:95]
  ds_read_b128 v[128:131], v10 offset:36864
  s_waitcnt lgkmcnt(3)
  v_mfma_f32_32x32x16_bf16 v[64:79], a[132:135], v[132:135], v[64:79]
  v_mfma_f32_32x32x16_bf16 v[80:95], v[228:231], v[132:135], v[80:95]
  ds_read_b128 v[132:135], v10 offset:37888
  s_waitcnt lgkmcnt(3)
  v_mfma_f32_32x32x16_bf16 v[64:79], a[136:139], v[136:139], v[64:79]
  v_mfma_f32_32x32x16_bf16 v[80:95], v[232:235], v[136:139], v[80:95]
  ds_read_b128 v[136:139], v10 offset:38912
  s_waitcnt lgkmcnt(3)
  v_mfma_f32_32x32x16_bf16 v[64:79], a[140:143], v[140:143], v[64:79]
  v_mfma_f32_32x32x16_bf16 v[80:95], v[236:239], v[140:143], v[80:95]
  ds_read_b128 v[140:143], v10 offset:39936
  s_waitcnt lgkmcnt(3)
  v_mfma_f32_32x32x16_bf16 v[64:79], a[144:147], v[128:131], v[64:79]
  v_mfma_f32_32x32x16_bf16 v[80:95], v[240:243], v[128:131], v[80:95]
  s_waitcnt lgkmcnt(2)
  v_mfma_f32_32x32x16_bf16 v[64:79], a[148:151], v[132:135], v[64:79]
  v_mfma_f32_32x32x16_bf16 v[80:95], v[244:247], v[132:135], v[80:95]
  s_waitcnt lgkmcnt(1)
  v_mfma_f32_32x32x16_bf16 v[64:79], a[152:155], v[136:139], v[64:79]
  v_mfma_f32_32x32x16_bf16 v[80:95], v[248:251], v[136:139], v[80:95]
  s_waitcnt lgkmcnt(0)
  v_mfma_f32_32x32x16_bf16 v[64:79], a[156:159], v[140:143], v[64:79]
  v_mfma_f32_32x32x16_bf16 v[80:95], v[252:255], v[140:143], v[80:95]
  s_nop 11
  v_cvt_pk_bf16_f32 v144, v64, v65
  v_cvt_pk_bf16_f32 v145, v66, v67
  v_cvt_pk_bf16_f32 v146, v68, v69
  v_cvt_pk_bf16_f32 v147, v70, v71
  v_cvt_pk_bf16_f32 v148, v72, v73
  v_cvt_pk_bf16_f32 v149, v74, v75
  v_cvt_pk_bf16_f32 v150, v76, v77
  v_cvt_pk_bf16_f32 v151, v78, v79
  v_cvt_pk_bf16_f32 v152, v80, v81
  v_cvt_pk_bf16_f32 v153, v82, v83
  v_cvt_pk_bf16_f32 v154, v84, v85
  v_cvt_pk_bf16_f32 v155, v86, v87
  v_cvt_pk_bf16_f32 v156, v88, v89
  v_cvt_pk_bf16_f32 v157, v90, v91
  v_cvt_pk_bf16_f32 v158, v92, v93
  v_cvt_pk_bf16_f32 v159, v94, v95
  s_mul_i32 s28, s50, 12288
  s_add_u32 s29, s28, s48
  buffer_store_dwordx4 v[144:147], v11, s[8:11], s29 offen offset:0 sc1
  buffer_store_dwordx4 v[148:151], v11, s[8:11], s29 offen offset:256 sc1
  s_add_u32 s29, s28, s49
  buffer_store_dwordx4 v[152:155], v11, s[8:11], s29 offen offset:0 sc1
  buffer_store_dwordx4 v[156:159], v11, s[8:11], s29 offen offset:256 sc1
  s_add_u32 s50, s50, 1
  s_cmp_lt_u32 s50, 64
  s_cbranch_scc1 ka_qkv_loop
  s_waitcnt vmcnt(0)
  s_barrier
  s_cmp_eq_u32 s21, 0
  s_cbranch_scc0 ka_exit
  v_mov_b32 v13, 64
  s_mov_b64 exec, 1
  buffer_store_dword v13, v12, s[8:11], 0 offen sc1
  s_waitcnt vmcnt(0)
  s_branch ka_exit
ka_u:
  s_mov_b32 s12, s42
  s_and_b32 s13, s43, 0xffff
  s_mov_b32 s14, 0x780000
  s_mov_b32 s15, 0x20000
  v_and_b32 v1, 63, v0
  v_lshrrev_b32 v2, 4, v1
  v_bfe_u32 v3, v1, 2, 2
  v_and_b32 v4, 3, v1
  s_lshl_b32 s28, s21, 3
  v_add_u32 v5, s28, v3
  v_mul_u32_u24 v5, 1280, v5
  v_lshlrev_b32 v6, 6, v2
  v_add_u32 v5, v5, v6
  v_lshlrev_b32 v6, 4, v4
  v_add_u32 v5, v5, v6
  v_lshrrev_b32 v6, 1, v2
  v_mul_u32_u24 v7, 20480, v6
  v_lshlrev_b32 v6, 6, v3
  v_add_u32 v7, v7, v6
  v_and_b32 v6, 1, v2
  v_lshlrev_b32 v6, 5, v6
  v_add_u32 v7, v7, v6
  v_lshrrev_b32 v6, 1, v4
  v_lshlrev_b32 v6, 4, v6
  v_add_u32 v7, v7, v6
  v_and_b32 v6, 1, v4
  v_lshlrev_b32 v6, 3, v6
  v_add_u32 v7, v7, v6
  s_mul_i32 s28, s21, 1280
  v_add_u32 v7, s28, v7
  s_mul_i32 s46, s23, 245760
  s_mul_i32 s29, s21, 10240
  s_add_u32 m0, s29, 0
  s_add_u32 s28, s46, 0
  buffer_load_dwordx4 v5, s[12:15], s28 offen lds
  s_mul_i32 s29, s21, 10240
  s_add_u32 m0, s29, 1024
  s_add_u32 s28, s46, 256
  buffer_load_dwordx4 v5, s[12:15], s28 offen lds
  s_mul_i32 s29, s21, 10240
  s_add_u32 m0, s29, 2048
  s_add_u32 s28, s46, 512
  buffer_load_dwordx4 v5, s[12:15], s28 offen lds
  s_mul_i32 s29, s21, 10240
  s_add_u32 m0, s29, 3072
  s_add_u32 s28, s46, 768
  buffer_load_dwordx4 v5, s[12:15], s28 offen lds
  s_mul_i32 s29, s21, 10240
  s_add_u32 m0, s29, 4096
  s_add_u32 s28, s46, 1024
  buffer_load_dwordx4 v5, s[12:15], s28 offen lds
  s_mul_i32 s29, s21, 10240
  s_add_u32 m0, s29, 5120
  s_add_u32 s28, s46, 5120
  buffer_load_dwordx4 v5, s[12:15], s28 offen lds
  s_mul_i32 s29, s21, 10240
  s_add_u32 m0, s29, 6144
  s_add_u32 s28, s46, 5376
  buffer_load_dwordx4 v5, s[12:15], s28 offen lds
  s_mul_i32 s29, s21, 10240
  s_add_u32 m0, s29, 7168
  s_add_u32 s28, s46, 5632
  buffer_load_dwordx4 v5, s[12:15], s28 offen lds
  s_mul_i32 s29, s21, 10240
  s_add_u32 m0, s29, 8192
  s_add_u32 s28, s46, 5888
  buffer_load_dwordx4 v5, s[12:15], s28 offen lds
  s_mul_i32 s29, s21, 10240
  s_add_u32 m0, s29, 9216
  s_add_u32 s28, s46, 6144
  buffer_load_dwordx4 v5, s[12:15], s28 offen lds
  s_mul_i32 s29, s21, 10240
  s_add_u32 m0, s29, 40960
  s_add_u32 s28, s46, 40960
  buffer_load_dwordx4 v5, s[12:15], s28 offen lds
  s_mul_i32 s29, s21, 10240
  s_add_u32 m0, s29, 41984
  s_add_u32 s28, s46, 41216
  buffer_load_dwordx4 v5, s[12:15], s28 offen lds
  s_mul_i32 s29, s21, 10240
  s_add_u32 m0, s29, 43008
  s_add_u32 s28, s46, 41472
  buffer_load_dwordx4 v5, s[12:15], s28 offen lds
  s_mul_i32 s29, s21, 10240
  s_add_u32 m0, s29, 44032
  s_add_u32 s28, s46, 41728
  buffer_load_dwordx4 v5, s[12:15], s28 offen lds
  s_mul_i32 s29, s21, 10240
  s_add_u32 m0, s29, 45056
  s_add_u32 s28, s46, 41984
  buffer_load_dwordx4 v5, s[12:15], s28 offen lds
  s_mul_i32 s29, s21, 10240
  s_add_u32 m0, s29, 46080
  s_add_u32 s28, s46, 46080
  buffer_load_dwordx4 v5, s[12:15], s28 offen lds
  s_mul_i32 s29, s21, 10240
  s_add_u32 m0, s29, 47104
  s_add_u32 s28, s46, 46336
  buffer_load_dwordx4 v5, s[12:15], s28 offen lds
  s_mul_i32 s29, s21, 10240
  s_add_u32 m0, s29, 48128
  s_add_u32 s28, s46, 46592
  buffer_load_dwordx4 v5, s[12:15], s28 offen lds
  s_mul_i32 s29, s21, 10240
  s_add_u32 m0, s29, 49152
  s_add_u32 s28, s46, 46848
  buffer_load_dwordx4 v5, s[12:15], s28 offen lds
  s_mul_i32 s29, s21, 10240
  s_add_u32 m0, s29, 50176
  s_add_u32 s28, s46, 47104
  buffer_load_dwordx4 v5, s[12:15], s28 offen lds
  s_waitcnt vmcnt(10)
  s_barrier
  s_mul_i32 s29, s21, 10240
  s_add_u32 m0, s29, 81920
  s_add_u32 s28, s46, 81920
  buffer_load_dwordx4 v5, s[12:15], s28 offen lds
  s_mul_i32 s29, s21, 10240
  s_add_u32 m0, s29, 82944
  s_add_u32 s28, s46, 82176
  buffer_load_dwordx4 v5, s[12:15], s28 offen lds
  s_mul_i32 s29, s21, 10240
  s_add_u32 m0, s29, 83968
  s_add_u32 s28, s46, 82432
  buffer_load_dwordx4 v5, s[12:15], s28 offen lds
  s_mul_i32 s29, s21, 10240
  s_add_u32 m0, s29, 84992
  s_add_u32 s28, s46, 82688
  buffer_load_dwordx4 v5, s[12:15], s28 offen lds
  s_mul_i32 s29, s21, 10240
  s_add_u32 m0, s29, 86016
  s_add_u32 s28, s46, 82944
  buffer_load_dwordx4 v5, s[12:15], s28 offen lds
  s_mul_i32 s29, s21, 10240
  s_add_u32 m0, s29, 87040
  s_add_u32 s28, s46, 87040
  buffer_load_dwordx4 v5, s[12:15], s28 offen lds
  s_mul_i32 s29, s21, 10240
  s_add_u32 m0, s29, 88064
  s_add_u32 s28, s46, 87296
  buffer_load_dwordx4 v5, s[12:15], s28 offen lds
  s_mul_i32 s29, s21, 10240
  s_add_u32 m0, s29, 89088
  s_add_u32 s28, s46, 87552
  buffer_load_dwordx4 v5, s[12:15], s28 offen lds
  s_mul_i32 s29, s21, 10240
  s_add_u32 m0, s29, 90112
  s_add_u32 s28, s46, 87808
  buffer_load_dwordx4 v5, s[12:15], s28 offen lds
  s_mul_i32 s29, s21, 10240
  s_add_u32 m0, s29, 91136
  s_add_u32 s28, s46, 88064
  buffer_load_dwordx4 v5, s[12:15], s28 offen lds
  v_add_u32 v8, 0, v7
  ds_read_b64_tr_b16 a[0:1], v8 offset:0
  ds_read_b64_tr_b16 a[2:3], v8 offset:10240
  ds_read_b64_tr_b16 a[4:5], v8 offset:5120
  ds_read_b64_tr_b16 a[6:7], v8 offset:15360
  ds_read_b64_tr_b16 a[48:49], v8 offset:256
  ds_read_b64_tr_b16 a[50:51], v8 offset:10496
  ds_read_b64_tr_b16 a[52:53], v8 offset:5376
  ds_read_b64_tr_b16 a[54:55], v8 offset:15616
  ds_read_b64_tr_b16 a[96:97], v8 offset:512
  ds_read_b64_tr_b16 a[98:99], v8 offset:10752
  ds_read_b64_tr_b16 a[100:101], v8 offset:5632
  ds_read_b64_tr_b16 a[102:103], v8 offset:15872
  s_waitcnt lgkmcnt(0)
  ds_read_b64_tr_b16 a[144:145], v8 offset:768
  ds_read_b64_tr_b16 a[146:147], v8 offset:11008
  ds_read_b64_tr_b16 a[148:149], v8 offset:5888
  ds_read_b64_tr_b16 a[150:151], v8 offset:16128
  ds_read_b64_tr_b16 a[192:193], v8 offset:1024
  ds_read_b64_tr_b16 a[194:195], v8 offset:11264
  ds_read_b64_tr_b16 a[196:197], v8 offset:6144
  ds_read_b64_tr_b16 a[198:199], v8 offset:16384
  s_waitcnt lgkmcnt(0)
  s_waitcnt vmcnt(10)
  s_barrier
  s_mul_i32 s29, s21, 10240
  s_add_u32 m0, s29, 0
  s_add_u32 s28, s46, 122880
  buffer_load_dwordx4 v5, s[12:15], s28 offen lds
  s_mul_i32 s29, s21, 10240
  s_add_u32 m0, s29, 1024
  s_add_u32 s28, s46, 123136
  buffer_load_dwordx4 v5, s[12:15], s28 offen lds
  s_mul_i32 s29, s21, 10240
  s_add_u32 m0, s29, 2048
  s_add_u32 s28, s46, 123392
  buffer_load_dwordx4 v5, s[12:15], s28 offen lds
  s_mul_i32 s29, s21, 10240
  s_add_u32 m0, s29, 3072
  s_add_u32 s28, s46, 123648
  buffer_load_dwordx4 v5, s[12:15], s28 offen lds
  s_mul_i32 s29, s21, 10240
  s_add_u32 m0, s29, 4096
  s_add_u32 s28, s46, 123904
  buffer_load_dwordx4 v5, s[12:15], s28 offen lds
  s_mul_i32 s29, s21, 10240
  s_add_u32 m0, s29, 5120
  s_add_u32 s28, s46, 128000
  buffer_load_dwordx4 v5, s[12:15], s28 offen lds
  s_mul_i32 s29, s21, 10240
  s_add_u32 m0, s29, 6144
  s_add_u32 s28, s46, 128256
  buffer_load_dwordx4 v5, s[12:15], s28 offen lds
  s_mul_i32 s29, s21, 10240
  s_add_u32 m0, s29, 7168
  s_add_u32 s28, s46, 128512
  buffer_load_dwordx4 v5, s[12:15], s28 offen lds
  s_mul_i32 s29, s21, 10240
  s_add_u32 m0, s29, 8192
  s_add_u32 s28, s46, 128768
  buffer_load_dwordx4 v5, s[12:15], s28 offen lds
  s_mul_i32 s29, s21, 10240
  s_add_u32 m0, s29, 9216
  s_add_u32 s28, s46, 129024
  buffer_load_dwordx4 v5, s[12:15], s28 offen lds
  v_add_u32 v8, 40960, v7
  ds_read_b64_tr_b16 a[8:9], v8 offset:0
  ds_read_b64_tr_b16 a[10:11], v8 offset:10240
  ds_read_b64_tr_b16 a[12:13], v8 offset:5120
  ds_read_b64_tr_b16 a[14:15], v8 offset:15360
  ds_read_b64_tr_b16 a[56:57], v8 offset:256
  ds_read_b64_tr_b16 a[58:59], v8 offset:10496
  ds_read_b64_tr_b16 a[60:61], v8 offset:5376
  ds_read_b64_tr_b16 a[62:63], v8 offset:15616
  ds_read_b64_tr_b16 a[104:105], v8 offset:512
  ds_read_b64_tr_b16 a[106:107], v8 offset:10752
  ds_read_b64_tr_b16 a[108:109], v8 offset:5632
  ds_read_b64_tr_b16 a[110:111], v8 offset:15872
  s_waitcnt lgkmcnt(0)
  ds_read_b64_tr_b16 a[152:153], v8 offset:768
  ds_read_b64_tr_b16 a[154:155], v8 offset:11008
  ds_read_b64_tr_b16 a[156:157], v8 offset:5888
  ds_read_b64_tr_b16 a[158:159], v8 offset:16128
  ds_read_b64_tr_b16 a[200:201], v8 offset:1024
  ds_read_b64_tr_b16 a[202:203], v8 offset:11264
  ds_read_b64_tr_b16 a[204:205], v8 offset:6144
  ds_read_b64_tr_b16 a[206:207], v8 offset:16384
  s_waitcnt lgkmcnt(0)
  s_waitcnt vmcnt(10)
  s_barrier
  s_mul_i32 s29, s21, 10240
  s_add_u32 m0, s29, 40960
  s_add_u32 s28, s46, 163840
  buffer_load_dwordx4 v5, s[12:15], s28 offen lds
  s_mul_i32 s29, s21, 10240
  s_add_u32 m0, s29, 41984
  s_add_u32 s28, s46, 164096
  buffer_load_dwordx4 v5, s[12:15], s28 offen lds
  s_mul_i32 s29, s21, 10240
  s_add_u32 m0, s29, 43008
  s_add_u32 s28, s46, 164352
  buffer_load_dwordx4 v5, s[12:15], s28 offen lds
  s_mul_i32 s29, s21, 10240
  s_add_u32 m0, s29, 44032
  s_add_u32 s28, s46, 164608
  buffer_load_dwordx4 v5, s[12:15], s28 offen lds
  s_mul_i32 s29, s21, 10240
  s_add_u32 m0, s29, 45056
  s_add_u32 s28, s46, 164864
  buffer_load_dwordx4 v5, s[12:15], s28 offen lds
  s_mul_i32 s29, s21, 10240
  s_add_u32 m0, s29, 46080
  s_add_u32 s28, s46, 168960
  buffer_load_dwordx4 v5, s[12:15], s28 offen lds
  s_mul_i32 s29, s21, 10240
  s_add_u32 m0, s29, 47104
  s_add_u32 s28, s46, 169216
  buffer_load_dwordx4 v5, s[12:15], s28 offen lds
  s_mul_i32 s29, s21, 10240
  s_add_u32 m0, s29, 48128
  s_add_u32 s28, s46, 169472
  buffer_load_dwordx4 v5, s[12:15], s28 offen lds
  s_mul_i32 s29, s21, 10240
  s_add_u32 m0, s29, 49152
  s_add_u32 s28, s46, 169728
  buffer_load_dwordx4 v5, s[12:15], s28 offen lds
  s_mul_i32 s29, s21, 10240
  s_add_u32 m0, s29, 50176
  s_add_u32 s28, s46, 169984
  buffer_load_dwordx4 v5, s[12:15], s28 offen lds
  v_add_u32 v8, 81920, v7
  ds_read_b64_tr_b16 a[16:17], v8 offset:0
  ds_read_b64_tr_b16 a[18:19], v8 offset:10240
  ds_read_b64_tr_b16 a[20:21], v8 offset:5120
  ds_read_b64_tr_b16 a[22:23], v8 offset:15360
  ds_read_b64_tr_b16 a[64:65], v8 offset:256
  ds_read_b64_tr_b16 a[66:67], v8 offset:10496
  ds_read_b64_tr_b16 a[68:69], v8 offset:5376
  ds_read_b64_tr_b16 a[70:71], v8 offset:15616
  ds_read_b64_tr_b16 a[112:113], v8 offset:512
  ds_read_b64_tr_b16 a[114:115], v8 offset:10752
  ds_read_b64_tr_b16 a[116:117], v8 offset:5632
  ds_read_b64_tr_b16 a[118:119], v8 offset:15872
  s_waitcnt lgkmcnt(0)
  ds_read_b64_tr_b16 a[160:161], v8 offset:768
  ds_read_b64_tr_b16 a[162:163], v8 offset:11008
  ds_read_b64_tr_b16 a[164:165], v8 offset:5888
  ds_read_b64_tr_b16 a[166:167], v8 offset:16128
  ds_read_b64_tr_b16 a[208:209], v8 offset:1024
  ds_read_b64_tr_b16 a[210:211], v8 offset:11264
  ds_read_b64_tr_b16 a[212:213], v8 offset:6144
  ds_read_b64_tr_b16 a[214:215], v8 offset:16384
  s_waitcnt lgkmcnt(0)
  s_waitcnt vmcnt(10)
  s_barrier
  s_mul_i32 s29, s21, 10240
  s_add_u32 m0, s29, 81920
  s_add_u32 s28, s46, 204800
  buffer_load_dwordx4 v5, s[12:15], s28 offen lds
  s_mul_i32 s29, s21, 10240
  s_add_u32 m0, s29, 82944
  s_add_u32 s28, s46, 205056
  buffer_load_dwordx4 v5, s[12:15], s28 offen lds
  s_mul_i32 s29, s21, 10240
  s_add_u32 m0, s29, 83968
  s_add_u32 s28, s46, 205312
  buffer_load_dwordx4 v5, s[12:15], s28 offen lds
  s_mul_i32 s29, s21, 10240
  s_add_u32 m0, s29, 84992
  s_add_u32 s28, s46, 205568
  buffer_load_dwordx4 v5, s[12:15], s28 offen lds
  s_mul_i32 s29, s21, 10240
  s_add_u32 m0, s29, 86016
  s_add_u32 s28, s46, 205824
  buffer_load_dwordx4 v5, s[12:15], s28 offen lds
  s_mul_i32 s29, s21, 10240
  s_add_u32 m0, s29, 87040
  s_add_u32 s28, s46, 209920
  buffer_load_dwordx4 v5, s[12:15], s28 offen lds
  s_mul_i32 s29, s21, 10240
  s_add_u32 m0, s29, 88064
  s_add_u32 s28, s46, 210176
  buffer_load_dwordx4 v5, s[12:15], s28 offen lds
  s_mul_i32 s29, s21, 10240
  s_add_u32 m0, s29, 89088
  s_add_u32 s28, s46, 210432
  buffer_load_dwordx4 v5, s[12:15], s28 offen lds
  s_mul_i32 s29, s21, 10240
  s_add_u32 m0, s29, 90112
  s_add_u32 s28, s46, 210688
  buffer_load_dwordx4 v5, s[12:15], s28 offen lds
  s_mul_i32 s29, s21, 10240
  s_add_u32 m0, s29, 91136
  s_add_u32 s28, s46, 210944
  buffer_load_dwordx4 v5, s[12:15], s28 offen lds
  v_add_u32 v8, 0, v7
  ds_read_b64_tr_b16 a[24:25], v8 offset:0
  ds_read_b64_tr_b16 a[26:27], v8 offset:10240
  ds_read_b64_tr_b16 a[28:29], v8 offset:5120
  ds_read_b64_tr_b16 a[30:31], v8 offset:15360
  ds_read_b64_tr_b16 a[72:73], v8 offset:256
  ds_read_b64_tr_b16 a[74:75], v8 offset:10496
  ds_read_b64_tr_b16 a[76:77], v8 offset:5376
  ds_read_b64_tr_b16 a[78:79], v8 offset:15616
  ds_read_b64_tr_b16 a[120:121], v8 offset:512
  ds_read_b64_tr_b16 a[122:123], v8 offset:10752
  ds_read_b64_tr_b16 a[124:125], v8 offset:5632
  ds_read_b64_tr_b16 a[126:127], v8 offset:15872
  s_waitcnt lgkmcnt(0)
  ds_read_b64_tr_b16 a[168:169], v8 offset:768
  ds_read_b64_tr_b16 a[170:171], v8 offset:11008
  ds_read_b64_tr_b16 a[172:173], v8 offset:5888
  ds_read_b64_tr_b16 a[174:175], v8 offset:16128
  ds_read_b64_tr_b16 a[216:217], v8 offset:1024
  ds_read_b64_tr_b16 a[218:219], v8 offset:11264
  ds_read_b64_tr_b16 a[220:221], v8 offset:6144
  ds_read_b64_tr_b16 a[222:223], v8 offset:16384
  s_waitcnt lgkmcnt(0)
  s_waitcnt vmcnt(10)
  s_barrier
  v_add_u32 v8, 40960, v7
  ds_read_b64_tr_b16 a[32:33], v8 offset:0
  ds_read_b64_tr_b16 a[34:35], v8 offset:10240
  ds_read_b64_tr_b16 a[36:37], v8 offset:5120
  ds_read_b64_tr_b16 a[38:39], v8 offset:15360
  ds_read_b64_tr_b16 a[80:81], v8 offset:256
  ds_read_b64_tr_b16 a[82:83], v8 offset:10496
  ds_read_b64_tr_b16 a[84:85], v8 offset:5376
  ds_read_b64_tr_b16 a[86:87], v8 offset:15616
  ds_read_b64_tr_b16 a[128:129], v8 offset:512
  ds_read_b64_tr_b16 a[130:131], v8 offset:10752
  ds_read_b64_tr_b16 a[132:133], v8 offset:5632
  ds_read_b64_tr_b16 a[134:135], v8 offset:15872
  s_waitcnt lgkmcnt(0)
  ds_read_b64_tr_b16 a[176:177], v8 offset:768
  ds_read_b64_tr_b16 a[178:179], v8 offset:11008
  ds_read_b64_tr_b16 a[180:181], v8 offset:5888
  ds_read_b64_tr_b16 a[182:183], v8 offset:16128
  ds_read_b64_tr_b16 a[224:225], v8 offset:1024
  ds_read_b64_tr_b16 a[226:227], v8 offset:11264
  ds_read_b64_tr_b16 a[228:229], v8 offset:6144
  ds_read_b64_tr_b16 a[230:231], v8 offset:16384
  s_waitcnt lgkmcnt(0)
  s_waitcnt vmcnt(0)
  s_barrier
  v_add_u32 v8, 81920, v7
  ds_read_b64_tr_b16 a[40:41], v8 offset:0
  ds_read_b64_tr_b16 a[42:43], v8 offset:10240
  ds_read_b64_tr_b16 a[44:45], v8 offset:5120
  ds_read_b64_tr_b16 a[46:47], v8 offset:15360
  ds_read_b64_tr_b16 a[88:89], v8 offset:256
  ds_read_b64_tr_b16 a[90:91], v8 offset:10496
  ds_read_b64_tr_b16 a[92:93], v8 offset:5376
  ds_read_b64_tr_b16 a[94:95], v8 offset:15616
  ds_read_b64_tr_b16 a[136:137], v8 offset:512
  ds_read_b64_tr_b16 a[138:139], v8 offset:10752
  ds_read_b64_tr_b16 a[140:141], v8 offset:5632
  ds_read_b64_tr_b16 a[142:143], v8 offset:15872
  s_waitcnt lgkmcnt(0)
  ds_read_b64_tr_b16 a[184:185], v8 offset:768
  ds_read_b64_tr_b16 a[186:187], v8 offset:11008
  ds_read_b64_tr_b16 a[188:189], v8 offset:5888
  ds_read_b64_tr_b16 a[190:191], v8 offset:16128
  ds_read_b64_tr_b16 a[232:233], v8 offset:1024
  ds_read_b64_tr_b16 a[234:235], v8 offset:11264
  ds_read_b64_tr_b16 a[236:237], v8 offset:6144
  ds_read_b64_tr_b16 a[238:239], v8 offset:16384
  s_waitcnt lgkmcnt(0)
  s_barrier
  v_lshlrev_b32 v5, 4, v1
  s_lshl_b32 s28, s21, 10
  v_add_u32 v6, s28, v5
  v_bfe_u32 v2, v1, 4, 1
  v_lshlrev_b32 v9, 10, v2
  v_and_b32 v2, 15, v1
  v_lshlrev_b32 v2, 4, v2
  v_add_u32 v9, v9, v2
  v_lshrrev_b32 v3, 5, v1
  v_lshlrev_b32 v3, 8, v3
  v_add_u32 v9, v9, v3
  v_add_u32 v10, 12288, v9
  v_bfe_u32 v3, v1, 4, 1
  v_lshlrev_b32 v11, 10, v3
  v_add_u32 v11, v11, v2
  v_lshrrev_b32 v3, 5, v1
  v_lshlrev_b32 v3, 9, v3
  v_add_u32 v11, v11, v3
  s_mul_i32 s28, s23, 6
  s_lshr_b32 s29, s28, 3
  s_add_u32 s28, s28, 5
  s_lshr_b32 s28, s28, 3
  v_and_b32 v2, 1, v1
  v_mov_b32 v12, s29
  v_mov_b32 v13, s28
  v_cmp_eq_u32 vcc, 1, v2
  s_nop 1
  v_cndmask_b32 v12, v12, v13, vcc
  v_lshlrev_b32 v12, 2, v12
  v_add_u32 v12, 2048, v12
  s_lshl_b32 s28, s23, 2
  s_add_u32 s28, s28, 3072
  v_mov_b32 v14, s28
  s_mul_i32 s47, s23, 786432
  s_add_u32 s47, s47, 0x7800000
  s_mul_i32 s48, s23, 40960
  s_mul_i32 s28, s21, 10240
  s_add_u32 s48, s48, s28
  s_add_u32 s48, s48, 0x9000000
  s_mov_b32 s50, 0
  s_mov_b32 s52, 0
  s_mov_b32 s54, 0
  s_mov_b32 s53, 0
  s_cmp_gt_u32 s52, s53
  s_cbranch_scc1 ka_wp_51_ok
  s_mov_b32 s45, 0
ka_wp_51_spin:
  buffer_load_dword v2, v12, s[8:11], 0 offen sc1
  s_add_u32 s45, s45, 1
  s_waitcnt vmcnt(0)
  v_min_u32_dpp v3, v2, v2 quad_perm:[1,0,3,2] row_mask:0xf bank_mask:0xf
  s_nop 1
  v_min_u32_dpp v2, v3, v3 quad_perm:[2,3,0,1] row_mask:0xf bank_mask:0xf
  s_nop 1
  v_min_u32_dpp v3, v2, v2 row_half_mirror row_mask:0xf bank_mask:0xf
  s_nop 1
  v_min_u32_dpp v2, v3, v3 quad_perm:[0,1,2,3] row_mask:0xf bank_mask:0xf
  s_nop 0
  v_readfirstlane_b32 s52, v2
  s_cmp_gt_u32 s52, s53
  s_cbranch_scc1 ka_wp_51_ok
  s_cmp_lt_u32 s45, 400000
  s_cbranch_scc1 ka_wp_51_spin
  s_branch ka_abort
ka_wp_51_ok:
  s_lshl_b32 s29, s21, 10
  s_add_u32 m0, s29, 0
  s_add_u32 s28, s47, 0
  buffer_load_dwordx4 v6, s[8:11], s28 offen sc1 lds
  s_lshl_b32 s29, s21, 10
  s_add_u32 m0, s29, 4096
  s_add_u32 s28, s47, 4096
  buffer_load_dwordx4 v6, s[8:11], s28 offen sc1 lds
  s_lshl_b32 s29, s21, 10
  s_add_u32 m0, s29, 8192
  s_add_u32 s28, s47, 8192
  buffer_load_dwordx4 v6, s[8:11], s28 offen sc1 lds
  s_add_u32 s47, s47, 12288
ka_u_loop:
  s_cmp_eq_u32 s50, 0
  s_cbranch_scc0 u0_52
  s_waitcnt vmcnt(0)
u0_52:
  s_waitcnt vmcnt(10)
  s_cmp_eq_u32 s54, 0
  s_cbranch_scc1 ud_53
  s_waitcnt vmcnt(0)
ud_53:
  s_barrier
  ds_read_b128 v[16:19], v9 offset:0
  ds_read_b128 v[20:23], v9 offset:512
  ds_read_b128 v[24:27], v9 offset:2048
  ds_read_b128 v[28:31], v9 offset:2560
  ds_read_b128 v[32:35], v9 offset:4096
  ds_read_b128 v[36:39], v9 offset:4608
  ds_read_b128 v[40:43], v9 offset:6144
  ds_read_b128 v[44:47], v9 offset:6656
  ds_read_b128 v[48:51], v9 offset:8192
  ds_read_b128 v[52:55], v9 offset:8704
  ds_read_b128 v[56:59], v9 offset:10240
  ds_read_b128 v[60:63], v9 offset:10752
  s_mov_b32 s54, 0
  s_cmp_ge_u32 s50, 63
  s_cbranch_scc1 un_54_n
  s_add_u32 s53, s50, 1
  s_cmp_gt_u32 s52, s53
  s_cbranch_scc1 un_54_go
  buffer_load_dword v2, v12, s[8:11], 0 offen sc1
  s_waitcnt vmcnt(0)
  v_min_u32_dpp v3, v2, v2 quad_perm:[1,0,3,2] row_mask:0xf bank_mask:0xf
  s_nop 0
  v_readfirstlane_b32 s52, v3
  s_cmp_gt_u32 s52, s53
  s_cbranch_scc1 un_54_go2
  s_mov_b32 s54, 1
  s_branch un_54
un_54_go2:
un_54_go:
  s_lshl_b32 s29, s21, 10
  s_add_u32 m0, s29, 12288
  s_add_u32 s28, s47, 0
  buffer_load_dwordx4 v6, s[8:11], s28 offen sc1 lds
  s_lshl_b32 s29, s21, 10
  s_add_u32 m0, s29, 16384
  s_add_u32 s28, s47, 4096
  buffer_load_dwordx4 v6, s[8:11], s28 offen sc1 lds
  s_lshl_b32 s29, s21, 10
  s_add_u32 m0, s29, 20480
  s_add_u32 s28, s47, 8192
  buffer_load_dwordx4 v6, s[8:11], s28 offen sc1 lds
  s_add_u32 s47, s47, 12288
  s_branch un_54
un_54_n:
  s_waitcnt vmcnt(0)
un_54:
  s_mul_i32 s30, s50, 1310720
  s_add_u32 s30, s30, s48
  s_waitcnt lgkmcnt(11)
  v_mfma_f32_32x32x16_bf16 v[64:79], v[16:19], a[0:3], 0
  s_waitcnt lgkmcnt(10)
  v_mfma_f32_32x32x16_bf16 v[64:79], v[20:23], a[4:7], v[64:79]
  s_waitcnt lgkmcnt(9)
  v_mfma_f32_32x32x16_bf16 v[64:79], v[24:27], a[8:11], v[64:79]
  s_waitcnt lgkmcnt(8)
  v_mfma_f32_32x32x16_bf16 v[64:79], v[28:31], a[12:15], v[64:79]
  s_waitcnt lgkmcnt(7)
  v_mfma_f32_32x32x16_bf16 v[64:79], v[32:35], a[16:19], v[64:79]
  s_waitcnt lgkmcnt(6)
  v_mfma_f32_32x32x16_bf16 v[64:79], v[36:39], a[20:23], v[64:79]
  s_waitcnt lgkmcnt(5)
  v_mfma_f32_32x32x16_bf16 v[64:79], v[40:43], a[24:27], v[64:79]
  s_waitcnt lgkmcnt(4)
  v_mfma_f32_32x32x16_bf16 v[64:79], v[44:47], a[28:31], v[64:79]
  s_waitcnt lgkmcnt(3)
  v_mfma_f32_32x32x16_bf16 v[64:79], v[48:51], a[32:35], v[64:79]
  s_waitcnt lgkmcnt(2)
  v_mfma_f32_32x32x16_bf16 v[64:79], v[52:55], a[36:39], v[64:79]
  s_waitcnt lgkmcnt(1)
  v_mfma_f32_32x32x16_bf16 v[64:79], v[56:59], a[40:43], v[64:79]
  s_waitcnt lgkmcnt(0)
  v_mfma_f32_32x32x16_bf16 v[64:79], v[60:63], a[44:47], v[64:79]
  v_mfma_f32_32x32x16_bf16 v[80:95], v[16:19], a[48:51], 0
  v_mfma_f32_32x32x16_bf16 v[80:95], v[20:23], a[52:55], v[80:95]
  v_mfma_f32_32x32x16_bf16 v[80:95], v[24:27], a[56:59], v[80:95]
  v_cvt_pk_bf16_f32 v96, v64, v65
  v_cvt_pk_bf16_f32 v97, v66, v67
  v_mfma_f32_32x32x16_bf16 v[80:95], v[28:31], a[60:63], v[80:95]
  v_cvt_pk_bf16_f32 v98, v68, v69
  v_cvt_pk_bf16_f32 v99, v70, v71
  v_mfma_f32_32x32x16_bf16 v[80:95], v[32:35], a[64:67], v[80:95]
  v_cvt_pk_bf16_f32 v100, v72, v73
  v_cvt_pk_bf16_f32 v101, v74, v75
  v_mfma_f32_32x32x16_bf16 v[80:95], v[36:39], a[68:71], v[80:95]
  v_cvt_pk_bf16_f32 v102, v76, v77
  v_cvt_pk_bf16_f32 v103, v78, v79
  v_mfma_f32_32x32x16_bf16 v[80:95], v[40:43], a[72:75], v[80:95]
  s_add_u32 s29, s30, 0
  buffer_store_dwordx4 v[96:99], v11, s[8:11], s29 offen offset:0 sc1
  v_mfma_f32_32x32x16_bf16 v[80:95], v[44:47], a[76:79], v[80:95]
  buffer_store_dwordx4 v[100:103], v11, s[8:11], s29 offen offset:256 sc1
  v_mfma_f32_32x32x16_bf16 v[80:95], v[48:51], a[80:83], v[80:95]
  v_mfma_f32_32x32x16_bf16 v[80:95], v[52:55], a[84:87], v[80:95]
  v_mfma_f32_32x32x16_bf16 v[80:95], v[56:59], a[88:91], v[80:95]
  v_mfma_f32_32x32x16_bf16 v[80:95], v[60:63], a[92:95], v[80:95]
  v_mfma_f32_32x32x16_bf16 v[64:79], v[16:19], a[96:99], 0
  v_mfma_f32_32x32x16_bf16 v[64:79], v[20:23], a[100:103], v[64:79]
  v_mfma_f32_32x32x16_bf16 v[64:79], v[24:27], a[104:107], v[64:79]
  v_cvt_pk_bf16_f32 v96, v80, v81
  v_cvt_pk_bf16_f32 v97, v82, v83
  v_mfma_f32_32x32x16_bf16 v[64:79], v[28:31], a[108:111], v[64:79]
  v_cvt_pk_bf16_f32 v98, v84, v85
  v_cvt_pk_bf16_f32 v99, v86, v87
  v_mfma_f32_32x32x16_bf16 v[64:79], v[32:35], a[112:115], v[64:79]
  v_cvt_pk_bf16_f32 v100, v88, v89
  v_cvt_pk_bf16_f32 v101, v90, v91
  v_mfma_f32_32x32x16_bf16 v[64:79], v[36:39], a[116:119], v[64:79]
  v_cvt_pk_bf16_f32 v102, v92, v93
  v_cvt_pk_bf16_f32 v103, v94, v95
  v_mfma_f32_32x32x16_bf16 v[64:79], v[40:43], a[120:123], v[64:79]
  s_add_u32 s29, s30, 2048
  buffer_store_dwordx4 v[96:99], v11, s[8:11], s29 offen offset:0 sc1
  v_mfma_f32_32x32x16_bf16 v[64:79], v[44:47], a[124:127], v[64:79]
  buffer_store_dwordx4 v[100:103], v11, s[8:11], s29 offen offset:256 sc1
  v_mfma_f32_32x32x16_bf16 v[64:79], v[48:51], a[128:131], v[64:79]
  v_mfma_f32_32x32x16_bf16 v[64:79], v[52:55], a[132:135], v[64:79]
  v_mfma_f32_32x32x16_bf16 v[64:79], v[56:59], a[136:139], v[64:79]
  v_mfma_f32_32x32x16_bf16 v[64:79], v[60:63], a[140:143], v[64:79]
  s_waitcnt vmcnt(7)
  s_barrier
  s_cmp_eq_u32 s21, 0
  s_cbranch_scc0 mp_55
  v_mov_b32 v13, s50
  s_mov_b64 s[24:25], exec
  s_mov_b64 exec, 1
  buffer_store_dword v13, v14, s[8:11], 0 offen sc1
  s_mov_b64 exec, s[24:25]
mp_55:
  v_mfma_f32_32x32x16_bf16 v[80:95], v[16:19], a[144:147], 0
  v_mfma_f32_32x32x16_bf16 v[80:95], v[20:23], a[148:151], v[80:95]
  v_mfma_f32_32x32x16_bf16 v[80:95], v[24:27], a[152:155], v[80:95]
  v_cvt_pk_bf16_f32 v96, v64, v65
  v_cvt_pk_bf16_f32 v97, v66, v67
  v_mfma_f32_32x32x16_bf16 v[80:95], v[28:31], a[156:159], v[80:95]
  v_cvt_pk_bf16_f32 v98, v68, v69
  v_cvt_pk_bf16_f32 v99, v70, v71
  v_mfma_f32_32x32x16_bf16 v[80:95], v[32:35], a[160:163], v[80:95]
  v_cvt_pk_bf16_f32 v100, v72, v73
  v_cvt_pk_bf16_f32 v101, v74, v75
  v_mfma_f32_32x32x16_bf16 v[80:95], v[36:39], a[164:167], v[80:95]
  v_cvt_pk_bf16_f32 v102, v76, v77
  v_cvt_pk_bf16_f32 v103, v78, v79
  v_mfma_f32_32x32x16_bf16 v[80:95], v[40:43], a[168:171], v[80:95]
  s_add_u32 s29, s30, 4096
  buffer_store_dwordx4 v[96:99], v11, s[8:11], s29 offen offset:0 sc1
  v_mfma_f32_32x32x16_bf16 v[80:95], v[44:47], a[172:175], v[80:95]
  buffer_store_dwordx4 v[100:103], v11, s[8:11], s29 offen offset:256 sc1
  v_mfma_f32_32x32x16_bf16 v[80:95], v[48:51], a[176:179], v[80:95]
  v_mfma_f32_32x32x16_bf16 v[80:95], v[52:55], a[180:183], v[80:95]
  v_mfma_f32_32x32x16_bf16 v[80:95], v[56:59], a[184:187], v[80:95]
  v_mfma_f32_32x32x16_bf16 v[80:95], v[60:63], a[188:191], v[80:95]
  v_mfma_f32_32x32x16_bf16 v[64:79], v[16:19], a[192:195], 0
  v_mfma_f32_32x32x16_bf16 v[64:79], v[20:23], a[196:199], v[64:79]
  v_mfma_f32_32x32x16_bf16 v[64:79], v[24:27], a[200:203], v[64:79]
  v_cvt_pk_bf16_f32 v96, v80, v81
  v_cvt_pk_bf16_f32 v97, v82, v83
  v_mfma_f32_32x32x16_bf16 v[64:79], v[28:31], a[204:207], v[64:79]
  v_cvt_pk_bf16_f32 v98, v84, v85
  v_cvt_pk_bf16_f32 v99, v86, v87
  v_mfma_f32_32x32x16_bf16 v[64:79], v[32:35], a[208:211], v[64:79]
  v_cvt_pk_bf16_f32 v100, v88, v89
  v_cvt_pk_bf16_f32 v101, v90, v91
  v_mfma_f32_32x32x16_bf16 v[64:79], v[36:39], a[212:215], v[64:79]
  v_cvt_pk_bf16_f32 v102, v92, v93
  v_cvt_pk_bf16_f32 v103, v94, v95
  v_mfma_f32_32x32x16_bf16 v[64:79], v[40:43], a[216:219], v[64:79]
  s_add_u32 s29, s30, 6144
  buffer_store_dwordx4 v[96:99], v11, s[8:11], s29 offen offset:0 sc1
  v_mfma_f32_32x32x16_bf16 v[64:79], v[44:47], a[220:223], v[64:79]
  buffer_store_dwordx4 v[100:103], v11, s[8:11], s29 offen offset:256 sc1
  v_mfma_f32_32x32x16_bf16 v[64:79], v[48:51], a[224:227], v[64:79]
  v_mfma_f32_32x32x16_bf16 v[64:79], v[52:55], a[228:231], v[64:79]
  v_mfma_f32_32x32x16_bf16 v[64:79], v[56:59], a[232:235], v[64:79]
  v_mfma_f32_32x32x16_bf16 v[64:79], v[60:63], a[236:239], v[64:79]
  s_nop 11
  v_cvt_pk_bf16_f32 v96, v64, v65
  v_cvt_pk_bf16_f32 v97, v66, v67
  v_cvt_pk_bf16_f32 v98, v68, v69
  v_cvt_pk_bf16_f32 v99, v70, v71
  v_cvt_pk_bf16_f32 v100, v72, v73
  v_cvt_pk_bf16_f32 v101, v74, v75
  v_cvt_pk_bf16_f32 v102, v76, v77
  v_cvt_pk_bf16_f32 v103, v78, v79
  s_add_u32 s29, s30, 8192
  buffer_store_dwordx4 v[96:99], v11, s[8:11], s29 offen offset:0 sc1
  buffer_store_dwordx4 v[100:103], v11, s[8:11], s29 offen offset:256 sc1
  s_cmp_eq_u32 s54, 0
  s_cbranch_scc1 udf_56
  s_cmp_gt_u32 s52, s53
  s_cbranch_scc1 ka_wp_57_ok
  s_mov_b32 s45, 0
ka_wp_57_spin:
  buffer_load_dword v2, v12, s[8:11], 0 offen sc1
  s_add_u32 s45, s45, 1
  s_waitcnt vmcnt(0)
  v_min_u32_dpp v3, v2, v2 quad_perm:[1,0,3,2] row_mask:0xf bank_mask:0xf
  s_nop 1
  v_min_u32_dpp v2, v3, v3 quad_perm:[2,3,0,1] row_mask:0xf bank_mask:0xf
  s_nop 1
  v_min_u32_dpp v3, v2, v2 row_half_mirror row_mask:0xf bank_mask:0xf
  s_nop 1
  v_min_u32_dpp v2, v3, v3 quad_perm:[0,1,2,3] row_mask:0xf bank_mask:0xf
  s_nop 0
  v_readfirstlane_b32 s52, v2
  s_cmp_gt_u32 s52, s53
  s_cbranch_scc1 ka_wp_57_ok
  s_cmp_lt_u32 s45, 400000
  s_cbranch_scc1 ka_wp_57_spin
  s_branch ka_abort
ka_wp_57_ok:
  s_lshl_b32 s29, s21, 10
  s_add_u32 m0, s29, 12288
  s_add_u32 s28, s47, 0
  buffer_load_dwordx4 v6, s[8:11], s28 offen sc1 lds
  s_lshl_b32 s29, s21, 10
  s_add_u32 m0, s29, 16384
  s_add_u32 s28, s47, 4096
  buffer_load_dwordx4 v6, s[8:11], s28 offen sc1 lds
  s_lshl_b32 s29, s21, 10
  s_add_u32 m0, s29, 20480
  s_add_u32 s28, s47, 8192
  buffer_load_dwordx4 v6, s[8:11], s28 offen sc1 lds
  s_add_u32 s47, s47, 12288
udf_56:
  s_add_u32 s50, s50, 1
  s_waitcnt vmcnt(10)
  s_cmp_eq_u32 s54, 0
  s_cbranch_scc1 ud_58
  s_waitcnt vmcnt(0)
ud_58:
  s_barrier
  ds_read_b128 v[16:19], v10 offset:0
  ds_read_b128 v[20:23], v10 offset:512
  ds_read_b128 v[24:27], v10 offset:2048
  ds_read_b128 v[28:31], v10 offset:2560
  ds_read_b128 v[32:35], v10 offset:4096
  ds_read_b128 v[36:39], v10 offset:4608
  ds_read_b128 v[40:43], v10 offset:6144
  ds_read_b128 v[44:47], v10 offset:6656
  ds_read_b128 v[48:51], v10 offset:8192
  ds_read_b128 v[52:55], v10 offset:8704
  ds_read_b128 v[56:59], v10 offset:10240
  ds_read_b128 v[60:63], v10 offset:10752
  s_mov_b32 s54, 0
  s_cmp_ge_u32 s50, 63
  s_cbranch_scc1 un_59_n
  s_add_u32 s53, s50, 1
  s_cmp_gt_u32 s52, s53
  s_cbranch_scc1 un_59_go
  buffer_load_dword v2, v12, s[8:11], 0 offen sc1
  s_waitcnt vmcnt(0)
  v_min_u32_dpp v3, v2, v2 quad_perm:[1,0,3,2] row_mask:0xf bank_mask:0xf
  s_nop 0
  v_readfirstlane_b32 s52, v3
  s_cmp_gt_u32 s52, s53
  s_cbranch_scc1 un_59_go2
  s_mov_b32 s54, 1
  s_branch un_59
un_59_go2:
un_59_go:
  s_lshl_b32 s29, s21, 10
  s_add_u32 m0, s29, 0
  s_add_u32 s28, s47, 0
  buffer_load_dwordx4 v6, s[8:11], s28 offen sc1 lds
  s_lshl_b32 s29, s21, 10
  s_add_u32 m0, s29, 4096
  s_add_u32 s28, s47, 4096
  buffer_load_dwordx4 v6, s[8:11], s28 offen sc1 lds
  s_lshl_b32 s29, s21, 10
  s_add_u32 m0, s29, 8192
  s_add_u32 s28, s47, 8192
  buffer_load_dwordx4 v6, s[8:11], s28 offen sc1 lds
  s_add_u32 s47, s47, 12288
  s_branch un_59
un_59_n:
  s_waitcnt vmcnt(0)
un_59:
  s_mul_i32 s30, s50, 1310720
  s_add_u32 s30, s30, s48
  s_waitcnt lgkmcnt(11)
  v_mfma_f32_32x32x16_bf16 v[64:79], v[16:19], a[0:3], 0
  s_waitcnt lgkmcnt(10)
  v_mfma_f32_32x32x16_bf16 v[64:79], v[20:23], a[4:7], v[64:79]
  s_waitcnt lgkmcnt(9)
  v_mfma_f32_32x32x16_bf16 v[64:79], v[24:27], a[8:11], v[64:79]
  s_waitcnt lgkmcnt(8)
  v_mfma_f32_32x32x16_bf16 v[64:79], v[28:31], a[12:15], v[64:79]
  s_waitcnt lgkmcnt(7)
  v_mfma_f32_32x32x16_bf16 v[64:79], v[32:35], a[16:19], v[64:79]
  s_waitcnt lgkmcnt(6)
  v_mfma_f32_32x32x16_bf16 v[64:79], v[36:39], a[20:23], v[64:79]
  s_waitcnt lgkmcnt(5)
  v_mfma_f32_32x32x16_bf16 v[64:79], v[40:43], a[24:27], v[64:79]
  s_waitcnt lgkmcnt(4)
  v_mfma_f32_32x32x16_bf16 v[64:79], v[44:47], a[28:31], v[64:79]
  s_waitcnt lgkmcnt(3)
  v_mfma_f32_32x32x16_bf16 v[64:79], v[48:51], a[32:35], v[64:79]
  s_waitcnt lgkmcnt(2)
  v_mfma_f32_32x32x16_bf16 v[64:79], v[52:55], a[36:39], v[64:79]
  s_waitcnt lgkmcnt(1)
  v_mfma_f32_32x32x16_bf16 v[64:79], v[56:59], a[40:43], v[64:79]
  s_waitcnt lgkmcnt(0)
  v_mfma_f32_32x32x16_bf16 v[64:79], v[60:63], a[44:47], v[64:79]
  v_mfma_f32_32x32x16_bf16 v[80:95], v[16:19], a[48:51], 0
  v_mfma_f32_32x32x16_bf16 v[80:95], v[20:23], a[52:55], v[80:95]
  v_mfma_f32_32x32x16_bf16 v[80:95], v[24:27], a[56:59], v[80:95]
  v_cvt_pk_bf16_f32 v96, v64, v65
  v_cvt_pk_bf16_f32 v97, v66, v67
  v_mfma_f32_32x32x16_bf16 v[80:95], v[28:31], a[60:63], v[80:95]
  v_cvt_pk_bf16_f32 v98, v68, v69
  v_cvt_pk_bf16_f32 v99, v70, v71
  v_mfma_f32_32x32x16_bf16 v[80:95], v[32:35], a[64:67], v[80:95]
  v_cvt_pk_bf16_f32 v100, v72, v73
  v_cvt_pk_bf16_f32 v101, v74, v75
  v_mfma_f32_32x32x16_bf16 v[80:95], v[36:39], a[68:71], v[80:95]
  v_cvt_pk_bf16_f32 v102, v76, v77
  v_cvt_pk_bf16_f32 v103, v78, v79
  v_mfma_f32_32x32x16_bf16 v[80:95], v[40:43], a[72:75], v[80:95]
  s_add_u32 s29, s30, 0
  buffer_store_dwordx4 v[96:99], v11, s[8:11], s29 offen offset:0 sc1
  v_mfma_f32_32x32x16_bf16 v[80:95], v[44:47], a[76:79], v[80:95]
  buffer_store_dwordx4 v[100:103], v11, s[8:11], s29 offen offset:256 sc1
  v_mfma_f32_32x32x16_bf16 v[80:95], v[48:51], a[80:83], v[80:95]
  v_mfma_f32_32x32x16_bf16 v[80:95], v[52:55], a[84:87], v[80:95]
  v_mfma_f32_32x32x16_bf16 v[80:95], v[56:59], a[88:91], v[80:95]
  v_mfma_f32_32x32x16_bf16 v[80:95], v[60:63], a[92:95], v[80:95]
  v_mfma_f32_32x32x16_bf16 v[64:79], v[16:19], a[96:99], 0
  v_mfma_f32_32x32x16_bf16 v[64:79], v[20:23], a[100:103], v[64:79]
  v_mfma_f32_32x32x16_bf16 v[64:79], v[24:27], a[104:107], v[64:79]
  v_cvt_pk_bf16_f32 v96, v80, v81
  v_cvt_pk_bf16_f32 v97, v82, v83
  v_mfma_f32_32x32x16_bf16 v[64:79], v[28:31], a[108:111], v[64:79]
  v_cvt_pk_bf16_f32 v98, v84, v85
  v_cvt_pk_bf16_f32 v99, v86, v87
  v_mfma_f32_32x32x16_bf16 v[64:79], v[32:35], a[112:115], v[64:79]
  v_cvt_pk_bf16_f32 v100, v88, v89
  v_cvt_pk_bf16_f32 v101, v90, v91
  v_mfma_f32_32x32x16_bf16 v[64:79], v[36:39], a[116:119], v[64:79]
  v_cvt_pk_bf16_f32 v102, v92, v93
  v_cvt_pk_bf16_f32 v103, v94, v95
  v_mfma_f32_32x32x16_bf16 v[64:79], v[40:43], a[120:123], v[64:79]
  s_add_u32 s29, s30, 2048
  buffer_store_dwordx4 v[96:99], v11, s[8:11], s29 offen offset:0 sc1
  v_mfma_f32_32x32x16_bf16 v[64:79], v[44:47], a[124:127], v[64:79]
  buffer_store_dwordx4 v[100:103], v11, s[8:11], s29 offen offset:256 sc1
  v_mfma_f32_32x32x16_bf16 v[64:79], v[48:51], a[128:131], v[64:79]
  v_mfma_f32_32x32x16_bf16 v[64:79], v[52:55], a[132:135], v[64:79]
  v_mfma_f32_32x32x16_bf16 v[64:79], v[56:59], a[136:139], v[64:79]
  v_mfma_f32_32x32x16_bf16 v[64:79], v[60:63], a[140:143], v[64:79]
  s_waitcnt vmcnt(7)
  s_barrier
  s_cmp_eq_u32 s21, 0
  s_cbranch_scc0 mp_60
  v_mov_b32 v13, s50
  s_mov_b64 s[24:25], exec
  s_mov_b64 exec, 1
  buffer_store_dword v13, v14, s[8:11], 0 offen sc1
  s_mov_b64 exec, s[24:25]
mp_60:
  v_mfma_f32_32x32x16_bf16 v[80:95], v[16:19], a[144:147], 0
  v_mfma_f32_32x32x16_bf16 v[80:95], v[20:23], a[148:151], v[80:95]
  v_mfma_f32_32x32x16_bf16 v[80:95], v[24:27], a[152:155], v[80:95]
  v_cvt_pk_bf16_f32 v96, v64, v65
  v_cvt_pk_bf16_f32 v97, v66, v67
  v_mfma_f32_32x32x16_bf16 v[80:95], v[28:31], a[156:159], v[80:95]
  v_cvt_pk_bf16_f32 v98, v68, v69
  v_cvt_pk_bf16_f32 v99, v70, v71
  v_mfma_f32_32x32x16_bf16 v[80:95], v[32:35], a[160:163], v[80:95]
  v_cvt_pk_bf16_f32 v100, v72, v73
  v_cvt_pk_bf16_f32 v101, v74, v75
  v_mfma_f32_32x32x16_bf16 v[80:95], v[36:39], a[164:167], v[80:95]
  v_cvt_pk_bf16_f32 v102, v76, v77
  v_cvt_pk_bf16_f32 v103, v78, v79
  v_mfma_f32_32x32x16_bf16 v[80:95], v[40:43], a[168:171], v[80:95]
  s_add_u32 s29, s30, 4096
  buffer_store_dwordx4 v[96:99], v11, s[8:11], s29 offen offset:0 sc1
  v_mfma_f32_32x32x16_bf16 v[80:95], v[44:47], a[172:175], v[80:95]
  buffer_store_dwordx4 v[100:103], v11, s[8:11], s29 offen offset:256 sc1
  v_mfma_f32_32x32x16_bf16 v[80:95], v[48:51], a[176:179], v[80:95]
  v_mfma_f32_32x32x16_bf16 v[80:95], v[52:55], a[180:183], v[80:95]
  v_mfma_f32_32x32x16_bf16 v[80:95], v[56:59], a[184:187], v[80:95]
  v_mfma_f32_32x32x16_bf16 v[80:95], v[60:63], a[188:191], v[80:95]
  v_mfma_f32_32x32x16_bf16 v[64:79], v[16:19], a[192:195], 0
  v_mfma_f32_32x32x16_bf16 v[64:79], v[20:23], a[196:199], v[64:79]
  v_mfma_f32_32x32x16_bf16 v[64:79], v[24:27], a[200:203], v[64:79]
  v_cvt_pk_bf16_f32 v96, v80, v81
  v_cvt_pk_bf16_f32 v97, v82, v83
  v_mfma_f32_32x32x16_bf16 v[64:79], v[28:31], a[204:207], v[64:79]
  v_cvt_pk_bf16_f32 v98, v84, v85
  v_cvt_pk_bf16_f32 v99, v86, v87
  v_mfma_f32_32x32x16_bf16 v[64:79], v[32:35], a[208:211], v[64:79]
  v_cvt_pk_bf16_f32 v100, v88, v89
  v_cvt_pk_bf16_f32 v101, v90, v91
  v_mfma_f32_32x32x16_bf16 v[64:79], v[36:39], a[212:215], v[64:79]
  v_cvt_pk_bf16_f32 v102, v92, v93
  v_cvt_pk_bf16_f32 v103, v94, v95
  v_mfma_f32_32x32x16_bf16 v[64:79], v[40:43], a[216:219], v[64:79]
  s_add_u32 s29, s30, 6144
  buffer_store_dwordx4 v[96:99], v11, s[8:11], s29 offen offset:0 sc1
  v_mfma_f32_32x32x16_bf16 v[64:79], v[44:47], a[220:223], v[64:79]
  buffer_store_dwordx4 v[100:103], v11, s[8:11], s29 offen offset:256 sc1
  v_mfma_f32_32x32x16_bf16 v[64:79], v[48:51], a[224:227], v[64:79]
  v_mfma_f32_32x32x16_bf16 v[64:79], v[52:55], a[228:231], v[64:79]
  v_mfma_f32_32x32x16_bf16 v[64:79], v[56:59], a[232:235], v[64:79]
  v_mfma_f32_32x32x16_bf16 v[64:79], v[60:63], a[236:239], v[64:79]
  s_nop 11
  v_cvt_pk_bf16_f32 v96, v64, v65
  v_cvt_pk_bf16_f32 v97, v66, v67
  v_cvt_pk_bf16_f32 v98, v68, v69
  v_cvt_pk_bf16_f32 v99, v70, v71
  v_cvt_pk_bf16_f32 v100, v72, v73
  v_cvt_pk_bf16_f32 v101, v74, v75
  v_cvt_pk_bf16_f32 v102, v76, v77
  v_cvt_pk_bf16_f32 v103, v78, v79
  s_add_u32 s29, s30, 8192
  buffer_store_dwordx4 v[96:99], v11, s[8:11], s29 offen offset:0 sc1
  buffer_store_dwordx4 v[100:103], v11, s[8:11], s29 offen offset:256 sc1
  s_cmp_eq_u32 s54, 0
  s_cbranch_scc1 udf_61
  s_cmp_gt_u32 s52, s53
  s_cbranch_scc1 ka_wp_62_ok
  s_mov_b32 s45, 0
ka_wp_62_spin:
  buffer_load_dword v2, v12, s[8:11], 0 offen sc1
  s_add_u32 s45, s45, 1
  s_waitcnt vmcnt(0)
  v_min_u32_dpp v3, v2, v2 quad_perm:[1,0,3,2] row_mask:0xf bank_mask:0xf
  s_nop 1
  v_min_u32_dpp v2, v3, v3 quad_perm:[2,3,0,1] row_mask:0xf bank_mask:0xf
  s_nop 1
  v_min_u32_dpp v3, v2, v2 row_half_mirror row_mask:0xf bank_mask:0xf
  s_nop 1
  v_min_u32_dpp v2, v3, v3 quad_perm:[0,1,2,3] row_mask:0xf bank_mask:0xf
  s_nop 0
  v_readfirstlane_b32 s52, v2
  s_cmp_gt_u32 s52, s53
  s_cbranch_scc1 ka_wp_62_ok
  s_cmp_lt_u32 s45, 400000
  s_cbranch_scc1 ka_wp_62_spin
  s_branch ka_abort
ka_wp_62_ok:
  s_lshl_b32 s29, s21, 10
  s_add_u32 m0, s29, 0
  s_add_u32 s28, s47, 0
  buffer_load_dwordx4 v6, s[8:11], s28 offen sc1 lds
  s_lshl_b32 s29, s21, 10
  s_add_u32 m0, s29, 4096
  s_add_u32 s28, s47, 4096
  buffer_load_dwordx4 v6, s[8:11], s28 offen sc1 lds
  s_lshl_b32 s29, s21, 10
  s_add_u32 m0, s29, 8192
  s_add_u32 s28, s47, 8192
  buffer_load_dwordx4 v6, s[8:11], s28 offen sc1 lds
  s_add_u32 s47, s47, 12288
udf_61:
  s_add_u32 s50, s50, 1
  s_cmp_lt_u32 s50, 64
  s_cbranch_scc1 ka_u_loop
  s_waitcnt vmcnt(0)
  s_barrier
  s_cmp_eq_u32 s21, 0
  s_cbranch_scc0 ka_exit
  v_mov_b32 v13, 64
  s_mov_b64 exec, 1
  buffer_store_dword v13, v14, s[8:11], 0 offen sc1
  s_waitcnt vmcnt(0)
  s_branch ka_exit
.macro CHAINROLES sfx, pol
ka\sfx\()_x:
  s_mov_b32 s12, s36
  s_and_b32 s13, s37, 0xffff
  s_mov_b32 s14, 0x780000
  s_mov_b32 s15, 0x20000
  s_mov_b32 s16, s38
  s_and_b32 s17, s39, 0xffff
  s_mov_b32 s18, 0x780000
  s_mov_b32 s19, 0x20000
  v_and_b32 v1, 63, v0
  v_lshrrev_b32 v2, 4, v1
  v_bfe_u32 v3, v1, 3, 1
  v_bfe_u32 v4, v1, 1, 2
  v_and_b32 v5, 1, v1
  s_mul_i32 s46, s23, 384
  s_lshl_b32 s28, s21, 2
  s_add_u32 s28, s28, 0
  v_add_u32 v6, s28, v2
  v_mul_u32_u24 v7, 43, v6
  v_lshrrev_b32 v7, 9, v7
  v_mul_u32_u24 v8, 12, v7
  v_sub_u32 v8, v6, v8
  v_lshrrev_b32 v9, 1, v7
  v_lshlrev_b32 v9, 4, v9
  v_and_b32 v10, 1, v7
  v_lshlrev_b32 v10, 2, v10
  v_add_u32 v9, v9, v10
  v_lshlrev_b32 v10, 3, v3
  v_add_u32 v9, v9, v10
  v_add_u32 v9, v9, v4
  v_mul_u32_u24 v9, 12288, v9
  v_lshrrev_b32 v10, 1, v8
  v_lshlrev_b32 v10, 2, v10
  v_lshlrev_b32 v11, 1, v5
  v_add_u32 v10, v10, v11
  v_and_b32 v11, 1, v8
  v_add_u32 v10, v10, v11
  v_lshlrev_b32 v10, 4, v10
  v_add_u32 v9, v9, v10
  v_add_u32 v136, s46, v9
  s_lshl_b32 s28, s21, 2
  s_add_u32 s28, s28, 16
  v_add_u32 v6, s28, v2
  v_mul_u32_u24 v7, 43, v6
  v_lshrrev_b32 v7, 9, v7
  v_mul_u32_u24 v8, 12, v7
  v_sub_u32 v8, v6, v8
  v_lshrrev_b32 v9, 1, v7
  v_lshlrev_b32 v9, 4, v9
  v_and_b32 v10, 1, v7
  v_lshlrev_b32 v10, 2, v10
  v_add_u32 v9, v9, v10
  v_lshlrev_b32 v10, 3, v3
  v_add_u32 v9, v9, v10
  v_add_u32 v9, v9, v4
  v_mul_u32_u24 v9, 12288, v9
  v_lshrrev_b32 v10, 1, v8
  v_lshlrev_b32 v10, 2, v10
  v_lshlrev_b32 v11, 1, v5
  v_add_u32 v10, v10, v11
  v_and_b32 v11, 1, v8
  v_add_u32 v10, v10, v11
  v_lshlrev_b32 v10, 4, v10
  v_add_u32 v9, v9, v10
  v_add_u32 v137, s46, v9
  s_lshl_b32 s28, s21, 2
  s_add_u32 s28, s28, 32
  v_add_u32 v6, s28, v2
  v_mul_u32_u24 v7, 43, v6
  v_lshrrev_b32 v7, 9, v7
  v_mul_u32_u24 v8, 12, v7
  v_sub_u32 v8, v6, v8
  v_lshrrev_b32 v9, 1, v7
  v_lshlrev_b32 v9, 4, v9
  v_and_b32 v10, 1, v7
  v_lshlrev_b32 v10, 2, v10
  v_add_u32 v9, v9, v10
  v_lshlrev_b32 v10, 3, v3
  v_add_u32 v9, v9, v10
  v_add_u32 v9, v9, v4
  v_mul_u32_u24 v9, 12288, v9
  v_lshrrev_b32 v10, 1, v8
  v_lshlrev_b32 v10, 2, v10
  v_lshlrev_b32 v11, 1, v5
  v_add_u32 v10, v10, v11
  v_and_b32 v11, 1, v8
  v_add_u32 v10, v10, v11
  v_lshlrev_b32 v10, 4, v10
  v_add_u32 v9, v9, v10
  v_add_u32 v138, s46, v9
  s_lshl_b32 s28, s21, 2
  s_add_u32 s28, s28, 48
  v_add_u32 v6, s28, v2
  v_mul_u32_u24 v7, 43, v6
  v_lshrrev_b32 v7, 9, v7
  v_mul_u32_u24 v8, 12, v7
  v_sub_u32 v8, v6, v8
  v_lshrrev_b32 v9, 1, v7
  v_lshlrev_b32 v9, 4, v9
  v_and_b32 v10, 1, v7
  v_lshlrev_b32 v10, 2, v10
  v_add_u32 v9, v9, v10
  v_lshlrev_b32 v10, 3, v3
  v_add_u32 v9, v9, v10
  v_add_u32 v9, v9, v4
  v_mul_u32_u24 v9, 12288, v9
  v_lshrrev_b32 v10, 1, v8
  v_lshlrev_b32 v10, 2, v10
  v_lshlrev_b32 v11, 1, v5
  v_add_u32 v10, v10, v11
  v_and_b32 v11, 1, v8
  v_add_u32 v10, v10, v11
  v_lshlrev_b32 v10, 4, v10
  v_add_u32 v9, v9, v10
  v_add_u32 v139, s46, v9
  s_lshl_b32 s28, s21, 2
  s_add_u32 s28, s28, 64
  v_add_u32 v6, s28, v2
  v_mul_u32_u24 v7, 43, v6
  v_lshrrev_b32 v7, 9, v7
  v_mul_u32_u24 v8, 12, v7
  v_sub_u32 v8, v6, v8
  v_lshrrev_b32 v9, 1, v7
  v_lshlrev_b32 v9, 4, v9
  v_and_b32 v10, 1, v7
  v_lshlrev_b32 v10, 2, v10
  v_add_u32 v9, v9, v10
  v_lshlrev_b32 v10, 3, v3
  v_add_u32 v9, v9, v10
  v_add_u32 v9, v9, v4
  v_mul_u32_u24 v9, 12288, v9
  v_lshrrev_b32 v10, 1, v8
  v_lshlrev_b32 v10, 2, v10
  v_lshlrev_b32 v11, 1, v5
  v_add_u32 v10, v10, v11
  v_and_b32 v11, 1, v8
  v_add_u32 v10, v10, v11
  v_lshlrev_b32 v10, 4, v10
  v_add_u32 v9, v9, v10
  v_add_u32 v140, s46, v9
  s_lshl_b32 s28, s21, 2
  s_add_u32 s28, s28, 80
  v_add_u32 v6, s28, v2
  v_mul_u32_u24 v7, 43, v6
  v_lshrrev_b32 v7, 9, v7
  v_mul_u32_u24 v8, 12, v7
  v_sub_u32 v8, v6, v8
  v_lshrrev_b32 v9, 1, v7
  v_lshlrev_b32 v9, 4, v9
  v_and_b32 v10, 1, v7
  v_lshlrev_b32 v10, 2, v10
  v_add_u32 v9, v9, v10
  v_lshlrev_b32 v10, 3, v3
  v_add_u32 v9, v9, v10
  v_add_u32 v9, v9, v4
  v_mul_u32_u24 v9, 12288, v9
  v_lshrrev_b32 v10, 1, v8
  v_lshlrev_b32 v10, 2, v10
  v_lshlrev_b32 v11, 1, v5
  v_add_u32 v10, v10, v11
  v_and_b32 v11, 1, v8
  v_add_u32 v10, v10, v11
  v_lshlrev_b32 v10, 4, v10
  v_add_u32 v9, v9, v10
  v_add_u32 v141, s46, v9
  v_lshrrev_b32 v6, 1, v2
  v_mul_u32_u24 v142, 6144, v6
  v_and_b32 v6, 1, v2
  v_lshlrev_b32 v6, 7, v6
  v_add_u32 v142, v142, v6
  v_bfe_u32 v6, v1, 2, 2
  v_lshlrev_b32 v6, 5, v6
  v_add_u32 v142, v142, v6
  v_and_b32 v6, 1, v1
  v_lshlrev_b32 v6, 4, v6
  v_add_u32 v142, v142, v6
  v_bfe_u32 v6, v1, 1, 1
  v_lshlrev_b32 v6, 3, v6
  v_add_u32 v142, v142, v6
  s_mul_i32 s28, s21, 768
  v_add_u32 v142, s28, v142
  s_lshl_b32 s29, s21, 10
  s_add_u32 m0, s29, 0
  s_mov_b32 s28, 0
  buffer_load_dwordx4 v136, s[12:15], s28 offen lds
  s_lshl_b32 s29, s21, 10
  s_add_u32 m0, s29, 4096
  s_mov_b32 s28, 0
  buffer_load_dwordx4 v137, s[12:15], s28 offen lds
  s_lshl_b32 s29, s21, 10
  s_add_u32 m0, s29, 8192
  s_mov_b32 s28, 0
  buffer_load_dwordx4 v138, s[12:15], s28 offen lds
  s_lshl_b32 s29, s21, 10
  s_add_u32 m0, s29, 12288
  s_mov_b32 s28, 0
  buffer_load_dwordx4 v139, s[12:15], s28 offen lds
  s_lshl_b32 s29, s21, 10
  s_add_u32 m0, s29, 16384
  s_mov_b32 s28, 0
  buffer_load_dwordx4 v140, s[12:15], s28 offen lds
  s_lshl_b32 s29, s21, 10
  s_add_u32 m0, s29, 20480
  s_mov_b32 s28, 0
  buffer_load_dwordx4 v141, s[12:15], s28 offen lds
  s_lshl_b32 s29, s21, 10
  s_add_u32 m0, s29, 24576
  s_mov_b32 s28, 786432
  buffer_load_dwordx4 v136, s[12:15], s28 offen lds
  s_lshl_b32 s29, s21, 10
  s_add_u32 m0, s29, 28672
  s_mov_b32 s28, 786432
  buffer_load_dwordx4 v137, s[12:15], s28 offen lds
  s_lshl_b32 s29, s21, 10
  s_add_u32 m0, s29, 32768
  s_mov_b32 s28, 786432
  buffer_load_dwordx4 v138, s[12:15], s28 offen lds
  s_lshl_b32 s29, s21, 10
  s_add_u32 m0, s29, 36864
  s_mov_b32 s28, 786432
  buffer_load_dwordx4 v139, s[12:15], s28 offen lds
  s_lshl_b32 s29, s21, 10
  s_add_u32 m0, s29, 40960
  s_mov_b32 s28, 786432
  buffer_load_dwordx4 v140, s[12:15], s28 offen lds
  s_lshl_b32 s29, s21, 10
  s_add_u32 m0, s29, 45056
  s_mov_b32 s28, 786432
  buffer_load_dwordx4 v141, s[12:15], s28 offen lds
  s_lshl_b32 s29, s21, 10
  s_add_u32 m0, s29, 49152
  s_mov_b32 s28, 1572864
  buffer_load_dwordx4 v136, s[12:15], s28 offen lds
  s_lshl_b32 s29, s21, 10
  s_add_u32 m0, s29, 53248
  s_mov_b32 s28, 1572864
  buffer_load_dwordx4 v137, s[12:15], s28 offen lds
  s_lshl_b32 s29, s21, 10
  s_add_u32 m0, s29, 57344
  s_mov_b32 s28, 1572864
  buffer_load_dwordx4 v138, s[12:15], s28 offen lds
  s_lshl_b32 s29, s21, 10
  s_add_u32 m0, s29, 61440
  s_mov_b32 s28, 1572864
  buffer_load_dwordx4 v139, s[12:15], s28 offen lds
  s_lshl_b32 s29, s21, 10
  s_add_u32 m0, s29, 65536
  s_mov_b32 s28, 1572864
  buffer_load_dwordx4 v140, s[12:15], s28 offen lds
  s_lshl_b32 s29, s21, 10
  s_add_u32 m0, s29, 69632
  s_mov_b32 s28, 1572864
  buffer_load_dwordx4 v141, s[12:15], s28 offen lds
  s_lshl_b32 s29, s21, 10
  s_add_u32 m0, s29, 73728
  s_mov_b32 s28, 2359296
  buffer_load_dwordx4 v136, s[12:15], s28 offen lds
  s_lshl_b32 s29, s21, 10
  s_add_u32 m0, s29, 77824
  s_mov_b32 s28, 2359296
  buffer_load_dwordx4 v137, s[12:15], s28 offen lds
  s_lshl_b32 s29, s21, 10
  s_add_u32 m0, s29, 81920
  s_mov_b32 s28, 2359296
  buffer_load_dwordx4 v138, s[12:15], s28 offen lds
  s_lshl_b32 s29, s21, 10
  s_add_u32 m0, s29, 86016
  s_mov_b32 s28, 2359296
  buffer_load_dwordx4 v139, s[12:15], s28 offen lds
  s_lshl_b32 s29, s21, 10
  s_add_u32 m0, s29, 90112
  s_mov_b32 s28, 2359296
  buffer_load_dwordx4 v140, s[12:15], s28 offen lds
  s_lshl_b32 s29, s21, 10
  s_add_u32 m0, s29, 94208
  s_mov_b32 s28, 2359296
  buffer_load_dwordx4 v141, s[12:15], s28 offen lds
  s_lshl_b32 s29, s21, 10
  s_add_u32 m0, s29, 98304
  s_mov_b32 s28, 3145728
  buffer_load_dwordx4 v136, s[12:15], s28 offen lds
  s_lshl_b32 s29, s21, 10
  s_add_u32 m0, s29, 102400
  s_mov_b32 s28, 3145728
  buffer_load_dwordx4 v137, s[12:15], s28 offen lds
  s_lshl_b32 s29, s21, 10
  s_add_u32 m0, s29, 106496
  s_mov_b32 s28, 3145728
  buffer_load_dwordx4 v138, s[12:15], s28 offen lds
  s_lshl_b32 s29, s21, 10
  s_add_u32 m0, s29, 110592
  s_mov_b32 s28, 3145728
  buffer_load_dwordx4 v139, s[12:15], s28 offen lds
  s_lshl_b32 s29, s21, 10
  s_add_u32 m0, s29, 114688
  s_mov_b32 s28, 3145728
  buffer_load_dwordx4 v140, s[12:15], s28 offen lds
  s_lshl_b32 s29, s21, 10
  s_add_u32 m0, s29, 118784
  s_mov_b32 s28, 3145728
  buffer_load_dwordx4 v141, s[12:15], s28 offen lds
  s_waitcnt vmcnt(24)
  s_barrier
  s_lshl_b32 s29, s21, 10
  s_add_u32 m0, s29, 122880
  s_mov_b32 s28, 3932160
  buffer_load_dwordx4 v136, s[12:15], s28 offen lds
  s_lshl_b32 s29, s21, 10
  s_add_u32 m0, s29, 126976
  s_mov_b32 s28, 3932160
  buffer_load_dwordx4 v137, s[12:15], s28 offen lds
  s_lshl_b32 s29, s21, 10
  s_add_u32 m0, s29, 131072
  s_mov_b32 s28, 3932160
  buffer_load_dwordx4 v138, s[12:15], s28 offen lds
  s_lshl_b32 s29, s21, 10
  s_add_u32 m0, s29, 135168
  s_mov_b32 s28, 3932160
  buffer_load_dwordx4 v139, s[12:15], s28 offen lds
  s_lshl_b32 s29, s21, 10
  s_add_u32 m0, s29, 139264
  s_mov_b32 s28, 3932160
  buffer_load_dwordx4 v140, s[12:15], s28 offen lds
  s_lshl_b32 s29, s21, 10
  s_add_u32 m0, s29, 143360
  s_mov_b32 s28, 3932160
  buffer_load_dwordx4 v141, s[12:15], s28 offen lds
  v_add_u32 v143, 0, v142
  ds_read_b64_tr_b16 a[0:1], v143 offset:0
  ds_read_b64_tr_b16 a[2:3], v143 offset:3072
  ds_read_b64_tr_b16 a[4:5], v143 offset:12288
  ds_read_b64_tr_b16 a[6:7], v143 offset:15360
  ds_read_b64_tr_b16 a[80:81], v143 offset:256
  ds_read_b64_tr_b16 a[82:83], v143 offset:3328
  ds_read_b64_tr_b16 a[84:85], v143 offset:12544
  ds_read_b64_tr_b16 a[86:87], v143 offset:15616
  ds_read_b64_tr_b16 a[160:161], v143 offset:512
  ds_read_b64_tr_b16 a[162:163], v143 offset:3584
  ds_read_b64_tr_b16 a[164:165], v143 offset:12800
  ds_read_b64_tr_b16 a[166:167], v143 offset:15872
  s_waitcnt lgkmcnt(0)
  s_waitcnt vmcnt(24)
  s_barrier
  s_lshl_b32 s29, s21, 10
  s_add_u32 m0, s29, 0
  s_mov_b32 s28, 4718592
  buffer_load_dwordx4 v136, s[12:15], s28 offen lds
  s_lshl_b32 s29, s21, 10
  s_add_u32 m0, s29, 4096
  s_mov_b32 s28, 4718592
  buffer_load_dwordx4 v137, s[12:15], s28 offen lds
  s_lshl_b32 s29, s21, 10
  s_add_u32 m0, s29, 8192
  s_mov_b32 s28, 4718592
  buffer_load_dwordx4 v138, s[12:15], s28 offen lds
  s_lshl_b32 s29, s21, 10
  s_add_u32 m0, s29, 12288
  s_mov_b32 s28, 4718592
  buffer_load_dwordx4 v139, s[12:15], s28 offen lds
  s_lshl_b32 s29, s21, 10
  s_add_u32 m0, s29, 16384
  s_mov_b32 s28, 4718592
  buffer_load_dwordx4 v140, s[12:15], s28 offen lds
  s_lshl_b32 s29, s21, 10
  s_add_u32 m0, s29, 20480
  s_mov_b32 s28, 4718592
  buffer_load_dwordx4 v141, s[12:15], s28 offen lds
  v_add_u32 v143, 24576, v142
  ds_read_b64_tr_b16 a[8:9], v143 offset:0
  ds_read_b64_tr_b16 a[10:11], v143 offset:3072
  ds_read_b64_tr_b16 a[12:13], v143 offset:12288
  ds_read_b64_tr_b16 a[14:15], v143 offset:15360
  ds_read_b64_tr_b16 a[88:89], v143 offset:256
  ds_read_b64_tr_b16 a[90:91], v143 offset:3328
  ds_read_b64_tr_b16 a[92:93], v143 offset:12544
  ds_read_b64_tr_b16 a[94:95], v143 offset:15616
  ds_read_b64_tr_b16 a[168:169], v143 offset:512
  ds_read_b64_tr_b16 a[170:171], v143 offset:3584
  ds_read_b64_tr_b16 a[172:173], v143 offset:12800
  ds_read_b64_tr_b16 a[174:175], v143 offset:15872
  s_waitcnt lgkmcnt(0)
  s_waitcnt vmcnt(24)
  s_barrier
  s_lshl_b32 s29, s21, 10
  s_add_u32 m0, s29, 24576
  s_mov_b32 s28, 5505024
  buffer_load_dwordx4 v136, s[12:15], s28 offen lds
  s_lshl_b32 s29, s21, 10
  s_add_u32 m0, s29, 28672
  s_mov_b32 s28, 5505024
  buffer_load_dwordx4 v137, s[12:15], s28 offen lds
  s_lshl_b32 s29, s21, 10
  s_add_u32 m0, s29, 32768
  s_mov_b32 s28, 5505024
  buffer_load_dwordx4 v138, s[12:15], s28 offen lds
  s_lshl_b32 s29, s21, 10
  s_add_u32 m0, s29, 36864
  s_mov_b32 s28, 5505024
  buffer_load_dwordx4 v139, s[12:15], s28 offen lds
  s_lshl_b32 s29, s21, 10
  s_add_u32 m0, s29, 40960
  s_mov_b32 s28, 5505024
  buffer_load_dwordx4 v140, s[12:15], s28 offen lds
  s_lshl_b32 s29, s21, 10
  s_add_u32 m0, s29, 45056
  s_mov_b32 s28, 5505024
  buffer_load_dwordx4 v141, s[12:15], s28 offen lds
  v_add_u32 v143, 49152, v142
  ds_read_b64_tr_b16 a[16:17], v143 offset:0
  ds_read_b64_tr_b16 a[18:19], v143 offset:3072
  ds_read_b64_tr_b16 a[20:21], v143 offset:12288
  ds_read_b64_tr_b16 a[22:23], v143 offset:15360
  ds_read_b64_tr_b16 a[96:97], v143 offset:256
  ds_read_b64_tr_b16 a[98:99], v143 offset:3328
  ds_read_b64_tr_b16 a[100:101], v143 offset:12544
  ds_read_b64_tr_b16 a[102:103], v143 offset:15616
  ds_read_b64_tr_b16 a[176:177], v143 offset:512
  ds_read_b64_tr_b16 a[178:179], v143 offset:3584
  ds_read_b64_tr_b16 a[180:181], v143 offset:12800
  ds_read_b64_tr_b16 a[182:183], v143 offset:15872
  s_waitcnt lgkmcnt(0)
  s_waitcnt vmcnt(24)
  s_barrier
  s_lshl_b32 s29, s21, 10
  s_add_u32 m0, s29, 49152
  s_mov_b32 s28, 6291456
  buffer_load_dwordx4 v136, s[12:15], s28 offen lds
  s_lshl_b32 s29, s21, 10
  s_add_u32 m0, s29, 53248
  s_mov_b32 s28, 6291456
  buffer_load_dwordx4 v137, s[12:15], s28 offen lds
  s_lshl_b32 s29, s21, 10
  s_add_u32 m0, s29, 57344
  s_mov_b32 s28, 6291456
  buffer_load_dwordx4 v138, s[12:15], s28 offen lds
  s_lshl_b32 s29, s21, 10
  s_add_u32 m0, s29, 61440
  s_mov_b32 s28, 6291456
  buffer_load_dwordx4 v139, s[12:15], s28 offen lds
  s_lshl_b32 s29, s21, 10
  s_add_u32 m0, s29, 65536
  s_mov_b32 s28, 6291456
  buffer_load_dwordx4 v140, s[12:15], s28 offen lds
  s_lshl_b32 s29, s21, 10
  s_add_u32 m0, s29, 69632
  s_mov_b32 s28, 6291456
  buffer_load_dwordx4 v141, s[12:15], s28 offen lds
  v_add_u32 v143, 73728, v142
  ds_read_b64_tr_b16 a[24:25], v143 offset:0
  ds_read_b64_tr_b16 a[26:27], v143 offset:3072
  ds_read_b64_tr_b16 a[28:29], v143 offset:12288
  ds_read_b64_tr_b16 a[30:31], v143 offset:15360
  ds_read_b64_tr_b16 a[104:105], v143 offset:256
  ds_read_b64_tr_b16 a[106:107], v143 offset:3328
  ds_read_b64_tr_b16 a[108:109], v143 offset:12544
  ds_read_b64_tr_b16 a[110:111], v143 offset:15616
  ds_read_b64_tr_b16 a[184:185], v143 offset:512
  ds_read_b64_tr_b16 a[186:187], v143 offset:3584
  ds_read_b64_tr_b16 a[188:189], v143 offset:12800
  ds_read_b64_tr_b16 a[190:191], v143 offset:15872
  s_waitcnt lgkmcnt(0)
  s_waitcnt vmcnt(24)
  s_barrier
  s_lshl_b32 s29, s21, 10
  s_add_u32 m0, s29, 73728
  s_mov_b32 s28, 7077888
  buffer_load_dwordx4 v136, s[12:15], s28 offen lds
  s_lshl_b32 s29, s21, 10
  s_add_u32 m0, s29, 77824
  s_mov_b32 s28, 7077888
  buffer_load_dwordx4 v137, s[12:15], s28 offen lds
  s_lshl_b32 s29, s21, 10
  s_add_u32 m0, s29, 81920
  s_mov_b32 s28, 7077888
  buffer_load_dwordx4 v138, s[12:15], s28 offen lds
  s_lshl_b32 s29, s21, 10
  s_add_u32 m0, s29, 86016
  s_mov_b32 s28, 7077888
  buffer_load_dwordx4 v139, s[12:15], s28 offen lds
  s_lshl_b32 s29, s21, 10
  s_add_u32 m0, s29, 90112
  s_mov_b32 s28, 7077888
  buffer_load_dwordx4 v140, s[12:15], s28 offen lds
  s_lshl_b32 s29, s21, 10
  s_add_u32 m0, s29, 94208
  s_mov_b32 s28, 7077888
  buffer_load_dwordx4 v141, s[12:15], s28 offen lds
  v_add_u32 v143, 98304, v142
  ds_read_b64_tr_b16 a[32:33], v143 offset:0
  ds_read_b64_tr_b16 a[34:35], v143 offset:3072
  ds_read_b64_tr_b16 a[36:37], v143 offset:12288
  ds_read_b64_tr_b16 a[38:39], v143 offset:15360
  ds_read_b64_tr_b16 a[112:113], v143 offset:256
  ds_read_b64_tr_b16 a[114:115], v143 offset:3328
  ds_read_b64_tr_b16 a[116:117], v143 offset:12544
  ds_read_b64_tr_b16 a[118:119], v143 offset:15616
  ds_read_b64_tr_b16 a[192:193], v143 offset:512
  ds_read_b64_tr_b16 a[194:195], v143 offset:3584
  ds_read_b64_tr_b16 a[196:197], v143 offset:12800
  ds_read_b64_tr_b16 a[198:199], v143 offset:15872
  s_waitcnt lgkmcnt(0)
  s_waitcnt vmcnt(24)
  s_barrier
  s_lshl_b32 s29, s21, 10
  s_add_u32 m0, s29, 98304
  s_mov_b32 s28, 0
  buffer_load_dwordx4 v136, s[16:19], s28 offen lds
  s_lshl_b32 s29, s21, 10
  s_add_u32 m0, s29, 102400
  s_mov_b32 s28, 0
  buffer_load_dwordx4 v137, s[16:19], s28 offen lds
  s_lshl_b32 s29, s21, 10
  s_add_u32 m0, s29, 106496
  s_mov_b32 s28, 0
  buffer_load_dwordx4 v138, s[16:19], s28 offen lds
  s_lshl_b32 s29, s21, 10
  s_add_u32 m0, s29, 110592
  s_mov_b32 s28, 0
  buffer_load_dwordx4 v139, s[16:19], s28 offen lds
  s_lshl_b32 s29, s21, 10
  s_add_u32 m0, s29, 114688
  s_mov_b32 s28, 0
  buffer_load_dwordx4 v140, s[16:19], s28 offen lds
  s_lshl_b32 s29, s21, 10
  s_add_u32 m0, s29, 118784
  s_mov_b32 s28, 0
  buffer_load_dwordx4 v141, s[16:19], s28 offen lds
  v_add_u32 v143, 122880, v142
  ds_read_b64_tr_b16 a[40:41], v143 offset:0
  ds_read_b64_tr_b16 a[42:43], v143 offset:3072
  ds_read_b64_tr_b16 a[44:45], v143 offset:12288
  ds_read_b64_tr_b16 a[46:47], v143 offset:15360
  ds_read_b64_tr_b16 a[120:121], v143 offset:256
  ds_read_b64_tr_b16 a[122:123], v143 offset:3328
  ds_read_b64_tr_b16 a[124:125], v143 offset:12544
  ds_read_b64_tr_b16 a[126:127], v143 offset:15616
  ds_read_b64_tr_b16 a[200:201], v143 offset:512
  ds_read_b64_tr_b16 a[202:203], v143 offset:3584
  ds_read_b64_tr_b16 a[204:205], v143 offset:12800
  ds_read_b64_tr_b16 a[206:207], v143 offset:15872
  s_waitcnt lgkmcnt(0)
  s_waitcnt vmcnt(24)
  s_barrier
  s_lshl_b32 s29, s21, 10
  s_add_u32 m0, s29, 122880
  s_mov_b32 s28, 1572864
  buffer_load_dwordx4 v136, s[16:19], s28 offen lds
  s_lshl_b32 s29, s21, 10
  s_add_u32 m0, s29, 126976
  s_mov_b32 s28, 1572864
  buffer_load_dwordx4 v137, s[16:19], s28 offen lds
  s_lshl_b32 s29, s21, 10
  s_add_u32 m0, s29, 131072
  s_mov_b32 s28, 1572864
  buffer_load_dwordx4 v138, s[16:19], s28 offen lds
  s_lshl_b32 s29, s21, 10
  s_add_u32 m0, s29, 135168
  s_mov_b32 s28, 1572864
  buffer_load_dwordx4 v139, s[16:19], s28 offen lds
  s_lshl_b32 s29, s21, 10
  s_add_u32 m0, s29, 139264
  s_mov_b32 s28, 1572864
  buffer_load_dwordx4 v140, s[16:19], s28 offen lds
  s_lshl_b32 s29, s21, 10
  s_add_u32 m0, s29, 143360
  s_mov_b32 s28, 1572864
  buffer_load_dwordx4 v141, s[16:19], s28 offen lds
  v_add_u32 v143, 0, v142
  ds_read_b64_tr_b16 a[48:49], v143 offset:0
  ds_read_b64_tr_b16 a[50:51], v143 offset:3072
  ds_read_b64_tr_b16 a[52:53], v143 offset:12288
  ds_read_b64_tr_b16 a[54:55], v143 offset:15360
  ds_read_b64_tr_b16 a[128:129], v143 offset:256
  ds_read_b64_tr_b16 a[130:131], v143 offset:3328
  ds_read_b64_tr_b16 a[132:133], v143 offset:12544
  ds_read_b64_tr_b16 a[134:135], v143 offset:15616
  ds_read_b64_tr_b16 a[208:209], v143 offset:512
  ds_read_b64_tr_b16 a[210:211], v143 offset:3584
  ds_read_b64_tr_b16 a[212:213], v143 offset:12800
  ds_read_b64_tr_b16 a[214:215], v143 offset:15872
  s_waitcnt lgkmcnt(0)
  s_waitcnt vmcnt(24)
  s_barrier
  s_lshl_b32 s29, s21, 10
  s_add_u32 m0, s29, 0
  s_mov_b32 s28, 3145728
  buffer_load_dwordx4 v136, s[16:19], s28 offen lds
  s_lshl_b32 s29, s21, 10
  s_add_u32 m0, s29, 4096
  s_mov_b32 s28, 3145728
  buffer_load_dwordx4 v137, s[16:19], s28 offen lds
  s_lshl_b32 s29, s21, 10
  s_add_u32 m0, s29, 8192
  s_mov_b32 s28, 3145728
  buffer_load_dwordx4 v138, s[16:19], s28 offen lds
  s_lshl_b32 s29, s21, 10
  s_add_u32 m0, s29, 12288
  s_mov_b32 s28, 3145728
  buffer_load_dwordx4 v139, s[16:19], s28 offen lds
  s_lshl_b32 s29, s21, 10
  s_add_u32 m0, s29, 16384
  s_mov_b32 s28, 3145728
  buffer_load_dwordx4 v140, s[16:19], s28 offen lds
  s_lshl_b32 s29, s21, 10
  s_add_u32 m0, s29, 20480
  s_mov_b32 s28, 3145728
  buffer_load_dwordx4 v141, s[16:19], s28 offen lds
  v_add_u32 v143, 24576, v142
  ds_read_b64_tr_b16 a[56:57], v143 offset:0
  ds_read_b64_tr_b16 a[58:59], v143 offset:3072
  ds_read_b64_tr_b16 a[60:61], v143 offset:12288
  ds_read_b64_tr_b16 a[62:63], v143 offset:15360
  ds_read_b64_tr_b16 a[136:137], v143 offset:256
  ds_read_b64_tr_b16 a[138:139], v143 offset:3328
  ds_read_b64_tr_b16 a[140:141], v143 offset:12544
  ds_read_b64_tr_b16 a[142:143], v143 offset:15616
  ds_read_b64_tr_b16 a[216:217], v143 offset:512
  ds_read_b64_tr_b16 a[218:219], v143 offset:3584
  ds_read_b64_tr_b16 a[220:221], v143 offset:12800
  ds_read_b64_tr_b16 a[222:223], v143 offset:15872
  s_waitcnt lgkmcnt(0)
  s_waitcnt vmcnt(24)
  s_barrier
  s_lshl_b32 s29, s21, 10
  s_add_u32 m0, s29, 24576
  s_mov_b32 s28, 4718592
  buffer_load_dwordx4 v136, s[16:19], s28 offen lds
  s_lshl_b32 s29, s21, 10
  s_add_u32 m0, s29, 28672
  s_mov_b32 s28, 4718592
  buffer_load_dwordx4 v137, s[16:19], s28 offen lds
  s_lshl_b32 s29, s21, 10
  s_add_u32 m0, s29, 32768
  s_mov_b32 s28, 4718592
  buffer_load_dwordx4 v138, s[16:19], s28 offen lds
  s_lshl_b32 s29, s21, 10
  s_add_u32 m0, s29, 36864
  s_mov_b32 s28, 4718592
  buffer_load_dwordx4 v139, s[16:19], s28 offen lds
  s_lshl_b32 s29, s21, 10
  s_add_u32 m0, s29, 40960
  s_mov_b32 s28, 4718592
  buffer_load_dwordx4 v140, s[16:19], s28 offen lds
  s_lshl_b32 s29, s21, 10
  s_add_u32 m0, s29, 45056
  s_mov_b32 s28, 4718592
  buffer_load_dwordx4 v141, s[16:19], s28 offen lds
  v_add_u32 v143, 49152, v142
  ds_read_b64_tr_b16 a[64:65], v143 offset:0
  ds_read_b64_tr_b16 a[66:67], v143 offset:3072
  ds_read_b64_tr_b16 a[68:69], v143 offset:12288
  ds_read_b64_tr_b16 a[70:71], v143 offset:15360
  ds_read_b64_tr_b16 a[144:145], v143 offset:256
  ds_read_b64_tr_b16 a[146:147], v143 offset:3328
  ds_read_b64_tr_b16 a[148:149], v143 offset:12544
  ds_read_b64_tr_b16 a[150:151], v143 offset:15616
  ds_read_b64_tr_b16 a[224:225], v143 offset:512
  ds_read_b64_tr_b16 a[226:227], v143 offset:3584
  ds_read_b64_tr_b16 a[228:229], v143 offset:12800
  ds_read_b64_tr_b16 a[230:231], v143 offset:15872
  s_waitcnt lgkmcnt(0)
  s_waitcnt vmcnt(24)
  s_barrier
  s_lshl_b32 s29, s21, 10
  s_add_u32 m0, s29, 49152
  s_mov_b32 s28, 6291456
  buffer_load_dwordx4 v136, s[16:19], s28 offen lds
  s_lshl_b32 s29, s21, 10
  s_add_u32 m0, s29, 53248
  s_mov_b32 s28, 6291456
  buffer_load_dwordx4 v137, s[16:19], s28 offen lds
  s_lshl_b32 s29, s21, 10
  s_add_u32 m0, s29, 57344
  s_mov_b32 s28, 6291456
  buffer_load_dwordx4 v138, s[16:19], s28 offen lds
  s_lshl_b32 s29, s21, 10
  s_add_u32 m0, s29, 61440
  s_mov_b32 s28, 6291456
  buffer_load_dwordx4 v139, s[16:19], s28 offen lds
  s_lshl_b32 s29, s21, 10
  s_add_u32 m0, s29, 65536
  s_mov_b32 s28, 6291456
  buffer_load_dwordx4 v140, s[16:19], s28 offen lds
  s_lshl_b32 s29, s21, 10
  s_add_u32 m0, s29, 69632
  s_mov_b32 s28, 6291456
  buffer_load_dwordx4 v141, s[16:19], s28 offen lds
  v_add_u32 v143, 73728, v142
  ds_read_b64_tr_b16 a[72:73], v143 offset:0
  ds_read_b64_tr_b16 a[74:75], v143 offset:3072
  ds_read_b64_tr_b16 a[76:77], v143 offset:12288
  ds_read_b64_tr_b16 a[78:79], v143 offset:15360
  ds_read_b64_tr_b16 a[152:153], v143 offset:256
  ds_read_b64_tr_b16 a[154:155], v143 offset:3328
  ds_read_b64_tr_b16 a[156:157], v143 offset:12544
  ds_read_b64_tr_b16 a[158:159], v143 offset:15616
  ds_read_b64_tr_b16 a[232:233], v143 offset:512
  ds_read_b64_tr_b16 a[234:235], v143 offset:3584
  ds_read_b64_tr_b16 a[236:237], v143 offset:12800
  ds_read_b64_tr_b16 a[238:239], v143 offset:15872
  s_waitcnt lgkmcnt(0)
  s_waitcnt vmcnt(24)
  s_barrier
  s_lshl_b32 s29, s21, 10
  s_add_u32 m0, s29, 73728
  s_mov_b32 s28, 786432
  buffer_load_dwordx4 v136, s[16:19], s28 offen lds
  s_lshl_b32 s29, s21, 10
  s_add_u32 m0, s29, 77824
  s_mov_b32 s28, 786432
  buffer_load_dwordx4 v137, s[16:19], s28 offen lds
  s_lshl_b32 s29, s21, 10
  s_add_u32 m0, s29, 81920
  s_mov_b32 s28, 786432
  buffer_load_dwordx4 v138, s[16:19], s28 offen lds
  s_lshl_b32 s29, s21, 10
  s_add_u32 m0, s29, 86016
  s_mov_b32 s28, 786432
  buffer_load_dwordx4 v139, s[16:19], s28 offen lds
  s_lshl_b32 s29, s21, 10
  s_add_u32 m0, s29, 90112
  s_mov_b32 s28, 786432
  buffer_load_dwordx4 v140, s[16:19], s28 offen lds
  s_lshl_b32 s29, s21, 10
  s_add_u32 m0, s29, 94208
  s_mov_b32 s28, 786432
  buffer_load_dwordx4 v141, s[16:19], s28 offen lds
  v_add_u32 v143, 98304, v142
  ds_read_b64_tr_b16 a[240:241], v143 offset:0
  ds_read_b64_tr_b16 a[242:243], v143 offset:3072
  ds_read_b64_tr_b16 a[244:245], v143 offset:12288
  ds_read_b64_tr_b16 a[246:247], v143 offset:15360
  ds_read_b64_tr_b16 v[176:177], v143 offset:256
  ds_read_b64_tr_b16 v[178:179], v143 offset:3328
  ds_read_b64_tr_b16 v[180:181], v143 offset:12544
  ds_read_b64_tr_b16 v[182:183], v143 offset:15616
  ds_read_b64_tr_b16 v[216:217], v143 offset:512
  ds_read_b64_tr_b16 v[218:219], v143 offset:3584
  ds_read_b64_tr_b16 v[220:221], v143 offset:12800
  ds_read_b64_tr_b16 v[222:223], v143 offset:15872
  s_waitcnt lgkmcnt(0)
  s_waitcnt vmcnt(24)
  s_barrier
  s_lshl_b32 s29, s21, 10
  s_add_u32 m0, s29, 98304
  s_mov_b32 s28, 2359296
  buffer_load_dwordx4 v136, s[16:19], s28 offen lds
  s_lshl_b32 s29, s21, 10
  s_add_u32 m0, s29, 102400
  s_mov_b32 s28, 2359296
  buffer_load_dwordx4 v137, s[16:19], s28 offen lds
  s_lshl_b32 s29, s21, 10
  s_add_u32 m0, s29, 106496
  s_mov_b32 s28, 2359296
  buffer_load_dwordx4 v138, s[16:19], s28 offen lds
  s_lshl_b32 s29, s21, 10
  s_add_u32 m0, s29, 110592
  s_mov_b32 s28, 2359296
  buffer_load_dwordx4 v139, s[16:19], s28 offen lds
  s_lshl_b32 s29, s21, 10
  s_add_u32 m0, s29, 114688
  s_mov_b32 s28, 2359296
  buffer_load_dwordx4 v140, s[16:19], s28 offen lds
  s_lshl_b32 s29, s21, 10
  s_add_u32 m0, s29, 118784
  s_mov_b32 s28, 2359296
  buffer_load_dwordx4 v141, s[16:19], s28 offen lds
  v_add_u32 v143, 122880, v142
  ds_read_b64_tr_b16 a[248:249], v143 offset:0
  ds_read_b64_tr_b16 a[250:251], v143 offset:3072
  ds_read_b64_tr_b16 a[252:253], v143 offset:12288
  ds_read_b64_tr_b16 a[254:255], v143 offset:15360
  ds_read_b64_tr_b16 v[184:185], v143 offset:256
  ds_read_b64_tr_b16 v[186:187], v143 offset:3328
  ds_read_b64_tr_b16 v[188:189], v143 offset:12544
  ds_read_b64_tr_b16 v[190:191], v143 offset:15616
  ds_read_b64_tr_b16 v[224:225], v143 offset:512
  ds_read_b64_tr_b16 v[226:227], v143 offset:3584
  ds_read_b64_tr_b16 v[228:229], v143 offset:12800
  ds_read_b64_tr_b16 v[230:231], v143 offset:15872
  s_waitcnt lgkmcnt(0)
  s_waitcnt vmcnt(24)
  s_barrier
  s_lshl_b32 s29, s21, 10
  s_add_u32 m0, s29, 122880
  s_mov_b32 s28, 3932160
  buffer_load_dwordx4 v136, s[16:19], s28 offen lds
  s_lshl_b32 s29, s21, 10
  s_add_u32 m0, s29, 126976
  s_mov_b32 s28, 3932160
  buffer_load_dwordx4 v137, s[16:19], s28 offen lds
  s_lshl_b32 s29, s21, 10
  s_add_u32 m0, s29, 131072
  s_mov_b32 s28, 3932160
  buffer_load_dwordx4 v138, s[16:19], s28 offen lds
  s_lshl_b32 s29, s21, 10
  s_add_u32 m0, s29, 135168
  s_mov_b32 s28, 3932160
  buffer_load_dwordx4 v139, s[16:19], s28 offen lds
  s_lshl_b32 s29, s21, 10
  s_add_u32 m0, s29, 139264
  s_mov_b32 s28, 3932160
  buffer_load_dwordx4 v140, s[16:19], s28 offen lds
  s_lshl_b32 s29, s21, 10
  s_add_u32 m0, s29, 143360
  s_mov_b32 s28, 3932160
  buffer_load_dwordx4 v141, s[16:19], s28 offen lds
  v_add_u32 v143, 0, v142
  ds_read_b64_tr_b16 v[152:153], v143 offset:0
  ds_read_b64_tr_b16 v[154:155], v143 offset:3072
  ds_read_b64_tr_b16 v[156:157], v143 offset:12288
  ds_read_b64_tr_b16 v[158:159], v143 offset:15360
  ds_read_b64_tr_b16 v[192:193], v143 offset:256
  ds_read_b64_tr_b16 v[194:195], v143 offset:3328
  ds_read_b64_tr_b16 v[196:197], v143 offset:12544
  ds_read_b64_tr_b16 v[198:199], v143 offset:15616
  ds_read_b64_tr_b16 v[232:233], v143 offset:512
  ds_read_b64_tr_b16 v[234:235], v143 offset:3584
  ds_read_b64_tr_b16 v[236:237], v143 offset:12800
  ds_read_b64_tr_b16 v[238:239], v143 offset:15872
  s_waitcnt lgkmcnt(0)
  s_waitcnt vmcnt(24)
  s_barrier
  s_lshl_b32 s29, s21, 10
  s_add_u32 m0, s29, 0
  s_mov_b32 s28, 5505024
  buffer_load_dwordx4 v136, s[16:19], s28 offen lds
  s_lshl_b32 s29, s21, 10
  s_add_u32 m0, s29, 4096
  s_mov_b32 s28, 5505024
  buffer_load_dwordx4 v137, s[16:19], s28 offen lds
  s_lshl_b32 s29, s21, 10
  s_add_u32 m0, s29, 8192
  s_mov_b32 s28, 5505024
  buffer_load_dwordx4 v138, s[16:19], s28 offen lds
  s_lshl_b32 s29, s21, 10
  s_add_u32 m0, s29, 12288
  s_mov_b32 s28, 5505024
  buffer_load_dwordx4 v139, s[16:19], s28 offen lds
  s_lshl_b32 s29, s21, 10
  s_add_u32 m0, s29, 16384
  s_mov_b32 s28, 5505024
  buffer_load_dwordx4 v140, s[16:19], s28 offen lds
  s_lshl_b32 s29, s21, 10
  s_add_u32 m0, s29, 20480
  s_mov_b32 s28, 5505024
  buffer_load_dwordx4 v141, s[16:19], s28 offen lds
  v_add_u32 v143, 24576, v142
  ds_read_b64_tr_b16 v[160:161], v143 offset:0
  ds_read_b64_tr_b16 v[162:163], v143 offset:3072
  ds_read_b64_tr_b16 v[164:165], v143 offset:12288
  ds_read_b64_tr_b16 v[166:167], v143 offset:15360
  ds_read_b64_tr_b16 v[200:201], v143 offset:256
  ds_read_b64_tr_b16 v[202:203], v143 offset:3328
  ds_read_b64_tr_b16 v[204:205], v143 offset:12544
  ds_read_b64_tr_b16 v[206:207], v143 offset:15616
  ds_read_b64_tr_b16 v[240:241], v143 offset:512
  ds_read_b64_tr_b16 v[242:243], v143 offset:3584
  ds_read_b64_tr_b16 v[244:245], v143 offset:12800
  ds_read_b64_tr_b16 v[246:247], v143 offset:15872
  s_waitcnt lgkmcnt(0)
  s_waitcnt vmcnt(24)
  s_barrier
  s_lshl_b32 s29, s21, 10
  s_add_u32 m0, s29, 24576
  s_mov_b32 s28, 7077888
  buffer_load_dwordx4 v136, s[16:19], s28 offen lds
  s_lshl_b32 s29, s21, 10
  s_add_u32 m0, s29, 28672
  s_mov_b32 s28, 7077888
  buffer_load_dwordx4 v137, s[16:19], s28 offen lds
  s_lshl_b32 s29, s21, 10
  s_add_u32 m0, s29, 32768
  s_mov_b32 s28, 7077888
  buffer_load_dwordx4 v138, s[16:19], s28 offen lds
  s_lshl_b32 s29, s21, 10
  s_add_u32 m0, s29, 36864
  s_mov_b32 s28, 7077888
  buffer_load_dwordx4 v139, s[16:19], s28 offen lds
  s_lshl_b32 s29, s21, 10
  s_add_u32 m0, s29, 40960
  s_mov_b32 s28, 7077888
  buffer_load_dwordx4 v140, s[16:19], s28 offen lds
  s_lshl_b32 s29, s21, 10
  s_add_u32 m0, s29, 45056
  s_mov_b32 s28, 7077888
  buffer_load_dwordx4 v141, s[16:19], s28 offen lds
  v_add_u32 v143, 49152, v142
  ds_read_b64_tr_b16 v[168:169], v143 offset:0
  ds_read_b64_tr_b16 v[170:171], v143 offset:3072
  ds_read_b64_tr_b16 v[172:173], v143 offset:12288
  ds_read_b64_tr_b16 v[174:175], v143 offset:15360
  ds_read_b64_tr_b16 v[208:209], v143 offset:256
  ds_read_b64_tr_b16 v[210:211], v143 offset:3328
  ds_read_b64_tr_b16 v[212:213], v143 offset:12544
  ds_read_b64_tr_b16 v[214:215], v143 offset:15616
  ds_read_b64_tr_b16 v[248:249], v143 offset:512
  ds_read_b64_tr_b16 v[250:251], v143 offset:3584
  ds_read_b64_tr_b16 v[252:253], v143 offset:12800
  ds_read_b64_tr_b16 v[254:255], v143 offset:15872
  s_waitcnt lgkmcnt(0)
  s_waitcnt vmcnt(24)
  s_barrier
  v_add_u32 v143, 73728, v142
  ds_read_b64_tr_b16 v[16:17], v143 offset:0
  ds_read_b64_tr_b16 v[18:19], v143 offset:3072
  ds_read_b64_tr_b16 v[20:21], v143 offset:12288
  ds_read_b64_tr_b16 v[22:23], v143 offset:15360
  ds_read_b64_tr_b16 v[24:25], v143 offset:256
  ds_read_b64_tr_b16 v[26:27], v143 offset:3328
  ds_read_b64_tr_b16 v[28:29], v143 offset:12544
  ds_read_b64_tr_b16 v[30:31], v143 offset:15616
  ds_read_b64_tr_b16 v[32:33], v143 offset:512
  ds_read_b64_tr_b16 v[34:35], v143 offset:3584
  ds_read_b64_tr_b16 v[36:37], v143 offset:12800
  ds_read_b64_tr_b16 v[38:39], v143 offset:15872
  s_waitcnt lgkmcnt(0)
  s_waitcnt vmcnt(18)
  s_barrier
  v_add_u32 v143, 98304, v142
  ds_read_b64_tr_b16 v[40:41], v143 offset:0
  ds_read_b64_tr_b16 v[42:43], v143 offset:3072
  ds_read_b64_tr_b16 v[44:45], v143 offset:12288
  ds_read_b64_tr_b16 v[46:47], v143 offset:15360
  ds_read_b64_tr_b16 v[48:49], v143 offset:256
  ds_read_b64_tr_b16 v[50:51], v143 offset:3328
  ds_read_b64_tr_b16 v[52:53], v143 offset:12544
  ds_read_b64_tr_b16 v[54:55], v143 offset:15616
  ds_read_b64_tr_b16 v[56:57], v143 offset:512
  ds_read_b64_tr_b16 v[58:59], v143 offset:3584
  ds_read_b64_tr_b16 v[60:61], v143 offset:12800
  ds_read_b64_tr_b16 v[62:63], v143 offset:15872
  s_waitcnt lgkmcnt(0)
  s_waitcnt vmcnt(12)
  s_barrier
  v_add_u32 v143, 122880, v142
  ds_read_b64_tr_b16 v[64:65], v143 offset:0
  ds_read_b64_tr_b16 v[66:67], v143 offset:3072
  ds_read_b64_tr_b16 v[68:69], v143 offset:12288
  ds_read_b64_tr_b16 v[70:71], v143 offset:15360
  ds_read_b64_tr_b16 v[72:73], v143 offset:256
  ds_read_b64_tr_b16 v[74:75], v143 offset:3328
  ds_read_b64_tr_b16 v[76:77], v143 offset:12544
  ds_read_b64_tr_b16 v[78:79], v143 offset:15616
  ds_read_b64_tr_b16 v[80:81], v143 offset:512
  ds_read_b64_tr_b16 v[82:83], v143 offset:3584
  ds_read_b64_tr_b16 v[84:85], v143 offset:12800
  ds_read_b64_tr_b16 v[86:87], v143 offset:15872
  s_waitcnt lgkmcnt(0)
  s_waitcnt vmcnt(6)
  s_barrier
  v_add_u32 v143, 0, v142
  ds_read_b64_tr_b16 v[88:89], v143 offset:0
  ds_read_b64_tr_b16 v[90:91], v143 offset:3072
  ds_read_b64_tr_b16 v[92:93], v143 offset:12288
  ds_read_b64_tr_b16 v[94:95], v143 offset:15360
  ds_read_b64_tr_b16 v[96:97], v143 offset:256
  ds_read_b64_tr_b16 v[98:99], v143 offset:3328
  ds_read_b64_tr_b16 v[100:101], v143 offset:12544
  ds_read_b64_tr_b16 v[102:103], v143 offset:15616
  ds_read_b64_tr_b16 v[104:105], v143 offset:512
  ds_read_b64_tr_b16 v[106:107], v143 offset:3584
  ds_read_b64_tr_b16 v[108:109], v143 offset:12800
  ds_read_b64_tr_b16 v[110:111], v143 offset:15872
  s_waitcnt lgkmcnt(0)
  s_waitcnt vmcnt(0)
  s_barrier
  v_add_u32 v143, 24576, v142
  ds_read_b64_tr_b16 v[112:113], v143 offset:0
  ds_read_b64_tr_b16 v[114:115], v143 offset:3072
  ds_read_b64_tr_b16 v[116:117], v143 offset:12288
  ds_read_b64_tr_b16 v[118:119], v143 offset:15360
  ds_read_b64_tr_b16 v[120:121], v143 offset:256
  ds_read_b64_tr_b16 v[122:123], v143 offset:3328
  ds_read_b64_tr_b16 v[124:125], v143 offset:12544
  ds_read_b64_tr_b16 v[126:127], v143 offset:15616
  ds_read_b64_tr_b16 v[128:129], v143 offset:512
  ds_read_b64_tr_b16 v[130:131], v143 offset:3584
  ds_read_b64_tr_b16 v[132:133], v143 offset:12800
  ds_read_b64_tr_b16 v[134:135], v143 offset:15872
  s_waitcnt lgkmcnt(0)
  s_barrier
  v_lshlrev_b32 v2, 4, v1
  s_mul_i32 s28, s21, 30720
  v_add_u32 v143, s28, v2
  ds_write_b128 v143, v[16:19] offset:0
  ds_write_b128 v143, v[20:23] offset:1024
  ds_write_b128 v143, v[24:27] offset:10240
  ds_write_b128 v143, v[28:31] offset:11264
  ds_write_b128 v143, v[32:35] offset:20480
  ds_write_b128 v143, v[36:39] offset:21504
  ds_write_b128 v143, v[40:43] offset:2048
  ds_write_b128 v143, v[44:47] offset:3072
  ds_write_b128 v143, v[48:51] offset:12288
  ds_write_b128 v143, v[52:55] offset:13312
  ds_write_b128 v143, v[56:59] offset:22528
  ds_write_b128 v143, v[60:63] offset:23552
  ds_write_b128 v143, v[64:67] offset:4096
  ds_write_b128 v143, v[68:71] offset:5120
  ds_write_b128 v143, v[72:75] offset:14336
  ds_write_b128 v143, v[76:79] offset:15360
  ds_write_b128 v143, v[80:83] offset:24576
  ds_write_b128 v143, v[84:87] offset:25600
  ds_write_b128 v143, v[88:91] offset:6144
  ds_write_b128 v143, v[92:95] offset:7168
  ds_write_b128 v143, v[96:99] offset:16384
  ds_write_b128 v143, v[100:103] offset:17408
  ds_write_b128 v143, v[104:107] offset:26624
  ds_write_b128 v143, v[108:111] offset:27648
  ds_write_b128 v143, v[112:115] offset:8192
  ds_write_b128 v143, v[116:119] offset:9216
  ds_write_b128 v143, v[120:123] offset:18432
  ds_write_b128 v143, v[124:127] offset:19456
  ds_write_b128 v143, v[128:131] offset:28672
  ds_write_b128 v143, v[132:135] offset:29696
  s_waitcnt lgkmcnt(0)
  v_and_b32 v1, 63, v0
  v_lshlrev_b32 v132, 4, v1
  s_mul_i32 s28, s21, 30720
  v_add_u32 v129, s28, v132
  s_lshl_b32 s28, s21, 10
  v_add_u32 v124, s28, v132
  v_add_u32 v125, 4096, v124
  v_add_u32 v126, 8192, v124
  v_add_u32 v127, 122880, v124
  v_add_u32 v128, 122880, v132
  v_and_b32 v2, 15, v1
  v_lshrrev_b32 v3, 4, v1
  v_add_u32 v3, v3, v2
  v_and_b32 v3, 3, v3
  v_lshlrev_b32 v3, 4, v3
  v_lshlrev_b32 v2, 6, v2
  v_add_u32 v2, v2, v3
  s_mul_i32 s28, s21, 3072
  s_add_u32 s28, s28, 133120
  v_add_u32 v130, s28, v2
  s_mul_i32 s28, s21, 1536
  s_add_u32 s28, s28, 145408
  v_lshlrev_b32 v2, 3, v1
  v_add_u32 v131, s28, v2
  v_mov_b32 v110, 0x44444444
  v_mov_b32 v2, 0xeeeeeeee
  v_and_b32 v3, 8, v1
  v_cmp_ne_u32 vcc, 0, v3
  s_nop 1
  v_cndmask_b32 v110, v110, v2, vcc
  v_and_b32 v4, 15, v1
  v_lshrrev_b32 v5, 4, v1
  v_lshlrev_b32 v6, 2, v5
  v_sub_u32 v6, v4, v6
  v_mov_b32 v7, 0x3f80
  v_mov_b32 v8, 0x3f800000
  v_mov_b32 v108, 0
  v_mov_b32 v109, 0
  v_cmp_eq_u32 vcc, 0, v6
  s_nop 1
  v_cndmask_b32 v108, v108, v7, vcc
  v_cmp_eq_u32 vcc, 1, v6
  s_nop 1
  v_cndmask_b32 v108, v108, v8, vcc
  v_cmp_eq_u32 vcc, 2, v6
  s_nop 1
  v_cndmask_b32 v109, v109, v7, vcc
  v_cmp_eq_u32 vcc, 3, v6
  s_nop 1
  v_cndmask_b32 v109, v109, v8, vcc
  s_mul_i32 s28, s23, 6
  s_lshr_b32 s29, s28, 3
  s_add_u32 s28, s28, 5
  s_lshr_b32 s28, s28, 3
  v_mov_b32 v6, s29
  v_mov_b32 v7, s28
  v_and_b32 v8, 1, v1
  v_cmp_eq_u32 vcc, 1, v8
  s_nop 1
  v_cndmask_b32 v6, v6, v7, vcc
  v_lshlrev_b32 v6, 2, v6
  v_bfe_u32 v8, v1, 1, 1
  v_lshlrev_b32 v8, 10, v8
  v_add_u32 v6, v6, v8
  v_add_u32 v138, 0, v6
  s_mul_i32 s97, s20, 655360
  s_add_u32 s97, s97, 0x400000
  s_mov_b32 s48, 0x4000
  s_mul_i32 s49, s20, 327680
  s_add_u32 s49, s49, 0x700000
  s_mul_i32 s50, s23, 786432
  s_add_u32 s63, s50, 0x4800000
  s_add_u32 s50, s50, 0x6000000
  s_mov_b32 s51, 0
  s_mov_b32 s52, 0
  s_mul_i32 s28, s21, 3
  s_add_u32 s28, s28, 0
  s_lshr_b32 s29, s28, 1
  s_lshl_b32 s29, s29, 11
  s_and_b32 s28, s28, 1
  s_lshl_b32 s28, s28, 3
  s_add_u32 s53, s29, s28
  s_mul_i32 s28, s21, 3
  s_add_u32 s28, s28, 1
  s_lshr_b32 s29, s28, 1
  s_lshl_b32 s29, s29, 11
  s_and_b32 s28, s28, 1
  s_lshl_b32 s28, s28, 3
  s_add_u32 s54, s29, s28
  s_mul_i32 s28, s21, 3
  s_add_u32 s28, s28, 2
  s_lshr_b32 s29, s28, 1
  s_lshl_b32 s29, s29, 11
  s_and_b32 s28, s28, 1
  s_lshl_b32 s28, s28, 3
  s_add_u32 s55, s29, s28
  v_mov_b32 v60, 0
  v_mov_b32 v61, 0
  v_mov_b32 v62, 0
  v_mov_b32 v63, 0
  v_mov_b32 v64, 0
  v_mov_b32 v65, 0
  v_mov_b32 v66, 0
  v_mov_b32 v67, 0
  v_mov_b32 v68, 0
  v_mov_b32 v69, 0
  v_mov_b32 v70, 0
  v_mov_b32 v71, 0
  v_mov_b32 v72, 0
  v_mov_b32 v73, 0
  v_mov_b32 v74, 0
  v_mov_b32 v75, 0
  v_mov_b32 v36, 0
  v_mov_b32 v37, 0
  v_mov_b32 v38, 0
  v_mov_b32 v39, 0
  v_mov_b32 v40, 0
  v_mov_b32 v41, 0
  v_mov_b32 v42, 0
  v_mov_b32 v43, 0
  s_barrier
  s_cmp_gt_u32 s52, s51
  s_cbranch_scc1 ka\sfx\()_x_wp_63_ok
  s_mov_b32 s45, 0
ka\sfx\()_x_wp_63_spin:
  buffer_load_dword v2, v138, s[8:11], 0 offen sc1
  s_add_u32 s45, s45, 1
  s_waitcnt vmcnt(0)
  v_min_u32_dpp v3, v2, v2 quad_perm:[1,0,3,2] row_mask:0xf bank_mask:0xf
  s_nop 1
  v_min_u32_dpp v2, v3, v3 quad_perm:[2,3,0,1] row_mask:0xf bank_mask:0xf
  s_nop 1
  v_min_u32_dpp v3, v2, v2 row_half_mirror row_mask:0xf bank_mask:0xf
  s_nop 1
  v_min_u32_dpp v2, v3, v3 quad_perm:[0,1,2,3] row_mask:0xf bank_mask:0xf
  s_nop 0
  v_readfirstlane_b32 s52, v2
  s_cmp_gt_u32 s52, s51
  s_cbranch_scc1 ka\sfx\()_x_wp_63_ok
  s_cmp_lt_u32 s45, 400000
  s_cbranch_scc1 ka\sfx\()_x_wp_63_spin
  s_branch ka\sfx\()_abort
ka\sfx\()_x_wp_63_ok:
  s_add_u32 s28, s50, s53
  buffer_load_dwordx2 v[88:89], v132, s[8:11], s28 offen offset:0 sc1
  buffer_load_dwordx2 v[92:93], v132, s[8:11], s28 offen offset:1024 sc1
  s_add_u32 s28, s50, s54
  buffer_load_dwordx2 v[90:91], v132, s[8:11], s28 offen offset:0 sc1
  buffer_load_dwordx2 v[94:95], v132, s[8:11], s28 offen offset:1024 sc1
  s_add_u32 s28, s50, s55
  buffer_load_dwordx2 v[96:97], v132, s[8:11], s28 offen offset:0 sc1
  buffer_load_dwordx2 v[98:99], v132, s[8:11], s28 offen offset:1024 sc1
  s_cmp_eq_u32 s21, 0
  s_cbranch_scc1 ka\sfx\()_x_w0
  s_cmp_eq_u32 s21, 1
  s_cbranch_scc1 ka\sfx\()_x_w1
  s_branch ka\sfx\()_x_w23
ka\sfx\()_x_w0:
  v_lshrrev_b32 v4, 3, v1
  v_and_b32 v5, 7, v1
  v_lshrrev_b32 v6, 2, v5
  v_and_b32 v7, 3, v5
  v_lshlrev_b32 v8, 10, v6
  v_lshlrev_b32 v9, 6, v4
  v_add_u32 v8, v8, v9
  v_add_u32 v9, v7, v4
  v_and_b32 v9, 3, v9
  v_lshlrev_b32 v9, 4, v9
  v_add_u32 v8, v8, v9
  v_add_u32 v133, 134144, v8
  v_add_u32 v8, 2, v6
  v_add_u32 v8, v8, v4
  v_and_b32 v8, 3, v8
  v_lshlrev_b32 v8, 4, v8
  v_lshlrev_b32 v9, 6, v4
  v_add_u32 v8, v8, v9
  v_lshlrev_b32 v9, 2, v7
  v_add_u32 v8, v8, v9
  v_add_u32 v134, 133120, v8
  s_and_b32 s26, s23, 7
  v_and_b32 v8, 1, v7
  v_lshlrev_b32 v8, 1, v8
  v_add_u32 v8, v8, v6
  v_lshlrev_b32 v8, 4, v8
  v_add_u32 v8, v8, v4
  v_lshlrev_b32 v8, 4, v8
  v_lshrrev_b32 v9, 1, v7
  v_lshlrev_b32 v9, 3, v9
  v_add_u32 v8, v8, v9
  s_lshr_b32 s28, s26, 1
  s_lshl_b32 s28, s28, 10
  s_and_b32 s29, s26, 1
  s_lshl_b32 s29, s29, 7
  s_add_u32 s28, s28, s29
  v_add_u32 v135, s28, v8
  v_lshlrev_b32 v8, 4, v6
  v_add_u32 v8, v8, v4
  v_lshlrev_b32 v8, 4, v8
  v_lshlrev_b32 v9, 1, v7
  v_add_u32 v8, v8, v9
  s_lshr_b32 s28, s26, 2
  s_lshl_b32 s28, s28, 7
  s_and_b32 s29, s26, 1
  s_lshl_b32 s29, s29, 9
  s_add_u32 s28, s28, s29
  s_bfe_u32 s29, s26, 0x10001
  s_lshl_b32 s29, s29, 3
  s_add_u32 s28, s28, s29
  s_add_u32 s28, s28, 4096
  v_add_u32 v8, s28, v8
  v_mov_b32 v9, 0x40000000
  v_and_b32 v10, 1, v5
  v_cmp_eq_u32 vcc, 0, v10
  s_nop 1
  v_cndmask_b32 v136, v9, v8, vcc
  s_mov_b32 s64, 0x3dd53b95
  s_mov_b32 s65, 0x3dd53b95
  v_mov_b32 v137, 0x42800000
ka\sfx\()_x_w0l:
  ds_read_b128 v[44:47], v129 offset:0
  ds_read_b128 v[48:51], v129 offset:1024
  ds_read_b128 v[52:55], v129 offset:2048
  ds_read_b128 v[56:59], v129 offset:3072
  s_waitcnt lgkmcnt(0)
  s_mov_b32 s45, 0
ka\sfx\()_x_pf_64:
  buffer_load_dwordx4 v[112:115], v124, s[8:11], s48 offen sc1
  buffer_load_dwordx4 v[116:119], v125, s[8:11], s48 offen sc1
  buffer_load_dwordx4 v[120:123], v126, s[8:11], s48 offen sc1
  s_add_u32 s45, s45, 1
  s_waitcnt vmcnt(2)
  ds_write_b128 v127, v[112:115] offset:0
  v_max3_u32 v139, v112, v113, v114
  v_max_u32 v139, v139, v115
  s_waitcnt vmcnt(1)
  ds_write_b128 v127, v[116:119] offset:4096
  v_max3_u32 v139, v139, v116, v117
  v_max3_u32 v139, v139, v118, v119
  s_waitcnt vmcnt(0)
  ds_write_b128 v127, v[120:123] offset:8192
  v_max3_u32 v139, v139, v120, v121
  v_max3_u32 v139, v139, v122, v123
  v_cmp_eq_u32 vcc, -1, v139
  s_cbranch_vccz ka\sfx\()_x_pf_64_ok
  s_cmp_lt_u32 s45, 400000
  s_cbranch_scc1 ka\sfx\()_x_pf_64
  s_branch ka\sfx\()_abort
ka\sfx\()_x_pf_64_ok:
  v_smfmac_f32_16x16x64_bf16 v[60:63], v[112:115], a[0:7], v110
  v_smfmac_f32_16x16x64_bf16 v[64:67], v[112:115], a[240:247], v110
  v_smfmac_f32_16x16x64_bf16 v[68:71], v[112:115], a[80:87], v110
  v_smfmac_f32_16x16x64_bf16 v[72:75], v[112:115], v[176:183], v110
  s_waitcnt lgkmcnt(0)
  s_barrier
  v_smfmac_f32_16x16x64_bf16 v[36:39], v[112:115], a[160:167], v110
  ds_read_b128 v[4:7], v128 offset:1024
  v_smfmac_f32_16x16x64_bf16 v[40:43], v[112:115], v[216:223], v110
  ds_read_b128 v[8:11], v128 offset:2048
  v_smfmac_f32_16x16x64_bf16 v[60:63], v[116:119], a[32:39], v110
  ds_read_b128 v[12:15], v128 offset:3072
  v_smfmac_f32_16x16x64_bf16 v[64:67], v[116:119], v[152:159], v110
  ds_read_b128 v[16:19], v128 offset:5120
  v_smfmac_f32_16x16x64_bf16 v[68:71], v[116:119], a[112:119], v110
  ds_read_b128 v[20:23], v128 offset:6144
  v_smfmac_f32_16x16x64_bf16 v[72:75], v[116:119], v[192:199], v110
  ds_read_b128 v[24:27], v128 offset:7168
  v_smfmac_f32_16x16x64_bf16 v[36:39], v[116:119], a[192:199], v110
  ds_read_b128 v[28:31], v128 offset:9216
  v_smfmac_f32_16x16x64_bf16 v[40:43], v[116:119], v[232:239], v110
  v_smfmac_f32_16x16x64_bf16 v[60:63], v[120:123], a[64:71], v110
  v_smfmac_f32_16x16x64_bf16 v[64:67], v[120:123], v[168:175], v110
  v_smfmac_f32_16x16x64_bf16 v[68:71], v[120:123], a[144:151], v110
  v_smfmac_f32_16x16x64_bf16 v[72:75], v[120:123], v[208:215], v110
  v_smfmac_f32_16x16x64_bf16 v[36:39], v[120:123], a[224:231], v110
  v_smfmac_f32_16x16x64_bf16 v[40:43], v[120:123], v[248:255], v110
  s_waitcnt lgkmcnt(6)
  v_smfmac_f32_16x16x64_bf16 v[60:63], v[4:7], a[8:15], v110
  v_smfmac_f32_16x16x64_bf16 v[64:67], v[4:7], v[44:51], v110
  ds_read_b128 v[44:47], v129 offset:4096
  s_waitcnt lgkmcnt(6)
  v_smfmac_f32_16x16x64_bf16 v[60:63], v[8:11], a[16:23], v110
  ds_read_b128 v[48:51], v129 offset:5120
  v_smfmac_f32_16x16x64_bf16 v[64:67], v[8:11], a[248:255], v110
  s_waitcnt lgkmcnt(6)
  v_smfmac_f32_16x16x64_bf16 v[60:63], v[12:15], a[24:31], v110
  v_smfmac_f32_16x16x64_bf16 v[64:67], v[12:15], v[52:59], v110
  ds_read_b128 v[52:55], v129 offset:6144
  s_waitcnt lgkmcnt(6)
  v_smfmac_f32_16x16x64_bf16 v[60:63], v[16:19], a[40:47], v110
  ds_read_b128 v[56:59], v129 offset:7168
  s_waitcnt lgkmcnt(2)
  v_smfmac_f32_16x16x64_bf16 v[64:67], v[16:19], v[44:51], v110
  ds_read_b128 v[44:47], v129 offset:8192
  v_smfmac_f32_16x16x64_bf16 v[60:63], v[20:23], a[48:55], v110
  ds_read_b128 v[48:51], v129 offset:9216
  v_smfmac_f32_16x16x64_bf16 v[64:67], v[20:23], v[160:167], v110
  v_smfmac_f32_16x16x64_bf16 v[60:63], v[24:27], a[56:63], v110
  s_waitcnt lgkmcnt(2)
  v_smfmac_f32_16x16x64_bf16 v[64:67], v[24:27], v[52:59], v110
  ds_read_b128 v[52:55], v129 offset:10240
  v_smfmac_f32_16x16x64_bf16 v[60:63], v[28:31], a[72:79], v110
  ds_read_b128 v[56:59], v129 offset:11264
  s_waitcnt lgkmcnt(2)
  v_smfmac_f32_16x16x64_bf16 v[64:67], v[28:31], v[44:51], v110
  ds_read_b128 v[44:47], v129 offset:12288
  v_smfmac_f32_16x16x64_bf16 v[68:71], v[4:7], a[88:95], v110
  ds_read_b128 v[48:51], v129 offset:13312
  s_waitcnt lgkmcnt(2)
  v_smfmac_f32_16x16x64_bf16 v[72:75], v[4:7], v[52:59], v110
  ds_read_b128 v[52:55], v129 offset:14336
  v_permlane32_swap_b32 v60, v64
  v_smfmac_f32_16x16x64_bf16 v[68:71], v[8:11], a[96:103], v110
  ds_read_b128 v[56:59], v129 offset:15360
  v_smfmac_f32_16x16x64_bf16 v[72:75], v[8:11], v[184:191], v110
  v_permlane32_swap_b32 v61, v65
  v_smfmac_f32_16x16x64_bf16 v[68:71], v[12:15], a[104:111], v110
  s_waitcnt lgkmcnt(2)
  v_smfmac_f32_16x16x64_bf16 v[72:75], v[12:15], v[44:51], v110
  ds_read_b128 v[44:47], v129 offset:16384
  v_permlane32_swap_b32 v62, v66
  v_smfmac_f32_16x16x64_bf16 v[68:71], v[16:19], a[120:127], v110
  ds_read_b128 v[48:51], v129 offset:17408
  v_permlane32_swap_b32 v63, v67
  s_waitcnt lgkmcnt(2)
  v_smfmac_f32_16x16x64_bf16 v[72:75], v[16:19], v[52:59], v110
  ds_read_b128 v[52:55], v129 offset:18432
  v_add_f32 v60, v60, v64
  v_smfmac_f32_16x16x64_bf16 v[68:71], v[20:23], a[128:135], v110
  ds_read_b128 v[56:59], v129 offset:19456
  v_add_f32 v61, v61, v65
  v_smfmac_f32_16x16x64_bf16 v[72:75], v[20:23], v[200:207], v110
  v_add_f32 v62, v62, v66
  v_smfmac_f32_16x16x64_bf16 v[68:71], v[24:27], a[136:143], v110
  v_add_f32 v63, v63, v67
  s_waitcnt lgkmcnt(2)
  v_smfmac_f32_16x16x64_bf16 v[72:75], v[24:27], v[44:51], v110
  ds_read_b128 v[44:47], v129 offset:20480
  v_cvt_pk_bf16_f32 v100, v60, v61
  v_smfmac_f32_16x16x64_bf16 v[68:71], v[28:31], a[152:159], v110
  ds_read_b128 v[48:51], v129 offset:21504
  v_cvt_pk_bf16_f32 v101, v62, v63
  s_waitcnt lgkmcnt(2)
  v_smfmac_f32_16x16x64_bf16 v[72:75], v[28:31], v[52:59], v110
  ds_read_b128 v[52:55], v129 offset:22528
  v_smfmac_f32_16x16x64_bf16 v[36:39], v[4:7], a[168:175], v110
  ds_read_b128 v[56:59], v129 offset:23552
  s_waitcnt lgkmcnt(2)
  v_smfmac_f32_16x16x64_bf16 v[40:43], v[4:7], v[44:51], v110
  ds_read_b128 v[44:47], v129 offset:24576
  v_permlane32_swap_b32 v68, v72
  v_smfmac_f32_16x16x64_bf16 v[36:39], v[8:11], a[176:183], v110
  ds_read_b128 v[48:51], v129 offset:25600
  v_smfmac_f32_16x16x64_bf16 v[40:43], v[8:11], v[224:231], v110
  v_permlane32_swap_b32 v69, v73
  v_smfmac_f32_16x16x64_bf16 v[36:39], v[12:15], a[184:191], v110
  s_waitcnt lgkmcnt(2)
  v_smfmac_f32_16x16x64_bf16 v[40:43], v[12:15], v[52:59], v110
  ds_read_b128 v[52:55], v129 offset:26624
  v_permlane32_swap_b32 v70, v74
  v_smfmac_f32_16x16x64_bf16 v[36:39], v[16:19], a[200:207], v110
  ds_read_b128 v[56:59], v129 offset:27648
  v_permlane32_swap_b32 v71, v75
  s_waitcnt lgkmcnt(2)
  v_smfmac_f32_16x16x64_bf16 v[40:43], v[16:19], v[44:51], v110
  ds_read_b128 v[44:47], v129 offset:28672
  v_add_f32 v68, v68, v72
  v_smfmac_f32_16x16x64_bf16 v[36:39], v[20:23], a[208:215], v110
  ds_read_b128 v[48:51], v129 offset:29696
  v_add_f32 v69, v69, v73
  v_smfmac_f32_16x16x64_bf16 v[40:43], v[20:23], v[240:247], v110
  v_add_f32 v70, v70, v74
  v_smfmac_f32_16x16x64_bf16 v[36:39], v[24:27], a[216:223], v110
  v_add_f32 v71, v71, v75
  s_waitcnt lgkmcnt(2)
  v_smfmac_f32_16x16x64_bf16 v[40:43], v[24:27], v[52:59], v110
  v_cvt_pk_bf16_f32 v102, v68, v69
  v_smfmac_f32_16x16x64_bf16 v[36:39], v[28:31], a[232:239], v110
  v_cvt_pk_bf16_f32 v103, v70, v71
  s_waitcnt lgkmcnt(0)
  v_smfmac_f32_16x16x64_bf16 v[40:43], v[28:31], v[44:51], v110
  v_mfma_f32_16x16x16_bf16 v[142:145], v[100:101], v[108:109], 0
  v_mfma_f32_16x16x16_bf16 v[146:149], v[102:103], v[108:109], 0
  s_nop 1
  v_permlane32_swap_b32 v36, v40
  v_permlane32_swap_b32 v37, v41
  v_permlane32_swap_b32 v38, v42
  v_permlane32_swap_b32 v39, v43
  v_add_f32 v36, v36, v40
  v_add_f32 v37, v37, v41
  v_add_f32 v38, v38, v42
  v_add_f32 v39, v39, v43
  v_cvt_pk_bf16_f32 v104, v36, v37
  v_cvt_pk_bf16_f32 v105, v38, v39
  v_cvt_pk_bf16_f32 v44, v142, v143
  v_cvt_pk_bf16_f32 v45, v144, v145
  v_mfma_f32_16x16x16_bf16 v[142:145], v[104:105], v[108:109], 0
  v_cvt_pk_bf16_f32 v46, v146, v147
  v_cvt_pk_bf16_f32 v47, v148, v149
  s_nop 1
  v_mfma_f32_16x16x32_bf16 v[76:79], v[44:47], v[44:47], 0
  v_mfma_f32_16x16x32_bf16 v[80:83], v[88:91], v[44:47], 0
  v_cvt_pk_bf16_f32 v106, v142, v143
  v_cvt_pk_bf16_f32 v107, v144, v145
  v_mfma_f32_16x16x32_bf16 v[84:87], v[92:95], v[44:47], 0
  s_nop 0
  v_mfma_f32_16x16x16_bf16 v[76:79], v[106:107], v[106:107], v[76:79]
  v_mfma_f32_16x16x16_bf16 v[80:83], v[96:97], v[106:107], v[80:83]
  v_mfma_f32_16x16x16_bf16 v[84:87], v[98:99], v[106:107], v[84:87]
  s_mov_b32 exec_lo, 0
  s_mov_b32 exec_hi, 0x00ff00ff
  s_nop 3
  ds_write_b128 v130, v[76:79]
  s_mov_b32 exec_lo, 0x00ff00ff
  ds_write_b128 v130, v[80:83] offset:1024
  s_nop 0
  ds_write_b128 v130, v[84:87] offset:2048
  s_mov_b64 exec, -1
  s_waitcnt lgkmcnt(0)
  s_barrier
  s_cmp_ge_u32 s51, 63
  s_cbranch_scc0 x63_65_\sfx\()
  ds_write_b64 v131, v[44:45]
  ds_write_b64 v131, v[46:47] offset:512
  ds_write_b64 v131, v[106:107] offset:1024
  s_branch ka\sfx\()_x_done
x63_65_\sfx\():
  ds_read_b128 v[4:7], v133 offset:0
  ds_read_b32 v20, v134 offset:0
  ds_read_b128 v[8:11], v133 offset:3072
  ds_read_b32 v21, v134 offset:3072
  ds_read_b128 v[12:15], v133 offset:6144
  ds_read_b32 v22, v134 offset:6144
  ds_read_b128 v[16:19], v133 offset:9216
  ds_read_b32 v23, v134 offset:9216
  s_waitcnt lgkmcnt(4)
  v_pk_add_f32 v[4:5], v[4:5], v[8:9]
  v_pk_add_f32 v[6:7], v[6:7], v[10:11]
  v_add_f32 v20, v20, v21
  s_waitcnt lgkmcnt(0)
  v_pk_add_f32 v[12:13], v[12:13], v[16:17]
  v_pk_add_f32 v[14:15], v[14:15], v[18:19]
  v_add_f32 v22, v22, v23
  v_pk_add_f32 v[4:5], v[4:5], v[12:13]
  v_pk_add_f32 v[6:7], v[6:7], v[14:15]
  v_add_f32 v8, v20, v22
  v_pk_mul_f32 v[4:5], v[4:5], s[64:65]
  v_pk_mul_f32 v[6:7], v[6:7], s[64:65]
  v_mul_f32 v8, s64, v8
  v_max3_f32 v24, abs(v4), abs(v5), abs(v6)
  v_max3_f32 v24, v24, abs(v7), abs(v8)
  v_cmp_nlt_f32 vcc, v24, v137
  s_cbranch_vccz smx_66_go_\sfx\()
  v_max3_f32 v24, v4, v5, v6
  v_max3_f32 v24, v24, v7, v8
  s_nop 1
  v_max_f32_dpp v25, v24, v24 quad_perm:[1,0,3,2] row_mask:0xf bank_mask:0xf
  s_nop 1
  v_max_f32_dpp v24, v25, v25 quad_perm:[2,3,0,1] row_mask:0xf bank_mask:0xf
  s_nop 1
  v_max_f32_dpp v25, v24, v24 row_half_mirror row_mask:0xf bank_mask:0xf
  v_sub_f32 v4, v4, v25
  v_sub_f32 v5, v5, v25
  v_sub_f32 v6, v6, v25
  v_sub_f32 v7, v7, v25
  v_sub_f32 v8, v8, v25
smx_66_go_\sfx\():
  v_exp_f32 v4, v4
  v_exp_f32 v5, v5
  v_exp_f32 v6, v6
  v_exp_f32 v7, v7
  v_exp_f32 v8, v8
  v_add_f32 v24, v4, v5
  v_add_f32 v25, v6, v7
  v_add_f32 v24, v24, v8
  v_add_f32 v24, v24, v25
  s_nop 1
  v_add_f32_dpp v25, v24, v24 quad_perm:[1,0,3,2] row_mask:0xf bank_mask:0xf
  s_nop 1
  v_add_f32_dpp v24, v25, v25 quad_perm:[2,3,0,1] row_mask:0xf bank_mask:0xf
  s_nop 1
  v_add_f32_dpp v25, v24, v24 row_half_mirror row_mask:0xf bank_mask:0xf
  v_rcp_f32 v24, v25
  s_nop 0
  v_mul_f32 v8, v8, v24
  v_pk_mul_f32 v[4:5], v[4:5], v[24:25] op_sel_hi:[1,0]
  v_pk_mul_f32 v[6:7], v[6:7], v[24:25] op_sel_hi:[1,0]
  v_mov_b32_dpp v9, v8 quad_perm:[1,0,3,2] row_mask:0xf bank_mask:0xf
  v_cvt_pk_bf16_f32 v10, v4, v5
  v_cvt_pk_bf16_f32 v11, v6, v7
  buffer_store_dwordx2 v[10:11], v135, s[8:11], s49 offen \pol
  v_cvt_pk_bf16_f32 v12, v8, v9
  buffer_store_dword v12, v136, s[8:11], s49 offen \pol
  ds_write_b64 v131, v[44:45]
  ds_write_b64 v131, v[46:47] offset:512
  ds_write_b64 v131, v[106:107] offset:1024
  s_waitcnt lgkmcnt(0)
  s_barrier
  v_mov_b32 v60, 0
  v_mov_b32 v61, 0
  v_mov_b32 v62, 0
  v_mov_b32 v63, 0
  v_mov_b32 v64, 0
  v_mov_b32 v65, 0
  v_mov_b32 v66, 0
  v_mov_b32 v67, 0
  v_mov_b32 v68, 0
  v_mov_b32 v69, 0
  v_mov_b32 v70, 0
  v_mov_b32 v71, 0
  v_mov_b32 v72, 0
  v_mov_b32 v73, 0
  v_mov_b32 v74, 0
  v_mov_b32 v75, 0
  v_mov_b32 v36, 0
  v_mov_b32 v37, 0
  v_mov_b32 v38, 0
  v_mov_b32 v39, 0
  v_mov_b32 v40, 0
  v_mov_b32 v41, 0
  v_mov_b32 v42, 0
  v_mov_b32 v43, 0
  s_add_u32 s97, s97, 10240
  s_mov_b32 s48, s97
  s_add_u32 s49, s49, 5120
  s_add_u32 s50, s50, 12288
  s_add_u32 s63, s63, 12288
  s_add_u32 s51, s51, 1
  s_cmp_gt_u32 s52, s51
  s_cbranch_scc1 ka\sfx\()_x_wp_67_ok
  s_mov_b32 s45, 0
ka\sfx\()_x_wp_67_spin:
  buffer_load_dword v2, v138, s[8:11], 0 offen sc1
  s_add_u32 s45, s45, 1
  s_waitcnt vmcnt(0)
  v_min_u32_dpp v3, v2, v2 quad_perm:[1,0,3,2] row_mask:0xf bank_mask:0xf
  s_nop 1
  v_min_u32_dpp v2, v3, v3 quad_perm:[2,3,0,1] row_mask:0xf bank_mask:0xf
  s_nop 1
  v_min_u32_dpp v3, v2, v2 row_half_mirror row_mask:0xf bank_mask:0xf
  s_nop 1
  v_min_u32_dpp v2, v3, v3 quad_perm:[0,1,2,3] row_mask:0xf bank_mask:0xf
  s_nop 0
  v_readfirstlane_b32 s52, v2
  s_cmp_gt_u32 s52, s51
  s_cbranch_scc1 ka\sfx\()_x_wp_67_ok
  s_cmp_lt_u32 s45, 400000
  s_cbranch_scc1 ka\sfx\()_x_wp_67_spin
  s_branch ka\sfx\()_abort
ka\sfx\()_x_wp_67_ok:
  s_add_u32 s28, s50, s53
  buffer_load_dwordx2 v[88:89], v132, s[8:11], s28 offen offset:0 sc1
  buffer_load_dwordx2 v[92:93], v132, s[8:11], s28 offen offset:1024 sc1
  s_add_u32 s28, s50, s54
  buffer_load_dwordx2 v[90:91], v132, s[8:11], s28 offen offset:0 sc1
  buffer_load_dwordx2 v[94:95], v132, s[8:11], s28 offen offset:1024 sc1
  s_add_u32 s28, s50, s55
  buffer_load_dwordx2 v[96:97], v132, s[8:11], s28 offen offset:0 sc1
  buffer_load_dwordx2 v[98:99], v132, s[8:11], s28 offen offset:1024 sc1
  s_branch ka\sfx\()_x_w0l
ka\sfx\()_x_w1:
ka\sfx\()_x_w1l:
  ds_read_b128 v[44:47], v129 offset:0
  ds_read_b128 v[48:51], v129 offset:1024
  ds_read_b128 v[52:55], v129 offset:10240
  ds_read_b128 v[56:59], v129 offset:11264
  s_waitcnt lgkmcnt(0)
  s_mov_b32 s45, 0
ka\sfx\()_x_pf_68:
  buffer_load_dwordx4 v[112:115], v124, s[8:11], s48 offen sc1
  buffer_load_dwordx4 v[116:119], v125, s[8:11], s48 offen sc1
  buffer_load_dwordx4 v[120:123], v126, s[8:11], s48 offen sc1
  s_add_u32 s45, s45, 1
  s_waitcnt vmcnt(2)
  ds_write_b128 v127, v[112:115] offset:0
  v_max3_u32 v139, v112, v113, v114
  v_max_u32 v139, v139, v115
  s_waitcnt vmcnt(1)
  ds_write_b128 v127, v[116:119] offset:4096
  v_max3_u32 v139, v139, v116, v117
  v_max3_u32 v139, v139, v118, v119
  s_waitcnt vmcnt(0)
  ds_write_b128 v127, v[120:123] offset:8192
  v_max3_u32 v139, v139, v120, v121
  v_max3_u32 v139, v139, v122, v123
  v_cmp_eq_u32 vcc, -1, v139
  s_cbranch_vccz ka\sfx\()_x_pf_68_ok
  s_cmp_lt_u32 s45, 400000
  s_cbranch_scc1 ka\sfx\()_x_pf_68
  s_branch ka\sfx\()_abort
ka\sfx\()_x_pf_68_ok:
  v_smfmac_f32_16x16x64_bf16 v[60:63], v[112:115], a[8:15], v110
  v_smfmac_f32_16x16x64_bf16 v[64:67], v[112:115], v[44:51], v110
  ds_read_b128 v[44:47], v129 offset:20480
  v_smfmac_f32_16x16x64_bf16 v[68:71], v[112:115], a[88:95], v110
  ds_read_b128 v[48:51], v129 offset:21504
  v_smfmac_f32_16x16x64_bf16 v[72:75], v[112:115], v[52:59], v110
  ds_read_b128 v[52:55], v129 offset:4096
  s_waitcnt lgkmcnt(3)
  s_barrier
  v_smfmac_f32_16x16x64_bf16 v[36:39], v[112:115], a[168:175], v110
  ds_read_b128 v[56:59], v129 offset:5120
  ds_read_b128 v[4:7], v128 offset:0
  s_waitcnt lgkmcnt(3)
  v_smfmac_f32_16x16x64_bf16 v[40:43], v[112:115], v[44:51], v110
  ds_read_b128 v[44:47], v129 offset:14336
  ds_read_b128 v[8:11], v128 offset:2048
  v_smfmac_f32_16x16x64_bf16 v[60:63], v[116:119], a[40:47], v110
  ds_read_b128 v[48:51], v129 offset:15360
  ds_read_b128 v[12:15], v128 offset:3072
  s_waitcnt lgkmcnt(5)
  v_smfmac_f32_16x16x64_bf16 v[64:67], v[116:119], v[52:59], v110
  ds_read_b128 v[52:55], v129 offset:24576
  ds_read_b128 v[16:19], v128 offset:4096
  v_smfmac_f32_16x16x64_bf16 v[68:71], v[116:119], a[120:127], v110
  ds_read_b128 v[56:59], v129 offset:25600
  ds_read_b128 v[20:23], v128 offset:6144
  s_waitcnt lgkmcnt(5)
  v_smfmac_f32_16x16x64_bf16 v[72:75], v[116:119], v[44:51], v110
  ds_read_b128 v[44:47], v129 offset:8192
  ds_read_b128 v[24:27], v128 offset:7168
  v_smfmac_f32_16x16x64_bf16 v[36:39], v[116:119], a[200:207], v110
  ds_read_b128 v[48:51], v129 offset:9216
  ds_read_b128 v[28:31], v128 offset:8192
  s_waitcnt lgkmcnt(5)
  v_smfmac_f32_16x16x64_bf16 v[40:43], v[116:119], v[52:59], v110
  ds_read_b128 v[52:55], v129 offset:18432
  v_smfmac_f32_16x16x64_bf16 v[60:63], v[120:123], a[72:79], v110
  ds_read_b128 v[56:59], v129 offset:19456
  s_waitcnt lgkmcnt(3)
  v_smfmac_f32_16x16x64_bf16 v[64:67], v[120:123], v[44:51], v110
  ds_read_b128 v[44:47], v129 offset:28672
  v_smfmac_f32_16x16x64_bf16 v[68:71], v[120:123], a[152:159], v110
  ds_read_b128 v[48:51], v129 offset:29696
  s_waitcnt lgkmcnt(2)
  v_smfmac_f32_16x16x64_bf16 v[72:75], v[120:123], v[52:59], v110
  ds_read_b128 v[52:55], v129 offset:2048
  v_smfmac_f32_16x16x64_bf16 v[36:39], v[120:123], a[232:239], v110
  ds_read_b128 v[56:59], v129 offset:3072
  s_waitcnt lgkmcnt(2)
  v_smfmac_f32_16x16x64_bf16 v[40:43], v[120:123], v[44:51], v110
  ds_read_b128 v[44:47], v129 offset:6144
  v_smfmac_f32_16x16x64_bf16 v[60:63], v[4:7], a[0:7], v110
  ds_read_b128 v[48:51], v129 offset:7168
  v_smfmac_f32_16x16x64_bf16 v[64:67], v[4:7], a[240:247], v110
  v_smfmac_f32_16x16x64_bf16 v[60:63], v[8:11], a[16:23], v110
  v_smfmac_f32_16x16x64_bf16 v[64:67], v[8:11], a[248:255], v110
  v_smfmac_f32_16x16x64_bf16 v[60:63], v[12:15], a[24:31], v110
  s_waitcnt lgkmcnt(2)
  v_smfmac_f32_16x16x64_bf16 v[64:67], v[12:15], v[52:59], v110
  ds_read_b128 v[52:55], v129 offset:12288
  v_smfmac_f32_16x16x64_bf16 v[60:63], v[16:19], a[32:39], v110
  ds_read_b128 v[56:59], v129 offset:13312
  v_smfmac_f32_16x16x64_bf16 v[64:67], v[16:19], v[152:159], v110
  v_smfmac_f32_16x16x64_bf16 v[60:63], v[20:23], a[48:55], v110
  v_smfmac_f32_16x16x64_bf16 v[64:67], v[20:23], v[160:167], v110
  v_smfmac_f32_16x16x64_bf16 v[60:63], v[24:27], a[56:63], v110
  s_waitcnt lgkmcnt(2)
  v_smfmac_f32_16x16x64_bf16 v[64:67], v[24:27], v[44:51], v110
  ds_read_b128 v[44:47], v129 offset:16384
  v_smfmac_f32_16x16x64_bf16 v[60:63], v[28:31], a[64:71], v110
  ds_read_b128 v[48:51], v129 offset:17408
  v_smfmac_f32_16x16x64_bf16 v[64:67], v[28:31], v[168:175], v110
  v_smfmac_f32_16x16x64_bf16 v[68:71], v[4:7], a[80:87], v110
  v_smfmac_f32_16x16x64_bf16 v[72:75], v[4:7], v[176:183], v110
  v_permlane32_swap_b32 v60, v64
  v_smfmac_f32_16x16x64_bf16 v[68:71], v[8:11], a[96:103], v110
  v_smfmac_f32_16x16x64_bf16 v[72:75], v[8:11], v[184:191], v110
  v_permlane32_swap_b32 v61, v65
  v_smfmac_f32_16x16x64_bf16 v[68:71], v[12:15], a[104:111], v110
  s_waitcnt lgkmcnt(2)
  v_smfmac_f32_16x16x64_bf16 v[72:75], v[12:15], v[52:59], v110
  ds_read_b128 v[52:55], v129 offset:22528
  v_permlane32_swap_b32 v62, v66
  v_smfmac_f32_16x16x64_bf16 v[68:71], v[16:19], a[112:119], v110
  ds_read_b128 v[56:59], v129 offset:23552
  v_permlane32_swap_b32 v63, v67
  v_smfmac_f32_16x16x64_bf16 v[72:75], v[16:19], v[192:199], v110
  v_add_f32 v60, v60, v64
  v_smfmac_f32_16x16x64_bf16 v[68:71], v[20:23], a[128:135], v110
  v_add_f32 v61, v61, v65
  v_smfmac_f32_16x16x64_bf16 v[72:75], v[20:23], v[200:207], v110
  v_add_f32 v62, v62, v66
  v_smfmac_f32_16x16x64_bf16 v[68:71], v[24:27], a[136:143], v110
  v_add_f32 v63, v63, v67
  s_waitcnt lgkmcnt(2)
  v_smfmac_f32_16x16x64_bf16 v[72:75], v[24:27], v[44:51], v110
  ds_read_b128 v[44:47], v129 offset:26624
  v_cvt_pk_bf16_f32 v100, v60, v61
  v_smfmac_f32_16x16x64_bf16 v[68:71], v[28:31], a[144:151], v110
  ds_read_b128 v[48:51], v129 offset:27648
  v_cvt_pk_bf16_f32 v101, v62, v63
  v_smfmac_f32_16x16x64_bf16 v[72:75], v[28:31], v[208:215], v110
  v_smfmac_f32_16x16x64_bf16 v[36:39], v[4:7], a[160:167], v110
  v_smfmac_f32_16x16x64_bf16 v[40:43], v[4:7], v[216:223], v110
  v_permlane32_swap_b32 v68, v72
  v_smfmac_f32_16x16x64_bf16 v[36:39], v[8:11], a[176:183], v110
  v_smfmac_f32_16x16x64_bf16 v[40:43], v[8:11], v[224:231], v110
  v_permlane32_swap_b32 v69, v73
  v_smfmac_f32_16x16x64_bf16 v[36:39], v[12:15], a[184:191], v110
  s_waitcnt lgkmcnt(2)
  v_smfmac_f32_16x16x64_bf16 v[40:43], v[12:15], v[52:59], v110
  v_permlane32_swap_b32 v70, v74
  v_smfmac_f32_16x16x64_bf16 v[36:39], v[16:19], a[192:199], v110
  v_permlane32_swap_b32 v71, v75
  v_smfmac_f32_16x16x64_bf16 v[40:43], v[16:19], v[232:239], v110
  v_add_f32 v68, v68, v72
  v_smfmac_f32_16x16x64_bf16 v[36:39], v[20:23], a[208:215], v110
  v_add_f32 v69, v69, v73
  v_smfmac_f32_16x16x64_bf16 v[40:43], v[20:23], v[240:247], v110
  v_add_f32 v70, v70, v74
  v_smfmac_f32_16x16x64_bf16 v[36:39], v[24:27], a[216:223], v110
  v_add_f32 v71, v71, v75
  s_waitcnt lgkmcnt(0)
  v_smfmac_f32_16x16x64_bf16 v[40:43], v[24:27], v[44:51], v110
  v_cvt_pk_bf16_f32 v102, v68, v69
  v_smfmac_f32_16x16x64_bf16 v[36:39], v[28:31], a[224:231], v110
  v_cvt_pk_bf16_f32 v103, v70, v71
  v_smfmac_f32_16x16x64_bf16 v[40:43], v[28:31], v[248:255], v110
  v_mfma_f32_16x16x16_bf16 v[142:145], v[100:101], v[108:109], 0
  v_mfma_f32_16x16x16_bf16 v[146:149], v[102:103], v[108:109], 0
  s_nop 1
  v_permlane32_swap_b32 v36, v40
  v_permlane32_swap_b32 v37, v41
  v_permlane32_swap_b32 v38, v42
  v_permlane32_swap_b32 v39, v43
  v_add_f32 v36, v36, v40
  v_add_f32 v37, v37, v41
  v_add_f32 v38, v38, v42
  v_add_f32 v39, v39, v43
  v_cvt_pk_bf16_f32 v104, v36, v37
  v_cvt_pk_bf16_f32 v105, v38, v39
  v_cvt_pk_bf16_f32 v44, v142, v143
  v_cvt_pk_bf16_f32 v45, v144, v145
  v_mfma_f32_16x16x16_bf16 v[142:145], v[104:105], v[108:109], 0
  v_cvt_pk_bf16_f32 v46, v146, v147
  v_cvt_pk_bf16_f32 v47, v148, v149
  s_nop 1
  v_mfma_f32_16x16x32_bf16 v[76:79], v[44:47], v[44:47], 0
  v_mfma_f32_16x16x32_bf16 v[80:83], v[88:91], v[44:47], 0
  v_cvt_pk_bf16_f32 v106, v142, v143
  v_cvt_pk_bf16_f32 v107, v144, v145
  v_mfma_f32_16x16x32_bf16 v[84:87], v[92:95], v[44:47], 0
  s_nop 0
  v_mfma_f32_16x16x16_bf16 v[76:79], v[106:107], v[106:107], v[76:79]
  v_mfma_f32_16x16x16_bf16 v[80:83], v[96:97], v[106:107], v[80:83]
  v_mfma_f32_16x16x16_bf16 v[84:87], v[98:99], v[106:107], v[84:87]
  s_mov_b32 exec_lo, 0
  s_mov_b32 exec_hi, 0x00ff00ff
  s_nop 3
  ds_write_b128 v130, v[76:79]
  s_mov_b32 exec_lo, 0x00ff00ff
  ds_write_b128 v130, v[80:83] offset:1024
  s_nop 0
  ds_write_b128 v130, v[84:87] offset:2048
  s_mov_b64 exec, -1
  s_waitcnt lgkmcnt(0)
  s_barrier
  ds_write_b64 v131, v[44:45]
  ds_write_b64 v131, v[46:47] offset:512
  ds_write_b64 v131, v[106:107] offset:1024
  s_waitcnt lgkmcnt(0)
  s_cmp_ge_u32 s51, 63
  s_cbranch_scc1 ka\sfx\()_x_done
  s_barrier
  v_mov_b32 v60, 0
  v_mov_b32 v61, 0
  v_mov_b32 v62, 0
  v_mov_b32 v63, 0
  v_mov_b32 v64, 0
  v_mov_b32 v65, 0
  v_mov_b32 v66, 0
  v_mov_b32 v67, 0
  v_mov_b32 v68, 0
  v_mov_b32 v69, 0
  v_mov_b32 v70, 0
  v_mov_b32 v71, 0
  v_mov_b32 v72, 0
  v_mov_b32 v73, 0
  v_mov_b32 v74, 0
  v_mov_b32 v75, 0
  v_mov_b32 v36, 0
  v_mov_b32 v37, 0
  v_mov_b32 v38, 0
  v_mov_b32 v39, 0
  v_mov_b32 v40, 0
  v_mov_b32 v41, 0
  v_mov_b32 v42, 0
  v_mov_b32 v43, 0
  s_add_u32 s97, s97, 10240
  s_mov_b32 s48, s97
  s_add_u32 s49, s49, 5120
  s_add_u32 s50, s50, 12288
  s_add_u32 s63, s63, 12288
  s_add_u32 s51, s51, 1
  s_cmp_gt_u32 s52, s51
  s_cbranch_scc1 ka\sfx\()_x_wp_69_ok
  s_mov_b32 s45, 0
ka\sfx\()_x_wp_69_spin:
  buffer_load_dword v2, v138, s[8:11], 0 offen sc1
  s_add_u32 s45, s45, 1
  s_waitcnt vmcnt(0)
  v_min_u32_dpp v3, v2, v2 quad_perm:[1,0,3,2] row_mask:0xf bank_mask:0xf
  s_nop 1
  v_min_u32_dpp v2, v3, v3 quad_perm:[2,3,0,1] row_mask:0xf bank_mask:0xf
  s_nop 1
  v_min_u32_dpp v3, v2, v2 row_half_mirror row_mask:0xf bank_mask:0xf
  s_nop 1
  v_min_u32_dpp v2, v3, v3 quad_perm:[0,1,2,3] row_mask:0xf bank_mask:0xf
  s_nop 0
  v_readfirstlane_b32 s52, v2
  s_cmp_gt_u32 s52, s51
  s_cbranch_scc1 ka\sfx\()_x_wp_69_ok
  s_cmp_lt_u32 s45, 400000
  s_cbranch_scc1 ka\sfx\()_x_wp_69_spin
  s_branch ka\sfx\()_abort
ka\sfx\()_x_wp_69_ok:
  s_add_u32 s28, s50, s53
  buffer_load_dwordx2 v[88:89], v132, s[8:11], s28 offen offset:0 sc1
  buffer_load_dwordx2 v[92:93], v132, s[8:11], s28 offen offset:1024 sc1
  s_add_u32 s28, s50, s54
  buffer_load_dwordx2 v[90:91], v132, s[8:11], s28 offen offset:0 sc1
  buffer_load_dwordx2 v[94:95], v132, s[8:11], s28 offen offset:1024 sc1
  s_add_u32 s28, s50, s55
  buffer_load_dwordx2 v[96:97], v132, s[8:11], s28 offen offset:0 sc1
  buffer_load_dwordx2 v[98:99], v132, s[8:11], s28 offen offset:1024 sc1
  s_branch ka\sfx\()_x_w1l
ka\sfx\()_x_w23:
  s_sub_u32 s65, s21, 2
  s_and_b32 s26, s23, 7
  v_and_b32 v4, 15, v1
  v_lshrrev_b32 v5, 4, v1
  v_and_b32 v6, 1, v5
  v_lshlrev_b32 v6, 5, v6
  v_add_u32 v6, v6, v4
  v_lshlrev_b32 v6, 4, v6
  v_lshrrev_b32 v7, 1, v5
  v_lshlrev_b32 v7, 3, v7
  v_add_u32 v6, v6, v7
  s_lshl_b32 s28, s26, 1
  s_add_u32 s28, s28, s65
  s_lshl_b32 s28, s28, 10
  v_add_u32 v133, s28, v6
  s_lshr_b32 s28, s26, 2
  s_lshl_b32 s28, s28, 1
  s_add_u32 s28, s28, s65
  s_lshl_b32 s28, s28, 10
  s_and_b32 s29, s26, 1
  s_lshl_b32 s29, s29, 9
  s_add_u32 s28, s28, s29
  s_bfe_u32 s29, s26, 0x10001
  s_lshl_b32 s29, s29, 3
  s_add_u32 s28, s28, s29
  s_add_u32 s28, s28, 15872
  v_lshlrev_b32 v6, 4, v5
  v_add_u32 v6, v6, v4
  v_lshlrev_b32 v6, 4, v6
  v_add_u32 v6, s28, v6
  v_mov_b32 v7, 0x40000000
  v_cmp_le_u32 vcc, 2, v5
  s_nop 1
  v_cndmask_b32 v134, v7, v6, vcc
  v_mov_b32 v135, 0xf149f2ca
  v_lshlrev_b32 v6, 3, v1
  v_add_u32 v136, 145408, v6
  s_mul_i32 s94, s65, 6144
  s_add_u32 s94, s94, 151552
  v_add_u32 v137, s94, v132
  v_cmp_le_u32 s[66:67], 2, v5
  v_lshlrev_b32 v6, 2, v5
  v_sub_u32 v6, v4, v6
  v_cmp_le_i32 s[68:69], 0, v6
  v_cmp_le_i32 s[70:71], 1, v6
  v_cmp_le_i32 s[72:73], 2, v6
  v_cmp_le_i32 s[74:75], 3, v6
  s_nop 1
  s_cmp_eq_u32 s65, 0
  s_cselect_b64 s[76:77], s[68:69], -1
  s_cselect_b64 s[84:85], 0, s[68:69]
  s_cselect_b64 s[78:79], s[70:71], -1
  s_cselect_b64 s[86:87], 0, s[70:71]
  s_cselect_b64 s[80:81], s[72:73], -1
  s_cselect_b64 s[88:89], 0, s[72:73]
  s_cselect_b64 s[82:83], s[74:75], -1
  s_cselect_b64 s[90:91], 0, s[74:75]
  s_mul_i32 s92, s20, 1310720
  s_add_u32 s92, s92, 0xe00000
  s_lshl_b32 s93, s65, 10
  s_mov_b32 s64, 0x3dd53b95
  s_add_u32 s95, s63, s93
  s_add_u32 m0, s94, 0
  s_add_u32 s28, s95, 0
  buffer_load_dwordx4 v132, s[8:11], s28 offen sc1 lds
  s_add_u32 m0, s94, 1024
  s_add_u32 s28, s95, 2048
  buffer_load_dwordx4 v132, s[8:11], s28 offen sc1 lds
  s_add_u32 m0, s94, 2048
  s_add_u32 s28, s95, 4096
  buffer_load_dwordx4 v132, s[8:11], s28 offen sc1 lds
  s_add_u32 m0, s94, 3072
  s_add_u32 s28, s95, 6144
  buffer_load_dwordx4 v132, s[8:11], s28 offen sc1 lds
  s_add_u32 m0, s94, 4096
  s_add_u32 s28, s95, 8192
  buffer_load_dwordx4 v132, s[8:11], s28 offen sc1 lds
  s_add_u32 m0, s94, 5120
  s_add_u32 s28, s95, 10240
  buffer_load_dwordx4 v132, s[8:11], s28 offen sc1 lds
  s_cmp_eq_u32 s21, 3
  s_cbranch_scc1 ka\sfx\()_x_w3l
ka\sfx\()_x_w2l:
  ds_read_b128 v[44:47], v129 offset:0
  ds_read_b128 v[48:51], v129 offset:1024
  ds_read_b128 v[52:55], v129 offset:2048
  ds_read_b128 v[56:59], v129 offset:3072
  s_waitcnt lgkmcnt(0)
  s_mov_b32 s45, 0
ka\sfx\()_x_pf_70:
  buffer_load_dwordx4 v[112:115], v124, s[8:11], s48 offen sc1
  buffer_load_dwordx4 v[116:119], v125, s[8:11], s48 offen sc1
  s_add_u32 s45, s45, 1
  s_waitcnt vmcnt(1)
  ds_write_b128 v127, v[112:115] offset:0
  v_max3_u32 v139, v112, v113, v114
  v_max_u32 v139, v139, v115
  s_waitcnt vmcnt(0)
  ds_write_b128 v127, v[116:119] offset:4096
  v_max3_u32 v139, v139, v116, v117
  v_max3_u32 v139, v139, v118, v119
  v_cmp_eq_u32 vcc, -1, v139
  s_cbranch_vccz ka\sfx\()_x_pf_70_ok
  s_cmp_lt_u32 s45, 400000
  s_cbranch_scc1 ka\sfx\()_x_pf_70
  s_branch ka\sfx\()_abort
ka\sfx\()_x_pf_70_ok:
  v_smfmac_f32_16x16x64_bf16 v[60:63], v[112:115], a[16:23], v110
  v_smfmac_f32_16x16x64_bf16 v[64:67], v[112:115], a[248:255], v110
  v_smfmac_f32_16x16x64_bf16 v[68:71], v[112:115], a[96:103], v110
  v_smfmac_f32_16x16x64_bf16 v[72:75], v[112:115], v[184:191], v110
  s_waitcnt lgkmcnt(0)
  s_barrier
  v_smfmac_f32_16x16x64_bf16 v[36:39], v[112:115], a[176:183], v110
  ds_read_b128 v[4:7], v128 offset:0
  v_smfmac_f32_16x16x64_bf16 v[40:43], v[112:115], v[224:231], v110
  ds_read_b128 v[8:11], v128 offset:1024
  v_smfmac_f32_16x16x64_bf16 v[60:63], v[116:119], a[48:55], v110
  ds_read_b128 v[12:15], v128 offset:3072
  v_smfmac_f32_16x16x64_bf16 v[64:67], v[116:119], v[160:167], v110
  ds_read_b128 v[16:19], v128 offset:4096
  v_smfmac_f32_16x16x64_bf16 v[68:71], v[116:119], a[128:135], v110
  ds_read_b128 v[20:23], v128 offset:5120
  v_smfmac_f32_16x16x64_bf16 v[72:75], v[116:119], v[200:207], v110
  ds_read_b128 v[24:27], v128 offset:7168
  v_smfmac_f32_16x16x64_bf16 v[36:39], v[116:119], a[208:215], v110
  ds_read_b128 v[28:31], v128 offset:8192
  v_smfmac_f32_16x16x64_bf16 v[40:43], v[116:119], v[240:247], v110
  ds_read_b128 v[32:35], v128 offset:9216
  s_waitcnt lgkmcnt(7)
  v_smfmac_f32_16x16x64_bf16 v[60:63], v[4:7], a[0:7], v110
  v_smfmac_f32_16x16x64_bf16 v[64:67], v[4:7], a[240:247], v110
  s_waitcnt lgkmcnt(6)
  v_smfmac_f32_16x16x64_bf16 v[60:63], v[8:11], a[8:15], v110
  v_smfmac_f32_16x16x64_bf16 v[64:67], v[8:11], v[44:51], v110
  ds_read_b128 v[44:47], v129 offset:4096
  s_waitcnt lgkmcnt(6)
  v_smfmac_f32_16x16x64_bf16 v[60:63], v[12:15], a[24:31], v110
  ds_read_b128 v[48:51], v129 offset:5120
  v_smfmac_f32_16x16x64_bf16 v[64:67], v[12:15], v[52:59], v110
  ds_read_b128 v[52:55], v129 offset:6144
  s_waitcnt lgkmcnt(7)
  v_smfmac_f32_16x16x64_bf16 v[60:63], v[16:19], a[32:39], v110
  ds_read_b128 v[56:59], v129 offset:7168
  v_smfmac_f32_16x16x64_bf16 v[64:67], v[16:19], v[152:159], v110
  s_waitcnt lgkmcnt(7)
  v_smfmac_f32_16x16x64_bf16 v[60:63], v[20:23], a[40:47], v110
  s_waitcnt lgkmcnt(2)
  v_smfmac_f32_16x16x64_bf16 v[64:67], v[20:23], v[44:51], v110
  ds_read_b128 v[44:47], v129 offset:8192
  v_smfmac_f32_16x16x64_bf16 v[60:63], v[24:27], a[56:63], v110
  ds_read_b128 v[48:51], v129 offset:9216
  s_waitcnt lgkmcnt(2)
  v_smfmac_f32_16x16x64_bf16 v[64:67], v[24:27], v[52:59], v110
  ds_read_b128 v[52:55], v129 offset:10240
  v_smfmac_f32_16x16x64_bf16 v[60:63], v[28:31], a[64:71], v110
  ds_read_b128 v[56:59], v129 offset:11264
  v_smfmac_f32_16x16x64_bf16 v[64:67], v[28:31], v[168:175], v110
  v_smfmac_f32_16x16x64_bf16 v[60:63], v[32:35], a[72:79], v110
  s_waitcnt lgkmcnt(2)
  v_smfmac_f32_16x16x64_bf16 v[64:67], v[32:35], v[44:51], v110
  ds_read_b128 v[44:47], v129 offset:12288
  v_smfmac_f32_16x16x64_bf16 v[68:71], v[4:7], a[80:87], v110
  ds_read_b128 v[48:51], v129 offset:13312
  v_smfmac_f32_16x16x64_bf16 v[72:75], v[4:7], v[176:183], v110
  v_permlane32_swap_b32 v60, v64
  v_smfmac_f32_16x16x64_bf16 v[68:71], v[8:11], a[88:95], v110
  s_waitcnt lgkmcnt(2)
  v_smfmac_f32_16x16x64_bf16 v[72:75], v[8:11], v[52:59], v110
  ds_read_b128 v[52:55], v129 offset:14336
  v_permlane32_swap_b32 v61, v65
  v_smfmac_f32_16x16x64_bf16 v[68:71], v[12:15], a[104:111], v110
  ds_read_b128 v[56:59], v129 offset:15360
  s_waitcnt lgkmcnt(2)
  v_smfmac_f32_16x16x64_bf16 v[72:75], v[12:15], v[44:51], v110
  ds_read_b128 v[44:47], v129 offset:16384
  v_permlane32_swap_b32 v62, v66
  v_smfmac_f32_16x16x64_bf16 v[68:71], v[16:19], a[112:119], v110
  ds_read_b128 v[48:51], v129 offset:17408
  v_permlane32_swap_b32 v63, v67
  v_smfmac_f32_16x16x64_bf16 v[72:75], v[16:19], v[192:199], v110
  v_add_f32 v60, v60, v64
  v_smfmac_f32_16x16x64_bf16 v[68:71], v[20:23], a[120:127], v110
  v_add_f32 v61, v61, v65
  s_waitcnt lgkmcnt(2)
  v_smfmac_f32_16x16x64_bf16 v[72:75], v[20:23], v[52:59], v110
  ds_read_b128 v[52:55], v129 offset:18432
  v_add_f32 v62, v62, v66
  v_smfmac_f32_16x16x64_bf16 v[68:71], v[24:27], a[136:143], v110
  ds_read_b128 v[56:59], v129 offset:19456
  v_add_f32 v63, v63, v67
  s_waitcnt lgkmcnt(2)
  v_smfmac_f32_16x16x64_bf16 v[72:75], v[24:27], v[44:51], v110
  ds_read_b128 v[44:47], v129 offset:20480
  v_cvt_pk_bf16_f32 v100, v60, v61
  v_smfmac_f32_16x16x64_bf16 v[68:71], v[28:31], a[144:151], v110
  ds_read_b128 v[48:51], v129 offset:21504
  v_cvt_pk_bf16_f32 v101, v62, v63
  v_smfmac_f32_16x16x64_bf16 v[72:75], v[28:31], v[208:215], v110
  v_smfmac_f32_16x16x64_bf16 v[68:71], v[32:35], a[152:159], v110
  s_waitcnt lgkmcnt(2)
  v_smfmac_f32_16x16x64_bf16 v[72:75], v[32:35], v[52:59], v110
  ds_read_b128 v[52:55], v129 offset:22528
  v_smfmac_f32_16x16x64_bf16 v[36:39], v[4:7], a[160:167], v110
  ds_read_b128 v[56:59], v129 offset:23552
  v_smfmac_f32_16x16x64_bf16 v[40:43], v[4:7], v[216:223], v110
  v_permlane32_swap_b32 v68, v72
  v_smfmac_f32_16x16x64_bf16 v[36:39], v[8:11], a[168:175], v110
  s_waitcnt lgkmcnt(2)
  v_smfmac_f32_16x16x64_bf16 v[40:43], v[8:11], v[44:51], v110
  ds_read_b128 v[44:47], v129 offset:24576
  v_permlane32_swap_b32 v69, v73
  v_smfmac_f32_16x16x64_bf16 v[36:39], v[12:15], a[184:191], v110
  ds_read_b128 v[48:51], v129 offset:25600
  s_waitcnt lgkmcnt(2)
  v_smfmac_f32_16x16x64_bf16 v[40:43], v[12:15], v[52:59], v110
  ds_read_b128 v[52:55], v129 offset:26624
  v_permlane32_swap_b32 v70, v74
  v_smfmac_f32_16x16x64_bf16 v[36:39], v[16:19], a[192:199], v110
  ds_read_b128 v[56:59], v129 offset:27648
  v_permlane32_swap_b32 v71, v75
  v_smfmac_f32_16x16x64_bf16 v[40:43], v[16:19], v[232:239], v110
  v_add_f32 v68, v68, v72
  v_smfmac_f32_16x16x64_bf16 v[36:39], v[20:23], a[200:207], v110
  v_add_f32 v69, v69, v73
  s_waitcnt lgkmcnt(2)
  v_smfmac_f32_16x16x64_bf16 v[40:43], v[20:23], v[44:51], v110
  ds_read_b128 v[44:47], v129 offset:28672
  v_add_f32 v70, v70, v74
  v_smfmac_f32_16x16x64_bf16 v[36:39], v[24:27], a[216:223], v110
  ds_read_b128 v[48:51], v129 offset:29696
  v_add_f32 v71, v71, v75
  s_waitcnt lgkmcnt(2)
  v_smfmac_f32_16x16x64_bf16 v[40:43], v[24:27], v[52:59], v110
  v_cvt_pk_bf16_f32 v102, v68, v69
  v_smfmac_f32_16x16x64_bf16 v[36:39], v[28:31], a[224:231], v110
  v_cvt_pk_bf16_f32 v103, v70, v71
  v_smfmac_f32_16x16x64_bf16 v[40:43], v[28:31], v[248:255], v110
  v_smfmac_f32_16x16x64_bf16 v[36:39], v[32:35], a[232:239], v110
  s_waitcnt lgkmcnt(0)
  v_smfmac_f32_16x16x64_bf16 v[40:43], v[32:35], v[44:51], v110
  v_mfma_f32_16x16x16_bf16 v[142:145], v[100:101], v[108:109], 0
  v_mfma_f32_16x16x16_bf16 v[146:149], v[102:103], v[108:109], 0
  s_nop 1
  v_permlane32_swap_b32 v36, v40
  v_permlane32_swap_b32 v37, v41
  v_permlane32_swap_b32 v38, v42
  v_permlane32_swap_b32 v39, v43
  v_add_f32 v36, v36, v40
  v_add_f32 v37, v37, v41
  v_add_f32 v38, v38, v42
  v_add_f32 v39, v39, v43
  v_cvt_pk_bf16_f32 v104, v36, v37
  v_cvt_pk_bf16_f32 v105, v38, v39
  v_cvt_pk_bf16_f32 v44, v142, v143
  v_cvt_pk_bf16_f32 v45, v144, v145
  v_mfma_f32_16x16x16_bf16 v[142:145], v[104:105], v[108:109], 0
  v_cvt_pk_bf16_f32 v46, v146, v147
  v_cvt_pk_bf16_f32 v47, v148, v149
  s_nop 1
  v_mfma_f32_16x16x32_bf16 v[76:79], v[44:47], v[44:47], 0
  v_mfma_f32_16x16x32_bf16 v[80:83], v[88:91], v[44:47], 0
  v_cvt_pk_bf16_f32 v106, v142, v143
  v_cvt_pk_bf16_f32 v107, v144, v145
  v_mfma_f32_16x16x32_bf16 v[84:87], v[92:95], v[44:47], 0
  s_nop 0
  v_mfma_f32_16x16x16_bf16 v[76:79], v[106:107], v[106:107], v[76:79]
  v_mfma_f32_16x16x16_bf16 v[80:83], v[96:97], v[106:107], v[80:83]
  v_mfma_f32_16x16x16_bf16 v[84:87], v[98:99], v[106:107], v[84:87]
  s_mov_b32 exec_lo, 0
  s_mov_b32 exec_hi, 0x00ff00ff
  s_nop 3
  ds_write_b128 v130, v[76:79]
  s_mov_b32 exec_lo, 0x00ff00ff
  ds_write_b128 v130, v[80:83] offset:1024
  s_nop 0
  ds_write_b128 v130, v[84:87] offset:2048
  s_mov_b64 exec, -1
  s_waitcnt lgkmcnt(0)
  s_barrier
  ds_write_b64 v131, v[44:45]
  ds_write_b64 v131, v[46:47] offset:512
  ds_write_b64 v131, v[106:107] offset:1024
  ds_read_b128 v[44:47], v137 offset:0
  ds_read_b128 v[48:51], v137 offset:1024
  ds_read_b128 v[52:55], v137 offset:2048
  ds_read_b128 v[56:59], v137 offset:3072
  ds_read_b128 v[68:71], v137 offset:4096
  ds_read_b128 v[72:75], v137 offset:5120
  s_waitcnt lgkmcnt(0)
  s_barrier
  s_mov_b32 s28, s50
  buffer_load_dwordx4 v[4:7], v132, s[8:11], s28 offen sc1
  buffer_load_dwordx4 v[8:11], v132, s[8:11], s28 offen offset:1024 sc1
  s_add_u32 s28, s28, 2048
  buffer_load_dwordx4 v[12:15], v132, s[8:11], s28 offen sc1
  buffer_load_dwordx4 v[16:19], v132, s[8:11], s28 offen offset:1024 sc1
  s_add_u32 s28, s28, 2048
  buffer_load_dwordx4 v[20:23], v132, s[8:11], s28 offen sc1
  buffer_load_dwordx4 v[24:27], v132, s[8:11], s28 offen offset:1024 sc1
  s_add_u32 s28, s28, 2048
  buffer_load_dwordx4 v[28:31], v132, s[8:11], s28 offen sc1
  buffer_load_dwordx4 v[32:35], v132, s[8:11], s28 offen offset:1024 sc1
  s_add_u32 s28, s28, 2048
  buffer_load_dwordx4 v[36:39], v132, s[8:11], s28 offen sc1
  buffer_load_dwordx4 v[40:43], v132, s[8:11], s28 offen offset:1024 sc1
  s_add_u32 s28, s28, 2048
  buffer_load_dwordx4 v[60:63], v132, s[8:11], s28 offen sc1
  buffer_load_dwordx4 v[64:67], v132, s[8:11], s28 offen offset:1024 sc1
  s_add_u32 s28, s28, 2048
  ds_read_b64 v[76:77], v136 offset:0
  ds_read_b64 v[78:79], v136 offset:512
  ds_read_b64 v[80:81], v136 offset:1024
  ds_read_b64 v[82:83], v136 offset:1536
  ds_read_b64 v[84:85], v136 offset:2048
  ds_read_b64 v[86:87], v136 offset:2560
  ds_read_b64 v[88:89], v136 offset:3072
  ds_read_b64 v[90:91], v136 offset:3584
  ds_read_b64 v[92:93], v136 offset:4096
  ds_read_b64 v[94:95], v136 offset:4608
  ds_read_b64 v[96:97], v136 offset:5120
  ds_read_b64 v[98:99], v136 offset:5632
  s_waitcnt lgkmcnt(0)
  s_cmp_ge_u32 s51, 63
  s_cbranch_scc1 xq_71_\sfx\()
  s_add_u32 s96, s51, 1
  s_cmp_gt_u32 s52, s96
  s_cbranch_scc1 ka\sfx\()_x_wp_72_ok
  s_mov_b32 s45, 0
ka\sfx\()_x_wp_72_spin:
  buffer_load_dword v2, v138, s[8:11], 0 offen sc1
  s_add_u32 s45, s45, 1
  s_waitcnt vmcnt(0)
  v_min_u32_dpp v3, v2, v2 quad_perm:[1,0,3,2] row_mask:0xf bank_mask:0xf
  s_nop 1
  v_min_u32_dpp v2, v3, v3 quad_perm:[2,3,0,1] row_mask:0xf bank_mask:0xf
  s_nop 1
  v_min_u32_dpp v3, v2, v2 row_half_mirror row_mask:0xf bank_mask:0xf
  s_nop 1
  v_min_u32_dpp v2, v3, v3 quad_perm:[0,1,2,3] row_mask:0xf bank_mask:0xf
  s_nop 0
  v_readfirstlane_b32 s52, v2
  s_cmp_gt_u32 s52, s96
  s_cbranch_scc1 ka\sfx\()_x_wp_72_ok
  s_cmp_lt_u32 s45, 400000
  s_cbranch_scc1 ka\sfx\()_x_wp_72_spin
  s_branch ka\sfx\()_abort
ka\sfx\()_x_wp_72_ok:
  s_add_u32 s95, s63, s93
  s_add_u32 s95, s95, 12288
  s_add_u32 m0, s94, 0
  s_add_u32 s28, s95, 0
  buffer_load_dwordx4 v132, s[8:11], s28 offen sc1 lds
  s_add_u32 m0, s94, 1024
  s_add_u32 s28, s95, 2048
  buffer_load_dwordx4 v132, s[8:11], s28 offen sc1 lds
  s_add_u32 m0, s94, 2048
  s_add_u32 s28, s95, 4096
  buffer_load_dwordx4 v132, s[8:11], s28 offen sc1 lds
  s_add_u32 m0, s94, 3072
  s_add_u32 s28, s95, 6144
  buffer_load_dwordx4 v132, s[8:11], s28 offen sc1 lds
  s_add_u32 m0, s94, 4096
  s_add_u32 s28, s95, 8192
  buffer_load_dwordx4 v132, s[8:11], s28 offen sc1 lds
  s_add_u32 m0, s94, 5120
  s_add_u32 s28, s95, 10240
  buffer_load_dwordx4 v132, s[8:11], s28 offen sc1 lds
  s_branch xq_71_j_\sfx\()
xq_71_\sfx\():
  s_waitcnt vmcnt(0)
xq_71_j_\sfx\():
  s_waitcnt vmcnt(16)
  v_mfma_f32_16x16x32_bf16 v[112:115], v[76:79], v[44:47], 0
  v_mfma_f32_16x16x32_bf16 v[116:119], v[4:7], v[44:47], 0
  v_mfma_f32_16x16x32_bf16 v[120:123], v[8:11], v[44:47], 0
  s_waitcnt vmcnt(14)
  v_mfma_f32_16x16x32_bf16 v[112:115], v[80:83], v[48:51], v[112:115]
  v_mfma_f32_16x16x32_bf16 v[116:119], v[12:15], v[48:51], v[116:119]
  v_mfma_f32_16x16x32_bf16 v[120:123], v[16:19], v[48:51], v[120:123]
  s_waitcnt vmcnt(12)
  v_mfma_f32_16x16x32_bf16 v[112:115], v[84:87], v[52:55], v[112:115]
  v_mfma_f32_16x16x32_bf16 v[116:119], v[20:23], v[52:55], v[116:119]
  v_mfma_f32_16x16x32_bf16 v[120:123], v[24:27], v[52:55], v[120:123]
  s_waitcnt vmcnt(10)
  v_mfma_f32_16x16x32_bf16 v[112:115], v[88:91], v[56:59], v[112:115]
  v_mfma_f32_16x16x32_bf16 v[116:119], v[28:31], v[56:59], v[116:119]
  v_mfma_f32_16x16x32_bf16 v[120:123], v[32:35], v[56:59], v[120:123]
  s_waitcnt vmcnt(8)
  v_mfma_f32_16x16x32_bf16 v[112:115], v[92:95], v[68:71], v[112:115]
  v_mfma_f32_16x16x32_bf16 v[116:119], v[36:39], v[68:71], v[116:119]
  v_mfma_f32_16x16x32_bf16 v[120:123], v[40:43], v[68:71], v[120:123]
  s_waitcnt vmcnt(6)
  v_mfma_f32_16x16x32_bf16 v[112:115], v[96:99], v[72:75], v[112:115]
  v_mfma_f32_16x16x32_bf16 v[116:119], v[60:63], v[72:75], v[116:119]
  v_mfma_f32_16x16x32_bf16 v[120:123], v[64:67], v[72:75], v[120:123]
  s_nop 8
  v_cndmask_b32 v112, v135, v112, s[66:67]
  v_cndmask_b32 v113, v135, v113, s[66:67]
  v_cndmask_b32 v114, v135, v114, s[66:67]
  v_cndmask_b32 v115, v135, v115, s[66:67]
  v_cndmask_b32 v116, v135, v116, s[76:77]
  v_cndmask_b32 v120, v135, v120, s[84:85]
  v_cndmask_b32 v117, v135, v117, s[78:79]
  v_cndmask_b32 v121, v135, v121, s[86:87]
  v_cndmask_b32 v118, v135, v118, s[80:81]
  v_cndmask_b32 v122, v135, v122, s[88:89]
  v_cndmask_b32 v119, v135, v119, s[82:83]
  v_cndmask_b32 v123, v135, v123, s[90:91]
  v_max3_f32 v4, v112, v113, v114
  v_max3_f32 v5, v115, v116, v117
  v_max3_f32 v6, v118, v119, v120
  v_max3_f32 v7, v121, v122, v123
  v_max3_f32 v4, v4, v5, v6
  v_max_f32 v4, v4, v7
  v_mov_b32 v5, v4
  s_nop 1
  v_permlane16_swap_b32 v4, v5
  v_max_f32 v4, v4, v5
  v_mov_b32 v5, v4
  s_nop 1
  v_permlane32_swap_b32 v4, v5
  v_max_f32 v4, v4, v5
  v_mul_f32 v4, s64, v4
  v_fma_f32 v112, v112, s64, -v4
  v_fma_f32 v113, v113, s64, -v4
  v_fma_f32 v114, v114, s64, -v4
  v_fma_f32 v115, v115, s64, -v4
  v_fma_f32 v116, v116, s64, -v4
  v_fma_f32 v117, v117, s64, -v4
  v_fma_f32 v118, v118, s64, -v4
  v_fma_f32 v119, v119, s64, -v4
  v_fma_f32 v120, v120, s64, -v4
  v_fma_f32 v121, v121, s64, -v4
  v_fma_f32 v122, v122, s64, -v4
  v_fma_f32 v123, v123, s64, -v4
  v_exp_f32 v112, v112
  v_exp_f32 v113, v113
  v_exp_f32 v114, v114
  v_exp_f32 v115, v115
  v_exp_f32 v116, v116
  v_exp_f32 v117, v117
  v_exp_f32 v118, v118
  v_exp_f32 v119, v119
  v_exp_f32 v120, v120
  v_exp_f32 v121, v121
  v_exp_f32 v122, v122
  v_exp_f32 v123, v123
  v_add_f32 v5, v112, v113
  v_add_f32 v6, v114, v115
  v_add_f32 v7, v116, v117
  v_add_f32 v8, v118, v119
  v_add_f32 v9, v120, v121
  v_add_f32 v10, v122, v123
  v_add_f32 v5, v5, v6
  v_add_f32 v7, v7, v8
  v_add_f32 v9, v9, v10
  v_add_f32 v5, v5, v7
  v_add_f32 v5, v5, v9
  v_mov_b32 v6, v5
  s_nop 1
  v_permlane16_swap_b32 v5, v6
  v_add_f32 v5, v5, v6
  v_mov_b32 v6, v5
  s_nop 1
  v_permlane32_swap_b32 v5, v6
  v_add_f32 v5, v5, v6
  v_rcp_f32 v5, v5
  s_nop 0
  v_mul_f32 v112, v112, v5
  v_mul_f32 v113, v113, v5
  v_mul_f32 v114, v114, v5
  v_mul_f32 v115, v115, v5
  v_mul_f32 v116, v116, v5
  v_mul_f32 v117, v117, v5
  v_mul_f32 v118, v118, v5
  v_mul_f32 v119, v119, v5
  v_mul_f32 v120, v120, v5
  v_mul_f32 v121, v121, v5
  v_mul_f32 v122, v122, v5
  v_mul_f32 v123, v123, v5
  v_cvt_pk_bf16_f32 v8, v112, v113
  v_cvt_pk_bf16_f32 v9, v114, v115
  v_cvt_pk_bf16_f32 v10, v116, v117
  v_cvt_pk_bf16_f32 v11, v118, v119
  v_cvt_pk_bf16_f32 v12, v120, v121
  v_cvt_pk_bf16_f32 v13, v122, v123
  buffer_store_dwordx2 v[10:11], v133, s[8:11], s92 offen \pol
  buffer_store_dwordx2 v[12:13], v133, s[8:11], s92 offen offset:256 \pol
  buffer_store_dwordx2 v[8:9], v134, s[8:11], s92 offen \pol
  s_add_u32 s92, s92, 20480
  s_cmp_ge_u32 s51, 63
  s_cbranch_scc1 ka\sfx\()_x_done
  v_mov_b32 v60, 0
  v_mov_b32 v61, 0
  v_mov_b32 v62, 0
  v_mov_b32 v63, 0
  v_mov_b32 v64, 0
  v_mov_b32 v65, 0
  v_mov_b32 v66, 0
  v_mov_b32 v67, 0
  v_mov_b32 v68, 0
  v_mov_b32 v69, 0
  v_mov_b32 v70, 0
  v_mov_b32 v71, 0
  v_mov_b32 v72, 0
  v_mov_b32 v73, 0
  v_mov_b32 v74, 0
  v_mov_b32 v75, 0
  v_mov_b32 v36, 0
  v_mov_b32 v37, 0
  v_mov_b32 v38, 0
  v_mov_b32 v39, 0
  v_mov_b32 v40, 0
  v_mov_b32 v41, 0
  v_mov_b32 v42, 0
  v_mov_b32 v43, 0
  s_add_u32 s97, s97, 10240
  s_mov_b32 s48, s97
  s_add_u32 s49, s49, 5120
  s_add_u32 s50, s50, 12288
  s_add_u32 s63, s63, 12288
  s_add_u32 s51, s51, 1
  s_cmp_gt_u32 s52, s51
  s_cbranch_scc1 ka\sfx\()_x_wp_73_ok
  s_mov_b32 s45, 0
ka\sfx\()_x_wp_73_spin:
  buffer_load_dword v2, v138, s[8:11], 0 offen sc1
  s_add_u32 s45, s45, 1
  s_waitcnt vmcnt(0)
  v_min_u32_dpp v3, v2, v2 quad_perm:[1,0,3,2] row_mask:0xf bank_mask:0xf
  s_nop 1
  v_min_u32_dpp v2, v3, v3 quad_perm:[2,3,0,1] row_mask:0xf bank_mask:0xf
  s_nop 1
  v_min_u32_dpp v3, v2, v2 row_half_mirror row_mask:0xf bank_mask:0xf
  s_nop 1
  v_min_u32_dpp v2, v3, v3 quad_perm:[0,1,2,3] row_mask:0xf bank_mask:0xf
  s_nop 0
  v_readfirstlane_b32 s52, v2
  s_cmp_gt_u32 s52, s51
  s_cbranch_scc1 ka\sfx\()_x_wp_73_ok
  s_cmp_lt_u32 s45, 400000
  s_cbranch_scc1 ka\sfx\()_x_wp_73_spin
  s_branch ka\sfx\()_abort
ka\sfx\()_x_wp_73_ok:
  s_add_u32 s28, s50, s53
  buffer_load_dwordx2 v[88:89], v132, s[8:11], s28 offen offset:0 sc1
  buffer_load_dwordx2 v[92:93], v132, s[8:11], s28 offen offset:1024 sc1
  s_add_u32 s28, s50, s54
  buffer_load_dwordx2 v[90:91], v132, s[8:11], s28 offen offset:0 sc1
  buffer_load_dwordx2 v[94:95], v132, s[8:11], s28 offen offset:1024 sc1
  s_add_u32 s28, s50, s55
  buffer_load_dwordx2 v[96:97], v132, s[8:11], s28 offen offset:0 sc1
  buffer_load_dwordx2 v[98:99], v132, s[8:11], s28 offen offset:1024 sc1
  s_branch ka\sfx\()_x_w2l
ka\sfx\()_x_w3l:
  ds_read_b128 v[44:47], v129 offset:2048
  ds_read_b128 v[48:51], v129 offset:3072
  ds_read_b128 v[52:55], v129 offset:12288
  ds_read_b128 v[56:59], v129 offset:13312
  s_waitcnt lgkmcnt(0)
  s_mov_b32 s45, 0
ka\sfx\()_x_pf_74:
  buffer_load_dwordx4 v[112:115], v124, s[8:11], s48 offen sc1
  buffer_load_dwordx4 v[116:119], v125, s[8:11], s48 offen sc1
  s_add_u32 s45, s45, 1
  s_waitcnt vmcnt(1)
  ds_write_b128 v127, v[112:115] offset:0
  v_max3_u32 v139, v112, v113, v114
  v_max_u32 v139, v139, v115
  s_waitcnt vmcnt(0)
  ds_write_b128 v127, v[116:119] offset:4096
  v_max3_u32 v139, v139, v116, v117
  v_max3_u32 v139, v139, v118, v119
  v_cmp_eq_u32 vcc, -1, v139
  s_cbranch_vccz ka\sfx\()_x_pf_74_ok
  s_cmp_lt_u32 s45, 400000
  s_cbranch_scc1 ka\sfx\()_x_pf_74
  s_branch ka\sfx\()_abort
ka\sfx\()_x_pf_74_ok:
  v_smfmac_f32_16x16x64_bf16 v[60:63], v[112:115], a[24:31], v110
  v_smfmac_f32_16x16x64_bf16 v[64:67], v[112:115], v[44:51], v110
  ds_read_b128 v[44:47], v129 offset:22528
  v_smfmac_f32_16x16x64_bf16 v[68:71], v[112:115], a[104:111], v110
  ds_read_b128 v[48:51], v129 offset:23552
  v_smfmac_f32_16x16x64_bf16 v[72:75], v[112:115], v[52:59], v110
  ds_read_b128 v[52:55], v129 offset:6144
  s_waitcnt lgkmcnt(3)
  s_barrier
  v_smfmac_f32_16x16x64_bf16 v[36:39], v[112:115], a[184:191], v110
  ds_read_b128 v[56:59], v129 offset:7168
  ds_read_b128 v[4:7], v128 offset:0
  s_waitcnt lgkmcnt(3)
  v_smfmac_f32_16x16x64_bf16 v[40:43], v[112:115], v[44:51], v110
  ds_read_b128 v[44:47], v129 offset:16384
  ds_read_b128 v[8:11], v128 offset:1024
  v_smfmac_f32_16x16x64_bf16 v[60:63], v[116:119], a[56:63], v110
  ds_read_b128 v[48:51], v129 offset:17408
  ds_read_b128 v[12:15], v128 offset:2048
  s_waitcnt lgkmcnt(5)
  v_smfmac_f32_16x16x64_bf16 v[64:67], v[116:119], v[52:59], v110
  ds_read_b128 v[52:55], v129 offset:26624
  ds_read_b128 v[16:19], v128 offset:4096
  v_smfmac_f32_16x16x64_bf16 v[68:71], v[116:119], a[136:143], v110
  ds_read_b128 v[56:59], v129 offset:27648
  ds_read_b128 v[20:23], v128 offset:5120
  s_waitcnt lgkmcnt(5)
  v_smfmac_f32_16x16x64_bf16 v[72:75], v[116:119], v[44:51], v110
  ds_read_b128 v[44:47], v129 offset:0
  ds_read_b128 v[24:27], v128 offset:6144
  v_smfmac_f32_16x16x64_bf16 v[36:39], v[116:119], a[216:223], v110
  ds_read_b128 v[48:51], v129 offset:1024
  ds_read_b128 v[28:31], v128 offset:8192
  s_waitcnt lgkmcnt(5)
  v_smfmac_f32_16x16x64_bf16 v[40:43], v[116:119], v[52:59], v110
  ds_read_b128 v[52:55], v129 offset:4096
  ds_read_b128 v[32:35], v128 offset:9216
  v_smfmac_f32_16x16x64_bf16 v[60:63], v[4:7], a[0:7], v110
  ds_read_b128 v[56:59], v129 offset:5120
  v_smfmac_f32_16x16x64_bf16 v[64:67], v[4:7], a[240:247], v110
  v_smfmac_f32_16x16x64_bf16 v[60:63], v[8:11], a[8:15], v110
  s_waitcnt lgkmcnt(4)
  v_smfmac_f32_16x16x64_bf16 v[64:67], v[8:11], v[44:51], v110
  ds_read_b128 v[44:47], v129 offset:8192
  v_smfmac_f32_16x16x64_bf16 v[60:63], v[12:15], a[16:23], v110
  ds_read_b128 v[48:51], v129 offset:9216
  v_smfmac_f32_16x16x64_bf16 v[64:67], v[12:15], a[248:255], v110
  v_smfmac_f32_16x16x64_bf16 v[60:63], v[16:19], a[32:39], v110
  v_smfmac_f32_16x16x64_bf16 v[64:67], v[16:19], v[152:159], v110
  v_smfmac_f32_16x16x64_bf16 v[60:63], v[20:23], a[40:47], v110
  s_waitcnt lgkmcnt(2)
  v_smfmac_f32_16x16x64_bf16 v[64:67], v[20:23], v[52:59], v110
  ds_read_b128 v[52:55], v129 offset:10240
  v_smfmac_f32_16x16x64_bf16 v[60:63], v[24:27], a[48:55], v110
  ds_read_b128 v[56:59], v129 offset:11264
  v_smfmac_f32_16x16x64_bf16 v[64:67], v[24:27], v[160:167], v110
  v_smfmac_f32_16x16x64_bf16 v[60:63], v[28:31], a[64:71], v110
  v_smfmac_f32_16x16x64_bf16 v[64:67], v[28:31], v[168:175], v110
  v_smfmac_f32_16x16x64_bf16 v[60:63], v[32:35], a[72:79], v110
  s_waitcnt lgkmcnt(2)
  v_smfmac_f32_16x16x64_bf16 v[64:67], v[32:35], v[44:51], v110
  ds_read_b128 v[44:47], v129 offset:14336
  v_smfmac_f32_16x16x64_bf16 v[68:71], v[4:7], a[80:87], v110
  ds_read_b128 v[48:51], v129 offset:15360
  v_smfmac_f32_16x16x64_bf16 v[72:75], v[4:7], v[176:183], v110
  v_permlane32_swap_b32 v60, v64
  v_smfmac_f32_16x16x64_bf16 v[68:71], v[8:11], a[88:95], v110
  s_waitcnt lgkmcnt(2)
  v_smfmac_f32_16x16x64_bf16 v[72:75], v[8:11], v[52:59], v110
  ds_read_b128 v[52:55], v129 offset:18432
  v_permlane32_swap_b32 v61, v65
  v_smfmac_f32_16x16x64_bf16 v[68:71], v[12:15], a[96:103], v110
  ds_read_b128 v[56:59], v129 offset:19456
  v_smfmac_f32_16x16x64_bf16 v[72:75], v[12:15], v[184:191], v110
  v_permlane32_swap_b32 v62, v66
  v_smfmac_f32_16x16x64_bf16 v[68:71], v[16:19], a[112:119], v110
  v_permlane32_swap_b32 v63, v67
  v_smfmac_f32_16x16x64_bf16 v[72:75], v[16:19], v[192:199], v110
  v_add_f32 v60, v60, v64
  v_smfmac_f32_16x16x64_bf16 v[68:71], v[20:23], a[120:127], v110
  v_add_f32 v61, v61, v65
  s_waitcnt lgkmcnt(2)
  v_smfmac_f32_16x16x64_bf16 v[72:75], v[20:23], v[44:51], v110
  ds_read_b128 v[44:47], v129 offset:20480
  v_add_f32 v62, v62, v66
  v_smfmac_f32_16x16x64_bf16 v[68:71], v[24:27], a[128:135], v110
  ds_read_b128 v[48:51], v129 offset:21504
  v_add_f32 v63, v63, v67
  v_smfmac_f32_16x16x64_bf16 v[72:75], v[24:27], v[200:207], v110
  v_cvt_pk_bf16_f32 v100, v60, v61
  v_smfmac_f32_16x16x64_bf16 v[68:71], v[28:31], a[144:151], v110
  v_cvt_pk_bf16_f32 v101, v62, v63
  v_smfmac_f32_16x16x64_bf16 v[72:75], v[28:31], v[208:215], v110
  v_smfmac_f32_16x16x64_bf16 v[68:71], v[32:35], a[152:159], v110
  s_waitcnt lgkmcnt(2)
  v_smfmac_f32_16x16x64_bf16 v[72:75], v[32:35], v[52:59], v110
  ds_read_b128 v[52:55], v129 offset:24576
  v_smfmac_f32_16x16x64_bf16 v[36:39], v[4:7], a[160:167], v110
  ds_read_b128 v[56:59], v129 offset:25600
  v_smfmac_f32_16x16x64_bf16 v[40:43], v[4:7], v[216:223], v110
  v_permlane32_swap_b32 v68, v72
  v_smfmac_f32_16x16x64_bf16 v[36:39], v[8:11], a[168:175], v110
  s_waitcnt lgkmcnt(2)
  v_smfmac_f32_16x16x64_bf16 v[40:43], v[8:11], v[44:51], v110
  ds_read_b128 v[44:47], v129 offset:28672
  v_permlane32_swap_b32 v69, v73
  v_smfmac_f32_16x16x64_bf16 v[36:39], v[12:15], a[176:183], v110
  ds_read_b128 v[48:51], v129 offset:29696
  v_smfmac_f32_16x16x64_bf16 v[40:43], v[12:15], v[224:231], v110
  v_permlane32_swap_b32 v70, v74
  v_smfmac_f32_16x16x64_bf16 v[36:39], v[16:19], a[192:199], v110
  v_permlane32_swap_b32 v71, v75
  v_smfmac_f32_16x16x64_bf16 v[40:43], v[16:19], v[232:239], v110
  v_add_f32 v68, v68, v72
  v_smfmac_f32_16x16x64_bf16 v[36:39], v[20:23], a[200:207], v110
  v_add_f32 v69, v69, v73
  s_waitcnt lgkmcnt(2)
  v_smfmac_f32_16x16x64_bf16 v[40:43], v[20:23], v[52:59], v110
  v_add_f32 v70, v70, v74
  v_smfmac_f32_16x16x64_bf16 v[36:39], v[24:27], a[208:215], v110
  v_add_f32 v71, v71, v75
  v_smfmac_f32_16x16x64_bf16 v[40:43], v[24:27], v[240:247], v110
  v_cvt_pk_bf16_f32 v102, v68, v69
  v_smfmac_f32_16x16x64_bf16 v[36:39], v[28:31], a[224:231], v110
  v_cvt_pk_bf16_f32 v103, v70, v71
  v_smfmac_f32_16x16x64_bf16 v[40:43], v[28:31], v[248:255], v110
  v_smfmac_f32_16x16x64_bf16 v[36:39], v[32:35], a[232:239], v110
  s_waitcnt lgkmcnt(0)
  v_smfmac_f32_16x16x64_bf16 v[40:43], v[32:35], v[44:51], v110
  v_mfma_f32_16x16x16_bf16 v[142:145], v[100:101], v[108:109], 0
  v_mfma_f32_16x16x16_bf16 v[146:149], v[102:103], v[108:109], 0
  s_nop 1
  v_permlane32_swap_b32 v36, v40
  v_permlane32_swap_b32 v37, v41
  v_permlane32_swap_b32 v38, v42
  v_permlane32_swap_b32 v39, v43
  v_add_f32 v36, v36, v40
  v_add_f32 v37, v37, v41
  v_add_f32 v38, v38, v42
  v_add_f32 v39, v39, v43
  v_cvt_pk_bf16_f32 v104, v36, v37
  v_cvt_pk_bf16_f32 v105, v38, v39
  v_cvt_pk_bf16_f32 v44, v142, v143
  v_cvt_pk_bf16_f32 v45, v144, v145
  v_mfma_f32_16x16x16_bf16 v[142:145], v[104:105], v[108:109], 0
  v_cvt_pk_bf16_f32 v46, v146, v147
  v_cvt_pk_bf16_f32 v47, v148, v149
  s_nop 1
  v_mfma_f32_16x16x32_bf16 v[76:79], v[44:47], v[44:47], 0
  v_mfma_f32_16x16x32_bf16 v[80:83], v[88:91], v[44:47], 0
  v_cvt_pk_bf16_f32 v106, v142, v143
  v_cvt_pk_bf16_f32 v107, v144, v145
  v_mfma_f32_16x16x32_bf16 v[84:87], v[92:95], v[44:47], 0
  s_nop 0
  v_mfma_f32_16x16x16_bf16 v[76:79], v[106:107], v[106:107], v[76:79]
  v_mfma_f32_16x16x16_bf16 v[80:83], v[96:97], v[106:107], v[80:83]
  v_mfma_f32_16x16x16_bf16 v[84:87], v[98:99], v[106:107], v[84:87]
  s_mov_b32 exec_lo, 0
  s_mov_b32 exec_hi, 0x00ff00ff
  s_nop 3
  ds_write_b128 v130, v[76:79]
  s_mov_b32 exec_lo, 0x00ff00ff
  ds_write_b128 v130, v[80:83] offset:1024
  s_nop 0
  ds_write_b128 v130, v[84:87] offset:2048
  s_mov_b64 exec, -1
  s_waitcnt lgkmcnt(0)
  s_barrier
  ds_write_b64 v131, v[44:45]
  ds_write_b64 v131, v[46:47] offset:512
  ds_write_b64 v131, v[106:107] offset:1024
  ds_read_b128 v[44:47], v137 offset:0
  ds_read_b128 v[48:51], v137 offset:1024
  ds_read_b128 v[52:55], v137 offset:2048
  ds_read_b128 v[56:59], v137 offset:3072
  ds_read_b128 v[68:71], v137 offset:4096
  ds_read_b128 v[72:75], v137 offset:5120
  s_waitcnt lgkmcnt(0)
  s_barrier
  s_mov_b32 s28, s50
  buffer_load_dwordx4 v[4:7], v132, s[8:11], s28 offen sc1
  buffer_load_dwordx4 v[8:11], v132, s[8:11], s28 offen offset:1024 sc1
  s_add_u32 s28, s28, 2048
  buffer_load_dwordx4 v[12:15], v132, s[8:11], s28 offen sc1
  buffer_load_dwordx4 v[16:19], v132, s[8:11], s28 offen offset:1024 sc1
  s_add_u32 s28, s28, 2048
  buffer_load_dwordx4 v[20:23], v132, s[8:11], s28 offen sc1
  buffer_load_dwordx4 v[24:27], v132, s[8:11], s28 offen offset:1024 sc1
  s_add_u32 s28, s28, 2048
  buffer_load_dwordx4 v[28:31], v132, s[8:11], s28 offen sc1
  buffer_load_dwordx4 v[32:35], v132, s[8:11], s28 offen offset:1024 sc1
  s_add_u32 s28, s28, 2048
  buffer_load_dwordx4 v[36:39], v132, s[8:11], s28 offen sc1
  buffer_load_dwordx4 v[40:43], v132, s[8:11], s28 offen offset:1024 sc1
  s_add_u32 s28, s28, 2048
  buffer_load_dwordx4 v[60:63], v132, s[8:11], s28 offen sc1
  buffer_load_dwordx4 v[64:67], v132, s[8:11], s28 offen offset:1024 sc1
  s_add_u32 s28, s28, 2048
  ds_read_b64 v[76:77], v136 offset:0
  ds_read_b64 v[78:79], v136 offset:512
  ds_read_b64 v[80:81], v136 offset:1024
  ds_read_b64 v[82:83], v136 offset:1536
  ds_read_b64 v[84:85], v136 offset:2048
  ds_read_b64 v[86:87], v136 offset:2560
  ds_read_b64 v[88:89], v136 offset:3072
  ds_read_b64 v[90:91], v136 offset:3584
  ds_read_b64 v[92:93], v136 offset:4096
  ds_read_b64 v[94:95], v136 offset:4608
  ds_read_b64 v[96:97], v136 offset:5120
  ds_read_b64 v[98:99], v136 offset:5632
  s_waitcnt lgkmcnt(0)
  s_cmp_ge_u32 s51, 63
  s_cbranch_scc1 xq_75_\sfx\()
  s_add_u32 s96, s51, 1
  s_cmp_gt_u32 s52, s96
  s_cbranch_scc1 ka\sfx\()_x_wp_76_ok
  s_mov_b32 s45, 0
ka\sfx\()_x_wp_76_spin:
  buffer_load_dword v2, v138, s[8:11], 0 offen sc1
  s_add_u32 s45, s45, 1
  s_waitcnt vmcnt(0)
  v_min_u32_dpp v3, v2, v2 quad_perm:[1,0,3,2] row_mask:0xf bank_mask:0xf
  s_nop 1
  v_min_u32_dpp v2, v3, v3 quad_perm:[2,3,0,1] row_mask:0xf bank_mask:0xf
  s_nop 1
  v_min_u32_dpp v3, v2, v2 row_half_mirror row_mask:0xf bank_mask:0xf
  s_nop 1
  v_min_u32_dpp v2, v3, v3 quad_perm:[0,1,2,3] row_mask:0xf bank_mask:0xf
  s_nop 0
  v_readfirstlane_b32 s52, v2
  s_cmp_gt_u32 s52, s96
  s_cbranch_scc1 ka\sfx\()_x_wp_76_ok
  s_cmp_lt_u32 s45, 400000
  s_cbranch_scc1 ka\sfx\()_x_wp_76_spin
  s_branch ka\sfx\()_abort
ka\sfx\()_x_wp_76_ok:
  s_add_u32 s95, s63, s93
  s_add_u32 s95, s95, 12288
  s_add_u32 m0, s94, 0
  s_add_u32 s28, s95, 0
  buffer_load_dwordx4 v132, s[8:11], s28 offen sc1 lds
  s_add_u32 m0, s94, 1024
  s_add_u32 s28, s95, 2048
  buffer_load_dwordx4 v132, s[8:11], s28 offen sc1 lds
  s_add_u32 m0, s94, 2048
  s_add_u32 s28, s95, 4096
  buffer_load_dwordx4 v132, s[8:11], s28 offen sc1 lds
  s_add_u32 m0, s94, 3072
  s_add_u32 s28, s95, 6144
  buffer_load_dwordx4 v132, s[8:11], s28 offen sc1 lds
  s_add_u32 m0, s94, 4096
  s_add_u32 s28, s95, 8192
  buffer_load_dwordx4 v132, s[8:11], s28 offen sc1 lds
  s_add_u32 m0, s94, 5120
  s_add_u32 s28, s95, 10240
  buffer_load_dwordx4 v132, s[8:11], s28 offen sc1 lds
  s_branch xq_75_j_\sfx\()
xq_75_\sfx\():
  s_waitcnt vmcnt(0)
xq_75_j_\sfx\():
  s_waitcnt vmcnt(16)
  v_mfma_f32_16x16x32_bf16 v[112:115], v[76:79], v[44:47], 0
  v_mfma_f32_16x16x32_bf16 v[116:119], v[4:7], v[44:47], 0
  v_mfma_f32_16x16x32_bf16 v[120:123], v[8:11], v[44:47], 0
  s_waitcnt vmcnt(14)
  v_mfma_f32_16x16x32_bf16 v[112:115], v[80:83], v[48:51], v[112:115]
  v_mfma_f32_16x16x32_bf16 v[116:119], v[12:15], v[48:51], v[116:119]
  v_mfma_f32_16x16x32_bf16 v[120:123], v[16:19], v[48:51], v[120:123]
  s_waitcnt vmcnt(12)
  v_mfma_f32_16x16x32_bf16 v[112:115], v[84:87], v[52:55], v[112:115]
  v_mfma_f32_16x16x32_bf16 v[116:119], v[20:23], v[52:55], v[116:119]
  v_mfma_f32_16x16x32_bf16 v[120:123], v[24:27], v[52:55], v[120:123]
  s_waitcnt vmcnt(10)
  v_mfma_f32_16x16x32_bf16 v[112:115], v[88:91], v[56:59], v[112:115]
  v_mfma_f32_16x16x32_bf16 v[116:119], v[28:31], v[56:59], v[116:119]
  v_mfma_f32_16x16x32_bf16 v[120:123], v[32:35], v[56:59], v[120:123]
  s_waitcnt vmcnt(8)
  v_mfma_f32_16x16x32_bf16 v[112:115], v[92:95], v[68:71], v[112:115]
  v_mfma_f32_16x16x32_bf16 v[116:119], v[36:39], v[68:71], v[116:119]
  v_mfma_f32_16x16x32_bf16 v[120:123], v[40:43], v[68:71], v[120:123]
  s_waitcnt vmcnt(6)
  v_mfma_f32_16x16x32_bf16 v[112:115], v[96:99], v[72:75], v[112:115]
  v_mfma_f32_16x16x32_bf16 v[116:119], v[60:63], v[72:75], v[116:119]
  v_mfma_f32_16x16x32_bf16 v[120:123], v[64:67], v[72:75], v[120:123]
  s_nop 8
  v_cndmask_b32 v112, v135, v112, s[66:67]
  v_cndmask_b32 v113, v135, v113, s[66:67]
  v_cndmask_b32 v114, v135, v114, s[66:67]
  v_cndmask_b32 v115, v135, v115, s[66:67]
  v_cndmask_b32 v116, v135, v116, s[76:77]
  v_cndmask_b32 v120, v135, v120, s[84:85]
  v_cndmask_b32 v117, v135, v117, s[78:79]
  v_cndmask_b32 v121, v135, v121, s[86:87]
  v_cndmask_b32 v118, v135, v118, s[80:81]
  v_cndmask_b32 v122, v135, v122, s[88:89]
  v_cndmask_b32 v119, v135, v119, s[82:83]
  v_cndmask_b32 v123, v135, v123, s[90:91]
  v_max3_f32 v4, v112, v113, v114
  v_max3_f32 v5, v115, v116, v117
  v_max3_f32 v6, v118, v119, v120
  v_max3_f32 v7, v121, v122, v123
  v_max3_f32 v4, v4, v5, v6
  v_max_f32 v4, v4, v7
  v_mov_b32 v5, v4
  s_nop 1
  v_permlane16_swap_b32 v4, v5
  v_max_f32 v4, v4, v5
  v_mov_b32 v5, v4
  s_nop 1
  v_permlane32_swap_b32 v4, v5
  v_max_f32 v4, v4, v5
  v_mul_f32 v4, s64, v4
  v_fma_f32 v112, v112, s64, -v4
  v_fma_f32 v113, v113, s64, -v4
  v_fma_f32 v114, v114, s64, -v4
  v_fma_f32 v115, v115, s64, -v4
  v_fma_f32 v116, v116, s64, -v4
  v_fma_f32 v117, v117, s64, -v4
  v_fma_f32 v118, v118, s64, -v4
  v_fma_f32 v119, v119, s64, -v4
  v_fma_f32 v120, v120, s64, -v4
  v_fma_f32 v121, v121, s64, -v4
  v_fma_f32 v122, v122, s64, -v4
  v_fma_f32 v123, v123, s64, -v4
  v_exp_f32 v112, v112
  v_exp_f32 v113, v113
  v_exp_f32 v114, v114
  v_exp_f32 v115, v115
  v_exp_f32 v116, v116
  v_exp_f32 v117, v117
  v_exp_f32 v118, v118
  v_exp_f32 v119, v119
  v_exp_f32 v120, v120
  v_exp_f32 v121, v121
  v_exp_f32 v122, v122
  v_exp_f32 v123, v123
  v_add_f32 v5, v112, v113
  v_add_f32 v6, v114, v115
  v_add_f32 v7, v116, v117
  v_add_f32 v8, v118, v119
  v_add_f32 v9, v120, v121
  v_add_f32 v10, v122, v123
  v_add_f32 v5, v5, v6
  v_add_f32 v7, v7, v8
  v_add_f32 v9, v9, v10
  v_add_f32 v5, v5, v7
  v_add_f32 v5, v5, v9
  v_mov_b32 v6, v5
  s_nop 1
  v_permlane16_swap_b32 v5, v6
  v_add_f32 v5, v5, v6
  v_mov_b32 v6, v5
  s_nop 1
  v_permlane32_swap_b32 v5, v6
  v_add_f32 v5, v5, v6
  v_rcp_f32 v5, v5
  s_nop 0
  v_mul_f32 v112, v112, v5
  v_mul_f32 v113, v113, v5
  v_mul_f32 v114, v114, v5
  v_mul_f32 v115, v115, v5
  v_mul_f32 v116, v116, v5
  v_mul_f32 v117, v117, v5
  v_mul_f32 v118, v118, v5
  v_mul_f32 v119, v119, v5
  v_mul_f32 v120, v120, v5
  v_mul_f32 v121, v121, v5
  v_mul_f32 v122, v122, v5
  v_mul_f32 v123, v123, v5
  v_cvt_pk_bf16_f32 v8, v112, v113
  v_cvt_pk_bf16_f32 v9, v114, v115
  v_cvt_pk_bf16_f32 v10, v116, v117
  v_cvt_pk_bf16_f32 v11, v118, v119
  v_cvt_pk_bf16_f32 v12, v120, v121
  v_cvt_pk_bf16_f32 v13, v122, v123
  buffer_store_dwordx2 v[10:11], v133, s[8:11], s92 offen \pol
  buffer_store_dwordx2 v[12:13], v133, s[8:11], s92 offen offset:256 \pol
  buffer_store_dwordx2 v[8:9], v134, s[8:11], s92 offen \pol
  s_add_u32 s92, s92, 20480
  s_cmp_ge_u32 s51, 63
  s_cbranch_scc1 ka\sfx\()_x_done
  v_mov_b32 v60, 0
  v_mov_b32 v61, 0
  v_mov_b32 v62, 0
  v_mov_b32 v63, 0
  v_mov_b32 v64, 0
  v_mov_b32 v65, 0
  v_mov_b32 v66, 0
  v_mov_b32 v67, 0
  v_mov_b32 v68, 0
  v_mov_b32 v69, 0
  v_mov_b32 v70, 0
  v_mov_b32 v71, 0
  v_mov_b32 v72, 0
  v_mov_b32 v73, 0
  v_mov_b32 v74, 0
  v_mov_b32 v75, 0
  v_mov_b32 v36, 0
  v_mov_b32 v37, 0
  v_mov_b32 v38, 0
  v_mov_b32 v39, 0
  v_mov_b32 v40, 0
  v_mov_b32 v41, 0
  v_mov_b32 v42, 0
  v_mov_b32 v43, 0
  s_add_u32 s97, s97, 10240
  s_mov_b32 s48, s97
  s_add_u32 s49, s49, 5120
  s_add_u32 s50, s50, 12288
  s_add_u32 s63, s63, 12288
  s_add_u32 s51, s51, 1
  s_cmp_gt_u32 s52, s51
  s_cbranch_scc1 ka\sfx\()_x_wp_77_ok
  s_mov_b32 s45, 0
ka\sfx\()_x_wp_77_spin:
  buffer_load_dword v2, v138, s[8:11], 0 offen sc1
  s_add_u32 s45, s45, 1
  s_waitcnt vmcnt(0)
  v_min_u32_dpp v3, v2, v2 quad_perm:[1,0,3,2] row_mask:0xf bank_mask:0xf
  s_nop 1
  v_min_u32_dpp v2, v3, v3 quad_perm:[2,3,0,1] row_mask:0xf bank_mask:0xf
  s_nop 1
  v_min_u32_dpp v3, v2, v2 row_half_mirror row_mask:0xf bank_mask:0xf
  s_nop 1
  v_min_u32_dpp v2, v3, v3 quad_perm:[0,1,2,3] row_mask:0xf bank_mask:0xf
  s_nop 0
  v_readfirstlane_b32 s52, v2
  s_cmp_gt_u32 s52, s51
  s_cbranch_scc1 ka\sfx\()_x_wp_77_ok
  s_cmp_lt_u32 s45, 400000
  s_cbranch_scc1 ka\sfx\()_x_wp_77_spin
  s_branch ka\sfx\()_abort
ka\sfx\()_x_wp_77_ok:
  s_add_u32 s28, s50, s53
  buffer_load_dwordx2 v[88:89], v132, s[8:11], s28 offen offset:0 sc1
  buffer_load_dwordx2 v[92:93], v132, s[8:11], s28 offen offset:1024 sc1
  s_add_u32 s28, s50, s54
  buffer_load_dwordx2 v[90:91], v132, s[8:11], s28 offen offset:0 sc1
  buffer_load_dwordx2 v[94:95], v132, s[8:11], s28 offen offset:1024 sc1
  s_add_u32 s28, s50, s55
  buffer_load_dwordx2 v[96:97], v132, s[8:11], s28 offen offset:0 sc1
  buffer_load_dwordx2 v[98:99], v132, s[8:11], s28 offen offset:1024 sc1
  s_branch ka\sfx\()_x_w3l
ka\sfx\()_x_done:
  s_waitcnt vmcnt(0) lgkmcnt(0)
  s_branch ka\sfx\()_exit
ka\sfx\()_y:
  v_and_b32 v1, 63, v0
  v_lshlrev_b32 v178, 4, v1
  s_and_b32 s28, s21, 1
  s_lshl_b32 s46, s23, 1
  s_add_u32 s46, s46, s28
  s_lshr_b32 s28, s21, 1
  s_lshl_b32 s28, s28, 2
  s_lshl_b32 s47, s20, 3
  s_add_u32 s47, s47, s28
  s_mul_i32 s28, s47, 40
  s_add_u32 s28, s28, s46
  s_mul_i32 s28, s28, 20480
  s_add_u32 s28, s28, 0x2e00000
  s_add_u32 s29, s28, 0
  buffer_load_dwordx4 a[0:3], v178, s[8:11], s29 offen
  buffer_load_dwordx4 a[4:7], v178, s[8:11], s29 offen offset:1024
  s_add_u32 s29, s28, 2048
  buffer_load_dwordx4 a[8:11], v178, s[8:11], s29 offen
  buffer_load_dwordx4 a[12:15], v178, s[8:11], s29 offen offset:1024
  s_add_u32 s29, s28, 4096
  buffer_load_dwordx4 a[16:19], v178, s[8:11], s29 offen
  buffer_load_dwordx4 a[20:23], v178, s[8:11], s29 offen offset:1024
  s_add_u32 s29, s28, 6144
  buffer_load_dwordx4 a[24:27], v178, s[8:11], s29 offen
  buffer_load_dwordx4 a[28:31], v178, s[8:11], s29 offen offset:1024
  s_add_u32 s29, s28, 8192
  buffer_load_dwordx4 a[32:35], v178, s[8:11], s29 offen
  buffer_load_dwordx4 a[36:39], v178, s[8:11], s29 offen offset:1024
  s_add_u32 s29, s28, 10240
  buffer_load_dwordx4 a[40:43], v178, s[8:11], s29 offen
  buffer_load_dwordx4 a[44:47], v178, s[8:11], s29 offen offset:1024
  s_add_u32 s29, s28, 12288
  buffer_load_dwordx4 a[48:51], v178, s[8:11], s29 offen
  buffer_load_dwordx4 a[52:55], v178, s[8:11], s29 offen offset:1024
  s_add_u32 s29, s28, 14336
  buffer_load_dwordx4 a[56:59], v178, s[8:11], s29 offen
  buffer_load_dwordx4 a[60:63], v178, s[8:11], s29 offen offset:1024
  s_add_u32 s29, s28, 16384
  buffer_load_dwordx4 a[64:67], v178, s[8:11], s29 offen
  buffer_load_dwordx4 a[68:71], v178, s[8:11], s29 offen offset:1024
  s_add_u32 s29, s28, 18432
  buffer_load_dwordx4 a[72:75], v178, s[8:11], s29 offen
  buffer_load_dwordx4 a[76:79], v178, s[8:11], s29 offen offset:1024
  s_add_u32 s29, s28, 819200
  buffer_load_dwordx4 a[80:83], v178, s[8:11], s29 offen
  buffer_load_dwordx4 a[84:87], v178, s[8:11], s29 offen offset:1024
  s_add_u32 s29, s28, 821248
  buffer_load_dwordx4 a[88:91], v178, s[8:11], s29 offen
  buffer_load_dwordx4 a[92:95], v178, s[8:11], s29 offen offset:1024
  s_add_u32 s29, s28, 823296
  buffer_load_dwordx4 a[96:99], v178, s[8:11], s29 offen
  buffer_load_dwordx4 a[100:103], v178, s[8:11], s29 offen offset:1024
  s_add_u32 s29, s28, 825344
  buffer_load_dwordx4 a[104:107], v178, s[8:11], s29 offen
  buffer_load_dwordx4 a[108:111], v178, s[8:11], s29 offen offset:1024
  s_add_u32 s29, s28, 827392
  buffer_load_dwordx4 a[112:115], v178, s[8:11], s29 offen
  buffer_load_dwordx4 a[116:119], v178, s[8:11], s29 offen offset:1024
  s_add_u32 s29, s28, 829440
  buffer_load_dwordx4 a[120:123], v178, s[8:11], s29 offen
  buffer_load_dwordx4 a[124:127], v178, s[8:11], s29 offen offset:1024
  s_add_u32 s29, s28, 831488
  buffer_load_dwordx4 a[128:131], v178, s[8:11], s29 offen
  buffer_load_dwordx4 a[132:135], v178, s[8:11], s29 offen offset:1024
  s_add_u32 s29, s28, 833536
  buffer_load_dwordx4 a[136:139], v178, s[8:11], s29 offen
  buffer_load_dwordx4 a[140:143], v178, s[8:11], s29 offen offset:1024
  s_add_u32 s29, s28, 835584
  buffer_load_dwordx4 a[144:147], v178, s[8:11], s29 offen
  buffer_load_dwordx4 a[148:151], v178, s[8:11], s29 offen offset:1024
  s_add_u32 s29, s28, 837632
  buffer_load_dwordx4 a[152:155], v178, s[8:11], s29 offen
  buffer_load_dwordx4 a[156:159], v178, s[8:11], s29 offen offset:1024
  s_waitcnt vmcnt(30)
  s_add_u32 s29, s28, 1638400
  buffer_load_dwordx4 a[160:163], v178, s[8:11], s29 offen
  buffer_load_dwordx4 a[164:167], v178, s[8:11], s29 offen offset:1024
  s_add_u32 s29, s28, 1640448
  buffer_load_dwordx4 a[168:171], v178, s[8:11], s29 offen
  buffer_load_dwordx4 a[172:175], v178, s[8:11], s29 offen offset:1024
  s_add_u32 s29, s28, 1642496
  buffer_load_dwordx4 a[176:179], v178, s[8:11], s29 offen
  buffer_load_dwordx4 a[180:183], v178, s[8:11], s29 offen offset:1024
  s_add_u32 s29, s28, 1644544
  buffer_load_dwordx4 a[184:187], v178, s[8:11], s29 offen
  buffer_load_dwordx4 a[188:191], v178, s[8:11], s29 offen offset:1024
  s_add_u32 s29, s28, 1646592
  buffer_load_dwordx4 a[192:195], v178, s[8:11], s29 offen
  buffer_load_dwordx4 a[196:199], v178, s[8:11], s29 offen offset:1024
  s_add_u32 s29, s28, 1648640
  buffer_load_dwordx4 a[200:203], v178, s[8:11], s29 offen
  buffer_load_dwordx4 a[204:207], v178, s[8:11], s29 offen offset:1024
  s_add_u32 s29, s28, 1650688
  buffer_load_dwordx4 a[208:211], v178, s[8:11], s29 offen
  buffer_load_dwordx4 a[212:215], v178, s[8:11], s29 offen offset:1024
  s_add_u32 s29, s28, 1652736
  buffer_load_dwordx4 a[216:219], v178, s[8:11], s29 offen
  buffer_load_dwordx4 a[220:223], v178, s[8:11], s29 offen offset:1024
  s_add_u32 s29, s28, 1654784
  buffer_load_dwordx4 a[224:227], v178, s[8:11], s29 offen
  buffer_load_dwordx4 a[228:231], v178, s[8:11], s29 offen offset:1024
  s_add_u32 s29, s28, 1656832
  buffer_load_dwordx4 a[232:235], v178, s[8:11], s29 offen
  buffer_load_dwordx4 a[236:239], v178, s[8:11], s29 offen offset:1024
  s_waitcnt vmcnt(30)
  s_add_u32 s29, s28, 2457600
  buffer_load_dwordx4 a[240:243], v178, s[8:11], s29 offen
  buffer_load_dwordx4 a[244:247], v178, s[8:11], s29 offen offset:1024
  s_add_u32 s29, s28, 2459648
  buffer_load_dwordx4 a[248:251], v178, s[8:11], s29 offen
  buffer_load_dwordx4 a[252:255], v178, s[8:11], s29 offen offset:1024
  s_add_u32 s29, s28, 2461696
  buffer_load_dwordx4 v[192:195], v178, s[8:11], s29 offen
  buffer_load_dwordx4 v[196:199], v178, s[8:11], s29 offen offset:1024
  s_add_u32 s29, s28, 2463744
  buffer_load_dwordx4 v[200:203], v178, s[8:11], s29 offen
  buffer_load_dwordx4 v[204:207], v178, s[8:11], s29 offen offset:1024
  s_add_u32 s29, s28, 2465792
  buffer_load_dwordx4 v[208:211], v178, s[8:11], s29 offen
  buffer_load_dwordx4 v[212:215], v178, s[8:11], s29 offen offset:1024
  s_add_u32 s29, s28, 2467840
  buffer_load_dwordx4 v[216:219], v178, s[8:11], s29 offen
  buffer_load_dwordx4 v[220:223], v178, s[8:11], s29 offen offset:1024
  s_add_u32 s29, s28, 2469888
  buffer_load_dwordx4 v[224:227], v178, s[8:11], s29 offen
  buffer_load_dwordx4 v[228:231], v178, s[8:11], s29 offen offset:1024
  s_add_u32 s29, s28, 2471936
  buffer_load_dwordx4 v[232:235], v178, s[8:11], s29 offen
  buffer_load_dwordx4 v[236:239], v178, s[8:11], s29 offen offset:1024
  s_add_u32 s29, s28, 2473984
  buffer_load_dwordx4 v[240:243], v178, s[8:11], s29 offen
  buffer_load_dwordx4 v[244:247], v178, s[8:11], s29 offen offset:1024
  s_add_u32 s29, s28, 2476032
  buffer_load_dwordx4 v[248:251], v178, s[8:11], s29 offen
  buffer_load_dwordx4 v[252:255], v178, s[8:11], s29 offen offset:1024
  s_waitcnt vmcnt(30)
  v_mov_b32 v172, 0x44444444
  v_mov_b32 v2, 0xeeeeeeee
  v_and_b32 v3, 8, v1
  v_cmp_ne_u32 vcc, 0, v3
  s_nop 1
  v_cndmask_b32 v172, v172, v2, vcc
  s_lshl_b32 s28, s21, 10
  v_add_u32 v173, s28, v178
  v_add_u32 v174, 4096, v173
  v_add_u32 v175, 8192, v173
  v_add_u32 v176, 0, v173
  v_add_u32 v177, 0, v178
  v_add_u32 v179, 10240, v173
  s_xor_b32 s28, s21, 2
  s_lshl_b32 s28, s28, 10
  s_add_u32 s28, s28, 10240
  v_add_u32 v180, s28, v178
  v_and_b32 v4, 15, v1
  v_lshrrev_b32 v5, 4, v1
  v_and_b32 v6, 7, v1
  v_lshlrev_b32 v7, 3, v5
  v_add_u32 v7, v7, v6
  v_lshlrev_b32 v185, 4, v7
  v_add_u32 v182, 4096, v178
  v_mov_b32 v8, 0x40000000
  v_cmp_gt_u32 vcc, 8, v4
  s_nop 1
  v_cndmask_b32 v184, v8, v185, vcc
  v_lshlrev_b32 v7, 4, v4
  v_lshlrev_b32 v9, 2, v5
  v_add_u32 v7, v7, v9
  v_cndmask_b32 v186, v8, v7, vcc
  s_lshl_b32 s28, s20, 5
  s_add_u32 s28, s28, 3072
  v_lshlrev_b32 v7, 2, v6
  v_add_u32 v187, s28, v7
  v_and_b32 v7, 1, v5
  v_lshlrev_b32 v7, 10, v7
  v_lshrrev_b32 v9, 1, v5
  v_lshlrev_b32 v9, 5, v9
  v_add_u32 v9, v9, v4
  v_lshlrev_b32 v9, 4, v9
  v_add_u32 v189, v7, v9
  v_mov_b32 v44, 0
  v_mov_b32 v45, 0
  v_mov_b32 v46, 0
  v_mov_b32 v47, 0
  v_mov_b32 v48, 0
  v_mov_b32 v49, 0
  v_mov_b32 v50, 0
  v_mov_b32 v51, 0
  v_mov_b32 v52, 0
  v_mov_b32 v53, 0
  v_mov_b32 v54, 0
  v_mov_b32 v55, 0
  v_mov_b32 v56, 0
  v_mov_b32 v57, 0
  v_mov_b32 v58, 0
  v_mov_b32 v59, 0
  s_mul_i32 s97, s20, 655360
  s_add_u32 s97, s97, 0x400000
  s_mov_b32 s48, 0x4000
  s_mul_i32 s49, s20, 327680
  s_add_u32 s49, s49, 0x700000
  s_mul_i32 s50, s20, 327680
  s_lshl_b32 s28, s46, 10
  s_add_u32 s50, s50, s28
  s_add_u32 s50, s50, 0x9000000
  s_mov_b32 s51, 0
  s_mov_b32 s52, 0
  s_mov_b32 s53, 0
  v_mov_b32 v2, 5056
  s_mov_b32 s45, 0
ka\sfx\()_y_sel:
  buffer_load_dword v3, v2, s[8:11], 0 offen sc1
  s_add_u32 s45, s45, 1
  s_waitcnt vmcnt(0)
  v_readfirstlane_b32 s61, v3
  s_cmp_lg_u32 s61, 0
  s_cbranch_scc1 ka\sfx\()_y_selok
  s_cmp_lt_u32 s45, 20000
  s_cbranch_scc1 ka\sfx\()_y_sel
ka\sfx\()_y_selok:
  s_and_b32 s61, s61, 2
  s_lshl_b32 s61, s61, 12
  s_add_u32 s29, s20, 0
  s_and_b32 s29, s29, 3
  s_mul_i32 s29, s29, 20
  s_add_u32 s29, s29, s23
  s_lshr_b32 s28, s29, 3
  s_lshl_b32 s28, s28, 14
  s_and_b32 s29, s29, 7
  s_lshl_b32 s29, s29, 10
  s_add_u32 s28, s28, s29
  s_and_b32 s29, s21, 1
  s_lshl_b32 s29, s29, 9
  s_add_u32 s28, s28, s29
  s_add_u32 s28, s28, s61
  s_add_u32 s56, s28, 0xa00000
  s_mov_b32 s66, s56
  s_add_u32 s29, s20, 1
  s_and_b32 s29, s29, 3
  s_mul_i32 s29, s29, 20
  s_add_u32 s29, s29, s23
  s_lshr_b32 s28, s29, 3
  s_lshl_b32 s28, s28, 14
  s_and_b32 s29, s29, 7
  s_lshl_b32 s29, s29, 10
  s_add_u32 s28, s28, s29
  s_and_b32 s29, s21, 1
  s_lshl_b32 s29, s29, 9
  s_add_u32 s28, s28, s29
  s_add_u32 s28, s28, s61
  s_add_u32 s57, s28, 0xa00000
  s_mov_b32 s67, s57
  s_add_u32 s29, s20, 2
  s_and_b32 s29, s29, 3
  s_mul_i32 s29, s29, 20
  s_add_u32 s29, s29, s23
  s_lshr_b32 s28, s29, 3
  s_lshl_b32 s28, s28, 14
  s_and_b32 s29, s29, 7
  s_lshl_b32 s29, s29, 10
  s_add_u32 s28, s28, s29
  s_and_b32 s29, s21, 1
  s_lshl_b32 s29, s29, 9
  s_add_u32 s28, s28, s29
  s_add_u32 s28, s28, s61
  s_add_u32 s58, s28, 0xa00000
  s_mov_b32 s68, s58
  s_add_u32 s29, s20, 3
  s_and_b32 s29, s29, 3
  s_mul_i32 s29, s29, 20
  s_add_u32 s29, s29, s23
  s_lshr_b32 s28, s29, 3
  s_lshl_b32 s28, s28, 14
  s_and_b32 s29, s29, 7
  s_lshl_b32 s29, s29, 10
  s_add_u32 s28, s28, s29
  s_and_b32 s29, s21, 1
  s_lshl_b32 s29, s29, 9
  s_add_u32 s28, s28, s29
  s_add_u32 s28, s28, s61
  s_add_u32 s59, s28, 0xa00000
  s_mov_b32 s69, s59
  v_mov_b32 v124, -1
  v_mov_b32 v125, -1
  v_mov_b32 v126, -1
  v_mov_b32 v127, -1
  s_lshr_b32 s28, s46, 2
  s_lshl_b32 s28, s28, 10
  s_and_b32 s29, s46, 3
  s_lshl_b32 s29, s29, 8
  s_add_u32 s28, s28, s29
  s_add_u32 s60, s28, s97
  s_add_u32 s60, s60, 10240
  s_and_b32 s28, s21, 1
  s_lshl_b32 s28, s28, 10
  s_add_u32 s28, s28, 32768
  v_add_u32 v181, s28, v178
  v_add_u32 v183, 65536, v178
  s_waitcnt vmcnt(0)
  s_cmp_ge_u32 s21, 2
  s_cbranch_scc1 ka\sfx\()_y_tok
ka\sfx\()_y_crit:
  s_add_u32 s98, s48, 4096
  s_add_u32 s100, s48, 8192
  s_mov_b32 s45, 0
ka\sfx\()_y_pf_78:
  buffer_load_dwordx4 v[160:163], v173, s[8:11], s48 offen sc1
  buffer_load_dwordx4 v[164:167], v173, s[8:11], s48 offen offset:2048 sc1
  buffer_load_dwordx4 v[168:171], v173, s[8:11], s98 offen sc1
  buffer_load_dwordx4 v[68:71], v173, s[8:11], s98 offen offset:2048 sc1
  buffer_load_dwordx4 v[72:75], v173, s[8:11], s100 offen sc1
  s_add_u32 s45, s45, 1
  s_waitcnt vmcnt(4)
  ds_write_b128 v176, v[160:163] offset:0
  v_max3_u32 v190, v160, v161, v162
  v_max_u32 v190, v190, v163
  s_waitcnt vmcnt(3)
  ds_write_b128 v176, v[164:167] offset:2048
  v_max3_u32 v190, v190, v164, v165
  v_max3_u32 v190, v190, v166, v167
  s_waitcnt vmcnt(2)
  ds_write_b128 v176, v[168:171] offset:4096
  v_max3_u32 v190, v190, v168, v169
  v_max3_u32 v190, v190, v170, v171
  s_waitcnt vmcnt(1)
  ds_write_b128 v176, v[68:71] offset:6144
  v_max3_u32 v190, v190, v68, v69
  v_max3_u32 v190, v190, v70, v71
  s_waitcnt vmcnt(0)
  ds_write_b128 v176, v[72:75] offset:8192
  v_max3_u32 v190, v190, v72, v73
  v_max3_u32 v190, v190, v74, v75
  v_cmp_eq_u32 vcc, -1, v190
  s_cbranch_vccz ka\sfx\()_y_pf_78_ok
  s_cmp_lt_u32 s45, 400000
  s_cbranch_scc1 ka\sfx\()_y_pf_78
  s_branch ka\sfx\()_abort
ka\sfx\()_y_pf_78_ok:
  s_waitcnt lgkmcnt(0)
  s_barrier
  ds_read_b128 v[4:7], v177 offset:0
  ds_read_b128 v[8:11], v177 offset:1024
  ds_read_b128 v[12:15], v177 offset:2048
  ds_read_b128 v[16:19], v177 offset:3072
  ds_read_b128 v[20:23], v177 offset:4096
  ds_read_b128 v[24:27], v177 offset:5120
  ds_read_b128 v[28:31], v177 offset:6144
  ds_read_b128 v[32:35], v177 offset:7168
  ds_read_b128 v[36:39], v177 offset:8192
  ds_read_b128 v[40:43], v177 offset:9216
  s_cmp_lt_u32 s51, 2
  s_cbranch_scc1 ka\sfx\()_y_norst
  s_sub_u32 s28, s51, 2
  s_and_b32 s28, s28, 3
  s_mul_i32 s28, s28, 163840
  s_add_u32 s28, s28, s56
  v_mov_b32 v160, -1
  v_mov_b32 v161, -1
  v_mov_b32 v162, -1
  v_mov_b32 v163, -1
  buffer_store_dwordx4 v[160:163], v184, s[8:11], s28 offen sc1
ka\sfx\()_y_norst:
  s_waitcnt lgkmcnt(9)
  v_smfmac_f32_16x16x64_bf16 v[44:47], v[4:7], a[0:7], v172
  v_smfmac_f32_16x16x64_bf16 v[48:51], v[4:7], a[80:87], v172
  v_smfmac_f32_16x16x64_bf16 v[52:55], v[4:7], a[160:167], v172
  v_smfmac_f32_16x16x64_bf16 v[56:59], v[4:7], a[240:247], v172
  s_waitcnt lgkmcnt(8)
  v_smfmac_f32_16x16x64_bf16 v[44:47], v[8:11], a[8:15], v172
  v_smfmac_f32_16x16x64_bf16 v[48:51], v[8:11], a[88:95], v172
  v_smfmac_f32_16x16x64_bf16 v[52:55], v[8:11], a[168:175], v172
  v_smfmac_f32_16x16x64_bf16 v[56:59], v[8:11], a[248:255], v172
  s_waitcnt lgkmcnt(7)
  v_smfmac_f32_16x16x64_bf16 v[44:47], v[12:15], a[16:23], v172
  v_smfmac_f32_16x16x64_bf16 v[48:51], v[12:15], a[96:103], v172
  v_smfmac_f32_16x16x64_bf16 v[52:55], v[12:15], a[176:183], v172
  v_smfmac_f32_16x16x64_bf16 v[56:59], v[12:15], v[192:199], v172
  s_waitcnt lgkmcnt(6)
  v_smfmac_f32_16x16x64_bf16 v[44:47], v[16:19], a[24:31], v172
  v_smfmac_f32_16x16x64_bf16 v[48:51], v[16:19], a[104:111], v172
  v_smfmac_f32_16x16x64_bf16 v[52:55], v[16:19], a[184:191], v172
  v_smfmac_f32_16x16x64_bf16 v[56:59], v[16:19], v[200:207], v172
  s_waitcnt lgkmcnt(5)
  v_smfmac_f32_16x16x64_bf16 v[44:47], v[20:23], a[32:39], v172
  v_smfmac_f32_16x16x64_bf16 v[48:51], v[20:23], a[112:119], v172
  v_smfmac_f32_16x16x64_bf16 v[52:55], v[20:23], a[192:199], v172
  v_smfmac_f32_16x16x64_bf16 v[56:59], v[20:23], v[208:215], v172
  s_waitcnt lgkmcnt(4)
  v_smfmac_f32_16x16x64_bf16 v[44:47], v[24:27], a[40:47], v172
  v_smfmac_f32_16x16x64_bf16 v[48:51], v[24:27], a[120:127], v172
  v_smfmac_f32_16x16x64_bf16 v[52:55], v[24:27], a[200:207], v172
  v_smfmac_f32_16x16x64_bf16 v[56:59], v[24:27], v[216:223], v172
  s_waitcnt lgkmcnt(3)
  v_smfmac_f32_16x16x64_bf16 v[44:47], v[28:31], a[48:55], v172
  v_smfmac_f32_16x16x64_bf16 v[48:51], v[28:31], a[128:135], v172
  v_smfmac_f32_16x16x64_bf16 v[52:55], v[28:31], a[208:215], v172
  v_smfmac_f32_16x16x64_bf16 v[56:59], v[28:31], v[224:231], v172
  s_waitcnt lgkmcnt(2)
  v_smfmac_f32_16x16x64_bf16 v[44:47], v[32:35], a[56:63], v172
  v_smfmac_f32_16x16x64_bf16 v[48:51], v[32:35], a[136:143], v172
  v_smfmac_f32_16x16x64_bf16 v[52:55], v[32:35], a[216:223], v172
  v_smfmac_f32_16x16x64_bf16 v[56:59], v[32:35], v[232:239], v172
  s_waitcnt lgkmcnt(1)
  v_smfmac_f32_16x16x64_bf16 v[44:47], v[36:39], a[64:71], v172
  v_smfmac_f32_16x16x64_bf16 v[48:51], v[36:39], a[144:151], v172
  v_smfmac_f32_16x16x64_bf16 v[52:55], v[36:39], a[224:231], v172
  v_smfmac_f32_16x16x64_bf16 v[56:59], v[36:39], v[240:247], v172
  s_waitcnt lgkmcnt(0)
  v_smfmac_f32_16x16x64_bf16 v[44:47], v[40:43], a[72:79], v172
  v_smfmac_f32_16x16x64_bf16 v[48:51], v[40:43], a[152:159], v172
  v_smfmac_f32_16x16x64_bf16 v[52:55], v[40:43], a[232:239], v172
  v_smfmac_f32_16x16x64_bf16 v[56:59], v[40:43], v[248:255], v172
  s_nop 9
  v_permlane32_swap_b32 v44, v48
  v_permlane32_swap_b32 v45, v49
  v_permlane32_swap_b32 v46, v50
  v_permlane32_swap_b32 v47, v51
  v_permlane32_swap_b32 v52, v56
  v_permlane32_swap_b32 v53, v57
  v_permlane32_swap_b32 v54, v58
  v_permlane32_swap_b32 v55, v59
  v_add_f32 v44, v44, v48
  v_add_f32 v45, v45, v49
  v_add_f32 v46, v46, v50
  v_add_f32 v47, v47, v51
  v_add_f32 v52, v52, v56
  v_add_f32 v53, v53, v57
  v_add_f32 v54, v54, v58
  v_add_f32 v55, v55, v59
  v_cvt_pk_bf16_f32 v60, v44, v45
  v_cvt_pk_bf16_f32 v61, v46, v47
  v_cvt_pk_bf16_f32 v62, v52, v53
  v_cvt_pk_bf16_f32 v63, v54, v55
  ds_write_b128 v179, v[60:63]
  v_mov_b32 v44, 0
  v_mov_b32 v45, 0
  v_mov_b32 v46, 0
  v_mov_b32 v47, 0
  v_mov_b32 v48, 0
  v_mov_b32 v49, 0
  v_mov_b32 v50, 0
  v_mov_b32 v51, 0
  v_mov_b32 v52, 0
  v_mov_b32 v53, 0
  v_mov_b32 v54, 0
  v_mov_b32 v55, 0
  v_mov_b32 v56, 0
  v_mov_b32 v57, 0
  v_mov_b32 v58, 0
  v_mov_b32 v59, 0
  s_waitcnt lgkmcnt(0)
  s_barrier
  s_cmp_ge_u32 s51, 63
  s_cbranch_scc1 ka\sfx\()_y_crit_end
  ds_read_b128 v[64:67], v180
  ds_read_b128 v[68:71], v181 offset:0
  ds_read_b128 v[72:75], v181 offset:2048
  ds_read_b128 v[76:79], v181 offset:4096
  ds_read_b128 v[80:83], v181 offset:6144
  ds_read_b128 v[84:87], v181 offset:8192
  ds_read_b128 v[88:91], v181 offset:10240
  ds_read_b128 v[92:95], v181 offset:12288
  ds_read_b128 v[96:99], v181 offset:14336
  v_xor_b32 v181, 0x4000, v181
  s_mov_b32 s45, 0
  buffer_load_dwordx4 v[100:103], v178, s[8:11], s49 offen offset:0 sc1
  buffer_load_dwordx4 v[104:107], v178, s[8:11], s49 offen offset:1024 sc1
  buffer_load_dwordx4 v[108:111], v178, s[8:11], s49 offen offset:2048 sc1
  buffer_load_dwordx4 v[112:115], v178, s[8:11], s49 offen offset:3072 sc1
  buffer_load_dwordx4 v[116:119], v182, s[8:11], s49 offen sc1
yp_79_\sfx\():
  buffer_load_dwordx4 v[120:123], v178, s[8:11], s49 offen offset:0 sc1
  buffer_load_dwordx4 v[124:127], v178, s[8:11], s49 offen offset:1024 sc1
  buffer_load_dwordx4 v[128:131], v178, s[8:11], s49 offen offset:2048 sc1
  buffer_load_dwordx4 v[132:135], v178, s[8:11], s49 offen offset:3072 sc1
  buffer_load_dwordx4 v[136:139], v182, s[8:11], s49 offen sc1
  s_waitcnt vmcnt(9) lgkmcnt(0)
  v_mfma_f32_16x16x32_bf16 v[140:143], v[68:71], v[100:103], 0
  v_max_u32 v190, v100, v102
  v_mfma_f32_16x16x32_bf16 v[144:147], v[72:75], v[100:103], 0
  s_waitcnt vmcnt(8)
  v_mfma_f32_16x16x32_bf16 v[140:143], v[76:79], v[104:107], v[140:143]
  v_max3_u32 v190, v190, v104, v106
  v_mfma_f32_16x16x32_bf16 v[144:147], v[80:83], v[104:107], v[144:147]
  s_waitcnt vmcnt(7)
  v_mfma_f32_16x16x32_bf16 v[140:143], v[84:87], v[108:111], v[140:143]
  v_max3_u32 v190, v190, v108, v110
  v_mfma_f32_16x16x32_bf16 v[144:147], v[88:91], v[108:111], v[144:147]
  s_waitcnt vmcnt(6)
  v_mfma_f32_16x16x32_bf16 v[140:143], v[92:95], v[112:115], v[140:143]
  v_max3_u32 v190, v190, v112, v114
  v_mfma_f32_16x16x32_bf16 v[144:147], v[96:99], v[112:115], v[144:147]
  s_waitcnt vmcnt(5)
  v_mfma_f32_16x16x32_bf16 v[140:143], v[60:63], v[116:119], v[140:143]
  v_max3_u32 v190, v190, v116, v117
  v_mfma_f32_16x16x32_bf16 v[144:147], v[64:67], v[116:119], v[144:147]
  v_max3_u32 v190, v190, v118, v119
  v_cmp_eq_u32 vcc, -1, v190
  s_cbranch_vccz yp_79_okA_\sfx\()
  buffer_load_dwordx4 v[100:103], v178, s[8:11], s49 offen offset:0 sc1
  buffer_load_dwordx4 v[104:107], v178, s[8:11], s49 offen offset:1024 sc1
  buffer_load_dwordx4 v[108:111], v178, s[8:11], s49 offen offset:2048 sc1
  buffer_load_dwordx4 v[112:115], v178, s[8:11], s49 offen offset:3072 sc1
  buffer_load_dwordx4 v[116:119], v182, s[8:11], s49 offen sc1
  s_waitcnt vmcnt(9) lgkmcnt(0)
  v_mfma_f32_16x16x32_bf16 v[148:151], v[68:71], v[120:123], 0
  v_max_u32 v190, v120, v122
  v_mfma_f32_16x16x32_bf16 v[152:155], v[72:75], v[120:123], 0
  s_waitcnt vmcnt(8)
  v_mfma_f32_16x16x32_bf16 v[148:151], v[76:79], v[124:127], v[148:151]
  v_max3_u32 v190, v190, v124, v126
  v_mfma_f32_16x16x32_bf16 v[152:155], v[80:83], v[124:127], v[152:155]
  s_waitcnt vmcnt(7)
  v_mfma_f32_16x16x32_bf16 v[148:151], v[84:87], v[128:131], v[148:151]
  v_max3_u32 v190, v190, v128, v130
  v_mfma_f32_16x16x32_bf16 v[152:155], v[88:91], v[128:131], v[152:155]
  s_waitcnt vmcnt(6)
  v_mfma_f32_16x16x32_bf16 v[148:151], v[92:95], v[132:135], v[148:151]
  v_max3_u32 v190, v190, v132, v134
  v_mfma_f32_16x16x32_bf16 v[152:155], v[96:99], v[132:135], v[152:155]
  s_waitcnt vmcnt(5)
  v_mfma_f32_16x16x32_bf16 v[148:151], v[60:63], v[136:139], v[148:151]
  v_max3_u32 v190, v190, v136, v137
  v_mfma_f32_16x16x32_bf16 v[152:155], v[64:67], v[136:139], v[152:155]
  v_max3_u32 v190, v190, v138, v139
  v_cmp_eq_u32 vcc, -1, v190
  s_cbranch_vccz yp_79_okB_\sfx\()
  s_add_u32 s45, s45, 1
  s_cmp_lt_u32 s45, 400000
  s_cbranch_scc1 yp_79_c_\sfx\()
  s_branch ka\sfx\()_abort
yp_79_c_\sfx\():
  s_branch yp_79_\sfx\()
yp_79_okB_\sfx\():
  s_nop 4
  v_add_f32_dpp v140, v152, v148 row_ror:8 row_mask:0xf bank_mask:0xf
  v_add_f32_dpp v141, v153, v149 row_ror:8 row_mask:0xf bank_mask:0xf
  v_add_f32_dpp v142, v154, v150 row_ror:8 row_mask:0xf bank_mask:0xf
  v_add_f32_dpp v143, v155, v151 row_ror:8 row_mask:0xf bank_mask:0xf
  s_branch yp_79_j_\sfx\()
yp_79_okA_\sfx\():
  s_nop 4
  v_add_f32_dpp v140, v144, v140 row_ror:8 row_mask:0xf bank_mask:0xf
  v_add_f32_dpp v141, v145, v141 row_ror:8 row_mask:0xf bank_mask:0xf
  v_add_f32_dpp v142, v146, v142 row_ror:8 row_mask:0xf bank_mask:0xf
  v_add_f32_dpp v143, v147, v143 row_ror:8 row_mask:0xf bank_mask:0xf
yp_79_j_\sfx\():
  buffer_load_dwordx4 v[4:7], v185, s[8:11], s67 offen sc1
  buffer_load_dwordx4 v[8:11], v185, s[8:11], s68 offen sc1
  buffer_load_dwordx4 v[12:15], v185, s[8:11], s69 offen sc1
  buffer_store_dwordx4 v[140:143], v184, s[8:11], s66 offen sc1
  s_mov_b32 s45, 0
  buffer_load_dwordx4 v[148:151], v185, s[8:11], s67 offen sc1
  buffer_load_dwordx4 v[152:155], v185, s[8:11], s68 offen sc1
  buffer_load_dwordx4 v[156:159], v185, s[8:11], s69 offen sc1
  s_waitcnt vmcnt(4)
  v_max3_u32 v190, v4, v7, v8
  v_max3_u32 v190, v190, v11, v12
  v_max_u32 v190, v190, v15
  v_add_f32 v160, v140, v4
  v_add_f32 v161, v141, v5
  v_add_f32 v162, v142, v6
  v_add_f32 v163, v143, v7
  v_cmp_eq_u32 vcc, -1, v190
  v_add_f32 v164, v8, v12
  v_add_f32 v165, v9, v13
  v_add_f32 v166, v10, v14
  v_add_f32 v167, v11, v15
  s_cbranch_vccz yc_80_ok_\sfx\()
yc_80_\sfx\():
  buffer_load_dwordx4 v[4:7], v185, s[8:11], s67 offen sc1
  buffer_load_dwordx4 v[8:11], v185, s[8:11], s68 offen sc1
  buffer_load_dwordx4 v[12:15], v185, s[8:11], s69 offen sc1
  s_waitcnt vmcnt(3)
  v_max3_u32 v190, v148, v151, v152
  v_max3_u32 v190, v190, v155, v156
  v_max_u32 v190, v190, v159
  v_add_f32 v160, v140, v148
  v_add_f32 v161, v141, v149
  v_add_f32 v162, v142, v150
  v_add_f32 v163, v143, v151
  v_cmp_eq_u32 vcc, -1, v190
  v_add_f32 v164, v152, v156
  v_add_f32 v165, v153, v157
  v_add_f32 v166, v154, v158
  v_add_f32 v167, v155, v159
  s_cbranch_vccz yc_80_ok_\sfx\()
  buffer_load_dwordx4 v[148:151], v185, s[8:11], s67 offen sc1
  buffer_load_dwordx4 v[152:155], v185, s[8:11], s68 offen sc1
  buffer_load_dwordx4 v[156:159], v185, s[8:11], s69 offen sc1
  s_waitcnt vmcnt(3)
  v_max3_u32 v190, v4, v7, v8
  v_max3_u32 v190, v190, v11, v12
  v_max_u32 v190, v190, v15
  v_add_f32 v160, v140, v4
  v_add_f32 v161, v141, v5
  v_add_f32 v162, v142, v6
  v_add_f32 v163, v143, v7
  v_cmp_eq_u32 vcc, -1, v190
  v_add_f32 v164, v8, v12
  v_add_f32 v165, v9, v13
  v_add_f32 v166, v10, v14
  v_add_f32 v167, v11, v15
  s_cbranch_vccz yc_80_ok_\sfx\()
  s_add_u32 s45, s45, 1
  s_cmp_lt_u32 s45, 400000
  s_cbranch_scc1 yc_80_\sfx\()
  s_branch ka\sfx\()_abort
yc_80_ok_\sfx\():
  v_add_f32 v160, v160, v164
  v_add_f32 v161, v161, v165
  v_add_f32 v162, v162, v166
  v_add_f32 v163, v163, v167
  v_cvt_pk_bf16_f32 v168, v160, v161
  v_cvt_pk_bf16_f32 v169, v162, v163
  buffer_store_dword v168, v186, s[8:11], s60 offen \pol
  buffer_store_dword v169, v186, s[8:11], s60 offen offset:128 \pol
  s_add_u32 s97, s97, 10240
  s_mov_b32 s48, s97
  s_add_u32 s60, s60, 10240
  s_add_u32 s49, s49, 5120
  s_add_u32 s28, s51, 1
  s_and_b32 s28, s28, 3
  s_mul_i32 s28, s28, 163840
  s_add_u32 s66, s56, s28
  s_add_u32 s67, s57, s28
  s_add_u32 s68, s58, s28
  s_add_u32 s69, s59, s28
  s_add_u32 s51, s51, 1
  s_branch ka\sfx\()_y_crit
ka\sfx\()_y_crit_end:
  s_waitcnt vmcnt(0) lgkmcnt(0)
  s_branch ka\sfx\()_exit
ka\sfx\()_y_tok:
  s_mul_i32 s61, s20, 1310720
  s_add_u32 s61, s61, 0xe00000
  s_mul_i32 s62, s20, 5242880
  s_lshl_b32 s28, s46, 11
  s_add_u32 s62, s62, s28
  s_add_u32 s62, s62, 0x1a00000
  s_mov_b32 s54, 0
  s_and_b32 s63, s21, 1
  s_lshl_b32 s63, s63, 10
  s_add_u32 s63, s63, 32768
  s_and_b32 s64, s21, 1
  s_mul_i32 s64, s64, 10240
ka\sfx\()_y_tokl:
  s_barrier
  ds_read_b128 v[4:7], v177 offset:0
  ds_read_b128 v[8:11], v177 offset:1024
  ds_read_b128 v[12:15], v177 offset:2048
  ds_read_b128 v[16:19], v177 offset:3072
  ds_read_b128 v[20:23], v177 offset:4096
  ds_read_b128 v[24:27], v177 offset:5120
  ds_read_b128 v[28:31], v177 offset:6144
  ds_read_b128 v[32:35], v177 offset:7168
  ds_read_b128 v[36:39], v177 offset:8192
  ds_read_b128 v[40:43], v177 offset:9216
  s_cmp_gt_u32 s52, s51
  s_cbranch_scc1 ka\sfx\()_y_wp_81_ok
  s_mov_b32 s45, 0
ka\sfx\()_y_wp_81_spin:
  buffer_load_dword v2, v187, s[8:11], 0 offen sc1
  s_add_u32 s45, s45, 1
  s_waitcnt vmcnt(0)
  v_min_u32_dpp v3, v2, v2 quad_perm:[1,0,3,2] row_mask:0xf bank_mask:0xf
  s_nop 1
  v_min_u32_dpp v2, v3, v3 quad_perm:[2,3,0,1] row_mask:0xf bank_mask:0xf
  s_nop 1
  v_min_u32_dpp v3, v2, v2 row_half_mirror row_mask:0xf bank_mask:0xf
  s_nop 1
  v_min_u32_dpp v2, v3, v3 quad_perm:[0,1,2,3] row_mask:0xf bank_mask:0xf
  s_nop 0
  v_readfirstlane_b32 s52, v2
  s_cmp_gt_u32 s52, s51
  s_cbranch_scc1 ka\sfx\()_y_wp_81_ok
  s_cmp_lt_u32 s45, 400000
  s_cbranch_scc1 ka\sfx\()_y_wp_81_spin
  s_branch ka\sfx\()_abort
ka\sfx\()_y_wp_81_ok:
  s_add_u32 s65, s61, s64
  s_waitcnt lgkmcnt(9)
  v_smfmac_f32_16x16x64_bf16 v[44:47], v[4:7], a[0:7], v172
  s_add_u32 m0, s63, 0
  s_add_u32 s28, s50, 0
  buffer_load_dwordx4 v178, s[8:11], s28 offen sc1 lds
  v_smfmac_f32_16x16x64_bf16 v[48:51], v[4:7], a[80:87], v172
  v_smfmac_f32_16x16x64_bf16 v[52:55], v[4:7], a[160:167], v172
  s_add_u32 m0, s63, 2048
  s_add_u32 s28, s50, 40960
  buffer_load_dwordx4 v178, s[8:11], s28 offen sc1 lds
  v_smfmac_f32_16x16x64_bf16 v[56:59], v[4:7], a[240:247], v172
  s_waitcnt lgkmcnt(8)
  v_smfmac_f32_16x16x64_bf16 v[44:47], v[8:11], a[8:15], v172
  s_add_u32 m0, s63, 4096
  s_add_u32 s28, s50, 81920
  buffer_load_dwordx4 v178, s[8:11], s28 offen sc1 lds
  v_smfmac_f32_16x16x64_bf16 v[48:51], v[8:11], a[88:95], v172
  v_smfmac_f32_16x16x64_bf16 v[52:55], v[8:11], a[168:175], v172
  s_add_u32 m0, s63, 6144
  s_add_u32 s28, s50, 122880
  buffer_load_dwordx4 v178, s[8:11], s28 offen sc1 lds
  v_smfmac_f32_16x16x64_bf16 v[56:59], v[8:11], a[248:255], v172
  s_waitcnt lgkmcnt(7)
  v_smfmac_f32_16x16x64_bf16 v[44:47], v[12:15], a[16:23], v172
  s_add_u32 m0, s63, 8192
  s_add_u32 s28, s50, 163840
  buffer_load_dwordx4 v178, s[8:11], s28 offen sc1 lds
  v_smfmac_f32_16x16x64_bf16 v[48:51], v[12:15], a[96:103], v172
  v_smfmac_f32_16x16x64_bf16 v[52:55], v[12:15], a[176:183], v172
  s_add_u32 m0, s63, 10240
  s_add_u32 s28, s50, 204800
  buffer_load_dwordx4 v178, s[8:11], s28 offen sc1 lds
  v_smfmac_f32_16x16x64_bf16 v[56:59], v[12:15], v[192:199], v172
  s_waitcnt lgkmcnt(6)
  v_smfmac_f32_16x16x64_bf16 v[44:47], v[16:19], a[24:31], v172
  s_add_u32 m0, s63, 12288
  s_add_u32 s28, s50, 245760
  buffer_load_dwordx4 v178, s[8:11], s28 offen sc1 lds
  v_smfmac_f32_16x16x64_bf16 v[48:51], v[16:19], a[104:111], v172
  v_smfmac_f32_16x16x64_bf16 v[52:55], v[16:19], a[184:191], v172
  s_add_u32 m0, s63, 14336
  s_add_u32 s28, s50, 286720
  buffer_load_dwordx4 v178, s[8:11], s28 offen sc1 lds
  v_smfmac_f32_16x16x64_bf16 v[56:59], v[16:19], v[200:207], v172
  s_waitcnt lgkmcnt(5)
  v_smfmac_f32_16x16x64_bf16 v[44:47], v[20:23], a[32:39], v172
  s_add_u32 m0, s64, 65536
  s_add_u32 s28, s65, 0
  buffer_load_dwordx4 v178, s[8:11], s28 offen sc1 lds
  v_smfmac_f32_16x16x64_bf16 v[48:51], v[20:23], a[112:119], v172
  v_smfmac_f32_16x16x64_bf16 v[52:55], v[20:23], a[192:199], v172
  s_add_u32 m0, s64, 66560
  s_add_u32 s28, s65, 1024
  buffer_load_dwordx4 v178, s[8:11], s28 offen sc1 lds
  v_smfmac_f32_16x16x64_bf16 v[56:59], v[20:23], v[208:215], v172
  s_waitcnt lgkmcnt(4)
  v_smfmac_f32_16x16x64_bf16 v[44:47], v[24:27], a[40:47], v172
  s_add_u32 m0, s64, 67584
  s_add_u32 s28, s65, 2048
  buffer_load_dwordx4 v178, s[8:11], s28 offen sc1 lds
  v_smfmac_f32_16x16x64_bf16 v[48:51], v[24:27], a[120:127], v172
  v_smfmac_f32_16x16x64_bf16 v[52:55], v[24:27], a[200:207], v172
  s_add_u32 m0, s64, 68608
  s_add_u32 s28, s65, 3072
  buffer_load_dwordx4 v178, s[8:11], s28 offen sc1 lds
  v_smfmac_f32_16x16x64_bf16 v[56:59], v[24:27], v[216:223], v172
  s_waitcnt lgkmcnt(3)
  v_smfmac_f32_16x16x64_bf16 v[44:47], v[28:31], a[48:55], v172
  s_add_u32 m0, s64, 69632
  s_add_u32 s28, s65, 4096
  buffer_load_dwordx4 v178, s[8:11], s28 offen sc1 lds
  v_smfmac_f32_16x16x64_bf16 v[48:51], v[28:31], a[128:135], v172
  v_smfmac_f32_16x16x64_bf16 v[52:55], v[28:31], a[208:215], v172
  s_add_u32 m0, s64, 70656
  s_add_u32 s28, s65, 5120
  buffer_load_dwordx4 v178, s[8:11], s28 offen sc1 lds
  v_smfmac_f32_16x16x64_bf16 v[56:59], v[28:31], v[224:231], v172
  s_waitcnt lgkmcnt(2)
  v_smfmac_f32_16x16x64_bf16 v[44:47], v[32:35], a[56:63], v172
  s_add_u32 m0, s64, 71680
  s_add_u32 s28, s65, 6144
  buffer_load_dwordx4 v178, s[8:11], s28 offen sc1 lds
  v_smfmac_f32_16x16x64_bf16 v[48:51], v[32:35], a[136:143], v172
  v_smfmac_f32_16x16x64_bf16 v[52:55], v[32:35], a[216:223], v172
  s_add_u32 m0, s64, 72704
  s_add_u32 s28, s65, 7168
  buffer_load_dwordx4 v178, s[8:11], s28 offen sc1 lds
  v_smfmac_f32_16x16x64_bf16 v[56:59], v[32:35], v[232:239], v172
  s_waitcnt lgkmcnt(1)
  v_smfmac_f32_16x16x64_bf16 v[44:47], v[36:39], a[64:71], v172
  s_add_u32 m0, s64, 73728
  s_add_u32 s28, s65, 8192
  buffer_load_dwordx4 v178, s[8:11], s28 offen sc1 lds
  v_smfmac_f32_16x16x64_bf16 v[48:51], v[36:39], a[144:151], v172
  v_smfmac_f32_16x16x64_bf16 v[52:55], v[36:39], a[224:231], v172
  s_add_u32 m0, s64, 74752
  s_add_u32 s28, s65, 9216
  buffer_load_dwordx4 v178, s[8:11], s28 offen sc1 lds
  v_smfmac_f32_16x16x64_bf16 v[56:59], v[36:39], v[240:247], v172
  s_waitcnt lgkmcnt(0)
  v_smfmac_f32_16x16x64_bf16 v[44:47], v[40:43], a[72:79], v172
  v_smfmac_f32_16x16x64_bf16 v[48:51], v[40:43], a[152:159], v172
  v_smfmac_f32_16x16x64_bf16 v[52:55], v[40:43], a[232:239], v172
  v_smfmac_f32_16x16x64_bf16 v[56:59], v[40:43], v[248:255], v172
  s_xor_b32 s63, s63, 0x4000
  s_add_u32 s50, s50, 1310720
  s_nop 9
  v_permlane32_swap_b32 v44, v48
  v_permlane32_swap_b32 v45, v49
  v_permlane32_swap_b32 v46, v50
  v_permlane32_swap_b32 v47, v51
  v_permlane32_swap_b32 v52, v56
  v_permlane32_swap_b32 v53, v57
  v_permlane32_swap_b32 v54, v58
  v_permlane32_swap_b32 v55, v59
  v_add_f32 v44, v44, v48
  v_add_f32 v45, v45, v49
  v_add_f32 v46, v46, v50
  v_add_f32 v47, v47, v51
  v_add_f32 v52, v52, v56
  v_add_f32 v53, v53, v57
  v_add_f32 v54, v54, v58
  v_add_f32 v55, v55, v59
  v_cvt_pk_bf16_f32 v64, v44, v45
  v_cvt_pk_bf16_f32 v65, v46, v47
  v_cvt_pk_bf16_f32 v66, v52, v53
  v_cvt_pk_bf16_f32 v67, v54, v55
  ds_write_b128 v179, v[64:67]
  v_mov_b32 v44, 0
  v_mov_b32 v45, 0
  v_mov_b32 v46, 0
  v_mov_b32 v47, 0
  v_mov_b32 v48, 0
  v_mov_b32 v49, 0
  v_mov_b32 v50, 0
  v_mov_b32 v51, 0
  v_mov_b32 v52, 0
  v_mov_b32 v53, 0
  v_mov_b32 v54, 0
  v_mov_b32 v55, 0
  v_mov_b32 v56, 0
  v_mov_b32 v57, 0
  v_mov_b32 v58, 0
  v_mov_b32 v59, 0
  s_waitcnt vmcnt(0) lgkmcnt(0)
  s_barrier
  ds_read_b128 v[60:63], v180
  s_cmp_eq_u32 s51, 0
  s_cbranch_scc1 yt_82_\sfx\()
  ds_read_b128 v[68:71], v181 offset:0
  ds_read_b128 v[72:75], v181 offset:2048
  ds_read_b128 v[76:79], v181 offset:4096
  ds_read_b128 v[80:83], v181 offset:6144
  ds_read_b128 v[84:87], v181 offset:8192
  ds_read_b128 v[88:91], v181 offset:10240
  ds_read_b128 v[92:95], v181 offset:12288
  ds_read_b128 v[96:99], v181 offset:14336
  s_mov_b32 s45, 0
ytp_83_\sfx\():
  s_waitcnt lgkmcnt(0)
  ds_read_b128 v[100:103], v183 offset:0
  ds_read_b128 v[104:107], v183 offset:2048
  ds_read_b128 v[108:111], v183 offset:4096
  ds_read_b128 v[112:115], v183 offset:6144
  ds_read_b128 v[116:119], v183 offset:8192
  ds_read_b128 v[120:123], v183 offset:10240
  ds_read_b128 v[124:127], v183 offset:12288
  ds_read_b128 v[128:131], v183 offset:14336
  ds_read_b128 v[132:135], v183 offset:16384
  ds_read_b128 v[136:139], v183 offset:18432
  s_waitcnt lgkmcnt(0)
  v_max_u32 v190, v100, v102
  v_max3_u32 v190, v190, v104, v106
  v_max3_u32 v190, v190, v108, v110
  v_max3_u32 v190, v190, v112, v114
  v_max3_u32 v190, v190, v116, v118
  v_max3_u32 v190, v190, v120, v122
  v_max3_u32 v190, v190, v124, v126
  v_max3_u32 v190, v190, v128, v130
  v_max3_u32 v190, v190, v132, v134
  v_max3_u32 v190, v190, v136, v138
  v_cmp_eq_u32 vcc, -1, v190
  s_cbranch_vccz ytp_83_ok_\sfx\()
  s_add_u32 s45, s45, 1
  s_cmp_lt_u32 s45, 400000
  s_cbranch_scc0 ka\sfx\()_abort
ytp_83_dma_\sfx\():
  s_mov_b32 m0, 65536
  s_add_u32 s28, s61, 0
  buffer_load_dwordx4 v178, s[8:11], s28 offen sc1 lds
  s_mov_b32 m0, 66560
  s_add_u32 s28, s61, 1024
  buffer_load_dwordx4 v178, s[8:11], s28 offen sc1 lds
  s_mov_b32 m0, 67584
  s_add_u32 s28, s61, 2048
  buffer_load_dwordx4 v178, s[8:11], s28 offen sc1 lds
  s_mov_b32 m0, 68608
  s_add_u32 s28, s61, 3072
  buffer_load_dwordx4 v178, s[8:11], s28 offen sc1 lds
  s_mov_b32 m0, 69632
  s_add_u32 s28, s61, 4096
  buffer_load_dwordx4 v178, s[8:11], s28 offen sc1 lds
  s_mov_b32 m0, 70656
  s_add_u32 s28, s61, 5120
  buffer_load_dwordx4 v178, s[8:11], s28 offen sc1 lds
  s_mov_b32 m0, 71680
  s_add_u32 s28, s61, 6144
  buffer_load_dwordx4 v178, s[8:11], s28 offen sc1 lds
  s_mov_b32 m0, 72704
  s_add_u32 s28, s61, 7168
  buffer_load_dwordx4 v178, s[8:11], s28 offen sc1 lds
  s_mov_b32 m0, 73728
  s_add_u32 s28, s61, 8192
  buffer_load_dwordx4 v178, s[8:11], s28 offen sc1 lds
  s_mov_b32 m0, 74752
  s_add_u32 s28, s61, 9216
  buffer_load_dwordx4 v178, s[8:11], s28 offen sc1 lds
  s_mov_b32 m0, 75776
  s_add_u32 s28, s61, 10240
  buffer_load_dwordx4 v178, s[8:11], s28 offen sc1 lds
  s_mov_b32 m0, 76800
  s_add_u32 s28, s61, 11264
  buffer_load_dwordx4 v178, s[8:11], s28 offen sc1 lds
  s_mov_b32 m0, 77824
  s_add_u32 s28, s61, 12288
  buffer_load_dwordx4 v178, s[8:11], s28 offen sc1 lds
  s_mov_b32 m0, 78848
  s_add_u32 s28, s61, 13312
  buffer_load_dwordx4 v178, s[8:11], s28 offen sc1 lds
  s_mov_b32 m0, 79872
  s_add_u32 s28, s61, 14336
  buffer_load_dwordx4 v178, s[8:11], s28 offen sc1 lds
  s_mov_b32 m0, 80896
  s_add_u32 s28, s61, 15360
  buffer_load_dwordx4 v178, s[8:11], s28 offen sc1 lds
  s_mov_b32 m0, 81920
  s_add_u32 s28, s61, 16384
  buffer_load_dwordx4 v178, s[8:11], s28 offen sc1 lds
  s_mov_b32 m0, 82944
  s_add_u32 s28, s61, 17408
  buffer_load_dwordx4 v178, s[8:11], s28 offen sc1 lds
  s_mov_b32 m0, 83968
  s_add_u32 s28, s61, 18432
  buffer_load_dwordx4 v178, s[8:11], s28 offen sc1 lds
  s_mov_b32 m0, 84992
  s_add_u32 s28, s61, 19456
  buffer_load_dwordx4 v178, s[8:11], s28 offen sc1 lds
  s_waitcnt vmcnt(0)
  s_branch ytp_83_\sfx\()
ytp_83_ok_\sfx\():
  v_mfma_f32_16x16x32_bf16 v[140:143], v[68:71], v[100:103], 0
  v_mfma_f32_16x16x32_bf16 v[140:143], v[72:75], v[104:107], v[140:143]
  v_mfma_f32_16x16x32_bf16 v[140:143], v[76:79], v[108:111], v[140:143]
  v_mfma_f32_16x16x32_bf16 v[140:143], v[80:83], v[112:115], v[140:143]
  v_mfma_f32_16x16x32_bf16 v[140:143], v[84:87], v[116:119], v[140:143]
  v_mfma_f32_16x16x32_bf16 v[140:143], v[88:91], v[120:123], v[140:143]
  v_mfma_f32_16x16x32_bf16 v[140:143], v[92:95], v[124:127], v[140:143]
  v_mfma_f32_16x16x32_bf16 v[140:143], v[96:99], v[128:131], v[140:143]
  v_mfma_f32_16x16x32_bf16 v[140:143], v[148:151], v[132:135], v[140:143]
  v_mfma_f32_16x16x32_bf16 v[140:143], v[152:155], v[136:139], v[140:143]
  s_nop 8
  s_add_u32 s28, s62, 0
  buffer_store_dwordx4 v[140:143], v189, s[8:11], s28 offen
  s_nop 1
  s_mov_b32 s45, 0
ytp_84_\sfx\():
  s_waitcnt lgkmcnt(0)
  ds_read_b128 v[100:103], v183 offset:1024
  ds_read_b128 v[104:107], v183 offset:3072
  ds_read_b128 v[108:111], v183 offset:5120
  ds_read_b128 v[112:115], v183 offset:7168
  ds_read_b128 v[116:119], v183 offset:9216
  ds_read_b128 v[120:123], v183 offset:11264
  ds_read_b128 v[124:127], v183 offset:13312
  ds_read_b128 v[128:131], v183 offset:15360
  ds_read_b128 v[132:135], v183 offset:17408
  ds_read_b128 v[136:139], v183 offset:19456
  s_waitcnt lgkmcnt(0)
  v_max_u32 v190, v100, v102
  v_max3_u32 v190, v190, v104, v106
  v_max3_u32 v190, v190, v108, v110
  v_max3_u32 v190, v190, v112, v114
  v_max3_u32 v190, v190, v116, v118
  v_max3_u32 v190, v190, v120, v122
  v_max3_u32 v190, v190, v124, v126
  v_max3_u32 v190, v190, v128, v130
  v_max3_u32 v190, v190, v132, v134
  v_max3_u32 v190, v190, v136, v138
  v_cmp_eq_u32 vcc, -1, v190
  s_cbranch_vccz ytp_84_ok_\sfx\()
  s_add_u32 s45, s45, 1
  s_cmp_lt_u32 s45, 400000
  s_cbranch_scc0 ka\sfx\()_abort
ytp_84_dma_\sfx\():
  s_mov_b32 m0, 65536
  s_add_u32 s28, s61, 0
  buffer_load_dwordx4 v178, s[8:11], s28 offen sc1 lds
  s_mov_b32 m0, 66560
  s_add_u32 s28, s61, 1024
  buffer_load_dwordx4 v178, s[8:11], s28 offen sc1 lds
  s_mov_b32 m0, 67584
  s_add_u32 s28, s61, 2048
  buffer_load_dwordx4 v178, s[8:11], s28 offen sc1 lds
  s_mov_b32 m0, 68608
  s_add_u32 s28, s61, 3072
  buffer_load_dwordx4 v178, s[8:11], s28 offen sc1 lds
  s_mov_b32 m0, 69632
  s_add_u32 s28, s61, 4096
  buffer_load_dwordx4 v178, s[8:11], s28 offen sc1 lds
  s_mov_b32 m0, 70656
  s_add_u32 s28, s61, 5120
  buffer_load_dwordx4 v178, s[8:11], s28 offen sc1 lds
  s_mov_b32 m0, 71680
  s_add_u32 s28, s61, 6144
  buffer_load_dwordx4 v178, s[8:11], s28 offen sc1 lds
  s_mov_b32 m0, 72704
  s_add_u32 s28, s61, 7168
  buffer_load_dwordx4 v178, s[8:11], s28 offen sc1 lds
  s_mov_b32 m0, 73728
  s_add_u32 s28, s61, 8192
  buffer_load_dwordx4 v178, s[8:11], s28 offen sc1 lds
  s_mov_b32 m0, 74752
  s_add_u32 s28, s61, 9216
  buffer_load_dwordx4 v178, s[8:11], s28 offen sc1 lds
  s_mov_b32 m0, 75776
  s_add_u32 s28, s61, 10240
  buffer_load_dwordx4 v178, s[8:11], s28 offen sc1 lds
  s_mov_b32 m0, 76800
  s_add_u32 s28, s61, 11264
  buffer_load_dwordx4 v178, s[8:11], s28 offen sc1 lds
  s_mov_b32 m0, 77824
  s_add_u32 s28, s61, 12288
  buffer_load_dwordx4 v178, s[8:11], s28 offen sc1 lds
  s_mov_b32 m0, 78848
  s_add_u32 s28, s61, 13312
  buffer_load_dwordx4 v178, s[8:11], s28 offen sc1 lds
  s_mov_b32 m0, 79872
  s_add_u32 s28, s61, 14336
  buffer_load_dwordx4 v178, s[8:11], s28 offen sc1 lds
  s_mov_b32 m0, 80896
  s_add_u32 s28, s61, 15360
  buffer_load_dwordx4 v178, s[8:11], s28 offen sc1 lds
  s_mov_b32 m0, 81920
  s_add_u32 s28, s61, 16384
  buffer_load_dwordx4 v178, s[8:11], s28 offen sc1 lds
  s_mov_b32 m0, 82944
  s_add_u32 s28, s61, 17408
  buffer_load_dwordx4 v178, s[8:11], s28 offen sc1 lds
  s_mov_b32 m0, 83968
  s_add_u32 s28, s61, 18432
  buffer_load_dwordx4 v178, s[8:11], s28 offen sc1 lds
  s_mov_b32 m0, 84992
  s_add_u32 s28, s61, 19456
  buffer_load_dwordx4 v178, s[8:11], s28 offen sc1 lds
  s_waitcnt vmcnt(0)
  s_branch ytp_84_\sfx\()
ytp_84_ok_\sfx\():
  v_mfma_f32_16x16x32_bf16 v[140:143], v[68:71], v[100:103], 0
  v_mfma_f32_16x16x32_bf16 v[140:143], v[72:75], v[104:107], v[140:143]
  v_mfma_f32_16x16x32_bf16 v[140:143], v[76:79], v[108:111], v[140:143]
  v_mfma_f32_16x16x32_bf16 v[140:143], v[80:83], v[112:115], v[140:143]
  v_mfma_f32_16x16x32_bf16 v[140:143], v[84:87], v[116:119], v[140:143]
  v_mfma_f32_16x16x32_bf16 v[140:143], v[88:91], v[120:123], v[140:143]
  v_mfma_f32_16x16x32_bf16 v[140:143], v[92:95], v[124:127], v[140:143]
  v_mfma_f32_16x16x32_bf16 v[140:143], v[96:99], v[128:131], v[140:143]
  v_mfma_f32_16x16x32_bf16 v[140:143], v[148:151], v[132:135], v[140:143]
  v_mfma_f32_16x16x32_bf16 v[140:143], v[152:155], v[136:139], v[140:143]
  s_nop 8
  s_add_u32 s28, s62, 256
  buffer_store_dwordx4 v[140:143], v189, s[8:11], s28 offen
  s_nop 1
  s_add_u32 s61, s61, 20480
  s_add_u32 s62, s62, 81920
  s_add_u32 s54, s54, 1
  v_xor_b32 v181, 0x4000, v181
yt_82_\sfx\():
  s_waitcnt lgkmcnt(0)
  v_mov_b32 v148, v60
  v_mov_b32 v149, v61
  v_mov_b32 v150, v62
  v_mov_b32 v151, v63
  v_mov_b32 v152, v64
  v_mov_b32 v153, v65
  v_mov_b32 v154, v66
  v_mov_b32 v155, v67
  s_add_u32 s97, s97, 10240
  s_mov_b32 s48, s97
  s_add_u32 s51, s51, 1
  s_cmp_lt_u32 s51, 64
  s_cbranch_scc1 ka\sfx\()_y_tokl
  s_barrier
  ds_read_b128 v[68:71], v181 offset:0
  ds_read_b128 v[72:75], v181 offset:2048
  ds_read_b128 v[76:79], v181 offset:4096
  ds_read_b128 v[80:83], v181 offset:6144
  ds_read_b128 v[84:87], v181 offset:8192
  ds_read_b128 v[88:91], v181 offset:10240
  ds_read_b128 v[92:95], v181 offset:12288
  ds_read_b128 v[96:99], v181 offset:14336
  s_mov_b32 s45, 0
  s_branch ytp_85_dma_\sfx\()
ytp_85_\sfx\():
  s_waitcnt lgkmcnt(0)
  ds_read_b128 v[100:103], v183 offset:0
  ds_read_b128 v[104:107], v183 offset:2048
  ds_read_b128 v[108:111], v183 offset:4096
  ds_read_b128 v[112:115], v183 offset:6144
  ds_read_b128 v[116:119], v183 offset:8192
  ds_read_b128 v[120:123], v183 offset:10240
  ds_read_b128 v[124:127], v183 offset:12288
  ds_read_b128 v[128:131], v183 offset:14336
  ds_read_b128 v[132:135], v183 offset:16384
  ds_read_b128 v[136:139], v183 offset:18432
  s_waitcnt lgkmcnt(0)
  v_max_u32 v190, v100, v102
  v_max3_u32 v190, v190, v104, v106
  v_max3_u32 v190, v190, v108, v110
  v_max3_u32 v190, v190, v112, v114
  v_max3_u32 v190, v190, v116, v118
  v_max3_u32 v190, v190, v120, v122
  v_max3_u32 v190, v190, v124, v126
  v_max3_u32 v190, v190, v128, v130
  v_max3_u32 v190, v190, v132, v134
  v_max3_u32 v190, v190, v136, v138
  v_cmp_eq_u32 vcc, -1, v190
  s_cbranch_vccz ytp_85_ok_\sfx\()
  s_add_u32 s45, s45, 1
  s_cmp_lt_u32 s45, 400000
  s_cbranch_scc0 ka\sfx\()_abort
ytp_85_dma_\sfx\():
  s_mov_b32 m0, 65536
  s_add_u32 s28, s61, 0
  buffer_load_dwordx4 v178, s[8:11], s28 offen sc1 lds
  s_mov_b32 m0, 66560
  s_add_u32 s28, s61, 1024
  buffer_load_dwordx4 v178, s[8:11], s28 offen sc1 lds
  s_mov_b32 m0, 67584
  s_add_u32 s28, s61, 2048
  buffer_load_dwordx4 v178, s[8:11], s28 offen sc1 lds
  s_mov_b32 m0, 68608
  s_add_u32 s28, s61, 3072
  buffer_load_dwordx4 v178, s[8:11], s28 offen sc1 lds
  s_mov_b32 m0, 69632
  s_add_u32 s28, s61, 4096
  buffer_load_dwordx4 v178, s[8:11], s28 offen sc1 lds
  s_mov_b32 m0, 70656
  s_add_u32 s28, s61, 5120
  buffer_load_dwordx4 v178, s[8:11], s28 offen sc1 lds
  s_mov_b32 m0, 71680
  s_add_u32 s28, s61, 6144
  buffer_load_dwordx4 v178, s[8:11], s28 offen sc1 lds
  s_mov_b32 m0, 72704
  s_add_u32 s28, s61, 7168
  buffer_load_dwordx4 v178, s[8:11], s28 offen sc1 lds
  s_mov_b32 m0, 73728
  s_add_u32 s28, s61, 8192
  buffer_load_dwordx4 v178, s[8:11], s28 offen sc1 lds
  s_mov_b32 m0, 74752
  s_add_u32 s28, s61, 9216
  buffer_load_dwordx4 v178, s[8:11], s28 offen sc1 lds
  s_mov_b32 m0, 75776
  s_add_u32 s28, s61, 10240
  buffer_load_dwordx4 v178, s[8:11], s28 offen sc1 lds
  s_mov_b32 m0, 76800
  s_add_u32 s28, s61, 11264
  buffer_load_dwordx4 v178, s[8:11], s28 offen sc1 lds
  s_mov_b32 m0, 77824
  s_add_u32 s28, s61, 12288
  buffer_load_dwordx4 v178, s[8:11], s28 offen sc1 lds
  s_mov_b32 m0, 78848
  s_add_u32 s28, s61, 13312
  buffer_load_dwordx4 v178, s[8:11], s28 offen sc1 lds
  s_mov_b32 m0, 79872
  s_add_u32 s28, s61, 14336
  buffer_load_dwordx4 v178, s[8:11], s28 offen sc1 lds
  s_mov_b32 m0, 80896
  s_add_u32 s28, s61, 15360
  buffer_load_dwordx4 v178, s[8:11], s28 offen sc1 lds
  s_mov_b32 m0, 81920
  s_add_u32 s28, s61, 16384
  buffer_load_dwordx4 v178, s[8:11], s28 offen sc1 lds
  s_mov_b32 m0, 82944
  s_add_u32 s28, s61, 17408
  buffer_load_dwordx4 v178, s[8:11], s28 offen sc1 lds
  s_mov_b32 m0, 83968
  s_add_u32 s28, s61, 18432
  buffer_load_dwordx4 v178, s[8:11], s28 offen sc1 lds
  s_mov_b32 m0, 84992
  s_add_u32 s28, s61, 19456
  buffer_load_dwordx4 v178, s[8:11], s28 offen sc1 lds
  s_waitcnt vmcnt(0)
  s_branch ytp_85_\sfx\()
ytp_85_ok_\sfx\():
  v_mfma_f32_16x16x32_bf16 v[140:143], v[68:71], v[100:103], 0
  v_mfma_f32_16x16x32_bf16 v[140:143], v[72:75], v[104:107], v[140:143]
  v_mfma_f32_16x16x32_bf16 v[140:143], v[76:79], v[108:111], v[140:143]
  v_mfma_f32_16x16x32_bf16 v[140:143], v[80:83], v[112:115], v[140:143]
  v_mfma_f32_16x16x32_bf16 v[140:143], v[84:87], v[116:119], v[140:143]
  v_mfma_f32_16x16x32_bf16 v[140:143], v[88:91], v[120:123], v[140:143]
  v_mfma_f32_16x16x32_bf16 v[140:143], v[92:95], v[124:127], v[140:143]
  v_mfma_f32_16x16x32_bf16 v[140:143], v[96:99], v[128:131], v[140:143]
  v_mfma_f32_16x16x32_bf16 v[140:143], v[148:151], v[132:135], v[140:143]
  v_mfma_f32_16x16x32_bf16 v[140:143], v[152:155], v[136:139], v[140:143]
  s_nop 8
  s_add_u32 s28, s62, 0
  buffer_store_dwordx4 v[140:143], v189, s[8:11], s28 offen
  s_nop 1
  s_mov_b32 s45, 0
ytp_86_\sfx\():
  s_waitcnt lgkmcnt(0)
  ds_read_b128 v[100:103], v183 offset:1024
  ds_read_b128 v[104:107], v183 offset:3072
  ds_read_b128 v[108:111], v183 offset:5120
  ds_read_b128 v[112:115], v183 offset:7168
  ds_read_b128 v[116:119], v183 offset:9216
  ds_read_b128 v[120:123], v183 offset:11264
  ds_read_b128 v[124:127], v183 offset:13312
  ds_read_b128 v[128:131], v183 offset:15360
  ds_read_b128 v[132:135], v183 offset:17408
  ds_read_b128 v[136:139], v183 offset:19456
  s_waitcnt lgkmcnt(0)
  v_max_u32 v190, v100, v102
  v_max3_u32 v190, v190, v104, v106
  v_max3_u32 v190, v190, v108, v110
  v_max3_u32 v190, v190, v112, v114
  v_max3_u32 v190, v190, v116, v118
  v_max3_u32 v190, v190, v120, v122
  v_max3_u32 v190, v190, v124, v126
  v_max3_u32 v190, v190, v128, v130
  v_max3_u32 v190, v190, v132, v134
  v_max3_u32 v190, v190, v136, v138
  v_cmp_eq_u32 vcc, -1, v190
  s_cbranch_vccz ytp_86_ok_\sfx\()
  s_add_u32 s45, s45, 1
  s_cmp_lt_u32 s45, 400000
  s_cbranch_scc0 ka\sfx\()_abort
ytp_86_dma_\sfx\():
  s_mov_b32 m0, 65536
  s_add_u32 s28, s61, 0
  buffer_load_dwordx4 v178, s[8:11], s28 offen sc1 lds
  s_mov_b32 m0, 66560
  s_add_u32 s28, s61, 1024
  buffer_load_dwordx4 v178, s[8:11], s28 offen sc1 lds
  s_mov_b32 m0, 67584
  s_add_u32 s28, s61, 2048
  buffer_load_dwordx4 v178, s[8:11], s28 offen sc1 lds
  s_mov_b32 m0, 68608
  s_add_u32 s28, s61, 3072
  buffer_load_dwordx4 v178, s[8:11], s28 offen sc1 lds
  s_mov_b32 m0, 69632
  s_add_u32 s28, s61, 4096
  buffer_load_dwordx4 v178, s[8:11], s28 offen sc1 lds
  s_mov_b32 m0, 70656
  s_add_u32 s28, s61, 5120
  buffer_load_dwordx4 v178, s[8:11], s28 offen sc1 lds
  s_mov_b32 m0, 71680
  s_add_u32 s28, s61, 6144
  buffer_load_dwordx4 v178, s[8:11], s28 offen sc1 lds
  s_mov_b32 m0, 72704
  s_add_u32 s28, s61, 7168
  buffer_load_dwordx4 v178, s[8:11], s28 offen sc1 lds
  s_mov_b32 m0, 73728
  s_add_u32 s28, s61, 8192
  buffer_load_dwordx4 v178, s[8:11], s28 offen sc1 lds
  s_mov_b32 m0, 74752
  s_add_u32 s28, s61, 9216
  buffer_load_dwordx4 v178, s[8:11], s28 offen sc1 lds
  s_mov_b32 m0, 75776
  s_add_u32 s28, s61, 10240
  buffer_load_dwordx4 v178, s[8:11], s28 offen sc1 lds
  s_mov_b32 m0, 76800
  s_add_u32 s28, s61, 11264
  buffer_load_dwordx4 v178, s[8:11], s28 offen sc1 lds
  s_mov_b32 m0, 77824
  s_add_u32 s28, s61, 12288
  buffer_load_dwordx4 v178, s[8:11], s28 offen sc1 lds
  s_mov_b32 m0, 78848
  s_add_u32 s28, s61, 13312
  buffer_load_dwordx4 v178, s[8:11], s28 offen sc1 lds
  s_mov_b32 m0, 79872
  s_add_u32 s28, s61, 14336
  buffer_load_dwordx4 v178, s[8:11], s28 offen sc1 lds
  s_mov_b32 m0, 80896
  s_add_u32 s28, s61, 15360
  buffer_load_dwordx4 v178, s[8:11], s28 offen sc1 lds
  s_mov_b32 m0, 81920
  s_add_u32 s28, s61, 16384
  buffer_load_dwordx4 v178, s[8:11], s28 offen sc1 lds
  s_mov_b32 m0, 82944
  s_add_u32 s28, s61, 17408
  buffer_load_dwordx4 v178, s[8:11], s28 offen sc1 lds
  s_mov_b32 m0, 83968
  s_add_u32 s28, s61, 18432
  buffer_load_dwordx4 v178, s[8:11], s28 offen sc1 lds
  s_mov_b32 m0, 84992
  s_add_u32 s28, s61, 19456
  buffer_load_dwordx4 v178, s[8:11], s28 offen sc1 lds
  s_waitcnt vmcnt(0)
  s_branch ytp_86_\sfx\()
ytp_86_ok_\sfx\():
  v_mfma_f32_16x16x32_bf16 v[140:143], v[68:71], v[100:103], 0
  v_mfma_f32_16x16x32_bf16 v[140:143], v[72:75], v[104:107], v[140:143]
  v_mfma_f32_16x16x32_bf16 v[140:143], v[76:79], v[108:111], v[140:143]
  v_mfma_f32_16x16x32_bf16 v[140:143], v[80:83], v[112:115], v[140:143]
  v_mfma_f32_16x16x32_bf16 v[140:143], v[84:87], v[116:119], v[140:143]
  v_mfma_f32_16x16x32_bf16 v[140:143], v[88:91], v[120:123], v[140:143]
  v_mfma_f32_16x16x32_bf16 v[140:143], v[92:95], v[124:127], v[140:143]
  v_mfma_f32_16x16x32_bf16 v[140:143], v[96:99], v[128:131], v[140:143]
  v_mfma_f32_16x16x32_bf16 v[140:143], v[148:151], v[132:135], v[140:143]
  v_mfma_f32_16x16x32_bf16 v[140:143], v[152:155], v[136:139], v[140:143]
  s_nop 8
  s_add_u32 s28, s62, 256
  buffer_store_dwordx4 v[140:143], v189, s[8:11], s28 offen
  s_nop 1
  s_add_u32 s61, s61, 20480
  s_add_u32 s62, s62, 81920
  s_add_u32 s54, s54, 1
  v_xor_b32 v181, 0x4000, v181
  s_waitcnt vmcnt(0)
  s_branch ka\sfx\()_exit
ka\sfx\()_abort:
  s_branch ka_abort
ka\sfx\()_exit:
  s_branch ka_exit
.endm
CHAINROLES f,
CHAINROLES s, sc1
ka_abort:
  s_load_dwordx2 s[6:7], s[0:1], 88
  v_mov_b32 v2, 80
  v_mov_b32 v3, 1
  s_waitcnt lgkmcnt(0)
  s_mov_b64 exec, 1
  global_atomic_add v2, v3, s[6:7]
  s_waitcnt vmcnt(0)
ka_exit:
  s_endpgm

.section .rodata,"a"
.p2align 6
.amdhsa_kernel ka2_kernel
  .amdhsa_next_free_vgpr 512
  .amdhsa_next_free_sgpr 102
  .amdhsa_accum_offset 256
  .amdhsa_group_segment_fixed_size 0
  .amdhsa_kernarg_size 104
  .amdhsa_user_sgpr_count 2
  .amdhsa_user_sgpr_kernarg_segment_ptr 1
  .amdhsa_system_sgpr_workgroup_id_x 1
.end_amdhsa_kernel
.text
.globl kb2_kernel
.p2align 8
.type kb2_kernel,@function
kb2_kernel:
  s_cmp_ge_u32 s2, 256
  s_cbranch_scc1 kb2_exit
  s_load_dwordx2 s[36:37], s[0:1], 0
  s_load_dwordx2 s[38:39], s[0:1], 80
  s_load_dwordx2 s[4:5], s[0:1], 96
  v_lshrrev_b32 v1, 6, v0
  s_nop 0
  v_readfirstlane_b32 s21, v1
  v_and_b32 v1, 63, v0
  v_lshlrev_b32 v2, 4, v1
  s_waitcnt lgkmcnt(0)
  s_mov_b32 s8, s4
  s_and_b32 s9, s5, 0xffff
  s_mov_b32 s10, 0x10000000
  s_mov_b32 s11, 0x20000
  s_mov_b32 s12, s36
  s_and_b32 s13, s37, 0xffff
  s_mov_b32 s14, 0x280000
  s_mov_b32 s15, 0x20000
  s_mov_b32 s16, s38
  s_and_b32 s17, s39, 0xffff
  s_mov_b32 s18, 0x280000
  s_mov_b32 s19, 0x20000
  s_and_b32 s22, s2, 7
  s_lshl_b32 s22, s22, 2
  s_bfe_u32 s23, s2, 0x20003
  s_add_u32 s22, s22, s23
  s_lshr_b32 s23, s2, 5
  s_lshl_b32 s46, s23, 7
  s_add_u32 s46, s46, 0xa000
  s_add_u32 s48, s46, 0x1400
  s_lshl_b32 s47, s22, 7
  s_add_u32 s47, s47, 0xa400
  s_lshr_b32 s26, s2, 2
  s_and_b32 s27, s2, 3
  s_lshl_b32 s27, s27, 3
  v_and_b32 v5, 7, v1
  v_bfe_u32 v6, v1, 3, 1
  v_lshrrev_b32 v7, 4, v1
  v_lshlrev_b32 v8, 5, v6
  v_add_u32 v8, v8, v5
  v_add_u32 v8, s27, v8
  v_lshlrev_b32 v8, 4, v8
  v_lshlrev_b32 v9, 11, v7
  v_add_u32 v9, v9, v8
  v_lshlrev_b32 v10, 10, v7
  v_add_u32 v10, v10, v8
  s_mul_i32 s28, s26, 81920
  s_lshl_b32 s29, s21, 13
  s_add_u32 s28, s28, s29
  s_cmp_lt_u32 s21, 2
  s_cselect_b32 s49, 3, 2
  v_mov_b32 v32, 0
  v_mov_b32 v33, 0
  v_mov_b32 v34, 0
  v_mov_b32 v35, 0
  v_mov_b32 v36, 0
  v_mov_b32 v37, 0
  v_mov_b32 v38, 0
  v_mov_b32 v39, 0
  v_mov_b32 v64, 0
  v_mov_b32 v65, 0
  v_mov_b32 v66, 0
  v_mov_b32 v67, 0
  v_mov_b32 v68, 0
  v_mov_b32 v69, 0
  v_mov_b32 v70, 0
  v_mov_b32 v71, 0
  v_mov_b32 v88, 0
  v_mov_b32 v89, 0
  v_mov_b32 v90, 0
  v_mov_b32 v91, 0
  v_mov_b32 v92, 0
  v_mov_b32 v93, 0
  v_mov_b32 v94, 0
  v_mov_b32 v95, 0
  v_mov_b32 v112, 0
  v_mov_b32 v113, 0
  v_mov_b32 v114, 0
  v_mov_b32 v115, 0
  v_mov_b32 v116, 0
  v_mov_b32 v117, 0
  v_mov_b32 v118, 0
  v_mov_b32 v119, 0
  v_mov_b32 v136, 0
  v_mov_b32 v137, 0
  v_mov_b32 v138, 0
  v_mov_b32 v139, 0
  v_mov_b32 v140, 0
  v_mov_b32 v141, 0
  v_mov_b32 v142, 0
  v_mov_b32 v143, 0
  s_add_u32 s30, s28, 27262976
  buffer_load_dwordx4 v[48:51], v9, s[8:11], s30 offen
  s_add_u32 s30, s28, 27264000
  buffer_load_dwordx4 v[52:55], v9, s[8:11], s30 offen
  s_add_u32 s30, s28, 32505856
  buffer_load_dwordx4 v[72:75], v9, s[8:11], s30 offen
  s_add_u32 s30, s28, 32506880
  buffer_load_dwordx4 v[76:79], v9, s[8:11], s30 offen
  s_add_u32 s30, s28, 37748736
  buffer_load_dwordx4 v[96:99], v9, s[8:11], s30 offen
  s_add_u32 s30, s28, 37749760
  buffer_load_dwordx4 v[100:103], v9, s[8:11], s30 offen
  s_add_u32 s30, s28, 42991616
  buffer_load_dwordx4 v[120:123], v9, s[8:11], s30 offen
  s_add_u32 s30, s28, 42992640
  buffer_load_dwordx4 v[124:127], v9, s[8:11], s30 offen
  s_add_u32 s30, s28, 20971520
  buffer_load_dwordx4 v[16:19], v9, s[8:11], s30 offen
  s_add_u32 s30, s28, 20972544
  buffer_load_dwordx4 v[20:23], v9, s[8:11], s30 offen
  s_add_u32 s30, s28, 27295744
  buffer_load_dwordx4 v[56:59], v9, s[8:11], s30 offen
  s_add_u32 s30, s28, 27296768
  buffer_load_dwordx4 v[60:63], v9, s[8:11], s30 offen
  s_add_u32 s30, s28, 32538624
  buffer_load_dwordx4 v[80:83], v9, s[8:11], s30 offen
  s_add_u32 s30, s28, 32539648
  buffer_load_dwordx4 v[84:87], v9, s[8:11], s30 offen
  s_add_u32 s30, s28, 37781504
  buffer_load_dwordx4 v[104:107], v9, s[8:11], s30 offen
  s_add_u32 s30, s28, 37782528
  buffer_load_dwordx4 v[108:111], v9, s[8:11], s30 offen
  s_add_u32 s30, s28, 43024384
  buffer_load_dwordx4 v[128:131], v9, s[8:11], s30 offen
  s_add_u32 s30, s28, 43025408
  buffer_load_dwordx4 v[132:135], v9, s[8:11], s30 offen
  s_add_u32 s30, s28, 21004288
  buffer_load_dwordx4 v[24:27], v9, s[8:11], s30 offen
  s_add_u32 s30, s28, 21005312
  buffer_load_dwordx4 v[28:31], v9, s[8:11], s30 offen
  s_cmp_lt_u32 s21, 2
  s_cbranch_scc0 g3_87
  s_add_u32 s30, s28, 27328512
  buffer_load_dwordx4 v[64:67], v9, s[8:11], s30 offen
  s_add_u32 s30, s28, 27329536
  buffer_load_dwordx4 v[68:71], v9, s[8:11], s30 offen
  s_add_u32 s30, s28, 32571392
  buffer_load_dwordx4 v[88:91], v9, s[8:11], s30 offen
  s_add_u32 s30, s28, 32572416
  buffer_load_dwordx4 v[92:95], v9, s[8:11], s30 offen
  s_add_u32 s30, s28, 37814272
  buffer_load_dwordx4 v[112:115], v9, s[8:11], s30 offen
  s_add_u32 s30, s28, 37815296
  buffer_load_dwordx4 v[116:119], v9, s[8:11], s30 offen
  s_add_u32 s30, s28, 43057152
  buffer_load_dwordx4 v[136:139], v9, s[8:11], s30 offen
  s_add_u32 s30, s28, 43058176
  buffer_load_dwordx4 v[140:143], v9, s[8:11], s30 offen
  s_add_u32 s30, s28, 21037056
  buffer_load_dwordx4 v[32:35], v9, s[8:11], s30 offen
  s_add_u32 s30, s28, 21038080
  buffer_load_dwordx4 v[36:39], v9, s[8:11], s30 offen
g3_87:
  s_mul_i32 s30, s22, 122880
  s_mul_i32 s31, s21, 30720
  s_add_u32 s30, s30, s31
  s_add_u32 s30, s30, 0xe100000
  s_add_u32 m0, s31, 0
  s_add_u32 s29, s30, 0
  buffer_load_dwordx4 v2, s[8:11], s29 offen lds
  s_add_u32 m0, s31, 1024
  s_add_u32 s29, s30, 1024
  buffer_load_dwordx4 v2, s[8:11], s29 offen lds
  s_add_u32 m0, s31, 2048
  s_add_u32 s29, s30, 2048
  buffer_load_dwordx4 v2, s[8:11], s29 offen lds
  s_add_u32 m0, s31, 3072
  s_add_u32 s29, s30, 3072
  buffer_load_dwordx4 v2, s[8:11], s29 offen lds
  s_add_u32 m0, s31, 4096
  s_add_u32 s29, s30, 4096
  buffer_load_dwordx4 v2, s[8:11], s29 offen lds
  s_add_u32 m0, s31, 5120
  s_add_u32 s29, s30, 5120
  buffer_load_dwordx4 v2, s[8:11], s29 offen lds
  s_add_u32 m0, s31, 6144
  s_add_u32 s29, s30, 6144
  buffer_load_dwordx4 v2, s[8:11], s29 offen lds
  s_add_u32 m0, s31, 7168
  s_add_u32 s29, s30, 7168
  buffer_load_dwordx4 v2, s[8:11], s29 offen lds
  s_add_u32 m0, s31, 8192
  s_add_u32 s29, s30, 8192
  buffer_load_dwordx4 v2, s[8:11], s29 offen lds
  s_add_u32 m0, s31, 9216
  s_add_u32 s29, s30, 9216
  buffer_load_dwordx4 v2, s[8:11], s29 offen lds
  s_add_u32 m0, s31, 10240
  s_add_u32 s29, s30, 10240
  buffer_load_dwordx4 v2, s[8:11], s29 offen lds
  s_add_u32 m0, s31, 11264
  s_add_u32 s29, s30, 11264
  buffer_load_dwordx4 v2, s[8:11], s29 offen lds
  s_add_u32 m0, s31, 12288
  s_add_u32 s29, s30, 12288
  buffer_load_dwordx4 v2, s[8:11], s29 offen lds
  s_add_u32 m0, s31, 13312
  s_add_u32 s29, s30, 13312
  buffer_load_dwordx4 v2, s[8:11], s29 offen lds
  s_add_u32 m0, s31, 14336
  s_add_u32 s29, s30, 14336
  buffer_load_dwordx4 v2, s[8:11], s29 offen lds
  s_add_u32 m0, s31, 15360
  s_add_u32 s29, s30, 15360
  buffer_load_dwordx4 v2, s[8:11], s29 offen lds
  s_add_u32 m0, s31, 16384
  s_add_u32 s29, s30, 16384
  buffer_load_dwordx4 v2, s[8:11], s29 offen lds
  s_add_u32 m0, s31, 17408
  s_add_u32 s29, s30, 17408
  buffer_load_dwordx4 v2, s[8:11], s29 offen lds
  s_add_u32 m0, s31, 18432
  s_add_u32 s29, s30, 18432
  buffer_load_dwordx4 v2, s[8:11], s29 offen lds
  s_add_u32 m0, s31, 19456
  s_add_u32 s29, s30, 19456
  buffer_load_dwordx4 v2, s[8:11], s29 offen lds
  s_add_u32 m0, s31, 20480
  s_add_u32 s29, s30, 20480
  buffer_load_dwordx4 v2, s[8:11], s29 offen lds
  s_add_u32 m0, s31, 21504
  s_add_u32 s29, s30, 21504
  buffer_load_dwordx4 v2, s[8:11], s29 offen lds
  s_add_u32 m0, s31, 22528
  s_add_u32 s29, s30, 22528
  buffer_load_dwordx4 v2, s[8:11], s29 offen lds
  s_add_u32 m0, s31, 23552
  s_add_u32 s29, s30, 23552
  buffer_load_dwordx4 v2, s[8:11], s29 offen lds
  s_add_u32 m0, s31, 24576
  s_add_u32 s29, s30, 24576
  buffer_load_dwordx4 v2, s[8:11], s29 offen lds
  s_add_u32 m0, s31, 25600
  s_add_u32 s29, s30, 25600
  buffer_load_dwordx4 v2, s[8:11], s29 offen lds
  s_add_u32 m0, s31, 26624
  s_add_u32 s29, s30, 26624
  buffer_load_dwordx4 v2, s[8:11], s29 offen lds
  s_add_u32 m0, s31, 27648
  s_add_u32 s29, s30, 27648
  buffer_load_dwordx4 v2, s[8:11], s29 offen lds
  s_add_u32 m0, s31, 28672
  s_add_u32 s29, s30, 28672
  buffer_load_dwordx4 v2, s[8:11], s29 offen lds
  s_add_u32 m0, s31, 29696
  s_add_u32 s29, s30, 29696
  buffer_load_dwordx4 v2, s[8:11], s29 offen lds
  s_waitcnt vmcnt(30)
  v_add_f32 v48, v48, v72
  v_add_f32 v96, v96, v120
  v_add_f32 v49, v49, v73
  v_add_f32 v97, v97, v121
  v_add_f32 v50, v50, v74
  v_add_f32 v98, v98, v122
  v_add_f32 v51, v51, v75
  v_add_f32 v99, v99, v123
  v_add_f32 v52, v52, v76
  v_add_f32 v100, v100, v124
  v_add_f32 v53, v53, v77
  v_add_f32 v101, v101, v125
  v_add_f32 v54, v54, v78
  v_add_f32 v102, v102, v126
  v_add_f32 v55, v55, v79
  v_add_f32 v103, v103, v127
  v_add_f32 v56, v56, v80
  v_add_f32 v104, v104, v128
  v_add_f32 v57, v57, v81
  v_add_f32 v105, v105, v129
  v_add_f32 v58, v58, v82
  v_add_f32 v106, v106, v130
  v_add_f32 v59, v59, v83
  v_add_f32 v107, v107, v131
  v_add_f32 v60, v60, v84
  v_add_f32 v108, v108, v132
  v_add_f32 v61, v61, v85
  v_add_f32 v109, v109, v133
  v_add_f32 v62, v62, v86
  v_add_f32 v110, v110, v134
  v_add_f32 v63, v63, v87
  v_add_f32 v111, v111, v135
  v_add_f32 v64, v64, v88
  v_add_f32 v112, v112, v136
  v_add_f32 v65, v65, v89
  v_add_f32 v113, v113, v137
  v_add_f32 v66, v66, v90
  v_add_f32 v114, v114, v138
  v_add_f32 v67, v67, v91
  v_add_f32 v115, v115, v139
  v_add_f32 v68, v68, v92
  v_add_f32 v116, v116, v140
  v_add_f32 v69, v69, v93
  v_add_f32 v117, v117, v141
  v_add_f32 v70, v70, v94
  v_add_f32 v118, v118, v142
  v_add_f32 v71, v71, v95
  v_add_f32 v119, v119, v143
  v_add_f32 v48, v48, v96
  v_add_f32 v16, v16, v48
  v_add_f32 v49, v49, v97
  v_add_f32 v17, v17, v49
  v_add_f32 v50, v50, v98
  v_add_f32 v18, v18, v50
  v_add_f32 v51, v51, v99
  v_add_f32 v19, v19, v51
  v_add_f32 v52, v52, v100
  v_add_f32 v20, v20, v52
  v_add_f32 v53, v53, v101
  v_add_f32 v21, v21, v53
  v_add_f32 v54, v54, v102
  v_add_f32 v22, v22, v54
  v_add_f32 v55, v55, v103
  v_add_f32 v23, v23, v55
  v_add_f32 v56, v56, v104
  v_add_f32 v24, v24, v56
  v_add_f32 v57, v57, v105
  v_add_f32 v25, v25, v57
  v_add_f32 v58, v58, v106
  v_add_f32 v26, v26, v58
  v_add_f32 v59, v59, v107
  v_add_f32 v27, v27, v59
  v_add_f32 v60, v60, v108
  v_add_f32 v28, v28, v60
  v_add_f32 v61, v61, v109
  v_add_f32 v29, v29, v61
  v_add_f32 v62, v62, v110
  v_add_f32 v30, v30, v62
  v_add_f32 v63, v63, v111
  v_add_f32 v31, v31, v63
  v_add_f32 v64, v64, v112
  v_add_f32 v32, v32, v64
  v_add_f32 v65, v65, v113
  v_add_f32 v33, v33, v65
  v_add_f32 v66, v66, v114
  v_add_f32 v34, v34, v66
  v_add_f32 v67, v67, v115
  v_add_f32 v35, v35, v67
  v_add_f32 v68, v68, v116
  v_add_f32 v36, v36, v68
  v_add_f32 v69, v69, v117
  v_add_f32 v37, v37, v69
  v_add_f32 v70, v70, v118
  v_add_f32 v38, v38, v70
  v_add_f32 v71, v71, v119
  v_add_f32 v39, v39, v71
  s_add_u32 s30, s28, 20971520
  buffer_store_dwordx4 v[16:19], v9, s[8:11], s30 offen sc1
  s_add_u32 s30, s28, 20972544
  buffer_store_dwordx4 v[20:23], v9, s[8:11], s30 offen sc1
  s_add_u32 s30, s28, 21004288
  buffer_store_dwordx4 v[24:27], v9, s[8:11], s30 offen sc1
  s_add_u32 s30, s28, 21005312
  buffer_store_dwordx4 v[28:31], v9, s[8:11], s30 offen sc1
  s_cmp_lt_u32 s21, 2
  s_cbranch_scc0 g3_88
  s_add_u32 s30, s28, 21037056
  buffer_store_dwordx4 v[32:35], v9, s[8:11], s30 offen sc1
  s_add_u32 s30, s28, 21038080
  buffer_store_dwordx4 v[36:39], v9, s[8:11], s30 offen sc1
g3_88:
  v_add_f32 v12, v16, v17
  v_add_f32 v12, v12, v18
  v_add_f32 v12, v12, v19
  v_add_f32 v12, v12, v20
  v_add_f32 v12, v12, v21
  v_add_f32 v12, v12, v22
  v_add_f32 v12, v12, v23
  v_add_f32 v12, v12, v24
  v_add_f32 v12, v12, v25
  v_add_f32 v12, v12, v26
  v_add_f32 v12, v12, v27
  v_add_f32 v12, v12, v28
  v_add_f32 v12, v12, v29
  v_add_f32 v12, v12, v30
  v_add_f32 v12, v12, v31
  v_add_f32 v12, v12, v32
  v_add_f32 v12, v12, v33
  v_add_f32 v12, v12, v34
  v_add_f32 v12, v12, v35
  v_add_f32 v12, v12, v36
  v_add_f32 v12, v12, v37
  v_add_f32 v12, v12, v38
  v_add_f32 v12, v12, v39
  s_nop 1
  v_add_f32_dpp v12, v12, v12 row_ror:8 row_mask:0xf bank_mask:0xf
  v_mov_b32 v13, v12
  s_nop 1
  v_permlane16_swap_b32 v12, v13
  v_add_f32 v12, v12, v13
  v_mov_b32 v13, v12
  s_nop 1
  v_permlane32_swap_b32 v12, v13
  v_add_f32 v12, v12, v13
  v_lshlrev_b32 v14, 2, v5
  v_add_u32 v14, 131072, v14
  s_lshl_b32 s30, s21, 5
  v_add_u32 v15, s30, v14
  ds_write_b32 v15, v12
  s_waitcnt lgkmcnt(0)
  s_barrier
  ds_read_b32 v48, v14
  ds_read_b32 v49, v14 offset:32
  ds_read_b32 v50, v14 offset:64
  ds_read_b32 v51, v14 offset:96
  s_waitcnt lgkmcnt(0)
  v_add_f32 v48, v48, v49
  v_add_f32 v50, v50, v51
  v_add_f32 v48, v48, v50
  v_mul_f32 v48, 0x3acccccd, v48
  v_sub_f32 v56, v16, v48
  v_sub_f32 v57, v17, v48
  v_sub_f32 v58, v18, v48
  v_sub_f32 v59, v19, v48
  v_sub_f32 v60, v20, v48
  v_sub_f32 v61, v21, v48
  v_sub_f32 v62, v22, v48
  v_sub_f32 v63, v23, v48
  v_sub_f32 v64, v24, v48
  v_sub_f32 v65, v25, v48
  v_sub_f32 v66, v26, v48
  v_sub_f32 v67, v27, v48
  v_sub_f32 v68, v28, v48
  v_sub_f32 v69, v29, v48
  v_sub_f32 v70, v30, v48
  v_sub_f32 v71, v31, v48
  v_sub_f32 v72, v32, v48
  v_sub_f32 v73, v33, v48
  v_sub_f32 v74, v34, v48
  v_sub_f32 v75, v35, v48
  v_sub_f32 v76, v36, v48
  v_sub_f32 v77, v37, v48
  v_sub_f32 v78, v38, v48
  v_sub_f32 v79, v39, v48
  s_cmp_lt_u32 s21, 2
  s_cbranch_scc1 g3z_89
  v_mov_b32 v72, 0
  v_mov_b32 v73, 0
  v_mov_b32 v74, 0
  v_mov_b32 v75, 0
  v_mov_b32 v76, 0
  v_mov_b32 v77, 0
  v_mov_b32 v78, 0
  v_mov_b32 v79, 0
g3z_89:
  v_mul_f32 v12, v56, v56
  v_fmac_f32 v12, v57, v57
  v_fmac_f32 v12, v58, v58
  v_fmac_f32 v12, v59, v59
  v_fmac_f32 v12, v60, v60
  v_fmac_f32 v12, v61, v61
  v_fmac_f32 v12, v62, v62
  v_fmac_f32 v12, v63, v63
  v_fmac_f32 v12, v64, v64
  v_fmac_f32 v12, v65, v65
  v_fmac_f32 v12, v66, v66
  v_fmac_f32 v12, v67, v67
  v_fmac_f32 v12, v68, v68
  v_fmac_f32 v12, v69, v69
  v_fmac_f32 v12, v70, v70
  v_fmac_f32 v12, v71, v71
  v_fmac_f32 v12, v72, v72
  v_fmac_f32 v12, v73, v73
  v_fmac_f32 v12, v74, v74
  v_fmac_f32 v12, v75, v75
  v_fmac_f32 v12, v76, v76
  v_fmac_f32 v12, v77, v77
  v_fmac_f32 v12, v78, v78
  v_fmac_f32 v12, v79, v79
  s_nop 1
  v_add_f32_dpp v12, v12, v12 row_ror:8 row_mask:0xf bank_mask:0xf
  v_mov_b32 v13, v12
  s_nop 1
  v_permlane16_swap_b32 v12, v13
  v_add_f32 v12, v12, v13
  v_mov_b32 v13, v12
  s_nop 1
  v_permlane32_swap_b32 v12, v13
  v_add_f32 v12, v12, v13
  v_lshlrev_b32 v14, 2, v5
  v_add_u32 v14, 131328, v14
  s_lshl_b32 s30, s21, 5
  v_add_u32 v15, s30, v14
  ds_write_b32 v15, v12
  s_waitcnt lgkmcnt(0)
  s_barrier
  ds_read_b32 v48, v14
  ds_read_b32 v49, v14 offset:32
  ds_read_b32 v50, v14 offset:64
  ds_read_b32 v51, v14 offset:96
  s_waitcnt lgkmcnt(0)
  v_add_f32 v48, v48, v49
  v_add_f32 v50, v50, v51
  v_add_f32 v48, v48, v50
  v_mov_b32 v49, 0x3727c5ac
  v_fmac_f32 v49, 0x3acccccd, v48
  v_rsq_f32 v49, v49
  s_nop 0
  v_mul_f32 v56, v56, v49
  v_mul_f32 v57, v57, v49
  v_mul_f32 v58, v58, v49
  v_mul_f32 v59, v59, v49
  v_mul_f32 v60, v60, v49
  v_mul_f32 v61, v61, v49
  v_mul_f32 v62, v62, v49
  v_mul_f32 v63, v63, v49
  v_mul_f32 v64, v64, v49
  v_mul_f32 v65, v65, v49
  v_mul_f32 v66, v66, v49
  v_mul_f32 v67, v67, v49
  v_mul_f32 v68, v68, v49
  v_mul_f32 v69, v69, v49
  v_mul_f32 v70, v70, v49
  v_mul_f32 v71, v71, v49
  v_mul_f32 v72, v72, v49
  v_mul_f32 v73, v73, v49
  v_mul_f32 v74, v74, v49
  v_mul_f32 v75, v75, v49
  v_mul_f32 v76, v76, v49
  v_mul_f32 v77, v77, v49
  v_mul_f32 v78, v78, v49
  v_mul_f32 v79, v79, v49
  v_cvt_pk_bf16_f32 v80, v56, v57
  v_cvt_pk_bf16_f32 v81, v58, v59
  v_cvt_pk_bf16_f32 v82, v60, v61
  v_cvt_pk_bf16_f32 v83, v62, v63
  v_cvt_pk_bf16_f32 v84, v64, v65
  v_cvt_pk_bf16_f32 v85, v66, v67
  v_cvt_pk_bf16_f32 v86, v68, v69
  v_cvt_pk_bf16_f32 v87, v70, v71
  v_cvt_pk_bf16_f32 v88, v72, v73
  v_cvt_pk_bf16_f32 v89, v74, v75
  v_cvt_pk_bf16_f32 v90, v76, v77
  v_cvt_pk_bf16_f32 v91, v78, v79
  s_mul_i32 s30, s26, 40960
  s_lshl_b32 s31, s21, 12
  s_add_u32 s30, s30, s31
  s_add_u32 s30, s30, 0x100000
  s_add_u32 s31, s30, 0
  buffer_store_dwordx4 v[80:83], v10, s[8:11], s31 offen sc1
  s_add_u32 s31, s30, 16384
  buffer_store_dwordx4 v[84:87], v10, s[8:11], s31 offen sc1
  s_cmp_lt_u32 s21, 2
  s_cbranch_scc0 g3_90
  s_add_u32 s31, s30, 32768
  buffer_store_dwordx4 v[88:91], v10, s[8:11], s31 offen sc1
g3_90:
  s_waitcnt vmcnt(0)
  s_barrier
  s_cmp_eq_u32 s21, 0
  s_cbranch_scc0 arr_91
  s_mov_b64 s[24:25], exec
  s_mov_b64 exec, 1
  v_mov_b32 v3, 0
  v_mov_b32 v4, 1
  buffer_atomic_add v4, v3, s[8:11], s46 offen
  s_mov_b64 exec, s[24:25]
arr_91:
  s_mov_b32 s45, 0
  v_mov_b32 v3, 0
aw_92:
  buffer_load_dword v4, v3, s[8:11], s46 offen sc1
  s_add_u32 s45, s45, 1
  s_waitcnt vmcnt(0)
  v_readfirstlane_b32 s29, v4
  s_cmp_ge_u32 s29, 32
  s_cbranch_scc1 aw_92_ok
  s_cmp_lt_u32 s45, 400000
  s_cbranch_scc1 aw_92
  s_branch kb2_abort
aw_92_ok:
  s_barrier
  s_lshl_b32 s26, s23, 3
  s_lshl_b32 s27, s21, 1
  s_add_u32 s24, s26, s27
  s_mul_i32 s27, s24, 40960
  s_add_u32 s27, s27, 0x100000
  s_add_u32 s28, s27, 40960
  v_mov_b32 v3, v2
  v_add_u32 v4, 65536, v2
  v_lshlrev_b32 v5, 7, v1
  s_add_u32 s29, s27, 0
  buffer_load_dword v6, v5, s[8:11], s29 offen sc1
  s_add_u32 s29, s27, 8192
  buffer_load_dword v6, v5, s[8:11], s29 offen sc1
  s_add_u32 s29, s27, 16384
  buffer_load_dword v6, v5, s[8:11], s29 offen sc1
  s_add_u32 s29, s27, 24576
  buffer_load_dword v6, v5, s[8:11], s29 offen sc1
  s_add_u32 s29, s27, 32768
  buffer_load_dword v6, v5, s[8:11], s29 offen sc1
  s_add_u32 s29, s27, 40960
  buffer_load_dword v6, v5, s[8:11], s29 offen sc1
  s_add_u32 s29, s27, 49152
  buffer_load_dword v6, v5, s[8:11], s29 offen sc1
  s_add_u32 s29, s27, 57344
  buffer_load_dword v6, v5, s[8:11], s29 offen sc1
  s_add_u32 s29, s27, 65536
  buffer_load_dword v6, v5, s[8:11], s29 offen sc1
  s_add_u32 s29, s27, 73728
  buffer_load_dword v6, v5, s[8:11], s29 offen sc1
  s_add_u32 s29, s27, 0
  buffer_load_dwordx4 v[16:19], v2, s[8:11], s29 offen sc1
  s_add_u32 s29, s28, 0
  buffer_load_dwordx4 v[20:23], v2, s[8:11], s29 offen sc1
  s_add_u32 s29, s27, 1024
  buffer_load_dwordx4 v[24:27], v2, s[8:11], s29 offen sc1
  s_add_u32 s29, s28, 1024
  buffer_load_dwordx4 v[28:31], v2, s[8:11], s29 offen sc1
  s_add_u32 s29, s27, 2048
  buffer_load_dwordx4 v[32:35], v2, s[8:11], s29 offen sc1
  s_add_u32 s29, s28, 2048
  buffer_load_dwordx4 v[36:39], v2, s[8:11], s29 offen sc1
  s_add_u32 s29, s27, 3072
  buffer_load_dwordx4 v[40:43], v2, s[8:11], s29 offen sc1
  s_add_u32 s29, s28, 3072
  buffer_load_dwordx4 v[44:47], v2, s[8:11], s29 offen sc1
  s_add_u32 s29, s27, 4096
  buffer_load_dwordx4 v[48:51], v2, s[8:11], s29 offen sc1
  s_add_u32 s29, s28, 4096
  buffer_load_dwordx4 v[52:55], v2, s[8:11], s29 offen sc1
  s_add_u32 s29, s27, 5120
  buffer_load_dwordx4 v[56:59], v2, s[8:11], s29 offen sc1
  s_add_u32 s29, s28, 5120
  buffer_load_dwordx4 v[60:63], v2, s[8:11], s29 offen sc1
  s_add_u32 s29, s27, 6144
  buffer_load_dwordx4 v[64:67], v2, s[8:11], s29 offen sc1
  s_add_u32 s29, s28, 6144
  buffer_load_dwordx4 v[68:71], v2, s[8:11], s29 offen sc1
  ds_read_b128 v[208:211], v3 offset:0
  ds_read_b128 v[212:215], v3 offset:40960
  ds_read_b128 v[216:219], v4 offset:16384
  s_add_u32 s29, s27, 7168
  buffer_load_dwordx4 v[72:75], v2, s[8:11], s29 offen sc1
  s_add_u32 s29, s28, 7168
  buffer_load_dwordx4 v[76:79], v2, s[8:11], s29 offen sc1
  ds_read_b128 v[220:223], v3 offset:1024
  ds_read_b128 v[224:227], v3 offset:41984
  ds_read_b128 v[228:231], v4 offset:17408
  s_waitcnt lgkmcnt(3)
  s_waitcnt vmcnt(14)
  v_mfma_f32_32x32x16_bf16 v[80:95], v[208:211], v[16:19], 0
  v_mfma_f32_32x32x16_bf16 v[96:111], v[212:215], v[16:19], 0
  v_mfma_f32_32x32x16_bf16 v[112:127], v[16:19], v[216:219], 0
  v_mfma_f32_32x32x16_bf16 v[128:143], v[208:211], v[20:23], 0
  v_mfma_f32_32x32x16_bf16 v[144:159], v[212:215], v[20:23], 0
  v_mfma_f32_32x32x16_bf16 v[160:175], v[20:23], v[216:219], 0
  s_add_u32 s29, s27, 8192
  buffer_load_dwordx4 v[16:19], v2, s[8:11], s29 offen sc1
  s_add_u32 s29, s28, 8192
  buffer_load_dwordx4 v[20:23], v2, s[8:11], s29 offen sc1
  ds_read_b128 v[208:211], v3 offset:2048
  ds_read_b128 v[212:215], v3 offset:43008
  ds_read_b128 v[216:219], v4 offset:18432
  s_waitcnt lgkmcnt(3)
  s_waitcnt vmcnt(14)
  v_mfma_f32_32x32x16_bf16 v[80:95], v[220:223], v[24:27], v[80:95]
  v_mfma_f32_32x32x16_bf16 v[96:111], v[224:227], v[24:27], v[96:111]
  v_mfma_f32_32x32x16_bf16 v[112:127], v[24:27], v[228:231], v[112:127]
  v_mfma_f32_32x32x16_bf16 v[128:143], v[220:223], v[28:31], v[128:143]
  v_mfma_f32_32x32x16_bf16 v[144:159], v[224:227], v[28:31], v[144:159]
  v_mfma_f32_32x32x16_bf16 v[160:175], v[28:31], v[228:231], v[160:175]
  s_add_u32 s29, s27, 9216
  buffer_load_dwordx4 v[24:27], v2, s[8:11], s29 offen sc1
  s_add_u32 s29, s28, 9216
  buffer_load_dwordx4 v[28:31], v2, s[8:11], s29 offen sc1
  ds_read_b128 v[220:223], v3 offset:3072
  ds_read_b128 v[224:227], v3 offset:44032
  ds_read_b128 v[228:231], v4 offset:19456
  s_waitcnt lgkmcnt(3)
  s_waitcnt vmcnt(14)
  v_mfma_f32_32x32x16_bf16 v[80:95], v[208:211], v[32:35], v[80:95]
  v_mfma_f32_32x32x16_bf16 v[96:111], v[212:215], v[32:35], v[96:111]
  v_mfma_f32_32x32x16_bf16 v[112:127], v[32:35], v[216:219], v[112:127]
  v_mfma_f32_32x32x16_bf16 v[128:143], v[208:211], v[36:39], v[128:143]
  v_mfma_f32_32x32x16_bf16 v[144:159], v[212:215], v[36:39], v[144:159]
  v_mfma_f32_32x32x16_bf16 v[160:175], v[36:39], v[216:219], v[160:175]
  s_add_u32 s29, s27, 10240
  buffer_load_dwordx4 v[32:35], v2, s[8:11], s29 offen sc1
  s_add_u32 s29, s28, 10240
  buffer_load_dwordx4 v[36:39], v2, s[8:11], s29 offen sc1
  ds_read_b128 v[208:211], v3 offset:4096
  ds_read_b128 v[212:215], v3 offset:45056
  ds_read_b128 v[216:219], v4 offset:20480
  s_waitcnt lgkmcnt(3)
  s_waitcnt vmcnt(14)
  v_mfma_f32_32x32x16_bf16 v[80:95], v[220:223], v[40:43], v[80:95]
  v_mfma_f32_32x32x16_bf16 v[96:111], v[224:227], v[40:43], v[96:111]
  v_mfma_f32_32x32x16_bf16 v[112:127], v[40:43], v[228:231], v[112:127]
  v_mfma_f32_32x32x16_bf16 v[128:143], v[220:223], v[44:47], v[128:143]
  v_mfma_f32_32x32x16_bf16 v[144:159], v[224:227], v[44:47], v[144:159]
  v_mfma_f32_32x32x16_bf16 v[160:175], v[44:47], v[228:231], v[160:175]
  s_add_u32 s29, s27, 11264
  buffer_load_dwordx4 v[40:43], v2, s[8:11], s29 offen sc1
  s_add_u32 s29, s28, 11264
  buffer_load_dwordx4 v[44:47], v2, s[8:11], s29 offen sc1
  ds_read_b128 v[220:223], v3 offset:5120
  ds_read_b128 v[224:227], v3 offset:46080
  ds_read_b128 v[228:231], v4 offset:21504
  s_waitcnt lgkmcnt(3)
  s_waitcnt vmcnt(14)
  v_mfma_f32_32x32x16_bf16 v[80:95], v[208:211], v[48:51], v[80:95]
  v_mfma_f32_32x32x16_bf16 v[96:111], v[212:215], v[48:51], v[96:111]
  v_mfma_f32_32x32x16_bf16 v[112:127], v[48:51], v[216:219], v[112:127]
  v_mfma_f32_32x32x16_bf16 v[128:143], v[208:211], v[52:55], v[128:143]
  v_mfma_f32_32x32x16_bf16 v[144:159], v[212:215], v[52:55], v[144:159]
  v_mfma_f32_32x32x16_bf16 v[160:175], v[52:55], v[216:219], v[160:175]
  s_add_u32 s29, s27, 12288
  buffer_load_dwordx4 v[48:51], v2, s[8:11], s29 offen sc1
  s_add_u32 s29, s28, 12288
  buffer_load_dwordx4 v[52:55], v2, s[8:11], s29 offen sc1
  ds_read_b128 v[208:211], v3 offset:6144
  ds_read_b128 v[212:215], v3 offset:47104
  ds_read_b128 v[216:219], v4 offset:22528
  s_waitcnt lgkmcnt(3)
  s_waitcnt vmcnt(14)
  v_mfma_f32_32x32x16_bf16 v[80:95], v[220:223], v[56:59], v[80:95]
  v_mfma_f32_32x32x16_bf16 v[96:111], v[224:227], v[56:59], v[96:111]
  v_mfma_f32_32x32x16_bf16 v[112:127], v[56:59], v[228:231], v[112:127]
  v_mfma_f32_32x32x16_bf16 v[128:143], v[220:223], v[60:63], v[128:143]
  v_mfma_f32_32x32x16_bf16 v[144:159], v[224:227], v[60:63], v[144:159]
  v_mfma_f32_32x32x16_bf16 v[160:175], v[60:63], v[228:231], v[160:175]
  s_add_u32 s29, s27, 13312
  buffer_load_dwordx4 v[56:59], v2, s[8:11], s29 offen sc1
  s_add_u32 s29, s28, 13312
  buffer_load_dwordx4 v[60:63], v2, s[8:11], s29 offen sc1
  ds_read_b128 v[220:223], v3 offset:7168
  ds_read_b128 v[224:227], v3 offset:48128
  ds_read_b128 v[228:231], v4 offset:23552
  s_waitcnt lgkmcnt(3)
  s_waitcnt vmcnt(14)
  v_mfma_f32_32x32x16_bf16 v[80:95], v[208:211], v[64:67], v[80:95]
  v_mfma_f32_32x32x16_bf16 v[96:111], v[212:215], v[64:67], v[96:111]
  v_mfma_f32_32x32x16_bf16 v[112:127], v[64:67], v[216:219], v[112:127]
  v_mfma_f32_32x32x16_bf16 v[128:143], v[208:211], v[68:71], v[128:143]
  v_mfma_f32_32x32x16_bf16 v[144:159], v[212:215], v[68:71], v[144:159]
  v_mfma_f32_32x32x16_bf16 v[160:175], v[68:71], v[216:219], v[160:175]
  s_add_u32 s29, s27, 14336
  buffer_load_dwordx4 v[64:67], v2, s[8:11], s29 offen sc1
  s_add_u32 s29, s28, 14336
  buffer_load_dwordx4 v[68:71], v2, s[8:11], s29 offen sc1
  ds_read_b128 v[208:211], v3 offset:8192
  ds_read_b128 v[212:215], v3 offset:49152
  ds_read_b128 v[216:219], v4 offset:24576
  s_waitcnt lgkmcnt(3)
  s_waitcnt vmcnt(14)
  v_mfma_f32_32x32x16_bf16 v[80:95], v[220:223], v[72:75], v[80:95]
  v_mfma_f32_32x32x16_bf16 v[96:111], v[224:227], v[72:75], v[96:111]
  v_mfma_f32_32x32x16_bf16 v[112:127], v[72:75], v[228:231], v[112:127]
  v_mfma_f32_32x32x16_bf16 v[128:143], v[220:223], v[76:79], v[128:143]
  v_mfma_f32_32x32x16_bf16 v[144:159], v[224:227], v[76:79], v[144:159]
  v_mfma_f32_32x32x16_bf16 v[160:175], v[76:79], v[228:231], v[160:175]
  s_add_u32 s29, s27, 15360
  buffer_load_dwordx4 v[72:75], v2, s[8:11], s29 offen sc1
  s_add_u32 s29, s28, 15360
  buffer_load_dwordx4 v[76:79], v2, s[8:11], s29 offen sc1
  ds_read_b128 v[220:223], v3 offset:9216
  ds_read_b128 v[224:227], v3 offset:50176
  ds_read_b128 v[228:231], v4 offset:25600
  s_waitcnt lgkmcnt(3)
  s_waitcnt vmcnt(14)
  v_mfma_f32_32x32x16_bf16 v[80:95], v[208:211], v[16:19], v[80:95]
  v_mfma_f32_32x32x16_bf16 v[96:111], v[212:215], v[16:19], v[96:111]
  v_mfma_f32_32x32x16_bf16 v[112:127], v[16:19], v[216:219], v[112:127]
  v_mfma_f32_32x32x16_bf16 v[128:143], v[208:211], v[20:23], v[128:143]
  v_mfma_f32_32x32x16_bf16 v[144:159], v[212:215], v[20:23], v[144:159]
  v_mfma_f32_32x32x16_bf16 v[160:175], v[20:23], v[216:219], v[160:175]
  s_add_u32 s29, s27, 16384
  buffer_load_dwordx4 v[16:19], v2, s[8:11], s29 offen sc1
  s_add_u32 s29, s28, 16384
  buffer_load_dwordx4 v[20:23], v2, s[8:11], s29 offen sc1
  ds_read_b128 v[208:211], v3 offset:10240
  ds_read_b128 v[212:215], v3 offset:51200
  ds_read_b128 v[216:219], v4 offset:26624
  s_waitcnt lgkmcnt(3)
  s_waitcnt vmcnt(14)
  v_mfma_f32_32x32x16_bf16 v[80:95], v[220:223], v[24:27], v[80:95]
  v_mfma_f32_32x32x16_bf16 v[96:111], v[224:227], v[24:27], v[96:111]
  v_mfma_f32_32x32x16_bf16 v[112:127], v[24:27], v[228:231], v[112:127]
  v_mfma_f32_32x32x16_bf16 v[128:143], v[220:223], v[28:31], v[128:143]
  v_mfma_f32_32x32x16_bf16 v[144:159], v[224:227], v[28:31], v[144:159]
  v_mfma_f32_32x32x16_bf16 v[160:175], v[28:31], v[228:231], v[160:175]
  s_add_u32 s29, s27, 17408
  buffer_load_dwordx4 v[24:27], v2, s[8:11], s29 offen sc1
  s_add_u32 s29, s28, 17408
  buffer_load_dwordx4 v[28:31], v2, s[8:11], s29 offen sc1
  ds_read_b128 v[220:223], v3 offset:11264
  ds_read_b128 v[224:227], v3 offset:52224
  ds_read_b128 v[228:231], v4 offset:27648
  s_waitcnt lgkmcnt(3)
  s_waitcnt vmcnt(14)
  v_mfma_f32_32x32x16_bf16 v[80:95], v[208:211], v[32:35], v[80:95]
  v_mfma_f32_32x32x16_bf16 v[96:111], v[212:215], v[32:35], v[96:111]
  v_mfma_f32_32x32x16_bf16 v[112:127], v[32:35], v[216:219], v[112:127]
  v_mfma_f32_32x32x16_bf16 v[128:143], v[208:211], v[36:39], v[128:143]
  v_mfma_f32_32x32x16_bf16 v[144:159], v[212:215], v[36:39], v[144:159]
  v_mfma_f32_32x32x16_bf16 v[160:175], v[36:39], v[216:219], v[160:175]
  s_add_u32 s29, s27, 18432
  buffer_load_dwordx4 v[32:35], v2, s[8:11], s29 offen sc1
  s_add_u32 s29, s28, 18432
  buffer_load_dwordx4 v[36:39], v2, s[8:11], s29 offen sc1
  ds_read_b128 v[208:211], v3 offset:12288
  ds_read_b128 v[212:215], v3 offset:53248
  ds_read_b128 v[216:219], v4 offset:28672
  s_waitcnt lgkmcnt(3)
  s_waitcnt vmcnt(14)
  v_mfma_f32_32x32x16_bf16 v[80:95], v[220:223], v[40:43], v[80:95]
  v_mfma_f32_32x32x16_bf16 v[96:111], v[224:227], v[40:43], v[96:111]
  v_mfma_f32_32x32x16_bf16 v[112:127], v[40:43], v[228:231], v[112:127]
  v_mfma_f32_32x32x16_bf16 v[128:143], v[220:223], v[44:47], v[128:143]
  v_mfma_f32_32x32x16_bf16 v[144:159], v[224:227], v[44:47], v[144:159]
  v_mfma_f32_32x32x16_bf16 v[160:175], v[44:47], v[228:231], v[160:175]
  s_add_u32 s29, s27, 19456
  buffer_load_dwordx4 v[40:43], v2, s[8:11], s29 offen sc1
  s_add_u32 s29, s28, 19456
  buffer_load_dwordx4 v[44:47], v2, s[8:11], s29 offen sc1
  ds_read_b128 v[220:223], v3 offset:13312
  ds_read_b128 v[224:227], v3 offset:54272
  ds_read_b128 v[228:231], v4 offset:29696
  s_waitcnt lgkmcnt(3)
  s_waitcnt vmcnt(14)
  v_mfma_f32_32x32x16_bf16 v[80:95], v[208:211], v[48:51], v[80:95]
  v_mfma_f32_32x32x16_bf16 v[96:111], v[212:215], v[48:51], v[96:111]
  v_mfma_f32_32x32x16_bf16 v[112:127], v[48:51], v[216:219], v[112:127]
  v_mfma_f32_32x32x16_bf16 v[128:143], v[208:211], v[52:55], v[128:143]
  v_mfma_f32_32x32x16_bf16 v[144:159], v[212:215], v[52:55], v[144:159]
  v_mfma_f32_32x32x16_bf16 v[160:175], v[52:55], v[216:219], v[160:175]
  s_add_u32 s29, s27, 20480
  buffer_load_dwordx4 v[48:51], v2, s[8:11], s29 offen sc1
  s_add_u32 s29, s28, 20480
  buffer_load_dwordx4 v[52:55], v2, s[8:11], s29 offen sc1
  ds_read_b128 v[208:211], v3 offset:14336
  ds_read_b128 v[212:215], v3 offset:55296
  ds_read_b128 v[216:219], v4 offset:30720
  s_waitcnt lgkmcnt(3)
  s_waitcnt vmcnt(14)
  v_mfma_f32_32x32x16_bf16 v[80:95], v[220:223], v[56:59], v[80:95]
  v_mfma_f32_32x32x16_bf16 v[96:111], v[224:227], v[56:59], v[96:111]
  v_mfma_f32_32x32x16_bf16 v[112:127], v[56:59], v[228:231], v[112:127]
  v_mfma_f32_32x32x16_bf16 v[128:143], v[220:223], v[60:63], v[128:143]
  v_mfma_f32_32x32x16_bf16 v[144:159], v[224:227], v[60:63], v[144:159]
  v_mfma_f32_32x32x16_bf16 v[160:175], v[60:63], v[228:231], v[160:175]
  s_add_u32 s29, s27, 21504
  buffer_load_dwordx4 v[56:59], v2, s[8:11], s29 offen sc1
  s_add_u32 s29, s28, 21504
  buffer_load_dwordx4 v[60:63], v2, s[8:11], s29 offen sc1
  ds_read_b128 v[220:223], v3 offset:15360
  ds_read_b128 v[224:227], v3 offset:56320
  ds_read_b128 v[228:231], v4 offset:31744
  s_waitcnt lgkmcnt(3)
  s_waitcnt vmcnt(14)
  v_mfma_f32_32x32x16_bf16 v[80:95], v[208:211], v[64:67], v[80:95]
  v_mfma_f32_32x32x16_bf16 v[96:111], v[212:215], v[64:67], v[96:111]
  v_mfma_f32_32x32x16_bf16 v[112:127], v[64:67], v[216:219], v[112:127]
  v_mfma_f32_32x32x16_bf16 v[128:143], v[208:211], v[68:71], v[128:143]
  v_mfma_f32_32x32x16_bf16 v[144:159], v[212:215], v[68:71], v[144:159]
  v_mfma_f32_32x32x16_bf16 v[160:175], v[68:71], v[216:219], v[160:175]
  s_add_u32 s29, s27, 22528
  buffer_load_dwordx4 v[64:67], v2, s[8:11], s29 offen sc1
  s_add_u32 s29, s28, 22528
  buffer_load_dwordx4 v[68:71], v2, s[8:11], s29 offen sc1
  ds_read_b128 v[208:211], v3 offset:16384
  ds_read_b128 v[212:215], v3 offset:57344
  ds_read_b128 v[216:219], v4 offset:32768
  s_waitcnt lgkmcnt(3)
  s_waitcnt vmcnt(14)
  v_mfma_f32_32x32x16_bf16 v[80:95], v[220:223], v[72:75], v[80:95]
  v_mfma_f32_32x32x16_bf16 v[96:111], v[224:227], v[72:75], v[96:111]
  v_mfma_f32_32x32x16_bf16 v[112:127], v[72:75], v[228:231], v[112:127]
  v_mfma_f32_32x32x16_bf16 v[128:143], v[220:223], v[76:79], v[128:143]
  v_mfma_f32_32x32x16_bf16 v[144:159], v[224:227], v[76:79], v[144:159]
  v_mfma_f32_32x32x16_bf16 v[160:175], v[76:79], v[228:231], v[160:175]
  s_add_u32 s29, s27, 23552
  buffer_load_dwordx4 v[72:75], v2, s[8:11], s29 offen sc1
  s_add_u32 s29, s28, 23552
  buffer_load_dwordx4 v[76:79], v2, s[8:11], s29 offen sc1
  ds_read_b128 v[220:223], v3 offset:17408
  ds_read_b128 v[224:227], v3 offset:58368
  ds_read_b128 v[228:231], v4 offset:33792
  s_waitcnt lgkmcnt(3)
  s_waitcnt vmcnt(14)
  v_mfma_f32_32x32x16_bf16 v[80:95], v[208:211], v[16:19], v[80:95]
  v_mfma_f32_32x32x16_bf16 v[96:111], v[212:215], v[16:19], v[96:111]
  v_mfma_f32_32x32x16_bf16 v[112:127], v[16:19], v[216:219], v[112:127]
  v_mfma_f32_32x32x16_bf16 v[128:143], v[208:211], v[20:23], v[128:143]
  v_mfma_f32_32x32x16_bf16 v[144:159], v[212:215], v[20:23], v[144:159]
  v_mfma_f32_32x32x16_bf16 v[160:175], v[20:23], v[216:219], v[160:175]
  s_add_u32 s29, s27, 24576
  buffer_load_dwordx4 v[16:19], v2, s[8:11], s29 offen sc1
  s_add_u32 s29, s28, 24576
  buffer_load_dwordx4 v[20:23], v2, s[8:11], s29 offen sc1
  ds_read_b128 v[208:211], v3 offset:18432
  ds_read_b128 v[212:215], v3 offset:59392
  ds_read_b128 v[216:219], v4 offset:34816
  s_waitcnt lgkmcnt(3)
  s_waitcnt vmcnt(14)
  v_mfma_f32_32x32x16_bf16 v[80:95], v[220:223], v[24:27], v[80:95]
  v_mfma_f32_32x32x16_bf16 v[96:111], v[224:227], v[24:27], v[96:111]
  v_mfma_f32_32x32x16_bf16 v[112:127], v[24:27], v[228:231], v[112:127]
  v_mfma_f32_32x32x16_bf16 v[128:143], v[220:223], v[28:31], v[128:143]
  v_mfma_f32_32x32x16_bf16 v[144:159], v[224:227], v[28:31], v[144:159]
  v_mfma_f32_32x32x16_bf16 v[160:175], v[28:31], v[228:231], v[160:175]
  s_add_u32 s29, s27, 25600
  buffer_load_dwordx4 v[24:27], v2, s[8:11], s29 offen sc1
  s_add_u32 s29, s28, 25600
  buffer_load_dwordx4 v[28:31], v2, s[8:11], s29 offen sc1
  ds_read_b128 v[220:223], v3 offset:19456
  ds_read_b128 v[224:227], v3 offset:60416
  ds_read_b128 v[228:231], v4 offset:35840
  s_waitcnt lgkmcnt(3)
  s_waitcnt vmcnt(14)
  v_mfma_f32_32x32x16_bf16 v[80:95], v[208:211], v[32:35], v[80:95]
  v_mfma_f32_32x32x16_bf16 v[96:111], v[212:215], v[32:35], v[96:111]
  v_mfma_f32_32x32x16_bf16 v[112:127], v[32:35], v[216:219], v[112:127]
  v_mfma_f32_32x32x16_bf16 v[128:143], v[208:211], v[36:39], v[128:143]
  v_mfma_f32_32x32x16_bf16 v[144:159], v[212:215], v[36:39], v[144:159]
  v_mfma_f32_32x32x16_bf16 v[160:175], v[36:39], v[216:219], v[160:175]
  s_add_u32 s29, s27, 26624
  buffer_load_dwordx4 v[32:35], v2, s[8:11], s29 offen sc1
  s_add_u32 s29, s28, 26624
  buffer_load_dwordx4 v[36:39], v2, s[8:11], s29 offen sc1
  ds_read_b128 v[208:211], v3 offset:20480
  ds_read_b128 v[212:215], v3 offset:61440
  ds_read_b128 v[216:219], v4 offset:36864
  s_waitcnt lgkmcnt(3)
  s_waitcnt vmcnt(14)
  v_mfma_f32_32x32x16_bf16 v[80:95], v[220:223], v[40:43], v[80:95]
  v_mfma_f32_32x32x16_bf16 v[96:111], v[224:227], v[40:43], v[96:111]
  v_mfma_f32_32x32x16_bf16 v[112:127], v[40:43], v[228:231], v[112:127]
  v_mfma_f32_32x32x16_bf16 v[128:143], v[220:223], v[44:47], v[128:143]
  v_mfma_f32_32x32x16_bf16 v[144:159], v[224:227], v[44:47], v[144:159]
  v_mfma_f32_32x32x16_bf16 v[160:175], v[44:47], v[228:231], v[160:175]
  s_add_u32 s29, s27, 27648
  buffer_load_dwordx4 v[40:43], v2, s[8:11], s29 offen sc1
  s_add_u32 s29, s28, 27648
  buffer_load_dwordx4 v[44:47], v2, s[8:11], s29 offen sc1
  ds_read_b128 v[220:223], v3 offset:21504
  ds_read_b128 v[224:227], v3 offset:62464
  ds_read_b128 v[228:231], v4 offset:37888
  s_waitcnt lgkmcnt(3)
  s_waitcnt vmcnt(14)
  v_mfma_f32_32x32x16_bf16 v[80:95], v[208:211], v[48:51], v[80:95]
  v_mfma_f32_32x32x16_bf16 v[96:111], v[212:215], v[48:51], v[96:111]
  v_mfma_f32_32x32x16_bf16 v[112:127], v[48:51], v[216:219], v[112:127]
  v_mfma_f32_32x32x16_bf16 v[128:143], v[208:211], v[52:55], v[128:143]
  v_mfma_f32_32x32x16_bf16 v[144:159], v[212:215], v[52:55], v[144:159]
  v_mfma_f32_32x32x16_bf16 v[160:175], v[52:55], v[216:219], v[160:175]
  s_add_u32 s29, s27, 28672
  buffer_load_dwordx4 v[48:51], v2, s[8:11], s29 offen sc1
  s_add_u32 s29, s28, 28672
  buffer_load_dwordx4 v[52:55], v2, s[8:11], s29 offen sc1
  ds_read_b128 v[208:211], v3 offset:22528
  ds_read_b128 v[212:215], v3 offset:63488
  ds_read_b128 v[216:219], v4 offset:38912
  s_waitcnt lgkmcnt(3)
  s_waitcnt vmcnt(14)
  v_mfma_f32_32x32x16_bf16 v[80:95], v[220:223], v[56:59], v[80:95]
  v_mfma_f32_32x32x16_bf16 v[96:111], v[224:227], v[56:59], v[96:111]
  v_mfma_f32_32x32x16_bf16 v[112:127], v[56:59], v[228:231], v[112:127]
  v_mfma_f32_32x32x16_bf16 v[128:143], v[220:223], v[60:63], v[128:143]
  v_mfma_f32_32x32x16_bf16 v[144:159], v[224:227], v[60:63], v[144:159]
  v_mfma_f32_32x32x16_bf16 v[160:175], v[60:63], v[228:231], v[160:175]
  s_add_u32 s29, s27, 29696
  buffer_load_dwordx4 v[56:59], v2, s[8:11], s29 offen sc1
  s_add_u32 s29, s28, 29696
  buffer_load_dwordx4 v[60:63], v2, s[8:11], s29 offen sc1
  ds_read_b128 v[220:223], v3 offset:23552
  ds_read_b128 v[224:227], v3 offset:64512
  ds_read_b128 v[228:231], v4 offset:39936
  s_waitcnt lgkmcnt(3)
  s_waitcnt vmcnt(14)
  v_mfma_f32_32x32x16_bf16 v[80:95], v[208:211], v[64:67], v[80:95]
  v_mfma_f32_32x32x16_bf16 v[96:111], v[212:215], v[64:67], v[96:111]
  v_mfma_f32_32x32x16_bf16 v[112:127], v[64:67], v[216:219], v[112:127]
  v_mfma_f32_32x32x16_bf16 v[128:143], v[208:211], v[68:71], v[128:143]
  v_mfma_f32_32x32x16_bf16 v[144:159], v[212:215], v[68:71], v[144:159]
  v_mfma_f32_32x32x16_bf16 v[160:175], v[68:71], v[216:219], v[160:175]
  s_add_u32 s29, s27, 30720
  buffer_load_dwordx4 v[64:67], v2, s[8:11], s29 offen sc1
  s_add_u32 s29, s28, 30720
  buffer_load_dwordx4 v[68:71], v2, s[8:11], s29 offen sc1
  ds_read_b128 v[208:211], v3 offset:24576
  ds_read_b128 v[212:215], v4 offset:0
  ds_read_b128 v[216:219], v4 offset:40960
  s_waitcnt lgkmcnt(3)
  s_waitcnt vmcnt(14)
  v_mfma_f32_32x32x16_bf16 v[80:95], v[220:223], v[72:75], v[80:95]
  v_mfma_f32_32x32x16_bf16 v[96:111], v[224:227], v[72:75], v[96:111]
  v_mfma_f32_32x32x16_bf16 v[112:127], v[72:75], v[228:231], v[112:127]
  v_mfma_f32_32x32x16_bf16 v[128:143], v[220:223], v[76:79], v[128:143]
  v_mfma_f32_32x32x16_bf16 v[144:159], v[224:227], v[76:79], v[144:159]
  v_mfma_f32_32x32x16_bf16 v[160:175], v[76:79], v[228:231], v[160:175]
  s_add_u32 s29, s27, 31744
  buffer_load_dwordx4 v[72:75], v2, s[8:11], s29 offen sc1
  s_add_u32 s29, s28, 31744
  buffer_load_dwordx4 v[76:79], v2, s[8:11], s29 offen sc1
  ds_read_b128 v[220:223], v3 offset:25600
  ds_read_b128 v[224:227], v4 offset:1024
  ds_read_b128 v[228:231], v4 offset:41984
  s_waitcnt lgkmcnt(3)
  s_waitcnt vmcnt(14)
  v_mfma_f32_32x32x16_bf16 v[80:95], v[208:211], v[16:19], v[80:95]
  v_mfma_f32_32x32x16_bf16 v[96:111], v[212:215], v[16:19], v[96:111]
  v_mfma_f32_32x32x16_bf16 v[112:127], v[16:19], v[216:219], v[112:127]
  v_mfma_f32_32x32x16_bf16 v[128:143], v[208:211], v[20:23], v[128:143]
  v_mfma_f32_32x32x16_bf16 v[144:159], v[212:215], v[20:23], v[144:159]
  v_mfma_f32_32x32x16_bf16 v[160:175], v[20:23], v[216:219], v[160:175]
  s_add_u32 s29, s27, 32768
  buffer_load_dwordx4 v[16:19], v2, s[8:11], s29 offen sc1
  s_add_u32 s29, s28, 32768
  buffer_load_dwordx4 v[20:23], v2, s[8:11], s29 offen sc1
  ds_read_b128 v[208:211], v3 offset:26624
  ds_read_b128 v[212:215], v4 offset:2048
  ds_read_b128 v[216:219], v4 offset:43008
  s_waitcnt lgkmcnt(3)
  s_waitcnt vmcnt(14)
  v_mfma_f32_32x32x16_bf16 v[80:95], v[220:223], v[24:27], v[80:95]
  v_mfma_f32_32x32x16_bf16 v[96:111], v[224:227], v[24:27], v[96:111]
  v_mfma_f32_32x32x16_bf16 v[112:127], v[24:27], v[228:231], v[112:127]
  v_mfma_f32_32x32x16_bf16 v[128:143], v[220:223], v[28:31], v[128:143]
  v_mfma_f32_32x32x16_bf16 v[144:159], v[224:227], v[28:31], v[144:159]
  v_mfma_f32_32x32x16_bf16 v[160:175], v[28:31], v[228:231], v[160:175]
  s_add_u32 s29, s27, 33792
  buffer_load_dwordx4 v[24:27], v2, s[8:11], s29 offen sc1
  s_add_u32 s29, s28, 33792
  buffer_load_dwordx4 v[28:31], v2, s[8:11], s29 offen sc1
  ds_read_b128 v[220:223], v3 offset:27648
  ds_read_b128 v[224:227], v4 offset:3072
  ds_read_b128 v[228:231], v4 offset:44032
  s_waitcnt lgkmcnt(3)
  s_waitcnt vmcnt(14)
  v_mfma_f32_32x32x16_bf16 v[80:95], v[208:211], v[32:35], v[80:95]
  v_mfma_f32_32x32x16_bf16 v[96:111], v[212:215], v[32:35], v[96:111]
  v_mfma_f32_32x32x16_bf16 v[112:127], v[32:35], v[216:219], v[112:127]
  v_mfma_f32_32x32x16_bf16 v[128:143], v[208:211], v[36:39], v[128:143]
  v_mfma_f32_32x32x16_bf16 v[144:159], v[212:215], v[36:39], v[144:159]
  v_mfma_f32_32x32x16_bf16 v[160:175], v[36:39], v[216:219], v[160:175]
  s_add_u32 s29, s27, 34816
  buffer_load_dwordx4 v[32:35], v2, s[8:11], s29 offen sc1
  s_add_u32 s29, s28, 34816
  buffer_load_dwordx4 v[36:39], v2, s[8:11], s29 offen sc1
  ds_read_b128 v[208:211], v3 offset:28672
  ds_read_b128 v[212:215], v4 offset:4096
  ds_read_b128 v[216:219], v4 offset:45056
  s_waitcnt lgkmcnt(3)
  s_waitcnt vmcnt(14)
  v_mfma_f32_32x32x16_bf16 v[80:95], v[220:223], v[40:43], v[80:95]
  v_mfma_f32_32x32x16_bf16 v[96:111], v[224:227], v[40:43], v[96:111]
  v_mfma_f32_32x32x16_bf16 v[112:127], v[40:43], v[228:231], v[112:127]
  v_mfma_f32_32x32x16_bf16 v[128:143], v[220:223], v[44:47], v[128:143]
  v_mfma_f32_32x32x16_bf16 v[144:159], v[224:227], v[44:47], v[144:159]
  v_mfma_f32_32x32x16_bf16 v[160:175], v[44:47], v[228:231], v[160:175]
  s_add_u32 s29, s27, 35840
  buffer_load_dwordx4 v[40:43], v2, s[8:11], s29 offen sc1
  s_add_u32 s29, s28, 35840
  buffer_load_dwordx4 v[44:47], v2, s[8:11], s29 offen sc1
  ds_read_b128 v[220:223], v3 offset:29696
  ds_read_b128 v[224:227], v4 offset:5120
  ds_read_b128 v[228:231], v4 offset:46080
  s_waitcnt lgkmcnt(3)
  s_waitcnt vmcnt(14)
  v_mfma_f32_32x32x16_bf16 v[80:95], v[208:211], v[48:51], v[80:95]
  v_mfma_f32_32x32x16_bf16 v[96:111], v[212:215], v[48:51], v[96:111]
  v_mfma_f32_32x32x16_bf16 v[112:127], v[48:51], v[216:219], v[112:127]
  v_mfma_f32_32x32x16_bf16 v[128:143], v[208:211], v[52:55], v[128:143]
  v_mfma_f32_32x32x16_bf16 v[144:159], v[212:215], v[52:55], v[144:159]
  v_mfma_f32_32x32x16_bf16 v[160:175], v[52:55], v[216:219], v[160:175]
  s_add_u32 s29, s27, 36864
  buffer_load_dwordx4 v[48:51], v2, s[8:11], s29 offen sc1
  s_add_u32 s29, s28, 36864
  buffer_load_dwordx4 v[52:55], v2, s[8:11], s29 offen sc1
  ds_read_b128 v[208:211], v3 offset:30720
  ds_read_b128 v[212:215], v4 offset:6144
  ds_read_b128 v[216:219], v4 offset:47104
  s_waitcnt lgkmcnt(3)
  s_waitcnt vmcnt(14)
  v_mfma_f32_32x32x16_bf16 v[80:95], v[220:223], v[56:59], v[80:95]
  v_mfma_f32_32x32x16_bf16 v[96:111], v[224:227], v[56:59], v[96:111]
  v_mfma_f32_32x32x16_bf16 v[112:127], v[56:59], v[228:231], v[112:127]
  v_mfma_f32_32x32x16_bf16 v[128:143], v[220:223], v[60:63], v[128:143]
  v_mfma_f32_32x32x16_bf16 v[144:159], v[224:227], v[60:63], v[144:159]
  v_mfma_f32_32x32x16_bf16 v[160:175], v[60:63], v[228:231], v[160:175]
  s_add_u32 s29, s27, 37888
  buffer_load_dwordx4 v[56:59], v2, s[8:11], s29 offen sc1
  s_add_u32 s29, s28, 37888
  buffer_load_dwordx4 v[60:63], v2, s[8:11], s29 offen sc1
  ds_read_b128 v[220:223], v3 offset:31744
  ds_read_b128 v[224:227], v4 offset:7168
  ds_read_b128 v[228:231], v4 offset:48128
  s_waitcnt lgkmcnt(3)
  s_waitcnt vmcnt(14)
  v_mfma_f32_32x32x16_bf16 v[80:95], v[208:211], v[64:67], v[80:95]
  v_mfma_f32_32x32x16_bf16 v[96:111], v[212:215], v[64:67], v[96:111]
  v_mfma_f32_32x32x16_bf16 v[112:127], v[64:67], v[216:219], v[112:127]
  v_mfma_f32_32x32x16_bf16 v[128:143], v[208:211], v[68:71], v[128:143]
  v_mfma_f32_32x32x16_bf16 v[144:159], v[212:215], v[68:71], v[144:159]
  v_mfma_f32_32x32x16_bf16 v[160:175], v[68:71], v[216:219], v[160:175]
  s_add_u32 s29, s27, 38912
  buffer_load_dwordx4 v[64:67], v2, s[8:11], s29 offen sc1
  s_add_u32 s29, s28, 38912
  buffer_load_dwordx4 v[68:71], v2, s[8:11], s29 offen sc1
  ds_read_b128 v[208:211], v3 offset:32768
  ds_read_b128 v[212:215], v4 offset:8192
  ds_read_b128 v[216:219], v4 offset:49152
  s_waitcnt lgkmcnt(3)
  s_waitcnt vmcnt(14)
  v_mfma_f32_32x32x16_bf16 v[80:95], v[220:223], v[72:75], v[80:95]
  v_mfma_f32_32x32x16_bf16 v[96:111], v[224:227], v[72:75], v[96:111]
  v_mfma_f32_32x32x16_bf16 v[112:127], v[72:75], v[228:231], v[112:127]
  v_mfma_f32_32x32x16_bf16 v[128:143], v[220:223], v[76:79], v[128:143]
  v_mfma_f32_32x32x16_bf16 v[144:159], v[224:227], v[76:79], v[144:159]
  v_mfma_f32_32x32x16_bf16 v[160:175], v[76:79], v[228:231], v[160:175]
  s_add_u32 s29, s27, 39936
  buffer_load_dwordx4 v[72:75], v2, s[8:11], s29 offen sc1
  s_add_u32 s29, s28, 39936
  buffer_load_dwordx4 v[76:79], v2, s[8:11], s29 offen sc1
  ds_read_b128 v[220:223], v3 offset:33792
  ds_read_b128 v[224:227], v4 offset:9216
  ds_read_b128 v[228:231], v4 offset:50176
  s_waitcnt lgkmcnt(3)
  s_waitcnt vmcnt(14)
  v_mfma_f32_32x32x16_bf16 v[80:95], v[208:211], v[16:19], v[80:95]
  v_mfma_f32_32x32x16_bf16 v[96:111], v[212:215], v[16:19], v[96:111]
  v_mfma_f32_32x32x16_bf16 v[112:127], v[16:19], v[216:219], v[112:127]
  v_mfma_f32_32x32x16_bf16 v[128:143], v[208:211], v[20:23], v[128:143]
  v_mfma_f32_32x32x16_bf16 v[144:159], v[212:215], v[20:23], v[144:159]
  v_mfma_f32_32x32x16_bf16 v[160:175], v[20:23], v[216:219], v[160:175]
  ds_read_b128 v[208:211], v3 offset:34816
  ds_read_b128 v[212:215], v4 offset:10240
  ds_read_b128 v[216:219], v4 offset:51200
  s_waitcnt lgkmcnt(3)
  s_waitcnt vmcnt(12)
  v_mfma_f32_32x32x16_bf16 v[80:95], v[220:223], v[24:27], v[80:95]
  v_mfma_f32_32x32x16_bf16 v[96:111], v[224:227], v[24:27], v[96:111]
  v_mfma_f32_32x32x16_bf16 v[112:127], v[24:27], v[228:231], v[112:127]
  v_mfma_f32_32x32x16_bf16 v[128:143], v[220:223], v[28:31], v[128:143]
  v_mfma_f32_32x32x16_bf16 v[144:159], v[224:227], v[28:31], v[144:159]
  v_mfma_f32_32x32x16_bf16 v[160:175], v[28:31], v[228:231], v[160:175]
  ds_read_b128 v[220:223], v3 offset:35840
  ds_read_b128 v[224:227], v4 offset:11264
  ds_read_b128 v[228:231], v4 offset:52224
  s_waitcnt lgkmcnt(3)
  s_waitcnt vmcnt(10)
  v_mfma_f32_32x32x16_bf16 v[80:95], v[208:211], v[32:35], v[80:95]
  v_mfma_f32_32x32x16_bf16 v[96:111], v[212:215], v[32:35], v[96:111]
  v_mfma_f32_32x32x16_bf16 v[112:127], v[32:35], v[216:219], v[112:127]
  v_mfma_f32_32x32x16_bf16 v[128:143], v[208:211], v[36:39], v[128:143]
  v_mfma_f32_32x32x16_bf16 v[144:159], v[212:215], v[36:39], v[144:159]
  v_mfma_f32_32x32x16_bf16 v[160:175], v[36:39], v[216:219], v[160:175]
  ds_read_b128 v[208:211], v3 offset:36864
  ds_read_b128 v[212:215], v4 offset:12288
  ds_read_b128 v[216:219], v4 offset:53248
  s_waitcnt lgkmcnt(3)
  s_waitcnt vmcnt(8)
  v_mfma_f32_32x32x16_bf16 v[80:95], v[220:223], v[40:43], v[80:95]
  v_mfma_f32_32x32x16_bf16 v[96:111], v[224:227], v[40:43], v[96:111]
  v_mfma_f32_32x32x16_bf16 v[112:127], v[40:43], v[228:231], v[112:127]
  v_mfma_f32_32x32x16_bf16 v[128:143], v[220:223], v[44:47], v[128:143]
  v_mfma_f32_32x32x16_bf16 v[144:159], v[224:227], v[44:47], v[144:159]
  v_mfma_f32_32x32x16_bf16 v[160:175], v[44:47], v[228:231], v[160:175]
  ds_read_b128 v[220:223], v3 offset:37888
  ds_read_b128 v[224:227], v4 offset:13312
  ds_read_b128 v[228:231], v4 offset:54272
  s_waitcnt lgkmcnt(3)
  s_waitcnt vmcnt(6)
  v_mfma_f32_32x32x16_bf16 v[80:95], v[208:211], v[48:51], v[80:95]
  v_mfma_f32_32x32x16_bf16 v[96:111], v[212:215], v[48:51], v[96:111]
  v_mfma_f32_32x32x16_bf16 v[112:127], v[48:51], v[216:219], v[112:127]
  v_mfma_f32_32x32x16_bf16 v[128:143], v[208:211], v[52:55], v[128:143]
  v_mfma_f32_32x32x16_bf16 v[144:159], v[212:215], v[52:55], v[144:159]
  v_mfma_f32_32x32x16_bf16 v[160:175], v[52:55], v[216:219], v[160:175]
  ds_read_b128 v[208:211], v3 offset:38912
  ds_read_b128 v[212:215], v4 offset:14336
  ds_read_b128 v[216:219], v4 offset:55296
  s_waitcnt lgkmcnt(3)
  s_waitcnt vmcnt(4)
  v_mfma_f32_32x32x16_bf16 v[80:95], v[220:223], v[56:59], v[80:95]
  v_mfma_f32_32x32x16_bf16 v[96:111], v[224:227], v[56:59], v[96:111]
  v_mfma_f32_32x32x16_bf16 v[112:127], v[56:59], v[228:231], v[112:127]
  v_mfma_f32_32x32x16_bf16 v[128:143], v[220:223], v[60:63], v[128:143]
  v_mfma_f32_32x32x16_bf16 v[144:159], v[224:227], v[60:63], v[144:159]
  v_mfma_f32_32x32x16_bf16 v[160:175], v[60:63], v[228:231], v[160:175]
  ds_read_b128 v[220:223], v3 offset:39936
  ds_read_b128 v[224:227], v4 offset:15360
  ds_read_b128 v[228:231], v4 offset:56320
  s_waitcnt lgkmcnt(3)
  s_waitcnt vmcnt(2)
  v_mfma_f32_32x32x16_bf16 v[80:95], v[208:211], v[64:67], v[80:95]
  v_mfma_f32_32x32x16_bf16 v[96:111], v[212:215], v[64:67], v[96:111]
  v_mfma_f32_32x32x16_bf16 v[112:127], v[64:67], v[216:219], v[112:127]
  v_mfma_f32_32x32x16_bf16 v[128:143], v[208:211], v[68:71], v[128:143]
  v_mfma_f32_32x32x16_bf16 v[144:159], v[212:215], v[68:71], v[144:159]
  v_mfma_f32_32x32x16_bf16 v[160:175], v[68:71], v[216:219], v[160:175]
  s_waitcnt lgkmcnt(0)
  s_waitcnt vmcnt(0)
  v_mfma_f32_32x32x16_bf16 v[80:95], v[220:223], v[72:75], v[80:95]
  v_mfma_f32_32x32x16_bf16 v[96:111], v[224:227], v[72:75], v[96:111]
  v_mfma_f32_32x32x16_bf16 v[112:127], v[72:75], v[228:231], v[112:127]
  v_mfma_f32_32x32x16_bf16 v[128:143], v[220:223], v[76:79], v[128:143]
  v_mfma_f32_32x32x16_bf16 v[144:159], v[224:227], v[76:79], v[144:159]
  v_mfma_f32_32x32x16_bf16 v[160:175], v[76:79], v[228:231], v[160:175]
  s_nop 11
  s_mov_b32 s30, 0x3ea52b5c
  v_mov_b32 v5, 0
  v_cmp_gt_u32 s[34:35], 32, v1
  v_mov_b32 v6, 1.0
  v_and_b32 v7, 31, v1
  v_cndmask_b32 v6, v5, v6, s[34:35]
  v_cmp_eq_u32 s[32:33], 20, v7
  v_mov_b32 v8, 1.0
  s_lshl_b32 s31, s22, 6
  s_add_u32 s31, s31, s24
  s_lshl_b32 s31, s31, 11
  v_mov_b32 v9, 0
  v_max3_f32 v9, v9, abs(v96), abs(v97)
  v_max3_f32 v9, v9, abs(v98), abs(v99)
  v_max3_f32 v9, v9, abs(v100), abs(v101)
  v_max3_f32 v9, v9, abs(v102), abs(v103)
  v_max3_f32 v9, v9, abs(v104), abs(v105)
  v_max3_f32 v9, v9, abs(v106), abs(v107)
  v_max3_f32 v9, v9, abs(v108), abs(v109)
  v_max3_f32 v9, v9, abs(v110), abs(v111)
  v_add_f32 v108, v108, v6
  v_cndmask_b32 v112, v112, v8, s[32:33]
  v_cndmask_b32 v113, v113, v8, s[32:33]
  v_cndmask_b32 v114, v114, v8, s[32:33]
  v_cndmask_b32 v115, v115, v8, s[32:33]
  v_cndmask_b32 v116, v116, v8, s[32:33]
  v_cndmask_b32 v117, v117, v8, s[32:33]
  v_cndmask_b32 v118, v118, v8, s[32:33]
  v_cndmask_b32 v119, v119, v8, s[32:33]
  v_cndmask_b32 v120, v120, v8, s[32:33]
  v_cndmask_b32 v121, v121, v8, s[32:33]
  v_cndmask_b32 v122, v122, v8, s[32:33]
  v_cndmask_b32 v123, v123, v8, s[32:33]
  v_cndmask_b32 v124, v124, v8, s[32:33]
  v_cndmask_b32 v125, v125, v8, s[32:33]
  v_cndmask_b32 v126, v126, v8, s[32:33]
  v_cndmask_b32 v127, v127, v8, s[32:33]
  v_cvt_pk_bf16_f32 v16, v96, v97
  v_cvt_pk_bf16_f32 v17, v98, v99
  v_cvt_pk_bf16_f32 v18, v100, v101
  v_cvt_pk_bf16_f32 v19, v102, v103
  v_cvt_pk_bf16_f32 v20, v104, v105
  v_cvt_pk_bf16_f32 v21, v106, v107
  v_cvt_pk_bf16_f32 v22, v108, v109
  v_cvt_pk_bf16_f32 v23, v110, v111
  s_add_u32 s29, s31, 245366784
  buffer_store_dwordx4 v[16:19], v2, s[8:11], s29 offen sc1
  buffer_store_dwordx4 v[20:23], v2, s[8:11], s29 offen offset:1024 sc1
  v_cvt_pk_bf16_f32 v24, v112, v113
  v_cvt_pk_bf16_f32 v25, v114, v115
  v_cvt_pk_bf16_f32 v26, v116, v117
  v_cvt_pk_bf16_f32 v27, v118, v119
  v_cvt_pk_bf16_f32 v28, v120, v121
  v_cvt_pk_bf16_f32 v29, v122, v123
  v_cvt_pk_bf16_f32 v30, v124, v125
  v_cvt_pk_bf16_f32 v31, v126, v127
  s_add_u32 s29, s31, 249561088
  buffer_store_dwordx4 v[24:27], v2, s[8:11], s29 offen sc1
  buffer_store_dwordx4 v[28:31], v2, s[8:11], s29 offen offset:1024 sc1
  v_mul_f32 v80, s30, v80
  v_mul_f32 v81, s30, v81
  v_mul_f32 v82, s30, v82
  v_mul_f32 v83, s30, v83
  v_mul_f32 v84, s30, v84
  v_mul_f32 v85, s30, v85
  v_mul_f32 v86, s30, v86
  v_mul_f32 v87, s30, v87
  v_mul_f32 v88, s30, v88
  v_mul_f32 v89, s30, v89
  v_mul_f32 v90, s30, v90
  v_mul_f32 v91, s30, v91
  v_mul_f32 v92, s30, v92
  v_mul_f32 v93, s30, v93
  v_mul_f32 v94, s30, v94
  v_mul_f32 v95, s30, v95
  v_cvt_pk_bf16_f32 v192, v80, v81
  v_cvt_pk_bf16_f32 v193, v82, v83
  v_cvt_pk_bf16_f32 v194, v84, v85
  v_cvt_pk_bf16_f32 v195, v86, v87
  v_cvt_pk_bf16_f32 v196, v88, v89
  v_cvt_pk_bf16_f32 v197, v90, v91
  v_cvt_pk_bf16_f32 v198, v92, v93
  v_cvt_pk_bf16_f32 v199, v94, v95
  v_max3_f32 v9, v9, abs(v144), abs(v145)
  v_max3_f32 v9, v9, abs(v146), abs(v147)
  v_max3_f32 v9, v9, abs(v148), abs(v149)
  v_max3_f32 v9, v9, abs(v150), abs(v151)
  v_max3_f32 v9, v9, abs(v152), abs(v153)
  v_max3_f32 v9, v9, abs(v154), abs(v155)
  v_max3_f32 v9, v9, abs(v156), abs(v157)
  v_max3_f32 v9, v9, abs(v158), abs(v159)
  v_add_f32 v156, v156, v6
  v_cndmask_b32 v160, v160, v8, s[32:33]
  v_cndmask_b32 v161, v161, v8, s[32:33]
  v_cndmask_b32 v162, v162, v8, s[32:33]
  v_cndmask_b32 v163, v163, v8, s[32:33]
  v_cndmask_b32 v164, v164, v8, s[32:33]
  v_cndmask_b32 v165, v165, v8, s[32:33]
  v_cndmask_b32 v166, v166, v8, s[32:33]
  v_cndmask_b32 v167, v167, v8, s[32:33]
  v_cndmask_b32 v168, v168, v8, s[32:33]
  v_cndmask_b32 v169, v169, v8, s[32:33]
  v_cndmask_b32 v170, v170, v8, s[32:33]
  v_cndmask_b32 v171, v171, v8, s[32:33]
  v_cndmask_b32 v172, v172, v8, s[32:33]
  v_cndmask_b32 v173, v173, v8, s[32:33]
  v_cndmask_b32 v174, v174, v8, s[32:33]
  v_cndmask_b32 v175, v175, v8, s[32:33]
  v_cvt_pk_bf16_f32 v32, v144, v145
  v_cvt_pk_bf16_f32 v33, v146, v147
  v_cvt_pk_bf16_f32 v34, v148, v149
  v_cvt_pk_bf16_f32 v35, v150, v151
  v_cvt_pk_bf16_f32 v36, v152, v153
  v_cvt_pk_bf16_f32 v37, v154, v155
  v_cvt_pk_bf16_f32 v38, v156, v157
  v_cvt_pk_bf16_f32 v39, v158, v159
  s_add_u32 s29, s31, 245368832
  buffer_store_dwordx4 v[32:35], v2, s[8:11], s29 offen sc1
  buffer_store_dwordx4 v[36:39], v2, s[8:11], s29 offen offset:1024 sc1
  v_cvt_pk_bf16_f32 v40, v160, v161
  v_cvt_pk_bf16_f32 v41, v162, v163
  v_cvt_pk_bf16_f32 v42, v164, v165
  v_cvt_pk_bf16_f32 v43, v166, v167
  v_cvt_pk_bf16_f32 v44, v168, v169
  v_cvt_pk_bf16_f32 v45, v170, v171
  v_cvt_pk_bf16_f32 v46, v172, v173
  v_cvt_pk_bf16_f32 v47, v174, v175
  s_add_u32 s29, s31, 249563136
  buffer_store_dwordx4 v[40:43], v2, s[8:11], s29 offen sc1
  buffer_store_dwordx4 v[44:47], v2, s[8:11], s29 offen offset:1024 sc1
  v_mul_f32 v128, s30, v128
  v_mul_f32 v129, s30, v129
  v_mul_f32 v130, s30, v130
  v_mul_f32 v131, s30, v131
  v_mul_f32 v132, s30, v132
  v_mul_f32 v133, s30, v133
  v_mul_f32 v134, s30, v134
  v_mul_f32 v135, s30, v135
  v_mul_f32 v136, s30, v136
  v_mul_f32 v137, s30, v137
  v_mul_f32 v138, s30, v138
  v_mul_f32 v139, s30, v139
  v_mul_f32 v140, s30, v140
  v_mul_f32 v141, s30, v141
  v_mul_f32 v142, s30, v142
  v_mul_f32 v143, s30, v143
  v_cvt_pk_bf16_f32 v200, v128, v129
  v_cvt_pk_bf16_f32 v201, v130, v131
  v_cvt_pk_bf16_f32 v202, v132, v133
  v_cvt_pk_bf16_f32 v203, v134, v135
  v_cvt_pk_bf16_f32 v204, v136, v137
  v_cvt_pk_bf16_f32 v205, v138, v139
  v_cvt_pk_bf16_f32 v206, v140, v141
  v_cvt_pk_bf16_f32 v207, v142, v143
  s_nop 1
  v_max_f32_dpp v10, v9, v9 quad_perm:[1,0,3,2] row_mask:0xf bank_mask:0xf
  s_nop 1
  v_max_f32_dpp v9, v10, v10 quad_perm:[2,3,0,1] row_mask:0xf bank_mask:0xf
  s_nop 1
  v_max_f32_dpp v10, v9, v9 row_half_mirror row_mask:0xf bank_mask:0xf
  s_nop 1
  v_max_f32_dpp v9, v10, v10 row_mirror row_mask:0xf bank_mask:0xf
  v_mov_b32 v10, v9
  s_nop 1
  v_permlane16_swap_b32 v9, v10
  v_max_f32 v9, v9, v10
  v_mov_b32 v10, v9
  s_nop 1
  v_permlane32_swap_b32 v9, v10
  v_max_f32 v9, v9, v10
  s_lshl_b32 s51, s22, 2
  s_add_u32 s51, s51, 0xb800
  v_mov_b32 v11, 0
  s_mov_b64 s[40:41], exec
  s_mov_b64 exec, 1
  buffer_atomic_umax v9, v11, s[8:11], s51 offen
  s_mov_b64 exec, s[40:41]
  s_mov_b32 s52, s24
  s_waitcnt vmcnt(0)
  s_barrier
  s_cmp_eq_u32 s21, 0
  s_cbranch_scc0 arr_93
  s_mov_b64 s[24:25], exec
  s_mov_b64 exec, 1
  v_mov_b32 v3, 0
  v_mov_b32 v4, 1
  buffer_atomic_add v4, v3, s[8:11], s47 offen
  s_mov_b64 exec, s[24:25]
arr_93:
  s_and_b32 s26, s2, 3
  s_mul_i32 s26, s26, 10
  s_mul_i32 s27, s21, 3
  s_cmp_eq_u32 s21, 3
  s_cselect_b32 s27, 8, s27
  s_add_u32 s50, s26, s27
  s_mul_i32 s26, s50, 20480
  s_add_u32 s26, s26, 0xe000000
  s_add_u32 s27, s26, 0
  buffer_load_dwordx4 a[0:3], v2, s[8:11], s27 offen
  s_add_u32 s27, s26, 1024
  buffer_load_dwordx4 a[4:7], v2, s[8:11], s27 offen
  s_add_u32 s27, s26, 2048
  buffer_load_dwordx4 a[8:11], v2, s[8:11], s27 offen
  s_add_u32 s27, s26, 3072
  buffer_load_dwordx4 a[12:15], v2, s[8:11], s27 offen
  s_add_u32 s27, s26, 4096
  buffer_load_dwordx4 a[16:19], v2, s[8:11], s27 offen
  s_add_u32 s27, s26, 5120
  buffer_load_dwordx4 a[20:23], v2, s[8:11], s27 offen
  s_add_u32 s27, s26, 6144
  buffer_load_dwordx4 a[24:27], v2, s[8:11], s27 offen
  s_add_u32 s27, s26, 7168
  buffer_load_dwordx4 a[28:31], v2, s[8:11], s27 offen
  s_add_u32 s27, s26, 8192
  buffer_load_dwordx4 a[32:35], v2, s[8:11], s27 offen
  s_add_u32 s27, s26, 9216
  buffer_load_dwordx4 a[36:39], v2, s[8:11], s27 offen
  s_add_u32 s27, s26, 10240
  buffer_load_dwordx4 a[40:43], v2, s[8:11], s27 offen
  s_add_u32 s27, s26, 11264
  buffer_load_dwordx4 a[44:47], v2, s[8:11], s27 offen
  s_add_u32 s27, s26, 12288
  buffer_load_dwordx4 a[48:51], v2, s[8:11], s27 offen
  s_add_u32 s27, s26, 13312
  buffer_load_dwordx4 a[52:55], v2, s[8:11], s27 offen
  s_add_u32 s27, s26, 14336
  buffer_load_dwordx4 a[56:59], v2, s[8:11], s27 offen
  s_add_u32 s27, s26, 15360
  buffer_load_dwordx4 a[60:63], v2, s[8:11], s27 offen
  s_add_u32 s27, s26, 16384
  buffer_load_dwordx4 a[64:67], v2, s[8:11], s27 offen
  s_add_u32 s27, s26, 17408
  buffer_load_dwordx4 a[68:71], v2, s[8:11], s27 offen
  s_add_u32 s27, s26, 18432
  buffer_load_dwordx4 a[72:75], v2, s[8:11], s27 offen
  s_add_u32 s27, s26, 19456
  buffer_load_dwordx4 a[76:79], v2, s[8:11], s27 offen
  s_add_u32 s27, s26, 20480
  buffer_load_dwordx4 a[80:83], v2, s[8:11], s27 offen
  s_add_u32 s27, s26, 21504
  buffer_load_dwordx4 a[84:87], v2, s[8:11], s27 offen
  s_add_u32 s27, s26, 22528
  buffer_load_dwordx4 a[88:91], v2, s[8:11], s27 offen
  s_add_u32 s27, s26, 23552
  buffer_load_dwordx4 a[92:95], v2, s[8:11], s27 offen
  s_add_u32 s27, s26, 24576
  buffer_load_dwordx4 a[96:99], v2, s[8:11], s27 offen
  s_add_u32 s27, s26, 25600
  buffer_load_dwordx4 a[100:103], v2, s[8:11], s27 offen
  s_add_u32 s27, s26, 26624
  buffer_load_dwordx4 a[104:107], v2, s[8:11], s27 offen
  s_add_u32 s27, s26, 27648
  buffer_load_dwordx4 a[108:111], v2, s[8:11], s27 offen
  s_add_u32 s27, s26, 28672
  buffer_load_dwordx4 a[112:115], v2, s[8:11], s27 offen
  s_add_u32 s27, s26, 29696
  buffer_load_dwordx4 a[116:119], v2, s[8:11], s27 offen
  s_add_u32 s27, s26, 30720
  buffer_load_dwordx4 a[120:123], v2, s[8:11], s27 offen
  s_add_u32 s27, s26, 31744
  buffer_load_dwordx4 a[124:127], v2, s[8:11], s27 offen
  s_add_u32 s27, s26, 32768
  buffer_load_dwordx4 a[128:131], v2, s[8:11], s27 offen
  s_add_u32 s27, s26, 33792
  buffer_load_dwordx4 a[132:135], v2, s[8:11], s27 offen
  s_add_u32 s27, s26, 34816
  buffer_load_dwordx4 a[136:139], v2, s[8:11], s27 offen
  s_add_u32 s27, s26, 35840
  buffer_load_dwordx4 a[140:143], v2, s[8:11], s27 offen
  s_add_u32 s27, s26, 36864
  buffer_load_dwordx4 a[144:147], v2, s[8:11], s27 offen
  s_add_u32 s27, s26, 37888
  buffer_load_dwordx4 a[148:151], v2, s[8:11], s27 offen
  s_add_u32 s27, s26, 38912
  buffer_load_dwordx4 a[152:155], v2, s[8:11], s27 offen
  s_add_u32 s27, s26, 39936
  buffer_load_dwordx4 a[156:159], v2, s[8:11], s27 offen
  s_cmp_lt_u32 s21, 2
  s_cbranch_scc0 g3_94
  s_add_u32 s27, s26, 40960
  buffer_load_dwordx4 a[160:163], v2, s[8:11], s27 offen
  s_add_u32 s27, s26, 41984
  buffer_load_dwordx4 a[164:167], v2, s[8:11], s27 offen
  s_add_u32 s27, s26, 43008
  buffer_load_dwordx4 a[168:171], v2, s[8:11], s27 offen
  s_add_u32 s27, s26, 44032
  buffer_load_dwordx4 a[172:175], v2, s[8:11], s27 offen
  s_add_u32 s27, s26, 45056
  buffer_load_dwordx4 a[176:179], v2, s[8:11], s27 offen
  s_add_u32 s27, s26, 46080
  buffer_load_dwordx4 a[180:183], v2, s[8:11], s27 offen
  s_add_u32 s27, s26, 47104
  buffer_load_dwordx4 a[184:187], v2, s[8:11], s27 offen
  s_add_u32 s27, s26, 48128
  buffer_load_dwordx4 a[188:191], v2, s[8:11], s27 offen
  s_add_u32 s27, s26, 49152
  buffer_load_dwordx4 a[192:195], v2, s[8:11], s27 offen
  s_add_u32 s27, s26, 50176
  buffer_load_dwordx4 a[196:199], v2, s[8:11], s27 offen
  s_add_u32 s27, s26, 51200
  buffer_load_dwordx4 a[200:203], v2, s[8:11], s27 offen
  s_add_u32 s27, s26, 52224
  buffer_load_dwordx4 a[204:207], v2, s[8:11], s27 offen
  s_add_u32 s27, s26, 53248
  buffer_load_dwordx4 a[208:211], v2, s[8:11], s27 offen
  s_add_u32 s27, s26, 54272
  buffer_load_dwordx4 a[212:215], v2, s[8:11], s27 offen
  s_add_u32 s27, s26, 55296
  buffer_load_dwordx4 a[216:219], v2, s[8:11], s27 offen
  s_add_u32 s27, s26, 56320
  buffer_load_dwordx4 a[220:223], v2, s[8:11], s27 offen
  s_add_u32 s27, s26, 57344
  buffer_load_dwordx4 a[224:227], v2, s[8:11], s27 offen
  s_add_u32 s27, s26, 58368
  buffer_load_dwordx4 a[228:231], v2, s[8:11], s27 offen
  s_add_u32 s27, s26, 59392
  buffer_load_dwordx4 a[232:235], v2, s[8:11], s27 offen
  s_add_u32 s27, s26, 60416
  buffer_load_dwordx4 a[236:239], v2, s[8:11], s27 offen
g3_94:
  v_mov_b32 v12, 0
  v_lshlrev_b32 v6, 16, v192
  v_and_b32 v7, 0xffff0000, v192
  v_add_f32_e64 v12, v12, abs(v6)
  v_add_f32_e64 v12, v12, abs(v7)
  v_lshlrev_b32 v6, 16, v193
  v_and_b32 v7, 0xffff0000, v193
  v_add_f32_e64 v12, v12, abs(v6)
  v_add_f32_e64 v12, v12, abs(v7)
  v_lshlrev_b32 v6, 16, v194
  v_and_b32 v7, 0xffff0000, v194
  v_add_f32_e64 v12, v12, abs(v6)
  v_add_f32_e64 v12, v12, abs(v7)
  v_lshlrev_b32 v6, 16, v195
  v_and_b32 v7, 0xffff0000, v195
  v_add_f32_e64 v12, v12, abs(v6)
  v_add_f32_e64 v12, v12, abs(v7)
  v_lshlrev_b32 v6, 16, v196
  v_and_b32 v7, 0xffff0000, v196
  v_add_f32_e64 v12, v12, abs(v6)
  v_add_f32_e64 v12, v12, abs(v7)
  v_lshlrev_b32 v6, 16, v197
  v_and_b32 v7, 0xffff0000, v197
  v_add_f32_e64 v12, v12, abs(v6)
  v_add_f32_e64 v12, v12, abs(v7)
  v_lshlrev_b32 v6, 16, v198
  v_and_b32 v7, 0xffff0000, v198
  v_add_f32_e64 v12, v12, abs(v6)
  v_add_f32_e64 v12, v12, abs(v7)
  v_lshlrev_b32 v6, 16, v199
  v_and_b32 v7, 0xffff0000, v199
  v_add_f32_e64 v12, v12, abs(v6)
  v_add_f32_e64 v12, v12, abs(v7)
  v_mov_b32 v6, v12
  s_nop 1
  v_permlane32_swap_b32 v12, v6
  v_add_f32 v12, v12, v6
  v_mov_b32 v13, 0
  v_lshlrev_b32 v6, 16, v200
  v_and_b32 v7, 0xffff0000, v200
  v_add_f32_e64 v13, v13, abs(v6)
  v_add_f32_e64 v13, v13, abs(v7)
  v_lshlrev_b32 v6, 16, v201
  v_and_b32 v7, 0xffff0000, v201
  v_add_f32_e64 v13, v13, abs(v6)
  v_add_f32_e64 v13, v13, abs(v7)
  v_lshlrev_b32 v6, 16, v202
  v_and_b32 v7, 0xffff0000, v202
  v_add_f32_e64 v13, v13, abs(v6)
  v_add_f32_e64 v13, v13, abs(v7)
  v_lshlrev_b32 v6, 16, v203
  v_and_b32 v7, 0xffff0000, v203
  v_add_f32_e64 v13, v13, abs(v6)
  v_add_f32_e64 v13, v13, abs(v7)
  v_lshlrev_b32 v6, 16, v204
  v_and_b32 v7, 0xffff0000, v204
  v_add_f32_e64 v13, v13, abs(v6)
  v_add_f32_e64 v13, v13, abs(v7)
  v_lshlrev_b32 v6, 16, v205
  v_and_b32 v7, 0xffff0000, v205
  v_add_f32_e64 v13, v13, abs(v6)
  v_add_f32_e64 v13, v13, abs(v7)
  v_lshlrev_b32 v6, 16, v206
  v_and_b32 v7, 0xffff0000, v206
  v_add_f32_e64 v13, v13, abs(v6)
  v_add_f32_e64 v13, v13, abs(v7)
  v_lshlrev_b32 v6, 16, v207
  v_and_b32 v7, 0xffff0000, v207
  v_add_f32_e64 v13, v13, abs(v6)
  v_add_f32_e64 v13, v13, abs(v7)
  v_mov_b32 v6, v13
  s_nop 1
  v_permlane32_swap_b32 v13, v6
  v_add_f32 v13, v13, v6
  s_mov_b32 s45, 0
  v_mov_b32 v3, 0
aw_95:
  buffer_load_dword v4, v3, s[8:11], s47 offen sc1
  s_add_u32 s45, s45, 1
  s_waitcnt vmcnt(0)
  v_readfirstlane_b32 s29, v4
  s_cmp_ge_u32 s29, 8
  s_cbranch_scc1 aw_95_ok
  s_cmp_lt_u32 s45, 400000
  s_cbranch_scc1 aw_95
  s_branch kb2_abort
aw_95_ok:
  v_mov_b32 v3, 0
  buffer_load_dword v4, v3, s[8:11], s51 offen sc1
  s_lshl_b32 s25, s22, 6
  s_lshl_b32 s27, s25, 11
  s_add_u32 s28, s27, 0xee00000
  s_add_u32 s27, s27, 0xea00000
  s_mov_b32 s41, 0
  s_mul_i32 s53, s41, 32768
  s_lshl_b32 s31, s21, 13
  s_add_u32 s53, s53, s31
  s_add_u32 m0, s31, 0
  s_add_u32 s29, s53, s27
  s_add_u32 s29, s29, 0
  buffer_load_dwordx4 v2, s[8:11], s29 offen sc1 lds
  s_add_u32 m0, s31, 1024
  s_add_u32 s29, s53, s27
  s_add_u32 s29, s29, 1024
  buffer_load_dwordx4 v2, s[8:11], s29 offen sc1 lds
  s_add_u32 m0, s31, 2048
  s_add_u32 s29, s53, s27
  s_add_u32 s29, s29, 2048
  buffer_load_dwordx4 v2, s[8:11], s29 offen sc1 lds
  s_add_u32 m0, s31, 3072
  s_add_u32 s29, s53, s27
  s_add_u32 s29, s29, 3072
  buffer_load_dwordx4 v2, s[8:11], s29 offen sc1 lds
  s_add_u32 m0, s31, 4096
  s_add_u32 s29, s53, s27
  s_add_u32 s29, s29, 4096
  buffer_load_dwordx4 v2, s[8:11], s29 offen sc1 lds
  s_add_u32 m0, s31, 5120
  s_add_u32 s29, s53, s27
  s_add_u32 s29, s29, 5120
  buffer_load_dwordx4 v2, s[8:11], s29 offen sc1 lds
  s_add_u32 m0, s31, 6144
  s_add_u32 s29, s53, s27
  s_add_u32 s29, s29, 6144
  buffer_load_dwordx4 v2, s[8:11], s29 offen sc1 lds
  s_add_u32 m0, s31, 7168
  s_add_u32 s29, s53, s27
  s_add_u32 s29, s29, 7168
  buffer_load_dwordx4 v2, s[8:11], s29 offen sc1 lds
  s_add_u32 m0, s31, 32768
  s_add_u32 s29, s53, s28
  s_add_u32 s29, s29, 0
  buffer_load_dwordx4 v2, s[8:11], s29 offen sc1 lds
  s_add_u32 m0, s31, 33792
  s_add_u32 s29, s53, s28
  s_add_u32 s29, s29, 1024
  buffer_load_dwordx4 v2, s[8:11], s29 offen sc1 lds
  s_add_u32 m0, s31, 34816
  s_add_u32 s29, s53, s28
  s_add_u32 s29, s29, 2048
  buffer_load_dwordx4 v2, s[8:11], s29 offen sc1 lds
  s_add_u32 m0, s31, 35840
  s_add_u32 s29, s53, s28
  s_add_u32 s29, s29, 3072
  buffer_load_dwordx4 v2, s[8:11], s29 offen sc1 lds
  s_add_u32 m0, s31, 36864
  s_add_u32 s29, s53, s28
  s_add_u32 s29, s29, 4096
  buffer_load_dwordx4 v2, s[8:11], s29 offen sc1 lds
  s_add_u32 m0, s31, 37888
  s_add_u32 s29, s53, s28
  s_add_u32 s29, s29, 5120
  buffer_load_dwordx4 v2, s[8:11], s29 offen sc1 lds
  s_add_u32 m0, s31, 38912
  s_add_u32 s29, s53, s28
  s_add_u32 s29, s29, 6144
  buffer_load_dwordx4 v2, s[8:11], s29 offen sc1 lds
  s_add_u32 m0, s31, 39936
  s_add_u32 s29, s53, s28
  s_add_u32 s29, s29, 7168
  buffer_load_dwordx4 v2, s[8:11], s29 offen sc1 lds
  s_waitcnt vmcnt(16)
  v_mul_f32 v12, v12, v4
  v_mul_f32 v12, 0x3f820000, v12
  v_mul_f32 v13, v13, v4
  v_mul_f32 v13, 0x3f820000, v13
  s_mov_b32 s40, 0
kb2_main:
  v_lshrrev_b32 v5, 16, v12
  v_or_b32 v5, 0x8000, v5
  v_and_b32 v6, 0xffff0000, v198
  v_or_b32 v5, v5, v6
  v_cndmask_b32 v198, v198, v5, s[34:35]
  v_lshrrev_b32 v5, 16, v13
  v_or_b32 v5, 0x8000, v5
  v_and_b32 v6, 0xffff0000, v206
  v_or_b32 v5, v5, v6
  v_cndmask_b32 v206, v206, v5, s[34:35]
kb2_main2:
  v_mov_b32 v112, 0
  v_mov_b32 v113, 0
  v_mov_b32 v114, 0
  v_mov_b32 v115, 0
  v_mov_b32 v116, 0
  v_mov_b32 v117, 0
  v_mov_b32 v118, 0
  v_mov_b32 v119, 0
  v_mov_b32 v120, 0
  v_mov_b32 v121, 0
  v_mov_b32 v122, 0
  v_mov_b32 v123, 0
  v_mov_b32 v124, 0
  v_mov_b32 v125, 0
  v_mov_b32 v126, 0
  v_mov_b32 v127, 0
  v_mov_b32 v128, 0
  v_mov_b32 v129, 0
  v_mov_b32 v130, 0
  v_mov_b32 v131, 0
  v_mov_b32 v132, 0
  v_mov_b32 v133, 0
  v_mov_b32 v134, 0
  v_mov_b32 v135, 0
  v_mov_b32 v136, 0
  v_mov_b32 v137, 0
  v_mov_b32 v138, 0
  v_mov_b32 v139, 0
  v_mov_b32 v140, 0
  v_mov_b32 v141, 0
  v_mov_b32 v142, 0
  v_mov_b32 v143, 0
  v_mov_b32 v3, v2
  v_add_u32 v4, 65536, v2
kb2_chunk2:
  s_waitcnt vmcnt(0)
  s_barrier
  s_add_u32 s41, s41, 1
  s_min_u32 s29, s41, 3
  s_mul_i32 s53, s29, 32768
  s_lshl_b32 s31, s21, 13
  s_add_u32 s53, s53, s31
  ds_read_b128 v[32:35], v3 offset:0
  ds_read_b128 v[36:39], v3 offset:1024
  ds_read_b128 v[48:51], v3 offset:32768
  ds_read_b128 v[52:55], v3 offset:33792
  ds_read_b128 v[40:43], v3 offset:2048
  ds_read_b128 v[44:47], v3 offset:3072
  s_waitcnt lgkmcnt(4)
  v_mfma_f32_32x32x16_bf16 v[64:79], v[32:35], v[192:195], 0
  v_mfma_f32_32x32x16_bf16 v[64:79], v[36:39], v[196:199], v[64:79]
  s_nop 11
  v_exp_f32 v64, v64
  v_exp_f32 v65, v65
  v_exp_f32 v66, v66
  v_exp_f32 v67, v67
  v_cvt_pk_bf16_f32 v96, v64, v65
  v_exp_f32 v68, v68
  v_exp_f32 v69, v69
  v_cvt_pk_bf16_f32 v97, v66, v67
  v_exp_f32 v70, v70
  v_mfma_f32_32x32x16_bf16 v[80:95], v[32:35], v[200:203], 0
  v_exp_f32 v71, v71
  v_cvt_pk_bf16_f32 v98, v68, v69
  v_exp_f32 v72, v72
  v_exp_f32 v73, v73
  v_cvt_pk_bf16_f32 v99, v70, v71
  v_mfma_f32_32x32x16_bf16 v[80:95], v[36:39], v[204:207], v[80:95]
  v_exp_f32 v74, v74
  v_exp_f32 v75, v75
  ds_read_b128 v[56:59], v3 offset:34816
  v_cvt_pk_bf16_f32 v100, v72, v73
  v_exp_f32 v76, v76
  v_exp_f32 v77, v77
  ds_read_b128 v[60:63], v3 offset:35840
  v_cvt_pk_bf16_f32 v101, v74, v75
  v_exp_f32 v78, v78
  s_add_u32 m0, s31, 65536
  s_add_u32 s29, s53, s27
  s_add_u32 s29, s29, 0
  buffer_load_dwordx4 v2, s[8:11], s29 offen sc1 lds
  v_exp_f32 v79, v79
  v_cvt_pk_bf16_f32 v102, v76, v77
  v_cvt_pk_bf16_f32 v103, v78, v79
  s_waitcnt lgkmcnt(4)
  v_mfma_f32_32x32x16_bf16 v[112:127], v[48:51], v[96:99], v[112:127]
  v_exp_f32 v80, v80
  v_exp_f32 v81, v81
  v_exp_f32 v82, v82
  v_exp_f32 v83, v83
  v_mfma_f32_32x32x16_bf16 v[112:127], v[52:55], v[100:103], v[112:127]
  v_cvt_pk_bf16_f32 v104, v80, v81
  v_exp_f32 v84, v84
  v_exp_f32 v85, v85
  v_cvt_pk_bf16_f32 v105, v82, v83
  v_exp_f32 v86, v86
  s_waitcnt lgkmcnt(2)
  v_mfma_f32_32x32x16_bf16 v[64:79], v[40:43], v[192:195], 0
  v_exp_f32 v87, v87
  v_cvt_pk_bf16_f32 v106, v84, v85
  v_exp_f32 v88, v88
  v_exp_f32 v89, v89
  v_cvt_pk_bf16_f32 v107, v86, v87
  v_mfma_f32_32x32x16_bf16 v[64:79], v[44:47], v[196:199], v[64:79]
  v_exp_f32 v90, v90
  v_exp_f32 v91, v91
  ds_read_b128 v[32:35], v3 offset:4096
  v_cvt_pk_bf16_f32 v108, v88, v89
  v_exp_f32 v92, v92
  v_exp_f32 v93, v93
  ds_read_b128 v[36:39], v3 offset:5120
  v_cvt_pk_bf16_f32 v109, v90, v91
  v_exp_f32 v94, v94
  v_exp_f32 v95, v95
  v_cvt_pk_bf16_f32 v110, v92, v93
  v_cvt_pk_bf16_f32 v111, v94, v95
  v_mfma_f32_32x32x16_bf16 v[128:143], v[48:51], v[104:107], v[128:143]
  v_exp_f32 v64, v64
  v_exp_f32 v65, v65
  v_exp_f32 v66, v66
  v_exp_f32 v67, v67
  v_mfma_f32_32x32x16_bf16 v[128:143], v[52:55], v[108:111], v[128:143]
  v_cvt_pk_bf16_f32 v96, v64, v65
  v_exp_f32 v68, v68
  v_exp_f32 v69, v69
  v_cvt_pk_bf16_f32 v97, v66, v67
  v_exp_f32 v70, v70
  v_mfma_f32_32x32x16_bf16 v[80:95], v[40:43], v[200:203], 0
  v_exp_f32 v71, v71
  v_cvt_pk_bf16_f32 v98, v68, v69
  v_exp_f32 v72, v72
  v_exp_f32 v73, v73
  v_cvt_pk_bf16_f32 v99, v70, v71
  v_mfma_f32_32x32x16_bf16 v[80:95], v[44:47], v[204:207], v[80:95]
  v_exp_f32 v74, v74
  v_exp_f32 v75, v75
  ds_read_b128 v[48:51], v3 offset:36864
  v_cvt_pk_bf16_f32 v100, v72, v73
  v_exp_f32 v76, v76
  v_exp_f32 v77, v77
  ds_read_b128 v[52:55], v3 offset:37888
  v_cvt_pk_bf16_f32 v101, v74, v75
  v_exp_f32 v78, v78
  s_add_u32 m0, s31, 66560
  s_add_u32 s29, s53, s27
  s_add_u32 s29, s29, 1024
  buffer_load_dwordx4 v2, s[8:11], s29 offen sc1 lds
  v_exp_f32 v79, v79
  v_cvt_pk_bf16_f32 v102, v76, v77
  v_cvt_pk_bf16_f32 v103, v78, v79
  s_waitcnt lgkmcnt(4)
  v_mfma_f32_32x32x16_bf16 v[112:127], v[56:59], v[96:99], v[112:127]
  v_exp_f32 v80, v80
  v_exp_f32 v81, v81
  v_exp_f32 v82, v82
  v_exp_f32 v83, v83
  v_mfma_f32_32x32x16_bf16 v[112:127], v[60:63], v[100:103], v[112:127]
  v_cvt_pk_bf16_f32 v104, v80, v81
  v_exp_f32 v84, v84
  v_exp_f32 v85, v85
  v_cvt_pk_bf16_f32 v105, v82, v83
  v_exp_f32 v86, v86
  s_waitcnt lgkmcnt(2)
  v_mfma_f32_32x32x16_bf16 v[64:79], v[32:35], v[192:195], 0
  v_exp_f32 v87, v87
  v_cvt_pk_bf16_f32 v106, v84, v85
  v_exp_f32 v88, v88
  v_exp_f32 v89, v89
  v_cvt_pk_bf16_f32 v107, v86, v87
  v_mfma_f32_32x32x16_bf16 v[64:79], v[36:39], v[196:199], v[64:79]
  v_exp_f32 v90, v90
  v_exp_f32 v91, v91
  ds_read_b128 v[40:43], v3 offset:6144
  v_cvt_pk_bf16_f32 v108, v88, v89
  v_exp_f32 v92, v92
  v_exp_f32 v93, v93
  ds_read_b128 v[44:47], v3 offset:7168
  v_cvt_pk_bf16_f32 v109, v90, v91
  v_exp_f32 v94, v94
  v_exp_f32 v95, v95
  v_cvt_pk_bf16_f32 v110, v92, v93
  v_cvt_pk_bf16_f32 v111, v94, v95
  v_mfma_f32_32x32x16_bf16 v[128:143], v[56:59], v[104:107], v[128:143]
  v_exp_f32 v64, v64
  v_exp_f32 v65, v65
  v_exp_f32 v66, v66
  v_exp_f32 v67, v67
  v_mfma_f32_32x32x16_bf16 v[128:143], v[60:63], v[108:111], v[128:143]
  v_cvt_pk_bf16_f32 v96, v64, v65
  v_exp_f32 v68, v68
  v_exp_f32 v69, v69
  v_cvt_pk_bf16_f32 v97, v66, v67
  v_exp_f32 v70, v70
  v_mfma_f32_32x32x16_bf16 v[80:95], v[32:35], v[200:203], 0
  v_exp_f32 v71, v71
  v_cvt_pk_bf16_f32 v98, v68, v69
  v_exp_f32 v72, v72
  v_exp_f32 v73, v73
  v_cvt_pk_bf16_f32 v99, v70, v71
  v_mfma_f32_32x32x16_bf16 v[80:95], v[36:39], v[204:207], v[80:95]
  v_exp_f32 v74, v74
  v_exp_f32 v75, v75
  ds_read_b128 v[56:59], v3 offset:38912
  v_cvt_pk_bf16_f32 v100, v72, v73
  v_exp_f32 v76, v76
  v_exp_f32 v77, v77
  ds_read_b128 v[60:63], v3 offset:39936
  v_cvt_pk_bf16_f32 v101, v74, v75
  v_exp_f32 v78, v78
  s_add_u32 m0, s31, 67584
  s_add_u32 s29, s53, s27
  s_add_u32 s29, s29, 2048
  buffer_load_dwordx4 v2, s[8:11], s29 offen sc1 lds
  v_exp_f32 v79, v79
  v_cvt_pk_bf16_f32 v102, v76, v77
  v_cvt_pk_bf16_f32 v103, v78, v79
  s_waitcnt lgkmcnt(4)
  v_mfma_f32_32x32x16_bf16 v[112:127], v[48:51], v[96:99], v[112:127]
  v_exp_f32 v80, v80
  v_exp_f32 v81, v81
  v_exp_f32 v82, v82
  v_exp_f32 v83, v83
  v_mfma_f32_32x32x16_bf16 v[112:127], v[52:55], v[100:103], v[112:127]
  v_cvt_pk_bf16_f32 v104, v80, v81
  v_exp_f32 v84, v84
  v_exp_f32 v85, v85
  v_cvt_pk_bf16_f32 v105, v82, v83
  v_exp_f32 v86, v86
  s_waitcnt lgkmcnt(2)
  v_mfma_f32_32x32x16_bf16 v[64:79], v[40:43], v[192:195], 0
  v_exp_f32 v87, v87
  v_cvt_pk_bf16_f32 v106, v84, v85
  v_exp_f32 v88, v88
  v_exp_f32 v89, v89
  v_cvt_pk_bf16_f32 v107, v86, v87
  v_mfma_f32_32x32x16_bf16 v[64:79], v[44:47], v[196:199], v[64:79]
  v_exp_f32 v90, v90
  v_exp_f32 v91, v91
  ds_read_b128 v[32:35], v3 offset:8192
  v_cvt_pk_bf16_f32 v108, v88, v89
  v_exp_f32 v92, v92
  v_exp_f32 v93, v93
  ds_read_b128 v[36:39], v3 offset:9216
  v_cvt_pk_bf16_f32 v109, v90, v91
  v_exp_f32 v94, v94
  v_exp_f32 v95, v95
  v_cvt_pk_bf16_f32 v110, v92, v93
  v_cvt_pk_bf16_f32 v111, v94, v95
  v_mfma_f32_32x32x16_bf16 v[128:143], v[48:51], v[104:107], v[128:143]
  v_exp_f32 v64, v64
  v_exp_f32 v65, v65
  v_exp_f32 v66, v66
  v_exp_f32 v67, v67
  v_mfma_f32_32x32x16_bf16 v[128:143], v[52:55], v[108:111], v[128:143]
  v_cvt_pk_bf16_f32 v96, v64, v65
  v_exp_f32 v68, v68
  v_exp_f32 v69, v69
  v_cvt_pk_bf16_f32 v97, v66, v67
  v_exp_f32 v70, v70
  v_mfma_f32_32x32x16_bf16 v[80:95], v[40:43], v[200:203], 0
  v_exp_f32 v71, v71
  v_cvt_pk_bf16_f32 v98, v68, v69
  v_exp_f32 v72, v72
  v_exp_f32 v73, v73
  v_cvt_pk_bf16_f32 v99, v70, v71
  v_mfma_f32_32x32x16_bf16 v[80:95], v[44:47], v[204:207], v[80:95]
  v_exp_f32 v74, v74
  v_exp_f32 v75, v75
  ds_read_b128 v[48:51], v3 offset:40960
  v_cvt_pk_bf16_f32 v100, v72, v73
  v_exp_f32 v76, v76
  v_exp_f32 v77, v77
  ds_read_b128 v[52:55], v3 offset:41984
  v_cvt_pk_bf16_f32 v101, v74, v75
  v_exp_f32 v78, v78
  s_add_u32 m0, s31, 68608
  s_add_u32 s29, s53, s27
  s_add_u32 s29, s29, 3072
  buffer_load_dwordx4 v2, s[8:11], s29 offen sc1 lds
  v_exp_f32 v79, v79
  v_cvt_pk_bf16_f32 v102, v76, v77
  v_cvt_pk_bf16_f32 v103, v78, v79
  s_waitcnt lgkmcnt(4)
  v_mfma_f32_32x32x16_bf16 v[112:127], v[56:59], v[96:99], v[112:127]
  v_exp_f32 v80, v80
  v_exp_f32 v81, v81
  v_exp_f32 v82, v82
  v_exp_f32 v83, v83
  v_mfma_f32_32x32x16_bf16 v[112:127], v[60:63], v[100:103], v[112:127]
  v_cvt_pk_bf16_f32 v104, v80, v81
  v_exp_f32 v84, v84
  v_exp_f32 v85, v85
  v_cvt_pk_bf16_f32 v105, v82, v83
  v_exp_f32 v86, v86
  s_waitcnt lgkmcnt(2)
  v_mfma_f32_32x32x16_bf16 v[64:79], v[32:35], v[192:195], 0
  v_exp_f32 v87, v87
  v_cvt_pk_bf16_f32 v106, v84, v85
  v_exp_f32 v88, v88
  v_exp_f32 v89, v89
  v_cvt_pk_bf16_f32 v107, v86, v87
  v_mfma_f32_32x32x16_bf16 v[64:79], v[36:39], v[196:199], v[64:79]
  v_exp_f32 v90, v90
  v_exp_f32 v91, v91
  ds_read_b128 v[40:43], v3 offset:10240
  v_cvt_pk_bf16_f32 v108, v88, v89
  v_exp_f32 v92, v92
  v_exp_f32 v93, v93
  ds_read_b128 v[44:47], v3 offset:11264
  v_cvt_pk_bf16_f32 v109, v90, v91
  v_exp_f32 v94, v94
  v_exp_f32 v95, v95
  v_cvt_pk_bf16_f32 v110, v92, v93
  v_cvt_pk_bf16_f32 v111, v94, v95
  v_mfma_f32_32x32x16_bf16 v[128:143], v[56:59], v[104:107], v[128:143]
  v_exp_f32 v64, v64
  v_exp_f32 v65, v65
  v_exp_f32 v66, v66
  v_exp_f32 v67, v67
  v_mfma_f32_32x32x16_bf16 v[128:143], v[60:63], v[108:111], v[128:143]
  v_cvt_pk_bf16_f32 v96, v64, v65
  v_exp_f32 v68, v68
  v_exp_f32 v69, v69
  v_cvt_pk_bf16_f32 v97, v66, v67
  v_exp_f32 v70, v70
  v_mfma_f32_32x32x16_bf16 v[80:95], v[32:35], v[200:203], 0
  v_exp_f32 v71, v71
  v_cvt_pk_bf16_f32 v98, v68, v69
  v_exp_f32 v72, v72
  v_exp_f32 v73, v73
  v_cvt_pk_bf16_f32 v99, v70, v71
  v_mfma_f32_32x32x16_bf16 v[80:95], v[36:39], v[204:207], v[80:95]
  v_exp_f32 v74, v74
  v_exp_f32 v75, v75
  ds_read_b128 v[56:59], v3 offset:43008
  v_cvt_pk_bf16_f32 v100, v72, v73
  v_exp_f32 v76, v76
  v_exp_f32 v77, v77
  ds_read_b128 v[60:63], v3 offset:44032
  v_cvt_pk_bf16_f32 v101, v74, v75
  v_exp_f32 v78, v78
  s_add_u32 m0, s31, 69632
  s_add_u32 s29, s53, s27
  s_add_u32 s29, s29, 4096
  buffer_load_dwordx4 v2, s[8:11], s29 offen sc1 lds
  v_exp_f32 v79, v79
  v_cvt_pk_bf16_f32 v102, v76, v77
  v_cvt_pk_bf16_f32 v103, v78, v79
  s_waitcnt lgkmcnt(4)
  v_mfma_f32_32x32x16_bf16 v[112:127], v[48:51], v[96:99], v[112:127]
  v_exp_f32 v80, v80
  v_exp_f32 v81, v81
  v_exp_f32 v82, v82
  v_exp_f32 v83, v83
  v_mfma_f32_32x32x16_bf16 v[112:127], v[52:55], v[100:103], v[112:127]
  v_cvt_pk_bf16_f32 v104, v80, v81
  v_exp_f32 v84, v84
  v_exp_f32 v85, v85
  v_cvt_pk_bf16_f32 v105, v82, v83
  v_exp_f32 v86, v86
  s_waitcnt lgkmcnt(2)
  v_mfma_f32_32x32x16_bf16 v[64:79], v[40:43], v[192:195], 0
  v_exp_f32 v87, v87
  v_cvt_pk_bf16_f32 v106, v84, v85
  v_exp_f32 v88, v88
  v_exp_f32 v89, v89
  v_cvt_pk_bf16_f32 v107, v86, v87
  v_mfma_f32_32x32x16_bf16 v[64:79], v[44:47], v[196:199], v[64:79]
  v_exp_f32 v90, v90
  v_exp_f32 v91, v91
  ds_read_b128 v[32:35], v3 offset:12288
  v_cvt_pk_bf16_f32 v108, v88, v89
  v_exp_f32 v92, v92
  v_exp_f32 v93, v93
  ds_read_b128 v[36:39], v3 offset:13312
  v_cvt_pk_bf16_f32 v109, v90, v91
  v_exp_f32 v94, v94
  v_exp_f32 v95, v95
  v_cvt_pk_bf16_f32 v110, v92, v93
  v_cvt_pk_bf16_f32 v111, v94, v95
  v_mfma_f32_32x32x16_bf16 v[128:143], v[48:51], v[104:107], v[128:143]
  v_exp_f32 v64, v64
  v_exp_f32 v65, v65
  v_exp_f32 v66, v66
  v_exp_f32 v67, v67
  v_mfma_f32_32x32x16_bf16 v[128:143], v[52:55], v[108:111], v[128:143]
  v_cvt_pk_bf16_f32 v96, v64, v65
  v_exp_f32 v68, v68
  v_exp_f32 v69, v69
  v_cvt_pk_bf16_f32 v97, v66, v67
  v_exp_f32 v70, v70
  v_mfma_f32_32x32x16_bf16 v[80:95], v[40:43], v[200:203], 0
  v_exp_f32 v71, v71
  v_cvt_pk_bf16_f32 v98, v68, v69
  v_exp_f32 v72, v72
  v_exp_f32 v73, v73
  v_cvt_pk_bf16_f32 v99, v70, v71
  v_mfma_f32_32x32x16_bf16 v[80:95], v[44:47], v[204:207], v[80:95]
  v_exp_f32 v74, v74
  v_exp_f32 v75, v75
  ds_read_b128 v[48:51], v3 offset:45056
  v_cvt_pk_bf16_f32 v100, v72, v73
  v_exp_f32 v76, v76
  v_exp_f32 v77, v77
  ds_read_b128 v[52:55], v3 offset:46080
  v_cvt_pk_bf16_f32 v101, v74, v75
  v_exp_f32 v78, v78
  s_add_u32 m0, s31, 70656
  s_add_u32 s29, s53, s27
  s_add_u32 s29, s29, 5120
  buffer_load_dwordx4 v2, s[8:11], s29 offen sc1 lds
  v_exp_f32 v79, v79
  v_cvt_pk_bf16_f32 v102, v76, v77
  v_cvt_pk_bf16_f32 v103, v78, v79
  s_waitcnt lgkmcnt(4)
  v_mfma_f32_32x32x16_bf16 v[112:127], v[56:59], v[96:99], v[112:127]
  v_exp_f32 v80, v80
  v_exp_f32 v81, v81
  v_exp_f32 v82, v82
  v_exp_f32 v83, v83
  v_mfma_f32_32x32x16_bf16 v[112:127], v[60:63], v[100:103], v[112:127]
  v_cvt_pk_bf16_f32 v104, v80, v81
  v_exp_f32 v84, v84
  v_exp_f32 v85, v85
  v_cvt_pk_bf16_f32 v105, v82, v83
  v_exp_f32 v86, v86
  s_waitcnt lgkmcnt(2)
  v_mfma_f32_32x32x16_bf16 v[64:79], v[32:35], v[192:195], 0
  v_exp_f32 v87, v87
  v_cvt_pk_bf16_f32 v106, v84, v85
  v_exp_f32 v88, v88
  v_exp_f32 v89, v89
  v_cvt_pk_bf16_f32 v107, v86, v87
  v_mfma_f32_32x32x16_bf16 v[64:79], v[36:39], v[196:199], v[64:79]
  v_exp_f32 v90, v90
  v_exp_f32 v91, v91
  ds_read_b128 v[40:43], v3 offset:14336
  v_cvt_pk_bf16_f32 v108, v88, v89
  v_exp_f32 v92, v92
  v_exp_f32 v93, v93
  ds_read_b128 v[44:47], v3 offset:15360
  v_cvt_pk_bf16_f32 v109, v90, v91
  v_exp_f32 v94, v94
  v_exp_f32 v95, v95
  v_cvt_pk_bf16_f32 v110, v92, v93
  v_cvt_pk_bf16_f32 v111, v94, v95
  v_mfma_f32_32x32x16_bf16 v[128:143], v[56:59], v[104:107], v[128:143]
  v_exp_f32 v64, v64
  v_exp_f32 v65, v65
  v_exp_f32 v66, v66
  v_exp_f32 v67, v67
  v_mfma_f32_32x32x16_bf16 v[128:143], v[60:63], v[108:111], v[128:143]
  v_cvt_pk_bf16_f32 v96, v64, v65
  v_exp_f32 v68, v68
  v_exp_f32 v69, v69
  v_cvt_pk_bf16_f32 v97, v66, v67
  v_exp_f32 v70, v70
  v_mfma_f32_32x32x16_bf16 v[80:95], v[32:35], v[200:203], 0
  v_exp_f32 v71, v71
  v_cvt_pk_bf16_f32 v98, v68, v69
  v_exp_f32 v72, v72
  v_exp_f32 v73, v73
  v_cvt_pk_bf16_f32 v99, v70, v71
  v_mfma_f32_32x32x16_bf16 v[80:95], v[36:39], v[204:207], v[80:95]
  v_exp_f32 v74, v74
  v_exp_f32 v75, v75
  ds_read_b128 v[56:59], v3 offset:47104
  v_cvt_pk_bf16_f32 v100, v72, v73
  v_exp_f32 v76, v76
  v_exp_f32 v77, v77
  ds_read_b128 v[60:63], v3 offset:48128
  v_cvt_pk_bf16_f32 v101, v74, v75
  v_exp_f32 v78, v78
  s_add_u32 m0, s31, 71680
  s_add_u32 s29, s53, s27
  s_add_u32 s29, s29, 6144
  buffer_load_dwordx4 v2, s[8:11], s29 offen sc1 lds
  v_exp_f32 v79, v79
  v_cvt_pk_bf16_f32 v102, v76, v77
  v_cvt_pk_bf16_f32 v103, v78, v79
  s_waitcnt lgkmcnt(4)
  v_mfma_f32_32x32x16_bf16 v[112:127], v[48:51], v[96:99], v[112:127]
  v_exp_f32 v80, v80
  v_exp_f32 v81, v81
  v_exp_f32 v82, v82
  v_exp_f32 v83, v83
  v_mfma_f32_32x32x16_bf16 v[112:127], v[52:55], v[100:103], v[112:127]
  v_cvt_pk_bf16_f32 v104, v80, v81
  v_exp_f32 v84, v84
  v_exp_f32 v85, v85
  v_cvt_pk_bf16_f32 v105, v82, v83
  v_exp_f32 v86, v86
  s_waitcnt lgkmcnt(2)
  v_mfma_f32_32x32x16_bf16 v[64:79], v[40:43], v[192:195], 0
  v_exp_f32 v87, v87
  v_cvt_pk_bf16_f32 v106, v84, v85
  v_exp_f32 v88, v88
  v_exp_f32 v89, v89
  v_cvt_pk_bf16_f32 v107, v86, v87
  v_mfma_f32_32x32x16_bf16 v[64:79], v[44:47], v[196:199], v[64:79]
  v_exp_f32 v90, v90
  v_exp_f32 v91, v91
  ds_read_b128 v[32:35], v3 offset:16384
  v_cvt_pk_bf16_f32 v108, v88, v89
  v_exp_f32 v92, v92
  v_exp_f32 v93, v93
  ds_read_b128 v[36:39], v3 offset:17408
  v_cvt_pk_bf16_f32 v109, v90, v91
  v_exp_f32 v94, v94
  v_exp_f32 v95, v95
  v_cvt_pk_bf16_f32 v110, v92, v93
  v_cvt_pk_bf16_f32 v111, v94, v95
  v_mfma_f32_32x32x16_bf16 v[128:143], v[48:51], v[104:107], v[128:143]
  v_exp_f32 v64, v64
  v_exp_f32 v65, v65
  v_exp_f32 v66, v66
  v_exp_f32 v67, v67
  v_mfma_f32_32x32x16_bf16 v[128:143], v[52:55], v[108:111], v[128:143]
  v_cvt_pk_bf16_f32 v96, v64, v65
  v_exp_f32 v68, v68
  v_exp_f32 v69, v69
  v_cvt_pk_bf16_f32 v97, v66, v67
  v_exp_f32 v70, v70
  v_mfma_f32_32x32x16_bf16 v[80:95], v[40:43], v[200:203], 0
  v_exp_f32 v71, v71
  v_cvt_pk_bf16_f32 v98, v68, v69
  v_exp_f32 v72, v72
  v_exp_f32 v73, v73
  v_cvt_pk_bf16_f32 v99, v70, v71
  v_mfma_f32_32x32x16_bf16 v[80:95], v[44:47], v[204:207], v[80:95]
  v_exp_f32 v74, v74
  v_exp_f32 v75, v75
  ds_read_b128 v[48:51], v3 offset:49152
  v_cvt_pk_bf16_f32 v100, v72, v73
  v_exp_f32 v76, v76
  v_exp_f32 v77, v77
  ds_read_b128 v[52:55], v3 offset:50176
  v_cvt_pk_bf16_f32 v101, v74, v75
  v_exp_f32 v78, v78
  s_add_u32 m0, s31, 72704
  s_add_u32 s29, s53, s27
  s_add_u32 s29, s29, 7168
  buffer_load_dwordx4 v2, s[8:11], s29 offen sc1 lds
  v_exp_f32 v79, v79
  v_cvt_pk_bf16_f32 v102, v76, v77
  v_cvt_pk_bf16_f32 v103, v78, v79
  s_waitcnt lgkmcnt(4)
  v_mfma_f32_32x32x16_bf16 v[112:127], v[56:59], v[96:99], v[112:127]
  v_exp_f32 v80, v80
  v_exp_f32 v81, v81
  v_exp_f32 v82, v82
  v_exp_f32 v83, v83
  v_mfma_f32_32x32x16_bf16 v[112:127], v[60:63], v[100:103], v[112:127]
  v_cvt_pk_bf16_f32 v104, v80, v81
  v_exp_f32 v84, v84
  v_exp_f32 v85, v85
  v_cvt_pk_bf16_f32 v105, v82, v83
  v_exp_f32 v86, v86
  s_waitcnt lgkmcnt(2)
  v_mfma_f32_32x32x16_bf16 v[64:79], v[32:35], v[192:195], 0
  v_exp_f32 v87, v87
  v_cvt_pk_bf16_f32 v106, v84, v85
  v_exp_f32 v88, v88
  v_exp_f32 v89, v89
  v_cvt_pk_bf16_f32 v107, v86, v87
  v_mfma_f32_32x32x16_bf16 v[64:79], v[36:39], v[196:199], v[64:79]
  v_exp_f32 v90, v90
  v_exp_f32 v91, v91
  ds_read_b128 v[40:43], v3 offset:18432
  v_cvt_pk_bf16_f32 v108, v88, v89
  v_exp_f32 v92, v92
  v_exp_f32 v93, v93
  ds_read_b128 v[44:47], v3 offset:19456
  v_cvt_pk_bf16_f32 v109, v90, v91
  v_exp_f32 v94, v94
  v_exp_f32 v95, v95
  v_cvt_pk_bf16_f32 v110, v92, v93
  v_cvt_pk_bf16_f32 v111, v94, v95
  v_mfma_f32_32x32x16_bf16 v[128:143], v[56:59], v[104:107], v[128:143]
  v_exp_f32 v64, v64
  v_exp_f32 v65, v65
  v_exp_f32 v66, v66
  v_exp_f32 v67, v67
  v_mfma_f32_32x32x16_bf16 v[128:143], v[60:63], v[108:111], v[128:143]
  v_cvt_pk_bf16_f32 v96, v64, v65
  v_exp_f32 v68, v68
  v_exp_f32 v69, v69
  v_cvt_pk_bf16_f32 v97, v66, v67
  v_exp_f32 v70, v70
  v_mfma_f32_32x32x16_bf16 v[80:95], v[32:35], v[200:203], 0
  v_exp_f32 v71, v71
  v_cvt_pk_bf16_f32 v98, v68, v69
  v_exp_f32 v72, v72
  v_exp_f32 v73, v73
  v_cvt_pk_bf16_f32 v99, v70, v71
  v_mfma_f32_32x32x16_bf16 v[80:95], v[36:39], v[204:207], v[80:95]
  v_exp_f32 v74, v74
  v_exp_f32 v75, v75
  ds_read_b128 v[56:59], v3 offset:51200
  v_cvt_pk_bf16_f32 v100, v72, v73
  v_exp_f32 v76, v76
  v_exp_f32 v77, v77
  ds_read_b128 v[60:63], v3 offset:52224
  v_cvt_pk_bf16_f32 v101, v74, v75
  v_exp_f32 v78, v78
  s_add_u32 m0, s31, 98304
  s_add_u32 s29, s53, s28
  s_add_u32 s29, s29, 0
  buffer_load_dwordx4 v2, s[8:11], s29 offen sc1 lds
  v_exp_f32 v79, v79
  v_cvt_pk_bf16_f32 v102, v76, v77
  v_cvt_pk_bf16_f32 v103, v78, v79
  s_waitcnt lgkmcnt(4)
  v_mfma_f32_32x32x16_bf16 v[112:127], v[48:51], v[96:99], v[112:127]
  v_exp_f32 v80, v80
  v_exp_f32 v81, v81
  v_exp_f32 v82, v82
  v_exp_f32 v83, v83
  v_mfma_f32_32x32x16_bf16 v[112:127], v[52:55], v[100:103], v[112:127]
  v_cvt_pk_bf16_f32 v104, v80, v81
  v_exp_f32 v84, v84
  v_exp_f32 v85, v85
  v_cvt_pk_bf16_f32 v105, v82, v83
  v_exp_f32 v86, v86
  s_waitcnt lgkmcnt(2)
  v_mfma_f32_32x32x16_bf16 v[64:79], v[40:43], v[192:195], 0
  v_exp_f32 v87, v87
  v_cvt_pk_bf16_f32 v106, v84, v85
  v_exp_f32 v88, v88
  v_exp_f32 v89, v89
  v_cvt_pk_bf16_f32 v107, v86, v87
  v_mfma_f32_32x32x16_bf16 v[64:79], v[44:47], v[196:199], v[64:79]
  v_exp_f32 v90, v90
  v_exp_f32 v91, v91
  ds_read_b128 v[32:35], v3 offset:20480
  v_cvt_pk_bf16_f32 v108, v88, v89
  v_exp_f32 v92, v92
  v_exp_f32 v93, v93
  ds_read_b128 v[36:39], v3 offset:21504
  v_cvt_pk_bf16_f32 v109, v90, v91
  v_exp_f32 v94, v94
  v_exp_f32 v95, v95
  v_cvt_pk_bf16_f32 v110, v92, v93
  v_cvt_pk_bf16_f32 v111, v94, v95
  v_mfma_f32_32x32x16_bf16 v[128:143], v[48:51], v[104:107], v[128:143]
  v_exp_f32 v64, v64
  v_exp_f32 v65, v65
  v_exp_f32 v66, v66
  v_exp_f32 v67, v67
  v_mfma_f32_32x32x16_bf16 v[128:143], v[52:55], v[108:111], v[128:143]
  v_cvt_pk_bf16_f32 v96, v64, v65
  v_exp_f32 v68, v68
  v_exp_f32 v69, v69
  v_cvt_pk_bf16_f32 v97, v66, v67
  v_exp_f32 v70, v70
  v_mfma_f32_32x32x16_bf16 v[80:95], v[40:43], v[200:203], 0
  v_exp_f32 v71, v71
  v_cvt_pk_bf16_f32 v98, v68, v69
  v_exp_f32 v72, v72
  v_exp_f32 v73, v73
  v_cvt_pk_bf16_f32 v99, v70, v71
  v_mfma_f32_32x32x16_bf16 v[80:95], v[44:47], v[204:207], v[80:95]
  v_exp_f32 v74, v74
  v_exp_f32 v75, v75
  ds_read_b128 v[48:51], v3 offset:53248
  v_cvt_pk_bf16_f32 v100, v72, v73
  v_exp_f32 v76, v76
  v_exp_f32 v77, v77
  ds_read_b128 v[52:55], v3 offset:54272
  v_cvt_pk_bf16_f32 v101, v74, v75
  v_exp_f32 v78, v78
  s_add_u32 m0, s31, 99328
  s_add_u32 s29, s53, s28
  s_add_u32 s29, s29, 1024
  buffer_load_dwordx4 v2, s[8:11], s29 offen sc1 lds
  v_exp_f32 v79, v79
  v_cvt_pk_bf16_f32 v102, v76, v77
  v_cvt_pk_bf16_f32 v103, v78, v79
  s_waitcnt lgkmcnt(4)
  v_mfma_f32_32x32x16_bf16 v[112:127], v[56:59], v[96:99], v[112:127]
  v_exp_f32 v80, v80
  v_exp_f32 v81, v81
  v_exp_f32 v82, v82
  v_exp_f32 v83, v83
  v_mfma_f32_32x32x16_bf16 v[112:127], v[60:63], v[100:103], v[112:127]
  v_cvt_pk_bf16_f32 v104, v80, v81
  v_exp_f32 v84, v84
  v_exp_f32 v85, v85
  v_cvt_pk_bf16_f32 v105, v82, v83
  v_exp_f32 v86, v86
  s_waitcnt lgkmcnt(2)
  v_mfma_f32_32x32x16_bf16 v[64:79], v[32:35], v[192:195], 0
  v_exp_f32 v87, v87
  v_cvt_pk_bf16_f32 v106, v84, v85
  v_exp_f32 v88, v88
  v_exp_f32 v89, v89
  v_cvt_pk_bf16_f32 v107, v86, v87
  v_mfma_f32_32x32x16_bf16 v[64:79], v[36:39], v[196:199], v[64:79]
  v_exp_f32 v90, v90
  v_exp_f32 v91, v91
  ds_read_b128 v[40:43], v3 offset:22528
  v_cvt_pk_bf16_f32 v108, v88, v89
  v_exp_f32 v92, v92
  v_exp_f32 v93, v93
  ds_read_b128 v[44:47], v3 offset:23552
  v_cvt_pk_bf16_f32 v109, v90, v91
  v_exp_f32 v94, v94
  v_exp_f32 v95, v95
  v_cvt_pk_bf16_f32 v110, v92, v93
  v_cvt_pk_bf16_f32 v111, v94, v95
  v_mfma_f32_32x32x16_bf16 v[128:143], v[56:59], v[104:107], v[128:143]
  v_exp_f32 v64, v64
  v_exp_f32 v65, v65
  v_exp_f32 v66, v66
  v_exp_f32 v67, v67
  v_mfma_f32_32x32x16_bf16 v[128:143], v[60:63], v[108:111], v[128:143]
  v_cvt_pk_bf16_f32 v96, v64, v65
  v_exp_f32 v68, v68
  v_exp_f32 v69, v69
  v_cvt_pk_bf16_f32 v97, v66, v67
  v_exp_f32 v70, v70
  v_mfma_f32_32x32x16_bf16 v[80:95], v[32:35], v[200:203], 0
  v_exp_f32 v71, v71
  v_cvt_pk_bf16_f32 v98, v68, v69
  v_exp_f32 v72, v72
  v_exp_f32 v73, v73
  v_cvt_pk_bf16_f32 v99, v70, v71
  v_mfma_f32_32x32x16_bf16 v[80:95], v[36:39], v[204:207], v[80:95]
  v_exp_f32 v74, v74
  v_exp_f32 v75, v75
  ds_read_b128 v[56:59], v3 offset:55296
  v_cvt_pk_bf16_f32 v100, v72, v73
  v_exp_f32 v76, v76
  v_exp_f32 v77, v77
  ds_read_b128 v[60:63], v3 offset:56320
  v_cvt_pk_bf16_f32 v101, v74, v75
  v_exp_f32 v78, v78
  s_add_u32 m0, s31, 100352
  s_add_u32 s29, s53, s28
  s_add_u32 s29, s29, 2048
  buffer_load_dwordx4 v2, s[8:11], s29 offen sc1 lds
  v_exp_f32 v79, v79
  v_cvt_pk_bf16_f32 v102, v76, v77
  v_cvt_pk_bf16_f32 v103, v78, v79
  s_waitcnt lgkmcnt(4)
  v_mfma_f32_32x32x16_bf16 v[112:127], v[48:51], v[96:99], v[112:127]
  v_exp_f32 v80, v80
  v_exp_f32 v81, v81
  v_exp_f32 v82, v82
  v_exp_f32 v83, v83
  v_mfma_f32_32x32x16_bf16 v[112:127], v[52:55], v[100:103], v[112:127]
  v_cvt_pk_bf16_f32 v104, v80, v81
  v_exp_f32 v84, v84
  v_exp_f32 v85, v85
  v_cvt_pk_bf16_f32 v105, v82, v83
  v_exp_f32 v86, v86
  s_waitcnt lgkmcnt(2)
  v_mfma_f32_32x32x16_bf16 v[64:79], v[40:43], v[192:195], 0
  v_exp_f32 v87, v87
  v_cvt_pk_bf16_f32 v106, v84, v85
  v_exp_f32 v88, v88
  v_exp_f32 v89, v89
  v_cvt_pk_bf16_f32 v107, v86, v87
  v_mfma_f32_32x32x16_bf16 v[64:79], v[44:47], v[196:199], v[64:79]
  v_exp_f32 v90, v90
  v_exp_f32 v91, v91
  ds_read_b128 v[32:35], v3 offset:24576
  v_cvt_pk_bf16_f32 v108, v88, v89
  v_exp_f32 v92, v92
  v_exp_f32 v93, v93
  ds_read_b128 v[36:39], v3 offset:25600
  v_cvt_pk_bf16_f32 v109, v90, v91
  v_exp_f32 v94, v94
  v_exp_f32 v95, v95
  v_cvt_pk_bf16_f32 v110, v92, v93
  v_cvt_pk_bf16_f32 v111, v94, v95
  v_mfma_f32_32x32x16_bf16 v[128:143], v[48:51], v[104:107], v[128:143]
  v_exp_f32 v64, v64
  v_exp_f32 v65, v65
  v_exp_f32 v66, v66
  v_exp_f32 v67, v67
  v_mfma_f32_32x32x16_bf16 v[128:143], v[52:55], v[108:111], v[128:143]
  v_cvt_pk_bf16_f32 v96, v64, v65
  v_exp_f32 v68, v68
  v_exp_f32 v69, v69
  v_cvt_pk_bf16_f32 v97, v66, v67
  v_exp_f32 v70, v70
  v_mfma_f32_32x32x16_bf16 v[80:95], v[40:43], v[200:203], 0
  v_exp_f32 v71, v71
  v_cvt_pk_bf16_f32 v98, v68, v69
  v_exp_f32 v72, v72
  v_exp_f32 v73, v73
  v_cvt_pk_bf16_f32 v99, v70, v71
  v_mfma_f32_32x32x16_bf16 v[80:95], v[44:47], v[204:207], v[80:95]
  v_exp_f32 v74, v74
  v_exp_f32 v75, v75
  ds_read_b128 v[48:51], v3 offset:57344
  v_cvt_pk_bf16_f32 v100, v72, v73
  v_exp_f32 v76, v76
  v_exp_f32 v77, v77
  ds_read_b128 v[52:55], v3 offset:58368
  v_cvt_pk_bf16_f32 v101, v74, v75
  v_exp_f32 v78, v78
  s_add_u32 m0, s31, 101376
  s_add_u32 s29, s53, s28
  s_add_u32 s29, s29, 3072
  buffer_load_dwordx4 v2, s[8:11], s29 offen sc1 lds
  v_exp_f32 v79, v79
  v_cvt_pk_bf16_f32 v102, v76, v77
  v_cvt_pk_bf16_f32 v103, v78, v79
  s_waitcnt lgkmcnt(4)
  v_mfma_f32_32x32x16_bf16 v[112:127], v[56:59], v[96:99], v[112:127]
  v_exp_f32 v80, v80
  v_exp_f32 v81, v81
  v_exp_f32 v82, v82
  v_exp_f32 v83, v83
  v_mfma_f32_32x32x16_bf16 v[112:127], v[60:63], v[100:103], v[112:127]
  v_cvt_pk_bf16_f32 v104, v80, v81
  v_exp_f32 v84, v84
  v_exp_f32 v85, v85
  v_cvt_pk_bf16_f32 v105, v82, v83
  v_exp_f32 v86, v86
  s_waitcnt lgkmcnt(2)
  v_mfma_f32_32x32x16_bf16 v[64:79], v[32:35], v[192:195], 0
  v_exp_f32 v87, v87
  v_cvt_pk_bf16_f32 v106, v84, v85
  v_exp_f32 v88, v88
  v_exp_f32 v89, v89
  v_cvt_pk_bf16_f32 v107, v86, v87
  v_mfma_f32_32x32x16_bf16 v[64:79], v[36:39], v[196:199], v[64:79]
  v_exp_f32 v90, v90
  v_exp_f32 v91, v91
  ds_read_b128 v[40:43], v3 offset:26624
  v_cvt_pk_bf16_f32 v108, v88, v89
  v_exp_f32 v92, v92
  v_exp_f32 v93, v93
  ds_read_b128 v[44:47], v3 offset:27648
  v_cvt_pk_bf16_f32 v109, v90, v91
  v_exp_f32 v94, v94
  v_exp_f32 v95, v95
  v_cvt_pk_bf16_f32 v110, v92, v93
  v_cvt_pk_bf16_f32 v111, v94, v95
  v_mfma_f32_32x32x16_bf16 v[128:143], v[56:59], v[104:107], v[128:143]
  v_exp_f32 v64, v64
  v_exp_f32 v65, v65
  v_exp_f32 v66, v66
  v_exp_f32 v67, v67
  v_mfma_f32_32x32x16_bf16 v[128:143], v[60:63], v[108:111], v[128:143]
  v_cvt_pk_bf16_f32 v96, v64, v65
  v_exp_f32 v68, v68
  v_exp_f32 v69, v69
  v_cvt_pk_bf16_f32 v97, v66, v67
  v_exp_f32 v70, v70
  v_mfma_f32_32x32x16_bf16 v[80:95], v[32:35], v[200:203], 0
  v_exp_f32 v71, v71
  v_cvt_pk_bf16_f32 v98, v68, v69
  v_exp_f32 v72, v72
  v_exp_f32 v73, v73
  v_cvt_pk_bf16_f32 v99, v70, v71
  v_mfma_f32_32x32x16_bf16 v[80:95], v[36:39], v[204:207], v[80:95]
  v_exp_f32 v74, v74
  v_exp_f32 v75, v75
  ds_read_b128 v[56:59], v3 offset:59392
  v_cvt_pk_bf16_f32 v100, v72, v73
  v_exp_f32 v76, v76
  v_exp_f32 v77, v77
  ds_read_b128 v[60:63], v3 offset:60416
  v_cvt_pk_bf16_f32 v101, v74, v75
  v_exp_f32 v78, v78
  s_add_u32 m0, s31, 102400
  s_add_u32 s29, s53, s28
  s_add_u32 s29, s29, 4096
  buffer_load_dwordx4 v2, s[8:11], s29 offen sc1 lds
  v_exp_f32 v79, v79
  v_cvt_pk_bf16_f32 v102, v76, v77
  v_cvt_pk_bf16_f32 v103, v78, v79
  s_waitcnt lgkmcnt(4)
  v_mfma_f32_32x32x16_bf16 v[112:127], v[48:51], v[96:99], v[112:127]
  v_exp_f32 v80, v80
  v_exp_f32 v81, v81
  v_exp_f32 v82, v82
  v_exp_f32 v83, v83
  v_mfma_f32_32x32x16_bf16 v[112:127], v[52:55], v[100:103], v[112:127]
  v_cvt_pk_bf16_f32 v104, v80, v81
  v_exp_f32 v84, v84
  v_exp_f32 v85, v85
  v_cvt_pk_bf16_f32 v105, v82, v83
  v_exp_f32 v86, v86
  s_waitcnt lgkmcnt(2)
  v_mfma_f32_32x32x16_bf16 v[64:79], v[40:43], v[192:195], 0
  v_exp_f32 v87, v87
  v_cvt_pk_bf16_f32 v106, v84, v85
  v_exp_f32 v88, v88
  v_exp_f32 v89, v89
  v_cvt_pk_bf16_f32 v107, v86, v87
  v_mfma_f32_32x32x16_bf16 v[64:79], v[44:47], v[196:199], v[64:79]
  v_exp_f32 v90, v90
  v_exp_f32 v91, v91
  ds_read_b128 v[32:35], v3 offset:28672
  v_cvt_pk_bf16_f32 v108, v88, v89
  v_exp_f32 v92, v92
  v_exp_f32 v93, v93
  ds_read_b128 v[36:39], v3 offset:29696
  v_cvt_pk_bf16_f32 v109, v90, v91
  v_exp_f32 v94, v94
  v_exp_f32 v95, v95
  v_cvt_pk_bf16_f32 v110, v92, v93
  v_cvt_pk_bf16_f32 v111, v94, v95
  v_mfma_f32_32x32x16_bf16 v[128:143], v[48:51], v[104:107], v[128:143]
  v_exp_f32 v64, v64
  v_exp_f32 v65, v65
  v_exp_f32 v66, v66
  v_exp_f32 v67, v67
  v_mfma_f32_32x32x16_bf16 v[128:143], v[52:55], v[108:111], v[128:143]
  v_cvt_pk_bf16_f32 v96, v64, v65
  v_exp_f32 v68, v68
  v_exp_f32 v69, v69
  v_cvt_pk_bf16_f32 v97, v66, v67
  v_exp_f32 v70, v70
  v_mfma_f32_32x32x16_bf16 v[80:95], v[40:43], v[200:203], 0
  v_exp_f32 v71, v71
  v_cvt_pk_bf16_f32 v98, v68, v69
  v_exp_f32 v72, v72
  v_exp_f32 v73, v73
  v_cvt_pk_bf16_f32 v99, v70, v71
  v_mfma_f32_32x32x16_bf16 v[80:95], v[44:47], v[204:207], v[80:95]
  v_exp_f32 v74, v74
  v_exp_f32 v75, v75
  ds_read_b128 v[48:51], v3 offset:61440
  v_cvt_pk_bf16_f32 v100, v72, v73
  v_exp_f32 v76, v76
  v_exp_f32 v77, v77
  ds_read_b128 v[52:55], v3 offset:62464
  v_cvt_pk_bf16_f32 v101, v74, v75
  v_exp_f32 v78, v78
  s_add_u32 m0, s31, 103424
  s_add_u32 s29, s53, s28
  s_add_u32 s29, s29, 5120
  buffer_load_dwordx4 v2, s[8:11], s29 offen sc1 lds
  v_exp_f32 v79, v79
  v_cvt_pk_bf16_f32 v102, v76, v77
  v_cvt_pk_bf16_f32 v103, v78, v79
  s_waitcnt lgkmcnt(4)
  v_mfma_f32_32x32x16_bf16 v[112:127], v[56:59], v[96:99], v[112:127]
  v_exp_f32 v80, v80
  v_exp_f32 v81, v81
  v_exp_f32 v82, v82
  v_exp_f32 v83, v83
  v_mfma_f32_32x32x16_bf16 v[112:127], v[60:63], v[100:103], v[112:127]
  v_cvt_pk_bf16_f32 v104, v80, v81
  v_exp_f32 v84, v84
  v_exp_f32 v85, v85
  v_cvt_pk_bf16_f32 v105, v82, v83
  v_exp_f32 v86, v86
  s_waitcnt lgkmcnt(2)
  v_mfma_f32_32x32x16_bf16 v[64:79], v[32:35], v[192:195], 0
  v_exp_f32 v87, v87
  v_cvt_pk_bf16_f32 v106, v84, v85
  v_exp_f32 v88, v88
  v_exp_f32 v89, v89
  v_cvt_pk_bf16_f32 v107, v86, v87
  v_mfma_f32_32x32x16_bf16 v[64:79], v[36:39], v[196:199], v[64:79]
  v_exp_f32 v90, v90
  v_exp_f32 v91, v91
  ds_read_b128 v[40:43], v3 offset:30720
  v_cvt_pk_bf16_f32 v108, v88, v89
  v_exp_f32 v92, v92
  v_exp_f32 v93, v93
  ds_read_b128 v[44:47], v3 offset:31744
  v_cvt_pk_bf16_f32 v109, v90, v91
  v_exp_f32 v94, v94
  v_exp_f32 v95, v95
  v_cvt_pk_bf16_f32 v110, v92, v93
  v_cvt_pk_bf16_f32 v111, v94, v95
  v_mfma_f32_32x32x16_bf16 v[128:143], v[56:59], v[104:107], v[128:143]
  v_exp_f32 v64, v64
  v_exp_f32 v65, v65
  v_exp_f32 v66, v66
  v_exp_f32 v67, v67
  v_mfma_f32_32x32x16_bf16 v[128:143], v[60:63], v[108:111], v[128:143]
  v_cvt_pk_bf16_f32 v96, v64, v65
  v_exp_f32 v68, v68
  v_exp_f32 v69, v69
  v_cvt_pk_bf16_f32 v97, v66, v67
  v_exp_f32 v70, v70
  v_mfma_f32_32x32x16_bf16 v[80:95], v[32:35], v[200:203], 0
  v_exp_f32 v71, v71
  v_cvt_pk_bf16_f32 v98, v68, v69
  v_exp_f32 v72, v72
  v_exp_f32 v73, v73
  v_cvt_pk_bf16_f32 v99, v70, v71
  v_mfma_f32_32x32x16_bf16 v[80:95], v[36:39], v[204:207], v[80:95]
  v_exp_f32 v74, v74
  v_exp_f32 v75, v75
  ds_read_b128 v[56:59], v3 offset:63488
  v_cvt_pk_bf16_f32 v100, v72, v73
  v_exp_f32 v76, v76
  v_exp_f32 v77, v77
  ds_read_b128 v[60:63], v3 offset:64512
  v_cvt_pk_bf16_f32 v101, v74, v75
  v_exp_f32 v78, v78
  s_add_u32 m0, s31, 104448
  s_add_u32 s29, s53, s28
  s_add_u32 s29, s29, 6144
  buffer_load_dwordx4 v2, s[8:11], s29 offen sc1 lds
  v_exp_f32 v79, v79
  v_cvt_pk_bf16_f32 v102, v76, v77
  v_cvt_pk_bf16_f32 v103, v78, v79
  s_waitcnt lgkmcnt(4)
  v_mfma_f32_32x32x16_bf16 v[112:127], v[48:51], v[96:99], v[112:127]
  v_exp_f32 v80, v80
  v_exp_f32 v81, v81
  v_exp_f32 v82, v82
  v_exp_f32 v83, v83
  v_mfma_f32_32x32x16_bf16 v[112:127], v[52:55], v[100:103], v[112:127]
  v_cvt_pk_bf16_f32 v104, v80, v81
  v_exp_f32 v84, v84
  v_exp_f32 v85, v85
  v_cvt_pk_bf16_f32 v105, v82, v83
  v_exp_f32 v86, v86
  s_waitcnt lgkmcnt(2)
  v_mfma_f32_32x32x16_bf16 v[64:79], v[40:43], v[192:195], 0
  v_exp_f32 v87, v87
  v_cvt_pk_bf16_f32 v106, v84, v85
  v_exp_f32 v88, v88
  v_exp_f32 v89, v89
  v_cvt_pk_bf16_f32 v107, v86, v87
  v_mfma_f32_32x32x16_bf16 v[64:79], v[44:47], v[196:199], v[64:79]
  v_exp_f32 v90, v90
  v_exp_f32 v91, v91
  v_cvt_pk_bf16_f32 v108, v88, v89
  v_exp_f32 v92, v92
  v_exp_f32 v93, v93
  v_cvt_pk_bf16_f32 v109, v90, v91
  v_exp_f32 v94, v94
  v_exp_f32 v95, v95
  v_cvt_pk_bf16_f32 v110, v92, v93
  v_cvt_pk_bf16_f32 v111, v94, v95
  v_mfma_f32_32x32x16_bf16 v[128:143], v[48:51], v[104:107], v[128:143]
  v_exp_f32 v64, v64
  v_exp_f32 v65, v65
  v_exp_f32 v66, v66
  v_exp_f32 v67, v67
  v_mfma_f32_32x32x16_bf16 v[128:143], v[52:55], v[108:111], v[128:143]
  v_cvt_pk_bf16_f32 v96, v64, v65
  v_exp_f32 v68, v68
  v_exp_f32 v69, v69
  v_cvt_pk_bf16_f32 v97, v66, v67
  v_exp_f32 v70, v70
  v_mfma_f32_32x32x16_bf16 v[80:95], v[40:43], v[200:203], 0
  v_exp_f32 v71, v71
  v_cvt_pk_bf16_f32 v98, v68, v69
  v_exp_f32 v72, v72
  v_exp_f32 v73, v73
  v_cvt_pk_bf16_f32 v99, v70, v71
  v_mfma_f32_32x32x16_bf16 v[80:95], v[44:47], v[204:207], v[80:95]
  v_exp_f32 v74, v74
  v_exp_f32 v75, v75
  v_cvt_pk_bf16_f32 v100, v72, v73
  v_exp_f32 v76, v76
  v_exp_f32 v77, v77
  v_cvt_pk_bf16_f32 v101, v74, v75
  v_exp_f32 v78, v78
  s_add_u32 m0, s31, 105472
  s_add_u32 s29, s53, s28
  s_add_u32 s29, s29, 7168
  buffer_load_dwordx4 v2, s[8:11], s29 offen sc1 lds
  v_exp_f32 v79, v79
  v_cvt_pk_bf16_f32 v102, v76, v77
  v_cvt_pk_bf16_f32 v103, v78, v79
  s_waitcnt lgkmcnt(0)
  v_mfma_f32_32x32x16_bf16 v[112:127], v[56:59], v[96:99], v[112:127]
  v_exp_f32 v80, v80
  v_exp_f32 v81, v81
  v_exp_f32 v82, v82
  v_exp_f32 v83, v83
  v_mfma_f32_32x32x16_bf16 v[112:127], v[60:63], v[100:103], v[112:127]
  v_cvt_pk_bf16_f32 v104, v80, v81
  v_exp_f32 v84, v84
  v_exp_f32 v85, v85
  v_cvt_pk_bf16_f32 v105, v82, v83
  v_exp_f32 v86, v86
  v_exp_f32 v87, v87
  v_cvt_pk_bf16_f32 v106, v84, v85
  v_exp_f32 v88, v88
  v_exp_f32 v89, v89
  v_cvt_pk_bf16_f32 v107, v86, v87
  v_exp_f32 v90, v90
  v_exp_f32 v91, v91
  v_cvt_pk_bf16_f32 v108, v88, v89
  v_exp_f32 v92, v92
  v_exp_f32 v93, v93
  v_cvt_pk_bf16_f32 v109, v90, v91
  v_exp_f32 v94, v94
  v_exp_f32 v95, v95
  v_cvt_pk_bf16_f32 v110, v92, v93
  v_cvt_pk_bf16_f32 v111, v94, v95
  s_nop 1
  v_mfma_f32_32x32x16_bf16 v[128:143], v[56:59], v[104:107], v[128:143]
  v_mfma_f32_32x32x16_bf16 v[128:143], v[60:63], v[108:111], v[128:143]
  s_waitcnt vmcnt(0)
  s_barrier
  s_add_u32 s41, s41, 1
  s_min_u32 s29, s41, 3
  s_mul_i32 s53, s29, 32768
  s_lshl_b32 s31, s21, 13
  s_add_u32 s53, s53, s31
  ds_read_b128 v[32:35], v4 offset:0
  ds_read_b128 v[36:39], v4 offset:1024
  ds_read_b128 v[48:51], v4 offset:32768
  ds_read_b128 v[52:55], v4 offset:33792
  ds_read_b128 v[40:43], v4 offset:2048
  ds_read_b128 v[44:47], v4 offset:3072
  s_waitcnt lgkmcnt(4)
  v_mfma_f32_32x32x16_bf16 v[64:79], v[32:35], v[192:195], 0
  v_mfma_f32_32x32x16_bf16 v[64:79], v[36:39], v[196:199], v[64:79]
  s_nop 11
  v_exp_f32 v64, v64
  v_exp_f32 v65, v65
  v_exp_f32 v66, v66
  v_exp_f32 v67, v67
  v_cvt_pk_bf16_f32 v96, v64, v65
  v_exp_f32 v68, v68
  v_exp_f32 v69, v69
  v_cvt_pk_bf16_f32 v97, v66, v67
  v_exp_f32 v70, v70
  v_mfma_f32_32x32x16_bf16 v[80:95], v[32:35], v[200:203], 0
  v_exp_f32 v71, v71
  v_cvt_pk_bf16_f32 v98, v68, v69
  v_exp_f32 v72, v72
  v_exp_f32 v73, v73
  v_cvt_pk_bf16_f32 v99, v70, v71
  v_mfma_f32_32x32x16_bf16 v[80:95], v[36:39], v[204:207], v[80:95]
  v_exp_f32 v74, v74
  v_exp_f32 v75, v75
  ds_read_b128 v[56:59], v4 offset:34816
  v_cvt_pk_bf16_f32 v100, v72, v73
  v_exp_f32 v76, v76
  v_exp_f32 v77, v77
  ds_read_b128 v[60:63], v4 offset:35840
  v_cvt_pk_bf16_f32 v101, v74, v75
  v_exp_f32 v78, v78
  s_add_u32 m0, s31, 0
  s_add_u32 s29, s53, s27
  s_add_u32 s29, s29, 0
  buffer_load_dwordx4 v2, s[8:11], s29 offen sc1 lds
  v_exp_f32 v79, v79
  v_cvt_pk_bf16_f32 v102, v76, v77
  v_cvt_pk_bf16_f32 v103, v78, v79
  s_waitcnt lgkmcnt(4)
  v_mfma_f32_32x32x16_bf16 v[112:127], v[48:51], v[96:99], v[112:127]
  v_exp_f32 v80, v80
  v_exp_f32 v81, v81
  v_exp_f32 v82, v82
  v_exp_f32 v83, v83
  v_mfma_f32_32x32x16_bf16 v[112:127], v[52:55], v[100:103], v[112:127]
  v_cvt_pk_bf16_f32 v104, v80, v81
  v_exp_f32 v84, v84
  v_exp_f32 v85, v85
  v_cvt_pk_bf16_f32 v105, v82, v83
  v_exp_f32 v86, v86
  s_waitcnt lgkmcnt(2)
  v_mfma_f32_32x32x16_bf16 v[64:79], v[40:43], v[192:195], 0
  v_exp_f32 v87, v87
  v_cvt_pk_bf16_f32 v106, v84, v85
  v_exp_f32 v88, v88
  v_exp_f32 v89, v89
  v_cvt_pk_bf16_f32 v107, v86, v87
  v_mfma_f32_32x32x16_bf16 v[64:79], v[44:47], v[196:199], v[64:79]
  v_exp_f32 v90, v90
  v_exp_f32 v91, v91
  ds_read_b128 v[32:35], v4 offset:4096
  v_cvt_pk_bf16_f32 v108, v88, v89
  v_exp_f32 v92, v92
  v_exp_f32 v93, v93
  ds_read_b128 v[36:39], v4 offset:5120
  v_cvt_pk_bf16_f32 v109, v90, v91
  v_exp_f32 v94, v94
  v_exp_f32 v95, v95
  v_cvt_pk_bf16_f32 v110, v92, v93
  v_cvt_pk_bf16_f32 v111, v94, v95
  v_mfma_f32_32x32x16_bf16 v[128:143], v[48:51], v[104:107], v[128:143]
  v_exp_f32 v64, v64
  v_exp_f32 v65, v65
  v_exp_f32 v66, v66
  v_exp_f32 v67, v67
  v_mfma_f32_32x32x16_bf16 v[128:143], v[52:55], v[108:111], v[128:143]
  v_cvt_pk_bf16_f32 v96, v64, v65
  v_exp_f32 v68, v68
  v_exp_f32 v69, v69
  v_cvt_pk_bf16_f32 v97, v66, v67
  v_exp_f32 v70, v70
  v_mfma_f32_32x32x16_bf16 v[80:95], v[40:43], v[200:203], 0
  v_exp_f32 v71, v71
  v_cvt_pk_bf16_f32 v98, v68, v69
  v_exp_f32 v72, v72
  v_exp_f32 v73, v73
  v_cvt_pk_bf16_f32 v99, v70, v71
  v_mfma_f32_32x32x16_bf16 v[80:95], v[44:47], v[204:207], v[80:95]
  v_exp_f32 v74, v74
  v_exp_f32 v75, v75
  ds_read_b128 v[48:51], v4 offset:36864
  v_cvt_pk_bf16_f32 v100, v72, v73
  v_exp_f32 v76, v76
  v_exp_f32 v77, v77
  ds_read_b128 v[52:55], v4 offset:37888
  v_cvt_pk_bf16_f32 v101, v74, v75
  v_exp_f32 v78, v78
  s_add_u32 m0, s31, 1024
  s_add_u32 s29, s53, s27
  s_add_u32 s29, s29, 1024
  buffer_load_dwordx4 v2, s[8:11], s29 offen sc1 lds
  v_exp_f32 v79, v79
  v_cvt_pk_bf16_f32 v102, v76, v77
  v_cvt_pk_bf16_f32 v103, v78, v79
  s_waitcnt lgkmcnt(4)
  v_mfma_f32_32x32x16_bf16 v[112:127], v[56:59], v[96:99], v[112:127]
  v_exp_f32 v80, v80
  v_exp_f32 v81, v81
  v_exp_f32 v82, v82
  v_exp_f32 v83, v83
  v_mfma_f32_32x32x16_bf16 v[112:127], v[60:63], v[100:103], v[112:127]
  v_cvt_pk_bf16_f32 v104, v80, v81
  v_exp_f32 v84, v84
  v_exp_f32 v85, v85
  v_cvt_pk_bf16_f32 v105, v82, v83
  v_exp_f32 v86, v86
  s_waitcnt lgkmcnt(2)
  v_mfma_f32_32x32x16_bf16 v[64:79], v[32:35], v[192:195], 0
  v_exp_f32 v87, v87
  v_cvt_pk_bf16_f32 v106, v84, v85
  v_exp_f32 v88, v88
  v_exp_f32 v89, v89
  v_cvt_pk_bf16_f32 v107, v86, v87
  v_mfma_f32_32x32x16_bf16 v[64:79], v[36:39], v[196:199], v[64:79]
  v_exp_f32 v90, v90
  v_exp_f32 v91, v91
  ds_read_b128 v[40:43], v4 offset:6144
  v_cvt_pk_bf16_f32 v108, v88, v89
  v_exp_f32 v92, v92
  v_exp_f32 v93, v93
  ds_read_b128 v[44:47], v4 offset:7168
  v_cvt_pk_bf16_f32 v109, v90, v91
  v_exp_f32 v94, v94
  v_exp_f32 v95, v95
  v_cvt_pk_bf16_f32 v110, v92, v93
  v_cvt_pk_bf16_f32 v111, v94, v95
  v_mfma_f32_32x32x16_bf16 v[128:143], v[56:59], v[104:107], v[128:143]
  v_exp_f32 v64, v64
  v_exp_f32 v65, v65
  v_exp_f32 v66, v66
  v_exp_f32 v67, v67
  v_mfma_f32_32x32x16_bf16 v[128:143], v[60:63], v[108:111], v[128:143]
  v_cvt_pk_bf16_f32 v96, v64, v65
  v_exp_f32 v68, v68
  v_exp_f32 v69, v69
  v_cvt_pk_bf16_f32 v97, v66, v67
  v_exp_f32 v70, v70
  v_mfma_f32_32x32x16_bf16 v[80:95], v[32:35], v[200:203], 0
  v_exp_f32 v71, v71
  v_cvt_pk_bf16_f32 v98, v68, v69
  v_exp_f32 v72, v72
  v_exp_f32 v73, v73
  v_cvt_pk_bf16_f32 v99, v70, v71
  v_mfma_f32_32x32x16_bf16 v[80:95], v[36:39], v[204:207], v[80:95]
  v_exp_f32 v74, v74
  v_exp_f32 v75, v75
  ds_read_b128 v[56:59], v4 offset:38912
  v_cvt_pk_bf16_f32 v100, v72, v73
  v_exp_f32 v76, v76
  v_exp_f32 v77, v77
  ds_read_b128 v[60:63], v4 offset:39936
  v_cvt_pk_bf16_f32 v101, v74, v75
  v_exp_f32 v78, v78
  s_add_u32 m0, s31, 2048
  s_add_u32 s29, s53, s27
  s_add_u32 s29, s29, 2048
  buffer_load_dwordx4 v2, s[8:11], s29 offen sc1 lds
  v_exp_f32 v79, v79
  v_cvt_pk_bf16_f32 v102, v76, v77
  v_cvt_pk_bf16_f32 v103, v78, v79
  s_waitcnt lgkmcnt(4)
  v_mfma_f32_32x32x16_bf16 v[112:127], v[48:51], v[96:99], v[112:127]
  v_exp_f32 v80, v80
  v_exp_f32 v81, v81
  v_exp_f32 v82, v82
  v_exp_f32 v83, v83
  v_mfma_f32_32x32x16_bf16 v[112:127], v[52:55], v[100:103], v[112:127]
  v_cvt_pk_bf16_f32 v104, v80, v81
  v_exp_f32 v84, v84
  v_exp_f32 v85, v85
  v_cvt_pk_bf16_f32 v105, v82, v83
  v_exp_f32 v86, v86
  s_waitcnt lgkmcnt(2)
  v_mfma_f32_32x32x16_bf16 v[64:79], v[40:43], v[192:195], 0
  v_exp_f32 v87, v87
  v_cvt_pk_bf16_f32 v106, v84, v85
  v_exp_f32 v88, v88
  v_exp_f32 v89, v89
  v_cvt_pk_bf16_f32 v107, v86, v87
  v_mfma_f32_32x32x16_bf16 v[64:79], v[44:47], v[196:199], v[64:79]
  v_exp_f32 v90, v90
  v_exp_f32 v91, v91
  ds_read_b128 v[32:35], v4 offset:8192
  v_cvt_pk_bf16_f32 v108, v88, v89
  v_exp_f32 v92, v92
  v_exp_f32 v93, v93
  ds_read_b128 v[36:39], v4 offset:9216
  v_cvt_pk_bf16_f32 v109, v90, v91
  v_exp_f32 v94, v94
  v_exp_f32 v95, v95
  v_cvt_pk_bf16_f32 v110, v92, v93
  v_cvt_pk_bf16_f32 v111, v94, v95
  v_mfma_f32_32x32x16_bf16 v[128:143], v[48:51], v[104:107], v[128:143]
  v_exp_f32 v64, v64
  v_exp_f32 v65, v65
  v_exp_f32 v66, v66
  v_exp_f32 v67, v67
  v_mfma_f32_32x32x16_bf16 v[128:143], v[52:55], v[108:111], v[128:143]
  v_cvt_pk_bf16_f32 v96, v64, v65
  v_exp_f32 v68, v68
  v_exp_f32 v69, v69
  v_cvt_pk_bf16_f32 v97, v66, v67
  v_exp_f32 v70, v70
  v_mfma_f32_32x32x16_bf16 v[80:95], v[40:43], v[200:203], 0
  v_exp_f32 v71, v71
  v_cvt_pk_bf16_f32 v98, v68, v69
  v_exp_f32 v72, v72
  v_exp_f32 v73, v73
  v_cvt_pk_bf16_f32 v99, v70, v71
  v_mfma_f32_32x32x16_bf16 v[80:95], v[44:47], v[204:207], v[80:95]
  v_exp_f32 v74, v74
  v_exp_f32 v75, v75
  ds_read_b128 v[48:51], v4 offset:40960
  v_cvt_pk_bf16_f32 v100, v72, v73
  v_exp_f32 v76, v76
  v_exp_f32 v77, v77
  ds_read_b128 v[52:55], v4 offset:41984
  v_cvt_pk_bf16_f32 v101, v74, v75
  v_exp_f32 v78, v78
  s_add_u32 m0, s31, 3072
  s_add_u32 s29, s53, s27
  s_add_u32 s29, s29, 3072
  buffer_load_dwordx4 v2, s[8:11], s29 offen sc1 lds
  v_exp_f32 v79, v79
  v_cvt_pk_bf16_f32 v102, v76, v77
  v_cvt_pk_bf16_f32 v103, v78, v79
  s_waitcnt lgkmcnt(4)
  v_mfma_f32_32x32x16_bf16 v[112:127], v[56:59], v[96:99], v[112:127]
  v_exp_f32 v80, v80
  v_exp_f32 v81, v81
  v_exp_f32 v82, v82
  v_exp_f32 v83, v83
  v_mfma_f32_32x32x16_bf16 v[112:127], v[60:63], v[100:103], v[112:127]
  v_cvt_pk_bf16_f32 v104, v80, v81
  v_exp_f32 v84, v84
  v_exp_f32 v85, v85
  v_cvt_pk_bf16_f32 v105, v82, v83
  v_exp_f32 v86, v86
  s_waitcnt lgkmcnt(2)
  v_mfma_f32_32x32x16_bf16 v[64:79], v[32:35], v[192:195], 0
  v_exp_f32 v87, v87
  v_cvt_pk_bf16_f32 v106, v84, v85
  v_exp_f32 v88, v88
  v_exp_f32 v89, v89
  v_cvt_pk_bf16_f32 v107, v86, v87
  v_mfma_f32_32x32x16_bf16 v[64:79], v[36:39], v[196:199], v[64:79]
  v_exp_f32 v90, v90
  v_exp_f32 v91, v91
  ds_read_b128 v[40:43], v4 offset:10240
  v_cvt_pk_bf16_f32 v108, v88, v89
  v_exp_f32 v92, v92
  v_exp_f32 v93, v93
  ds_read_b128 v[44:47], v4 offset:11264
  v_cvt_pk_bf16_f32 v109, v90, v91
  v_exp_f32 v94, v94
  v_exp_f32 v95, v95
  v_cvt_pk_bf16_f32 v110, v92, v93
  v_cvt_pk_bf16_f32 v111, v94, v95
  v_mfma_f32_32x32x16_bf16 v[128:143], v[56:59], v[104:107], v[128:143]
  v_exp_f32 v64, v64
  v_exp_f32 v65, v65
  v_exp_f32 v66, v66
  v_exp_f32 v67, v67
  v_mfma_f32_32x32x16_bf16 v[128:143], v[60:63], v[108:111], v[128:143]
  v_cvt_pk_bf16_f32 v96, v64, v65
  v_exp_f32 v68, v68
  v_exp_f32 v69, v69
  v_cvt_pk_bf16_f32 v97, v66, v67
  v_exp_f32 v70, v70
  v_mfma_f32_32x32x16_bf16 v[80:95], v[32:35], v[200:203], 0
  v_exp_f32 v71, v71
  v_cvt_pk_bf16_f32 v98, v68, v69
  v_exp_f32 v72, v72
  v_exp_f32 v73, v73
  v_cvt_pk_bf16_f32 v99, v70, v71
  v_mfma_f32_32x32x16_bf16 v[80:95], v[36:39], v[204:207], v[80:95]
  v_exp_f32 v74, v74
  v_exp_f32 v75, v75
  ds_read_b128 v[56:59], v4 offset:43008
  v_cvt_pk_bf16_f32 v100, v72, v73
  v_exp_f32 v76, v76
  v_exp_f32 v77, v77
  ds_read_b128 v[60:63], v4 offset:44032
  v_cvt_pk_bf16_f32 v101, v74, v75
  v_exp_f32 v78, v78
  s_add_u32 m0, s31, 4096
  s_add_u32 s29, s53, s27
  s_add_u32 s29, s29, 4096
  buffer_load_dwordx4 v2, s[8:11], s29 offen sc1 lds
  v_exp_f32 v79, v79
  v_cvt_pk_bf16_f32 v102, v76, v77
  v_cvt_pk_bf16_f32 v103, v78, v79
  s_waitcnt lgkmcnt(4)
  v_mfma_f32_32x32x16_bf16 v[112:127], v[48:51], v[96:99], v[112:127]
  v_exp_f32 v80, v80
  v_exp_f32 v81, v81
  v_exp_f32 v82, v82
  v_exp_f32 v83, v83
  v_mfma_f32_32x32x16_bf16 v[112:127], v[52:55], v[100:103], v[112:127]
  v_cvt_pk_bf16_f32 v104, v80, v81
  v_exp_f32 v84, v84
  v_exp_f32 v85, v85
  v_cvt_pk_bf16_f32 v105, v82, v83
  v_exp_f32 v86, v86
  s_waitcnt lgkmcnt(2)
  v_mfma_f32_32x32x16_bf16 v[64:79], v[40:43], v[192:195], 0
  v_exp_f32 v87, v87
  v_cvt_pk_bf16_f32 v106, v84, v85
  v_exp_f32 v88, v88
  v_exp_f32 v89, v89
  v_cvt_pk_bf16_f32 v107, v86, v87
  v_mfma_f32_32x32x16_bf16 v[64:79], v[44:47], v[196:199], v[64:79]
  v_exp_f32 v90, v90
  v_exp_f32 v91, v91
  ds_read_b128 v[32:35], v4 offset:12288
  v_cvt_pk_bf16_f32 v108, v88, v89
  v_exp_f32 v92, v92
  v_exp_f32 v93, v93
  ds_read_b128 v[36:39], v4 offset:13312
  v_cvt_pk_bf16_f32 v109, v90, v91
  v_exp_f32 v94, v94
  v_exp_f32 v95, v95
  v_cvt_pk_bf16_f32 v110, v92, v93
  v_cvt_pk_bf16_f32 v111, v94, v95
  v_mfma_f32_32x32x16_bf16 v[128:143], v[48:51], v[104:107], v[128:143]
  v_exp_f32 v64, v64
  v_exp_f32 v65, v65
  v_exp_f32 v66, v66
  v_exp_f32 v67, v67
  v_mfma_f32_32x32x16_bf16 v[128:143], v[52:55], v[108:111], v[128:143]
  v_cvt_pk_bf16_f32 v96, v64, v65
  v_exp_f32 v68, v68
  v_exp_f32 v69, v69
  v_cvt_pk_bf16_f32 v97, v66, v67
  v_exp_f32 v70, v70
  v_mfma_f32_32x32x16_bf16 v[80:95], v[40:43], v[200:203], 0
  v_exp_f32 v71, v71
  v_cvt_pk_bf16_f32 v98, v68, v69
  v_exp_f32 v72, v72
  v_exp_f32 v73, v73
  v_cvt_pk_bf16_f32 v99, v70, v71
  v_mfma_f32_32x32x16_bf16 v[80:95], v[44:47], v[204:207], v[80:95]
  v_exp_f32 v74, v74
  v_exp_f32 v75, v75
  ds_read_b128 v[48:51], v4 offset:45056
  v_cvt_pk_bf16_f32 v100, v72, v73
  v_exp_f32 v76, v76
  v_exp_f32 v77, v77
  ds_read_b128 v[52:55], v4 offset:46080
  v_cvt_pk_bf16_f32 v101, v74, v75
  v_exp_f32 v78, v78
  s_add_u32 m0, s31, 5120
  s_add_u32 s29, s53, s27
  s_add_u32 s29, s29, 5120
  buffer_load_dwordx4 v2, s[8:11], s29 offen sc1 lds
  v_exp_f32 v79, v79
  v_cvt_pk_bf16_f32 v102, v76, v77
  v_cvt_pk_bf16_f32 v103, v78, v79
  s_waitcnt lgkmcnt(4)
  v_mfma_f32_32x32x16_bf16 v[112:127], v[56:59], v[96:99], v[112:127]
  v_exp_f32 v80, v80
  v_exp_f32 v81, v81
  v_exp_f32 v82, v82
  v_exp_f32 v83, v83
  v_mfma_f32_32x32x16_bf16 v[112:127], v[60:63], v[100:103], v[112:127]
  v_cvt_pk_bf16_f32 v104, v80, v81
  v_exp_f32 v84, v84
  v_exp_f32 v85, v85
  v_cvt_pk_bf16_f32 v105, v82, v83
  v_exp_f32 v86, v86
  s_waitcnt lgkmcnt(2)
  v_mfma_f32_32x32x16_bf16 v[64:79], v[32:35], v[192:195], 0
  v_exp_f32 v87, v87
  v_cvt_pk_bf16_f32 v106, v84, v85
  v_exp_f32 v88, v88
  v_exp_f32 v89, v89
  v_cvt_pk_bf16_f32 v107, v86, v87
  v_mfma_f32_32x32x16_bf16 v[64:79], v[36:39], v[196:199], v[64:79]
  v_exp_f32 v90, v90
  v_exp_f32 v91, v91
  ds_read_b128 v[40:43], v4 offset:14336
  v_cvt_pk_bf16_f32 v108, v88, v89
  v_exp_f32 v92, v92
  v_exp_f32 v93, v93
  ds_read_b128 v[44:47], v4 offset:15360
  v_cvt_pk_bf16_f32 v109, v90, v91
  v_exp_f32 v94, v94
  v_exp_f32 v95, v95
  v_cvt_pk_bf16_f32 v110, v92, v93
  v_cvt_pk_bf16_f32 v111, v94, v95
  v_mfma_f32_32x32x16_bf16 v[128:143], v[56:59], v[104:107], v[128:143]
  v_exp_f32 v64, v64
  v_exp_f32 v65, v65
  v_exp_f32 v66, v66
  v_exp_f32 v67, v67
  v_mfma_f32_32x32x16_bf16 v[128:143], v[60:63], v[108:111], v[128:143]
  v_cvt_pk_bf16_f32 v96, v64, v65
  v_exp_f32 v68, v68
  v_exp_f32 v69, v69
  v_cvt_pk_bf16_f32 v97, v66, v67
  v_exp_f32 v70, v70
  v_mfma_f32_32x32x16_bf16 v[80:95], v[32:35], v[200:203], 0
  v_exp_f32 v71, v71
  v_cvt_pk_bf16_f32 v98, v68, v69
  v_exp_f32 v72, v72
  v_exp_f32 v73, v73
  v_cvt_pk_bf16_f32 v99, v70, v71
  v_mfma_f32_32x32x16_bf16 v[80:95], v[36:39], v[204:207], v[80:95]
  v_exp_f32 v74, v74
  v_exp_f32 v75, v75
  ds_read_b128 v[56:59], v4 offset:47104
  v_cvt_pk_bf16_f32 v100, v72, v73
  v_exp_f32 v76, v76
  v_exp_f32 v77, v77
  ds_read_b128 v[60:63], v4 offset:48128
  v_cvt_pk_bf16_f32 v101, v74, v75
  v_exp_f32 v78, v78
  s_add_u32 m0, s31, 6144
  s_add_u32 s29, s53, s27
  s_add_u32 s29, s29, 6144
  buffer_load_dwordx4 v2, s[8:11], s29 offen sc1 lds
  v_exp_f32 v79, v79
  v_cvt_pk_bf16_f32 v102, v76, v77
  v_cvt_pk_bf16_f32 v103, v78, v79
  s_waitcnt lgkmcnt(4)
  v_mfma_f32_32x32x16_bf16 v[112:127], v[48:51], v[96:99], v[112:127]
  v_exp_f32 v80, v80
  v_exp_f32 v81, v81
  v_exp_f32 v82, v82
  v_exp_f32 v83, v83
  v_mfma_f32_32x32x16_bf16 v[112:127], v[52:55], v[100:103], v[112:127]
  v_cvt_pk_bf16_f32 v104, v80, v81
  v_exp_f32 v84, v84
  v_exp_f32 v85, v85
  v_cvt_pk_bf16_f32 v105, v82, v83
  v_exp_f32 v86, v86
  s_waitcnt lgkmcnt(2)
  v_mfma_f32_32x32x16_bf16 v[64:79], v[40:43], v[192:195], 0
  v_exp_f32 v87, v87
  v_cvt_pk_bf16_f32 v106, v84, v85
  v_exp_f32 v88, v88
  v_exp_f32 v89, v89
  v_cvt_pk_bf16_f32 v107, v86, v87
  v_mfma_f32_32x32x16_bf16 v[64:79], v[44:47], v[196:199], v[64:79]
  v_exp_f32 v90, v90
  v_exp_f32 v91, v91
  ds_read_b128 v[32:35], v4 offset:16384
  v_cvt_pk_bf16_f32 v108, v88, v89
  v_exp_f32 v92, v92
  v_exp_f32 v93, v93
  ds_read_b128 v[36:39], v4 offset:17408
  v_cvt_pk_bf16_f32 v109, v90, v91
  v_exp_f32 v94, v94
  v_exp_f32 v95, v95
  v_cvt_pk_bf16_f32 v110, v92, v93
  v_cvt_pk_bf16_f32 v111, v94, v95
  v_mfma_f32_32x32x16_bf16 v[128:143], v[48:51], v[104:107], v[128:143]
  v_exp_f32 v64, v64
  v_exp_f32 v65, v65
  v_exp_f32 v66, v66
  v_exp_f32 v67, v67
  v_mfma_f32_32x32x16_bf16 v[128:143], v[52:55], v[108:111], v[128:143]
  v_cvt_pk_bf16_f32 v96, v64, v65
  v_exp_f32 v68, v68
  v_exp_f32 v69, v69
  v_cvt_pk_bf16_f32 v97, v66, v67
  v_exp_f32 v70, v70
  v_mfma_f32_32x32x16_bf16 v[80:95], v[40:43], v[200:203], 0
  v_exp_f32 v71, v71
  v_cvt_pk_bf16_f32 v98, v68, v69
  v_exp_f32 v72, v72
  v_exp_f32 v73, v73
  v_cvt_pk_bf16_f32 v99, v70, v71
  v_mfma_f32_32x32x16_bf16 v[80:95], v[44:47], v[204:207], v[80:95]
  v_exp_f32 v74, v74
  v_exp_f32 v75, v75
  ds_read_b128 v[48:51], v4 offset:49152
  v_cvt_pk_bf16_f32 v100, v72, v73
  v_exp_f32 v76, v76
  v_exp_f32 v77, v77
  ds_read_b128 v[52:55], v4 offset:50176
  v_cvt_pk_bf16_f32 v101, v74, v75
  v_exp_f32 v78, v78
  s_add_u32 m0, s31, 7168
  s_add_u32 s29, s53, s27
  s_add_u32 s29, s29, 7168
  buffer_load_dwordx4 v2, s[8:11], s29 offen sc1 lds
  v_exp_f32 v79, v79
  v_cvt_pk_bf16_f32 v102, v76, v77
  v_cvt_pk_bf16_f32 v103, v78, v79
  s_waitcnt lgkmcnt(4)
  v_mfma_f32_32x32x16_bf16 v[112:127], v[56:59], v[96:99], v[112:127]
  v_exp_f32 v80, v80
  v_exp_f32 v81, v81
  v_exp_f32 v82, v82
  v_exp_f32 v83, v83
  v_mfma_f32_32x32x16_bf16 v[112:127], v[60:63], v[100:103], v[112:127]
  v_cvt_pk_bf16_f32 v104, v80, v81
  v_exp_f32 v84, v84
  v_exp_f32 v85, v85
  v_cvt_pk_bf16_f32 v105, v82, v83
  v_exp_f32 v86, v86
  s_waitcnt lgkmcnt(2)
  v_mfma_f32_32x32x16_bf16 v[64:79], v[32:35], v[192:195], 0
  v_exp_f32 v87, v87
  v_cvt_pk_bf16_f32 v106, v84, v85
  v_exp_f32 v88, v88
  v_exp_f32 v89, v89
  v_cvt_pk_bf16_f32 v107, v86, v87
  v_mfma_f32_32x32x16_bf16 v[64:79], v[36:39], v[196:199], v[64:79]
  v_exp_f32 v90, v90
  v_exp_f32 v91, v91
  ds_read_b128 v[40:43], v4 offset:18432
  v_cvt_pk_bf16_f32 v108, v88, v89
  v_exp_f32 v92, v92
  v_exp_f32 v93, v93
  ds_read_b128 v[44:47], v4 offset:19456
  v_cvt_pk_bf16_f32 v109, v90, v91
  v_exp_f32 v94, v94
  v_exp_f32 v95, v95
  v_cvt_pk_bf16_f32 v110, v92, v93
  v_cvt_pk_bf16_f32 v111, v94, v95
  v_mfma_f32_32x32x16_bf16 v[128:143], v[56:59], v[104:107], v[128:143]
  v_exp_f32 v64, v64
  v_exp_f32 v65, v65
  v_exp_f32 v66, v66
  v_exp_f32 v67, v67
  v_mfma_f32_32x32x16_bf16 v[128:143], v[60:63], v[108:111], v[128:143]
  v_cvt_pk_bf16_f32 v96, v64, v65
  v_exp_f32 v68, v68
  v_exp_f32 v69, v69
  v_cvt_pk_bf16_f32 v97, v66, v67
  v_exp_f32 v70, v70
  v_mfma_f32_32x32x16_bf16 v[80:95], v[32:35], v[200:203], 0
  v_exp_f32 v71, v71
  v_cvt_pk_bf16_f32 v98, v68, v69
  v_exp_f32 v72, v72
  v_exp_f32 v73, v73
  v_cvt_pk_bf16_f32 v99, v70, v71
  v_mfma_f32_32x32x16_bf16 v[80:95], v[36:39], v[204:207], v[80:95]
  v_exp_f32 v74, v74
  v_exp_f32 v75, v75
  ds_read_b128 v[56:59], v4 offset:51200
  v_cvt_pk_bf16_f32 v100, v72, v73
  v_exp_f32 v76, v76
  v_exp_f32 v77, v77
  ds_read_b128 v[60:63], v4 offset:52224
  v_cvt_pk_bf16_f32 v101, v74, v75
  v_exp_f32 v78, v78
  s_add_u32 m0, s31, 32768
  s_add_u32 s29, s53, s28
  s_add_u32 s29, s29, 0
  buffer_load_dwordx4 v2, s[8:11], s29 offen sc1 lds
  v_exp_f32 v79, v79
  v_cvt_pk_bf16_f32 v102, v76, v77
  v_cvt_pk_bf16_f32 v103, v78, v79
  s_waitcnt lgkmcnt(4)
  v_mfma_f32_32x32x16_bf16 v[112:127], v[48:51], v[96:99], v[112:127]
  v_exp_f32 v80, v80
  v_exp_f32 v81, v81
  v_exp_f32 v82, v82
  v_exp_f32 v83, v83
  v_mfma_f32_32x32x16_bf16 v[112:127], v[52:55], v[100:103], v[112:127]
  v_cvt_pk_bf16_f32 v104, v80, v81
  v_exp_f32 v84, v84
  v_exp_f32 v85, v85
  v_cvt_pk_bf16_f32 v105, v82, v83
  v_exp_f32 v86, v86
  s_waitcnt lgkmcnt(2)
  v_mfma_f32_32x32x16_bf16 v[64:79], v[40:43], v[192:195], 0
  v_exp_f32 v87, v87
  v_cvt_pk_bf16_f32 v106, v84, v85
  v_exp_f32 v88, v88
  v_exp_f32 v89, v89
  v_cvt_pk_bf16_f32 v107, v86, v87
  v_mfma_f32_32x32x16_bf16 v[64:79], v[44:47], v[196:199], v[64:79]
  v_exp_f32 v90, v90
  v_exp_f32 v91, v91
  ds_read_b128 v[32:35], v4 offset:20480
  v_cvt_pk_bf16_f32 v108, v88, v89
  v_exp_f32 v92, v92
  v_exp_f32 v93, v93
  ds_read_b128 v[36:39], v4 offset:21504
  v_cvt_pk_bf16_f32 v109, v90, v91
  v_exp_f32 v94, v94
  v_exp_f32 v95, v95
  v_cvt_pk_bf16_f32 v110, v92, v93
  v_cvt_pk_bf16_f32 v111, v94, v95
  v_mfma_f32_32x32x16_bf16 v[128:143], v[48:51], v[104:107], v[128:143]
  v_exp_f32 v64, v64
  v_exp_f32 v65, v65
  v_exp_f32 v66, v66
  v_exp_f32 v67, v67
  v_mfma_f32_32x32x16_bf16 v[128:143], v[52:55], v[108:111], v[128:143]
  v_cvt_pk_bf16_f32 v96, v64, v65
  v_exp_f32 v68, v68
  v_exp_f32 v69, v69
  v_cvt_pk_bf16_f32 v97, v66, v67
  v_exp_f32 v70, v70
  v_mfma_f32_32x32x16_bf16 v[80:95], v[40:43], v[200:203], 0
  v_exp_f32 v71, v71
  v_cvt_pk_bf16_f32 v98, v68, v69
  v_exp_f32 v72, v72
  v_exp_f32 v73, v73
  v_cvt_pk_bf16_f32 v99, v70, v71
  v_mfma_f32_32x32x16_bf16 v[80:95], v[44:47], v[204:207], v[80:95]
  v_exp_f32 v74, v74
  v_exp_f32 v75, v75
  ds_read_b128 v[48:51], v4 offset:53248
  v_cvt_pk_bf16_f32 v100, v72, v73
  v_exp_f32 v76, v76
  v_exp_f32 v77, v77
  ds_read_b128 v[52:55], v4 offset:54272
  v_cvt_pk_bf16_f32 v101, v74, v75
  v_exp_f32 v78, v78
  s_add_u32 m0, s31, 33792
  s_add_u32 s29, s53, s28
  s_add_u32 s29, s29, 1024
  buffer_load_dwordx4 v2, s[8:11], s29 offen sc1 lds
  v_exp_f32 v79, v79
  v_cvt_pk_bf16_f32 v102, v76, v77
  v_cvt_pk_bf16_f32 v103, v78, v79
  s_waitcnt lgkmcnt(4)
  v_mfma_f32_32x32x16_bf16 v[112:127], v[56:59], v[96:99], v[112:127]
  v_exp_f32 v80, v80
  v_exp_f32 v81, v81
  v_exp_f32 v82, v82
  v_exp_f32 v83, v83
  v_mfma_f32_32x32x16_bf16 v[112:127], v[60:63], v[100:103], v[112:127]
  v_cvt_pk_bf16_f32 v104, v80, v81
  v_exp_f32 v84, v84
  v_exp_f32 v85, v85
  v_cvt_pk_bf16_f32 v105, v82, v83
  v_exp_f32 v86, v86
  s_waitcnt lgkmcnt(2)
  v_mfma_f32_32x32x16_bf16 v[64:79], v[32:35], v[192:195], 0
  v_exp_f32 v87, v87
  v_cvt_pk_bf16_f32 v106, v84, v85
  v_exp_f32 v88, v88
  v_exp_f32 v89, v89
  v_cvt_pk_bf16_f32 v107, v86, v87
  v_mfma_f32_32x32x16_bf16 v[64:79], v[36:39], v[196:199], v[64:79]
  v_exp_f32 v90, v90
  v_exp_f32 v91, v91
  ds_read_b128 v[40:43], v4 offset:22528
  v_cvt_pk_bf16_f32 v108, v88, v89
  v_exp_f32 v92, v92
  v_exp_f32 v93, v93
  ds_read_b128 v[44:47], v4 offset:23552
  v_cvt_pk_bf16_f32 v109, v90, v91
  v_exp_f32 v94, v94
  v_exp_f32 v95, v95
  v_cvt_pk_bf16_f32 v110, v92, v93
  v_cvt_pk_bf16_f32 v111, v94, v95
  v_mfma_f32_32x32x16_bf16 v[128:143], v[56:59], v[104:107], v[128:143]
  v_exp_f32 v64, v64
  v_exp_f32 v65, v65
  v_exp_f32 v66, v66
  v_exp_f32 v67, v67
  v_mfma_f32_32x32x16_bf16 v[128:143], v[60:63], v[108:111], v[128:143]
  v_cvt_pk_bf16_f32 v96, v64, v65
  v_exp_f32 v68, v68
  v_exp_f32 v69, v69
  v_cvt_pk_bf16_f32 v97, v66, v67
  v_exp_f32 v70, v70
  v_mfma_f32_32x32x16_bf16 v[80:95], v[32:35], v[200:203], 0
  v_exp_f32 v71, v71
  v_cvt_pk_bf16_f32 v98, v68, v69
  v_exp_f32 v72, v72
  v_exp_f32 v73, v73
  v_cvt_pk_bf16_f32 v99, v70, v71
  v_mfma_f32_32x32x16_bf16 v[80:95], v[36:39], v[204:207], v[80:95]
  v_exp_f32 v74, v74
  v_exp_f32 v75, v75
  ds_read_b128 v[56:59], v4 offset:55296
  v_cvt_pk_bf16_f32 v100, v72, v73
  v_exp_f32 v76, v76
  v_exp_f32 v77, v77
  ds_read_b128 v[60:63], v4 offset:56320
  v_cvt_pk_bf16_f32 v101, v74, v75
  v_exp_f32 v78, v78
  s_add_u32 m0, s31, 34816
  s_add_u32 s29, s53, s28
  s_add_u32 s29, s29, 2048
  buffer_load_dwordx4 v2, s[8:11], s29 offen sc1 lds
  v_exp_f32 v79, v79
  v_cvt_pk_bf16_f32 v102, v76, v77
  v_cvt_pk_bf16_f32 v103, v78, v79
  s_waitcnt lgkmcnt(4)
  v_mfma_f32_32x32x16_bf16 v[112:127], v[48:51], v[96:99], v[112:127]
  v_exp_f32 v80, v80
  v_exp_f32 v81, v81
  v_exp_f32 v82, v82
  v_exp_f32 v83, v83
  v_mfma_f32_32x32x16_bf16 v[112:127], v[52:55], v[100:103], v[112:127]
  v_cvt_pk_bf16_f32 v104, v80, v81
  v_exp_f32 v84, v84
  v_exp_f32 v85, v85
  v_cvt_pk_bf16_f32 v105, v82, v83
  v_exp_f32 v86, v86
  s_waitcnt lgkmcnt(2)
  v_mfma_f32_32x32x16_bf16 v[64:79], v[40:43], v[192:195], 0
  v_exp_f32 v87, v87
  v_cvt_pk_bf16_f32 v106, v84, v85
  v_exp_f32 v88, v88
  v_exp_f32 v89, v89
  v_cvt_pk_bf16_f32 v107, v86, v87
  v_mfma_f32_32x32x16_bf16 v[64:79], v[44:47], v[196:199], v[64:79]
  v_exp_f32 v90, v90
  v_exp_f32 v91, v91
  ds_read_b128 v[32:35], v4 offset:24576
  v_cvt_pk_bf16_f32 v108, v88, v89
  v_exp_f32 v92, v92
  v_exp_f32 v93, v93
  ds_read_b128 v[36:39], v4 offset:25600
  v_cvt_pk_bf16_f32 v109, v90, v91
  v_exp_f32 v94, v94
  v_exp_f32 v95, v95
  v_cvt_pk_bf16_f32 v110, v92, v93
  v_cvt_pk_bf16_f32 v111, v94, v95
  v_mfma_f32_32x32x16_bf16 v[128:143], v[48:51], v[104:107], v[128:143]
  v_exp_f32 v64, v64
  v_exp_f32 v65, v65
  v_exp_f32 v66, v66
  v_exp_f32 v67, v67
  v_mfma_f32_32x32x16_bf16 v[128:143], v[52:55], v[108:111], v[128:143]
  v_cvt_pk_bf16_f32 v96, v64, v65
  v_exp_f32 v68, v68
  v_exp_f32 v69, v69
  v_cvt_pk_bf16_f32 v97, v66, v67
  v_exp_f32 v70, v70
  v_mfma_f32_32x32x16_bf16 v[80:95], v[40:43], v[200:203], 0
  v_exp_f32 v71, v71
  v_cvt_pk_bf16_f32 v98, v68, v69
  v_exp_f32 v72, v72
  v_exp_f32 v73, v73
  v_cvt_pk_bf16_f32 v99, v70, v71
  v_mfma_f32_32x32x16_bf16 v[80:95], v[44:47], v[204:207], v[80:95]
  v_exp_f32 v74, v74
  v_exp_f32 v75, v75
  ds_read_b128 v[48:51], v4 offset:57344
  v_cvt_pk_bf16_f32 v100, v72, v73
  v_exp_f32 v76, v76
  v_exp_f32 v77, v77
  ds_read_b128 v[52:55], v4 offset:58368
  v_cvt_pk_bf16_f32 v101, v74, v75
  v_exp_f32 v78, v78
  s_add_u32 m0, s31, 35840
  s_add_u32 s29, s53, s28
  s_add_u32 s29, s29, 3072
  buffer_load_dwordx4 v2, s[8:11], s29 offen sc1 lds
  v_exp_f32 v79, v79
  v_cvt_pk_bf16_f32 v102, v76, v77
  v_cvt_pk_bf16_f32 v103, v78, v79
  s_waitcnt lgkmcnt(4)
  v_mfma_f32_32x32x16_bf16 v[112:127], v[56:59], v[96:99], v[112:127]
  v_exp_f32 v80, v80
  v_exp_f32 v81, v81
  v_exp_f32 v82, v82
  v_exp_f32 v83, v83
  v_mfma_f32_32x32x16_bf16 v[112:127], v[60:63], v[100:103], v[112:127]
  v_cvt_pk_bf16_f32 v104, v80, v81
  v_exp_f32 v84, v84
  v_exp_f32 v85, v85
  v_cvt_pk_bf16_f32 v105, v82, v83
  v_exp_f32 v86, v86
  s_waitcnt lgkmcnt(2)
  v_mfma_f32_32x32x16_bf16 v[64:79], v[32:35], v[192:195], 0
  v_exp_f32 v87, v87
  v_cvt_pk_bf16_f32 v106, v84, v85
  v_exp_f32 v88, v88
  v_exp_f32 v89, v89
  v_cvt_pk_bf16_f32 v107, v86, v87
  v_mfma_f32_32x32x16_bf16 v[64:79], v[36:39], v[196:199], v[64:79]
  v_exp_f32 v90, v90
  v_exp_f32 v91, v91
  ds_read_b128 v[40:43], v4 offset:26624
  v_cvt_pk_bf16_f32 v108, v88, v89
  v_exp_f32 v92, v92
  v_exp_f32 v93, v93
  ds_read_b128 v[44:47], v4 offset:27648
  v_cvt_pk_bf16_f32 v109, v90, v91
  v_exp_f32 v94, v94
  v_exp_f32 v95, v95
  v_cvt_pk_bf16_f32 v110, v92, v93
  v_cvt_pk_bf16_f32 v111, v94, v95
  v_mfma_f32_32x32x16_bf16 v[128:143], v[56:59], v[104:107], v[128:143]
  v_exp_f32 v64, v64
  v_exp_f32 v65, v65
  v_exp_f32 v66, v66
  v_exp_f32 v67, v67
  v_mfma_f32_32x32x16_bf16 v[128:143], v[60:63], v[108:111], v[128:143]
  v_cvt_pk_bf16_f32 v96, v64, v65
  v_exp_f32 v68, v68
  v_exp_f32 v69, v69
  v_cvt_pk_bf16_f32 v97, v66, v67
  v_exp_f32 v70, v70
  v_mfma_f32_32x32x16_bf16 v[80:95], v[32:35], v[200:203], 0
  v_exp_f32 v71, v71
  v_cvt_pk_bf16_f32 v98, v68, v69
  v_exp_f32 v72, v72
  v_exp_f32 v73, v73
  v_cvt_pk_bf16_f32 v99, v70, v71
  v_mfma_f32_32x32x16_bf16 v[80:95], v[36:39], v[204:207], v[80:95]
  v_exp_f32 v74, v74
  v_exp_f32 v75, v75
  ds_read_b128 v[56:59], v4 offset:59392
  v_cvt_pk_bf16_f32 v100, v72, v73
  v_exp_f32 v76, v76
  v_exp_f32 v77, v77
  ds_read_b128 v[60:63], v4 offset:60416
  v_cvt_pk_bf16_f32 v101, v74, v75
  v_exp_f32 v78, v78
  s_add_u32 m0, s31, 36864
  s_add_u32 s29, s53, s28
  s_add_u32 s29, s29, 4096
  buffer_load_dwordx4 v2, s[8:11], s29 offen sc1 lds
  v_exp_f32 v79, v79
  v_cvt_pk_bf16_f32 v102, v76, v77
  v_cvt_pk_bf16_f32 v103, v78, v79
  s_waitcnt lgkmcnt(4)
  v_mfma_f32_32x32x16_bf16 v[112:127], v[48:51], v[96:99], v[112:127]
  v_exp_f32 v80, v80
  v_exp_f32 v81, v81
  v_exp_f32 v82, v82
  v_exp_f32 v83, v83
  v_mfma_f32_32x32x16_bf16 v[112:127], v[52:55], v[100:103], v[112:127]
  v_cvt_pk_bf16_f32 v104, v80, v81
  v_exp_f32 v84, v84
  v_exp_f32 v85, v85
  v_cvt_pk_bf16_f32 v105, v82, v83
  v_exp_f32 v86, v86
  s_waitcnt lgkmcnt(2)
  v_mfma_f32_32x32x16_bf16 v[64:79], v[40:43], v[192:195], 0
  v_exp_f32 v87, v87
  v_cvt_pk_bf16_f32 v106, v84, v85
  v_exp_f32 v88, v88
  v_exp_f32 v89, v89
  v_cvt_pk_bf16_f32 v107, v86, v87
  v_mfma_f32_32x32x16_bf16 v[64:79], v[44:47], v[196:199], v[64:79]
  v_exp_f32 v90, v90
  v_exp_f32 v91, v91
  ds_read_b128 v[32:35], v4 offset:28672
  v_cvt_pk_bf16_f32 v108, v88, v89
  v_exp_f32 v92, v92
  v_exp_f32 v93, v93
  ds_read_b128 v[36:39], v4 offset:29696
  v_cvt_pk_bf16_f32 v109, v90, v91
  v_exp_f32 v94, v94
  v_exp_f32 v95, v95
  v_cvt_pk_bf16_f32 v110, v92, v93
  v_cvt_pk_bf16_f32 v111, v94, v95
  v_mfma_f32_32x32x16_bf16 v[128:143], v[48:51], v[104:107], v[128:143]
  v_exp_f32 v64, v64
  v_exp_f32 v65, v65
  v_exp_f32 v66, v66
  v_exp_f32 v67, v67
  v_mfma_f32_32x32x16_bf16 v[128:143], v[52:55], v[108:111], v[128:143]
  v_cvt_pk_bf16_f32 v96, v64, v65
  v_exp_f32 v68, v68
  v_exp_f32 v69, v69
  v_cvt_pk_bf16_f32 v97, v66, v67
  v_exp_f32 v70, v70
  v_mfma_f32_32x32x16_bf16 v[80:95], v[40:43], v[200:203], 0
  v_exp_f32 v71, v71
  v_cvt_pk_bf16_f32 v98, v68, v69
  v_exp_f32 v72, v72
  v_exp_f32 v73, v73
  v_cvt_pk_bf16_f32 v99, v70, v71
  v_mfma_f32_32x32x16_bf16 v[80:95], v[44:47], v[204:207], v[80:95]
  v_exp_f32 v74, v74
  v_exp_f32 v75, v75
  ds_read_b128 v[48:51], v4 offset:61440
  v_cvt_pk_bf16_f32 v100, v72, v73
  v_exp_f32 v76, v76
  v_exp_f32 v77, v77
  ds_read_b128 v[52:55], v4 offset:62464
  v_cvt_pk_bf16_f32 v101, v74, v75
  v_exp_f32 v78, v78
  s_add_u32 m0, s31, 37888
  s_add_u32 s29, s53, s28
  s_add_u32 s29, s29, 5120
  buffer_load_dwordx4 v2, s[8:11], s29 offen sc1 lds
  v_exp_f32 v79, v79
  v_cvt_pk_bf16_f32 v102, v76, v77
  v_cvt_pk_bf16_f32 v103, v78, v79
  s_waitcnt lgkmcnt(4)
  v_mfma_f32_32x32x16_bf16 v[112:127], v[56:59], v[96:99], v[112:127]
  v_exp_f32 v80, v80
  v_exp_f32 v81, v81
  v_exp_f32 v82, v82
  v_exp_f32 v83, v83
  v_mfma_f32_32x32x16_bf16 v[112:127], v[60:63], v[100:103], v[112:127]
  v_cvt_pk_bf16_f32 v104, v80, v81
  v_exp_f32 v84, v84
  v_exp_f32 v85, v85
  v_cvt_pk_bf16_f32 v105, v82, v83
  v_exp_f32 v86, v86
  s_waitcnt lgkmcnt(2)
  v_mfma_f32_32x32x16_bf16 v[64:79], v[32:35], v[192:195], 0
  v_exp_f32 v87, v87
  v_cvt_pk_bf16_f32 v106, v84, v85
  v_exp_f32 v88, v88
  v_exp_f32 v89, v89
  v_cvt_pk_bf16_f32 v107, v86, v87
  v_mfma_f32_32x32x16_bf16 v[64:79], v[36:39], v[196:199], v[64:79]
  v_exp_f32 v90, v90
  v_exp_f32 v91, v91
  ds_read_b128 v[40:43], v4 offset:30720
  v_cvt_pk_bf16_f32 v108, v88, v89
  v_exp_f32 v92, v92
  v_exp_f32 v93, v93
  ds_read_b128 v[44:47], v4 offset:31744
  v_cvt_pk_bf16_f32 v109, v90, v91
  v_exp_f32 v94, v94
  v_exp_f32 v95, v95
  v_cvt_pk_bf16_f32 v110, v92, v93
  v_cvt_pk_bf16_f32 v111, v94, v95
  v_mfma_f32_32x32x16_bf16 v[128:143], v[56:59], v[104:107], v[128:143]
  v_exp_f32 v64, v64
  v_exp_f32 v65, v65
  v_exp_f32 v66, v66
  v_exp_f32 v67, v67
  v_mfma_f32_32x32x16_bf16 v[128:143], v[60:63], v[108:111], v[128:143]
  v_cvt_pk_bf16_f32 v96, v64, v65
  v_exp_f32 v68, v68
  v_exp_f32 v69, v69
  v_cvt_pk_bf16_f32 v97, v66, v67
  v_exp_f32 v70, v70
  v_mfma_f32_32x32x16_bf16 v[80:95], v[32:35], v[200:203], 0
  v_exp_f32 v71, v71
  v_cvt_pk_bf16_f32 v98, v68, v69
  v_exp_f32 v72, v72
  v_exp_f32 v73, v73
  v_cvt_pk_bf16_f32 v99, v70, v71
  v_mfma_f32_32x32x16_bf16 v[80:95], v[36:39], v[204:207], v[80:95]
  v_exp_f32 v74, v74
  v_exp_f32 v75, v75
  ds_read_b128 v[56:59], v4 offset:63488
  v_cvt_pk_bf16_f32 v100, v72, v73
  v_exp_f32 v76, v76
  v_exp_f32 v77, v77
  ds_read_b128 v[60:63], v4 offset:64512
  v_cvt_pk_bf16_f32 v101, v74, v75
  v_exp_f32 v78, v78
  s_add_u32 m0, s31, 38912
  s_add_u32 s29, s53, s28
  s_add_u32 s29, s29, 6144
  buffer_load_dwordx4 v2, s[8:11], s29 offen sc1 lds
  v_exp_f32 v79, v79
  v_cvt_pk_bf16_f32 v102, v76, v77
  v_cvt_pk_bf16_f32 v103, v78, v79
  s_waitcnt lgkmcnt(4)
  v_mfma_f32_32x32x16_bf16 v[112:127], v[48:51], v[96:99], v[112:127]
  v_exp_f32 v80, v80
  v_exp_f32 v81, v81
  v_exp_f32 v82, v82
  v_exp_f32 v83, v83
  v_mfma_f32_32x32x16_bf16 v[112:127], v[52:55], v[100:103], v[112:127]
  v_cvt_pk_bf16_f32 v104, v80, v81
  v_exp_f32 v84, v84
  v_exp_f32 v85, v85
  v_cvt_pk_bf16_f32 v105, v82, v83
  v_exp_f32 v86, v86
  s_waitcnt lgkmcnt(2)
  v_mfma_f32_32x32x16_bf16 v[64:79], v[40:43], v[192:195], 0
  v_exp_f32 v87, v87
  v_cvt_pk_bf16_f32 v106, v84, v85
  v_exp_f32 v88, v88
  v_exp_f32 v89, v89
  v_cvt_pk_bf16_f32 v107, v86, v87
  v_mfma_f32_32x32x16_bf16 v[64:79], v[44:47], v[196:199], v[64:79]
  v_exp_f32 v90, v90
  v_exp_f32 v91, v91
  v_cvt_pk_bf16_f32 v108, v88, v89
  v_exp_f32 v92, v92
  v_exp_f32 v93, v93
  v_cvt_pk_bf16_f32 v109, v90, v91
  v_exp_f32 v94, v94
  v_exp_f32 v95, v95
  v_cvt_pk_bf16_f32 v110, v92, v93
  v_cvt_pk_bf16_f32 v111, v94, v95
  v_mfma_f32_32x32x16_bf16 v[128:143], v[48:51], v[104:107], v[128:143]
  v_exp_f32 v64, v64
  v_exp_f32 v65, v65
  v_exp_f32 v66, v66
  v_exp_f32 v67, v67
  v_mfma_f32_32x32x16_bf16 v[128:143], v[52:55], v[108:111], v[128:143]
  v_cvt_pk_bf16_f32 v96, v64, v65
  v_exp_f32 v68, v68
  v_exp_f32 v69, v69
  v_cvt_pk_bf16_f32 v97, v66, v67
  v_exp_f32 v70, v70
  v_mfma_f32_32x32x16_bf16 v[80:95], v[40:43], v[200:203], 0
  v_exp_f32 v71, v71
  v_cvt_pk_bf16_f32 v98, v68, v69
  v_exp_f32 v72, v72
  v_exp_f32 v73, v73
  v_cvt_pk_bf16_f32 v99, v70, v71
  v_mfma_f32_32x32x16_bf16 v[80:95], v[44:47], v[204:207], v[80:95]
  v_exp_f32 v74, v74
  v_exp_f32 v75, v75
  v_cvt_pk_bf16_f32 v100, v72, v73
  v_exp_f32 v76, v76
  v_exp_f32 v77, v77
  v_cvt_pk_bf16_f32 v101, v74, v75
  v_exp_f32 v78, v78
  s_add_u32 m0, s31, 39936
  s_add_u32 s29, s53, s28
  s_add_u32 s29, s29, 7168
  buffer_load_dwordx4 v2, s[8:11], s29 offen sc1 lds
  v_exp_f32 v79, v79
  v_cvt_pk_bf16_f32 v102, v76, v77
  v_cvt_pk_bf16_f32 v103, v78, v79
  s_waitcnt lgkmcnt(0)
  v_mfma_f32_32x32x16_bf16 v[112:127], v[56:59], v[96:99], v[112:127]
  v_exp_f32 v80, v80
  v_exp_f32 v81, v81
  v_exp_f32 v82, v82
  v_exp_f32 v83, v83
  v_mfma_f32_32x32x16_bf16 v[112:127], v[60:63], v[100:103], v[112:127]
  v_cvt_pk_bf16_f32 v104, v80, v81
  v_exp_f32 v84, v84
  v_exp_f32 v85, v85
  v_cvt_pk_bf16_f32 v105, v82, v83
  v_exp_f32 v86, v86
  v_exp_f32 v87, v87
  v_cvt_pk_bf16_f32 v106, v84, v85
  v_exp_f32 v88, v88
  v_exp_f32 v89, v89
  v_cvt_pk_bf16_f32 v107, v86, v87
  v_exp_f32 v90, v90
  v_exp_f32 v91, v91
  v_cvt_pk_bf16_f32 v108, v88, v89
  v_exp_f32 v92, v92
  v_exp_f32 v93, v93
  v_cvt_pk_bf16_f32 v109, v90, v91
  v_exp_f32 v94, v94
  v_exp_f32 v95, v95
  v_cvt_pk_bf16_f32 v110, v92, v93
  v_cvt_pk_bf16_f32 v111, v94, v95
  s_nop 1
  v_mfma_f32_32x32x16_bf16 v[128:143], v[56:59], v[104:107], v[128:143]
  v_mfma_f32_32x32x16_bf16 v[128:143], v[60:63], v[108:111], v[128:143]
  s_cmp_lt_u32 s41, 4
  s_cbranch_scc1 kb2_chunk2
  s_nop 11
  v_mov_b32 v5, v120
  v_mov_b32 v6, v120
  s_nop 1
  v_permlane32_swap_b32 v5, v6
  v_mov_b32 v14, v6
  v_mov_b32 v5, v136
  v_mov_b32 v6, v136
  s_nop 1
  v_permlane32_swap_b32 v5, v6
  v_mov_b32 v15, v6
  s_cmp_eq_u32 s40, 0
  s_cbranch_scc0 kb2_fin
  v_min_f32 v5, v14, v15
  v_cmp_gt_f32 vcc, 0x12800000, v5
  v_cmp_u_f32 s[36:37], v5, v5
  s_nop 1
  s_or_b64 vcc, vcc, s[36:37]
  s_cmp_lg_u64 vcc, 0
  s_cselect_b32 s42, 1, 0
  v_mov_b32 v5, s42
  s_lshl_b32 s30, s21, 2
  s_add_u32 s30, s30, 131584
  v_mov_b32 v6, s30
  ds_write_b32 v6, v5
  s_waitcnt vmcnt(0) lgkmcnt(0)
  s_barrier
  v_mov_b32 v6, 131584
  ds_read_b128 v[8:11], v6
  s_waitcnt lgkmcnt(0)
  v_or_b32 v8, v8, v9
  v_or_b32 v10, v10, v11
  v_or_b32 v8, v8, v10
  s_nop 0
  v_readfirstlane_b32 s42, v8
  s_cmp_eq_u32 s42, 0
  s_cbranch_scc1 kb2_fin
  s_mov_b32 s40, 1
  v_and_b32 v5, 0xffff0000, v198
  v_cndmask_b32 v198, v198, v5, s[34:35]
  v_mov_b32 v12, 0xff7fffff
  v_and_b32 v5, 0xffff0000, v206
  v_cndmask_b32 v206, v206, v5, s[34:35]
  v_mov_b32 v13, 0xff7fffff
  s_mov_b32 s41, 0
kb2_mx:
  s_lshl_b32 s30, s41, 11
  s_add_u32 s30, s30, s27
  buffer_load_dwordx4 v[32:35], v2, s[8:11], s30 offen sc1
  buffer_load_dwordx4 v[36:39], v2, s[8:11], s30 offen offset:1024 sc1
  s_waitcnt vmcnt(0)
  v_mfma_f32_32x32x16_bf16 v[64:79], v[32:35], v[192:195], 0
  v_mfma_f32_32x32x16_bf16 v[64:79], v[36:39], v[196:199], v[64:79]
  v_mfma_f32_32x32x16_bf16 v[80:95], v[32:35], v[200:203], 0
  v_mfma_f32_32x32x16_bf16 v[80:95], v[36:39], v[204:207], v[80:95]
  s_nop 11
  v_max3_f32 v12, v12, v64, v65
  v_max3_f32 v12, v12, v66, v67
  v_max3_f32 v12, v12, v68, v69
  v_max3_f32 v12, v12, v70, v71
  v_max3_f32 v12, v12, v72, v73
  v_max3_f32 v12, v12, v74, v75
  v_max3_f32 v12, v12, v76, v77
  v_max3_f32 v12, v12, v78, v79
  v_max3_f32 v13, v13, v80, v81
  v_max3_f32 v13, v13, v82, v83
  v_max3_f32 v13, v13, v84, v85
  v_max3_f32 v13, v13, v86, v87
  v_max3_f32 v13, v13, v88, v89
  v_max3_f32 v13, v13, v90, v91
  v_max3_f32 v13, v13, v92, v93
  v_max3_f32 v13, v13, v94, v95
  s_add_u32 s41, s41, 1
  s_cmp_lt_u32 s41, 64
  s_cbranch_scc1 kb2_mx
  v_mov_b32 v5, v12
  s_nop 1
  v_permlane32_swap_b32 v12, v5
  v_max_f32 v12, v12, v5
  v_cvt_pk_bf16_f32 v5, v12, v12
  v_and_b32 v5, 0xffff, v5
  v_xor_b32 v5, 0x8000, v5
  v_and_b32 v6, 0xffff0000, v198
  v_or_b32 v5, v5, v6
  v_cndmask_b32 v198, v198, v5, s[34:35]
  v_mov_b32 v5, v13
  s_nop 1
  v_permlane32_swap_b32 v13, v5
  v_max_f32 v13, v13, v5
  v_cvt_pk_bf16_f32 v5, v13, v13
  v_and_b32 v5, 0xffff, v5
  v_xor_b32 v5, 0x8000, v5
  v_and_b32 v6, 0xffff0000, v206
  v_or_b32 v5, v5, v6
  v_cndmask_b32 v206, v206, v5, s[34:35]
  s_barrier
  s_mov_b32 s41, 0
  s_mul_i32 s53, s41, 32768
  s_lshl_b32 s31, s21, 13
  s_add_u32 s53, s53, s31
  s_add_u32 m0, s31, 0
  s_add_u32 s29, s53, s27
  s_add_u32 s29, s29, 0
  buffer_load_dwordx4 v2, s[8:11], s29 offen sc1 lds
  s_add_u32 m0, s31, 1024
  s_add_u32 s29, s53, s27
  s_add_u32 s29, s29, 1024
  buffer_load_dwordx4 v2, s[8:11], s29 offen sc1 lds
  s_add_u32 m0, s31, 2048
  s_add_u32 s29, s53, s27
  s_add_u32 s29, s29, 2048
  buffer_load_dwordx4 v2, s[8:11], s29 offen sc1 lds
  s_add_u32 m0, s31, 3072
  s_add_u32 s29, s53, s27
  s_add_u32 s29, s29, 3072
  buffer_load_dwordx4 v2, s[8:11], s29 offen sc1 lds
  s_add_u32 m0, s31, 4096
  s_add_u32 s29, s53, s27
  s_add_u32 s29, s29, 4096
  buffer_load_dwordx4 v2, s[8:11], s29 offen sc1 lds
  s_add_u32 m0, s31, 5120
  s_add_u32 s29, s53, s27
  s_add_u32 s29, s29, 5120
  buffer_load_dwordx4 v2, s[8:11], s29 offen sc1 lds
  s_add_u32 m0, s31, 6144
  s_add_u32 s29, s53, s27
  s_add_u32 s29, s29, 6144
  buffer_load_dwordx4 v2, s[8:11], s29 offen sc1 lds
  s_add_u32 m0, s31, 7168
  s_add_u32 s29, s53, s27
  s_add_u32 s29, s29, 7168
  buffer_load_dwordx4 v2, s[8:11], s29 offen sc1 lds
  s_add_u32 m0, s31, 32768
  s_add_u32 s29, s53, s28
  s_add_u32 s29, s29, 0
  buffer_load_dwordx4 v2, s[8:11], s29 offen sc1 lds
  s_add_u32 m0, s31, 33792
  s_add_u32 s29, s53, s28
  s_add_u32 s29, s29, 1024
  buffer_load_dwordx4 v2, s[8:11], s29 offen sc1 lds
  s_add_u32 m0, s31, 34816
  s_add_u32 s29, s53, s28
  s_add_u32 s29, s29, 2048
  buffer_load_dwordx4 v2, s[8:11], s29 offen sc1 lds
  s_add_u32 m0, s31, 35840
  s_add_u32 s29, s53, s28
  s_add_u32 s29, s29, 3072
  buffer_load_dwordx4 v2, s[8:11], s29 offen sc1 lds
  s_add_u32 m0, s31, 36864
  s_add_u32 s29, s53, s28
  s_add_u32 s29, s29, 4096
  buffer_load_dwordx4 v2, s[8:11], s29 offen sc1 lds
  s_add_u32 m0, s31, 37888
  s_add_u32 s29, s53, s28
  s_add_u32 s29, s29, 5120
  buffer_load_dwordx4 v2, s[8:11], s29 offen sc1 lds
  s_add_u32 m0, s31, 38912
  s_add_u32 s29, s53, s28
  s_add_u32 s29, s29, 6144
  buffer_load_dwordx4 v2, s[8:11], s29 offen sc1 lds
  s_add_u32 m0, s31, 39936
  s_add_u32 s29, s53, s28
  s_add_u32 s29, s29, 7168
  buffer_load_dwordx4 v2, s[8:11], s29 offen sc1 lds
  s_branch kb2_main2
kb2_fin:
  v_and_b32 v3, 15, v1
  v_bfe_u32 v11, v1, 4, 1
  v_mul_u32_u24 v11, 20480, v11
  v_lshrrev_b32 v4, 5, v1
  s_mul_i32 s30, s22, 20
  v_lshlrev_b32 v5, 2, v4
  v_add_u32 v5, 0, v5
  v_add_u32 v5, s30, v5
  v_lshrrev_b32 v6, 5, v5
  v_lshlrev_b32 v6, 10, v6
  v_bfe_u32 v7, v5, 3, 2
  v_lshlrev_b32 v7, 4, v7
  v_add_u32 v7, v7, v3
  v_lshlrev_b32 v7, 4, v7
  v_add_u32 v6, v6, v7
  v_bfe_u32 v7, v5, 2, 1
  v_lshlrev_b32 v7, 3, v7
  v_add_u32 v6, v6, v7
  v_add_u32 v32, v6, v11
  v_lshlrev_b32 v5, 2, v4
  v_add_u32 v5, 8, v5
  v_add_u32 v5, s30, v5
  v_lshrrev_b32 v6, 5, v5
  v_lshlrev_b32 v6, 10, v6
  v_bfe_u32 v7, v5, 3, 2
  v_lshlrev_b32 v7, 4, v7
  v_add_u32 v7, v7, v3
  v_lshlrev_b32 v7, 4, v7
  v_add_u32 v6, v6, v7
  v_bfe_u32 v7, v5, 2, 1
  v_lshlrev_b32 v7, 3, v7
  v_add_u32 v6, v6, v7
  v_add_u32 v33, v6, v11
  v_lshlrev_b32 v5, 2, v4
  v_add_u32 v5, 16, v5
  v_add_u32 v5, s30, v5
  v_lshrrev_b32 v6, 5, v5
  v_lshlrev_b32 v6, 10, v6
  v_bfe_u32 v7, v5, 3, 2
  v_lshlrev_b32 v7, 4, v7
  v_add_u32 v7, v7, v3
  v_lshlrev_b32 v7, 4, v7
  v_add_u32 v6, v6, v7
  v_bfe_u32 v7, v5, 2, 1
  v_lshlrev_b32 v7, 3, v7
  v_add_u32 v6, v6, v7
  v_add_u32 v34, v6, v11
  v_mov_b32 v5, 0x40000000
  v_cndmask_b32 v34, v5, v34, s[34:35]
  v_rcp_f32 v5, v14
  s_nop 0
  v_mul_f32 v112, v112, v5
  v_mul_f32 v113, v113, v5
  v_mul_f32 v114, v114, v5
  v_mul_f32 v115, v115, v5
  v_mul_f32 v116, v116, v5
  v_mul_f32 v117, v117, v5
  v_mul_f32 v118, v118, v5
  v_mul_f32 v119, v119, v5
  v_mul_f32 v120, v120, v5
  v_mul_f32 v121, v121, v5
  v_mul_f32 v122, v122, v5
  v_mul_f32 v123, v123, v5
  v_cvt_pk_bf16_f32 v40, v112, v113
  v_cvt_pk_bf16_f32 v41, v114, v115
  v_cvt_pk_bf16_f32 v42, v116, v117
  v_cvt_pk_bf16_f32 v43, v118, v119
  v_cvt_pk_bf16_f32 v44, v120, v121
  v_cvt_pk_bf16_f32 v45, v122, v123
  s_add_u32 s31, s52, 0
  s_mul_i32 s31, s31, 40960
  s_add_u32 s31, s31, 0xf200000
  buffer_store_dwordx2 v[40:41], v32, s[8:11], s31 offen sc1
  buffer_store_dwordx2 v[42:43], v33, s[8:11], s31 offen sc1
  buffer_store_dwordx2 v[44:45], v34, s[8:11], s31 offen sc1
  v_rcp_f32 v5, v15
  s_nop 0
  v_mul_f32 v128, v128, v5
  v_mul_f32 v129, v129, v5
  v_mul_f32 v130, v130, v5
  v_mul_f32 v131, v131, v5
  v_mul_f32 v132, v132, v5
  v_mul_f32 v133, v133, v5
  v_mul_f32 v134, v134, v5
  v_mul_f32 v135, v135, v5
  v_mul_f32 v136, v136, v5
  v_mul_f32 v137, v137, v5
  v_mul_f32 v138, v138, v5
  v_mul_f32 v139, v139, v5
  v_cvt_pk_bf16_f32 v48, v128, v129
  v_cvt_pk_bf16_f32 v49, v130, v131
  v_cvt_pk_bf16_f32 v50, v132, v133
  v_cvt_pk_bf16_f32 v51, v134, v135
  v_cvt_pk_bf16_f32 v52, v136, v137
  v_cvt_pk_bf16_f32 v53, v138, v139
  s_add_u32 s31, s52, 1
  s_mul_i32 s31, s31, 40960
  s_add_u32 s31, s31, 0xf200000
  buffer_store_dwordx2 v[48:49], v32, s[8:11], s31 offen sc1
  buffer_store_dwordx2 v[50:51], v33, s[8:11], s31 offen sc1
  buffer_store_dwordx2 v[52:53], v34, s[8:11], s31 offen sc1
  s_waitcnt vmcnt(0)
  s_barrier
  s_cmp_eq_u32 s21, 0
  s_cbranch_scc0 arr_96
  s_mov_b64 s[24:25], exec
  s_mov_b64 exec, 1
  v_mov_b32 v3, 0
  v_mov_b32 v4, 1
  buffer_atomic_add v4, v3, s[8:11], s48 offen
  s_mov_b64 exec, s[24:25]
arr_96:
  v_and_b32 v5, 15, v1
  v_lshrrev_b32 v6, 4, v1
  v_and_b32 v7, 1, v6
  v_lshlrev_b32 v7, 10, v7
  v_lshrrev_b32 v8, 1, v6
  v_lshlrev_b32 v8, 5, v8
  v_add_u32 v8, v8, v5
  v_lshlrev_b32 v8, 4, v8
  v_add_u32 v9, v7, v8
  s_lshr_b32 s26, s2, 2
  s_mul_i32 s27, s26, 81920
  s_lshl_b32 s28, s50, 11
  s_add_u32 s27, s27, s28
  s_add_u32 s27, s27, 0x1400000
  s_add_u32 s28, s27, 0
  buffer_load_dwordx4 v[16:19], v9, s[8:11], s28 offen sc1
  s_add_u32 s28, s27, 256
  buffer_load_dwordx4 v[20:23], v9, s[8:11], s28 offen sc1
  s_add_u32 s28, s27, 2048
  buffer_load_dwordx4 v[24:27], v9, s[8:11], s28 offen sc1
  s_add_u32 s28, s27, 2304
  buffer_load_dwordx4 v[28:31], v9, s[8:11], s28 offen sc1
  s_cmp_lt_u32 s21, 2
  s_cbranch_scc0 g3_97
  s_add_u32 s28, s27, 4096
  buffer_load_dwordx4 v[32:35], v9, s[8:11], s28 offen sc1
  s_add_u32 s28, s27, 4352
  buffer_load_dwordx4 v[36:39], v9, s[8:11], s28 offen sc1
g3_97:
  s_mov_b32 s45, 0
  v_mov_b32 v3, 0
aw_98:
  buffer_load_dword v4, v3, s[8:11], s48 offen sc1
  s_add_u32 s45, s45, 1
  s_waitcnt vmcnt(0)
  v_readfirstlane_b32 s29, v4
  s_cmp_ge_u32 s29, 32
  s_cbranch_scc1 aw_98_ok
  s_cmp_lt_u32 s45, 400000
  s_cbranch_scc1 aw_98
  s_branch kb2_abort
aw_98_ok:
  s_mul_i32 s28, s26, 40960
  s_mul_i32 s31, s21, 10240
  s_add_u32 s28, s28, s31
  s_add_u32 s28, s28, 0xf200000
  s_add_u32 m0, s31, 0
  s_add_u32 s29, s28, 0
  buffer_load_dwordx4 v2, s[8:11], s29 offen sc1 lds
  s_add_u32 m0, s31, 1024
  s_add_u32 s29, s28, 1024
  buffer_load_dwordx4 v2, s[8:11], s29 offen sc1 lds
  s_add_u32 m0, s31, 2048
  s_add_u32 s29, s28, 2048
  buffer_load_dwordx4 v2, s[8:11], s29 offen sc1 lds
  s_add_u32 m0, s31, 3072
  s_add_u32 s29, s28, 3072
  buffer_load_dwordx4 v2, s[8:11], s29 offen sc1 lds
  s_add_u32 m0, s31, 4096
  s_add_u32 s29, s28, 4096
  buffer_load_dwordx4 v2, s[8:11], s29 offen sc1 lds
  s_add_u32 m0, s31, 5120
  s_add_u32 s29, s28, 5120
  buffer_load_dwordx4 v2, s[8:11], s29 offen sc1 lds
  s_add_u32 m0, s31, 6144
  s_add_u32 s29, s28, 6144
  buffer_load_dwordx4 v2, s[8:11], s29 offen sc1 lds
  s_add_u32 m0, s31, 7168
  s_add_u32 s29, s28, 7168
  buffer_load_dwordx4 v2, s[8:11], s29 offen sc1 lds
  s_add_u32 m0, s31, 8192
  s_add_u32 s29, s28, 8192
  buffer_load_dwordx4 v2, s[8:11], s29 offen sc1 lds
  s_add_u32 m0, s31, 9216
  s_add_u32 s29, s28, 9216
  buffer_load_dwordx4 v2, s[8:11], s29 offen sc1 lds
  s_waitcnt vmcnt(0)
  s_barrier
  ds_read_b128 v[80:83], v2 offset:0
  ds_read_b128 v[84:87], v2 offset:20480
  ds_read_b128 v[88:91], v2 offset:1024
  ds_read_b128 v[92:95], v2 offset:21504
  ds_read_b128 v[96:99], v2 offset:2048
  ds_read_b128 v[100:103], v2 offset:22528
  s_waitcnt lgkmcnt(4)
  v_mfma_f32_16x16x32_bf16 v[48:51], a[0:3], v[80:83], 0
  v_mfma_f32_16x16x32_bf16 v[52:55], a[0:3], v[84:87], 0
  v_mfma_f32_16x16x32_bf16 v[56:59], a[80:83], v[80:83], 0
  v_mfma_f32_16x16x32_bf16 v[60:63], a[80:83], v[84:87], 0
  v_mfma_f32_16x16x32_bf16 v[64:67], a[160:163], v[80:83], 0
  v_mfma_f32_16x16x32_bf16 v[68:71], a[160:163], v[84:87], 0
  ds_read_b128 v[80:83], v2 offset:3072
  ds_read_b128 v[84:87], v2 offset:23552
  s_waitcnt lgkmcnt(4)
  v_mfma_f32_16x16x32_bf16 v[48:51], a[4:7], v[88:91], v[48:51]
  v_mfma_f32_16x16x32_bf16 v[52:55], a[4:7], v[92:95], v[52:55]
  v_mfma_f32_16x16x32_bf16 v[56:59], a[84:87], v[88:91], v[56:59]
  v_mfma_f32_16x16x32_bf16 v[60:63], a[84:87], v[92:95], v[60:63]
  v_mfma_f32_16x16x32_bf16 v[64:67], a[164:167], v[88:91], v[64:67]
  v_mfma_f32_16x16x32_bf16 v[68:71], a[164:167], v[92:95], v[68:71]
  ds_read_b128 v[88:91], v2 offset:4096
  ds_read_b128 v[92:95], v2 offset:24576
  s_waitcnt lgkmcnt(4)
  v_mfma_f32_16x16x32_bf16 v[48:51], a[8:11], v[96:99], v[48:51]
  v_mfma_f32_16x16x32_bf16 v[52:55], a[8:11], v[100:103], v[52:55]
  v_mfma_f32_16x16x32_bf16 v[56:59], a[88:91], v[96:99], v[56:59]
  v_mfma_f32_16x16x32_bf16 v[60:63], a[88:91], v[100:103], v[60:63]
  v_mfma_f32_16x16x32_bf16 v[64:67], a[168:171], v[96:99], v[64:67]
  v_mfma_f32_16x16x32_bf16 v[68:71], a[168:171], v[100:103], v[68:71]
  ds_read_b128 v[96:99], v2 offset:5120
  ds_read_b128 v[100:103], v2 offset:25600
  s_waitcnt lgkmcnt(4)
  v_mfma_f32_16x16x32_bf16 v[48:51], a[12:15], v[80:83], v[48:51]
  v_mfma_f32_16x16x32_bf16 v[52:55], a[12:15], v[84:87], v[52:55]
  v_mfma_f32_16x16x32_bf16 v[56:59], a[92:95], v[80:83], v[56:59]
  v_mfma_f32_16x16x32_bf16 v[60:63], a[92:95], v[84:87], v[60:63]
  v_mfma_f32_16x16x32_bf16 v[64:67], a[172:175], v[80:83], v[64:67]
  v_mfma_f32_16x16x32_bf16 v[68:71], a[172:175], v[84:87], v[68:71]
  ds_read_b128 v[80:83], v2 offset:6144
  ds_read_b128 v[84:87], v2 offset:26624
  s_waitcnt lgkmcnt(4)
  v_mfma_f32_16x16x32_bf16 v[48:51], a[16:19], v[88:91], v[48:51]
  v_mfma_f32_16x16x32_bf16 v[52:55], a[16:19], v[92:95], v[52:55]
  v_mfma_f32_16x16x32_bf16 v[56:59], a[96:99], v[88:91], v[56:59]
  v_mfma_f32_16x16x32_bf16 v[60:63], a[96:99], v[92:95], v[60:63]
  v_mfma_f32_16x16x32_bf16 v[64:67], a[176:179], v[88:91], v[64:67]
  v_mfma_f32_16x16x32_bf16 v[68:71], a[176:179], v[92:95], v[68:71]
  ds_read_b128 v[88:91], v2 offset:7168
  ds_read_b128 v[92:95], v2 offset:27648
  s_waitcnt lgkmcnt(4)
  v_mfma_f32_16x16x32_bf16 v[48:51], a[20:23], v[96:99], v[48:51]
  v_mfma_f32_16x16x32_bf16 v[52:55], a[20:23], v[100:103], v[52:55]
  v_mfma_f32_16x16x32_bf16 v[56:59], a[100:103], v[96:99], v[56:59]
  v_mfma_f32_16x16x32_bf16 v[60:63], a[100:103], v[100:103], v[60:63]
  v_mfma_f32_16x16x32_bf16 v[64:67], a[180:183], v[96:99], v[64:67]
  v_mfma_f32_16x16x32_bf16 v[68:71], a[180:183], v[100:103], v[68:71]
  ds_read_b128 v[96:99], v2 offset:8192
  ds_read_b128 v[100:103], v2 offset:28672
  s_waitcnt lgkmcnt(4)
  v_mfma_f32_16x16x32_bf16 v[48:51], a[24:27], v[80:83], v[48:51]
  v_mfma_f32_16x16x32_bf16 v[52:55], a[24:27], v[84:87], v[52:55]
  v_mfma_f32_16x16x32_bf16 v[56:59], a[104:107], v[80:83], v[56:59]
  v_mfma_f32_16x16x32_bf16 v[60:63], a[104:107], v[84:87], v[60:63]
  v_mfma_f32_16x16x32_bf16 v[64:67], a[184:187], v[80:83], v[64:67]
  v_mfma_f32_16x16x32_bf16 v[68:71], a[184:187], v[84:87], v[68:71]
  ds_read_b128 v[80:83], v2 offset:9216
  ds_read_b128 v[84:87], v2 offset:29696
  s_waitcnt lgkmcnt(4)
  v_mfma_f32_16x16x32_bf16 v[48:51], a[28:31], v[88:91], v[48:51]
  v_mfma_f32_16x16x32_bf16 v[52:55], a[28:31], v[92:95], v[52:55]
  v_mfma_f32_16x16x32_bf16 v[56:59], a[108:111], v[88:91], v[56:59]
  v_mfma_f32_16x16x32_bf16 v[60:63], a[108:111], v[92:95], v[60:63]
  v_mfma_f32_16x16x32_bf16 v[64:67], a[188:191], v[88:91], v[64:67]
  v_mfma_f32_16x16x32_bf16 v[68:71], a[188:191], v[92:95], v[68:71]
  ds_read_b128 v[88:91], v2 offset:10240
  ds_read_b128 v[92:95], v2 offset:30720
  s_waitcnt lgkmcnt(4)
  v_mfma_f32_16x16x32_bf16 v[48:51], a[32:35], v[96:99], v[48:51]
  v_mfma_f32_16x16x32_bf16 v[52:55], a[32:35], v[100:103], v[52:55]
  v_mfma_f32_16x16x32_bf16 v[56:59], a[112:115], v[96:99], v[56:59]
  v_mfma_f32_16x16x32_bf16 v[60:63], a[112:115], v[100:103], v[60:63]
  v_mfma_f32_16x16x32_bf16 v[64:67], a[192:195], v[96:99], v[64:67]
  v_mfma_f32_16x16x32_bf16 v[68:71], a[192:195], v[100:103], v[68:71]
  ds_read_b128 v[96:99], v2 offset:11264
  ds_read_b128 v[100:103], v2 offset:31744
  s_waitcnt lgkmcnt(4)
  v_mfma_f32_16x16x32_bf16 v[48:51], a[36:39], v[80:83], v[48:51]
  v_mfma_f32_16x16x32_bf16 v[52:55], a[36:39], v[84:87], v[52:55]
  v_mfma_f32_16x16x32_bf16 v[56:59], a[116:119], v[80:83], v[56:59]
  v_mfma_f32_16x16x32_bf16 v[60:63], a[116:119], v[84:87], v[60:63]
  v_mfma_f32_16x16x32_bf16 v[64:67], a[196:199], v[80:83], v[64:67]
  v_mfma_f32_16x16x32_bf16 v[68:71], a[196:199], v[84:87], v[68:71]
  ds_read_b128 v[80:83], v2 offset:12288
  ds_read_b128 v[84:87], v2 offset:32768
  s_waitcnt lgkmcnt(4)
  v_mfma_f32_16x16x32_bf16 v[48:51], a[40:43], v[88:91], v[48:51]
  v_mfma_f32_16x16x32_bf16 v[52:55], a[40:43], v[92:95], v[52:55]
  v_mfma_f32_16x16x32_bf16 v[56:59], a[120:123], v[88:91], v[56:59]
  v_mfma_f32_16x16x32_bf16 v[60:63], a[120:123], v[92:95], v[60:63]
  v_mfma_f32_16x16x32_bf16 v[64:67], a[200:203], v[88:91], v[64:67]
  v_mfma_f32_16x16x32_bf16 v[68:71], a[200:203], v[92:95], v[68:71]
  ds_read_b128 v[88:91], v2 offset:13312
  ds_read_b128 v[92:95], v2 offset:33792
  s_waitcnt lgkmcnt(4)
  v_mfma_f32_16x16x32_bf16 v[48:51], a[44:47], v[96:99], v[48:51]
  v_mfma_f32_16x16x32_bf16 v[52:55], a[44:47], v[100:103], v[52:55]
  v_mfma_f32_16x16x32_bf16 v[56:59], a[124:127], v[96:99], v[56:59]
  v_mfma_f32_16x16x32_bf16 v[60:63], a[124:127], v[100:103], v[60:63]
  v_mfma_f32_16x16x32_bf16 v[64:67], a[204:207], v[96:99], v[64:67]
  v_mfma_f32_16x16x32_bf16 v[68:71], a[204:207], v[100:103], v[68:71]
  ds_read_b128 v[96:99], v2 offset:14336
  ds_read_b128 v[100:103], v2 offset:34816
  s_waitcnt lgkmcnt(4)
  v_mfma_f32_16x16x32_bf16 v[48:51], a[48:51], v[80:83], v[48:51]
  v_mfma_f32_16x16x32_bf16 v[52:55], a[48:51], v[84:87], v[52:55]
  v_mfma_f32_16x16x32_bf16 v[56:59], a[128:131], v[80:83], v[56:59]
  v_mfma_f32_16x16x32_bf16 v[60:63], a[128:131], v[84:87], v[60:63]
  v_mfma_f32_16x16x32_bf16 v[64:67], a[208:211], v[80:83], v[64:67]
  v_mfma_f32_16x16x32_bf16 v[68:71], a[208:211], v[84:87], v[68:71]
  ds_read_b128 v[80:83], v2 offset:15360
  ds_read_b128 v[84:87], v2 offset:35840
  s_waitcnt lgkmcnt(4)
  v_mfma_f32_16x16x32_bf16 v[48:51], a[52:55], v[88:91], v[48:51]
  v_mfma_f32_16x16x32_bf16 v[52:55], a[52:55], v[92:95], v[52:55]
  v_mfma_f32_16x16x32_bf16 v[56:59], a[132:135], v[88:91], v[56:59]
  v_mfma_f32_16x16x32_bf16 v[60:63], a[132:135], v[92:95], v[60:63]
  v_mfma_f32_16x16x32_bf16 v[64:67], a[212:215], v[88:91], v[64:67]
  v_mfma_f32_16x16x32_bf16 v[68:71], a[212:215], v[92:95], v[68:71]
  ds_read_b128 v[88:91], v2 offset:16384
  ds_read_b128 v[92:95], v2 offset:36864
  s_waitcnt lgkmcnt(4)
  v_mfma_f32_16x16x32_bf16 v[48:51], a[56:59], v[96:99], v[48:51]
  v_mfma_f32_16x16x32_bf16 v[52:55], a[56:59], v[100:103], v[52:55]
  v_mfma_f32_16x16x32_bf16 v[56:59], a[136:139], v[96:99], v[56:59]
  v_mfma_f32_16x16x32_bf16 v[60:63], a[136:139], v[100:103], v[60:63]
  v_mfma_f32_16x16x32_bf16 v[64:67], a[216:219], v[96:99], v[64:67]
  v_mfma_f32_16x16x32_bf16 v[68:71], a[216:219], v[100:103], v[68:71]
  ds_read_b128 v[96:99], v2 offset:17408
  ds_read_b128 v[100:103], v2 offset:37888
  s_waitcnt lgkmcnt(4)
  v_mfma_f32_16x16x32_bf16 v[48:51], a[60:63], v[80:83], v[48:51]
  v_mfma_f32_16x16x32_bf16 v[52:55], a[60:63], v[84:87], v[52:55]
  v_mfma_f32_16x16x32_bf16 v[56:59], a[140:143], v[80:83], v[56:59]
  v_mfma_f32_16x16x32_bf16 v[60:63], a[140:143], v[84:87], v[60:63]
  v_mfma_f32_16x16x32_bf16 v[64:67], a[220:223], v[80:83], v[64:67]
  v_mfma_f32_16x16x32_bf16 v[68:71], a[220:223], v[84:87], v[68:71]
  ds_read_b128 v[80:83], v2 offset:18432
  ds_read_b128 v[84:87], v2 offset:38912
  s_waitcnt lgkmcnt(4)
  v_mfma_f32_16x16x32_bf16 v[48:51], a[64:67], v[88:91], v[48:51]
  v_mfma_f32_16x16x32_bf16 v[52:55], a[64:67], v[92:95], v[52:55]
  v_mfma_f32_16x16x32_bf16 v[56:59], a[144:147], v[88:91], v[56:59]
  v_mfma_f32_16x16x32_bf16 v[60:63], a[144:147], v[92:95], v[60:63]
  v_mfma_f32_16x16x32_bf16 v[64:67], a[224:227], v[88:91], v[64:67]
  v_mfma_f32_16x16x32_bf16 v[68:71], a[224:227], v[92:95], v[68:71]
  ds_read_b128 v[88:91], v2 offset:19456
  ds_read_b128 v[92:95], v2 offset:39936
  s_waitcnt lgkmcnt(4)
  v_mfma_f32_16x16x32_bf16 v[48:51], a[68:71], v[96:99], v[48:51]
  v_mfma_f32_16x16x32_bf16 v[52:55], a[68:71], v[100:103], v[52:55]
  v_mfma_f32_16x16x32_bf16 v[56:59], a[148:151], v[96:99], v[56:59]
  v_mfma_f32_16x16x32_bf16 v[60:63], a[148:151], v[100:103], v[60:63]
  v_mfma_f32_16x16x32_bf16 v[64:67], a[228:231], v[96:99], v[64:67]
  v_mfma_f32_16x16x32_bf16 v[68:71], a[228:231], v[100:103], v[68:71]
  s_waitcnt lgkmcnt(2)
  v_mfma_f32_16x16x32_bf16 v[48:51], a[72:75], v[80:83], v[48:51]
  v_mfma_f32_16x16x32_bf16 v[52:55], a[72:75], v[84:87], v[52:55]
  v_mfma_f32_16x16x32_bf16 v[56:59], a[152:155], v[80:83], v[56:59]
  v_mfma_f32_16x16x32_bf16 v[60:63], a[152:155], v[84:87], v[60:63]
  v_mfma_f32_16x16x32_bf16 v[64:67], a[232:235], v[80:83], v[64:67]
  v_mfma_f32_16x16x32_bf16 v[68:71], a[232:235], v[84:87], v[68:71]
  s_waitcnt lgkmcnt(0)
  v_mfma_f32_16x16x32_bf16 v[48:51], a[76:79], v[88:91], v[48:51]
  v_mfma_f32_16x16x32_bf16 v[52:55], a[76:79], v[92:95], v[52:55]
  v_mfma_f32_16x16x32_bf16 v[56:59], a[156:159], v[88:91], v[56:59]
  v_mfma_f32_16x16x32_bf16 v[60:63], a[156:159], v[92:95], v[60:63]
  v_mfma_f32_16x16x32_bf16 v[64:67], a[236:239], v[88:91], v[64:67]
  v_mfma_f32_16x16x32_bf16 v[68:71], a[236:239], v[92:95], v[68:71]
  s_nop 7
  v_mul_u32_u24 v10, 1280, v5
  v_lshlrev_b32 v11, 3, v6
  v_add_u32 v10, v10, v11
  s_mul_i32 s30, s26, 40960
  s_lshl_b32 s31, s50, 5
  s_add_u32 s30, s30, s31
  v_add_f32 v48, v48, v16
  v_add_f32 v49, v49, v17
  v_add_f32 v50, v50, v18
  v_add_f32 v51, v51, v19
  v_cvt_pk_bf16_f32 v48, v48, v49
  v_cvt_pk_bf16_f32 v49, v50, v51
  s_add_u32 s28, s30, 0
  buffer_store_dwordx2 v[48:49], v10, s[16:19], s28 offen
  v_add_f32 v52, v52, v20
  v_add_f32 v53, v53, v21
  v_add_f32 v54, v54, v22
  v_add_f32 v55, v55, v23
  v_cvt_pk_bf16_f32 v52, v52, v53
  v_cvt_pk_bf16_f32 v53, v54, v55
  s_add_u32 s28, s30, 20480
  buffer_store_dwordx2 v[52:53], v10, s[16:19], s28 offen
  v_add_f32 v56, v56, v24
  v_add_f32 v57, v57, v25
  v_add_f32 v58, v58, v26
  v_add_f32 v59, v59, v27
  v_cvt_pk_bf16_f32 v56, v56, v57
  v_cvt_pk_bf16_f32 v57, v58, v59
  s_add_u32 s28, s30, 32
  buffer_store_dwordx2 v[56:57], v10, s[16:19], s28 offen
  v_add_f32 v60, v60, v28
  v_add_f32 v61, v61, v29
  v_add_f32 v62, v62, v30
  v_add_f32 v63, v63, v31
  v_cvt_pk_bf16_f32 v60, v60, v61
  v_cvt_pk_bf16_f32 v61, v62, v63
  s_add_u32 s28, s30, 20512
  buffer_store_dwordx2 v[60:61], v10, s[16:19], s28 offen
  s_cmp_lt_u32 s21, 2
  s_cbranch_scc0 g3_99
  v_add_f32 v64, v64, v32
  v_add_f32 v65, v65, v33
  v_add_f32 v66, v66, v34
  v_add_f32 v67, v67, v35
  v_cvt_pk_bf16_f32 v64, v64, v65
  v_cvt_pk_bf16_f32 v65, v66, v67
  s_add_u32 s28, s30, 64
  buffer_store_dwordx2 v[64:65], v10, s[16:19], s28 offen
  v_add_f32 v68, v68, v36
  v_add_f32 v69, v69, v37
  v_add_f32 v70, v70, v38
  v_add_f32 v71, v71, v39
  v_cvt_pk_bf16_f32 v68, v68, v69
  v_cvt_pk_bf16_f32 v69, v70, v71
  s_add_u32 s28, s30, 20544
  buffer_store_dwordx2 v[68:69], v10, s[16:19], s28 offen
g3_99:
  s_endpgm
kb2_abort:
  s_load_dwordx2 s[6:7], s[0:1], 88
  v_mov_b32 v2, 80
  v_mov_b32 v3, 1
  s_waitcnt lgkmcnt(0)
  s_mov_b64 exec, 1
  global_atomic_add v2, v3, s[6:7]
  s_waitcnt vmcnt(0)
kb2_exit:
  s_endpgm

.section .rodata,"a"
.p2align 6
.amdhsa_kernel kb2_kernel
  .amdhsa_next_free_vgpr 512
  .amdhsa_next_free_sgpr 102
  .amdhsa_accum_offset 256
  .amdhsa_group_segment_fixed_size 0
  .amdhsa_kernarg_size 104
  .amdhsa_user_sgpr_count 2
  .amdhsa_user_sgpr_kernarg_segment_ptr 1
  .amdhsa_system_sgpr_workgroup_id_x 1
.end_amdhsa_kernel
```

```asm
; @launch kernel=prep_kernel grid=(256,1,1) block=(256,1,1) lds=32768
; @launch kernel=ka1_kernel grid=(256,1,1) block=(256,1,1) lds=163840
; @launch kernel=kb1_kernel grid=(256,1,1) block=(256,1,1) lds=135168
; @launch kernel=ka2_kernel grid=(256,1,1) block=(256,1,1) lds=163840
; @launch kernel=kb2_kernel grid=(256,1,1) block=(256,1,1) lds=135168
.amdgcn_target "amdgcn-amd-amdhsa--gfx950"
.text
.globl prep_kernel
.p2align 8
.type prep_kernel,@function
prep_kernel:
  s_cmp_ge_u32 s2, 256
  s_cbranch_scc1 k0_exit
  s_load_dwordx2 s[38:39], s[0:1], 8
  s_load_dwordx4 s[40:43], s[0:1], 32
  s_load_dwordx2 s[4:5], s[0:1], 96
  v_lshrrev_b32 v1, 6, v0
  s_nop 0
  v_readfirstlane_b32 s21, v1
  v_and_b32 v1, 63, v0
  v_lshlrev_b32 v2, 4, v1
  s_waitcnt lgkmcnt(0)
  s_mov_b32 s8, s4
  s_and_b32 s9, s5, 0xffff
  s_mov_b32 s10, 0x10000000
  s_mov_b32 s11, 0x20000
  s_mov_b32 s12, s40
  s_and_b32 s13, s41, 0xffff
  s_mov_b32 s14, 0x780000
  s_mov_b32 s15, 0x20000
  s_mov_b32 s16, s42
  s_and_b32 s17, s43, 0xffff
  s_mov_b32 s18, 0x780000
  s_mov_b32 s19, 0x20000
  s_and_b32 s22, s2, 7
  s_lshl_b32 s22, s22, 2
  s_lshr_b32 s23, s2, 6
  s_add_u32 s22, s22, s23
  s_bfe_u32 s23, s2, 0x30003
  v_lshrrev_b32 v8, 3, v1
  v_bfe_u32 v9, v1, 1, 2
  v_and_b32 v10, 1, v1
  s_mul_i32 s24, s22, 245760
  s_mul_i32 s25, s23, 160
  s_add_u32 s24, s24, s25
  s_add_u32 s26, s21, 0
  s_cmp_lt_u32 s26, 30
  s_cbranch_scc0 wd_1
  s_lshl_b32 s27, s26, 3
  v_add_u32 v11, s27, v8
  v_mul_u32_u24 v12, 52429, v11
  v_lshrrev_b32 v12, 18, v12
  v_mul_u32_u24 v13, 5, v12
  v_sub_u32 v13, v11, v13
  v_lshlrev_b32 v12, 2, v12
  v_add_u32 v12, v12, v9
  v_mul_u32_u24 v12, 1280, v12
  v_lshlrev_b32 v13, 5, v13
  v_add_u32 v12, v12, v13
  v_lshlrev_b32 v13, 4, v10
  v_add_u32 v12, v12, v13
  s_lshl_b32 m0, s26, 10
  s_nop 0
  buffer_load_dwordx4 v12, s[16:19], s24 offen lds
wd_1:
  s_add_u32 s26, s21, 4
  s_cmp_lt_u32 s26, 30
  s_cbranch_scc0 wd_2
  s_lshl_b32 s27, s26, 3
  v_add_u32 v11, s27, v8
  v_mul_u32_u24 v12, 52429, v11
  v_lshrrev_b32 v12, 18, v12
  v_mul_u32_u24 v13, 5, v12
  v_sub_u32 v13, v11, v13
  v_lshlrev_b32 v12, 2, v12
  v_add_u32 v12, v12, v9
  v_mul_u32_u24 v12, 1280, v12
  v_lshlrev_b32 v13, 5, v13
  v_add_u32 v12, v12, v13
  v_lshlrev_b32 v13, 4, v10
  v_add_u32 v12, v12, v13
  s_lshl_b32 m0, s26, 10
  s_nop 0
  buffer_load_dwordx4 v12, s[16:19], s24 offen lds
wd_2:
  s_add_u32 s26, s21, 8
  s_cmp_lt_u32 s26, 30
  s_cbranch_scc0 wd_3
  s_lshl_b32 s27, s26, 3
  v_add_u32 v11, s27, v8
  v_mul_u32_u24 v12, 52429, v11
  v_lshrrev_b32 v12, 18, v12
  v_mul_u32_u24 v13, 5, v12
  v_sub_u32 v13, v11, v13
  v_lshlrev_b32 v12, 2, v12
  v_add_u32 v12, v12, v9
  v_mul_u32_u24 v12, 1280, v12
  v_lshlrev_b32 v13, 5, v13
  v_add_u32 v12, v12, v13
  v_lshlrev_b32 v13, 4, v10
  v_add_u32 v12, v12, v13
  s_lshl_b32 m0, s26, 10
  s_nop 0
  buffer_load_dwordx4 v12, s[16:19], s24 offen lds
wd_3:
  s_add_u32 s26, s21, 12
  s_cmp_lt_u32 s26, 30
  s_cbranch_scc0 wd_4
  s_lshl_b32 s27, s26, 3
  v_add_u32 v11, s27, v8
  v_mul_u32_u24 v12, 52429, v11
  v_lshrrev_b32 v12, 18, v12
  v_mul_u32_u24 v13, 5, v12
  v_sub_u32 v13, v11, v13
  v_lshlrev_b32 v12, 2, v12
  v_add_u32 v12, v12, v9
  v_mul_u32_u24 v12, 1280, v12
  v_lshlrev_b32 v13, 5, v13
  v_add_u32 v12, v12, v13
  v_lshlrev_b32 v13, 4, v10
  v_add_u32 v12, v12, v13
  s_lshl_b32 m0, s26, 10
  s_nop 0
  buffer_load_dwordx4 v12, s[16:19], s24 offen lds
wd_4:
  s_add_u32 s26, s21, 16
  s_cmp_lt_u32 s26, 30
  s_cbranch_scc0 wd_5
  s_lshl_b32 s27, s26, 3
  v_add_u32 v11, s27, v8
  v_mul_u32_u24 v12, 52429, v11
  v_lshrrev_b32 v12, 18, v12
  v_mul_u32_u24 v13, 5, v12
  v_sub_u32 v13, v11, v13
  v_lshlrev_b32 v12, 2, v12
  v_add_u32 v12, v12, v9
  v_mul_u32_u24 v12, 1280, v12
  v_lshlrev_b32 v13, 5, v13
  v_add_u32 v12, v12, v13
  v_lshlrev_b32 v13, 4, v10
  v_add_u32 v12, v12, v13
  s_lshl_b32 m0, s26, 10
  s_nop 0
  buffer_load_dwordx4 v12, s[16:19], s24 offen lds
wd_5:
  s_add_u32 s26, s21, 20
  s_cmp_lt_u32 s26, 30
  s_cbranch_scc0 wd_6
  s_lshl_b32 s27, s26, 3
  v_add_u32 v11, s27, v8
  v_mul_u32_u24 v12, 52429, v11
  v_lshrrev_b32 v12, 18, v12
  v_mul_u32_u24 v13, 5, v12
  v_sub_u32 v13, v11, v13
  v_lshlrev_b32 v12, 2, v12
  v_add_u32 v12, v12, v9
  v_mul_u32_u24 v12, 1280, v12
  v_lshlrev_b32 v13, 5, v13
  v_add_u32 v12, v12, v13
  v_lshlrev_b32 v13, 4, v10
  v_add_u32 v12, v12, v13
  s_lshl_b32 m0, s26, 10
  s_nop 0
  buffer_load_dwordx4 v12, s[16:19], s24 offen lds
wd_6:
  s_add_u32 s26, s21, 24
  s_cmp_lt_u32 s26, 30
  s_cbranch_scc0 wd_7
  s_lshl_b32 s27, s26, 3
  v_add_u32 v11, s27, v8
  v_mul_u32_u24 v12, 52429, v11
  v_lshrrev_b32 v12, 18, v12
  v_mul_u32_u24 v13, 5, v12
  v_sub_u32 v13, v11, v13
  v_lshlrev_b32 v12, 2, v12
  v_add_u32 v12, v12, v9
  v_mul_u32_u24 v12, 1280, v12
  v_lshlrev_b32 v13, 5, v13
  v_add_u32 v12, v12, v13
  v_lshlrev_b32 v13, 4, v10
  v_add_u32 v12, v12, v13
  s_lshl_b32 m0, s26, 10
  s_nop 0
  buffer_load_dwordx4 v12, s[16:19], s24 offen lds
wd_7:
  s_add_u32 s26, s21, 28
  s_cmp_lt_u32 s26, 30
  s_cbranch_scc0 wd_8
  s_lshl_b32 s27, s26, 3
  v_add_u32 v11, s27, v8
  v_mul_u32_u24 v12, 52429, v11
  v_lshrrev_b32 v12, 18, v12
  v_mul_u32_u24 v13, 5, v12
  v_sub_u32 v13, v11, v13
  v_lshlrev_b32 v12, 2, v12
  v_add_u32 v12, v12, v9
  v_mul_u32_u24 v12, 1280, v12
  v_lshlrev_b32 v13, 5, v13
  v_add_u32 v12, v12, v13
  v_lshlrev_b32 v13, 4, v10
  v_add_u32 v12, v12, v13
  s_lshl_b32 m0, s26, 10
  s_nop 0
  buffer_load_dwordx4 v12, s[16:19], s24 offen lds
wd_8:
  v_and_b32 v8, 15, v1
  v_lshrrev_b32 v9, 2, v8
  v_lshlrev_b32 v9, 3, v9
  v_and_b32 v10, 3, v8
  v_add_u32 v9, v9, v10
  v_mul_u32_u24 v9, 12288, v9
  v_lshrrev_b32 v10, 4, v1
  v_lshlrev_b32 v10, 4, v10
  v_add_u32 v9, v9, v10
  v_add_u32 v10, 49152, v9
  s_mul_i32 s24, s22, 384
  s_mul_i32 s25, s21, 1966080
  s_add_u32 s24, s24, s25
  s_add_u32 s27, s24, 0
  buffer_load_dwordx4 a[120:123], v9, s[12:15], s27 offen offset:0
  buffer_load_dwordx4 a[124:127], v9, s[12:15], s27 offen offset:64
  buffer_load_dwordx4 a[128:131], v9, s[12:15], s27 offen offset:128
  buffer_load_dwordx4 a[132:135], v9, s[12:15], s27 offen offset:192
  buffer_load_dwordx4 a[136:139], v9, s[12:15], s27 offen offset:256
  buffer_load_dwordx4 a[140:143], v9, s[12:15], s27 offen offset:320
  buffer_load_dwordx4 a[144:147], v10, s[12:15], s27 offen offset:0
  buffer_load_dwordx4 a[148:151], v10, s[12:15], s27 offen offset:64
  buffer_load_dwordx4 a[152:155], v10, s[12:15], s27 offen offset:128
  buffer_load_dwordx4 a[156:159], v10, s[12:15], s27 offen offset:192
  buffer_load_dwordx4 a[160:163], v10, s[12:15], s27 offen offset:256
  buffer_load_dwordx4 a[164:167], v10, s[12:15], s27 offen offset:320
  s_add_u32 s27, s24, 393216
  buffer_load_dwordx4 a[168:171], v9, s[12:15], s27 offen offset:0
  buffer_load_dwordx4 a[172:175], v9, s[12:15], s27 offen offset:64
  buffer_load_dwordx4 a[176:179], v9, s[12:15], s27 offen offset:128
  buffer_load_dwordx4 a[180:183], v9, s[12:15], s27 offen offset:192
  buffer_load_dwordx4 a[184:187], v9, s[12:15], s27 offen offset:256
  buffer_load_dwordx4 a[188:191], v9, s[12:15], s27 offen offset:320
  buffer_load_dwordx4 a[192:195], v10, s[12:15], s27 offen offset:0
  buffer_load_dwordx4 a[196:199], v10, s[12:15], s27 offen offset:64
  buffer_load_dwordx4 a[200:203], v10, s[12:15], s27 offen offset:128
  buffer_load_dwordx4 a[204:207], v10, s[12:15], s27 offen offset:192
  buffer_load_dwordx4 a[208:211], v10, s[12:15], s27 offen offset:256
  buffer_load_dwordx4 a[212:215], v10, s[12:15], s27 offen offset:320
  s_add_u32 s27, s24, 786432
  buffer_load_dwordx4 v[64:67], v9, s[12:15], s27 offen offset:0
  buffer_load_dwordx4 v[68:71], v9, s[12:15], s27 offen offset:64
  buffer_load_dwordx4 v[72:75], v9, s[12:15], s27 offen offset:128
  buffer_load_dwordx4 v[76:79], v9, s[12:15], s27 offen offset:192
  buffer_load_dwordx4 v[80:83], v9, s[12:15], s27 offen offset:256
  buffer_load_dwordx4 v[84:87], v9, s[12:15], s27 offen offset:320
  buffer_load_dwordx4 v[88:91], v10, s[12:15], s27 offen offset:0
  buffer_load_dwordx4 v[92:95], v10, s[12:15], s27 offen offset:64
  buffer_load_dwordx4 v[96:99], v10, s[12:15], s27 offen offset:128
  buffer_load_dwordx4 v[100:103], v10, s[12:15], s27 offen offset:192
  buffer_load_dwordx4 v[104:107], v10, s[12:15], s27 offen offset:256
  buffer_load_dwordx4 v[108:111], v10, s[12:15], s27 offen offset:320
  s_add_u32 s27, s24, 1179648
  buffer_load_dwordx4 v[112:115], v9, s[12:15], s27 offen offset:0
  buffer_load_dwordx4 v[116:119], v9, s[12:15], s27 offen offset:64
  buffer_load_dwordx4 v[120:123], v9, s[12:15], s27 offen offset:128
  buffer_load_dwordx4 v[124:127], v9, s[12:15], s27 offen offset:192
  buffer_load_dwordx4 v[128:131], v9, s[12:15], s27 offen offset:256
  buffer_load_dwordx4 v[132:135], v9, s[12:15], s27 offen offset:320
  buffer_load_dwordx4 v[136:139], v10, s[12:15], s27 offen offset:0
  buffer_load_dwordx4 v[140:143], v10, s[12:15], s27 offen offset:64
  buffer_load_dwordx4 v[144:147], v10, s[12:15], s27 offen offset:128
  buffer_load_dwordx4 v[148:151], v10, s[12:15], s27 offen offset:192
  buffer_load_dwordx4 v[152:155], v10, s[12:15], s27 offen offset:256
  buffer_load_dwordx4 v[156:159], v10, s[12:15], s27 offen offset:320
  s_mul_i32 s26, s22, 40
  s_mul_i32 s27, s23, 5
  s_add_u32 s26, s26, s27
  s_mul_i32 s26, s26, 20
  s_mul_i32 s27, s21, 5
  s_add_u32 s26, s26, s27
  s_lshl_b32 s26, s26, 10
  s_add_u32 s26, s26, 0x2e00000
  v_lshrrev_b32 v8, 4, v1
  v_mul_u32_u24 v8, 1280, v8
  v_bfe_u32 v11, v1, 2, 2
  v_lshlrev_b32 v11, 5, v11
  v_add_u32 v8, v8, v11
  v_bfe_u32 v11, v1, 1, 1
  v_lshlrev_b32 v11, 4, v11
  v_add_u32 v8, v8, v11
  v_and_b32 v11, 1, v1
  v_lshlrev_b32 v11, 3, v11
  v_add_u32 v8, v8, v11
  s_waitcnt vmcnt(48)
  s_barrier
  ds_read_b64_tr_b16 a[0:1], v8 offset:0
  ds_read_b64_tr_b16 a[2:3], v8 offset:640
  ds_read_b64_tr_b16 a[4:5], v8 offset:128
  ds_read_b64_tr_b16 a[6:7], v8 offset:768
  ds_read_b64_tr_b16 a[8:9], v8 offset:256
  ds_read_b64_tr_b16 a[10:11], v8 offset:896
  ds_read_b64_tr_b16 a[12:13], v8 offset:384
  ds_read_b64_tr_b16 a[14:15], v8 offset:1024
  ds_read_b64_tr_b16 a[16:17], v8 offset:512
  ds_read_b64_tr_b16 a[18:19], v8 offset:1152
  ds_read_b64_tr_b16 a[20:21], v8 offset:5120
  ds_read_b64_tr_b16 a[22:23], v8 offset:5760
  s_waitcnt lgkmcnt(0)
  ds_read_b64_tr_b16 a[24:25], v8 offset:5248
  ds_read_b64_tr_b16 a[26:27], v8 offset:5888
  ds_read_b64_tr_b16 a[28:29], v8 offset:5376
  ds_read_b64_tr_b16 a[30:31], v8 offset:6016
  ds_read_b64_tr_b16 a[32:33], v8 offset:5504
  ds_read_b64_tr_b16 a[34:35], v8 offset:6144
  ds_read_b64_tr_b16 a[36:37], v8 offset:5632
  ds_read_b64_tr_b16 a[38:39], v8 offset:6272
  ds_read_b64_tr_b16 a[40:41], v8 offset:10240
  ds_read_b64_tr_b16 a[42:43], v8 offset:10880
  ds_read_b64_tr_b16 a[44:45], v8 offset:10368
  ds_read_b64_tr_b16 a[46:47], v8 offset:11008
  s_waitcnt lgkmcnt(0)
  ds_read_b64_tr_b16 a[48:49], v8 offset:10496
  ds_read_b64_tr_b16 a[50:51], v8 offset:11136
  ds_read_b64_tr_b16 a[52:53], v8 offset:10624
  ds_read_b64_tr_b16 a[54:55], v8 offset:11264
  ds_read_b64_tr_b16 a[56:57], v8 offset:10752
  ds_read_b64_tr_b16 a[58:59], v8 offset:11392
  ds_read_b64_tr_b16 a[60:61], v8 offset:15360
  ds_read_b64_tr_b16 a[62:63], v8 offset:16000
  ds_read_b64_tr_b16 a[64:65], v8 offset:15488
  ds_read_b64_tr_b16 a[66:67], v8 offset:16128
  ds_read_b64_tr_b16 a[68:69], v8 offset:15616
  ds_read_b64_tr_b16 a[70:71], v8 offset:16256
  s_waitcnt lgkmcnt(0)
  ds_read_b64_tr_b16 a[72:73], v8 offset:15744
  ds_read_b64_tr_b16 a[74:75], v8 offset:16384
  ds_read_b64_tr_b16 a[76:77], v8 offset:15872
  ds_read_b64_tr_b16 a[78:79], v8 offset:16512
  ds_read_b64_tr_b16 a[80:81], v8 offset:20480
  ds_read_b64_tr_b16 a[82:83], v8 offset:21120
  ds_read_b64_tr_b16 a[84:85], v8 offset:20608
  ds_read_b64_tr_b16 a[86:87], v8 offset:21248
  ds_read_b64_tr_b16 a[88:89], v8 offset:20736
  ds_read_b64_tr_b16 a[90:91], v8 offset:21376
  ds_read_b64_tr_b16 a[92:93], v8 offset:20864
  ds_read_b64_tr_b16 a[94:95], v8 offset:21504
  s_waitcnt lgkmcnt(0)
  ds_read_b64_tr_b16 a[96:97], v8 offset:20992
  ds_read_b64_tr_b16 a[98:99], v8 offset:21632
  ds_read_b64_tr_b16 a[100:101], v8 offset:25600
  ds_read_b64_tr_b16 a[102:103], v8 offset:26240
  ds_read_b64_tr_b16 a[104:105], v8 offset:25728
  ds_read_b64_tr_b16 a[106:107], v8 offset:26368
  ds_read_b64_tr_b16 a[108:109], v8 offset:25856
  ds_read_b64_tr_b16 a[110:111], v8 offset:26496
  ds_read_b64_tr_b16 a[112:113], v8 offset:25984
  ds_read_b64_tr_b16 a[114:115], v8 offset:26624
  ds_read_b64_tr_b16 a[116:117], v8 offset:26112
  ds_read_b64_tr_b16 a[118:119], v8 offset:26752
  s_waitcnt lgkmcnt(0)
  s_waitcnt lgkmcnt(0)
  v_mov_b32 v208, -1
  v_mov_b32 v209, -1
  v_mov_b32 v210, -1
  v_mov_b32 v211, -1
  s_lshl_b32 s28, s2, 2
  s_add_u32 s28, s28, s21
  s_waitcnt vmcnt(36)
  s_add_u32 s27, s24, 1572864
  buffer_load_dwordx4 v[160:163], v9, s[12:15], s27 offen offset:0
  buffer_load_dwordx4 v[164:167], v9, s[12:15], s27 offen offset:64
  buffer_load_dwordx4 v[168:171], v9, s[12:15], s27 offen offset:128
  buffer_load_dwordx4 v[172:175], v9, s[12:15], s27 offen offset:192
  buffer_load_dwordx4 v[176:179], v9, s[12:15], s27 offen offset:256
  buffer_load_dwordx4 v[180:183], v9, s[12:15], s27 offen offset:320
  buffer_load_dwordx4 v[184:187], v10, s[12:15], s27 offen offset:0
  buffer_load_dwordx4 v[188:191], v10, s[12:15], s27 offen offset:64
  buffer_load_dwordx4 v[192:195], v10, s[12:15], s27 offen offset:128
  buffer_load_dwordx4 v[196:199], v10, s[12:15], s27 offen offset:192
  buffer_load_dwordx4 v[200:203], v10, s[12:15], s27 offen offset:256
  buffer_load_dwordx4 v[204:207], v10, s[12:15], s27 offen offset:320
  v_mfma_f32_16x16x32_bf16 v[16:19], a[120:123], a[0:3], 0
  v_mfma_f32_16x16x32_bf16 v[20:23], a[120:123], a[4:7], 0
  v_mfma_f32_16x16x32_bf16 v[24:27], a[120:123], a[8:11], 0
  v_mfma_f32_16x16x32_bf16 v[28:31], a[120:123], a[12:15], 0
  v_mfma_f32_16x16x32_bf16 v[32:35], a[120:123], a[16:19], 0
  v_mfma_f32_16x16x32_bf16 v[36:39], a[144:147], a[0:3], 0
  v_mfma_f32_16x16x32_bf16 v[40:43], a[144:147], a[4:7], 0
  v_mfma_f32_16x16x32_bf16 v[44:47], a[144:147], a[8:11], 0
  v_mfma_f32_16x16x32_bf16 v[48:51], a[144:147], a[12:15], 0
  v_mfma_f32_16x16x32_bf16 v[52:55], a[144:147], a[16:19], 0
  v_mfma_f32_16x16x32_bf16 v[16:19], a[124:127], a[20:23], v[16:19]
  v_mfma_f32_16x16x32_bf16 v[20:23], a[124:127], a[24:27], v[20:23]
  v_mfma_f32_16x16x32_bf16 v[24:27], a[124:127], a[28:31], v[24:27]
  v_mfma_f32_16x16x32_bf16 v[28:31], a[124:127], a[32:35], v[28:31]
  v_mfma_f32_16x16x32_bf16 v[32:35], a[124:127], a[36:39], v[32:35]
  v_mfma_f32_16x16x32_bf16 v[36:39], a[148:151], a[20:23], v[36:39]
  v_mfma_f32_16x16x32_bf16 v[40:43], a[148:151], a[24:27], v[40:43]
  v_mfma_f32_16x16x32_bf16 v[44:47], a[148:151], a[28:31], v[44:47]
  v_mfma_f32_16x16x32_bf16 v[48:51], a[148:151], a[32:35], v[48:51]
  v_mfma_f32_16x16x32_bf16 v[52:55], a[148:151], a[36:39], v[52:55]
  v_mfma_f32_16x16x32_bf16 v[16:19], a[128:131], a[40:43], v[16:19]
  v_mfma_f32_16x16x32_bf16 v[20:23], a[128:131], a[44:47], v[20:23]
  v_mfma_f32_16x16x32_bf16 v[24:27], a[128:131], a[48:51], v[24:27]
  v_mfma_f32_16x16x32_bf16 v[28:31], a[128:131], a[52:55], v[28:31]
  v_mfma_f32_16x16x32_bf16 v[32:35], a[128:131], a[56:59], v[32:35]
  v_mfma_f32_16x16x32_bf16 v[36:39], a[152:155], a[40:43], v[36:39]
  v_mfma_f32_16x16x32_bf16 v[40:43], a[152:155], a[44:47], v[40:43]
  v_mfma_f32_16x16x32_bf16 v[44:47], a[152:155], a[48:51], v[44:47]
  v_mfma_f32_16x16x32_bf16 v[48:51], a[152:155], a[52:55], v[48:51]
  v_mfma_f32_16x16x32_bf16 v[52:55], a[152:155], a[56:59], v[52:55]
  v_mfma_f32_16x16x32_bf16 v[16:19], a[132:135], a[60:63], v[16:19]
  v_mfma_f32_16x16x32_bf16 v[20:23], a[132:135], a[64:67], v[20:23]
  v_mfma_f32_16x16x32_bf16 v[24:27], a[132:135], a[68:71], v[24:27]
  v_mfma_f32_16x16x32_bf16 v[28:31], a[132:135], a[72:75], v[28:31]
  v_mfma_f32_16x16x32_bf16 v[32:35], a[132:135], a[76:79], v[32:35]
  v_mfma_f32_16x16x32_bf16 v[36:39], a[156:159], a[60:63], v[36:39]
  v_mfma_f32_16x16x32_bf16 v[40:43], a[156:159], a[64:67], v[40:43]
  v_mfma_f32_16x16x32_bf16 v[44:47], a[156:159], a[68:71], v[44:47]
  v_mfma_f32_16x16x32_bf16 v[48:51], a[156:159], a[72:75], v[48:51]
  v_mfma_f32_16x16x32_bf16 v[52:55], a[156:159], a[76:79], v[52:55]
  v_mfma_f32_16x16x32_bf16 v[16:19], a[136:139], a[80:83], v[16:19]
  v_mfma_f32_16x16x32_bf16 v[20:23], a[136:139], a[84:87], v[20:23]
  v_mfma_f32_16x16x32_bf16 v[24:27], a[136:139], a[88:91], v[24:27]
  v_mfma_f32_16x16x32_bf16 v[28:31], a[136:139], a[92:95], v[28:31]
  v_mfma_f32_16x16x32_bf16 v[32:35], a[136:139], a[96:99], v[32:35]
  v_mfma_f32_16x16x32_bf16 v[36:39], a[160:163], a[80:83], v[36:39]
  v_mfma_f32_16x16x32_bf16 v[40:43], a[160:163], a[84:87], v[40:43]
  v_mfma_f32_16x16x32_bf16 v[44:47], a[160:163], a[88:91], v[44:47]
  v_mfma_f32_16x16x32_bf16 v[48:51], a[160:163], a[92:95], v[48:51]
  v_mfma_f32_16x16x32_bf16 v[52:55], a[160:163], a[96:99], v[52:55]
  v_mfma_f32_16x16x32_bf16 v[16:19], a[140:143], a[100:103], v[16:19]
  v_mfma_f32_16x16x32_bf16 v[20:23], a[140:143], a[104:107], v[20:23]
  v_mfma_f32_16x16x32_bf16 v[24:27], a[140:143], a[108:111], v[24:27]
  v_mfma_f32_16x16x32_bf16 v[28:31], a[140:143], a[112:115], v[28:31]
  v_mfma_f32_16x16x32_bf16 v[32:35], a[140:143], a[116:119], v[32:35]
  v_mfma_f32_16x16x32_bf16 v[36:39], a[164:167], a[100:103], v[36:39]
  v_mfma_f32_16x16x32_bf16 v[40:43], a[164:167], a[104:107], v[40:43]
  v_mfma_f32_16x16x32_bf16 v[44:47], a[164:167], a[108:111], v[44:47]
  v_mfma_f32_16x16x32_bf16 v[48:51], a[164:167], a[112:115], v[48:51]
  v_mfma_f32_16x16x32_bf16 v[52:55], a[164:167], a[116:119], v[52:55]
  s_nop 7
  v_cvt_pk_bf16_f32 v212, v16, v17
  v_cvt_pk_bf16_f32 v213, v18, v19
  v_cvt_pk_bf16_f32 v214, v36, v37
  v_cvt_pk_bf16_f32 v215, v38, v39
  s_add_u32 s27, s26, 0
  buffer_store_dwordx4 v[212:215], v2, s[8:11], s27 offen
  v_cvt_pk_bf16_f32 v216, v20, v21
  v_cvt_pk_bf16_f32 v217, v22, v23
  v_cvt_pk_bf16_f32 v218, v40, v41
  v_cvt_pk_bf16_f32 v219, v42, v43
  s_add_u32 s27, s26, 20480
  buffer_store_dwordx4 v[216:219], v2, s[8:11], s27 offen
  v_cvt_pk_bf16_f32 v220, v24, v25
  v_cvt_pk_bf16_f32 v221, v26, v27
  v_cvt_pk_bf16_f32 v222, v44, v45
  v_cvt_pk_bf16_f32 v223, v46, v47
  s_add_u32 s27, s26, 40960
  buffer_store_dwordx4 v[220:223], v2, s[8:11], s27 offen
  v_cvt_pk_bf16_f32 v224, v28, v29
  v_cvt_pk_bf16_f32 v225, v30, v31
  v_cvt_pk_bf16_f32 v226, v48, v49
  v_cvt_pk_bf16_f32 v227, v50, v51
  s_add_u32 s27, s26, 61440
  buffer_store_dwordx4 v[224:227], v2, s[8:11], s27 offen
  v_cvt_pk_bf16_f32 v212, v32, v33
  v_cvt_pk_bf16_f32 v213, v34, v35
  v_cvt_pk_bf16_f32 v214, v52, v53
  v_cvt_pk_bf16_f32 v215, v54, v55
  s_add_u32 s27, s26, 81920
  buffer_store_dwordx4 v[212:215], v2, s[8:11], s27 offen
  s_add_u32 s29, s28, 0
  s_cmp_lt_u32 s29, 2560
  s_cbranch_scc0 f_9
  s_lshl_b32 s29, s29, 10
  s_add_u32 s29, s29, 0x400000
  buffer_store_dwordx4 v[208:211], v2, s[8:11], s29 offen
f_9:
  s_add_u32 s29, s28, 1024
  s_cmp_lt_u32 s29, 2560
  s_cbranch_scc0 f_10
  s_lshl_b32 s29, s29, 10
  s_add_u32 s29, s29, 0x400000
  buffer_store_dwordx4 v[208:211], v2, s[8:11], s29 offen
f_10:
  s_waitcnt vmcnt(41)
  v_mfma_f32_16x16x32_bf16 v[16:19], a[168:171], a[0:3], 0
  v_mfma_f32_16x16x32_bf16 v[20:23], a[168:171], a[4:7], 0
  v_mfma_f32_16x16x32_bf16 v[24:27], a[168:171], a[8:11], 0
  v_mfma_f32_16x16x32_bf16 v[28:31], a[168:171], a[12:15], 0
  v_mfma_f32_16x16x32_bf16 v[32:35], a[168:171], a[16:19], 0
  v_mfma_f32_16x16x32_bf16 v[36:39], a[192:195], a[0:3], 0
  v_mfma_f32_16x16x32_bf16 v[40:43], a[192:195], a[4:7], 0
  v_mfma_f32_16x16x32_bf16 v[44:47], a[192:195], a[8:11], 0
  v_mfma_f32_16x16x32_bf16 v[48:51], a[192:195], a[12:15], 0
  v_mfma_f32_16x16x32_bf16 v[52:55], a[192:195], a[16:19], 0
  v_mfma_f32_16x16x32_bf16 v[16:19], a[172:175], a[20:23], v[16:19]
  v_mfma_f32_16x16x32_bf16 v[20:23], a[172:175], a[24:27], v[20:23]
  v_mfma_f32_16x16x32_bf16 v[24:27], a[172:175], a[28:31], v[24:27]
  v_mfma_f32_16x16x32_bf16 v[28:31], a[172:175], a[32:35], v[28:31]
  v_mfma_f32_16x16x32_bf16 v[32:35], a[172:175], a[36:39], v[32:35]
  v_mfma_f32_16x16x32_bf16 v[36:39], a[196:199], a[20:23], v[36:39]
  v_mfma_f32_16x16x32_bf16 v[40:43], a[196:199], a[24:27], v[40:43]
  v_mfma_f32_16x16x32_bf16 v[44:47], a[196:199], a[28:31], v[44:47]
  v_mfma_f32_16x16x32_bf16 v[48:51], a[196:199], a[32:35], v[48:51]
  v_mfma_f32_16x16x32_bf16 v[52:55], a[196:199], a[36:39], v[52:55]
  v_mfma_f32_16x16x32_bf16 v[16:19], a[176:179], a[40:43], v[16:19]
  v_mfma_f32_16x16x32_bf16 v[20:23], a[176:179], a[44:47], v[20:23]
  v_mfma_f32_16x16x32_bf16 v[24:27], a[176:179], a[48:51], v[24:27]
  v_mfma_f32_16x16x32_bf16 v[28:31], a[176:179], a[52:55], v[28:31]
  v_mfma_f32_16x16x32_bf16 v[32:35], a[176:179], a[56:59], v[32:35]
  v_mfma_f32_16x16x32_bf16 v[36:39], a[200:203], a[40:43], v[36:39]
  v_mfma_f32_16x16x32_bf16 v[40:43], a[200:203], a[44:47], v[40:43]
  v_mfma_f32_16x16x32_bf16 v[44:47], a[200:203], a[48:51], v[44:47]
  v_mfma_f32_16x16x32_bf16 v[48:51], a[200:203], a[52:55], v[48:51]
  v_mfma_f32_16x16x32_bf16 v[52:55], a[200:203], a[56:59], v[52:55]
  v_mfma_f32_16x16x32_bf16 v[16:19], a[180:183], a[60:63], v[16:19]
  v_mfma_f32_16x16x32_bf16 v[20:23], a[180:183], a[64:67], v[20:23]
  v_mfma_f32_16x16x32_bf16 v[24:27], a[180:183], a[68:71], v[24:27]
  v_mfma_f32_16x16x32_bf16 v[28:31], a[180:183], a[72:75], v[28:31]
  v_mfma_f32_16x16x32_bf16 v[32:35], a[180:183], a[76:79], v[32:35]
  v_mfma_f32_16x16x32_bf16 v[36:39], a[204:207], a[60:63], v[36:39]
  v_mfma_f32_16x16x32_bf16 v[40:43], a[204:207], a[64:67], v[40:43]
  v_mfma_f32_16x16x32_bf16 v[44:47], a[204:207], a[68:71], v[44:47]
  v_mfma_f32_16x16x32_bf16 v[48:51], a[204:207], a[72:75], v[48:51]
  v_mfma_f32_16x16x32_bf16 v[52:55], a[204:207], a[76:79], v[52:55]
  v_mfma_f32_16x16x32_bf16 v[16:19], a[184:187], a[80:83], v[16:19]
  v_mfma_f32_16x16x32_bf16 v[20:23], a[184:187], a[84:87], v[20:23]
  v_mfma_f32_16x16x32_bf16 v[24:27], a[184:187], a[88:91], v[24:27]
  v_mfma_f32_16x16x32_bf16 v[28:31], a[184:187], a[92:95], v[28:31]
  v_mfma_f32_16x16x32_bf16 v[32:35], a[184:187], a[96:99], v[32:35]
  v_mfma_f32_16x16x32_bf16 v[36:39], a[208:211], a[80:83], v[36:39]
  v_mfma_f32_16x16x32_bf16 v[40:43], a[208:211], a[84:87], v[40:43]
  v_mfma_f32_16x16x32_bf16 v[44:47], a[208:211], a[88:91], v[44:47]
  v_mfma_f32_16x16x32_bf16 v[48:51], a[208:211], a[92:95], v[48:51]
  v_mfma_f32_16x16x32_bf16 v[52:55], a[208:211], a[96:99], v[52:55]
  v_mfma_f32_16x16x32_bf16 v[16:19], a[188:191], a[100:103], v[16:19]
  v_mfma_f32_16x16x32_bf16 v[20:23], a[188:191], a[104:107], v[20:23]
  v_mfma_f32_16x16x32_bf16 v[24:27], a[188:191], a[108:111], v[24:27]
  v_mfma_f32_16x16x32_bf16 v[28:31], a[188:191], a[112:115], v[28:31]
  v_mfma_f32_16x16x32_bf16 v[32:35], a[188:191], a[116:119], v[32:35]
  v_mfma_f32_16x16x32_bf16 v[36:39], a[212:215], a[100:103], v[36:39]
  v_mfma_f32_16x16x32_bf16 v[40:43], a[212:215], a[104:107], v[40:43]
  v_mfma_f32_16x16x32_bf16 v[44:47], a[212:215], a[108:111], v[44:47]
  v_mfma_f32_16x16x32_bf16 v[48:51], a[212:215], a[112:115], v[48:51]
  v_mfma_f32_16x16x32_bf16 v[52:55], a[212:215], a[116:119], v[52:55]
  s_nop 7
  v_cvt_pk_bf16_f32 v212, v16, v17
  v_cvt_pk_bf16_f32 v213, v18, v19
  v_cvt_pk_bf16_f32 v214, v36, v37
  v_cvt_pk_bf16_f32 v215, v38, v39
  s_add_u32 s27, s26, 1024
  buffer_store_dwordx4 v[212:215], v2, s[8:11], s27 offen
  v_cvt_pk_bf16_f32 v216, v20, v21
  v_cvt_pk_bf16_f32 v217, v22, v23
  v_cvt_pk_bf16_f32 v218, v40, v41
  v_cvt_pk_bf16_f32 v219, v42, v43
  s_add_u32 s27, s26, 21504
  buffer_store_dwordx4 v[216:219], v2, s[8:11], s27 offen
  v_cvt_pk_bf16_f32 v220, v24, v25
  v_cvt_pk_bf16_f32 v221, v26, v27
  v_cvt_pk_bf16_f32 v222, v44, v45
  v_cvt_pk_bf16_f32 v223, v46, v47
  s_add_u32 s27, s26, 41984
  buffer_store_dwordx4 v[220:223], v2, s[8:11], s27 offen
  v_cvt_pk_bf16_f32 v224, v28, v29
  v_cvt_pk_bf16_f32 v225, v30, v31
  v_cvt_pk_bf16_f32 v226, v48, v49
  v_cvt_pk_bf16_f32 v227, v50, v51
  s_add_u32 s27, s26, 62464
  buffer_store_dwordx4 v[224:227], v2, s[8:11], s27 offen
  v_cvt_pk_bf16_f32 v212, v32, v33
  v_cvt_pk_bf16_f32 v213, v34, v35
  v_cvt_pk_bf16_f32 v214, v52, v53
  v_cvt_pk_bf16_f32 v215, v54, v55
  s_add_u32 s27, s26, 82944
  buffer_store_dwordx4 v[212:215], v2, s[8:11], s27 offen
  s_add_u32 s29, s28, 2048
  s_cmp_lt_u32 s29, 2560
  s_cbranch_scc0 f_11
  s_lshl_b32 s29, s29, 10
  s_add_u32 s29, s29, 0x400000
  buffer_store_dwordx4 v[208:211], v2, s[8:11], s29 offen
f_11:
  s_add_u32 s29, s28, 0
  s_cmp_lt_u32 s29, 1280
  s_cbranch_scc0 f_12
  s_lshl_b32 s29, s29, 10
  s_add_u32 s29, s29, 0x700000
  buffer_store_dwordx4 v[208:211], v2, s[8:11], s29 offen
f_12:
  s_waitcnt vmcnt(34)
  v_mfma_f32_16x16x32_bf16 v[16:19], v[64:67], a[0:3], 0
  v_mfma_f32_16x16x32_bf16 v[20:23], v[64:67], a[4:7], 0
  v_mfma_f32_16x16x32_bf16 v[24:27], v[64:67], a[8:11], 0
  v_mfma_f32_16x16x32_bf16 v[28:31], v[64:67], a[12:15], 0
  v_mfma_f32_16x16x32_bf16 v[32:35], v[64:67], a[16:19], 0
  v_mfma_f32_16x16x32_bf16 v[36:39], v[88:91], a[0:3], 0
  v_mfma_f32_16x16x32_bf16 v[40:43], v[88:91], a[4:7], 0
  v_mfma_f32_16x16x32_bf16 v[44:47], v[88:91], a[8:11], 0
  v_mfma_f32_16x16x32_bf16 v[48:51], v[88:91], a[12:15], 0
  v_mfma_f32_16x16x32_bf16 v[52:55], v[88:91], a[16:19], 0
  v_mfma_f32_16x16x32_bf16 v[16:19], v[68:71], a[20:23], v[16:19]
  v_mfma_f32_16x16x32_bf16 v[20:23], v[68:71], a[24:27], v[20:23]
  v_mfma_f32_16x16x32_bf16 v[24:27], v[68:71], a[28:31], v[24:27]
  v_mfma_f32_16x16x32_bf16 v[28:31], v[68:71], a[32:35], v[28:31]
  v_mfma_f32_16x16x32_bf16 v[32:35], v[68:71], a[36:39], v[32:35]
  v_mfma_f32_16x16x32_bf16 v[36:39], v[92:95], a[20:23], v[36:39]
  v_mfma_f32_16x16x32_bf16 v[40:43], v[92:95], a[24:27], v[40:43]
  v_mfma_f32_16x16x32_bf16 v[44:47], v[92:95], a[28:31], v[44:47]
  v_mfma_f32_16x16x32_bf16 v[48:51], v[92:95], a[32:35], v[48:51]
  v_mfma_f32_16x16x32_bf16 v[52:55], v[92:95], a[36:39], v[52:55]
  v_mfma_f32_16x16x32_bf16 v[16:19], v[72:75], a[40:43], v[16:19]
  v_mfma_f32_16x16x32_bf16 v[20:23], v[72:75], a[44:47], v[20:23]
  v_mfma_f32_16x16x32_bf16 v[24:27], v[72:75], a[48:51], v[24:27]
  v_mfma_f32_16x16x32_bf16 v[28:31], v[72:75], a[52:55], v[28:31]
  v_mfma_f32_16x16x32_bf16 v[32:35], v[72:75], a[56:59], v[32:35]
  v_mfma_f32_16x16x32_bf16 v[36:39], v[96:99], a[40:43], v[36:39]
  v_mfma_f32_16x16x32_bf16 v[40:43], v[96:99], a[44:47], v[40:43]
  v_mfma_f32_16x16x32_bf16 v[44:47], v[96:99], a[48:51], v[44:47]
  v_mfma_f32_16x16x32_bf16 v[48:51], v[96:99], a[52:55], v[48:51]
  v_mfma_f32_16x16x32_bf16 v[52:55], v[96:99], a[56:59], v[52:55]
  v_mfma_f32_16x16x32_bf16 v[16:19], v[76:79], a[60:63], v[16:19]
  v_mfma_f32_16x16x32_bf16 v[20:23], v[76:79], a[64:67], v[20:23]
  v_mfma_f32_16x16x32_bf16 v[24:27], v[76:79], a[68:71], v[24:27]
  v_mfma_f32_16x16x32_bf16 v[28:31], v[76:79], a[72:75], v[28:31]
  v_mfma_f32_16x16x32_bf16 v[32:35], v[76:79], a[76:79], v[32:35]
  v_mfma_f32_16x16x32_bf16 v[36:39], v[100:103], a[60:63], v[36:39]
  v_mfma_f32_16x16x32_bf16 v[40:43], v[100:103], a[64:67], v[40:43]
  v_mfma_f32_16x16x32_bf16 v[44:47], v[100:103], a[68:71], v[44:47]
  v_mfma_f32_16x16x32_bf16 v[48:51], v[100:103], a[72:75], v[48:51]
  v_mfma_f32_16x16x32_bf16 v[52:55], v[100:103], a[76:79], v[52:55]
  v_mfma_f32_16x16x32_bf16 v[16:19], v[80:83], a[80:83], v[16:19]
  v_mfma_f32_16x16x32_bf16 v[20:23], v[80:83], a[84:87], v[20:23]
  v_mfma_f32_16x16x32_bf16 v[24:27], v[80:83], a[88:91], v[24:27]
  v_mfma_f32_16x16x32_bf16 v[28:31], v[80:83], a[92:95], v[28:31]
  v_mfma_f32_16x16x32_bf16 v[32:35], v[80:83], a[96:99], v[32:35]
  v_mfma_f32_16x16x32_bf16 v[36:39], v[104:107], a[80:83], v[36:39]
  v_mfma_f32_16x16x32_bf16 v[40:43], v[104:107], a[84:87], v[40:43]
  v_mfma_f32_16x16x32_bf16 v[44:47], v[104:107], a[88:91], v[44:47]
  v_mfma_f32_16x16x32_bf16 v[48:51], v[104:107], a[92:95], v[48:51]
  v_mfma_f32_16x16x32_bf16 v[52:55], v[104:107], a[96:99], v[52:55]
  v_mfma_f32_16x16x32_bf16 v[16:19], v[84:87], a[100:103], v[16:19]
  v_mfma_f32_16x16x32_bf16 v[20:23], v[84:87], a[104:107], v[20:23]
  v_mfma_f32_16x16x32_bf16 v[24:27], v[84:87], a[108:111], v[24:27]
  v_mfma_f32_16x16x32_bf16 v[28:31], v[84:87], a[112:115], v[28:31]
  v_mfma_f32_16x16x32_bf16 v[32:35], v[84:87], a[116:119], v[32:35]
  v_mfma_f32_16x16x32_bf16 v[36:39], v[108:111], a[100:103], v[36:39]
  v_mfma_f32_16x16x32_bf16 v[40:43], v[108:111], a[104:107], v[40:43]
  v_mfma_f32_16x16x32_bf16 v[44:47], v[108:111], a[108:111], v[44:47]
  v_mfma_f32_16x16x32_bf16 v[48:51], v[108:111], a[112:115], v[48:51]
  v_mfma_f32_16x16x32_bf16 v[52:55], v[108:111], a[116:119], v[52:55]
  s_nop 7
  v_cvt_pk_bf16_f32 v212, v16, v17
  v_cvt_pk_bf16_f32 v213, v18, v19
  v_cvt_pk_bf16_f32 v214, v36, v37
  v_cvt_pk_bf16_f32 v215, v38, v39
  s_add_u32 s27, s26, 2048
  buffer_store_dwordx4 v[212:215], v2, s[8:11], s27 offen
  v_cvt_pk_bf16_f32 v216, v20, v21
  v_cvt_pk_bf16_f32 v217, v22, v23
  v_cvt_pk_bf16_f32 v218, v40, v41
  v_cvt_pk_bf16_f32 v219, v42, v43
  s_add_u32 s27, s26, 22528
  buffer_store_dwordx4 v[216:219], v2, s[8:11], s27 offen
  v_cvt_pk_bf16_f32 v220, v24, v25
  v_cvt_pk_bf16_f32 v221, v26, v27
  v_cvt_pk_bf16_f32 v222, v44, v45
  v_cvt_pk_bf16_f32 v223, v46, v47
  s_add_u32 s27, s26, 43008
  buffer_store_dwordx4 v[220:223], v2, s[8:11], s27 offen
  v_cvt_pk_bf16_f32 v224, v28, v29
  v_cvt_pk_bf16_f32 v225, v30, v31
  v_cvt_pk_bf16_f32 v226, v48, v49
  v_cvt_pk_bf16_f32 v227, v50, v51
  s_add_u32 s27, s26, 63488
  buffer_store_dwordx4 v[224:227], v2, s[8:11], s27 offen
  v_cvt_pk_bf16_f32 v212, v32, v33
  v_cvt_pk_bf16_f32 v213, v34, v35
  v_cvt_pk_bf16_f32 v214, v52, v53
  v_cvt_pk_bf16_f32 v215, v54, v55
  s_add_u32 s27, s26, 83968
  buffer_store_dwordx4 v[212:215], v2, s[8:11], s27 offen
  s_add_u32 s29, s28, 1024
  s_cmp_lt_u32 s29, 1280
  s_cbranch_scc0 f_13
  s_lshl_b32 s29, s29, 10
  s_add_u32 s29, s29, 0x700000
  buffer_store_dwordx4 v[208:211], v2, s[8:11], s29 offen
f_13:
  s_add_u32 s29, s28, 0
  s_cmp_lt_u32 s29, 640
  s_cbranch_scc0 f_14
  s_lshl_b32 s29, s29, 10
  s_add_u32 s29, s29, 0xa00000
  buffer_store_dwordx4 v[208:211], v2, s[8:11], s29 offen
f_14:
  s_waitcnt vmcnt(27)
  v_mfma_f32_16x16x32_bf16 v[16:19], v[112:115], a[0:3], 0
  v_mfma_f32_16x16x32_bf16 v[20:23], v[112:115], a[4:7], 0
  v_mfma_f32_16x16x32_bf16 v[24:27], v[112:115], a[8:11], 0
  v_mfma_f32_16x16x32_bf16 v[28:31], v[112:115], a[12:15], 0
  v_mfma_f32_16x16x32_bf16 v[32:35], v[112:115], a[16:19], 0
  v_mfma_f32_16x16x32_bf16 v[36:39], v[136:139], a[0:3], 0
  v_mfma_f32_16x16x32_bf16 v[40:43], v[136:139], a[4:7], 0
  v_mfma_f32_16x16x32_bf16 v[44:47], v[136:139], a[8:11], 0
  v_mfma_f32_16x16x32_bf16 v[48:51], v[136:139], a[12:15], 0
  v_mfma_f32_16x16x32_bf16 v[52:55], v[136:139], a[16:19], 0
  v_mfma_f32_16x16x32_bf16 v[16:19], v[116:119], a[20:23], v[16:19]
  v_mfma_f32_16x16x32_bf16 v[20:23], v[116:119], a[24:27], v[20:23]
  v_mfma_f32_16x16x32_bf16 v[24:27], v[116:119], a[28:31], v[24:27]
  v_mfma_f32_16x16x32_bf16 v[28:31], v[116:119], a[32:35], v[28:31]
  v_mfma_f32_16x16x32_bf16 v[32:35], v[116:119], a[36:39], v[32:35]
  v_mfma_f32_16x16x32_bf16 v[36:39], v[140:143], a[20:23], v[36:39]
  v_mfma_f32_16x16x32_bf16 v[40:43], v[140:143], a[24:27], v[40:43]
  v_mfma_f32_16x16x32_bf16 v[44:47], v[140:143], a[28:31], v[44:47]
  v_mfma_f32_16x16x32_bf16 v[48:51], v[140:143], a[32:35], v[48:51]
  v_mfma_f32_16x16x32_bf16 v[52:55], v[140:143], a[36:39], v[52:55]
  v_mfma_f32_16x16x32_bf16 v[16:19], v[120:123], a[40:43], v[16:19]
  v_mfma_f32_16x16x32_bf16 v[20:23], v[120:123], a[44:47], v[20:23]
  v_mfma_f32_16x16x32_bf16 v[24:27], v[120:123], a[48:51], v[24:27]
  v_mfma_f32_16x16x32_bf16 v[28:31], v[120:123], a[52:55], v[28:31]
  v_mfma_f32_16x16x32_bf16 v[32:35], v[120:123], a[56:59], v[32:35]
  v_mfma_f32_16x16x32_bf16 v[36:39], v[144:147], a[40:43], v[36:39]
  v_mfma_f32_16x16x32_bf16 v[40:43], v[144:147], a[44:47], v[40:43]
  v_mfma_f32_16x16x32_bf16 v[44:47], v[144:147], a[48:51], v[44:47]
  v_mfma_f32_16x16x32_bf16 v[48:51], v[144:147], a[52:55], v[48:51]
  v_mfma_f32_16x16x32_bf16 v[52:55], v[144:147], a[56:59], v[52:55]
  v_mfma_f32_16x16x32_bf16 v[16:19], v[124:127], a[60:63], v[16:19]
  v_mfma_f32_16x16x32_bf16 v[20:23], v[124:127], a[64:67], v[20:23]
  v_mfma_f32_16x16x32_bf16 v[24:27], v[124:127], a[68:71], v[24:27]
  v_mfma_f32_16x16x32_bf16 v[28:31], v[124:127], a[72:75], v[28:31]
  v_mfma_f32_16x16x32_bf16 v[32:35], v[124:127], a[76:79], v[32:35]
  v_mfma_f32_16x16x32_bf16 v[36:39], v[148:151], a[60:63], v[36:39]
  v_mfma_f32_16x16x32_bf16 v[40:43], v[148:151], a[64:67], v[40:43]
  v_mfma_f32_16x16x32_bf16 v[44:47], v[148:151], a[68:71], v[44:47]
  v_mfma_f32_16x16x32_bf16 v[48:51], v[148:151], a[72:75], v[48:51]
  v_mfma_f32_16x16x32_bf16 v[52:55], v[148:151], a[76:79], v[52:55]
  v_mfma_f32_16x16x32_bf16 v[16:19], v[128:131], a[80:83], v[16:19]
  v_mfma_f32_16x16x32_bf16 v[20:23], v[128:131], a[84:87], v[20:23]
  v_mfma_f32_16x16x32_bf16 v[24:27], v[128:131], a[88:91], v[24:27]
  v_mfma_f32_16x16x32_bf16 v[28:31], v[128:131], a[92:95], v[28:31]
  v_mfma_f32_16x16x32_bf16 v[32:35], v[128:131], a[96:99], v[32:35]
  v_mfma_f32_16x16x32_bf16 v[36:39], v[152:155], a[80:83], v[36:39]
  v_mfma_f32_16x16x32_bf16 v[40:43], v[152:155], a[84:87], v[40:43]
  v_mfma_f32_16x16x32_bf16 v[44:47], v[152:155], a[88:91], v[44:47]
  v_mfma_f32_16x16x32_bf16 v[48:51], v[152:155], a[92:95], v[48:51]
  v_mfma_f32_16x16x32_bf16 v[52:55], v[152:155], a[96:99], v[52:55]
  v_mfma_f32_16x16x32_bf16 v[16:19], v[132:135], a[100:103], v[16:19]
  v_mfma_f32_16x16x32_bf16 v[20:23], v[132:135], a[104:107], v[20:23]
  v_mfma_f32_16x16x32_bf16 v[24:27], v[132:135], a[108:111], v[24:27]
  v_mfma_f32_16x16x32_bf16 v[28:31], v[132:135], a[112:115], v[28:31]
  v_mfma_f32_16x16x32_bf16 v[32:35], v[132:135], a[116:119], v[32:35]
  v_mfma_f32_16x16x32_bf16 v[36:39], v[156:159], a[100:103], v[36:39]
  v_mfma_f32_16x16x32_bf16 v[40:43], v[156:159], a[104:107], v[40:43]
  v_mfma_f32_16x16x32_bf16 v[44:47], v[156:159], a[108:111], v[44:47]
  v_mfma_f32_16x16x32_bf16 v[48:51], v[156:159], a[112:115], v[48:51]
  v_mfma_f32_16x16x32_bf16 v[52:55], v[156:159], a[116:119], v[52:55]
  s_nop 7
  v_cvt_pk_bf16_f32 v212, v16, v17
  v_cvt_pk_bf16_f32 v213, v18, v19
  v_cvt_pk_bf16_f32 v214, v36, v37
  v_cvt_pk_bf16_f32 v215, v38, v39
  s_add_u32 s27, s26, 3072
  buffer_store_dwordx4 v[212:215], v2, s[8:11], s27 offen
  v_cvt_pk_bf16_f32 v216, v20, v21
  v_cvt_pk_bf16_f32 v217, v22, v23
  v_cvt_pk_bf16_f32 v218, v40, v41
  v_cvt_pk_bf16_f32 v219, v42, v43
  s_add_u32 s27, s26, 23552
  buffer_store_dwordx4 v[216:219], v2, s[8:11], s27 offen
  v_cvt_pk_bf16_f32 v220, v24, v25
  v_cvt_pk_bf16_f32 v221, v26, v27
  v_cvt_pk_bf16_f32 v222, v44, v45
  v_cvt_pk_bf16_f32 v223, v46, v47
  s_add_u32 s27, s26, 44032
  buffer_store_dwordx4 v[220:223], v2, s[8:11], s27 offen
  v_cvt_pk_bf16_f32 v224, v28, v29
  v_cvt_pk_bf16_f32 v225, v30, v31
  v_cvt_pk_bf16_f32 v226, v48, v49
  v_cvt_pk_bf16_f32 v227, v50, v51
  s_add_u32 s27, s26, 64512
  buffer_store_dwordx4 v[224:227], v2, s[8:11], s27 offen
  v_cvt_pk_bf16_f32 v212, v32, v33
  v_cvt_pk_bf16_f32 v213, v34, v35
  v_cvt_pk_bf16_f32 v214, v52, v53
  v_cvt_pk_bf16_f32 v215, v54, v55
  s_add_u32 s27, s26, 84992
  buffer_store_dwordx4 v[212:215], v2, s[8:11], s27 offen
  s_add_u32 s29, s28, 0
  s_cmp_lt_u32 s29, 5120
  s_cbranch_scc0 f_15
  s_lshl_b32 s29, s29, 10
  s_add_u32 s29, s29, 0xe00000
  buffer_store_dwordx4 v[208:211], v2, s[8:11], s29 offen
f_15:
  s_add_u32 s29, s28, 1024
  s_cmp_lt_u32 s29, 5120
  s_cbranch_scc0 f_16
  s_lshl_b32 s29, s29, 10
  s_add_u32 s29, s29, 0xe00000
  buffer_store_dwordx4 v[208:211], v2, s[8:11], s29 offen
f_16:
  s_waitcnt vmcnt(20)
  v_mfma_f32_16x16x32_bf16 v[16:19], v[160:163], a[0:3], 0
  v_mfma_f32_16x16x32_bf16 v[20:23], v[160:163], a[4:7], 0
  v_mfma_f32_16x16x32_bf16 v[24:27], v[160:163], a[8:11], 0
  v_mfma_f32_16x16x32_bf16 v[28:31], v[160:163], a[12:15], 0
  v_mfma_f32_16x16x32_bf16 v[32:35], v[160:163], a[16:19], 0
  v_mfma_f32_16x16x32_bf16 v[36:39], v[184:187], a[0:3], 0
  v_mfma_f32_16x16x32_bf16 v[40:43], v[184:187], a[4:7], 0
  v_mfma_f32_16x16x32_bf16 v[44:47], v[184:187], a[8:11], 0
  v_mfma_f32_16x16x32_bf16 v[48:51], v[184:187], a[12:15], 0
  v_mfma_f32_16x16x32_bf16 v[52:55], v[184:187], a[16:19], 0
  v_mfma_f32_16x16x32_bf16 v[16:19], v[164:167], a[20:23], v[16:19]
  v_mfma_f32_16x16x32_bf16 v[20:23], v[164:167], a[24:27], v[20:23]
  v_mfma_f32_16x16x32_bf16 v[24:27], v[164:167], a[28:31], v[24:27]
  v_mfma_f32_16x16x32_bf16 v[28:31], v[164:167], a[32:35], v[28:31]
  v_mfma_f32_16x16x32_bf16 v[32:35], v[164:167], a[36:39], v[32:35]
  v_mfma_f32_16x16x32_bf16 v[36:39], v[188:191], a[20:23], v[36:39]
  v_mfma_f32_16x16x32_bf16 v[40:43], v[188:191], a[24:27], v[40:43]
  v_mfma_f32_16x16x32_bf16 v[44:47], v[188:191], a[28:31], v[44:47]
  v_mfma_f32_16x16x32_bf16 v[48:51], v[188:191], a[32:35], v[48:51]
  v_mfma_f32_16x16x32_bf16 v[52:55], v[188:191], a[36:39], v[52:55]
  v_mfma_f32_16x16x32_bf16 v[16:19], v[168:171], a[40:43], v[16:19]
  v_mfma_f32_16x16x32_bf16 v[20:23], v[168:171], a[44:47], v[20:23]
  v_mfma_f32_16x16x32_bf16 v[24:27], v[168:171], a[48:51], v[24:27]
  v_mfma_f32_16x16x32_bf16 v[28:31], v[168:171], a[52:55], v[28:31]
  v_mfma_f32_16x16x32_bf16 v[32:35], v[168:171], a[56:59], v[32:35]
  v_mfma_f32_16x16x32_bf16 v[36:39], v[192:195], a[40:43], v[36:39]
  v_mfma_f32_16x16x32_bf16 v[40:43], v[192:195], a[44:47], v[40:43]
  v_mfma_f32_16x16x32_bf16 v[44:47], v[192:195], a[48:51], v[44:47]
  v_mfma_f32_16x16x32_bf16 v[48:51], v[192:195], a[52:55], v[48:51]
  v_mfma_f32_16x16x32_bf16 v[52:55], v[192:195], a[56:59], v[52:55]
  v_mfma_f32_16x16x32_bf16 v[16:19], v[172:175], a[60:63], v[16:19]
  v_mfma_f32_16x16x32_bf16 v[20:23], v[172:175], a[64:67], v[20:23]
  v_mfma_f32_16x16x32_bf16 v[24:27], v[172:175], a[68:71], v[24:27]
  v_mfma_f32_16x16x32_bf16 v[28:31], v[172:175], a[72:75], v[28:31]
  v_mfma_f32_16x16x32_bf16 v[32:35], v[172:175], a[76:79], v[32:35]
  v_mfma_f32_16x16x32_bf16 v[36:39], v[196:199], a[60:63], v[36:39]
  v_mfma_f32_16x16x32_bf16 v[40:43], v[196:199], a[64:67], v[40:43]
  v_mfma_f32_16x16x32_bf16 v[44:47], v[196:199], a[68:71], v[44:47]
  v_mfma_f32_16x16x32_bf16 v[48:51], v[196:199], a[72:75], v[48:51]
  v_mfma_f32_16x16x32_bf16 v[52:55], v[196:199], a[76:79], v[52:55]
  v_mfma_f32_16x16x32_bf16 v[16:19], v[176:179], a[80:83], v[16:19]
  v_mfma_f32_16x16x32_bf16 v[20:23], v[176:179], a[84:87], v[20:23]
  v_mfma_f32_16x16x32_bf16 v[24:27], v[176:179], a[88:91], v[24:27]
  v_mfma_f32_16x16x32_bf16 v[28:31], v[176:179], a[92:95], v[28:31]
  v_mfma_f32_16x16x32_bf16 v[32:35], v[176:179], a[96:99], v[32:35]
  v_mfma_f32_16x16x32_bf16 v[36:39], v[200:203], a[80:83], v[36:39]
  v_mfma_f32_16x16x32_bf16 v[40:43], v[200:203], a[84:87], v[40:43]
  v_mfma_f32_16x16x32_bf16 v[44:47], v[200:203], a[88:91], v[44:47]
  v_mfma_f32_16x16x32_bf16 v[48:51], v[200:203], a[92:95], v[48:51]
  v_mfma_f32_16x16x32_bf16 v[52:55], v[200:203], a[96:99], v[52:55]
  v_mfma_f32_16x16x32_bf16 v[16:19], v[180:183], a[100:103], v[16:19]
  v_mfma_f32_16x16x32_bf16 v[20:23], v[180:183], a[104:107], v[20:23]
  v_mfma_f32_16x16x32_bf16 v[24:27], v[180:183], a[108:111], v[24:27]
  v_mfma_f32_16x16x32_bf16 v[28:31], v[180:183], a[112:115], v[28:31]
  v_mfma_f32_16x16x32_bf16 v[32:35], v[180:183], a[116:119], v[32:35]
  v_mfma_f32_16x16x32_bf16 v[36:39], v[204:207], a[100:103], v[36:39]
  v_mfma_f32_16x16x32_bf16 v[40:43], v[204:207], a[104:107], v[40:43]
  v_mfma_f32_16x16x32_bf16 v[44:47], v[204:207], a[108:111], v[44:47]
  v_mfma_f32_16x16x32_bf16 v[48:51], v[204:207], a[112:115], v[48:51]
  v_mfma_f32_16x16x32_bf16 v[52:55], v[204:207], a[116:119], v[52:55]
  s_nop 7
  v_cvt_pk_bf16_f32 v212, v16, v17
  v_cvt_pk_bf16_f32 v213, v18, v19
  v_cvt_pk_bf16_f32 v214, v36, v37
  v_cvt_pk_bf16_f32 v215, v38, v39
  s_add_u32 s27, s26, 4096
  buffer_store_dwordx4 v[212:215], v2, s[8:11], s27 offen
  v_cvt_pk_bf16_f32 v216, v20, v21
  v_cvt_pk_bf16_f32 v217, v22, v23
  v_cvt_pk_bf16_f32 v218, v40, v41
  v_cvt_pk_bf16_f32 v219, v42, v43
  s_add_u32 s27, s26, 24576
  buffer_store_dwordx4 v[216:219], v2, s[8:11], s27 offen
  v_cvt_pk_bf16_f32 v220, v24, v25
  v_cvt_pk_bf16_f32 v221, v26, v27
  v_cvt_pk_bf16_f32 v222, v44, v45
  v_cvt_pk_bf16_f32 v223, v46, v47
  s_add_u32 s27, s26, 45056
  buffer_store_dwordx4 v[220:223], v2, s[8:11], s27 offen
  v_cvt_pk_bf16_f32 v224, v28, v29
  v_cvt_pk_bf16_f32 v225, v30, v31
  v_cvt_pk_bf16_f32 v226, v48, v49
  v_cvt_pk_bf16_f32 v227, v50, v51
  s_add_u32 s27, s26, 65536
  buffer_store_dwordx4 v[224:227], v2, s[8:11], s27 offen
  v_cvt_pk_bf16_f32 v212, v32, v33
  v_cvt_pk_bf16_f32 v213, v34, v35
  v_cvt_pk_bf16_f32 v214, v52, v53
  v_cvt_pk_bf16_f32 v215, v54, v55
  s_add_u32 s27, s26, 86016
  buffer_store_dwordx4 v[212:215], v2, s[8:11], s27 offen
  s_add_u32 s29, s28, 2048
  s_cmp_lt_u32 s29, 5120
  s_cbranch_scc0 f_17
  s_lshl_b32 s29, s29, 10
  s_add_u32 s29, s29, 0xe00000
  buffer_store_dwordx4 v[208:211], v2, s[8:11], s29 offen
f_17:
  s_add_u32 s29, s28, 3072
  s_cmp_lt_u32 s29, 5120
  s_cbranch_scc0 f_18
  s_lshl_b32 s29, s29, 10
  s_add_u32 s29, s29, 0xe00000
  buffer_store_dwordx4 v[208:211], v2, s[8:11], s29 offen
f_18:
  s_add_u32 s29, s28, 4096
  s_cmp_lt_u32 s29, 5120
  s_cbranch_scc0 f_19
  s_lshl_b32 s29, s29, 10
  s_add_u32 s29, s29, 0xe00000
  buffer_store_dwordx4 v[208:211], v2, s[8:11], s29 offen
f_19:
  s_cmp_eq_u32 s2, 0
  s_cbranch_scc0 z_20
  s_cmp_eq_u32 s21, 0
  s_cbranch_scc0 z_20
  v_mov_b32 v8, 0
  v_mov_b32 v9, 0
  v_mov_b32 v10, 0
  v_mov_b32 v11, 0
  s_mov_b32 s26, 0x0
  buffer_store_dwordx4 v[8:11], v2, s[8:11], s26 offen
  s_add_u32 s26, s26, 1024
  buffer_store_dwordx4 v[8:11], v2, s[8:11], s26 offen
  s_add_u32 s26, s26, 1024
  buffer_store_dwordx4 v[8:11], v2, s[8:11], s26 offen
  s_add_u32 s26, s26, 1024
  buffer_store_dwordx4 v[8:11], v2, s[8:11], s26 offen
  s_add_u32 s26, s26, 1024
  buffer_store_dwordx4 v[8:11], v2, s[8:11], s26 offen
  s_add_u32 s26, s26, 1024
  buffer_store_dwordx4 v[8:11], v2, s[8:11], s26 offen
  s_add_u32 s26, s26, 1024
  s_mov_b32 s26, 0x8000
  buffer_store_dwordx4 v[8:11], v2, s[8:11], s26 offen
  s_add_u32 s26, s26, 1024
  buffer_store_dwordx4 v[8:11], v2, s[8:11], s26 offen
  s_add_u32 s26, s26, 1024
  buffer_store_dwordx4 v[8:11], v2, s[8:11], s26 offen
  s_add_u32 s26, s26, 1024
  buffer_store_dwordx4 v[8:11], v2, s[8:11], s26 offen
  s_add_u32 s26, s26, 1024
  buffer_store_dwordx4 v[8:11], v2, s[8:11], s26 offen
  s_add_u32 s26, s26, 1024
  buffer_store_dwordx4 v[8:11], v2, s[8:11], s26 offen
  s_add_u32 s26, s26, 1024
  buffer_store_dwordx4 v[8:11], v2, s[8:11], s26 offen
  s_add_u32 s26, s26, 1024
  buffer_store_dwordx4 v[8:11], v2, s[8:11], s26 offen
  s_add_u32 s26, s26, 1024
  buffer_store_dwordx4 v[8:11], v2, s[8:11], s26 offen
  s_add_u32 s26, s26, 1024
  buffer_store_dwordx4 v[8:11], v2, s[8:11], s26 offen
  s_add_u32 s26, s26, 1024
  buffer_store_dwordx4 v[8:11], v2, s[8:11], s26 offen
  s_add_u32 s26, s26, 1024
  buffer_store_dwordx4 v[8:11], v2, s[8:11], s26 offen
  s_add_u32 s26, s26, 1024
  buffer_store_dwordx4 v[8:11], v2, s[8:11], s26 offen
  s_add_u32 s26, s26, 1024
  buffer_store_dwordx4 v[8:11], v2, s[8:11], s26 offen
  s_add_u32 s26, s26, 1024
  buffer_store_dwordx4 v[8:11], v2, s[8:11], s26 offen
  s_add_u32 s26, s26, 1024
  buffer_store_dwordx4 v[8:11], v2, s[8:11], s26 offen
  s_add_u32 s26, s26, 1024
z_20:
  s_cmp_eq_u32 s2, 1
  s_cbranch_scc0 m0_21
  s_cmp_eq_u32 s21, 0
  s_cbranch_scc0 m0_21
  s_mov_b32 s12, s38
  s_and_b32 s13, s39, 0xffff
  s_mov_b32 s14, 0x2800
  s_mov_b32 s15, 0x20000
  v_and_b32 v8, 7, v1
  v_mul_u32_u24 v8, 1280, v8
  v_lshrrev_b32 v9, 4, v1
  v_lshlrev_b32 v9, 5, v9
  v_add_u32 v8, v8, v9
  v_bfe_u32 v9, v1, 3, 1
  v_lshlrev_b32 v9, 2, v9
  v_add_u32 v8, v8, v9
  s_mov_b32 s26, 0x4000
  buffer_load_dword v16, v8, s[12:15], 0 offen offset:0
  buffer_load_dword v17, v8, s[12:15], 0 offen offset:8
  buffer_load_dword v18, v8, s[12:15], 0 offen offset:16
  buffer_load_dword v19, v8, s[12:15], 0 offen offset:24
  buffer_load_dword v20, v8, s[12:15], 0 offen offset:128
  buffer_load_dword v21, v8, s[12:15], 0 offen offset:136
  buffer_load_dword v22, v8, s[12:15], 0 offen offset:144
  buffer_load_dword v23, v8, s[12:15], 0 offen offset:152
  buffer_load_dword v24, v8, s[12:15], 0 offen offset:256
  buffer_load_dword v25, v8, s[12:15], 0 offen offset:264
  buffer_load_dword v26, v8, s[12:15], 0 offen offset:272
  buffer_load_dword v27, v8, s[12:15], 0 offen offset:280
  buffer_load_dword v28, v8, s[12:15], 0 offen offset:384
  buffer_load_dword v29, v8, s[12:15], 0 offen offset:392
  buffer_load_dword v30, v8, s[12:15], 0 offen offset:400
  buffer_load_dword v31, v8, s[12:15], 0 offen offset:408
  buffer_load_dword v32, v8, s[12:15], 0 offen offset:512
  buffer_load_dword v33, v8, s[12:15], 0 offen offset:520
  buffer_load_dword v34, v8, s[12:15], 0 offen offset:528
  buffer_load_dword v35, v8, s[12:15], 0 offen offset:536
  buffer_load_dword v36, v8, s[12:15], 0 offen offset:640
  buffer_load_dword v37, v8, s[12:15], 0 offen offset:648
  buffer_load_dword v38, v8, s[12:15], 0 offen offset:656
  buffer_load_dword v39, v8, s[12:15], 0 offen offset:664
  buffer_load_dword v40, v8, s[12:15], 0 offen offset:768
  buffer_load_dword v41, v8, s[12:15], 0 offen offset:776
  buffer_load_dword v42, v8, s[12:15], 0 offen offset:784
  buffer_load_dword v43, v8, s[12:15], 0 offen offset:792
  buffer_load_dword v44, v8, s[12:15], 0 offen offset:896
  buffer_load_dword v45, v8, s[12:15], 0 offen offset:904
  buffer_load_dword v46, v8, s[12:15], 0 offen offset:912
  buffer_load_dword v47, v8, s[12:15], 0 offen offset:920
  buffer_load_dword v48, v8, s[12:15], 0 offen offset:1024
  buffer_load_dword v49, v8, s[12:15], 0 offen offset:1032
  buffer_load_dword v50, v8, s[12:15], 0 offen offset:1040
  buffer_load_dword v51, v8, s[12:15], 0 offen offset:1048
  buffer_load_dword v52, v8, s[12:15], 0 offen offset:1152
  buffer_load_dword v53, v8, s[12:15], 0 offen offset:1160
  buffer_load_dword v54, v8, s[12:15], 0 offen offset:1168
  buffer_load_dword v55, v8, s[12:15], 0 offen offset:1176
  s_waitcnt vmcnt(0)
  buffer_store_dwordx4 v[16:19], v2, s[8:11], s26 offen
  s_add_u32 s26, s26, 1024
  buffer_store_dwordx4 v[20:23], v2, s[8:11], s26 offen
  s_add_u32 s26, s26, 1024
  buffer_store_dwordx4 v[24:27], v2, s[8:11], s26 offen
  s_add_u32 s26, s26, 1024
  buffer_store_dwordx4 v[28:31], v2, s[8:11], s26 offen
  s_add_u32 s26, s26, 1024
  buffer_store_dwordx4 v[32:35], v2, s[8:11], s26 offen
  s_add_u32 s26, s26, 1024
  buffer_store_dwordx4 v[36:39], v2, s[8:11], s26 offen
  s_add_u32 s26, s26, 1024
  buffer_store_dwordx4 v[40:43], v2, s[8:11], s26 offen
  s_add_u32 s26, s26, 1024
  buffer_store_dwordx4 v[44:47], v2, s[8:11], s26 offen
  s_add_u32 s26, s26, 1024
  buffer_store_dwordx4 v[48:51], v2, s[8:11], s26 offen
  s_add_u32 s26, s26, 1024
  buffer_store_dwordx4 v[52:55], v2, s[8:11], s26 offen
  s_add_u32 s26, s26, 1024
m0_21:
k0_exit:
  s_endpgm

.section .rodata,"a"
.p2align 6
.amdhsa_kernel prep_kernel
  .amdhsa_next_free_vgpr 512
  .amdhsa_next_free_sgpr 102
  .amdhsa_accum_offset 256
  .amdhsa_group_segment_fixed_size 0
  .amdhsa_kernarg_size 104
  .amdhsa_user_sgpr_count 2
  .amdhsa_user_sgpr_kernarg_segment_ptr 1
  .amdhsa_system_sgpr_workgroup_id_x 1
.end_amdhsa_kernel
.text
.globl ka1_kernel
.p2align 8
.type ka1_kernel,@function
ka1_kernel:
  s_mov_b32 s99, 0
  s_branch ka_body

.section .rodata,"a"
.p2align 6
.amdhsa_kernel ka1_kernel
  .amdhsa_next_free_vgpr 512
  .amdhsa_next_free_sgpr 102
  .amdhsa_accum_offset 256
  .amdhsa_group_segment_fixed_size 0
  .amdhsa_kernarg_size 104
  .amdhsa_user_sgpr_count 2
  .amdhsa_user_sgpr_kernarg_segment_ptr 1
  .amdhsa_system_sgpr_workgroup_id_x 1
.end_amdhsa_kernel
.text
.globl kb1_kernel
.p2align 8
.type kb1_kernel,@function
kb1_kernel:
  s_cmp_ge_u32 s2, 256
  s_cbranch_scc1 kb1_exit
  s_load_dwordx2 s[36:37], s[0:1], 0
  s_load_dwordx2 s[38:39], s[0:1], 80
  s_load_dwordx2 s[4:5], s[0:1], 96
  v_lshrrev_b32 v1, 6, v0
  s_nop 0
  v_readfirstlane_b32 s21, v1
  v_and_b32 v1, 63, v0
  v_lshlrev_b32 v2, 4, v1
  s_waitcnt lgkmcnt(0)
  s_mov_b32 s8, s4
  s_and_b32 s9, s5, 0xffff
  s_mov_b32 s10, 0x10000000
  s_mov_b32 s11, 0x20000
  s_mov_b32 s12, s36
  s_and_b32 s13, s37, 0xffff
  s_mov_b32 s14, 0x280000
  s_mov_b32 s15, 0x20000
  s_mov_b32 s16, s38
  s_and_b32 s17, s39, 0xffff
  s_mov_b32 s18, 0x280000
  s_mov_b32 s19, 0x20000
  s_and_b32 s22, s2, 7
  s_lshl_b32 s22, s22, 2
  s_bfe_u32 s23, s2, 0x20003
  s_add_u32 s22, s22, s23
  s_lshr_b32 s23, s2, 5
  s_lshl_b32 s46, s23, 7
  s_add_u32 s46, s46, 0x8000
  s_add_u32 s48, s46, 0x1400
  s_lshl_b32 s47, s22, 7
  s_add_u32 s47, s47, 0x8400
  s_lshr_b32 s26, s2, 2
  s_and_b32 s27, s2, 3
  s_lshl_b32 s27, s27, 3
  v_and_b32 v5, 7, v1
  v_bfe_u32 v6, v1, 3, 1
  v_lshrrev_b32 v7, 4, v1
  v_lshlrev_b32 v8, 5, v6
  v_add_u32 v8, v8, v5
  v_add_u32 v8, s27, v8
  v_lshlrev_b32 v8, 4, v8
  v_lshlrev_b32 v9, 11, v7
  v_add_u32 v9, v9, v8
  v_lshlrev_b32 v10, 10, v7
  v_add_u32 v10, v10, v8
  s_mul_i32 s28, s26, 81920
  s_lshl_b32 s29, s21, 13
  s_add_u32 s28, s28, s29
  s_cmp_lt_u32 s21, 2
  s_cselect_b32 s49, 3, 2
  v_mov_b32 v32, 0
  v_mov_b32 v33, 0
  v_mov_b32 v34, 0
  v_mov_b32 v35, 0
  v_mov_b32 v36, 0
  v_mov_b32 v37, 0
  v_mov_b32 v38, 0
  v_mov_b32 v39, 0
  v_mov_b32 v64, 0
  v_mov_b32 v65, 0
  v_mov_b32 v66, 0
  v_mov_b32 v67, 0
  v_mov_b32 v68, 0
  v_mov_b32 v69, 0
  v_mov_b32 v70, 0
  v_mov_b32 v71, 0
  v_mov_b32 v88, 0
  v_mov_b32 v89, 0
  v_mov_b32 v90, 0
  v_mov_b32 v91, 0
  v_mov_b32 v92, 0
  v_mov_b32 v93, 0
  v_mov_b32 v94, 0
  v_mov_b32 v95, 0
  v_mov_b32 v112, 0
  v_mov_b32 v113, 0
  v_mov_b32 v114, 0
  v_mov_b32 v115, 0
  v_mov_b32 v116, 0
  v_mov_b32 v117, 0
  v_mov_b32 v118, 0
  v_mov_b32 v119, 0
  v_mov_b32 v136, 0
  v_mov_b32 v137, 0
  v_mov_b32 v138, 0
  v_mov_b32 v139, 0
  v_mov_b32 v140, 0
  v_mov_b32 v141, 0
  v_mov_b32 v142, 0
  v_mov_b32 v143, 0
  s_add_u32 s30, s28, 27262976
  buffer_load_dwordx4 v[48:51], v9, s[8:11], s30 offen
  s_add_u32 s30, s28, 27264000
  buffer_load_dwordx4 v[52:55], v9, s[8:11], s30 offen
  s_add_u32 s30, s28, 32505856
  buffer_load_dwordx4 v[72:75], v9, s[8:11], s30 offen
  s_add_u32 s30, s28, 32506880
  buffer_load_dwordx4 v[76:79], v9, s[8:11], s30 offen
  s_add_u32 s30, s28, 37748736
  buffer_load_dwordx4 v[96:99], v9, s[8:11], s30 offen
  s_add_u32 s30, s28, 37749760
  buffer_load_dwordx4 v[100:103], v9, s[8:11], s30 offen
  s_add_u32 s30, s28, 42991616
  buffer_load_dwordx4 v[120:123], v9, s[8:11], s30 offen
  s_add_u32 s30, s28, 42992640
  buffer_load_dwordx4 v[124:127], v9, s[8:11], s30 offen
  s_add_u32 s30, s28, 27295744
  buffer_load_dwordx4 v[56:59], v9, s[8:11], s30 offen
  s_add_u32 s30, s28, 27296768
  buffer_load_dwordx4 v[60:63], v9, s[8:11], s30 offen
  s_add_u32 s30, s28, 32538624
  buffer_load_dwordx4 v[80:83], v9, s[8:11], s30 offen
  s_add_u32 s30, s28, 32539648
  buffer_load_dwordx4 v[84:87], v9, s[8:11], s30 offen
  s_add_u32 s30, s28, 37781504
  buffer_load_dwordx4 v[104:107], v9, s[8:11], s30 offen
  s_add_u32 s30, s28, 37782528
  buffer_load_dwordx4 v[108:111], v9, s[8:11], s30 offen
  s_add_u32 s30, s28, 43024384
  buffer_load_dwordx4 v[128:131], v9, s[8:11], s30 offen
  s_add_u32 s30, s28, 43025408
  buffer_load_dwordx4 v[132:135], v9, s[8:11], s30 offen
  s_cmp_lt_u32 s21, 2
  s_cbranch_scc0 g3_22
  s_add_u32 s30, s28, 27328512
  buffer_load_dwordx4 v[64:67], v9, s[8:11], s30 offen
  s_add_u32 s30, s28, 27329536
  buffer_load_dwordx4 v[68:71], v9, s[8:11], s30 offen
  s_add_u32 s30, s28, 32571392
  buffer_load_dwordx4 v[88:91], v9, s[8:11], s30 offen
  s_add_u32 s30, s28, 32572416
  buffer_load_dwordx4 v[92:95], v9, s[8:11], s30 offen
  s_add_u32 s30, s28, 37814272
  buffer_load_dwordx4 v[112:115], v9, s[8:11], s30 offen
  s_add_u32 s30, s28, 37815296
  buffer_load_dwordx4 v[116:119], v9, s[8:11], s30 offen
  s_add_u32 s30, s28, 43057152
  buffer_load_dwordx4 v[136:139], v9, s[8:11], s30 offen
  s_add_u32 s30, s28, 43058176
  buffer_load_dwordx4 v[140:143], v9, s[8:11], s30 offen
g3_22:
  s_lshl_b32 s30, s26, 5
  s_add_u32 s30, s30, s27
  v_add_u32 v11, s30, v5
  v_mul_u32_u24 v11, 1280, v11
  v_lshlrev_b32 v12, 5, v7
  v_add_u32 v11, v11, v12
  v_lshlrev_b32 v12, 4, v6
  v_add_u32 v11, v11, v12
  s_lshl_b32 s30, s21, 7
  buffer_load_dwordx4 v[144:147], v11, s[12:15], s30 offen offset:0
  buffer_load_dwordx4 v[148:151], v11, s[12:15], s30 offen offset:512
  s_cmp_lt_u32 s21, 2
  s_cbranch_scc0 g3_23
  buffer_load_dwordx4 v[152:155], v11, s[12:15], s30 offen offset:1024
g3_23:
  s_mul_i32 s30, s22, 122880
  s_mul_i32 s31, s21, 30720
  s_add_u32 s30, s30, s31
  s_add_u32 s30, s30, 0xe100000
  s_add_u32 m0, s31, 0
  s_add_u32 s29, s30, 0
  buffer_load_dwordx4 v2, s[8:11], s29 offen lds
  s_add_u32 m0, s31, 1024
  s_add_u32 s29, s30, 1024
  buffer_load_dwordx4 v2, s[8:11], s29 offen lds
  s_add_u32 m0, s31, 2048
  s_add_u32 s29, s30, 2048
  buffer_load_dwordx4 v2, s[8:11], s29 offen lds
  s_add_u32 m0, s31, 3072
  s_add_u32 s29, s30, 3072
  buffer_load_dwordx4 v2, s[8:11], s29 offen lds
  s_add_u32 m0, s31, 4096
  s_add_u32 s29, s30, 4096
  buffer_load_dwordx4 v2, s[8:11], s29 offen lds
  s_add_u32 m0, s31, 5120
  s_add_u32 s29, s30, 5120
  buffer_load_dwordx4 v2, s[8:11], s29 offen lds
  s_add_u32 m0, s31, 6144
  s_add_u32 s29, s30, 6144
  buffer_load_dwordx4 v2, s[8:11], s29 offen lds
  s_add_u32 m0, s31, 7168
  s_add_u32 s29, s30, 7168
  buffer_load_dwordx4 v2, s[8:11], s29 offen lds
  s_add_u32 m0, s31, 8192
  s_add_u32 s29, s30, 8192
  buffer_load_dwordx4 v2, s[8:11], s29 offen lds
  s_add_u32 m0, s31, 9216
  s_add_u32 s29, s30, 9216
  buffer_load_dwordx4 v2, s[8:11], s29 offen lds
  s_add_u32 m0, s31, 10240
  s_add_u32 s29, s30, 10240
  buffer_load_dwordx4 v2, s[8:11], s29 offen lds
  s_add_u32 m0, s31, 11264
  s_add_u32 s29, s30, 11264
  buffer_load_dwordx4 v2, s[8:11], s29 offen lds
  s_add_u32 m0, s31, 12288
  s_add_u32 s29, s30, 12288
  buffer_load_dwordx4 v2, s[8:11], s29 offen lds
  s_add_u32 m0, s31, 13312
  s_add_u32 s29, s30, 13312
  buffer_load_dwordx4 v2, s[8:11], s29 offen lds
  s_add_u32 m0, s31, 14336
  s_add_u32 s29, s30, 14336
  buffer_load_dwordx4 v2, s[8:11], s29 offen lds
  s_add_u32 m0, s31, 15360
  s_add_u32 s29, s30, 15360
  buffer_load_dwordx4 v2, s[8:11], s29 offen lds
  s_add_u32 m0, s31, 16384
  s_add_u32 s29, s30, 16384
  buffer_load_dwordx4 v2, s[8:11], s29 offen lds
  s_add_u32 m0, s31, 17408
  s_add_u32 s29, s30, 17408
  buffer_load_dwordx4 v2, s[8:11], s29 offen lds
  s_add_u32 m0, s31, 18432
  s_add_u32 s29, s30, 18432
  buffer_load_dwordx4 v2, s[8:11], s29 offen lds
  s_add_u32 m0, s31, 19456
  s_add_u32 s29, s30, 19456
  buffer_load_dwordx4 v2, s[8:11], s29 offen lds
  s_add_u32 m0, s31, 20480
  s_add_u32 s29, s30, 20480
  buffer_load_dwordx4 v2, s[8:11], s29 offen lds
  s_add_u32 m0, s31, 21504
  s_add_u32 s29, s30, 21504
  buffer_load_dwordx4 v2, s[8:11], s29 offen lds
  s_add_u32 m0, s31, 22528
  s_add_u32 s29, s30, 22528
  buffer_load_dwordx4 v2, s[8:11], s29 offen lds
  s_add_u32 m0, s31, 23552
  s_add_u32 s29, s30, 23552
  buffer_load_dwordx4 v2, s[8:11], s29 offen lds
  s_add_u32 m0, s31, 24576
  s_add_u32 s29, s30, 24576
  buffer_load_dwordx4 v2, s[8:11], s29 offen lds
  s_add_u32 m0, s31, 25600
  s_add_u32 s29, s30, 25600
  buffer_load_dwordx4 v2, s[8:11], s29 offen lds
  s_add_u32 m0, s31, 26624
  s_add_u32 s29, s30, 26624
  buffer_load_dwordx4 v2, s[8:11], s29 offen lds
  s_add_u32 m0, s31, 27648
  s_add_u32 s29, s30, 27648
  buffer_load_dwordx4 v2, s[8:11], s29 offen lds
  s_add_u32 m0, s31, 28672
  s_add_u32 s29, s30, 28672
  buffer_load_dwordx4 v2, s[8:11], s29 offen lds
  s_add_u32 m0, s31, 29696
  s_add_u32 s29, s30, 29696
  buffer_load_dwordx4 v2, s[8:11], s29 offen lds
  s_waitcnt vmcnt(30)
  v_lshlrev_b32 v16, 16, v144
  v_and_b32 v17, 0xffff0000, v144
  v_lshlrev_b32 v18, 16, v145
  v_and_b32 v19, 0xffff0000, v145
  v_lshlrev_b32 v20, 16, v146
  v_and_b32 v21, 0xffff0000, v146
  v_lshlrev_b32 v22, 16, v147
  v_and_b32 v23, 0xffff0000, v147
  v_lshlrev_b32 v24, 16, v148
  v_and_b32 v25, 0xffff0000, v148
  v_lshlrev_b32 v26, 16, v149
  v_and_b32 v27, 0xffff0000, v149
  v_lshlrev_b32 v28, 16, v150
  v_and_b32 v29, 0xffff0000, v150
  v_lshlrev_b32 v30, 16, v151
  v_and_b32 v31, 0xffff0000, v151
  s_cmp_lt_u32 s21, 2
  s_cbranch_scc0 g3_24
  v_lshlrev_b32 v32, 16, v152
  v_and_b32 v33, 0xffff0000, v152
  v_lshlrev_b32 v34, 16, v153
  v_and_b32 v35, 0xffff0000, v153
  v_lshlrev_b32 v36, 16, v154
  v_and_b32 v37, 0xffff0000, v154
  v_lshlrev_b32 v38, 16, v155
  v_and_b32 v39, 0xffff0000, v155
g3_24:
  v_add_f32 v48, v48, v72
  v_add_f32 v96, v96, v120
  v_add_f32 v49, v49, v73
  v_add_f32 v97, v97, v121
  v_add_f32 v50, v50, v74
  v_add_f32 v98, v98, v122
  v_add_f32 v51, v51, v75
  v_add_f32 v99, v99, v123
  v_add_f32 v52, v52, v76
  v_add_f32 v100, v100, v124
  v_add_f32 v53, v53, v77
  v_add_f32 v101, v101, v125
  v_add_f32 v54, v54, v78
  v_add_f32 v102, v102, v126
  v_add_f32 v55, v55, v79
  v_add_f32 v103, v103, v127
  v_add_f32 v56, v56, v80
  v_add_f32 v104, v104, v128
  v_add_f32 v57, v57, v81
  v_add_f32 v105, v105, v129
  v_add_f32 v58, v58, v82
  v_add_f32 v106, v106, v130
  v_add_f32 v59, v59, v83
  v_add_f32 v107, v107, v131
  v_add_f32 v60, v60, v84
  v_add_f32 v108, v108, v132
  v_add_f32 v61, v61, v85
  v_add_f32 v109, v109, v133
  v_add_f32 v62, v62, v86
  v_add_f32 v110, v110, v134
  v_add_f32 v63, v63, v87
  v_add_f32 v111, v111, v135
  v_add_f32 v64, v64, v88
  v_add_f32 v112, v112, v136
  v_add_f32 v65, v65, v89
  v_add_f32 v113, v113, v137
  v_add_f32 v66, v66, v90
  v_add_f32 v114, v114, v138
  v_add_f32 v67, v67, v91
  v_add_f32 v115, v115, v139
  v_add_f32 v68, v68, v92
  v_add_f32 v116, v116, v140
  v_add_f32 v69, v69, v93
  v_add_f32 v117, v117, v141
  v_add_f32 v70, v70, v94
  v_add_f32 v118, v118, v142
  v_add_f32 v71, v71, v95
  v_add_f32 v119, v119, v143
  v_add_f32 v48, v48, v96
  v_add_f32 v16, v16, v48
  v_add_f32 v49, v49, v97
  v_add_f32 v17, v17, v49
  v_add_f32 v50, v50, v98
  v_add_f32 v18, v18, v50
  v_add_f32 v51, v51, v99
  v_add_f32 v19, v19, v51
  v_add_f32 v52, v52, v100
  v_add_f32 v20, v20, v52
  v_add_f32 v53, v53, v101
  v_add_f32 v21, v21, v53
  v_add_f32 v54, v54, v102
  v_add_f32 v22, v22, v54
  v_add_f32 v55, v55, v103
  v_add_f32 v23, v23, v55
  v_add_f32 v56, v56, v104
  v_add_f32 v24, v24, v56
  v_add_f32 v57, v57, v105
  v_add_f32 v25, v25, v57
  v_add_f32 v58, v58, v106
  v_add_f32 v26, v26, v58
  v_add_f32 v59, v59, v107
  v_add_f32 v27, v27, v59
  v_add_f32 v60, v60, v108
  v_add_f32 v28, v28, v60
  v_add_f32 v61, v61, v109
  v_add_f32 v29, v29, v61
  v_add_f32 v62, v62, v110
  v_add_f32 v30, v30, v62
  v_add_f32 v63, v63, v111
  v_add_f32 v31, v31, v63
  v_add_f32 v64, v64, v112
  v_add_f32 v32, v32, v64
  v_add_f32 v65, v65, v113
  v_add_f32 v33, v33, v65
  v_add_f32 v66, v66, v114
  v_add_f32 v34, v34, v66
  v_add_f32 v67, v67, v115
  v_add_f32 v35, v35, v67
  v_add_f32 v68, v68, v116
  v_add_f32 v36, v36, v68
  v_add_f32 v69, v69, v117
  v_add_f32 v37, v37, v69
  v_add_f32 v70, v70, v118
  v_add_f32 v38, v38, v70
  v_add_f32 v71, v71, v119
  v_add_f32 v39, v39, v71
  s_add_u32 s30, s28, 20971520
  buffer_store_dwordx4 v[16:19], v9, s[8:11], s30 offen sc1
  s_add_u32 s30, s28, 20972544
  buffer_store_dwordx4 v[20:23], v9, s[8:11], s30 offen sc1
  s_add_u32 s30, s28, 21004288
  buffer_store_dwordx4 v[24:27], v9, s[8:11], s30 offen sc1
  s_add_u32 s30, s28, 21005312
  buffer_store_dwordx4 v[28:31], v9, s[8:11], s30 offen sc1
  s_cmp_lt_u32 s21, 2
  s_cbranch_scc0 g3_25
  s_add_u32 s30, s28, 21037056
  buffer_store_dwordx4 v[32:35], v9, s[8:11], s30 offen sc1
  s_add_u32 s30, s28, 21038080
  buffer_store_dwordx4 v[36:39], v9, s[8:11], s30 offen sc1
g3_25:
  v_add_f32 v12, v16, v17
  v_add_f32 v12, v12, v18
  v_add_f32 v12, v12, v19
  v_add_f32 v12, v12, v20
  v_add_f32 v12, v12, v21
  v_add_f32 v12, v12, v22
  v_add_f32 v12, v12, v23
  v_add_f32 v12, v12, v24
  v_add_f32 v12, v12, v25
  v_add_f32 v12, v12, v26
  v_add_f32 v12, v12, v27
  v_add_f32 v12, v12, v28
  v_add_f32 v12, v12, v29
  v_add_f32 v12, v12, v30
  v_add_f32 v12, v12, v31
  v_add_f32 v12, v12, v32
  v_add_f32 v12, v12, v33
  v_add_f32 v12, v12, v34
  v_add_f32 v12, v12, v35
  v_add_f32 v12, v12, v36
  v_add_f32 v12, v12, v37
  v_add_f32 v12, v12, v38
  v_add_f32 v12, v12, v39
  s_nop 1
  v_add_f32_dpp v12, v12, v12 row_ror:8 row_mask:0xf bank_mask:0xf
  v_mov_b32 v13, v12
  s_nop 1
  v_permlane16_swap_b32 v12, v13
  v_add_f32 v12, v12, v13
  v_mov_b32 v13, v12
  s_nop 1
  v_permlane32_swap_b32 v12, v13
  v_add_f32 v12, v12, v13
  v_lshlrev_b32 v14, 2, v5
  v_add_u32 v14, 131072, v14
  s_lshl_b32 s30, s21, 5
  v_add_u32 v15, s30, v14
  ds_write_b32 v15, v12
  s_waitcnt lgkmcnt(0)
  s_barrier
  ds_read_b32 v48, v14
  ds_read_b32 v49, v14 offset:32
  ds_read_b32 v50, v14 offset:64
  ds_read_b32 v51, v14 offset:96
  s_waitcnt lgkmcnt(0)
  v_add_f32 v48, v48, v49
  v_add_f32 v50, v50, v51
  v_add_f32 v48, v48, v50
  v_mul_f32 v48, 0x3acccccd, v48
  v_sub_f32 v56, v16, v48
  v_sub_f32 v57, v17, v48
  v_sub_f32 v58, v18, v48
  v_sub_f32 v59, v19, v48
  v_sub_f32 v60, v20, v48
  v_sub_f32 v61, v21, v48
  v_sub_f32 v62, v22, v48
  v_sub_f32 v63, v23, v48
  v_sub_f32 v64, v24, v48
  v_sub_f32 v65, v25, v48
  v_sub_f32 v66, v26, v48
  v_sub_f32 v67, v27, v48
  v_sub_f32 v68, v28, v48
  v_sub_f32 v69, v29, v48
  v_sub_f32 v70, v30, v48
  v_sub_f32 v71, v31, v48
  v_sub_f32 v72, v32, v48
  v_sub_f32 v73, v33, v48
  v_sub_f32 v74, v34, v48
  v_sub_f32 v75, v35, v48
  v_sub_f32 v76, v36, v48
  v_sub_f32 v77, v37, v48
  v_sub_f32 v78, v38, v48
  v_sub_f32 v79, v39, v48
  s_cmp_lt_u32 s21, 2
  s_cbranch_scc1 g3z_26
  v_mov_b32 v72, 0
  v_mov_b32 v73, 0
  v_mov_b32 v74, 0
  v_mov_b32 v75, 0
  v_mov_b32 v76, 0
  v_mov_b32 v77, 0
  v_mov_b32 v78, 0
  v_mov_b32 v79, 0
g3z_26:
  v_mul_f32 v12, v56, v56
  v_fmac_f32 v12, v57, v57
  v_fmac_f32 v12, v58, v58
  v_fmac_f32 v12, v59, v59
  v_fmac_f32 v12, v60, v60
  v_fmac_f32 v12, v61, v61
  v_fmac_f32 v12, v62, v62
  v_fmac_f32 v12, v63, v63
  v_fmac_f32 v12, v64, v64
  v_fmac_f32 v12, v65, v65
  v_fmac_f32 v12, v66, v66
  v_fmac_f32 v12, v67, v67
  v_fmac_f32 v12, v68, v68
  v_fmac_f32 v12, v69, v69
  v_fmac_f32 v12, v70, v70
  v_fmac_f32 v12, v71, v71
  v_fmac_f32 v12, v72, v72
  v_fmac_f32 v12, v73, v73
  v_fmac_f32 v12, v74, v74
  v_fmac_f32 v12, v75, v75
  v_fmac_f32 v12, v76, v76
  v_fmac_f32 v12, v77, v77
  v_fmac_f32 v12, v78, v78
  v_fmac_f32 v12, v79, v79
  s_nop 1
  v_add_f32_dpp v12, v12, v12 row_ror:8 row_mask:0xf bank_mask:0xf
  v_mov_b32 v13, v12
  s_nop 1
  v_permlane16_swap_b32 v12, v13
  v_add_f32 v12, v12, v13
  v_mov_b32 v13, v12
  s_nop 1
  v_permlane32_swap_b32 v12, v13
  v_add_f32 v12, v12, v13
  v_lshlrev_b32 v14, 2, v5
  v_add_u32 v14, 131328, v14
  s_lshl_b32 s30, s21, 5
  v_add_u32 v15, s30, v14
  ds_write_b32 v15, v12
  s_waitcnt lgkmcnt(0)
  s_barrier
  ds_read_b32 v48, v14
  ds_read_b32 v49, v14 offset:32
  ds_read_b32 v50, v14 offset:64
  ds_read_b32 v51, v14 offset:96
  s_waitcnt lgkmcnt(0)
  v_add_f32 v48, v48, v49
  v_add_f32 v50, v50, v51
  v_add_f32 v48, v48, v50
  v_mov_b32 v49, 0x3727c5ac
  v_fmac_f32 v49, 0x3acccccd, v48
  v_rsq_f32 v49, v49
  s_nop 0
  v_mul_f32 v56, v56, v49
  v_mul_f32 v57, v57, v49
  v_mul_f32 v58, v58, v49
  v_mul_f32 v59, v59, v49
  v_mul_f32 v60, v60, v49
  v_mul_f32 v61, v61, v49
  v_mul_f32 v62, v62, v49
  v_mul_f32 v63, v63, v49
  v_mul_f32 v64, v64, v49
  v_mul_f32 v65, v65, v49
  v_mul_f32 v66, v66, v49
  v_mul_f32 v67, v67, v49
  v_mul_f32 v68, v68, v49
  v_mul_f32 v69, v69, v49
  v_mul_f32 v70, v70, v49
  v_mul_f32 v71, v71, v49
  v_mul_f32 v72, v72, v49
  v_mul_f32 v73, v73, v49
  v_mul_f32 v74, v74, v49
  v_mul_f32 v75, v75, v49
  v_mul_f32 v76, v76, v49
  v_mul_f32 v77, v77, v49
  v_mul_f32 v78, v78, v49
  v_mul_f32 v79, v79, v49
  v_cvt_pk_bf16_f32 v80, v56, v57
  v_cvt_pk_bf16_f32 v81, v58, v59
  v_cvt_pk_bf16_f32 v82, v60, v61
  v_cvt_pk_bf16_f32 v83, v62, v63
  v_cvt_pk_bf16_f32 v84, v64, v65
  v_cvt_pk_bf16_f32 v85, v66, v67
  v_cvt_pk_bf16_f32 v86, v68, v69
  v_cvt_pk_bf16_f32 v87, v70, v71
  v_cvt_pk_bf16_f32 v88, v72, v73
  v_cvt_pk_bf16_f32 v89, v74, v75
  v_cvt_pk_bf16_f32 v90, v76, v77
  v_cvt_pk_bf16_f32 v91, v78, v79
  s_mul_i32 s30, s26, 40960
  s_lshl_b32 s31, s21, 12
  s_add_u32 s30, s30, s31
  s_add_u32 s30, s30, 0x100000
  s_add_u32 s31, s30, 0
  buffer_store_dwordx4 v[80:83], v10, s[8:11], s31 offen sc1
  s_add_u32 s31, s30, 16384
  buffer_store_dwordx4 v[84:87], v10, s[8:11], s31 offen sc1
  s_cmp_lt_u32 s21, 2
  s_cbranch_scc0 g3_27
  s_add_u32 s31, s30, 32768
  buffer_store_dwordx4 v[88:91], v10, s[8:11], s31 offen sc1
g3_27:
  s_waitcnt vmcnt(0)
  s_barrier
  s_cmp_eq_u32 s21, 0
  s_cbranch_scc0 arr_28
  s_mov_b64 s[24:25], exec
  s_mov_b64 exec, 1
  v_mov_b32 v3, 0
  v_mov_b32 v4, 1
  buffer_atomic_add v4, v3, s[8:11], s46 offen
  s_mov_b64 exec, s[24:25]
arr_28:
  s_mov_b32 s45, 0
  v_mov_b32 v3, 0
aw_29:
  buffer_load_dword v4, v3, s[8:11], s46 offen sc1
  s_add_u32 s45, s45, 1
  s_waitcnt vmcnt(0)
  v_readfirstlane_b32 s29, v4
  s_cmp_ge_u32 s29, 32
  s_cbranch_scc1 aw_29_ok
  s_cmp_lt_u32 s45, 400000
  s_cbranch_scc1 aw_29
  s_branch kb1_abort
aw_29_ok:
  s_barrier
  s_lshl_b32 s26, s23, 3
  s_lshl_b32 s27, s21, 1
  s_add_u32 s24, s26, s27
  s_mul_i32 s27, s24, 40960
  s_add_u32 s27, s27, 0x100000
  s_add_u32 s28, s27, 40960
  v_mov_b32 v3, v2
  v_add_u32 v4, 65536, v2
  v_lshlrev_b32 v5, 7, v1
  s_add_u32 s29, s27, 0
  buffer_load_dword v6, v5, s[8:11], s29 offen sc1
  s_add_u32 s29, s27, 8192
  buffer_load_dword v6, v5, s[8:11], s29 offen sc1
  s_add_u32 s29, s27, 16384
  buffer_load_dword v6, v5, s[8:11], s29 offen sc1
  s_add_u32 s29, s27, 24576
  buffer_load_dword v6, v5, s[8:11], s29 offen sc1
  s_add_u32 s29, s27, 32768
  buffer_load_dword v6, v5, s[8:11], s29 offen sc1
  s_add_u32 s29, s27, 40960
  buffer_load_dword v6, v5, s[8:11], s29 offen sc1
  s_add_u32 s29, s27, 49152
  buffer_load_dword v6, v5, s[8:11], s29 offen sc1
  s_add_u32 s29, s27, 57344
  buffer_load_dword v6, v5, s[8:11], s29 offen sc1
  s_add_u32 s29, s27, 65536
  buffer_load_dword v6, v5, s[8:11], s29 offen sc1
  s_add_u32 s29, s27, 73728
  buffer_load_dword v6, v5, s[8:11], s29 offen sc1
  s_add_u32 s29, s27, 0
  buffer_load_dwordx4 v[16:19], v2, s[8:11], s29 offen sc1
  s_add_u32 s29, s28, 0
  buffer_load_dwordx4 v[20:23], v2, s[8:11], s29 offen sc1
  s_add_u32 s29, s27, 1024
  buffer_load_dwordx4 v[24:27], v2, s[8:11], s29 offen sc1
  s_add_u32 s29, s28, 1024
  buffer_load_dwordx4 v[28:31], v2, s[8:11], s29 offen sc1
  s_add_u32 s29, s27, 2048
  buffer_load_dwordx4 v[32:35], v2, s[8:11], s29 offen sc1
  s_add_u32 s29, s28, 2048
  buffer_load_dwordx4 v[36:39], v2, s[8:11], s29 offen sc1
  s_add_u32 s29, s27, 3072
  buffer_load_dwordx4 v[40:43], v2, s[8:11], s29 offen sc1
  s_add_u32 s29, s28, 3072
  buffer_load_dwordx4 v[44:47], v2, s[8:11], s29 offen sc1
  s_add_u32 s29, s27, 4096
  buffer_load_dwordx4 v[48:51], v2, s[8:11], s29 offen sc1
  s_add_u32 s29, s28, 4096
  buffer_load_dwordx4 v[52:55], v2, s[8:11], s29 offen sc1
  s_add_u32 s29, s27, 5120
  buffer_load_dwordx4 v[56:59], v2, s[8:11], s29 offen sc1
  s_add_u32 s29, s28, 5120
  buffer_load_dwordx4 v[60:63], v2, s[8:11], s29 offen sc1
  s_add_u32 s29, s27, 6144
  buffer_load_dwordx4 v[64:67], v2, s[8:11], s29 offen sc1
  s_add_u32 s29, s28, 6144
  buffer_load_dwordx4 v[68:71], v2, s[8:11], s29 offen sc1
  ds_read_b128 v[208:211], v3 offset:0
  ds_read_b128 v[212:215], v3 offset:40960
  ds_read_b128 v[216:219], v4 offset:16384
  s_add_u32 s29, s27, 7168
  buffer_load_dwordx4 v[72:75], v2, s[8:11], s29 offen sc1
  s_add_u32 s29, s28, 7168
  buffer_load_dwordx4 v[76:79], v2, s[8:11], s29 offen sc1
  ds_read_b128 v[220:223], v3 offset:1024
  ds_read_b128 v[224:227], v3 offset:41984
  ds_read_b128 v[228:231], v4 offset:17408
  s_waitcnt lgkmcnt(3)
  s_waitcnt vmcnt(14)
  v_mfma_f32_32x32x16_bf16 v[80:95], v[208:211], v[16:19], 0
  v_mfma_f32_32x32x16_bf16 v[96:111], v[212:215], v[16:19], 0
  v_mfma_f32_32x32x16_bf16 v[112:127], v[16:19], v[216:219], 0
  v_mfma_f32_32x32x16_bf16 v[128:143], v[208:211], v[20:23], 0
  v_mfma_f32_32x32x16_bf16 v[144:159], v[212:215], v[20:23], 0
  v_mfma_f32_32x32x16_bf16 v[160:175], v[20:23], v[216:219], 0
  s_add_u32 s29, s27, 8192
  buffer_load_dwordx4 v[16:19], v2, s[8:11], s29 offen sc1
  s_add_u32 s29, s28, 8192
  buffer_load_dwordx4 v[20:23], v2, s[8:11], s29 offen sc1
  ds_read_b128 v[208:211], v3 offset:2048
  ds_read_b128 v[212:215], v3 offset:43008
  ds_read_b128 v[216:219], v4 offset:18432
  s_waitcnt lgkmcnt(3)
  s_waitcnt vmcnt(14)
  v_mfma_f32_32x32x16_bf16 v[80:95], v[220:223], v[24:27], v[80:95]
  v_mfma_f32_32x32x16_bf16 v[96:111], v[224:227], v[24:27], v[96:111]
  v_mfma_f32_32x32x16_bf16 v[112:127], v[24:27], v[228:231], v[112:127]
  v_mfma_f32_32x32x16_bf16 v[128:143], v[220:223], v[28:31], v[128:143]
  v_mfma_f32_32x32x16_bf16 v[144:159], v[224:227], v[28:31], v[144:159]
  v_mfma_f32_32x32x16_bf16 v[160:175], v[28:31], v[228:231], v[160:175]
  s_add_u32 s29, s27, 9216
  buffer_load_dwordx4 v[24:27], v2, s[8:11], s29 offen sc1
  s_add_u32 s29, s28, 9216
  buffer_load_dwordx4 v[28:31], v2, s[8:11], s29 offen sc1
  ds_read_b128 v[220:223], v3 offset:3072
  ds_read_b128 v[224:227], v3 offset:44032
  ds_read_b128 v[228:231], v4 offset:19456
  s_waitcnt lgkmcnt(3)
  s_waitcnt vmcnt(14)
  v_mfma_f32_32x32x16_bf16 v[80:95], v[208:211], v[32:35], v[80:95]
  v_mfma_f32_32x32x16_bf16 v[96:111], v[212:215], v[32:35], v[96:111]
  v_mfma_f32_32x32x16_bf16 v[112:127], v[32:35], v[216:219], v[112:127]
  v_mfma_f32_32x32x16_bf16 v[128:143], v[208:211], v[36:39], v[128:143]
  v_mfma_f32_32x32x16_bf16 v[144:159], v[212:215], v[36:39], v[144:159]
  v_mfma_f32_32x32x16_bf16 v[160:175], v[36:39], v[216:219], v[160:175]
  s_add_u32 s29, s27, 10240
  buffer_load_dwordx4 v[32:35], v2, s[8:11], s29 offen sc1
  s_add_u32 s29, s28, 10240
  buffer_load_dwordx4 v[36:39], v2, s[8:11], s29 offen sc1
  ds_read_b128 v[208:211], v3 offset:4096
  ds_read_b128 v[212:215], v3 offset:45056
  ds_read_b128 v[216:219], v4 offset:20480
  s_waitcnt lgkmcnt(3)
  s_waitcnt vmcnt(14)
  v_mfma_f32_32x32x16_bf16 v[80:95], v[220:223], v[40:43], v[80:95]
  v_mfma_f32_32x32x16_bf16 v[96:111], v[224:227], v[40:43], v[96:111]
  v_mfma_f32_32x32x16_bf16 v[112:127], v[40:43], v[228:231], v[112:127]
  v_mfma_f32_32x32x16_bf16 v[128:143], v[220:223], v[44:47], v[128:143]
  v_mfma_f32_32x32x16_bf16 v[144:159], v[224:227], v[44:47], v[144:159]
  v_mfma_f32_32x32x16_bf16 v[160:175], v[44:47], v[228:231], v[160:175]
  s_add_u32 s29, s27, 11264
  buffer_load_dwordx4 v[40:43], v2, s[8:11], s29 offen sc1
  s_add_u32 s29, s28, 11264
  buffer_load_dwordx4 v[44:47], v2, s[8:11], s29 offen sc1
  ds_read_b128 v[220:223], v3 offset:5120
  ds_read_b128 v[224:227], v3 offset:46080
  ds_read_b128 v[228:231], v4 offset:21504
  s_waitcnt lgkmcnt(3)
  s_waitcnt vmcnt(14)
  v_mfma_f32_32x32x16_bf16 v[80:95], v[208:211], v[48:51], v[80:95]
  v_mfma_f32_32x32x16_bf16 v[96:111], v[212:215], v[48:51], v[96:111]
  v_mfma_f32_32x32x16_bf16 v[112:127], v[48:51], v[216:219], v[112:127]
  v_mfma_f32_32x32x16_bf16 v[128:143], v[208:211], v[52:55], v[128:143]
  v_mfma_f32_32x32x16_bf16 v[144:159], v[212:215], v[52:55], v[144:159]
  v_mfma_f32_32x32x16_bf16 v[160:175], v[52:55], v[216:219], v[160:175]
  s_add_u32 s29, s27, 12288
  buffer_load_dwordx4 v[48:51], v2, s[8:11], s29 offen sc1
  s_add_u32 s29, s28, 12288
  buffer_load_dwordx4 v[52:55], v2, s[8:11], s29 offen sc1
  ds_read_b128 v[208:211], v3 offset:6144
  ds_read_b128 v[212:215], v3 offset:47104
  ds_read_b128 v[216:219], v4 offset:22528
  s_waitcnt lgkmcnt(3)
  s_waitcnt vmcnt(14)
  v_mfma_f32_32x32x16_bf16 v[80:95], v[220:223], v[56:59], v[80:95]
  v_mfma_f32_32x32x16_bf16 v[96:111], v[224:227], v[56:59], v[96:111]
  v_mfma_f32_32x32x16_bf16 v[112:127], v[56:59], v[228:231], v[112:127]
  v_mfma_f32_32x32x16_bf16 v[128:143], v[220:223], v[60:63], v[128:143]
  v_mfma_f32_32x32x16_bf16 v[144:159], v[224:227], v[60:63], v[144:159]
  v_mfma_f32_32x32x16_bf16 v[160:175], v[60:63], v[228:231], v[160:175]
  s_add_u32 s29, s27, 13312
  buffer_load_dwordx4 v[56:59], v2, s[8:11], s29 offen sc1
  s_add_u32 s29, s28, 13312
  buffer_load_dwordx4 v[60:63], v2, s[8:11], s29 offen sc1
  ds_read_b128 v[220:223], v3 offset:7168
  ds_read_b128 v[224:227], v3 offset:48128
  ds_read_b128 v[228:231], v4 offset:23552
  s_waitcnt lgkmcnt(3)
  s_waitcnt vmcnt(14)
  v_mfma_f32_32x32x16_bf16 v[80:95], v[208:211], v[64:67], v[80:95]
  v_mfma_f32_32x32x16_bf16 v[96:111], v[212:215], v[64:67], v[96:111]
  v_mfma_f32_32x32x16_bf16 v[112:127], v[64:67], v[216:219], v[112:127]
  v_mfma_f32_32x32x16_bf16 v[128:143], v[208:211], v[68:71], v[128:143]
  v_mfma_f32_32x32x16_bf16 v[144:159], v[212:215], v[68:71], v[144:159]
  v_mfma_f32_32x32x16_bf16 v[160:175], v[68:71], v[216:219], v[160:175]
  s_add_u32 s29, s27, 14336
  buffer_load_dwordx4 v[64:67], v2, s[8:11], s29 offen sc1
  s_add_u32 s29, s28, 14336
  buffer_load_dwordx4 v[68:71], v2, s[8:11], s29 offen sc1
  ds_read_b128 v[208:211], v3 offset:8192
  ds_read_b128 v[212:215], v3 offset:49152
  ds_read_b128 v[216:219], v4 offset:24576
  s_waitcnt lgkmcnt(3)
  s_waitcnt vmcnt(14)
  v_mfma_f32_32x32x16_bf16 v[80:95], v[220:223], v[72:75], v[80:95]
  v_mfma_f32_32x32x16_bf16 v[96:111], v[224:227], v[72:75], v[96:111]
  v_mfma_f32_32x32x16_bf16 v[112:127], v[72:75], v[228:231], v[112:127]
  v_mfma_f32_32x32x16_bf16 v[128:143], v[220:223], v[76:79], v[128:143]
  v_mfma_f32_32x32x16_bf16 v[144:159], v[224:227], v[76:79], v[144:159]
  v_mfma_f32_32x32x16_bf16 v[160:175], v[76:79], v[228:231], v[160:175]
  s_add_u32 s29, s27, 15360
  buffer_load_dwordx4 v[72:75], v2, s[8:11], s29 offen sc1
  s_add_u32 s29, s28, 15360
  buffer_load_dwordx4 v[76:79], v2, s[8:11], s29 offen sc1
  ds_read_b128 v[220:223], v3 offset:9216
  ds_read_b128 v[224:227], v3 offset:50176
  ds_read_b128 v[228:231], v4 offset:25600
  s_waitcnt lgkmcnt(3)
  s_waitcnt vmcnt(14)
  v_mfma_f32_32x32x16_bf16 v[80:95], v[208:211], v[16:19], v[80:95]
  v_mfma_f32_32x32x16_bf16 v[96:111], v[212:215], v[16:19], v[96:111]
  v_mfma_f32_32x32x16_bf16 v[112:127], v[16:19], v[216:219], v[112:127]
  v_mfma_f32_32x32x16_bf16 v[128:143], v[208:211], v[20:23], v[128:143]
  v_mfma_f32_32x32x16_bf16 v[144:159], v[212:215], v[20:23], v[144:159]
  v_mfma_f32_32x32x16_bf16 v[160:175], v[20:23], v[216:219], v[160:175]
  s_add_u32 s29, s27, 16384
  buffer_load_dwordx4 v[16:19], v2, s[8:11], s29 offen sc1
  s_add_u32 s29, s28, 16384
  buffer_load_dwordx4 v[20:23], v2, s[8:11], s29 offen sc1
  ds_read_b128 v[208:211], v3 offset:10240
  ds_read_b128 v[212:215], v3 offset:51200
  ds_read_b128 v[216:219], v4 offset:26624
  s_waitcnt lgkmcnt(3)
  s_waitcnt vmcnt(14)
  v_mfma_f32_32x32x16_bf16 v[80:95], v[220:223], v[24:27], v[80:95]
  v_mfma_f32_32x32x16_bf16 v[96:111], v[224:227], v[24:27], v[96:111]
  v_mfma_f32_32x32x16_bf16 v[112:127], v[24:27], v[228:231], v[112:127]
  v_mfma_f32_32x32x16_bf16 v[128:143], v[220:223], v[28:31], v[128:143]
  v_mfma_f32_32x32x16_bf16 v[144:159], v[224:227], v[28:31], v[144:159]
  v_mfma_f32_32x32x16_bf16 v[160:175], v[28:31], v[228:231], v[160:175]
  s_add_u32 s29, s27, 17408
  buffer_load_dwordx4 v[24:27], v2, s[8:11], s29 offen sc1
  s_add_u32 s29, s28, 17408
  buffer_load_dwordx4 v[28:31], v2, s[8:11], s29 offen sc1
  ds_read_b128 v[220:223], v3 offset:11264
  ds_read_b128 v[224:227], v3 offset:52224
  ds_read_b128 v[228:231], v4 offset:27648
  s_waitcnt lgkmcnt(3)
  s_waitcnt vmcnt(14)
  v_mfma_f32_32x32x16_bf16 v[80:95], v[208:211], v[32:35], v[80:95]
  v_mfma_f32_32x32x16_bf16 v[96:111], v[212:215], v[32:35], v[96:111]
  v_mfma_f32_32x32x16_bf16 v[112:127], v[32:35], v[216:219], v[112:127]
  v_mfma_f32_32x32x16_bf16 v[128:143], v[208:211], v[36:39], v[128:143]
  v_mfma_f32_32x32x16_bf16 v[144:159], v[212:215], v[36:39], v[144:159]
  v_mfma_f32_32x32x16_bf16 v[160:175], v[36:39], v[216:219], v[160:175]
  s_add_u32 s29, s27, 18432
  buffer_load_dwordx4 v[32:35], v2, s[8:11], s29 offen sc1
  s_add_u32 s29, s28, 18432
  buffer_load_dwordx4 v[36:39], v2, s[8:11], s29 offen sc1
  ds_read_b128 v[208:211], v3 offset:12288
  ds_read_b128 v[212:215], v3 offset:53248
  ds_read_b128 v[216:219], v4 offset:28672
  s_waitcnt lgkmcnt(3)
  s_waitcnt vmcnt(14)
  v_mfma_f32_32x32x16_bf16 v[80:95], v[220:223], v[40:43], v[80:95]
  v_mfma_f32_32x32x16_bf16 v[96:111], v[224:227], v[40:43], v[96:111]
  v_mfma_f32_32x32x16_bf16 v[112:127], v[40:43], v[228:231], v[112:127]
  v_mfma_f32_32x32x16_bf16 v[128:143], v[220:223], v[44:47], v[128:143]
  v_mfma_f32_32x32x16_bf16 v[144:159], v[224:227], v[44:47], v[144:159]
  v_mfma_f32_32x32x16_bf16 v[160:175], v[44:47], v[228:231], v[160:175]
  s_add_u32 s29, s27, 19456
  buffer_load_dwordx4 v[40:43], v2, s[8:11], s29 offen sc1
  s_add_u32 s29, s28, 19456
  buffer_load_dwordx4 v[44:47], v2, s[8:11], s29 offen sc1
  ds_read_b128 v[220:223], v3 offset:13312
  ds_read_b128 v[224:227], v3 offset:54272
  ds_read_b128 v[228:231], v4 offset:29696
  s_waitcnt lgkmcnt(3)
  s_waitcnt vmcnt(14)
  v_mfma_f32_32x32x16_bf16 v[80:95], v[208:211], v[48:51], v[80:95]
  v_mfma_f32_32x32x16_bf16 v[96:111], v[212:215], v[48:51], v[96:111]
  v_mfma_f32_32x32x16_bf16 v[112:127], v[48:51], v[216:219], v[112:127]
  v_mfma_f32_32x32x16_bf16 v[128:143], v[208:211], v[52:55], v[128:143]
  v_mfma_f32_32x32x16_bf16 v[144:159], v[212:215], v[52:55], v[144:159]
  v_mfma_f32_32x32x16_bf16 v[160:175], v[52:55], v[216:219], v[160:175]
  s_add_u32 s29, s27, 20480
  buffer_load_dwordx4 v[48:51], v2, s[8:11], s29 offen sc1
  s_add_u32 s29, s28, 20480
  buffer_load_dwordx4 v[52:55], v2, s[8:11], s29 offen sc1
  ds_read_b128 v[208:211], v3 offset:14336
  ds_read_b128 v[212:215], v3 offset:55296
  ds_read_b128 v[216:219], v4 offset:30720
  s_waitcnt lgkmcnt(3)
  s_waitcnt vmcnt(14)
  v_mfma_f32_32x32x16_bf16 v[80:95], v[220:223], v[56:59], v[80:95]
  v_mfma_f32_32x32x16_bf16 v[96:111], v[224:227], v[56:59], v[96:111]
  v_mfma_f32_32x32x16_bf16 v[112:127], v[56:59], v[228:231], v[112:127]
  v_mfma_f32_32x32x16_bf16 v[128:143], v[220:223], v[60:63], v[128:143]
  v_mfma_f32_32x32x16_bf16 v[144:159], v[224:227], v[60:63], v[144:159]
  v_mfma_f32_32x32x16_bf16 v[160:175], v[60:63], v[228:231], v[160:175]
  s_add_u32 s29, s27, 21504
  buffer_load_dwordx4 v[56:59], v2, s[8:11], s29 offen sc1
  s_add_u32 s29, s28, 21504
  buffer_load_dwordx4 v[60:63], v2, s[8:11], s29 offen sc1
  ds_read_b128 v[220:223], v3 offset:15360
  ds_read_b128 v[224:227], v3 offset:56320
  ds_read_b128 v[228:231], v4 offset:31744
  s_waitcnt lgkmcnt(3)
  s_waitcnt vmcnt(14)
  v_mfma_f32_32x32x16_bf16 v[80:95], v[208:211], v[64:67], v[80:95]
  v_mfma_f32_32x32x16_bf16 v[96:111], v[212:215], v[64:67], v[96:111]
  v_mfma_f32_32x32x16_bf16 v[112:127], v[64:67], v[216:219], v[112:127]
  v_mfma_f32_32x32x16_bf16 v[128:143], v[208:211], v[68:71], v[128:143]
  v_mfma_f32_32x32x16_bf16 v[144:159], v[212:215], v[68:71], v[144:159]
  v_mfma_f32_32x32x16_bf16 v[160:175], v[68:71], v[216:219], v[160:175]
  s_add_u32 s29, s27, 22528
  buffer_load_dwordx4 v[64:67], v2, s[8:11], s29 offen sc1
  s_add_u32 s29, s28, 22528
  buffer_load_dwordx4 v[68:71], v2, s[8:11], s29 offen sc1
  ds_read_b128 v[208:211], v3 offset:16384
  ds_read_b128 v[212:215], v3 offset:57344
  ds_read_b128 v[216:219], v4 offset:32768
  s_waitcnt lgkmcnt(3)
  s_waitcnt vmcnt(14)
  v_mfma_f32_32x32x16_bf16 v[80:95], v[220:223], v[72:75], v[80:95]
  v_mfma_f32_32x32x16_bf16 v[96:111], v[224:227], v[72:75], v[96:111]
  v_mfma_f32_32x32x16_bf16 v[112:127], v[72:75], v[228:231], v[112:127]
  v_mfma_f32_32x32x16_bf16 v[128:143], v[220:223], v[76:79], v[128:143]
  v_mfma_f32_32x32x16_bf16 v[144:159], v[224:227], v[76:79], v[144:159]
  v_mfma_f32_32x32x16_bf16 v[160:175], v[76:79], v[228:231], v[160:175]
  s_add_u32 s29, s27, 23552
  buffer_load_dwordx4 v[72:75], v2, s[8:11], s29 offen sc1
  s_add_u32 s29, s28, 23552
  buffer_load_dwordx4 v[76:79], v2, s[8:11], s29 offen sc1
  ds_read_b128 v[220:223], v3 offset:17408
  ds_read_b128 v[224:227], v3 offset:58368
  ds_read_b128 v[228:231], v4 offset:33792
  s_waitcnt lgkmcnt(3)
  s_waitcnt vmcnt(14)
  v_mfma_f32_32x32x16_bf16 v[80:95], v[208:211], v[16:19], v[80:95]
  v_mfma_f32_32x32x16_bf16 v[96:111], v[212:215], v[16:19], v[96:111]
  v_mfma_f32_32x32x16_bf16 v[112:127], v[16:19], v[216:219], v[112:127]
  v_mfma_f32_32x32x16_bf16 v[128:143], v[208:211], v[20:23], v[128:143]
  v_mfma_f32_32x32x16_bf16 v[144:159], v[212:215], v[20:23], v[144:159]
  v_mfma_f32_32x32x16_bf16 v[160:175], v[20:23], v[216:219], v[160:175]
  s_add_u32 s29, s27, 24576
  buffer_load_dwordx4 v[16:19], v2, s[8:11], s29 offen sc1
  s_add_u32 s29, s28, 24576
  buffer_load_dwordx4 v[20:23], v2, s[8:11], s29 offen sc1
  ds_read_b128 v[208:211], v3 offset:18432
  ds_read_b128 v[212:215], v3 offset:59392
  ds_read_b128 v[216:219], v4 offset:34816
  s_waitcnt lgkmcnt(3)
  s_waitcnt vmcnt(14)
  v_mfma_f32_32x32x16_bf16 v[80:95], v[220:223], v[24:27], v[80:95]
  v_mfma_f32_32x32x16_bf16 v[96:111], v[224:227], v[24:27], v[96:111]
  v_mfma_f32_32x32x16_bf16 v[112:127], v[24:27], v[228:231], v[112:127]
  v_mfma_f32_32x32x16_bf16 v[128:143], v[220:223], v[28:31], v[128:143]
  v_mfma_f32_32x32x16_bf16 v[144:159], v[224:227], v[28:31], v[144:159]
  v_mfma_f32_32x32x16_bf16 v[160:175], v[28:31], v[228:231], v[160:175]
  s_add_u32 s29, s27, 25600
  buffer_load_dwordx4 v[24:27], v2, s[8:11], s29 offen sc1
  s_add_u32 s29, s28, 25600
  buffer_load_dwordx4 v[28:31], v2, s[8:11], s29 offen sc1
  ds_read_b128 v[220:223], v3 offset:19456
  ds_read_b128 v[224:227], v3 offset:60416
  ds_read_b128 v[228:231], v4 offset:35840
  s_waitcnt lgkmcnt(3)
  s_waitcnt vmcnt(14)
  v_mfma_f32_32x32x16_bf16 v[80:95], v[208:211], v[32:35], v[80:95]
  v_mfma_f32_32x32x16_bf16 v[96:111], v[212:215], v[32:35], v[96:111]
  v_mfma_f32_32x32x16_bf16 v[112:127], v[32:35], v[216:219], v[112:127]
  v_mfma_f32_32x32x16_bf16 v[128:143], v[208:211], v[36:39], v[128:143]
  v_mfma_f32_32x32x16_bf16 v[144:159], v[212:215], v[36:39], v[144:159]
  v_mfma_f32_32x32x16_bf16 v[160:175], v[36:39], v[216:219], v[160:175]
  s_add_u32 s29, s27, 26624
  buffer_load_dwordx4 v[32:35], v2, s[8:11], s29 offen sc1
  s_add_u32 s29, s28, 26624
  buffer_load_dwordx4 v[36:39], v2, s[8:11], s29 offen sc1
  ds_read_b128 v[208:211], v3 offset:20480
  ds_read_b128 v[212:215], v3 offset:61440
  ds_read_b128 v[216:219], v4 offset:36864
  s_waitcnt lgkmcnt(3)
  s_waitcnt vmcnt(14)
  v_mfma_f32_32x32x16_bf16 v[80:95], v[220:223], v[40:43], v[80:95]
  v_mfma_f32_32x32x16_bf16 v[96:111], v[224:227], v[40:43], v[96:111]
  v_mfma_f32_32x32x16_bf16 v[112:127], v[40:43], v[228:231], v[112:127]
  v_mfma_f32_32x32x16_bf16 v[128:143], v[220:223], v[44:47], v[128:143]
  v_mfma_f32_32x32x16_bf16 v[144:159], v[224:227], v[44:47], v[144:159]
  v_mfma_f32_32x32x16_bf16 v[160:175], v[44:47], v[228:231], v[160:175]
  s_add_u32 s29, s27, 27648
  buffer_load_dwordx4 v[40:43], v2, s[8:11], s29 offen sc1
  s_add_u32 s29, s28, 27648
  buffer_load_dwordx4 v[44:47], v2, s[8:11], s29 offen sc1
  ds_read_b128 v[220:223], v3 offset:21504
  ds_read_b128 v[224:227], v3 offset:62464
  ds_read_b128 v[228:231], v4 offset:37888
  s_waitcnt lgkmcnt(3)
  s_waitcnt vmcnt(14)
  v_mfma_f32_32x32x16_bf16 v[80:95], v[208:211], v[48:51], v[80:95]
  v_mfma_f32_32x32x16_bf16 v[96:111], v[212:215], v[48:51], v[96:111]
  v_mfma_f32_32x32x16_bf16 v[112:127], v[48:51], v[216:219], v[112:127]
  v_mfma_f32_32x32x16_bf16 v[128:143], v[208:211], v[52:55], v[128:143]
  v_mfma_f32_32x32x16_bf16 v[144:159], v[212:215], v[52:55], v[144:159]
  v_mfma_f32_32x32x16_bf16 v[160:175], v[52:55], v[216:219], v[160:175]
  s_add_u32 s29, s27, 28672
  buffer_load_dwordx4 v[48:51], v2, s[8:11], s29 offen sc1
  s_add_u32 s29, s28, 28672
  buffer_load_dwordx4 v[52:55], v2, s[8:11], s29 offen sc1
  ds_read_b128 v[208:211], v3 offset:22528
  ds_read_b128 v[212:215], v3 offset:63488
  ds_read_b128 v[216:219], v4 offset:38912
  s_waitcnt lgkmcnt(3)
  s_waitcnt vmcnt(14)
  v_mfma_f32_32x32x16_bf16 v[80:95], v[220:223], v[56:59], v[80:95]
  v_mfma_f32_32x32x16_bf16 v[96:111], v[224:227], v[56:59], v[96:111]
  v_mfma_f32_32x32x16_bf16 v[112:127], v[56:59], v[228:231], v[112:127]
  v_mfma_f32_32x32x16_bf16 v[128:143], v[220:223], v[60:63], v[128:143]
  v_mfma_f32_32x32x16_bf16 v[144:159], v[224:227], v[60:63], v[144:159]
  v_mfma_f32_32x32x16_bf16 v[160:175], v[60:63], v[228:231], v[160:175]
  s_add_u32 s29, s27, 29696
  buffer_load_dwordx4 v[56:59], v2, s[8:11], s29 offen sc1
  s_add_u32 s29, s28, 29696
  buffer_load_dwordx4 v[60:63], v2, s[8:11], s29 offen sc1
  ds_read_b128 v[220:223], v3 offset:23552
  ds_read_b128 v[224:227], v3 offset:64512
  ds_read_b128 v[228:231], v4 offset:39936
  s_waitcnt lgkmcnt(3)
  s_waitcnt vmcnt(14)
  v_mfma_f32_32x32x16_bf16 v[80:95], v[208:211], v[64:67], v[80:95]
  v_mfma_f32_32x32x16_bf16 v[96:111], v[212:215], v[64:67], v[96:111]
  v_mfma_f32_32x32x16_bf16 v[112:127], v[64:67], v[216:219], v[112:127]
  v_mfma_f32_32x32x16_bf16 v[128:143], v[208:211], v[68:71], v[128:143]
  v_mfma_f32_32x32x16_bf16 v[144:159], v[212:215], v[68:71], v[144:159]
  v_mfma_f32_32x32x16_bf16 v[160:175], v[68:71], v[216:219], v[160:175]
  s_add_u32 s29, s27, 30720
  buffer_load_dwordx4 v[64:67], v2, s[8:11], s29 offen sc1
  s_add_u32 s29, s28, 30720
  buffer_load_dwordx4 v[68:71], v2, s[8:11], s29 offen sc1
  ds_read_b128 v[208:211], v3 offset:24576
  ds_read_b128 v[212:215], v4 offset:0
  ds_read_b128 v[216:219], v4 offset:40960
  s_waitcnt lgkmcnt(3)
  s_waitcnt vmcnt(14)
  v_mfma_f32_32x32x16_bf16 v[80:95], v[220:223], v[72:75], v[80:95]
  v_mfma_f32_32x32x16_bf16 v[96:111], v[224:227], v[72:75], v[96:111]
  v_mfma_f32_32x32x16_bf16 v[112:127], v[72:75], v[228:231], v[112:127]
  v_mfma_f32_32x32x16_bf16 v[128:143], v[220:223], v[76:79], v[128:143]
  v_mfma_f32_32x32x16_bf16 v[144:159], v[224:227], v[76:79], v[144:159]
  v_mfma_f32_32x32x16_bf16 v[160:175], v[76:79], v[228:231], v[160:175]
  s_add_u32 s29, s27, 31744
  buffer_load_dwordx4 v[72:75], v2, s[8:11], s29 offen sc1
  s_add_u32 s29, s28, 31744
  buffer_load_dwordx4 v[76:79], v2, s[8:11], s29 offen sc1
  ds_read_b128 v[220:223], v3 offset:25600
  ds_read_b128 v[224:227], v4 offset:1024
  ds_read_b128 v[228:231], v4 offset:41984
  s_waitcnt lgkmcnt(3)
  s_waitcnt vmcnt(14)
  v_mfma_f32_32x32x16_bf16 v[80:95], v[208:211], v[16:19], v[80:95]
  v_mfma_f32_32x32x16_bf16 v[96:111], v[212:215], v[16:19], v[96:111]
  v_mfma_f32_32x32x16_bf16 v[112:127], v[16:19], v[216:219], v[112:127]
  v_mfma_f32_32x32x16_bf16 v[128:143], v[208:211], v[20:23], v[128:143]
  v_mfma_f32_32x32x16_bf16 v[144:159], v[212:215], v[20:23], v[144:159]
  v_mfma_f32_32x32x16_bf16 v[160:175], v[20:23], v[216:219], v[160:175]
  s_add_u32 s29, s27, 32768
  buffer_load_dwordx4 v[16:19], v2, s[8:11], s29 offen sc1
  s_add_u32 s29, s28, 32768
  buffer_load_dwordx4 v[20:23], v2, s[8:11], s29 offen sc1
  ds_read_b128 v[208:211], v3 offset:26624
  ds_read_b128 v[212:215], v4 offset:2048
  ds_read_b128 v[216:219], v4 offset:43008
  s_waitcnt lgkmcnt(3)
  s_waitcnt vmcnt(14)
  v_mfma_f32_32x32x16_bf16 v[80:95], v[220:223], v[24:27], v[80:95]
  v_mfma_f32_32x32x16_bf16 v[96:111], v[224:227], v[24:27], v[96:111]
  v_mfma_f32_32x32x16_bf16 v[112:127], v[24:27], v[228:231], v[112:127]
  v_mfma_f32_32x32x16_bf16 v[128:143], v[220:223], v[28:31], v[128:143]
  v_mfma_f32_32x32x16_bf16 v[144:159], v[224:227], v[28:31], v[144:159]
  v_mfma_f32_32x32x16_bf16 v[160:175], v[28:31], v[228:231], v[160:175]
  s_add_u32 s29, s27, 33792
  buffer_load_dwordx4 v[24:27], v2, s[8:11], s29 offen sc1
  s_add_u32 s29, s28, 33792
  buffer_load_dwordx4 v[28:31], v2, s[8:11], s29 offen sc1
  ds_read_b128 v[220:223], v3 offset:27648
  ds_read_b128 v[224:227], v4 offset:3072
  ds_read_b128 v[228:231], v4 offset:44032
  s_waitcnt lgkmcnt(3)
  s_waitcnt vmcnt(14)
  v_mfma_f32_32x32x16_bf16 v[80:95], v[208:211], v[32:35], v[80:95]
  v_mfma_f32_32x32x16_bf16 v[96:111], v[212:215], v[32:35], v[96:111]
  v_mfma_f32_32x32x16_bf16 v[112:127], v[32:35], v[216:219], v[112:127]
  v_mfma_f32_32x32x16_bf16 v[128:143], v[208:211], v[36:39], v[128:143]
  v_mfma_f32_32x32x16_bf16 v[144:159], v[212:215], v[36:39], v[144:159]
  v_mfma_f32_32x32x16_bf16 v[160:175], v[36:39], v[216:219], v[160:175]
  s_add_u32 s29, s27, 34816
  buffer_load_dwordx4 v[32:35], v2, s[8:11], s29 offen sc1
  s_add_u32 s29, s28, 34816
  buffer_load_dwordx4 v[36:39], v2, s[8:11], s29 offen sc1
  ds_read_b128 v[208:211], v3 offset:28672
  ds_read_b128 v[212:215], v4 offset:4096
  ds_read_b128 v[216:219], v4 offset:45056
  s_waitcnt lgkmcnt(3)
  s_waitcnt vmcnt(14)
  v_mfma_f32_32x32x16_bf16 v[80:95], v[220:223], v[40:43], v[80:95]
  v_mfma_f32_32x32x16_bf16 v[96:111], v[224:227], v[40:43], v[96:111]
  v_mfma_f32_32x32x16_bf16 v[112:127], v[40:43], v[228:231], v[112:127]
  v_mfma_f32_32x32x16_bf16 v[128:143], v[220:223], v[44:47], v[128:143]
  v_mfma_f32_32x32x16_bf16 v[144:159], v[224:227], v[44:47], v[144:159]
  v_mfma_f32_32x32x16_bf16 v[160:175], v[44:47], v[228:231], v[160:175]
  s_add_u32 s29, s27, 35840
  buffer_load_dwordx4 v[40:43], v2, s[8:11], s29 offen sc1
  s_add_u32 s29, s28, 35840
  buffer_load_dwordx4 v[44:47], v2, s[8:11], s29 offen sc1
  ds_read_b128 v[220:223], v3 offset:29696
  ds_read_b128 v[224:227], v4 offset:5120
  ds_read_b128 v[228:231], v4 offset:46080
  s_waitcnt lgkmcnt(3)
  s_waitcnt vmcnt(14)
  v_mfma_f32_32x32x16_bf16 v[80:95], v[208:211], v[48:51], v[80:95]
  v_mfma_f32_32x32x16_bf16 v[96:111], v[212:215], v[48:51], v[96:111]
  v_mfma_f32_32x32x16_bf16 v[112:127], v[48:51], v[216:219], v[112:127]
  v_mfma_f32_32x32x16_bf16 v[128:143], v[208:211], v[52:55], v[128:143]
  v_mfma_f32_32x32x16_bf16 v[144:159], v[212:215], v[52:55], v[144:159]
  v_mfma_f32_32x32x16_bf16 v[160:175], v[52:55], v[216:219], v[160:175]
  s_add_u32 s29, s27, 36864
  buffer_load_dwordx4 v[48:51], v2, s[8:11], s29 offen sc1
  s_add_u32 s29, s28, 36864
  buffer_load_dwordx4 v[52:55], v2, s[8:11], s29 offen sc1
  ds_read_b128 v[208:211], v3 offset:30720
  ds_read_b128 v[212:215], v4 offset:6144
  ds_read_b128 v[216:219], v4 offset:47104
  s_waitcnt lgkmcnt(3)
  s_waitcnt vmcnt(14)
  v_mfma_f32_32x32x16_bf16 v[80:95], v[220:223], v[56:59], v[80:95]
  v_mfma_f32_32x32x16_bf16 v[96:111], v[224:227], v[56:59], v[96:111]
  v_mfma_f32_32x32x16_bf16 v[112:127], v[56:59], v[228:231], v[112:127]
  v_mfma_f32_32x32x16_bf16 v[128:143], v[220:223], v[60:63], v[128:143]
  v_mfma_f32_32x32x16_bf16 v[144:159], v[224:227], v[60:63], v[144:159]
  v_mfma_f32_32x32x16_bf16 v[160:175], v[60:63], v[228:231], v[160:175]
  s_add_u32 s29, s27, 37888
  buffer_load_dwordx4 v[56:59], v2, s[8:11], s29 offen sc1
  s_add_u32 s29, s28, 37888
  buffer_load_dwordx4 v[60:63], v2, s[8:11], s29 offen sc1
  ds_read_b128 v[220:223], v3 offset:31744
  ds_read_b128 v[224:227], v4 offset:7168
  ds_read_b128 v[228:231], v4 offset:48128
  s_waitcnt lgkmcnt(3)
  s_waitcnt vmcnt(14)
  v_mfma_f32_32x32x16_bf16 v[80:95], v[208:211], v[64:67], v[80:95]
  v_mfma_f32_32x32x16_bf16 v[96:111], v[212:215], v[64:67], v[96:111]
  v_mfma_f32_32x32x16_bf16 v[112:127], v[64:67], v[216:219], v[112:127]
  v_mfma_f32_32x32x16_bf16 v[128:143], v[208:211], v[68:71], v[128:143]
  v_mfma_f32_32x32x16_bf16 v[144:159], v[212:215], v[68:71], v[144:159]
  v_mfma_f32_32x32x16_bf16 v[160:175], v[68:71], v[216:219], v[160:175]
  s_add_u32 s29, s27, 38912
  buffer_load_dwordx4 v[64:67], v2, s[8:11], s29 offen sc1
  s_add_u32 s29, s28, 38912
  buffer_load_dwordx4 v[68:71], v2, s[8:11], s29 offen sc1
  ds_read_b128 v[208:211], v3 offset:32768
  ds_read_b128 v[212:215], v4 offset:8192
  ds_read_b128 v[216:219], v4 offset:49152
  s_waitcnt lgkmcnt(3)
  s_waitcnt vmcnt(14)
  v_mfma_f32_32x32x16_bf16 v[80:95], v[220:223], v[72:75], v[80:95]
  v_mfma_f32_32x32x16_bf16 v[96:111], v[224:227], v[72:75], v[96:111]
  v_mfma_f32_32x32x16_bf16 v[112:127], v[72:75], v[228:231], v[112:127]
  v_mfma_f32_32x32x16_bf16 v[128:143], v[220:223], v[76:79], v[128:143]
  v_mfma_f32_32x32x16_bf16 v[144:159], v[224:227], v[76:79], v[144:159]
  v_mfma_f32_32x32x16_bf16 v[160:175], v[76:79], v[228:231], v[160:175]
  s_add_u32 s29, s27, 39936
  buffer_load_dwordx4 v[72:75], v2, s[8:11], s29 offen sc1
  s_add_u32 s29, s28, 39936
  buffer_load_dwordx4 v[76:79], v2, s[8:11], s29 offen sc1
  ds_read_b128 v[220:223], v3 offset:33792
  ds_read_b128 v[224:227], v4 offset:9216
  ds_read_b128 v[228:231], v4 offset:50176
  s_waitcnt lgkmcnt(3)
  s_waitcnt vmcnt(14)
  v_mfma_f32_32x32x16_bf16 v[80:95], v[208:211], v[16:19], v[80:95]
  v_mfma_f32_32x32x16_bf16 v[96:111], v[212:215], v[16:19], v[96:111]
  v_mfma_f32_32x32x16_bf16 v[112:127], v[16:19], v[216:219], v[112:127]
  v_mfma_f32_32x32x16_bf16 v[128:143], v[208:211], v[20:23], v[128:143]
  v_mfma_f32_32x32x16_bf16 v[144:159], v[212:215], v[20:23], v[144:159]
  v_mfma_f32_32x32x16_bf16 v[160:175], v[20:23], v[216:219], v[160:175]
  ds_read_b128 v[208:211], v3 offset:34816
  ds_read_b128 v[212:215], v4 offset:10240
  ds_read_b128 v[216:219], v4 offset:51200
  s_waitcnt lgkmcnt(3)
  s_waitcnt vmcnt(12)
  v_mfma_f32_32x32x16_bf16 v[80:95], v[220:223], v[24:27], v[80:95]
  v_mfma_f32_32x32x16_bf16 v[96:111], v[224:227], v[24:27], v[96:111]
  v_mfma_f32_32x32x16_bf16 v[112:127], v[24:27], v[228:231], v[112:127]
  v_mfma_f32_32x32x16_bf16 v[128:143], v[220:223], v[28:31], v[128:143]
  v_mfma_f32_32x32x16_bf16 v[144:159], v[224:227], v[28:31], v[144:159]
  v_mfma_f32_32x32x16_bf16 v[160:175], v[28:31], v[228:231], v[160:175]
  ds_read_b128 v[220:223], v3 offset:35840
  ds_read_b128 v[224:227], v4 offset:11264
  ds_read_b128 v[228:231], v4 offset:52224
  s_waitcnt lgkmcnt(3)
  s_waitcnt vmcnt(10)
  v_mfma_f32_32x32x16_bf16 v[80:95], v[208:211], v[32:35], v[80:95]
  v_mfma_f32_32x32x16_bf16 v[96:111], v[212:215], v[32:35], v[96:111]
  v_mfma_f32_32x32x16_bf16 v[112:127], v[32:35], v[216:219], v[112:127]
  v_mfma_f32_32x32x16_bf16 v[128:143], v[208:211], v[36:39], v[128:143]
  v_mfma_f32_32x32x16_bf16 v[144:159], v[212:215], v[36:39], v[144:159]
  v_mfma_f32_32x32x16_bf16 v[160:175], v[36:39], v[216:219], v[160:175]
  ds_read_b128 v[208:211], v3 offset:36864
  ds_read_b128 v[212:215], v4 offset:12288
  ds_read_b128 v[216:219], v4 offset:53248
  s_waitcnt lgkmcnt(3)
  s_waitcnt vmcnt(8)
  v_mfma_f32_32x32x16_bf16 v[80:95], v[220:223], v[40:43], v[80:95]
  v_mfma_f32_32x32x16_bf16 v[96:111], v[224:227], v[40:43], v[96:111]
  v_mfma_f32_32x32x16_bf16 v[112:127], v[40:43], v[228:231], v[112:127]
  v_mfma_f32_32x32x16_bf16 v[128:143], v[220:223], v[44:47], v[128:143]
  v_mfma_f32_32x32x16_bf16 v[144:159], v[224:227], v[44:47], v[144:159]
  v_mfma_f32_32x32x16_bf16 v[160:175], v[44:47], v[228:231], v[160:175]
  ds_read_b128 v[220:223], v3 offset:37888
  ds_read_b128 v[224:227], v4 offset:13312
  ds_read_b128 v[228:231], v4 offset:54272
  s_waitcnt lgkmcnt(3)
  s_waitcnt vmcnt(6)
  v_mfma_f32_32x32x16_bf16 v[80:95], v[208:211], v[48:51], v[80:95]
  v_mfma_f32_32x32x16_bf16 v[96:111], v[212:215], v[48:51], v[96:111]
  v_mfma_f32_32x32x16_bf16 v[112:127], v[48:51], v[216:219], v[112:127]
  v_mfma_f32_32x32x16_bf16 v[128:143], v[208:211], v[52:55], v[128:143]
  v_mfma_f32_32x32x16_bf16 v[144:159], v[212:215], v[52:55], v[144:159]
  v_mfma_f32_32x32x16_bf16 v[160:175], v[52:55], v[216:219], v[160:175]
  ds_read_b128 v[208:211], v3 offset:38912
  ds_read_b128 v[212:215], v4 offset:14336
  ds_read_b128 v[216:219], v4 offset:55296
  s_waitcnt lgkmcnt(3)
  s_waitcnt vmcnt(4)
  v_mfma_f32_32x32x16_bf16 v[80:95], v[220:223], v[56:59], v[80:95]
  v_mfma_f32_32x32x16_bf16 v[96:111], v[224:227], v[56:59], v[96:111]
  v_mfma_f32_32x32x16_bf16 v[112:127], v[56:59], v[228:231], v[112:127]
  v_mfma_f32_32x32x16_bf16 v[128:143], v[220:223], v[60:63], v[128:143]
  v_mfma_f32_32x32x16_bf16 v[144:159], v[224:227], v[60:63], v[144:159]
  v_mfma_f32_32x32x16_bf16 v[160:175], v[60:63], v[228:231], v[160:175]
  ds_read_b128 v[220:223], v3 offset:39936
  ds_read_b128 v[224:227], v4 offset:15360
  ds_read_b128 v[228:231], v4 offset:56320
  s_waitcnt lgkmcnt(3)
  s_waitcnt vmcnt(2)
  v_mfma_f32_32x32x16_bf16 v[80:95], v[208:211], v[64:67], v[80:95]
  v_mfma_f32_32x32x16_bf16 v[96:111], v[212:215], v[64:67], v[96:111]
  v_mfma_f32_32x32x16_bf16 v[112:127], v[64:67], v[216:219], v[112:127]
  v_mfma_f32_32x32x16_bf16 v[128:143], v[208:211], v[68:71], v[128:143]
  v_mfma_f32_32x32x16_bf16 v[144:159], v[212:215], v[68:71], v[144:159]
  v_mfma_f32_32x32x16_bf16 v[160:175], v[68:71], v[216:219], v[160:175]
  s_waitcnt lgkmcnt(0)
  s_waitcnt vmcnt(0)
  v_mfma_f32_32x32x16_bf16 v[80:95], v[220:223], v[72:75], v[80:95]
  v_mfma_f32_32x32x16_bf16 v[96:111], v[224:227], v[72:75], v[96:111]
  v_mfma_f32_32x32x16_bf16 v[112:127], v[72:75], v[228:231], v[112:127]
  v_mfma_f32_32x32x16_bf16 v[128:143], v[220:223], v[76:79], v[128:143]
  v_mfma_f32_32x32x16_bf16 v[144:159], v[224:227], v[76:79], v[144:159]
  v_mfma_f32_32x32x16_bf16 v[160:175], v[76:79], v[228:231], v[160:175]
  s_nop 11
  s_mov_b32 s30, 0x3ea52b5c
  v_mov_b32 v5, 0
  v_cmp_gt_u32 s[34:35], 32, v1
  v_mov_b32 v6, 1.0
  v_and_b32 v7, 31, v1
  v_cndmask_b32 v6, v5, v6, s[34:35]
  v_cmp_eq_u32 s[32:33], 20, v7
  v_mov_b32 v8, 1.0
  s_lshl_b32 s31, s22, 6
  s_add_u32 s31, s31, s24
  s_lshl_b32 s31, s31, 11
  v_mov_b32 v9, 0
  v_max3_f32 v9, v9, abs(v96), abs(v97)
  v_max3_f32 v9, v9, abs(v98), abs(v99)
  v_max3_f32 v9, v9, abs(v100), abs(v101)
  v_max3_f32 v9, v9, abs(v102), abs(v103)
  v_max3_f32 v9, v9, abs(v104), abs(v105)
  v_max3_f32 v9, v9, abs(v106), abs(v107)
  v_max3_f32 v9, v9, abs(v108), abs(v109)
  v_max3_f32 v9, v9, abs(v110), abs(v111)
  v_add_f32 v108, v108, v6
  v_cndmask_b32 v112, v112, v8, s[32:33]
  v_cndmask_b32 v113, v113, v8, s[32:33]
  v_cndmask_b32 v114, v114, v8, s[32:33]
  v_cndmask_b32 v115, v115, v8, s[32:33]
  v_cndmask_b32 v116, v116, v8, s[32:33]
  v_cndmask_b32 v117, v117, v8, s[32:33]
  v_cndmask_b32 v118, v118, v8, s[32:33]
  v_cndmask_b32 v119, v119, v8, s[32:33]
  v_cndmask_b32 v120, v120, v8, s[32:33]
  v_cndmask_b32 v121, v121, v8, s[32:33]
  v_cndmask_b32 v122, v122, v8, s[32:33]
  v_cndmask_b32 v123, v123, v8, s[32:33]
  v_cndmask_b32 v124, v124, v8, s[32:33]
  v_cndmask_b32 v125, v125, v8, s[32:33]
  v_cndmask_b32 v126, v126, v8, s[32:33]
  v_cndmask_b32 v127, v127, v8, s[32:33]
  v_cvt_pk_bf16_f32 v16, v96, v97
  v_cvt_pk_bf16_f32 v17, v98, v99
  v_cvt_pk_bf16_f32 v18, v100, v101
  v_cvt_pk_bf16_f32 v19, v102, v103
  v_cvt_pk_bf16_f32 v20, v104, v105
  v_cvt_pk_bf16_f32 v21, v106, v107
  v_cvt_pk_bf16_f32 v22, v108, v109
  v_cvt_pk_bf16_f32 v23, v110, v111
  s_add_u32 s29, s31, 245366784
  buffer_store_dwordx4 v[16:19], v2, s[8:11], s29 offen sc1
  buffer_store_dwordx4 v[20:23], v2, s[8:11], s29 offen offset:1024 sc1
  v_cvt_pk_bf16_f32 v24, v112, v113
  v_cvt_pk_bf16_f32 v25, v114, v115
  v_cvt_pk_bf16_f32 v26, v116, v117
  v_cvt_pk_bf16_f32 v27, v118, v119
  v_cvt_pk_bf16_f32 v28, v120, v121
  v_cvt_pk_bf16_f32 v29, v122, v123
  v_cvt_pk_bf16_f32 v30, v124, v125
  v_cvt_pk_bf16_f32 v31, v126, v127
  s_add_u32 s29, s31, 249561088
  buffer_store_dwordx4 v[24:27], v2, s[8:11], s29 offen sc1
  buffer_store_dwordx4 v[28:31], v2, s[8:11], s29 offen offset:1024 sc1
  v_mul_f32 v80, s30, v80
  v_mul_f32 v81, s30, v81
  v_mul_f32 v82, s30, v82
  v_mul_f32 v83, s30, v83
  v_mul_f32 v84, s30, v84
  v_mul_f32 v85, s30, v85
  v_mul_f32 v86, s30, v86
  v_mul_f32 v87, s30, v87
  v_mul_f32 v88, s30, v88
  v_mul_f32 v89, s30, v89
  v_mul_f32 v90, s30, v90
  v_mul_f32 v91, s30, v91
  v_mul_f32 v92, s30, v92
  v_mul_f32 v93, s30, v93
  v_mul_f32 v94, s30, v94
  v_mul_f32 v95, s30, v95
  v_cvt_pk_bf16_f32 v192, v80, v81
  v_cvt_pk_bf16_f32 v193, v82, v83
  v_cvt_pk_bf16_f32 v194, v84, v85
  v_cvt_pk_bf16_f32 v195, v86, v87
  v_cvt_pk_bf16_f32 v196, v88, v89
  v_cvt_pk_bf16_f32 v197, v90, v91
  v_cvt_pk_bf16_f32 v198, v92, v93
  v_cvt_pk_bf16_f32 v199, v94, v95
  v_max3_f32 v9, v9, abs(v144), abs(v145)
  v_max3_f32 v9, v9, abs(v146), abs(v147)
  v_max3_f32 v9, v9, abs(v148), abs(v149)
  v_max3_f32 v9, v9, abs(v150), abs(v151)
  v_max3_f32 v9, v9, abs(v152), abs(v153)
  v_max3_f32 v9, v9, abs(v154), abs(v155)
  v_max3_f32 v9, v9, abs(v156), abs(v157)
  v_max3_f32 v9, v9, abs(v158), abs(v159)
  v_add_f32 v156, v156, v6
  v_cndmask_b32 v160, v160, v8, s[32:33]
  v_cndmask_b32 v161, v161, v8, s[32:33]
  v_cndmask_b32 v162, v162, v8, s[32:33]
  v_cndmask_b32 v163, v163, v8, s[32:33]
  v_cndmask_b32 v164, v164, v8, s[32:33]
  v_cndmask_b32 v165, v165, v8, s[32:33]
  v_cndmask_b32 v166, v166, v8, s[32:33]
  v_cndmask_b32 v167, v167, v8, s[32:33]
  v_cndmask_b32 v168, v168, v8, s[32:33]
  v_cndmask_b32 v169, v169, v8, s[32:33]
  v_cndmask_b32 v170, v170, v8, s[32:33]
  v_cndmask_b32 v171, v171, v8, s[32:33]
  v_cndmask_b32 v172, v172, v8, s[32:33]
  v_cndmask_b32 v173, v173, v8, s[32:33]
  v_cndmask_b32 v174, v174, v8, s[32:33]
  v_cndmask_b32 v175, v175, v8, s[32:33]
  v_cvt_pk_bf16_f32 v32, v144, v145
  v_cvt_pk_bf16_f32 v33, v146, v147
  v_cvt_pk_bf16_f32 v34, v148, v149
  v_cvt_pk_bf16_f32 v35, v150, v151
  v_cvt_pk_bf16_f32 v36, v152, v153
  v_cvt_pk_bf16_f32 v37, v154, v155
  v_cvt_pk_bf16_f32 v38, v156, v157
  v_cvt_pk_bf16_f32 v39, v158, v159
  s_add_u32 s29, s31, 245368832
  buffer_store_dwordx4 v[32:35], v2, s[8:11], s29 offen sc1
  buffer_store_dwordx4 v[36:39], v2, s[8:11], s29 offen offset:1024 sc1
  v_cvt_pk_bf16_f32 v40, v160, v161
  v_cvt_pk_bf16_f32 v41, v162, v163
  v_cvt_pk_bf16_f32 v42, v164, v165
  v_cvt_pk_bf16_f32 v43, v166, v167
  v_cvt_pk_bf16_f32 v44, v168, v169
  v_cvt_pk_bf16_f32 v45, v170, v171
  v_cvt_pk_bf16_f32 v46, v172, v173
  v_cvt_pk_bf16_f32 v47, v174, v175
  s_add_u32 s29, s31, 249563136
  buffer_store_dwordx4 v[40:43], v2, s[8:11], s29 offen sc1
  buffer_store_dwordx4 v[44:47], v2, s[8:11], s29 offen offset:1024 sc1
  v_mul_f32 v128, s30, v128
  v_mul_f32 v129, s30, v129
  v_mul_f32 v130, s30, v130
  v_mul_f32 v131, s30, v131
  v_mul_f32 v132, s30, v132
  v_mul_f32 v133, s30, v133
  v_mul_f32 v134, s30, v134
  v_mul_f32 v135, s30, v135
  v_mul_f32 v136, s30, v136
  v_mul_f32 v137, s30, v137
  v_mul_f32 v138, s30, v138
  v_mul_f32 v139, s30, v139
  v_mul_f32 v140, s30, v140
  v_mul_f32 v141, s30, v141
  v_mul_f32 v142, s30, v142
  v_mul_f32 v143, s30, v143
  v_cvt_pk_bf16_f32 v200, v128, v129
  v_cvt_pk_bf16_f32 v201, v130, v131
  v_cvt_pk_bf16_f32 v202, v132, v133
  v_cvt_pk_bf16_f32 v203, v134, v135
  v_cvt_pk_bf16_f32 v204, v136, v137
  v_cvt_pk_bf16_f32 v205, v138, v139
  v_cvt_pk_bf16_f32 v206, v140, v141
  v_cvt_pk_bf16_f32 v207, v142, v143
  s_nop 1
  v_max_f32_dpp v10, v9, v9 quad_perm:[1,0,3,2] row_mask:0xf bank_mask:0xf
  s_nop 1
  v_max_f32_dpp v9, v10, v10 quad_perm:[2,3,0,1] row_mask:0xf bank_mask:0xf
  s_nop 1
  v_max_f32_dpp v10, v9, v9 row_half_mirror row_mask:0xf bank_mask:0xf
  s_nop 1
  v_max_f32_dpp v9, v10, v10 row_mirror row_mask:0xf bank_mask:0xf
  v_mov_b32 v10, v9
  s_nop 1
  v_permlane16_swap_b32 v9, v10
  v_max_f32 v9, v9, v10
  v_mov_b32 v10, v9
  s_nop 1
  v_permlane32_swap_b32 v9, v10
  v_max_f32 v9, v9, v10
  s_lshl_b32 s51, s22, 2
  s_add_u32 s51, s51, 0x9800
  v_mov_b32 v11, 0
  s_mov_b64 s[40:41], exec
  s_mov_b64 exec, 1
  buffer_atomic_umax v9, v11, s[8:11], s51 offen
  s_mov_b64 exec, s[40:41]
  s_mov_b32 s52, s24
  s_waitcnt vmcnt(0)
  s_barrier
  s_cmp_eq_u32 s21, 0
  s_cbranch_scc0 arr_30
  s_mov_b64 s[24:25], exec
  s_mov_b64 exec, 1
  v_mov_b32 v3, 0
  v_mov_b32 v4, 1
  buffer_atomic_add v4, v3, s[8:11], s47 offen
  s_mov_b64 exec, s[24:25]
arr_30:
  s_and_b32 s26, s2, 3
  s_mul_i32 s26, s26, 10
  s_mul_i32 s27, s21, 3
  s_cmp_eq_u32 s21, 3
  s_cselect_b32 s27, 8, s27
  s_add_u32 s50, s26, s27
  s_mul_i32 s26, s50, 20480
  s_add_u32 s26, s26, 0xe000000
  s_add_u32 s27, s26, 0
  buffer_load_dwordx4 a[0:3], v2, s[8:11], s27 offen
  s_add_u32 s27, s26, 1024
  buffer_load_dwordx4 a[4:7], v2, s[8:11], s27 offen
  s_add_u32 s27, s26, 2048
  buffer_load_dwordx4 a[8:11], v2, s[8:11], s27 offen
  s_add_u32 s27, s26, 3072
  buffer_load_dwordx4 a[12:15], v2, s[8:11], s27 offen
  s_add_u32 s27, s26, 4096
  buffer_load_dwordx4 a[16:19], v2, s[8:11], s27 offen
  s_add_u32 s27, s26, 5120
  buffer_load_dwordx4 a[20:23], v2, s[8:11], s27 offen
  s_add_u32 s27, s26, 6144
  buffer_load_dwordx4 a[24:27], v2, s[8:11], s27 offen
  s_add_u32 s27, s26, 7168
  buffer_load_dwordx4 a[28:31], v2, s[8:11], s27 offen
  s_add_u32 s27, s26, 8192
  buffer_load_dwordx4 a[32:35], v2, s[8:11], s27 offen
  s_add_u32 s27, s26, 9216
  buffer_load_dwordx4 a[36:39], v2, s[8:11], s27 offen
  s_add_u32 s27, s26, 10240
  buffer_load_dwordx4 a[40:43], v2, s[8:11], s27 offen
  s_add_u32 s27, s26, 11264
  buffer_load_dwordx4 a[44:47], v2, s[8:11], s27 offen
  s_add_u32 s27, s26, 12288
  buffer_load_dwordx4 a[48:51], v2, s[8:11], s27 offen
  s_add_u32 s27, s26, 13312
  buffer_load_dwordx4 a[52:55], v2, s[8:11], s27 offen
  s_add_u32 s27, s26, 14336
  buffer_load_dwordx4 a[56:59], v2, s[8:11], s27 offen
  s_add_u32 s27, s26, 15360
  buffer_load_dwordx4 a[60:63], v2, s[8:11], s27 offen
  s_add_u32 s27, s26, 16384
  buffer_load_dwordx4 a[64:67], v2, s[8:11], s27 offen
  s_add_u32 s27, s26, 17408
  buffer_load_dwordx4 a[68:71], v2, s[8:11], s27 offen
  s_add_u32 s27, s26, 18432
  buffer_load_dwordx4 a[72:75], v2, s[8:11], s27 offen
  s_add_u32 s27, s26, 19456
  buffer_load_dwordx4 a[76:79], v2, s[8:11], s27 offen
  s_add_u32 s27, s26, 20480
  buffer_load_dwordx4 a[80:83], v2, s[8:11], s27 offen
  s_add_u32 s27, s26, 21504
  buffer_load_dwordx4 a[84:87], v2, s[8:11], s27 offen
  s_add_u32 s27, s26, 22528
  buffer_load_dwordx4 a[88:91], v2, s[8:11], s27 offen
  s_add_u32 s27, s26, 23552
  buffer_load_dwordx4 a[92:95], v2, s[8:11], s27 offen
  s_add_u32 s27, s26, 24576
  buffer_load_dwordx4 a[96:99], v2, s[8:11], s27 offen
  s_add_u32 s27, s26, 25600
  buffer_load_dwordx4 a[100:103], v2, s[8:11], s27 offen
  s_add_u32 s27, s26, 26624
  buffer_load_dwordx4 a[104:107], v2, s[8:11], s27 offen
  s_add_u32 s27, s26, 27648
  buffer_load_dwordx4 a[108:111], v2, s[8:11], s27 offen
  s_add_u32 s27, s26, 28672
  buffer_load_dwordx4 a[112:115], v2, s[8:11], s27 offen
  s_add_u32 s27, s26, 29696
  buffer_load_dwordx4 a[116:119], v2, s[8:11], s27 offen
  s_add_u32 s27, s26, 30720
  buffer_load_dwordx4 a[120:123], v2, s[8:11], s27 offen
  s_add_u32 s27, s26, 31744
  buffer_load_dwordx4 a[124:127], v2, s[8:11], s27 offen
  s_add_u32 s27, s26, 32768
  buffer_load_dwordx4 a[128:131], v2, s[8:11], s27 offen
  s_add_u32 s27, s26, 33792
  buffer_load_dwordx4 a[132:135], v2, s[8:11], s27 offen
  s_add_u32 s27, s26, 34816
  buffer_load_dwordx4 a[136:139], v2, s[8:11], s27 offen
  s_add_u32 s27, s26, 35840
  buffer_load_dwordx4 a[140:143], v2, s[8:11], s27 offen
  s_add_u32 s27, s26, 36864
  buffer_load_dwordx4 a[144:147], v2, s[8:11], s27 offen
  s_add_u32 s27, s26, 37888
  buffer_load_dwordx4 a[148:151], v2, s[8:11], s27 offen
  s_add_u32 s27, s26, 38912
  buffer_load_dwordx4 a[152:155], v2, s[8:11], s27 offen
  s_add_u32 s27, s26, 39936
  buffer_load_dwordx4 a[156:159], v2, s[8:11], s27 offen
  s_cmp_lt_u32 s21, 2
  s_cbranch_scc0 g3_31
  s_add_u32 s27, s26, 40960
  buffer_load_dwordx4 a[160:163], v2, s[8:11], s27 offen
  s_add_u32 s27, s26, 41984
  buffer_load_dwordx4 a[164:167], v2, s[8:11], s27 offen
  s_add_u32 s27, s26, 43008
  buffer_load_dwordx4 a[168:171], v2, s[8:11], s27 offen
  s_add_u32 s27, s26, 44032
  buffer_load_dwordx4 a[172:175], v2, s[8:11], s27 offen
  s_add_u32 s27, s26, 45056
  buffer_load_dwordx4 a[176:179], v2, s[8:11], s27 offen
  s_add_u32 s27, s26, 46080
  buffer_load_dwordx4 a[180:183], v2, s[8:11], s27 offen
  s_add_u32 s27, s26, 47104
  buffer_load_dwordx4 a[184:187], v2, s[8:11], s27 offen
  s_add_u32 s27, s26, 48128
  buffer_load_dwordx4 a[188:191], v2, s[8:11], s27 offen
  s_add_u32 s27, s26, 49152
  buffer_load_dwordx4 a[192:195], v2, s[8:11], s27 offen
  s_add_u32 s27, s26, 50176
  buffer_load_dwordx4 a[196:199], v2, s[8:11], s27 offen
  s_add_u32 s27, s26, 51200
  buffer_load_dwordx4 a[200:203], v2, s[8:11], s27 offen
  s_add_u32 s27, s26, 52224
  buffer_load_dwordx4 a[204:207], v2, s[8:11], s27 offen
  s_add_u32 s27, s26, 53248
  buffer_load_dwordx4 a[208:211], v2, s[8:11], s27 offen
  s_add_u32 s27, s26, 54272
  buffer_load_dwordx4 a[212:215], v2, s[8:11], s27 offen
  s_add_u32 s27, s26, 55296
  buffer_load_dwordx4 a[216:219], v2, s[8:11], s27 offen
  s_add_u32 s27, s26, 56320
  buffer_load_dwordx4 a[220:223], v2, s[8:11], s27 offen
  s_add_u32 s27, s26, 57344
  buffer_load_dwordx4 a[224:227], v2, s[8:11], s27 offen
  s_add_u32 s27, s26, 58368
  buffer_load_dwordx4 a[228:231], v2, s[8:11], s27 offen
  s_add_u32 s27, s26, 59392
  buffer_load_dwordx4 a[232:235], v2, s[8:11], s27 offen
  s_add_u32 s27, s26, 60416
  buffer_load_dwordx4 a[236:239], v2, s[8:11], s27 offen
g3_31:
  v_mov_b32 v12, 0
  v_lshlrev_b32 v6, 16, v192
  v_and_b32 v7, 0xffff0000, v192
  v_add_f32_e64 v12, v12, abs(v6)
  v_add_f32_e64 v12, v12, abs(v7)
  v_lshlrev_b32 v6, 16, v193
  v_and_b32 v7, 0xffff0000, v193
  v_add_f32_e64 v12, v12, abs(v6)
  v_add_f32_e64 v12, v12, abs(v7)
  v_lshlrev_b32 v6, 16, v194
  v_and_b32 v7, 0xffff0000, v194
  v_add_f32_e64 v12, v12, abs(v6)
  v_add_f32_e64 v12, v12, abs(v7)
  v_lshlrev_b32 v6, 16, v195
  v_and_b32 v7, 0xffff0000, v195
  v_add_f32_e64 v12, v12, abs(v6)
  v_add_f32_e64 v12, v12, abs(v7)
  v_lshlrev_b32 v6, 16, v196
  v_and_b32 v7, 0xffff0000, v196
  v_add_f32_e64 v12, v12, abs(v6)
  v_add_f32_e64 v12, v12, abs(v7)
  v_lshlrev_b32 v6, 16, v197
  v_and_b32 v7, 0xffff0000, v197
  v_add_f32_e64 v12, v12, abs(v6)
  v_add_f32_e64 v12, v12, abs(v7)
  v_lshlrev_b32 v6, 16, v198
  v_and_b32 v7, 0xffff0000, v198
  v_add_f32_e64 v12, v12, abs(v6)
  v_add_f32_e64 v12, v12, abs(v7)
  v_lshlrev_b32 v6, 16, v199
  v_and_b32 v7, 0xffff0000, v199
  v_add_f32_e64 v12, v12, abs(v6)
  v_add_f32_e64 v12, v12, abs(v7)
  v_mov_b32 v6, v12
  s_nop 1
  v_permlane32_swap_b32 v12, v6
  v_add_f32 v12, v12, v6
  v_mov_b32 v13, 0
  v_lshlrev_b32 v6, 16, v200
  v_and_b32 v7, 0xffff0000, v200
  v_add_f32_e64 v13, v13, abs(v6)
  v_add_f32_e64 v13, v13, abs(v7)
  v_lshlrev_b32 v6, 16, v201
  v_and_b32 v7, 0xffff0000, v201
  v_add_f32_e64 v13, v13, abs(v6)
  v_add_f32_e64 v13, v13, abs(v7)
  v_lshlrev_b32 v6, 16, v202
  v_and_b32 v7, 0xffff0000, v202
  v_add_f32_e64 v13, v13, abs(v6)
  v_add_f32_e64 v13, v13, abs(v7)
  v_lshlrev_b32 v6, 16, v203
  v_and_b32 v7, 0xffff0000, v203
  v_add_f32_e64 v13, v13, abs(v6)
  v_add_f32_e64 v13, v13, abs(v7)
  v_lshlrev_b32 v6, 16, v204
  v_and_b32 v7, 0xffff0000, v204
  v_add_f32_e64 v13, v13, abs(v6)
  v_add_f32_e64 v13, v13, abs(v7)
  v_lshlrev_b32 v6, 16, v205
  v_and_b32 v7, 0xffff0000, v205
  v_add_f32_e64 v13, v13, abs(v6)
  v_add_f32_e64 v13, v13, abs(v7)
  v_lshlrev_b32 v6, 16, v206
  v_and_b32 v7, 0xffff0000, v206
  v_add_f32_e64 v13, v13, abs(v6)
  v_add_f32_e64 v13, v13, abs(v7)
  v_lshlrev_b32 v6, 16, v207
  v_and_b32 v7, 0xffff0000, v207
  v_add_f32_e64 v13, v13, abs(v6)
  v_add_f32_e64 v13, v13, abs(v7)
  v_mov_b32 v6, v13
  s_nop 1
  v_permlane32_swap_b32 v13, v6
  v_add_f32 v13, v13, v6
  v_mov_b32 v8, -1
  v_mov_b32 v9, -1
  v_mov_b32 v10, -1
  v_mov_b32 v11, -1
  s_lshl_b32 s30, s2, 2
  s_add_u32 s30, s30, s21
  s_add_u32 s31, s30, 0
  s_cmp_lt_u32 s31, 2560
  s_cbranch_scc0 f_32
  s_lshl_b32 s31, s31, 10
  s_add_u32 s31, s31, 0x400000
  buffer_store_dwordx4 v[8:11], v2, s[8:11], s31 offen
f_32:
  s_add_u32 s31, s30, 1024
  s_cmp_lt_u32 s31, 2560
  s_cbranch_scc0 f_33
  s_lshl_b32 s31, s31, 10
  s_add_u32 s31, s31, 0x400000
  buffer_store_dwordx4 v[8:11], v2, s[8:11], s31 offen
f_33:
  s_add_u32 s31, s30, 2048
  s_cmp_lt_u32 s31, 2560
  s_cbranch_scc0 f_34
  s_lshl_b32 s31, s31, 10
  s_add_u32 s31, s31, 0x400000
  buffer_store_dwordx4 v[8:11], v2, s[8:11], s31 offen
f_34:
  s_add_u32 s31, s30, 0
  s_cmp_lt_u32 s31, 1280
  s_cbranch_scc0 f_35
  s_lshl_b32 s31, s31, 10
  s_add_u32 s31, s31, 0x700000
  buffer_store_dwordx4 v[8:11], v2, s[8:11], s31 offen
f_35:
  s_add_u32 s31, s30, 1024
  s_cmp_lt_u32 s31, 1280
  s_cbranch_scc0 f_36
  s_lshl_b32 s31, s31, 10
  s_add_u32 s31, s31, 0x700000
  buffer_store_dwordx4 v[8:11], v2, s[8:11], s31 offen
f_36:
  s_add_u32 s31, s30, 0
  s_cmp_lt_u32 s31, 640
  s_cbranch_scc0 f_37
  s_lshl_b32 s31, s31, 10
  s_add_u32 s31, s31, 0xa00000
  buffer_store_dwordx4 v[8:11], v2, s[8:11], s31 offen
f_37:
  s_add_u32 s31, s30, 0
  s_cmp_lt_u32 s31, 5120
  s_cbranch_scc0 f_38
  s_lshl_b32 s31, s31, 10
  s_add_u32 s31, s31, 0xe00000
  buffer_store_dwordx4 v[8:11], v2, s[8:11], s31 offen
f_38:
  s_add_u32 s31, s30, 1024
  s_cmp_lt_u32 s31, 5120
  s_cbranch_scc0 f_39
  s_lshl_b32 s31, s31, 10
  s_add_u32 s31, s31, 0xe00000
  buffer_store_dwordx4 v[8:11], v2, s[8:11], s31 offen
f_39:
  s_add_u32 s31, s30, 2048
  s_cmp_lt_u32 s31, 5120
  s_cbranch_scc0 f_40
  s_lshl_b32 s31, s31, 10
  s_add_u32 s31, s31, 0xe00000
  buffer_store_dwordx4 v[8:11], v2, s[8:11], s31 offen
f_40:
  s_add_u32 s31, s30, 3072
  s_cmp_lt_u32 s31, 5120
  s_cbranch_scc0 f_41
  s_lshl_b32 s31, s31, 10
  s_add_u32 s31, s31, 0xe00000
  buffer_store_dwordx4 v[8:11], v2, s[8:11], s31 offen
f_41:
  s_add_u32 s31, s30, 4096
  s_cmp_lt_u32 s31, 5120
  s_cbranch_scc0 f_42
  s_lshl_b32 s31, s31, 10
  s_add_u32 s31, s31, 0xe00000
  buffer_store_dwordx4 v[8:11], v2, s[8:11], s31 offen
f_42:
  s_cmp_eq_u32 s2, 0
  s_cbranch_scc0 z_43
  s_cmp_eq_u32 s21, 0
  s_cbranch_scc0 z_43
  v_mov_b32 v8, 0
  v_mov_b32 v9, 0
  v_mov_b32 v10, 0
  v_mov_b32 v11, 0
  s_mov_b32 s30, 0x0
  buffer_store_dwordx4 v[8:11], v2, s[8:11], s30 offen
  s_add_u32 s30, s30, 1024
  buffer_store_dwordx4 v[8:11], v2, s[8:11], s30 offen
  s_add_u32 s30, s30, 1024
  buffer_store_dwordx4 v[8:11], v2, s[8:11], s30 offen
  s_add_u32 s30, s30, 1024
  buffer_store_dwordx4 v[8:11], v2, s[8:11], s30 offen
  s_add_u32 s30, s30, 1024
  buffer_store_dwordx4 v[8:11], v2, s[8:11], s30 offen
  s_add_u32 s30, s30, 1024
z_43:
  s_mov_b32 s45, 0
  v_mov_b32 v3, 0
aw_44:
  buffer_load_dword v4, v3, s[8:11], s47 offen sc1
  s_add_u32 s45, s45, 1
  s_waitcnt vmcnt(0)
  v_readfirstlane_b32 s29, v4
  s_cmp_ge_u32 s29, 8
  s_cbranch_scc1 aw_44_ok
  s_cmp_lt_u32 s45, 400000
  s_cbranch_scc1 aw_44
  s_branch kb1_abort
aw_44_ok:
  v_mov_b32 v3, 0
  buffer_load_dword v4, v3, s[8:11], s51 offen sc1
  s_lshl_b32 s25, s22, 6
  s_lshl_b32 s27, s25, 11
  s_add_u32 s28, s27, 0xee00000
  s_add_u32 s27, s27, 0xea00000
  s_mov_b32 s41, 0
  s_mul_i32 s53, s41, 32768
  s_lshl_b32 s31, s21, 13
  s_add_u32 s53, s53, s31
  s_add_u32 m0, s31, 0
  s_add_u32 s29, s53, s27
  s_add_u32 s29, s29, 0
  buffer_load_dwordx4 v2, s[8:11], s29 offen sc1 lds
  s_add_u32 m0, s31, 1024
  s_add_u32 s29, s53, s27
  s_add_u32 s29, s29, 1024
  buffer_load_dwordx4 v2, s[8:11], s29 offen sc1 lds
  s_add_u32 m0, s31, 2048
  s_add_u32 s29, s53, s27
  s_add_u32 s29, s29, 2048
  buffer_load_dwordx4 v2, s[8:11], s29 offen sc1 lds
  s_add_u32 m0, s31, 3072
  s_add_u32 s29, s53, s27
  s_add_u32 s29, s29, 3072
  buffer_load_dwordx4 v2, s[8:11], s29 offen sc1 lds
  s_add_u32 m0, s31, 4096
  s_add_u32 s29, s53, s27
  s_add_u32 s29, s29, 4096
  buffer_load_dwordx4 v2, s[8:11], s29 offen sc1 lds
  s_add_u32 m0, s31, 5120
  s_add_u32 s29, s53, s27
  s_add_u32 s29, s29, 5120
  buffer_load_dwordx4 v2, s[8:11], s29 offen sc1 lds
  s_add_u32 m0, s31, 6144
  s_add_u32 s29, s53, s27
  s_add_u32 s29, s29, 6144
  buffer_load_dwordx4 v2, s[8:11], s29 offen sc1 lds
  s_add_u32 m0, s31, 7168
  s_add_u32 s29, s53, s27
  s_add_u32 s29, s29, 7168
  buffer_load_dwordx4 v2, s[8:11], s29 offen sc1 lds
  s_add_u32 m0, s31, 32768
  s_add_u32 s29, s53, s28
  s_add_u32 s29, s29, 0
  buffer_load_dwordx4 v2, s[8:11], s29 offen sc1 lds
  s_add_u32 m0, s31, 33792
  s_add_u32 s29, s53, s28
  s_add_u32 s29, s29, 1024
  buffer_load_dwordx4 v2, s[8:11], s29 offen sc1 lds
  s_add_u32 m0, s31, 34816
  s_add_u32 s29, s53, s28
  s_add_u32 s29, s29, 2048
  buffer_load_dwordx4 v2, s[8:11], s29 offen sc1 lds
  s_add_u32 m0, s31, 35840
  s_add_u32 s29, s53, s28
  s_add_u32 s29, s29, 3072
  buffer_load_dwordx4 v2, s[8:11], s29 offen sc1 lds
  s_add_u32 m0, s31, 36864
  s_add_u32 s29, s53, s28
  s_add_u32 s29, s29, 4096
  buffer_load_dwordx4 v2, s[8:11], s29 offen sc1 lds
  s_add_u32 m0, s31, 37888
  s_add_u32 s29, s53, s28
  s_add_u32 s29, s29, 5120
  buffer_load_dwordx4 v2, s[8:11], s29 offen sc1 lds
  s_add_u32 m0, s31, 38912
  s_add_u32 s29, s53, s28
  s_add_u32 s29, s29, 6144
  buffer_load_dwordx4 v2, s[8:11], s29 offen sc1 lds
  s_add_u32 m0, s31, 39936
  s_add_u32 s29, s53, s28
  s_add_u32 s29, s29, 7168
  buffer_load_dwordx4 v2, s[8:11], s29 offen sc1 lds
  s_waitcnt vmcnt(16)
  v_mul_f32 v12, v12, v4
  v_mul_f32 v12, 0x3f820000, v12
  v_mul_f32 v13, v13, v4
  v_mul_f32 v13, 0x3f820000, v13
  s_mov_b32 s40, 0
kb1_main:
  v_lshrrev_b32 v5, 16, v12
  v_or_b32 v5, 0x8000, v5
  v_and_b32 v6, 0xffff0000, v198
  v_or_b32 v5, v5, v6
  v_cndmask_b32 v198, v198, v5, s[34:35]
  v_lshrrev_b32 v5, 16, v13
  v_or_b32 v5, 0x8000, v5
  v_and_b32 v6, 0xffff0000, v206
  v_or_b32 v5, v5, v6
  v_cndmask_b32 v206, v206, v5, s[34:35]
kb1_main2:
  v_mov_b32 v112, 0
  v_mov_b32 v113, 0
  v_mov_b32 v114, 0
  v_mov_b32 v115, 0
  v_mov_b32 v116, 0
  v_mov_b32 v117, 0
  v_mov_b32 v118, 0
  v_mov_b32 v119, 0
  v_mov_b32 v120, 0
  v_mov_b32 v121, 0
  v_mov_b32 v122, 0
  v_mov_b32 v123, 0
  v_mov_b32 v124, 0
  v_mov_b32 v125, 0
  v_mov_b32 v126, 0
  v_mov_b32 v127, 0
  v_mov_b32 v128, 0
  v_mov_b32 v129, 0
  v_mov_b32 v130, 0
  v_mov_b32 v131, 0
  v_mov_b32 v132, 0
  v_mov_b32 v133, 0
  v_mov_b32 v134, 0
  v_mov_b32 v135, 0
  v_mov_b32 v136, 0
  v_mov_b32 v137, 0
  v_mov_b32 v138, 0
  v_mov_b32 v139, 0
  v_mov_b32 v140, 0
  v_mov_b32 v141, 0
  v_mov_b32 v142, 0
  v_mov_b32 v143, 0
  v_mov_b32 v3, v2
  v_add_u32 v4, 65536, v2
kb1_chunk2:
  s_waitcnt vmcnt(0)
  s_barrier
  s_add_u32 s41, s41, 1
  s_min_u32 s29, s41, 3
  s_mul_i32 s53, s29, 32768
  s_lshl_b32 s31, s21, 13
  s_add_u32 s53, s53, s31
  ds_read_b128 v[32:35], v3 offset:0
  ds_read_b128 v[36:39], v3 offset:1024
  ds_read_b128 v[48:51], v3 offset:32768
  ds_read_b128 v[52:55], v3 offset:33792
  ds_read_b128 v[40:43], v3 offset:2048
  ds_read_b128 v[44:47], v3 offset:3072
  s_waitcnt lgkmcnt(4)
  v_mfma_f32_32x32x16_bf16 v[64:79], v[32:35], v[192:195], 0
  v_mfma_f32_32x32x16_bf16 v[64:79], v[36:39], v[196:199], v[64:79]
  s_nop 11
  v_exp_f32 v64, v64
  v_exp_f32 v65, v65
  v_exp_f32 v66, v66
  v_exp_f32 v67, v67
  v_cvt_pk_bf16_f32 v96, v64, v65
  v_exp_f32 v68, v68
  v_exp_f32 v69, v69
  v_cvt_pk_bf16_f32 v97, v66, v67
  v_exp_f32 v70, v70
  v_mfma_f32_32x32x16_bf16 v[80:95], v[32:35], v[200:203], 0
  v_exp_f32 v71, v71
  v_cvt_pk_bf16_f32 v98, v68, v69
  v_exp_f32 v72, v72
  v_exp_f32 v73, v73
  v_cvt_pk_bf16_f32 v99, v70, v71
  v_mfma_f32_32x32x16_bf16 v[80:95], v[36:39], v[204:207], v[80:95]
  v_exp_f32 v74, v74
  v_exp_f32 v75, v75
  ds_read_b128 v[56:59], v3 offset:34816
  v_cvt_pk_bf16_f32 v100, v72, v73
  v_exp_f32 v76, v76
  v_exp_f32 v77, v77
  ds_read_b128 v[60:63], v3 offset:35840
  v_cvt_pk_bf16_f32 v101, v74, v75
  v_exp_f32 v78, v78
  s_add_u32 m0, s31, 65536
  s_add_u32 s29, s53, s27
  s_add_u32 s29, s29, 0
  buffer_load_dwordx4 v2, s[8:11], s29 offen sc1 lds
  v_exp_f32 v79, v79
  v_cvt_pk_bf16_f32 v102, v76, v77
  v_cvt_pk_bf16_f32 v103, v78, v79
  s_waitcnt lgkmcnt(4)
  v_mfma_f32_32x32x16_bf16 v[112:127], v[48:51], v[96:99], v[112:127]
  v_exp_f32 v80, v80
  v_exp_f32 v81, v81
  v_exp_f32 v82, v82
  v_exp_f32 v83, v83
  v_mfma_f32_32x32x16_bf16 v[112:127], v[52:55], v[100:103], v[112:127]
  v_cvt_pk_bf16_f32 v104, v80, v81
  v_exp_f32 v84, v84
  v_exp_f32 v85, v85
  v_cvt_pk_bf16_f32 v105, v82, v83
  v_exp_f32 v86, v86
  s_waitcnt lgkmcnt(2)
  v_mfma_f32_32x32x16_bf16 v[64:79], v[40:43], v[192:195], 0
  v_exp_f32 v87, v87
  v_cvt_pk_bf16_f32 v106, v84, v85
  v_exp_f32 v88, v88
  v_exp_f32 v89, v89
  v_cvt_pk_bf16_f32 v107, v86, v87
  v_mfma_f32_32x32x16_bf16 v[64:79], v[44:47], v[196:199], v[64:79]
  v_exp_f32 v90, v90
  v_exp_f32 v91, v91
  ds_read_b128 v[32:35], v3 offset:4096
  v_cvt_pk_bf16_f32 v108, v88, v89
  v_exp_f32 v92, v92
  v_exp_f32 v93, v93
  ds_read_b128 v[36:39], v3 offset:5120
  v_cvt_pk_bf16_f32 v109, v90, v91
  v_exp_f32 v94, v94
  v_exp_f32 v95, v95
  v_cvt_pk_bf16_f32 v110, v92, v93
  v_cvt_pk_bf16_f32 v111, v94, v95
  v_mfma_f32_32x32x16_bf16 v[128:143], v[48:51], v[104:107], v[128:143]
  v_exp_f32 v64, v64
  v_exp_f32 v65, v65
  v_exp_f32 v66, v66
  v_exp_f32 v67, v67
  v_mfma_f32_32x32x16_bf16 v[128:143], v[52:55], v[108:111], v[128:143]
  v_cvt_pk_bf16_f32 v96, v64, v65
  v_exp_f32 v68, v68
  v_exp_f32 v69, v69
  v_cvt_pk_bf16_f32 v97, v66, v67
  v_exp_f32 v70, v70
  v_mfma_f32_32x32x16_bf16 v[80:95], v[40:43], v[200:203], 0
  v_exp_f32 v71, v71
  v_cvt_pk_bf16_f32 v98, v68, v69
  v_exp_f32 v72, v72
  v_exp_f32 v73, v73
  v_cvt_pk_bf16_f32 v99, v70, v71
  v_mfma_f32_32x32x16_bf16 v[80:95], v[44:47], v[204:207], v[80:95]
  v_exp_f32 v74, v74
  v_exp_f32 v75, v75
  ds_read_b128 v[48:51], v3 offset:36864
  v_cvt_pk_bf16_f32 v100, v72, v73
  v_exp_f32 v76, v76
  v_exp_f32 v77, v77
  ds_read_b128 v[52:55], v3 offset:37888
  v_cvt_pk_bf16_f32 v101, v74, v75
  v_exp_f32 v78, v78
  s_add_u32 m0, s31, 66560
  s_add_u32 s29, s53, s27
  s_add_u32 s29, s29, 1024
  buffer_load_dwordx4 v2, s[8:11], s29 offen sc1 lds
  v_exp_f32 v79, v79
  v_cvt_pk_bf16_f32 v102, v76, v77
  v_cvt_pk_bf16_f32 v103, v78, v79
  s_waitcnt lgkmcnt(4)
  v_mfma_f32_32x32x16_bf16 v[112:127], v[56:59], v[96:99], v[112:127]
  v_exp_f32 v80, v80
  v_exp_f32 v81, v81
  v_exp_f32 v82, v82
  v_exp_f32 v83, v83
  v_mfma_f32_32x32x16_bf16 v[112:127], v[60:63], v[100:103], v[112:127]
  v_cvt_pk_bf16_f32 v104, v80, v81
  v_exp_f32 v84, v84
  v_exp_f32 v85, v85
  v_cvt_pk_bf16_f32 v105, v82, v83
  v_exp_f32 v86, v86
  s_waitcnt lgkmcnt(2)
  v_mfma_f32_32x32x16_bf16 v[64:79], v[32:35], v[192:195], 0
  v_exp_f32 v87, v87
  v_cvt_pk_bf16_f32 v106, v84, v85
  v_exp_f32 v88, v88
  v_exp_f32 v89, v89
  v_cvt_pk_bf16_f32 v107, v86, v87
  v_mfma_f32_32x32x16_bf16 v[64:79], v[36:39], v[196:199], v[64:79]
  v_exp_f32 v90, v90
  v_exp_f32 v91, v91
  ds_read_b128 v[40:43], v3 offset:6144
  v_cvt_pk_bf16_f32 v108, v88, v89
  v_exp_f32 v92, v92
  v_exp_f32 v93, v93
  ds_read_b128 v[44:47], v3 offset:7168
  v_cvt_pk_bf16_f32 v109, v90, v91
  v_exp_f32 v94, v94
  v_exp_f32 v95, v95
  v_cvt_pk_bf16_f32 v110, v92, v93
  v_cvt_pk_bf16_f32 v111, v94, v95
  v_mfma_f32_32x32x16_bf16 v[128:143], v[56:59], v[104:107], v[128:143]
  v_exp_f32 v64, v64
  v_exp_f32 v65, v65
  v_exp_f32 v66, v66
  v_exp_f32 v67, v67
  v_mfma_f32_32x32x16_bf16 v[128:143], v[60:63], v[108:111], v[128:143]
  v_cvt_pk_bf16_f32 v96, v64, v65
  v_exp_f32 v68, v68
  v_exp_f32 v69, v69
  v_cvt_pk_bf16_f32 v97, v66, v67
  v_exp_f32 v70, v70
  v_mfma_f32_32x32x16_bf16 v[80:95], v[32:35], v[200:203], 0
  v_exp_f32 v71, v71
  v_cvt_pk_bf16_f32 v98, v68, v69
  v_exp_f32 v72, v72
  v_exp_f32 v73, v73
  v_cvt_pk_bf16_f32 v99, v70, v71
  v_mfma_f32_32x32x16_bf16 v[80:95], v[36:39], v[204:207], v[80:95]
  v_exp_f32 v74, v74
  v_exp_f32 v75, v75
  ds_read_b128 v[56:59], v3 offset:38912
  v_cvt_pk_bf16_f32 v100, v72, v73
  v_exp_f32 v76, v76
  v_exp_f32 v77, v77
  ds_read_b128 v[60:63], v3 offset:39936
  v_cvt_pk_bf16_f32 v101, v74, v75
  v_exp_f32 v78, v78
  s_add_u32 m0, s31, 67584
  s_add_u32 s29, s53, s27
  s_add_u32 s29, s29, 2048
  buffer_load_dwordx4 v2, s[8:11], s29 offen sc1 lds
  v_exp_f32 v79, v79
  v_cvt_pk_bf16_f32 v102, v76, v77
  v_cvt_pk_bf16_f32 v103, v78, v79
  s_waitcnt lgkmcnt(4)
  v_mfma_f32_32x32x16_bf16 v[112:127], v[48:51], v[96:99], v[112:127]
  v_exp_f32 v80, v80
  v_exp_f32 v81, v81
  v_exp_f32 v82, v82
  v_exp_f32 v83, v83
  v_mfma_f32_32x32x16_bf16 v[112:127], v[52:55], v[100:103], v[112:127]
  v_cvt_pk_bf16_f32 v104, v80, v81
  v_exp_f32 v84, v84
  v_exp_f32 v85, v85
  v_cvt_pk_bf16_f32 v105, v82, v83
  v_exp_f32 v86, v86
  s_waitcnt lgkmcnt(2)
  v_mfma_f32_32x32x16_bf16 v[64:79], v[40:43], v[192:195], 0
  v_exp_f32 v87, v87
  v_cvt_pk_bf16_f32 v106, v84, v85
  v_exp_f32 v88, v88
  v_exp_f32 v89, v89
  v_cvt_pk_bf16_f32 v107, v86, v87
  v_mfma_f32_32x32x16_bf16 v[64:79], v[44:47], v[196:199], v[64:79]
  v_exp_f32 v90, v90
  v_exp_f32 v91, v91
  ds_read_b128 v[32:35], v3 offset:8192
  v_cvt_pk_bf16_f32 v108, v88, v89
  v_exp_f32 v92, v92
  v_exp_f32 v93, v93
  ds_read_b128 v[36:39], v3 offset:9216
  v_cvt_pk_bf16_f32 v109, v90, v91
  v_exp_f32 v94, v94
  v_exp_f32 v95, v95
  v_cvt_pk_bf16_f32 v110, v92, v93
  v_cvt_pk_bf16_f32 v111, v94, v95
  v_mfma_f32_32x32x16_bf16 v[128:143], v[48:51], v[104:107], v[128:143]
  v_exp_f32 v64, v64
  v_exp_f32 v65, v65
  v_exp_f32 v66, v66
  v_exp_f32 v67, v67
  v_mfma_f32_32x32x16_bf16 v[128:143], v[52:55], v[108:111], v[128:143]
  v_cvt_pk_bf16_f32 v96, v64, v65
  v_exp_f32 v68, v68
  v_exp_f32 v69, v69
  v_cvt_pk_bf16_f32 v97, v66, v67
  v_exp_f32 v70, v70
  v_mfma_f32_32x32x16_bf16 v[80:95], v[40:43], v[200:203], 0
  v_exp_f32 v71, v71
  v_cvt_pk_bf16_f32 v98, v68, v69
  v_exp_f32 v72, v72
  v_exp_f32 v73, v73
  v_cvt_pk_bf16_f32 v99, v70, v71
  v_mfma_f32_32x32x16_bf16 v[80:95], v[44:47], v[204:207], v[80:95]
  v_exp_f32 v74, v74
  v_exp_f32 v75, v75
  ds_read_b128 v[48:51], v3 offset:40960
  v_cvt_pk_bf16_f32 v100, v72, v73
  v_exp_f32 v76, v76
  v_exp_f32 v77, v77
  ds_read_b128 v[52:55], v3 offset:41984
  v_cvt_pk_bf16_f32 v101, v74, v75
  v_exp_f32 v78, v78
  s_add_u32 m0, s31, 68608
  s_add_u32 s29, s53, s27
  s_add_u32 s29, s29, 3072
  buffer_load_dwordx4 v2, s[8:11], s29 offen sc1 lds
  v_exp_f32 v79, v79
  v_cvt_pk_bf16_f32 v102, v76, v77
  v_cvt_pk_bf16_f32 v103, v78, v79
  s_waitcnt lgkmcnt(4)
  v_mfma_f32_32x32x16_bf16 v[112:127], v[56:59], v[96:99], v[112:127]
  v_exp_f32 v80, v80
  v_exp_f32 v81, v81
  v_exp_f32 v82, v82
  v_exp_f32 v83, v83
  v_mfma_f32_32x32x16_bf16 v[112:127], v[60:63], v[100:103], v[112:127]
  v_cvt_pk_bf16_f32 v104, v80, v81
  v_exp_f32 v84, v84
  v_exp_f32 v85, v85
  v_cvt_pk_bf16_f32 v105, v82, v83
  v_exp_f32 v86, v86
  s_waitcnt lgkmcnt(2)
  v_mfma_f32_32x32x16_bf16 v[64:79], v[32:35], v[192:195], 0
  v_exp_f32 v87, v87
  v_cvt_pk_bf16_f32 v106, v84, v85
  v_exp_f32 v88, v88
  v_exp_f32 v89, v89
  v_cvt_pk_bf16_f32 v107, v86, v87
  v_mfma_f32_32x32x16_bf16 v[64:79], v[36:39], v[196:199], v[64:79]
  v_exp_f32 v90, v90
  v_exp_f32 v91, v91
  ds_read_b128 v[40:43], v3 offset:10240
  v_cvt_pk_bf16_f32 v108, v88, v89
  v_exp_f32 v92, v92
  v_exp_f32 v93, v93
  ds_read_b128 v[44:47], v3 offset:11264
  v_cvt_pk_bf16_f32 v109, v90, v91
  v_exp_f32 v94, v94
  v_exp_f32 v95, v95
  v_cvt_pk_bf16_f32 v110, v92, v93
  v_cvt_pk_bf16_f32 v111, v94, v95
  v_mfma_f32_32x32x16_bf16 v[128:143], v[56:59], v[104:107], v[128:143]
  v_exp_f32 v64, v64
  v_exp_f32 v65, v65
  v_exp_f32 v66, v66
  v_exp_f32 v67, v67
  v_mfma_f32_32x32x16_bf16 v[128:143], v[60:63], v[108:111], v[128:143]
  v_cvt_pk_bf16_f32 v96, v64, v65
  v_exp_f32 v68, v68
  v_exp_f32 v69, v69
  v_cvt_pk_bf16_f32 v97, v66, v67
  v_exp_f32 v70, v70
  v_mfma_f32_32x32x16_bf16 v[80:95], v[32:35], v[200:203], 0
  v_exp_f32 v71, v71
  v_cvt_pk_bf16_f32 v98, v68, v69
  v_exp_f32 v72, v72
  v_exp_f32 v73, v73
  v_cvt_pk_bf16_f32 v99, v70, v71
  v_mfma_f32_32x32x16_bf16 v[80:95], v[36:39], v[204:207], v[80:95]
  v_exp_f32 v74, v74
  v_exp_f32 v75, v75
  ds_read_b128 v[56:59], v3 offset:43008
  v_cvt_pk_bf16_f32 v100, v72, v73
  v_exp_f32 v76, v76
  v_exp_f32 v77, v77
  ds_read_b128 v[60:63], v3 offset:44032
  v_cvt_pk_bf16_f32 v101, v74, v75
  v_exp_f32 v78, v78
  s_add_u32 m0, s31, 69632
  s_add_u32 s29, s53, s27
  s_add_u32 s29, s29, 4096
  buffer_load_dwordx4 v2, s[8:11], s29 offen sc1 lds
  v_exp_f32 v79, v79
  v_cvt_pk_bf16_f32 v102, v76, v77
  v_cvt_pk_bf16_f32 v103, v78, v79
  s_waitcnt lgkmcnt(4)
  v_mfma_f32_32x32x16_bf16 v[112:127], v[48:51], v[96:99], v[112:127]
  v_exp_f32 v80, v80
  v_exp_f32 v81, v81
  v_exp_f32 v82, v82
  v_exp_f32 v83, v83
  v_mfma_f32_32x32x16_bf16 v[112:127], v[52:55], v[100:103], v[112:127]
  v_cvt_pk_bf16_f32 v104, v80, v81
  v_exp_f32 v84, v84
  v_exp_f32 v85, v85
  v_cvt_pk_bf16_f32 v105, v82, v83
  v_exp_f32 v86, v86
  s_waitcnt lgkmcnt(2)
  v_mfma_f32_32x32x16_bf16 v[64:79], v[40:43], v[192:195], 0
  v_exp_f32 v87, v87
  v_cvt_pk_bf16_f32 v106, v84, v85
  v_exp_f32 v88, v88
  v_exp_f32 v89, v89
  v_cvt_pk_bf16_f32 v107, v86, v87
  v_mfma_f32_32x32x16_bf16 v[64:79], v[44:47], v[196:199], v[64:79]
  v_exp_f32 v90, v90
  v_exp_f32 v91, v91
  ds_read_b128 v[32:35], v3 offset:12288
  v_cvt_pk_bf16_f32 v108, v88, v89
  v_exp_f32 v92, v92
  v_exp_f32 v93, v93
  ds_read_b128 v[36:39], v3 offset:13312
  v_cvt_pk_bf16_f32 v109, v90, v91
  v_exp_f32 v94, v94
  v_exp_f32 v95, v95
  v_cvt_pk_bf16_f32 v110, v92, v93
  v_cvt_pk_bf16_f32 v111, v94, v95
  v_mfma_f32_32x32x16_bf16 v[128:143], v[48:51], v[104:107], v[128:143]
  v_exp_f32 v64, v64
  v_exp_f32 v65, v65
  v_exp_f32 v66, v66
  v_exp_f32 v67, v67
  v_mfma_f32_32x32x16_bf16 v[128:143], v[52:55], v[108:111], v[128:143]
  v_cvt_pk_bf16_f32 v96, v64, v65
  v_exp_f32 v68, v68
  v_exp_f32 v69, v69
  v_cvt_pk_bf16_f32 v97, v66, v67
  v_exp_f32 v70, v70
  v_mfma_f32_32x32x16_bf16 v[80:95], v[40:43], v[200:203], 0
  v_exp_f32 v71, v71
  v_cvt_pk_bf16_f32 v98, v68, v69
  v_exp_f32 v72, v72
  v_exp_f32 v73, v73
  v_cvt_pk_bf16_f32 v99, v70, v71
  v_mfma_f32_32x32x16_bf16 v[80:95], v[44:47], v[204:207], v[80:95]
  v_exp_f32 v74, v74
  v_exp_f32 v75, v75
  ds_read_b128 v[48:51], v3 offset:45056
  v_cvt_pk_bf16_f32 v100, v72, v73
  v_exp_f32 v76, v76
  v_exp_f32 v77, v77
  ds_read_b128 v[52:55], v3 offset:46080
  v_cvt_pk_bf16_f32 v101, v74, v75
  v_exp_f32 v78, v78
  s_add_u32 m0, s31, 70656
  s_add_u32 s29, s53, s27
  s_add_u32 s29, s29, 5120
  buffer_load_dwordx4 v2, s[8:11], s29 offen sc1 lds
  v_exp_f32 v79, v79
  v_cvt_pk_bf16_f32 v102, v76, v77
  v_cvt_pk_bf16_f32 v103, v78, v79
  s_waitcnt lgkmcnt(4)
  v_mfma_f32_32x32x16_bf16 v[112:127], v[56:59], v[96:99], v[112:127]
  v_exp_f32 v80, v80
  v_exp_f32 v81, v81
  v_exp_f32 v82, v82
  v_exp_f32 v83, v83
  v_mfma_f32_32x32x16_bf16 v[112:127], v[60:63], v[100:103], v[112:127]
  v_cvt_pk_bf16_f32 v104, v80, v81
  v_exp_f32 v84, v84
  v_exp_f32 v85, v85
  v_cvt_pk_bf16_f32 v105, v82, v83
  v_exp_f32 v86, v86
  s_waitcnt lgkmcnt(2)
  v_mfma_f32_32x32x16_bf16 v[64:79], v[32:35], v[192:195], 0
  v_exp_f32 v87, v87
  v_cvt_pk_bf16_f32 v106, v84, v85
  v_exp_f32 v88, v88
  v_exp_f32 v89, v89
  v_cvt_pk_bf16_f32 v107, v86, v87
  v_mfma_f32_32x32x16_bf16 v[64:79], v[36:39], v[196:199], v[64:79]
  v_exp_f32 v90, v90
  v_exp_f32 v91, v91
  ds_read_b128 v[40:43], v3 offset:14336
  v_cvt_pk_bf16_f32 v108, v88, v89
  v_exp_f32 v92, v92
  v_exp_f32 v93, v93
  ds_read_b128 v[44:47], v3 offset:15360
  v_cvt_pk_bf16_f32 v109, v90, v91
  v_exp_f32 v94, v94
  v_exp_f32 v95, v95
  v_cvt_pk_bf16_f32 v110, v92, v93
  v_cvt_pk_bf16_f32 v111, v94, v95
  v_mfma_f32_32x32x16_bf16 v[128:143], v[56:59], v[104:107], v[128:143]
  v_exp_f32 v64, v64
  v_exp_f32 v65, v65
  v_exp_f32 v66, v66
  v_exp_f32 v67, v67
  v_mfma_f32_32x32x16_bf16 v[128:143], v[60:63], v[108:111], v[128:143]
  v_cvt_pk_bf16_f32 v96, v64, v65
  v_exp_f32 v68, v68
  v_exp_f32 v69, v69
  v_cvt_pk_bf16_f32 v97, v66, v67
  v_exp_f32 v70, v70
  v_mfma_f32_32x32x16_bf16 v[80:95], v[32:35], v[200:203], 0
  v_exp_f32 v71, v71
  v_cvt_pk_bf16_f32 v98, v68, v69
  v_exp_f32 v72, v72
  v_exp_f32 v73, v73
  v_cvt_pk_bf16_f32 v99, v70, v71
  v_mfma_f32_32x32x16_bf16 v[80:95], v[36:39], v[204:207], v[80:95]
  v_exp_f32 v74, v74
  v_exp_f32 v75, v75
  ds_read_b128 v[56:59], v3 offset:47104
  v_cvt_pk_bf16_f32 v100, v72, v73
  v_exp_f32 v76, v76
  v_exp_f32 v77, v77
  ds_read_b128 v[60:63], v3 offset:48128
  v_cvt_pk_bf16_f32 v101, v74, v75
  v_exp_f32 v78, v78
  s_add_u32 m0, s31, 71680
  s_add_u32 s29, s53, s27
  s_add_u32 s29, s29, 6144
  buffer_load_dwordx4 v2, s[8:11], s29 offen sc1 lds
  v_exp_f32 v79, v79
  v_cvt_pk_bf16_f32 v102, v76, v77
  v_cvt_pk_bf16_f32 v103, v78, v79
  s_waitcnt lgkmcnt(4)
  v_mfma_f32_32x32x16_bf16 v[112:127], v[48:51], v[96:99], v[112:127]
  v_exp_f32 v80, v80
  v_exp_f32 v81, v81
  v_exp_f32 v82, v82
  v_exp_f32 v83, v83
  v_mfma_f32_32x32x16_bf16 v[112:127], v[52:55], v[100:103], v[112:127]
  v_cvt_pk_bf16_f32 v104, v80, v81
  v_exp_f32 v84, v84
  v_exp_f32 v85, v85
  v_cvt_pk_bf16_f32 v105, v82, v83
  v_exp_f32 v86, v86
  s_waitcnt lgkmcnt(2)
  v_mfma_f32_32x32x16_bf16 v[64:79], v[40:43], v[192:195], 0
  v_exp_f32 v87, v87
  v_cvt_pk_bf16_f32 v106, v84, v85
  v_exp_f32 v88, v88
  v_exp_f32 v89, v89
  v_cvt_pk_bf16_f32 v107, v86, v87
  v_mfma_f32_32x32x16_bf16 v[64:79], v[44:47], v[196:199], v[64:79]
  v_exp_f32 v90, v90
  v_exp_f32 v91, v91
  ds_read_b128 v[32:35], v3 offset:16384
  v_cvt_pk_bf16_f32 v108, v88, v89
  v_exp_f32 v92, v92
  v_exp_f32 v93, v93
  ds_read_b128 v[36:39], v3 offset:17408
  v_cvt_pk_bf16_f32 v109, v90, v91
  v_exp_f32 v94, v94
  v_exp_f32 v95, v95
  v_cvt_pk_bf16_f32 v110, v92, v93
  v_cvt_pk_bf16_f32 v111, v94, v95
  v_mfma_f32_32x32x16_bf16 v[128:143], v[48:51], v[104:107], v[128:143]
  v_exp_f32 v64, v64
  v_exp_f32 v65, v65
  v_exp_f32 v66, v66
  v_exp_f32 v67, v67
  v_mfma_f32_32x32x16_bf16 v[128:143], v[52:55], v[108:111], v[128:143]
  v_cvt_pk_bf16_f32 v96, v64, v65
  v_exp_f32 v68, v68
  v_exp_f32 v69, v69
  v_cvt_pk_bf16_f32 v97, v66, v67
  v_exp_f32 v70, v70
  v_mfma_f32_32x32x16_bf16 v[80:95], v[40:43], v[200:203], 0
  v_exp_f32 v71, v71
  v_cvt_pk_bf16_f32 v98, v68, v69
  v_exp_f32 v72, v72
  v_exp_f32 v73, v73
  v_cvt_pk_bf16_f32 v99, v70, v71
  v_mfma_f32_32x32x16_bf16 v[80:95], v[44:47], v[204:207], v[80:95]
  v_exp_f32 v74, v74
  v_exp_f32 v75, v75
  ds_read_b128 v[48:51], v3 offset:49152
  v_cvt_pk_bf16_f32 v100, v72, v73
  v_exp_f32 v76, v76
  v_exp_f32 v77, v77
  ds_read_b128 v[52:55], v3 offset:50176
  v_cvt_pk_bf16_f32 v101, v74, v75
  v_exp_f32 v78, v78
  s_add_u32 m0, s31, 72704
  s_add_u32 s29, s53, s27
  s_add_u32 s29, s29, 7168
  buffer_load_dwordx4 v2, s[8:11], s29 offen sc1 lds
  v_exp_f32 v79, v79
  v_cvt_pk_bf16_f32 v102, v76, v77
  v_cvt_pk_bf16_f32 v103, v78, v79
  s_waitcnt lgkmcnt(4)
  v_mfma_f32_32x32x16_bf16 v[112:127], v[56:59], v[96:99], v[112:127]
  v_exp_f32 v80, v80
  v_exp_f32 v81, v81
  v_exp_f32 v82, v82
  v_exp_f32 v83, v83
  v_mfma_f32_32x32x16_bf16 v[112:127], v[60:63], v[100:103], v[112:127]
  v_cvt_pk_bf16_f32 v104, v80, v81
  v_exp_f32 v84, v84
  v_exp_f32 v85, v85
  v_cvt_pk_bf16_f32 v105, v82, v83
  v_exp_f32 v86, v86
  s_waitcnt lgkmcnt(2)
  v_mfma_f32_32x32x16_bf16 v[64:79], v[32:35], v[192:195], 0
  v_exp_f32 v87, v87
  v_cvt_pk_bf16_f32 v106, v84, v85
  v_exp_f32 v88, v88
  v_exp_f32 v89, v89
  v_cvt_pk_bf16_f32 v107, v86, v87
  v_mfma_f32_32x32x16_bf16 v[64:79], v[36:39], v[196:199], v[64:79]
  v_exp_f32 v90, v90
  v_exp_f32 v91, v91
  ds_read_b128 v[40:43], v3 offset:18432
  v_cvt_pk_bf16_f32 v108, v88, v89
  v_exp_f32 v92, v92
  v_exp_f32 v93, v93
  ds_read_b128 v[44:47], v3 offset:19456
  v_cvt_pk_bf16_f32 v109, v90, v91
  v_exp_f32 v94, v94
  v_exp_f32 v95, v95
  v_cvt_pk_bf16_f32 v110, v92, v93
  v_cvt_pk_bf16_f32 v111, v94, v95
  v_mfma_f32_32x32x16_bf16 v[128:143], v[56:59], v[104:107], v[128:143]
  v_exp_f32 v64, v64
  v_exp_f32 v65, v65
  v_exp_f32 v66, v66
  v_exp_f32 v67, v67
  v_mfma_f32_32x32x16_bf16 v[128:143], v[60:63], v[108:111], v[128:143]
  v_cvt_pk_bf16_f32 v96, v64, v65
  v_exp_f32 v68, v68
  v_exp_f32 v69, v69
  v_cvt_pk_bf16_f32 v97, v66, v67
  v_exp_f32 v70, v70
  v_mfma_f32_32x32x16_bf16 v[80:95], v[32:35], v[200:203], 0
  v_exp_f32 v71, v71
  v_cvt_pk_bf16_f32 v98, v68, v69
  v_exp_f32 v72, v72
  v_exp_f32 v73, v73
  v_cvt_pk_bf16_f32 v99, v70, v71
  v_mfma_f32_32x32x16_bf16 v[80:95], v[36:39], v[204:207], v[80:95]
  v_exp_f32 v74, v74
  v_exp_f32 v75, v75
  ds_read_b128 v[56:59], v3 offset:51200
  v_cvt_pk_bf16_f32 v100, v72, v73
  v_exp_f32 v76, v76
  v_exp_f32 v77, v77
  ds_read_b128 v[60:63], v3 offset:52224
  v_cvt_pk_bf16_f32 v101, v74, v75
  v_exp_f32 v78, v78
  s_add_u32 m0, s31, 98304
  s_add_u32 s29, s53, s28
  s_add_u32 s29, s29, 0
  buffer_load_dwordx4 v2, s[8:11], s29 offen sc1 lds
  v_exp_f32 v79, v79
  v_cvt_pk_bf16_f32 v102, v76, v77
  v_cvt_pk_bf16_f32 v103, v78, v79
  s_waitcnt lgkmcnt(4)
  v_mfma_f32_32x32x16_bf16 v[112:127], v[48:51], v[96:99], v[112:127]
  v_exp_f32 v80, v80
  v_exp_f32 v81, v81
  v_exp_f32 v82, v82
  v_exp_f32 v83, v83
  v_mfma_f32_32x32x16_bf16 v[112:127], v[52:55], v[100:103], v[112:127]
  v_cvt_pk_bf16_f32 v104, v80, v81
  v_exp_f32 v84, v84
  v_exp_f32 v85, v85
  v_cvt_pk_bf16_f32 v105, v82, v83
  v_exp_f32 v86, v86
  s_waitcnt lgkmcnt(2)
  v_mfma_f32_32x32x16_bf16 v[64:79], v[40:43], v[192:195], 0
  v_exp_f32 v87, v87
  v_cvt_pk_bf16_f32 v106, v84, v85
  v_exp_f32 v88, v88
  v_exp_f32 v89, v89
  v_cvt_pk_bf16_f32 v107, v86, v87
  v_mfma_f32_32x32x16_bf16 v[64:79], v[44:47], v[196:199], v[64:79]
  v_exp_f32 v90, v90
  v_exp_f32 v91, v91
  ds_read_b128 v[32:35], v3 offset:20480
  v_cvt_pk_bf16_f32 v108, v88, v89
  v_exp_f32 v92, v92
  v_exp_f32 v93, v93
  ds_read_b128 v[36:39], v3 offset:21504
  v_cvt_pk_bf16_f32 v109, v90, v91
  v_exp_f32 v94, v94
  v_exp_f32 v95, v95
  v_cvt_pk_bf16_f32 v110, v92, v93
  v_cvt_pk_bf16_f32 v111, v94, v95
  v_mfma_f32_32x32x16_bf16 v[128:143], v[48:51], v[104:107], v[128:143]
  v_exp_f32 v64, v64
  v_exp_f32 v65, v65
  v_exp_f32 v66, v66
  v_exp_f32 v67, v67
  v_mfma_f32_32x32x16_bf16 v[128:143], v[52:55], v[108:111], v[128:143]
  v_cvt_pk_bf16_f32 v96, v64, v65
  v_exp_f32 v68, v68
  v_exp_f32 v69, v69
  v_cvt_pk_bf16_f32 v97, v66, v67
  v_exp_f32 v70, v70
  v_mfma_f32_32x32x16_bf16 v[80:95], v[40:43], v[200:203], 0
  v_exp_f32 v71, v71
  v_cvt_pk_bf16_f32 v98, v68, v69
  v_exp_f32 v72, v72
  v_exp_f32 v73, v73
  v_cvt_pk_bf16_f32 v99, v70, v71
  v_mfma_f32_32x32x16_bf16 v[80:95], v[44:47], v[204:207], v[80:95]
  v_exp_f32 v74, v74
  v_exp_f32 v75, v75
  ds_read_b128 v[48:51], v3 offset:53248
  v_cvt_pk_bf16_f32 v100, v72, v73
  v_exp_f32 v76, v76
  v_exp_f32 v77, v77
  ds_read_b128 v[52:55], v3 offset:54272
  v_cvt_pk_bf16_f32 v101, v74, v75
  v_exp_f32 v78, v78
  s_add_u32 m0, s31, 99328
  s_add_u32 s29, s53, s28
  s_add_u32 s29, s29, 1024
  buffer_load_dwordx4 v2, s[8:11], s29 offen sc1 lds
  v_exp_f32 v79, v79
  v_cvt_pk_bf16_f32 v102, v76, v77
  v_cvt_pk_bf16_f32 v103, v78, v79
  s_waitcnt lgkmcnt(4)
  v_mfma_f32_32x32x16_bf16 v[112:127], v[56:59], v[96:99], v[112:127]
  v_exp_f32 v80, v80
  v_exp_f32 v81, v81
  v_exp_f32 v82, v82
  v_exp_f32 v83, v83
  v_mfma_f32_32x32x16_bf16 v[112:127], v[60:63], v[100:103], v[112:127]
  v_cvt_pk_bf16_f32 v104, v80, v81
  v_exp_f32 v84, v84
  v_exp_f32 v85, v85
  v_cvt_pk_bf16_f32 v105, v82, v83
  v_exp_f32 v86, v86
  s_waitcnt lgkmcnt(2)
  v_mfma_f32_32x32x16_bf16 v[64:79], v[32:35], v[192:195], 0
  v_exp_f32 v87, v87
  v_cvt_pk_bf16_f32 v106, v84, v85
  v_exp_f32 v88, v88
  v_exp_f32 v89, v89
  v_cvt_pk_bf16_f32 v107, v86, v87
  v_mfma_f32_32x32x16_bf16 v[64:79], v[36:39], v[196:199], v[64:79]
  v_exp_f32 v90, v90
  v_exp_f32 v91, v91
  ds_read_b128 v[40:43], v3 offset:22528
  v_cvt_pk_bf16_f32 v108, v88, v89
  v_exp_f32 v92, v92
  v_exp_f32 v93, v93
  ds_read_b128 v[44:47], v3 offset:23552
  v_cvt_pk_bf16_f32 v109, v90, v91
  v_exp_f32 v94, v94
  v_exp_f32 v95, v95
  v_cvt_pk_bf16_f32 v110, v92, v93
  v_cvt_pk_bf16_f32 v111, v94, v95
  v_mfma_f32_32x32x16_bf16 v[128:143], v[56:59], v[104:107], v[128:143]
  v_exp_f32 v64, v64
  v_exp_f32 v65, v65
  v_exp_f32 v66, v66
  v_exp_f32 v67, v67
  v_mfma_f32_32x32x16_bf16 v[128:143], v[60:63], v[108:111], v[128:143]
  v_cvt_pk_bf16_f32 v96, v64, v65
  v_exp_f32 v68, v68
  v_exp_f32 v69, v69
  v_cvt_pk_bf16_f32 v97, v66, v67
  v_exp_f32 v70, v70
  v_mfma_f32_32x32x16_bf16 v[80:95], v[32:35], v[200:203], 0
  v_exp_f32 v71, v71
  v_cvt_pk_bf16_f32 v98, v68, v69
  v_exp_f32 v72, v72
  v_exp_f32 v73, v73
  v_cvt_pk_bf16_f32 v99, v70, v71
  v_mfma_f32_32x32x16_bf16 v[80:95], v[36:39], v[204:207], v[80:95]
  v_exp_f32 v74, v74
  v_exp_f32 v75, v75
  ds_read_b128 v[56:59], v3 offset:55296
  v_cvt_pk_bf16_f32 v100, v72, v73
  v_exp_f32 v76, v76
  v_exp_f32 v77, v77
  ds_read_b128 v[60:63], v3 offset:56320
  v_cvt_pk_bf16_f32 v101, v74, v75
  v_exp_f32 v78, v78
  s_add_u32 m0, s31, 100352
  s_add_u32 s29, s53, s28
  s_add_u32 s29, s29, 2048
  buffer_load_dwordx4 v2, s[8:11], s29 offen sc1 lds
  v_exp_f32 v79, v79
  v_cvt_pk_bf16_f32 v102, v76, v77
  v_cvt_pk_bf16_f32 v103, v78, v79
  s_waitcnt lgkmcnt(4)
  v_mfma_f32_32x32x16_bf16 v[112:127], v[48:51], v[96:99], v[112:127]
  v_exp_f32 v80, v80
  v_exp_f32 v81, v81
  v_exp_f32 v82, v82
  v_exp_f32 v83, v83
  v_mfma_f32_32x32x16_bf16 v[112:127], v[52:55], v[100:103], v[112:127]
  v_cvt_pk_bf16_f32 v104, v80, v81
  v_exp_f32 v84, v84
  v_exp_f32 v85, v85
  v_cvt_pk_bf16_f32 v105, v82, v83
  v_exp_f32 v86, v86
  s_waitcnt lgkmcnt(2)
  v_mfma_f32_32x32x16_bf16 v[64:79], v[40:43], v[192:195], 0
  v_exp_f32 v87, v87
  v_cvt_pk_bf16_f32 v106, v84, v85
  v_exp_f32 v88, v88
  v_exp_f32 v89, v89
  v_cvt_pk_bf16_f32 v107, v86, v87
  v_mfma_f32_32x32x16_bf16 v[64:79], v[44:47], v[196:199], v[64:79]
  v_exp_f32 v90, v90
  v_exp_f32 v91, v91
  ds_read_b128 v[32:35], v3 offset:24576
  v_cvt_pk_bf16_f32 v108, v88, v89
  v_exp_f32 v92, v92
  v_exp_f32 v93, v93
  ds_read_b128 v[36:39], v3 offset:25600
  v_cvt_pk_bf16_f32 v109, v90, v91
  v_exp_f32 v94, v94
  v_exp_f32 v95, v95
  v_cvt_pk_bf16_f32 v110, v92, v93
  v_cvt_pk_bf16_f32 v111, v94, v95
  v_mfma_f32_32x32x16_bf16 v[128:143], v[48:51], v[104:107], v[128:143]
  v_exp_f32 v64, v64
  v_exp_f32 v65, v65
  v_exp_f32 v66, v66
  v_exp_f32 v67, v67
  v_mfma_f32_32x32x16_bf16 v[128:143], v[52:55], v[108:111], v[128:143]
  v_cvt_pk_bf16_f32 v96, v64, v65
  v_exp_f32 v68, v68
  v_exp_f32 v69, v69
  v_cvt_pk_bf16_f32 v97, v66, v67
  v_exp_f32 v70, v70
  v_mfma_f32_32x32x16_bf16 v[80:95], v[40:43], v[200:203], 0
  v_exp_f32 v71, v71
  v_cvt_pk_bf16_f32 v98, v68, v69
  v_exp_f32 v72, v72
  v_exp_f32 v73, v73
  v_cvt_pk_bf16_f32 v99, v70, v71
  v_mfma_f32_32x32x16_bf16 v[80:95], v[44:47], v[204:207], v[80:95]
  v_exp_f32 v74, v74
  v_exp_f32 v75, v75
  ds_read_b128 v[48:51], v3 offset:57344
  v_cvt_pk_bf16_f32 v100, v72, v73
  v_exp_f32 v76, v76
  v_exp_f32 v77, v77
  ds_read_b128 v[52:55], v3 offset:58368
  v_cvt_pk_bf16_f32 v101, v74, v75
  v_exp_f32 v78, v78
  s_add_u32 m0, s31, 101376
  s_add_u32 s29, s53, s28
  s_add_u32 s29, s29, 3072
  buffer_load_dwordx4 v2, s[8:11], s29 offen sc1 lds
  v_exp_f32 v79, v79
  v_cvt_pk_bf16_f32 v102, v76, v77
  v_cvt_pk_bf16_f32 v103, v78, v79
  s_waitcnt lgkmcnt(4)
  v_mfma_f32_32x32x16_bf16 v[112:127], v[56:59], v[96:99], v[112:127]
  v_exp_f32 v80, v80
  v_exp_f32 v81, v81
  v_exp_f32 v82, v82
  v_exp_f32 v83, v83
  v_mfma_f32_32x32x16_bf16 v[112:127], v[60:63], v[100:103], v[112:127]
  v_cvt_pk_bf16_f32 v104, v80, v81
  v_exp_f32 v84, v84
  v_exp_f32 v85, v85
  v_cvt_pk_bf16_f32 v105, v82, v83
  v_exp_f32 v86, v86
  s_waitcnt lgkmcnt(2)
  v_mfma_f32_32x32x16_bf16 v[64:79], v[32:35], v[192:195], 0
  v_exp_f32 v87, v87
  v_cvt_pk_bf16_f32 v106, v84, v85
  v_exp_f32 v88, v88
  v_exp_f32 v89, v89
  v_cvt_pk_bf16_f32 v107, v86, v87
  v_mfma_f32_32x32x16_bf16 v[64:79], v[36:39], v[196:199], v[64:79]
  v_exp_f32 v90, v90
  v_exp_f32 v91, v91
  ds_read_b128 v[40:43], v3 offset:26624
  v_cvt_pk_bf16_f32 v108, v88, v89
  v_exp_f32 v92, v92
  v_exp_f32 v93, v93
  ds_read_b128 v[44:47], v3 offset:27648
  v_cvt_pk_bf16_f32 v109, v90, v91
  v_exp_f32 v94, v94
  v_exp_f32 v95, v95
  v_cvt_pk_bf16_f32 v110, v92, v93
  v_cvt_pk_bf16_f32 v111, v94, v95
  v_mfma_f32_32x32x16_bf16 v[128:143], v[56:59], v[104:107], v[128:143]
  v_exp_f32 v64, v64
  v_exp_f32 v65, v65
  v_exp_f32 v66, v66
  v_exp_f32 v67, v67
  v_mfma_f32_32x32x16_bf16 v[128:143], v[60:63], v[108:111], v[128:143]
  v_cvt_pk_bf16_f32 v96, v64, v65
  v_exp_f32 v68, v68
  v_exp_f32 v69, v69
  v_cvt_pk_bf16_f32 v97, v66, v67
  v_exp_f32 v70, v70
  v_mfma_f32_32x32x16_bf16 v[80:95], v[32:35], v[200:203], 0
  v_exp_f32 v71, v71
  v_cvt_pk_bf16_f32 v98, v68, v69
  v_exp_f32 v72, v72
  v_exp_f32 v73, v73
  v_cvt_pk_bf16_f32 v99, v70, v71
  v_mfma_f32_32x32x16_bf16 v[80:95], v[36:39], v[204:207], v[80:95]
  v_exp_f32 v74, v74
  v_exp_f32 v75, v75
  ds_read_b128 v[56:59], v3 offset:59392
  v_cvt_pk_bf16_f32 v100, v72, v73
  v_exp_f32 v76, v76
  v_exp_f32 v77, v77
  ds_read_b128 v[60:63], v3 offset:60416
  v_cvt_pk_bf16_f32 v101, v74, v75
  v_exp_f32 v78, v78
  s_add_u32 m0, s31, 102400
  s_add_u32 s29, s53, s28
  s_add_u32 s29, s29, 4096
  buffer_load_dwordx4 v2, s[8:11], s29 offen sc1 lds
  v_exp_f32 v79, v79
  v_cvt_pk_bf16_f32 v102, v76, v77
  v_cvt_pk_bf16_f32 v103, v78, v79
  s_waitcnt lgkmcnt(4)
  v_mfma_f32_32x32x16_bf16 v[112:127], v[48:51], v[96:99], v[112:127]
  v_exp_f32 v80, v80
  v_exp_f32 v81, v81
  v_exp_f32 v82, v82
  v_exp_f32 v83, v83
  v_mfma_f32_32x32x16_bf16 v[112:127], v[52:55], v[100:103], v[112:127]
  v_cvt_pk_bf16_f32 v104, v80, v81
  v_exp_f32 v84, v84
  v_exp_f32 v85, v85
  v_cvt_pk_bf16_f32 v105, v82, v83
  v_exp_f32 v86, v86
  s_waitcnt lgkmcnt(2)
  v_mfma_f32_32x32x16_bf16 v[64:79], v[40:43], v[192:195], 0
  v_exp_f32 v87, v87
  v_cvt_pk_bf16_f32 v106, v84, v85
  v_exp_f32 v88, v88
  v_exp_f32 v89, v89
  v_cvt_pk_bf16_f32 v107, v86, v87
  v_mfma_f32_32x32x16_bf16 v[64:79], v[44:47], v[196:199], v[64:79]
  v_exp_f32 v90, v90
  v_exp_f32 v91, v91
  ds_read_b128 v[32:35], v3 offset:28672
  v_cvt_pk_bf16_f32 v108, v88, v89
  v_exp_f32 v92, v92
  v_exp_f32 v93, v93
  ds_read_b128 v[36:39], v3 offset:29696
  v_cvt_pk_bf16_f32 v109, v90, v91
  v_exp_f32 v94, v94
  v_exp_f32 v95, v95
  v_cvt_pk_bf16_f32 v110, v92, v93
  v_cvt_pk_bf16_f32 v111, v94, v95
  v_mfma_f32_32x32x16_bf16 v[128:143], v[48:51], v[104:107], v[128:143]
  v_exp_f32 v64, v64
  v_exp_f32 v65, v65
  v_exp_f32 v66, v66
  v_exp_f32 v67, v67
  v_mfma_f32_32x32x16_bf16 v[128:143], v[52:55], v[108:111], v[128:143]
  v_cvt_pk_bf16_f32 v96, v64, v65
  v_exp_f32 v68, v68
  v_exp_f32 v69, v69
  v_cvt_pk_bf16_f32 v97, v66, v67
  v_exp_f32 v70, v70
  v_mfma_f32_32x32x16_bf16 v[80:95], v[40:43], v[200:203], 0
  v_exp_f32 v71, v71
  v_cvt_pk_bf16_f32 v98, v68, v69
  v_exp_f32 v72, v72
  v_exp_f32 v73, v73
  v_cvt_pk_bf16_f32 v99, v70, v71
  v_mfma_f32_32x32x16_bf16 v[80:95], v[44:47], v[204:207], v[80:95]
  v_exp_f32 v74, v74
  v_exp_f32 v75, v75
  ds_read_b128 v[48:51], v3 offset:61440
  v_cvt_pk_bf16_f32 v100, v72, v73
  v_exp_f32 v76, v76
  v_exp_f32 v77, v77
  ds_read_b128 v[52:55], v3 offset:62464
  v_cvt_pk_bf16_f32 v101, v74, v75
  v_exp_f32 v78, v78
  s_add_u32 m0, s31, 103424
  s_add_u32 s29, s53, s28
  s_add_u32 s29, s29, 5120
  buffer_load_dwordx4 v2, s[8:11], s29 offen sc1 lds
  v_exp_f32 v79, v79
  v_cvt_pk_bf16_f32 v102, v76, v77
  v_cvt_pk_bf16_f32 v103, v78, v79
  s_waitcnt lgkmcnt(4)
  v_mfma_f32_32x32x16_bf16 v[112:127], v[56:59], v[96:99], v[112:127]
  v_exp_f32 v80, v80
  v_exp_f32 v81, v81
  v_exp_f32 v82, v82
  v_exp_f32 v83, v83
  v_mfma_f32_32x32x16_bf16 v[112:127], v[60:63], v[100:103], v[112:127]
  v_cvt_pk_bf16_f32 v104, v80, v81
  v_exp_f32 v84, v84
  v_exp_f32 v85, v85
  v_cvt_pk_bf16_f32 v105, v82, v83
  v_exp_f32 v86, v86
  s_waitcnt lgkmcnt(2)
  v_mfma_f32_32x32x16_bf16 v[64:79], v[32:35], v[192:195], 0
  v_exp_f32 v87, v87
  v_cvt_pk_bf16_f32 v106, v84, v85
  v_exp_f32 v88, v88
  v_exp_f32 v89, v89
  v_cvt_pk_bf16_f32 v107, v86, v87
  v_mfma_f32_32x32x16_bf16 v[64:79], v[36:39], v[196:199], v[64:79]
  v_exp_f32 v90, v90
  v_exp_f32 v91, v91
  ds_read_b128 v[40:43], v3 offset:30720
  v_cvt_pk_bf16_f32 v108, v88, v89
  v_exp_f32 v92, v92
  v_exp_f32 v93, v93
  ds_read_b128 v[44:47], v3 offset:31744
  v_cvt_pk_bf16_f32 v109, v90, v91
  v_exp_f32 v94, v94
  v_exp_f32 v95, v95
  v_cvt_pk_bf16_f32 v110, v92, v93
  v_cvt_pk_bf16_f32 v111, v94, v95
  v_mfma_f32_32x32x16_bf16 v[128:143], v[56:59], v[104:107], v[128:143]
  v_exp_f32 v64, v64
  v_exp_f32 v65, v65
  v_exp_f32 v66, v66
  v_exp_f32 v67, v67
  v_mfma_f32_32x32x16_bf16 v[128:143], v[60:63], v[108:111], v[128:143]
  v_cvt_pk_bf16_f32 v96, v64, v65
  v_exp_f32 v68, v68
  v_exp_f32 v69, v69
  v_cvt_pk_bf16_f32 v97, v66, v67
  v_exp_f32 v70, v70
  v_mfma_f32_32x32x16_bf16 v[80:95], v[32:35], v[200:203], 0
  v_exp_f32 v71, v71
  v_cvt_pk_bf16_f32 v98, v68, v69
  v_exp_f32 v72, v72
  v_exp_f32 v73, v73
  v_cvt_pk_bf16_f32 v99, v70, v71
  v_mfma_f32_32x32x16_bf16 v[80:95], v[36:39], v[204:207], v[80:95]
  v_exp_f32 v74, v74
  v_exp_f32 v75, v75
  ds_read_b128 v[56:59], v3 offset:63488
  v_cvt_pk_bf16_f32 v100, v72, v73
  v_exp_f32 v76, v76
  v_exp_f32 v77, v77
  ds_read_b128 v[60:63], v3 offset:64512
  v_cvt_pk_bf16_f32 v101, v74, v75
  v_exp_f32 v78, v78
  s_add_u32 m0, s31, 104448
  s_add_u32 s29, s53, s28
  s_add_u32 s29, s29, 6144
  buffer_load_dwordx4 v2, s[8:11], s29 offen sc1 lds
  v_exp_f32 v79, v79
  v_cvt_pk_bf16_f32 v102, v76, v77
  v_cvt_pk_bf16_f32 v103, v78, v79
  s_waitcnt lgkmcnt(4)
  v_mfma_f32_32x32x16_bf16 v[112:127], v[48:51], v[96:99], v[112:127]
  v_exp_f32 v80, v80
  v_exp_f32 v81, v81
  v_exp_f32 v82, v82
  v_exp_f32 v83, v83
  v_mfma_f32_32x32x16_bf16 v[112:127], v[52:55], v[100:103], v[112:127]
  v_cvt_pk_bf16_f32 v104, v80, v81
  v_exp_f32 v84, v84
  v_exp_f32 v85, v85
  v_cvt_pk_bf16_f32 v105, v82, v83
  v_exp_f32 v86, v86
  s_waitcnt lgkmcnt(2)
  v_mfma_f32_32x32x16_bf16 v[64:79], v[40:43], v[192:195], 0
  v_exp_f32 v87, v87
  v_cvt_pk_bf16_f32 v106, v84, v85
  v_exp_f32 v88, v88
  v_exp_f32 v89, v89
  v_cvt_pk_bf16_f32 v107, v86, v87
  v_mfma_f32_32x32x16_bf16 v[64:79], v[44:47], v[196:199], v[64:79]
  v_exp_f32 v90, v90
  v_exp_f32 v91, v91
  v_cvt_pk_bf16_f32 v108, v88, v89
  v_exp_f32 v92, v92
  v_exp_f32 v93, v93
  v_cvt_pk_bf16_f32 v109, v90, v91
  v_exp_f32 v94, v94
  v_exp_f32 v95, v95
  v_cvt_pk_bf16_f32 v110, v92, v93
  v_cvt_pk_bf16_f32 v111, v94, v95
  v_mfma_f32_32x32x16_bf16 v[128:143], v[48:51], v[104:107], v[128:143]
  v_exp_f32 v64, v64
  v_exp_f32 v65, v65
  v_exp_f32 v66, v66
  v_exp_f32 v67, v67
  v_mfma_f32_32x32x16_bf16 v[128:143], v[52:55], v[108:111], v[128:143]
  v_cvt_pk_bf16_f32 v96, v64, v65
  v_exp_f32 v68, v68
  v_exp_f32 v69, v69
  v_cvt_pk_bf16_f32 v97, v66, v67
  v_exp_f32 v70, v70
  v_mfma_f32_32x32x16_bf16 v[80:95], v[40:43], v[200:203], 0
  v_exp_f32 v71, v71
  v_cvt_pk_bf16_f32 v98, v68, v69
  v_exp_f32 v72, v72
  v_exp_f32 v73, v73
  v_cvt_pk_bf16_f32 v99, v70, v71
  v_mfma_f32_32x32x16_bf16 v[80:95], v[44:47], v[204:207], v[80:95]
  v_exp_f32 v74, v74
  v_exp_f32 v75, v75
  v_cvt_pk_bf16_f32 v100, v72, v73
  v_exp_f32 v76, v76
  v_exp_f32 v77, v77
  v_cvt_pk_bf16_f32 v101, v74, v75
  v_exp_f32 v78, v78
  s_add_u32 m0, s31, 105472
  s_add_u32 s29, s53, s28
  s_add_u32 s29, s29, 7168
  buffer_load_dwordx4 v2, s[8:11], s29 offen sc1 lds
  v_exp_f32 v79, v79
  v_cvt_pk_bf16_f32 v102, v76, v77
  v_cvt_pk_bf16_f32 v103, v78, v79
  s_waitcnt lgkmcnt(0)
  v_mfma_f32_32x32x16_bf16 v[112:127], v[56:59], v[96:99], v[112:127]
  v_exp_f32 v80, v80
  v_exp_f32 v81, v81
  v_exp_f32 v82, v82
  v_exp_f32 v83, v83
  v_mfma_f32_32x32x16_bf16 v[112:127], v[60:63], v[100:103], v[112:127]
  v_cvt_pk_bf16_f32 v104, v80, v81
  v_exp_f32 v84, v84
  v_exp_f32 v85, v85
  v_cvt_pk_bf16_f32 v105, v82, v83
  v_exp_f32 v86, v86
  v_exp_f32 v87, v87
  v_cvt_pk_bf16_f32 v106, v84, v85
  v_exp_f32 v88, v88
  v_exp_f32 v89, v89
  v_cvt_pk_bf16_f32 v107, v86, v87
  v_exp_f32 v90, v90
  v_exp_f32 v91, v91
  v_cvt_pk_bf16_f32 v108, v88, v89
  v_exp_f32 v92, v92
  v_exp_f32 v93, v93
  v_cvt_pk_bf16_f32 v109, v90, v91
  v_exp_f32 v94, v94
  v_exp_f32 v95, v95
  v_cvt_pk_bf16_f32 v110, v92, v93
  v_cvt_pk_bf16_f32 v111, v94, v95
  s_nop 1
  v_mfma_f32_32x32x16_bf16 v[128:143], v[56:59], v[104:107], v[128:143]
  v_mfma_f32_32x32x16_bf16 v[128:143], v[60:63], v[108:111], v[128:143]
  s_waitcnt vmcnt(0)
  s_barrier
  s_add_u32 s41, s41, 1
  s_min_u32 s29, s41, 3
  s_mul_i32 s53, s29, 32768
  s_lshl_b32 s31, s21, 13
  s_add_u32 s53, s53, s31
  ds_read_b128 v[32:35], v4 offset:0
  ds_read_b128 v[36:39], v4 offset:1024
  ds_read_b128 v[48:51], v4 offset:32768
  ds_read_b128 v[52:55], v4 offset:33792
  ds_read_b128 v[40:43], v4 offset:2048
  ds_read_b128 v[44:47], v4 offset:3072
  s_waitcnt lgkmcnt(4)
  v_mfma_f32_32x32x16_bf16 v[64:79], v[32:35], v[192:195], 0
  v_mfma_f32_32x32x16_bf16 v[64:79], v[36:39], v[196:199], v[64:79]
  s_nop 11
  v_exp_f32 v64, v64
  v_exp_f32 v65, v65
  v_exp_f32 v66, v66
  v_exp_f32 v67, v67
  v_cvt_pk_bf16_f32 v96, v64, v65
  v_exp_f32 v68, v68
  v_exp_f32 v69, v69
  v_cvt_pk_bf16_f32 v97, v66, v67
  v_exp_f32 v70, v70
  v_mfma_f32_32x32x16_bf16 v[80:95], v[32:35], v[200:203], 0
  v_exp_f32 v71, v71
  v_cvt_pk_bf16_f32 v98, v68, v69
  v_exp_f32 v72, v72
  v_exp_f32 v73, v73
  v_cvt_pk_bf16_f32 v99, v70, v71
  v_mfma_f32_32x32x16_bf16 v[80:95], v[36:39], v[204:207], v[80:95]
  v_exp_f32 v74, v74
  v_exp_f32 v75, v75
  ds_read_b128 v[56:59], v4 offset:34816
  v_cvt_pk_bf16_f32 v100, v72, v73
  v_exp_f32 v76, v76
  v_exp_f32 v77, v77
  ds_read_b128 v[60:63], v4 offset:35840
  v_cvt_pk_bf16_f32 v101, v74, v75
  v_exp_f32 v78, v78
  s_add_u32 m0, s31, 0
  s_add_u32 s29, s53, s27
  s_add_u32 s29, s29, 0
  buffer_load_dwordx4 v2, s[8:11], s29 offen sc1 lds
  v_exp_f32 v79, v79
  v_cvt_pk_bf16_f32 v102, v76, v77
  v_cvt_pk_bf16_f32 v103, v78, v79
  s_waitcnt lgkmcnt(4)
  v_mfma_f32_32x32x16_bf16 v[112:127], v[48:51], v[96:99], v[112:127]
  v_exp_f32 v80, v80
  v_exp_f32 v81, v81
  v_exp_f32 v82, v82
  v_exp_f32 v83, v83
  v_mfma_f32_32x32x16_bf16 v[112:127], v[52:55], v[100:103], v[112:127]
  v_cvt_pk_bf16_f32 v104, v80, v81
  v_exp_f32 v84, v84
  v_exp_f32 v85, v85
  v_cvt_pk_bf16_f32 v105, v82, v83
  v_exp_f32 v86, v86
  s_waitcnt lgkmcnt(2)
  v_mfma_f32_32x32x16_bf16 v[64:79], v[40:43], v[192:195], 0
  v_exp_f32 v87, v87
  v_cvt_pk_bf16_f32 v106, v84, v85
  v_exp_f32 v88, v88
  v_exp_f32 v89, v89
  v_cvt_pk_bf16_f32 v107, v86, v87
  v_mfma_f32_32x32x16_bf16 v[64:79], v[44:47], v[196:199], v[64:79]
  v_exp_f32 v90, v90
  v_exp_f32 v91, v91
  ds_read_b128 v[32:35], v4 offset:4096
  v_cvt_pk_bf16_f32 v108, v88, v89
  v_exp_f32 v92, v92
  v_exp_f32 v93, v93
  ds_read_b128 v[36:39], v4 offset:5120
  v_cvt_pk_bf16_f32 v109, v90, v91
  v_exp_f32 v94, v94
  v_exp_f32 v95, v95
  v_cvt_pk_bf16_f32 v110, v92, v93
  v_cvt_pk_bf16_f32 v111, v94, v95
  v_mfma_f32_32x32x16_bf16 v[128:143], v[48:51], v[104:107], v[128:143]
  v_exp_f32 v64, v64
  v_exp_f32 v65, v65
  v_exp_f32 v66, v66
  v_exp_f32 v67, v67
  v_mfma_f32_32x32x16_bf16 v[128:143], v[52:55], v[108:111], v[128:143]
  v_cvt_pk_bf16_f32 v96, v64, v65
  v_exp_f32 v68, v68
  v_exp_f32 v69, v69
  v_cvt_pk_bf16_f32 v97, v66, v67
  v_exp_f32 v70, v70
  v_mfma_f32_32x32x16_bf16 v[80:95], v[40:43], v[200:203], 0
  v_exp_f32 v71, v71
  v_cvt_pk_bf16_f32 v98, v68, v69
  v_exp_f32 v72, v72
  v_exp_f32 v73, v73
  v_cvt_pk_bf16_f32 v99, v70, v71
  v_mfma_f32_32x32x16_bf16 v[80:95], v[44:47], v[204:207], v[80:95]
  v_exp_f32 v74, v74
  v_exp_f32 v75, v75
  ds_read_b128 v[48:51], v4 offset:36864
  v_cvt_pk_bf16_f32 v100, v72, v73
  v_exp_f32 v76, v76
  v_exp_f32 v77, v77
  ds_read_b128 v[52:55], v4 offset:37888
  v_cvt_pk_bf16_f32 v101, v74, v75
  v_exp_f32 v78, v78
  s_add_u32 m0, s31, 1024
  s_add_u32 s29, s53, s27
  s_add_u32 s29, s29, 1024
  buffer_load_dwordx4 v2, s[8:11], s29 offen sc1 lds
  v_exp_f32 v79, v79
  v_cvt_pk_bf16_f32 v102, v76, v77
  v_cvt_pk_bf16_f32 v103, v78, v79
  s_waitcnt lgkmcnt(4)
  v_mfma_f32_32x32x16_bf16 v[112:127], v[56:59], v[96:99], v[112:127]
  v_exp_f32 v80, v80
  v_exp_f32 v81, v81
  v_exp_f32 v82, v82
  v_exp_f32 v83, v83
  v_mfma_f32_32x32x16_bf16 v[112:127], v[60:63], v[100:103], v[112:127]
  v_cvt_pk_bf16_f32 v104, v80, v81
  v_exp_f32 v84, v84
  v_exp_f32 v85, v85
  v_cvt_pk_bf16_f32 v105, v82, v83
  v_exp_f32 v86, v86
  s_waitcnt lgkmcnt(2)
  v_mfma_f32_32x32x16_bf16 v[64:79], v[32:35], v[192:195], 0
  v_exp_f32 v87, v87
  v_cvt_pk_bf16_f32 v106, v84, v85
  v_exp_f32 v88, v88
  v_exp_f32 v89, v89
  v_cvt_pk_bf16_f32 v107, v86, v87
  v_mfma_f32_32x32x16_bf16 v[64:79], v[36:39], v[196:199], v[64:79]
  v_exp_f32 v90, v90
  v_exp_f32 v91, v91
  ds_read_b128 v[40:43], v4 offset:6144
  v_cvt_pk_bf16_f32 v108, v88, v89
  v_exp_f32 v92, v92
  v_exp_f32 v93, v93
  ds_read_b128 v[44:47], v4 offset:7168
  v_cvt_pk_bf16_f32 v109, v90, v91
  v_exp_f32 v94, v94
  v_exp_f32 v95, v95
  v_cvt_pk_bf16_f32 v110, v92, v93
  v_cvt_pk_bf16_f32 v111, v94, v95
  v_mfma_f32_32x32x16_bf16 v[128:143], v[56:59], v[104:107], v[128:143]
  v_exp_f32 v64, v64
  v_exp_f32 v65, v65
  v_exp_f32 v66, v66
  v_exp_f32 v67, v67
  v_mfma_f32_32x32x16_bf16 v[128:143], v[60:63], v[108:111], v[128:143]
  v_cvt_pk_bf16_f32 v96, v64, v65
  v_exp_f32 v68, v68
  v_exp_f32 v69, v69
  v_cvt_pk_bf16_f32 v97, v66, v67
  v_exp_f32 v70, v70
  v_mfma_f32_32x32x16_bf16 v[80:95], v[32:35], v[200:203], 0
  v_exp_f32 v71, v71
  v_cvt_pk_bf16_f32 v98, v68, v69
  v_exp_f32 v72, v72
  v_exp_f32 v73, v73
  v_cvt_pk_bf16_f32 v99, v70, v71
  v_mfma_f32_32x32x16_bf16 v[80:95], v[36:39], v[204:207], v[80:95]
  v_exp_f32 v74, v74
  v_exp_f32 v75, v75
  ds_read_b128 v[56:59], v4 offset:38912
  v_cvt_pk_bf16_f32 v100, v72, v73
  v_exp_f32 v76, v76
  v_exp_f32 v77, v77
  ds_read_b128 v[60:63], v4 offset:39936
  v_cvt_pk_bf16_f32 v101, v74, v75
  v_exp_f32 v78, v78
  s_add_u32 m0, s31, 2048
  s_add_u32 s29, s53, s27
  s_add_u32 s29, s29, 2048
  buffer_load_dwordx4 v2, s[8:11], s29 offen sc1 lds
  v_exp_f32 v79, v79
  v_cvt_pk_bf16_f32 v102, v76, v77
  v_cvt_pk_bf16_f32 v103, v78, v79
  s_waitcnt lgkmcnt(4)
  v_mfma_f32_32x32x16_bf16 v[112:127], v[48:51], v[96:99], v[112:127]
  v_exp_f32 v80, v80
  v_exp_f32 v81, v81
  v_exp_f32 v82, v82
  v_exp_f32 v83, v83
  v_mfma_f32_32x32x16_bf16 v[112:127], v[52:55], v[100:103], v[112:127]
  v_cvt_pk_bf16_f32 v104, v80, v81
  v_exp_f32 v84, v84
  v_exp_f32 v85, v85
  v_cvt_pk_bf16_f32 v105, v82, v83
  v_exp_f32 v86, v86
  s_waitcnt lgkmcnt(2)
  v_mfma_f32_32x32x16_bf16 v[64:79], v[40:43], v[192:195], 0
  v_exp_f32 v87, v87
  v_cvt_pk_bf16_f32 v106, v84, v85
  v_exp_f32 v88, v88
  v_exp_f32 v89, v89
  v_cvt_pk_bf16_f32 v107, v86, v87
  v_mfma_f32_32x32x16_bf16 v[64:79], v[44:47], v[196:199], v[64:79]
  v_exp_f32 v90, v90
  v_exp_f32 v91, v91
  ds_read_b128 v[32:35], v4 offset:8192
  v_cvt_pk_bf16_f32 v108, v88, v89
  v_exp_f32 v92, v92
  v_exp_f32 v93, v93
  ds_read_b128 v[36:39], v4 offset:9216
  v_cvt_pk_bf16_f32 v109, v90, v91
  v_exp_f32 v94, v94
  v_exp_f32 v95, v95
  v_cvt_pk_bf16_f32 v110, v92, v93
  v_cvt_pk_bf16_f32 v111, v94, v95
  v_mfma_f32_32x32x16_bf16 v[128:143], v[48:51], v[104:107], v[128:143]
  v_exp_f32 v64, v64
  v_exp_f32 v65, v65
  v_exp_f32 v66, v66
  v_exp_f32 v67, v67
  v_mfma_f32_32x32x16_bf16 v[128:143], v[52:55], v[108:111], v[128:143]
  v_cvt_pk_bf16_f32 v96, v64, v65
  v_exp_f32 v68, v68
  v_exp_f32 v69, v69
  v_cvt_pk_bf16_f32 v97, v66, v67
  v_exp_f32 v70, v70
  v_mfma_f32_32x32x16_bf16 v[80:95], v[40:43], v[200:203], 0
  v_exp_f32 v71, v71
  v_cvt_pk_bf16_f32 v98, v68, v69
  v_exp_f32 v72, v72
  v_exp_f32 v73, v73
  v_cvt_pk_bf16_f32 v99, v70, v71
  v_mfma_f32_32x32x16_bf16 v[80:95], v[44:47], v[204:207], v[80:95]
  v_exp_f32 v74, v74
  v_exp_f32 v75, v75
  ds_read_b128 v[48:51], v4 offset:40960
  v_cvt_pk_bf16_f32 v100, v72, v73
  v_exp_f32 v76, v76
  v_exp_f32 v77, v77
  ds_read_b128 v[52:55], v4 offset:41984
  v_cvt_pk_bf16_f32 v101, v74, v75
  v_exp_f32 v78, v78
  s_add_u32 m0, s31, 3072
  s_add_u32 s29, s53, s27
  s_add_u32 s29, s29, 3072
  buffer_load_dwordx4 v2, s[8:11], s29 offen sc1 lds
  v_exp_f32 v79, v79
  v_cvt_pk_bf16_f32 v102, v76, v77
  v_cvt_pk_bf16_f32 v103, v78, v79
  s_waitcnt lgkmcnt(4)
  v_mfma_f32_32x32x16_bf16 v[112:127], v[56:59], v[96:99], v[112:127]
  v_exp_f32 v80, v80
  v_exp_f32 v81, v81
  v_exp_f32 v82, v82
  v_exp_f32 v83, v83
  v_mfma_f32_32x32x16_bf16 v[112:127], v[60:63], v[100:103], v[112:127]
  v_cvt_pk_bf16_f32 v104, v80, v81
  v_exp_f32 v84, v84
  v_exp_f32 v85, v85
  v_cvt_pk_bf16_f32 v105, v82, v83
  v_exp_f32 v86, v86
  s_waitcnt lgkmcnt(2)
  v_mfma_f32_32x32x16_bf16 v[64:79], v[32:35], v[192:195], 0
  v_exp_f32 v87, v87
  v_cvt_pk_bf16_f32 v106, v84, v85
  v_exp_f32 v88, v88
  v_exp_f32 v89, v89
  v_cvt_pk_bf16_f32 v107, v86, v87
  v_mfma_f32_32x32x16_bf16 v[64:79], v[36:39], v[196:199], v[64:79]
  v_exp_f32 v90, v90
  v_exp_f32 v91, v91
  ds_read_b128 v[40:43], v4 offset:10240
  v_cvt_pk_bf16_f32 v108, v88, v89
  v_exp_f32 v92, v92
  v_exp_f32 v93, v93
  ds_read_b128 v[44:47], v4 offset:11264
  v_cvt_pk_bf16_f32 v109, v90, v91
  v_exp_f32 v94, v94
  v_exp_f32 v95, v95
  v_cvt_pk_bf16_f32 v110, v92, v93
  v_cvt_pk_bf16_f32 v111, v94, v95
  v_mfma_f32_32x32x16_bf16 v[128:143], v[56:59], v[104:107], v[128:143]
  v_exp_f32 v64, v64
  v_exp_f32 v65, v65
  v_exp_f32 v66, v66
  v_exp_f32 v67, v67
  v_mfma_f32_32x32x16_bf16 v[128:143], v[60:63], v[108:111], v[128:143]
  v_cvt_pk_bf16_f32 v96, v64, v65
  v_exp_f32 v68, v68
  v_exp_f32 v69, v69
  v_cvt_pk_bf16_f32 v97, v66, v67
  v_exp_f32 v70, v70
  v_mfma_f32_32x32x16_bf16 v[80:95], v[32:35], v[200:203], 0
  v_exp_f32 v71, v71
  v_cvt_pk_bf16_f32 v98, v68, v69
  v_exp_f32 v72, v72
  v_exp_f32 v73, v73
  v_cvt_pk_bf16_f32 v99, v70, v71
  v_mfma_f32_32x32x16_bf16 v[80:95], v[36:39], v[204:207], v[80:95]
  v_exp_f32 v74, v74
  v_exp_f32 v75, v75
  ds_read_b128 v[56:59], v4 offset:43008
  v_cvt_pk_bf16_f32 v100, v72, v73
  v_exp_f32 v76, v76
  v_exp_f32 v77, v77
  ds_read_b128 v[60:63], v4 offset:44032
  v_cvt_pk_bf16_f32 v101, v74, v75
  v_exp_f32 v78, v78
  s_add_u32 m0, s31, 4096
  s_add_u32 s29, s53, s27
  s_add_u32 s29, s29, 4096
  buffer_load_dwordx4 v2, s[8:11], s29 offen sc1 lds
  v_exp_f32 v79, v79
  v_cvt_pk_bf16_f32 v102, v76, v77
  v_cvt_pk_bf16_f32 v103, v78, v79
  s_waitcnt lgkmcnt(4)
  v_mfma_f32_32x32x16_bf16 v[112:127], v[48:51], v[96:99], v[112:127]
  v_exp_f32 v80, v80
  v_exp_f32 v81, v81
  v_exp_f32 v82, v82
  v_exp_f32 v83, v83
  v_mfma_f32_32x32x16_bf16 v[112:127], v[52:55], v[100:103], v[112:127]
  v_cvt_pk_bf16_f32 v104, v80, v81
  v_exp_f32 v84, v84
  v_exp_f32 v85, v85
  v_cvt_pk_bf16_f32 v105, v82, v83
  v_exp_f32 v86, v86
  s_waitcnt lgkmcnt(2)
  v_mfma_f32_32x32x16_bf16 v[64:79], v[40:43], v[192:195], 0
  v_exp_f32 v87, v87
  v_cvt_pk_bf16_f32 v106, v84, v85
  v_exp_f32 v88, v88
  v_exp_f32 v89, v89
  v_cvt_pk_bf16_f32 v107, v86, v87
  v_mfma_f32_32x32x16_bf16 v[64:79], v[44:47], v[196:199], v[64:79]
  v_exp_f32 v90, v90
  v_exp_f32 v91, v91
  ds_read_b128 v[32:35], v4 offset:12288
  v_cvt_pk_bf16_f32 v108, v88, v89
  v_exp_f32 v92, v92
  v_exp_f32 v93, v93
  ds_read_b128 v[36:39], v4 offset:13312
  v_cvt_pk_bf16_f32 v109, v90, v91
  v_exp_f32 v94, v94
  v_exp_f32 v95, v95
  v_cvt_pk_bf16_f32 v110, v92, v93
  v_cvt_pk_bf16_f32 v111, v94, v95
  v_mfma_f32_32x32x16_bf16 v[128:143], v[48:51], v[104:107], v[128:143]
  v_exp_f32 v64, v64
  v_exp_f32 v65, v65
  v_exp_f32 v66, v66
  v_exp_f32 v67, v67
  v_mfma_f32_32x32x16_bf16 v[128:143], v[52:55], v[108:111], v[128:143]
  v_cvt_pk_bf16_f32 v96, v64, v65
  v_exp_f32 v68, v68
  v_exp_f32 v69, v69
  v_cvt_pk_bf16_f32 v97, v66, v67
  v_exp_f32 v70, v70
  v_mfma_f32_32x32x16_bf16 v[80:95], v[40:43], v[200:203], 0
  v_exp_f32 v71, v71
  v_cvt_pk_bf16_f32 v98, v68, v69
  v_exp_f32 v72, v72
  v_exp_f32 v73, v73
  v_cvt_pk_bf16_f32 v99, v70, v71
  v_mfma_f32_32x32x16_bf16 v[80:95], v[44:47], v[204:207], v[80:95]
  v_exp_f32 v74, v74
  v_exp_f32 v75, v75
  ds_read_b128 v[48:51], v4 offset:45056
  v_cvt_pk_bf16_f32 v100, v72, v73
  v_exp_f32 v76, v76
  v_exp_f32 v77, v77
  ds_read_b128 v[52:55], v4 offset:46080
  v_cvt_pk_bf16_f32 v101, v74, v75
  v_exp_f32 v78, v78
  s_add_u32 m0, s31, 5120
  s_add_u32 s29, s53, s27
  s_add_u32 s29, s29, 5120
  buffer_load_dwordx4 v2, s[8:11], s29 offen sc1 lds
  v_exp_f32 v79, v79
  v_cvt_pk_bf16_f32 v102, v76, v77
  v_cvt_pk_bf16_f32 v103, v78, v79
  s_waitcnt lgkmcnt(4)
  v_mfma_f32_32x32x16_bf16 v[112:127], v[56:59], v[96:99], v[112:127]
  v_exp_f32 v80, v80
  v_exp_f32 v81, v81
  v_exp_f32 v82, v82
  v_exp_f32 v83, v83
  v_mfma_f32_32x32x16_bf16 v[112:127], v[60:63], v[100:103], v[112:127]
  v_cvt_pk_bf16_f32 v104, v80, v81
  v_exp_f32 v84, v84
  v_exp_f32 v85, v85
  v_cvt_pk_bf16_f32 v105, v82, v83
  v_exp_f32 v86, v86
  s_waitcnt lgkmcnt(2)
  v_mfma_f32_32x32x16_bf16 v[64:79], v[32:35], v[192:195], 0
  v_exp_f32 v87, v87
  v_cvt_pk_bf16_f32 v106, v84, v85
  v_exp_f32 v88, v88
  v_exp_f32 v89, v89
  v_cvt_pk_bf16_f32 v107, v86, v87
  v_mfma_f32_32x32x16_bf16 v[64:79], v[36:39], v[196:199], v[64:79]
  v_exp_f32 v90, v90
  v_exp_f32 v91, v91
  ds_read_b128 v[40:43], v4 offset:14336
  v_cvt_pk_bf16_f32 v108, v88, v89
  v_exp_f32 v92, v92
  v_exp_f32 v93, v93
  ds_read_b128 v[44:47], v4 offset:15360
  v_cvt_pk_bf16_f32 v109, v90, v91
  v_exp_f32 v94, v94
  v_exp_f32 v95, v95
  v_cvt_pk_bf16_f32 v110, v92, v93
  v_cvt_pk_bf16_f32 v111, v94, v95
  v_mfma_f32_32x32x16_bf16 v[128:143], v[56:59], v[104:107], v[128:143]
  v_exp_f32 v64, v64
  v_exp_f32 v65, v65
  v_exp_f32 v66, v66
  v_exp_f32 v67, v67
  v_mfma_f32_32x32x16_bf16 v[128:143], v[60:63], v[108:111], v[128:143]
  v_cvt_pk_bf16_f32 v96, v64, v65
  v_exp_f32 v68, v68
  v_exp_f32 v69, v69
  v_cvt_pk_bf16_f32 v97, v66, v67
  v_exp_f32 v70, v70
  v_mfma_f32_32x32x16_bf16 v[80:95], v[32:35], v[200:203], 0
  v_exp_f32 v71, v71
  v_cvt_pk_bf16_f32 v98, v68, v69
  v_exp_f32 v72, v72
  v_exp_f32 v73, v73
  v_cvt_pk_bf16_f32 v99, v70, v71
  v_mfma_f32_32x32x16_bf16 v[80:95], v[36:39], v[204:207], v[80:95]
  v_exp_f32 v74, v74
  v_exp_f32 v75, v75
  ds_read_b128 v[56:59], v4 offset:47104
  v_cvt_pk_bf16_f32 v100, v72, v73
  v_exp_f32 v76, v76
  v_exp_f32 v77, v77
  ds_read_b128 v[60:63], v4 offset:48128
  v_cvt_pk_bf16_f32 v101, v74, v75
  v_exp_f32 v78, v78
  s_add_u32 m0, s31, 6144
  s_add_u32 s29, s53, s27
  s_add_u32 s29, s29, 6144
  buffer_load_dwordx4 v2, s[8:11], s29 offen sc1 lds
  v_exp_f32 v79, v79
  v_cvt_pk_bf16_f32 v102, v76, v77
  v_cvt_pk_bf16_f32 v103, v78, v79
  s_waitcnt lgkmcnt(4)
  v_mfma_f32_32x32x16_bf16 v[112:127], v[48:51], v[96:99], v[112:127]
  v_exp_f32 v80, v80
  v_exp_f32 v81, v81
  v_exp_f32 v82, v82
  v_exp_f32 v83, v83
  v_mfma_f32_32x32x16_bf16 v[112:127], v[52:55], v[100:103], v[112:127]
  v_cvt_pk_bf16_f32 v104, v80, v81
  v_exp_f32 v84, v84
  v_exp_f32 v85, v85
  v_cvt_pk_bf16_f32 v105, v82, v83
  v_exp_f32 v86, v86
  s_waitcnt lgkmcnt(2)
  v_mfma_f32_32x32x16_bf16 v[64:79], v[40:43], v[192:195], 0
  v_exp_f32 v87, v87
  v_cvt_pk_bf16_f32 v106, v84, v85
  v_exp_f32 v88, v88
  v_exp_f32 v89, v89
  v_cvt_pk_bf16_f32 v107, v86, v87
  v_mfma_f32_32x32x16_bf16 v[64:79], v[44:47], v[196:199], v[64:79]
  v_exp_f32 v90, v90
  v_exp_f32 v91, v91
  ds_read_b128 v[32:35], v4 offset:16384
  v_cvt_pk_bf16_f32 v108, v88, v89
  v_exp_f32 v92, v92
  v_exp_f32 v93, v93
  ds_read_b128 v[36:39], v4 offset:17408
  v_cvt_pk_bf16_f32 v109, v90, v91
  v_exp_f32 v94, v94
  v_exp_f32 v95, v95
  v_cvt_pk_bf16_f32 v110, v92, v93
  v_cvt_pk_bf16_f32 v111, v94, v95
  v_mfma_f32_32x32x16_bf16 v[128:143], v[48:51], v[104:107], v[128:143]
  v_exp_f32 v64, v64
  v_exp_f32 v65, v65
  v_exp_f32 v66, v66
  v_exp_f32 v67, v67
  v_mfma_f32_32x32x16_bf16 v[128:143], v[52:55], v[108:111], v[128:143]
  v_cvt_pk_bf16_f32 v96, v64, v65
  v_exp_f32 v68, v68
  v_exp_f32 v69, v69
  v_cvt_pk_bf16_f32 v97, v66, v67
  v_exp_f32 v70, v70
  v_mfma_f32_32x32x16_bf16 v[80:95], v[40:43], v[200:203], 0
  v_exp_f32 v71, v71
  v_cvt_pk_bf16_f32 v98, v68, v69
  v_exp_f32 v72, v72
  v_exp_f32 v73, v73
  v_cvt_pk_bf16_f32 v99, v70, v71
  v_mfma_f32_32x32x16_bf16 v[80:95], v[44:47], v[204:207], v[80:95]
  v_exp_f32 v74, v74
  v_exp_f32 v75, v75
  ds_read_b128 v[48:51], v4 offset:49152
  v_cvt_pk_bf16_f32 v100, v72, v73
  v_exp_f32 v76, v76
  v_exp_f32 v77, v77
  ds_read_b128 v[52:55], v4 offset:50176
  v_cvt_pk_bf16_f32 v101, v74, v75
  v_exp_f32 v78, v78
  s_add_u32 m0, s31, 7168
  s_add_u32 s29, s53, s27
  s_add_u32 s29, s29, 7168
  buffer_load_dwordx4 v2, s[8:11], s29 offen sc1 lds
  v_exp_f32 v79, v79
  v_cvt_pk_bf16_f32 v102, v76, v77
  v_cvt_pk_bf16_f32 v103, v78, v79
  s_waitcnt lgkmcnt(4)
  v_mfma_f32_32x32x16_bf16 v[112:127], v[56:59], v[96:99], v[112:127]
  v_exp_f32 v80, v80
  v_exp_f32 v81, v81
  v_exp_f32 v82, v82
  v_exp_f32 v83, v83
  v_mfma_f32_32x32x16_bf16 v[112:127], v[60:63], v[100:103], v[112:127]
  v_cvt_pk_bf16_f32 v104, v80, v81
  v_exp_f32 v84, v84
  v_exp_f32 v85, v85
  v_cvt_pk_bf16_f32 v105, v82, v83
  v_exp_f32 v86, v86
  s_waitcnt lgkmcnt(2)
  v_mfma_f32_32x32x16_bf16 v[64:79], v[32:35], v[192:195], 0
  v_exp_f32 v87, v87
  v_cvt_pk_bf16_f32 v106, v84, v85
  v_exp_f32 v88, v88
  v_exp_f32 v89, v89
  v_cvt_pk_bf16_f32 v107, v86, v87
  v_mfma_f32_32x32x16_bf16 v[64:79], v[36:39], v[196:199], v[64:79]
  v_exp_f32 v90, v90
  v_exp_f32 v91, v91
  ds_read_b128 v[40:43], v4 offset:18432
  v_cvt_pk_bf16_f32 v108, v88, v89
  v_exp_f32 v92, v92
  v_exp_f32 v93, v93
  ds_read_b128 v[44:47], v4 offset:19456
  v_cvt_pk_bf16_f32 v109, v90, v91
  v_exp_f32 v94, v94
  v_exp_f32 v95, v95
  v_cvt_pk_bf16_f32 v110, v92, v93
  v_cvt_pk_bf16_f32 v111, v94, v95
  v_mfma_f32_32x32x16_bf16 v[128:143], v[56:59], v[104:107], v[128:143]
  v_exp_f32 v64, v64
  v_exp_f32 v65, v65
  v_exp_f32 v66, v66
  v_exp_f32 v67, v67
  v_mfma_f32_32x32x16_bf16 v[128:143], v[60:63], v[108:111], v[128:143]
  v_cvt_pk_bf16_f32 v96, v64, v65
  v_exp_f32 v68, v68
  v_exp_f32 v69, v69
  v_cvt_pk_bf16_f32 v97, v66, v67
  v_exp_f32 v70, v70
  v_mfma_f32_32x32x16_bf16 v[80:95], v[32:35], v[200:203], 0
  v_exp_f32 v71, v71
  v_cvt_pk_bf16_f32 v98, v68, v69
  v_exp_f32 v72, v72
  v_exp_f32 v73, v73
  v_cvt_pk_bf16_f32 v99, v70, v71
  v_mfma_f32_32x32x16_bf16 v[80:95], v[36:39], v[204:207], v[80:95]
  v_exp_f32 v74, v74
  v_exp_f32 v75, v75
  ds_read_b128 v[56:59], v4 offset:51200
  v_cvt_pk_bf16_f32 v100, v72, v73
  v_exp_f32 v76, v76
  v_exp_f32 v77, v77
  ds_read_b128 v[60:63], v4 offset:52224
  v_cvt_pk_bf16_f32 v101, v74, v75
  v_exp_f32 v78, v78
  s_add_u32 m0, s31, 32768
  s_add_u32 s29, s53, s28
  s_add_u32 s29, s29, 0
  buffer_load_dwordx4 v2, s[8:11], s29 offen sc1 lds
  v_exp_f32 v79, v79
  v_cvt_pk_bf16_f32 v102, v76, v77
  v_cvt_pk_bf16_f32 v103, v78, v79
  s_waitcnt lgkmcnt(4)
  v_mfma_f32_32x32x16_bf16 v[112:127], v[48:51], v[96:99], v[112:127]
  v_exp_f32 v80, v80
  v_exp_f32 v81, v81
  v_exp_f32 v82, v82
  v_exp_f32 v83, v83
  v_mfma_f32_32x32x16_bf16 v[112:127], v[52:55], v[100:103], v[112:127]
  v_cvt_pk_bf16_f32 v104, v80, v81
  v_exp_f32 v84, v84
  v_exp_f32 v85, v85
  v_cvt_pk_bf16_f32 v105, v82, v83
  v_exp_f32 v86, v86
  s_waitcnt lgkmcnt(2)
  v_mfma_f32_32x32x16_bf16 v[64:79], v[40:43], v[192:195], 0
  v_exp_f32 v87, v87
  v_cvt_pk_bf16_f32 v106, v84, v85
  v_exp_f32 v88, v88
  v_exp_f32 v89, v89
  v_cvt_pk_bf16_f32 v107, v86, v87
  v_mfma_f32_32x32x16_bf16 v[64:79], v[44:47], v[196:199], v[64:79]
  v_exp_f32 v90, v90
  v_exp_f32 v91, v91
  ds_read_b128 v[32:35], v4 offset:20480
  v_cvt_pk_bf16_f32 v108, v88, v89
  v_exp_f32 v92, v92
  v_exp_f32 v93, v93
  ds_read_b128 v[36:39], v4 offset:21504
  v_cvt_pk_bf16_f32 v109, v90, v91
  v_exp_f32 v94, v94
  v_exp_f32 v95, v95
  v_cvt_pk_bf16_f32 v110, v92, v93
  v_cvt_pk_bf16_f32 v111, v94, v95
  v_mfma_f32_32x32x16_bf16 v[128:143], v[48:51], v[104:107], v[128:143]
  v_exp_f32 v64, v64
  v_exp_f32 v65, v65
  v_exp_f32 v66, v66
  v_exp_f32 v67, v67
  v_mfma_f32_32x32x16_bf16 v[128:143], v[52:55], v[108:111], v[128:143]
  v_cvt_pk_bf16_f32 v96, v64, v65
  v_exp_f32 v68, v68
  v_exp_f32 v69, v69
  v_cvt_pk_bf16_f32 v97, v66, v67
  v_exp_f32 v70, v70
  v_mfma_f32_32x32x16_bf16 v[80:95], v[40:43], v[200:203], 0
  v_exp_f32 v71, v71
  v_cvt_pk_bf16_f32 v98, v68, v69
  v_exp_f32 v72, v72
  v_exp_f32 v73, v73
  v_cvt_pk_bf16_f32 v99, v70, v71
  v_mfma_f32_32x32x16_bf16 v[80:95], v[44:47], v[204:207], v[80:95]
  v_exp_f32 v74, v74
  v_exp_f32 v75, v75
  ds_read_b128 v[48:51], v4 offset:53248
  v_cvt_pk_bf16_f32 v100, v72, v73
  v_exp_f32 v76, v76
  v_exp_f32 v77, v77
  ds_read_b128 v[52:55], v4 offset:54272
  v_cvt_pk_bf16_f32 v101, v74, v75
  v_exp_f32 v78, v78
  s_add_u32 m0, s31, 33792
  s_add_u32 s29, s53, s28
  s_add_u32 s29, s29, 1024
  buffer_load_dwordx4 v2, s[8:11], s29 offen sc1 lds
  v_exp_f32 v79, v79
  v_cvt_pk_bf16_f32 v102, v76, v77
  v_cvt_pk_bf16_f32 v103, v78, v79
  s_waitcnt lgkmcnt(4)
  v_mfma_f32_32x32x16_bf16 v[112:127], v[56:59], v[96:99], v[112:127]
  v_exp_f32 v80, v80
  v_exp_f32 v81, v81
  v_exp_f32 v82, v82
  v_exp_f32 v83, v83
  v_mfma_f32_32x32x16_bf16 v[112:127], v[60:63], v[100:103], v[112:127]
  v_cvt_pk_bf16_f32 v104, v80, v81
  v_exp_f32 v84, v84
  v_exp_f32 v85, v85
  v_cvt_pk_bf16_f32 v105, v82, v83
  v_exp_f32 v86, v86
  s_waitcnt lgkmcnt(2)
  v_mfma_f32_32x32x16_bf16 v[64:79], v[32:35], v[192:195], 0
  v_exp_f32 v87, v87
  v_cvt_pk_bf16_f32 v106, v84, v85
  v_exp_f32 v88, v88
  v_exp_f32 v89, v89
  v_cvt_pk_bf16_f32 v107, v86, v87
  v_mfma_f32_32x32x16_bf16 v[64:79], v[36:39], v[196:199], v[64:79]
  v_exp_f32 v90, v90
  v_exp_f32 v91, v91
  ds_read_b128 v[40:43], v4 offset:22528
  v_cvt_pk_bf16_f32 v108, v88, v89
  v_exp_f32 v92, v92
  v_exp_f32 v93, v93
  ds_read_b128 v[44:47], v4 offset:23552
  v_cvt_pk_bf16_f32 v109, v90, v91
  v_exp_f32 v94, v94
  v_exp_f32 v95, v95
  v_cvt_pk_bf16_f32 v110, v92, v93
  v_cvt_pk_bf16_f32 v111, v94, v95
  v_mfma_f32_32x32x16_bf16 v[128:143], v[56:59], v[104:107], v[128:143]
  v_exp_f32 v64, v64
  v_exp_f32 v65, v65
  v_exp_f32 v66, v66
  v_exp_f32 v67, v67
  v_mfma_f32_32x32x16_bf16 v[128:143], v[60:63], v[108:111], v[128:143]
  v_cvt_pk_bf16_f32 v96, v64, v65
  v_exp_f32 v68, v68
  v_exp_f32 v69, v69
  v_cvt_pk_bf16_f32 v97, v66, v67
  v_exp_f32 v70, v70
  v_mfma_f32_32x32x16_bf16 v[80:95], v[32:35], v[200:203], 0
  v_exp_f32 v71, v71
  v_cvt_pk_bf16_f32 v98, v68, v69
  v_exp_f32 v72, v72
  v_exp_f32 v73, v73
  v_cvt_pk_bf16_f32 v99, v70, v71
  v_mfma_f32_32x32x16_bf16 v[80:95], v[36:39], v[204:207], v[80:95]
  v_exp_f32 v74, v74
  v_exp_f32 v75, v75
  ds_read_b128 v[56:59], v4 offset:55296
  v_cvt_pk_bf16_f32 v100, v72, v73
  v_exp_f32 v76, v76
  v_exp_f32 v77, v77
  ds_read_b128 v[60:63], v4 offset:56320
  v_cvt_pk_bf16_f32 v101, v74, v75
  v_exp_f32 v78, v78
  s_add_u32 m0, s31, 34816
  s_add_u32 s29, s53, s28
  s_add_u32 s29, s29, 2048
  buffer_load_dwordx4 v2, s[8:11], s29 offen sc1 lds
  v_exp_f32 v79, v79
  v_cvt_pk_bf16_f32 v102, v76, v77
  v_cvt_pk_bf16_f32 v103, v78, v79
  s_waitcnt lgkmcnt(4)
  v_mfma_f32_32x32x16_bf16 v[112:127], v[48:51], v[96:99], v[112:127]
  v_exp_f32 v80, v80
  v_exp_f32 v81, v81
  v_exp_f32 v82, v82
  v_exp_f32 v83, v83
  v_mfma_f32_32x32x16_bf16 v[112:127], v[52:55], v[100:103], v[112:127]
  v_cvt_pk_bf16_f32 v104, v80, v81
  v_exp_f32 v84, v84
  v_exp_f32 v85, v85
  v_cvt_pk_bf16_f32 v105, v82, v83
  v_exp_f32 v86, v86
  s_waitcnt lgkmcnt(2)
  v_mfma_f32_32x32x16_bf16 v[64:79], v[40:43], v[192:195], 0
  v_exp_f32 v87, v87
  v_cvt_pk_bf16_f32 v106, v84, v85
  v_exp_f32 v88, v88
  v_exp_f32 v89, v89
  v_cvt_pk_bf16_f32 v107, v86, v87
  v_mfma_f32_32x32x16_bf16 v[64:79], v[44:47], v[196:199], v[64:79]
  v_exp_f32 v90, v90
  v_exp_f32 v91, v91
  ds_read_b128 v[32:35], v4 offset:24576
  v_cvt_pk_bf16_f32 v108, v88, v89
  v_exp_f32 v92, v92
  v_exp_f32 v93, v93
  ds_read_b128 v[36:39], v4 offset:25600
  v_cvt_pk_bf16_f32 v109, v90, v91
  v_exp_f32 v94, v94
  v_exp_f32 v95, v95
  v_cvt_pk_bf16_f32 v110, v92, v93
  v_cvt_pk_bf16_f32 v111, v94, v95
  v_mfma_f32_32x32x16_bf16 v[128:143], v[48:51], v[104:107], v[128:143]
  v_exp_f32 v64, v64
  v_exp_f32 v65, v65
  v_exp_f32 v66, v66
  v_exp_f32 v67, v67
  v_mfma_f32_32x32x16_bf16 v[128:143], v[52:55], v[108:111], v[128:143]
  v_cvt_pk_bf16_f32 v96, v64, v65
  v_exp_f32 v68, v68
  v_exp_f32 v69, v69
  v_cvt_pk_bf16_f32 v97, v66, v67
  v_exp_f32 v70, v70
  v_mfma_f32_32x32x16_bf16 v[80:95], v[40:43], v[200:203], 0
  v_exp_f32 v71, v71
  v_cvt_pk_bf16_f32 v98, v68, v69
  v_exp_f32 v72, v72
  v_exp_f32 v73, v73
  v_cvt_pk_bf16_f32 v99, v70, v71
  v_mfma_f32_32x32x16_bf16 v[80:95], v[44:47], v[204:207], v[80:95]
  v_exp_f32 v74, v74
  v_exp_f32 v75, v75
  ds_read_b128 v[48:51], v4 offset:57344
  v_cvt_pk_bf16_f32 v100, v72, v73
  v_exp_f32 v76, v76
  v_exp_f32 v77, v77
  ds_read_b128 v[52:55], v4 offset:58368
  v_cvt_pk_bf16_f32 v101, v74, v75
  v_exp_f32 v78, v78
  s_add_u32 m0, s31, 35840
  s_add_u32 s29, s53, s28
  s_add_u32 s29, s29, 3072
  buffer_load_dwordx4 v2, s[8:11], s29 offen sc1 lds
  v_exp_f32 v79, v79
  v_cvt_pk_bf16_f32 v102, v76, v77
  v_cvt_pk_bf16_f32 v103, v78, v79
  s_waitcnt lgkmcnt(4)
  v_mfma_f32_32x32x16_bf16 v[112:127], v[56:59], v[96:99], v[112:127]
  v_exp_f32 v80, v80
  v_exp_f32 v81, v81
  v_exp_f32 v82, v82
  v_exp_f32 v83, v83
  v_mfma_f32_32x32x16_bf16 v[112:127], v[60:63], v[100:103], v[112:127]
  v_cvt_pk_bf16_f32 v104, v80, v81
  v_exp_f32 v84, v84
  v_exp_f32 v85, v85
  v_cvt_pk_bf16_f32 v105, v82, v83
  v_exp_f32 v86, v86
  s_waitcnt lgkmcnt(2)
  v_mfma_f32_32x32x16_bf16 v[64:79], v[32:35], v[192:195], 0
  v_exp_f32 v87, v87
  v_cvt_pk_bf16_f32 v106, v84, v85
  v_exp_f32 v88, v88
  v_exp_f32 v89, v89
  v_cvt_pk_bf16_f32 v107, v86, v87
  v_mfma_f32_32x32x16_bf16 v[64:79], v[36:39], v[196:199], v[64:79]
  v_exp_f32 v90, v90
  v_exp_f32 v91, v91
  ds_read_b128 v[40:43], v4 offset:26624
  v_cvt_pk_bf16_f32 v108, v88, v89
  v_exp_f32 v92, v92
  v_exp_f32 v93, v93
  ds_read_b128 v[44:47], v4 offset:27648
  v_cvt_pk_bf16_f32 v109, v90, v91
  v_exp_f32 v94, v94
  v_exp_f32 v95, v95
  v_cvt_pk_bf16_f32 v110, v92, v93
  v_cvt_pk_bf16_f32 v111, v94, v95
  v_mfma_f32_32x32x16_bf16 v[128:143], v[56:59], v[104:107], v[128:143]
  v_exp_f32 v64, v64
  v_exp_f32 v65, v65
  v_exp_f32 v66, v66
  v_exp_f32 v67, v67
  v_mfma_f32_32x32x16_bf16 v[128:143], v[60:63], v[108:111], v[128:143]
  v_cvt_pk_bf16_f32 v96, v64, v65
  v_exp_f32 v68, v68
  v_exp_f32 v69, v69
  v_cvt_pk_bf16_f32 v97, v66, v67
  v_exp_f32 v70, v70
  v_mfma_f32_32x32x16_bf16 v[80:95], v[32:35], v[200:203], 0
  v_exp_f32 v71, v71
  v_cvt_pk_bf16_f32 v98, v68, v69
  v_exp_f32 v72, v72
  v_exp_f32 v73, v73
  v_cvt_pk_bf16_f32 v99, v70, v71
  v_mfma_f32_32x32x16_bf16 v[80:95], v[36:39], v[204:207], v[80:95]
  v_exp_f32 v74, v74
  v_exp_f32 v75, v75
  ds_read_b128 v[56:59], v4 offset:59392
  v_cvt_pk_bf16_f32 v100, v72, v73
  v_exp_f32 v76, v76
  v_exp_f32 v77, v77
  ds_read_b128 v[60:63], v4 offset:60416
  v_cvt_pk_bf16_f32 v101, v74, v75
  v_exp_f32 v78, v78
  s_add_u32 m0, s31, 36864
  s_add_u32 s29, s53, s28
  s_add_u32 s29, s29, 4096
  buffer_load_dwordx4 v2, s[8:11], s29 offen sc1 lds
  v_exp_f32 v79, v79
  v_cvt_pk_bf16_f32 v102, v76, v77
  v_cvt_pk_bf16_f32 v103, v78, v79
  s_waitcnt lgkmcnt(4)
  v_mfma_f32_32x32x16_bf16 v[112:127], v[48:51], v[96:99], v[112:127]
  v_exp_f32 v80, v80
  v_exp_f32 v81, v81
  v_exp_f32 v82, v82
  v_exp_f32 v83, v83
  v_mfma_f32_32x32x16_bf16 v[112:127], v[52:55], v[100:103], v[112:127]
  v_cvt_pk_bf16_f32 v104, v80, v81
  v_exp_f32 v84, v84
  v_exp_f32 v85, v85
  v_cvt_pk_bf16_f32 v105, v82, v83
  v_exp_f32 v86, v86
  s_waitcnt lgkmcnt(2)
  v_mfma_f32_32x32x16_bf16 v[64:79], v[40:43], v[192:195], 0
  v_exp_f32 v87, v87
  v_cvt_pk_bf16_f32 v106, v84, v85
  v_exp_f32 v88, v88
  v_exp_f32 v89, v89
  v_cvt_pk_bf16_f32 v107, v86, v87
  v_mfma_f32_32x32x16_bf16 v[64:79], v[44:47], v[196:199], v[64:79]
  v_exp_f32 v90, v90
  v_exp_f32 v91, v91
  ds_read_b128 v[32:35], v4 offset:28672
  v_cvt_pk_bf16_f32 v108, v88, v89
  v_exp_f32 v92, v92
  v_exp_f32 v93, v93
  ds_read_b128 v[36:39], v4 offset:29696
  v_cvt_pk_bf16_f32 v109, v90, v91
  v_exp_f32 v94, v94
  v_exp_f32 v95, v95
  v_cvt_pk_bf16_f32 v110, v92, v93
  v_cvt_pk_bf16_f32 v111, v94, v95
  v_mfma_f32_32x32x16_bf16 v[128:143], v[48:51], v[104:107], v[128:143]
  v_exp_f32 v64, v64
  v_exp_f32 v65, v65
  v_exp_f32 v66, v66
  v_exp_f32 v67, v67
  v_mfma_f32_32x32x16_bf16 v[128:143], v[52:55], v[108:111], v[128:143]
  v_cvt_pk_bf16_f32 v96, v64, v65
  v_exp_f32 v68, v68
  v_exp_f32 v69, v69
  v_cvt_pk_bf16_f32 v97, v66, v67
  v_exp_f32 v70, v70
  v_mfma_f32_32x32x16_bf16 v[80:95], v[40:43], v[200:203], 0
  v_exp_f32 v71, v71
  v_cvt_pk_bf16_f32 v98, v68, v69
  v_exp_f32 v72, v72
  v_exp_f32 v73, v73
  v_cvt_pk_bf16_f32 v99, v70, v71
  v_mfma_f32_32x32x16_bf16 v[80:95], v[44:47], v[204:207], v[80:95]
  v_exp_f32 v74, v74
  v_exp_f32 v75, v75
  ds_read_b128 v[48:51], v4 offset:61440
  v_cvt_pk_bf16_f32 v100, v72, v73
  v_exp_f32 v76, v76
  v_exp_f32 v77, v77
  ds_read_b128 v[52:55], v4 offset:62464
  v_cvt_pk_bf16_f32 v101, v74, v75
  v_exp_f32 v78, v78
  s_add_u32 m0, s31, 37888
  s_add_u32 s29, s53, s28
  s_add_u32 s29, s29, 5120
  buffer_load_dwordx4 v2, s[8:11], s29 offen sc1 lds
  v_exp_f32 v79, v79
  v_cvt_pk_bf16_f32 v102, v76, v77
  v_cvt_pk_bf16_f32 v103, v78, v79
  s_waitcnt lgkmcnt(4)
  v_mfma_f32_32x32x16_bf16 v[112:127], v[56:59], v[96:99], v[112:127]
  v_exp_f32 v80, v80
  v_exp_f32 v81, v81
  v_exp_f32 v82, v82
  v_exp_f32 v83, v83
  v_mfma_f32_32x32x16_bf16 v[112:127], v[60:63], v[100:103], v[112:127]
  v_cvt_pk_bf16_f32 v104, v80, v81
  v_exp_f32 v84, v84
  v_exp_f32 v85, v85
  v_cvt_pk_bf16_f32 v105, v82, v83
  v_exp_f32 v86, v86
  s_waitcnt lgkmcnt(2)
  v_mfma_f32_32x32x16_bf16 v[64:79], v[32:35], v[192:195], 0
  v_exp_f32 v87, v87
  v_cvt_pk_bf16_f32 v106, v84, v85
  v_exp_f32 v88, v88
  v_exp_f32 v89, v89
  v_cvt_pk_bf16_f32 v107, v86, v87
  v_mfma_f32_32x32x16_bf16 v[64:79], v[36:39], v[196:199], v[64:79]
  v_exp_f32 v90, v90
  v_exp_f32 v91, v91
  ds_read_b128 v[40:43], v4 offset:30720
  v_cvt_pk_bf16_f32 v108, v88, v89
  v_exp_f32 v92, v92
  v_exp_f32 v93, v93
  ds_read_b128 v[44:47], v4 offset:31744
  v_cvt_pk_bf16_f32 v109, v90, v91
  v_exp_f32 v94, v94
  v_exp_f32 v95, v95
  v_cvt_pk_bf16_f32 v110, v92, v93
  v_cvt_pk_bf16_f32 v111, v94, v95
  v_mfma_f32_32x32x16_bf16 v[128:143], v[56:59], v[104:107], v[128:143]
  v_exp_f32 v64, v64
  v_exp_f32 v65, v65
  v_exp_f32 v66, v66
  v_exp_f32 v67, v67
  v_mfma_f32_32x32x16_bf16 v[128:143], v[60:63], v[108:111], v[128:143]
  v_cvt_pk_bf16_f32 v96, v64, v65
  v_exp_f32 v68, v68
  v_exp_f32 v69, v69
  v_cvt_pk_bf16_f32 v97, v66, v67
  v_exp_f32 v70, v70
  v_mfma_f32_32x32x16_bf16 v[80:95], v[32:35], v[200:203], 0
  v_exp_f32 v71, v71
  v_cvt_pk_bf16_f32 v98, v68, v69
  v_exp_f32 v72, v72
  v_exp_f32 v73, v73
  v_cvt_pk_bf16_f32 v99, v70, v71
  v_mfma_f32_32x32x16_bf16 v[80:95], v[36:39], v[204:207], v[80:95]
  v_exp_f32 v74, v74
  v_exp_f32 v75, v75
  ds_read_b128 v[56:59], v4 offset:63488
  v_cvt_pk_bf16_f32 v100, v72, v73
  v_exp_f32 v76, v76
  v_exp_f32 v77, v77
  ds_read_b128 v[60:63], v4 offset:64512
  v_cvt_pk_bf16_f32 v101, v74, v75
  v_exp_f32 v78, v78
  s_add_u32 m0, s31, 38912
  s_add_u32 s29, s53, s28
  s_add_u32 s29, s29, 6144
  buffer_load_dwordx4 v2, s[8:11], s29 offen sc1 lds
  v_exp_f32 v79, v79
  v_cvt_pk_bf16_f32 v102, v76, v77
  v_cvt_pk_bf16_f32 v103, v78, v79
  s_waitcnt lgkmcnt(4)
  v_mfma_f32_32x32x16_bf16 v[112:127], v[48:51], v[96:99], v[112:127]
  v_exp_f32 v80, v80
  v_exp_f32 v81, v81
  v_exp_f32 v82, v82
  v_exp_f32 v83, v83
  v_mfma_f32_32x32x16_bf16 v[112:127], v[52:55], v[100:103], v[112:127]
  v_cvt_pk_bf16_f32 v104, v80, v81
  v_exp_f32 v84, v84
  v_exp_f32 v85, v85
  v_cvt_pk_bf16_f32 v105, v82, v83
  v_exp_f32 v86, v86
  s_waitcnt lgkmcnt(2)
  v_mfma_f32_32x32x16_bf16 v[64:79], v[40:43], v[192:195], 0
  v_exp_f32 v87, v87
  v_cvt_pk_bf16_f32 v106, v84, v85
  v_exp_f32 v88, v88
  v_exp_f32 v89, v89
  v_cvt_pk_bf16_f32 v107, v86, v87
  v_mfma_f32_32x32x16_bf16 v[64:79], v[44:47], v[196:199], v[64:79]
  v_exp_f32 v90, v90
  v_exp_f32 v91, v91
  v_cvt_pk_bf16_f32 v108, v88, v89
  v_exp_f32 v92, v92
  v_exp_f32 v93, v93
  v_cvt_pk_bf16_f32 v109, v90, v91
  v_exp_f32 v94, v94
  v_exp_f32 v95, v95
  v_cvt_pk_bf16_f32 v110, v92, v93
  v_cvt_pk_bf16_f32 v111, v94, v95
  v_mfma_f32_32x32x16_bf16 v[128:143], v[48:51], v[104:107], v[128:143]
  v_exp_f32 v64, v64
  v_exp_f32 v65, v65
  v_exp_f32 v66, v66
  v_exp_f32 v67, v67
  v_mfma_f32_32x32x16_bf16 v[128:143], v[52:55], v[108:111], v[128:143]
  v_cvt_pk_bf16_f32 v96, v64, v65
  v_exp_f32 v68, v68
  v_exp_f32 v69, v69
  v_cvt_pk_bf16_f32 v97, v66, v67
  v_exp_f32 v70, v70
  v_mfma_f32_32x32x16_bf16 v[80:95], v[40:43], v[200:203], 0
  v_exp_f32 v71, v71
  v_cvt_pk_bf16_f32 v98, v68, v69
  v_exp_f32 v72, v72
  v_exp_f32 v73, v73
  v_cvt_pk_bf16_f32 v99, v70, v71
  v_mfma_f32_32x32x16_bf16 v[80:95], v[44:47], v[204:207], v[80:95]
  v_exp_f32 v74, v74
  v_exp_f32 v75, v75
  v_cvt_pk_bf16_f32 v100, v72, v73
  v_exp_f32 v76, v76
  v_exp_f32 v77, v77
  v_cvt_pk_bf16_f32 v101, v74, v75
  v_exp_f32 v78, v78
  s_add_u32 m0, s31, 39936
  s_add_u32 s29, s53, s28
  s_add_u32 s29, s29, 7168
  buffer_load_dwordx4 v2, s[8:11], s29 offen sc1 lds
  v_exp_f32 v79, v79
  v_cvt_pk_bf16_f32 v102, v76, v77
  v_cvt_pk_bf16_f32 v103, v78, v79
  s_waitcnt lgkmcnt(0)
  v_mfma_f32_32x32x16_bf16 v[112:127], v[56:59], v[96:99], v[112:127]
  v_exp_f32 v80, v80
  v_exp_f32 v81, v81
  v_exp_f32 v82, v82
  v_exp_f32 v83, v83
  v_mfma_f32_32x32x16_bf16 v[112:127], v[60:63], v[100:103], v[112:127]
  v_cvt_pk_bf16_f32 v104, v80, v81
  v_exp_f32 v84, v84
  v_exp_f32 v85, v85
  v_cvt_pk_bf16_f32 v105, v82, v83
  v_exp_f32 v86, v86
  v_exp_f32 v87, v87
  v_cvt_pk_bf16_f32 v106, v84, v85
  v_exp_f32 v88, v88
  v_exp_f32 v89, v89
  v_cvt_pk_bf16_f32 v107, v86, v87
  v_exp_f32 v90, v90
  v_exp_f32 v91, v91
  v_cvt_pk_bf16_f32 v108, v88, v89
  v_exp_f32 v92, v92
  v_exp_f32 v93, v93
  v_cvt_pk_bf16_f32 v109, v90, v91
  v_exp_f32 v94, v94
  v_exp_f32 v95, v95
  v_cvt_pk_bf16_f32 v110, v92, v93
  v_cvt_pk_bf16_f32 v111, v94, v95
  s_nop 1
  v_mfma_f32_32x32x16_bf16 v[128:143], v[56:59], v[104:107], v[128:143]
  v_mfma_f32_32x32x16_bf16 v[128:143], v[60:63], v[108:111], v[128:143]
  s_cmp_lt_u32 s41, 4
  s_cbranch_scc1 kb1_chunk2
  s_nop 11
  v_mov_b32 v5, v120
  v_mov_b32 v6, v120
  s_nop 1
  v_permlane32_swap_b32 v5, v6
  v_mov_b32 v14, v6
  v_mov_b32 v5, v136
  v_mov_b32 v6, v136
  s_nop 1
  v_permlane32_swap_b32 v5, v6
  v_mov_b32 v15, v6
  s_cmp_eq_u32 s40, 0
  s_cbranch_scc0 kb1_fin
  v_min_f32 v5, v14, v15
  v_cmp_gt_f32 vcc, 0x12800000, v5
  v_cmp_u_f32 s[36:37], v5, v5
  s_nop 1
  s_or_b64 vcc, vcc, s[36:37]
  s_cmp_lg_u64 vcc, 0
  s_cselect_b32 s42, 1, 0
  v_mov_b32 v5, s42
  s_lshl_b32 s30, s21, 2
  s_add_u32 s30, s30, 131584
  v_mov_b32 v6, s30
  ds_write_b32 v6, v5
  s_waitcnt vmcnt(0) lgkmcnt(0)
  s_barrier
  v_mov_b32 v6, 131584
  ds_read_b128 v[8:11], v6
  s_waitcnt lgkmcnt(0)
  v_or_b32 v8, v8, v9
  v_or_b32 v10, v10, v11
  v_or_b32 v8, v8, v10
  s_nop 0
  v_readfirstlane_b32 s42, v8
  s_cmp_eq_u32 s42, 0
  s_cbranch_scc1 kb1_fin
  s_mov_b32 s40, 1
  v_and_b32 v5, 0xffff0000, v198
  v_cndmask_b32 v198, v198, v5, s[34:35]
  v_mov_b32 v12, 0xff7fffff
  v_and_b32 v5, 0xffff0000, v206
  v_cndmask_b32 v206, v206, v5, s[34:35]
  v_mov_b32 v13, 0xff7fffff
  s_mov_b32 s41, 0
kb1_mx:
  s_lshl_b32 s30, s41, 11
  s_add_u32 s30, s30, s27
  buffer_load_dwordx4 v[32:35], v2, s[8:11], s30 offen sc1
  buffer_load_dwordx4 v[36:39], v2, s[8:11], s30 offen offset:1024 sc1
  s_waitcnt vmcnt(0)
  v_mfma_f32_32x32x16_bf16 v[64:79], v[32:35], v[192:195], 0
  v_mfma_f32_32x32x16_bf16 v[64:79], v[36:39], v[196:199], v[64:79]
  v_mfma_f32_32x32x16_bf16 v[80:95], v[32:35], v[200:203], 0
  v_mfma_f32_32x32x16_bf16 v[80:95], v[36:39], v[204:207], v[80:95]
  s_nop 11
  v_max3_f32 v12, v12, v64, v65
  v_max3_f32 v12, v12, v66, v67
  v_max3_f32 v12, v12, v68, v69
  v_max3_f32 v12, v12, v70, v71
  v_max3_f32 v12, v12, v72, v73
  v_max3_f32 v12, v12, v74, v75
  v_max3_f32 v12, v12, v76, v77
  v_max3_f32 v12, v12, v78, v79
  v_max3_f32 v13, v13, v80, v81
  v_max3_f32 v13, v13, v82, v83
  v_max3_f32 v13, v13, v84, v85
  v_max3_f32 v13, v13, v86, v87
  v_max3_f32 v13, v13, v88, v89
  v_max3_f32 v13, v13, v90, v91
  v_max3_f32 v13, v13, v92, v93
  v_max3_f32 v13, v13, v94, v95
  s_add_u32 s41, s41, 1
  s_cmp_lt_u32 s41, 64
  s_cbranch_scc1 kb1_mx
  v_mov_b32 v5, v12
  s_nop 1
  v_permlane32_swap_b32 v12, v5
  v_max_f32 v12, v12, v5
  v_cvt_pk_bf16_f32 v5, v12, v12
  v_and_b32 v5, 0xffff, v5
  v_xor_b32 v5, 0x8000, v5
  v_and_b32 v6, 0xffff0000, v198
  v_or_b32 v5, v5, v6
  v_cndmask_b32 v198, v198, v5, s[34:35]
  v_mov_b32 v5, v13
  s_nop 1
  v_permlane32_swap_b32 v13, v5
  v_max_f32 v13, v13, v5
  v_cvt_pk_bf16_f32 v5, v13, v13
  v_and_b32 v5, 0xffff, v5
  v_xor_b32 v5, 0x8000, v5
  v_and_b32 v6, 0xffff0000, v206
  v_or_b32 v5, v5, v6
  v_cndmask_b32 v206, v206, v5, s[34:35]
  s_barrier
  s_mov_b32 s41, 0
  s_mul_i32 s53, s41, 32768
  s_lshl_b32 s31, s21, 13
  s_add_u32 s53, s53, s31
  s_add_u32 m0, s31, 0
  s_add_u32 s29, s53, s27
  s_add_u32 s29, s29, 0
  buffer_load_dwordx4 v2, s[8:11], s29 offen sc1 lds
  s_add_u32 m0, s31, 1024
  s_add_u32 s29, s53, s27
  s_add_u32 s29, s29, 1024
  buffer_load_dwordx4 v2, s[8:11], s29 offen sc1 lds
  s_add_u32 m0, s31, 2048
  s_add_u32 s29, s53, s27
  s_add_u32 s29, s29, 2048
  buffer_load_dwordx4 v2, s[8:11], s29 offen sc1 lds
  s_add_u32 m0, s31, 3072
  s_add_u32 s29, s53, s27
  s_add_u32 s29, s29, 3072
  buffer_load_dwordx4 v2, s[8:11], s29 offen sc1 lds
  s_add_u32 m0, s31, 4096
  s_add_u32 s29, s53, s27
  s_add_u32 s29, s29, 4096
  buffer_load_dwordx4 v2, s[8:11], s29 offen sc1 lds
  s_add_u32 m0, s31, 5120
  s_add_u32 s29, s53, s27
  s_add_u32 s29, s29, 5120
  buffer_load_dwordx4 v2, s[8:11], s29 offen sc1 lds
  s_add_u32 m0, s31, 6144
  s_add_u32 s29, s53, s27
  s_add_u32 s29, s29, 6144
  buffer_load_dwordx4 v2, s[8:11], s29 offen sc1 lds
  s_add_u32 m0, s31, 7168
  s_add_u32 s29, s53, s27
  s_add_u32 s29, s29, 7168
  buffer_load_dwordx4 v2, s[8:11], s29 offen sc1 lds
  s_add_u32 m0, s31, 32768
  s_add_u32 s29, s53, s28
  s_add_u32 s29, s29, 0
  buffer_load_dwordx4 v2, s[8:11], s29 offen sc1 lds
  s_add_u32 m0, s31, 33792
  s_add_u32 s29, s53, s28
  s_add_u32 s29, s29, 1024
  buffer_load_dwordx4 v2, s[8:11], s29 offen sc1 lds
  s_add_u32 m0, s31, 34816
  s_add_u32 s29, s53, s28
  s_add_u32 s29, s29, 2048
  buffer_load_dwordx4 v2, s[8:11], s29 offen sc1 lds
  s_add_u32 m0, s31, 35840
  s_add_u32 s29, s53, s28
  s_add_u32 s29, s29, 3072
  buffer_load_dwordx4 v2, s[8:11], s29 offen sc1 lds
  s_add_u32 m0, s31, 36864
  s_add_u32 s29, s53, s28
  s_add_u32 s29, s29, 4096
  buffer_load_dwordx4 v2, s[8:11], s29 offen sc1 lds
  s_add_u32 m0, s31, 37888
  s_add_u32 s29, s53, s28
  s_add_u32 s29, s29, 5120
  buffer_load_dwordx4 v2, s[8:11], s29 offen sc1 lds
  s_add_u32 m0, s31, 38912
  s_add_u32 s29, s53, s28
  s_add_u32 s29, s29, 6144
  buffer_load_dwordx4 v2, s[8:11], s29 offen sc1 lds
  s_add_u32 m0, s31, 39936
  s_add_u32 s29, s53, s28
  s_add_u32 s29, s29, 7168
  buffer_load_dwordx4 v2, s[8:11], s29 offen sc1 lds
  s_branch kb1_main2
kb1_fin:
  v_and_b32 v3, 15, v1
  v_bfe_u32 v11, v1, 4, 1
  v_mul_u32_u24 v11, 20480, v11
  v_lshrrev_b32 v4, 5, v1
  s_mul_i32 s30, s22, 20
  v_lshlrev_b32 v5, 2, v4
  v_add_u32 v5, 0, v5
  v_add_u32 v5, s30, v5
  v_lshrrev_b32 v6, 5, v5
  v_lshlrev_b32 v6, 10, v6
  v_bfe_u32 v7, v5, 3, 2
  v_lshlrev_b32 v7, 4, v7
  v_add_u32 v7, v7, v3
  v_lshlrev_b32 v7, 4, v7
  v_add_u32 v6, v6, v7
  v_bfe_u32 v7, v5, 2, 1
  v_lshlrev_b32 v7, 3, v7
  v_add_u32 v6, v6, v7
  v_add_u32 v32, v6, v11
  v_lshlrev_b32 v5, 2, v4
  v_add_u32 v5, 8, v5
  v_add_u32 v5, s30, v5
  v_lshrrev_b32 v6, 5, v5
  v_lshlrev_b32 v6, 10, v6
  v_bfe_u32 v7, v5, 3, 2
  v_lshlrev_b32 v7, 4, v7
  v_add_u32 v7, v7, v3
  v_lshlrev_b32 v7, 4, v7
  v_add_u32 v6, v6, v7
  v_bfe_u32 v7, v5, 2, 1
  v_lshlrev_b32 v7, 3, v7
  v_add_u32 v6, v6, v7
  v_add_u32 v33, v6, v11
  v_lshlrev_b32 v5, 2, v4
  v_add_u32 v5, 16, v5
  v_add_u32 v5, s30, v5
  v_lshrrev_b32 v6, 5, v5
  v_lshlrev_b32 v6, 10, v6
  v_bfe_u32 v7, v5, 3, 2
  v_lshlrev_b32 v7, 4, v7
  v_add_u32 v7, v7, v3
  v_lshlrev_b32 v7, 4, v7
  v_add_u32 v6, v6, v7
  v_bfe_u32 v7, v5, 2, 1
  v_lshlrev_b32 v7, 3, v7
  v_add_u32 v6, v6, v7
  v_add_u32 v34, v6, v11
  v_mov_b32 v5, 0x40000000
  v_cndmask_b32 v34, v5, v34, s[34:35]
  v_rcp_f32 v5, v14
  s_nop 0
  v_mul_f32 v112, v112, v5
  v_mul_f32 v113, v113, v5
  v_mul_f32 v114, v114, v5
  v_mul_f32 v115, v115, v5
  v_mul_f32 v116, v116, v5
  v_mul_f32 v117, v117, v5
  v_mul_f32 v118, v118, v5
  v_mul_f32 v119, v119, v5
  v_mul_f32 v120, v120, v5
  v_mul_f32 v121, v121, v5
  v_mul_f32 v122, v122, v5
  v_mul_f32 v123, v123, v5
  v_cvt_pk_bf16_f32 v40, v112, v113
  v_cvt_pk_bf16_f32 v41, v114, v115
  v_cvt_pk_bf16_f32 v42, v116, v117
  v_cvt_pk_bf16_f32 v43, v118, v119
  v_cvt_pk_bf16_f32 v44, v120, v121
  v_cvt_pk_bf16_f32 v45, v122, v123
  s_add_u32 s31, s52, 0
  s_mul_i32 s31, s31, 40960
  s_add_u32 s31, s31, 0xf200000
  buffer_store_dwordx2 v[40:41], v32, s[8:11], s31 offen sc1
  buffer_store_dwordx2 v[42:43], v33, s[8:11], s31 offen sc1
  buffer_store_dwordx2 v[44:45], v34, s[8:11], s31 offen sc1
  v_rcp_f32 v5, v15
  s_nop 0
  v_mul_f32 v128, v128, v5
  v_mul_f32 v129, v129, v5
  v_mul_f32 v130, v130, v5
  v_mul_f32 v131, v131, v5
  v_mul_f32 v132, v132, v5
  v_mul_f32 v133, v133, v5
  v_mul_f32 v134, v134, v5
  v_mul_f32 v135, v135, v5
  v_mul_f32 v136, v136, v5
  v_mul_f32 v137, v137, v5
  v_mul_f32 v138, v138, v5
  v_mul_f32 v139, v139, v5
  v_cvt_pk_bf16_f32 v48, v128, v129
  v_cvt_pk_bf16_f32 v49, v130, v131
  v_cvt_pk_bf16_f32 v50, v132, v133
  v_cvt_pk_bf16_f32 v51, v134, v135
  v_cvt_pk_bf16_f32 v52, v136, v137
  v_cvt_pk_bf16_f32 v53, v138, v139
  s_add_u32 s31, s52, 1
  s_mul_i32 s31, s31, 40960
  s_add_u32 s31, s31, 0xf200000
  buffer_store_dwordx2 v[48:49], v32, s[8:11], s31 offen sc1
  buffer_store_dwordx2 v[50:51], v33, s[8:11], s31 offen sc1
  buffer_store_dwordx2 v[52:53], v34, s[8:11], s31 offen sc1
  s_waitcnt vmcnt(0)
  s_barrier
  s_cmp_eq_u32 s21, 0
  s_cbranch_scc0 arr_45
  s_mov_b64 s[24:25], exec
  s_mov_b64 exec, 1
  v_mov_b32 v3, 0
  v_mov_b32 v4, 1
  buffer_atomic_add v4, v3, s[8:11], s48 offen
  s_mov_b64 exec, s[24:25]
arr_45:
  v_and_b32 v5, 15, v1
  v_lshrrev_b32 v6, 4, v1
  v_and_b32 v7, 1, v6
  v_lshlrev_b32 v7, 10, v7
  v_lshrrev_b32 v8, 1, v6
  v_lshlrev_b32 v8, 5, v8
  v_add_u32 v8, v8, v5
  v_lshlrev_b32 v8, 4, v8
  v_add_u32 v9, v7, v8
  s_lshr_b32 s26, s2, 2
  s_mul_i32 s27, s26, 81920
  s_lshl_b32 s28, s50, 11
  s_add_u32 s27, s27, s28
  s_add_u32 s27, s27, 0x1400000
  s_add_u32 s28, s27, 0
  buffer_load_dwordx4 v[16:19], v9, s[8:11], s28 offen sc1
  s_add_u32 s28, s27, 256
  buffer_load_dwordx4 v[20:23], v9, s[8:11], s28 offen sc1
  s_add_u32 s28, s27, 2048
  buffer_load_dwordx4 v[24:27], v9, s[8:11], s28 offen sc1
  s_add_u32 s28, s27, 2304
  buffer_load_dwordx4 v[28:31], v9, s[8:11], s28 offen sc1
  s_cmp_lt_u32 s21, 2
  s_cbranch_scc0 g3_46
  s_add_u32 s28, s27, 4096
  buffer_load_dwordx4 v[32:35], v9, s[8:11], s28 offen sc1
  s_add_u32 s28, s27, 4352
  buffer_load_dwordx4 v[36:39], v9, s[8:11], s28 offen sc1
g3_46:
  s_mov_b32 s45, 0
  v_mov_b32 v3, 0
aw_47:
  buffer_load_dword v4, v3, s[8:11], s48 offen sc1
  s_add_u32 s45, s45, 1
  s_waitcnt vmcnt(0)
  v_readfirstlane_b32 s29, v4
  s_cmp_ge_u32 s29, 32
  s_cbranch_scc1 aw_47_ok
  s_cmp_lt_u32 s45, 400000
  s_cbranch_scc1 aw_47
  s_branch kb1_abort
aw_47_ok:
  s_mul_i32 s28, s26, 40960
  s_mul_i32 s31, s21, 10240
  s_add_u32 s28, s28, s31
  s_add_u32 s28, s28, 0xf200000
  s_add_u32 m0, s31, 0
  s_add_u32 s29, s28, 0
  buffer_load_dwordx4 v2, s[8:11], s29 offen sc1 lds
  s_add_u32 m0, s31, 1024
  s_add_u32 s29, s28, 1024
  buffer_load_dwordx4 v2, s[8:11], s29 offen sc1 lds
  s_add_u32 m0, s31, 2048
  s_add_u32 s29, s28, 2048
  buffer_load_dwordx4 v2, s[8:11], s29 offen sc1 lds
  s_add_u32 m0, s31, 3072
  s_add_u32 s29, s28, 3072
  buffer_load_dwordx4 v2, s[8:11], s29 offen sc1 lds
  s_add_u32 m0, s31, 4096
  s_add_u32 s29, s28, 4096
  buffer_load_dwordx4 v2, s[8:11], s29 offen sc1 lds
  s_add_u32 m0, s31, 5120
  s_add_u32 s29, s28, 5120
  buffer_load_dwordx4 v2, s[8:11], s29 offen sc1 lds
  s_add_u32 m0, s31, 6144
  s_add_u32 s29, s28, 6144
  buffer_load_dwordx4 v2, s[8:11], s29 offen sc1 lds
  s_add_u32 m0, s31, 7168
  s_add_u32 s29, s28, 7168
  buffer_load_dwordx4 v2, s[8:11], s29 offen sc1 lds
  s_add_u32 m0, s31, 8192
  s_add_u32 s29, s28, 8192
  buffer_load_dwordx4 v2, s[8:11], s29 offen sc1 lds
  s_add_u32 m0, s31, 9216
  s_add_u32 s29, s28, 9216
  buffer_load_dwordx4 v2, s[8:11], s29 offen sc1 lds
  s_waitcnt vmcnt(0)
  s_barrier
  ds_read_b128 v[80:83], v2 offset:0
  ds_read_b128 v[84:87], v2 offset:20480
  ds_read_b128 v[88:91], v2 offset:1024
  ds_read_b128 v[92:95], v2 offset:21504
  ds_read_b128 v[96:99], v2 offset:2048
  ds_read_b128 v[100:103], v2 offset:22528
  s_waitcnt lgkmcnt(4)
  v_mfma_f32_16x16x32_bf16 v[48:51], a[0:3], v[80:83], 0
  v_mfma_f32_16x16x32_bf16 v[52:55], a[0:3], v[84:87], 0
  v_mfma_f32_16x16x32_bf16 v[56:59], a[80:83], v[80:83], 0
  v_mfma_f32_16x16x32_bf16 v[60:63], a[80:83], v[84:87], 0
  v_mfma_f32_16x16x32_bf16 v[64:67], a[160:163], v[80:83], 0
  v_mfma_f32_16x16x32_bf16 v[68:71], a[160:163], v[84:87], 0
  ds_read_b128 v[80:83], v2 offset:3072
  ds_read_b128 v[84:87], v2 offset:23552
  s_waitcnt lgkmcnt(4)
  v_mfma_f32_16x16x32_bf16 v[48:51], a[4:7], v[88:91], v[48:51]
  v_mfma_f32_16x16x32_bf16 v[52:55], a[4:7], v[92:95], v[52:55]
  v_mfma_f32_16x16x32_bf16 v[56:59], a[84:87], v[88:91], v[56:59]
  v_mfma_f32_16x16x32_bf16 v[60:63], a[84:87], v[92:95], v[60:63]
  v_mfma_f32_16x16x32_bf16 v[64:67], a[164:167], v[88:91], v[64:67]
  v_mfma_f32_16x16x32_bf16 v[68:71], a[164:167], v[92:95], v[68:71]
  ds_read_b128 v[88:91], v2 offset:4096
  ds_read_b128 v[92:95], v2 offset:24576
  s_waitcnt lgkmcnt(4)
  v_mfma_f32_16x16x32_bf16 v[48:51], a[8:11], v[96:99], v[48:51]
  v_mfma_f32_16x16x32_bf16 v[52:55], a[8:11], v[100:103], v[52:55]
  v_mfma_f32_16x16x32_bf16 v[56:59], a[88:91], v[96:99], v[56:59]
  v_mfma_f32_16x16x32_bf16 v[60:63], a[88:91], v[100:103], v[60:63]
  v_mfma_f32_16x16x32_bf16 v[64:67], a[168:171], v[96:99], v[64:67]
  v_mfma_f32_16x16x32_bf16 v[68:71], a[168:171], v[100:103], v[68:71]
  ds_read_b128 v[96:99], v2 offset:5120
  ds_read_b128 v[100:103], v2 offset:25600
  s_waitcnt lgkmcnt(4)
  v_mfma_f32_16x16x32_bf16 v[48:51], a[12:15], v[80:83], v[48:51]
  v_mfma_f32_16x16x32_bf16 v[52:55], a[12:15], v[84:87], v[52:55]
  v_mfma_f32_16x16x32_bf16 v[56:59], a[92:95], v[80:83], v[56:59]
  v_mfma_f32_16x16x32_bf16 v[60:63], a[92:95], v[84:87], v[60:63]
  v_mfma_f32_16x16x32_bf16 v[64:67], a[172:175], v[80:83], v[64:67]
  v_mfma_f32_16x16x32_bf16 v[68:71], a[172:175], v[84:87], v[68:71]
  ds_read_b128 v[80:83], v2 offset:6144
  ds_read_b128 v[84:87], v2 offset:26624
  s_waitcnt lgkmcnt(4)
  v_mfma_f32_16x16x32_bf16 v[48:51], a[16:19], v[88:91], v[48:51]
  v_mfma_f32_16x16x32_bf16 v[52:55], a[16:19], v[92:95], v[52:55]
  v_mfma_f32_16x16x32_bf16 v[56:59], a[96:99], v[88:91], v[56:59]
  v_mfma_f32_16x16x32_bf16 v[60:63], a[96:99], v[92:95], v[60:63]
  v_mfma_f32_16x16x32_bf16 v[64:67], a[176:179], v[88:91], v[64:67]
  v_mfma_f32_16x16x32_bf16 v[68:71], a[176:179], v[92:95], v[68:71]
  ds_read_b128 v[88:91], v2 offset:7168
  ds_read_b128 v[92:95], v2 offset:27648
  s_waitcnt lgkmcnt(4)
  v_mfma_f32_16x16x32_bf16 v[48:51], a[20:23], v[96:99], v[48:51]
  v_mfma_f32_16x16x32_bf16 v[52:55], a[20:23], v[100:103], v[52:55]
  v_mfma_f32_16x16x32_bf16 v[56:59], a[100:103], v[96:99], v[56:59]
  v_mfma_f32_16x16x32_bf16 v[60:63], a[100:103], v[100:103], v[60:63]
  v_mfma_f32_16x16x32_bf16 v[64:67], a[180:183], v[96:99], v[64:67]
  v_mfma_f32_16x16x32_bf16 v[68:71], a[180:183], v[100:103], v[68:71]
  ds_read_b128 v[96:99], v2 offset:8192
  ds_read_b128 v[100:103], v2 offset:28672
  s_waitcnt lgkmcnt(4)
  v_mfma_f32_16x16x32_bf16 v[48:51], a[24:27], v[80:83], v[48:51]
  v_mfma_f32_16x16x32_bf16 v[52:55], a[24:27], v[84:87], v[52:55]
  v_mfma_f32_16x16x32_bf16 v[56:59], a[104:107], v[80:83], v[56:59]
  v_mfma_f32_16x16x32_bf16 v[60:63], a[104:107], v[84:87], v[60:63]
  v_mfma_f32_16x16x32_bf16 v[64:67], a[184:187], v[80:83], v[64:67]
  v_mfma_f32_16x16x32_bf16 v[68:71], a[184:187], v[84:87], v[68:71]
  ds_read_b128 v[80:83], v2 offset:9216
  ds_read_b128 v[84:87], v2 offset:29696
  s_waitcnt lgkmcnt(4)
  v_mfma_f32_16x16x32_bf16 v[48:51], a[28:31], v[88:91], v[48:51]
  v_mfma_f32_16x16x32_bf16 v[52:55], a[28:31], v[92:95], v[52:55]
  v_mfma_f32_16x16x32_bf16 v[56:59], a[108:111], v[88:91], v[56:59]
  v_mfma_f32_16x16x32_bf16 v[60:63], a[108:111], v[92:95], v[60:63]
  v_mfma_f32_16x16x32_bf16 v[64:67], a[188:191], v[88:91], v[64:67]
  v_mfma_f32_16x16x32_bf16 v[68:71], a[188:191], v[92:95], v[68:71]
  ds_read_b128 v[88:91], v2 offset:10240
  ds_read_b128 v[92:95], v2 offset:30720
  s_waitcnt lgkmcnt(4)
  v_mfma_f32_16x16x32_bf16 v[48:51], a[32:35], v[96:99], v[48:51]
  v_mfma_f32_16x16x32_bf16 v[52:55], a[32:35], v[100:103], v[52:55]
  v_mfma_f32_16x16x32_bf16 v[56:59], a[112:115], v[96:99], v[56:59]
  v_mfma_f32_16x16x32_bf16 v[60:63], a[112:115], v[100:103], v[60:63]
  v_mfma_f32_16x16x32_bf16 v[64:67], a[192:195], v[96:99], v[64:67]
  v_mfma_f32_16x16x32_bf16 v[68:71], a[192:195], v[100:103], v[68:71]
  ds_read_b128 v[96:99], v2 offset:11264
  ds_read_b128 v[100:103], v2 offset:31744
  s_waitcnt lgkmcnt(4)
  v_mfma_f32_16x16x32_bf16 v[48:51], a[36:39], v[80:83], v[48:51]
  v_mfma_f32_16x16x32_bf16 v[52:55], a[36:39], v[84:87], v[52:55]
  v_mfma_f32_16x16x32_bf16 v[56:59], a[116:119], v[80:83], v[56:59]
  v_mfma_f32_16x16x32_bf16 v[60:63], a[116:119], v[84:87], v[60:63]
  v_mfma_f32_16x16x32_bf16 v[64:67], a[196:199], v[80:83], v[64:67]
  v_mfma_f32_16x16x32_bf16 v[68:71], a[196:199], v[84:87], v[68:71]
  ds_read_b128 v[80:83], v2 offset:12288
  ds_read_b128 v[84:87], v2 offset:32768
  s_waitcnt lgkmcnt(4)
  v_mfma_f32_16x16x32_bf16 v[48:51], a[40:43], v[88:91], v[48:51]
  v_mfma_f32_16x16x32_bf16 v[52:55], a[40:43], v[92:95], v[52:55]
  v_mfma_f32_16x16x32_bf16 v[56:59], a[120:123], v[88:91], v[56:59]
  v_mfma_f32_16x16x32_bf16 v[60:63], a[120:123], v[92:95], v[60:63]
  v_mfma_f32_16x16x32_bf16 v[64:67], a[200:203], v[88:91], v[64:67]
  v_mfma_f32_16x16x32_bf16 v[68:71], a[200:203], v[92:95], v[68:71]
  ds_read_b128 v[88:91], v2 offset:13312
  ds_read_b128 v[92:95], v2 offset:33792
  s_waitcnt lgkmcnt(4)
  v_mfma_f32_16x16x32_bf16 v[48:51], a[44:47], v[96:99], v[48:51]
  v_mfma_f32_16x16x32_bf16 v[52:55], a[44:47], v[100:103], v[52:55]
  v_mfma_f32_16x16x32_bf16 v[56:59], a[124:127], v[96:99], v[56:59]
  v_mfma_f32_16x16x32_bf16 v[60:63], a[124:127], v[100:103], v[60:63]
  v_mfma_f32_16x16x32_bf16 v[64:67], a[204:207], v[96:99], v[64:67]
  v_mfma_f32_16x16x32_bf16 v[68:71], a[204:207], v[100:103], v[68:71]
  ds_read_b128 v[96:99], v2 offset:14336
  ds_read_b128 v[100:103], v2 offset:34816
  s_waitcnt lgkmcnt(4)
  v_mfma_f32_16x16x32_bf16 v[48:51], a[48:51], v[80:83], v[48:51]
  v_mfma_f32_16x16x32_bf16 v[52:55], a[48:51], v[84:87], v[52:55]
  v_mfma_f32_16x16x32_bf16 v[56:59], a[128:131], v[80:83], v[56:59]
  v_mfma_f32_16x16x32_bf16 v[60:63], a[128:131], v[84:87], v[60:63]
  v_mfma_f32_16x16x32_bf16 v[64:67], a[208:211], v[80:83], v[64:67]
  v_mfma_f32_16x16x32_bf16 v[68:71], a[208:211], v[84:87], v[68:71]
  ds_read_b128 v[80:83], v2 offset:15360
  ds_read_b128 v[84:87], v2 offset:35840
  s_waitcnt lgkmcnt(4)
  v_mfma_f32_16x16x32_bf16 v[48:51], a[52:55], v[88:91], v[48:51]
  v_mfma_f32_16x16x32_bf16 v[52:55], a[52:55], v[92:95], v[52:55]
  v_mfma_f32_16x16x32_bf16 v[56:59], a[132:135], v[88:91], v[56:59]
  v_mfma_f32_16x16x32_bf16 v[60:63], a[132:135], v[92:95], v[60:63]
  v_mfma_f32_16x16x32_bf16 v[64:67], a[212:215], v[88:91], v[64:67]
  v_mfma_f32_16x16x32_bf16 v[68:71], a[212:215], v[92:95], v[68:71]
  ds_read_b128 v[88:91], v2 offset:16384
  ds_read_b128 v[92:95], v2 offset:36864
  s_waitcnt lgkmcnt(4)
  v_mfma_f32_16x16x32_bf16 v[48:51], a[56:59], v[96:99], v[48:51]
  v_mfma_f32_16x16x32_bf16 v[52:55], a[56:59], v[100:103], v[52:55]
  v_mfma_f32_16x16x32_bf16 v[56:59], a[136:139], v[96:99], v[56:59]
  v_mfma_f32_16x16x32_bf16 v[60:63], a[136:139], v[100:103], v[60:63]
  v_mfma_f32_16x16x32_bf16 v[64:67], a[216:219], v[96:99], v[64:67]
  v_mfma_f32_16x16x32_bf16 v[68:71], a[216:219], v[100:103], v[68:71]
  ds_read_b128 v[96:99], v2 offset:17408
  ds_read_b128 v[100:103], v2 offset:37888
  s_waitcnt lgkmcnt(4)
  v_mfma_f32_16x16x32_bf16 v[48:51], a[60:63], v[80:83], v[48:51]
  v_mfma_f32_16x16x32_bf16 v[52:55], a[60:63], v[84:87], v[52:55]
  v_mfma_f32_16x16x32_bf16 v[56:59], a[140:143], v[80:83], v[56:59]
  v_mfma_f32_16x16x32_bf16 v[60:63], a[140:143], v[84:87], v[60:63]
  v_mfma_f32_16x16x32_bf16 v[64:67], a[220:223], v[80:83], v[64:67]
  v_mfma_f32_16x16x32_bf16 v[68:71], a[220:223], v[84:87], v[68:71]
  ds_read_b128 v[80:83], v2 offset:18432
  ds_read_b128 v[84:87], v2 offset:38912
  s_waitcnt lgkmcnt(4)
  v_mfma_f32_16x16x32_bf16 v[48:51], a[64:67], v[88:91], v[48:51]
  v_mfma_f32_16x16x32_bf16 v[52:55], a[64:67], v[92:95], v[52:55]
  v_mfma_f32_16x16x32_bf16 v[56:59], a[144:147], v[88:91], v[56:59]
  v_mfma_f32_16x16x32_bf16 v[60:63], a[144:147], v[92:95], v[60:63]
  v_mfma_f32_16x16x32_bf16 v[64:67], a[224:227], v[88:91], v[64:67]
  v_mfma_f32_16x16x32_bf16 v[68:71], a[224:227], v[92:95], v[68:71]
  ds_read_b128 v[88:91], v2 offset:19456
  ds_read_b128 v[92:95], v2 offset:39936
  s_waitcnt lgkmcnt(4)
  v_mfma_f32_16x16x32_bf16 v[48:51], a[68:71], v[96:99], v[48:51]
  v_mfma_f32_16x16x32_bf16 v[52:55], a[68:71], v[100:103], v[52:55]
  v_mfma_f32_16x16x32_bf16 v[56:59], a[148:151], v[96:99], v[56:59]
  v_mfma_f32_16x16x32_bf16 v[60:63], a[148:151], v[100:103], v[60:63]
  v_mfma_f32_16x16x32_bf16 v[64:67], a[228:231], v[96:99], v[64:67]
  v_mfma_f32_16x16x32_bf16 v[68:71], a[228:231], v[100:103], v[68:71]
  s_waitcnt lgkmcnt(2)
  v_mfma_f32_16x16x32_bf16 v[48:51], a[72:75], v[80:83], v[48:51]
  v_mfma_f32_16x16x32_bf16 v[52:55], a[72:75], v[84:87], v[52:55]
  v_mfma_f32_16x16x32_bf16 v[56:59], a[152:155], v[80:83], v[56:59]
  v_mfma_f32_16x16x32_bf16 v[60:63], a[152:155], v[84:87], v[60:63]
  v_mfma_f32_16x16x32_bf16 v[64:67], a[232:235], v[80:83], v[64:67]
  v_mfma_f32_16x16x32_bf16 v[68:71], a[232:235], v[84:87], v[68:71]
  s_waitcnt lgkmcnt(0)
  v_mfma_f32_16x16x32_bf16 v[48:51], a[76:79], v[88:91], v[48:51]
  v_mfma_f32_16x16x32_bf16 v[52:55], a[76:79], v[92:95], v[52:55]
  v_mfma_f32_16x16x32_bf16 v[56:59], a[156:159], v[88:91], v[56:59]
  v_mfma_f32_16x16x32_bf16 v[60:63], a[156:159], v[92:95], v[60:63]
  v_mfma_f32_16x16x32_bf16 v[64:67], a[236:239], v[88:91], v[64:67]
  v_mfma_f32_16x16x32_bf16 v[68:71], a[236:239], v[92:95], v[68:71]
  s_nop 7
  v_add_f32 v48, v48, v16
  v_add_f32 v49, v49, v17
  v_add_f32 v50, v50, v18
  v_add_f32 v51, v51, v19
  s_add_u32 s28, s27, 0
  buffer_store_dwordx4 v[48:51], v9, s[8:11], s28 offen
  v_add_f32 v52, v52, v20
  v_add_f32 v53, v53, v21
  v_add_f32 v54, v54, v22
  v_add_f32 v55, v55, v23
  s_add_u32 s28, s27, 256
  buffer_store_dwordx4 v[52:55], v9, s[8:11], s28 offen
  v_add_f32 v56, v56, v24
  v_add_f32 v57, v57, v25
  v_add_f32 v58, v58, v26
  v_add_f32 v59, v59, v27
  s_add_u32 s28, s27, 2048
  buffer_store_dwordx4 v[56:59], v9, s[8:11], s28 offen
  v_add_f32 v60, v60, v28
  v_add_f32 v61, v61, v29
  v_add_f32 v62, v62, v30
  v_add_f32 v63, v63, v31
  s_add_u32 s28, s27, 2304
  buffer_store_dwordx4 v[60:63], v9, s[8:11], s28 offen
  s_cmp_lt_u32 s21, 2
  s_cbranch_scc0 g3_48
  v_add_f32 v64, v64, v32
  v_add_f32 v65, v65, v33
  v_add_f32 v66, v66, v34
  v_add_f32 v67, v67, v35
  s_add_u32 s28, s27, 4096
  buffer_store_dwordx4 v[64:67], v9, s[8:11], s28 offen
  v_add_f32 v68, v68, v36
  v_add_f32 v69, v69, v37
  v_add_f32 v70, v70, v38
  v_add_f32 v71, v71, v39
  s_add_u32 s28, s27, 4352
  buffer_store_dwordx4 v[68:71], v9, s[8:11], s28 offen
g3_48:
  s_endpgm
kb1_abort:
  s_load_dwordx2 s[6:7], s[0:1], 88
  v_mov_b32 v2, 80
  v_mov_b32 v3, 1
  s_waitcnt lgkmcnt(0)
  s_mov_b64 exec, 1
  global_atomic_add v2, v3, s[6:7]
  s_waitcnt vmcnt(0)
kb1_exit:
  s_endpgm

.section .rodata,"a"
.p2align 6
.amdhsa_kernel kb1_kernel
  .amdhsa_next_free_vgpr 512
  .amdhsa_next_free_sgpr 102
  .amdhsa_accum_offset 256
  .amdhsa_group_segment_fixed_size 0
  .amdhsa_kernarg_size 104
  .amdhsa_user_sgpr_count 2
  .amdhsa_user_sgpr_kernarg_segment_ptr 1
  .amdhsa_system_sgpr_workgroup_id_x 1
.end_amdhsa_kernel
.text
.globl ka2_kernel
.p2align 8
.type ka2_kernel,@function
ka2_kernel:
  s_mov_b32 s99, 1
ka_body:
  s_cmp_ge_u32 s2, 256
  s_cbranch_scc1 ka_exit

  s_load_dwordx2 s[4:5], s[0:1], 96
  s_load_dwordx2 s[6:7], s[0:1], 88
  s_load_dwordx4 s[36:39], s[0:1], 16
  s_load_dwordx4 s[40:43], s[0:1], 32
  s_getreg_b32 s26, hwreg(HW_REG_XCC_ID)
  s_and_b32 s26, s26, 15
  v_lshrrev_b32 v1, 6, v0
  s_nop 0
  v_readfirstlane_b32 s21, v1
  s_waitcnt lgkmcnt(0)
  s_mov_b32 s8, s4
  s_and_b32 s9, s5, 0xffff
  s_mov_b32 s10, 0x10000000
  s_mov_b32 s11, 0x20000
  s_cmp_eq_u32 s21, 3
  s_cbranch_scc0 lnu_49_x
  v_and_b32 v1, 63, v0
  v_and_b32 v5, 7, v1
  v_bfe_u32 v6, v1, 3, 1
  v_lshrrev_b32 v7, 4, v1
  v_lshlrev_b32 v8, 5, v6
  v_add_u32 v8, v8, v5
  v_lshlrev_b32 v8, 4, v8
  v_lshlrev_b32 v10, 10, v7
  v_add_u32 v10, v10, v8
  s_lshr_b32 s46, s2, 2
  s_and_b32 s47, s2, 3
  s_lshl_b32 s47, s47, 7
  s_cmp_eq_u32 s99, 1
  s_cbranch_scc0 lnu_49_b
  v_lshlrev_b32 v9, 11, v7
  v_add_u32 v9, v9, v8
  s_mul_i32 s48, s46, 81920
  s_add_u32 s48, s48, s47
  s_add_u32 s48, s48, 0x1400000
  s_add_u32 s49, s48, 0
  buffer_load_dwordx4 v[16:19], v9, s[8:11], s49 offen
  s_add_u32 s49, s48, 1024
  buffer_load_dwordx4 v[20:23], v9, s[8:11], s49 offen
  s_add_u32 s49, s48, 8192
  buffer_load_dwordx4 v[24:27], v9, s[8:11], s49 offen
  s_add_u32 s49, s48, 9216
  buffer_load_dwordx4 v[28:31], v9, s[8:11], s49 offen
  s_add_u32 s49, s48, 16384
  buffer_load_dwordx4 v[32:35], v9, s[8:11], s49 offen
  s_add_u32 s49, s48, 17408
  buffer_load_dwordx4 v[36:39], v9, s[8:11], s49 offen
  s_add_u32 s49, s48, 24576
  buffer_load_dwordx4 v[40:43], v9, s[8:11], s49 offen
  s_add_u32 s49, s48, 25600
  buffer_load_dwordx4 v[44:47], v9, s[8:11], s49 offen
  s_add_u32 s49, s48, 32768
  buffer_load_dwordx4 v[48:51], v9, s[8:11], s49 offen
  s_add_u32 s49, s48, 33792
  buffer_load_dwordx4 v[52:55], v9, s[8:11], s49 offen
  s_add_u32 s49, s48, 40960
  buffer_load_dwordx4 v[56:59], v9, s[8:11], s49 offen
  s_add_u32 s49, s48, 41984
  buffer_load_dwordx4 v[60:63], v9, s[8:11], s49 offen
  s_add_u32 s49, s48, 49152
  buffer_load_dwordx4 v[64:67], v9, s[8:11], s49 offen
  s_add_u32 s49, s48, 50176
  buffer_load_dwordx4 v[68:71], v9, s[8:11], s49 offen
  s_add_u32 s49, s48, 57344
  buffer_load_dwordx4 v[72:75], v9, s[8:11], s49 offen
  s_add_u32 s49, s48, 58368
  buffer_load_dwordx4 v[76:79], v9, s[8:11], s49 offen
  s_add_u32 s49, s48, 65536
  buffer_load_dwordx4 v[80:83], v9, s[8:11], s49 offen
  s_add_u32 s49, s48, 66560
  buffer_load_dwordx4 v[84:87], v9, s[8:11], s49 offen
  s_add_u32 s49, s48, 73728
  buffer_load_dwordx4 v[88:91], v9, s[8:11], s49 offen
  s_add_u32 s49, s48, 74752
  buffer_load_dwordx4 v[92:95], v9, s[8:11], s49 offen
  s_waitcnt vmcnt(0)
  s_branch lnu_49_f
lnu_49_b:
  s_load_dwordx2 s[48:49], s[0:1], 0
  v_mul_u32_u24 v11, 1280, v5
  v_lshlrev_b32 v12, 5, v7
  v_add_u32 v11, v11, v12
  v_lshlrev_b32 v12, 4, v6
  v_add_u32 v11, v11, v12
  s_waitcnt lgkmcnt(0)
  s_mov_b32 s12, s48
  s_and_b32 s13, s49, 0xffff
  s_mov_b32 s14, 0x280000
  s_mov_b32 s15, 0x20000
  s_mul_i32 s49, s2, 10240
  buffer_load_dwordx4 v[56:59], v11, s[12:15], s49 offen offset:0
  buffer_load_dwordx4 v[60:63], v11, s[12:15], s49 offen offset:128
  buffer_load_dwordx4 v[64:67], v11, s[12:15], s49 offen offset:256
  buffer_load_dwordx4 v[68:71], v11, s[12:15], s49 offen offset:384
  buffer_load_dwordx4 v[72:75], v11, s[12:15], s49 offen offset:512
  buffer_load_dwordx4 v[76:79], v11, s[12:15], s49 offen offset:640
  buffer_load_dwordx4 v[80:83], v11, s[12:15], s49 offen offset:768
  buffer_load_dwordx4 v[84:87], v11, s[12:15], s49 offen offset:896
  buffer_load_dwordx4 v[88:91], v11, s[12:15], s49 offen offset:1024
  buffer_load_dwordx4 v[92:95], v11, s[12:15], s49 offen offset:1152
  s_waitcnt vmcnt(0)
  v_mov_b32 v4, v56
  v_lshlrev_b32 v16, 16, v4
  v_and_b32 v17, 0xffff0000, v4
  v_mov_b32 v4, v57
  v_lshlrev_b32 v18, 16, v4
  v_and_b32 v19, 0xffff0000, v4
  v_mov_b32 v4, v58
  v_lshlrev_b32 v20, 16, v4
  v_and_b32 v21, 0xffff0000, v4
  v_mov_b32 v4, v59
  v_lshlrev_b32 v22, 16, v4
  v_and_b32 v23, 0xffff0000, v4
  v_mov_b32 v4, v60
  v_lshlrev_b32 v24, 16, v4
  v_and_b32 v25, 0xffff0000, v4
  v_mov_b32 v4, v61
  v_lshlrev_b32 v26, 16, v4
  v_and_b32 v27, 0xffff0000, v4
  v_mov_b32 v4, v62
  v_lshlrev_b32 v28, 16, v4
  v_and_b32 v29, 0xffff0000, v4
  v_mov_b32 v4, v63
  v_lshlrev_b32 v30, 16, v4
  v_and_b32 v31, 0xffff0000, v4
  v_mov_b32 v4, v64
  v_lshlrev_b32 v32, 16, v4
  v_and_b32 v33, 0xffff0000, v4
  v_mov_b32 v4, v65
  v_lshlrev_b32 v34, 16, v4
  v_and_b32 v35, 0xffff0000, v4
  v_mov_b32 v4, v66
  v_lshlrev_b32 v36, 16, v4
  v_and_b32 v37, 0xffff0000, v4
  v_mov_b32 v4, v67
  v_lshlrev_b32 v38, 16, v4
  v_and_b32 v39, 0xffff0000, v4
  v_mov_b32 v4, v68
  v_lshlrev_b32 v40, 16, v4
  v_and_b32 v41, 0xffff0000, v4
  v_mov_b32 v4, v69
  v_lshlrev_b32 v42, 16, v4
  v_and_b32 v43, 0xffff0000, v4
  v_mov_b32 v4, v70
  v_lshlrev_b32 v44, 16, v4
  v_and_b32 v45, 0xffff0000, v4
  v_mov_b32 v4, v71
  v_lshlrev_b32 v46, 16, v4
  v_and_b32 v47, 0xffff0000, v4
  v_mov_b32 v4, v72
  v_lshlrev_b32 v48, 16, v4
  v_and_b32 v49, 0xffff0000, v4
  v_mov_b32 v4, v73
  v_lshlrev_b32 v50, 16, v4
  v_and_b32 v51, 0xffff0000, v4
  v_mov_b32 v4, v74
  v_lshlrev_b32 v52, 16, v4
  v_and_b32 v53, 0xffff0000, v4
  v_mov_b32 v4, v75
  v_lshlrev_b32 v54, 16, v4
  v_and_b32 v55, 0xffff0000, v4
  v_mov_b32 v4, v76
  v_lshlrev_b32 v56, 16, v4
  v_and_b32 v57, 0xffff0000, v4
  v_mov_b32 v4, v77
  v_lshlrev_b32 v58, 16, v4
  v_and_b32 v59, 0xffff0000, v4
  v_mov_b32 v4, v78
  v_lshlrev_b32 v60, 16, v4
  v_and_b32 v61, 0xffff0000, v4
  v_mov_b32 v4, v79
  v_lshlrev_b32 v62, 16, v4
  v_and_b32 v63, 0xffff0000, v4
  v_mov_b32 v4, v80
  v_lshlrev_b32 v64, 16, v4
  v_and_b32 v65, 0xffff0000, v4
  v_mov_b32 v4, v81
  v_lshlrev_b32 v66, 16, v4
  v_and_b32 v67, 0xffff0000, v4
  v_mov_b32 v4, v82
  v_lshlrev_b32 v68, 16, v4
  v_and_b32 v69, 0xffff0000, v4
  v_mov_b32 v4, v83
  v_lshlrev_b32 v70, 16, v4
  v_and_b32 v71, 0xffff0000, v4
  v_mov_b32 v4, v84
  v_lshlrev_b32 v72, 16, v4
  v_and_b32 v73, 0xffff0000, v4
  v_mov_b32 v4, v85
  v_lshlrev_b32 v74, 16, v4
  v_and_b32 v75, 0xffff0000, v4
  v_mov_b32 v4, v86
  v_lshlrev_b32 v76, 16, v4
  v_and_b32 v77, 0xffff0000, v4
  v_mov_b32 v4, v87
  v_lshlrev_b32 v78, 16, v4
  v_and_b32 v79, 0xffff0000, v4
  v_mov_b32 v4, v88
  v_lshlrev_b32 v80, 16, v4
  v_and_b32 v81, 0xffff0000, v4
  v_mov_b32 v4, v89
  v_lshlrev_b32 v82, 16, v4
  v_and_b32 v83, 0xffff0000, v4
  v_mov_b32 v4, v90
  v_lshlrev_b32 v84, 16, v4
  v_and_b32 v85, 0xffff0000, v4
  v_mov_b32 v4, v91
  v_lshlrev_b32 v86, 16, v4
  v_and_b32 v87, 0xffff0000, v4
  v_mov_b32 v4, v92
  v_lshlrev_b32 v88, 16, v4
  v_and_b32 v89, 0xffff0000, v4
  v_mov_b32 v4, v93
  v_lshlrev_b32 v90, 16, v4
  v_and_b32 v91, 0xffff0000, v4
  v_mov_b32 v4, v94
  v_lshlrev_b32 v92, 16, v4
  v_and_b32 v93, 0xffff0000, v4
  v_mov_b32 v4, v95
  v_lshlrev_b32 v94, 16, v4
  v_and_b32 v95, 0xffff0000, v4
lnu_49_f:
  v_pk_add_f32 v[12:13], v[16:17], v[18:19]
  v_pk_add_f32 v[12:13], v[12:13], v[20:21]
  v_pk_add_f32 v[12:13], v[12:13], v[22:23]
  v_pk_add_f32 v[12:13], v[12:13], v[24:25]
  v_pk_add_f32 v[12:13], v[12:13], v[26:27]
  v_pk_add_f32 v[12:13], v[12:13], v[28:29]
  v_pk_add_f32 v[12:13], v[12:13], v[30:31]
  v_pk_add_f32 v[12:13], v[12:13], v[32:33]
  v_pk_add_f32 v[12:13], v[12:13], v[34:35]
  v_pk_add_f32 v[12:13], v[12:13], v[36:37]
  v_pk_add_f32 v[12:13], v[12:13], v[38:39]
  v_pk_add_f32 v[12:13], v[12:13], v[40:41]
  v_pk_add_f32 v[12:13], v[12:13], v[42:43]
  v_pk_add_f32 v[12:13], v[12:13], v[44:45]
  v_pk_add_f32 v[12:13], v[12:13], v[46:47]
  v_pk_add_f32 v[12:13], v[12:13], v[48:49]
  v_pk_add_f32 v[12:13], v[12:13], v[50:51]
  v_pk_add_f32 v[12:13], v[12:13], v[52:53]
  v_pk_add_f32 v[12:13], v[12:13], v[54:55]
  v_pk_add_f32 v[12:13], v[12:13], v[56:57]
  v_pk_add_f32 v[12:13], v[12:13], v[58:59]
  v_pk_add_f32 v[12:13], v[12:13], v[60:61]
  v_pk_add_f32 v[12:13], v[12:13], v[62:63]
  v_pk_add_f32 v[12:13], v[12:13], v[64:65]
  v_pk_add_f32 v[12:13], v[12:13], v[66:67]
  v_pk_add_f32 v[12:13], v[12:13], v[68:69]
  v_pk_add_f32 v[12:13], v[12:13], v[70:71]
  v_pk_add_f32 v[12:13], v[12:13], v[72:73]
  v_pk_add_f32 v[12:13], v[12:13], v[74:75]
  v_pk_add_f32 v[12:13], v[12:13], v[76:77]
  v_pk_add_f32 v[12:13], v[12:13], v[78:79]
  v_pk_add_f32 v[12:13], v[12:13], v[80:81]
  v_pk_add_f32 v[12:13], v[12:13], v[82:83]
  v_pk_add_f32 v[12:13], v[12:13], v[84:85]
  v_pk_add_f32 v[12:13], v[12:13], v[86:87]
  v_pk_add_f32 v[12:13], v[12:13], v[88:89]
  v_pk_add_f32 v[12:13], v[12:13], v[90:91]
  v_pk_add_f32 v[12:13], v[12:13], v[92:93]
  v_pk_add_f32 v[12:13], v[12:13], v[94:95]
  v_add_f32 v12, v12, v13
  s_nop 1
  v_add_f32_dpp v12, v12, v12 row_ror:8 row_mask:0xf bank_mask:0xf
  v_mov_b32 v13, v12
  s_nop 1
  v_permlane16_swap_b32 v12, v13
  v_add_f32 v12, v12, v13
  v_mov_b32 v13, v12
  s_nop 1
  v_permlane32_swap_b32 v12, v13
  v_add_f32 v12, v12, v13
  v_mul_f32 v12, 0xbacccccd, v12
  v_mov_b32 v13, v12
  v_pk_add_f32 v[16:17], v[16:17], v[12:13]
  v_pk_add_f32 v[18:19], v[18:19], v[12:13]
  v_pk_add_f32 v[20:21], v[20:21], v[12:13]
  v_pk_add_f32 v[22:23], v[22:23], v[12:13]
  v_pk_add_f32 v[24:25], v[24:25], v[12:13]
  v_pk_add_f32 v[26:27], v[26:27], v[12:13]
  v_pk_add_f32 v[28:29], v[28:29], v[12:13]
  v_pk_add_f32 v[30:31], v[30:31], v[12:13]
  v_pk_add_f32 v[32:33], v[32:33], v[12:13]
  v_pk_add_f32 v[34:35], v[34:35], v[12:13]
  v_pk_add_f32 v[36:37], v[36:37], v[12:13]
  v_pk_add_f32 v[38:39], v[38:39], v[12:13]
  v_pk_add_f32 v[40:41], v[40:41], v[12:13]
  v_pk_add_f32 v[42:43], v[42:43], v[12:13]
  v_pk_add_f32 v[44:45], v[44:45], v[12:13]
  v_pk_add_f32 v[46:47], v[46:47], v[12:13]
  v_pk_add_f32 v[48:49], v[48:49], v[12:13]
  v_pk_add_f32 v[50:51], v[50:51], v[12:13]
  v_pk_add_f32 v[52:53], v[52:53], v[12:13]
  v_pk_add_f32 v[54:55], v[54:55], v[12:13]
  v_pk_add_f32 v[56:57], v[56:57], v[12:13]
  v_pk_add_f32 v[58:59], v[58:59], v[12:13]
  v_pk_add_f32 v[60:61], v[60:61], v[12:13]
  v_pk_add_f32 v[62:63], v[62:63], v[12:13]
  v_pk_add_f32 v[64:65], v[64:65], v[12:13]
  v_pk_add_f32 v[66:67], v[66:67], v[12:13]
  v_pk_add_f32 v[68:69], v[68:69], v[12:13]
  v_pk_add_f32 v[70:71], v[70:71], v[12:13]
  v_pk_add_f32 v[72:73], v[72:73], v[12:13]
  v_pk_add_f32 v[74:75], v[74:75], v[12:13]
  v_pk_add_f32 v[76:77], v[76:77], v[12:13]
  v_pk_add_f32 v[78:79], v[78:79], v[12:13]
  v_pk_add_f32 v[80:81], v[80:81], v[12:13]
  v_pk_add_f32 v[82:83], v[82:83], v[12:13]
  v_pk_add_f32 v[84:85], v[84:85], v[12:13]
  v_pk_add_f32 v[86:87], v[86:87], v[12:13]
  v_pk_add_f32 v[88:89], v[88:89], v[12:13]
  v_pk_add_f32 v[90:91], v[90:91], v[12:13]
  v_pk_add_f32 v[92:93], v[92:93], v[12:13]
  v_pk_add_f32 v[94:95], v[94:95], v[12:13]
  v_pk_mul_f32 v[12:13], v[16:17], v[16:17]
  v_pk_fma_f32 v[12:13], v[18:19], v[18:19], v[12:13]
  v_pk_fma_f32 v[12:13], v[20:21], v[20:21], v[12:13]
  v_pk_fma_f32 v[12:13], v[22:23], v[22:23], v[12:13]
  v_pk_fma_f32 v[12:13], v[24:25], v[24:25], v[12:13]
  v_pk_fma_f32 v[12:13], v[26:27], v[26:27], v[12:13]
  v_pk_fma_f32 v[12:13], v[28:29], v[28:29], v[12:13]
  v_pk_fma_f32 v[12:13], v[30:31], v[30:31], v[12:13]
  v_pk_fma_f32 v[12:13], v[32:33], v[32:33], v[12:13]
  v_pk_fma_f32 v[12:13], v[34:35], v[34:35], v[12:13]
  v_pk_fma_f32 v[12:13], v[36:37], v[36:37], v[12:13]
  v_pk_fma_f32 v[12:13], v[38:39], v[38:39], v[12:13]
  v_pk_fma_f32 v[12:13], v[40:41], v[40:41], v[12:13]
  v_pk_fma_f32 v[12:13], v[42:43], v[42:43], v[12:13]
  v_pk_fma_f32 v[12:13], v[44:45], v[44:45], v[12:13]
  v_pk_fma_f32 v[12:13], v[46:47], v[46:47], v[12:13]
  v_pk_fma_f32 v[12:13], v[48:49], v[48:49], v[12:13]
  v_pk_fma_f32 v[12:13], v[50:51], v[50:51], v[12:13]
  v_pk_fma_f32 v[12:13], v[52:53], v[52:53], v[12:13]
  v_pk_fma_f32 v[12:13], v[54:55], v[54:55], v[12:13]
  v_pk_fma_f32 v[12:13], v[56:57], v[56:57], v[12:13]
  v_pk_fma_f32 v[12:13], v[58:59], v[58:59], v[12:13]
  v_pk_fma_f32 v[12:13], v[60:61], v[60:61], v[12:13]
  v_pk_fma_f32 v[12:13], v[62:63], v[62:63], v[12:13]
  v_pk_fma_f32 v[12:13], v[64:65], v[64:65], v[12:13]
  v_pk_fma_f32 v[12:13], v[66:67], v[66:67], v[12:13]
  v_pk_fma_f32 v[12:13], v[68:69], v[68:69], v[12:13]
  v_pk_fma_f32 v[12:13], v[70:71], v[70:71], v[12:13]
  v_pk_fma_f32 v[12:13], v[72:73], v[72:73], v[12:13]
  v_pk_fma_f32 v[12:13], v[74:75], v[74:75], v[12:13]
  v_pk_fma_f32 v[12:13], v[76:77], v[76:77], v[12:13]
  v_pk_fma_f32 v[12:13], v[78:79], v[78:79], v[12:13]
  v_pk_fma_f32 v[12:13], v[80:81], v[80:81], v[12:13]
  v_pk_fma_f32 v[12:13], v[82:83], v[82:83], v[12:13]
  v_pk_fma_f32 v[12:13], v[84:85], v[84:85], v[12:13]
  v_pk_fma_f32 v[12:13], v[86:87], v[86:87], v[12:13]
  v_pk_fma_f32 v[12:13], v[88:89], v[88:89], v[12:13]
  v_pk_fma_f32 v[12:13], v[90:91], v[90:91], v[12:13]
  v_pk_fma_f32 v[12:13], v[92:93], v[92:93], v[12:13]
  v_pk_fma_f32 v[12:13], v[94:95], v[94:95], v[12:13]
  v_add_f32 v12, v12, v13
  s_nop 1
  v_add_f32_dpp v12, v12, v12 row_ror:8 row_mask:0xf bank_mask:0xf
  v_mov_b32 v13, v12
  s_nop 1
  v_permlane16_swap_b32 v12, v13
  v_add_f32 v12, v12, v13
  v_mov_b32 v13, v12
  s_nop 1
  v_permlane32_swap_b32 v12, v13
  v_add_f32 v12, v12, v13
  v_mov_b32 v13, 0x3727c5ac
  v_fmac_f32 v13, 0x3acccccd, v12
  v_rsq_f32 v12, v13
  s_nop 0
  v_mov_b32 v13, v12
  v_pk_mul_f32 v[16:17], v[16:17], v[12:13]
  v_pk_mul_f32 v[18:19], v[18:19], v[12:13]
  v_pk_mul_f32 v[20:21], v[20:21], v[12:13]
  v_pk_mul_f32 v[22:23], v[22:23], v[12:13]
  v_pk_mul_f32 v[24:25], v[24:25], v[12:13]
  v_pk_mul_f32 v[26:27], v[26:27], v[12:13]
  v_pk_mul_f32 v[28:29], v[28:29], v[12:13]
  v_pk_mul_f32 v[30:31], v[30:31], v[12:13]
  v_pk_mul_f32 v[32:33], v[32:33], v[12:13]
  v_pk_mul_f32 v[34:35], v[34:35], v[12:13]
  v_pk_mul_f32 v[36:37], v[36:37], v[12:13]
  v_pk_mul_f32 v[38:39], v[38:39], v[12:13]
  v_pk_mul_f32 v[40:41], v[40:41], v[12:13]
  v_pk_mul_f32 v[42:43], v[42:43], v[12:13]
  v_pk_mul_f32 v[44:45], v[44:45], v[12:13]
  v_pk_mul_f32 v[46:47], v[46:47], v[12:13]
  v_pk_mul_f32 v[48:49], v[48:49], v[12:13]
  v_pk_mul_f32 v[50:51], v[50:51], v[12:13]
  v_pk_mul_f32 v[52:53], v[52:53], v[12:13]
  v_pk_mul_f32 v[54:55], v[54:55], v[12:13]
  v_pk_mul_f32 v[56:57], v[56:57], v[12:13]
  v_pk_mul_f32 v[58:59], v[58:59], v[12:13]
  v_pk_mul_f32 v[60:61], v[60:61], v[12:13]
  v_pk_mul_f32 v[62:63], v[62:63], v[12:13]
  v_pk_mul_f32 v[64:65], v[64:65], v[12:13]
  v_pk_mul_f32 v[66:67], v[66:67], v[12:13]
  v_pk_mul_f32 v[68:69], v[68:69], v[12:13]
  v_pk_mul_f32 v[70:71], v[70:71], v[12:13]
  v_pk_mul_f32 v[72:73], v[72:73], v[12:13]
  v_pk_mul_f32 v[74:75], v[74:75], v[12:13]
  v_pk_mul_f32 v[76:77], v[76:77], v[12:13]
  v_pk_mul_f32 v[78:79], v[78:79], v[12:13]
  v_pk_mul_f32 v[80:81], v[80:81], v[12:13]
  v_pk_mul_f32 v[82:83], v[82:83], v[12:13]
  v_pk_mul_f32 v[84:85], v[84:85], v[12:13]
  v_pk_mul_f32 v[86:87], v[86:87], v[12:13]
  v_pk_mul_f32 v[88:89], v[88:89], v[12:13]
  v_pk_mul_f32 v[90:91], v[90:91], v[12:13]
  v_pk_mul_f32 v[92:93], v[92:93], v[12:13]
  v_pk_mul_f32 v[94:95], v[94:95], v[12:13]
  v_cvt_pk_bf16_f32 v16, v16, v17
  v_cvt_pk_bf16_f32 v17, v18, v19
  v_cvt_pk_bf16_f32 v18, v20, v21
  v_cvt_pk_bf16_f32 v19, v22, v23
  v_cvt_pk_bf16_f32 v20, v24, v25
  v_cvt_pk_bf16_f32 v21, v26, v27
  v_cvt_pk_bf16_f32 v22, v28, v29
  v_cvt_pk_bf16_f32 v23, v30, v31
  v_cvt_pk_bf16_f32 v24, v32, v33
  v_cvt_pk_bf16_f32 v25, v34, v35
  v_cvt_pk_bf16_f32 v26, v36, v37
  v_cvt_pk_bf16_f32 v27, v38, v39
  v_cvt_pk_bf16_f32 v28, v40, v41
  v_cvt_pk_bf16_f32 v29, v42, v43
  v_cvt_pk_bf16_f32 v30, v44, v45
  v_cvt_pk_bf16_f32 v31, v46, v47
  v_cvt_pk_bf16_f32 v32, v48, v49
  v_cvt_pk_bf16_f32 v33, v50, v51
  v_cvt_pk_bf16_f32 v34, v52, v53
  v_cvt_pk_bf16_f32 v35, v54, v55
  v_cvt_pk_bf16_f32 v36, v56, v57
  v_cvt_pk_bf16_f32 v37, v58, v59
  v_cvt_pk_bf16_f32 v38, v60, v61
  v_cvt_pk_bf16_f32 v39, v62, v63
  v_cvt_pk_bf16_f32 v40, v64, v65
  v_cvt_pk_bf16_f32 v41, v66, v67
  v_cvt_pk_bf16_f32 v42, v68, v69
  v_cvt_pk_bf16_f32 v43, v70, v71
  v_cvt_pk_bf16_f32 v44, v72, v73
  v_cvt_pk_bf16_f32 v45, v74, v75
  v_cvt_pk_bf16_f32 v46, v76, v77
  v_cvt_pk_bf16_f32 v47, v78, v79
  v_cvt_pk_bf16_f32 v48, v80, v81
  v_cvt_pk_bf16_f32 v49, v82, v83
  v_cvt_pk_bf16_f32 v50, v84, v85
  v_cvt_pk_bf16_f32 v51, v86, v87
  v_cvt_pk_bf16_f32 v52, v88, v89
  v_cvt_pk_bf16_f32 v53, v90, v91
  v_cvt_pk_bf16_f32 v54, v92, v93
  v_cvt_pk_bf16_f32 v55, v94, v95
  s_mul_i32 s48, s46, 40960
  s_add_u32 s48, s48, s47
  s_add_u32 s48, s48, 0x100000
  s_add_u32 s49, s48, 0
  buffer_store_dwordx4 v[16:19], v10, s[8:11], s49 offen sc1
  s_add_u32 s49, s48, 4096
  buffer_store_dwordx4 v[20:23], v10, s[8:11], s49 offen sc1
  s_add_u32 s49, s48, 8192
  buffer_store_dwordx4 v[24:27], v10, s[8:11], s49 offen sc1
  s_add_u32 s49, s48, 12288
  buffer_store_dwordx4 v[28:31], v10, s[8:11], s49 offen sc1
  s_add_u32 s49, s48, 16384
  buffer_store_dwordx4 v[32:35], v10, s[8:11], s49 offen sc1
  s_add_u32 s49, s48, 20480
  buffer_store_dwordx4 v[36:39], v10, s[8:11], s49 offen sc1
  s_add_u32 s49, s48, 24576
  buffer_store_dwordx4 v[40:43], v10, s[8:11], s49 offen sc1
  s_add_u32 s49, s48, 28672
  buffer_store_dwordx4 v[44:47], v10, s[8:11], s49 offen sc1
  s_add_u32 s49, s48, 32768
  buffer_store_dwordx4 v[48:51], v10, s[8:11], s49 offen sc1
  s_add_u32 s49, s48, 36864
  buffer_store_dwordx4 v[52:55], v10, s[8:11], s49 offen sc1
lnu_49_x:
  s_cmp_eq_u32 s21, 0
  s_cbranch_scc0 ka_cen_done
  s_mov_b64 s[24:25], exec
  s_mov_b64 exec, 1
  v_mov_b32 v3, 1
  s_lshl_b32 s27, s26, 2
  v_mov_b32 v4, s27
  global_atomic_add v5, v4, v3, s[6:7] sc0
  v_mov_b32 v4, 64
  s_waitcnt vmcnt(0)
  global_atomic_add v6, v4, v3, s[6:7] sc0
  s_mov_b32 s45, 0
  s_waitcnt vmcnt(0)
ka_cen_spin:
  global_load_dword v7, v4, s[6:7] sc1
  s_add_u32 s45, s45, 1
  s_waitcnt vmcnt(0)
  v_readfirstlane_b32 s27, v7
  s_cmp_ge_u32 s27, 256
  s_cbranch_scc1 ka_cen_ok
  s_cmp_lt_u32 s45, 400000
  s_cbranch_scc1 ka_cen_spin
ka_cen_ok:
  s_mov_b64 exec, 0xff
  v_lshlrev_b32 v4, 2, v0
  global_load_dword v7, v4, s[6:7] sc1
  s_waitcnt vmcnt(0)
  v_cmp_ne_u32 vcc, 32, v7
  s_nop 1
  s_cmp_eq_u64 vcc, 0
  s_cselect_b32 s27, 1, 0
  s_cmp_ge_u32 s27, 1
  s_cselect_b32 s27, 1, 0
  s_mov_b64 exec, 1
  v_mov_b32 v8, s27
  v_mov_b32 v4, 0
  v_mov_b32 v9, 0
  ds_write_b128 v4, v[6:9]
  ds_write_b32 v4, v5 offset:16
  s_waitcnt lgkmcnt(0)
  s_mov_b64 exec, s[24:25]
ka_cen_done:
  s_barrier
  v_mov_b32 v4, 0
  ds_read_b128 v[6:9], v4
  ds_read_b32 v5, v4 offset:16
  s_waitcnt lgkmcnt(0)
  v_readfirstlane_b32 s27, v6
  v_readfirstlane_b32 s44, v8
  v_readfirstlane_b32 s28, v5
  s_barrier
  s_cmp_eq_u32 s44, 1
  s_cbranch_scc1 ka_cen_fast
  s_lshr_b32 s20, s27, 5
  s_and_b32 s22, s27, 31
  s_branch ka_cen_end
ka_cen_fast:
  s_mov_b32 s20, s26
  s_mov_b32 s22, s28
ka_cen_end:
  s_and_b32 s20, s20, 7
  s_and_b32 s22, s22, 31
  s_cmp_lt_u32 s20, 4
  s_cbranch_scc0 ka_bulk
  s_cmp_lt_u32 s22, 8
  s_cbranch_scc0 ka_noty
  s_lshl_b32 s23, s20, 3
  s_add_u32 s23, s23, s22
  s_cmp_eq_u32 s44, 1
  s_cbranch_scc1 kaf_x
  s_branch kas_x
ka_noty:
  s_cmp_lt_u32 s22, 28
  s_cbranch_scc0 ka_spare
  s_sub_u32 s23, s22, 8
  s_cmp_eq_u32 s44, 1
  s_cbranch_scc1 kaf_y
  s_branch kas_y
ka_bulk:
  s_sub_u32 s28, s20, 4
  s_lshl_b32 s23, s22, 2
  s_add_u32 s23, s23, s28
  s_cmp_lt_u32 s23, 72
  s_cbranch_scc1 ka_qkv
  s_sub_u32 s23, s23, 72
  s_cmp_lt_u32 s23, 32
  s_cbranch_scc1 ka_u
  s_sub_u32 s23, s23, 32
  s_branch ka_ln
ka_ln:
  v_and_b32 v1, 63, v0
  s_lshl_b32 s46, s23, 2
  s_add_u32 s46, s46, s21
  v_and_b32 v5, 7, v1
  v_bfe_u32 v6, v1, 3, 1
  v_lshrrev_b32 v7, 4, v1
  v_lshlrev_b32 v8, 5, v6
  v_add_u32 v8, v8, v5
  v_lshlrev_b32 v8, 4, v8
  v_lshlrev_b32 v9, 11, v7
  v_add_u32 v9, v9, v8
  v_lshlrev_b32 v10, 10, v7
  v_add_u32 v10, v10, v8
  v_mul_u32_u24 v11, 1280, v5
  v_lshlrev_b32 v12, 5, v7
  v_add_u32 v11, v11, v12
  v_lshlrev_b32 v12, 4, v6
  v_add_u32 v11, v11, v12
  s_load_dwordx2 s[36:37], s[0:1], 0
  s_load_dwordx4 s[40:43], s[0:1], 64
  s_waitcnt lgkmcnt(0)
  s_mov_b32 s12, s36
  s_and_b32 s13, s37, 0xffff
  s_mov_b32 s14, 0x280000
  s_mov_b32 s15, 0x20000

  s_cmp_eq_u32 s21, 3
  s_cbranch_scc0 lna_50
  s_waitcnt vmcnt(0)
  s_mov_b64 s[24:25], exec
  s_mov_b64 exec, 1
  v_mov_b32 v2, 4992
  v_mov_b32 v3, 1
  buffer_atomic_add v3, v2, s[8:11], 0 offen
  s_mov_b64 exec, s[24:25]
lna_50:
  s_cmp_eq_u32 s99, 0
  s_cbranch_scc0 ka_lnx
  s_mov_b32 s12, s42
  s_and_b32 s13, s43, 0xffff
  s_mov_b32 s14, 0xc8000
  s_mov_b32 s15, 0x20000
  s_mov_b32 s16, s40
  s_and_b32 s17, s41, 0xffff
  s_mov_b32 s18, 0x258000
  s_mov_b32 s19, 0x20000
  s_lshl_b32 s46, s23, 2
  s_add_u32 s46, s46, s21
  v_lshlrev_b32 v2, 4, v1
  v_and_b32 v8, 31, v1
  v_lshrrev_b32 v9, 5, v1
  v_lshrrev_b32 v10, 4, v8
  v_lshlrev_b32 v10, 4, v10
  v_bfe_u32 v11, v8, 2, 1
  v_lshlrev_b32 v11, 3, v11
  v_add_u32 v10, v10, v11
  v_bfe_u32 v11, v8, 3, 1
  v_lshlrev_b32 v11, 2, v11
  v_add_u32 v10, v10, v11
  v_and_b32 v11, 3, v8
  v_add_u32 v10, v10, v11
  v_mov_b32 v15, 0x40000000
  v_lshrrev_b32 v14, 4, v1
  v_mul_u32_u24 v14, 10240, v14
  v_and_b32 v13, 15, v1
  v_lshlrev_b32 v13, 1, v13
  v_add_u32 v14, v14, v13
ka_gl:
  s_add_u32 s27, s46, 0
  s_mov_b32 s50, 0
  s_cmp_lt_u32 s27, 800
  s_cbranch_scc0 gq_52
  s_mul_i32 s28, s27, 3277
  s_lshr_b32 s28, s28, 16
  s_mul_i32 s29, s28, 20
  s_sub_u32 s29, s27, s29
  s_lshl_b32 s30, s28, 5
  s_mul_i32 s31, s29, 40960
  s_add_u32 s30, s30, s31
  s_add_u32 s31, s30, 0
  buffer_load_ushort v20, v14, s[12:15], s31 offen
  s_add_u32 s31, s30, 1280
  buffer_load_ushort v21, v14, s[12:15], s31 offen
  s_add_u32 s31, s30, 2560
  buffer_load_ushort v22, v14, s[12:15], s31 offen
  s_add_u32 s31, s30, 3840
  buffer_load_ushort v23, v14, s[12:15], s31 offen
  s_add_u32 s31, s30, 5120
  buffer_load_ushort v24, v14, s[12:15], s31 offen
  s_add_u32 s31, s30, 6400
  buffer_load_ushort v25, v14, s[12:15], s31 offen
  s_add_u32 s31, s30, 7680
  buffer_load_ushort v26, v14, s[12:15], s31 offen
  s_add_u32 s31, s30, 8960
  buffer_load_ushort v27, v14, s[12:15], s31 offen
  s_lshl_b32 s28, s27, 10
  s_add_u32 s50, s28, 0xe000000
  s_branch g_51
gq_52:
  s_sub_u32 s27, s27, 800
  s_cmp_lt_u32 s27, 3840
  s_cbranch_scc0 g_51
  s_mul_i32 s28, s27, 6554
  s_lshr_b32 s28, s28, 18
  s_mul_i32 s29, s28, 40
  s_sub_u32 s29, s27, s29
  s_mul_i32 s30, s28, 21846
  s_lshr_b32 s30, s30, 16
  s_mul_i32 s31, s30, 3
  s_sub_u32 s31, s28, s31
  s_cmp_lt_u32 s31, 2
  s_cselect_b64 vcc, -1, 0
  v_cndmask_b32 v12, v8, v10, vcc
  v_cmp_gt_u32 vcc, 20, v12
  v_lshlrev_b32 v12, 1, v12
  v_mul_u32_u24 v13, 30720, v9
  v_add_u32 v12, v12, v13
  v_cndmask_b32 v12, v15, v12, vcc
  s_mul_i32 s31, s31, 1280
  s_mul_i32 s30, s30, 40
  s_add_u32 s30, s30, s31
  s_mul_i32 s31, s29, 61440
  s_add_u32 s30, s30, s31
  s_add_u32 s31, s30, 0
  buffer_load_ushort v20, v12, s[16:19], s31 offen
  s_add_u32 s31, s30, 3840
  buffer_load_ushort v21, v12, s[16:19], s31 offen
  s_add_u32 s31, s30, 7680
  buffer_load_ushort v22, v12, s[16:19], s31 offen
  s_add_u32 s31, s30, 11520
  buffer_load_ushort v23, v12, s[16:19], s31 offen
  s_add_u32 s31, s30, 15360
  buffer_load_ushort v24, v12, s[16:19], s31 offen
  s_add_u32 s31, s30, 19200
  buffer_load_ushort v25, v12, s[16:19], s31 offen
  s_add_u32 s31, s30, 23040
  buffer_load_ushort v26, v12, s[16:19], s31 offen
  s_add_u32 s31, s30, 26880
  buffer_load_ushort v27, v12, s[16:19], s31 offen
  s_lshl_b32 s28, s27, 10
  s_add_u32 s50, s28, 0xe100000
g_51:
  s_add_u32 s27, s46, 96
  s_mov_b32 s51, 0
  s_cmp_lt_u32 s27, 800
  s_cbranch_scc0 gq_55
  s_mul_i32 s28, s27, 3277
  s_lshr_b32 s28, s28, 16
  s_mul_i32 s29, s28, 20
  s_sub_u32 s29, s27, s29
  s_lshl_b32 s30, s28, 5
  s_mul_i32 s31, s29, 40960
  s_add_u32 s30, s30, s31
  s_add_u32 s31, s30, 0
  buffer_load_ushort v28, v14, s[12:15], s31 offen
  s_add_u32 s31, s30, 1280
  buffer_load_ushort v29, v14, s[12:15], s31 offen
  s_add_u32 s31, s30, 2560
  buffer_load_ushort v30, v14, s[12:15], s31 offen
  s_add_u32 s31, s30, 3840
  buffer_load_ushort v31, v14, s[12:15], s31 offen
  s_add_u32 s31, s30, 5120
  buffer_load_ushort v32, v14, s[12:15], s31 offen
  s_add_u32 s31, s30, 6400
  buffer_load_ushort v33, v14, s[12:15], s31 offen
  s_add_u32 s31, s30, 7680
  buffer_load_ushort v34, v14, s[12:15], s31 offen
  s_add_u32 s31, s30, 8960
  buffer_load_ushort v35, v14, s[12:15], s31 offen
  s_lshl_b32 s28, s27, 10
  s_add_u32 s51, s28, 0xe000000
  s_branch g_54
gq_55:
  s_sub_u32 s27, s27, 800
  s_cmp_lt_u32 s27, 3840
  s_cbranch_scc0 g_54
  s_mul_i32 s28, s27, 6554
  s_lshr_b32 s28, s28, 18
  s_mul_i32 s29, s28, 40
  s_sub_u32 s29, s27, s29
  s_mul_i32 s30, s28, 21846
  s_lshr_b32 s30, s30, 16
  s_mul_i32 s31, s30, 3
  s_sub_u32 s31, s28, s31
  s_cmp_lt_u32 s31, 2
  s_cselect_b64 vcc, -1, 0
  v_cndmask_b32 v12, v8, v10, vcc
  v_cmp_gt_u32 vcc, 20, v12
  v_lshlrev_b32 v12, 1, v12
  v_mul_u32_u24 v13, 30720, v9
  v_add_u32 v12, v12, v13
  v_cndmask_b32 v12, v15, v12, vcc
  s_mul_i32 s31, s31, 1280
  s_mul_i32 s30, s30, 40
  s_add_u32 s30, s30, s31
  s_mul_i32 s31, s29, 61440
  s_add_u32 s30, s30, s31
  s_add_u32 s31, s30, 0
  buffer_load_ushort v28, v12, s[16:19], s31 offen
  s_add_u32 s31, s30, 3840
  buffer_load_ushort v29, v12, s[16:19], s31 offen
  s_add_u32 s31, s30, 7680
  buffer_load_ushort v30, v12, s[16:19], s31 offen
  s_add_u32 s31, s30, 11520
  buffer_load_ushort v31, v12, s[16:19], s31 offen
  s_add_u32 s31, s30, 15360
  buffer_load_ushort v32, v12, s[16:19], s31 offen
  s_add_u32 s31, s30, 19200
  buffer_load_ushort v33, v12, s[16:19], s31 offen
  s_add_u32 s31, s30, 23040
  buffer_load_ushort v34, v12, s[16:19], s31 offen
  s_add_u32 s31, s30, 26880
  buffer_load_ushort v35, v12, s[16:19], s31 offen
  s_lshl_b32 s28, s27, 10
  s_add_u32 s51, s28, 0xe100000
g_54:
  s_add_u32 s27, s46, 192
  s_mov_b32 s52, 0
  s_cmp_lt_u32 s27, 800
  s_cbranch_scc0 gq_58
  s_mul_i32 s28, s27, 3277
  s_lshr_b32 s28, s28, 16
  s_mul_i32 s29, s28, 20
  s_sub_u32 s29, s27, s29
  s_lshl_b32 s30, s28, 5
  s_mul_i32 s31, s29, 40960
  s_add_u32 s30, s30, s31
  s_add_u32 s31, s30, 0
  buffer_load_ushort v36, v14, s[12:15], s31 offen
  s_add_u32 s31, s30, 1280
  buffer_load_ushort v37, v14, s[12:15], s31 offen
  s_add_u32 s31, s30, 2560
  buffer_load_ushort v38, v14, s[12:15], s31 offen
  s_add_u32 s31, s30, 3840
  buffer_load_ushort v39, v14, s[12:15], s31 offen
  s_add_u32 s31, s30, 5120
  buffer_load_ushort v40, v14, s[12:15], s31 offen
  s_add_u32 s31, s30, 6400
  buffer_load_ushort v41, v14, s[12:15], s31 offen
  s_add_u32 s31, s30, 7680
  buffer_load_ushort v42, v14, s[12:15], s31 offen
  s_add_u32 s31, s30, 8960
  buffer_load_ushort v43, v14, s[12:15], s31 offen
  s_lshl_b32 s28, s27, 10
  s_add_u32 s52, s28, 0xe000000
  s_branch g_57
gq_58:
  s_sub_u32 s27, s27, 800
  s_cmp_lt_u32 s27, 3840
  s_cbranch_scc0 g_57
  s_mul_i32 s28, s27, 6554
  s_lshr_b32 s28, s28, 18
  s_mul_i32 s29, s28, 40
  s_sub_u32 s29, s27, s29
  s_mul_i32 s30, s28, 21846
  s_lshr_b32 s30, s30, 16
  s_mul_i32 s31, s30, 3
  s_sub_u32 s31, s28, s31
  s_cmp_lt_u32 s31, 2
  s_cselect_b64 vcc, -1, 0
  v_cndmask_b32 v12, v8, v10, vcc
  v_cmp_gt_u32 vcc, 20, v12
  v_lshlrev_b32 v12, 1, v12
  v_mul_u32_u24 v13, 30720, v9
  v_add_u32 v12, v12, v13
  v_cndmask_b32 v12, v15, v12, vcc
  s_mul_i32 s31, s31, 1280
  s_mul_i32 s30, s30, 40
  s_add_u32 s30, s30, s31
  s_mul_i32 s31, s29, 61440
  s_add_u32 s30, s30, s31
  s_add_u32 s31, s30, 0
  buffer_load_ushort v36, v12, s[16:19], s31 offen
  s_add_u32 s31, s30, 3840
  buffer_load_ushort v37, v12, s[16:19], s31 offen
  s_add_u32 s31, s30, 7680
  buffer_load_ushort v38, v12, s[16:19], s31 offen
  s_add_u32 s31, s30, 11520
  buffer_load_ushort v39, v12, s[16:19], s31 offen
  s_add_u32 s31, s30, 15360
  buffer_load_ushort v40, v12, s[16:19], s31 offen
  s_add_u32 s31, s30, 19200
  buffer_load_ushort v41, v12, s[16:19], s31 offen
  s_add_u32 s31, s30, 23040
  buffer_load_ushort v42, v12, s[16:19], s31 offen
  s_add_u32 s31, s30, 26880
  buffer_load_ushort v43, v12, s[16:19], s31 offen
  s_lshl_b32 s28, s27, 10
  s_add_u32 s52, s28, 0xe100000
g_57:
  s_add_u32 s27, s46, 288
  s_mov_b32 s53, 0
  s_cmp_lt_u32 s27, 800
  s_cbranch_scc0 gq_61
  s_mul_i32 s28, s27, 3277
  s_lshr_b32 s28, s28, 16
  s_mul_i32 s29, s28, 20
  s_sub_u32 s29, s27, s29
  s_lshl_b32 s30, s28, 5
  s_mul_i32 s31, s29, 40960
  s_add_u32 s30, s30, s31
  s_add_u32 s31, s30, 0
  buffer_load_ushort v44, v14, s[12:15], s31 offen
  s_add_u32 s31, s30, 1280
  buffer_load_ushort v45, v14, s[12:15], s31 offen
  s_add_u32 s31, s30, 2560
  buffer_load_ushort v46, v14, s[12:15], s31 offen
  s_add_u32 s31, s30, 3840
  buffer_load_ushort v47, v14, s[12:15], s31 offen
  s_add_u32 s31, s30, 5120
  buffer_load_ushort v48, v14, s[12:15], s31 offen
  s_add_u32 s31, s30, 6400
  buffer_load_ushort v49, v14, s[12:15], s31 offen
  s_add_u32 s31, s30, 7680
  buffer_load_ushort v50, v14, s[12:15], s31 offen
  s_add_u32 s31, s30, 8960
  buffer_load_ushort v51, v14, s[12:15], s31 offen
  s_lshl_b32 s28, s27, 10
  s_add_u32 s53, s28, 0xe000000
  s_branch g_60
gq_61:
  s_sub_u32 s27, s27, 800
  s_cmp_lt_u32 s27, 3840
  s_cbranch_scc0 g_60
  s_mul_i32 s28, s27, 6554
  s_lshr_b32 s28, s28, 18
  s_mul_i32 s29, s28, 40
  s_sub_u32 s29, s27, s29
  s_mul_i32 s30, s28, 21846
  s_lshr_b32 s30, s30, 16
  s_mul_i32 s31, s30, 3
  s_sub_u32 s31, s28, s31
  s_cmp_lt_u32 s31, 2
  s_cselect_b64 vcc, -1, 0
  v_cndmask_b32 v12, v8, v10, vcc
  v_cmp_gt_u32 vcc, 20, v12
  v_lshlrev_b32 v12, 1, v12
  v_mul_u32_u24 v13, 30720, v9
  v_add_u32 v12, v12, v13
  v_cndmask_b32 v12, v15, v12, vcc
  s_mul_i32 s31, s31, 1280
  s_mul_i32 s30, s30, 40
  s_add_u32 s30, s30, s31
  s_mul_i32 s31, s29, 61440
  s_add_u32 s30, s30, s31
  s_add_u32 s31, s30, 0
  buffer_load_ushort v44, v12, s[16:19], s31 offen
  s_add_u32 s31, s30, 3840
  buffer_load_ushort v45, v12, s[16:19], s31 offen
  s_add_u32 s31, s30, 7680
  buffer_load_ushort v46, v12, s[16:19], s31 offen
  s_add_u32 s31, s30, 11520
  buffer_load_ushort v47, v12, s[16:19], s31 offen
  s_add_u32 s31, s30, 15360
  buffer_load_ushort v48, v12, s[16:19], s31 offen
  s_add_u32 s31, s30, 19200
  buffer_load_ushort v49, v12, s[16:19], s31 offen
  s_add_u32 s31, s30, 23040
  buffer_load_ushort v50, v12, s[16:19], s31 offen
  s_add_u32 s31, s30, 26880
  buffer_load_ushort v51, v12, s[16:19], s31 offen
  s_lshl_b32 s28, s27, 10
  s_add_u32 s53, s28, 0xe100000
g_60:
  s_waitcnt vmcnt(0)
  s_cmp_eq_u32 s50, 0
  s_cbranch_scc1 gs_63
  v_lshl_or_b32 v60, v21, 16, v20
  v_lshl_or_b32 v61, v23, 16, v22
  v_lshl_or_b32 v62, v25, 16, v24
  v_lshl_or_b32 v63, v27, 16, v26
  buffer_store_dwordx4 v[60:63], v2, s[8:11], s50 offen
gs_63:
  s_cmp_eq_u32 s51, 0
  s_cbranch_scc1 gs_64
  v_lshl_or_b32 v64, v29, 16, v28
  v_lshl_or_b32 v65, v31, 16, v30
  v_lshl_or_b32 v66, v33, 16, v32
  v_lshl_or_b32 v67, v35, 16, v34
  buffer_store_dwordx4 v[64:67], v2, s[8:11], s51 offen
gs_64:
  s_cmp_eq_u32 s52, 0
  s_cbranch_scc1 gs_65
  v_lshl_or_b32 v68, v37, 16, v36
  v_lshl_or_b32 v69, v39, 16, v38
  v_lshl_or_b32 v70, v41, 16, v40
  v_lshl_or_b32 v71, v43, 16, v42
  buffer_store_dwordx4 v[68:71], v2, s[8:11], s52 offen
gs_65:
  s_cmp_eq_u32 s53, 0
  s_cbranch_scc1 gs_66
  v_lshl_or_b32 v72, v45, 16, v44
  v_lshl_or_b32 v73, v47, 16, v46
  v_lshl_or_b32 v74, v49, 16, v48
  v_lshl_or_b32 v75, v51, 16, v50
  buffer_store_dwordx4 v[72:75], v2, s[8:11], s53 offen
gs_66:
  s_add_u32 s46, s46, 384
  s_cmp_lt_u32 s46, 4640
  s_cbranch_scc1 ka_gl
ka_lnx:
  s_waitcnt vmcnt(0)
  s_branch ka_exit
ka_spare:
  s_cmp_eq_u32 s21, 3
  s_cbranch_scc0 lna_67
  s_waitcnt vmcnt(0)
  s_mov_b64 s[24:25], exec
  s_mov_b64 exec, 1
  v_mov_b32 v2, 4992
  v_mov_b32 v3, 1
  buffer_atomic_add v3, v2, s[8:11], 0 offen
  s_mov_b64 exec, s[24:25]
lna_67:
  s_cmp_eq_u32 s20, 0
  s_cbranch_scc0 ka_pf
  s_cmp_eq_u32 s22, 28
  s_cbranch_scc0 ka_pf
  s_cmp_eq_u32 s21, 0
  s_cbranch_scc0 ka_pf
  s_mov_b64 s[24:25], exec
  s_mov_b64 exec, 1
  v_mov_b32 v2, 0
  v_mov_b32 v3, 0
  s_mov_b32 s30, -1
  s_mov_b32 s31, -1
  s_mov_b32 s28, 0xb00000
  buffer_store_dword v3, v2, s[8:11], s28 offen sc1
  s_waitcnt vmcnt(0)
  s_memtime s[32:33]
  s_waitcnt lgkmcnt(0)
  buffer_load_dword v4, v2, s[8:11], s28 offen sc1
  s_waitcnt vmcnt(0)
  s_memtime s[34:35]
  s_waitcnt lgkmcnt(0)
  s_sub_u32 s34, s34, s32
  s_min_u32 s30, s30, s34
  s_mov_b32 s28, 0xb02000
  buffer_store_dword v3, v2, s[8:11], s28 offen sc1
  s_waitcnt vmcnt(0)
  s_memtime s[32:33]
  s_waitcnt lgkmcnt(0)
  buffer_load_dword v4, v2, s[8:11], s28 offen sc1
  s_waitcnt vmcnt(0)
  s_memtime s[34:35]
  s_waitcnt lgkmcnt(0)
  s_sub_u32 s34, s34, s32
  s_min_u32 s31, s31, s34
  s_mov_b32 s28, 0xb00100
  buffer_store_dword v3, v2, s[8:11], s28 offen sc1
  s_waitcnt vmcnt(0)
  s_memtime s[32:33]
  s_waitcnt lgkmcnt(0)
  buffer_load_dword v4, v2, s[8:11], s28 offen sc1
  s_waitcnt vmcnt(0)
  s_memtime s[34:35]
  s_waitcnt lgkmcnt(0)
  s_sub_u32 s34, s34, s32
  s_min_u32 s30, s30, s34
  s_mov_b32 s28, 0xb02100
  buffer_store_dword v3, v2, s[8:11], s28 offen sc1
  s_waitcnt vmcnt(0)
  s_memtime s[32:33]
  s_waitcnt lgkmcnt(0)
  buffer_load_dword v4, v2, s[8:11], s28 offen sc1
  s_waitcnt vmcnt(0)
  s_memtime s[34:35]
  s_waitcnt lgkmcnt(0)
  s_sub_u32 s34, s34, s32
  s_min_u32 s31, s31, s34
  s_mov_b32 s28, 0xb00200
  buffer_store_dword v3, v2, s[8:11], s28 offen sc1
  s_waitcnt vmcnt(0)
  s_memtime s[32:33]
  s_waitcnt lgkmcnt(0)
  buffer_load_dword v4, v2, s[8:11], s28 offen sc1
  s_waitcnt vmcnt(0)
  s_memtime s[34:35]
  s_waitcnt lgkmcnt(0)
  s_sub_u32 s34, s34, s32
  s_min_u32 s30, s30, s34
  s_mov_b32 s28, 0xb02200
  buffer_store_dword v3, v2, s[8:11], s28 offen sc1
  s_waitcnt vmcnt(0)
  s_memtime s[32:33]
  s_waitcnt lgkmcnt(0)
  buffer_load_dword v4, v2, s[8:11], s28 offen sc1
  s_waitcnt vmcnt(0)
  s_memtime s[34:35]
  s_waitcnt lgkmcnt(0)
  s_sub_u32 s34, s34, s32
  s_min_u32 s31, s31, s34
  s_mov_b32 s28, 0xb00300
  buffer_store_dword v3, v2, s[8:11], s28 offen sc1
  s_waitcnt vmcnt(0)
  s_memtime s[32:33]
  s_waitcnt lgkmcnt(0)
  buffer_load_dword v4, v2, s[8:11], s28 offen sc1
  s_waitcnt vmcnt(0)
  s_memtime s[34:35]
  s_waitcnt lgkmcnt(0)
  s_sub_u32 s34, s34, s32
  s_min_u32 s30, s30, s34
  s_mov_b32 s28, 0xb02300
  buffer_store_dword v3, v2, s[8:11], s28 offen sc1
  s_waitcnt vmcnt(0)
  s_memtime s[32:33]
  s_waitcnt lgkmcnt(0)
  buffer_load_dword v4, v2, s[8:11], s28 offen sc1
  s_waitcnt vmcnt(0)
  s_memtime s[34:35]
  s_waitcnt lgkmcnt(0)
  s_sub_u32 s34, s34, s32
  s_min_u32 s31, s31, s34
  s_cmp_lt_u32 s30, s31
  s_cselect_b32 s28, 1, 2
  v_mov_b32 v3, s28
  v_mov_b32 v2, 5056
  buffer_store_dword v3, v2, s[8:11], 0 offen sc1
  v_mov_b32 v3, s30
  buffer_store_dword v3, v2, s[8:11], 0 offen offset:4 sc1
  v_mov_b32 v3, s31
  buffer_store_dword v3, v2, s[8:11], 0 offen offset:8 sc1
  s_waitcnt vmcnt(0)
  s_mov_b64 exec, s[24:25]
ka_pf:
  v_and_b32 v1, 63, v0
  v_lshlrev_b32 v4, 6, v1
  s_sub_u32 s46, s22, 28
  s_lshl_b32 s46, s46, 2
  s_add_u32 s46, s46, s21
  s_mul_i32 s28, s20, 24
  v_and_b32 v5, 15, v1
  v_min_u32 v5, 11, v5
  v_cmp_le_u32 vcc, 6, v5
  v_subrev_u32 v6, 6, v5
  v_mov_b32 v7, 0x400
  v_cndmask_b32 v5, v5, v6, vcc
  v_cndmask_b32 v7, 0, v7, vcc
  v_lshlrev_b32 v5, 2, v5
  v_add_u32 v5, v5, v7
  s_add_u32 s28, s28, 0
  v_add_u32 v5, s28, v5
  v_and_b32 v6, 7, v1
  v_lshlrev_b32 v6, 2, v6
  s_lshl_b32 s28, s20, 5
  s_add_u32 s28, s28, 3072
  v_add_u32 v6, s28, v6
  s_mul_i32 s47, s20, 327680
  s_mul_i32 s28, s46, 20480
  s_add_u32 s47, s47, s28
  s_add_u32 s47, s47, 0x9000000
  s_mul_i32 s28, s46, 3
  s_add_u32 s28, s28, 0
  s_cmp_ge_u32 s28, 24
  s_cselect_b32 s29, 0x1800000, 0
  s_cselect_b32 s30, 24, 0
  s_sub_u32 s28, s28, s30
  s_mul_i32 s30, s28, 43
  s_lshr_b32 s30, s30, 7
  s_mul_i32 s31, s30, 3
  s_sub_u32 s31, s28, s31
  s_lshl_b32 s28, s20, 3
  s_add_u32 s30, s30, s28
  s_mul_i32 s30, s30, 786432
  s_lshl_b32 s31, s31, 12
  s_add_u32 s30, s30, s31
  s_add_u32 s30, s30, 0x4800000
  s_add_u32 s48, s30, s29
  s_mul_i32 s28, s46, 3
  s_add_u32 s28, s28, 1
  s_cmp_ge_u32 s28, 24
  s_cselect_b32 s29, 0x1800000, 0
  s_cselect_b32 s30, 24, 0
  s_sub_u32 s28, s28, s30
  s_mul_i32 s30, s28, 43
  s_lshr_b32 s30, s30, 7
  s_mul_i32 s31, s30, 3
  s_sub_u32 s31, s28, s31
  s_lshl_b32 s28, s20, 3
  s_add_u32 s30, s30, s28
  s_mul_i32 s30, s30, 786432
  s_lshl_b32 s31, s31, 12
  s_add_u32 s30, s30, s31
  s_add_u32 s30, s30, 0x4800000
  s_add_u32 s49, s30, s29
  s_mul_i32 s28, s46, 3
  s_add_u32 s28, s28, 2
  s_cmp_ge_u32 s28, 24
  s_cselect_b32 s29, 0x1800000, 0
  s_cselect_b32 s30, 24, 0
  s_sub_u32 s28, s28, s30
  s_mul_i32 s30, s28, 43
  s_lshr_b32 s30, s30, 7
  s_mul_i32 s31, s30, 3
  s_sub_u32 s31, s28, s31
  s_lshl_b32 s28, s20, 3
  s_add_u32 s30, s30, s28
  s_mul_i32 s30, s30, 786432
  s_lshl_b32 s31, s31, 12
  s_add_u32 s30, s30, s31
  s_add_u32 s30, s30, 0x4800000
  s_add_u32 s50, s30, s29
  s_mul_i32 s28, s20, 327680
  s_add_u32 s28, s28, 0x700000
  s_lshl_b32 s29, s46, 12
  s_add_u32 s51, s28, s29
  s_mov_b32 s52, 5120
  s_cmp_ge_u32 s46, 2
  s_cbranch_scc0 ka_pf1
  s_mul_i32 s28, s20, 655360
  s_add_u32 s28, s28, 0x402800
  s_sub_u32 s29, s46, 2
  s_lshl_b32 s29, s29, 12
  s_add_u32 s51, s28, s29
  s_mov_b32 s52, 10240
  s_cmp_ge_u32 s46, 5
  s_cbranch_scc0 ka_pf1
  s_mul_i32 s28, s20, 1310720
  s_add_u32 s28, s28, 0xe00000
  s_sub_u32 s29, s46, 5
  s_lshl_b32 s29, s29, 12
  s_add_u32 s51, s28, s29
  s_mov_b32 s52, 20480
ka_pf1:
  s_mul_i32 s53, s20, 655360
  s_add_u32 s53, s53, 0x400000
  s_mov_b32 s54, 0
  s_mov_b32 s55, 0
  s_mov_b32 s56, 0
  v_mov_b32 v7, 0
ka_pfl:
  s_cmp_gt_u32 s54, 3
  s_cbranch_scc0 ka_pfgo
  s_sub_u32 s28, s54, 3
  s_mul_i32 s28, s28, 10240
  s_add_u32 s28, s28, s53
  s_mov_b32 s45, 0
ka_pfw:
  buffer_load_dword v8, v7, s[8:11], s28 offen sc1
  s_add_u32 s45, s45, 1
  s_waitcnt vmcnt(0)
  v_readfirstlane_b32 s29, v8
  s_cmp_lg_u32 s29, -1
  s_cbranch_scc1 ka_pfgo
  s_sleep 4
  s_cmp_lt_u32 s45, 400000
  s_cbranch_scc1 ka_pfw
  s_branch ka_exit
ka_pfgo:
  s_cmp_lt_u32 s46, 10
  s_cbranch_scc0 ka_pf2
  buffer_load_dword v9, v4, s[8:11], s51 offen sc1
ka_pf2:
  s_cmp_gt_u32 s55, s54
  s_cbranch_scc1 ka_wp_68_ok
  s_mov_b32 s45, 0
ka_wp_68_spin:
  buffer_load_dword v2, v5, s[8:11], 0 offen sc1
  s_add_u32 s45, s45, 1
  s_waitcnt vmcnt(0)
  v_min_u32_dpp v3, v2, v2 quad_perm:[1,0,3,2] row_mask:0xf bank_mask:0xf
  s_nop 1
  v_min_u32_dpp v2, v3, v3 quad_perm:[2,3,0,1] row_mask:0xf bank_mask:0xf
  s_nop 1
  v_min_u32_dpp v3, v2, v2 row_half_mirror row_mask:0xf bank_mask:0xf
  s_nop 1
  v_min_u32_dpp v2, v3, v3 row_mirror row_mask:0xf bank_mask:0xf
  s_nop 0
  v_readfirstlane_b32 s55, v2
  s_cmp_gt_u32 s55, s54
  s_cbranch_scc1 ka_wp_68_ok
  s_cmp_lt_u32 s45, 400000
  s_cbranch_scc1 ka_wp_68_spin
  s_branch ka_abort
ka_wp_68_ok:
  buffer_load_dword v10, v4, s[8:11], s48 offen sc1
  buffer_load_dword v11, v4, s[8:11], s49 offen sc1
  buffer_load_dword v12, v4, s[8:11], s50 offen sc1
  s_cmp_gt_u32 s56, s54
  s_cbranch_scc1 ka_wp_69_ok
  s_mov_b32 s45, 0
ka_wp_69_spin:
  buffer_load_dword v2, v6, s[8:11], 0 offen sc1
  s_add_u32 s45, s45, 1
  s_waitcnt vmcnt(0)
  v_min_u32_dpp v3, v2, v2 quad_perm:[1,0,3,2] row_mask:0xf bank_mask:0xf
  s_nop 1
  v_min_u32_dpp v2, v3, v3 quad_perm:[2,3,0,1] row_mask:0xf bank_mask:0xf
  s_nop 1
  v_min_u32_dpp v3, v2, v2 row_half_mirror row_mask:0xf bank_mask:0xf
  s_nop 1
  v_min_u32_dpp v2, v3, v3 quad_perm:[0,1,2,3] row_mask:0xf bank_mask:0xf
  s_nop 0
  v_readfirstlane_b32 s56, v2
  s_cmp_gt_u32 s56, s54
  s_cbranch_scc1 ka_wp_69_ok
  s_cmp_lt_u32 s45, 400000
  s_cbranch_scc1 ka_wp_69_spin
  s_branch ka_abort
ka_wp_69_ok:
  s_add_u32 s28, s47, 0
  buffer_load_dword v13, v4, s[8:11], s28 offen sc1
  s_add_u32 s28, s47, 4096
  buffer_load_dword v14, v4, s[8:11], s28 offen sc1
  s_add_u32 s28, s47, 8192
  buffer_load_dword v15, v4, s[8:11], s28 offen sc1
  s_add_u32 s28, s47, 12288
  buffer_load_dword v16, v4, s[8:11], s28 offen sc1
  s_add_u32 s28, s47, 16384
  buffer_load_dword v17, v4, s[8:11], s28 offen sc1
  s_add_u32 s47, s47, 1310720
  s_add_u32 s48, s48, 12288
  s_add_u32 s49, s49, 12288
  s_add_u32 s50, s50, 12288
  s_add_u32 s51, s51, s52
  s_add_u32 s54, s54, 1
  s_waitcnt vmcnt(0)
  s_cmp_lt_u32 s54, 64
  s_cbranch_scc1 ka_pfl
  s_branch ka_exit
ka_qkv:
  s_mul_i32 s26, s23, 43
  s_lshr_b32 s26, s26, 10
  s_mul_i32 s27, s26, 24
  s_sub_u32 s27, s23, s27
  s_cmp_eq_u32 s26, 0
  s_cselect_b32 s28, s36, s38
  s_cselect_b32 s29, s37, s39
  s_cmp_eq_u32 s26, 2
  s_cselect_b32 s28, s40, s28
  s_cselect_b32 s29, s41, s29
  s_mov_b32 s12, s28
  s_and_b32 s13, s29, 0xffff
  s_mov_b32 s14, 0x780000
  s_mov_b32 s15, 0x20000
  s_mul_i32 s46, s26, 0x1800000
  s_add_u32 s46, s46, 0x4800000
  s_lshl_b32 s47, s26, 10
  s_lshl_b32 s28, s27, 2
  s_add_u32 s47, s47, s28
  s_add_u32 s47, s47, 0
  s_lshl_b32 s28, s27, 3
  s_lshl_b32 s29, s21, 1
  s_add_u32 s28, s28, s29
  s_add_u32 s29, s28, 0
  s_mul_i32 s30, s29, 171
  s_lshr_b32 s30, s30, 10
  s_mul_i32 s31, s30, 6
  s_sub_u32 s31, s29, s31
  s_mul_i32 s30, s30, 786432
  s_lshl_b32 s31, s31, 11
  s_add_u32 s30, s30, s31
  s_add_u32 s48, s30, s46
  s_add_u32 s29, s28, 1
  s_mul_i32 s30, s29, 171
  s_lshr_b32 s30, s30, 10
  s_mul_i32 s31, s30, 6
  s_sub_u32 s31, s29, s31
  s_mul_i32 s30, s30, 786432
  s_lshl_b32 s31, s31, 11
  s_add_u32 s30, s30, s31
  s_add_u32 s49, s30, s46
  v_and_b32 v1, 63, v0
  v_lshrrev_b32 v2, 4, v1
  v_bfe_u32 v3, v1, 2, 2
  v_and_b32 v4, 3, v1
  s_lshr_b32 s28, s21, 1
  s_lshl_b32 s28, s28, 2
  v_add_u32 v5, s28, v3
  v_mul_u32_u24 v5, 12288, v5
  s_and_b32 s28, s21, 1
  s_lshl_b32 s28, s28, 8
  s_lshl_b32 s29, s27, 9
  s_add_u32 s28, s28, s29
  v_add_u32 v5, s28, v5
  v_lshlrev_b32 v6, 6, v2
  v_add_u32 v5, v5, v6
  v_lshlrev_b32 v6, 4, v4
  v_add_u32 v5, v5, v6
  v_lshrrev_b32 v6, 1, v2
  v_lshlrev_b32 v7, 12, v6
  v_lshlrev_b32 v6, 6, v3
  v_add_u32 v7, v7, v6
  v_and_b32 v6, 1, v2
  v_lshlrev_b32 v6, 5, v6
  v_add_u32 v7, v7, v6
  v_lshrrev_b32 v6, 1, v4
  v_lshlrev_b32 v6, 4, v6
  v_add_u32 v7, v7, v6
  v_and_b32 v6, 1, v4
  v_lshlrev_b32 v6, 3, v6
  v_add_u32 v7, v7, v6
  s_lshl_b32 s28, s21, 9
  v_add_u32 v7, s28, v7
  s_lshl_b32 s29, s21, 10
  s_add_u32 m0, s29, 0
  s_mov_b32 s28, 0
  buffer_load_dwordx4 v5, s[12:15], s28 offen lds
  s_lshl_b32 s29, s21, 10
  s_add_u32 m0, s29, 4096
  s_mov_b32 s28, 98304
  buffer_load_dwordx4 v5, s[12:15], s28 offen lds
  s_lshl_b32 s29, s21, 10
  s_add_u32 m0, s29, 8192
  s_mov_b32 s28, 196608
  buffer_load_dwordx4 v5, s[12:15], s28 offen lds
  s_lshl_b32 s29, s21, 10
  s_add_u32 m0, s29, 12288
  s_mov_b32 s28, 294912
  buffer_load_dwordx4 v5, s[12:15], s28 offen lds
  s_lshl_b32 s29, s21, 10
  s_add_u32 m0, s29, 16384
  s_mov_b32 s28, 393216
  buffer_load_dwordx4 v5, s[12:15], s28 offen lds
  s_lshl_b32 s29, s21, 10
  s_add_u32 m0, s29, 20480
  s_mov_b32 s28, 491520
  buffer_load_dwordx4 v5, s[12:15], s28 offen lds
  s_lshl_b32 s29, s21, 10
  s_add_u32 m0, s29, 24576
  s_mov_b32 s28, 589824
  buffer_load_dwordx4 v5, s[12:15], s28 offen lds
  s_lshl_b32 s29, s21, 10
  s_add_u32 m0, s29, 28672
  s_mov_b32 s28, 688128
  buffer_load_dwordx4 v5, s[12:15], s28 offen lds
  s_lshl_b32 s29, s21, 10
  s_add_u32 m0, s29, 32768
  s_mov_b32 s28, 786432
  buffer_load_dwordx4 v5, s[12:15], s28 offen lds
  s_lshl_b32 s29, s21, 10
  s_add_u32 m0, s29, 36864
  s_mov_b32 s28, 884736
  buffer_load_dwordx4 v5, s[12:15], s28 offen lds
  s_lshl_b32 s29, s21, 10
  s_add_u32 m0, s29, 40960
  s_mov_b32 s28, 983040
  buffer_load_dwordx4 v5, s[12:15], s28 offen lds
  s_lshl_b32 s29, s21, 10
  s_add_u32 m0, s29, 45056
  s_mov_b32 s28, 1081344
  buffer_load_dwordx4 v5, s[12:15], s28 offen lds
  s_lshl_b32 s29, s21, 10
  s_add_u32 m0, s29, 49152
  s_mov_b32 s28, 1179648
  buffer_load_dwordx4 v5, s[12:15], s28 offen lds
  s_lshl_b32 s29, s21, 10
  s_add_u32 m0, s29, 53248
  s_mov_b32 s28, 1277952
  buffer_load_dwordx4 v5, s[12:15], s28 offen lds
  s_lshl_b32 s29, s21, 10
  s_add_u32 m0, s29, 57344
  s_mov_b32 s28, 1376256
  buffer_load_dwordx4 v5, s[12:15], s28 offen lds
  s_lshl_b32 s29, s21, 10
  s_add_u32 m0, s29, 61440
  s_mov_b32 s28, 1474560
  buffer_load_dwordx4 v5, s[12:15], s28 offen lds
  s_lshl_b32 s29, s21, 10
  s_add_u32 m0, s29, 65536
  s_mov_b32 s28, 1572864
  buffer_load_dwordx4 v5, s[12:15], s28 offen lds
  s_lshl_b32 s29, s21, 10
  s_add_u32 m0, s29, 69632
  s_mov_b32 s28, 1671168
  buffer_load_dwordx4 v5, s[12:15], s28 offen lds
  s_lshl_b32 s29, s21, 10
  s_add_u32 m0, s29, 73728
  s_mov_b32 s28, 1769472
  buffer_load_dwordx4 v5, s[12:15], s28 offen lds
  s_lshl_b32 s29, s21, 10
  s_add_u32 m0, s29, 77824
  s_mov_b32 s28, 1867776
  buffer_load_dwordx4 v5, s[12:15], s28 offen lds
  s_lshl_b32 s29, s21, 10
  s_add_u32 m0, s29, 81920
  s_mov_b32 s28, 1966080
  buffer_load_dwordx4 v5, s[12:15], s28 offen lds
  s_lshl_b32 s29, s21, 10
  s_add_u32 m0, s29, 86016
  s_mov_b32 s28, 2064384
  buffer_load_dwordx4 v5, s[12:15], s28 offen lds
  s_lshl_b32 s29, s21, 10
  s_add_u32 m0, s29, 90112
  s_mov_b32 s28, 2162688
  buffer_load_dwordx4 v5, s[12:15], s28 offen lds
  s_lshl_b32 s29, s21, 10
  s_add_u32 m0, s29, 94208
  s_mov_b32 s28, 2260992
  buffer_load_dwordx4 v5, s[12:15], s28 offen lds
  s_waitcnt vmcnt(20)
  s_cmp_eq_u32 s21, 3
  s_cbranch_scc0 lna_70
  s_mov_b64 s[24:25], exec
  s_mov_b64 exec, 1
  v_mov_b32 v2, 4992
  v_mov_b32 v3, 1
  buffer_atomic_add v3, v2, s[8:11], 0 offen
  s_mov_b64 exec, s[24:25]
lna_70:
  s_barrier
  s_lshl_b32 s29, s21, 10
  s_add_u32 m0, s29, 98304
  s_mov_b32 s28, 2359296
  buffer_load_dwordx4 v5, s[12:15], s28 offen lds
  s_lshl_b32 s29, s21, 10
  s_add_u32 m0, s29, 102400
  s_mov_b32 s28, 2457600
  buffer_load_dwordx4 v5, s[12:15], s28 offen lds
  s_lshl_b32 s29, s21, 10
  s_add_u32 m0, s29, 106496
  s_mov_b32 s28, 2555904
  buffer_load_dwordx4 v5, s[12:15], s28 offen lds
  s_lshl_b32 s29, s21, 10
  s_add_u32 m0, s29, 110592
  s_mov_b32 s28, 2654208
  buffer_load_dwordx4 v5, s[12:15], s28 offen lds
  v_add_u32 v8, 0, v7
  ds_read_b64_tr_b16 a[0:1], v8 offset:0
  ds_read_b64_tr_b16 a[2:3], v8 offset:2048
  ds_read_b64_tr_b16 a[4:5], v8 offset:8192
  ds_read_b64_tr_b16 a[6:7], v8 offset:10240
  ds_read_b64_tr_b16 a[160:161], v8 offset:256
  ds_read_b64_tr_b16 a[162:163], v8 offset:2304
  ds_read_b64_tr_b16 a[164:165], v8 offset:8448
  ds_read_b64_tr_b16 a[166:167], v8 offset:10496
  s_waitcnt lgkmcnt(0)
  s_waitcnt vmcnt(20)
  s_barrier
  s_lshl_b32 s29, s21, 10
  s_add_u32 m0, s29, 114688
  s_mov_b32 s28, 2752512
  buffer_load_dwordx4 v5, s[12:15], s28 offen lds
  s_lshl_b32 s29, s21, 10
  s_add_u32 m0, s29, 118784
  s_mov_b32 s28, 2850816
  buffer_load_dwordx4 v5, s[12:15], s28 offen lds
  s_lshl_b32 s29, s21, 10
  s_add_u32 m0, s29, 122880
  s_mov_b32 s28, 2949120
  buffer_load_dwordx4 v5, s[12:15], s28 offen lds
  s_lshl_b32 s29, s21, 10
  s_add_u32 m0, s29, 126976
  s_mov_b32 s28, 3047424
  buffer_load_dwordx4 v5, s[12:15], s28 offen lds
  v_add_u32 v8, 16384, v7
  ds_read_b64_tr_b16 a[8:9], v8 offset:0
  ds_read_b64_tr_b16 a[10:11], v8 offset:2048
  ds_read_b64_tr_b16 a[12:13], v8 offset:8192
  ds_read_b64_tr_b16 a[14:15], v8 offset:10240
  ds_read_b64_tr_b16 a[168:169], v8 offset:256
  ds_read_b64_tr_b16 a[170:171], v8 offset:2304
  ds_read_b64_tr_b16 a[172:173], v8 offset:8448
  ds_read_b64_tr_b16 a[174:175], v8 offset:10496
  s_waitcnt lgkmcnt(0)
  s_waitcnt vmcnt(20)
  s_barrier
  s_lshl_b32 s29, s21, 10
  s_add_u32 m0, s29, 0
  s_mov_b32 s28, 3145728
  buffer_load_dwordx4 v5, s[12:15], s28 offen lds
  s_lshl_b32 s29, s21, 10
  s_add_u32 m0, s29, 4096
  s_mov_b32 s28, 3244032
  buffer_load_dwordx4 v5, s[12:15], s28 offen lds
  s_lshl_b32 s29, s21, 10
  s_add_u32 m0, s29, 8192
  s_mov_b32 s28, 3342336
  buffer_load_dwordx4 v5, s[12:15], s28 offen lds
  s_lshl_b32 s29, s21, 10
  s_add_u32 m0, s29, 12288
  s_mov_b32 s28, 3440640
  buffer_load_dwordx4 v5, s[12:15], s28 offen lds
  v_add_u32 v8, 32768, v7
  ds_read_b64_tr_b16 a[16:17], v8 offset:0
  ds_read_b64_tr_b16 a[18:19], v8 offset:2048
  ds_read_b64_tr_b16 a[20:21], v8 offset:8192
  ds_read_b64_tr_b16 a[22:23], v8 offset:10240
  ds_read_b64_tr_b16 a[176:177], v8 offset:256
  ds_read_b64_tr_b16 a[178:179], v8 offset:2304
  ds_read_b64_tr_b16 a[180:181], v8 offset:8448
  ds_read_b64_tr_b16 a[182:183], v8 offset:10496
  s_waitcnt lgkmcnt(0)
  s_waitcnt vmcnt(20)
  s_barrier
  s_lshl_b32 s29, s21, 10
  s_add_u32 m0, s29, 16384
  s_mov_b32 s28, 3538944
  buffer_load_dwordx4 v5, s[12:15], s28 offen lds
  s_lshl_b32 s29, s21, 10
  s_add_u32 m0, s29, 20480
  s_mov_b32 s28, 3637248
  buffer_load_dwordx4 v5, s[12:15], s28 offen lds
  s_lshl_b32 s29, s21, 10
  s_add_u32 m0, s29, 24576
  s_mov_b32 s28, 3735552
  buffer_load_dwordx4 v5, s[12:15], s28 offen lds
  s_lshl_b32 s29, s21, 10
  s_add_u32 m0, s29, 28672
  s_mov_b32 s28, 3833856
  buffer_load_dwordx4 v5, s[12:15], s28 offen lds
  v_add_u32 v8, 49152, v7
  ds_read_b64_tr_b16 a[24:25], v8 offset:0
  ds_read_b64_tr_b16 a[26:27], v8 offset:2048
  ds_read_b64_tr_b16 a[28:29], v8 offset:8192
  ds_read_b64_tr_b16 a[30:31], v8 offset:10240
  ds_read_b64_tr_b16 a[184:185], v8 offset:256
  ds_read_b64_tr_b16 a[186:187], v8 offset:2304
  ds_read_b64_tr_b16 a[188:189], v8 offset:8448
  ds_read_b64_tr_b16 a[190:191], v8 offset:10496
  s_waitcnt lgkmcnt(0)
  s_waitcnt vmcnt(20)
  s_barrier
  s_lshl_b32 s29, s21, 10
  s_add_u32 m0, s29, 32768
  s_mov_b32 s28, 3932160
  buffer_load_dwordx4 v5, s[12:15], s28 offen lds
  s_lshl_b32 s29, s21, 10
  s_add_u32 m0, s29, 36864
  s_mov_b32 s28, 4030464
  buffer_load_dwordx4 v5, s[12:15], s28 offen lds
  s_lshl_b32 s29, s21, 10
  s_add_u32 m0, s29, 40960
  s_mov_b32 s28, 4128768
  buffer_load_dwordx4 v5, s[12:15], s28 offen lds
  s_lshl_b32 s29, s21, 10
  s_add_u32 m0, s29, 45056
  s_mov_b32 s28, 4227072
  buffer_load_dwordx4 v5, s[12:15], s28 offen lds
  v_add_u32 v8, 65536, v7
  ds_read_b64_tr_b16 a[32:33], v8 offset:0
  ds_read_b64_tr_b16 a[34:35], v8 offset:2048
  ds_read_b64_tr_b16 a[36:37], v8 offset:8192
  ds_read_b64_tr_b16 a[38:39], v8 offset:10240
  ds_read_b64_tr_b16 a[192:193], v8 offset:256
  ds_read_b64_tr_b16 a[194:195], v8 offset:2304
  ds_read_b64_tr_b16 a[196:197], v8 offset:8448
  ds_read_b64_tr_b16 a[198:199], v8 offset:10496
  s_waitcnt lgkmcnt(0)
  s_waitcnt vmcnt(20)
  s_barrier
  s_lshl_b32 s29, s21, 10
  s_add_u32 m0, s29, 49152
  s_mov_b32 s28, 4325376
  buffer_load_dwordx4 v5, s[12:15], s28 offen lds
  s_lshl_b32 s29, s21, 10
  s_add_u32 m0, s29, 53248
  s_mov_b32 s28, 4423680
  buffer_load_dwordx4 v5, s[12:15], s28 offen lds
  s_lshl_b32 s29, s21, 10
  s_add_u32 m0, s29, 57344
  s_mov_b32 s28, 4521984
  buffer_load_dwordx4 v5, s[12:15], s28 offen lds
  s_lshl_b32 s29, s21, 10
  s_add_u32 m0, s29, 61440
  s_mov_b32 s28, 4620288
  buffer_load_dwordx4 v5, s[12:15], s28 offen lds
  v_add_u32 v8, 81920, v7
  ds_read_b64_tr_b16 a[40:41], v8 offset:0
  ds_read_b64_tr_b16 a[42:43], v8 offset:2048
  ds_read_b64_tr_b16 a[44:45], v8 offset:8192
  ds_read_b64_tr_b16 a[46:47], v8 offset:10240
  ds_read_b64_tr_b16 a[200:201], v8 offset:256
  ds_read_b64_tr_b16 a[202:203], v8 offset:2304
  ds_read_b64_tr_b16 a[204:205], v8 offset:8448
  ds_read_b64_tr_b16 a[206:207], v8 offset:10496
  s_waitcnt lgkmcnt(0)
  s_waitcnt vmcnt(20)
  s_barrier
  s_lshl_b32 s29, s21, 10
  s_add_u32 m0, s29, 65536
  s_mov_b32 s28, 4718592
  buffer_load_dwordx4 v5, s[12:15], s28 offen lds
  s_lshl_b32 s29, s21, 10
  s_add_u32 m0, s29, 69632
  s_mov_b32 s28, 4816896
  buffer_load_dwordx4 v5, s[12:15], s28 offen lds
  s_lshl_b32 s29, s21, 10
  s_add_u32 m0, s29, 73728
  s_mov_b32 s28, 4915200
  buffer_load_dwordx4 v5, s[12:15], s28 offen lds
  s_lshl_b32 s29, s21, 10
  s_add_u32 m0, s29, 77824
  s_mov_b32 s28, 5013504
  buffer_load_dwordx4 v5, s[12:15], s28 offen lds
  v_add_u32 v8, 98304, v7
  ds_read_b64_tr_b16 a[48:49], v8 offset:0
  ds_read_b64_tr_b16 a[50:51], v8 offset:2048
  ds_read_b64_tr_b16 a[52:53], v8 offset:8192
  ds_read_b64_tr_b16 a[54:55], v8 offset:10240
  ds_read_b64_tr_b16 a[208:209], v8 offset:256
  ds_read_b64_tr_b16 a[210:211], v8 offset:2304
  ds_read_b64_tr_b16 a[212:213], v8 offset:8448
  ds_read_b64_tr_b16 a[214:215], v8 offset:10496
  s_waitcnt lgkmcnt(0)
  s_waitcnt vmcnt(20)
  s_barrier
  s_lshl_b32 s29, s21, 10
  s_add_u32 m0, s29, 81920
  s_mov_b32 s28, 5111808
  buffer_load_dwordx4 v5, s[12:15], s28 offen lds
  s_lshl_b32 s29, s21, 10
  s_add_u32 m0, s29, 86016
  s_mov_b32 s28, 5210112
  buffer_load_dwordx4 v5, s[12:15], s28 offen lds
  s_lshl_b32 s29, s21, 10
  s_add_u32 m0, s29, 90112
  s_mov_b32 s28, 5308416
  buffer_load_dwordx4 v5, s[12:15], s28 offen lds
  s_lshl_b32 s29, s21, 10
  s_add_u32 m0, s29, 94208
  s_mov_b32 s28, 5406720
  buffer_load_dwordx4 v5, s[12:15], s28 offen lds
  v_add_u32 v8, 114688, v7
  ds_read_b64_tr_b16 a[56:57], v8 offset:0
  ds_read_b64_tr_b16 a[58:59], v8 offset:2048
  ds_read_b64_tr_b16 a[60:61], v8 offset:8192
  ds_read_b64_tr_b16 a[62:63], v8 offset:10240
  ds_read_b64_tr_b16 a[216:217], v8 offset:256
  ds_read_b64_tr_b16 a[218:219], v8 offset:2304
  ds_read_b64_tr_b16 a[220:221], v8 offset:8448
  ds_read_b64_tr_b16 a[222:223], v8 offset:10496
  s_waitcnt lgkmcnt(0)
  s_waitcnt vmcnt(20)
  s_barrier
  s_lshl_b32 s29, s21, 10
  s_add_u32 m0, s29, 98304
  s_mov_b32 s28, 5505024
  buffer_load_dwordx4 v5, s[12:15], s28 offen lds
  s_lshl_b32 s29, s21, 10
  s_add_u32 m0, s29, 102400
  s_mov_b32 s28, 5603328
  buffer_load_dwordx4 v5, s[12:15], s28 offen lds
  s_lshl_b32 s29, s21, 10
  s_add_u32 m0, s29, 106496
  s_mov_b32 s28, 5701632
  buffer_load_dwordx4 v5, s[12:15], s28 offen lds
  s_lshl_b32 s29, s21, 10
  s_add_u32 m0, s29, 110592
  s_mov_b32 s28, 5799936
  buffer_load_dwordx4 v5, s[12:15], s28 offen lds
  v_add_u32 v8, 0, v7
  ds_read_b64_tr_b16 a[64:65], v8 offset:0
  ds_read_b64_tr_b16 a[66:67], v8 offset:2048
  ds_read_b64_tr_b16 a[68:69], v8 offset:8192
  ds_read_b64_tr_b16 a[70:71], v8 offset:10240
  ds_read_b64_tr_b16 a[224:225], v8 offset:256
  ds_read_b64_tr_b16 a[226:227], v8 offset:2304
  ds_read_b64_tr_b16 a[228:229], v8 offset:8448
  ds_read_b64_tr_b16 a[230:231], v8 offset:10496
  s_waitcnt lgkmcnt(0)
  s_waitcnt vmcnt(20)
  s_barrier
  s_lshl_b32 s29, s21, 10
  s_add_u32 m0, s29, 114688
  s_mov_b32 s28, 5898240
  buffer_load_dwordx4 v5, s[12:15], s28 offen lds
  s_lshl_b32 s29, s21, 10
  s_add_u32 m0, s29, 118784
  s_mov_b32 s28, 5996544
  buffer_load_dwordx4 v5, s[12:15], s28 offen lds
  s_lshl_b32 s29, s21, 10
  s_add_u32 m0, s29, 122880
  s_mov_b32 s28, 6094848
  buffer_load_dwordx4 v5, s[12:15], s28 offen lds
  s_lshl_b32 s29, s21, 10
  s_add_u32 m0, s29, 126976
  s_mov_b32 s28, 6193152
  buffer_load_dwordx4 v5, s[12:15], s28 offen lds
  v_add_u32 v8, 16384, v7
  ds_read_b64_tr_b16 a[72:73], v8 offset:0
  ds_read_b64_tr_b16 a[74:75], v8 offset:2048
  ds_read_b64_tr_b16 a[76:77], v8 offset:8192
  ds_read_b64_tr_b16 a[78:79], v8 offset:10240
  ds_read_b64_tr_b16 a[232:233], v8 offset:256
  ds_read_b64_tr_b16 a[234:235], v8 offset:2304
  ds_read_b64_tr_b16 a[236:237], v8 offset:8448
  ds_read_b64_tr_b16 a[238:239], v8 offset:10496
  s_waitcnt lgkmcnt(0)
  s_waitcnt vmcnt(20)
  s_barrier
  s_lshl_b32 s29, s21, 10
  s_add_u32 m0, s29, 0
  s_mov_b32 s28, 6291456
  buffer_load_dwordx4 v5, s[12:15], s28 offen lds
  s_lshl_b32 s29, s21, 10
  s_add_u32 m0, s29, 4096
  s_mov_b32 s28, 6389760
  buffer_load_dwordx4 v5, s[12:15], s28 offen lds
  s_lshl_b32 s29, s21, 10
  s_add_u32 m0, s29, 8192
  s_mov_b32 s28, 6488064
  buffer_load_dwordx4 v5, s[12:15], s28 offen lds
  s_lshl_b32 s29, s21, 10
  s_add_u32 m0, s29, 12288
  s_mov_b32 s28, 6586368
  buffer_load_dwordx4 v5, s[12:15], s28 offen lds
  v_add_u32 v8, 32768, v7
  ds_read_b64_tr_b16 a[80:81], v8 offset:0
  ds_read_b64_tr_b16 a[82:83], v8 offset:2048
  ds_read_b64_tr_b16 a[84:85], v8 offset:8192
  ds_read_b64_tr_b16 a[86:87], v8 offset:10240
  ds_read_b64_tr_b16 a[240:241], v8 offset:256
  ds_read_b64_tr_b16 a[242:243], v8 offset:2304
  ds_read_b64_tr_b16 a[244:245], v8 offset:8448
  ds_read_b64_tr_b16 a[246:247], v8 offset:10496
  s_waitcnt lgkmcnt(0)
  s_waitcnt vmcnt(20)
  s_barrier
  s_lshl_b32 s29, s21, 10
  s_add_u32 m0, s29, 16384
  s_mov_b32 s28, 6684672
  buffer_load_dwordx4 v5, s[12:15], s28 offen lds
  s_lshl_b32 s29, s21, 10
  s_add_u32 m0, s29, 20480
  s_mov_b32 s28, 6782976
  buffer_load_dwordx4 v5, s[12:15], s28 offen lds
  s_lshl_b32 s29, s21, 10
  s_add_u32 m0, s29, 24576
  s_mov_b32 s28, 6881280
  buffer_load_dwordx4 v5, s[12:15], s28 offen lds
  s_lshl_b32 s29, s21, 10
  s_add_u32 m0, s29, 28672
  s_mov_b32 s28, 6979584
  buffer_load_dwordx4 v5, s[12:15], s28 offen lds
  v_add_u32 v8, 49152, v7
  ds_read_b64_tr_b16 a[88:89], v8 offset:0
  ds_read_b64_tr_b16 a[90:91], v8 offset:2048
  ds_read_b64_tr_b16 a[92:93], v8 offset:8192
  ds_read_b64_tr_b16 a[94:95], v8 offset:10240
  ds_read_b64_tr_b16 a[248:249], v8 offset:256
  ds_read_b64_tr_b16 a[250:251], v8 offset:2304
  ds_read_b64_tr_b16 a[252:253], v8 offset:8448
  ds_read_b64_tr_b16 a[254:255], v8 offset:10496
  s_waitcnt lgkmcnt(0)
  s_waitcnt vmcnt(20)
  s_barrier
  s_lshl_b32 s29, s21, 10
  s_add_u32 m0, s29, 32768
  s_mov_b32 s28, 7077888
  buffer_load_dwordx4 v5, s[12:15], s28 offen lds
  s_lshl_b32 s29, s21, 10
  s_add_u32 m0, s29, 36864
  s_mov_b32 s28, 7176192
  buffer_load_dwordx4 v5, s[12:15], s28 offen lds
  s_lshl_b32 s29, s21, 10
  s_add_u32 m0, s29, 40960
  s_mov_b32 s28, 7274496
  buffer_load_dwordx4 v5, s[12:15], s28 offen lds
  s_lshl_b32 s29, s21, 10
  s_add_u32 m0, s29, 45056
  s_mov_b32 s28, 7372800
  buffer_load_dwordx4 v5, s[12:15], s28 offen lds
  v_add_u32 v8, 65536, v7
  ds_read_b64_tr_b16 a[96:97], v8 offset:0
  ds_read_b64_tr_b16 a[98:99], v8 offset:2048
  ds_read_b64_tr_b16 a[100:101], v8 offset:8192
  ds_read_b64_tr_b16 a[102:103], v8 offset:10240
  ds_read_b64_tr_b16 v[192:193], v8 offset:256
  ds_read_b64_tr_b16 v[194:195], v8 offset:2304
  ds_read_b64_tr_b16 v[196:197], v8 offset:8448
  ds_read_b64_tr_b16 v[198:199], v8 offset:10496
  s_waitcnt lgkmcnt(0)
  s_waitcnt vmcnt(20)
  s_barrier
  s_lshl_b32 s29, s21, 10
  s_add_u32 m0, s29, 49152
  s_mov_b32 s28, 7471104
  buffer_load_dwordx4 v5, s[12:15], s28 offen lds
  s_lshl_b32 s29, s21, 10
  s_add_u32 m0, s29, 53248
  s_mov_b32 s28, 7569408
  buffer_load_dwordx4 v5, s[12:15], s28 offen lds
  s_lshl_b32 s29, s21, 10
  s_add_u32 m0, s29, 57344
  s_mov_b32 s28, 7667712
  buffer_load_dwordx4 v5, s[12:15], s28 offen lds
  s_lshl_b32 s29, s21, 10
  s_add_u32 m0, s29, 61440
  s_mov_b32 s28, 7766016
  buffer_load_dwordx4 v5, s[12:15], s28 offen lds
  v_add_u32 v8, 81920, v7
  ds_read_b64_tr_b16 a[104:105], v8 offset:0
  ds_read_b64_tr_b16 a[106:107], v8 offset:2048
  ds_read_b64_tr_b16 a[108:109], v8 offset:8192
  ds_read_b64_tr_b16 a[110:111], v8 offset:10240
  ds_read_b64_tr_b16 v[200:201], v8 offset:256
  ds_read_b64_tr_b16 v[202:203], v8 offset:2304
  ds_read_b64_tr_b16 v[204:205], v8 offset:8448
  ds_read_b64_tr_b16 v[206:207], v8 offset:10496
  s_waitcnt lgkmcnt(0)
  s_waitcnt vmcnt(20)
  s_barrier
  v_add_u32 v8, 98304, v7
  ds_read_b64_tr_b16 a[112:113], v8 offset:0
  ds_read_b64_tr_b16 a[114:115], v8 offset:2048
  ds_read_b64_tr_b16 a[116:117], v8 offset:8192
  ds_read_b64_tr_b16 a[118:119], v8 offset:10240
  ds_read_b64_tr_b16 v[208:209], v8 offset:256
  ds_read_b64_tr_b16 v[210:211], v8 offset:2304
  ds_read_b64_tr_b16 v[212:213], v8 offset:8448
  ds_read_b64_tr_b16 v[214:215], v8 offset:10496
  s_waitcnt lgkmcnt(0)
  s_waitcnt vmcnt(16)
  s_barrier
  v_add_u32 v8, 114688, v7
  ds_read_b64_tr_b16 a[120:121], v8 offset:0
  ds_read_b64_tr_b16 a[122:123], v8 offset:2048
  ds_read_b64_tr_b16 a[124:125], v8 offset:8192
  ds_read_b64_tr_b16 a[126:127], v8 offset:10240
  ds_read_b64_tr_b16 v[216:217], v8 offset:256
  ds_read_b64_tr_b16 v[218:219], v8 offset:2304
  ds_read_b64_tr_b16 v[220:221], v8 offset:8448
  ds_read_b64_tr_b16 v[222:223], v8 offset:10496
  s_waitcnt lgkmcnt(0)
  s_waitcnt vmcnt(12)
  s_barrier
  v_add_u32 v8, 0, v7
  ds_read_b64_tr_b16 a[128:129], v8 offset:0
  ds_read_b64_tr_b16 a[130:131], v8 offset:2048
  ds_read_b64_tr_b16 a[132:133], v8 offset:8192
  ds_read_b64_tr_b16 a[134:135], v8 offset:10240
  ds_read_b64_tr_b16 v[224:225], v8 offset:256
  ds_read_b64_tr_b16 v[226:227], v8 offset:2304
  ds_read_b64_tr_b16 v[228:229], v8 offset:8448
  ds_read_b64_tr_b16 v[230:231], v8 offset:10496
  s_waitcnt lgkmcnt(0)
  s_waitcnt vmcnt(8)
  s_barrier
  v_add_u32 v8, 16384, v7
  ds_read_b64_tr_b16 a[136:137], v8 offset:0
  ds_read_b64_tr_b16 a[138:139], v8 offset:2048
  ds_read_b64_tr_b16 a[140:141], v8 offset:8192
  ds_read_b64_tr_b16 a[142:143], v8 offset:10240
  ds_read_b64_tr_b16 v[232:233], v8 offset:256
  ds_read_b64_tr_b16 v[234:235], v8 offset:2304
  ds_read_b64_tr_b16 v[236:237], v8 offset:8448
  ds_read_b64_tr_b16 v[238:239], v8 offset:10496
  s_waitcnt lgkmcnt(0)
  s_waitcnt vmcnt(4)
  s_barrier
  v_add_u32 v8, 32768, v7
  ds_read_b64_tr_b16 a[144:145], v8 offset:0
  ds_read_b64_tr_b16 a[146:147], v8 offset:2048
  ds_read_b64_tr_b16 a[148:149], v8 offset:8192
  ds_read_b64_tr_b16 a[150:151], v8 offset:10240
  ds_read_b64_tr_b16 v[240:241], v8 offset:256
  ds_read_b64_tr_b16 v[242:243], v8 offset:2304
  ds_read_b64_tr_b16 v[244:245], v8 offset:8448
  ds_read_b64_tr_b16 v[246:247], v8 offset:10496
  s_waitcnt lgkmcnt(0)
  s_waitcnt vmcnt(0)
  s_barrier
  v_add_u32 v8, 49152, v7
  ds_read_b64_tr_b16 a[152:153], v8 offset:0
  ds_read_b64_tr_b16 a[154:155], v8 offset:2048
  ds_read_b64_tr_b16 a[156:157], v8 offset:8192
  ds_read_b64_tr_b16 a[158:159], v8 offset:10240
  ds_read_b64_tr_b16 v[248:249], v8 offset:256
  ds_read_b64_tr_b16 v[250:251], v8 offset:2304
  ds_read_b64_tr_b16 v[252:253], v8 offset:8448
  ds_read_b64_tr_b16 v[254:255], v8 offset:10496
  s_waitcnt lgkmcnt(0)
  s_barrier
  v_lshlrev_b32 v5, 4, v1
  s_lshl_b32 s28, s21, 10
  v_add_u32 v6, s28, v5
  v_mov_b32 v9, v5
  v_add_u32 v10, 40960, v5
  v_bfe_u32 v2, v1, 4, 1
  v_lshlrev_b32 v11, 10, v2
  v_and_b32 v2, 15, v1
  v_lshlrev_b32 v2, 4, v2
  v_add_u32 v11, v11, v2
  v_lshrrev_b32 v2, 5, v1
  v_lshlrev_b32 v2, 9, v2
  v_add_u32 v11, v11, v2
  v_mov_b32 v12, s47
  s_mov_b32 s50, 0
  s_mov_b32 s51, 0x100000
  s_mov_b32 s45, 0
  v_mov_b32 v2, 4992
xw_71:
  buffer_load_dword v3, v2, s[8:11], 0 offen sc1
  s_add_u32 s45, s45, 1
  s_waitcnt vmcnt(0)
  v_readfirstlane_b32 s28, v3
  s_cmp_ge_u32 s28, 256
  s_cbranch_scc1 xw_71_ok
  s_cmp_lt_u32 s45, 400000
  s_cbranch_scc1 xw_71
  s_branch ka_abort
xw_71_ok:
  s_lshl_b32 s29, s21, 10
  s_add_u32 m0, s29, 0
  s_add_u32 s28, s51, 0
  buffer_load_dwordx4 v6, s[8:11], s28 offen sc1 lds
  s_lshl_b32 s29, s21, 10
  s_add_u32 m0, s29, 4096
  s_add_u32 s28, s51, 4096
  buffer_load_dwordx4 v6, s[8:11], s28 offen sc1 lds
  s_lshl_b32 s29, s21, 10
  s_add_u32 m0, s29, 8192
  s_add_u32 s28, s51, 8192
  buffer_load_dwordx4 v6, s[8:11], s28 offen sc1 lds
  s_lshl_b32 s29, s21, 10
  s_add_u32 m0, s29, 12288
  s_add_u32 s28, s51, 12288
  buffer_load_dwordx4 v6, s[8:11], s28 offen sc1 lds
  s_lshl_b32 s29, s21, 10
  s_add_u32 m0, s29, 16384
  s_add_u32 s28, s51, 16384
  buffer_load_dwordx4 v6, s[8:11], s28 offen sc1 lds
  s_lshl_b32 s29, s21, 10
  s_add_u32 m0, s29, 20480
  s_add_u32 s28, s51, 20480
  buffer_load_dwordx4 v6, s[8:11], s28 offen sc1 lds
  s_lshl_b32 s29, s21, 10
  s_add_u32 m0, s29, 24576
  s_add_u32 s28, s51, 24576
  buffer_load_dwordx4 v6, s[8:11], s28 offen sc1 lds
  s_lshl_b32 s29, s21, 10
  s_add_u32 m0, s29, 28672
  s_add_u32 s28, s51, 28672
  buffer_load_dwordx4 v6, s[8:11], s28 offen sc1 lds
  s_lshl_b32 s29, s21, 10
  s_add_u32 m0, s29, 32768
  s_add_u32 s28, s51, 32768
  buffer_load_dwordx4 v6, s[8:11], s28 offen sc1 lds
  s_lshl_b32 s29, s21, 10
  s_add_u32 m0, s29, 36864
  s_add_u32 s28, s51, 36864
  buffer_load_dwordx4 v6, s[8:11], s28 offen sc1 lds
  s_add_u32 s51, s51, 40960
ka_qkv_loop:
  s_cmp_eq_u32 s50, 0
  s_cbranch_scc0 q0_72
  s_waitcnt vmcnt(0)
q0_72:
  s_waitcnt vmcnt(4)
  s_barrier
  s_cmp_ge_u32 s50, 63
  s_cbranch_scc1 qn_73_n
  s_lshl_b32 s29, s21, 10
  s_add_u32 m0, s29, 40960
  s_add_u32 s28, s51, 0
  buffer_load_dwordx4 v6, s[8:11], s28 offen sc1 lds
  s_lshl_b32 s29, s21, 10
  s_add_u32 m0, s29, 45056
  s_add_u32 s28, s51, 4096
  buffer_load_dwordx4 v6, s[8:11], s28 offen sc1 lds
  s_lshl_b32 s29, s21, 10
  s_add_u32 m0, s29, 49152
  s_add_u32 s28, s51, 8192
  buffer_load_dwordx4 v6, s[8:11], s28 offen sc1 lds
  s_lshl_b32 s29, s21, 10
  s_add_u32 m0, s29, 53248
  s_add_u32 s28, s51, 12288
  buffer_load_dwordx4 v6, s[8:11], s28 offen sc1 lds
  s_lshl_b32 s29, s21, 10
  s_add_u32 m0, s29, 57344
  s_add_u32 s28, s51, 16384
  buffer_load_dwordx4 v6, s[8:11], s28 offen sc1 lds
  s_lshl_b32 s29, s21, 10
  s_add_u32 m0, s29, 61440
  s_add_u32 s28, s51, 20480
  buffer_load_dwordx4 v6, s[8:11], s28 offen sc1 lds
  s_lshl_b32 s29, s21, 10
  s_add_u32 m0, s29, 65536
  s_add_u32 s28, s51, 24576
  buffer_load_dwordx4 v6, s[8:11], s28 offen sc1 lds
  s_lshl_b32 s29, s21, 10
  s_add_u32 m0, s29, 69632
  s_add_u32 s28, s51, 28672
  buffer_load_dwordx4 v6, s[8:11], s28 offen sc1 lds
  s_lshl_b32 s29, s21, 10
  s_add_u32 m0, s29, 73728
  s_add_u32 s28, s51, 32768
  buffer_load_dwordx4 v6, s[8:11], s28 offen sc1 lds
  s_lshl_b32 s29, s21, 10
  s_add_u32 m0, s29, 77824
  s_add_u32 s28, s51, 36864
  buffer_load_dwordx4 v6, s[8:11], s28 offen sc1 lds
  s_add_u32 s51, s51, 40960
  s_branch qn_73
qn_73_n:
  s_waitcnt vmcnt(0)
qn_73:
  ds_read_b128 v[128:131], v9 offset:0
  ds_read_b128 v[132:135], v9 offset:1024
  ds_read_b128 v[136:139], v9 offset:2048
  ds_read_b128 v[140:143], v9 offset:3072
  s_waitcnt lgkmcnt(3)
  v_mfma_f32_32x32x16_bf16 v[64:79], a[0:3], v[128:131], 0
  v_mfma_f32_32x32x16_bf16 v[80:95], a[160:163], v[128:131], 0
  ds_read_b128 v[128:131], v9 offset:4096
  s_waitcnt lgkmcnt(3)
  v_mfma_f32_32x32x16_bf16 v[64:79], a[4:7], v[132:135], v[64:79]
  v_mfma_f32_32x32x16_bf16 v[80:95], a[164:167], v[132:135], v[80:95]
  ds_read_b128 v[132:135], v9 offset:5120
  s_waitcnt lgkmcnt(3)
  v_mfma_f32_32x32x16_bf16 v[64:79], a[8:11], v[136:139], v[64:79]
  v_mfma_f32_32x32x16_bf16 v[80:95], a[168:171], v[136:139], v[80:95]
  ds_read_b128 v[136:139], v9 offset:6144
  s_waitcnt lgkmcnt(3)
  v_mfma_f32_32x32x16_bf16 v[64:79], a[12:15], v[140:143], v[64:79]
  v_mfma_f32_32x32x16_bf16 v[80:95], a[172:175], v[140:143], v[80:95]
  ds_read_b128 v[140:143], v9 offset:7168
  s_waitcnt lgkmcnt(3)
  v_mfma_f32_32x32x16_bf16 v[64:79], a[16:19], v[128:131], v[64:79]
  v_mfma_f32_32x32x16_bf16 v[80:95], a[176:179], v[128:131], v[80:95]
  ds_read_b128 v[128:131], v9 offset:8192
  s_waitcnt lgkmcnt(3)
  v_mfma_f32_32x32x16_bf16 v[64:79], a[20:23], v[132:135], v[64:79]
  v_mfma_f32_32x32x16_bf16 v[80:95], a[180:183], v[132:135], v[80:95]
  ds_read_b128 v[132:135], v9 offset:9216
  s_waitcnt lgkmcnt(3)
  v_mfma_f32_32x32x16_bf16 v[64:79], a[24:27], v[136:139], v[64:79]
  v_mfma_f32_32x32x16_bf16 v[80:95], a[184:187], v[136:139], v[80:95]
  ds_read_b128 v[136:139], v9 offset:10240
  s_waitcnt lgkmcnt(3)
  v_mfma_f32_32x32x16_bf16 v[64:79], a[28:31], v[140:143], v[64:79]
  v_mfma_f32_32x32x16_bf16 v[80:95], a[188:191], v[140:143], v[80:95]
  ds_read_b128 v[140:143], v9 offset:11264
  s_waitcnt lgkmcnt(3)
  v_mfma_f32_32x32x16_bf16 v[64:79], a[32:35], v[128:131], v[64:79]
  v_mfma_f32_32x32x16_bf16 v[80:95], a[192:195], v[128:131], v[80:95]
  ds_read_b128 v[128:131], v9 offset:12288
  s_waitcnt lgkmcnt(3)
  v_mfma_f32_32x32x16_bf16 v[64:79], a[36:39], v[132:135], v[64:79]
  v_mfma_f32_32x32x16_bf16 v[80:95], a[196:199], v[132:135], v[80:95]
  ds_read_b128 v[132:135], v9 offset:13312
  s_waitcnt lgkmcnt(3)
  v_mfma_f32_32x32x16_bf16 v[64:79], a[40:43], v[136:139], v[64:79]
  v_mfma_f32_32x32x16_bf16 v[80:95], a[200:203], v[136:139], v[80:95]
  ds_read_b128 v[136:139], v9 offset:14336
  s_waitcnt lgkmcnt(3)
  v_mfma_f32_32x32x16_bf16 v[64:79], a[44:47], v[140:143], v[64:79]
  v_mfma_f32_32x32x16_bf16 v[80:95], a[204:207], v[140:143], v[80:95]
  ds_read_b128 v[140:143], v9 offset:15360
  s_waitcnt lgkmcnt(3)
  v_mfma_f32_32x32x16_bf16 v[64:79], a[48:51], v[128:131], v[64:79]
  v_mfma_f32_32x32x16_bf16 v[80:95], a[208:211], v[128:131], v[80:95]
  ds_read_b128 v[128:131], v9 offset:16384
  s_waitcnt lgkmcnt(3)
  v_mfma_f32_32x32x16_bf16 v[64:79], a[52:55], v[132:135], v[64:79]
  v_mfma_f32_32x32x16_bf16 v[80:95], a[212:215], v[132:135], v[80:95]
  ds_read_b128 v[132:135], v9 offset:17408
  s_waitcnt lgkmcnt(3)
  v_mfma_f32_32x32x16_bf16 v[64:79], a[56:59], v[136:139], v[64:79]
  v_mfma_f32_32x32x16_bf16 v[80:95], a[216:219], v[136:139], v[80:95]
  ds_read_b128 v[136:139], v9 offset:18432
  s_waitcnt lgkmcnt(3)
  v_mfma_f32_32x32x16_bf16 v[64:79], a[60:63], v[140:143], v[64:79]
  v_mfma_f32_32x32x16_bf16 v[80:95], a[220:223], v[140:143], v[80:95]
  ds_read_b128 v[140:143], v9 offset:19456
  s_waitcnt lgkmcnt(3)
  v_mfma_f32_32x32x16_bf16 v[64:79], a[64:67], v[128:131], v[64:79]
  v_mfma_f32_32x32x16_bf16 v[80:95], a[224:227], v[128:131], v[80:95]
  ds_read_b128 v[128:131], v9 offset:20480
  s_waitcnt lgkmcnt(3)
  v_mfma_f32_32x32x16_bf16 v[64:79], a[68:71], v[132:135], v[64:79]
  v_mfma_f32_32x32x16_bf16 v[80:95], a[228:231], v[132:135], v[80:95]
  ds_read_b128 v[132:135], v9 offset:21504
  s_waitcnt lgkmcnt(3)
  v_mfma_f32_32x32x16_bf16 v[64:79], a[72:75], v[136:139], v[64:79]
  v_mfma_f32_32x32x16_bf16 v[80:95], a[232:235], v[136:139], v[80:95]
  ds_read_b128 v[136:139], v9 offset:22528
  s_waitcnt lgkmcnt(3)
  v_mfma_f32_32x32x16_bf16 v[64:79], a[76:79], v[140:143], v[64:79]
  v_mfma_f32_32x32x16_bf16 v[80:95], a[236:239], v[140:143], v[80:95]
  ds_read_b128 v[140:143], v9 offset:23552
  s_waitcnt lgkmcnt(3)
  v_mfma_f32_32x32x16_bf16 v[64:79], a[80:83], v[128:131], v[64:79]
  v_mfma_f32_32x32x16_bf16 v[80:95], a[240:243], v[128:131], v[80:95]
  ds_read_b128 v[128:131], v9 offset:24576
  s_waitcnt lgkmcnt(3)
  v_mfma_f32_32x32x16_bf16 v[64:79], a[84:87], v[132:135], v[64:79]
  v_mfma_f32_32x32x16_bf16 v[80:95], a[244:247], v[132:135], v[80:95]
  ds_read_b128 v[132:135], v9 offset:25600
  s_waitcnt lgkmcnt(3)
  v_mfma_f32_32x32x16_bf16 v[64:79], a[88:91], v[136:139], v[64:79]
  v_mfma_f32_32x32x16_bf16 v[80:95], a[248:251], v[136:139], v[80:95]
  ds_read_b128 v[136:139], v9 offset:26624
  s_waitcnt lgkmcnt(3)
  v_mfma_f32_32x32x16_bf16 v[64:79], a[92:95], v[140:143], v[64:79]
  v_mfma_f32_32x32x16_bf16 v[80:95], a[252:255], v[140:143], v[80:95]
  ds_read_b128 v[140:143], v9 offset:27648
  s_waitcnt vmcnt(10)
  s_barrier
  s_cmp_eq_u32 s21, 0
  s_cbranch_scc0 mp_74
  v_mov_b32 v13, s50
  s_mov_b64 s[24:25], exec
  s_mov_b64 exec, 1
  buffer_store_dword v13, v12, s[8:11], 0 offen sc1
  s_mov_b64 exec, s[24:25]
mp_74:
  s_waitcnt lgkmcnt(3)
  v_mfma_f32_32x32x16_bf16 v[64:79], a[96:99], v[128:131], v[64:79]
  v_mfma_f32_32x32x16_bf16 v[80:95], v[192:195], v[128:131], v[80:95]
  ds_read_b128 v[128:131], v9 offset:28672
  s_waitcnt lgkmcnt(3)
  v_mfma_f32_32x32x16_bf16 v[64:79], a[100:103], v[132:135], v[64:79]
  v_mfma_f32_32x32x16_bf16 v[80:95], v[196:199], v[132:135], v[80:95]
  ds_read_b128 v[132:135], v9 offset:29696
  s_waitcnt lgkmcnt(3)
  v_mfma_f32_32x32x16_bf16 v[64:79], a[104:107], v[136:139], v[64:79]
  v_mfma_f32_32x32x16_bf16 v[80:95], v[200:203], v[136:139], v[80:95]
  ds_read_b128 v[136:139], v9 offset:30720
  s_waitcnt lgkmcnt(3)
  v_mfma_f32_32x32x16_bf16 v[64:79], a[108:111], v[140:143], v[64:79]
  v_mfma_f32_32x32x16_bf16 v[80:95], v[204:207], v[140:143], v[80:95]
  ds_read_b128 v[140:143], v9 offset:31744
  s_waitcnt lgkmcnt(3)
  v_mfma_f32_32x32x16_bf16 v[64:79], a[112:115], v[128:131], v[64:79]
  v_mfma_f32_32x32x16_bf16 v[80:95], v[208:211], v[128:131], v[80:95]
  ds_read_b128 v[128:131], v9 offset:32768
  s_waitcnt lgkmcnt(3)
  v_mfma_f32_32x32x16_bf16 v[64:79], a[116:119], v[132:135], v[64:79]
  v_mfma_f32_32x32x16_bf16 v[80:95], v[212:215], v[132:135], v[80:95]
  ds_read_b128 v[132:135], v9 offset:33792
  s_waitcnt lgkmcnt(3)
  v_mfma_f32_32x32x16_bf16 v[64:79], a[120:123], v[136:139], v[64:79]
  v_mfma_f32_32x32x16_bf16 v[80:95], v[216:219], v[136:139], v[80:95]
  ds_read_b128 v[136:139], v9 offset:34816
  s_waitcnt lgkmcnt(3)
  v_mfma_f32_32x32x16_bf16 v[64:79], a[124:127], v[140:143], v[64:79]
  v_mfma_f32_32x32x16_bf16 v[80:95], v[220:223], v[140:143], v[80:95]
  ds_read_b128 v[140:143], v9 offset:35840
  s_waitcnt lgkmcnt(3)
  v_mfma_f32_32x32x16_bf16 v[64:79], a[128:131], v[128:131], v[64:79]
  v_mfma_f32_32x32x16_bf16 v[80:95], v[224:227], v[128:131], v[80:95]
  ds_read_b128 v[128:131], v9 offset:36864
  s_waitcnt lgkmcnt(3)
  v_mfma_f32_32x32x16_bf16 v[64:79], a[132:135], v[132:135], v[64:79]
  v_mfma_f32_32x32x16_bf16 v[80:95], v[228:231], v[132:135], v[80:95]
  ds_read_b128 v[132:135], v9 offset:37888
  s_waitcnt lgkmcnt(3)
  v_mfma_f32_32x32x16_bf16 v[64:79], a[136:139], v[136:139], v[64:79]
  v_mfma_f32_32x32x16_bf16 v[80:95], v[232:235], v[136:139], v[80:95]
  ds_read_b128 v[136:139], v9 offset:38912
  s_waitcnt lgkmcnt(3)
  v_mfma_f32_32x32x16_bf16 v[64:79], a[140:143], v[140:143], v[64:79]
  v_mfma_f32_32x32x16_bf16 v[80:95], v[236:239], v[140:143], v[80:95]
  ds_read_b128 v[140:143], v9 offset:39936
  s_waitcnt lgkmcnt(3)
  v_mfma_f32_32x32x16_bf16 v[64:79], a[144:147], v[128:131], v[64:79]
  v_mfma_f32_32x32x16_bf16 v[80:95], v[240:243], v[128:131], v[80:95]
  s_waitcnt lgkmcnt(2)
  v_mfma_f32_32x32x16_bf16 v[64:79], a[148:151], v[132:135], v[64:79]
  v_mfma_f32_32x32x16_bf16 v[80:95], v[244:247], v[132:135], v[80:95]
  s_waitcnt lgkmcnt(1)
  v_mfma_f32_32x32x16_bf16 v[64:79], a[152:155], v[136:139], v[64:79]
  v_mfma_f32_32x32x16_bf16 v[80:95], v[248:251], v[136:139], v[80:95]
  s_waitcnt lgkmcnt(0)
  v_mfma_f32_32x32x16_bf16 v[64:79], a[156:159], v[140:143], v[64:79]
  v_mfma_f32_32x32x16_bf16 v[80:95], v[252:255], v[140:143], v[80:95]
  s_nop 11
  v_cvt_pk_bf16_f32 v144, v64, v65
  v_cvt_pk_bf16_f32 v145, v66, v67
  v_cvt_pk_bf16_f32 v146, v68, v69
  v_cvt_pk_bf16_f32 v147, v70, v71
  v_cvt_pk_bf16_f32 v148, v72, v73
  v_cvt_pk_bf16_f32 v149, v74, v75
  v_cvt_pk_bf16_f32 v150, v76, v77
  v_cvt_pk_bf16_f32 v151, v78, v79
  v_cvt_pk_bf16_f32 v152, v80, v81
  v_cvt_pk_bf16_f32 v153, v82, v83
  v_cvt_pk_bf16_f32 v154, v84, v85
  v_cvt_pk_bf16_f32 v155, v86, v87
  v_cvt_pk_bf16_f32 v156, v88, v89
  v_cvt_pk_bf16_f32 v157, v90, v91
  v_cvt_pk_bf16_f32 v158, v92, v93
  v_cvt_pk_bf16_f32 v159, v94, v95
  s_mul_i32 s28, s50, 12288
  s_add_u32 s29, s28, s48
  buffer_store_dwordx4 v[144:147], v11, s[8:11], s29 offen offset:0 sc1
  buffer_store_dwordx4 v[148:151], v11, s[8:11], s29 offen offset:256 sc1
  s_add_u32 s29, s28, s49
  buffer_store_dwordx4 v[152:155], v11, s[8:11], s29 offen offset:0 sc1
  buffer_store_dwordx4 v[156:159], v11, s[8:11], s29 offen offset:256 sc1
  s_add_u32 s50, s50, 1
  s_waitcnt vmcnt(4)
  s_barrier
  s_cmp_ge_u32 s50, 63
  s_cbranch_scc1 qn_75_n
  s_lshl_b32 s29, s21, 10
  s_add_u32 m0, s29, 0
  s_add_u32 s28, s51, 0
  buffer_load_dwordx4 v6, s[8:11], s28 offen sc1 lds
  s_lshl_b32 s29, s21, 10
  s_add_u32 m0, s29, 4096
  s_add_u32 s28, s51, 4096
  buffer_load_dwordx4 v6, s[8:11], s28 offen sc1 lds
  s_lshl_b32 s29, s21, 10
  s_add_u32 m0, s29, 8192
  s_add_u32 s28, s51, 8192
  buffer_load_dwordx4 v6, s[8:11], s28 offen sc1 lds
  s_lshl_b32 s29, s21, 10
  s_add_u32 m0, s29, 12288
  s_add_u32 s28, s51, 12288
  buffer_load_dwordx4 v6, s[8:11], s28 offen sc1 lds
  s_lshl_b32 s29, s21, 10
  s_add_u32 m0, s29, 16384
  s_add_u32 s28, s51, 16384
  buffer_load_dwordx4 v6, s[8:11], s28 offen sc1 lds
  s_lshl_b32 s29, s21, 10
  s_add_u32 m0, s29, 20480
  s_add_u32 s28, s51, 20480
  buffer_load_dwordx4 v6, s[8:11], s28 offen sc1 lds
  s_lshl_b32 s29, s21, 10
  s_add_u32 m0, s29, 24576
  s_add_u32 s28, s51, 24576
  buffer_load_dwordx4 v6, s[8:11], s28 offen sc1 lds
  s_lshl_b32 s29, s21, 10
  s_add_u32 m0, s29, 28672
  s_add_u32 s28, s51, 28672
  buffer_load_dwordx4 v6, s[8:11], s28 offen sc1 lds
  s_lshl_b32 s29, s21, 10
  s_add_u32 m0, s29, 32768
  s_add_u32 s28, s51, 32768
  buffer_load_dwordx4 v6, s[8:11], s28 offen sc1 lds
  s_lshl_b32 s29, s21, 10
  s_add_u32 m0, s29, 36864
  s_add_u32 s28, s51, 36864
  buffer_load_dwordx4 v6, s[8:11], s28 offen sc1 lds
  s_add_u32 s51, s51, 40960
  s_branch qn_75
qn_75_n:
  s_waitcnt vmcnt(0)
qn_75:
  ds_read_b128 v[128:131], v10 offset:0
  ds_read_b128 v[132:135], v10 offset:1024
  ds_read_b128 v[136:139], v10 offset:2048
  ds_read_b128 v[140:143], v10 offset:3072
  s_waitcnt lgkmcnt(3)
  v_mfma_f32_32x32x16_bf16 v[64:79], a[0:3], v[128:131], 0
  v_mfma_f32_32x32x16_bf16 v[80:95], a[160:163], v[128:131], 0
  ds_read_b128 v[128:131], v10 offset:4096
  s_waitcnt lgkmcnt(3)
  v_mfma_f32_32x32x16_bf16 v[64:79], a[4:7], v[132:135], v[64:79]
  v_mfma_f32_32x32x16_bf16 v[80:95], a[164:167], v[132:135], v[80:95]
  ds_read_b128 v[132:135], v10 offset:5120
  s_waitcnt lgkmcnt(3)
  v_mfma_f32_32x32x16_bf16 v[64:79], a[8:11], v[136:139], v[64:79]
  v_mfma_f32_32x32x16_bf16 v[80:95], a[168:171], v[136:139], v[80:95]
  ds_read_b128 v[136:139], v10 offset:6144
  s_waitcnt lgkmcnt(3)
  v_mfma_f32_32x32x16_bf16 v[64:79], a[12:15], v[140:143], v[64:79]
  v_mfma_f32_32x32x16_bf16 v[80:95], a[172:175], v[140:143], v[80:95]
  ds_read_b128 v[140:143], v10 offset:7168
  s_waitcnt lgkmcnt(3)
  v_mfma_f32_32x32x16_bf16 v[64:79], a[16:19], v[128:131], v[64:79]
  v_mfma_f32_32x32x16_bf16 v[80:95], a[176:179], v[128:131], v[80:95]
  ds_read_b128 v[128:131], v10 offset:8192
  s_waitcnt lgkmcnt(3)
  v_mfma_f32_32x32x16_bf16 v[64:79], a[20:23], v[132:135], v[64:79]
  v_mfma_f32_32x32x16_bf16 v[80:95], a[180:183], v[132:135], v[80:95]
  ds_read_b128 v[132:135], v10 offset:9216
  s_waitcnt lgkmcnt(3)
  v_mfma_f32_32x32x16_bf16 v[64:79], a[24:27], v[136:139], v[64:79]
  v_mfma_f32_32x32x16_bf16 v[80:95], a[184:187], v[136:139], v[80:95]
  ds_read_b128 v[136:139], v10 offset:10240
  s_waitcnt lgkmcnt(3)
  v_mfma_f32_32x32x16_bf16 v[64:79], a[28:31], v[140:143], v[64:79]
  v_mfma_f32_32x32x16_bf16 v[80:95], a[188:191], v[140:143], v[80:95]
  ds_read_b128 v[140:143], v10 offset:11264
  s_waitcnt lgkmcnt(3)
  v_mfma_f32_32x32x16_bf16 v[64:79], a[32:35], v[128:131], v[64:79]
  v_mfma_f32_32x32x16_bf16 v[80:95], a[192:195], v[128:131], v[80:95]
  ds_read_b128 v[128:131], v10 offset:12288
  s_waitcnt lgkmcnt(3)
  v_mfma_f32_32x32x16_bf16 v[64:79], a[36:39], v[132:135], v[64:79]
  v_mfma_f32_32x32x16_bf16 v[80:95], a[196:199], v[132:135], v[80:95]
  ds_read_b128 v[132:135], v10 offset:13312
  s_waitcnt lgkmcnt(3)
  v_mfma_f32_32x32x16_bf16 v[64:79], a[40:43], v[136:139], v[64:79]
  v_mfma_f32_32x32x16_bf16 v[80:95], a[200:203], v[136:139], v[80:95]
  ds_read_b128 v[136:139], v10 offset:14336
  s_waitcnt lgkmcnt(3)
  v_mfma_f32_32x32x16_bf16 v[64:79], a[44:47], v[140:143], v[64:79]
  v_mfma_f32_32x32x16_bf16 v[80:95], a[204:207], v[140:143], v[80:95]
  ds_read_b128 v[140:143], v10 offset:15360
  s_waitcnt lgkmcnt(3)
  v_mfma_f32_32x32x16_bf16 v[64:79], a[48:51], v[128:131], v[64:79]
  v_mfma_f32_32x32x16_bf16 v[80:95], a[208:211], v[128:131], v[80:95]
  ds_read_b128 v[128:131], v10 offset:16384
  s_waitcnt lgkmcnt(3)
  v_mfma_f32_32x32x16_bf16 v[64:79], a[52:55], v[132:135], v[64:79]
  v_mfma_f32_32x32x16_bf16 v[80:95], a[212:215], v[132:135], v[80:95]
  ds_read_b128 v[132:135], v10 offset:17408
  s_waitcnt lgkmcnt(3)
  v_mfma_f32_32x32x16_bf16 v[64:79], a[56:59], v[136:139], v[64:79]
  v_mfma_f32_32x32x16_bf16 v[80:95], a[216:219], v[136:139], v[80:95]
  ds_read_b128 v[136:139], v10 offset:18432
  s_waitcnt lgkmcnt(3)
  v_mfma_f32_32x32x16_bf16 v[64:79], a[60:63], v[140:143], v[64:79]
  v_mfma_f32_32x32x16_bf16 v[80:95], a[220:223], v[140:143], v[80:95]
  ds_read_b128 v[140:143], v10 offset:19456
  s_waitcnt lgkmcnt(3)
  v_mfma_f32_32x32x16_bf16 v[64:79], a[64:67], v[128:131], v[64:79]
  v_mfma_f32_32x32x16_bf16 v[80:95], a[224:227], v[128:131], v[80:95]
  ds_read_b128 v[128:131], v10 offset:20480
  s_waitcnt lgkmcnt(3)
  v_mfma_f32_32x32x16_bf16 v[64:79], a[68:71], v[132:135], v[64:79]
  v_mfma_f32_32x32x16_bf16 v[80:95], a[228:231], v[132:135], v[80:95]
  ds_read_b128 v[132:135], v10 offset:21504
  s_waitcnt lgkmcnt(3)
  v_mfma_f32_32x32x16_bf16 v[64:79], a[72:75], v[136:139], v[64:79]
  v_mfma_f32_32x32x16_bf16 v[80:95], a[232:235], v[136:139], v[80:95]
  ds_read_b128 v[136:139], v10 offset:22528
  s_waitcnt lgkmcnt(3)
  v_mfma_f32_32x32x16_bf16 v[64:79], a[76:79], v[140:143], v[64:79]
  v_mfma_f32_32x32x16_bf16 v[80:95], a[236:239], v[140:143], v[80:95]
  ds_read_b128 v[140:143], v10 offset:23552
  s_waitcnt lgkmcnt(3)
  v_mfma_f32_32x32x16_bf16 v[64:79], a[80:83], v[128:131], v[64:79]
  v_mfma_f32_32x32x16_bf16 v[80:95], a[240:243], v[128:131], v[80:95]
  ds_read_b128 v[128:131], v10 offset:24576
  s_waitcnt lgkmcnt(3)
  v_mfma_f32_32x32x16_bf16 v[64:79], a[84:87], v[132:135], v[64:79]
  v_mfma_f32_32x32x16_bf16 v[80:95], a[244:247], v[132:135], v[80:95]
  ds_read_b128 v[132:135], v10 offset:25600
  s_waitcnt lgkmcnt(3)
  v_mfma_f32_32x32x16_bf16 v[64:79], a[88:91], v[136:139], v[64:79]
  v_mfma_f32_32x32x16_bf16 v[80:95], a[248:251], v[136:139], v[80:95]
  ds_read_b128 v[136:139], v10 offset:26624
  s_waitcnt lgkmcnt(3)
  v_mfma_f32_32x32x16_bf16 v[64:79], a[92:95], v[140:143], v[64:79]
  v_mfma_f32_32x32x16_bf16 v[80:95], a[252:255], v[140:143], v[80:95]
  ds_read_b128 v[140:143], v10 offset:27648
  s_waitcnt vmcnt(10)
  s_barrier
  s_cmp_eq_u32 s21, 0
  s_cbranch_scc0 mp_76
  v_mov_b32 v13, s50
  s_mov_b64 s[24:25], exec
  s_mov_b64 exec, 1
  buffer_store_dword v13, v12, s[8:11], 0 offen sc1
  s_mov_b64 exec, s[24:25]
mp_76:
  s_waitcnt lgkmcnt(3)
  v_mfma_f32_32x32x16_bf16 v[64:79], a[96:99], v[128:131], v[64:79]
  v_mfma_f32_32x32x16_bf16 v[80:95], v[192:195], v[128:131], v[80:95]
  ds_read_b128 v[128:131], v10 offset:28672
  s_waitcnt lgkmcnt(3)
  v_mfma_f32_32x32x16_bf16 v[64:79], a[100:103], v[132:135], v[64:79]
  v_mfma_f32_32x32x16_bf16 v[80:95], v[196:199], v[132:135], v[80:95]
  ds_read_b128 v[132:135], v10 offset:29696
  s_waitcnt lgkmcnt(3)
  v_mfma_f32_32x32x16_bf16 v[64:79], a[104:107], v[136:139], v[64:79]
  v_mfma_f32_32x32x16_bf16 v[80:95], v[200:203], v[136:139], v[80:95]
  ds_read_b128 v[136:139], v10 offset:30720
  s_waitcnt lgkmcnt(3)
  v_mfma_f32_32x32x16_bf16 v[64:79], a[108:111], v[140:143], v[64:79]
  v_mfma_f32_32x32x16_bf16 v[80:95], v[204:207], v[140:143], v[80:95]
  ds_read_b128 v[140:143], v10 offset:31744
  s_waitcnt lgkmcnt(3)
  v_mfma_f32_32x32x16_bf16 v[64:79], a[112:115], v[128:131], v[64:79]
  v_mfma_f32_32x32x16_bf16 v[80:95], v[208:211], v[128:131], v[80:95]
  ds_read_b128 v[128:131], v10 offset:32768
  s_waitcnt lgkmcnt(3)
  v_mfma_f32_32x32x16_bf16 v[64:79], a[116:119], v[132:135], v[64:79]
  v_mfma_f32_32x32x16_bf16 v[80:95], v[212:215], v[132:135], v[80:95]
  ds_read_b128 v[132:135], v10 offset:33792
  s_waitcnt lgkmcnt(3)
  v_mfma_f32_32x32x16_bf16 v[64:79], a[120:123], v[136:139], v[64:79]
  v_mfma_f32_32x32x16_bf16 v[80:95], v[216:219], v[136:139], v[80:95]
  ds_read_b128 v[136:139], v10 offset:34816
  s_waitcnt lgkmcnt(3)
  v_mfma_f32_32x32x16_bf16 v[64:79], a[124:127], v[140:143], v[64:79]
  v_mfma_f32_32x32x16_bf16 v[80:95], v[220:223], v[140:143], v[80:95]
  ds_read_b128 v[140:143], v10 offset:35840
  s_waitcnt lgkmcnt(3)
  v_mfma_f32_32x32x16_bf16 v[64:79], a[128:131], v[128:131], v[64:79]
  v_mfma_f32_32x32x16_bf16 v[80:95], v[224:227], v[128:131], v[80:95]
  ds_read_b128 v[128:131], v10 offset:36864
  s_waitcnt lgkmcnt(3)
  v_mfma_f32_32x32x16_bf16 v[64:79], a[132:135], v[132:135], v[64:79]
  v_mfma_f32_32x32x16_bf16 v[80:95], v[228:231], v[132:135], v[80:95]
  ds_read_b128 v[132:135], v10 offset:37888
  s_waitcnt lgkmcnt(3)
  v_mfma_f32_32x32x16_bf16 v[64:79], a[136:139], v[136:139], v[64:79]
  v_mfma_f32_32x32x16_bf16 v[80:95], v[232:235], v[136:139], v[80:95]
  ds_read_b128 v[136:139], v10 offset:38912
  s_waitcnt lgkmcnt(3)
  v_mfma_f32_32x32x16_bf16 v[64:79], a[140:143], v[140:143], v[64:79]
  v_mfma_f32_32x32x16_bf16 v[80:95], v[236:239], v[140:143], v[80:95]
  ds_read_b128 v[140:143], v10 offset:39936
  s_waitcnt lgkmcnt(3)
  v_mfma_f32_32x32x16_bf16 v[64:79], a[144:147], v[128:131], v[64:79]
  v_mfma_f32_32x32x16_bf16 v[80:95], v[240:243], v[128:131], v[80:95]
  s_waitcnt lgkmcnt(2)
  v_mfma_f32_32x32x16_bf16 v[64:79], a[148:151], v[132:135], v[64:79]
  v_mfma_f32_32x32x16_bf16 v[80:95], v[244:247], v[132:135], v[80:95]
  s_waitcnt lgkmcnt(1)
  v_mfma_f32_32x32x16_bf16 v[64:79], a[152:155], v[136:139], v[64:79]
  v_mfma_f32_32x32x16_bf16 v[80:95], v[248:251], v[136:139], v[80:95]
  s_waitcnt lgkmcnt(0)
  v_mfma_f32_32x32x16_bf16 v[64:79], a[156:159], v[140:143], v[64:79]
  v_mfma_f32_32x32x16_bf16 v[80:95], v[252:255], v[140:143], v[80:95]
  s_nop 11
  v_cvt_pk_bf16_f32 v144, v64, v65
  v_cvt_pk_bf16_f32 v145, v66, v67
  v_cvt_pk_bf16_f32 v146, v68, v69
  v_cvt_pk_bf16_f32 v147, v70, v71
  v_cvt_pk_bf16_f32 v148, v72, v73
  v_cvt_pk_bf16_f32 v149, v74, v75
  v_cvt_pk_bf16_f32 v150, v76, v77
  v_cvt_pk_bf16_f32 v151, v78, v79
  v_cvt_pk_bf16_f32 v152, v80, v81
  v_cvt_pk_bf16_f32 v153, v82, v83
  v_cvt_pk_bf16_f32 v154, v84, v85
  v_cvt_pk_bf16_f32 v155, v86, v87
  v_cvt_pk_bf16_f32 v156, v88, v89
  v_cvt_pk_bf16_f32 v157, v90, v91
  v_cvt_pk_bf16_f32 v158, v92, v93
  v_cvt_pk_bf16_f32 v159, v94, v95
  s_mul_i32 s28, s50, 12288
  s_add_u32 s29, s28, s48
  buffer_store_dwordx4 v[144:147], v11, s[8:11], s29 offen offset:0 sc1
  buffer_store_dwordx4 v[148:151], v11, s[8:11], s29 offen offset:256 sc1
  s_add_u32 s29, s28, s49
  buffer_store_dwordx4 v[152:155], v11, s[8:11], s29 offen offset:0 sc1
  buffer_store_dwordx4 v[156:159], v11, s[8:11], s29 offen offset:256 sc1
  s_add_u32 s50, s50, 1
  s_cmp_lt_u32 s50, 64
  s_cbranch_scc1 ka_qkv_loop
  s_waitcnt vmcnt(0)
  s_barrier
  s_cmp_eq_u32 s21, 0
  s_cbranch_scc0 ka_exit
  v_mov_b32 v13, 64
  s_mov_b64 exec, 1
  buffer_store_dword v13, v12, s[8:11], 0 offen sc1
  s_waitcnt vmcnt(0)
  s_branch ka_exit
ka_u:
  s_mov_b32 s12, s42
  s_and_b32 s13, s43, 0xffff
  s_mov_b32 s14, 0x780000
  s_mov_b32 s15, 0x20000
  v_and_b32 v1, 63, v0
  v_lshrrev_b32 v2, 4, v1
  v_bfe_u32 v3, v1, 2, 2
  v_and_b32 v4, 3, v1
  s_lshl_b32 s28, s21, 3
  v_add_u32 v5, s28, v3
  v_mul_u32_u24 v5, 1280, v5
  v_lshlrev_b32 v6, 6, v2
  v_add_u32 v5, v5, v6
  v_lshlrev_b32 v6, 4, v4
  v_add_u32 v5, v5, v6
  v_lshrrev_b32 v6, 1, v2
  v_mul_u32_u24 v7, 20480, v6
  v_lshlrev_b32 v6, 6, v3
  v_add_u32 v7, v7, v6
  v_and_b32 v6, 1, v2
  v_lshlrev_b32 v6, 5, v6
  v_add_u32 v7, v7, v6
  v_lshrrev_b32 v6, 1, v4
  v_lshlrev_b32 v6, 4, v6
  v_add_u32 v7, v7, v6
  v_and_b32 v6, 1, v4
  v_lshlrev_b32 v6, 3, v6
  v_add_u32 v7, v7, v6
  s_mul_i32 s28, s21, 1280
  v_add_u32 v7, s28, v7
  s_mul_i32 s46, s23, 245760
  s_mul_i32 s29, s21, 10240
  s_add_u32 m0, s29, 0
  s_add_u32 s28, s46, 0
  buffer_load_dwordx4 v5, s[12:15], s28 offen lds
  s_mul_i32 s29, s21, 10240
  s_add_u32 m0, s29, 1024
  s_add_u32 s28, s46, 256
  buffer_load_dwordx4 v5, s[12:15], s28 offen lds
  s_mul_i32 s29, s21, 10240
  s_add_u32 m0, s29, 2048
  s_add_u32 s28, s46, 512
  buffer_load_dwordx4 v5, s[12:15], s28 offen lds
  s_mul_i32 s29, s21, 10240
  s_add_u32 m0, s29, 3072
  s_add_u32 s28, s46, 768
  buffer_load_dwordx4 v5, s[12:15], s28 offen lds
  s_mul_i32 s29, s21, 10240
  s_add_u32 m0, s29, 4096
  s_add_u32 s28, s46, 1024
  buffer_load_dwordx4 v5, s[12:15], s28 offen lds
  s_mul_i32 s29, s21, 10240
  s_add_u32 m0, s29, 5120
  s_add_u32 s28, s46, 5120
  buffer_load_dwordx4 v5, s[12:15], s28 offen lds
  s_mul_i32 s29, s21, 10240
  s_add_u32 m0, s29, 6144
  s_add_u32 s28, s46, 5376
  buffer_load_dwordx4 v5, s[12:15], s28 offen lds
  s_mul_i32 s29, s21, 10240
  s_add_u32 m0, s29, 7168
  s_add_u32 s28, s46, 5632
  buffer_load_dwordx4 v5, s[12:15], s28 offen lds
  s_mul_i32 s29, s21, 10240
  s_add_u32 m0, s29, 8192
  s_add_u32 s28, s46, 5888
  buffer_load_dwordx4 v5, s[12:15], s28 offen lds
  s_mul_i32 s29, s21, 10240
  s_add_u32 m0, s29, 9216
  s_add_u32 s28, s46, 6144
  buffer_load_dwordx4 v5, s[12:15], s28 offen lds
  s_mul_i32 s29, s21, 10240
  s_add_u32 m0, s29, 40960
  s_add_u32 s28, s46, 40960
  buffer_load_dwordx4 v5, s[12:15], s28 offen lds
  s_mul_i32 s29, s21, 10240
  s_add_u32 m0, s29, 41984
  s_add_u32 s28, s46, 41216
  buffer_load_dwordx4 v5, s[12:15], s28 offen lds
  s_mul_i32 s29, s21, 10240
  s_add_u32 m0, s29, 43008
  s_add_u32 s28, s46, 41472
  buffer_load_dwordx4 v5, s[12:15], s28 offen lds
  s_mul_i32 s29, s21, 10240
  s_add_u32 m0, s29, 44032
  s_add_u32 s28, s46, 41728
  buffer_load_dwordx4 v5, s[12:15], s28 offen lds
  s_mul_i32 s29, s21, 10240
  s_add_u32 m0, s29, 45056
  s_add_u32 s28, s46, 41984
  buffer_load_dwordx4 v5, s[12:15], s28 offen lds
  s_mul_i32 s29, s21, 10240
  s_add_u32 m0, s29, 46080
  s_add_u32 s28, s46, 46080
  buffer_load_dwordx4 v5, s[12:15], s28 offen lds
  s_mul_i32 s29, s21, 10240
  s_add_u32 m0, s29, 47104
  s_add_u32 s28, s46, 46336
  buffer_load_dwordx4 v5, s[12:15], s28 offen lds
  s_mul_i32 s29, s21, 10240
  s_add_u32 m0, s29, 48128
  s_add_u32 s28, s46, 46592
  buffer_load_dwordx4 v5, s[12:15], s28 offen lds
  s_mul_i32 s29, s21, 10240
  s_add_u32 m0, s29, 49152
  s_add_u32 s28, s46, 46848
  buffer_load_dwordx4 v5, s[12:15], s28 offen lds
  s_mul_i32 s29, s21, 10240
  s_add_u32 m0, s29, 50176
  s_add_u32 s28, s46, 47104
  buffer_load_dwordx4 v5, s[12:15], s28 offen lds
  s_waitcnt vmcnt(10)
  s_cmp_eq_u32 s21, 3
  s_cbranch_scc0 lna_77
  s_mov_b64 s[24:25], exec
  s_mov_b64 exec, 1
  v_mov_b32 v2, 4992
  v_mov_b32 v3, 1
  buffer_atomic_add v3, v2, s[8:11], 0 offen
  s_mov_b64 exec, s[24:25]
lna_77:
  s_barrier
  s_mul_i32 s29, s21, 10240
  s_add_u32 m0, s29, 81920
  s_add_u32 s28, s46, 81920
  buffer_load_dwordx4 v5, s[12:15], s28 offen lds
  s_mul_i32 s29, s21, 10240
  s_add_u32 m0, s29, 82944
  s_add_u32 s28, s46, 82176
  buffer_load_dwordx4 v5, s[12:15], s28 offen lds
  s_mul_i32 s29, s21, 10240
  s_add_u32 m0, s29, 83968
  s_add_u32 s28, s46, 82432
  buffer_load_dwordx4 v5, s[12:15], s28 offen lds
  s_mul_i32 s29, s21, 10240
  s_add_u32 m0, s29, 84992
  s_add_u32 s28, s46, 82688
  buffer_load_dwordx4 v5, s[12:15], s28 offen lds
  s_mul_i32 s29, s21, 10240
  s_add_u32 m0, s29, 86016
  s_add_u32 s28, s46, 82944
  buffer_load_dwordx4 v5, s[12:15], s28 offen lds
  s_mul_i32 s29, s21, 10240
  s_add_u32 m0, s29, 87040
  s_add_u32 s28, s46, 87040
  buffer_load_dwordx4 v5, s[12:15], s28 offen lds
  s_mul_i32 s29, s21, 10240
  s_add_u32 m0, s29, 88064
  s_add_u32 s28, s46, 87296
  buffer_load_dwordx4 v5, s[12:15], s28 offen lds
  s_mul_i32 s29, s21, 10240
  s_add_u32 m0, s29, 89088
  s_add_u32 s28, s46, 87552
  buffer_load_dwordx4 v5, s[12:15], s28 offen lds
  s_mul_i32 s29, s21, 10240
  s_add_u32 m0, s29, 90112
  s_add_u32 s28, s46, 87808
  buffer_load_dwordx4 v5, s[12:15], s28 offen lds
  s_mul_i32 s29, s21, 10240
  s_add_u32 m0, s29, 91136
  s_add_u32 s28, s46, 88064
  buffer_load_dwordx4 v5, s[12:15], s28 offen lds
  v_add_u32 v8, 0, v7
  ds_read_b64_tr_b16 a[0:1], v8 offset:0
  ds_read_b64_tr_b16 a[2:3], v8 offset:10240
  ds_read_b64_tr_b16 a[4:5], v8 offset:5120
  ds_read_b64_tr_b16 a[6:7], v8 offset:15360
  ds_read_b64_tr_b16 a[48:49], v8 offset:256
  ds_read_b64_tr_b16 a[50:51], v8 offset:10496
  ds_read_b64_tr_b16 a[52:53], v8 offset:5376
  ds_read_b64_tr_b16 a[54:55], v8 offset:15616
  ds_read_b64_tr_b16 a[96:97], v8 offset:512
  ds_read_b64_tr_b16 a[98:99], v8 offset:10752
  ds_read_b64_tr_b16 a[100:101], v8 offset:5632
  ds_read_b64_tr_b16 a[102:103], v8 offset:15872
  s_waitcnt lgkmcnt(0)
  ds_read_b64_tr_b16 a[144:145], v8 offset:768
  ds_read_b64_tr_b16 a[146:147], v8 offset:11008
  ds_read_b64_tr_b16 a[148:149], v8 offset:5888
  ds_read_b64_tr_b16 a[150:151], v8 offset:16128
  ds_read_b64_tr_b16 a[192:193], v8 offset:1024
  ds_read_b64_tr_b16 a[194:195], v8 offset:11264
  ds_read_b64_tr_b16 a[196:197], v8 offset:6144
  ds_read_b64_tr_b16 a[198:199], v8 offset:16384
  s_waitcnt lgkmcnt(0)
  s_waitcnt vmcnt(10)
  s_barrier
  s_mul_i32 s29, s21, 10240
  s_add_u32 m0, s29, 0
  s_add_u32 s28, s46, 122880
  buffer_load_dwordx4 v5, s[12:15], s28 offen lds
  s_mul_i32 s29, s21, 10240
  s_add_u32 m0, s29, 1024
  s_add_u32 s28, s46, 123136
  buffer_load_dwordx4 v5, s[12:15], s28 offen lds
  s_mul_i32 s29, s21, 10240
  s_add_u32 m0, s29, 2048
  s_add_u32 s28, s46, 123392
  buffer_load_dwordx4 v5, s[12:15], s28 offen lds
  s_mul_i32 s29, s21, 10240
  s_add_u32 m0, s29, 3072
  s_add_u32 s28, s46, 123648
  buffer_load_dwordx4 v5, s[12:15], s28 offen lds
  s_mul_i32 s29, s21, 10240
  s_add_u32 m0, s29, 4096
  s_add_u32 s28, s46, 123904
  buffer_load_dwordx4 v5, s[12:15], s28 offen lds
  s_mul_i32 s29, s21, 10240
  s_add_u32 m0, s29, 5120
  s_add_u32 s28, s46, 128000
  buffer_load_dwordx4 v5, s[12:15], s28 offen lds
  s_mul_i32 s29, s21, 10240
  s_add_u32 m0, s29, 6144
  s_add_u32 s28, s46, 128256
  buffer_load_dwordx4 v5, s[12:15], s28 offen lds
  s_mul_i32 s29, s21, 10240
  s_add_u32 m0, s29, 7168
  s_add_u32 s28, s46, 128512
  buffer_load_dwordx4 v5, s[12:15], s28 offen lds
  s_mul_i32 s29, s21, 10240
  s_add_u32 m0, s29, 8192
  s_add_u32 s28, s46, 128768
  buffer_load_dwordx4 v5, s[12:15], s28 offen lds
  s_mul_i32 s29, s21, 10240
  s_add_u32 m0, s29, 9216
  s_add_u32 s28, s46, 129024
  buffer_load_dwordx4 v5, s[12:15], s28 offen lds
  v_add_u32 v8, 40960, v7
  ds_read_b64_tr_b16 a[8:9], v8 offset:0
  ds_read_b64_tr_b16 a[10:11], v8 offset:10240
  ds_read_b64_tr_b16 a[12:13], v8 offset:5120
  ds_read_b64_tr_b16 a[14:15], v8 offset:15360
  ds_read_b64_tr_b16 a[56:57], v8 offset:256
  ds_read_b64_tr_b16 a[58:59], v8 offset:10496
  ds_read_b64_tr_b16 a[60:61], v8 offset:5376
  ds_read_b64_tr_b16 a[62:63], v8 offset:15616
  ds_read_b64_tr_b16 a[104:105], v8 offset:512
  ds_read_b64_tr_b16 a[106:107], v8 offset:10752
  ds_read_b64_tr_b16 a[108:109], v8 offset:5632
  ds_read_b64_tr_b16 a[110:111], v8 offset:15872
  s_waitcnt lgkmcnt(0)
  ds_read_b64_tr_b16 a[152:153], v8 offset:768
  ds_read_b64_tr_b16 a[154:155], v8 offset:11008
  ds_read_b64_tr_b16 a[156:157], v8 offset:5888
  ds_read_b64_tr_b16 a[158:159], v8 offset:16128
  ds_read_b64_tr_b16 a[200:201], v8 offset:1024
  ds_read_b64_tr_b16 a[202:203], v8 offset:11264
  ds_read_b64_tr_b16 a[204:205], v8 offset:6144
  ds_read_b64_tr_b16 a[206:207], v8 offset:16384
  s_waitcnt lgkmcnt(0)
  s_waitcnt vmcnt(10)
  s_barrier
  s_mul_i32 s29, s21, 10240
  s_add_u32 m0, s29, 40960
  s_add_u32 s28, s46, 163840
  buffer_load_dwordx4 v5, s[12:15], s28 offen lds
  s_mul_i32 s29, s21, 10240
  s_add_u32 m0, s29, 41984
  s_add_u32 s28, s46, 164096
  buffer_load_dwordx4 v5, s[12:15], s28 offen lds
  s_mul_i32 s29, s21, 10240
  s_add_u32 m0, s29, 43008
  s_add_u32 s28, s46, 164352
  buffer_load_dwordx4 v5, s[12:15], s28 offen lds
  s_mul_i32 s29, s21, 10240
  s_add_u32 m0, s29, 44032
  s_add_u32 s28, s46, 164608
  buffer_load_dwordx4 v5, s[12:15], s28 offen lds
  s_mul_i32 s29, s21, 10240
  s_add_u32 m0, s29, 45056
  s_add_u32 s28, s46, 164864
  buffer_load_dwordx4 v5, s[12:15], s28 offen lds
  s_mul_i32 s29, s21, 10240
  s_add_u32 m0, s29, 46080
  s_add_u32 s28, s46, 168960
  buffer_load_dwordx4 v5, s[12:15], s28 offen lds
  s_mul_i32 s29, s21, 10240
  s_add_u32 m0, s29, 47104
  s_add_u32 s28, s46, 169216
  buffer_load_dwordx4 v5, s[12:15], s28 offen lds
  s_mul_i32 s29, s21, 10240
  s_add_u32 m0, s29, 48128
  s_add_u32 s28, s46, 169472
  buffer_load_dwordx4 v5, s[12:15], s28 offen lds
  s_mul_i32 s29, s21, 10240
  s_add_u32 m0, s29, 49152
  s_add_u32 s28, s46, 169728
  buffer_load_dwordx4 v5, s[12:15], s28 offen lds
  s_mul_i32 s29, s21, 10240
  s_add_u32 m0, s29, 50176
  s_add_u32 s28, s46, 169984
  buffer_load_dwordx4 v5, s[12:15], s28 offen lds
  v_add_u32 v8, 81920, v7
  ds_read_b64_tr_b16 a[16:17], v8 offset:0
  ds_read_b64_tr_b16 a[18:19], v8 offset:10240
  ds_read_b64_tr_b16 a[20:21], v8 offset:5120
  ds_read_b64_tr_b16 a[22:23], v8 offset:15360
  ds_read_b64_tr_b16 a[64:65], v8 offset:256
  ds_read_b64_tr_b16 a[66:67], v8 offset:10496
  ds_read_b64_tr_b16 a[68:69], v8 offset:5376
  ds_read_b64_tr_b16 a[70:71], v8 offset:15616
  ds_read_b64_tr_b16 a[112:113], v8 offset:512
  ds_read_b64_tr_b16 a[114:115], v8 offset:10752
  ds_read_b64_tr_b16 a[116:117], v8 offset:5632
  ds_read_b64_tr_b16 a[118:119], v8 offset:15872
  s_waitcnt lgkmcnt(0)
  ds_read_b64_tr_b16 a[160:161], v8 offset:768
  ds_read_b64_tr_b16 a[162:163], v8 offset:11008
  ds_read_b64_tr_b16 a[164:165], v8 offset:5888
  ds_read_b64_tr_b16 a[166:167], v8 offset:16128
  ds_read_b64_tr_b16 a[208:209], v8 offset:1024
  ds_read_b64_tr_b16 a[210:211], v8 offset:11264
  ds_read_b64_tr_b16 a[212:213], v8 offset:6144
  ds_read_b64_tr_b16 a[214:215], v8 offset:16384
  s_waitcnt lgkmcnt(0)
  s_waitcnt vmcnt(10)
  s_barrier
  s_mul_i32 s29, s21, 10240
  s_add_u32 m0, s29, 81920
  s_add_u32 s28, s46, 204800
  buffer_load_dwordx4 v5, s[12:15], s28 offen lds
  s_mul_i32 s29, s21, 10240
  s_add_u32 m0, s29, 82944
  s_add_u32 s28, s46, 205056
  buffer_load_dwordx4 v5, s[12:15], s28 offen lds
  s_mul_i32 s29, s21, 10240
  s_add_u32 m0, s29, 83968
  s_add_u32 s28, s46, 205312
  buffer_load_dwordx4 v5, s[12:15], s28 offen lds
  s_mul_i32 s29, s21, 10240
  s_add_u32 m0, s29, 84992
  s_add_u32 s28, s46, 205568
  buffer_load_dwordx4 v5, s[12:15], s28 offen lds
  s_mul_i32 s29, s21, 10240
  s_add_u32 m0, s29, 86016
  s_add_u32 s28, s46, 205824
  buffer_load_dwordx4 v5, s[12:15], s28 offen lds
  s_mul_i32 s29, s21, 10240
  s_add_u32 m0, s29, 87040
  s_add_u32 s28, s46, 209920
  buffer_load_dwordx4 v5, s[12:15], s28 offen lds
  s_mul_i32 s29, s21, 10240
  s_add_u32 m0, s29, 88064
  s_add_u32 s28, s46, 210176
  buffer_load_dwordx4 v5, s[12:15], s28 offen lds
  s_mul_i32 s29, s21, 10240
  s_add_u32 m0, s29, 89088
  s_add_u32 s28, s46, 210432
  buffer_load_dwordx4 v5, s[12:15], s28 offen lds
  s_mul_i32 s29, s21, 10240
  s_add_u32 m0, s29, 90112
  s_add_u32 s28, s46, 210688
  buffer_load_dwordx4 v5, s[12:15], s28 offen lds
  s_mul_i32 s29, s21, 10240
  s_add_u32 m0, s29, 91136
  s_add_u32 s28, s46, 210944
  buffer_load_dwordx4 v5, s[12:15], s28 offen lds
  v_add_u32 v8, 0, v7
  ds_read_b64_tr_b16 a[24:25], v8 offset:0
  ds_read_b64_tr_b16 a[26:27], v8 offset:10240
  ds_read_b64_tr_b16 a[28:29], v8 offset:5120
  ds_read_b64_tr_b16 a[30:31], v8 offset:15360
  ds_read_b64_tr_b16 a[72:73], v8 offset:256
  ds_read_b64_tr_b16 a[74:75], v8 offset:10496
  ds_read_b64_tr_b16 a[76:77], v8 offset:5376
  ds_read_b64_tr_b16 a[78:79], v8 offset:15616
  ds_read_b64_tr_b16 a[120:121], v8 offset:512
  ds_read_b64_tr_b16 a[122:123], v8 offset:10752
  ds_read_b64_tr_b16 a[124:125], v8 offset:5632
  ds_read_b64_tr_b16 a[126:127], v8 offset:15872
  s_waitcnt lgkmcnt(0)
  ds_read_b64_tr_b16 a[168:169], v8 offset:768
  ds_read_b64_tr_b16 a[170:171], v8 offset:11008
  ds_read_b64_tr_b16 a[172:173], v8 offset:5888
  ds_read_b64_tr_b16 a[174:175], v8 offset:16128
  ds_read_b64_tr_b16 a[216:217], v8 offset:1024
  ds_read_b64_tr_b16 a[218:219], v8 offset:11264
  ds_read_b64_tr_b16 a[220:221], v8 offset:6144
  ds_read_b64_tr_b16 a[222:223], v8 offset:16384
  s_waitcnt lgkmcnt(0)
  s_waitcnt vmcnt(10)
  s_barrier
  v_add_u32 v8, 40960, v7
  ds_read_b64_tr_b16 a[32:33], v8 offset:0
  ds_read_b64_tr_b16 a[34:35], v8 offset:10240
  ds_read_b64_tr_b16 a[36:37], v8 offset:5120
  ds_read_b64_tr_b16 a[38:39], v8 offset:15360
  ds_read_b64_tr_b16 a[80:81], v8 offset:256
  ds_read_b64_tr_b16 a[82:83], v8 offset:10496
  ds_read_b64_tr_b16 a[84:85], v8 offset:5376
  ds_read_b64_tr_b16 a[86:87], v8 offset:15616
  ds_read_b64_tr_b16 a[128:129], v8 offset:512
  ds_read_b64_tr_b16 a[130:131], v8 offset:10752
  ds_read_b64_tr_b16 a[132:133], v8 offset:5632
  ds_read_b64_tr_b16 a[134:135], v8 offset:15872
  s_waitcnt lgkmcnt(0)
  ds_read_b64_tr_b16 a[176:177], v8 offset:768
  ds_read_b64_tr_b16 a[178:179], v8 offset:11008
  ds_read_b64_tr_b16 a[180:181], v8 offset:5888
  ds_read_b64_tr_b16 a[182:183], v8 offset:16128
  ds_read_b64_tr_b16 a[224:225], v8 offset:1024
  ds_read_b64_tr_b16 a[226:227], v8 offset:11264
  ds_read_b64_tr_b16 a[228:229], v8 offset:6144
  ds_read_b64_tr_b16 a[230:231], v8 offset:16384
  s_waitcnt lgkmcnt(0)
  s_waitcnt vmcnt(0)
  s_barrier
  v_add_u32 v8, 81920, v7
  ds_read_b64_tr_b16 a[40:41], v8 offset:0
  ds_read_b64_tr_b16 a[42:43], v8 offset:10240
  ds_read_b64_tr_b16 a[44:45], v8 offset:5120
  ds_read_b64_tr_b16 a[46:47], v8 offset:15360
  ds_read_b64_tr_b16 a[88:89], v8 offset:256
  ds_read_b64_tr_b16 a[90:91], v8 offset:10496
  ds_read_b64_tr_b16 a[92:93], v8 offset:5376
  ds_read_b64_tr_b16 a[94:95], v8 offset:15616
  ds_read_b64_tr_b16 a[136:137], v8 offset:512
  ds_read_b64_tr_b16 a[138:139], v8 offset:10752
  ds_read_b64_tr_b16 a[140:141], v8 offset:5632
  ds_read_b64_tr_b16 a[142:143], v8 offset:15872
  s_waitcnt lgkmcnt(0)
  ds_read_b64_tr_b16 a[184:185], v8 offset:768
  ds_read_b64_tr_b16 a[186:187], v8 offset:11008
  ds_read_b64_tr_b16 a[188:189], v8 offset:5888
  ds_read_b64_tr_b16 a[190:191], v8 offset:16128
  ds_read_b64_tr_b16 a[232:233], v8 offset:1024
  ds_read_b64_tr_b16 a[234:235], v8 offset:11264
  ds_read_b64_tr_b16 a[236:237], v8 offset:6144
  ds_read_b64_tr_b16 a[238:239], v8 offset:16384
  s_waitcnt lgkmcnt(0)
  s_barrier
  v_lshlrev_b32 v5, 4, v1
  s_lshl_b32 s28, s21, 10
  v_add_u32 v6, s28, v5
  v_bfe_u32 v2, v1, 4, 1
  v_lshlrev_b32 v9, 10, v2
  v_and_b32 v2, 15, v1
  v_lshlrev_b32 v2, 4, v2
  v_add_u32 v9, v9, v2
  v_lshrrev_b32 v3, 5, v1
  v_lshlrev_b32 v3, 8, v3
  v_add_u32 v9, v9, v3
  v_add_u32 v10, 12288, v9
  v_bfe_u32 v3, v1, 4, 1
  v_lshlrev_b32 v11, 10, v3
  v_add_u32 v11, v11, v2
  v_lshrrev_b32 v3, 5, v1
  v_lshlrev_b32 v3, 9, v3
  v_add_u32 v11, v11, v3
  s_mul_i32 s28, s23, 6
  s_lshr_b32 s29, s28, 3
  s_add_u32 s28, s28, 5
  s_lshr_b32 s28, s28, 3
  v_and_b32 v2, 1, v1
  v_mov_b32 v12, s29
  v_mov_b32 v13, s28
  v_cmp_eq_u32 vcc, 1, v2
  s_nop 1
  v_cndmask_b32 v12, v12, v13, vcc
  v_lshlrev_b32 v12, 2, v12
  v_add_u32 v12, 2048, v12
  s_lshl_b32 s28, s23, 2
  s_add_u32 s28, s28, 3072
  v_mov_b32 v14, s28
  s_mul_i32 s47, s23, 786432
  s_add_u32 s47, s47, 0x7800000
  s_mul_i32 s48, s23, 40960
  s_mul_i32 s28, s21, 10240
  s_add_u32 s48, s48, s28
  s_add_u32 s48, s48, 0x9000000
  s_mov_b32 s50, 0
  s_mov_b32 s52, 0
  s_mov_b32 s54, 0
  s_mov_b32 s53, 0
  s_cmp_gt_u32 s52, s53
  s_cbranch_scc1 ka_wp_78_ok
  s_mov_b32 s45, 0
ka_wp_78_spin:
  buffer_load_dword v2, v12, s[8:11], 0 offen sc1
  s_add_u32 s45, s45, 1
  s_waitcnt vmcnt(0)
  v_min_u32_dpp v3, v2, v2 quad_perm:[1,0,3,2] row_mask:0xf bank_mask:0xf
  s_nop 1
  v_min_u32_dpp v2, v3, v3 quad_perm:[2,3,0,1] row_mask:0xf bank_mask:0xf
  s_nop 1
  v_min_u32_dpp v3, v2, v2 row_half_mirror row_mask:0xf bank_mask:0xf
  s_nop 1
  v_min_u32_dpp v2, v3, v3 quad_perm:[0,1,2,3] row_mask:0xf bank_mask:0xf
  s_nop 0
  v_readfirstlane_b32 s52, v2
  s_cmp_gt_u32 s52, s53
  s_cbranch_scc1 ka_wp_78_ok
  s_cmp_lt_u32 s45, 400000
  s_cbranch_scc1 ka_wp_78_spin
  s_branch ka_abort
ka_wp_78_ok:
  s_lshl_b32 s29, s21, 10
  s_add_u32 m0, s29, 0
  s_add_u32 s28, s47, 0
  buffer_load_dwordx4 v6, s[8:11], s28 offen sc1 lds
  s_lshl_b32 s29, s21, 10
  s_add_u32 m0, s29, 4096
  s_add_u32 s28, s47, 4096
  buffer_load_dwordx4 v6, s[8:11], s28 offen sc1 lds
  s_lshl_b32 s29, s21, 10
  s_add_u32 m0, s29, 8192
  s_add_u32 s28, s47, 8192
  buffer_load_dwordx4 v6, s[8:11], s28 offen sc1 lds
  s_add_u32 s47, s47, 12288
ka_u_loop:
  s_cmp_eq_u32 s50, 0
  s_cbranch_scc0 u0_79
  s_waitcnt vmcnt(0)
u0_79:
  s_waitcnt vmcnt(10)
  s_cmp_eq_u32 s54, 0
  s_cbranch_scc1 ud_80
  s_waitcnt vmcnt(0)
ud_80:
  s_barrier
  ds_read_b128 v[16:19], v9 offset:0
  ds_read_b128 v[20:23], v9 offset:512
  ds_read_b128 v[24:27], v9 offset:2048
  ds_read_b128 v[28:31], v9 offset:2560
  ds_read_b128 v[32:35], v9 offset:4096
  ds_read_b128 v[36:39], v9 offset:4608
  ds_read_b128 v[40:43], v9 offset:6144
  ds_read_b128 v[44:47], v9 offset:6656
  ds_read_b128 v[48:51], v9 offset:8192
  ds_read_b128 v[52:55], v9 offset:8704
  ds_read_b128 v[56:59], v9 offset:10240
  ds_read_b128 v[60:63], v9 offset:10752
  s_mov_b32 s54, 0
  s_cmp_ge_u32 s50, 63
  s_cbranch_scc1 un_81_n
  s_add_u32 s53, s50, 1
  s_cmp_gt_u32 s52, s53
  s_cbranch_scc1 un_81_go
  buffer_load_dword v2, v12, s[8:11], 0 offen sc1
  s_waitcnt vmcnt(0)
  v_min_u32_dpp v3, v2, v2 quad_perm:[1,0,3,2] row_mask:0xf bank_mask:0xf
  s_nop 0
  v_readfirstlane_b32 s52, v3
  s_cmp_gt_u32 s52, s53
  s_cbranch_scc1 un_81_go2
  s_mov_b32 s54, 1
  s_branch un_81
un_81_go2:
un_81_go:
  s_lshl_b32 s29, s21, 10
  s_add_u32 m0, s29, 12288
  s_add_u32 s28, s47, 0
  buffer_load_dwordx4 v6, s[8:11], s28 offen sc1 lds
  s_lshl_b32 s29, s21, 10
  s_add_u32 m0, s29, 16384
  s_add_u32 s28, s47, 4096
  buffer_load_dwordx4 v6, s[8:11], s28 offen sc1 lds
  s_lshl_b32 s29, s21, 10
  s_add_u32 m0, s29, 20480
  s_add_u32 s28, s47, 8192
  buffer_load_dwordx4 v6, s[8:11], s28 offen sc1 lds
  s_add_u32 s47, s47, 12288
  s_branch un_81
un_81_n:
  s_waitcnt vmcnt(0)
un_81:
  s_mul_i32 s30, s50, 1310720
  s_add_u32 s30, s30, s48
  s_waitcnt lgkmcnt(11)
  v_mfma_f32_32x32x16_bf16 v[64:79], v[16:19], a[0:3], 0
  s_waitcnt lgkmcnt(10)
  v_mfma_f32_32x32x16_bf16 v[64:79], v[20:23], a[4:7], v[64:79]
  s_waitcnt lgkmcnt(9)
  v_mfma_f32_32x32x16_bf16 v[64:79], v[24:27], a[8:11], v[64:79]
  s_waitcnt lgkmcnt(8)
  v_mfma_f32_32x32x16_bf16 v[64:79], v[28:31], a[12:15], v[64:79]
  s_waitcnt lgkmcnt(7)
  v_mfma_f32_32x32x16_bf16 v[64:79], v[32:35], a[16:19], v[64:79]
  s_waitcnt lgkmcnt(6)
  v_mfma_f32_32x32x16_bf16 v[64:79], v[36:39], a[20:23], v[64:79]
  s_waitcnt lgkmcnt(5)
  v_mfma_f32_32x32x16_bf16 v[64:79], v[40:43], a[24:27], v[64:79]
  s_waitcnt lgkmcnt(4)
  v_mfma_f32_32x32x16_bf16 v[64:79], v[44:47], a[28:31], v[64:79]
  s_waitcnt lgkmcnt(3)
  v_mfma_f32_32x32x16_bf16 v[64:79], v[48:51], a[32:35], v[64:79]
  s_waitcnt lgkmcnt(2)
  v_mfma_f32_32x32x16_bf16 v[64:79], v[52:55], a[36:39], v[64:79]
  s_waitcnt lgkmcnt(1)
  v_mfma_f32_32x32x16_bf16 v[64:79], v[56:59], a[40:43], v[64:79]
  s_waitcnt lgkmcnt(0)
  v_mfma_f32_32x32x16_bf16 v[64:79], v[60:63], a[44:47], v[64:79]
  v_mfma_f32_32x32x16_bf16 v[80:95], v[16:19], a[48:51], 0
  v_mfma_f32_32x32x16_bf16 v[80:95], v[20:23], a[52:55], v[80:95]
  v_mfma_f32_32x32x16_bf16 v[80:95], v[24:27], a[56:59], v[80:95]
  v_cvt_pk_bf16_f32 v96, v64, v65
  v_cvt_pk_bf16_f32 v97, v66, v67
  v_mfma_f32_32x32x16_bf16 v[80:95], v[28:31], a[60:63], v[80:95]
  v_cvt_pk_bf16_f32 v98, v68, v69
  v_cvt_pk_bf16_f32 v99, v70, v71
  v_mfma_f32_32x32x16_bf16 v[80:95], v[32:35], a[64:67], v[80:95]
  v_cvt_pk_bf16_f32 v100, v72, v73
  v_cvt_pk_bf16_f32 v101, v74, v75
  v_mfma_f32_32x32x16_bf16 v[80:95], v[36:39], a[68:71], v[80:95]
  v_cvt_pk_bf16_f32 v102, v76, v77
  v_cvt_pk_bf16_f32 v103, v78, v79
  v_mfma_f32_32x32x16_bf16 v[80:95], v[40:43], a[72:75], v[80:95]
  s_add_u32 s29, s30, 0
  buffer_store_dwordx4 v[96:99], v11, s[8:11], s29 offen offset:0 sc1
  v_mfma_f32_32x32x16_bf16 v[80:95], v[44:47], a[76:79], v[80:95]
  buffer_store_dwordx4 v[100:103], v11, s[8:11], s29 offen offset:256 sc1
  v_mfma_f32_32x32x16_bf16 v[80:95], v[48:51], a[80:83], v[80:95]
  v_mfma_f32_32x32x16_bf16 v[80:95], v[52:55], a[84:87], v[80:95]
  v_mfma_f32_32x32x16_bf16 v[80:95], v[56:59], a[88:91], v[80:95]
  v_mfma_f32_32x32x16_bf16 v[80:95], v[60:63], a[92:95], v[80:95]
  v_mfma_f32_32x32x16_bf16 v[64:79], v[16:19], a[96:99], 0
  v_mfma_f32_32x32x16_bf16 v[64:79], v[20:23], a[100:103], v[64:79]
  v_mfma_f32_32x32x16_bf16 v[64:79], v[24:27], a[104:107], v[64:79]
  v_cvt_pk_bf16_f32 v96, v80, v81
  v_cvt_pk_bf16_f32 v97, v82, v83
  v_mfma_f32_32x32x16_bf16 v[64:79], v[28:31], a[108:111], v[64:79]
  v_cvt_pk_bf16_f32 v98, v84, v85
  v_cvt_pk_bf16_f32 v99, v86, v87
  v_mfma_f32_32x32x16_bf16 v[64:79], v[32:35], a[112:115], v[64:79]
  v_cvt_pk_bf16_f32 v100, v88, v89
  v_cvt_pk_bf16_f32 v101, v90, v91
  v_mfma_f32_32x32x16_bf16 v[64:79], v[36:39], a[116:119], v[64:79]
  v_cvt_pk_bf16_f32 v102, v92, v93
  v_cvt_pk_bf16_f32 v103, v94, v95
  v_mfma_f32_32x32x16_bf16 v[64:79], v[40:43], a[120:123], v[64:79]
  s_add_u32 s29, s30, 2048
  buffer_store_dwordx4 v[96:99], v11, s[8:11], s29 offen offset:0 sc1
  v_mfma_f32_32x32x16_bf16 v[64:79], v[44:47], a[124:127], v[64:79]
  buffer_store_dwordx4 v[100:103], v11, s[8:11], s29 offen offset:256 sc1
  v_mfma_f32_32x32x16_bf16 v[64:79], v[48:51], a[128:131], v[64:79]
  v_mfma_f32_32x32x16_bf16 v[64:79], v[52:55], a[132:135], v[64:79]
  v_mfma_f32_32x32x16_bf16 v[64:79], v[56:59], a[136:139], v[64:79]
  v_mfma_f32_32x32x16_bf16 v[64:79], v[60:63], a[140:143], v[64:79]
  s_waitcnt vmcnt(7)
  s_barrier
  s_cmp_eq_u32 s21, 0
  s_cbranch_scc0 mp_82
  v_mov_b32 v13, s50
  s_mov_b64 s[24:25], exec
  s_mov_b64 exec, 1
  buffer_store_dword v13, v14, s[8:11], 0 offen sc1
  s_mov_b64 exec, s[24:25]
mp_82:
  v_mfma_f32_32x32x16_bf16 v[80:95], v[16:19], a[144:147], 0
  v_mfma_f32_32x32x16_bf16 v[80:95], v[20:23], a[148:151], v[80:95]
  v_mfma_f32_32x32x16_bf16 v[80:95], v[24:27], a[152:155], v[80:95]
  v_cvt_pk_bf16_f32 v96, v64, v65
  v_cvt_pk_bf16_f32 v97, v66, v67
  v_mfma_f32_32x32x16_bf16 v[80:95], v[28:31], a[156:159], v[80:95]
  v_cvt_pk_bf16_f32 v98, v68, v69
  v_cvt_pk_bf16_f32 v99, v70, v71
  v_mfma_f32_32x32x16_bf16 v[80:95], v[32:35], a[160:163], v[80:95]
  v_cvt_pk_bf16_f32 v100, v72, v73
  v_cvt_pk_bf16_f32 v101, v74, v75
  v_mfma_f32_32x32x16_bf16 v[80:95], v[36:39], a[164:167], v[80:95]
  v_cvt_pk_bf16_f32 v102, v76, v77
  v_cvt_pk_bf16_f32 v103, v78, v79
  v_mfma_f32_32x32x16_bf16 v[80:95], v[40:43], a[168:171], v[80:95]
  s_add_u32 s29, s30, 4096
  buffer_store_dwordx4 v[96:99], v11, s[8:11], s29 offen offset:0 sc1
  v_mfma_f32_32x32x16_bf16 v[80:95], v[44:47], a[172:175], v[80:95]
  buffer_store_dwordx4 v[100:103], v11, s[8:11], s29 offen offset:256 sc1
  v_mfma_f32_32x32x16_bf16 v[80:95], v[48:51], a[176:179], v[80:95]
  v_mfma_f32_32x32x16_bf16 v[80:95], v[52:55], a[180:183], v[80:95]
  v_mfma_f32_32x32x16_bf16 v[80:95], v[56:59], a[184:187], v[80:95]
  v_mfma_f32_32x32x16_bf16 v[80:95], v[60:63], a[188:191], v[80:95]
  v_mfma_f32_32x32x16_bf16 v[64:79], v[16:19], a[192:195], 0
  v_mfma_f32_32x32x16_bf16 v[64:79], v[20:23], a[196:199], v[64:79]
  v_mfma_f32_32x32x16_bf16 v[64:79], v[24:27], a[200:203], v[64:79]
  v_cvt_pk_bf16_f32 v96, v80, v81
  v_cvt_pk_bf16_f32 v97, v82, v83
  v_mfma_f32_32x32x16_bf16 v[64:79], v[28:31], a[204:207], v[64:79]
  v_cvt_pk_bf16_f32 v98, v84, v85
  v_cvt_pk_bf16_f32 v99, v86, v87
  v_mfma_f32_32x32x16_bf16 v[64:79], v[32:35], a[208:211], v[64:79]
  v_cvt_pk_bf16_f32 v100, v88, v89
  v_cvt_pk_bf16_f32 v101, v90, v91
  v_mfma_f32_32x32x16_bf16 v[64:79], v[36:39], a[212:215], v[64:79]
  v_cvt_pk_bf16_f32 v102, v92, v93
  v_cvt_pk_bf16_f32 v103, v94, v95
  v_mfma_f32_32x32x16_bf16 v[64:79], v[40:43], a[216:219], v[64:79]
  s_add_u32 s29, s30, 6144
  buffer_store_dwordx4 v[96:99], v11, s[8:11], s29 offen offset:0 sc1
  v_mfma_f32_32x32x16_bf16 v[64:79], v[44:47], a[220:223], v[64:79]
  buffer_store_dwordx4 v[100:103], v11, s[8:11], s29 offen offset:256 sc1
  v_mfma_f32_32x32x16_bf16 v[64:79], v[48:51], a[224:227], v[64:79]
  v_mfma_f32_32x32x16_bf16 v[64:79], v[52:55], a[228:231], v[64:79]
  v_mfma_f32_32x32x16_bf16 v[64:79], v[56:59], a[232:235], v[64:79]
  v_mfma_f32_32x32x16_bf16 v[64:79], v[60:63], a[236:239], v[64:79]
  s_nop 11
  v_cvt_pk_bf16_f32 v96, v64, v65
  v_cvt_pk_bf16_f32 v97, v66, v67
  v_cvt_pk_bf16_f32 v98, v68, v69
  v_cvt_pk_bf16_f32 v99, v70, v71
  v_cvt_pk_bf16_f32 v100, v72, v73
  v_cvt_pk_bf16_f32 v101, v74, v75
  v_cvt_pk_bf16_f32 v102, v76, v77
  v_cvt_pk_bf16_f32 v103, v78, v79
  s_add_u32 s29, s30, 8192
  buffer_store_dwordx4 v[96:99], v11, s[8:11], s29 offen offset:0 sc1
  buffer_store_dwordx4 v[100:103], v11, s[8:11], s29 offen offset:256 sc1
  s_cmp_eq_u32 s54, 0
  s_cbranch_scc1 udf_83
  s_cmp_gt_u32 s52, s53
  s_cbranch_scc1 ka_wp_84_ok
  s_mov_b32 s45, 0
ka_wp_84_spin:
  buffer_load_dword v2, v12, s[8:11], 0 offen sc1
  s_add_u32 s45, s45, 1
  s_waitcnt vmcnt(0)
  v_min_u32_dpp v3, v2, v2 quad_perm:[1,0,3,2] row_mask:0xf bank_mask:0xf
  s_nop 1
  v_min_u32_dpp v2, v3, v3 quad_perm:[2,3,0,1] row_mask:0xf bank_mask:0xf
  s_nop 1
  v_min_u32_dpp v3, v2, v2 row_half_mirror row_mask:0xf bank_mask:0xf
  s_nop 1
  v_min_u32_dpp v2, v3, v3 quad_perm:[0,1,2,3] row_mask:0xf bank_mask:0xf
  s_nop 0
  v_readfirstlane_b32 s52, v2
  s_cmp_gt_u32 s52, s53
  s_cbranch_scc1 ka_wp_84_ok
  s_cmp_lt_u32 s45, 400000
  s_cbranch_scc1 ka_wp_84_spin
  s_branch ka_abort
ka_wp_84_ok:
  s_lshl_b32 s29, s21, 10
  s_add_u32 m0, s29, 12288
  s_add_u32 s28, s47, 0
  buffer_load_dwordx4 v6, s[8:11], s28 offen sc1 lds
  s_lshl_b32 s29, s21, 10
  s_add_u32 m0, s29, 16384
  s_add_u32 s28, s47, 4096
  buffer_load_dwordx4 v6, s[8:11], s28 offen sc1 lds
  s_lshl_b32 s29, s21, 10
  s_add_u32 m0, s29, 20480
  s_add_u32 s28, s47, 8192
  buffer_load_dwordx4 v6, s[8:11], s28 offen sc1 lds
  s_add_u32 s47, s47, 12288
udf_83:
  s_add_u32 s50, s50, 1
  s_waitcnt vmcnt(10)
  s_cmp_eq_u32 s54, 0
  s_cbranch_scc1 ud_85
  s_waitcnt vmcnt(0)
ud_85:
  s_barrier
  ds_read_b128 v[16:19], v10 offset:0
  ds_read_b128 v[20:23], v10 offset:512
  ds_read_b128 v[24:27], v10 offset:2048
  ds_read_b128 v[28:31], v10 offset:2560
  ds_read_b128 v[32:35], v10 offset:4096
  ds_read_b128 v[36:39], v10 offset:4608
  ds_read_b128 v[40:43], v10 offset:6144
  ds_read_b128 v[44:47], v10 offset:6656
  ds_read_b128 v[48:51], v10 offset:8192
  ds_read_b128 v[52:55], v10 offset:8704
  ds_read_b128 v[56:59], v10 offset:10240
  ds_read_b128 v[60:63], v10 offset:10752
  s_mov_b32 s54, 0
  s_cmp_ge_u32 s50, 63
  s_cbranch_scc1 un_86_n
  s_add_u32 s53, s50, 1
  s_cmp_gt_u32 s52, s53
  s_cbranch_scc1 un_86_go
  buffer_load_dword v2, v12, s[8:11], 0 offen sc1
  s_waitcnt vmcnt(0)
  v_min_u32_dpp v3, v2, v2 quad_perm:[1,0,3,2] row_mask:0xf bank_mask:0xf
  s_nop 0
  v_readfirstlane_b32 s52, v3
  s_cmp_gt_u32 s52, s53
  s_cbranch_scc1 un_86_go2
  s_mov_b32 s54, 1
  s_branch un_86
un_86_go2:
un_86_go:
  s_lshl_b32 s29, s21, 10
  s_add_u32 m0, s29, 0
  s_add_u32 s28, s47, 0
  buffer_load_dwordx4 v6, s[8:11], s28 offen sc1 lds
  s_lshl_b32 s29, s21, 10
  s_add_u32 m0, s29, 4096
  s_add_u32 s28, s47, 4096
  buffer_load_dwordx4 v6, s[8:11], s28 offen sc1 lds
  s_lshl_b32 s29, s21, 10
  s_add_u32 m0, s29, 8192
  s_add_u32 s28, s47, 8192
  buffer_load_dwordx4 v6, s[8:11], s28 offen sc1 lds
  s_add_u32 s47, s47, 12288
  s_branch un_86
un_86_n:
  s_waitcnt vmcnt(0)
un_86:
  s_mul_i32 s30, s50, 1310720
  s_add_u32 s30, s30, s48
  s_waitcnt lgkmcnt(11)
  v_mfma_f32_32x32x16_bf16 v[64:79], v[16:19], a[0:3], 0
  s_waitcnt lgkmcnt(10)
  v_mfma_f32_32x32x16_bf16 v[64:79], v[20:23], a[4:7], v[64:79]
  s_waitcnt lgkmcnt(9)
  v_mfma_f32_32x32x16_bf16 v[64:79], v[24:27], a[8:11], v[64:79]
  s_waitcnt lgkmcnt(8)
  v_mfma_f32_32x32x16_bf16 v[64:79], v[28:31], a[12:15], v[64:79]
  s_waitcnt lgkmcnt(7)
  v_mfma_f32_32x32x16_bf16 v[64:79], v[32:35], a[16:19], v[64:79]
  s_waitcnt lgkmcnt(6)
  v_mfma_f32_32x32x16_bf16 v[64:79], v[36:39], a[20:23], v[64:79]
  s_waitcnt lgkmcnt(5)
  v_mfma_f32_32x32x16_bf16 v[64:79], v[40:43], a[24:27], v[64:79]
  s_waitcnt lgkmcnt(4)
  v_mfma_f32_32x32x16_bf16 v[64:79], v[44:47], a[28:31], v[64:79]
  s_waitcnt lgkmcnt(3)
  v_mfma_f32_32x32x16_bf16 v[64:79], v[48:51], a[32:35], v[64:79]
  s_waitcnt lgkmcnt(2)
  v_mfma_f32_32x32x16_bf16 v[64:79], v[52:55], a[36:39], v[64:79]
  s_waitcnt lgkmcnt(1)
  v_mfma_f32_32x32x16_bf16 v[64:79], v[56:59], a[40:43], v[64:79]
  s_waitcnt lgkmcnt(0)
  v_mfma_f32_32x32x16_bf16 v[64:79], v[60:63], a[44:47], v[64:79]
  v_mfma_f32_32x32x16_bf16 v[80:95], v[16:19], a[48:51], 0
  v_mfma_f32_32x32x16_bf16 v[80:95], v[20:23], a[52:55], v[80:95]
  v_mfma_f32_32x32x16_bf16 v[80:95], v[24:27], a[56:59], v[80:95]
  v_cvt_pk_bf16_f32 v96, v64, v65
  v_cvt_pk_bf16_f32 v97, v66, v67
  v_mfma_f32_32x32x16_bf16 v[80:95], v[28:31], a[60:63], v[80:95]
  v_cvt_pk_bf16_f32 v98, v68, v69
  v_cvt_pk_bf16_f32 v99, v70, v71
  v_mfma_f32_32x32x16_bf16 v[80:95], v[32:35], a[64:67], v[80:95]
  v_cvt_pk_bf16_f32 v100, v72, v73
  v_cvt_pk_bf16_f32 v101, v74, v75
  v_mfma_f32_32x32x16_bf16 v[80:95], v[36:39], a[68:71], v[80:95]
  v_cvt_pk_bf16_f32 v102, v76, v77
  v_cvt_pk_bf16_f32 v103, v78, v79
  v_mfma_f32_32x32x16_bf16 v[80:95], v[40:43], a[72:75], v[80:95]
  s_add_u32 s29, s30, 0
  buffer_store_dwordx4 v[96:99], v11, s[8:11], s29 offen offset:0 sc1
  v_mfma_f32_32x32x16_bf16 v[80:95], v[44:47], a[76:79], v[80:95]
  buffer_store_dwordx4 v[100:103], v11, s[8:11], s29 offen offset:256 sc1
  v_mfma_f32_32x32x16_bf16 v[80:95], v[48:51], a[80:83], v[80:95]
  v_mfma_f32_32x32x16_bf16 v[80:95], v[52:55], a[84:87], v[80:95]
  v_mfma_f32_32x32x16_bf16 v[80:95], v[56:59], a[88:91], v[80:95]
  v_mfma_f32_32x32x16_bf16 v[80:95], v[60:63], a[92:95], v[80:95]
  v_mfma_f32_32x32x16_bf16 v[64:79], v[16:19], a[96:99], 0
  v_mfma_f32_32x32x16_bf16 v[64:79], v[20:23], a[100:103], v[64:79]
  v_mfma_f32_32x32x16_bf16 v[64:79], v[24:27], a[104:107], v[64:79]
  v_cvt_pk_bf16_f32 v96, v80, v81
  v_cvt_pk_bf16_f32 v97, v82, v83
  v_mfma_f32_32x32x16_bf16 v[64:79], v[28:31], a[108:111], v[64:79]
  v_cvt_pk_bf16_f32 v98, v84, v85
  v_cvt_pk_bf16_f32 v99, v86, v87
  v_mfma_f32_32x32x16_bf16 v[64:79], v[32:35], a[112:115], v[64:79]
  v_cvt_pk_bf16_f32 v100, v88, v89
  v_cvt_pk_bf16_f32 v101, v90, v91
  v_mfma_f32_32x32x16_bf16 v[64:79], v[36:39], a[116:119], v[64:79]
  v_cvt_pk_bf16_f32 v102, v92, v93
  v_cvt_pk_bf16_f32 v103, v94, v95
  v_mfma_f32_32x32x16_bf16 v[64:79], v[40:43], a[120:123], v[64:79]
  s_add_u32 s29, s30, 2048
  buffer_store_dwordx4 v[96:99], v11, s[8:11], s29 offen offset:0 sc1
  v_mfma_f32_32x32x16_bf16 v[64:79], v[44:47], a[124:127], v[64:79]
  buffer_store_dwordx4 v[100:103], v11, s[8:11], s29 offen offset:256 sc1
  v_mfma_f32_32x32x16_bf16 v[64:79], v[48:51], a[128:131], v[64:79]
  v_mfma_f32_32x32x16_bf16 v[64:79], v[52:55], a[132:135], v[64:79]
  v_mfma_f32_32x32x16_bf16 v[64:79], v[56:59], a[136:139], v[64:79]
  v_mfma_f32_32x32x16_bf16 v[64:79], v[60:63], a[140:143], v[64:79]
  s_waitcnt vmcnt(7)
  s_barrier
  s_cmp_eq_u32 s21, 0
  s_cbranch_scc0 mp_87
  v_mov_b32 v13, s50
  s_mov_b64 s[24:25], exec
  s_mov_b64 exec, 1
  buffer_store_dword v13, v14, s[8:11], 0 offen sc1
  s_mov_b64 exec, s[24:25]
mp_87:
  v_mfma_f32_32x32x16_bf16 v[80:95], v[16:19], a[144:147], 0
  v_mfma_f32_32x32x16_bf16 v[80:95], v[20:23], a[148:151], v[80:95]
  v_mfma_f32_32x32x16_bf16 v[80:95], v[24:27], a[152:155], v[80:95]
  v_cvt_pk_bf16_f32 v96, v64, v65
  v_cvt_pk_bf16_f32 v97, v66, v67
  v_mfma_f32_32x32x16_bf16 v[80:95], v[28:31], a[156:159], v[80:95]
  v_cvt_pk_bf16_f32 v98, v68, v69
  v_cvt_pk_bf16_f32 v99, v70, v71
  v_mfma_f32_32x32x16_bf16 v[80:95], v[32:35], a[160:163], v[80:95]
  v_cvt_pk_bf16_f32 v100, v72, v73
  v_cvt_pk_bf16_f32 v101, v74, v75
  v_mfma_f32_32x32x16_bf16 v[80:95], v[36:39], a[164:167], v[80:95]
  v_cvt_pk_bf16_f32 v102, v76, v77
  v_cvt_pk_bf16_f32 v103, v78, v79
  v_mfma_f32_32x32x16_bf16 v[80:95], v[40:43], a[168:171], v[80:95]
  s_add_u32 s29, s30, 4096
  buffer_store_dwordx4 v[96:99], v11, s[8:11], s29 offen offset:0 sc1
  v_mfma_f32_32x32x16_bf16 v[80:95], v[44:47], a[172:175], v[80:95]
  buffer_store_dwordx4 v[100:103], v11, s[8:11], s29 offen offset:256 sc1
  v_mfma_f32_32x32x16_bf16 v[80:95], v[48:51], a[176:179], v[80:95]
  v_mfma_f32_32x32x16_bf16 v[80:95], v[52:55], a[180:183], v[80:95]
  v_mfma_f32_32x32x16_bf16 v[80:95], v[56:59], a[184:187], v[80:95]
  v_mfma_f32_32x32x16_bf16 v[80:95], v[60:63], a[188:191], v[80:95]
  v_mfma_f32_32x32x16_bf16 v[64:79], v[16:19], a[192:195], 0
  v_mfma_f32_32x32x16_bf16 v[64:79], v[20:23], a[196:199], v[64:79]
  v_mfma_f32_32x32x16_bf16 v[64:79], v[24:27], a[200:203], v[64:79]
  v_cvt_pk_bf16_f32 v96, v80, v81
  v_cvt_pk_bf16_f32 v97, v82, v83
  v_mfma_f32_32x32x16_bf16 v[64:79], v[28:31], a[204:207], v[64:79]
  v_cvt_pk_bf16_f32 v98, v84, v85
  v_cvt_pk_bf16_f32 v99, v86, v87
  v_mfma_f32_32x32x16_bf16 v[64:79], v[32:35], a[208:211], v[64:79]
  v_cvt_pk_bf16_f32 v100, v88, v89
  v_cvt_pk_bf16_f32 v101, v90, v91
  v_mfma_f32_32x32x16_bf16 v[64:79], v[36:39], a[212:215], v[64:79]
  v_cvt_pk_bf16_f32 v102, v92, v93
  v_cvt_pk_bf16_f32 v103, v94, v95
  v_mfma_f32_32x32x16_bf16 v[64:79], v[40:43], a[216:219], v[64:79]
  s_add_u32 s29, s30, 6144
  buffer_store_dwordx4 v[96:99], v11, s[8:11], s29 offen offset:0 sc1
  v_mfma_f32_32x32x16_bf16 v[64:79], v[44:47], a[220:223], v[64:79]
  buffer_store_dwordx4 v[100:103], v11, s[8:11], s29 offen offset:256 sc1
  v_mfma_f32_32x32x16_bf16 v[64:79], v[48:51], a[224:227], v[64:79]
  v_mfma_f32_32x32x16_bf16 v[64:79], v[52:55], a[228:231], v[64:79]
  v_mfma_f32_32x32x16_bf16 v[64:79], v[56:59], a[232:235], v[64:79]
  v_mfma_f32_32x32x16_bf16 v[64:79], v[60:63], a[236:239], v[64:79]
  s_nop 11
  v_cvt_pk_bf16_f32 v96, v64, v65
  v_cvt_pk_bf16_f32 v97, v66, v67
  v_cvt_pk_bf16_f32 v98, v68, v69
  v_cvt_pk_bf16_f32 v99, v70, v71
  v_cvt_pk_bf16_f32 v100, v72, v73
  v_cvt_pk_bf16_f32 v101, v74, v75
  v_cvt_pk_bf16_f32 v102, v76, v77
  v_cvt_pk_bf16_f32 v103, v78, v79
  s_add_u32 s29, s30, 8192
  buffer_store_dwordx4 v[96:99], v11, s[8:11], s29 offen offset:0 sc1
  buffer_store_dwordx4 v[100:103], v11, s[8:11], s29 offen offset:256 sc1
  s_cmp_eq_u32 s54, 0
  s_cbranch_scc1 udf_88
  s_cmp_gt_u32 s52, s53
  s_cbranch_scc1 ka_wp_89_ok
  s_mov_b32 s45, 0
ka_wp_89_spin:
  buffer_load_dword v2, v12, s[8:11], 0 offen sc1
  s_add_u32 s45, s45, 1
  s_waitcnt vmcnt(0)
  v_min_u32_dpp v3, v2, v2 quad_perm:[1,0,3,2] row_mask:0xf bank_mask:0xf
  s_nop 1
  v_min_u32_dpp v2, v3, v3 quad_perm:[2,3,0,1] row_mask:0xf bank_mask:0xf
  s_nop 1
  v_min_u32_dpp v3, v2, v2 row_half_mirror row_mask:0xf bank_mask:0xf
  s_nop 1
  v_min_u32_dpp v2, v3, v3 quad_perm:[0,1,2,3] row_mask:0xf bank_mask:0xf
  s_nop 0
  v_readfirstlane_b32 s52, v2
  s_cmp_gt_u32 s52, s53
  s_cbranch_scc1 ka_wp_89_ok
  s_cmp_lt_u32 s45, 400000
  s_cbranch_scc1 ka_wp_89_spin
  s_branch ka_abort
ka_wp_89_ok:
  s_lshl_b32 s29, s21, 10
  s_add_u32 m0, s29, 0
  s_add_u32 s28, s47, 0
  buffer_load_dwordx4 v6, s[8:11], s28 offen sc1 lds
  s_lshl_b32 s29, s21, 10
  s_add_u32 m0, s29, 4096
  s_add_u32 s28, s47, 4096
  buffer_load_dwordx4 v6, s[8:11], s28 offen sc1 lds
  s_lshl_b32 s29, s21, 10
  s_add_u32 m0, s29, 8192
  s_add_u32 s28, s47, 8192
  buffer_load_dwordx4 v6, s[8:11], s28 offen sc1 lds
  s_add_u32 s47, s47, 12288
udf_88:
  s_add_u32 s50, s50, 1
  s_cmp_lt_u32 s50, 64
  s_cbranch_scc1 ka_u_loop
  s_waitcnt vmcnt(0)
  s_barrier
  s_cmp_eq_u32 s21, 0
  s_cbranch_scc0 ka_exit
  v_mov_b32 v13, 64
  s_mov_b64 exec, 1
  buffer_store_dword v13, v14, s[8:11], 0 offen sc1
  s_waitcnt vmcnt(0)
  s_branch ka_exit
.macro CHAINROLES sfx, pol
ka\sfx\()_x:
  s_mov_b32 s12, s36
  s_and_b32 s13, s37, 0xffff
  s_mov_b32 s14, 0x780000
  s_mov_b32 s15, 0x20000
  s_mov_b32 s16, s38
  s_and_b32 s17, s39, 0xffff
  s_mov_b32 s18, 0x780000
  s_mov_b32 s19, 0x20000
  v_and_b32 v1, 63, v0
  v_lshrrev_b32 v2, 4, v1
  v_bfe_u32 v3, v1, 3, 1
  v_bfe_u32 v4, v1, 1, 2
  v_and_b32 v5, 1, v1
  s_mul_i32 s46, s23, 384
  s_lshl_b32 s28, s21, 2
  s_add_u32 s28, s28, 0
  v_add_u32 v6, s28, v2
  v_mul_u32_u24 v7, 43, v6
  v_lshrrev_b32 v7, 9, v7
  v_mul_u32_u24 v8, 12, v7
  v_sub_u32 v8, v6, v8
  v_lshrrev_b32 v9, 1, v7
  v_lshlrev_b32 v9, 4, v9
  v_and_b32 v10, 1, v7
  v_lshlrev_b32 v10, 2, v10
  v_add_u32 v9, v9, v10
  v_lshlrev_b32 v10, 3, v3
  v_add_u32 v9, v9, v10
  v_add_u32 v9, v9, v4
  v_mul_u32_u24 v9, 12288, v9
  v_lshrrev_b32 v10, 1, v8
  v_lshlrev_b32 v10, 2, v10
  v_lshlrev_b32 v11, 1, v5
  v_add_u32 v10, v10, v11
  v_and_b32 v11, 1, v8
  v_add_u32 v10, v10, v11
  v_lshlrev_b32 v10, 4, v10
  v_add_u32 v9, v9, v10
  v_add_u32 v136, s46, v9
  s_lshl_b32 s28, s21, 2
  s_add_u32 s28, s28, 16
  v_add_u32 v6, s28, v2
  v_mul_u32_u24 v7, 43, v6
  v_lshrrev_b32 v7, 9, v7
  v_mul_u32_u24 v8, 12, v7
  v_sub_u32 v8, v6, v8
  v_lshrrev_b32 v9, 1, v7
  v_lshlrev_b32 v9, 4, v9
  v_and_b32 v10, 1, v7
  v_lshlrev_b32 v10, 2, v10
  v_add_u32 v9, v9, v10
  v_lshlrev_b32 v10, 3, v3
  v_add_u32 v9, v9, v10
  v_add_u32 v9, v9, v4
  v_mul_u32_u24 v9, 12288, v9
  v_lshrrev_b32 v10, 1, v8
  v_lshlrev_b32 v10, 2, v10
  v_lshlrev_b32 v11, 1, v5
  v_add_u32 v10, v10, v11
  v_and_b32 v11, 1, v8
  v_add_u32 v10, v10, v11
  v_lshlrev_b32 v10, 4, v10
  v_add_u32 v9, v9, v10
  v_add_u32 v137, s46, v9
  s_lshl_b32 s28, s21, 2
  s_add_u32 s28, s28, 32
  v_add_u32 v6, s28, v2
  v_mul_u32_u24 v7, 43, v6
  v_lshrrev_b32 v7, 9, v7
  v_mul_u32_u24 v8, 12, v7
  v_sub_u32 v8, v6, v8
  v_lshrrev_b32 v9, 1, v7
  v_lshlrev_b32 v9, 4, v9
  v_and_b32 v10, 1, v7
  v_lshlrev_b32 v10, 2, v10
  v_add_u32 v9, v9, v10
  v_lshlrev_b32 v10, 3, v3
  v_add_u32 v9, v9, v10
  v_add_u32 v9, v9, v4
  v_mul_u32_u24 v9, 12288, v9
  v_lshrrev_b32 v10, 1, v8
  v_lshlrev_b32 v10, 2, v10
  v_lshlrev_b32 v11, 1, v5
  v_add_u32 v10, v10, v11
  v_and_b32 v11, 1, v8
  v_add_u32 v10, v10, v11
  v_lshlrev_b32 v10, 4, v10
  v_add_u32 v9, v9, v10
  v_add_u32 v138, s46, v9
  s_lshl_b32 s28, s21, 2
  s_add_u32 s28, s28, 48
  v_add_u32 v6, s28, v2
  v_mul_u32_u24 v7, 43, v6
  v_lshrrev_b32 v7, 9, v7
  v_mul_u32_u24 v8, 12, v7
  v_sub_u32 v8, v6, v8
  v_lshrrev_b32 v9, 1, v7
  v_lshlrev_b32 v9, 4, v9
  v_and_b32 v10, 1, v7
  v_lshlrev_b32 v10, 2, v10
  v_add_u32 v9, v9, v10
  v_lshlrev_b32 v10, 3, v3
  v_add_u32 v9, v9, v10
  v_add_u32 v9, v9, v4
  v_mul_u32_u24 v9, 12288, v9
  v_lshrrev_b32 v10, 1, v8
  v_lshlrev_b32 v10, 2, v10
  v_lshlrev_b32 v11, 1, v5
  v_add_u32 v10, v10, v11
  v_and_b32 v11, 1, v8
  v_add_u32 v10, v10, v11
  v_lshlrev_b32 v10, 4, v10
  v_add_u32 v9, v9, v10
  v_add_u32 v139, s46, v9
  s_lshl_b32 s28, s21, 2
  s_add_u32 s28, s28, 64
  v_add_u32 v6, s28, v2
  v_mul_u32_u24 v7, 43, v6
  v_lshrrev_b32 v7, 9, v7
  v_mul_u32_u24 v8, 12, v7
  v_sub_u32 v8, v6, v8
  v_lshrrev_b32 v9, 1, v7
  v_lshlrev_b32 v9, 4, v9
  v_and_b32 v10, 1, v7
  v_lshlrev_b32 v10, 2, v10
  v_add_u32 v9, v9, v10
  v_lshlrev_b32 v10, 3, v3
  v_add_u32 v9, v9, v10
  v_add_u32 v9, v9, v4
  v_mul_u32_u24 v9, 12288, v9
  v_lshrrev_b32 v10, 1, v8
  v_lshlrev_b32 v10, 2, v10
  v_lshlrev_b32 v11, 1, v5
  v_add_u32 v10, v10, v11
  v_and_b32 v11, 1, v8
  v_add_u32 v10, v10, v11
  v_lshlrev_b32 v10, 4, v10
  v_add_u32 v9, v9, v10
  v_add_u32 v140, s46, v9
  s_lshl_b32 s28, s21, 2
  s_add_u32 s28, s28, 80
  v_add_u32 v6, s28, v2
  v_mul_u32_u24 v7, 43, v6
  v_lshrrev_b32 v7, 9, v7
  v_mul_u32_u24 v8, 12, v7
  v_sub_u32 v8, v6, v8
  v_lshrrev_b32 v9, 1, v7
  v_lshlrev_b32 v9, 4, v9
  v_and_b32 v10, 1, v7
  v_lshlrev_b32 v10, 2, v10
  v_add_u32 v9, v9, v10
  v_lshlrev_b32 v10, 3, v3
  v_add_u32 v9, v9, v10
  v_add_u32 v9, v9, v4
  v_mul_u32_u24 v9, 12288, v9
  v_lshrrev_b32 v10, 1, v8
  v_lshlrev_b32 v10, 2, v10
  v_lshlrev_b32 v11, 1, v5
  v_add_u32 v10, v10, v11
  v_and_b32 v11, 1, v8
  v_add_u32 v10, v10, v11
  v_lshlrev_b32 v10, 4, v10
  v_add_u32 v9, v9, v10
  v_add_u32 v141, s46, v9
  v_lshrrev_b32 v6, 1, v2
  v_mul_u32_u24 v142, 6144, v6
  v_and_b32 v6, 1, v2
  v_lshlrev_b32 v6, 7, v6
  v_add_u32 v142, v142, v6
  v_bfe_u32 v6, v1, 2, 2
  v_lshlrev_b32 v6, 5, v6
  v_add_u32 v142, v142, v6
  v_and_b32 v6, 1, v1
  v_lshlrev_b32 v6, 4, v6
  v_add_u32 v142, v142, v6
  v_bfe_u32 v6, v1, 1, 1
  v_lshlrev_b32 v6, 3, v6
  v_add_u32 v142, v142, v6
  s_mul_i32 s28, s21, 768
  v_add_u32 v142, s28, v142
  s_lshl_b32 s29, s21, 10
  s_add_u32 m0, s29, 0
  s_mov_b32 s28, 0
  buffer_load_dwordx4 v136, s[12:15], s28 offen lds
  s_lshl_b32 s29, s21, 10
  s_add_u32 m0, s29, 4096
  s_mov_b32 s28, 0
  buffer_load_dwordx4 v137, s[12:15], s28 offen lds
  s_lshl_b32 s29, s21, 10
  s_add_u32 m0, s29, 8192
  s_mov_b32 s28, 0
  buffer_load_dwordx4 v138, s[12:15], s28 offen lds
  s_lshl_b32 s29, s21, 10
  s_add_u32 m0, s29, 12288
  s_mov_b32 s28, 0
  buffer_load_dwordx4 v139, s[12:15], s28 offen lds
  s_lshl_b32 s29, s21, 10
  s_add_u32 m0, s29, 16384
  s_mov_b32 s28, 0
  buffer_load_dwordx4 v140, s[12:15], s28 offen lds
  s_lshl_b32 s29, s21, 10
  s_add_u32 m0, s29, 20480
  s_mov_b32 s28, 0
  buffer_load_dwordx4 v141, s[12:15], s28 offen lds
  s_lshl_b32 s29, s21, 10
  s_add_u32 m0, s29, 24576
  s_mov_b32 s28, 786432
  buffer_load_dwordx4 v136, s[12:15], s28 offen lds
  s_lshl_b32 s29, s21, 10
  s_add_u32 m0, s29, 28672
  s_mov_b32 s28, 786432
  buffer_load_dwordx4 v137, s[12:15], s28 offen lds
  s_lshl_b32 s29, s21, 10
  s_add_u32 m0, s29, 32768
  s_mov_b32 s28, 786432
  buffer_load_dwordx4 v138, s[12:15], s28 offen lds
  s_lshl_b32 s29, s21, 10
  s_add_u32 m0, s29, 36864
  s_mov_b32 s28, 786432
  buffer_load_dwordx4 v139, s[12:15], s28 offen lds
  s_lshl_b32 s29, s21, 10
  s_add_u32 m0, s29, 40960
  s_mov_b32 s28, 786432
  buffer_load_dwordx4 v140, s[12:15], s28 offen lds
  s_lshl_b32 s29, s21, 10
  s_add_u32 m0, s29, 45056
  s_mov_b32 s28, 786432
  buffer_load_dwordx4 v141, s[12:15], s28 offen lds
  s_lshl_b32 s29, s21, 10
  s_add_u32 m0, s29, 49152
  s_mov_b32 s28, 1572864
  buffer_load_dwordx4 v136, s[12:15], s28 offen lds
  s_lshl_b32 s29, s21, 10
  s_add_u32 m0, s29, 53248
  s_mov_b32 s28, 1572864
  buffer_load_dwordx4 v137, s[12:15], s28 offen lds
  s_lshl_b32 s29, s21, 10
  s_add_u32 m0, s29, 57344
  s_mov_b32 s28, 1572864
  buffer_load_dwordx4 v138, s[12:15], s28 offen lds
  s_lshl_b32 s29, s21, 10
  s_add_u32 m0, s29, 61440
  s_mov_b32 s28, 1572864
  buffer_load_dwordx4 v139, s[12:15], s28 offen lds
  s_lshl_b32 s29, s21, 10
  s_add_u32 m0, s29, 65536
  s_mov_b32 s28, 1572864
  buffer_load_dwordx4 v140, s[12:15], s28 offen lds
  s_lshl_b32 s29, s21, 10
  s_add_u32 m0, s29, 69632
  s_mov_b32 s28, 1572864
  buffer_load_dwordx4 v141, s[12:15], s28 offen lds
  s_lshl_b32 s29, s21, 10
  s_add_u32 m0, s29, 73728
  s_mov_b32 s28, 2359296
  buffer_load_dwordx4 v136, s[12:15], s28 offen lds
  s_lshl_b32 s29, s21, 10
  s_add_u32 m0, s29, 77824
  s_mov_b32 s28, 2359296
  buffer_load_dwordx4 v137, s[12:15], s28 offen lds
  s_lshl_b32 s29, s21, 10
  s_add_u32 m0, s29, 81920
  s_mov_b32 s28, 2359296
  buffer_load_dwordx4 v138, s[12:15], s28 offen lds
  s_lshl_b32 s29, s21, 10
  s_add_u32 m0, s29, 86016
  s_mov_b32 s28, 2359296
  buffer_load_dwordx4 v139, s[12:15], s28 offen lds
  s_lshl_b32 s29, s21, 10
  s_add_u32 m0, s29, 90112
  s_mov_b32 s28, 2359296
  buffer_load_dwordx4 v140, s[12:15], s28 offen lds
  s_lshl_b32 s29, s21, 10
  s_add_u32 m0, s29, 94208
  s_mov_b32 s28, 2359296
  buffer_load_dwordx4 v141, s[12:15], s28 offen lds
  s_lshl_b32 s29, s21, 10
  s_add_u32 m0, s29, 98304
  s_mov_b32 s28, 3145728
  buffer_load_dwordx4 v136, s[12:15], s28 offen lds
  s_lshl_b32 s29, s21, 10
  s_add_u32 m0, s29, 102400
  s_mov_b32 s28, 3145728
  buffer_load_dwordx4 v137, s[12:15], s28 offen lds
  s_lshl_b32 s29, s21, 10
  s_add_u32 m0, s29, 106496
  s_mov_b32 s28, 3145728
  buffer_load_dwordx4 v138, s[12:15], s28 offen lds
  s_lshl_b32 s29, s21, 10
  s_add_u32 m0, s29, 110592
  s_mov_b32 s28, 3145728
  buffer_load_dwordx4 v139, s[12:15], s28 offen lds
  s_lshl_b32 s29, s21, 10
  s_add_u32 m0, s29, 114688
  s_mov_b32 s28, 3145728
  buffer_load_dwordx4 v140, s[12:15], s28 offen lds
  s_lshl_b32 s29, s21, 10
  s_add_u32 m0, s29, 118784
  s_mov_b32 s28, 3145728
  buffer_load_dwordx4 v141, s[12:15], s28 offen lds
  s_waitcnt vmcnt(24)
  s_cmp_eq_u32 s21, 3
  s_cbranch_scc0 lna_90_\sfx\()
  s_mov_b64 s[24:25], exec
  s_mov_b64 exec, 1
  v_mov_b32 v2, 4992
  v_mov_b32 v3, 1
  buffer_atomic_add v3, v2, s[8:11], 0 offen
  s_mov_b64 exec, s[24:25]
lna_90_\sfx\():
  s_barrier
  s_lshl_b32 s29, s21, 10
  s_add_u32 m0, s29, 122880
  s_mov_b32 s28, 3932160
  buffer_load_dwordx4 v136, s[12:15], s28 offen lds
  s_lshl_b32 s29, s21, 10
  s_add_u32 m0, s29, 126976
  s_mov_b32 s28, 3932160
  buffer_load_dwordx4 v137, s[12:15], s28 offen lds
  s_lshl_b32 s29, s21, 10
  s_add_u32 m0, s29, 131072
  s_mov_b32 s28, 3932160
  buffer_load_dwordx4 v138, s[12:15], s28 offen lds
  s_lshl_b32 s29, s21, 10
  s_add_u32 m0, s29, 135168
  s_mov_b32 s28, 3932160
  buffer_load_dwordx4 v139, s[12:15], s28 offen lds
  s_lshl_b32 s29, s21, 10
  s_add_u32 m0, s29, 139264
  s_mov_b32 s28, 3932160
  buffer_load_dwordx4 v140, s[12:15], s28 offen lds
  s_lshl_b32 s29, s21, 10
  s_add_u32 m0, s29, 143360
  s_mov_b32 s28, 3932160
  buffer_load_dwordx4 v141, s[12:15], s28 offen lds
  v_add_u32 v143, 0, v142
  ds_read_b64_tr_b16 a[0:1], v143 offset:0
  ds_read_b64_tr_b16 a[2:3], v143 offset:3072
  ds_read_b64_tr_b16 a[4:5], v143 offset:12288
  ds_read_b64_tr_b16 a[6:7], v143 offset:15360
  ds_read_b64_tr_b16 a[80:81], v143 offset:256
  ds_read_b64_tr_b16 a[82:83], v143 offset:3328
  ds_read_b64_tr_b16 a[84:85], v143 offset:12544
  ds_read_b64_tr_b16 a[86:87], v143 offset:15616
  ds_read_b64_tr_b16 a[160:161], v143 offset:512
  ds_read_b64_tr_b16 a[162:163], v143 offset:3584
  ds_read_b64_tr_b16 a[164:165], v143 offset:12800
  ds_read_b64_tr_b16 a[166:167], v143 offset:15872
  s_waitcnt lgkmcnt(0)
  s_waitcnt vmcnt(24)
  s_barrier
  s_lshl_b32 s29, s21, 10
  s_add_u32 m0, s29, 0
  s_mov_b32 s28, 4718592
  buffer_load_dwordx4 v136, s[12:15], s28 offen lds
  s_lshl_b32 s29, s21, 10
  s_add_u32 m0, s29, 4096
  s_mov_b32 s28, 4718592
  buffer_load_dwordx4 v137, s[12:15], s28 offen lds
  s_lshl_b32 s29, s21, 10
  s_add_u32 m0, s29, 8192
  s_mov_b32 s28, 4718592
  buffer_load_dwordx4 v138, s[12:15], s28 offen lds
  s_lshl_b32 s29, s21, 10
  s_add_u32 m0, s29, 12288
  s_mov_b32 s28, 4718592
  buffer_load_dwordx4 v139, s[12:15], s28 offen lds
  s_lshl_b32 s29, s21, 10
  s_add_u32 m0, s29, 16384
  s_mov_b32 s28, 4718592
  buffer_load_dwordx4 v140, s[12:15], s28 offen lds
  s_lshl_b32 s29, s21, 10
  s_add_u32 m0, s29, 20480
  s_mov_b32 s28, 4718592
  buffer_load_dwordx4 v141, s[12:15], s28 offen lds
  v_add_u32 v143, 24576, v142
  ds_read_b64_tr_b16 a[8:9], v143 offset:0
  ds_read_b64_tr_b16 a[10:11], v143 offset:3072
  ds_read_b64_tr_b16 a[12:13], v143 offset:12288
  ds_read_b64_tr_b16 a[14:15], v143 offset:15360
  ds_read_b64_tr_b16 a[88:89], v143 offset:256
  ds_read_b64_tr_b16 a[90:91], v143 offset:3328
  ds_read_b64_tr_b16 a[92:93], v143 offset:12544
  ds_read_b64_tr_b16 a[94:95], v143 offset:15616
  ds_read_b64_tr_b16 a[168:169], v143 offset:512
  ds_read_b64_tr_b16 a[170:171], v143 offset:3584
  ds_read_b64_tr_b16 a[172:173], v143 offset:12800
  ds_read_b64_tr_b16 a[174:175], v143 offset:15872
  s_waitcnt lgkmcnt(0)
  s_waitcnt vmcnt(24)
  s_barrier
  s_lshl_b32 s29, s21, 10
  s_add_u32 m0, s29, 24576
  s_mov_b32 s28, 5505024
  buffer_load_dwordx4 v136, s[12:15], s28 offen lds
  s_lshl_b32 s29, s21, 10
  s_add_u32 m0, s29, 28672
  s_mov_b32 s28, 5505024
  buffer_load_dwordx4 v137, s[12:15], s28 offen lds
  s_lshl_b32 s29, s21, 10
  s_add_u32 m0, s29, 32768
  s_mov_b32 s28, 5505024
  buffer_load_dwordx4 v138, s[12:15], s28 offen lds
  s_lshl_b32 s29, s21, 10
  s_add_u32 m0, s29, 36864
  s_mov_b32 s28, 5505024
  buffer_load_dwordx4 v139, s[12:15], s28 offen lds
  s_lshl_b32 s29, s21, 10
  s_add_u32 m0, s29, 40960
  s_mov_b32 s28, 5505024
  buffer_load_dwordx4 v140, s[12:15], s28 offen lds
  s_lshl_b32 s29, s21, 10
  s_add_u32 m0, s29, 45056
  s_mov_b32 s28, 5505024
  buffer_load_dwordx4 v141, s[12:15], s28 offen lds
  v_add_u32 v143, 49152, v142
  ds_read_b64_tr_b16 a[16:17], v143 offset:0
  ds_read_b64_tr_b16 a[18:19], v143 offset:3072
  ds_read_b64_tr_b16 a[20:21], v143 offset:12288
  ds_read_b64_tr_b16 a[22:23], v143 offset:15360
  ds_read_b64_tr_b16 a[96:97], v143 offset:256
  ds_read_b64_tr_b16 a[98:99], v143 offset:3328
  ds_read_b64_tr_b16 a[100:101], v143 offset:12544
  ds_read_b64_tr_b16 a[102:103], v143 offset:15616
  ds_read_b64_tr_b16 a[176:177], v143 offset:512
  ds_read_b64_tr_b16 a[178:179], v143 offset:3584
  ds_read_b64_tr_b16 a[180:181], v143 offset:12800
  ds_read_b64_tr_b16 a[182:183], v143 offset:15872
  s_waitcnt lgkmcnt(0)
  s_waitcnt vmcnt(24)
  s_barrier
  s_lshl_b32 s29, s21, 10
  s_add_u32 m0, s29, 49152
  s_mov_b32 s28, 6291456
  buffer_load_dwordx4 v136, s[12:15], s28 offen lds
  s_lshl_b32 s29, s21, 10
  s_add_u32 m0, s29, 53248
  s_mov_b32 s28, 6291456
  buffer_load_dwordx4 v137, s[12:15], s28 offen lds
  s_lshl_b32 s29, s21, 10
  s_add_u32 m0, s29, 57344
  s_mov_b32 s28, 6291456
  buffer_load_dwordx4 v138, s[12:15], s28 offen lds
  s_lshl_b32 s29, s21, 10
  s_add_u32 m0, s29, 61440
  s_mov_b32 s28, 6291456
  buffer_load_dwordx4 v139, s[12:15], s28 offen lds
  s_lshl_b32 s29, s21, 10
  s_add_u32 m0, s29, 65536
  s_mov_b32 s28, 6291456
  buffer_load_dwordx4 v140, s[12:15], s28 offen lds
  s_lshl_b32 s29, s21, 10
  s_add_u32 m0, s29, 69632
  s_mov_b32 s28, 6291456
  buffer_load_dwordx4 v141, s[12:15], s28 offen lds
  v_add_u32 v143, 73728, v142
  ds_read_b64_tr_b16 a[24:25], v143 offset:0
  ds_read_b64_tr_b16 a[26:27], v143 offset:3072
  ds_read_b64_tr_b16 a[28:29], v143 offset:12288
  ds_read_b64_tr_b16 a[30:31], v143 offset:15360
  ds_read_b64_tr_b16 a[104:105], v143 offset:256
  ds_read_b64_tr_b16 a[106:107], v143 offset:3328
  ds_read_b64_tr_b16 a[108:109], v143 offset:12544
  ds_read_b64_tr_b16 a[110:111], v143 offset:15616
  ds_read_b64_tr_b16 a[184:185], v143 offset:512
  ds_read_b64_tr_b16 a[186:187], v143 offset:3584
  ds_read_b64_tr_b16 a[188:189], v143 offset:12800
  ds_read_b64_tr_b16 a[190:191], v143 offset:15872
  s_waitcnt lgkmcnt(0)
  s_waitcnt vmcnt(24)
  s_barrier
  s_lshl_b32 s29, s21, 10
  s_add_u32 m0, s29, 73728
  s_mov_b32 s28, 7077888
  buffer_load_dwordx4 v136, s[12:15], s28 offen lds
  s_lshl_b32 s29, s21, 10
  s_add_u32 m0, s29, 77824
  s_mov_b32 s28, 7077888
  buffer_load_dwordx4 v137, s[12:15], s28 offen lds
  s_lshl_b32 s29, s21, 10
  s_add_u32 m0, s29, 81920
  s_mov_b32 s28, 7077888
  buffer_load_dwordx4 v138, s[12:15], s28 offen lds
  s_lshl_b32 s29, s21, 10
  s_add_u32 m0, s29, 86016
  s_mov_b32 s28, 7077888
  buffer_load_dwordx4 v139, s[12:15], s28 offen lds
  s_lshl_b32 s29, s21, 10
  s_add_u32 m0, s29, 90112
  s_mov_b32 s28, 7077888
  buffer_load_dwordx4 v140, s[12:15], s28 offen lds
  s_lshl_b32 s29, s21, 10
  s_add_u32 m0, s29, 94208
  s_mov_b32 s28, 7077888
  buffer_load_dwordx4 v141, s[12:15], s28 offen lds
  v_add_u32 v143, 98304, v142
  ds_read_b64_tr_b16 a[32:33], v143 offset:0
  ds_read_b64_tr_b16 a[34:35], v143 offset:3072
  ds_read_b64_tr_b16 a[36:37], v143 offset:12288
  ds_read_b64_tr_b16 a[38:39], v143 offset:15360
  ds_read_b64_tr_b16 a[112:113], v143 offset:256
  ds_read_b64_tr_b16 a[114:115], v143 offset:3328
  ds_read_b64_tr_b16 a[116:117], v143 offset:12544
  ds_read_b64_tr_b16 a[118:119], v143 offset:15616
  ds_read_b64_tr_b16 a[192:193], v143 offset:512
  ds_read_b64_tr_b16 a[194:195], v143 offset:3584
  ds_read_b64_tr_b16 a[196:197], v143 offset:12800
  ds_read_b64_tr_b16 a[198:199], v143 offset:15872
  s_waitcnt lgkmcnt(0)
  s_waitcnt vmcnt(24)
  s_barrier
  s_lshl_b32 s29, s21, 10
  s_add_u32 m0, s29, 98304
  s_mov_b32 s28, 0
  buffer_load_dwordx4 v136, s[16:19], s28 offen lds
  s_lshl_b32 s29, s21, 10
  s_add_u32 m0, s29, 102400
  s_mov_b32 s28, 0
  buffer_load_dwordx4 v137, s[16:19], s28 offen lds
  s_lshl_b32 s29, s21, 10
  s_add_u32 m0, s29, 106496
  s_mov_b32 s28, 0
  buffer_load_dwordx4 v138, s[16:19], s28 offen lds
  s_lshl_b32 s29, s21, 10
  s_add_u32 m0, s29, 110592
  s_mov_b32 s28, 0
  buffer_load_dwordx4 v139, s[16:19], s28 offen lds
  s_lshl_b32 s29, s21, 10
  s_add_u32 m0, s29, 114688
  s_mov_b32 s28, 0
  buffer_load_dwordx4 v140, s[16:19], s28 offen lds
  s_lshl_b32 s29, s21, 10
  s_add_u32 m0, s29, 118784
  s_mov_b32 s28, 0
  buffer_load_dwordx4 v141, s[16:19], s28 offen lds
  v_add_u32 v143, 122880, v142
  ds_read_b64_tr_b16 a[40:41], v143 offset:0
  ds_read_b64_tr_b16 a[42:43], v143 offset:3072
  ds_read_b64_tr_b16 a[44:45], v143 offset:12288
  ds_read_b64_tr_b16 a[46:47], v143 offset:15360
  ds_read_b64_tr_b16 a[120:121], v143 offset:256
  ds_read_b64_tr_b16 a[122:123], v143 offset:3328
  ds_read_b64_tr_b16 a[124:125], v143 offset:12544
  ds_read_b64_tr_b16 a[126:127], v143 offset:15616
  ds_read_b64_tr_b16 a[200:201], v143 offset:512
  ds_read_b64_tr_b16 a[202:203], v143 offset:3584
  ds_read_b64_tr_b16 a[204:205], v143 offset:12800
  ds_read_b64_tr_b16 a[206:207], v143 offset:15872
  s_waitcnt lgkmcnt(0)
  s_waitcnt vmcnt(24)
  s_barrier
  s_lshl_b32 s29, s21, 10
  s_add_u32 m0, s29, 122880
  s_mov_b32 s28, 1572864
  buffer_load_dwordx4 v136, s[16:19], s28 offen lds
  s_lshl_b32 s29, s21, 10
  s_add_u32 m0, s29, 126976
  s_mov_b32 s28, 1572864
  buffer_load_dwordx4 v137, s[16:19], s28 offen lds
  s_lshl_b32 s29, s21, 10
  s_add_u32 m0, s29, 131072
  s_mov_b32 s28, 1572864
  buffer_load_dwordx4 v138, s[16:19], s28 offen lds
  s_lshl_b32 s29, s21, 10
  s_add_u32 m0, s29, 135168
  s_mov_b32 s28, 1572864
  buffer_load_dwordx4 v139, s[16:19], s28 offen lds
  s_lshl_b32 s29, s21, 10
  s_add_u32 m0, s29, 139264
  s_mov_b32 s28, 1572864
  buffer_load_dwordx4 v140, s[16:19], s28 offen lds
  s_lshl_b32 s29, s21, 10
  s_add_u32 m0, s29, 143360
  s_mov_b32 s28, 1572864
  buffer_load_dwordx4 v141, s[16:19], s28 offen lds
  v_add_u32 v143, 0, v142
  ds_read_b64_tr_b16 a[48:49], v143 offset:0
  ds_read_b64_tr_b16 a[50:51], v143 offset:3072
  ds_read_b64_tr_b16 a[52:53], v143 offset:12288
  ds_read_b64_tr_b16 a[54:55], v143 offset:15360
  ds_read_b64_tr_b16 a[128:129], v143 offset:256
  ds_read_b64_tr_b16 a[130:131], v143 offset:3328
  ds_read_b64_tr_b16 a[132:133], v143 offset:12544
  ds_read_b64_tr_b16 a[134:135], v143 offset:15616
  ds_read_b64_tr_b16 a[208:209], v143 offset:512
  ds_read_b64_tr_b16 a[210:211], v143 offset:3584
  ds_read_b64_tr_b16 a[212:213], v143 offset:12800
  ds_read_b64_tr_b16 a[214:215], v143 offset:15872
  s_waitcnt lgkmcnt(0)
  s_waitcnt vmcnt(24)
  s_barrier
  s_lshl_b32 s29, s21, 10
  s_add_u32 m0, s29, 0
  s_mov_b32 s28, 3145728
  buffer_load_dwordx4 v136, s[16:19], s28 offen lds
  s_lshl_b32 s29, s21, 10
  s_add_u32 m0, s29, 4096
  s_mov_b32 s28, 3145728
  buffer_load_dwordx4 v137, s[16:19], s28 offen lds
  s_lshl_b32 s29, s21, 10
  s_add_u32 m0, s29, 8192
  s_mov_b32 s28, 3145728
  buffer_load_dwordx4 v138, s[16:19], s28 offen lds
  s_lshl_b32 s29, s21, 10
  s_add_u32 m0, s29, 12288
  s_mov_b32 s28, 3145728
  buffer_load_dwordx4 v139, s[16:19], s28 offen lds
  s_lshl_b32 s29, s21, 10
  s_add_u32 m0, s29, 16384
  s_mov_b32 s28, 3145728
  buffer_load_dwordx4 v140, s[16:19], s28 offen lds
  s_lshl_b32 s29, s21, 10
  s_add_u32 m0, s29, 20480
  s_mov_b32 s28, 3145728
  buffer_load_dwordx4 v141, s[16:19], s28 offen lds
  v_add_u32 v143, 24576, v142
  ds_read_b64_tr_b16 a[56:57], v143 offset:0
  ds_read_b64_tr_b16 a[58:59], v143 offset:3072
  ds_read_b64_tr_b16 a[60:61], v143 offset:12288
  ds_read_b64_tr_b16 a[62:63], v143 offset:15360
  ds_read_b64_tr_b16 a[136:137], v143 offset:256
  ds_read_b64_tr_b16 a[138:139], v143 offset:3328
  ds_read_b64_tr_b16 a[140:141], v143 offset:12544
  ds_read_b64_tr_b16 a[142:143], v143 offset:15616
  ds_read_b64_tr_b16 a[216:217], v143 offset:512
  ds_read_b64_tr_b16 a[218:219], v143 offset:3584
  ds_read_b64_tr_b16 a[220:221], v143 offset:12800
  ds_read_b64_tr_b16 a[222:223], v143 offset:15872
  s_waitcnt lgkmcnt(0)
  s_waitcnt vmcnt(24)
  s_barrier
  s_lshl_b32 s29, s21, 10
  s_add_u32 m0, s29, 24576
  s_mov_b32 s28, 4718592
  buffer_load_dwordx4 v136, s[16:19], s28 offen lds
  s_lshl_b32 s29, s21, 10
  s_add_u32 m0, s29, 28672
  s_mov_b32 s28, 4718592
  buffer_load_dwordx4 v137, s[16:19], s28 offen lds
  s_lshl_b32 s29, s21, 10
  s_add_u32 m0, s29, 32768
  s_mov_b32 s28, 4718592
  buffer_load_dwordx4 v138, s[16:19], s28 offen lds
  s_lshl_b32 s29, s21, 10
  s_add_u32 m0, s29, 36864
  s_mov_b32 s28, 4718592
  buffer_load_dwordx4 v139, s[16:19], s28 offen lds
  s_lshl_b32 s29, s21, 10
  s_add_u32 m0, s29, 40960
  s_mov_b32 s28, 4718592
  buffer_load_dwordx4 v140, s[16:19], s28 offen lds
  s_lshl_b32 s29, s21, 10
  s_add_u32 m0, s29, 45056
  s_mov_b32 s28, 4718592
  buffer_load_dwordx4 v141, s[16:19], s28 offen lds
  v_add_u32 v143, 49152, v142
  ds_read_b64_tr_b16 a[64:65], v143 offset:0
  ds_read_b64_tr_b16 a[66:67], v143 offset:3072
  ds_read_b64_tr_b16 a[68:69], v143 offset:12288
  ds_read_b64_tr_b16 a[70:71], v143 offset:15360
  ds_read_b64_tr_b16 a[144:145], v143 offset:256
  ds_read_b64_tr_b16 a[146:147], v143 offset:3328
  ds_read_b64_tr_b16 a[148:149], v143 offset:12544
  ds_read_b64_tr_b16 a[150:151], v143 offset:15616
  ds_read_b64_tr_b16 a[224:225], v143 offset:512
  ds_read_b64_tr_b16 a[226:227], v143 offset:3584
  ds_read_b64_tr_b16 a[228:229], v143 offset:12800
  ds_read_b64_tr_b16 a[230:231], v143 offset:15872
  s_waitcnt lgkmcnt(0)
  s_waitcnt vmcnt(24)
  s_barrier
  s_lshl_b32 s29, s21, 10
  s_add_u32 m0, s29, 49152
  s_mov_b32 s28, 6291456
  buffer_load_dwordx4 v136, s[16:19], s28 offen lds
  s_lshl_b32 s29, s21, 10
  s_add_u32 m0, s29, 53248
  s_mov_b32 s28, 6291456
  buffer_load_dwordx4 v137, s[16:19], s28 offen lds
  s_lshl_b32 s29, s21, 10
  s_add_u32 m0, s29, 57344
  s_mov_b32 s28, 6291456
  buffer_load_dwordx4 v138, s[16:19], s28 offen lds
  s_lshl_b32 s29, s21, 10
  s_add_u32 m0, s29, 61440
  s_mov_b32 s28, 6291456
  buffer_load_dwordx4 v139, s[16:19], s28 offen lds
  s_lshl_b32 s29, s21, 10
  s_add_u32 m0, s29, 65536
  s_mov_b32 s28, 6291456
  buffer_load_dwordx4 v140, s[16:19], s28 offen lds
  s_lshl_b32 s29, s21, 10
  s_add_u32 m0, s29, 69632
  s_mov_b32 s28, 6291456
  buffer_load_dwordx4 v141, s[16:19], s28 offen lds
  v_add_u32 v143, 73728, v142
  ds_read_b64_tr_b16 a[72:73], v143 offset:0
  ds_read_b64_tr_b16 a[74:75], v143 offset:3072
  ds_read_b64_tr_b16 a[76:77], v143 offset:12288
  ds_read_b64_tr_b16 a[78:79], v143 offset:15360
  ds_read_b64_tr_b16 a[152:153], v143 offset:256
  ds_read_b64_tr_b16 a[154:155], v143 offset:3328
  ds_read_b64_tr_b16 a[156:157], v143 offset:12544
  ds_read_b64_tr_b16 a[158:159], v143 offset:15616
  ds_read_b64_tr_b16 a[232:233], v143 offset:512
  ds_read_b64_tr_b16 a[234:235], v143 offset:3584
  ds_read_b64_tr_b16 a[236:237], v143 offset:12800
  ds_read_b64_tr_b16 a[238:239], v143 offset:15872
  s_waitcnt lgkmcnt(0)
  s_waitcnt vmcnt(24)
  s_barrier
  s_lshl_b32 s29, s21, 10
  s_add_u32 m0, s29, 73728
  s_mov_b32 s28, 786432
  buffer_load_dwordx4 v136, s[16:19], s28 offen lds
  s_lshl_b32 s29, s21, 10
  s_add_u32 m0, s29, 77824
  s_mov_b32 s28, 786432
  buffer_load_dwordx4 v137, s[16:19], s28 offen lds
  s_lshl_b32 s29, s21, 10
  s_add_u32 m0, s29, 81920
  s_mov_b32 s28, 786432
  buffer_load_dwordx4 v138, s[16:19], s28 offen lds
  s_lshl_b32 s29, s21, 10
  s_add_u32 m0, s29, 86016
  s_mov_b32 s28, 786432
  buffer_load_dwordx4 v139, s[16:19], s28 offen lds
  s_lshl_b32 s29, s21, 10
  s_add_u32 m0, s29, 90112
  s_mov_b32 s28, 786432
  buffer_load_dwordx4 v140, s[16:19], s28 offen lds
  s_lshl_b32 s29, s21, 10
  s_add_u32 m0, s29, 94208
  s_mov_b32 s28, 786432
  buffer_load_dwordx4 v141, s[16:19], s28 offen lds
  v_add_u32 v143, 98304, v142
  ds_read_b64_tr_b16 a[240:241], v143 offset:0
  ds_read_b64_tr_b16 a[242:243], v143 offset:3072
  ds_read_b64_tr_b16 a[244:245], v143 offset:12288
  ds_read_b64_tr_b16 a[246:247], v143 offset:15360
  ds_read_b64_tr_b16 v[176:177], v143 offset:256
  ds_read_b64_tr_b16 v[178:179], v143 offset:3328
  ds_read_b64_tr_b16 v[180:181], v143 offset:12544
  ds_read_b64_tr_b16 v[182:183], v143 offset:15616
  ds_read_b64_tr_b16 v[216:217], v143 offset:512
  ds_read_b64_tr_b16 v[218:219], v143 offset:3584
  ds_read_b64_tr_b16 v[220:221], v143 offset:12800
  ds_read_b64_tr_b16 v[222:223], v143 offset:15872
  s_waitcnt lgkmcnt(0)
  s_waitcnt vmcnt(24)
  s_barrier
  s_lshl_b32 s29, s21, 10
  s_add_u32 m0, s29, 98304
  s_mov_b32 s28, 2359296
  buffer_load_dwordx4 v136, s[16:19], s28 offen lds
  s_lshl_b32 s29, s21, 10
  s_add_u32 m0, s29, 102400
  s_mov_b32 s28, 2359296
  buffer_load_dwordx4 v137, s[16:19], s28 offen lds
  s_lshl_b32 s29, s21, 10
  s_add_u32 m0, s29, 106496
  s_mov_b32 s28, 2359296
  buffer_load_dwordx4 v138, s[16:19], s28 offen lds
  s_lshl_b32 s29, s21, 10
  s_add_u32 m0, s29, 110592
  s_mov_b32 s28, 2359296
  buffer_load_dwordx4 v139, s[16:19], s28 offen lds
  s_lshl_b32 s29, s21, 10
  s_add_u32 m0, s29, 114688
  s_mov_b32 s28, 2359296
  buffer_load_dwordx4 v140, s[16:19], s28 offen lds
  s_lshl_b32 s29, s21, 10
  s_add_u32 m0, s29, 118784
  s_mov_b32 s28, 2359296
  buffer_load_dwordx4 v141, s[16:19], s28 offen lds
  v_add_u32 v143, 122880, v142
  ds_read_b64_tr_b16 a[248:249], v143 offset:0
  ds_read_b64_tr_b16 a[250:251], v143 offset:3072
  ds_read_b64_tr_b16 a[252:253], v143 offset:12288
  ds_read_b64_tr_b16 a[254:255], v143 offset:15360
  ds_read_b64_tr_b16 v[184:185], v143 offset:256
  ds_read_b64_tr_b16 v[186:187], v143 offset:3328
  ds_read_b64_tr_b16 v[188:189], v143 offset:12544
  ds_read_b64_tr_b16 v[190:191], v143 offset:15616
  ds_read_b64_tr_b16 v[224:225], v143 offset:512
  ds_read_b64_tr_b16 v[226:227], v143 offset:3584
  ds_read_b64_tr_b16 v[228:229], v143 offset:12800
  ds_read_b64_tr_b16 v[230:231], v143 offset:15872
  s_waitcnt lgkmcnt(0)
  s_waitcnt vmcnt(24)
  s_barrier
  s_lshl_b32 s29, s21, 10
  s_add_u32 m0, s29, 122880
  s_mov_b32 s28, 3932160
  buffer_load_dwordx4 v136, s[16:19], s28 offen lds
  s_lshl_b32 s29, s21, 10
  s_add_u32 m0, s29, 126976
  s_mov_b32 s28, 3932160
  buffer_load_dwordx4 v137, s[16:19], s28 offen lds
  s_lshl_b32 s29, s21, 10
  s_add_u32 m0, s29, 131072
  s_mov_b32 s28, 3932160
  buffer_load_dwordx4 v138, s[16:19], s28 offen lds
  s_lshl_b32 s29, s21, 10
  s_add_u32 m0, s29, 135168
  s_mov_b32 s28, 3932160
  buffer_load_dwordx4 v139, s[16:19], s28 offen lds
  s_lshl_b32 s29, s21, 10
  s_add_u32 m0, s29, 139264
  s_mov_b32 s28, 3932160
  buffer_load_dwordx4 v140, s[16:19], s28 offen lds
  s_lshl_b32 s29, s21, 10
  s_add_u32 m0, s29, 143360
  s_mov_b32 s28, 3932160
  buffer_load_dwordx4 v141, s[16:19], s28 offen lds
  v_add_u32 v143, 0, v142
  ds_read_b64_tr_b16 v[152:153], v143 offset:0
  ds_read_b64_tr_b16 v[154:155], v143 offset:3072
  ds_read_b64_tr_b16 v[156:157], v143 offset:12288
  ds_read_b64_tr_b16 v[158:159], v143 offset:15360
  ds_read_b64_tr_b16 v[192:193], v143 offset:256
  ds_read_b64_tr_b16 v[194:195], v143 offset:3328
  ds_read_b64_tr_b16 v[196:197], v143 offset:12544
  ds_read_b64_tr_b16 v[198:199], v143 offset:15616
  ds_read_b64_tr_b16 v[232:233], v143 offset:512
  ds_read_b64_tr_b16 v[234:235], v143 offset:3584
  ds_read_b64_tr_b16 v[236:237], v143 offset:12800
  ds_read_b64_tr_b16 v[238:239], v143 offset:15872
  s_waitcnt lgkmcnt(0)
  s_waitcnt vmcnt(24)
  s_barrier
  s_lshl_b32 s29, s21, 10
  s_add_u32 m0, s29, 0
  s_mov_b32 s28, 5505024
  buffer_load_dwordx4 v136, s[16:19], s28 offen lds
  s_lshl_b32 s29, s21, 10
  s_add_u32 m0, s29, 4096
  s_mov_b32 s28, 5505024
  buffer_load_dwordx4 v137, s[16:19], s28 offen lds
  s_lshl_b32 s29, s21, 10
  s_add_u32 m0, s29, 8192
  s_mov_b32 s28, 5505024
  buffer_load_dwordx4 v138, s[16:19], s28 offen lds
  s_lshl_b32 s29, s21, 10
  s_add_u32 m0, s29, 12288
  s_mov_b32 s28, 5505024
  buffer_load_dwordx4 v139, s[16:19], s28 offen lds
  s_lshl_b32 s29, s21, 10
  s_add_u32 m0, s29, 16384
  s_mov_b32 s28, 5505024
  buffer_load_dwordx4 v140, s[16:19], s28 offen lds
  s_lshl_b32 s29, s21, 10
  s_add_u32 m0, s29, 20480
  s_mov_b32 s28, 5505024
  buffer_load_dwordx4 v141, s[16:19], s28 offen lds
  v_add_u32 v143, 24576, v142
  ds_read_b64_tr_b16 v[160:161], v143 offset:0
  ds_read_b64_tr_b16 v[162:163], v143 offset:3072
  ds_read_b64_tr_b16 v[164:165], v143 offset:12288
  ds_read_b64_tr_b16 v[166:167], v143 offset:15360
  ds_read_b64_tr_b16 v[200:201], v143 offset:256
  ds_read_b64_tr_b16 v[202:203], v143 offset:3328
  ds_read_b64_tr_b16 v[204:205], v143 offset:12544
  ds_read_b64_tr_b16 v[206:207], v143 offset:15616
  ds_read_b64_tr_b16 v[240:241], v143 offset:512
  ds_read_b64_tr_b16 v[242:243], v143 offset:3584
  ds_read_b64_tr_b16 v[244:245], v143 offset:12800
  ds_read_b64_tr_b16 v[246:247], v143 offset:15872
  s_waitcnt lgkmcnt(0)
  s_waitcnt vmcnt(24)
  s_barrier
  s_lshl_b32 s29, s21, 10
  s_add_u32 m0, s29, 24576
  s_mov_b32 s28, 7077888
  buffer_load_dwordx4 v136, s[16:19], s28 offen lds
  s_lshl_b32 s29, s21, 10
  s_add_u32 m0, s29, 28672
  s_mov_b32 s28, 7077888
  buffer_load_dwordx4 v137, s[16:19], s28 offen lds
  s_lshl_b32 s29, s21, 10
  s_add_u32 m0, s29, 32768
  s_mov_b32 s28, 7077888
  buffer_load_dwordx4 v138, s[16:19], s28 offen lds
  s_lshl_b32 s29, s21, 10
  s_add_u32 m0, s29, 36864
  s_mov_b32 s28, 7077888
  buffer_load_dwordx4 v139, s[16:19], s28 offen lds
  s_lshl_b32 s29, s21, 10
  s_add_u32 m0, s29, 40960
  s_mov_b32 s28, 7077888
  buffer_load_dwordx4 v140, s[16:19], s28 offen lds
  s_lshl_b32 s29, s21, 10
  s_add_u32 m0, s29, 45056
  s_mov_b32 s28, 7077888
  buffer_load_dwordx4 v141, s[16:19], s28 offen lds
  v_add_u32 v143, 49152, v142
  ds_read_b64_tr_b16 v[168:169], v143 offset:0
  ds_read_b64_tr_b16 v[170:171], v143 offset:3072
  ds_read_b64_tr_b16 v[172:173], v143 offset:12288
  ds_read_b64_tr_b16 v[174:175], v143 offset:15360
  ds_read_b64_tr_b16 v[208:209], v143 offset:256
  ds_read_b64_tr_b16 v[210:211], v143 offset:3328
  ds_read_b64_tr_b16 v[212:213], v143 offset:12544
  ds_read_b64_tr_b16 v[214:215], v143 offset:15616
  ds_read_b64_tr_b16 v[248:249], v143 offset:512
  ds_read_b64_tr_b16 v[250:251], v143 offset:3584
  ds_read_b64_tr_b16 v[252:253], v143 offset:12800
  ds_read_b64_tr_b16 v[254:255], v143 offset:15872
  s_waitcnt lgkmcnt(0)
  s_waitcnt vmcnt(24)
  s_barrier
  v_add_u32 v143, 73728, v142
  ds_read_b64_tr_b16 v[16:17], v143 offset:0
  ds_read_b64_tr_b16 v[18:19], v143 offset:3072
  ds_read_b64_tr_b16 v[20:21], v143 offset:12288
  ds_read_b64_tr_b16 v[22:23], v143 offset:15360
  ds_read_b64_tr_b16 v[24:25], v143 offset:256
  ds_read_b64_tr_b16 v[26:27], v143 offset:3328
  ds_read_b64_tr_b16 v[28:29], v143 offset:12544
  ds_read_b64_tr_b16 v[30:31], v143 offset:15616
  ds_read_b64_tr_b16 v[32:33], v143 offset:512
  ds_read_b64_tr_b16 v[34:35], v143 offset:3584
  ds_read_b64_tr_b16 v[36:37], v143 offset:12800
  ds_read_b64_tr_b16 v[38:39], v143 offset:15872
  s_waitcnt lgkmcnt(0)
  s_waitcnt vmcnt(18)
  s_barrier
  v_add_u32 v143, 98304, v142
  ds_read_b64_tr_b16 v[40:41], v143 offset:0
  ds_read_b64_tr_b16 v[42:43], v143 offset:3072
  ds_read_b64_tr_b16 v[44:45], v143 offset:12288
  ds_read_b64_tr_b16 v[46:47], v143 offset:15360
  ds_read_b64_tr_b16 v[48:49], v143 offset:256
  ds_read_b64_tr_b16 v[50:51], v143 offset:3328
  ds_read_b64_tr_b16 v[52:53], v143 offset:12544
  ds_read_b64_tr_b16 v[54:55], v143 offset:15616
  ds_read_b64_tr_b16 v[56:57], v143 offset:512
  ds_read_b64_tr_b16 v[58:59], v143 offset:3584
  ds_read_b64_tr_b16 v[60:61], v143 offset:12800
  ds_read_b64_tr_b16 v[62:63], v143 offset:15872
  s_waitcnt lgkmcnt(0)
  s_waitcnt vmcnt(12)
  s_barrier
  v_add_u32 v143, 122880, v142
  ds_read_b64_tr_b16 v[64:65], v143 offset:0
  ds_read_b64_tr_b16 v[66:67], v143 offset:3072
  ds_read_b64_tr_b16 v[68:69], v143 offset:12288
  ds_read_b64_tr_b16 v[70:71], v143 offset:15360
  ds_read_b64_tr_b16 v[72:73], v143 offset:256
  ds_read_b64_tr_b16 v[74:75], v143 offset:3328
  ds_read_b64_tr_b16 v[76:77], v143 offset:12544
  ds_read_b64_tr_b16 v[78:79], v143 offset:15616
  ds_read_b64_tr_b16 v[80:81], v143 offset:512
  ds_read_b64_tr_b16 v[82:83], v143 offset:3584
  ds_read_b64_tr_b16 v[84:85], v143 offset:12800
  ds_read_b64_tr_b16 v[86:87], v143 offset:15872
  s_waitcnt lgkmcnt(0)
  s_waitcnt vmcnt(6)
  s_barrier
  v_add_u32 v143, 0, v142
  ds_read_b64_tr_b16 v[88:89], v143 offset:0
  ds_read_b64_tr_b16 v[90:91], v143 offset:3072
  ds_read_b64_tr_b16 v[92:93], v143 offset:12288
  ds_read_b64_tr_b16 v[94:95], v143 offset:15360
  ds_read_b64_tr_b16 v[96:97], v143 offset:256
  ds_read_b64_tr_b16 v[98:99], v143 offset:3328
  ds_read_b64_tr_b16 v[100:101], v143 offset:12544
  ds_read_b64_tr_b16 v[102:103], v143 offset:15616
  ds_read_b64_tr_b16 v[104:105], v143 offset:512
  ds_read_b64_tr_b16 v[106:107], v143 offset:3584
  ds_read_b64_tr_b16 v[108:109], v143 offset:12800
  ds_read_b64_tr_b16 v[110:111], v143 offset:15872
  s_waitcnt lgkmcnt(0)
  s_waitcnt vmcnt(0)
  s_barrier
  v_add_u32 v143, 24576, v142
  ds_read_b64_tr_b16 v[112:113], v143 offset:0
  ds_read_b64_tr_b16 v[114:115], v143 offset:3072
  ds_read_b64_tr_b16 v[116:117], v143 offset:12288
  ds_read_b64_tr_b16 v[118:119], v143 offset:15360
  ds_read_b64_tr_b16 v[120:121], v143 offset:256
  ds_read_b64_tr_b16 v[122:123], v143 offset:3328
  ds_read_b64_tr_b16 v[124:125], v143 offset:12544
  ds_read_b64_tr_b16 v[126:127], v143 offset:15616
  ds_read_b64_tr_b16 v[128:129], v143 offset:512
  ds_read_b64_tr_b16 v[130:131], v143 offset:3584
  ds_read_b64_tr_b16 v[132:133], v143 offset:12800
  ds_read_b64_tr_b16 v[134:135], v143 offset:15872
  s_waitcnt lgkmcnt(0)
  s_barrier
  v_lshlrev_b32 v2, 4, v1
  s_mul_i32 s28, s21, 30720
  v_add_u32 v143, s28, v2
  ds_write_b128 v143, v[16:19] offset:0
  ds_write_b128 v143, v[20:23] offset:1024
  ds_write_b128 v143, v[24:27] offset:10240
  ds_write_b128 v143, v[28:31] offset:11264
  ds_write_b128 v143, v[32:35] offset:20480
  ds_write_b128 v143, v[36:39] offset:21504
  ds_write_b128 v143, v[40:43] offset:2048
  ds_write_b128 v143, v[44:47] offset:3072
  ds_write_b128 v143, v[48:51] offset:12288
  ds_write_b128 v143, v[52:55] offset:13312
  ds_write_b128 v143, v[56:59] offset:22528
  ds_write_b128 v143, v[60:63] offset:23552
  ds_write_b128 v143, v[64:67] offset:4096
  ds_write_b128 v143, v[68:71] offset:5120
  ds_write_b128 v143, v[72:75] offset:14336
  ds_write_b128 v143, v[76:79] offset:15360
  ds_write_b128 v143, v[80:83] offset:24576
  ds_write_b128 v143, v[84:87] offset:25600
  ds_write_b128 v143, v[88:91] offset:6144
  ds_write_b128 v143, v[92:95] offset:7168
  ds_write_b128 v143, v[96:99] offset:16384
  ds_write_b128 v143, v[100:103] offset:17408
  ds_write_b128 v143, v[104:107] offset:26624
  ds_write_b128 v143, v[108:111] offset:27648
  ds_write_b128 v143, v[112:115] offset:8192
  ds_write_b128 v143, v[116:119] offset:9216
  ds_write_b128 v143, v[120:123] offset:18432
  ds_write_b128 v143, v[124:127] offset:19456
  ds_write_b128 v143, v[128:131] offset:28672
  ds_write_b128 v143, v[132:135] offset:29696
  s_waitcnt lgkmcnt(0)
  v_and_b32 v1, 63, v0
  v_lshlrev_b32 v132, 4, v1
  s_mul_i32 s28, s21, 30720
  v_add_u32 v129, s28, v132
  s_lshl_b32 s28, s21, 10
  v_add_u32 v124, s28, v132
  v_add_u32 v125, 4096, v124
  v_add_u32 v126, 8192, v124
  v_add_u32 v127, 122880, v124
  v_add_u32 v128, 122880, v132
  v_and_b32 v2, 15, v1
  v_lshrrev_b32 v3, 4, v1
  v_add_u32 v3, v3, v2
  v_and_b32 v3, 3, v3
  v_lshlrev_b32 v3, 4, v3
  v_lshlrev_b32 v2, 6, v2
  v_add_u32 v2, v2, v3
  s_mul_i32 s28, s21, 3072
  s_add_u32 s28, s28, 133120
  v_add_u32 v130, s28, v2
  s_mul_i32 s28, s21, 1536
  s_add_u32 s28, s28, 145408
  v_lshlrev_b32 v2, 3, v1
  v_add_u32 v131, s28, v2
  v_mov_b32 v110, 0x44444444
  v_mov_b32 v2, 0xeeeeeeee
  v_and_b32 v3, 8, v1
  v_cmp_ne_u32 vcc, 0, v3
  s_nop 1
  v_cndmask_b32 v110, v110, v2, vcc
  v_and_b32 v4, 15, v1
  v_lshrrev_b32 v5, 4, v1
  v_lshlrev_b32 v6, 2, v5
  v_sub_u32 v6, v4, v6
  v_mov_b32 v7, 0x3f80
  v_mov_b32 v8, 0x3f800000
  v_mov_b32 v108, 0
  v_mov_b32 v109, 0
  v_cmp_eq_u32 vcc, 0, v6
  s_nop 1
  v_cndmask_b32 v108, v108, v7, vcc
  v_cmp_eq_u32 vcc, 1, v6
  s_nop 1
  v_cndmask_b32 v108, v108, v8, vcc
  v_cmp_eq_u32 vcc, 2, v6
  s_nop 1
  v_cndmask_b32 v109, v109, v7, vcc
  v_cmp_eq_u32 vcc, 3, v6
  s_nop 1
  v_cndmask_b32 v109, v109, v8, vcc
  s_mul_i32 s28, s23, 6
  s_lshr_b32 s29, s28, 3
  s_add_u32 s28, s28, 5
  s_lshr_b32 s28, s28, 3
  v_mov_b32 v6, s29
  v_mov_b32 v7, s28
  v_and_b32 v8, 1, v1
  v_cmp_eq_u32 vcc, 1, v8
  s_nop 1
  v_cndmask_b32 v6, v6, v7, vcc
  v_lshlrev_b32 v6, 2, v6
  v_bfe_u32 v8, v1, 1, 1
  v_lshlrev_b32 v8, 10, v8
  v_add_u32 v6, v6, v8
  v_add_u32 v138, 0, v6
  s_mul_i32 s97, s20, 655360
  s_add_u32 s97, s97, 0x400000
  s_mov_b32 s48, 0x4000
  s_mul_i32 s49, s20, 327680
  s_add_u32 s49, s49, 0x700000
  s_mul_i32 s50, s23, 786432
  s_add_u32 s63, s50, 0x4800000
  s_add_u32 s50, s50, 0x6000000
  s_mov_b32 s51, 0
  s_mov_b32 s52, 0
  s_mul_i32 s28, s21, 3
  s_add_u32 s28, s28, 0
  s_lshr_b32 s29, s28, 1
  s_lshl_b32 s29, s29, 11
  s_and_b32 s28, s28, 1
  s_lshl_b32 s28, s28, 3
  s_add_u32 s53, s29, s28
  s_mul_i32 s28, s21, 3
  s_add_u32 s28, s28, 1
  s_lshr_b32 s29, s28, 1
  s_lshl_b32 s29, s29, 11
  s_and_b32 s28, s28, 1
  s_lshl_b32 s28, s28, 3
  s_add_u32 s54, s29, s28
  s_mul_i32 s28, s21, 3
  s_add_u32 s28, s28, 2
  s_lshr_b32 s29, s28, 1
  s_lshl_b32 s29, s29, 11
  s_and_b32 s28, s28, 1
  s_lshl_b32 s28, s28, 3
  s_add_u32 s55, s29, s28
  v_mov_b32 v60, 0
  v_mov_b32 v61, 0
  v_mov_b32 v62, 0
  v_mov_b32 v63, 0
  v_mov_b32 v64, 0
  v_mov_b32 v65, 0
  v_mov_b32 v66, 0
  v_mov_b32 v67, 0
  v_mov_b32 v68, 0
  v_mov_b32 v69, 0
  v_mov_b32 v70, 0
  v_mov_b32 v71, 0
  v_mov_b32 v72, 0
  v_mov_b32 v73, 0
  v_mov_b32 v74, 0
  v_mov_b32 v75, 0
  v_mov_b32 v36, 0
  v_mov_b32 v37, 0
  v_mov_b32 v38, 0
  v_mov_b32 v39, 0
  v_mov_b32 v40, 0
  v_mov_b32 v41, 0
  v_mov_b32 v42, 0
  v_mov_b32 v43, 0
  s_barrier
  s_cmp_gt_u32 s52, s51
  s_cbranch_scc1 ka\sfx\()_x_wp_91_ok
  s_mov_b32 s45, 0
ka\sfx\()_x_wp_91_spin:
  buffer_load_dword v2, v138, s[8:11], 0 offen sc1
  s_add_u32 s45, s45, 1
  s_waitcnt vmcnt(0)
  v_min_u32_dpp v3, v2, v2 quad_perm:[1,0,3,2] row_mask:0xf bank_mask:0xf
  s_nop 1
  v_min_u32_dpp v2, v3, v3 quad_perm:[2,3,0,1] row_mask:0xf bank_mask:0xf
  s_nop 1
  v_min_u32_dpp v3, v2, v2 row_half_mirror row_mask:0xf bank_mask:0xf
  s_nop 1
  v_min_u32_dpp v2, v3, v3 quad_perm:[0,1,2,3] row_mask:0xf bank_mask:0xf
  s_nop 0
  v_readfirstlane_b32 s52, v2
  s_cmp_gt_u32 s52, s51
  s_cbranch_scc1 ka\sfx\()_x_wp_91_ok
  s_cmp_lt_u32 s45, 400000
  s_cbranch_scc1 ka\sfx\()_x_wp_91_spin
  s_branch ka\sfx\()_abort
ka\sfx\()_x_wp_91_ok:
  s_add_u32 s28, s50, s53
  buffer_load_dwordx2 v[88:89], v132, s[8:11], s28 offen offset:0 sc1
  buffer_load_dwordx2 v[92:93], v132, s[8:11], s28 offen offset:1024 sc1
  s_add_u32 s28, s50, s54
  buffer_load_dwordx2 v[90:91], v132, s[8:11], s28 offen offset:0 sc1
  buffer_load_dwordx2 v[94:95], v132, s[8:11], s28 offen offset:1024 sc1
  s_add_u32 s28, s50, s55
  buffer_load_dwordx2 v[96:97], v132, s[8:11], s28 offen offset:0 sc1
  buffer_load_dwordx2 v[98:99], v132, s[8:11], s28 offen offset:1024 sc1
  s_cmp_eq_u32 s21, 0
  s_cbranch_scc1 ka\sfx\()_x_w0
  s_cmp_eq_u32 s21, 1
  s_cbranch_scc1 ka\sfx\()_x_w1
  s_branch ka\sfx\()_x_w23
ka\sfx\()_x_w0:
  v_lshrrev_b32 v4, 3, v1
  v_and_b32 v5, 7, v1
  v_lshrrev_b32 v6, 2, v5
  v_and_b32 v7, 3, v5
  v_lshlrev_b32 v8, 10, v6
  v_lshlrev_b32 v9, 6, v4
  v_add_u32 v8, v8, v9
  v_add_u32 v9, v7, v4
  v_and_b32 v9, 3, v9
  v_lshlrev_b32 v9, 4, v9
  v_add_u32 v8, v8, v9
  v_add_u32 v133, 134144, v8
  v_add_u32 v8, 2, v6
  v_add_u32 v8, v8, v4
  v_and_b32 v8, 3, v8
  v_lshlrev_b32 v8, 4, v8
  v_lshlrev_b32 v9, 6, v4
  v_add_u32 v8, v8, v9
  v_lshlrev_b32 v9, 2, v7
  v_add_u32 v8, v8, v9
  v_add_u32 v134, 133120, v8
  s_and_b32 s26, s23, 7
  v_and_b32 v8, 1, v7
  v_lshlrev_b32 v8, 1, v8
  v_add_u32 v8, v8, v6
  v_lshlrev_b32 v8, 4, v8
  v_add_u32 v8, v8, v4
  v_lshlrev_b32 v8, 4, v8
  v_lshrrev_b32 v9, 1, v7
  v_lshlrev_b32 v9, 3, v9
  v_add_u32 v8, v8, v9
  s_lshr_b32 s28, s26, 1
  s_lshl_b32 s28, s28, 10
  s_and_b32 s29, s26, 1
  s_lshl_b32 s29, s29, 7
  s_add_u32 s28, s28, s29
  v_add_u32 v135, s28, v8
  v_lshlrev_b32 v8, 4, v6
  v_add_u32 v8, v8, v4
  v_lshlrev_b32 v8, 4, v8
  v_lshlrev_b32 v9, 1, v7
  v_add_u32 v8, v8, v9
  s_lshr_b32 s28, s26, 2
  s_lshl_b32 s28, s28, 7
  s_and_b32 s29, s26, 1
  s_lshl_b32 s29, s29, 9
  s_add_u32 s28, s28, s29
  s_bfe_u32 s29, s26, 0x10001
  s_lshl_b32 s29, s29, 3
  s_add_u32 s28, s28, s29
  s_add_u32 s28, s28, 4096
  v_add_u32 v8, s28, v8
  v_mov_b32 v9, 0x40000000
  v_and_b32 v10, 1, v5
  v_cmp_eq_u32 vcc, 0, v10
  s_nop 1
  v_cndmask_b32 v136, v9, v8, vcc
  s_mov_b32 s64, 0x3dd53b95
  s_mov_b32 s65, 0x3dd53b95
  v_mov_b32 v137, 0x42800000
ka\sfx\()_x_w0l:
  ds_read_b128 v[44:47], v129 offset:0
  ds_read_b128 v[48:51], v129 offset:1024
  ds_read_b128 v[52:55], v129 offset:2048
  ds_read_b128 v[56:59], v129 offset:3072
  s_waitcnt lgkmcnt(0)
  s_mov_b32 s45, 0
ka\sfx\()_x_pf_92:
  buffer_load_dwordx4 v[112:115], v124, s[8:11], s48 offen sc1
  buffer_load_dwordx4 v[116:119], v125, s[8:11], s48 offen sc1
  buffer_load_dwordx4 v[120:123], v126, s[8:11], s48 offen sc1
  s_add_u32 s45, s45, 1
  s_waitcnt vmcnt(2)
  ds_write_b128 v127, v[112:115] offset:0
  v_max3_u32 v139, v112, v113, v114
  v_max_u32 v139, v139, v115
  s_waitcnt vmcnt(1)
  ds_write_b128 v127, v[116:119] offset:4096
  v_max3_u32 v139, v139, v116, v117
  v_max3_u32 v139, v139, v118, v119
  s_waitcnt vmcnt(0)
  ds_write_b128 v127, v[120:123] offset:8192
  v_max3_u32 v139, v139, v120, v121
  v_max3_u32 v139, v139, v122, v123
  v_cmp_eq_u32 vcc, -1, v139
  s_cbranch_vccz ka\sfx\()_x_pf_92_ok
  s_cmp_lt_u32 s45, 400000
  s_cbranch_scc1 ka\sfx\()_x_pf_92
  s_branch ka\sfx\()_abort
ka\sfx\()_x_pf_92_ok:
  v_smfmac_f32_16x16x64_bf16 v[60:63], v[112:115], a[0:7], v110
  v_smfmac_f32_16x16x64_bf16 v[64:67], v[112:115], a[240:247], v110
  v_smfmac_f32_16x16x64_bf16 v[68:71], v[112:115], a[80:87], v110
  v_smfmac_f32_16x16x64_bf16 v[72:75], v[112:115], v[176:183], v110
  s_waitcnt lgkmcnt(0)
  s_barrier
  v_smfmac_f32_16x16x64_bf16 v[36:39], v[112:115], a[160:167], v110
  ds_read_b128 v[4:7], v128 offset:1024
  v_smfmac_f32_16x16x64_bf16 v[40:43], v[112:115], v[216:223], v110
  ds_read_b128 v[8:11], v128 offset:2048
  v_smfmac_f32_16x16x64_bf16 v[60:63], v[116:119], a[32:39], v110
  ds_read_b128 v[12:15], v128 offset:3072
  v_smfmac_f32_16x16x64_bf16 v[64:67], v[116:119], v[152:159], v110
  ds_read_b128 v[16:19], v128 offset:5120
  v_smfmac_f32_16x16x64_bf16 v[68:71], v[116:119], a[112:119], v110
  ds_read_b128 v[20:23], v128 offset:6144
  v_smfmac_f32_16x16x64_bf16 v[72:75], v[116:119], v[192:199], v110
  ds_read_b128 v[24:27], v128 offset:7168
  v_smfmac_f32_16x16x64_bf16 v[36:39], v[116:119], a[192:199], v110
  ds_read_b128 v[28:31], v128 offset:9216
  v_smfmac_f32_16x16x64_bf16 v[40:43], v[116:119], v[232:239], v110
  v_smfmac_f32_16x16x64_bf16 v[60:63], v[120:123], a[64:71], v110
  v_smfmac_f32_16x16x64_bf16 v[64:67], v[120:123], v[168:175], v110
  v_smfmac_f32_16x16x64_bf16 v[68:71], v[120:123], a[144:151], v110
  v_smfmac_f32_16x16x64_bf16 v[72:75], v[120:123], v[208:215], v110
  v_smfmac_f32_16x16x64_bf16 v[36:39], v[120:123], a[224:231], v110
  v_smfmac_f32_16x16x64_bf16 v[40:43], v[120:123], v[248:255], v110
  s_waitcnt lgkmcnt(6)
  v_smfmac_f32_16x16x64_bf16 v[60:63], v[4:7], a[8:15], v110
  v_smfmac_f32_16x16x64_bf16 v[64:67], v[4:7], v[44:51], v110
  ds_read_b128 v[44:47], v129 offset:4096
  s_waitcnt lgkmcnt(6)
  v_smfmac_f32_16x16x64_bf16 v[60:63], v[8:11], a[16:23], v110
  ds_read_b128 v[48:51], v129 offset:5120
  v_smfmac_f32_16x16x64_bf16 v[64:67], v[8:11], a[248:255], v110
  s_waitcnt lgkmcnt(6)
  v_smfmac_f32_16x16x64_bf16 v[60:63], v[12:15], a[24:31], v110
  v_smfmac_f32_16x16x64_bf16 v[64:67], v[12:15], v[52:59], v110
  ds_read_b128 v[52:55], v129 offset:6144
  s_waitcnt lgkmcnt(6)
  v_smfmac_f32_16x16x64_bf16 v[60:63], v[16:19], a[40:47], v110
  ds_read_b128 v[56:59], v129 offset:7168
  s_waitcnt lgkmcnt(2)
  v_smfmac_f32_16x16x64_bf16 v[64:67], v[16:19], v[44:51], v110
  ds_read_b128 v[44:47], v129 offset:8192
  v_smfmac_f32_16x16x64_bf16 v[60:63], v[20:23], a[48:55], v110
  ds_read_b128 v[48:51], v129 offset:9216
  v_smfmac_f32_16x16x64_bf16 v[64:67], v[20:23], v[160:167], v110
  v_smfmac_f32_16x16x64_bf16 v[60:63], v[24:27], a[56:63], v110
  s_waitcnt lgkmcnt(2)
  v_smfmac_f32_16x16x64_bf16 v[64:67], v[24:27], v[52:59], v110
  ds_read_b128 v[52:55], v129 offset:10240
  v_smfmac_f32_16x16x64_bf16 v[60:63], v[28:31], a[72:79], v110
  ds_read_b128 v[56:59], v129 offset:11264
  s_waitcnt lgkmcnt(2)
  v_smfmac_f32_16x16x64_bf16 v[64:67], v[28:31], v[44:51], v110
  ds_read_b128 v[44:47], v129 offset:12288
  v_smfmac_f32_16x16x64_bf16 v[68:71], v[4:7], a[88:95], v110
  ds_read_b128 v[48:51], v129 offset:13312
  s_waitcnt lgkmcnt(2)
  v_smfmac_f32_16x16x64_bf16 v[72:75], v[4:7], v[52:59], v110
  ds_read_b128 v[52:55], v129 offset:14336
  v_permlane32_swap_b32 v60, v64
  v_smfmac_f32_16x16x64_bf16 v[68:71], v[8:11], a[96:103], v110
  ds_read_b128 v[56:59], v129 offset:15360
  v_smfmac_f32_16x16x64_bf16 v[72:75], v[8:11], v[184:191], v110
  v_permlane32_swap_b32 v61, v65
  v_smfmac_f32_16x16x64_bf16 v[68:71], v[12:15], a[104:111], v110
  s_waitcnt lgkmcnt(2)
  v_smfmac_f32_16x16x64_bf16 v[72:75], v[12:15], v[44:51], v110
  ds_read_b128 v[44:47], v129 offset:16384
  v_permlane32_swap_b32 v62, v66
  v_smfmac_f32_16x16x64_bf16 v[68:71], v[16:19], a[120:127], v110
  ds_read_b128 v[48:51], v129 offset:17408
  v_permlane32_swap_b32 v63, v67
  s_waitcnt lgkmcnt(2)
  v_smfmac_f32_16x16x64_bf16 v[72:75], v[16:19], v[52:59], v110
  ds_read_b128 v[52:55], v129 offset:18432
  v_add_f32 v60, v60, v64
  v_smfmac_f32_16x16x64_bf16 v[68:71], v[20:23], a[128:135], v110
  ds_read_b128 v[56:59], v129 offset:19456
  v_add_f32 v61, v61, v65
  v_smfmac_f32_16x16x64_bf16 v[72:75], v[20:23], v[200:207], v110
  v_add_f32 v62, v62, v66
  v_smfmac_f32_16x16x64_bf16 v[68:71], v[24:27], a[136:143], v110
  v_add_f32 v63, v63, v67
  s_waitcnt lgkmcnt(2)
  v_smfmac_f32_16x16x64_bf16 v[72:75], v[24:27], v[44:51], v110
  ds_read_b128 v[44:47], v129 offset:20480
  v_cvt_pk_bf16_f32 v100, v60, v61
  v_smfmac_f32_16x16x64_bf16 v[68:71], v[28:31], a[152:159], v110
  ds_read_b128 v[48:51], v129 offset:21504
  v_cvt_pk_bf16_f32 v101, v62, v63
  s_waitcnt lgkmcnt(2)
  v_smfmac_f32_16x16x64_bf16 v[72:75], v[28:31], v[52:59], v110
  ds_read_b128 v[52:55], v129 offset:22528
  v_smfmac_f32_16x16x64_bf16 v[36:39], v[4:7], a[168:175], v110
  ds_read_b128 v[56:59], v129 offset:23552
  s_waitcnt lgkmcnt(2)
  v_smfmac_f32_16x16x64_bf16 v[40:43], v[4:7], v[44:51], v110
  ds_read_b128 v[44:47], v129 offset:24576
  v_permlane32_swap_b32 v68, v72
  v_smfmac_f32_16x16x64_bf16 v[36:39], v[8:11], a[176:183], v110
  ds_read_b128 v[48:51], v129 offset:25600
  v_smfmac_f32_16x16x64_bf16 v[40:43], v[8:11], v[224:231], v110
  v_permlane32_swap_b32 v69, v73
  v_smfmac_f32_16x16x64_bf16 v[36:39], v[12:15], a[184:191], v110
  s_waitcnt lgkmcnt(2)
  v_smfmac_f32_16x16x64_bf16 v[40:43], v[12:15], v[52:59], v110
  ds_read_b128 v[52:55], v129 offset:26624
  v_permlane32_swap_b32 v70, v74
  v_smfmac_f32_16x16x64_bf16 v[36:39], v[16:19], a[200:207], v110
  ds_read_b128 v[56:59], v129 offset:27648
  v_permlane32_swap_b32 v71, v75
  s_waitcnt lgkmcnt(2)
  v_smfmac_f32_16x16x64_bf16 v[40:43], v[16:19], v[44:51], v110
  ds_read_b128 v[44:47], v129 offset:28672
  v_add_f32 v68, v68, v72
  v_smfmac_f32_16x16x64_bf16 v[36:39], v[20:23], a[208:215], v110
  ds_read_b128 v[48:51], v129 offset:29696
  v_add_f32 v69, v69, v73
  v_smfmac_f32_16x16x64_bf16 v[40:43], v[20:23], v[240:247], v110
  v_add_f32 v70, v70, v74
  v_smfmac_f32_16x16x64_bf16 v[36:39], v[24:27], a[216:223], v110
  v_add_f32 v71, v71, v75
  s_waitcnt lgkmcnt(2)
  v_smfmac_f32_16x16x64_bf16 v[40:43], v[24:27], v[52:59], v110
  v_cvt_pk_bf16_f32 v102, v68, v69
  v_smfmac_f32_16x16x64_bf16 v[36:39], v[28:31], a[232:239], v110
  v_cvt_pk_bf16_f32 v103, v70, v71
  s_waitcnt lgkmcnt(0)
  v_smfmac_f32_16x16x64_bf16 v[40:43], v[28:31], v[44:51], v110
  v_mfma_f32_16x16x16_bf16 v[142:145], v[100:101], v[108:109], 0
  v_mfma_f32_16x16x16_bf16 v[146:149], v[102:103], v[108:109], 0
  s_nop 1
  v_permlane32_swap_b32 v36, v40
  v_permlane32_swap_b32 v37, v41
  v_permlane32_swap_b32 v38, v42
  v_permlane32_swap_b32 v39, v43
  v_add_f32 v36, v36, v40
  v_add_f32 v37, v37, v41
  v_add_f32 v38, v38, v42
  v_add_f32 v39, v39, v43
  v_cvt_pk_bf16_f32 v104, v36, v37
  v_cvt_pk_bf16_f32 v105, v38, v39
  v_cvt_pk_bf16_f32 v44, v142, v143
  v_cvt_pk_bf16_f32 v45, v144, v145
  v_mfma_f32_16x16x16_bf16 v[142:145], v[104:105], v[108:109], 0
  v_cvt_pk_bf16_f32 v46, v146, v147
  v_cvt_pk_bf16_f32 v47, v148, v149
  s_nop 1
  v_mfma_f32_16x16x32_bf16 v[76:79], v[44:47], v[44:47], 0
  v_mfma_f32_16x16x32_bf16 v[80:83], v[88:91], v[44:47], 0
  v_cvt_pk_bf16_f32 v106, v142, v143
  v_cvt_pk_bf16_f32 v107, v144, v145
  v_mfma_f32_16x16x32_bf16 v[84:87], v[92:95], v[44:47], 0
  s_nop 0
  v_mfma_f32_16x16x16_bf16 v[76:79], v[106:107], v[106:107], v[76:79]
  v_mfma_f32_16x16x16_bf16 v[80:83], v[96:97], v[106:107], v[80:83]
  v_mfma_f32_16x16x16_bf16 v[84:87], v[98:99], v[106:107], v[84:87]
  s_mov_b32 exec_lo, 0
  s_mov_b32 exec_hi, 0x00ff00ff
  s_nop 3
  ds_write_b128 v130, v[76:79]
  s_mov_b32 exec_lo, 0x00ff00ff
  ds_write_b128 v130, v[80:83] offset:1024
  s_nop 0
  ds_write_b128 v130, v[84:87] offset:2048
  s_mov_b64 exec, -1
  s_waitcnt lgkmcnt(0)
  s_barrier
  s_cmp_ge_u32 s51, 63
  s_cbranch_scc0 x63_93_\sfx\()
  ds_write_b64 v131, v[44:45]
  ds_write_b64 v131, v[46:47] offset:512
  ds_write_b64 v131, v[106:107] offset:1024
  s_branch ka\sfx\()_x_done
x63_93_\sfx\():
  ds_read_b128 v[4:7], v133 offset:0
  ds_read_b32 v20, v134 offset:0
  ds_read_b128 v[8:11], v133 offset:3072
  ds_read_b32 v21, v134 offset:3072
  ds_read_b128 v[12:15], v133 offset:6144
  ds_read_b32 v22, v134 offset:6144
  ds_read_b128 v[16:19], v133 offset:9216
  ds_read_b32 v23, v134 offset:9216
  s_waitcnt lgkmcnt(4)
  v_pk_add_f32 v[4:5], v[4:5], v[8:9]
  v_pk_add_f32 v[6:7], v[6:7], v[10:11]
  v_add_f32 v20, v20, v21
  s_waitcnt lgkmcnt(0)
  v_pk_add_f32 v[12:13], v[12:13], v[16:17]
  v_pk_add_f32 v[14:15], v[14:15], v[18:19]
  v_add_f32 v22, v22, v23
  v_pk_add_f32 v[4:5], v[4:5], v[12:13]
  v_pk_add_f32 v[6:7], v[6:7], v[14:15]
  v_add_f32 v8, v20, v22
  v_pk_mul_f32 v[4:5], v[4:5], s[64:65]
  v_pk_mul_f32 v[6:7], v[6:7], s[64:65]
  v_mul_f32 v8, s64, v8
  v_max3_f32 v24, abs(v4), abs(v5), abs(v6)
  v_max3_f32 v24, v24, abs(v7), abs(v8)
  v_cmp_nlt_f32 vcc, v24, v137
  s_cbranch_vccz smx_94_go_\sfx\()
  v_max3_f32 v24, v4, v5, v6
  v_max3_f32 v24, v24, v7, v8
  s_nop 1
  v_max_f32_dpp v25, v24, v24 quad_perm:[1,0,3,2] row_mask:0xf bank_mask:0xf
  s_nop 1
  v_max_f32_dpp v24, v25, v25 quad_perm:[2,3,0,1] row_mask:0xf bank_mask:0xf
  s_nop 1
  v_max_f32_dpp v25, v24, v24 row_half_mirror row_mask:0xf bank_mask:0xf
  v_sub_f32 v4, v4, v25
  v_sub_f32 v5, v5, v25
  v_sub_f32 v6, v6, v25
  v_sub_f32 v7, v7, v25
  v_sub_f32 v8, v8, v25
smx_94_go_\sfx\():
  v_exp_f32 v4, v4
  v_exp_f32 v5, v5
  v_exp_f32 v6, v6
  v_exp_f32 v7, v7
  v_exp_f32 v8, v8
  v_add_f32 v24, v4, v5
  v_add_f32 v25, v6, v7
  v_add_f32 v24, v24, v8
  v_add_f32 v24, v24, v25
  s_nop 1
  v_add_f32_dpp v25, v24, v24 quad_perm:[1,0,3,2] row_mask:0xf bank_mask:0xf
  s_nop 1
  v_add_f32_dpp v24, v25, v25 quad_perm:[2,3,0,1] row_mask:0xf bank_mask:0xf
  s_nop 1
  v_add_f32_dpp v25, v24, v24 row_half_mirror row_mask:0xf bank_mask:0xf
  v_rcp_f32 v24, v25
  s_nop 0
  v_mul_f32 v8, v8, v24
  v_pk_mul_f32 v[4:5], v[4:5], v[24:25] op_sel_hi:[1,0]
  v_pk_mul_f32 v[6:7], v[6:7], v[24:25] op_sel_hi:[1,0]
  v_mov_b32_dpp v9, v8 quad_perm:[1,0,3,2] row_mask:0xf bank_mask:0xf
  v_cvt_pk_bf16_f32 v10, v4, v5
  v_cvt_pk_bf16_f32 v11, v6, v7
  buffer_store_dwordx2 v[10:11], v135, s[8:11], s49 offen \pol
  v_cvt_pk_bf16_f32 v12, v8, v9
  buffer_store_dword v12, v136, s[8:11], s49 offen \pol
  ds_write_b64 v131, v[44:45]
  ds_write_b64 v131, v[46:47] offset:512
  ds_write_b64 v131, v[106:107] offset:1024
  s_waitcnt lgkmcnt(0)
  s_barrier
  v_mov_b32 v60, 0
  v_mov_b32 v61, 0
  v_mov_b32 v62, 0
  v_mov_b32 v63, 0
  v_mov_b32 v64, 0
  v_mov_b32 v65, 0
  v_mov_b32 v66, 0
  v_mov_b32 v67, 0
  v_mov_b32 v68, 0
  v_mov_b32 v69, 0
  v_mov_b32 v70, 0
  v_mov_b32 v71, 0
  v_mov_b32 v72, 0
  v_mov_b32 v73, 0
  v_mov_b32 v74, 0
  v_mov_b32 v75, 0
  v_mov_b32 v36, 0
  v_mov_b32 v37, 0
  v_mov_b32 v38, 0
  v_mov_b32 v39, 0
  v_mov_b32 v40, 0
  v_mov_b32 v41, 0
  v_mov_b32 v42, 0
  v_mov_b32 v43, 0
  s_add_u32 s97, s97, 10240
  s_mov_b32 s48, s97
  s_add_u32 s49, s49, 5120
  s_add_u32 s50, s50, 12288
  s_add_u32 s63, s63, 12288
  s_add_u32 s51, s51, 1
  s_cmp_gt_u32 s52, s51
  s_cbranch_scc1 ka\sfx\()_x_wp_95_ok
  s_mov_b32 s45, 0
ka\sfx\()_x_wp_95_spin:
  buffer_load_dword v2, v138, s[8:11], 0 offen sc1
  s_add_u32 s45, s45, 1
  s_waitcnt vmcnt(0)
  v_min_u32_dpp v3, v2, v2 quad_perm:[1,0,3,2] row_mask:0xf bank_mask:0xf
  s_nop 1
  v_min_u32_dpp v2, v3, v3 quad_perm:[2,3,0,1] row_mask:0xf bank_mask:0xf
  s_nop 1
  v_min_u32_dpp v3, v2, v2 row_half_mirror row_mask:0xf bank_mask:0xf
  s_nop 1
  v_min_u32_dpp v2, v3, v3 quad_perm:[0,1,2,3] row_mask:0xf bank_mask:0xf
  s_nop 0
  v_readfirstlane_b32 s52, v2
  s_cmp_gt_u32 s52, s51
  s_cbranch_scc1 ka\sfx\()_x_wp_95_ok
  s_cmp_lt_u32 s45, 400000
  s_cbranch_scc1 ka\sfx\()_x_wp_95_spin
  s_branch ka\sfx\()_abort
ka\sfx\()_x_wp_95_ok:
  s_add_u32 s28, s50, s53
  buffer_load_dwordx2 v[88:89], v132, s[8:11], s28 offen offset:0 sc1
  buffer_load_dwordx2 v[92:93], v132, s[8:11], s28 offen offset:1024 sc1
  s_add_u32 s28, s50, s54
  buffer_load_dwordx2 v[90:91], v132, s[8:11], s28 offen offset:0 sc1
  buffer_load_dwordx2 v[94:95], v132, s[8:11], s28 offen offset:1024 sc1
  s_add_u32 s28, s50, s55
  buffer_load_dwordx2 v[96:97], v132, s[8:11], s28 offen offset:0 sc1
  buffer_load_dwordx2 v[98:99], v132, s[8:11], s28 offen offset:1024 sc1
  s_branch ka\sfx\()_x_w0l
ka\sfx\()_x_w1:
ka\sfx\()_x_w1l:
  ds_read_b128 v[44:47], v129 offset:0
  ds_read_b128 v[48:51], v129 offset:1024
  ds_read_b128 v[52:55], v129 offset:10240
  ds_read_b128 v[56:59], v129 offset:11264
  s_waitcnt lgkmcnt(0)
  s_mov_b32 s45, 0
ka\sfx\()_x_pf_96:
  buffer_load_dwordx4 v[112:115], v124, s[8:11], s48 offen sc1
  buffer_load_dwordx4 v[116:119], v125, s[8:11], s48 offen sc1
  buffer_load_dwordx4 v[120:123], v126, s[8:11], s48 offen sc1
  s_add_u32 s45, s45, 1
  s_waitcnt vmcnt(2)
  ds_write_b128 v127, v[112:115] offset:0
  v_max3_u32 v139, v112, v113, v114
  v_max_u32 v139, v139, v115
  s_waitcnt vmcnt(1)
  ds_write_b128 v127, v[116:119] offset:4096
  v_max3_u32 v139, v139, v116, v117
  v_max3_u32 v139, v139, v118, v119
  s_waitcnt vmcnt(0)
  ds_write_b128 v127, v[120:123] offset:8192
  v_max3_u32 v139, v139, v120, v121
  v_max3_u32 v139, v139, v122, v123
  v_cmp_eq_u32 vcc, -1, v139
  s_cbranch_vccz ka\sfx\()_x_pf_96_ok
  s_cmp_lt_u32 s45, 400000
  s_cbranch_scc1 ka\sfx\()_x_pf_96
  s_branch ka\sfx\()_abort
ka\sfx\()_x_pf_96_ok:
  v_smfmac_f32_16x16x64_bf16 v[60:63], v[112:115], a[8:15], v110
  v_smfmac_f32_16x16x64_bf16 v[64:67], v[112:115], v[44:51], v110
  ds_read_b128 v[44:47], v129 offset:20480
  v_smfmac_f32_16x16x64_bf16 v[68:71], v[112:115], a[88:95], v110
  ds_read_b128 v[48:51], v129 offset:21504
  v_smfmac_f32_16x16x64_bf16 v[72:75], v[112:115], v[52:59], v110
  ds_read_b128 v[52:55], v129 offset:4096
  s_waitcnt lgkmcnt(3)
  s_barrier
  v_smfmac_f32_16x16x64_bf16 v[36:39], v[112:115], a[168:175], v110
  ds_read_b128 v[56:59], v129 offset:5120
  ds_read_b128 v[4:7], v128 offset:0
  s_waitcnt lgkmcnt(3)
  v_smfmac_f32_16x16x64_bf16 v[40:43], v[112:115], v[44:51], v110
  ds_read_b128 v[44:47], v129 offset:14336
  ds_read_b128 v[8:11], v128 offset:2048
  v_smfmac_f32_16x16x64_bf16 v[60:63], v[116:119], a[40:47], v110
  ds_read_b128 v[48:51], v129 offset:15360
  ds_read_b128 v[12:15], v128 offset:3072
  s_waitcnt lgkmcnt(5)
  v_smfmac_f32_16x16x64_bf16 v[64:67], v[116:119], v[52:59], v110
  ds_read_b128 v[52:55], v129 offset:24576
  ds_read_b128 v[16:19], v128 offset:4096
  v_smfmac_f32_16x16x64_bf16 v[68:71], v[116:119], a[120:127], v110
  ds_read_b128 v[56:59], v129 offset:25600
  ds_read_b128 v[20:23], v128 offset:6144
  s_waitcnt lgkmcnt(5)
  v_smfmac_f32_16x16x64_bf16 v[72:75], v[116:119], v[44:51], v110
  ds_read_b128 v[44:47], v129 offset:8192
  ds_read_b128 v[24:27], v128 offset:7168
  v_smfmac_f32_16x16x64_bf16 v[36:39], v[116:119], a[200:207], v110
  ds_read_b128 v[48:51], v129 offset:9216
  ds_read_b128 v[28:31], v128 offset:8192
  s_waitcnt lgkmcnt(5)
  v_smfmac_f32_16x16x64_bf16 v[40:43], v[116:119], v[52:59], v110
  ds_read_b128 v[52:55], v129 offset:18432
  v_smfmac_f32_16x16x64_bf16 v[60:63], v[120:123], a[72:79], v110
  ds_read_b128 v[56:59], v129 offset:19456
  s_waitcnt lgkmcnt(3)
  v_smfmac_f32_16x16x64_bf16 v[64:67], v[120:123], v[44:51], v110
  ds_read_b128 v[44:47], v129 offset:28672
  v_smfmac_f32_16x16x64_bf16 v[68:71], v[120:123], a[152:159], v110
  ds_read_b128 v[48:51], v129 offset:29696
  s_waitcnt lgkmcnt(2)
  v_smfmac_f32_16x16x64_bf16 v[72:75], v[120:123], v[52:59], v110
  ds_read_b128 v[52:55], v129 offset:2048
  v_smfmac_f32_16x16x64_bf16 v[36:39], v[120:123], a[232:239], v110
  ds_read_b128 v[56:59], v129 offset:3072
  s_waitcnt lgkmcnt(2)
  v_smfmac_f32_16x16x64_bf16 v[40:43], v[120:123], v[44:51], v110
  ds_read_b128 v[44:47], v129 offset:6144
  v_smfmac_f32_16x16x64_bf16 v[60:63], v[4:7], a[0:7], v110
  ds_read_b128 v[48:51], v129 offset:7168
  v_smfmac_f32_16x16x64_bf16 v[64:67], v[4:7], a[240:247], v110
  v_smfmac_f32_16x16x64_bf16 v[60:63], v[8:11], a[16:23], v110
  v_smfmac_f32_16x16x64_bf16 v[64:67], v[8:11], a[248:255], v110
  v_smfmac_f32_16x16x64_bf16 v[60:63], v[12:15], a[24:31], v110
  s_waitcnt lgkmcnt(2)
  v_smfmac_f32_16x16x64_bf16 v[64:67], v[12:15], v[52:59], v110
  ds_read_b128 v[52:55], v129 offset:12288
  v_smfmac_f32_16x16x64_bf16 v[60:63], v[16:19], a[32:39], v110
  ds_read_b128 v[56:59], v129 offset:13312
  v_smfmac_f32_16x16x64_bf16 v[64:67], v[16:19], v[152:159], v110
  v_smfmac_f32_16x16x64_bf16 v[60:63], v[20:23], a[48:55], v110
  v_smfmac_f32_16x16x64_bf16 v[64:67], v[20:23], v[160:167], v110
  v_smfmac_f32_16x16x64_bf16 v[60:63], v[24:27], a[56:63], v110
  s_waitcnt lgkmcnt(2)
  v_smfmac_f32_16x16x64_bf16 v[64:67], v[24:27], v[44:51], v110
  ds_read_b128 v[44:47], v129 offset:16384
  v_smfmac_f32_16x16x64_bf16 v[60:63], v[28:31], a[64:71], v110
  ds_read_b128 v[48:51], v129 offset:17408
  v_smfmac_f32_16x16x64_bf16 v[64:67], v[28:31], v[168:175], v110
  v_smfmac_f32_16x16x64_bf16 v[68:71], v[4:7], a[80:87], v110
  v_smfmac_f32_16x16x64_bf16 v[72:75], v[4:7], v[176:183], v110
  v_permlane32_swap_b32 v60, v64
  v_smfmac_f32_16x16x64_bf16 v[68:71], v[8:11], a[96:103], v110
  v_smfmac_f32_16x16x64_bf16 v[72:75], v[8:11], v[184:191], v110
  v_permlane32_swap_b32 v61, v65
  v_smfmac_f32_16x16x64_bf16 v[68:71], v[12:15], a[104:111], v110
  s_waitcnt lgkmcnt(2)
  v_smfmac_f32_16x16x64_bf16 v[72:75], v[12:15], v[52:59], v110
  ds_read_b128 v[52:55], v129 offset:22528
  v_permlane32_swap_b32 v62, v66
  v_smfmac_f32_16x16x64_bf16 v[68:71], v[16:19], a[112:119], v110
  ds_read_b128 v[56:59], v129 offset:23552
  v_permlane32_swap_b32 v63, v67
  v_smfmac_f32_16x16x64_bf16 v[72:75], v[16:19], v[192:199], v110
  v_add_f32 v60, v60, v64
  v_smfmac_f32_16x16x64_bf16 v[68:71], v[20:23], a[128:135], v110
  v_add_f32 v61, v61, v65
  v_smfmac_f32_16x16x64_bf16 v[72:75], v[20:23], v[200:207], v110
  v_add_f32 v62, v62, v66
  v_smfmac_f32_16x16x64_bf16 v[68:71], v[24:27], a[136:143], v110
  v_add_f32 v63, v63, v67
  s_waitcnt lgkmcnt(2)
  v_smfmac_f32_16x16x64_bf16 v[72:75], v[24:27], v[44:51], v110
  ds_read_b128 v[44:47], v129 offset:26624
  v_cvt_pk_bf16_f32 v100, v60, v61
  v_smfmac_f32_16x16x64_bf16 v[68:71], v[28:31], a[144:151], v110
  ds_read_b128 v[48:51], v129 offset:27648
  v_cvt_pk_bf16_f32 v101, v62, v63
  v_smfmac_f32_16x16x64_bf16 v[72:75], v[28:31], v[208:215], v110
  v_smfmac_f32_16x16x64_bf16 v[36:39], v[4:7], a[160:167], v110
  v_smfmac_f32_16x16x64_bf16 v[40:43], v[4:7], v[216:223], v110
  v_permlane32_swap_b32 v68, v72
  v_smfmac_f32_16x16x64_bf16 v[36:39], v[8:11], a[176:183], v110
  v_smfmac_f32_16x16x64_bf16 v[40:43], v[8:11], v[224:231], v110
  v_permlane32_swap_b32 v69, v73
  v_smfmac_f32_16x16x64_bf16 v[36:39], v[12:15], a[184:191], v110
  s_waitcnt lgkmcnt(2)
  v_smfmac_f32_16x16x64_bf16 v[40:43], v[12:15], v[52:59], v110
  v_permlane32_swap_b32 v70, v74
  v_smfmac_f32_16x16x64_bf16 v[36:39], v[16:19], a[192:199], v110
  v_permlane32_swap_b32 v71, v75
  v_smfmac_f32_16x16x64_bf16 v[40:43], v[16:19], v[232:239], v110
  v_add_f32 v68, v68, v72
  v_smfmac_f32_16x16x64_bf16 v[36:39], v[20:23], a[208:215], v110
  v_add_f32 v69, v69, v73
  v_smfmac_f32_16x16x64_bf16 v[40:43], v[20:23], v[240:247], v110
  v_add_f32 v70, v70, v74
  v_smfmac_f32_16x16x64_bf16 v[36:39], v[24:27], a[216:223], v110
  v_add_f32 v71, v71, v75
  s_waitcnt lgkmcnt(0)
  v_smfmac_f32_16x16x64_bf16 v[40:43], v[24:27], v[44:51], v110
  v_cvt_pk_bf16_f32 v102, v68, v69
  v_smfmac_f32_16x16x64_bf16 v[36:39], v[28:31], a[224:231], v110
  v_cvt_pk_bf16_f32 v103, v70, v71
  v_smfmac_f32_16x16x64_bf16 v[40:43], v[28:31], v[248:255], v110
  v_mfma_f32_16x16x16_bf16 v[142:145], v[100:101], v[108:109], 0
  v_mfma_f32_16x16x16_bf16 v[146:149], v[102:103], v[108:109], 0
  s_nop 1
  v_permlane32_swap_b32 v36, v40
  v_permlane32_swap_b32 v37, v41
  v_permlane32_swap_b32 v38, v42
  v_permlane32_swap_b32 v39, v43
  v_add_f32 v36, v36, v40
  v_add_f32 v37, v37, v41
  v_add_f32 v38, v38, v42
  v_add_f32 v39, v39, v43
  v_cvt_pk_bf16_f32 v104, v36, v37
  v_cvt_pk_bf16_f32 v105, v38, v39
  v_cvt_pk_bf16_f32 v44, v142, v143
  v_cvt_pk_bf16_f32 v45, v144, v145
  v_mfma_f32_16x16x16_bf16 v[142:145], v[104:105], v[108:109], 0
  v_cvt_pk_bf16_f32 v46, v146, v147
  v_cvt_pk_bf16_f32 v47, v148, v149
  s_nop 1
  v_mfma_f32_16x16x32_bf16 v[76:79], v[44:47], v[44:47], 0
  v_mfma_f32_16x16x32_bf16 v[80:83], v[88:91], v[44:47], 0
  v_cvt_pk_bf16_f32 v106, v142, v143
  v_cvt_pk_bf16_f32 v107, v144, v145
  v_mfma_f32_16x16x32_bf16 v[84:87], v[92:95], v[44:47], 0
  s_nop 0
  v_mfma_f32_16x16x16_bf16 v[76:79], v[106:107], v[106:107], v[76:79]
  v_mfma_f32_16x16x16_bf16 v[80:83], v[96:97], v[106:107], v[80:83]
  v_mfma_f32_16x16x16_bf16 v[84:87], v[98:99], v[106:107], v[84:87]
  s_mov_b32 exec_lo, 0
  s_mov_b32 exec_hi, 0x00ff00ff
  s_nop 3
  ds_write_b128 v130, v[76:79]
  s_mov_b32 exec_lo, 0x00ff00ff
  ds_write_b128 v130, v[80:83] offset:1024
  s_nop 0
  ds_write_b128 v130, v[84:87] offset:2048
  s_mov_b64 exec, -1
  s_waitcnt lgkmcnt(0)
  s_barrier
  ds_write_b64 v131, v[44:45]
  ds_write_b64 v131, v[46:47] offset:512
  ds_write_b64 v131, v[106:107] offset:1024
  s_waitcnt lgkmcnt(0)
  s_cmp_ge_u32 s51, 63
  s_cbranch_scc1 ka\sfx\()_x_done
  s_barrier
  v_mov_b32 v60, 0
  v_mov_b32 v61, 0
  v_mov_b32 v62, 0
  v_mov_b32 v63, 0
  v_mov_b32 v64, 0
  v_mov_b32 v65, 0
  v_mov_b32 v66, 0
  v_mov_b32 v67, 0
  v_mov_b32 v68, 0
  v_mov_b32 v69, 0
  v_mov_b32 v70, 0
  v_mov_b32 v71, 0
  v_mov_b32 v72, 0
  v_mov_b32 v73, 0
  v_mov_b32 v74, 0
  v_mov_b32 v75, 0
  v_mov_b32 v36, 0
  v_mov_b32 v37, 0
  v_mov_b32 v38, 0
  v_mov_b32 v39, 0
  v_mov_b32 v40, 0
  v_mov_b32 v41, 0
  v_mov_b32 v42, 0
  v_mov_b32 v43, 0
  s_add_u32 s97, s97, 10240
  s_mov_b32 s48, s97
  s_add_u32 s49, s49, 5120
  s_add_u32 s50, s50, 12288
  s_add_u32 s63, s63, 12288
  s_add_u32 s51, s51, 1
  s_cmp_gt_u32 s52, s51
  s_cbranch_scc1 ka\sfx\()_x_wp_97_ok
  s_mov_b32 s45, 0
ka\sfx\()_x_wp_97_spin:
  buffer_load_dword v2, v138, s[8:11], 0 offen sc1
  s_add_u32 s45, s45, 1
  s_waitcnt vmcnt(0)
  v_min_u32_dpp v3, v2, v2 quad_perm:[1,0,3,2] row_mask:0xf bank_mask:0xf
  s_nop 1
  v_min_u32_dpp v2, v3, v3 quad_perm:[2,3,0,1] row_mask:0xf bank_mask:0xf
  s_nop 1
  v_min_u32_dpp v3, v2, v2 row_half_mirror row_mask:0xf bank_mask:0xf
  s_nop 1
  v_min_u32_dpp v2, v3, v3 quad_perm:[0,1,2,3] row_mask:0xf bank_mask:0xf
  s_nop 0
  v_readfirstlane_b32 s52, v2
  s_cmp_gt_u32 s52, s51
  s_cbranch_scc1 ka\sfx\()_x_wp_97_ok
  s_cmp_lt_u32 s45, 400000
  s_cbranch_scc1 ka\sfx\()_x_wp_97_spin
  s_branch ka\sfx\()_abort
ka\sfx\()_x_wp_97_ok:
  s_add_u32 s28, s50, s53
  buffer_load_dwordx2 v[88:89], v132, s[8:11], s28 offen offset:0 sc1
  buffer_load_dwordx2 v[92:93], v132, s[8:11], s28 offen offset:1024 sc1
  s_add_u32 s28, s50, s54
  buffer_load_dwordx2 v[90:91], v132, s[8:11], s28 offen offset:0 sc1
  buffer_load_dwordx2 v[94:95], v132, s[8:11], s28 offen offset:1024 sc1
  s_add_u32 s28, s50, s55
  buffer_load_dwordx2 v[96:97], v132, s[8:11], s28 offen offset:0 sc1
  buffer_load_dwordx2 v[98:99], v132, s[8:11], s28 offen offset:1024 sc1
  s_branch ka\sfx\()_x_w1l
ka\sfx\()_x_w23:
  s_sub_u32 s65, s21, 2
  s_and_b32 s26, s23, 7
  v_and_b32 v4, 15, v1
  v_lshrrev_b32 v5, 4, v1
  v_and_b32 v6, 1, v5
  v_lshlrev_b32 v6, 5, v6
  v_add_u32 v6, v6, v4
  v_lshlrev_b32 v6, 4, v6
  v_lshrrev_b32 v7, 1, v5
  v_lshlrev_b32 v7, 3, v7
  v_add_u32 v6, v6, v7
  s_lshl_b32 s28, s26, 1
  s_add_u32 s28, s28, s65
  s_lshl_b32 s28, s28, 10
  v_add_u32 v133, s28, v6
  s_lshr_b32 s28, s26, 2
  s_lshl_b32 s28, s28, 1
  s_add_u32 s28, s28, s65
  s_lshl_b32 s28, s28, 10
  s_and_b32 s29, s26, 1
  s_lshl_b32 s29, s29, 9
  s_add_u32 s28, s28, s29
  s_bfe_u32 s29, s26, 0x10001
  s_lshl_b32 s29, s29, 3
  s_add_u32 s28, s28, s29
  s_add_u32 s28, s28, 15872
  v_lshlrev_b32 v6, 4, v5
  v_add_u32 v6, v6, v4
  v_lshlrev_b32 v6, 4, v6
  v_add_u32 v6, s28, v6
  v_mov_b32 v7, 0x40000000
  v_cmp_le_u32 vcc, 2, v5
  s_nop 1
  v_cndmask_b32 v134, v7, v6, vcc
  v_mov_b32 v135, 0xf149f2ca
  v_lshlrev_b32 v6, 3, v1
  v_add_u32 v136, 145408, v6
  s_mul_i32 s94, s65, 6144
  s_add_u32 s94, s94, 151552
  v_add_u32 v137, s94, v132
  v_cmp_le_u32 s[66:67], 2, v5
  v_lshlrev_b32 v6, 2, v5
  v_sub_u32 v6, v4, v6
  v_cmp_le_i32 s[68:69], 0, v6
  v_cmp_le_i32 s[70:71], 1, v6
  v_cmp_le_i32 s[72:73], 2, v6
  v_cmp_le_i32 s[74:75], 3, v6
  s_nop 1
  s_cmp_eq_u32 s65, 0
  s_cselect_b64 s[76:77], s[68:69], -1
  s_cselect_b64 s[84:85], 0, s[68:69]
  s_cselect_b64 s[78:79], s[70:71], -1
  s_cselect_b64 s[86:87], 0, s[70:71]
  s_cselect_b64 s[80:81], s[72:73], -1
  s_cselect_b64 s[88:89], 0, s[72:73]
  s_cselect_b64 s[82:83], s[74:75], -1
  s_cselect_b64 s[90:91], 0, s[74:75]
  s_mul_i32 s92, s20, 1310720
  s_add_u32 s92, s92, 0xe00000
  s_lshl_b32 s93, s65, 10
  s_mov_b32 s64, 0x3dd53b95
  s_add_u32 s95, s63, s93
  s_add_u32 m0, s94, 0
  s_add_u32 s28, s95, 0
  buffer_load_dwordx4 v132, s[8:11], s28 offen sc1 lds
  s_add_u32 m0, s94, 1024
  s_add_u32 s28, s95, 2048
  buffer_load_dwordx4 v132, s[8:11], s28 offen sc1 lds
  s_add_u32 m0, s94, 2048
  s_add_u32 s28, s95, 4096
  buffer_load_dwordx4 v132, s[8:11], s28 offen sc1 lds
  s_add_u32 m0, s94, 3072
  s_add_u32 s28, s95, 6144
  buffer_load_dwordx4 v132, s[8:11], s28 offen sc1 lds
  s_add_u32 m0, s94, 4096
  s_add_u32 s28, s95, 8192
  buffer_load_dwordx4 v132, s[8:11], s28 offen sc1 lds
  s_add_u32 m0, s94, 5120
  s_add_u32 s28, s95, 10240
  buffer_load_dwordx4 v132, s[8:11], s28 offen sc1 lds
  s_cmp_eq_u32 s21, 3
  s_cbranch_scc1 ka\sfx\()_x_w3l
ka\sfx\()_x_w2l:
  ds_read_b128 v[44:47], v129 offset:0
  ds_read_b128 v[48:51], v129 offset:1024
  ds_read_b128 v[52:55], v129 offset:2048
  ds_read_b128 v[56:59], v129 offset:3072
  s_waitcnt lgkmcnt(0)
  s_mov_b32 s45, 0
ka\sfx\()_x_pf_98:
  buffer_load_dwordx4 v[112:115], v124, s[8:11], s48 offen sc1
  buffer_load_dwordx4 v[116:119], v125, s[8:11], s48 offen sc1
  s_add_u32 s45, s45, 1
  s_waitcnt vmcnt(1)
  ds_write_b128 v127, v[112:115] offset:0
  v_max3_u32 v139, v112, v113, v114
  v_max_u32 v139, v139, v115
  s_waitcnt vmcnt(0)
  ds_write_b128 v127, v[116:119] offset:4096
  v_max3_u32 v139, v139, v116, v117
  v_max3_u32 v139, v139, v118, v119
  v_cmp_eq_u32 vcc, -1, v139
  s_cbranch_vccz ka\sfx\()_x_pf_98_ok
  s_cmp_lt_u32 s45, 400000
  s_cbranch_scc1 ka\sfx\()_x_pf_98
  s_branch ka\sfx\()_abort
ka\sfx\()_x_pf_98_ok:
  v_smfmac_f32_16x16x64_bf16 v[60:63], v[112:115], a[16:23], v110
  v_smfmac_f32_16x16x64_bf16 v[64:67], v[112:115], a[248:255], v110
  v_smfmac_f32_16x16x64_bf16 v[68:71], v[112:115], a[96:103], v110
  v_smfmac_f32_16x16x64_bf16 v[72:75], v[112:115], v[184:191], v110
  s_waitcnt lgkmcnt(0)
  s_barrier
  v_smfmac_f32_16x16x64_bf16 v[36:39], v[112:115], a[176:183], v110
  ds_read_b128 v[4:7], v128 offset:0
  v_smfmac_f32_16x16x64_bf16 v[40:43], v[112:115], v[224:231], v110
  ds_read_b128 v[8:11], v128 offset:1024
  v_smfmac_f32_16x16x64_bf16 v[60:63], v[116:119], a[48:55], v110
  ds_read_b128 v[12:15], v128 offset:3072
  v_smfmac_f32_16x16x64_bf16 v[64:67], v[116:119], v[160:167], v110
  ds_read_b128 v[16:19], v128 offset:4096
  v_smfmac_f32_16x16x64_bf16 v[68:71], v[116:119], a[128:135], v110
  ds_read_b128 v[20:23], v128 offset:5120
  v_smfmac_f32_16x16x64_bf16 v[72:75], v[116:119], v[200:207], v110
  ds_read_b128 v[24:27], v128 offset:7168
  v_smfmac_f32_16x16x64_bf16 v[36:39], v[116:119], a[208:215], v110
  ds_read_b128 v[28:31], v128 offset:8192
  v_smfmac_f32_16x16x64_bf16 v[40:43], v[116:119], v[240:247], v110
  ds_read_b128 v[32:35], v128 offset:9216
  s_waitcnt lgkmcnt(7)
  v_smfmac_f32_16x16x64_bf16 v[60:63], v[4:7], a[0:7], v110
  v_smfmac_f32_16x16x64_bf16 v[64:67], v[4:7], a[240:247], v110
  s_waitcnt lgkmcnt(6)
  v_smfmac_f32_16x16x64_bf16 v[60:63], v[8:11], a[8:15], v110
  v_smfmac_f32_16x16x64_bf16 v[64:67], v[8:11], v[44:51], v110
  ds_read_b128 v[44:47], v129 offset:4096
  s_waitcnt lgkmcnt(6)
  v_smfmac_f32_16x16x64_bf16 v[60:63], v[12:15], a[24:31], v110
  ds_read_b128 v[48:51], v129 offset:5120
  v_smfmac_f32_16x16x64_bf16 v[64:67], v[12:15], v[52:59], v110
  ds_read_b128 v[52:55], v129 offset:6144
  s_waitcnt lgkmcnt(7)
  v_smfmac_f32_16x16x64_bf16 v[60:63], v[16:19], a[32:39], v110
  ds_read_b128 v[56:59], v129 offset:7168
  v_smfmac_f32_16x16x64_bf16 v[64:67], v[16:19], v[152:159], v110
  s_waitcnt lgkmcnt(7)
  v_smfmac_f32_16x16x64_bf16 v[60:63], v[20:23], a[40:47], v110
  s_waitcnt lgkmcnt(2)
  v_smfmac_f32_16x16x64_bf16 v[64:67], v[20:23], v[44:51], v110
  ds_read_b128 v[44:47], v129 offset:8192
  v_smfmac_f32_16x16x64_bf16 v[60:63], v[24:27], a[56:63], v110
  ds_read_b128 v[48:51], v129 offset:9216
  s_waitcnt lgkmcnt(2)
  v_smfmac_f32_16x16x64_bf16 v[64:67], v[24:27], v[52:59], v110
  ds_read_b128 v[52:55], v129 offset:10240
  v_smfmac_f32_16x16x64_bf16 v[60:63], v[28:31], a[64:71], v110
  ds_read_b128 v[56:59], v129 offset:11264
  v_smfmac_f32_16x16x64_bf16 v[64:67], v[28:31], v[168:175], v110
  v_smfmac_f32_16x16x64_bf16 v[60:63], v[32:35], a[72:79], v110
  s_waitcnt lgkmcnt(2)
  v_smfmac_f32_16x16x64_bf16 v[64:67], v[32:35], v[44:51], v110
  ds_read_b128 v[44:47], v129 offset:12288
  v_smfmac_f32_16x16x64_bf16 v[68:71], v[4:7], a[80:87], v110
  ds_read_b128 v[48:51], v129 offset:13312
  v_smfmac_f32_16x16x64_bf16 v[72:75], v[4:7], v[176:183], v110
  v_permlane32_swap_b32 v60, v64
  v_smfmac_f32_16x16x64_bf16 v[68:71], v[8:11], a[88:95], v110
  s_waitcnt lgkmcnt(2)
  v_smfmac_f32_16x16x64_bf16 v[72:75], v[8:11], v[52:59], v110
  ds_read_b128 v[52:55], v129 offset:14336
  v_permlane32_swap_b32 v61, v65
  v_smfmac_f32_16x16x64_bf16 v[68:71], v[12:15], a[104:111], v110
  ds_read_b128 v[56:59], v129 offset:15360
  s_waitcnt lgkmcnt(2)
  v_smfmac_f32_16x16x64_bf16 v[72:75], v[12:15], v[44:51], v110
  ds_read_b128 v[44:47], v129 offset:16384
  v_permlane32_swap_b32 v62, v66
  v_smfmac_f32_16x16x64_bf16 v[68:71], v[16:19], a[112:119], v110
  ds_read_b128 v[48:51], v129 offset:17408
  v_permlane32_swap_b32 v63, v67
  v_smfmac_f32_16x16x64_bf16 v[72:75], v[16:19], v[192:199], v110
  v_add_f32 v60, v60, v64
  v_smfmac_f32_16x16x64_bf16 v[68:71], v[20:23], a[120:127], v110
  v_add_f32 v61, v61, v65
  s_waitcnt lgkmcnt(2)
  v_smfmac_f32_16x16x64_bf16 v[72:75], v[20:23], v[52:59], v110
  ds_read_b128 v[52:55], v129 offset:18432
  v_add_f32 v62, v62, v66
  v_smfmac_f32_16x16x64_bf16 v[68:71], v[24:27], a[136:143], v110
  ds_read_b128 v[56:59], v129 offset:19456
  v_add_f32 v63, v63, v67
  s_waitcnt lgkmcnt(2)
  v_smfmac_f32_16x16x64_bf16 v[72:75], v[24:27], v[44:51], v110
  ds_read_b128 v[44:47], v129 offset:20480
  v_cvt_pk_bf16_f32 v100, v60, v61
  v_smfmac_f32_16x16x64_bf16 v[68:71], v[28:31], a[144:151], v110
  ds_read_b128 v[48:51], v129 offset:21504
  v_cvt_pk_bf16_f32 v101, v62, v63
  v_smfmac_f32_16x16x64_bf16 v[72:75], v[28:31], v[208:215], v110
  v_smfmac_f32_16x16x64_bf16 v[68:71], v[32:35], a[152:159], v110
  s_waitcnt lgkmcnt(2)
  v_smfmac_f32_16x16x64_bf16 v[72:75], v[32:35], v[52:59], v110
  ds_read_b128 v[52:55], v129 offset:22528
  v_smfmac_f32_16x16x64_bf16 v[36:39], v[4:7], a[160:167], v110
  ds_read_b128 v[56:59], v129 offset:23552
  v_smfmac_f32_16x16x64_bf16 v[40:43], v[4:7], v[216:223], v110
  v_permlane32_swap_b32 v68, v72
  v_smfmac_f32_16x16x64_bf16 v[36:39], v[8:11], a[168:175], v110
  s_waitcnt lgkmcnt(2)
  v_smfmac_f32_16x16x64_bf16 v[40:43], v[8:11], v[44:51], v110
  ds_read_b128 v[44:47], v129 offset:24576
  v_permlane32_swap_b32 v69, v73
  v_smfmac_f32_16x16x64_bf16 v[36:39], v[12:15], a[184:191], v110
  ds_read_b128 v[48:51], v129 offset:25600
  s_waitcnt lgkmcnt(2)
  v_smfmac_f32_16x16x64_bf16 v[40:43], v[12:15], v[52:59], v110
  ds_read_b128 v[52:55], v129 offset:26624
  v_permlane32_swap_b32 v70, v74
  v_smfmac_f32_16x16x64_bf16 v[36:39], v[16:19], a[192:199], v110
  ds_read_b128 v[56:59], v129 offset:27648
  v_permlane32_swap_b32 v71, v75
  v_smfmac_f32_16x16x64_bf16 v[40:43], v[16:19], v[232:239], v110
  v_add_f32 v68, v68, v72
  v_smfmac_f32_16x16x64_bf16 v[36:39], v[20:23], a[200:207], v110
  v_add_f32 v69, v69, v73
  s_waitcnt lgkmcnt(2)
  v_smfmac_f32_16x16x64_bf16 v[40:43], v[20:23], v[44:51], v110
  ds_read_b128 v[44:47], v129 offset:28672
  v_add_f32 v70, v70, v74
  v_smfmac_f32_16x16x64_bf16 v[36:39], v[24:27], a[216:223], v110
  ds_read_b128 v[48:51], v129 offset:29696
  v_add_f32 v71, v71, v75
  s_waitcnt lgkmcnt(2)
  v_smfmac_f32_16x16x64_bf16 v[40:43], v[24:27], v[52:59], v110
  v_cvt_pk_bf16_f32 v102, v68, v69
  v_smfmac_f32_16x16x64_bf16 v[36:39], v[28:31], a[224:231], v110
  v_cvt_pk_bf16_f32 v103, v70, v71
  v_smfmac_f32_16x16x64_bf16 v[40:43], v[28:31], v[248:255], v110
  v_smfmac_f32_16x16x64_bf16 v[36:39], v[32:35], a[232:239], v110
  s_waitcnt lgkmcnt(0)
  v_smfmac_f32_16x16x64_bf16 v[40:43], v[32:35], v[44:51], v110
  v_mfma_f32_16x16x16_bf16 v[142:145], v[100:101], v[108:109], 0
  v_mfma_f32_16x16x16_bf16 v[146:149], v[102:103], v[108:109], 0
  s_nop 1
  v_permlane32_swap_b32 v36, v40
  v_permlane32_swap_b32 v37, v41
  v_permlane32_swap_b32 v38, v42
  v_permlane32_swap_b32 v39, v43
  v_add_f32 v36, v36, v40
  v_add_f32 v37, v37, v41
  v_add_f32 v38, v38, v42
  v_add_f32 v39, v39, v43
  v_cvt_pk_bf16_f32 v104, v36, v37
  v_cvt_pk_bf16_f32 v105, v38, v39
  v_cvt_pk_bf16_f32 v44, v142, v143
  v_cvt_pk_bf16_f32 v45, v144, v145
  v_mfma_f32_16x16x16_bf16 v[142:145], v[104:105], v[108:109], 0
  v_cvt_pk_bf16_f32 v46, v146, v147
  v_cvt_pk_bf16_f32 v47, v148, v149
  s_nop 1
  v_mfma_f32_16x16x32_bf16 v[76:79], v[44:47], v[44:47], 0
  v_mfma_f32_16x16x32_bf16 v[80:83], v[88:91], v[44:47], 0
  v_cvt_pk_bf16_f32 v106, v142, v143
  v_cvt_pk_bf16_f32 v107, v144, v145
  v_mfma_f32_16x16x32_bf16 v[84:87], v[92:95], v[44:47], 0
  s_nop 0
  v_mfma_f32_16x16x16_bf16 v[76:79], v[106:107], v[106:107], v[76:79]
  v_mfma_f32_16x16x16_bf16 v[80:83], v[96:97], v[106:107], v[80:83]
  v_mfma_f32_16x16x16_bf16 v[84:87], v[98:99], v[106:107], v[84:87]
  s_mov_b32 exec_lo, 0
  s_mov_b32 exec_hi, 0x00ff00ff
  s_nop 3
  ds_write_b128 v130, v[76:79]
  s_mov_b32 exec_lo, 0x00ff00ff
  ds_write_b128 v130, v[80:83] offset:1024
  s_nop 0
  ds_write_b128 v130, v[84:87] offset:2048
  s_mov_b64 exec, -1
  s_waitcnt lgkmcnt(0)
  s_barrier
  ds_write_b64 v131, v[44:45]
  ds_write_b64 v131, v[46:47] offset:512
  ds_write_b64 v131, v[106:107] offset:1024
  ds_read_b128 v[44:47], v137 offset:0
  ds_read_b128 v[48:51], v137 offset:1024
  ds_read_b128 v[52:55], v137 offset:2048
  ds_read_b128 v[56:59], v137 offset:3072
  ds_read_b128 v[68:71], v137 offset:4096
  ds_read_b128 v[72:75], v137 offset:5120
  s_waitcnt lgkmcnt(0)
  s_barrier
  s_mov_b32 s28, s50
  buffer_load_dwordx4 v[4:7], v132, s[8:11], s28 offen sc1
  buffer_load_dwordx4 v[8:11], v132, s[8:11], s28 offen offset:1024 sc1
  s_add_u32 s28, s28, 2048
  buffer_load_dwordx4 v[12:15], v132, s[8:11], s28 offen sc1
  buffer_load_dwordx4 v[16:19], v132, s[8:11], s28 offen offset:1024 sc1
  s_add_u32 s28, s28, 2048
  buffer_load_dwordx4 v[20:23], v132, s[8:11], s28 offen sc1
  buffer_load_dwordx4 v[24:27], v132, s[8:11], s28 offen offset:1024 sc1
  s_add_u32 s28, s28, 2048
  buffer_load_dwordx4 v[28:31], v132, s[8:11], s28 offen sc1
  buffer_load_dwordx4 v[32:35], v132, s[8:11], s28 offen offset:1024 sc1
  s_add_u32 s28, s28, 2048
  buffer_load_dwordx4 v[36:39], v132, s[8:11], s28 offen sc1
  buffer_load_dwordx4 v[40:43], v132, s[8:11], s28 offen offset:1024 sc1
  s_add_u32 s28, s28, 2048
  buffer_load_dwordx4 v[60:63], v132, s[8:11], s28 offen sc1
  buffer_load_dwordx4 v[64:67], v132, s[8:11], s28 offen offset:1024 sc1
  s_add_u32 s28, s28, 2048
  ds_read_b64 v[76:77], v136 offset:0
  ds_read_b64 v[78:79], v136 offset:512
  ds_read_b64 v[80:81], v136 offset:1024
  ds_read_b64 v[82:83], v136 offset:1536
  ds_read_b64 v[84:85], v136 offset:2048
  ds_read_b64 v[86:87], v136 offset:2560
  ds_read_b64 v[88:89], v136 offset:3072
  ds_read_b64 v[90:91], v136 offset:3584
  ds_read_b64 v[92:93], v136 offset:4096
  ds_read_b64 v[94:95], v136 offset:4608
  ds_read_b64 v[96:97], v136 offset:5120
  ds_read_b64 v[98:99], v136 offset:5632
  s_waitcnt lgkmcnt(0)
  s_cmp_ge_u32 s51, 63
  s_cbranch_scc1 xq_99_\sfx\()
  s_add_u32 s96, s51, 1
  s_cmp_gt_u32 s52, s96
  s_cbranch_scc1 ka\sfx\()_x_wp_100_ok
  s_mov_b32 s45, 0
ka\sfx\()_x_wp_100_spin:
  buffer_load_dword v2, v138, s[8:11], 0 offen sc1
  s_add_u32 s45, s45, 1
  s_waitcnt vmcnt(0)
  v_min_u32_dpp v3, v2, v2 quad_perm:[1,0,3,2] row_mask:0xf bank_mask:0xf
  s_nop 1
  v_min_u32_dpp v2, v3, v3 quad_perm:[2,3,0,1] row_mask:0xf bank_mask:0xf
  s_nop 1
  v_min_u32_dpp v3, v2, v2 row_half_mirror row_mask:0xf bank_mask:0xf
  s_nop 1
  v_min_u32_dpp v2, v3, v3 quad_perm:[0,1,2,3] row_mask:0xf bank_mask:0xf
  s_nop 0
  v_readfirstlane_b32 s52, v2
  s_cmp_gt_u32 s52, s96
  s_cbranch_scc1 ka\sfx\()_x_wp_100_ok
  s_cmp_lt_u32 s45, 400000
  s_cbranch_scc1 ka\sfx\()_x_wp_100_spin
  s_branch ka\sfx\()_abort
ka\sfx\()_x_wp_100_ok:
  s_add_u32 s95, s63, s93
  s_add_u32 s95, s95, 12288
  s_add_u32 m0, s94, 0
  s_add_u32 s28, s95, 0
  buffer_load_dwordx4 v132, s[8:11], s28 offen sc1 lds
  s_add_u32 m0, s94, 1024
  s_add_u32 s28, s95, 2048
  buffer_load_dwordx4 v132, s[8:11], s28 offen sc1 lds
  s_add_u32 m0, s94, 2048
  s_add_u32 s28, s95, 4096
  buffer_load_dwordx4 v132, s[8:11], s28 offen sc1 lds
  s_add_u32 m0, s94, 3072
  s_add_u32 s28, s95, 6144
  buffer_load_dwordx4 v132, s[8:11], s28 offen sc1 lds
  s_add_u32 m0, s94, 4096
  s_add_u32 s28, s95, 8192
  buffer_load_dwordx4 v132, s[8:11], s28 offen sc1 lds
  s_add_u32 m0, s94, 5120
  s_add_u32 s28, s95, 10240
  buffer_load_dwordx4 v132, s[8:11], s28 offen sc1 lds
  s_branch xq_99_j_\sfx\()
xq_99_\sfx\():
  s_waitcnt vmcnt(0)
xq_99_j_\sfx\():
  s_waitcnt vmcnt(16)
  v_mfma_f32_16x16x32_bf16 v[112:115], v[76:79], v[44:47], 0
  v_mfma_f32_16x16x32_bf16 v[116:119], v[4:7], v[44:47], 0
  v_mfma_f32_16x16x32_bf16 v[120:123], v[8:11], v[44:47], 0
  s_waitcnt vmcnt(14)
  v_mfma_f32_16x16x32_bf16 v[112:115], v[80:83], v[48:51], v[112:115]
  v_mfma_f32_16x16x32_bf16 v[116:119], v[12:15], v[48:51], v[116:119]
  v_mfma_f32_16x16x32_bf16 v[120:123], v[16:19], v[48:51], v[120:123]
  s_waitcnt vmcnt(12)
  v_mfma_f32_16x16x32_bf16 v[112:115], v[84:87], v[52:55], v[112:115]
  v_mfma_f32_16x16x32_bf16 v[116:119], v[20:23], v[52:55], v[116:119]
  v_mfma_f32_16x16x32_bf16 v[120:123], v[24:27], v[52:55], v[120:123]
  s_waitcnt vmcnt(10)
  v_mfma_f32_16x16x32_bf16 v[112:115], v[88:91], v[56:59], v[112:115]
  v_mfma_f32_16x16x32_bf16 v[116:119], v[28:31], v[56:59], v[116:119]
  v_mfma_f32_16x16x32_bf16 v[120:123], v[32:35], v[56:59], v[120:123]
  s_waitcnt vmcnt(8)
  v_mfma_f32_16x16x32_bf16 v[112:115], v[92:95], v[68:71], v[112:115]
  v_mfma_f32_16x16x32_bf16 v[116:119], v[36:39], v[68:71], v[116:119]
  v_mfma_f32_16x16x32_bf16 v[120:123], v[40:43], v[68:71], v[120:123]
  s_waitcnt vmcnt(6)
  v_mfma_f32_16x16x32_bf16 v[112:115], v[96:99], v[72:75], v[112:115]
  v_mfma_f32_16x16x32_bf16 v[116:119], v[60:63], v[72:75], v[116:119]
  v_mfma_f32_16x16x32_bf16 v[120:123], v[64:67], v[72:75], v[120:123]
  s_nop 8
  v_cndmask_b32 v112, v135, v112, s[66:67]
  v_cndmask_b32 v113, v135, v113, s[66:67]
  v_cndmask_b32 v114, v135, v114, s[66:67]
  v_cndmask_b32 v115, v135, v115, s[66:67]
  v_cndmask_b32 v116, v135, v116, s[76:77]
  v_cndmask_b32 v120, v135, v120, s[84:85]
  v_cndmask_b32 v117, v135, v117, s[78:79]
  v_cndmask_b32 v121, v135, v121, s[86:87]
  v_cndmask_b32 v118, v135, v118, s[80:81]
  v_cndmask_b32 v122, v135, v122, s[88:89]
  v_cndmask_b32 v119, v135, v119, s[82:83]
  v_cndmask_b32 v123, v135, v123, s[90:91]
  v_max3_f32 v4, v112, v113, v114
  v_max3_f32 v5, v115, v116, v117
  v_max3_f32 v6, v118, v119, v120
  v_max3_f32 v7, v121, v122, v123
  v_max3_f32 v4, v4, v5, v6
  v_max_f32 v4, v4, v7
  v_mov_b32 v5, v4
  s_nop 1
  v_permlane16_swap_b32 v4, v5
  v_max_f32 v4, v4, v5
  v_mov_b32 v5, v4
  s_nop 1
  v_permlane32_swap_b32 v4, v5
  v_max_f32 v4, v4, v5
  v_mul_f32 v4, s64, v4
  v_fma_f32 v112, v112, s64, -v4
  v_fma_f32 v113, v113, s64, -v4
  v_fma_f32 v114, v114, s64, -v4
  v_fma_f32 v115, v115, s64, -v4
  v_fma_f32 v116, v116, s64, -v4
  v_fma_f32 v117, v117, s64, -v4
  v_fma_f32 v118, v118, s64, -v4
  v_fma_f32 v119, v119, s64, -v4
  v_fma_f32 v120, v120, s64, -v4
  v_fma_f32 v121, v121, s64, -v4
  v_fma_f32 v122, v122, s64, -v4
  v_fma_f32 v123, v123, s64, -v4
  v_exp_f32 v112, v112
  v_exp_f32 v113, v113
  v_exp_f32 v114, v114
  v_exp_f32 v115, v115
  v_exp_f32 v116, v116
  v_exp_f32 v117, v117
  v_exp_f32 v118, v118
  v_exp_f32 v119, v119
  v_exp_f32 v120, v120
  v_exp_f32 v121, v121
  v_exp_f32 v122, v122
  v_exp_f32 v123, v123
  v_add_f32 v5, v112, v113
  v_add_f32 v6, v114, v115
  v_add_f32 v7, v116, v117
  v_add_f32 v8, v118, v119
  v_add_f32 v9, v120, v121
  v_add_f32 v10, v122, v123
  v_add_f32 v5, v5, v6
  v_add_f32 v7, v7, v8
  v_add_f32 v9, v9, v10
  v_add_f32 v5, v5, v7
  v_add_f32 v5, v5, v9
  v_mov_b32 v6, v5
  s_nop 1
  v_permlane16_swap_b32 v5, v6
  v_add_f32 v5, v5, v6
  v_mov_b32 v6, v5
  s_nop 1
  v_permlane32_swap_b32 v5, v6
  v_add_f32 v5, v5, v6
  v_rcp_f32 v5, v5
  s_nop 0
  v_mul_f32 v112, v112, v5
  v_mul_f32 v113, v113, v5
  v_mul_f32 v114, v114, v5
  v_mul_f32 v115, v115, v5
  v_mul_f32 v116, v116, v5
  v_mul_f32 v117, v117, v5
  v_mul_f32 v118, v118, v5
  v_mul_f32 v119, v119, v5
  v_mul_f32 v120, v120, v5
  v_mul_f32 v121, v121, v5
  v_mul_f32 v122, v122, v5
  v_mul_f32 v123, v123, v5
  v_cvt_pk_bf16_f32 v8, v112, v113
  v_cvt_pk_bf16_f32 v9, v114, v115
  v_cvt_pk_bf16_f32 v10, v116, v117
  v_cvt_pk_bf16_f32 v11, v118, v119
  v_cvt_pk_bf16_f32 v12, v120, v121
  v_cvt_pk_bf16_f32 v13, v122, v123
  buffer_store_dwordx2 v[10:11], v133, s[8:11], s92 offen \pol
  buffer_store_dwordx2 v[12:13], v133, s[8:11], s92 offen offset:256 \pol
  buffer_store_dwordx2 v[8:9], v134, s[8:11], s92 offen \pol
  s_add_u32 s92, s92, 20480
  s_cmp_ge_u32 s51, 63
  s_cbranch_scc1 ka\sfx\()_x_done
  v_mov_b32 v60, 0
  v_mov_b32 v61, 0
  v_mov_b32 v62, 0
  v_mov_b32 v63, 0
  v_mov_b32 v64, 0
  v_mov_b32 v65, 0
  v_mov_b32 v66, 0
  v_mov_b32 v67, 0
  v_mov_b32 v68, 0
  v_mov_b32 v69, 0
  v_mov_b32 v70, 0
  v_mov_b32 v71, 0
  v_mov_b32 v72, 0
  v_mov_b32 v73, 0
  v_mov_b32 v74, 0
  v_mov_b32 v75, 0
  v_mov_b32 v36, 0
  v_mov_b32 v37, 0
  v_mov_b32 v38, 0
  v_mov_b32 v39, 0
  v_mov_b32 v40, 0
  v_mov_b32 v41, 0
  v_mov_b32 v42, 0
  v_mov_b32 v43, 0
  s_add_u32 s97, s97, 10240
  s_mov_b32 s48, s97
  s_add_u32 s49, s49, 5120
  s_add_u32 s50, s50, 12288
  s_add_u32 s63, s63, 12288
  s_add_u32 s51, s51, 1
  s_cmp_gt_u32 s52, s51
  s_cbranch_scc1 ka\sfx\()_x_wp_101_ok
  s_mov_b32 s45, 0
ka\sfx\()_x_wp_101_spin:
  buffer_load_dword v2, v138, s[8:11], 0 offen sc1
  s_add_u32 s45, s45, 1
  s_waitcnt vmcnt(0)
  v_min_u32_dpp v3, v2, v2 quad_perm:[1,0,3,2] row_mask:0xf bank_mask:0xf
  s_nop 1
  v_min_u32_dpp v2, v3, v3 quad_perm:[2,3,0,1] row_mask:0xf bank_mask:0xf
  s_nop 1
  v_min_u32_dpp v3, v2, v2 row_half_mirror row_mask:0xf bank_mask:0xf
  s_nop 1
  v_min_u32_dpp v2, v3, v3 quad_perm:[0,1,2,3] row_mask:0xf bank_mask:0xf
  s_nop 0
  v_readfirstlane_b32 s52, v2
  s_cmp_gt_u32 s52, s51
  s_cbranch_scc1 ka\sfx\()_x_wp_101_ok
  s_cmp_lt_u32 s45, 400000
  s_cbranch_scc1 ka\sfx\()_x_wp_101_spin
  s_branch ka\sfx\()_abort
ka\sfx\()_x_wp_101_ok:
  s_add_u32 s28, s50, s53
  buffer_load_dwordx2 v[88:89], v132, s[8:11], s28 offen offset:0 sc1
  buffer_load_dwordx2 v[92:93], v132, s[8:11], s28 offen offset:1024 sc1
  s_add_u32 s28, s50, s54
  buffer_load_dwordx2 v[90:91], v132, s[8:11], s28 offen offset:0 sc1
  buffer_load_dwordx2 v[94:95], v132, s[8:11], s28 offen offset:1024 sc1
  s_add_u32 s28, s50, s55
  buffer_load_dwordx2 v[96:97], v132, s[8:11], s28 offen offset:0 sc1
  buffer_load_dwordx2 v[98:99], v132, s[8:11], s28 offen offset:1024 sc1
  s_branch ka\sfx\()_x_w2l
ka\sfx\()_x_w3l:
  ds_read_b128 v[44:47], v129 offset:2048
  ds_read_b128 v[48:51], v129 offset:3072
  ds_read_b128 v[52:55], v129 offset:12288
  ds_read_b128 v[56:59], v129 offset:13312
  s_waitcnt lgkmcnt(0)
  s_mov_b32 s45, 0
ka\sfx\()_x_pf_102:
  buffer_load_dwordx4 v[112:115], v124, s[8:11], s48 offen sc1
  buffer_load_dwordx4 v[116:119], v125, s[8:11], s48 offen sc1
  s_add_u32 s45, s45, 1
  s_waitcnt vmcnt(1)
  ds_write_b128 v127, v[112:115] offset:0
  v_max3_u32 v139, v112, v113, v114
  v_max_u32 v139, v139, v115
  s_waitcnt vmcnt(0)
  ds_write_b128 v127, v[116:119] offset:4096
  v_max3_u32 v139, v139, v116, v117
  v_max3_u32 v139, v139, v118, v119
  v_cmp_eq_u32 vcc, -1, v139
  s_cbranch_vccz ka\sfx\()_x_pf_102_ok
  s_cmp_lt_u32 s45, 400000
  s_cbranch_scc1 ka\sfx\()_x_pf_102
  s_branch ka\sfx\()_abort
ka\sfx\()_x_pf_102_ok:
  v_smfmac_f32_16x16x64_bf16 v[60:63], v[112:115], a[24:31], v110
  v_smfmac_f32_16x16x64_bf16 v[64:67], v[112:115], v[44:51], v110
  ds_read_b128 v[44:47], v129 offset:22528
  v_smfmac_f32_16x16x64_bf16 v[68:71], v[112:115], a[104:111], v110
  ds_read_b128 v[48:51], v129 offset:23552
  v_smfmac_f32_16x16x64_bf16 v[72:75], v[112:115], v[52:59], v110
  ds_read_b128 v[52:55], v129 offset:6144
  s_waitcnt lgkmcnt(3)
  s_barrier
  v_smfmac_f32_16x16x64_bf16 v[36:39], v[112:115], a[184:191], v110
  ds_read_b128 v[56:59], v129 offset:7168
  ds_read_b128 v[4:7], v128 offset:0
  s_waitcnt lgkmcnt(3)
  v_smfmac_f32_16x16x64_bf16 v[40:43], v[112:115], v[44:51], v110
  ds_read_b128 v[44:47], v129 offset:16384
  ds_read_b128 v[8:11], v128 offset:1024
  v_smfmac_f32_16x16x64_bf16 v[60:63], v[116:119], a[56:63], v110
  ds_read_b128 v[48:51], v129 offset:17408
  ds_read_b128 v[12:15], v128 offset:2048
  s_waitcnt lgkmcnt(5)
  v_smfmac_f32_16x16x64_bf16 v[64:67], v[116:119], v[52:59], v110
  ds_read_b128 v[52:55], v129 offset:26624
  ds_read_b128 v[16:19], v128 offset:4096
  v_smfmac_f32_16x16x64_bf16 v[68:71], v[116:119], a[136:143], v110
  ds_read_b128 v[56:59], v129 offset:27648
  ds_read_b128 v[20:23], v128 offset:5120
  s_waitcnt lgkmcnt(5)
  v_smfmac_f32_16x16x64_bf16 v[72:75], v[116:119], v[44:51], v110
  ds_read_b128 v[44:47], v129 offset:0
  ds_read_b128 v[24:27], v128 offset:6144
  v_smfmac_f32_16x16x64_bf16 v[36:39], v[116:119], a[216:223], v110
  ds_read_b128 v[48:51], v129 offset:1024
  ds_read_b128 v[28:31], v128 offset:8192
  s_waitcnt lgkmcnt(5)
  v_smfmac_f32_16x16x64_bf16 v[40:43], v[116:119], v[52:59], v110
  ds_read_b128 v[52:55], v129 offset:4096
  ds_read_b128 v[32:35], v128 offset:9216
  v_smfmac_f32_16x16x64_bf16 v[60:63], v[4:7], a[0:7], v110
  ds_read_b128 v[56:59], v129 offset:5120
  v_smfmac_f32_16x16x64_bf16 v[64:67], v[4:7], a[240:247], v110
  v_smfmac_f32_16x16x64_bf16 v[60:63], v[8:11], a[8:15], v110
  s_waitcnt lgkmcnt(4)
  v_smfmac_f32_16x16x64_bf16 v[64:67], v[8:11], v[44:51], v110
  ds_read_b128 v[44:47], v129 offset:8192
  v_smfmac_f32_16x16x64_bf16 v[60:63], v[12:15], a[16:23], v110
  ds_read_b128 v[48:51], v129 offset:9216
  v_smfmac_f32_16x16x64_bf16 v[64:67], v[12:15], a[248:255], v110
  v_smfmac_f32_16x16x64_bf16 v[60:63], v[16:19], a[32:39], v110
  v_smfmac_f32_16x16x64_bf16 v[64:67], v[16:19], v[152:159], v110
  v_smfmac_f32_16x16x64_bf16 v[60:63], v[20:23], a[40:47], v110
  s_waitcnt lgkmcnt(2)
  v_smfmac_f32_16x16x64_bf16 v[64:67], v[20:23], v[52:59], v110
  ds_read_b128 v[52:55], v129 offset:10240
  v_smfmac_f32_16x16x64_bf16 v[60:63], v[24:27], a[48:55], v110
  ds_read_b128 v[56:59], v129 offset:11264
  v_smfmac_f32_16x16x64_bf16 v[64:67], v[24:27], v[160:167], v110
  v_smfmac_f32_16x16x64_bf16 v[60:63], v[28:31], a[64:71], v110
  v_smfmac_f32_16x16x64_bf16 v[64:67], v[28:31], v[168:175], v110
  v_smfmac_f32_16x16x64_bf16 v[60:63], v[32:35], a[72:79], v110
  s_waitcnt lgkmcnt(2)
  v_smfmac_f32_16x16x64_bf16 v[64:67], v[32:35], v[44:51], v110
  ds_read_b128 v[44:47], v129 offset:14336
  v_smfmac_f32_16x16x64_bf16 v[68:71], v[4:7], a[80:87], v110
  ds_read_b128 v[48:51], v129 offset:15360
  v_smfmac_f32_16x16x64_bf16 v[72:75], v[4:7], v[176:183], v110
  v_permlane32_swap_b32 v60, v64
  v_smfmac_f32_16x16x64_bf16 v[68:71], v[8:11], a[88:95], v110
  s_waitcnt lgkmcnt(2)
  v_smfmac_f32_16x16x64_bf16 v[72:75], v[8:11], v[52:59], v110
  ds_read_b128 v[52:55], v129 offset:18432
  v_permlane32_swap_b32 v61, v65
  v_smfmac_f32_16x16x64_bf16 v[68:71], v[12:15], a[96:103], v110
  ds_read_b128 v[56:59], v129 offset:19456
  v_smfmac_f32_16x16x64_bf16 v[72:75], v[12:15], v[184:191], v110
  v_permlane32_swap_b32 v62, v66
  v_smfmac_f32_16x16x64_bf16 v[68:71], v[16:19], a[112:119], v110
  v_permlane32_swap_b32 v63, v67
  v_smfmac_f32_16x16x64_bf16 v[72:75], v[16:19], v[192:199], v110
  v_add_f32 v60, v60, v64
  v_smfmac_f32_16x16x64_bf16 v[68:71], v[20:23], a[120:127], v110
  v_add_f32 v61, v61, v65
  s_waitcnt lgkmcnt(2)
  v_smfmac_f32_16x16x64_bf16 v[72:75], v[20:23], v[44:51], v110
  ds_read_b128 v[44:47], v129 offset:20480
  v_add_f32 v62, v62, v66
  v_smfmac_f32_16x16x64_bf16 v[68:71], v[24:27], a[128:135], v110
  ds_read_b128 v[48:51], v129 offset:21504
  v_add_f32 v63, v63, v67
  v_smfmac_f32_16x16x64_bf16 v[72:75], v[24:27], v[200:207], v110
  v_cvt_pk_bf16_f32 v100, v60, v61
  v_smfmac_f32_16x16x64_bf16 v[68:71], v[28:31], a[144:151], v110
  v_cvt_pk_bf16_f32 v101, v62, v63
  v_smfmac_f32_16x16x64_bf16 v[72:75], v[28:31], v[208:215], v110
  v_smfmac_f32_16x16x64_bf16 v[68:71], v[32:35], a[152:159], v110
  s_waitcnt lgkmcnt(2)
  v_smfmac_f32_16x16x64_bf16 v[72:75], v[32:35], v[52:59], v110
  ds_read_b128 v[52:55], v129 offset:24576
  v_smfmac_f32_16x16x64_bf16 v[36:39], v[4:7], a[160:167], v110
  ds_read_b128 v[56:59], v129 offset:25600
  v_smfmac_f32_16x16x64_bf16 v[40:43], v[4:7], v[216:223], v110
  v_permlane32_swap_b32 v68, v72
  v_smfmac_f32_16x16x64_bf16 v[36:39], v[8:11], a[168:175], v110
  s_waitcnt lgkmcnt(2)
  v_smfmac_f32_16x16x64_bf16 v[40:43], v[8:11], v[44:51], v110
  ds_read_b128 v[44:47], v129 offset:28672
  v_permlane32_swap_b32 v69, v73
  v_smfmac_f32_16x16x64_bf16 v[36:39], v[12:15], a[176:183], v110
  ds_read_b128 v[48:51], v129 offset:29696
  v_smfmac_f32_16x16x64_bf16 v[40:43], v[12:15], v[224:231], v110
  v_permlane32_swap_b32 v70, v74
  v_smfmac_f32_16x16x64_bf16 v[36:39], v[16:19], a[192:199], v110
  v_permlane32_swap_b32 v71, v75
  v_smfmac_f32_16x16x64_bf16 v[40:43], v[16:19], v[232:239], v110
  v_add_f32 v68, v68, v72
  v_smfmac_f32_16x16x64_bf16 v[36:39], v[20:23], a[200:207], v110
  v_add_f32 v69, v69, v73
  s_waitcnt lgkmcnt(2)
  v_smfmac_f32_16x16x64_bf16 v[40:43], v[20:23], v[52:59], v110
  v_add_f32 v70, v70, v74
  v_smfmac_f32_16x16x64_bf16 v[36:39], v[24:27], a[208:215], v110
  v_add_f32 v71, v71, v75
  v_smfmac_f32_16x16x64_bf16 v[40:43], v[24:27], v[240:247], v110
  v_cvt_pk_bf16_f32 v102, v68, v69
  v_smfmac_f32_16x16x64_bf16 v[36:39], v[28:31], a[224:231], v110
  v_cvt_pk_bf16_f32 v103, v70, v71
  v_smfmac_f32_16x16x64_bf16 v[40:43], v[28:31], v[248:255], v110
  v_smfmac_f32_16x16x64_bf16 v[36:39], v[32:35], a[232:239], v110
  s_waitcnt lgkmcnt(0)
  v_smfmac_f32_16x16x64_bf16 v[40:43], v[32:35], v[44:51], v110
  v_mfma_f32_16x16x16_bf16 v[142:145], v[100:101], v[108:109], 0
  v_mfma_f32_16x16x16_bf16 v[146:149], v[102:103], v[108:109], 0
  s_nop 1
  v_permlane32_swap_b32 v36, v40
  v_permlane32_swap_b32 v37, v41
  v_permlane32_swap_b32 v38, v42
  v_permlane32_swap_b32 v39, v43
  v_add_f32 v36, v36, v40
  v_add_f32 v37, v37, v41
  v_add_f32 v38, v38, v42
  v_add_f32 v39, v39, v43
  v_cvt_pk_bf16_f32 v104, v36, v37
  v_cvt_pk_bf16_f32 v105, v38, v39
  v_cvt_pk_bf16_f32 v44, v142, v143
  v_cvt_pk_bf16_f32 v45, v144, v145
  v_mfma_f32_16x16x16_bf16 v[142:145], v[104:105], v[108:109], 0
  v_cvt_pk_bf16_f32 v46, v146, v147
  v_cvt_pk_bf16_f32 v47, v148, v149
  s_nop 1
  v_mfma_f32_16x16x32_bf16 v[76:79], v[44:47], v[44:47], 0
  v_mfma_f32_16x16x32_bf16 v[80:83], v[88:91], v[44:47], 0
  v_cvt_pk_bf16_f32 v106, v142, v143
  v_cvt_pk_bf16_f32 v107, v144, v145
  v_mfma_f32_16x16x32_bf16 v[84:87], v[92:95], v[44:47], 0
  s_nop 0
  v_mfma_f32_16x16x16_bf16 v[76:79], v[106:107], v[106:107], v[76:79]
  v_mfma_f32_16x16x16_bf16 v[80:83], v[96:97], v[106:107], v[80:83]
  v_mfma_f32_16x16x16_bf16 v[84:87], v[98:99], v[106:107], v[84:87]
  s_mov_b32 exec_lo, 0
  s_mov_b32 exec_hi, 0x00ff00ff
  s_nop 3
  ds_write_b128 v130, v[76:79]
  s_mov_b32 exec_lo, 0x00ff00ff
  ds_write_b128 v130, v[80:83] offset:1024
  s_nop 0
  ds_write_b128 v130, v[84:87] offset:2048
  s_mov_b64 exec, -1
  s_waitcnt lgkmcnt(0)
  s_barrier
  ds_write_b64 v131, v[44:45]
  ds_write_b64 v131, v[46:47] offset:512
  ds_write_b64 v131, v[106:107] offset:1024
  ds_read_b128 v[44:47], v137 offset:0
  ds_read_b128 v[48:51], v137 offset:1024
  ds_read_b128 v[52:55], v137 offset:2048
  ds_read_b128 v[56:59], v137 offset:3072
  ds_read_b128 v[68:71], v137 offset:4096
  ds_read_b128 v[72:75], v137 offset:5120
  s_waitcnt lgkmcnt(0)
  s_barrier
  s_mov_b32 s28, s50
  buffer_load_dwordx4 v[4:7], v132, s[8:11], s28 offen sc1
  buffer_load_dwordx4 v[8:11], v132, s[8:11], s28 offen offset:1024 sc1
  s_add_u32 s28, s28, 2048
  buffer_load_dwordx4 v[12:15], v132, s[8:11], s28 offen sc1
  buffer_load_dwordx4 v[16:19], v132, s[8:11], s28 offen offset:1024 sc1
  s_add_u32 s28, s28, 2048
  buffer_load_dwordx4 v[20:23], v132, s[8:11], s28 offen sc1
  buffer_load_dwordx4 v[24:27], v132, s[8:11], s28 offen offset:1024 sc1
  s_add_u32 s28, s28, 2048
  buffer_load_dwordx4 v[28:31], v132, s[8:11], s28 offen sc1
  buffer_load_dwordx4 v[32:35], v132, s[8:11], s28 offen offset:1024 sc1
  s_add_u32 s28, s28, 2048
  buffer_load_dwordx4 v[36:39], v132, s[8:11], s28 offen sc1
  buffer_load_dwordx4 v[40:43], v132, s[8:11], s28 offen offset:1024 sc1
  s_add_u32 s28, s28, 2048
  buffer_load_dwordx4 v[60:63], v132, s[8:11], s28 offen sc1
  buffer_load_dwordx4 v[64:67], v132, s[8:11], s28 offen offset:1024 sc1
  s_add_u32 s28, s28, 2048
  ds_read_b64 v[76:77], v136 offset:0
  ds_read_b64 v[78:79], v136 offset:512
  ds_read_b64 v[80:81], v136 offset:1024
  ds_read_b64 v[82:83], v136 offset:1536
  ds_read_b64 v[84:85], v136 offset:2048
  ds_read_b64 v[86:87], v136 offset:2560
  ds_read_b64 v[88:89], v136 offset:3072
  ds_read_b64 v[90:91], v136 offset:3584
  ds_read_b64 v[92:93], v136 offset:4096
  ds_read_b64 v[94:95], v136 offset:4608
  ds_read_b64 v[96:97], v136 offset:5120
  ds_read_b64 v[98:99], v136 offset:5632
  s_waitcnt lgkmcnt(0)
  s_cmp_ge_u32 s51, 63
  s_cbranch_scc1 xq_103_\sfx\()
  s_add_u32 s96, s51, 1
  s_cmp_gt_u32 s52, s96
  s_cbranch_scc1 ka\sfx\()_x_wp_104_ok
  s_mov_b32 s45, 0
ka\sfx\()_x_wp_104_spin:
  buffer_load_dword v2, v138, s[8:11], 0 offen sc1
  s_add_u32 s45, s45, 1
  s_waitcnt vmcnt(0)
  v_min_u32_dpp v3, v2, v2 quad_perm:[1,0,3,2] row_mask:0xf bank_mask:0xf
  s_nop 1
  v_min_u32_dpp v2, v3, v3 quad_perm:[2,3,0,1] row_mask:0xf bank_mask:0xf
  s_nop 1
  v_min_u32_dpp v3, v2, v2 row_half_mirror row_mask:0xf bank_mask:0xf
  s_nop 1
  v_min_u32_dpp v2, v3, v3 quad_perm:[0,1,2,3] row_mask:0xf bank_mask:0xf
  s_nop 0
  v_readfirstlane_b32 s52, v2
  s_cmp_gt_u32 s52, s96
  s_cbranch_scc1 ka\sfx\()_x_wp_104_ok
  s_cmp_lt_u32 s45, 400000
  s_cbranch_scc1 ka\sfx\()_x_wp_104_spin
  s_branch ka\sfx\()_abort
ka\sfx\()_x_wp_104_ok:
  s_add_u32 s95, s63, s93
  s_add_u32 s95, s95, 12288
  s_add_u32 m0, s94, 0
  s_add_u32 s28, s95, 0
  buffer_load_dwordx4 v132, s[8:11], s28 offen sc1 lds
  s_add_u32 m0, s94, 1024
  s_add_u32 s28, s95, 2048
  buffer_load_dwordx4 v132, s[8:11], s28 offen sc1 lds
  s_add_u32 m0, s94, 2048
  s_add_u32 s28, s95, 4096
  buffer_load_dwordx4 v132, s[8:11], s28 offen sc1 lds
  s_add_u32 m0, s94, 3072
  s_add_u32 s28, s95, 6144
  buffer_load_dwordx4 v132, s[8:11], s28 offen sc1 lds
  s_add_u32 m0, s94, 4096
  s_add_u32 s28, s95, 8192
  buffer_load_dwordx4 v132, s[8:11], s28 offen sc1 lds
  s_add_u32 m0, s94, 5120
  s_add_u32 s28, s95, 10240
  buffer_load_dwordx4 v132, s[8:11], s28 offen sc1 lds
  s_branch xq_103_j_\sfx\()
xq_103_\sfx\():
  s_waitcnt vmcnt(0)
xq_103_j_\sfx\():
  s_waitcnt vmcnt(16)
  v_mfma_f32_16x16x32_bf16 v[112:115], v[76:79], v[44:47], 0
  v_mfma_f32_16x16x32_bf16 v[116:119], v[4:7], v[44:47], 0
  v_mfma_f32_16x16x32_bf16 v[120:123], v[8:11], v[44:47], 0
  s_waitcnt vmcnt(14)
  v_mfma_f32_16x16x32_bf16 v[112:115], v[80:83], v[48:51], v[112:115]
  v_mfma_f32_16x16x32_bf16 v[116:119], v[12:15], v[48:51], v[116:119]
  v_mfma_f32_16x16x32_bf16 v[120:123], v[16:19], v[48:51], v[120:123]
  s_waitcnt vmcnt(12)
  v_mfma_f32_16x16x32_bf16 v[112:115], v[84:87], v[52:55], v[112:115]
  v_mfma_f32_16x16x32_bf16 v[116:119], v[20:23], v[52:55], v[116:119]
  v_mfma_f32_16x16x32_bf16 v[120:123], v[24:27], v[52:55], v[120:123]
  s_waitcnt vmcnt(10)
  v_mfma_f32_16x16x32_bf16 v[112:115], v[88:91], v[56:59], v[112:115]
  v_mfma_f32_16x16x32_bf16 v[116:119], v[28:31], v[56:59], v[116:119]
  v_mfma_f32_16x16x32_bf16 v[120:123], v[32:35], v[56:59], v[120:123]
  s_waitcnt vmcnt(8)
  v_mfma_f32_16x16x32_bf16 v[112:115], v[92:95], v[68:71], v[112:115]
  v_mfma_f32_16x16x32_bf16 v[116:119], v[36:39], v[68:71], v[116:119]
  v_mfma_f32_16x16x32_bf16 v[120:123], v[40:43], v[68:71], v[120:123]
  s_waitcnt vmcnt(6)
  v_mfma_f32_16x16x32_bf16 v[112:115], v[96:99], v[72:75], v[112:115]
  v_mfma_f32_16x16x32_bf16 v[116:119], v[60:63], v[72:75], v[116:119]
  v_mfma_f32_16x16x32_bf16 v[120:123], v[64:67], v[72:75], v[120:123]
  s_nop 8
  v_cndmask_b32 v112, v135, v112, s[66:67]
  v_cndmask_b32 v113, v135, v113, s[66:67]
  v_cndmask_b32 v114, v135, v114, s[66:67]
  v_cndmask_b32 v115, v135, v115, s[66:67]
  v_cndmask_b32 v116, v135, v116, s[76:77]
  v_cndmask_b32 v120, v135, v120, s[84:85]
  v_cndmask_b32 v117, v135, v117, s[78:79]
  v_cndmask_b32 v121, v135, v121, s[86:87]
  v_cndmask_b32 v118, v135, v118, s[80:81]
  v_cndmask_b32 v122, v135, v122, s[88:89]
  v_cndmask_b32 v119, v135, v119, s[82:83]
  v_cndmask_b32 v123, v135, v123, s[90:91]
  v_max3_f32 v4, v112, v113, v114
  v_max3_f32 v5, v115, v116, v117
  v_max3_f32 v6, v118, v119, v120
  v_max3_f32 v7, v121, v122, v123
  v_max3_f32 v4, v4, v5, v6
  v_max_f32 v4, v4, v7
  v_mov_b32 v5, v4
  s_nop 1
  v_permlane16_swap_b32 v4, v5
  v_max_f32 v4, v4, v5
  v_mov_b32 v5, v4
  s_nop 1
  v_permlane32_swap_b32 v4, v5
  v_max_f32 v4, v4, v5
  v_mul_f32 v4, s64, v4
  v_fma_f32 v112, v112, s64, -v4
  v_fma_f32 v113, v113, s64, -v4
  v_fma_f32 v114, v114, s64, -v4
  v_fma_f32 v115, v115, s64, -v4
  v_fma_f32 v116, v116, s64, -v4
  v_fma_f32 v117, v117, s64, -v4
  v_fma_f32 v118, v118, s64, -v4
  v_fma_f32 v119, v119, s64, -v4
  v_fma_f32 v120, v120, s64, -v4
  v_fma_f32 v121, v121, s64, -v4
  v_fma_f32 v122, v122, s64, -v4
  v_fma_f32 v123, v123, s64, -v4
  v_exp_f32 v112, v112
  v_exp_f32 v113, v113
  v_exp_f32 v114, v114
  v_exp_f32 v115, v115
  v_exp_f32 v116, v116
  v_exp_f32 v117, v117
  v_exp_f32 v118, v118
  v_exp_f32 v119, v119
  v_exp_f32 v120, v120
  v_exp_f32 v121, v121
  v_exp_f32 v122, v122
  v_exp_f32 v123, v123
  v_add_f32 v5, v112, v113
  v_add_f32 v6, v114, v115
  v_add_f32 v7, v116, v117
  v_add_f32 v8, v118, v119
  v_add_f32 v9, v120, v121
  v_add_f32 v10, v122, v123
  v_add_f32 v5, v5, v6
  v_add_f32 v7, v7, v8
  v_add_f32 v9, v9, v10
  v_add_f32 v5, v5, v7
  v_add_f32 v5, v5, v9
  v_mov_b32 v6, v5
  s_nop 1
  v_permlane16_swap_b32 v5, v6
  v_add_f32 v5, v5, v6
  v_mov_b32 v6, v5
  s_nop 1
  v_permlane32_swap_b32 v5, v6
  v_add_f32 v5, v5, v6
  v_rcp_f32 v5, v5
  s_nop 0
  v_mul_f32 v112, v112, v5
  v_mul_f32 v113, v113, v5
  v_mul_f32 v114, v114, v5
  v_mul_f32 v115, v115, v5
  v_mul_f32 v116, v116, v5
  v_mul_f32 v117, v117, v5
  v_mul_f32 v118, v118, v5
  v_mul_f32 v119, v119, v5
  v_mul_f32 v120, v120, v5
  v_mul_f32 v121, v121, v5
  v_mul_f32 v122, v122, v5
  v_mul_f32 v123, v123, v5
  v_cvt_pk_bf16_f32 v8, v112, v113
  v_cvt_pk_bf16_f32 v9, v114, v115
  v_cvt_pk_bf16_f32 v10, v116, v117
  v_cvt_pk_bf16_f32 v11, v118, v119
  v_cvt_pk_bf16_f32 v12, v120, v121
  v_cvt_pk_bf16_f32 v13, v122, v123
  buffer_store_dwordx2 v[10:11], v133, s[8:11], s92 offen \pol
  buffer_store_dwordx2 v[12:13], v133, s[8:11], s92 offen offset:256 \pol
  buffer_store_dwordx2 v[8:9], v134, s[8:11], s92 offen \pol
  s_add_u32 s92, s92, 20480
  s_cmp_ge_u32 s51, 63
  s_cbranch_scc1 ka\sfx\()_x_done
  v_mov_b32 v60, 0
  v_mov_b32 v61, 0
  v_mov_b32 v62, 0
  v_mov_b32 v63, 0
  v_mov_b32 v64, 0
  v_mov_b32 v65, 0
  v_mov_b32 v66, 0
  v_mov_b32 v67, 0
  v_mov_b32 v68, 0
  v_mov_b32 v69, 0
  v_mov_b32 v70, 0
  v_mov_b32 v71, 0
  v_mov_b32 v72, 0
  v_mov_b32 v73, 0
  v_mov_b32 v74, 0
  v_mov_b32 v75, 0
  v_mov_b32 v36, 0
  v_mov_b32 v37, 0
  v_mov_b32 v38, 0
  v_mov_b32 v39, 0
  v_mov_b32 v40, 0
  v_mov_b32 v41, 0
  v_mov_b32 v42, 0
  v_mov_b32 v43, 0
  s_add_u32 s97, s97, 10240
  s_mov_b32 s48, s97
  s_add_u32 s49, s49, 5120
  s_add_u32 s50, s50, 12288
  s_add_u32 s63, s63, 12288
  s_add_u32 s51, s51, 1
  s_cmp_gt_u32 s52, s51
  s_cbranch_scc1 ka\sfx\()_x_wp_105_ok
  s_mov_b32 s45, 0
ka\sfx\()_x_wp_105_spin:
  buffer_load_dword v2, v138, s[8:11], 0 offen sc1
  s_add_u32 s45, s45, 1
  s_waitcnt vmcnt(0)
  v_min_u32_dpp v3, v2, v2 quad_perm:[1,0,3,2] row_mask:0xf bank_mask:0xf
  s_nop 1
  v_min_u32_dpp v2, v3, v3 quad_perm:[2,3,0,1] row_mask:0xf bank_mask:0xf
  s_nop 1
  v_min_u32_dpp v3, v2, v2 row_half_mirror row_mask:0xf bank_mask:0xf
  s_nop 1
  v_min_u32_dpp v2, v3, v3 quad_perm:[0,1,2,3] row_mask:0xf bank_mask:0xf
  s_nop 0
  v_readfirstlane_b32 s52, v2
  s_cmp_gt_u32 s52, s51
  s_cbranch_scc1 ka\sfx\()_x_wp_105_ok
  s_cmp_lt_u32 s45, 400000
  s_cbranch_scc1 ka\sfx\()_x_wp_105_spin
  s_branch ka\sfx\()_abort
ka\sfx\()_x_wp_105_ok:
  s_add_u32 s28, s50, s53
  buffer_load_dwordx2 v[88:89], v132, s[8:11], s28 offen offset:0 sc1
  buffer_load_dwordx2 v[92:93], v132, s[8:11], s28 offen offset:1024 sc1
  s_add_u32 s28, s50, s54
  buffer_load_dwordx2 v[90:91], v132, s[8:11], s28 offen offset:0 sc1
  buffer_load_dwordx2 v[94:95], v132, s[8:11], s28 offen offset:1024 sc1
  s_add_u32 s28, s50, s55
  buffer_load_dwordx2 v[96:97], v132, s[8:11], s28 offen offset:0 sc1
  buffer_load_dwordx2 v[98:99], v132, s[8:11], s28 offen offset:1024 sc1
  s_branch ka\sfx\()_x_w3l
ka\sfx\()_x_done:
  s_waitcnt vmcnt(0) lgkmcnt(0)
  s_branch ka\sfx\()_exit
ka\sfx\()_y:
  v_and_b32 v1, 63, v0
  v_lshlrev_b32 v178, 4, v1
  s_and_b32 s28, s21, 1
  s_lshl_b32 s46, s23, 1
  s_add_u32 s46, s46, s28
  s_lshr_b32 s28, s21, 1
  s_lshl_b32 s28, s28, 2
  s_lshl_b32 s47, s20, 3
  s_add_u32 s47, s47, s28
  s_mul_i32 s28, s47, 40
  s_add_u32 s28, s28, s46
  s_mul_i32 s28, s28, 20480
  s_add_u32 s28, s28, 0x2e00000
  s_add_u32 s29, s28, 0
  buffer_load_dwordx4 a[0:3], v178, s[8:11], s29 offen
  buffer_load_dwordx4 a[4:7], v178, s[8:11], s29 offen offset:1024
  s_add_u32 s29, s28, 2048
  buffer_load_dwordx4 a[8:11], v178, s[8:11], s29 offen
  buffer_load_dwordx4 a[12:15], v178, s[8:11], s29 offen offset:1024
  s_add_u32 s29, s28, 4096
  buffer_load_dwordx4 a[16:19], v178, s[8:11], s29 offen
  buffer_load_dwordx4 a[20:23], v178, s[8:11], s29 offen offset:1024
  s_add_u32 s29, s28, 6144
  buffer_load_dwordx4 a[24:27], v178, s[8:11], s29 offen
  buffer_load_dwordx4 a[28:31], v178, s[8:11], s29 offen offset:1024
  s_add_u32 s29, s28, 8192
  buffer_load_dwordx4 a[32:35], v178, s[8:11], s29 offen
  buffer_load_dwordx4 a[36:39], v178, s[8:11], s29 offen offset:1024
  s_add_u32 s29, s28, 10240
  buffer_load_dwordx4 a[40:43], v178, s[8:11], s29 offen
  buffer_load_dwordx4 a[44:47], v178, s[8:11], s29 offen offset:1024
  s_add_u32 s29, s28, 12288
  buffer_load_dwordx4 a[48:51], v178, s[8:11], s29 offen
  buffer_load_dwordx4 a[52:55], v178, s[8:11], s29 offen offset:1024
  s_add_u32 s29, s28, 14336
  buffer_load_dwordx4 a[56:59], v178, s[8:11], s29 offen
  buffer_load_dwordx4 a[60:63], v178, s[8:11], s29 offen offset:1024
  s_add_u32 s29, s28, 16384
  buffer_load_dwordx4 a[64:67], v178, s[8:11], s29 offen
  buffer_load_dwordx4 a[68:71], v178, s[8:11], s29 offen offset:1024
  s_add_u32 s29, s28, 18432
  buffer_load_dwordx4 a[72:75], v178, s[8:11], s29 offen
  buffer_load_dwordx4 a[76:79], v178, s[8:11], s29 offen offset:1024
  s_add_u32 s29, s28, 819200
  buffer_load_dwordx4 a[80:83], v178, s[8:11], s29 offen
  buffer_load_dwordx4 a[84:87], v178, s[8:11], s29 offen offset:1024
  s_add_u32 s29, s28, 821248
  buffer_load_dwordx4 a[88:91], v178, s[8:11], s29 offen
  buffer_load_dwordx4 a[92:95], v178, s[8:11], s29 offen offset:1024
  s_add_u32 s29, s28, 823296
  buffer_load_dwordx4 a[96:99], v178, s[8:11], s29 offen
  buffer_load_dwordx4 a[100:103], v178, s[8:11], s29 offen offset:1024
  s_add_u32 s29, s28, 825344
  buffer_load_dwordx4 a[104:107], v178, s[8:11], s29 offen
  buffer_load_dwordx4 a[108:111], v178, s[8:11], s29 offen offset:1024
  s_add_u32 s29, s28, 827392
  buffer_load_dwordx4 a[112:115], v178, s[8:11], s29 offen
  buffer_load_dwordx4 a[116:119], v178, s[8:11], s29 offen offset:1024
  s_add_u32 s29, s28, 829440
  buffer_load_dwordx4 a[120:123], v178, s[8:11], s29 offen
  buffer_load_dwordx4 a[124:127], v178, s[8:11], s29 offen offset:1024
  s_add_u32 s29, s28, 831488
  buffer_load_dwordx4 a[128:131], v178, s[8:11], s29 offen
  buffer_load_dwordx4 a[132:135], v178, s[8:11], s29 offen offset:1024
  s_add_u32 s29, s28, 833536
  buffer_load_dwordx4 a[136:139], v178, s[8:11], s29 offen
  buffer_load_dwordx4 a[140:143], v178, s[8:11], s29 offen offset:1024
  s_add_u32 s29, s28, 835584
  buffer_load_dwordx4 a[144:147], v178, s[8:11], s29 offen
  buffer_load_dwordx4 a[148:151], v178, s[8:11], s29 offen offset:1024
  s_add_u32 s29, s28, 837632
  buffer_load_dwordx4 a[152:155], v178, s[8:11], s29 offen
  buffer_load_dwordx4 a[156:159], v178, s[8:11], s29 offen offset:1024
  s_waitcnt vmcnt(30)
  s_cmp_eq_u32 s21, 3
  s_cbranch_scc0 lna_106_\sfx\()
  s_mov_b64 s[24:25], exec
  s_mov_b64 exec, 1
  v_mov_b32 v2, 4992
  v_mov_b32 v3, 1
  buffer_atomic_add v3, v2, s[8:11], 0 offen
  s_mov_b64 exec, s[24:25]
lna_106_\sfx\():
  s_add_u32 s29, s28, 1638400
  buffer_load_dwordx4 a[160:163], v178, s[8:11], s29 offen
  buffer_load_dwordx4 a[164:167], v178, s[8:11], s29 offen offset:1024
  s_add_u32 s29, s28, 1640448
  buffer_load_dwordx4 a[168:171], v178, s[8:11], s29 offen
  buffer_load_dwordx4 a[172:175], v178, s[8:11], s29 offen offset:1024
  s_add_u32 s29, s28, 1642496
  buffer_load_dwordx4 a[176:179], v178, s[8:11], s29 offen
  buffer_load_dwordx4 a[180:183], v178, s[8:11], s29 offen offset:1024
  s_add_u32 s29, s28, 1644544
  buffer_load_dwordx4 a[184:187], v178, s[8:11], s29 offen
  buffer_load_dwordx4 a[188:191], v178, s[8:11], s29 offen offset:1024
  s_add_u32 s29, s28, 1646592
  buffer_load_dwordx4 a[192:195], v178, s[8:11], s29 offen
  buffer_load_dwordx4 a[196:199], v178, s[8:11], s29 offen offset:1024
  s_add_u32 s29, s28, 1648640
  buffer_load_dwordx4 a[200:203], v178, s[8:11], s29 offen
  buffer_load_dwordx4 a[204:207], v178, s[8:11], s29 offen offset:1024
  s_add_u32 s29, s28, 1650688
  buffer_load_dwordx4 a[208:211], v178, s[8:11], s29 offen
  buffer_load_dwordx4 a[212:215], v178, s[8:11], s29 offen offset:1024
  s_add_u32 s29, s28, 1652736
  buffer_load_dwordx4 a[216:219], v178, s[8:11], s29 offen
  buffer_load_dwordx4 a[220:223], v178, s[8:11], s29 offen offset:1024
  s_add_u32 s29, s28, 1654784
  buffer_load_dwordx4 a[224:227], v178, s[8:11], s29 offen
  buffer_load_dwordx4 a[228:231], v178, s[8:11], s29 offen offset:1024
  s_add_u32 s29, s28, 1656832
  buffer_load_dwordx4 a[232:235], v178, s[8:11], s29 offen
  buffer_load_dwordx4 a[236:239], v178, s[8:11], s29 offen offset:1024
  s_waitcnt vmcnt(30)
  s_add_u32 s29, s28, 2457600
  buffer_load_dwordx4 a[240:243], v178, s[8:11], s29 offen
  buffer_load_dwordx4 a[244:247], v178, s[8:11], s29 offen offset:1024
  s_add_u32 s29, s28, 2459648
  buffer_load_dwordx4 a[248:251], v178, s[8:11], s29 offen
  buffer_load_dwordx4 a[252:255], v178, s[8:11], s29 offen offset:1024
  s_add_u32 s29, s28, 2461696
  buffer_load_dwordx4 v[192:195], v178, s[8:11], s29 offen
  buffer_load_dwordx4 v[196:199], v178, s[8:11], s29 offen offset:1024
  s_add_u32 s29, s28, 2463744
  buffer_load_dwordx4 v[200:203], v178, s[8:11], s29 offen
  buffer_load_dwordx4 v[204:207], v178, s[8:11], s29 offen offset:1024
  s_add_u32 s29, s28, 2465792
  buffer_load_dwordx4 v[208:211], v178, s[8:11], s29 offen
  buffer_load_dwordx4 v[212:215], v178, s[8:11], s29 offen offset:1024
  s_add_u32 s29, s28, 2467840
  buffer_load_dwordx4 v[216:219], v178, s[8:11], s29 offen
  buffer_load_dwordx4 v[220:223], v178, s[8:11], s29 offen offset:1024
  s_add_u32 s29, s28, 2469888
  buffer_load_dwordx4 v[224:227], v178, s[8:11], s29 offen
  buffer_load_dwordx4 v[228:231], v178, s[8:11], s29 offen offset:1024
  s_add_u32 s29, s28, 2471936
  buffer_load_dwordx4 v[232:235], v178, s[8:11], s29 offen
  buffer_load_dwordx4 v[236:239], v178, s[8:11], s29 offen offset:1024
  s_add_u32 s29, s28, 2473984
  buffer_load_dwordx4 v[240:243], v178, s[8:11], s29 offen
  buffer_load_dwordx4 v[244:247], v178, s[8:11], s29 offen offset:1024
  s_add_u32 s29, s28, 2476032
  buffer_load_dwordx4 v[248:251], v178, s[8:11], s29 offen
  buffer_load_dwordx4 v[252:255], v178, s[8:11], s29 offen offset:1024
  s_waitcnt vmcnt(30)
  v_mov_b32 v172, 0x44444444
  v_mov_b32 v2, 0xeeeeeeee
  v_and_b32 v3, 8, v1
  v_cmp_ne_u32 vcc, 0, v3
  s_nop 1
  v_cndmask_b32 v172, v172, v2, vcc
  s_lshl_b32 s28, s21, 10
  v_add_u32 v173, s28, v178
  v_add_u32 v174, 4096, v173
  v_add_u32 v175, 8192, v173
  v_add_u32 v176, 0, v173
  v_add_u32 v177, 0, v178
  v_add_u32 v179, 10240, v173
  s_xor_b32 s28, s21, 2
  s_lshl_b32 s28, s28, 10
  s_add_u32 s28, s28, 10240
  v_add_u32 v180, s28, v178
  v_and_b32 v4, 15, v1
  v_lshrrev_b32 v5, 4, v1
  v_and_b32 v6, 7, v1
  v_lshlrev_b32 v7, 3, v5
  v_add_u32 v7, v7, v6
  v_lshlrev_b32 v185, 4, v7
  v_add_u32 v182, 4096, v178
  v_mov_b32 v8, 0x40000000
  v_cmp_gt_u32 vcc, 8, v4
  s_nop 1
  v_cndmask_b32 v184, v8, v185, vcc
  v_lshlrev_b32 v7, 4, v4
  v_lshlrev_b32 v9, 2, v5
  v_add_u32 v7, v7, v9
  v_cndmask_b32 v186, v8, v7, vcc
  s_lshl_b32 s28, s20, 5
  s_add_u32 s28, s28, 3072
  v_lshlrev_b32 v7, 2, v6
  v_add_u32 v187, s28, v7
  v_and_b32 v7, 1, v5
  v_lshlrev_b32 v7, 10, v7
  v_lshrrev_b32 v9, 1, v5
  v_lshlrev_b32 v9, 5, v9
  v_add_u32 v9, v9, v4
  v_lshlrev_b32 v9, 4, v9
  v_add_u32 v189, v7, v9
  v_mov_b32 v44, 0
  v_mov_b32 v45, 0
  v_mov_b32 v46, 0
  v_mov_b32 v47, 0
  v_mov_b32 v48, 0
  v_mov_b32 v49, 0
  v_mov_b32 v50, 0
  v_mov_b32 v51, 0
  v_mov_b32 v52, 0
  v_mov_b32 v53, 0
  v_mov_b32 v54, 0
  v_mov_b32 v55, 0
  v_mov_b32 v56, 0
  v_mov_b32 v57, 0
  v_mov_b32 v58, 0
  v_mov_b32 v59, 0
  s_mul_i32 s97, s20, 655360
  s_add_u32 s97, s97, 0x400000
  s_mov_b32 s48, 0x4000
  s_mul_i32 s49, s20, 327680
  s_add_u32 s49, s49, 0x700000
  s_mul_i32 s50, s20, 327680
  s_lshl_b32 s28, s46, 10
  s_add_u32 s50, s50, s28
  s_add_u32 s50, s50, 0x9000000
  s_mov_b32 s51, 0
  s_mov_b32 s52, 0
  s_mov_b32 s53, 0
  v_mov_b32 v2, 5056
  s_mov_b32 s45, 0
ka\sfx\()_y_sel:
  buffer_load_dword v3, v2, s[8:11], 0 offen sc1
  s_add_u32 s45, s45, 1
  s_waitcnt vmcnt(0)
  v_readfirstlane_b32 s61, v3
  s_cmp_lg_u32 s61, 0
  s_cbranch_scc1 ka\sfx\()_y_selok
  s_cmp_lt_u32 s45, 20000
  s_cbranch_scc1 ka\sfx\()_y_sel
ka\sfx\()_y_selok:
  s_and_b32 s61, s61, 2
  s_lshl_b32 s61, s61, 12
  s_add_u32 s29, s20, 0
  s_and_b32 s29, s29, 3
  s_mul_i32 s29, s29, 20
  s_add_u32 s29, s29, s23
  s_lshr_b32 s28, s29, 3
  s_lshl_b32 s28, s28, 14
  s_and_b32 s29, s29, 7
  s_lshl_b32 s29, s29, 10
  s_add_u32 s28, s28, s29
  s_and_b32 s29, s21, 1
  s_lshl_b32 s29, s29, 9
  s_add_u32 s28, s28, s29
  s_add_u32 s28, s28, s61
  s_add_u32 s56, s28, 0xa00000
  s_mov_b32 s66, s56
  s_add_u32 s29, s20, 1
  s_and_b32 s29, s29, 3
  s_mul_i32 s29, s29, 20
  s_add_u32 s29, s29, s23
  s_lshr_b32 s28, s29, 3
  s_lshl_b32 s28, s28, 14
  s_and_b32 s29, s29, 7
  s_lshl_b32 s29, s29, 10
  s_add_u32 s28, s28, s29
  s_and_b32 s29, s21, 1
  s_lshl_b32 s29, s29, 9
  s_add_u32 s28, s28, s29
  s_add_u32 s28, s28, s61
  s_add_u32 s57, s28, 0xa00000
  s_mov_b32 s67, s57
  s_add_u32 s29, s20, 2
  s_and_b32 s29, s29, 3
  s_mul_i32 s29, s29, 20
  s_add_u32 s29, s29, s23
  s_lshr_b32 s28, s29, 3
  s_lshl_b32 s28, s28, 14
  s_and_b32 s29, s29, 7
  s_lshl_b32 s29, s29, 10
  s_add_u32 s28, s28, s29
  s_and_b32 s29, s21, 1
  s_lshl_b32 s29, s29, 9
  s_add_u32 s28, s28, s29
  s_add_u32 s28, s28, s61
  s_add_u32 s58, s28, 0xa00000
  s_mov_b32 s68, s58
  s_add_u32 s29, s20, 3
  s_and_b32 s29, s29, 3
  s_mul_i32 s29, s29, 20
  s_add_u32 s29, s29, s23
  s_lshr_b32 s28, s29, 3
  s_lshl_b32 s28, s28, 14
  s_and_b32 s29, s29, 7
  s_lshl_b32 s29, s29, 10
  s_add_u32 s28, s28, s29
  s_and_b32 s29, s21, 1
  s_lshl_b32 s29, s29, 9
  s_add_u32 s28, s28, s29
  s_add_u32 s28, s28, s61
  s_add_u32 s59, s28, 0xa00000
  s_mov_b32 s69, s59
  v_mov_b32 v124, -1
  v_mov_b32 v125, -1
  v_mov_b32 v126, -1
  v_mov_b32 v127, -1
  s_lshr_b32 s28, s46, 2
  s_lshl_b32 s28, s28, 10
  s_and_b32 s29, s46, 3
  s_lshl_b32 s29, s29, 8
  s_add_u32 s28, s28, s29
  s_add_u32 s60, s28, s97
  s_add_u32 s60, s60, 10240
  s_and_b32 s28, s21, 1
  s_lshl_b32 s28, s28, 10
  s_add_u32 s28, s28, 32768
  v_add_u32 v181, s28, v178
  v_add_u32 v183, 65536, v178
  s_waitcnt vmcnt(0)
  s_cmp_ge_u32 s21, 2
  s_cbranch_scc1 ka\sfx\()_y_tok
ka\sfx\()_y_crit:
  s_add_u32 s98, s48, 4096
  s_add_u32 s100, s48, 8192
  s_mov_b32 s45, 0
ka\sfx\()_y_pf_107:
  buffer_load_dwordx4 v[160:163], v173, s[8:11], s48 offen sc1
  buffer_load_dwordx4 v[164:167], v173, s[8:11], s48 offen offset:2048 sc1
  buffer_load_dwordx4 v[168:171], v173, s[8:11], s98 offen sc1
  buffer_load_dwordx4 v[68:71], v173, s[8:11], s98 offen offset:2048 sc1
  buffer_load_dwordx4 v[72:75], v173, s[8:11], s100 offen sc1
  s_add_u32 s45, s45, 1
  s_waitcnt vmcnt(4)
  ds_write_b128 v176, v[160:163] offset:0
  v_max3_u32 v190, v160, v161, v162
  v_max_u32 v190, v190, v163
  s_waitcnt vmcnt(3)
  ds_write_b128 v176, v[164:167] offset:2048
  v_max3_u32 v190, v190, v164, v165
  v_max3_u32 v190, v190, v166, v167
  s_waitcnt vmcnt(2)
  ds_write_b128 v176, v[168:171] offset:4096
  v_max3_u32 v190, v190, v168, v169
  v_max3_u32 v190, v190, v170, v171
  s_waitcnt vmcnt(1)
  ds_write_b128 v176, v[68:71] offset:6144
  v_max3_u32 v190, v190, v68, v69
  v_max3_u32 v190, v190, v70, v71
  s_waitcnt vmcnt(0)
  ds_write_b128 v176, v[72:75] offset:8192
  v_max3_u32 v190, v190, v72, v73
  v_max3_u32 v190, v190, v74, v75
  v_cmp_eq_u32 vcc, -1, v190
  s_cbranch_vccz ka\sfx\()_y_pf_107_ok
  s_cmp_lt_u32 s45, 400000
  s_cbranch_scc1 ka\sfx\()_y_pf_107
  s_branch ka\sfx\()_abort
ka\sfx\()_y_pf_107_ok:
  s_waitcnt lgkmcnt(0)
  s_barrier
  ds_read_b128 v[4:7], v177 offset:0
  ds_read_b128 v[8:11], v177 offset:1024
  ds_read_b128 v[12:15], v177 offset:2048
  ds_read_b128 v[16:19], v177 offset:3072
  ds_read_b128 v[20:23], v177 offset:4096
  ds_read_b128 v[24:27], v177 offset:5120
  ds_read_b128 v[28:31], v177 offset:6144
  ds_read_b128 v[32:35], v177 offset:7168
  ds_read_b128 v[36:39], v177 offset:8192
  ds_read_b128 v[40:43], v177 offset:9216
  s_cmp_lt_u32 s51, 2
  s_cbranch_scc1 ka\sfx\()_y_norst
  s_sub_u32 s28, s51, 2
  s_and_b32 s28, s28, 3
  s_mul_i32 s28, s28, 163840
  s_add_u32 s28, s28, s56
  v_mov_b32 v160, -1
  v_mov_b32 v161, -1
  v_mov_b32 v162, -1
  v_mov_b32 v163, -1
  buffer_store_dwordx4 v[160:163], v184, s[8:11], s28 offen sc1
ka\sfx\()_y_norst:
  s_waitcnt lgkmcnt(9)
  v_smfmac_f32_16x16x64_bf16 v[44:47], v[4:7], a[0:7], v172
  v_smfmac_f32_16x16x64_bf16 v[48:51], v[4:7], a[80:87], v172
  v_smfmac_f32_16x16x64_bf16 v[52:55], v[4:7], a[160:167], v172
  v_smfmac_f32_16x16x64_bf16 v[56:59], v[4:7], a[240:247], v172
  s_waitcnt lgkmcnt(8)
  v_smfmac_f32_16x16x64_bf16 v[44:47], v[8:11], a[8:15], v172
  v_smfmac_f32_16x16x64_bf16 v[48:51], v[8:11], a[88:95], v172
  v_smfmac_f32_16x16x64_bf16 v[52:55], v[8:11], a[168:175], v172
  v_smfmac_f32_16x16x64_bf16 v[56:59], v[8:11], a[248:255], v172
  s_waitcnt lgkmcnt(7)
  v_smfmac_f32_16x16x64_bf16 v[44:47], v[12:15], a[16:23], v172
  v_smfmac_f32_16x16x64_bf16 v[48:51], v[12:15], a[96:103], v172
  v_smfmac_f32_16x16x64_bf16 v[52:55], v[12:15], a[176:183], v172
  v_smfmac_f32_16x16x64_bf16 v[56:59], v[12:15], v[192:199], v172
  s_waitcnt lgkmcnt(6)
  v_smfmac_f32_16x16x64_bf16 v[44:47], v[16:19], a[24:31], v172
  v_smfmac_f32_16x16x64_bf16 v[48:51], v[16:19], a[104:111], v172
  v_smfmac_f32_16x16x64_bf16 v[52:55], v[16:19], a[184:191], v172
  v_smfmac_f32_16x16x64_bf16 v[56:59], v[16:19], v[200:207], v172
  s_waitcnt lgkmcnt(5)
  v_smfmac_f32_16x16x64_bf16 v[44:47], v[20:23], a[32:39], v172
  v_smfmac_f32_16x16x64_bf16 v[48:51], v[20:23], a[112:119], v172
  v_smfmac_f32_16x16x64_bf16 v[52:55], v[20:23], a[192:199], v172
  v_smfmac_f32_16x16x64_bf16 v[56:59], v[20:23], v[208:215], v172
  s_waitcnt lgkmcnt(4)
  v_smfmac_f32_16x16x64_bf16 v[44:47], v[24:27], a[40:47], v172
  v_smfmac_f32_16x16x64_bf16 v[48:51], v[24:27], a[120:127], v172
  v_smfmac_f32_16x16x64_bf16 v[52:55], v[24:27], a[200:207], v172
  v_smfmac_f32_16x16x64_bf16 v[56:59], v[24:27], v[216:223], v172
  s_waitcnt lgkmcnt(3)
  v_smfmac_f32_16x16x64_bf16 v[44:47], v[28:31], a[48:55], v172
  v_smfmac_f32_16x16x64_bf16 v[48:51], v[28:31], a[128:135], v172
  v_smfmac_f32_16x16x64_bf16 v[52:55], v[28:31], a[208:215], v172
  v_smfmac_f32_16x16x64_bf16 v[56:59], v[28:31], v[224:231], v172
  s_waitcnt lgkmcnt(2)
  v_smfmac_f32_16x16x64_bf16 v[44:47], v[32:35], a[56:63], v172
  v_smfmac_f32_16x16x64_bf16 v[48:51], v[32:35], a[136:143], v172
  v_smfmac_f32_16x16x64_bf16 v[52:55], v[32:35], a[216:223], v172
  v_smfmac_f32_16x16x64_bf16 v[56:59], v[32:35], v[232:239], v172
  s_waitcnt lgkmcnt(1)
  v_smfmac_f32_16x16x64_bf16 v[44:47], v[36:39], a[64:71], v172
  v_smfmac_f32_16x16x64_bf16 v[48:51], v[36:39], a[144:151], v172
  v_smfmac_f32_16x16x64_bf16 v[52:55], v[36:39], a[224:231], v172
  v_smfmac_f32_16x16x64_bf16 v[56:59], v[36:39], v[240:247], v172
  s_waitcnt lgkmcnt(0)
  v_smfmac_f32_16x16x64_bf16 v[44:47], v[40:43], a[72:79], v172
  v_smfmac_f32_16x16x64_bf16 v[48:51], v[40:43], a[152:159], v172
  v_smfmac_f32_16x16x64_bf16 v[52:55], v[40:43], a[232:239], v172
  v_smfmac_f32_16x16x64_bf16 v[56:59], v[40:43], v[248:255], v172
  s_nop 9
  v_permlane32_swap_b32 v44, v48
  v_permlane32_swap_b32 v45, v49
  v_permlane32_swap_b32 v46, v50
  v_permlane32_swap_b32 v47, v51
  v_permlane32_swap_b32 v52, v56
  v_permlane32_swap_b32 v53, v57
  v_permlane32_swap_b32 v54, v58
  v_permlane32_swap_b32 v55, v59
  v_add_f32 v44, v44, v48
  v_add_f32 v45, v45, v49
  v_add_f32 v46, v46, v50
  v_add_f32 v47, v47, v51
  v_add_f32 v52, v52, v56
  v_add_f32 v53, v53, v57
  v_add_f32 v54, v54, v58
  v_add_f32 v55, v55, v59
  v_cvt_pk_bf16_f32 v60, v44, v45
  v_cvt_pk_bf16_f32 v61, v46, v47
  v_cvt_pk_bf16_f32 v62, v52, v53
  v_cvt_pk_bf16_f32 v63, v54, v55
  ds_write_b128 v179, v[60:63]
  v_mov_b32 v44, 0
  v_mov_b32 v45, 0
  v_mov_b32 v46, 0
  v_mov_b32 v47, 0
  v_mov_b32 v48, 0
  v_mov_b32 v49, 0
  v_mov_b32 v50, 0
  v_mov_b32 v51, 0
  v_mov_b32 v52, 0
  v_mov_b32 v53, 0
  v_mov_b32 v54, 0
  v_mov_b32 v55, 0
  v_mov_b32 v56, 0
  v_mov_b32 v57, 0
  v_mov_b32 v58, 0
  v_mov_b32 v59, 0
  s_waitcnt lgkmcnt(0)
  s_barrier
  s_cmp_ge_u32 s51, 63
  s_cbranch_scc1 ka\sfx\()_y_crit_end
  ds_read_b128 v[64:67], v180
  ds_read_b128 v[68:71], v181 offset:0
  ds_read_b128 v[72:75], v181 offset:2048
  ds_read_b128 v[76:79], v181 offset:4096
  ds_read_b128 v[80:83], v181 offset:6144
  ds_read_b128 v[84:87], v181 offset:8192
  ds_read_b128 v[88:91], v181 offset:10240
  ds_read_b128 v[92:95], v181 offset:12288
  ds_read_b128 v[96:99], v181 offset:14336
  v_xor_b32 v181, 0x4000, v181
  s_mov_b32 s45, 0
  buffer_load_dwordx4 v[100:103], v178, s[8:11], s49 offen offset:0 sc1
  buffer_load_dwordx4 v[104:107], v178, s[8:11], s49 offen offset:1024 sc1
  buffer_load_dwordx4 v[108:111], v178, s[8:11], s49 offen offset:2048 sc1
  buffer_load_dwordx4 v[112:115], v178, s[8:11], s49 offen offset:3072 sc1
  buffer_load_dwordx4 v[116:119], v182, s[8:11], s49 offen sc1
yp_108_\sfx\():
  buffer_load_dwordx4 v[120:123], v178, s[8:11], s49 offen offset:0 sc1
  buffer_load_dwordx4 v[124:127], v178, s[8:11], s49 offen offset:1024 sc1
  buffer_load_dwordx4 v[128:131], v178, s[8:11], s49 offen offset:2048 sc1
  buffer_load_dwordx4 v[132:135], v178, s[8:11], s49 offen offset:3072 sc1
  buffer_load_dwordx4 v[136:139], v182, s[8:11], s49 offen sc1
  s_waitcnt vmcnt(9) lgkmcnt(0)
  v_mfma_f32_16x16x32_bf16 v[140:143], v[68:71], v[100:103], 0
  v_max_u32 v190, v100, v102
  v_mfma_f32_16x16x32_bf16 v[144:147], v[72:75], v[100:103], 0
  s_waitcnt vmcnt(8)
  v_mfma_f32_16x16x32_bf16 v[140:143], v[76:79], v[104:107], v[140:143]
  v_max3_u32 v190, v190, v104, v106
  v_mfma_f32_16x16x32_bf16 v[144:147], v[80:83], v[104:107], v[144:147]
  s_waitcnt vmcnt(7)
  v_mfma_f32_16x16x32_bf16 v[140:143], v[84:87], v[108:111], v[140:143]
  v_max3_u32 v190, v190, v108, v110
  v_mfma_f32_16x16x32_bf16 v[144:147], v[88:91], v[108:111], v[144:147]
  s_waitcnt vmcnt(6)
  v_mfma_f32_16x16x32_bf16 v[140:143], v[92:95], v[112:115], v[140:143]
  v_max3_u32 v190, v190, v112, v114
  v_mfma_f32_16x16x32_bf16 v[144:147], v[96:99], v[112:115], v[144:147]
  s_waitcnt vmcnt(5)
  v_mfma_f32_16x16x32_bf16 v[140:143], v[60:63], v[116:119], v[140:143]
  v_max3_u32 v190, v190, v116, v117
  v_mfma_f32_16x16x32_bf16 v[144:147], v[64:67], v[116:119], v[144:147]
  v_max3_u32 v190, v190, v118, v119
  v_cmp_eq_u32 vcc, -1, v190
  s_cbranch_vccz yp_108_okA_\sfx\()
  buffer_load_dwordx4 v[100:103], v178, s[8:11], s49 offen offset:0 sc1
  buffer_load_dwordx4 v[104:107], v178, s[8:11], s49 offen offset:1024 sc1
  buffer_load_dwordx4 v[108:111], v178, s[8:11], s49 offen offset:2048 sc1
  buffer_load_dwordx4 v[112:115], v178, s[8:11], s49 offen offset:3072 sc1
  buffer_load_dwordx4 v[116:119], v182, s[8:11], s49 offen sc1
  s_waitcnt vmcnt(9) lgkmcnt(0)
  v_mfma_f32_16x16x32_bf16 v[148:151], v[68:71], v[120:123], 0
  v_max_u32 v190, v120, v122
  v_mfma_f32_16x16x32_bf16 v[152:155], v[72:75], v[120:123], 0
  s_waitcnt vmcnt(8)
  v_mfma_f32_16x16x32_bf16 v[148:151], v[76:79], v[124:127], v[148:151]
  v_max3_u32 v190, v190, v124, v126
  v_mfma_f32_16x16x32_bf16 v[152:155], v[80:83], v[124:127], v[152:155]
  s_waitcnt vmcnt(7)
  v_mfma_f32_16x16x32_bf16 v[148:151], v[84:87], v[128:131], v[148:151]
  v_max3_u32 v190, v190, v128, v130
  v_mfma_f32_16x16x32_bf16 v[152:155], v[88:91], v[128:131], v[152:155]
  s_waitcnt vmcnt(6)
  v_mfma_f32_16x16x32_bf16 v[148:151], v[92:95], v[132:135], v[148:151]
  v_max3_u32 v190, v190, v132, v134
  v_mfma_f32_16x16x32_bf16 v[152:155], v[96:99], v[132:135], v[152:155]
  s_waitcnt vmcnt(5)
  v_mfma_f32_16x16x32_bf16 v[148:151], v[60:63], v[136:139], v[148:151]
  v_max3_u32 v190, v190, v136, v137
  v_mfma_f32_16x16x32_bf16 v[152:155], v[64:67], v[136:139], v[152:155]
  v_max3_u32 v190, v190, v138, v139
  v_cmp_eq_u32 vcc, -1, v190
  s_cbranch_vccz yp_108_okB_\sfx\()
  s_add_u32 s45, s45, 1
  s_cmp_lt_u32 s45, 400000
  s_cbranch_scc1 yp_108_c_\sfx\()
  s_branch ka\sfx\()_abort
yp_108_c_\sfx\():
  s_branch yp_108_\sfx\()
yp_108_okB_\sfx\():
  s_nop 4
  v_add_f32_dpp v140, v152, v148 row_ror:8 row_mask:0xf bank_mask:0xf
  v_add_f32_dpp v141, v153, v149 row_ror:8 row_mask:0xf bank_mask:0xf
  v_add_f32_dpp v142, v154, v150 row_ror:8 row_mask:0xf bank_mask:0xf
  v_add_f32_dpp v143, v155, v151 row_ror:8 row_mask:0xf bank_mask:0xf
  s_branch yp_108_j_\sfx\()
yp_108_okA_\sfx\():
  s_nop 4
  v_add_f32_dpp v140, v144, v140 row_ror:8 row_mask:0xf bank_mask:0xf
  v_add_f32_dpp v141, v145, v141 row_ror:8 row_mask:0xf bank_mask:0xf
  v_add_f32_dpp v142, v146, v142 row_ror:8 row_mask:0xf bank_mask:0xf
  v_add_f32_dpp v143, v147, v143 row_ror:8 row_mask:0xf bank_mask:0xf
yp_108_j_\sfx\():
  buffer_load_dwordx4 v[4:7], v185, s[8:11], s67 offen sc1
  buffer_load_dwordx4 v[8:11], v185, s[8:11], s68 offen sc1
  buffer_load_dwordx4 v[12:15], v185, s[8:11], s69 offen sc1
  buffer_store_dwordx4 v[140:143], v184, s[8:11], s66 offen sc1
  s_mov_b32 s45, 0
  buffer_load_dwordx4 v[148:151], v185, s[8:11], s67 offen sc1
  buffer_load_dwordx4 v[152:155], v185, s[8:11], s68 offen sc1
  buffer_load_dwordx4 v[156:159], v185, s[8:11], s69 offen sc1
  s_waitcnt vmcnt(4)
  v_max3_u32 v190, v4, v7, v8
  v_max3_u32 v190, v190, v11, v12
  v_max_u32 v190, v190, v15
  v_add_f32 v160, v140, v4
  v_add_f32 v161, v141, v5
  v_add_f32 v162, v142, v6
  v_add_f32 v163, v143, v7
  v_cmp_eq_u32 vcc, -1, v190
  v_add_f32 v164, v8, v12
  v_add_f32 v165, v9, v13
  v_add_f32 v166, v10, v14
  v_add_f32 v167, v11, v15
  s_cbranch_vccz yc_109_ok_\sfx\()
yc_109_\sfx\():
  buffer_load_dwordx4 v[4:7], v185, s[8:11], s67 offen sc1
  buffer_load_dwordx4 v[8:11], v185, s[8:11], s68 offen sc1
  buffer_load_dwordx4 v[12:15], v185, s[8:11], s69 offen sc1
  s_waitcnt vmcnt(3)
  v_max3_u32 v190, v148, v151, v152
  v_max3_u32 v190, v190, v155, v156
  v_max_u32 v190, v190, v159
  v_add_f32 v160, v140, v148
  v_add_f32 v161, v141, v149
  v_add_f32 v162, v142, v150
  v_add_f32 v163, v143, v151
  v_cmp_eq_u32 vcc, -1, v190
  v_add_f32 v164, v152, v156
  v_add_f32 v165, v153, v157
  v_add_f32 v166, v154, v158
  v_add_f32 v167, v155, v159
  s_cbranch_vccz yc_109_ok_\sfx\()
  buffer_load_dwordx4 v[148:151], v185, s[8:11], s67 offen sc1
  buffer_load_dwordx4 v[152:155], v185, s[8:11], s68 offen sc1
  buffer_load_dwordx4 v[156:159], v185, s[8:11], s69 offen sc1
  s_waitcnt vmcnt(3)
  v_max3_u32 v190, v4, v7, v8
  v_max3_u32 v190, v190, v11, v12
  v_max_u32 v190, v190, v15
  v_add_f32 v160, v140, v4
  v_add_f32 v161, v141, v5
  v_add_f32 v162, v142, v6
  v_add_f32 v163, v143, v7
  v_cmp_eq_u32 vcc, -1, v190
  v_add_f32 v164, v8, v12
  v_add_f32 v165, v9, v13
  v_add_f32 v166, v10, v14
  v_add_f32 v167, v11, v15
  s_cbranch_vccz yc_109_ok_\sfx\()
  s_add_u32 s45, s45, 1
  s_cmp_lt_u32 s45, 400000
  s_cbranch_scc1 yc_109_\sfx\()
  s_branch ka\sfx\()_abort
yc_109_ok_\sfx\():
  v_add_f32 v160, v160, v164
  v_add_f32 v161, v161, v165
  v_add_f32 v162, v162, v166
  v_add_f32 v163, v163, v167
  v_cvt_pk_bf16_f32 v168, v160, v161
  v_cvt_pk_bf16_f32 v169, v162, v163
  buffer_store_dword v168, v186, s[8:11], s60 offen \pol
  buffer_store_dword v169, v186, s[8:11], s60 offen offset:128 \pol
  s_add_u32 s97, s97, 10240
  s_mov_b32 s48, s97
  s_add_u32 s60, s60, 10240
  s_add_u32 s49, s49, 5120
  s_add_u32 s28, s51, 1
  s_and_b32 s28, s28, 3
  s_mul_i32 s28, s28, 163840
  s_add_u32 s66, s56, s28
  s_add_u32 s67, s57, s28
  s_add_u32 s68, s58, s28
  s_add_u32 s69, s59, s28
  s_add_u32 s51, s51, 1
  s_branch ka\sfx\()_y_crit
ka\sfx\()_y_crit_end:
  s_waitcnt vmcnt(0) lgkmcnt(0)
  s_branch ka\sfx\()_exit
ka\sfx\()_y_tok:
  s_mul_i32 s61, s20, 1310720
  s_add_u32 s61, s61, 0xe00000
  s_mul_i32 s62, s20, 5242880
  s_lshl_b32 s28, s46, 11
  s_add_u32 s62, s62, s28
  s_add_u32 s62, s62, 0x1a00000
  s_mov_b32 s54, 0
  s_and_b32 s63, s21, 1
  s_lshl_b32 s63, s63, 10
  s_add_u32 s63, s63, 32768
  s_and_b32 s64, s21, 1
  s_mul_i32 s64, s64, 10240
ka\sfx\()_y_tokl:
  s_barrier
  ds_read_b128 v[4:7], v177 offset:0
  ds_read_b128 v[8:11], v177 offset:1024
  ds_read_b128 v[12:15], v177 offset:2048
  ds_read_b128 v[16:19], v177 offset:3072
  ds_read_b128 v[20:23], v177 offset:4096
  ds_read_b128 v[24:27], v177 offset:5120
  ds_read_b128 v[28:31], v177 offset:6144
  ds_read_b128 v[32:35], v177 offset:7168
  ds_read_b128 v[36:39], v177 offset:8192
  ds_read_b128 v[40:43], v177 offset:9216
  s_cmp_gt_u32 s52, s51
  s_cbranch_scc1 ka\sfx\()_y_wp_110_ok
  s_mov_b32 s45, 0
ka\sfx\()_y_wp_110_spin:
  buffer_load_dword v2, v187, s[8:11], 0 offen sc1
  s_add_u32 s45, s45, 1
  s_waitcnt vmcnt(0)
  v_min_u32_dpp v3, v2, v2 quad_perm:[1,0,3,2] row_mask:0xf bank_mask:0xf
  s_nop 1
  v_min_u32_dpp v2, v3, v3 quad_perm:[2,3,0,1] row_mask:0xf bank_mask:0xf
  s_nop 1
  v_min_u32_dpp v3, v2, v2 row_half_mirror row_mask:0xf bank_mask:0xf
  s_nop 1
  v_min_u32_dpp v2, v3, v3 quad_perm:[0,1,2,3] row_mask:0xf bank_mask:0xf
  s_nop 0
  v_readfirstlane_b32 s52, v2
  s_cmp_gt_u32 s52, s51
  s_cbranch_scc1 ka\sfx\()_y_wp_110_ok
  s_cmp_lt_u32 s45, 400000
  s_cbranch_scc1 ka\sfx\()_y_wp_110_spin
  s_branch ka\sfx\()_abort
ka\sfx\()_y_wp_110_ok:
  s_add_u32 s65, s61, s64
  s_waitcnt lgkmcnt(9)
  v_smfmac_f32_16x16x64_bf16 v[44:47], v[4:7], a[0:7], v172
  s_add_u32 m0, s63, 0
  s_add_u32 s28, s50, 0
  buffer_load_dwordx4 v178, s[8:11], s28 offen sc1 lds
  v_smfmac_f32_16x16x64_bf16 v[48:51], v[4:7], a[80:87], v172
  v_smfmac_f32_16x16x64_bf16 v[52:55], v[4:7], a[160:167], v172
  s_add_u32 m0, s63, 2048
  s_add_u32 s28, s50, 40960
  buffer_load_dwordx4 v178, s[8:11], s28 offen sc1 lds
  v_smfmac_f32_16x16x64_bf16 v[56:59], v[4:7], a[240:247], v172
  s_waitcnt lgkmcnt(8)
  v_smfmac_f32_16x16x64_bf16 v[44:47], v[8:11], a[8:15], v172
  s_add_u32 m0, s63, 4096
  s_add_u32 s28, s50, 81920
  buffer_load_dwordx4 v178, s[8:11], s28 offen sc1 lds
  v_smfmac_f32_16x16x64_bf16 v[48:51], v[8:11], a[88:95], v172
  v_smfmac_f32_16x16x64_bf16 v[52:55], v[8:11], a[168:175], v172
  s_add_u32 m0, s63, 6144
  s_add_u32 s28, s50, 122880
  buffer_load_dwordx4 v178, s[8:11], s28 offen sc1 lds
  v_smfmac_f32_16x16x64_bf16 v[56:59], v[8:11], a[248:255], v172
  s_waitcnt lgkmcnt(7)
  v_smfmac_f32_16x16x64_bf16 v[44:47], v[12:15], a[16:23], v172
  s_add_u32 m0, s63, 8192
  s_add_u32 s28, s50, 163840
  buffer_load_dwordx4 v178, s[8:11], s28 offen sc1 lds
  v_smfmac_f32_16x16x64_bf16 v[48:51], v[12:15], a[96:103], v172
  v_smfmac_f32_16x16x64_bf16 v[52:55], v[12:15], a[176:183], v172
  s_add_u32 m0, s63, 10240
  s_add_u32 s28, s50, 204800
  buffer_load_dwordx4 v178, s[8:11], s28 offen sc1 lds
  v_smfmac_f32_16x16x64_bf16 v[56:59], v[12:15], v[192:199], v172
  s_waitcnt lgkmcnt(6)
  v_smfmac_f32_16x16x64_bf16 v[44:47], v[16:19], a[24:31], v172
  s_add_u32 m0, s63, 12288
  s_add_u32 s28, s50, 245760
  buffer_load_dwordx4 v178, s[8:11], s28 offen sc1 lds
  v_smfmac_f32_16x16x64_bf16 v[48:51], v[16:19], a[104:111], v172
  v_smfmac_f32_16x16x64_bf16 v[52:55], v[16:19], a[184:191], v172
  s_add_u32 m0, s63, 14336
  s_add_u32 s28, s50, 286720
  buffer_load_dwordx4 v178, s[8:11], s28 offen sc1 lds
  v_smfmac_f32_16x16x64_bf16 v[56:59], v[16:19], v[200:207], v172
  s_waitcnt lgkmcnt(5)
  v_smfmac_f32_16x16x64_bf16 v[44:47], v[20:23], a[32:39], v172
  s_add_u32 m0, s64, 65536
  s_add_u32 s28, s65, 0
  buffer_load_dwordx4 v178, s[8:11], s28 offen sc1 lds
  v_smfmac_f32_16x16x64_bf16 v[48:51], v[20:23], a[112:119], v172
  v_smfmac_f32_16x16x64_bf16 v[52:55], v[20:23], a[192:199], v172
  s_add_u32 m0, s64, 66560
  s_add_u32 s28, s65, 1024
  buffer_load_dwordx4 v178, s[8:11], s28 offen sc1 lds
  v_smfmac_f32_16x16x64_bf16 v[56:59], v[20:23], v[208:215], v172
  s_waitcnt lgkmcnt(4)
  v_smfmac_f32_16x16x64_bf16 v[44:47], v[24:27], a[40:47], v172
  s_add_u32 m0, s64, 67584
  s_add_u32 s28, s65, 2048
  buffer_load_dwordx4 v178, s[8:11], s28 offen sc1 lds
  v_smfmac_f32_16x16x64_bf16 v[48:51], v[24:27], a[120:127], v172
  v_smfmac_f32_16x16x64_bf16 v[52:55], v[24:27], a[200:207], v172
  s_add_u32 m0, s64, 68608
  s_add_u32 s28, s65, 3072
  buffer_load_dwordx4 v178, s[8:11], s28 offen sc1 lds
  v_smfmac_f32_16x16x64_bf16 v[56:59], v[24:27], v[216:223], v172
  s_waitcnt lgkmcnt(3)
  v_smfmac_f32_16x16x64_bf16 v[44:47], v[28:31], a[48:55], v172
  s_add_u32 m0, s64, 69632
  s_add_u32 s28, s65, 4096
  buffer_load_dwordx4 v178, s[8:11], s28 offen sc1 lds
  v_smfmac_f32_16x16x64_bf16 v[48:51], v[28:31], a[128:135], v172
  v_smfmac_f32_16x16x64_bf16 v[52:55], v[28:31], a[208:215], v172
  s_add_u32 m0, s64, 70656
  s_add_u32 s28, s65, 5120
  buffer_load_dwordx4 v178, s[8:11], s28 offen sc1 lds
  v_smfmac_f32_16x16x64_bf16 v[56:59], v[28:31], v[224:231], v172
  s_waitcnt lgkmcnt(2)
  v_smfmac_f32_16x16x64_bf16 v[44:47], v[32:35], a[56:63], v172
  s_add_u32 m0, s64, 71680
  s_add_u32 s28, s65, 6144
  buffer_load_dwordx4 v178, s[8:11], s28 offen sc1 lds
  v_smfmac_f32_16x16x64_bf16 v[48:51], v[32:35], a[136:143], v172
  v_smfmac_f32_16x16x64_bf16 v[52:55], v[32:35], a[216:223], v172
  s_add_u32 m0, s64, 72704
  s_add_u32 s28, s65, 7168
  buffer_load_dwordx4 v178, s[8:11], s28 offen sc1 lds
  v_smfmac_f32_16x16x64_bf16 v[56:59], v[32:35], v[232:239], v172
  s_waitcnt lgkmcnt(1)
  v_smfmac_f32_16x16x64_bf16 v[44:47], v[36:39], a[64:71], v172
  s_add_u32 m0, s64, 73728
  s_add_u32 s28, s65, 8192
  buffer_load_dwordx4 v178, s[8:11], s28 offen sc1 lds
  v_smfmac_f32_16x16x64_bf16 v[48:51], v[36:39], a[144:151], v172
  v_smfmac_f32_16x16x64_bf16 v[52:55], v[36:39], a[224:231], v172
  s_add_u32 m0, s64, 74752
  s_add_u32 s28, s65, 9216
  buffer_load_dwordx4 v178, s[8:11], s28 offen sc1 lds
  v_smfmac_f32_16x16x64_bf16 v[56:59], v[36:39], v[240:247], v172
  s_waitcnt lgkmcnt(0)
  v_smfmac_f32_16x16x64_bf16 v[44:47], v[40:43], a[72:79], v172
  v_smfmac_f32_16x16x64_bf16 v[48:51], v[40:43], a[152:159], v172
  v_smfmac_f32_16x16x64_bf16 v[52:55], v[40:43], a[232:239], v172
  v_smfmac_f32_16x16x64_bf16 v[56:59], v[40:43], v[248:255], v172
  s_xor_b32 s63, s63, 0x4000
  s_add_u32 s50, s50, 1310720
  s_nop 9
  v_permlane32_swap_b32 v44, v48
  v_permlane32_swap_b32 v45, v49
  v_permlane32_swap_b32 v46, v50
  v_permlane32_swap_b32 v47, v51
  v_permlane32_swap_b32 v52, v56
  v_permlane32_swap_b32 v53, v57
  v_permlane32_swap_b32 v54, v58
  v_permlane32_swap_b32 v55, v59
  v_add_f32 v44, v44, v48
  v_add_f32 v45, v45, v49
  v_add_f32 v46, v46, v50
  v_add_f32 v47, v47, v51
  v_add_f32 v52, v52, v56
  v_add_f32 v53, v53, v57
  v_add_f32 v54, v54, v58
  v_add_f32 v55, v55, v59
  v_cvt_pk_bf16_f32 v64, v44, v45
  v_cvt_pk_bf16_f32 v65, v46, v47
  v_cvt_pk_bf16_f32 v66, v52, v53
  v_cvt_pk_bf16_f32 v67, v54, v55
  ds_write_b128 v179, v[64:67]
  v_mov_b32 v44, 0
  v_mov_b32 v45, 0
  v_mov_b32 v46, 0
  v_mov_b32 v47, 0
  v_mov_b32 v48, 0
  v_mov_b32 v49, 0
  v_mov_b32 v50, 0
  v_mov_b32 v51, 0
  v_mov_b32 v52, 0
  v_mov_b32 v53, 0
  v_mov_b32 v54, 0
  v_mov_b32 v55, 0
  v_mov_b32 v56, 0
  v_mov_b32 v57, 0
  v_mov_b32 v58, 0
  v_mov_b32 v59, 0
  s_waitcnt vmcnt(0) lgkmcnt(0)
  s_barrier
  ds_read_b128 v[60:63], v180
  s_cmp_eq_u32 s51, 0
  s_cbranch_scc1 yt_111_\sfx\()
  ds_read_b128 v[68:71], v181 offset:0
  ds_read_b128 v[72:75], v181 offset:2048
  ds_read_b128 v[76:79], v181 offset:4096
  ds_read_b128 v[80:83], v181 offset:6144
  ds_read_b128 v[84:87], v181 offset:8192
  ds_read_b128 v[88:91], v181 offset:10240
  ds_read_b128 v[92:95], v181 offset:12288
  ds_read_b128 v[96:99], v181 offset:14336
  s_mov_b32 s45, 0
ytp_112_\sfx\():
  s_waitcnt lgkmcnt(0)
  ds_read_b128 v[100:103], v183 offset:0
  ds_read_b128 v[104:107], v183 offset:2048
  ds_read_b128 v[108:111], v183 offset:4096
  ds_read_b128 v[112:115], v183 offset:6144
  ds_read_b128 v[116:119], v183 offset:8192
  ds_read_b128 v[120:123], v183 offset:10240
  ds_read_b128 v[124:127], v183 offset:12288
  ds_read_b128 v[128:131], v183 offset:14336
  ds_read_b128 v[132:135], v183 offset:16384
  ds_read_b128 v[136:139], v183 offset:18432
  s_waitcnt lgkmcnt(0)
  v_max_u32 v190, v100, v102
  v_max3_u32 v190, v190, v104, v106
  v_max3_u32 v190, v190, v108, v110
  v_max3_u32 v190, v190, v112, v114
  v_max3_u32 v190, v190, v116, v118
  v_max3_u32 v190, v190, v120, v122
  v_max3_u32 v190, v190, v124, v126
  v_max3_u32 v190, v190, v128, v130
  v_max3_u32 v190, v190, v132, v134
  v_max3_u32 v190, v190, v136, v138
  v_cmp_eq_u32 vcc, -1, v190
  s_cbranch_vccz ytp_112_ok_\sfx\()
  s_add_u32 s45, s45, 1
  s_cmp_lt_u32 s45, 400000
  s_cbranch_scc0 ka\sfx\()_abort
ytp_112_dma_\sfx\():
  s_mov_b32 m0, 65536
  s_add_u32 s28, s61, 0
  buffer_load_dwordx4 v178, s[8:11], s28 offen sc1 lds
  s_mov_b32 m0, 66560
  s_add_u32 s28, s61, 1024
  buffer_load_dwordx4 v178, s[8:11], s28 offen sc1 lds
  s_mov_b32 m0, 67584
  s_add_u32 s28, s61, 2048
  buffer_load_dwordx4 v178, s[8:11], s28 offen sc1 lds
  s_mov_b32 m0, 68608
  s_add_u32 s28, s61, 3072
  buffer_load_dwordx4 v178, s[8:11], s28 offen sc1 lds
  s_mov_b32 m0, 69632
  s_add_u32 s28, s61, 4096
  buffer_load_dwordx4 v178, s[8:11], s28 offen sc1 lds
  s_mov_b32 m0, 70656
  s_add_u32 s28, s61, 5120
  buffer_load_dwordx4 v178, s[8:11], s28 offen sc1 lds
  s_mov_b32 m0, 71680
  s_add_u32 s28, s61, 6144
  buffer_load_dwordx4 v178, s[8:11], s28 offen sc1 lds
  s_mov_b32 m0, 72704
  s_add_u32 s28, s61, 7168
  buffer_load_dwordx4 v178, s[8:11], s28 offen sc1 lds
  s_mov_b32 m0, 73728
  s_add_u32 s28, s61, 8192
  buffer_load_dwordx4 v178, s[8:11], s28 offen sc1 lds
  s_mov_b32 m0, 74752
  s_add_u32 s28, s61, 9216
  buffer_load_dwordx4 v178, s[8:11], s28 offen sc1 lds
  s_mov_b32 m0, 75776
  s_add_u32 s28, s61, 10240
  buffer_load_dwordx4 v178, s[8:11], s28 offen sc1 lds
  s_mov_b32 m0, 76800
  s_add_u32 s28, s61, 11264
  buffer_load_dwordx4 v178, s[8:11], s28 offen sc1 lds
  s_mov_b32 m0, 77824
  s_add_u32 s28, s61, 12288
  buffer_load_dwordx4 v178, s[8:11], s28 offen sc1 lds
  s_mov_b32 m0, 78848
  s_add_u32 s28, s61, 13312
  buffer_load_dwordx4 v178, s[8:11], s28 offen sc1 lds
  s_mov_b32 m0, 79872
  s_add_u32 s28, s61, 14336
  buffer_load_dwordx4 v178, s[8:11], s28 offen sc1 lds
  s_mov_b32 m0, 80896
  s_add_u32 s28, s61, 15360
  buffer_load_dwordx4 v178, s[8:11], s28 offen sc1 lds
  s_mov_b32 m0, 81920
  s_add_u32 s28, s61, 16384
  buffer_load_dwordx4 v178, s[8:11], s28 offen sc1 lds
  s_mov_b32 m0, 82944
  s_add_u32 s28, s61, 17408
  buffer_load_dwordx4 v178, s[8:11], s28 offen sc1 lds
  s_mov_b32 m0, 83968
  s_add_u32 s28, s61, 18432
  buffer_load_dwordx4 v178, s[8:11], s28 offen sc1 lds
  s_mov_b32 m0, 84992
  s_add_u32 s28, s61, 19456
  buffer_load_dwordx4 v178, s[8:11], s28 offen sc1 lds
  s_waitcnt vmcnt(0)
  s_branch ytp_112_\sfx\()
ytp_112_ok_\sfx\():
  v_mfma_f32_16x16x32_bf16 v[140:143], v[68:71], v[100:103], 0
  v_mfma_f32_16x16x32_bf16 v[140:143], v[72:75], v[104:107], v[140:143]
  v_mfma_f32_16x16x32_bf16 v[140:143], v[76:79], v[108:111], v[140:143]
  v_mfma_f32_16x16x32_bf16 v[140:143], v[80:83], v[112:115], v[140:143]
  v_mfma_f32_16x16x32_bf16 v[140:143], v[84:87], v[116:119], v[140:143]
  v_mfma_f32_16x16x32_bf16 v[140:143], v[88:91], v[120:123], v[140:143]
  v_mfma_f32_16x16x32_bf16 v[140:143], v[92:95], v[124:127], v[140:143]
  v_mfma_f32_16x16x32_bf16 v[140:143], v[96:99], v[128:131], v[140:143]
  v_mfma_f32_16x16x32_bf16 v[140:143], v[148:151], v[132:135], v[140:143]
  v_mfma_f32_16x16x32_bf16 v[140:143], v[152:155], v[136:139], v[140:143]
  s_nop 8
  s_add_u32 s28, s62, 0
  buffer_store_dwordx4 v[140:143], v189, s[8:11], s28 offen
  s_nop 1
  s_mov_b32 s45, 0
ytp_113_\sfx\():
  s_waitcnt lgkmcnt(0)
  ds_read_b128 v[100:103], v183 offset:1024
  ds_read_b128 v[104:107], v183 offset:3072
  ds_read_b128 v[108:111], v183 offset:5120
  ds_read_b128 v[112:115], v183 offset:7168
  ds_read_b128 v[116:119], v183 offset:9216
  ds_read_b128 v[120:123], v183 offset:11264
  ds_read_b128 v[124:127], v183 offset:13312
  ds_read_b128 v[128:131], v183 offset:15360
  ds_read_b128 v[132:135], v183 offset:17408
  ds_read_b128 v[136:139], v183 offset:19456
  s_waitcnt lgkmcnt(0)
  v_max_u32 v190, v100, v102
  v_max3_u32 v190, v190, v104, v106
  v_max3_u32 v190, v190, v108, v110
  v_max3_u32 v190, v190, v112, v114
  v_max3_u32 v190, v190, v116, v118
  v_max3_u32 v190, v190, v120, v122
  v_max3_u32 v190, v190, v124, v126
  v_max3_u32 v190, v190, v128, v130
  v_max3_u32 v190, v190, v132, v134
  v_max3_u32 v190, v190, v136, v138
  v_cmp_eq_u32 vcc, -1, v190
  s_cbranch_vccz ytp_113_ok_\sfx\()
  s_add_u32 s45, s45, 1
  s_cmp_lt_u32 s45, 400000
  s_cbranch_scc0 ka\sfx\()_abort
ytp_113_dma_\sfx\():
  s_mov_b32 m0, 65536
  s_add_u32 s28, s61, 0
  buffer_load_dwordx4 v178, s[8:11], s28 offen sc1 lds
  s_mov_b32 m0, 66560
  s_add_u32 s28, s61, 1024
  buffer_load_dwordx4 v178, s[8:11], s28 offen sc1 lds
  s_mov_b32 m0, 67584
  s_add_u32 s28, s61, 2048
  buffer_load_dwordx4 v178, s[8:11], s28 offen sc1 lds
  s_mov_b32 m0, 68608
  s_add_u32 s28, s61, 3072
  buffer_load_dwordx4 v178, s[8:11], s28 offen sc1 lds
  s_mov_b32 m0, 69632
  s_add_u32 s28, s61, 4096
  buffer_load_dwordx4 v178, s[8:11], s28 offen sc1 lds
  s_mov_b32 m0, 70656
  s_add_u32 s28, s61, 5120
  buffer_load_dwordx4 v178, s[8:11], s28 offen sc1 lds
  s_mov_b32 m0, 71680
  s_add_u32 s28, s61, 6144
  buffer_load_dwordx4 v178, s[8:11], s28 offen sc1 lds
  s_mov_b32 m0, 72704
  s_add_u32 s28, s61, 7168
  buffer_load_dwordx4 v178, s[8:11], s28 offen sc1 lds
  s_mov_b32 m0, 73728
  s_add_u32 s28, s61, 8192
  buffer_load_dwordx4 v178, s[8:11], s28 offen sc1 lds
  s_mov_b32 m0, 74752
  s_add_u32 s28, s61, 9216
  buffer_load_dwordx4 v178, s[8:11], s28 offen sc1 lds
  s_mov_b32 m0, 75776
  s_add_u32 s28, s61, 10240
  buffer_load_dwordx4 v178, s[8:11], s28 offen sc1 lds
  s_mov_b32 m0, 76800
  s_add_u32 s28, s61, 11264
  buffer_load_dwordx4 v178, s[8:11], s28 offen sc1 lds
  s_mov_b32 m0, 77824
  s_add_u32 s28, s61, 12288
  buffer_load_dwordx4 v178, s[8:11], s28 offen sc1 lds
  s_mov_b32 m0, 78848
  s_add_u32 s28, s61, 13312
  buffer_load_dwordx4 v178, s[8:11], s28 offen sc1 lds
  s_mov_b32 m0, 79872
  s_add_u32 s28, s61, 14336
  buffer_load_dwordx4 v178, s[8:11], s28 offen sc1 lds
  s_mov_b32 m0, 80896
  s_add_u32 s28, s61, 15360
  buffer_load_dwordx4 v178, s[8:11], s28 offen sc1 lds
  s_mov_b32 m0, 81920
  s_add_u32 s28, s61, 16384
  buffer_load_dwordx4 v178, s[8:11], s28 offen sc1 lds
  s_mov_b32 m0, 82944
  s_add_u32 s28, s61, 17408
  buffer_load_dwordx4 v178, s[8:11], s28 offen sc1 lds
  s_mov_b32 m0, 83968
  s_add_u32 s28, s61, 18432
  buffer_load_dwordx4 v178, s[8:11], s28 offen sc1 lds
  s_mov_b32 m0, 84992
  s_add_u32 s28, s61, 19456
  buffer_load_dwordx4 v178, s[8:11], s28 offen sc1 lds
  s_waitcnt vmcnt(0)
  s_branch ytp_113_\sfx\()
ytp_113_ok_\sfx\():
  v_mfma_f32_16x16x32_bf16 v[140:143], v[68:71], v[100:103], 0
  v_mfma_f32_16x16x32_bf16 v[140:143], v[72:75], v[104:107], v[140:143]
  v_mfma_f32_16x16x32_bf16 v[140:143], v[76:79], v[108:111], v[140:143]
  v_mfma_f32_16x16x32_bf16 v[140:143], v[80:83], v[112:115], v[140:143]
  v_mfma_f32_16x16x32_bf16 v[140:143], v[84:87], v[116:119], v[140:143]
  v_mfma_f32_16x16x32_bf16 v[140:143], v[88:91], v[120:123], v[140:143]
  v_mfma_f32_16x16x32_bf16 v[140:143], v[92:95], v[124:127], v[140:143]
  v_mfma_f32_16x16x32_bf16 v[140:143], v[96:99], v[128:131], v[140:143]
  v_mfma_f32_16x16x32_bf16 v[140:143], v[148:151], v[132:135], v[140:143]
  v_mfma_f32_16x16x32_bf16 v[140:143], v[152:155], v[136:139], v[140:143]
  s_nop 8
  s_add_u32 s28, s62, 256
  buffer_store_dwordx4 v[140:143], v189, s[8:11], s28 offen
  s_nop 1
  s_add_u32 s61, s61, 20480
  s_add_u32 s62, s62, 81920
  s_add_u32 s54, s54, 1
  v_xor_b32 v181, 0x4000, v181
yt_111_\sfx\():
  s_waitcnt lgkmcnt(0)
  v_mov_b32 v148, v60
  v_mov_b32 v149, v61
  v_mov_b32 v150, v62
  v_mov_b32 v151, v63
  v_mov_b32 v152, v64
  v_mov_b32 v153, v65
  v_mov_b32 v154, v66
  v_mov_b32 v155, v67
  s_add_u32 s97, s97, 10240
  s_mov_b32 s48, s97
  s_add_u32 s51, s51, 1
  s_cmp_lt_u32 s51, 64
  s_cbranch_scc1 ka\sfx\()_y_tokl
  s_barrier
  ds_read_b128 v[68:71], v181 offset:0
  ds_read_b128 v[72:75], v181 offset:2048
  ds_read_b128 v[76:79], v181 offset:4096
  ds_read_b128 v[80:83], v181 offset:6144
  ds_read_b128 v[84:87], v181 offset:8192
  ds_read_b128 v[88:91], v181 offset:10240
  ds_read_b128 v[92:95], v181 offset:12288
  ds_read_b128 v[96:99], v181 offset:14336
  s_mov_b32 s45, 0
  s_branch ytp_114_dma_\sfx\()
ytp_114_\sfx\():
  s_waitcnt lgkmcnt(0)
  ds_read_b128 v[100:103], v183 offset:0
  ds_read_b128 v[104:107], v183 offset:2048
  ds_read_b128 v[108:111], v183 offset:4096
  ds_read_b128 v[112:115], v183 offset:6144
  ds_read_b128 v[116:119], v183 offset:8192
  ds_read_b128 v[120:123], v183 offset:10240
  ds_read_b128 v[124:127], v183 offset:12288
  ds_read_b128 v[128:131], v183 offset:14336
  ds_read_b128 v[132:135], v183 offset:16384
  ds_read_b128 v[136:139], v183 offset:18432
  s_waitcnt lgkmcnt(0)
  v_max_u32 v190, v100, v102
  v_max3_u32 v190, v190, v104, v106
  v_max3_u32 v190, v190, v108, v110
  v_max3_u32 v190, v190, v112, v114
  v_max3_u32 v190, v190, v116, v118
  v_max3_u32 v190, v190, v120, v122
  v_max3_u32 v190, v190, v124, v126
  v_max3_u32 v190, v190, v128, v130
  v_max3_u32 v190, v190, v132, v134
  v_max3_u32 v190, v190, v136, v138
  v_cmp_eq_u32 vcc, -1, v190
  s_cbranch_vccz ytp_114_ok_\sfx\()
  s_add_u32 s45, s45, 1
  s_cmp_lt_u32 s45, 400000
  s_cbranch_scc0 ka\sfx\()_abort
ytp_114_dma_\sfx\():
  s_mov_b32 m0, 65536
  s_add_u32 s28, s61, 0
  buffer_load_dwordx4 v178, s[8:11], s28 offen sc1 lds
  s_mov_b32 m0, 66560
  s_add_u32 s28, s61, 1024
  buffer_load_dwordx4 v178, s[8:11], s28 offen sc1 lds
  s_mov_b32 m0, 67584
  s_add_u32 s28, s61, 2048
  buffer_load_dwordx4 v178, s[8:11], s28 offen sc1 lds
  s_mov_b32 m0, 68608
  s_add_u32 s28, s61, 3072
  buffer_load_dwordx4 v178, s[8:11], s28 offen sc1 lds
  s_mov_b32 m0, 69632
  s_add_u32 s28, s61, 4096
  buffer_load_dwordx4 v178, s[8:11], s28 offen sc1 lds
  s_mov_b32 m0, 70656
  s_add_u32 s28, s61, 5120
  buffer_load_dwordx4 v178, s[8:11], s28 offen sc1 lds
  s_mov_b32 m0, 71680
  s_add_u32 s28, s61, 6144
  buffer_load_dwordx4 v178, s[8:11], s28 offen sc1 lds
  s_mov_b32 m0, 72704
  s_add_u32 s28, s61, 7168
  buffer_load_dwordx4 v178, s[8:11], s28 offen sc1 lds
  s_mov_b32 m0, 73728
  s_add_u32 s28, s61, 8192
  buffer_load_dwordx4 v178, s[8:11], s28 offen sc1 lds
  s_mov_b32 m0, 74752
  s_add_u32 s28, s61, 9216
  buffer_load_dwordx4 v178, s[8:11], s28 offen sc1 lds
  s_mov_b32 m0, 75776
  s_add_u32 s28, s61, 10240
  buffer_load_dwordx4 v178, s[8:11], s28 offen sc1 lds
  s_mov_b32 m0, 76800
  s_add_u32 s28, s61, 11264
  buffer_load_dwordx4 v178, s[8:11], s28 offen sc1 lds
  s_mov_b32 m0, 77824
  s_add_u32 s28, s61, 12288
  buffer_load_dwordx4 v178, s[8:11], s28 offen sc1 lds
  s_mov_b32 m0, 78848
  s_add_u32 s28, s61, 13312
  buffer_load_dwordx4 v178, s[8:11], s28 offen sc1 lds
  s_mov_b32 m0, 79872
  s_add_u32 s28, s61, 14336
  buffer_load_dwordx4 v178, s[8:11], s28 offen sc1 lds
  s_mov_b32 m0, 80896
  s_add_u32 s28, s61, 15360
  buffer_load_dwordx4 v178, s[8:11], s28 offen sc1 lds
  s_mov_b32 m0, 81920
  s_add_u32 s28, s61, 16384
  buffer_load_dwordx4 v178, s[8:11], s28 offen sc1 lds
  s_mov_b32 m0, 82944
  s_add_u32 s28, s61, 17408
  buffer_load_dwordx4 v178, s[8:11], s28 offen sc1 lds
  s_mov_b32 m0, 83968
  s_add_u32 s28, s61, 18432
  buffer_load_dwordx4 v178, s[8:11], s28 offen sc1 lds
  s_mov_b32 m0, 84992
  s_add_u32 s28, s61, 19456
  buffer_load_dwordx4 v178, s[8:11], s28 offen sc1 lds
  s_waitcnt vmcnt(0)
  s_branch ytp_114_\sfx\()
ytp_114_ok_\sfx\():
  v_mfma_f32_16x16x32_bf16 v[140:143], v[68:71], v[100:103], 0
  v_mfma_f32_16x16x32_bf16 v[140:143], v[72:75], v[104:107], v[140:143]
  v_mfma_f32_16x16x32_bf16 v[140:143], v[76:79], v[108:111], v[140:143]
  v_mfma_f32_16x16x32_bf16 v[140:143], v[80:83], v[112:115], v[140:143]
  v_mfma_f32_16x16x32_bf16 v[140:143], v[84:87], v[116:119], v[140:143]
  v_mfma_f32_16x16x32_bf16 v[140:143], v[88:91], v[120:123], v[140:143]
  v_mfma_f32_16x16x32_bf16 v[140:143], v[92:95], v[124:127], v[140:143]
  v_mfma_f32_16x16x32_bf16 v[140:143], v[96:99], v[128:131], v[140:143]
  v_mfma_f32_16x16x32_bf16 v[140:143], v[148:151], v[132:135], v[140:143]
  v_mfma_f32_16x16x32_bf16 v[140:143], v[152:155], v[136:139], v[140:143]
  s_nop 8
  s_add_u32 s28, s62, 0
  buffer_store_dwordx4 v[140:143], v189, s[8:11], s28 offen
  s_nop 1
  s_mov_b32 s45, 0
ytp_115_\sfx\():
  s_waitcnt lgkmcnt(0)
  ds_read_b128 v[100:103], v183 offset:1024
  ds_read_b128 v[104:107], v183 offset:3072
  ds_read_b128 v[108:111], v183 offset:5120
  ds_read_b128 v[112:115], v183 offset:7168
  ds_read_b128 v[116:119], v183 offset:9216
  ds_read_b128 v[120:123], v183 offset:11264
  ds_read_b128 v[124:127], v183 offset:13312
  ds_read_b128 v[128:131], v183 offset:15360
  ds_read_b128 v[132:135], v183 offset:17408
  ds_read_b128 v[136:139], v183 offset:19456
  s_waitcnt lgkmcnt(0)
  v_max_u32 v190, v100, v102
  v_max3_u32 v190, v190, v104, v106
  v_max3_u32 v190, v190, v108, v110
  v_max3_u32 v190, v190, v112, v114
  v_max3_u32 v190, v190, v116, v118
  v_max3_u32 v190, v190, v120, v122
  v_max3_u32 v190, v190, v124, v126
  v_max3_u32 v190, v190, v128, v130
  v_max3_u32 v190, v190, v132, v134
  v_max3_u32 v190, v190, v136, v138
  v_cmp_eq_u32 vcc, -1, v190
  s_cbranch_vccz ytp_115_ok_\sfx\()
  s_add_u32 s45, s45, 1
  s_cmp_lt_u32 s45, 400000
  s_cbranch_scc0 ka\sfx\()_abort
ytp_115_dma_\sfx\():
  s_mov_b32 m0, 65536
  s_add_u32 s28, s61, 0
  buffer_load_dwordx4 v178, s[8:11], s28 offen sc1 lds
  s_mov_b32 m0, 66560
  s_add_u32 s28, s61, 1024
  buffer_load_dwordx4 v178, s[8:11], s28 offen sc1 lds
  s_mov_b32 m0, 67584
  s_add_u32 s28, s61, 2048
  buffer_load_dwordx4 v178, s[8:11], s28 offen sc1 lds
  s_mov_b32 m0, 68608
  s_add_u32 s28, s61, 3072
  buffer_load_dwordx4 v178, s[8:11], s28 offen sc1 lds
  s_mov_b32 m0, 69632
  s_add_u32 s28, s61, 4096
  buffer_load_dwordx4 v178, s[8:11], s28 offen sc1 lds
  s_mov_b32 m0, 70656
  s_add_u32 s28, s61, 5120
  buffer_load_dwordx4 v178, s[8:11], s28 offen sc1 lds
  s_mov_b32 m0, 71680
  s_add_u32 s28, s61, 6144
  buffer_load_dwordx4 v178, s[8:11], s28 offen sc1 lds
  s_mov_b32 m0, 72704
  s_add_u32 s28, s61, 7168
  buffer_load_dwordx4 v178, s[8:11], s28 offen sc1 lds
  s_mov_b32 m0, 73728
  s_add_u32 s28, s61, 8192
  buffer_load_dwordx4 v178, s[8:11], s28 offen sc1 lds
  s_mov_b32 m0, 74752
  s_add_u32 s28, s61, 9216
  buffer_load_dwordx4 v178, s[8:11], s28 offen sc1 lds
  s_mov_b32 m0, 75776
  s_add_u32 s28, s61, 10240
  buffer_load_dwordx4 v178, s[8:11], s28 offen sc1 lds
  s_mov_b32 m0, 76800
  s_add_u32 s28, s61, 11264
  buffer_load_dwordx4 v178, s[8:11], s28 offen sc1 lds
  s_mov_b32 m0, 77824
  s_add_u32 s28, s61, 12288
  buffer_load_dwordx4 v178, s[8:11], s28 offen sc1 lds
  s_mov_b32 m0, 78848
  s_add_u32 s28, s61, 13312
  buffer_load_dwordx4 v178, s[8:11], s28 offen sc1 lds
  s_mov_b32 m0, 79872
  s_add_u32 s28, s61, 14336
  buffer_load_dwordx4 v178, s[8:11], s28 offen sc1 lds
  s_mov_b32 m0, 80896
  s_add_u32 s28, s61, 15360
  buffer_load_dwordx4 v178, s[8:11], s28 offen sc1 lds
  s_mov_b32 m0, 81920
  s_add_u32 s28, s61, 16384
  buffer_load_dwordx4 v178, s[8:11], s28 offen sc1 lds
  s_mov_b32 m0, 82944
  s_add_u32 s28, s61, 17408
  buffer_load_dwordx4 v178, s[8:11], s28 offen sc1 lds
  s_mov_b32 m0, 83968
  s_add_u32 s28, s61, 18432
  buffer_load_dwordx4 v178, s[8:11], s28 offen sc1 lds
  s_mov_b32 m0, 84992
  s_add_u32 s28, s61, 19456
  buffer_load_dwordx4 v178, s[8:11], s28 offen sc1 lds
  s_waitcnt vmcnt(0)
  s_branch ytp_115_\sfx\()
ytp_115_ok_\sfx\():
  v_mfma_f32_16x16x32_bf16 v[140:143], v[68:71], v[100:103], 0
  v_mfma_f32_16x16x32_bf16 v[140:143], v[72:75], v[104:107], v[140:143]
  v_mfma_f32_16x16x32_bf16 v[140:143], v[76:79], v[108:111], v[140:143]
  v_mfma_f32_16x16x32_bf16 v[140:143], v[80:83], v[112:115], v[140:143]
  v_mfma_f32_16x16x32_bf16 v[140:143], v[84:87], v[116:119], v[140:143]
  v_mfma_f32_16x16x32_bf16 v[140:143], v[88:91], v[120:123], v[140:143]
  v_mfma_f32_16x16x32_bf16 v[140:143], v[92:95], v[124:127], v[140:143]
  v_mfma_f32_16x16x32_bf16 v[140:143], v[96:99], v[128:131], v[140:143]
  v_mfma_f32_16x16x32_bf16 v[140:143], v[148:151], v[132:135], v[140:143]
  v_mfma_f32_16x16x32_bf16 v[140:143], v[152:155], v[136:139], v[140:143]
  s_nop 8
  s_add_u32 s28, s62, 256
  buffer_store_dwordx4 v[140:143], v189, s[8:11], s28 offen
  s_nop 1
  s_add_u32 s61, s61, 20480
  s_add_u32 s62, s62, 81920
  s_add_u32 s54, s54, 1
  v_xor_b32 v181, 0x4000, v181
  s_waitcnt vmcnt(0)
  s_branch ka\sfx\()_exit
ka\sfx\()_abort:
  s_branch ka_abort
ka\sfx\()_exit:
  s_branch ka_exit
.endm
CHAINROLES f,
CHAINROLES s, sc1
ka_abort:
  s_load_dwordx2 s[6:7], s[0:1], 88
  v_mov_b32 v2, 80
  v_mov_b32 v3, 1
  s_waitcnt lgkmcnt(0)
  s_mov_b64 exec, 1
  global_atomic_add v2, v3, s[6:7]
  s_waitcnt vmcnt(0)
ka_exit:
  s_endpgm

.section .rodata,"a"
.p2align 6
.amdhsa_kernel ka2_kernel
  .amdhsa_next_free_vgpr 512
  .amdhsa_next_free_sgpr 102
  .amdhsa_accum_offset 256
  .amdhsa_group_segment_fixed_size 0
  .amdhsa_kernarg_size 104
  .amdhsa_user_sgpr_count 2
  .amdhsa_user_sgpr_kernarg_segment_ptr 1
  .amdhsa_system_sgpr_workgroup_id_x 1
.end_amdhsa_kernel
.text
.globl kb2_kernel
.p2align 8
.type kb2_kernel,@function
kb2_kernel:
  s_cmp_ge_u32 s2, 256
  s_cbranch_scc1 kb2_exit
  s_load_dwordx2 s[36:37], s[0:1], 0
  s_load_dwordx2 s[38:39], s[0:1], 80
  s_load_dwordx2 s[4:5], s[0:1], 96
  v_lshrrev_b32 v1, 6, v0
  s_nop 0
  v_readfirstlane_b32 s21, v1
  v_and_b32 v1, 63, v0
  v_lshlrev_b32 v2, 4, v1
  s_waitcnt lgkmcnt(0)
  s_mov_b32 s8, s4
  s_and_b32 s9, s5, 0xffff
  s_mov_b32 s10, 0x10000000
  s_mov_b32 s11, 0x20000
  s_mov_b32 s12, s36
  s_and_b32 s13, s37, 0xffff
  s_mov_b32 s14, 0x280000
  s_mov_b32 s15, 0x20000
  s_mov_b32 s16, s38
  s_and_b32 s17, s39, 0xffff
  s_mov_b32 s18, 0x280000
  s_mov_b32 s19, 0x20000
  s_and_b32 s22, s2, 7
  s_lshl_b32 s22, s22, 2
  s_bfe_u32 s23, s2, 0x20003
  s_add_u32 s22, s22, s23
  s_lshr_b32 s23, s2, 5
  s_lshl_b32 s46, s23, 7
  s_add_u32 s46, s46, 0xa000
  s_add_u32 s48, s46, 0x1400
  s_lshl_b32 s47, s22, 7
  s_add_u32 s47, s47, 0xa400
  s_lshr_b32 s26, s2, 2
  s_and_b32 s27, s2, 3
  s_lshl_b32 s27, s27, 3
  v_and_b32 v5, 7, v1
  v_bfe_u32 v6, v1, 3, 1
  v_lshrrev_b32 v7, 4, v1
  v_lshlrev_b32 v8, 5, v6
  v_add_u32 v8, v8, v5
  v_add_u32 v8, s27, v8
  v_lshlrev_b32 v8, 4, v8
  v_lshlrev_b32 v9, 11, v7
  v_add_u32 v9, v9, v8
  v_lshlrev_b32 v10, 10, v7
  v_add_u32 v10, v10, v8
  s_mul_i32 s28, s26, 81920
  s_lshl_b32 s29, s21, 13
  s_add_u32 s28, s28, s29
  s_cmp_lt_u32 s21, 2
  s_cselect_b32 s49, 3, 2
  v_mov_b32 v32, 0
  v_mov_b32 v33, 0
  v_mov_b32 v34, 0
  v_mov_b32 v35, 0
  v_mov_b32 v36, 0
  v_mov_b32 v37, 0
  v_mov_b32 v38, 0
  v_mov_b32 v39, 0
  v_mov_b32 v64, 0
  v_mov_b32 v65, 0
  v_mov_b32 v66, 0
  v_mov_b32 v67, 0
  v_mov_b32 v68, 0
  v_mov_b32 v69, 0
  v_mov_b32 v70, 0
  v_mov_b32 v71, 0
  v_mov_b32 v88, 0
  v_mov_b32 v89, 0
  v_mov_b32 v90, 0
  v_mov_b32 v91, 0
  v_mov_b32 v92, 0
  v_mov_b32 v93, 0
  v_mov_b32 v94, 0
  v_mov_b32 v95, 0
  v_mov_b32 v112, 0
  v_mov_b32 v113, 0
  v_mov_b32 v114, 0
  v_mov_b32 v115, 0
  v_mov_b32 v116, 0
  v_mov_b32 v117, 0
  v_mov_b32 v118, 0
  v_mov_b32 v119, 0
  v_mov_b32 v136, 0
  v_mov_b32 v137, 0
  v_mov_b32 v138, 0
  v_mov_b32 v139, 0
  v_mov_b32 v140, 0
  v_mov_b32 v141, 0
  v_mov_b32 v142, 0
  v_mov_b32 v143, 0
  s_add_u32 s30, s28, 27262976
  buffer_load_dwordx4 v[48:51], v9, s[8:11], s30 offen
  s_add_u32 s30, s28, 27264000
  buffer_load_dwordx4 v[52:55], v9, s[8:11], s30 offen
  s_add_u32 s30, s28, 32505856
  buffer_load_dwordx4 v[72:75], v9, s[8:11], s30 offen
  s_add_u32 s30, s28, 32506880
  buffer_load_dwordx4 v[76:79], v9, s[8:11], s30 offen
  s_add_u32 s30, s28, 37748736
  buffer_load_dwordx4 v[96:99], v9, s[8:11], s30 offen
  s_add_u32 s30, s28, 37749760
  buffer_load_dwordx4 v[100:103], v9, s[8:11], s30 offen
  s_add_u32 s30, s28, 42991616
  buffer_load_dwordx4 v[120:123], v9, s[8:11], s30 offen
  s_add_u32 s30, s28, 42992640
  buffer_load_dwordx4 v[124:127], v9, s[8:11], s30 offen
  s_add_u32 s30, s28, 20971520
  buffer_load_dwordx4 v[16:19], v9, s[8:11], s30 offen
  s_add_u32 s30, s28, 20972544
  buffer_load_dwordx4 v[20:23], v9, s[8:11], s30 offen
  s_add_u32 s30, s28, 27295744
  buffer_load_dwordx4 v[56:59], v9, s[8:11], s30 offen
  s_add_u32 s30, s28, 27296768
  buffer_load_dwordx4 v[60:63], v9, s[8:11], s30 offen
  s_add_u32 s30, s28, 32538624
  buffer_load_dwordx4 v[80:83], v9, s[8:11], s30 offen
  s_add_u32 s30, s28, 32539648
  buffer_load_dwordx4 v[84:87], v9, s[8:11], s30 offen
  s_add_u32 s30, s28, 37781504
  buffer_load_dwordx4 v[104:107], v9, s[8:11], s30 offen
  s_add_u32 s30, s28, 37782528
  buffer_load_dwordx4 v[108:111], v9, s[8:11], s30 offen
  s_add_u32 s30, s28, 43024384
  buffer_load_dwordx4 v[128:131], v9, s[8:11], s30 offen
  s_add_u32 s30, s28, 43025408
  buffer_load_dwordx4 v[132:135], v9, s[8:11], s30 offen
  s_add_u32 s30, s28, 21004288
  buffer_load_dwordx4 v[24:27], v9, s[8:11], s30 offen
  s_add_u32 s30, s28, 21005312
  buffer_load_dwordx4 v[28:31], v9, s[8:11], s30 offen
  s_cmp_lt_u32 s21, 2
  s_cbranch_scc0 g3_116
  s_add_u32 s30, s28, 27328512
  buffer_load_dwordx4 v[64:67], v9, s[8:11], s30 offen
  s_add_u32 s30, s28, 27329536
  buffer_load_dwordx4 v[68:71], v9, s[8:11], s30 offen
  s_add_u32 s30, s28, 32571392
  buffer_load_dwordx4 v[88:91], v9, s[8:11], s30 offen
  s_add_u32 s30, s28, 32572416
  buffer_load_dwordx4 v[92:95], v9, s[8:11], s30 offen
  s_add_u32 s30, s28, 37814272
  buffer_load_dwordx4 v[112:115], v9, s[8:11], s30 offen
  s_add_u32 s30, s28, 37815296
  buffer_load_dwordx4 v[116:119], v9, s[8:11], s30 offen
  s_add_u32 s30, s28, 43057152
  buffer_load_dwordx4 v[136:139], v9, s[8:11], s30 offen
  s_add_u32 s30, s28, 43058176
  buffer_load_dwordx4 v[140:143], v9, s[8:11], s30 offen
  s_add_u32 s30, s28, 21037056
  buffer_load_dwordx4 v[32:35], v9, s[8:11], s30 offen
  s_add_u32 s30, s28, 21038080
  buffer_load_dwordx4 v[36:39], v9, s[8:11], s30 offen
g3_116:
  s_mul_i32 s30, s22, 122880
  s_mul_i32 s31, s21, 30720
  s_add_u32 s30, s30, s31
  s_add_u32 s30, s30, 0xe100000
  s_add_u32 m0, s31, 0
  s_add_u32 s29, s30, 0
  buffer_load_dwordx4 v2, s[8:11], s29 offen lds
  s_add_u32 m0, s31, 1024
  s_add_u32 s29, s30, 1024
  buffer_load_dwordx4 v2, s[8:11], s29 offen lds
  s_add_u32 m0, s31, 2048
  s_add_u32 s29, s30, 2048
  buffer_load_dwordx4 v2, s[8:11], s29 offen lds
  s_add_u32 m0, s31, 3072
  s_add_u32 s29, s30, 3072
  buffer_load_dwordx4 v2, s[8:11], s29 offen lds
  s_add_u32 m0, s31, 4096
  s_add_u32 s29, s30, 4096
  buffer_load_dwordx4 v2, s[8:11], s29 offen lds
  s_add_u32 m0, s31, 5120
  s_add_u32 s29, s30, 5120
  buffer_load_dwordx4 v2, s[8:11], s29 offen lds
  s_add_u32 m0, s31, 6144
  s_add_u32 s29, s30, 6144
  buffer_load_dwordx4 v2, s[8:11], s29 offen lds
  s_add_u32 m0, s31, 7168
  s_add_u32 s29, s30, 7168
  buffer_load_dwordx4 v2, s[8:11], s29 offen lds
  s_add_u32 m0, s31, 8192
  s_add_u32 s29, s30, 8192
  buffer_load_dwordx4 v2, s[8:11], s29 offen lds
  s_add_u32 m0, s31, 9216
  s_add_u32 s29, s30, 9216
  buffer_load_dwordx4 v2, s[8:11], s29 offen lds
  s_add_u32 m0, s31, 10240
  s_add_u32 s29, s30, 10240
  buffer_load_dwordx4 v2, s[8:11], s29 offen lds
  s_add_u32 m0, s31, 11264
  s_add_u32 s29, s30, 11264
  buffer_load_dwordx4 v2, s[8:11], s29 offen lds
  s_add_u32 m0, s31, 12288
  s_add_u32 s29, s30, 12288
  buffer_load_dwordx4 v2, s[8:11], s29 offen lds
  s_add_u32 m0, s31, 13312
  s_add_u32 s29, s30, 13312
  buffer_load_dwordx4 v2, s[8:11], s29 offen lds
  s_add_u32 m0, s31, 14336
  s_add_u32 s29, s30, 14336
  buffer_load_dwordx4 v2, s[8:11], s29 offen lds
  s_add_u32 m0, s31, 15360
  s_add_u32 s29, s30, 15360
  buffer_load_dwordx4 v2, s[8:11], s29 offen lds
  s_add_u32 m0, s31, 16384
  s_add_u32 s29, s30, 16384
  buffer_load_dwordx4 v2, s[8:11], s29 offen lds
  s_add_u32 m0, s31, 17408
  s_add_u32 s29, s30, 17408
  buffer_load_dwordx4 v2, s[8:11], s29 offen lds
  s_add_u32 m0, s31, 18432
  s_add_u32 s29, s30, 18432
  buffer_load_dwordx4 v2, s[8:11], s29 offen lds
  s_add_u32 m0, s31, 19456
  s_add_u32 s29, s30, 19456
  buffer_load_dwordx4 v2, s[8:11], s29 offen lds
  s_add_u32 m0, s31, 20480
  s_add_u32 s29, s30, 20480
  buffer_load_dwordx4 v2, s[8:11], s29 offen lds
  s_add_u32 m0, s31, 21504
  s_add_u32 s29, s30, 21504
  buffer_load_dwordx4 v2, s[8:11], s29 offen lds
  s_add_u32 m0, s31, 22528
  s_add_u32 s29, s30, 22528
  buffer_load_dwordx4 v2, s[8:11], s29 offen lds
  s_add_u32 m0, s31, 23552
  s_add_u32 s29, s30, 23552
  buffer_load_dwordx4 v2, s[8:11], s29 offen lds
  s_add_u32 m0, s31, 24576
  s_add_u32 s29, s30, 24576
  buffer_load_dwordx4 v2, s[8:11], s29 offen lds
  s_add_u32 m0, s31, 25600
  s_add_u32 s29, s30, 25600
  buffer_load_dwordx4 v2, s[8:11], s29 offen lds
  s_add_u32 m0, s31, 26624
  s_add_u32 s29, s30, 26624
  buffer_load_dwordx4 v2, s[8:11], s29 offen lds
  s_add_u32 m0, s31, 27648
  s_add_u32 s29, s30, 27648
  buffer_load_dwordx4 v2, s[8:11], s29 offen lds
  s_add_u32 m0, s31, 28672
  s_add_u32 s29, s30, 28672
  buffer_load_dwordx4 v2, s[8:11], s29 offen lds
  s_add_u32 m0, s31, 29696
  s_add_u32 s29, s30, 29696
  buffer_load_dwordx4 v2, s[8:11], s29 offen lds
  s_waitcnt vmcnt(30)
  v_add_f32 v48, v48, v72
  v_add_f32 v96, v96, v120
  v_add_f32 v49, v49, v73
  v_add_f32 v97, v97, v121
  v_add_f32 v50, v50, v74
  v_add_f32 v98, v98, v122
  v_add_f32 v51, v51, v75
  v_add_f32 v99, v99, v123
  v_add_f32 v52, v52, v76
  v_add_f32 v100, v100, v124
  v_add_f32 v53, v53, v77
  v_add_f32 v101, v101, v125
  v_add_f32 v54, v54, v78
  v_add_f32 v102, v102, v126
  v_add_f32 v55, v55, v79
  v_add_f32 v103, v103, v127
  v_add_f32 v56, v56, v80
  v_add_f32 v104, v104, v128
  v_add_f32 v57, v57, v81
  v_add_f32 v105, v105, v129
  v_add_f32 v58, v58, v82
  v_add_f32 v106, v106, v130
  v_add_f32 v59, v59, v83
  v_add_f32 v107, v107, v131
  v_add_f32 v60, v60, v84
  v_add_f32 v108, v108, v132
  v_add_f32 v61, v61, v85
  v_add_f32 v109, v109, v133
  v_add_f32 v62, v62, v86
  v_add_f32 v110, v110, v134
  v_add_f32 v63, v63, v87
  v_add_f32 v111, v111, v135
  v_add_f32 v64, v64, v88
  v_add_f32 v112, v112, v136
  v_add_f32 v65, v65, v89
  v_add_f32 v113, v113, v137
  v_add_f32 v66, v66, v90
  v_add_f32 v114, v114, v138
  v_add_f32 v67, v67, v91
  v_add_f32 v115, v115, v139
  v_add_f32 v68, v68, v92
  v_add_f32 v116, v116, v140
  v_add_f32 v69, v69, v93
  v_add_f32 v117, v117, v141
  v_add_f32 v70, v70, v94
  v_add_f32 v118, v118, v142
  v_add_f32 v71, v71, v95
  v_add_f32 v119, v119, v143
  v_add_f32 v48, v48, v96
  v_add_f32 v16, v16, v48
  v_add_f32 v49, v49, v97
  v_add_f32 v17, v17, v49
  v_add_f32 v50, v50, v98
  v_add_f32 v18, v18, v50
  v_add_f32 v51, v51, v99
  v_add_f32 v19, v19, v51
  v_add_f32 v52, v52, v100
  v_add_f32 v20, v20, v52
  v_add_f32 v53, v53, v101
  v_add_f32 v21, v21, v53
  v_add_f32 v54, v54, v102
  v_add_f32 v22, v22, v54
  v_add_f32 v55, v55, v103
  v_add_f32 v23, v23, v55
  v_add_f32 v56, v56, v104
  v_add_f32 v24, v24, v56
  v_add_f32 v57, v57, v105
  v_add_f32 v25, v25, v57
  v_add_f32 v58, v58, v106
  v_add_f32 v26, v26, v58
  v_add_f32 v59, v59, v107
  v_add_f32 v27, v27, v59
  v_add_f32 v60, v60, v108
  v_add_f32 v28, v28, v60
  v_add_f32 v61, v61, v109
  v_add_f32 v29, v29, v61
  v_add_f32 v62, v62, v110
  v_add_f32 v30, v30, v62
  v_add_f32 v63, v63, v111
  v_add_f32 v31, v31, v63
  v_add_f32 v64, v64, v112
  v_add_f32 v32, v32, v64
  v_add_f32 v65, v65, v113
  v_add_f32 v33, v33, v65
  v_add_f32 v66, v66, v114
  v_add_f32 v34, v34, v66
  v_add_f32 v67, v67, v115
  v_add_f32 v35, v35, v67
  v_add_f32 v68, v68, v116
  v_add_f32 v36, v36, v68
  v_add_f32 v69, v69, v117
  v_add_f32 v37, v37, v69
  v_add_f32 v70, v70, v118
  v_add_f32 v38, v38, v70
  v_add_f32 v71, v71, v119
  v_add_f32 v39, v39, v71
  s_add_u32 s30, s28, 20971520
  buffer_store_dwordx4 v[16:19], v9, s[8:11], s30 offen sc1
  s_add_u32 s30, s28, 20972544
  buffer_store_dwordx4 v[20:23], v9, s[8:11], s30 offen sc1
  s_add_u32 s30, s28, 21004288
  buffer_store_dwordx4 v[24:27], v9, s[8:11], s30 offen sc1
  s_add_u32 s30, s28, 21005312
  buffer_store_dwordx4 v[28:31], v9, s[8:11], s30 offen sc1
  s_cmp_lt_u32 s21, 2
  s_cbranch_scc0 g3_117
  s_add_u32 s30, s28, 21037056
  buffer_store_dwordx4 v[32:35], v9, s[8:11], s30 offen sc1
  s_add_u32 s30, s28, 21038080
  buffer_store_dwordx4 v[36:39], v9, s[8:11], s30 offen sc1
g3_117:
  v_add_f32 v12, v16, v17
  v_add_f32 v12, v12, v18
  v_add_f32 v12, v12, v19
  v_add_f32 v12, v12, v20
  v_add_f32 v12, v12, v21
  v_add_f32 v12, v12, v22
  v_add_f32 v12, v12, v23
  v_add_f32 v12, v12, v24
  v_add_f32 v12, v12, v25
  v_add_f32 v12, v12, v26
  v_add_f32 v12, v12, v27
  v_add_f32 v12, v12, v28
  v_add_f32 v12, v12, v29
  v_add_f32 v12, v12, v30
  v_add_f32 v12, v12, v31
  v_add_f32 v12, v12, v32
  v_add_f32 v12, v12, v33
  v_add_f32 v12, v12, v34
  v_add_f32 v12, v12, v35
  v_add_f32 v12, v12, v36
  v_add_f32 v12, v12, v37
  v_add_f32 v12, v12, v38
  v_add_f32 v12, v12, v39
  s_nop 1
  v_add_f32_dpp v12, v12, v12 row_ror:8 row_mask:0xf bank_mask:0xf
  v_mov_b32 v13, v12
  s_nop 1
  v_permlane16_swap_b32 v12, v13
  v_add_f32 v12, v12, v13
  v_mov_b32 v13, v12
  s_nop 1
  v_permlane32_swap_b32 v12, v13
  v_add_f32 v12, v12, v13
  v_lshlrev_b32 v14, 2, v5
  v_add_u32 v14, 131072, v14
  s_lshl_b32 s30, s21, 5
  v_add_u32 v15, s30, v14
  ds_write_b32 v15, v12
  s_waitcnt lgkmcnt(0)
  s_barrier
  ds_read_b32 v48, v14
  ds_read_b32 v49, v14 offset:32
  ds_read_b32 v50, v14 offset:64
  ds_read_b32 v51, v14 offset:96
  s_waitcnt lgkmcnt(0)
  v_add_f32 v48, v48, v49
  v_add_f32 v50, v50, v51
  v_add_f32 v48, v48, v50
  v_mul_f32 v48, 0x3acccccd, v48
  v_sub_f32 v56, v16, v48
  v_sub_f32 v57, v17, v48
  v_sub_f32 v58, v18, v48
  v_sub_f32 v59, v19, v48
  v_sub_f32 v60, v20, v48
  v_sub_f32 v61, v21, v48
  v_sub_f32 v62, v22, v48
  v_sub_f32 v63, v23, v48
  v_sub_f32 v64, v24, v48
  v_sub_f32 v65, v25, v48
  v_sub_f32 v66, v26, v48
  v_sub_f32 v67, v27, v48
  v_sub_f32 v68, v28, v48
  v_sub_f32 v69, v29, v48
  v_sub_f32 v70, v30, v48
  v_sub_f32 v71, v31, v48
  v_sub_f32 v72, v32, v48
  v_sub_f32 v73, v33, v48
  v_sub_f32 v74, v34, v48
  v_sub_f32 v75, v35, v48
  v_sub_f32 v76, v36, v48
  v_sub_f32 v77, v37, v48
  v_sub_f32 v78, v38, v48
  v_sub_f32 v79, v39, v48
  s_cmp_lt_u32 s21, 2
  s_cbranch_scc1 g3z_118
  v_mov_b32 v72, 0
  v_mov_b32 v73, 0
  v_mov_b32 v74, 0
  v_mov_b32 v75, 0
  v_mov_b32 v76, 0
  v_mov_b32 v77, 0
  v_mov_b32 v78, 0
  v_mov_b32 v79, 0
g3z_118:
  v_mul_f32 v12, v56, v56
  v_fmac_f32 v12, v57, v57
  v_fmac_f32 v12, v58, v58
  v_fmac_f32 v12, v59, v59
  v_fmac_f32 v12, v60, v60
  v_fmac_f32 v12, v61, v61
  v_fmac_f32 v12, v62, v62
  v_fmac_f32 v12, v63, v63
  v_fmac_f32 v12, v64, v64
  v_fmac_f32 v12, v65, v65
  v_fmac_f32 v12, v66, v66
  v_fmac_f32 v12, v67, v67
  v_fmac_f32 v12, v68, v68
  v_fmac_f32 v12, v69, v69
  v_fmac_f32 v12, v70, v70
  v_fmac_f32 v12, v71, v71
  v_fmac_f32 v12, v72, v72
  v_fmac_f32 v12, v73, v73
  v_fmac_f32 v12, v74, v74
  v_fmac_f32 v12, v75, v75
  v_fmac_f32 v12, v76, v76
  v_fmac_f32 v12, v77, v77
  v_fmac_f32 v12, v78, v78
  v_fmac_f32 v12, v79, v79
  s_nop 1
  v_add_f32_dpp v12, v12, v12 row_ror:8 row_mask:0xf bank_mask:0xf
  v_mov_b32 v13, v12
  s_nop 1
  v_permlane16_swap_b32 v12, v13
  v_add_f32 v12, v12, v13
  v_mov_b32 v13, v12
  s_nop 1
  v_permlane32_swap_b32 v12, v13
  v_add_f32 v12, v12, v13
  v_lshlrev_b32 v14, 2, v5
  v_add_u32 v14, 131328, v14
  s_lshl_b32 s30, s21, 5
  v_add_u32 v15, s30, v14
  ds_write_b32 v15, v12
  s_waitcnt lgkmcnt(0)
  s_barrier
  ds_read_b32 v48, v14
  ds_read_b32 v49, v14 offset:32
  ds_read_b32 v50, v14 offset:64
  ds_read_b32 v51, v14 offset:96
  s_waitcnt lgkmcnt(0)
  v_add_f32 v48, v48, v49
  v_add_f32 v50, v50, v51
  v_add_f32 v48, v48, v50
  v_mov_b32 v49, 0x3727c5ac
  v_fmac_f32 v49, 0x3acccccd, v48
  v_rsq_f32 v49, v49
  s_nop 0
  v_mul_f32 v56, v56, v49
  v_mul_f32 v57, v57, v49
  v_mul_f32 v58, v58, v49
  v_mul_f32 v59, v59, v49
  v_mul_f32 v60, v60, v49
  v_mul_f32 v61, v61, v49
  v_mul_f32 v62, v62, v49
  v_mul_f32 v63, v63, v49
  v_mul_f32 v64, v64, v49
  v_mul_f32 v65, v65, v49
  v_mul_f32 v66, v66, v49
  v_mul_f32 v67, v67, v49
  v_mul_f32 v68, v68, v49
  v_mul_f32 v69, v69, v49
  v_mul_f32 v70, v70, v49
  v_mul_f32 v71, v71, v49
  v_mul_f32 v72, v72, v49
  v_mul_f32 v73, v73, v49
  v_mul_f32 v74, v74, v49
  v_mul_f32 v75, v75, v49
  v_mul_f32 v76, v76, v49
  v_mul_f32 v77, v77, v49
  v_mul_f32 v78, v78, v49
  v_mul_f32 v79, v79, v49
  v_cvt_pk_bf16_f32 v80, v56, v57
  v_cvt_pk_bf16_f32 v81, v58, v59
  v_cvt_pk_bf16_f32 v82, v60, v61
  v_cvt_pk_bf16_f32 v83, v62, v63
  v_cvt_pk_bf16_f32 v84, v64, v65
  v_cvt_pk_bf16_f32 v85, v66, v67
  v_cvt_pk_bf16_f32 v86, v68, v69
  v_cvt_pk_bf16_f32 v87, v70, v71
  v_cvt_pk_bf16_f32 v88, v72, v73
  v_cvt_pk_bf16_f32 v89, v74, v75
  v_cvt_pk_bf16_f32 v90, v76, v77
  v_cvt_pk_bf16_f32 v91, v78, v79
  s_mul_i32 s30, s26, 40960
  s_lshl_b32 s31, s21, 12
  s_add_u32 s30, s30, s31
  s_add_u32 s30, s30, 0x100000
  s_add_u32 s31, s30, 0
  buffer_store_dwordx4 v[80:83], v10, s[8:11], s31 offen sc1
  s_add_u32 s31, s30, 16384
  buffer_store_dwordx4 v[84:87], v10, s[8:11], s31 offen sc1
  s_cmp_lt_u32 s21, 2
  s_cbranch_scc0 g3_119
  s_add_u32 s31, s30, 32768
  buffer_store_dwordx4 v[88:91], v10, s[8:11], s31 offen sc1
g3_119:
  s_waitcnt vmcnt(0)
  s_barrier
  s_cmp_eq_u32 s21, 0
  s_cbranch_scc0 arr_120
  s_mov_b64 s[24:25], exec
  s_mov_b64 exec, 1
  v_mov_b32 v3, 0
  v_mov_b32 v4, 1
  buffer_atomic_add v4, v3, s[8:11], s46 offen
  s_mov_b64 exec, s[24:25]
arr_120:
  s_mov_b32 s45, 0
  v_mov_b32 v3, 0
aw_121:
  buffer_load_dword v4, v3, s[8:11], s46 offen sc1
  s_add_u32 s45, s45, 1
  s_waitcnt vmcnt(0)
  v_readfirstlane_b32 s29, v4
  s_cmp_ge_u32 s29, 32
  s_cbranch_scc1 aw_121_ok
  s_cmp_lt_u32 s45, 400000
  s_cbranch_scc1 aw_121
  s_branch kb2_abort
aw_121_ok:
  s_barrier
  s_lshl_b32 s26, s23, 3
  s_lshl_b32 s27, s21, 1
  s_add_u32 s24, s26, s27
  s_mul_i32 s27, s24, 40960
  s_add_u32 s27, s27, 0x100000
  s_add_u32 s28, s27, 40960
  v_mov_b32 v3, v2
  v_add_u32 v4, 65536, v2
  v_lshlrev_b32 v5, 7, v1
  s_add_u32 s29, s27, 0
  buffer_load_dword v6, v5, s[8:11], s29 offen sc1
  s_add_u32 s29, s27, 8192
  buffer_load_dword v6, v5, s[8:11], s29 offen sc1
  s_add_u32 s29, s27, 16384
  buffer_load_dword v6, v5, s[8:11], s29 offen sc1
  s_add_u32 s29, s27, 24576
  buffer_load_dword v6, v5, s[8:11], s29 offen sc1
  s_add_u32 s29, s27, 32768
  buffer_load_dword v6, v5, s[8:11], s29 offen sc1
  s_add_u32 s29, s27, 40960
  buffer_load_dword v6, v5, s[8:11], s29 offen sc1
  s_add_u32 s29, s27, 49152
  buffer_load_dword v6, v5, s[8:11], s29 offen sc1
  s_add_u32 s29, s27, 57344
  buffer_load_dword v6, v5, s[8:11], s29 offen sc1
  s_add_u32 s29, s27, 65536
  buffer_load_dword v6, v5, s[8:11], s29 offen sc1
  s_add_u32 s29, s27, 73728
  buffer_load_dword v6, v5, s[8:11], s29 offen sc1
  s_add_u32 s29, s27, 0
  buffer_load_dwordx4 v[16:19], v2, s[8:11], s29 offen sc1
  s_add_u32 s29, s28, 0
  buffer_load_dwordx4 v[20:23], v2, s[8:11], s29 offen sc1
  s_add_u32 s29, s27, 1024
  buffer_load_dwordx4 v[24:27], v2, s[8:11], s29 offen sc1
  s_add_u32 s29, s28, 1024
  buffer_load_dwordx4 v[28:31], v2, s[8:11], s29 offen sc1
  s_add_u32 s29, s27, 2048
  buffer_load_dwordx4 v[32:35], v2, s[8:11], s29 offen sc1
  s_add_u32 s29, s28, 2048
  buffer_load_dwordx4 v[36:39], v2, s[8:11], s29 offen sc1
  s_add_u32 s29, s27, 3072
  buffer_load_dwordx4 v[40:43], v2, s[8:11], s29 offen sc1
  s_add_u32 s29, s28, 3072
  buffer_load_dwordx4 v[44:47], v2, s[8:11], s29 offen sc1
  s_add_u32 s29, s27, 4096
  buffer_load_dwordx4 v[48:51], v2, s[8:11], s29 offen sc1
  s_add_u32 s29, s28, 4096
  buffer_load_dwordx4 v[52:55], v2, s[8:11], s29 offen sc1
  s_add_u32 s29, s27, 5120
  buffer_load_dwordx4 v[56:59], v2, s[8:11], s29 offen sc1
  s_add_u32 s29, s28, 5120
  buffer_load_dwordx4 v[60:63], v2, s[8:11], s29 offen sc1
  s_add_u32 s29, s27, 6144
  buffer_load_dwordx4 v[64:67], v2, s[8:11], s29 offen sc1
  s_add_u32 s29, s28, 6144
  buffer_load_dwordx4 v[68:71], v2, s[8:11], s29 offen sc1
  ds_read_b128 v[208:211], v3 offset:0
  ds_read_b128 v[212:215], v3 offset:40960
  ds_read_b128 v[216:219], v4 offset:16384
  s_add_u32 s29, s27, 7168
  buffer_load_dwordx4 v[72:75], v2, s[8:11], s29 offen sc1
  s_add_u32 s29, s28, 7168
  buffer_load_dwordx4 v[76:79], v2, s[8:11], s29 offen sc1
  ds_read_b128 v[220:223], v3 offset:1024
  ds_read_b128 v[224:227], v3 offset:41984
  ds_read_b128 v[228:231], v4 offset:17408
  s_waitcnt lgkmcnt(3)
  s_waitcnt vmcnt(14)
  v_mfma_f32_32x32x16_bf16 v[80:95], v[208:211], v[16:19], 0
  v_mfma_f32_32x32x16_bf16 v[96:111], v[212:215], v[16:19], 0
  v_mfma_f32_32x32x16_bf16 v[112:127], v[16:19], v[216:219], 0
  v_mfma_f32_32x32x16_bf16 v[128:143], v[208:211], v[20:23], 0
  v_mfma_f32_32x32x16_bf16 v[144:159], v[212:215], v[20:23], 0
  v_mfma_f32_32x32x16_bf16 v[160:175], v[20:23], v[216:219], 0
  s_add_u32 s29, s27, 8192
  buffer_load_dwordx4 v[16:19], v2, s[8:11], s29 offen sc1
  s_add_u32 s29, s28, 8192
  buffer_load_dwordx4 v[20:23], v2, s[8:11], s29 offen sc1
  ds_read_b128 v[208:211], v3 offset:2048
  ds_read_b128 v[212:215], v3 offset:43008
  ds_read_b128 v[216:219], v4 offset:18432
  s_waitcnt lgkmcnt(3)
  s_waitcnt vmcnt(14)
  v_mfma_f32_32x32x16_bf16 v[80:95], v[220:223], v[24:27], v[80:95]
  v_mfma_f32_32x32x16_bf16 v[96:111], v[224:227], v[24:27], v[96:111]
  v_mfma_f32_32x32x16_bf16 v[112:127], v[24:27], v[228:231], v[112:127]
  v_mfma_f32_32x32x16_bf16 v[128:143], v[220:223], v[28:31], v[128:143]
  v_mfma_f32_32x32x16_bf16 v[144:159], v[224:227], v[28:31], v[144:159]
  v_mfma_f32_32x32x16_bf16 v[160:175], v[28:31], v[228:231], v[160:175]
  s_add_u32 s29, s27, 9216
  buffer_load_dwordx4 v[24:27], v2, s[8:11], s29 offen sc1
  s_add_u32 s29, s28, 9216
  buffer_load_dwordx4 v[28:31], v2, s[8:11], s29 offen sc1
  ds_read_b128 v[220:223], v3 offset:3072
  ds_read_b128 v[224:227], v3 offset:44032
  ds_read_b128 v[228:231], v4 offset:19456
  s_waitcnt lgkmcnt(3)
  s_waitcnt vmcnt(14)
  v_mfma_f32_32x32x16_bf16 v[80:95], v[208:211], v[32:35], v[80:95]
  v_mfma_f32_32x32x16_bf16 v[96:111], v[212:215], v[32:35], v[96:111]
  v_mfma_f32_32x32x16_bf16 v[112:127], v[32:35], v[216:219], v[112:127]
  v_mfma_f32_32x32x16_bf16 v[128:143], v[208:211], v[36:39], v[128:143]
  v_mfma_f32_32x32x16_bf16 v[144:159], v[212:215], v[36:39], v[144:159]
  v_mfma_f32_32x32x16_bf16 v[160:175], v[36:39], v[216:219], v[160:175]
  s_add_u32 s29, s27, 10240
  buffer_load_dwordx4 v[32:35], v2, s[8:11], s29 offen sc1
  s_add_u32 s29, s28, 10240
  buffer_load_dwordx4 v[36:39], v2, s[8:11], s29 offen sc1
  ds_read_b128 v[208:211], v3 offset:4096
  ds_read_b128 v[212:215], v3 offset:45056
  ds_read_b128 v[216:219], v4 offset:20480
  s_waitcnt lgkmcnt(3)
  s_waitcnt vmcnt(14)
  v_mfma_f32_32x32x16_bf16 v[80:95], v[220:223], v[40:43], v[80:95]
  v_mfma_f32_32x32x16_bf16 v[96:111], v[224:227], v[40:43], v[96:111]
  v_mfma_f32_32x32x16_bf16 v[112:127], v[40:43], v[228:231], v[112:127]
  v_mfma_f32_32x32x16_bf16 v[128:143], v[220:223], v[44:47], v[128:143]
  v_mfma_f32_32x32x16_bf16 v[144:159], v[224:227], v[44:47], v[144:159]
  v_mfma_f32_32x32x16_bf16 v[160:175], v[44:47], v[228:231], v[160:175]
  s_add_u32 s29, s27, 11264
  buffer_load_dwordx4 v[40:43], v2, s[8:11], s29 offen sc1
  s_add_u32 s29, s28, 11264
  buffer_load_dwordx4 v[44:47], v2, s[8:11], s29 offen sc1
  ds_read_b128 v[220:223], v3 offset:5120
  ds_read_b128 v[224:227], v3 offset:46080
  ds_read_b128 v[228:231], v4 offset:21504
  s_waitcnt lgkmcnt(3)
  s_waitcnt vmcnt(14)
  v_mfma_f32_32x32x16_bf16 v[80:95], v[208:211], v[48:51], v[80:95]
  v_mfma_f32_32x32x16_bf16 v[96:111], v[212:215], v[48:51], v[96:111]
  v_mfma_f32_32x32x16_bf16 v[112:127], v[48:51], v[216:219], v[112:127]
  v_mfma_f32_32x32x16_bf16 v[128:143], v[208:211], v[52:55], v[128:143]
  v_mfma_f32_32x32x16_bf16 v[144:159], v[212:215], v[52:55], v[144:159]
  v_mfma_f32_32x32x16_bf16 v[160:175], v[52:55], v[216:219], v[160:175]
  s_add_u32 s29, s27, 12288
  buffer_load_dwordx4 v[48:51], v2, s[8:11], s29 offen sc1
  s_add_u32 s29, s28, 12288
  buffer_load_dwordx4 v[52:55], v2, s[8:11], s29 offen sc1
  ds_read_b128 v[208:211], v3 offset:6144
  ds_read_b128 v[212:215], v3 offset:47104
  ds_read_b128 v[216:219], v4 offset:22528
  s_waitcnt lgkmcnt(3)
  s_waitcnt vmcnt(14)
  v_mfma_f32_32x32x16_bf16 v[80:95], v[220:223], v[56:59], v[80:95]
  v_mfma_f32_32x32x16_bf16 v[96:111], v[224:227], v[56:59], v[96:111]
  v_mfma_f32_32x32x16_bf16 v[112:127], v[56:59], v[228:231], v[112:127]
  v_mfma_f32_32x32x16_bf16 v[128:143], v[220:223], v[60:63], v[128:143]
  v_mfma_f32_32x32x16_bf16 v[144:159], v[224:227], v[60:63], v[144:159]
  v_mfma_f32_32x32x16_bf16 v[160:175], v[60:63], v[228:231], v[160:175]
  s_add_u32 s29, s27, 13312
  buffer_load_dwordx4 v[56:59], v2, s[8:11], s29 offen sc1
  s_add_u32 s29, s28, 13312
  buffer_load_dwordx4 v[60:63], v2, s[8:11], s29 offen sc1
  ds_read_b128 v[220:223], v3 offset:7168
  ds_read_b128 v[224:227], v3 offset:48128
  ds_read_b128 v[228:231], v4 offset:23552
  s_waitcnt lgkmcnt(3)
  s_waitcnt vmcnt(14)
  v_mfma_f32_32x32x16_bf16 v[80:95], v[208:211], v[64:67], v[80:95]
  v_mfma_f32_32x32x16_bf16 v[96:111], v[212:215], v[64:67], v[96:111]
  v_mfma_f32_32x32x16_bf16 v[112:127], v[64:67], v[216:219], v[112:127]
  v_mfma_f32_32x32x16_bf16 v[128:143], v[208:211], v[68:71], v[128:143]
  v_mfma_f32_32x32x16_bf16 v[144:159], v[212:215], v[68:71], v[144:159]
  v_mfma_f32_32x32x16_bf16 v[160:175], v[68:71], v[216:219], v[160:175]
  s_add_u32 s29, s27, 14336
  buffer_load_dwordx4 v[64:67], v2, s[8:11], s29 offen sc1
  s_add_u32 s29, s28, 14336
  buffer_load_dwordx4 v[68:71], v2, s[8:11], s29 offen sc1
  ds_read_b128 v[208:211], v3 offset:8192
  ds_read_b128 v[212:215], v3 offset:49152
  ds_read_b128 v[216:219], v4 offset:24576
  s_waitcnt lgkmcnt(3)
  s_waitcnt vmcnt(14)
  v_mfma_f32_32x32x16_bf16 v[80:95], v[220:223], v[72:75], v[80:95]
  v_mfma_f32_32x32x16_bf16 v[96:111], v[224:227], v[72:75], v[96:111]
  v_mfma_f32_32x32x16_bf16 v[112:127], v[72:75], v[228:231], v[112:127]
  v_mfma_f32_32x32x16_bf16 v[128:143], v[220:223], v[76:79], v[128:143]
  v_mfma_f32_32x32x16_bf16 v[144:159], v[224:227], v[76:79], v[144:159]
  v_mfma_f32_32x32x16_bf16 v[160:175], v[76:79], v[228:231], v[160:175]
  s_add_u32 s29, s27, 15360
  buffer_load_dwordx4 v[72:75], v2, s[8:11], s29 offen sc1
  s_add_u32 s29, s28, 15360
  buffer_load_dwordx4 v[76:79], v2, s[8:11], s29 offen sc1
  ds_read_b128 v[220:223], v3 offset:9216
  ds_read_b128 v[224:227], v3 offset:50176
  ds_read_b128 v[228:231], v4 offset:25600
  s_waitcnt lgkmcnt(3)
  s_waitcnt vmcnt(14)
  v_mfma_f32_32x32x16_bf16 v[80:95], v[208:211], v[16:19], v[80:95]
  v_mfma_f32_32x32x16_bf16 v[96:111], v[212:215], v[16:19], v[96:111]
  v_mfma_f32_32x32x16_bf16 v[112:127], v[16:19], v[216:219], v[112:127]
  v_mfma_f32_32x32x16_bf16 v[128:143], v[208:211], v[20:23], v[128:143]
  v_mfma_f32_32x32x16_bf16 v[144:159], v[212:215], v[20:23], v[144:159]
  v_mfma_f32_32x32x16_bf16 v[160:175], v[20:23], v[216:219], v[160:175]
  s_add_u32 s29, s27, 16384
  buffer_load_dwordx4 v[16:19], v2, s[8:11], s29 offen sc1
  s_add_u32 s29, s28, 16384
  buffer_load_dwordx4 v[20:23], v2, s[8:11], s29 offen sc1
  ds_read_b128 v[208:211], v3 offset:10240
  ds_read_b128 v[212:215], v3 offset:51200
  ds_read_b128 v[216:219], v4 offset:26624
  s_waitcnt lgkmcnt(3)
  s_waitcnt vmcnt(14)
  v_mfma_f32_32x32x16_bf16 v[80:95], v[220:223], v[24:27], v[80:95]
  v_mfma_f32_32x32x16_bf16 v[96:111], v[224:227], v[24:27], v[96:111]
  v_mfma_f32_32x32x16_bf16 v[112:127], v[24:27], v[228:231], v[112:127]
  v_mfma_f32_32x32x16_bf16 v[128:143], v[220:223], v[28:31], v[128:143]
  v_mfma_f32_32x32x16_bf16 v[144:159], v[224:227], v[28:31], v[144:159]
  v_mfma_f32_32x32x16_bf16 v[160:175], v[28:31], v[228:231], v[160:175]
  s_add_u32 s29, s27, 17408
  buffer_load_dwordx4 v[24:27], v2, s[8:11], s29 offen sc1
  s_add_u32 s29, s28, 17408
  buffer_load_dwordx4 v[28:31], v2, s[8:11], s29 offen sc1
  ds_read_b128 v[220:223], v3 offset:11264
  ds_read_b128 v[224:227], v3 offset:52224
  ds_read_b128 v[228:231], v4 offset:27648
  s_waitcnt lgkmcnt(3)
  s_waitcnt vmcnt(14)
  v_mfma_f32_32x32x16_bf16 v[80:95], v[208:211], v[32:35], v[80:95]
  v_mfma_f32_32x32x16_bf16 v[96:111], v[212:215], v[32:35], v[96:111]
  v_mfma_f32_32x32x16_bf16 v[112:127], v[32:35], v[216:219], v[112:127]
  v_mfma_f32_32x32x16_bf16 v[128:143], v[208:211], v[36:39], v[128:143]
  v_mfma_f32_32x32x16_bf16 v[144:159], v[212:215], v[36:39], v[144:159]
  v_mfma_f32_32x32x16_bf16 v[160:175], v[36:39], v[216:219], v[160:175]
  s_add_u32 s29, s27, 18432
  buffer_load_dwordx4 v[32:35], v2, s[8:11], s29 offen sc1
  s_add_u32 s29, s28, 18432
  buffer_load_dwordx4 v[36:39], v2, s[8:11], s29 offen sc1
  ds_read_b128 v[208:211], v3 offset:12288
  ds_read_b128 v[212:215], v3 offset:53248
  ds_read_b128 v[216:219], v4 offset:28672
  s_waitcnt lgkmcnt(3)
  s_waitcnt vmcnt(14)
  v_mfma_f32_32x32x16_bf16 v[80:95], v[220:223], v[40:43], v[80:95]
  v_mfma_f32_32x32x16_bf16 v[96:111], v[224:227], v[40:43], v[96:111]
  v_mfma_f32_32x32x16_bf16 v[112:127], v[40:43], v[228:231], v[112:127]
  v_mfma_f32_32x32x16_bf16 v[128:143], v[220:223], v[44:47], v[128:143]
  v_mfma_f32_32x32x16_bf16 v[144:159], v[224:227], v[44:47], v[144:159]
  v_mfma_f32_32x32x16_bf16 v[160:175], v[44:47], v[228:231], v[160:175]
  s_add_u32 s29, s27, 19456
  buffer_load_dwordx4 v[40:43], v2, s[8:11], s29 offen sc1
  s_add_u32 s29, s28, 19456
  buffer_load_dwordx4 v[44:47], v2, s[8:11], s29 offen sc1
  ds_read_b128 v[220:223], v3 offset:13312
  ds_read_b128 v[224:227], v3 offset:54272
  ds_read_b128 v[228:231], v4 offset:29696
  s_waitcnt lgkmcnt(3)
  s_waitcnt vmcnt(14)
  v_mfma_f32_32x32x16_bf16 v[80:95], v[208:211], v[48:51], v[80:95]
  v_mfma_f32_32x32x16_bf16 v[96:111], v[212:215], v[48:51], v[96:111]
  v_mfma_f32_32x32x16_bf16 v[112:127], v[48:51], v[216:219], v[112:127]
  v_mfma_f32_32x32x16_bf16 v[128:143], v[208:211], v[52:55], v[128:143]
  v_mfma_f32_32x32x16_bf16 v[144:159], v[212:215], v[52:55], v[144:159]
  v_mfma_f32_32x32x16_bf16 v[160:175], v[52:55], v[216:219], v[160:175]
  s_add_u32 s29, s27, 20480
  buffer_load_dwordx4 v[48:51], v2, s[8:11], s29 offen sc1
  s_add_u32 s29, s28, 20480
  buffer_load_dwordx4 v[52:55], v2, s[8:11], s29 offen sc1
  ds_read_b128 v[208:211], v3 offset:14336
  ds_read_b128 v[212:215], v3 offset:55296
  ds_read_b128 v[216:219], v4 offset:30720
  s_waitcnt lgkmcnt(3)
  s_waitcnt vmcnt(14)
  v_mfma_f32_32x32x16_bf16 v[80:95], v[220:223], v[56:59], v[80:95]
  v_mfma_f32_32x32x16_bf16 v[96:111], v[224:227], v[56:59], v[96:111]
  v_mfma_f32_32x32x16_bf16 v[112:127], v[56:59], v[228:231], v[112:127]
  v_mfma_f32_32x32x16_bf16 v[128:143], v[220:223], v[60:63], v[128:143]
  v_mfma_f32_32x32x16_bf16 v[144:159], v[224:227], v[60:63], v[144:159]
  v_mfma_f32_32x32x16_bf16 v[160:175], v[60:63], v[228:231], v[160:175]
  s_add_u32 s29, s27, 21504
  buffer_load_dwordx4 v[56:59], v2, s[8:11], s29 offen sc1
  s_add_u32 s29, s28, 21504
  buffer_load_dwordx4 v[60:63], v2, s[8:11], s29 offen sc1
  ds_read_b128 v[220:223], v3 offset:15360
  ds_read_b128 v[224:227], v3 offset:56320
  ds_read_b128 v[228:231], v4 offset:31744
  s_waitcnt lgkmcnt(3)
  s_waitcnt vmcnt(14)
  v_mfma_f32_32x32x16_bf16 v[80:95], v[208:211], v[64:67], v[80:95]
  v_mfma_f32_32x32x16_bf16 v[96:111], v[212:215], v[64:67], v[96:111]
  v_mfma_f32_32x32x16_bf16 v[112:127], v[64:67], v[216:219], v[112:127]
  v_mfma_f32_32x32x16_bf16 v[128:143], v[208:211], v[68:71], v[128:143]
  v_mfma_f32_32x32x16_bf16 v[144:159], v[212:215], v[68:71], v[144:159]
  v_mfma_f32_32x32x16_bf16 v[160:175], v[68:71], v[216:219], v[160:175]
  s_add_u32 s29, s27, 22528
  buffer_load_dwordx4 v[64:67], v2, s[8:11], s29 offen sc1
  s_add_u32 s29, s28, 22528
  buffer_load_dwordx4 v[68:71], v2, s[8:11], s29 offen sc1
  ds_read_b128 v[208:211], v3 offset:16384
  ds_read_b128 v[212:215], v3 offset:57344
  ds_read_b128 v[216:219], v4 offset:32768
  s_waitcnt lgkmcnt(3)
  s_waitcnt vmcnt(14)
  v_mfma_f32_32x32x16_bf16 v[80:95], v[220:223], v[72:75], v[80:95]
  v_mfma_f32_32x32x16_bf16 v[96:111], v[224:227], v[72:75], v[96:111]
  v_mfma_f32_32x32x16_bf16 v[112:127], v[72:75], v[228:231], v[112:127]
  v_mfma_f32_32x32x16_bf16 v[128:143], v[220:223], v[76:79], v[128:143]
  v_mfma_f32_32x32x16_bf16 v[144:159], v[224:227], v[76:79], v[144:159]
  v_mfma_f32_32x32x16_bf16 v[160:175], v[76:79], v[228:231], v[160:175]
  s_add_u32 s29, s27, 23552
  buffer_load_dwordx4 v[72:75], v2, s[8:11], s29 offen sc1
  s_add_u32 s29, s28, 23552
  buffer_load_dwordx4 v[76:79], v2, s[8:11], s29 offen sc1
  ds_read_b128 v[220:223], v3 offset:17408
  ds_read_b128 v[224:227], v3 offset:58368
  ds_read_b128 v[228:231], v4 offset:33792
  s_waitcnt lgkmcnt(3)
  s_waitcnt vmcnt(14)
  v_mfma_f32_32x32x16_bf16 v[80:95], v[208:211], v[16:19], v[80:95]
  v_mfma_f32_32x32x16_bf16 v[96:111], v[212:215], v[16:19], v[96:111]
  v_mfma_f32_32x32x16_bf16 v[112:127], v[16:19], v[216:219], v[112:127]
  v_mfma_f32_32x32x16_bf16 v[128:143], v[208:211], v[20:23], v[128:143]
  v_mfma_f32_32x32x16_bf16 v[144:159], v[212:215], v[20:23], v[144:159]
  v_mfma_f32_32x32x16_bf16 v[160:175], v[20:23], v[216:219], v[160:175]
  s_add_u32 s29, s27, 24576
  buffer_load_dwordx4 v[16:19], v2, s[8:11], s29 offen sc1
  s_add_u32 s29, s28, 24576
  buffer_load_dwordx4 v[20:23], v2, s[8:11], s29 offen sc1
  ds_read_b128 v[208:211], v3 offset:18432
  ds_read_b128 v[212:215], v3 offset:59392
  ds_read_b128 v[216:219], v4 offset:34816
  s_waitcnt lgkmcnt(3)
  s_waitcnt vmcnt(14)
  v_mfma_f32_32x32x16_bf16 v[80:95], v[220:223], v[24:27], v[80:95]
  v_mfma_f32_32x32x16_bf16 v[96:111], v[224:227], v[24:27], v[96:111]
  v_mfma_f32_32x32x16_bf16 v[112:127], v[24:27], v[228:231], v[112:127]
  v_mfma_f32_32x32x16_bf16 v[128:143], v[220:223], v[28:31], v[128:143]
  v_mfma_f32_32x32x16_bf16 v[144:159], v[224:227], v[28:31], v[144:159]
  v_mfma_f32_32x32x16_bf16 v[160:175], v[28:31], v[228:231], v[160:175]
  s_add_u32 s29, s27, 25600
  buffer_load_dwordx4 v[24:27], v2, s[8:11], s29 offen sc1
  s_add_u32 s29, s28, 25600
  buffer_load_dwordx4 v[28:31], v2, s[8:11], s29 offen sc1
  ds_read_b128 v[220:223], v3 offset:19456
  ds_read_b128 v[224:227], v3 offset:60416
  ds_read_b128 v[228:231], v4 offset:35840
  s_waitcnt lgkmcnt(3)
  s_waitcnt vmcnt(14)
  v_mfma_f32_32x32x16_bf16 v[80:95], v[208:211], v[32:35], v[80:95]
  v_mfma_f32_32x32x16_bf16 v[96:111], v[212:215], v[32:35], v[96:111]
  v_mfma_f32_32x32x16_bf16 v[112:127], v[32:35], v[216:219], v[112:127]
  v_mfma_f32_32x32x16_bf16 v[128:143], v[208:211], v[36:39], v[128:143]
  v_mfma_f32_32x32x16_bf16 v[144:159], v[212:215], v[36:39], v[144:159]
  v_mfma_f32_32x32x16_bf16 v[160:175], v[36:39], v[216:219], v[160:175]
  s_add_u32 s29, s27, 26624
  buffer_load_dwordx4 v[32:35], v2, s[8:11], s29 offen sc1
  s_add_u32 s29, s28, 26624
  buffer_load_dwordx4 v[36:39], v2, s[8:11], s29 offen sc1
  ds_read_b128 v[208:211], v3 offset:20480
  ds_read_b128 v[212:215], v3 offset:61440
  ds_read_b128 v[216:219], v4 offset:36864
  s_waitcnt lgkmcnt(3)
  s_waitcnt vmcnt(14)
  v_mfma_f32_32x32x16_bf16 v[80:95], v[220:223], v[40:43], v[80:95]
  v_mfma_f32_32x32x16_bf16 v[96:111], v[224:227], v[40:43], v[96:111]
  v_mfma_f32_32x32x16_bf16 v[112:127], v[40:43], v[228:231], v[112:127]
  v_mfma_f32_32x32x16_bf16 v[128:143], v[220:223], v[44:47], v[128:143]
  v_mfma_f32_32x32x16_bf16 v[144:159], v[224:227], v[44:47], v[144:159]
  v_mfma_f32_32x32x16_bf16 v[160:175], v[44:47], v[228:231], v[160:175]
  s_add_u32 s29, s27, 27648
  buffer_load_dwordx4 v[40:43], v2, s[8:11], s29 offen sc1
  s_add_u32 s29, s28, 27648
  buffer_load_dwordx4 v[44:47], v2, s[8:11], s29 offen sc1
  ds_read_b128 v[220:223], v3 offset:21504
  ds_read_b128 v[224:227], v3 offset:62464
  ds_read_b128 v[228:231], v4 offset:37888
  s_waitcnt lgkmcnt(3)
  s_waitcnt vmcnt(14)
  v_mfma_f32_32x32x16_bf16 v[80:95], v[208:211], v[48:51], v[80:95]
  v_mfma_f32_32x32x16_bf16 v[96:111], v[212:215], v[48:51], v[96:111]
  v_mfma_f32_32x32x16_bf16 v[112:127], v[48:51], v[216:219], v[112:127]
  v_mfma_f32_32x32x16_bf16 v[128:143], v[208:211], v[52:55], v[128:143]
  v_mfma_f32_32x32x16_bf16 v[144:159], v[212:215], v[52:55], v[144:159]
  v_mfma_f32_32x32x16_bf16 v[160:175], v[52:55], v[216:219], v[160:175]
  s_add_u32 s29, s27, 28672
  buffer_load_dwordx4 v[48:51], v2, s[8:11], s29 offen sc1
  s_add_u32 s29, s28, 28672
  buffer_load_dwordx4 v[52:55], v2, s[8:11], s29 offen sc1
  ds_read_b128 v[208:211], v3 offset:22528
  ds_read_b128 v[212:215], v3 offset:63488
  ds_read_b128 v[216:219], v4 offset:38912
  s_waitcnt lgkmcnt(3)
  s_waitcnt vmcnt(14)
  v_mfma_f32_32x32x16_bf16 v[80:95], v[220:223], v[56:59], v[80:95]
  v_mfma_f32_32x32x16_bf16 v[96:111], v[224:227], v[56:59], v[96:111]
  v_mfma_f32_32x32x16_bf16 v[112:127], v[56:59], v[228:231], v[112:127]
  v_mfma_f32_32x32x16_bf16 v[128:143], v[220:223], v[60:63], v[128:143]
  v_mfma_f32_32x32x16_bf16 v[144:159], v[224:227], v[60:63], v[144:159]
  v_mfma_f32_32x32x16_bf16 v[160:175], v[60:63], v[228:231], v[160:175]
  s_add_u32 s29, s27, 29696
  buffer_load_dwordx4 v[56:59], v2, s[8:11], s29 offen sc1
  s_add_u32 s29, s28, 29696
  buffer_load_dwordx4 v[60:63], v2, s[8:11], s29 offen sc1
  ds_read_b128 v[220:223], v3 offset:23552
  ds_read_b128 v[224:227], v3 offset:64512
  ds_read_b128 v[228:231], v4 offset:39936
  s_waitcnt lgkmcnt(3)
  s_waitcnt vmcnt(14)
  v_mfma_f32_32x32x16_bf16 v[80:95], v[208:211], v[64:67], v[80:95]
  v_mfma_f32_32x32x16_bf16 v[96:111], v[212:215], v[64:67], v[96:111]
  v_mfma_f32_32x32x16_bf16 v[112:127], v[64:67], v[216:219], v[112:127]
  v_mfma_f32_32x32x16_bf16 v[128:143], v[208:211], v[68:71], v[128:143]
  v_mfma_f32_32x32x16_bf16 v[144:159], v[212:215], v[68:71], v[144:159]
  v_mfma_f32_32x32x16_bf16 v[160:175], v[68:71], v[216:219], v[160:175]
  s_add_u32 s29, s27, 30720
  buffer_load_dwordx4 v[64:67], v2, s[8:11], s29 offen sc1
  s_add_u32 s29, s28, 30720
  buffer_load_dwordx4 v[68:71], v2, s[8:11], s29 offen sc1
  ds_read_b128 v[208:211], v3 offset:24576
  ds_read_b128 v[212:215], v4 offset:0
  ds_read_b128 v[216:219], v4 offset:40960
  s_waitcnt lgkmcnt(3)
  s_waitcnt vmcnt(14)
  v_mfma_f32_32x32x16_bf16 v[80:95], v[220:223], v[72:75], v[80:95]
  v_mfma_f32_32x32x16_bf16 v[96:111], v[224:227], v[72:75], v[96:111]
  v_mfma_f32_32x32x16_bf16 v[112:127], v[72:75], v[228:231], v[112:127]
  v_mfma_f32_32x32x16_bf16 v[128:143], v[220:223], v[76:79], v[128:143]
  v_mfma_f32_32x32x16_bf16 v[144:159], v[224:227], v[76:79], v[144:159]
  v_mfma_f32_32x32x16_bf16 v[160:175], v[76:79], v[228:231], v[160:175]
  s_add_u32 s29, s27, 31744
  buffer_load_dwordx4 v[72:75], v2, s[8:11], s29 offen sc1
  s_add_u32 s29, s28, 31744
  buffer_load_dwordx4 v[76:79], v2, s[8:11], s29 offen sc1
  ds_read_b128 v[220:223], v3 offset:25600
  ds_read_b128 v[224:227], v4 offset:1024
  ds_read_b128 v[228:231], v4 offset:41984
  s_waitcnt lgkmcnt(3)
  s_waitcnt vmcnt(14)
  v_mfma_f32_32x32x16_bf16 v[80:95], v[208:211], v[16:19], v[80:95]
  v_mfma_f32_32x32x16_bf16 v[96:111], v[212:215], v[16:19], v[96:111]
  v_mfma_f32_32x32x16_bf16 v[112:127], v[16:19], v[216:219], v[112:127]
  v_mfma_f32_32x32x16_bf16 v[128:143], v[208:211], v[20:23], v[128:143]
  v_mfma_f32_32x32x16_bf16 v[144:159], v[212:215], v[20:23], v[144:159]
  v_mfma_f32_32x32x16_bf16 v[160:175], v[20:23], v[216:219], v[160:175]
  s_add_u32 s29, s27, 32768
  buffer_load_dwordx4 v[16:19], v2, s[8:11], s29 offen sc1
  s_add_u32 s29, s28, 32768
  buffer_load_dwordx4 v[20:23], v2, s[8:11], s29 offen sc1
  ds_read_b128 v[208:211], v3 offset:26624
  ds_read_b128 v[212:215], v4 offset:2048
  ds_read_b128 v[216:219], v4 offset:43008
  s_waitcnt lgkmcnt(3)
  s_waitcnt vmcnt(14)
  v_mfma_f32_32x32x16_bf16 v[80:95], v[220:223], v[24:27], v[80:95]
  v_mfma_f32_32x32x16_bf16 v[96:111], v[224:227], v[24:27], v[96:111]
  v_mfma_f32_32x32x16_bf16 v[112:127], v[24:27], v[228:231], v[112:127]
  v_mfma_f32_32x32x16_bf16 v[128:143], v[220:223], v[28:31], v[128:143]
  v_mfma_f32_32x32x16_bf16 v[144:159], v[224:227], v[28:31], v[144:159]
  v_mfma_f32_32x32x16_bf16 v[160:175], v[28:31], v[228:231], v[160:175]
  s_add_u32 s29, s27, 33792
  buffer_load_dwordx4 v[24:27], v2, s[8:11], s29 offen sc1
  s_add_u32 s29, s28, 33792
  buffer_load_dwordx4 v[28:31], v2, s[8:11], s29 offen sc1
  ds_read_b128 v[220:223], v3 offset:27648
  ds_read_b128 v[224:227], v4 offset:3072
  ds_read_b128 v[228:231], v4 offset:44032
  s_waitcnt lgkmcnt(3)
  s_waitcnt vmcnt(14)
  v_mfma_f32_32x32x16_bf16 v[80:95], v[208:211], v[32:35], v[80:95]
  v_mfma_f32_32x32x16_bf16 v[96:111], v[212:215], v[32:35], v[96:111]
  v_mfma_f32_32x32x16_bf16 v[112:127], v[32:35], v[216:219], v[112:127]
  v_mfma_f32_32x32x16_bf16 v[128:143], v[208:211], v[36:39], v[128:143]
  v_mfma_f32_32x32x16_bf16 v[144:159], v[212:215], v[36:39], v[144:159]
  v_mfma_f32_32x32x16_bf16 v[160:175], v[36:39], v[216:219], v[160:175]
  s_add_u32 s29, s27, 34816
  buffer_load_dwordx4 v[32:35], v2, s[8:11], s29 offen sc1
  s_add_u32 s29, s28, 34816
  buffer_load_dwordx4 v[36:39], v2, s[8:11], s29 offen sc1
  ds_read_b128 v[208:211], v3 offset:28672
  ds_read_b128 v[212:215], v4 offset:4096
  ds_read_b128 v[216:219], v4 offset:45056
  s_waitcnt lgkmcnt(3)
  s_waitcnt vmcnt(14)
  v_mfma_f32_32x32x16_bf16 v[80:95], v[220:223], v[40:43], v[80:95]
  v_mfma_f32_32x32x16_bf16 v[96:111], v[224:227], v[40:43], v[96:111]
  v_mfma_f32_32x32x16_bf16 v[112:127], v[40:43], v[228:231], v[112:127]
  v_mfma_f32_32x32x16_bf16 v[128:143], v[220:223], v[44:47], v[128:143]
  v_mfma_f32_32x32x16_bf16 v[144:159], v[224:227], v[44:47], v[144:159]
  v_mfma_f32_32x32x16_bf16 v[160:175], v[44:47], v[228:231], v[160:175]
  s_add_u32 s29, s27, 35840
  buffer_load_dwordx4 v[40:43], v2, s[8:11], s29 offen sc1
  s_add_u32 s29, s28, 35840
  buffer_load_dwordx4 v[44:47], v2, s[8:11], s29 offen sc1
  ds_read_b128 v[220:223], v3 offset:29696
  ds_read_b128 v[224:227], v4 offset:5120
  ds_read_b128 v[228:231], v4 offset:46080
  s_waitcnt lgkmcnt(3)
  s_waitcnt vmcnt(14)
  v_mfma_f32_32x32x16_bf16 v[80:95], v[208:211], v[48:51], v[80:95]
  v_mfma_f32_32x32x16_bf16 v[96:111], v[212:215], v[48:51], v[96:111]
  v_mfma_f32_32x32x16_bf16 v[112:127], v[48:51], v[216:219], v[112:127]
  v_mfma_f32_32x32x16_bf16 v[128:143], v[208:211], v[52:55], v[128:143]
  v_mfma_f32_32x32x16_bf16 v[144:159], v[212:215], v[52:55], v[144:159]
  v_mfma_f32_32x32x16_bf16 v[160:175], v[52:55], v[216:219], v[160:175]
  s_add_u32 s29, s27, 36864
  buffer_load_dwordx4 v[48:51], v2, s[8:11], s29 offen sc1
  s_add_u32 s29, s28, 36864
  buffer_load_dwordx4 v[52:55], v2, s[8:11], s29 offen sc1
  ds_read_b128 v[208:211], v3 offset:30720
  ds_read_b128 v[212:215], v4 offset:6144
  ds_read_b128 v[216:219], v4 offset:47104
  s_waitcnt lgkmcnt(3)
  s_waitcnt vmcnt(14)
  v_mfma_f32_32x32x16_bf16 v[80:95], v[220:223], v[56:59], v[80:95]
  v_mfma_f32_32x32x16_bf16 v[96:111], v[224:227], v[56:59], v[96:111]
  v_mfma_f32_32x32x16_bf16 v[112:127], v[56:59], v[228:231], v[112:127]
  v_mfma_f32_32x32x16_bf16 v[128:143], v[220:223], v[60:63], v[128:143]
  v_mfma_f32_32x32x16_bf16 v[144:159], v[224:227], v[60:63], v[144:159]
  v_mfma_f32_32x32x16_bf16 v[160:175], v[60:63], v[228:231], v[160:175]
  s_add_u32 s29, s27, 37888
  buffer_load_dwordx4 v[56:59], v2, s[8:11], s29 offen sc1
  s_add_u32 s29, s28, 37888
  buffer_load_dwordx4 v[60:63], v2, s[8:11], s29 offen sc1
  ds_read_b128 v[220:223], v3 offset:31744
  ds_read_b128 v[224:227], v4 offset:7168
  ds_read_b128 v[228:231], v4 offset:48128
  s_waitcnt lgkmcnt(3)
  s_waitcnt vmcnt(14)
  v_mfma_f32_32x32x16_bf16 v[80:95], v[208:211], v[64:67], v[80:95]
  v_mfma_f32_32x32x16_bf16 v[96:111], v[212:215], v[64:67], v[96:111]
  v_mfma_f32_32x32x16_bf16 v[112:127], v[64:67], v[216:219], v[112:127]
  v_mfma_f32_32x32x16_bf16 v[128:143], v[208:211], v[68:71], v[128:143]
  v_mfma_f32_32x32x16_bf16 v[144:159], v[212:215], v[68:71], v[144:159]
  v_mfma_f32_32x32x16_bf16 v[160:175], v[68:71], v[216:219], v[160:175]
  s_add_u32 s29, s27, 38912
  buffer_load_dwordx4 v[64:67], v2, s[8:11], s29 offen sc1
  s_add_u32 s29, s28, 38912
  buffer_load_dwordx4 v[68:71], v2, s[8:11], s29 offen sc1
  ds_read_b128 v[208:211], v3 offset:32768
  ds_read_b128 v[212:215], v4 offset:8192
  ds_read_b128 v[216:219], v4 offset:49152
  s_waitcnt lgkmcnt(3)
  s_waitcnt vmcnt(14)
  v_mfma_f32_32x32x16_bf16 v[80:95], v[220:223], v[72:75], v[80:95]
  v_mfma_f32_32x32x16_bf16 v[96:111], v[224:227], v[72:75], v[96:111]
  v_mfma_f32_32x32x16_bf16 v[112:127], v[72:75], v[228:231], v[112:127]
  v_mfma_f32_32x32x16_bf16 v[128:143], v[220:223], v[76:79], v[128:143]
  v_mfma_f32_32x32x16_bf16 v[144:159], v[224:227], v[76:79], v[144:159]
  v_mfma_f32_32x32x16_bf16 v[160:175], v[76:79], v[228:231], v[160:175]
  s_add_u32 s29, s27, 39936
  buffer_load_dwordx4 v[72:75], v2, s[8:11], s29 offen sc1
  s_add_u32 s29, s28, 39936
  buffer_load_dwordx4 v[76:79], v2, s[8:11], s29 offen sc1
  ds_read_b128 v[220:223], v3 offset:33792
  ds_read_b128 v[224:227], v4 offset:9216
  ds_read_b128 v[228:231], v4 offset:50176
  s_waitcnt lgkmcnt(3)
  s_waitcnt vmcnt(14)
  v_mfma_f32_32x32x16_bf16 v[80:95], v[208:211], v[16:19], v[80:95]
  v_mfma_f32_32x32x16_bf16 v[96:111], v[212:215], v[16:19], v[96:111]
  v_mfma_f32_32x32x16_bf16 v[112:127], v[16:19], v[216:219], v[112:127]
  v_mfma_f32_32x32x16_bf16 v[128:143], v[208:211], v[20:23], v[128:143]
  v_mfma_f32_32x32x16_bf16 v[144:159], v[212:215], v[20:23], v[144:159]
  v_mfma_f32_32x32x16_bf16 v[160:175], v[20:23], v[216:219], v[160:175]
  ds_read_b128 v[208:211], v3 offset:34816
  ds_read_b128 v[212:215], v4 offset:10240
  ds_read_b128 v[216:219], v4 offset:51200
  s_waitcnt lgkmcnt(3)
  s_waitcnt vmcnt(12)
  v_mfma_f32_32x32x16_bf16 v[80:95], v[220:223], v[24:27], v[80:95]
  v_mfma_f32_32x32x16_bf16 v[96:111], v[224:227], v[24:27], v[96:111]
  v_mfma_f32_32x32x16_bf16 v[112:127], v[24:27], v[228:231], v[112:127]
  v_mfma_f32_32x32x16_bf16 v[128:143], v[220:223], v[28:31], v[128:143]
  v_mfma_f32_32x32x16_bf16 v[144:159], v[224:227], v[28:31], v[144:159]
  v_mfma_f32_32x32x16_bf16 v[160:175], v[28:31], v[228:231], v[160:175]
  ds_read_b128 v[220:223], v3 offset:35840
  ds_read_b128 v[224:227], v4 offset:11264
  ds_read_b128 v[228:231], v4 offset:52224
  s_waitcnt lgkmcnt(3)
  s_waitcnt vmcnt(10)
  v_mfma_f32_32x32x16_bf16 v[80:95], v[208:211], v[32:35], v[80:95]
  v_mfma_f32_32x32x16_bf16 v[96:111], v[212:215], v[32:35], v[96:111]
  v_mfma_f32_32x32x16_bf16 v[112:127], v[32:35], v[216:219], v[112:127]
  v_mfma_f32_32x32x16_bf16 v[128:143], v[208:211], v[36:39], v[128:143]
  v_mfma_f32_32x32x16_bf16 v[144:159], v[212:215], v[36:39], v[144:159]
  v_mfma_f32_32x32x16_bf16 v[160:175], v[36:39], v[216:219], v[160:175]
  ds_read_b128 v[208:211], v3 offset:36864
  ds_read_b128 v[212:215], v4 offset:12288
  ds_read_b128 v[216:219], v4 offset:53248
  s_waitcnt lgkmcnt(3)
  s_waitcnt vmcnt(8)
  v_mfma_f32_32x32x16_bf16 v[80:95], v[220:223], v[40:43], v[80:95]
  v_mfma_f32_32x32x16_bf16 v[96:111], v[224:227], v[40:43], v[96:111]
  v_mfma_f32_32x32x16_bf16 v[112:127], v[40:43], v[228:231], v[112:127]
  v_mfma_f32_32x32x16_bf16 v[128:143], v[220:223], v[44:47], v[128:143]
  v_mfma_f32_32x32x16_bf16 v[144:159], v[224:227], v[44:47], v[144:159]
  v_mfma_f32_32x32x16_bf16 v[160:175], v[44:47], v[228:231], v[160:175]
  ds_read_b128 v[220:223], v3 offset:37888
  ds_read_b128 v[224:227], v4 offset:13312
  ds_read_b128 v[228:231], v4 offset:54272
  s_waitcnt lgkmcnt(3)
  s_waitcnt vmcnt(6)
  v_mfma_f32_32x32x16_bf16 v[80:95], v[208:211], v[48:51], v[80:95]
  v_mfma_f32_32x32x16_bf16 v[96:111], v[212:215], v[48:51], v[96:111]
  v_mfma_f32_32x32x16_bf16 v[112:127], v[48:51], v[216:219], v[112:127]
  v_mfma_f32_32x32x16_bf16 v[128:143], v[208:211], v[52:55], v[128:143]
  v_mfma_f32_32x32x16_bf16 v[144:159], v[212:215], v[52:55], v[144:159]
  v_mfma_f32_32x32x16_bf16 v[160:175], v[52:55], v[216:219], v[160:175]
  ds_read_b128 v[208:211], v3 offset:38912
  ds_read_b128 v[212:215], v4 offset:14336
  ds_read_b128 v[216:219], v4 offset:55296
  s_waitcnt lgkmcnt(3)
  s_waitcnt vmcnt(4)
  v_mfma_f32_32x32x16_bf16 v[80:95], v[220:223], v[56:59], v[80:95]
  v_mfma_f32_32x32x16_bf16 v[96:111], v[224:227], v[56:59], v[96:111]
  v_mfma_f32_32x32x16_bf16 v[112:127], v[56:59], v[228:231], v[112:127]
  v_mfma_f32_32x32x16_bf16 v[128:143], v[220:223], v[60:63], v[128:143]
  v_mfma_f32_32x32x16_bf16 v[144:159], v[224:227], v[60:63], v[144:159]
  v_mfma_f32_32x32x16_bf16 v[160:175], v[60:63], v[228:231], v[160:175]
  ds_read_b128 v[220:223], v3 offset:39936
  ds_read_b128 v[224:227], v4 offset:15360
  ds_read_b128 v[228:231], v4 offset:56320
  s_waitcnt lgkmcnt(3)
  s_waitcnt vmcnt(2)
  v_mfma_f32_32x32x16_bf16 v[80:95], v[208:211], v[64:67], v[80:95]
  v_mfma_f32_32x32x16_bf16 v[96:111], v[212:215], v[64:67], v[96:111]
  v_mfma_f32_32x32x16_bf16 v[112:127], v[64:67], v[216:219], v[112:127]
  v_mfma_f32_32x32x16_bf16 v[128:143], v[208:211], v[68:71], v[128:143]
  v_mfma_f32_32x32x16_bf16 v[144:159], v[212:215], v[68:71], v[144:159]
  v_mfma_f32_32x32x16_bf16 v[160:175], v[68:71], v[216:219], v[160:175]
  s_waitcnt lgkmcnt(0)
  s_waitcnt vmcnt(0)
  v_mfma_f32_32x32x16_bf16 v[80:95], v[220:223], v[72:75], v[80:95]
  v_mfma_f32_32x32x16_bf16 v[96:111], v[224:227], v[72:75], v[96:111]
  v_mfma_f32_32x32x16_bf16 v[112:127], v[72:75], v[228:231], v[112:127]
  v_mfma_f32_32x32x16_bf16 v[128:143], v[220:223], v[76:79], v[128:143]
  v_mfma_f32_32x32x16_bf16 v[144:159], v[224:227], v[76:79], v[144:159]
  v_mfma_f32_32x32x16_bf16 v[160:175], v[76:79], v[228:231], v[160:175]
  s_nop 11
  s_mov_b32 s30, 0x3ea52b5c
  v_mov_b32 v5, 0
  v_cmp_gt_u32 s[34:35], 32, v1
  v_mov_b32 v6, 1.0
  v_and_b32 v7, 31, v1
  v_cndmask_b32 v6, v5, v6, s[34:35]
  v_cmp_eq_u32 s[32:33], 20, v7
  v_mov_b32 v8, 1.0
  s_lshl_b32 s31, s22, 6
  s_add_u32 s31, s31, s24
  s_lshl_b32 s31, s31, 11
  v_mov_b32 v9, 0
  v_max3_f32 v9, v9, abs(v96), abs(v97)
  v_max3_f32 v9, v9, abs(v98), abs(v99)
  v_max3_f32 v9, v9, abs(v100), abs(v101)
  v_max3_f32 v9, v9, abs(v102), abs(v103)
  v_max3_f32 v9, v9, abs(v104), abs(v105)
  v_max3_f32 v9, v9, abs(v106), abs(v107)
  v_max3_f32 v9, v9, abs(v108), abs(v109)
  v_max3_f32 v9, v9, abs(v110), abs(v111)
  v_add_f32 v108, v108, v6
  v_cndmask_b32 v112, v112, v8, s[32:33]
  v_cndmask_b32 v113, v113, v8, s[32:33]
  v_cndmask_b32 v114, v114, v8, s[32:33]
  v_cndmask_b32 v115, v115, v8, s[32:33]
  v_cndmask_b32 v116, v116, v8, s[32:33]
  v_cndmask_b32 v117, v117, v8, s[32:33]
  v_cndmask_b32 v118, v118, v8, s[32:33]
  v_cndmask_b32 v119, v119, v8, s[32:33]
  v_cndmask_b32 v120, v120, v8, s[32:33]
  v_cndmask_b32 v121, v121, v8, s[32:33]
  v_cndmask_b32 v122, v122, v8, s[32:33]
  v_cndmask_b32 v123, v123, v8, s[32:33]
  v_cndmask_b32 v124, v124, v8, s[32:33]
  v_cndmask_b32 v125, v125, v8, s[32:33]
  v_cndmask_b32 v126, v126, v8, s[32:33]
  v_cndmask_b32 v127, v127, v8, s[32:33]
  v_cvt_pk_bf16_f32 v16, v96, v97
  v_cvt_pk_bf16_f32 v17, v98, v99
  v_cvt_pk_bf16_f32 v18, v100, v101
  v_cvt_pk_bf16_f32 v19, v102, v103
  v_cvt_pk_bf16_f32 v20, v104, v105
  v_cvt_pk_bf16_f32 v21, v106, v107
  v_cvt_pk_bf16_f32 v22, v108, v109
  v_cvt_pk_bf16_f32 v23, v110, v111
  s_add_u32 s29, s31, 245366784
  buffer_store_dwordx4 v[16:19], v2, s[8:11], s29 offen sc1
  buffer_store_dwordx4 v[20:23], v2, s[8:11], s29 offen offset:1024 sc1
  v_cvt_pk_bf16_f32 v24, v112, v113
  v_cvt_pk_bf16_f32 v25, v114, v115
  v_cvt_pk_bf16_f32 v26, v116, v117
  v_cvt_pk_bf16_f32 v27, v118, v119
  v_cvt_pk_bf16_f32 v28, v120, v121
  v_cvt_pk_bf16_f32 v29, v122, v123
  v_cvt_pk_bf16_f32 v30, v124, v125
  v_cvt_pk_bf16_f32 v31, v126, v127
  s_add_u32 s29, s31, 249561088
  buffer_store_dwordx4 v[24:27], v2, s[8:11], s29 offen sc1
  buffer_store_dwordx4 v[28:31], v2, s[8:11], s29 offen offset:1024 sc1
  v_mul_f32 v80, s30, v80
  v_mul_f32 v81, s30, v81
  v_mul_f32 v82, s30, v82
  v_mul_f32 v83, s30, v83
  v_mul_f32 v84, s30, v84
  v_mul_f32 v85, s30, v85
  v_mul_f32 v86, s30, v86
  v_mul_f32 v87, s30, v87
  v_mul_f32 v88, s30, v88
  v_mul_f32 v89, s30, v89
  v_mul_f32 v90, s30, v90
  v_mul_f32 v91, s30, v91
  v_mul_f32 v92, s30, v92
  v_mul_f32 v93, s30, v93
  v_mul_f32 v94, s30, v94
  v_mul_f32 v95, s30, v95
  v_cvt_pk_bf16_f32 v192, v80, v81
  v_cvt_pk_bf16_f32 v193, v82, v83
  v_cvt_pk_bf16_f32 v194, v84, v85
  v_cvt_pk_bf16_f32 v195, v86, v87
  v_cvt_pk_bf16_f32 v196, v88, v89
  v_cvt_pk_bf16_f32 v197, v90, v91
  v_cvt_pk_bf16_f32 v198, v92, v93
  v_cvt_pk_bf16_f32 v199, v94, v95
  v_max3_f32 v9, v9, abs(v144), abs(v145)
  v_max3_f32 v9, v9, abs(v146), abs(v147)
  v_max3_f32 v9, v9, abs(v148), abs(v149)
  v_max3_f32 v9, v9, abs(v150), abs(v151)
  v_max3_f32 v9, v9, abs(v152), abs(v153)
  v_max3_f32 v9, v9, abs(v154), abs(v155)
  v_max3_f32 v9, v9, abs(v156), abs(v157)
  v_max3_f32 v9, v9, abs(v158), abs(v159)
  v_add_f32 v156, v156, v6
  v_cndmask_b32 v160, v160, v8, s[32:33]
  v_cndmask_b32 v161, v161, v8, s[32:33]
  v_cndmask_b32 v162, v162, v8, s[32:33]
  v_cndmask_b32 v163, v163, v8, s[32:33]
  v_cndmask_b32 v164, v164, v8, s[32:33]
  v_cndmask_b32 v165, v165, v8, s[32:33]
  v_cndmask_b32 v166, v166, v8, s[32:33]
  v_cndmask_b32 v167, v167, v8, s[32:33]
  v_cndmask_b32 v168, v168, v8, s[32:33]
  v_cndmask_b32 v169, v169, v8, s[32:33]
  v_cndmask_b32 v170, v170, v8, s[32:33]
  v_cndmask_b32 v171, v171, v8, s[32:33]
  v_cndmask_b32 v172, v172, v8, s[32:33]
  v_cndmask_b32 v173, v173, v8, s[32:33]
  v_cndmask_b32 v174, v174, v8, s[32:33]
  v_cndmask_b32 v175, v175, v8, s[32:33]
  v_cvt_pk_bf16_f32 v32, v144, v145
  v_cvt_pk_bf16_f32 v33, v146, v147
  v_cvt_pk_bf16_f32 v34, v148, v149
  v_cvt_pk_bf16_f32 v35, v150, v151
  v_cvt_pk_bf16_f32 v36, v152, v153
  v_cvt_pk_bf16_f32 v37, v154, v155
  v_cvt_pk_bf16_f32 v38, v156, v157
  v_cvt_pk_bf16_f32 v39, v158, v159
  s_add_u32 s29, s31, 245368832
  buffer_store_dwordx4 v[32:35], v2, s[8:11], s29 offen sc1
  buffer_store_dwordx4 v[36:39], v2, s[8:11], s29 offen offset:1024 sc1
  v_cvt_pk_bf16_f32 v40, v160, v161
  v_cvt_pk_bf16_f32 v41, v162, v163
  v_cvt_pk_bf16_f32 v42, v164, v165
  v_cvt_pk_bf16_f32 v43, v166, v167
  v_cvt_pk_bf16_f32 v44, v168, v169
  v_cvt_pk_bf16_f32 v45, v170, v171
  v_cvt_pk_bf16_f32 v46, v172, v173
  v_cvt_pk_bf16_f32 v47, v174, v175
  s_add_u32 s29, s31, 249563136
  buffer_store_dwordx4 v[40:43], v2, s[8:11], s29 offen sc1
  buffer_store_dwordx4 v[44:47], v2, s[8:11], s29 offen offset:1024 sc1
  v_mul_f32 v128, s30, v128
  v_mul_f32 v129, s30, v129
  v_mul_f32 v130, s30, v130
  v_mul_f32 v131, s30, v131
  v_mul_f32 v132, s30, v132
  v_mul_f32 v133, s30, v133
  v_mul_f32 v134, s30, v134
  v_mul_f32 v135, s30, v135
  v_mul_f32 v136, s30, v136
  v_mul_f32 v137, s30, v137
  v_mul_f32 v138, s30, v138
  v_mul_f32 v139, s30, v139
  v_mul_f32 v140, s30, v140
  v_mul_f32 v141, s30, v141
  v_mul_f32 v142, s30, v142
  v_mul_f32 v143, s30, v143
  v_cvt_pk_bf16_f32 v200, v128, v129
  v_cvt_pk_bf16_f32 v201, v130, v131
  v_cvt_pk_bf16_f32 v202, v132, v133
  v_cvt_pk_bf16_f32 v203, v134, v135
  v_cvt_pk_bf16_f32 v204, v136, v137
  v_cvt_pk_bf16_f32 v205, v138, v139
  v_cvt_pk_bf16_f32 v206, v140, v141
  v_cvt_pk_bf16_f32 v207, v142, v143
  s_nop 1
  v_max_f32_dpp v10, v9, v9 quad_perm:[1,0,3,2] row_mask:0xf bank_mask:0xf
  s_nop 1
  v_max_f32_dpp v9, v10, v10 quad_perm:[2,3,0,1] row_mask:0xf bank_mask:0xf
  s_nop 1
  v_max_f32_dpp v10, v9, v9 row_half_mirror row_mask:0xf bank_mask:0xf
  s_nop 1
  v_max_f32_dpp v9, v10, v10 row_mirror row_mask:0xf bank_mask:0xf
  v_mov_b32 v10, v9
  s_nop 1
  v_permlane16_swap_b32 v9, v10
  v_max_f32 v9, v9, v10
  v_mov_b32 v10, v9
  s_nop 1
  v_permlane32_swap_b32 v9, v10
  v_max_f32 v9, v9, v10
  s_lshl_b32 s51, s22, 2
  s_add_u32 s51, s51, 0xb800
  v_mov_b32 v11, 0
  s_mov_b64 s[40:41], exec
  s_mov_b64 exec, 1
  buffer_atomic_umax v9, v11, s[8:11], s51 offen
  s_mov_b64 exec, s[40:41]
  s_mov_b32 s52, s24
  s_waitcnt vmcnt(0)
  s_barrier
  s_cmp_eq_u32 s21, 0
  s_cbranch_scc0 arr_122
  s_mov_b64 s[24:25], exec
  s_mov_b64 exec, 1
  v_mov_b32 v3, 0
  v_mov_b32 v4, 1
  buffer_atomic_add v4, v3, s[8:11], s47 offen
  s_mov_b64 exec, s[24:25]
arr_122:
  s_and_b32 s26, s2, 3
  s_mul_i32 s26, s26, 10
  s_mul_i32 s27, s21, 3
  s_cmp_eq_u32 s21, 3
  s_cselect_b32 s27, 8, s27
  s_add_u32 s50, s26, s27
  s_mul_i32 s26, s50, 20480
  s_add_u32 s26, s26, 0xe000000
  s_add_u32 s27, s26, 0
  buffer_load_dwordx4 a[0:3], v2, s[8:11], s27 offen
  s_add_u32 s27, s26, 1024
  buffer_load_dwordx4 a[4:7], v2, s[8:11], s27 offen
  s_add_u32 s27, s26, 2048
  buffer_load_dwordx4 a[8:11], v2, s[8:11], s27 offen
  s_add_u32 s27, s26, 3072
  buffer_load_dwordx4 a[12:15], v2, s[8:11], s27 offen
  s_add_u32 s27, s26, 4096
  buffer_load_dwordx4 a[16:19], v2, s[8:11], s27 offen
  s_add_u32 s27, s26, 5120
  buffer_load_dwordx4 a[20:23], v2, s[8:11], s27 offen
  s_add_u32 s27, s26, 6144
  buffer_load_dwordx4 a[24:27], v2, s[8:11], s27 offen
  s_add_u32 s27, s26, 7168
  buffer_load_dwordx4 a[28:31], v2, s[8:11], s27 offen
  s_add_u32 s27, s26, 8192
  buffer_load_dwordx4 a[32:35], v2, s[8:11], s27 offen
  s_add_u32 s27, s26, 9216
  buffer_load_dwordx4 a[36:39], v2, s[8:11], s27 offen
  s_add_u32 s27, s26, 10240
  buffer_load_dwordx4 a[40:43], v2, s[8:11], s27 offen
  s_add_u32 s27, s26, 11264
  buffer_load_dwordx4 a[44:47], v2, s[8:11], s27 offen
  s_add_u32 s27, s26, 12288
  buffer_load_dwordx4 a[48:51], v2, s[8:11], s27 offen
  s_add_u32 s27, s26, 13312
  buffer_load_dwordx4 a[52:55], v2, s[8:11], s27 offen
  s_add_u32 s27, s26, 14336
  buffer_load_dwordx4 a[56:59], v2, s[8:11], s27 offen
  s_add_u32 s27, s26, 15360
  buffer_load_dwordx4 a[60:63], v2, s[8:11], s27 offen
  s_add_u32 s27, s26, 16384
  buffer_load_dwordx4 a[64:67], v2, s[8:11], s27 offen
  s_add_u32 s27, s26, 17408
  buffer_load_dwordx4 a[68:71], v2, s[8:11], s27 offen
  s_add_u32 s27, s26, 18432
  buffer_load_dwordx4 a[72:75], v2, s[8:11], s27 offen
  s_add_u32 s27, s26, 19456
  buffer_load_dwordx4 a[76:79], v2, s[8:11], s27 offen
  s_add_u32 s27, s26, 20480
  buffer_load_dwordx4 a[80:83], v2, s[8:11], s27 offen
  s_add_u32 s27, s26, 21504
  buffer_load_dwordx4 a[84:87], v2, s[8:11], s27 offen
  s_add_u32 s27, s26, 22528
  buffer_load_dwordx4 a[88:91], v2, s[8:11], s27 offen
  s_add_u32 s27, s26, 23552
  buffer_load_dwordx4 a[92:95], v2, s[8:11], s27 offen
  s_add_u32 s27, s26, 24576
  buffer_load_dwordx4 a[96:99], v2, s[8:11], s27 offen
  s_add_u32 s27, s26, 25600
  buffer_load_dwordx4 a[100:103], v2, s[8:11], s27 offen
  s_add_u32 s27, s26, 26624
  buffer_load_dwordx4 a[104:107], v2, s[8:11], s27 offen
  s_add_u32 s27, s26, 27648
  buffer_load_dwordx4 a[108:111], v2, s[8:11], s27 offen
  s_add_u32 s27, s26, 28672
  buffer_load_dwordx4 a[112:115], v2, s[8:11], s27 offen
  s_add_u32 s27, s26, 29696
  buffer_load_dwordx4 a[116:119], v2, s[8:11], s27 offen
  s_add_u32 s27, s26, 30720
  buffer_load_dwordx4 a[120:123], v2, s[8:11], s27 offen
  s_add_u32 s27, s26, 31744
  buffer_load_dwordx4 a[124:127], v2, s[8:11], s27 offen
  s_add_u32 s27, s26, 32768
  buffer_load_dwordx4 a[128:131], v2, s[8:11], s27 offen
  s_add_u32 s27, s26, 33792
  buffer_load_dwordx4 a[132:135], v2, s[8:11], s27 offen
  s_add_u32 s27, s26, 34816
  buffer_load_dwordx4 a[136:139], v2, s[8:11], s27 offen
  s_add_u32 s27, s26, 35840
  buffer_load_dwordx4 a[140:143], v2, s[8:11], s27 offen
  s_add_u32 s27, s26, 36864
  buffer_load_dwordx4 a[144:147], v2, s[8:11], s27 offen
  s_add_u32 s27, s26, 37888
  buffer_load_dwordx4 a[148:151], v2, s[8:11], s27 offen
  s_add_u32 s27, s26, 38912
  buffer_load_dwordx4 a[152:155], v2, s[8:11], s27 offen
  s_add_u32 s27, s26, 39936
  buffer_load_dwordx4 a[156:159], v2, s[8:11], s27 offen
  s_cmp_lt_u32 s21, 2
  s_cbranch_scc0 g3_123
  s_add_u32 s27, s26, 40960
  buffer_load_dwordx4 a[160:163], v2, s[8:11], s27 offen
  s_add_u32 s27, s26, 41984
  buffer_load_dwordx4 a[164:167], v2, s[8:11], s27 offen
  s_add_u32 s27, s26, 43008
  buffer_load_dwordx4 a[168:171], v2, s[8:11], s27 offen
  s_add_u32 s27, s26, 44032
  buffer_load_dwordx4 a[172:175], v2, s[8:11], s27 offen
  s_add_u32 s27, s26, 45056
  buffer_load_dwordx4 a[176:179], v2, s[8:11], s27 offen
  s_add_u32 s27, s26, 46080
  buffer_load_dwordx4 a[180:183], v2, s[8:11], s27 offen
  s_add_u32 s27, s26, 47104
  buffer_load_dwordx4 a[184:187], v2, s[8:11], s27 offen
  s_add_u32 s27, s26, 48128
  buffer_load_dwordx4 a[188:191], v2, s[8:11], s27 offen
  s_add_u32 s27, s26, 49152
  buffer_load_dwordx4 a[192:195], v2, s[8:11], s27 offen
  s_add_u32 s27, s26, 50176
  buffer_load_dwordx4 a[196:199], v2, s[8:11], s27 offen
  s_add_u32 s27, s26, 51200
  buffer_load_dwordx4 a[200:203], v2, s[8:11], s27 offen
  s_add_u32 s27, s26, 52224
  buffer_load_dwordx4 a[204:207], v2, s[8:11], s27 offen
  s_add_u32 s27, s26, 53248
  buffer_load_dwordx4 a[208:211], v2, s[8:11], s27 offen
  s_add_u32 s27, s26, 54272
  buffer_load_dwordx4 a[212:215], v2, s[8:11], s27 offen
  s_add_u32 s27, s26, 55296
  buffer_load_dwordx4 a[216:219], v2, s[8:11], s27 offen
  s_add_u32 s27, s26, 56320
  buffer_load_dwordx4 a[220:223], v2, s[8:11], s27 offen
  s_add_u32 s27, s26, 57344
  buffer_load_dwordx4 a[224:227], v2, s[8:11], s27 offen
  s_add_u32 s27, s26, 58368
  buffer_load_dwordx4 a[228:231], v2, s[8:11], s27 offen
  s_add_u32 s27, s26, 59392
  buffer_load_dwordx4 a[232:235], v2, s[8:11], s27 offen
  s_add_u32 s27, s26, 60416
  buffer_load_dwordx4 a[236:239], v2, s[8:11], s27 offen
g3_123:
  v_mov_b32 v12, 0
  v_lshlrev_b32 v6, 16, v192
  v_and_b32 v7, 0xffff0000, v192
  v_add_f32_e64 v12, v12, abs(v6)
  v_add_f32_e64 v12, v12, abs(v7)
  v_lshlrev_b32 v6, 16, v193
  v_and_b32 v7, 0xffff0000, v193
  v_add_f32_e64 v12, v12, abs(v6)
  v_add_f32_e64 v12, v12, abs(v7)
  v_lshlrev_b32 v6, 16, v194
  v_and_b32 v7, 0xffff0000, v194
  v_add_f32_e64 v12, v12, abs(v6)
  v_add_f32_e64 v12, v12, abs(v7)
  v_lshlrev_b32 v6, 16, v195
  v_and_b32 v7, 0xffff0000, v195
  v_add_f32_e64 v12, v12, abs(v6)
  v_add_f32_e64 v12, v12, abs(v7)
  v_lshlrev_b32 v6, 16, v196
  v_and_b32 v7, 0xffff0000, v196
  v_add_f32_e64 v12, v12, abs(v6)
  v_add_f32_e64 v12, v12, abs(v7)
  v_lshlrev_b32 v6, 16, v197
  v_and_b32 v7, 0xffff0000, v197
  v_add_f32_e64 v12, v12, abs(v6)
  v_add_f32_e64 v12, v12, abs(v7)
  v_lshlrev_b32 v6, 16, v198
  v_and_b32 v7, 0xffff0000, v198
  v_add_f32_e64 v12, v12, abs(v6)
  v_add_f32_e64 v12, v12, abs(v7)
  v_lshlrev_b32 v6, 16, v199
  v_and_b32 v7, 0xffff0000, v199
  v_add_f32_e64 v12, v12, abs(v6)
  v_add_f32_e64 v12, v12, abs(v7)
  v_mov_b32 v6, v12
  s_nop 1
  v_permlane32_swap_b32 v12, v6
  v_add_f32 v12, v12, v6
  v_mov_b32 v13, 0
  v_lshlrev_b32 v6, 16, v200
  v_and_b32 v7, 0xffff0000, v200
  v_add_f32_e64 v13, v13, abs(v6)
  v_add_f32_e64 v13, v13, abs(v7)
  v_lshlrev_b32 v6, 16, v201
  v_and_b32 v7, 0xffff0000, v201
  v_add_f32_e64 v13, v13, abs(v6)
  v_add_f32_e64 v13, v13, abs(v7)
  v_lshlrev_b32 v6, 16, v202
  v_and_b32 v7, 0xffff0000, v202
  v_add_f32_e64 v13, v13, abs(v6)
  v_add_f32_e64 v13, v13, abs(v7)
  v_lshlrev_b32 v6, 16, v203
  v_and_b32 v7, 0xffff0000, v203
  v_add_f32_e64 v13, v13, abs(v6)
  v_add_f32_e64 v13, v13, abs(v7)
  v_lshlrev_b32 v6, 16, v204
  v_and_b32 v7, 0xffff0000, v204
  v_add_f32_e64 v13, v13, abs(v6)
  v_add_f32_e64 v13, v13, abs(v7)
  v_lshlrev_b32 v6, 16, v205
  v_and_b32 v7, 0xffff0000, v205
  v_add_f32_e64 v13, v13, abs(v6)
  v_add_f32_e64 v13, v13, abs(v7)
  v_lshlrev_b32 v6, 16, v206
  v_and_b32 v7, 0xffff0000, v206
  v_add_f32_e64 v13, v13, abs(v6)
  v_add_f32_e64 v13, v13, abs(v7)
  v_lshlrev_b32 v6, 16, v207
  v_and_b32 v7, 0xffff0000, v207
  v_add_f32_e64 v13, v13, abs(v6)
  v_add_f32_e64 v13, v13, abs(v7)
  v_mov_b32 v6, v13
  s_nop 1
  v_permlane32_swap_b32 v13, v6
  v_add_f32 v13, v13, v6
  s_mov_b32 s45, 0
  v_mov_b32 v3, 0
aw_124:
  buffer_load_dword v4, v3, s[8:11], s47 offen sc1
  s_add_u32 s45, s45, 1
  s_waitcnt vmcnt(0)
  v_readfirstlane_b32 s29, v4
  s_cmp_ge_u32 s29, 8
  s_cbranch_scc1 aw_124_ok
  s_cmp_lt_u32 s45, 400000
  s_cbranch_scc1 aw_124
  s_branch kb2_abort
aw_124_ok:
  v_mov_b32 v3, 0
  buffer_load_dword v4, v3, s[8:11], s51 offen sc1
  s_lshl_b32 s25, s22, 6
  s_lshl_b32 s27, s25, 11
  s_add_u32 s28, s27, 0xee00000
  s_add_u32 s27, s27, 0xea00000
  s_mov_b32 s41, 0
  s_mul_i32 s53, s41, 32768
  s_lshl_b32 s31, s21, 13
  s_add_u32 s53, s53, s31
  s_add_u32 m0, s31, 0
  s_add_u32 s29, s53, s27
  s_add_u32 s29, s29, 0
  buffer_load_dwordx4 v2, s[8:11], s29 offen sc1 lds
  s_add_u32 m0, s31, 1024
  s_add_u32 s29, s53, s27
  s_add_u32 s29, s29, 1024
  buffer_load_dwordx4 v2, s[8:11], s29 offen sc1 lds
  s_add_u32 m0, s31, 2048
  s_add_u32 s29, s53, s27
  s_add_u32 s29, s29, 2048
  buffer_load_dwordx4 v2, s[8:11], s29 offen sc1 lds
  s_add_u32 m0, s31, 3072
  s_add_u32 s29, s53, s27
  s_add_u32 s29, s29, 3072
  buffer_load_dwordx4 v2, s[8:11], s29 offen sc1 lds
  s_add_u32 m0, s31, 4096
  s_add_u32 s29, s53, s27
  s_add_u32 s29, s29, 4096
  buffer_load_dwordx4 v2, s[8:11], s29 offen sc1 lds
  s_add_u32 m0, s31, 5120
  s_add_u32 s29, s53, s27
  s_add_u32 s29, s29, 5120
  buffer_load_dwordx4 v2, s[8:11], s29 offen sc1 lds
  s_add_u32 m0, s31, 6144
  s_add_u32 s29, s53, s27
  s_add_u32 s29, s29, 6144
  buffer_load_dwordx4 v2, s[8:11], s29 offen sc1 lds
  s_add_u32 m0, s31, 7168
  s_add_u32 s29, s53, s27
  s_add_u32 s29, s29, 7168
  buffer_load_dwordx4 v2, s[8:11], s29 offen sc1 lds
  s_add_u32 m0, s31, 32768
  s_add_u32 s29, s53, s28
  s_add_u32 s29, s29, 0
  buffer_load_dwordx4 v2, s[8:11], s29 offen sc1 lds
  s_add_u32 m0, s31, 33792
  s_add_u32 s29, s53, s28
  s_add_u32 s29, s29, 1024
  buffer_load_dwordx4 v2, s[8:11], s29 offen sc1 lds
  s_add_u32 m0, s31, 34816
  s_add_u32 s29, s53, s28
  s_add_u32 s29, s29, 2048
  buffer_load_dwordx4 v2, s[8:11], s29 offen sc1 lds
  s_add_u32 m0, s31, 35840
  s_add_u32 s29, s53, s28
  s_add_u32 s29, s29, 3072
  buffer_load_dwordx4 v2, s[8:11], s29 offen sc1 lds
  s_add_u32 m0, s31, 36864
  s_add_u32 s29, s53, s28
  s_add_u32 s29, s29, 4096
  buffer_load_dwordx4 v2, s[8:11], s29 offen sc1 lds
  s_add_u32 m0, s31, 37888
  s_add_u32 s29, s53, s28
  s_add_u32 s29, s29, 5120
  buffer_load_dwordx4 v2, s[8:11], s29 offen sc1 lds
  s_add_u32 m0, s31, 38912
  s_add_u32 s29, s53, s28
  s_add_u32 s29, s29, 6144
  buffer_load_dwordx4 v2, s[8:11], s29 offen sc1 lds
  s_add_u32 m0, s31, 39936
  s_add_u32 s29, s53, s28
  s_add_u32 s29, s29, 7168
  buffer_load_dwordx4 v2, s[8:11], s29 offen sc1 lds
  s_waitcnt vmcnt(16)
  v_mul_f32 v12, v12, v4
  v_mul_f32 v12, 0x3f820000, v12
  v_mul_f32 v13, v13, v4
  v_mul_f32 v13, 0x3f820000, v13
  s_mov_b32 s40, 0
kb2_main:
  v_lshrrev_b32 v5, 16, v12
  v_or_b32 v5, 0x8000, v5
  v_and_b32 v6, 0xffff0000, v198
  v_or_b32 v5, v5, v6
  v_cndmask_b32 v198, v198, v5, s[34:35]
  v_lshrrev_b32 v5, 16, v13
  v_or_b32 v5, 0x8000, v5
  v_and_b32 v6, 0xffff0000, v206
  v_or_b32 v5, v5, v6
  v_cndmask_b32 v206, v206, v5, s[34:35]
kb2_main2:
  v_mov_b32 v112, 0
  v_mov_b32 v113, 0
  v_mov_b32 v114, 0
  v_mov_b32 v115, 0
  v_mov_b32 v116, 0
  v_mov_b32 v117, 0
  v_mov_b32 v118, 0
  v_mov_b32 v119, 0
  v_mov_b32 v120, 0
  v_mov_b32 v121, 0
  v_mov_b32 v122, 0
  v_mov_b32 v123, 0
  v_mov_b32 v124, 0
  v_mov_b32 v125, 0
  v_mov_b32 v126, 0
  v_mov_b32 v127, 0
  v_mov_b32 v128, 0
  v_mov_b32 v129, 0
  v_mov_b32 v130, 0
  v_mov_b32 v131, 0
  v_mov_b32 v132, 0
  v_mov_b32 v133, 0
  v_mov_b32 v134, 0
  v_mov_b32 v135, 0
  v_mov_b32 v136, 0
  v_mov_b32 v137, 0
  v_mov_b32 v138, 0
  v_mov_b32 v139, 0
  v_mov_b32 v140, 0
  v_mov_b32 v141, 0
  v_mov_b32 v142, 0
  v_mov_b32 v143, 0
  v_mov_b32 v3, v2
  v_add_u32 v4, 65536, v2
kb2_chunk2:
  s_waitcnt vmcnt(0)
  s_barrier
  s_add_u32 s41, s41, 1
  s_min_u32 s29, s41, 3
  s_mul_i32 s53, s29, 32768
  s_lshl_b32 s31, s21, 13
  s_add_u32 s53, s53, s31
  ds_read_b128 v[32:35], v3 offset:0
  ds_read_b128 v[36:39], v3 offset:1024
  ds_read_b128 v[48:51], v3 offset:32768
  ds_read_b128 v[52:55], v3 offset:33792
  ds_read_b128 v[40:43], v3 offset:2048
  ds_read_b128 v[44:47], v3 offset:3072
  s_waitcnt lgkmcnt(4)
  v_mfma_f32_32x32x16_bf16 v[64:79], v[32:35], v[192:195], 0
  v_mfma_f32_32x32x16_bf16 v[64:79], v[36:39], v[196:199], v[64:79]
  s_nop 11
  v_exp_f32 v64, v64
  v_exp_f32 v65, v65
  v_exp_f32 v66, v66
  v_exp_f32 v67, v67
  v_cvt_pk_bf16_f32 v96, v64, v65
  v_exp_f32 v68, v68
  v_exp_f32 v69, v69
  v_cvt_pk_bf16_f32 v97, v66, v67
  v_exp_f32 v70, v70
  v_mfma_f32_32x32x16_bf16 v[80:95], v[32:35], v[200:203], 0
  v_exp_f32 v71, v71
  v_cvt_pk_bf16_f32 v98, v68, v69
  v_exp_f32 v72, v72
  v_exp_f32 v73, v73
  v_cvt_pk_bf16_f32 v99, v70, v71
  v_mfma_f32_32x32x16_bf16 v[80:95], v[36:39], v[204:207], v[80:95]
  v_exp_f32 v74, v74
  v_exp_f32 v75, v75
  ds_read_b128 v[56:59], v3 offset:34816
  v_cvt_pk_bf16_f32 v100, v72, v73
  v_exp_f32 v76, v76
  v_exp_f32 v77, v77
  ds_read_b128 v[60:63], v3 offset:35840
  v_cvt_pk_bf16_f32 v101, v74, v75
  v_exp_f32 v78, v78
  s_add_u32 m0, s31, 65536
  s_add_u32 s29, s53, s27
  s_add_u32 s29, s29, 0
  buffer_load_dwordx4 v2, s[8:11], s29 offen sc1 lds
  v_exp_f32 v79, v79
  v_cvt_pk_bf16_f32 v102, v76, v77
  v_cvt_pk_bf16_f32 v103, v78, v79
  s_waitcnt lgkmcnt(4)
  v_mfma_f32_32x32x16_bf16 v[112:127], v[48:51], v[96:99], v[112:127]
  v_exp_f32 v80, v80
  v_exp_f32 v81, v81
  v_exp_f32 v82, v82
  v_exp_f32 v83, v83
  v_mfma_f32_32x32x16_bf16 v[112:127], v[52:55], v[100:103], v[112:127]
  v_cvt_pk_bf16_f32 v104, v80, v81
  v_exp_f32 v84, v84
  v_exp_f32 v85, v85
  v_cvt_pk_bf16_f32 v105, v82, v83
  v_exp_f32 v86, v86
  s_waitcnt lgkmcnt(2)
  v_mfma_f32_32x32x16_bf16 v[64:79], v[40:43], v[192:195], 0
  v_exp_f32 v87, v87
  v_cvt_pk_bf16_f32 v106, v84, v85
  v_exp_f32 v88, v88
  v_exp_f32 v89, v89
  v_cvt_pk_bf16_f32 v107, v86, v87
  v_mfma_f32_32x32x16_bf16 v[64:79], v[44:47], v[196:199], v[64:79]
  v_exp_f32 v90, v90
  v_exp_f32 v91, v91
  ds_read_b128 v[32:35], v3 offset:4096
  v_cvt_pk_bf16_f32 v108, v88, v89
  v_exp_f32 v92, v92
  v_exp_f32 v93, v93
  ds_read_b128 v[36:39], v3 offset:5120
  v_cvt_pk_bf16_f32 v109, v90, v91
  v_exp_f32 v94, v94
  v_exp_f32 v95, v95
  v_cvt_pk_bf16_f32 v110, v92, v93
  v_cvt_pk_bf16_f32 v111, v94, v95
  v_mfma_f32_32x32x16_bf16 v[128:143], v[48:51], v[104:107], v[128:143]
  v_exp_f32 v64, v64
  v_exp_f32 v65, v65
  v_exp_f32 v66, v66
  v_exp_f32 v67, v67
  v_mfma_f32_32x32x16_bf16 v[128:143], v[52:55], v[108:111], v[128:143]
  v_cvt_pk_bf16_f32 v96, v64, v65
  v_exp_f32 v68, v68
  v_exp_f32 v69, v69
  v_cvt_pk_bf16_f32 v97, v66, v67
  v_exp_f32 v70, v70
  v_mfma_f32_32x32x16_bf16 v[80:95], v[40:43], v[200:203], 0
  v_exp_f32 v71, v71
  v_cvt_pk_bf16_f32 v98, v68, v69
  v_exp_f32 v72, v72
  v_exp_f32 v73, v73
  v_cvt_pk_bf16_f32 v99, v70, v71
  v_mfma_f32_32x32x16_bf16 v[80:95], v[44:47], v[204:207], v[80:95]
  v_exp_f32 v74, v74
  v_exp_f32 v75, v75
  ds_read_b128 v[48:51], v3 offset:36864
  v_cvt_pk_bf16_f32 v100, v72, v73
  v_exp_f32 v76, v76
  v_exp_f32 v77, v77
  ds_read_b128 v[52:55], v3 offset:37888
  v_cvt_pk_bf16_f32 v101, v74, v75
  v_exp_f32 v78, v78
  s_add_u32 m0, s31, 66560
  s_add_u32 s29, s53, s27
  s_add_u32 s29, s29, 1024
  buffer_load_dwordx4 v2, s[8:11], s29 offen sc1 lds
  v_exp_f32 v79, v79
  v_cvt_pk_bf16_f32 v102, v76, v77
  v_cvt_pk_bf16_f32 v103, v78, v79
  s_waitcnt lgkmcnt(4)
  v_mfma_f32_32x32x16_bf16 v[112:127], v[56:59], v[96:99], v[112:127]
  v_exp_f32 v80, v80
  v_exp_f32 v81, v81
  v_exp_f32 v82, v82
  v_exp_f32 v83, v83
  v_mfma_f32_32x32x16_bf16 v[112:127], v[60:63], v[100:103], v[112:127]
  v_cvt_pk_bf16_f32 v104, v80, v81
  v_exp_f32 v84, v84
  v_exp_f32 v85, v85
  v_cvt_pk_bf16_f32 v105, v82, v83
  v_exp_f32 v86, v86
  s_waitcnt lgkmcnt(2)
  v_mfma_f32_32x32x16_bf16 v[64:79], v[32:35], v[192:195], 0
  v_exp_f32 v87, v87
  v_cvt_pk_bf16_f32 v106, v84, v85
  v_exp_f32 v88, v88
  v_exp_f32 v89, v89
  v_cvt_pk_bf16_f32 v107, v86, v87
  v_mfma_f32_32x32x16_bf16 v[64:79], v[36:39], v[196:199], v[64:79]
  v_exp_f32 v90, v90
  v_exp_f32 v91, v91
  ds_read_b128 v[40:43], v3 offset:6144
  v_cvt_pk_bf16_f32 v108, v88, v89
  v_exp_f32 v92, v92
  v_exp_f32 v93, v93
  ds_read_b128 v[44:47], v3 offset:7168
  v_cvt_pk_bf16_f32 v109, v90, v91
  v_exp_f32 v94, v94
  v_exp_f32 v95, v95
  v_cvt_pk_bf16_f32 v110, v92, v93
  v_cvt_pk_bf16_f32 v111, v94, v95
  v_mfma_f32_32x32x16_bf16 v[128:143], v[56:59], v[104:107], v[128:143]
  v_exp_f32 v64, v64
  v_exp_f32 v65, v65
  v_exp_f32 v66, v66
  v_exp_f32 v67, v67
  v_mfma_f32_32x32x16_bf16 v[128:143], v[60:63], v[108:111], v[128:143]
  v_cvt_pk_bf16_f32 v96, v64, v65
  v_exp_f32 v68, v68
  v_exp_f32 v69, v69
  v_cvt_pk_bf16_f32 v97, v66, v67
  v_exp_f32 v70, v70
  v_mfma_f32_32x32x16_bf16 v[80:95], v[32:35], v[200:203], 0
  v_exp_f32 v71, v71
  v_cvt_pk_bf16_f32 v98, v68, v69
  v_exp_f32 v72, v72
  v_exp_f32 v73, v73
  v_cvt_pk_bf16_f32 v99, v70, v71
  v_mfma_f32_32x32x16_bf16 v[80:95], v[36:39], v[204:207], v[80:95]
  v_exp_f32 v74, v74
  v_exp_f32 v75, v75
  ds_read_b128 v[56:59], v3 offset:38912
  v_cvt_pk_bf16_f32 v100, v72, v73
  v_exp_f32 v76, v76
  v_exp_f32 v77, v77
  ds_read_b128 v[60:63], v3 offset:39936
  v_cvt_pk_bf16_f32 v101, v74, v75
  v_exp_f32 v78, v78
  s_add_u32 m0, s31, 67584
  s_add_u32 s29, s53, s27
  s_add_u32 s29, s29, 2048
  buffer_load_dwordx4 v2, s[8:11], s29 offen sc1 lds
  v_exp_f32 v79, v79
  v_cvt_pk_bf16_f32 v102, v76, v77
  v_cvt_pk_bf16_f32 v103, v78, v79
  s_waitcnt lgkmcnt(4)
  v_mfma_f32_32x32x16_bf16 v[112:127], v[48:51], v[96:99], v[112:127]
  v_exp_f32 v80, v80
  v_exp_f32 v81, v81
  v_exp_f32 v82, v82
  v_exp_f32 v83, v83
  v_mfma_f32_32x32x16_bf16 v[112:127], v[52:55], v[100:103], v[112:127]
  v_cvt_pk_bf16_f32 v104, v80, v81
  v_exp_f32 v84, v84
  v_exp_f32 v85, v85
  v_cvt_pk_bf16_f32 v105, v82, v83
  v_exp_f32 v86, v86
  s_waitcnt lgkmcnt(2)
  v_mfma_f32_32x32x16_bf16 v[64:79], v[40:43], v[192:195], 0
  v_exp_f32 v87, v87
  v_cvt_pk_bf16_f32 v106, v84, v85
  v_exp_f32 v88, v88
  v_exp_f32 v89, v89
  v_cvt_pk_bf16_f32 v107, v86, v87
  v_mfma_f32_32x32x16_bf16 v[64:79], v[44:47], v[196:199], v[64:79]
  v_exp_f32 v90, v90
  v_exp_f32 v91, v91
  ds_read_b128 v[32:35], v3 offset:8192
  v_cvt_pk_bf16_f32 v108, v88, v89
  v_exp_f32 v92, v92
  v_exp_f32 v93, v93
  ds_read_b128 v[36:39], v3 offset:9216
  v_cvt_pk_bf16_f32 v109, v90, v91
  v_exp_f32 v94, v94
  v_exp_f32 v95, v95
  v_cvt_pk_bf16_f32 v110, v92, v93
  v_cvt_pk_bf16_f32 v111, v94, v95
  v_mfma_f32_32x32x16_bf16 v[128:143], v[48:51], v[104:107], v[128:143]
  v_exp_f32 v64, v64
  v_exp_f32 v65, v65
  v_exp_f32 v66, v66
  v_exp_f32 v67, v67
  v_mfma_f32_32x32x16_bf16 v[128:143], v[52:55], v[108:111], v[128:143]
  v_cvt_pk_bf16_f32 v96, v64, v65
  v_exp_f32 v68, v68
  v_exp_f32 v69, v69
  v_cvt_pk_bf16_f32 v97, v66, v67
  v_exp_f32 v70, v70
  v_mfma_f32_32x32x16_bf16 v[80:95], v[40:43], v[200:203], 0
  v_exp_f32 v71, v71
  v_cvt_pk_bf16_f32 v98, v68, v69
  v_exp_f32 v72, v72
  v_exp_f32 v73, v73
  v_cvt_pk_bf16_f32 v99, v70, v71
  v_mfma_f32_32x32x16_bf16 v[80:95], v[44:47], v[204:207], v[80:95]
  v_exp_f32 v74, v74
  v_exp_f32 v75, v75
  ds_read_b128 v[48:51], v3 offset:40960
  v_cvt_pk_bf16_f32 v100, v72, v73
  v_exp_f32 v76, v76
  v_exp_f32 v77, v77
  ds_read_b128 v[52:55], v3 offset:41984
  v_cvt_pk_bf16_f32 v101, v74, v75
  v_exp_f32 v78, v78
  s_add_u32 m0, s31, 68608
  s_add_u32 s29, s53, s27
  s_add_u32 s29, s29, 3072
  buffer_load_dwordx4 v2, s[8:11], s29 offen sc1 lds
  v_exp_f32 v79, v79
  v_cvt_pk_bf16_f32 v102, v76, v77
  v_cvt_pk_bf16_f32 v103, v78, v79
  s_waitcnt lgkmcnt(4)
  v_mfma_f32_32x32x16_bf16 v[112:127], v[56:59], v[96:99], v[112:127]
  v_exp_f32 v80, v80
  v_exp_f32 v81, v81
  v_exp_f32 v82, v82
  v_exp_f32 v83, v83
  v_mfma_f32_32x32x16_bf16 v[112:127], v[60:63], v[100:103], v[112:127]
  v_cvt_pk_bf16_f32 v104, v80, v81
  v_exp_f32 v84, v84
  v_exp_f32 v85, v85
  v_cvt_pk_bf16_f32 v105, v82, v83
  v_exp_f32 v86, v86
  s_waitcnt lgkmcnt(2)
  v_mfma_f32_32x32x16_bf16 v[64:79], v[32:35], v[192:195], 0
  v_exp_f32 v87, v87
  v_cvt_pk_bf16_f32 v106, v84, v85
  v_exp_f32 v88, v88
  v_exp_f32 v89, v89
  v_cvt_pk_bf16_f32 v107, v86, v87
  v_mfma_f32_32x32x16_bf16 v[64:79], v[36:39], v[196:199], v[64:79]
  v_exp_f32 v90, v90
  v_exp_f32 v91, v91
  ds_read_b128 v[40:43], v3 offset:10240
  v_cvt_pk_bf16_f32 v108, v88, v89
  v_exp_f32 v92, v92
  v_exp_f32 v93, v93
  ds_read_b128 v[44:47], v3 offset:11264
  v_cvt_pk_bf16_f32 v109, v90, v91
  v_exp_f32 v94, v94
  v_exp_f32 v95, v95
  v_cvt_pk_bf16_f32 v110, v92, v93
  v_cvt_pk_bf16_f32 v111, v94, v95
  v_mfma_f32_32x32x16_bf16 v[128:143], v[56:59], v[104:107], v[128:143]
  v_exp_f32 v64, v64
  v_exp_f32 v65, v65
  v_exp_f32 v66, v66
  v_exp_f32 v67, v67
  v_mfma_f32_32x32x16_bf16 v[128:143], v[60:63], v[108:111], v[128:143]
  v_cvt_pk_bf16_f32 v96, v64, v65
  v_exp_f32 v68, v68
  v_exp_f32 v69, v69
  v_cvt_pk_bf16_f32 v97, v66, v67
  v_exp_f32 v70, v70
  v_mfma_f32_32x32x16_bf16 v[80:95], v[32:35], v[200:203], 0
  v_exp_f32 v71, v71
  v_cvt_pk_bf16_f32 v98, v68, v69
  v_exp_f32 v72, v72
  v_exp_f32 v73, v73
  v_cvt_pk_bf16_f32 v99, v70, v71
  v_mfma_f32_32x32x16_bf16 v[80:95], v[36:39], v[204:207], v[80:95]
  v_exp_f32 v74, v74
  v_exp_f32 v75, v75
  ds_read_b128 v[56:59], v3 offset:43008
  v_cvt_pk_bf16_f32 v100, v72, v73
  v_exp_f32 v76, v76
  v_exp_f32 v77, v77
  ds_read_b128 v[60:63], v3 offset:44032
  v_cvt_pk_bf16_f32 v101, v74, v75
  v_exp_f32 v78, v78
  s_add_u32 m0, s31, 69632
  s_add_u32 s29, s53, s27
  s_add_u32 s29, s29, 4096
  buffer_load_dwordx4 v2, s[8:11], s29 offen sc1 lds
  v_exp_f32 v79, v79
  v_cvt_pk_bf16_f32 v102, v76, v77
  v_cvt_pk_bf16_f32 v103, v78, v79
  s_waitcnt lgkmcnt(4)
  v_mfma_f32_32x32x16_bf16 v[112:127], v[48:51], v[96:99], v[112:127]
  v_exp_f32 v80, v80
  v_exp_f32 v81, v81
  v_exp_f32 v82, v82
  v_exp_f32 v83, v83
  v_mfma_f32_32x32x16_bf16 v[112:127], v[52:55], v[100:103], v[112:127]
  v_cvt_pk_bf16_f32 v104, v80, v81
  v_exp_f32 v84, v84
  v_exp_f32 v85, v85
  v_cvt_pk_bf16_f32 v105, v82, v83
  v_exp_f32 v86, v86
  s_waitcnt lgkmcnt(2)
  v_mfma_f32_32x32x16_bf16 v[64:79], v[40:43], v[192:195], 0
  v_exp_f32 v87, v87
  v_cvt_pk_bf16_f32 v106, v84, v85
  v_exp_f32 v88, v88
  v_exp_f32 v89, v89
  v_cvt_pk_bf16_f32 v107, v86, v87
  v_mfma_f32_32x32x16_bf16 v[64:79], v[44:47], v[196:199], v[64:79]
  v_exp_f32 v90, v90
  v_exp_f32 v91, v91
  ds_read_b128 v[32:35], v3 offset:12288
  v_cvt_pk_bf16_f32 v108, v88, v89
  v_exp_f32 v92, v92
  v_exp_f32 v93, v93
  ds_read_b128 v[36:39], v3 offset:13312
  v_cvt_pk_bf16_f32 v109, v90, v91
  v_exp_f32 v94, v94
  v_exp_f32 v95, v95
  v_cvt_pk_bf16_f32 v110, v92, v93
  v_cvt_pk_bf16_f32 v111, v94, v95
  v_mfma_f32_32x32x16_bf16 v[128:143], v[48:51], v[104:107], v[128:143]
  v_exp_f32 v64, v64
  v_exp_f32 v65, v65
  v_exp_f32 v66, v66
  v_exp_f32 v67, v67
  v_mfma_f32_32x32x16_bf16 v[128:143], v[52:55], v[108:111], v[128:143]
  v_cvt_pk_bf16_f32 v96, v64, v65
  v_exp_f32 v68, v68
  v_exp_f32 v69, v69
  v_cvt_pk_bf16_f32 v97, v66, v67
  v_exp_f32 v70, v70
  v_mfma_f32_32x32x16_bf16 v[80:95], v[40:43], v[200:203], 0
  v_exp_f32 v71, v71
  v_cvt_pk_bf16_f32 v98, v68, v69
  v_exp_f32 v72, v72
  v_exp_f32 v73, v73
  v_cvt_pk_bf16_f32 v99, v70, v71
  v_mfma_f32_32x32x16_bf16 v[80:95], v[44:47], v[204:207], v[80:95]
  v_exp_f32 v74, v74
  v_exp_f32 v75, v75
  ds_read_b128 v[48:51], v3 offset:45056
  v_cvt_pk_bf16_f32 v100, v72, v73
  v_exp_f32 v76, v76
  v_exp_f32 v77, v77
  ds_read_b128 v[52:55], v3 offset:46080
  v_cvt_pk_bf16_f32 v101, v74, v75
  v_exp_f32 v78, v78
  s_add_u32 m0, s31, 70656
  s_add_u32 s29, s53, s27
  s_add_u32 s29, s29, 5120
  buffer_load_dwordx4 v2, s[8:11], s29 offen sc1 lds
  v_exp_f32 v79, v79
  v_cvt_pk_bf16_f32 v102, v76, v77
  v_cvt_pk_bf16_f32 v103, v78, v79
  s_waitcnt lgkmcnt(4)
  v_mfma_f32_32x32x16_bf16 v[112:127], v[56:59], v[96:99], v[112:127]
  v_exp_f32 v80, v80
  v_exp_f32 v81, v81
  v_exp_f32 v82, v82
  v_exp_f32 v83, v83
  v_mfma_f32_32x32x16_bf16 v[112:127], v[60:63], v[100:103], v[112:127]
  v_cvt_pk_bf16_f32 v104, v80, v81
  v_exp_f32 v84, v84
  v_exp_f32 v85, v85
  v_cvt_pk_bf16_f32 v105, v82, v83
  v_exp_f32 v86, v86
  s_waitcnt lgkmcnt(2)
  v_mfma_f32_32x32x16_bf16 v[64:79], v[32:35], v[192:195], 0
  v_exp_f32 v87, v87
  v_cvt_pk_bf16_f32 v106, v84, v85
  v_exp_f32 v88, v88
  v_exp_f32 v89, v89
  v_cvt_pk_bf16_f32 v107, v86, v87
  v_mfma_f32_32x32x16_bf16 v[64:79], v[36:39], v[196:199], v[64:79]
  v_exp_f32 v90, v90
  v_exp_f32 v91, v91
  ds_read_b128 v[40:43], v3 offset:14336
  v_cvt_pk_bf16_f32 v108, v88, v89
  v_exp_f32 v92, v92
  v_exp_f32 v93, v93
  ds_read_b128 v[44:47], v3 offset:15360
  v_cvt_pk_bf16_f32 v109, v90, v91
  v_exp_f32 v94, v94
  v_exp_f32 v95, v95
  v_cvt_pk_bf16_f32 v110, v92, v93
  v_cvt_pk_bf16_f32 v111, v94, v95
  v_mfma_f32_32x32x16_bf16 v[128:143], v[56:59], v[104:107], v[128:143]
  v_exp_f32 v64, v64
  v_exp_f32 v65, v65
  v_exp_f32 v66, v66
  v_exp_f32 v67, v67
  v_mfma_f32_32x32x16_bf16 v[128:143], v[60:63], v[108:111], v[128:143]
  v_cvt_pk_bf16_f32 v96, v64, v65
  v_exp_f32 v68, v68
  v_exp_f32 v69, v69
  v_cvt_pk_bf16_f32 v97, v66, v67
  v_exp_f32 v70, v70
  v_mfma_f32_32x32x16_bf16 v[80:95], v[32:35], v[200:203], 0
  v_exp_f32 v71, v71
  v_cvt_pk_bf16_f32 v98, v68, v69
  v_exp_f32 v72, v72
  v_exp_f32 v73, v73
  v_cvt_pk_bf16_f32 v99, v70, v71
  v_mfma_f32_32x32x16_bf16 v[80:95], v[36:39], v[204:207], v[80:95]
  v_exp_f32 v74, v74
  v_exp_f32 v75, v75
  ds_read_b128 v[56:59], v3 offset:47104
  v_cvt_pk_bf16_f32 v100, v72, v73
  v_exp_f32 v76, v76
  v_exp_f32 v77, v77
  ds_read_b128 v[60:63], v3 offset:48128
  v_cvt_pk_bf16_f32 v101, v74, v75
  v_exp_f32 v78, v78
  s_add_u32 m0, s31, 71680
  s_add_u32 s29, s53, s27
  s_add_u32 s29, s29, 6144
  buffer_load_dwordx4 v2, s[8:11], s29 offen sc1 lds
  v_exp_f32 v79, v79
  v_cvt_pk_bf16_f32 v102, v76, v77
  v_cvt_pk_bf16_f32 v103, v78, v79
  s_waitcnt lgkmcnt(4)
  v_mfma_f32_32x32x16_bf16 v[112:127], v[48:51], v[96:99], v[112:127]
  v_exp_f32 v80, v80
  v_exp_f32 v81, v81
  v_exp_f32 v82, v82
  v_exp_f32 v83, v83
  v_mfma_f32_32x32x16_bf16 v[112:127], v[52:55], v[100:103], v[112:127]
  v_cvt_pk_bf16_f32 v104, v80, v81
  v_exp_f32 v84, v84
  v_exp_f32 v85, v85
  v_cvt_pk_bf16_f32 v105, v82, v83
  v_exp_f32 v86, v86
  s_waitcnt lgkmcnt(2)
  v_mfma_f32_32x32x16_bf16 v[64:79], v[40:43], v[192:195], 0
  v_exp_f32 v87, v87
  v_cvt_pk_bf16_f32 v106, v84, v85
  v_exp_f32 v88, v88
  v_exp_f32 v89, v89
  v_cvt_pk_bf16_f32 v107, v86, v87
  v_mfma_f32_32x32x16_bf16 v[64:79], v[44:47], v[196:199], v[64:79]
  v_exp_f32 v90, v90
  v_exp_f32 v91, v91
  ds_read_b128 v[32:35], v3 offset:16384
  v_cvt_pk_bf16_f32 v108, v88, v89
  v_exp_f32 v92, v92
  v_exp_f32 v93, v93
  ds_read_b128 v[36:39], v3 offset:17408
  v_cvt_pk_bf16_f32 v109, v90, v91
  v_exp_f32 v94, v94
  v_exp_f32 v95, v95
  v_cvt_pk_bf16_f32 v110, v92, v93
  v_cvt_pk_bf16_f32 v111, v94, v95
  v_mfma_f32_32x32x16_bf16 v[128:143], v[48:51], v[104:107], v[128:143]
  v_exp_f32 v64, v64
  v_exp_f32 v65, v65
  v_exp_f32 v66, v66
  v_exp_f32 v67, v67
  v_mfma_f32_32x32x16_bf16 v[128:143], v[52:55], v[108:111], v[128:143]
  v_cvt_pk_bf16_f32 v96, v64, v65
  v_exp_f32 v68, v68
  v_exp_f32 v69, v69
  v_cvt_pk_bf16_f32 v97, v66, v67
  v_exp_f32 v70, v70
  v_mfma_f32_32x32x16_bf16 v[80:95], v[40:43], v[200:203], 0
  v_exp_f32 v71, v71
  v_cvt_pk_bf16_f32 v98, v68, v69
  v_exp_f32 v72, v72
  v_exp_f32 v73, v73
  v_cvt_pk_bf16_f32 v99, v70, v71
  v_mfma_f32_32x32x16_bf16 v[80:95], v[44:47], v[204:207], v[80:95]
  v_exp_f32 v74, v74
  v_exp_f32 v75, v75
  ds_read_b128 v[48:51], v3 offset:49152
  v_cvt_pk_bf16_f32 v100, v72, v73
  v_exp_f32 v76, v76
  v_exp_f32 v77, v77
  ds_read_b128 v[52:55], v3 offset:50176
  v_cvt_pk_bf16_f32 v101, v74, v75
  v_exp_f32 v78, v78
  s_add_u32 m0, s31, 72704
  s_add_u32 s29, s53, s27
  s_add_u32 s29, s29, 7168
  buffer_load_dwordx4 v2, s[8:11], s29 offen sc1 lds
  v_exp_f32 v79, v79
  v_cvt_pk_bf16_f32 v102, v76, v77
  v_cvt_pk_bf16_f32 v103, v78, v79
  s_waitcnt lgkmcnt(4)
  v_mfma_f32_32x32x16_bf16 v[112:127], v[56:59], v[96:99], v[112:127]
  v_exp_f32 v80, v80
  v_exp_f32 v81, v81
  v_exp_f32 v82, v82
  v_exp_f32 v83, v83
  v_mfma_f32_32x32x16_bf16 v[112:127], v[60:63], v[100:103], v[112:127]
  v_cvt_pk_bf16_f32 v104, v80, v81
  v_exp_f32 v84, v84
  v_exp_f32 v85, v85
  v_cvt_pk_bf16_f32 v105, v82, v83
  v_exp_f32 v86, v86
  s_waitcnt lgkmcnt(2)
  v_mfma_f32_32x32x16_bf16 v[64:79], v[32:35], v[192:195], 0
  v_exp_f32 v87, v87
  v_cvt_pk_bf16_f32 v106, v84, v85
  v_exp_f32 v88, v88
  v_exp_f32 v89, v89
  v_cvt_pk_bf16_f32 v107, v86, v87
  v_mfma_f32_32x32x16_bf16 v[64:79], v[36:39], v[196:199], v[64:79]
  v_exp_f32 v90, v90
  v_exp_f32 v91, v91
  ds_read_b128 v[40:43], v3 offset:18432
  v_cvt_pk_bf16_f32 v108, v88, v89
  v_exp_f32 v92, v92
  v_exp_f32 v93, v93
  ds_read_b128 v[44:47], v3 offset:19456
  v_cvt_pk_bf16_f32 v109, v90, v91
  v_exp_f32 v94, v94
  v_exp_f32 v95, v95
  v_cvt_pk_bf16_f32 v110, v92, v93
  v_cvt_pk_bf16_f32 v111, v94, v95
  v_mfma_f32_32x32x16_bf16 v[128:143], v[56:59], v[104:107], v[128:143]
  v_exp_f32 v64, v64
  v_exp_f32 v65, v65
  v_exp_f32 v66, v66
  v_exp_f32 v67, v67
  v_mfma_f32_32x32x16_bf16 v[128:143], v[60:63], v[108:111], v[128:143]
  v_cvt_pk_bf16_f32 v96, v64, v65
  v_exp_f32 v68, v68
  v_exp_f32 v69, v69
  v_cvt_pk_bf16_f32 v97, v66, v67
  v_exp_f32 v70, v70
  v_mfma_f32_32x32x16_bf16 v[80:95], v[32:35], v[200:203], 0
  v_exp_f32 v71, v71
  v_cvt_pk_bf16_f32 v98, v68, v69
  v_exp_f32 v72, v72
  v_exp_f32 v73, v73
  v_cvt_pk_bf16_f32 v99, v70, v71
  v_mfma_f32_32x32x16_bf16 v[80:95], v[36:39], v[204:207], v[80:95]
  v_exp_f32 v74, v74
  v_exp_f32 v75, v75
  ds_read_b128 v[56:59], v3 offset:51200
  v_cvt_pk_bf16_f32 v100, v72, v73
  v_exp_f32 v76, v76
  v_exp_f32 v77, v77
  ds_read_b128 v[60:63], v3 offset:52224
  v_cvt_pk_bf16_f32 v101, v74, v75
  v_exp_f32 v78, v78
  s_add_u32 m0, s31, 98304
  s_add_u32 s29, s53, s28
  s_add_u32 s29, s29, 0
  buffer_load_dwordx4 v2, s[8:11], s29 offen sc1 lds
  v_exp_f32 v79, v79
  v_cvt_pk_bf16_f32 v102, v76, v77
  v_cvt_pk_bf16_f32 v103, v78, v79
  s_waitcnt lgkmcnt(4)
  v_mfma_f32_32x32x16_bf16 v[112:127], v[48:51], v[96:99], v[112:127]
  v_exp_f32 v80, v80
  v_exp_f32 v81, v81
  v_exp_f32 v82, v82
  v_exp_f32 v83, v83
  v_mfma_f32_32x32x16_bf16 v[112:127], v[52:55], v[100:103], v[112:127]
  v_cvt_pk_bf16_f32 v104, v80, v81
  v_exp_f32 v84, v84
  v_exp_f32 v85, v85
  v_cvt_pk_bf16_f32 v105, v82, v83
  v_exp_f32 v86, v86
  s_waitcnt lgkmcnt(2)
  v_mfma_f32_32x32x16_bf16 v[64:79], v[40:43], v[192:195], 0
  v_exp_f32 v87, v87
  v_cvt_pk_bf16_f32 v106, v84, v85
  v_exp_f32 v88, v88
  v_exp_f32 v89, v89
  v_cvt_pk_bf16_f32 v107, v86, v87
  v_mfma_f32_32x32x16_bf16 v[64:79], v[44:47], v[196:199], v[64:79]
  v_exp_f32 v90, v90
  v_exp_f32 v91, v91
  ds_read_b128 v[32:35], v3 offset:20480
  v_cvt_pk_bf16_f32 v108, v88, v89
  v_exp_f32 v92, v92
  v_exp_f32 v93, v93
  ds_read_b128 v[36:39], v3 offset:21504
  v_cvt_pk_bf16_f32 v109, v90, v91
  v_exp_f32 v94, v94
  v_exp_f32 v95, v95
  v_cvt_pk_bf16_f32 v110, v92, v93
  v_cvt_pk_bf16_f32 v111, v94, v95
  v_mfma_f32_32x32x16_bf16 v[128:143], v[48:51], v[104:107], v[128:143]
  v_exp_f32 v64, v64
  v_exp_f32 v65, v65
  v_exp_f32 v66, v66
  v_exp_f32 v67, v67
  v_mfma_f32_32x32x16_bf16 v[128:143], v[52:55], v[108:111], v[128:143]
  v_cvt_pk_bf16_f32 v96, v64, v65
  v_exp_f32 v68, v68
  v_exp_f32 v69, v69
  v_cvt_pk_bf16_f32 v97, v66, v67
  v_exp_f32 v70, v70
  v_mfma_f32_32x32x16_bf16 v[80:95], v[40:43], v[200:203], 0
  v_exp_f32 v71, v71
  v_cvt_pk_bf16_f32 v98, v68, v69
  v_exp_f32 v72, v72
  v_exp_f32 v73, v73
  v_cvt_pk_bf16_f32 v99, v70, v71
  v_mfma_f32_32x32x16_bf16 v[80:95], v[44:47], v[204:207], v[80:95]
  v_exp_f32 v74, v74
  v_exp_f32 v75, v75
  ds_read_b128 v[48:51], v3 offset:53248
  v_cvt_pk_bf16_f32 v100, v72, v73
  v_exp_f32 v76, v76
  v_exp_f32 v77, v77
  ds_read_b128 v[52:55], v3 offset:54272
  v_cvt_pk_bf16_f32 v101, v74, v75
  v_exp_f32 v78, v78
  s_add_u32 m0, s31, 99328
  s_add_u32 s29, s53, s28
  s_add_u32 s29, s29, 1024
  buffer_load_dwordx4 v2, s[8:11], s29 offen sc1 lds
  v_exp_f32 v79, v79
  v_cvt_pk_bf16_f32 v102, v76, v77
  v_cvt_pk_bf16_f32 v103, v78, v79
  s_waitcnt lgkmcnt(4)
  v_mfma_f32_32x32x16_bf16 v[112:127], v[56:59], v[96:99], v[112:127]
  v_exp_f32 v80, v80
  v_exp_f32 v81, v81
  v_exp_f32 v82, v82
  v_exp_f32 v83, v83
  v_mfma_f32_32x32x16_bf16 v[112:127], v[60:63], v[100:103], v[112:127]
  v_cvt_pk_bf16_f32 v104, v80, v81
  v_exp_f32 v84, v84
  v_exp_f32 v85, v85
  v_cvt_pk_bf16_f32 v105, v82, v83
  v_exp_f32 v86, v86
  s_waitcnt lgkmcnt(2)
  v_mfma_f32_32x32x16_bf16 v[64:79], v[32:35], v[192:195], 0
  v_exp_f32 v87, v87
  v_cvt_pk_bf16_f32 v106, v84, v85
  v_exp_f32 v88, v88
  v_exp_f32 v89, v89
  v_cvt_pk_bf16_f32 v107, v86, v87
  v_mfma_f32_32x32x16_bf16 v[64:79], v[36:39], v[196:199], v[64:79]
  v_exp_f32 v90, v90
  v_exp_f32 v91, v91
  ds_read_b128 v[40:43], v3 offset:22528
  v_cvt_pk_bf16_f32 v108, v88, v89
  v_exp_f32 v92, v92
  v_exp_f32 v93, v93
  ds_read_b128 v[44:47], v3 offset:23552
  v_cvt_pk_bf16_f32 v109, v90, v91
  v_exp_f32 v94, v94
  v_exp_f32 v95, v95
  v_cvt_pk_bf16_f32 v110, v92, v93
  v_cvt_pk_bf16_f32 v111, v94, v95
  v_mfma_f32_32x32x16_bf16 v[128:143], v[56:59], v[104:107], v[128:143]
  v_exp_f32 v64, v64
  v_exp_f32 v65, v65
  v_exp_f32 v66, v66
  v_exp_f32 v67, v67
  v_mfma_f32_32x32x16_bf16 v[128:143], v[60:63], v[108:111], v[128:143]
  v_cvt_pk_bf16_f32 v96, v64, v65
  v_exp_f32 v68, v68
  v_exp_f32 v69, v69
  v_cvt_pk_bf16_f32 v97, v66, v67
  v_exp_f32 v70, v70
  v_mfma_f32_32x32x16_bf16 v[80:95], v[32:35], v[200:203], 0
  v_exp_f32 v71, v71
  v_cvt_pk_bf16_f32 v98, v68, v69
  v_exp_f32 v72, v72
  v_exp_f32 v73, v73
  v_cvt_pk_bf16_f32 v99, v70, v71
  v_mfma_f32_32x32x16_bf16 v[80:95], v[36:39], v[204:207], v[80:95]
  v_exp_f32 v74, v74
  v_exp_f32 v75, v75
  ds_read_b128 v[56:59], v3 offset:55296
  v_cvt_pk_bf16_f32 v100, v72, v73
  v_exp_f32 v76, v76
  v_exp_f32 v77, v77
  ds_read_b128 v[60:63], v3 offset:56320
  v_cvt_pk_bf16_f32 v101, v74, v75
  v_exp_f32 v78, v78
  s_add_u32 m0, s31, 100352
  s_add_u32 s29, s53, s28
  s_add_u32 s29, s29, 2048
  buffer_load_dwordx4 v2, s[8:11], s29 offen sc1 lds
  v_exp_f32 v79, v79
  v_cvt_pk_bf16_f32 v102, v76, v77
  v_cvt_pk_bf16_f32 v103, v78, v79
  s_waitcnt lgkmcnt(4)
  v_mfma_f32_32x32x16_bf16 v[112:127], v[48:51], v[96:99], v[112:127]
  v_exp_f32 v80, v80
  v_exp_f32 v81, v81
  v_exp_f32 v82, v82
  v_exp_f32 v83, v83
  v_mfma_f32_32x32x16_bf16 v[112:127], v[52:55], v[100:103], v[112:127]
  v_cvt_pk_bf16_f32 v104, v80, v81
  v_exp_f32 v84, v84
  v_exp_f32 v85, v85
  v_cvt_pk_bf16_f32 v105, v82, v83
  v_exp_f32 v86, v86
  s_waitcnt lgkmcnt(2)
  v_mfma_f32_32x32x16_bf16 v[64:79], v[40:43], v[192:195], 0
  v_exp_f32 v87, v87
  v_cvt_pk_bf16_f32 v106, v84, v85
  v_exp_f32 v88, v88
  v_exp_f32 v89, v89
  v_cvt_pk_bf16_f32 v107, v86, v87
  v_mfma_f32_32x32x16_bf16 v[64:79], v[44:47], v[196:199], v[64:79]
  v_exp_f32 v90, v90
  v_exp_f32 v91, v91
  ds_read_b128 v[32:35], v3 offset:24576
  v_cvt_pk_bf16_f32 v108, v88, v89
  v_exp_f32 v92, v92
  v_exp_f32 v93, v93
  ds_read_b128 v[36:39], v3 offset:25600
  v_cvt_pk_bf16_f32 v109, v90, v91
  v_exp_f32 v94, v94
  v_exp_f32 v95, v95
  v_cvt_pk_bf16_f32 v110, v92, v93
  v_cvt_pk_bf16_f32 v111, v94, v95
  v_mfma_f32_32x32x16_bf16 v[128:143], v[48:51], v[104:107], v[128:143]
  v_exp_f32 v64, v64
  v_exp_f32 v65, v65
  v_exp_f32 v66, v66
  v_exp_f32 v67, v67
  v_mfma_f32_32x32x16_bf16 v[128:143], v[52:55], v[108:111], v[128:143]
  v_cvt_pk_bf16_f32 v96, v64, v65
  v_exp_f32 v68, v68
  v_exp_f32 v69, v69
  v_cvt_pk_bf16_f32 v97, v66, v67
  v_exp_f32 v70, v70
  v_mfma_f32_32x32x16_bf16 v[80:95], v[40:43], v[200:203], 0
  v_exp_f32 v71, v71
  v_cvt_pk_bf16_f32 v98, v68, v69
  v_exp_f32 v72, v72
  v_exp_f32 v73, v73
  v_cvt_pk_bf16_f32 v99, v70, v71
  v_mfma_f32_32x32x16_bf16 v[80:95], v[44:47], v[204:207], v[80:95]
  v_exp_f32 v74, v74
  v_exp_f32 v75, v75
  ds_read_b128 v[48:51], v3 offset:57344
  v_cvt_pk_bf16_f32 v100, v72, v73
  v_exp_f32 v76, v76
  v_exp_f32 v77, v77
  ds_read_b128 v[52:55], v3 offset:58368
  v_cvt_pk_bf16_f32 v101, v74, v75
  v_exp_f32 v78, v78
  s_add_u32 m0, s31, 101376
  s_add_u32 s29, s53, s28
  s_add_u32 s29, s29, 3072
  buffer_load_dwordx4 v2, s[8:11], s29 offen sc1 lds
  v_exp_f32 v79, v79
  v_cvt_pk_bf16_f32 v102, v76, v77
  v_cvt_pk_bf16_f32 v103, v78, v79
  s_waitcnt lgkmcnt(4)
  v_mfma_f32_32x32x16_bf16 v[112:127], v[56:59], v[96:99], v[112:127]
  v_exp_f32 v80, v80
  v_exp_f32 v81, v81
  v_exp_f32 v82, v82
  v_exp_f32 v83, v83
  v_mfma_f32_32x32x16_bf16 v[112:127], v[60:63], v[100:103], v[112:127]
  v_cvt_pk_bf16_f32 v104, v80, v81
  v_exp_f32 v84, v84
  v_exp_f32 v85, v85
  v_cvt_pk_bf16_f32 v105, v82, v83
  v_exp_f32 v86, v86
  s_waitcnt lgkmcnt(2)
  v_mfma_f32_32x32x16_bf16 v[64:79], v[32:35], v[192:195], 0
  v_exp_f32 v87, v87
  v_cvt_pk_bf16_f32 v106, v84, v85
  v_exp_f32 v88, v88
  v_exp_f32 v89, v89
  v_cvt_pk_bf16_f32 v107, v86, v87
  v_mfma_f32_32x32x16_bf16 v[64:79], v[36:39], v[196:199], v[64:79]
  v_exp_f32 v90, v90
  v_exp_f32 v91, v91
  ds_read_b128 v[40:43], v3 offset:26624
  v_cvt_pk_bf16_f32 v108, v88, v89
  v_exp_f32 v92, v92
  v_exp_f32 v93, v93
  ds_read_b128 v[44:47], v3 offset:27648
  v_cvt_pk_bf16_f32 v109, v90, v91
  v_exp_f32 v94, v94
  v_exp_f32 v95, v95
  v_cvt_pk_bf16_f32 v110, v92, v93
  v_cvt_pk_bf16_f32 v111, v94, v95
  v_mfma_f32_32x32x16_bf16 v[128:143], v[56:59], v[104:107], v[128:143]
  v_exp_f32 v64, v64
  v_exp_f32 v65, v65
  v_exp_f32 v66, v66
  v_exp_f32 v67, v67
  v_mfma_f32_32x32x16_bf16 v[128:143], v[60:63], v[108:111], v[128:143]
  v_cvt_pk_bf16_f32 v96, v64, v65
  v_exp_f32 v68, v68
  v_exp_f32 v69, v69
  v_cvt_pk_bf16_f32 v97, v66, v67
  v_exp_f32 v70, v70
  v_mfma_f32_32x32x16_bf16 v[80:95], v[32:35], v[200:203], 0
  v_exp_f32 v71, v71
  v_cvt_pk_bf16_f32 v98, v68, v69
  v_exp_f32 v72, v72
  v_exp_f32 v73, v73
  v_cvt_pk_bf16_f32 v99, v70, v71
  v_mfma_f32_32x32x16_bf16 v[80:95], v[36:39], v[204:207], v[80:95]
  v_exp_f32 v74, v74
  v_exp_f32 v75, v75
  ds_read_b128 v[56:59], v3 offset:59392
  v_cvt_pk_bf16_f32 v100, v72, v73
  v_exp_f32 v76, v76
  v_exp_f32 v77, v77
  ds_read_b128 v[60:63], v3 offset:60416
  v_cvt_pk_bf16_f32 v101, v74, v75
  v_exp_f32 v78, v78
  s_add_u32 m0, s31, 102400
  s_add_u32 s29, s53, s28
  s_add_u32 s29, s29, 4096
  buffer_load_dwordx4 v2, s[8:11], s29 offen sc1 lds
  v_exp_f32 v79, v79
  v_cvt_pk_bf16_f32 v102, v76, v77
  v_cvt_pk_bf16_f32 v103, v78, v79
  s_waitcnt lgkmcnt(4)
  v_mfma_f32_32x32x16_bf16 v[112:127], v[48:51], v[96:99], v[112:127]
  v_exp_f32 v80, v80
  v_exp_f32 v81, v81
  v_exp_f32 v82, v82
  v_exp_f32 v83, v83
  v_mfma_f32_32x32x16_bf16 v[112:127], v[52:55], v[100:103], v[112:127]
  v_cvt_pk_bf16_f32 v104, v80, v81
  v_exp_f32 v84, v84
  v_exp_f32 v85, v85
  v_cvt_pk_bf16_f32 v105, v82, v83
  v_exp_f32 v86, v86
  s_waitcnt lgkmcnt(2)
  v_mfma_f32_32x32x16_bf16 v[64:79], v[40:43], v[192:195], 0
  v_exp_f32 v87, v87
  v_cvt_pk_bf16_f32 v106, v84, v85
  v_exp_f32 v88, v88
  v_exp_f32 v89, v89
  v_cvt_pk_bf16_f32 v107, v86, v87
  v_mfma_f32_32x32x16_bf16 v[64:79], v[44:47], v[196:199], v[64:79]
  v_exp_f32 v90, v90
  v_exp_f32 v91, v91
  ds_read_b128 v[32:35], v3 offset:28672
  v_cvt_pk_bf16_f32 v108, v88, v89
  v_exp_f32 v92, v92
  v_exp_f32 v93, v93
  ds_read_b128 v[36:39], v3 offset:29696
  v_cvt_pk_bf16_f32 v109, v90, v91
  v_exp_f32 v94, v94
  v_exp_f32 v95, v95
  v_cvt_pk_bf16_f32 v110, v92, v93
  v_cvt_pk_bf16_f32 v111, v94, v95
  v_mfma_f32_32x32x16_bf16 v[128:143], v[48:51], v[104:107], v[128:143]
  v_exp_f32 v64, v64
  v_exp_f32 v65, v65
  v_exp_f32 v66, v66
  v_exp_f32 v67, v67
  v_mfma_f32_32x32x16_bf16 v[128:143], v[52:55], v[108:111], v[128:143]
  v_cvt_pk_bf16_f32 v96, v64, v65
  v_exp_f32 v68, v68
  v_exp_f32 v69, v69
  v_cvt_pk_bf16_f32 v97, v66, v67
  v_exp_f32 v70, v70
  v_mfma_f32_32x32x16_bf16 v[80:95], v[40:43], v[200:203], 0
  v_exp_f32 v71, v71
  v_cvt_pk_bf16_f32 v98, v68, v69
  v_exp_f32 v72, v72
  v_exp_f32 v73, v73
  v_cvt_pk_bf16_f32 v99, v70, v71
  v_mfma_f32_32x32x16_bf16 v[80:95], v[44:47], v[204:207], v[80:95]
  v_exp_f32 v74, v74
  v_exp_f32 v75, v75
  ds_read_b128 v[48:51], v3 offset:61440
  v_cvt_pk_bf16_f32 v100, v72, v73
  v_exp_f32 v76, v76
  v_exp_f32 v77, v77
  ds_read_b128 v[52:55], v3 offset:62464
  v_cvt_pk_bf16_f32 v101, v74, v75
  v_exp_f32 v78, v78
  s_add_u32 m0, s31, 103424
  s_add_u32 s29, s53, s28
  s_add_u32 s29, s29, 5120
  buffer_load_dwordx4 v2, s[8:11], s29 offen sc1 lds
  v_exp_f32 v79, v79
  v_cvt_pk_bf16_f32 v102, v76, v77
  v_cvt_pk_bf16_f32 v103, v78, v79
  s_waitcnt lgkmcnt(4)
  v_mfma_f32_32x32x16_bf16 v[112:127], v[56:59], v[96:99], v[112:127]
  v_exp_f32 v80, v80
  v_exp_f32 v81, v81
  v_exp_f32 v82, v82
  v_exp_f32 v83, v83
  v_mfma_f32_32x32x16_bf16 v[112:127], v[60:63], v[100:103], v[112:127]
  v_cvt_pk_bf16_f32 v104, v80, v81
  v_exp_f32 v84, v84
  v_exp_f32 v85, v85
  v_cvt_pk_bf16_f32 v105, v82, v83
  v_exp_f32 v86, v86
  s_waitcnt lgkmcnt(2)
  v_mfma_f32_32x32x16_bf16 v[64:79], v[32:35], v[192:195], 0
  v_exp_f32 v87, v87
  v_cvt_pk_bf16_f32 v106, v84, v85
  v_exp_f32 v88, v88
  v_exp_f32 v89, v89
  v_cvt_pk_bf16_f32 v107, v86, v87
  v_mfma_f32_32x32x16_bf16 v[64:79], v[36:39], v[196:199], v[64:79]
  v_exp_f32 v90, v90
  v_exp_f32 v91, v91
  ds_read_b128 v[40:43], v3 offset:30720
  v_cvt_pk_bf16_f32 v108, v88, v89
  v_exp_f32 v92, v92
  v_exp_f32 v93, v93
  ds_read_b128 v[44:47], v3 offset:31744
  v_cvt_pk_bf16_f32 v109, v90, v91
  v_exp_f32 v94, v94
  v_exp_f32 v95, v95
  v_cvt_pk_bf16_f32 v110, v92, v93
  v_cvt_pk_bf16_f32 v111, v94, v95
  v_mfma_f32_32x32x16_bf16 v[128:143], v[56:59], v[104:107], v[128:143]
  v_exp_f32 v64, v64
  v_exp_f32 v65, v65
  v_exp_f32 v66, v66
  v_exp_f32 v67, v67
  v_mfma_f32_32x32x16_bf16 v[128:143], v[60:63], v[108:111], v[128:143]
  v_cvt_pk_bf16_f32 v96, v64, v65
  v_exp_f32 v68, v68
  v_exp_f32 v69, v69
  v_cvt_pk_bf16_f32 v97, v66, v67
  v_exp_f32 v70, v70
  v_mfma_f32_32x32x16_bf16 v[80:95], v[32:35], v[200:203], 0
  v_exp_f32 v71, v71
  v_cvt_pk_bf16_f32 v98, v68, v69
  v_exp_f32 v72, v72
  v_exp_f32 v73, v73
  v_cvt_pk_bf16_f32 v99, v70, v71
  v_mfma_f32_32x32x16_bf16 v[80:95], v[36:39], v[204:207], v[80:95]
  v_exp_f32 v74, v74
  v_exp_f32 v75, v75
  ds_read_b128 v[56:59], v3 offset:63488
  v_cvt_pk_bf16_f32 v100, v72, v73
  v_exp_f32 v76, v76
  v_exp_f32 v77, v77
  ds_read_b128 v[60:63], v3 offset:64512
  v_cvt_pk_bf16_f32 v101, v74, v75
  v_exp_f32 v78, v78
  s_add_u32 m0, s31, 104448
  s_add_u32 s29, s53, s28
  s_add_u32 s29, s29, 6144
  buffer_load_dwordx4 v2, s[8:11], s29 offen sc1 lds
  v_exp_f32 v79, v79
  v_cvt_pk_bf16_f32 v102, v76, v77
  v_cvt_pk_bf16_f32 v103, v78, v79
  s_waitcnt lgkmcnt(4)
  v_mfma_f32_32x32x16_bf16 v[112:127], v[48:51], v[96:99], v[112:127]
  v_exp_f32 v80, v80
  v_exp_f32 v81, v81
  v_exp_f32 v82, v82
  v_exp_f32 v83, v83
  v_mfma_f32_32x32x16_bf16 v[112:127], v[52:55], v[100:103], v[112:127]
  v_cvt_pk_bf16_f32 v104, v80, v81
  v_exp_f32 v84, v84
  v_exp_f32 v85, v85
  v_cvt_pk_bf16_f32 v105, v82, v83
  v_exp_f32 v86, v86
  s_waitcnt lgkmcnt(2)
  v_mfma_f32_32x32x16_bf16 v[64:79], v[40:43], v[192:195], 0
  v_exp_f32 v87, v87
  v_cvt_pk_bf16_f32 v106, v84, v85
  v_exp_f32 v88, v88
  v_exp_f32 v89, v89
  v_cvt_pk_bf16_f32 v107, v86, v87
  v_mfma_f32_32x32x16_bf16 v[64:79], v[44:47], v[196:199], v[64:79]
  v_exp_f32 v90, v90
  v_exp_f32 v91, v91
  v_cvt_pk_bf16_f32 v108, v88, v89
  v_exp_f32 v92, v92
  v_exp_f32 v93, v93
  v_cvt_pk_bf16_f32 v109, v90, v91
  v_exp_f32 v94, v94
  v_exp_f32 v95, v95
  v_cvt_pk_bf16_f32 v110, v92, v93
  v_cvt_pk_bf16_f32 v111, v94, v95
  v_mfma_f32_32x32x16_bf16 v[128:143], v[48:51], v[104:107], v[128:143]
  v_exp_f32 v64, v64
  v_exp_f32 v65, v65
  v_exp_f32 v66, v66
  v_exp_f32 v67, v67
  v_mfma_f32_32x32x16_bf16 v[128:143], v[52:55], v[108:111], v[128:143]
  v_cvt_pk_bf16_f32 v96, v64, v65
  v_exp_f32 v68, v68
  v_exp_f32 v69, v69
  v_cvt_pk_bf16_f32 v97, v66, v67
  v_exp_f32 v70, v70
  v_mfma_f32_32x32x16_bf16 v[80:95], v[40:43], v[200:203], 0
  v_exp_f32 v71, v71
  v_cvt_pk_bf16_f32 v98, v68, v69
  v_exp_f32 v72, v72
  v_exp_f32 v73, v73
  v_cvt_pk_bf16_f32 v99, v70, v71
  v_mfma_f32_32x32x16_bf16 v[80:95], v[44:47], v[204:207], v[80:95]
  v_exp_f32 v74, v74
  v_exp_f32 v75, v75
  v_cvt_pk_bf16_f32 v100, v72, v73
  v_exp_f32 v76, v76
  v_exp_f32 v77, v77
  v_cvt_pk_bf16_f32 v101, v74, v75
  v_exp_f32 v78, v78
  s_add_u32 m0, s31, 105472
  s_add_u32 s29, s53, s28
  s_add_u32 s29, s29, 7168
  buffer_load_dwordx4 v2, s[8:11], s29 offen sc1 lds
  v_exp_f32 v79, v79
  v_cvt_pk_bf16_f32 v102, v76, v77
  v_cvt_pk_bf16_f32 v103, v78, v79
  s_waitcnt lgkmcnt(0)
  v_mfma_f32_32x32x16_bf16 v[112:127], v[56:59], v[96:99], v[112:127]
  v_exp_f32 v80, v80
  v_exp_f32 v81, v81
  v_exp_f32 v82, v82
  v_exp_f32 v83, v83
  v_mfma_f32_32x32x16_bf16 v[112:127], v[60:63], v[100:103], v[112:127]
  v_cvt_pk_bf16_f32 v104, v80, v81
  v_exp_f32 v84, v84
  v_exp_f32 v85, v85
  v_cvt_pk_bf16_f32 v105, v82, v83
  v_exp_f32 v86, v86
  v_exp_f32 v87, v87
  v_cvt_pk_bf16_f32 v106, v84, v85
  v_exp_f32 v88, v88
  v_exp_f32 v89, v89
  v_cvt_pk_bf16_f32 v107, v86, v87
  v_exp_f32 v90, v90
  v_exp_f32 v91, v91
  v_cvt_pk_bf16_f32 v108, v88, v89
  v_exp_f32 v92, v92
  v_exp_f32 v93, v93
  v_cvt_pk_bf16_f32 v109, v90, v91
  v_exp_f32 v94, v94
  v_exp_f32 v95, v95
  v_cvt_pk_bf16_f32 v110, v92, v93
  v_cvt_pk_bf16_f32 v111, v94, v95
  s_nop 1
  v_mfma_f32_32x32x16_bf16 v[128:143], v[56:59], v[104:107], v[128:143]
  v_mfma_f32_32x32x16_bf16 v[128:143], v[60:63], v[108:111], v[128:143]
  s_waitcnt vmcnt(0)
  s_barrier
  s_add_u32 s41, s41, 1
  s_min_u32 s29, s41, 3
  s_mul_i32 s53, s29, 32768
  s_lshl_b32 s31, s21, 13
  s_add_u32 s53, s53, s31
  ds_read_b128 v[32:35], v4 offset:0
  ds_read_b128 v[36:39], v4 offset:1024
  ds_read_b128 v[48:51], v4 offset:32768
  ds_read_b128 v[52:55], v4 offset:33792
  ds_read_b128 v[40:43], v4 offset:2048
  ds_read_b128 v[44:47], v4 offset:3072
  s_waitcnt lgkmcnt(4)
  v_mfma_f32_32x32x16_bf16 v[64:79], v[32:35], v[192:195], 0
  v_mfma_f32_32x32x16_bf16 v[64:79], v[36:39], v[196:199], v[64:79]
  s_nop 11
  v_exp_f32 v64, v64
  v_exp_f32 v65, v65
  v_exp_f32 v66, v66
  v_exp_f32 v67, v67
  v_cvt_pk_bf16_f32 v96, v64, v65
  v_exp_f32 v68, v68
  v_exp_f32 v69, v69
  v_cvt_pk_bf16_f32 v97, v66, v67
  v_exp_f32 v70, v70
  v_mfma_f32_32x32x16_bf16 v[80:95], v[32:35], v[200:203], 0
  v_exp_f32 v71, v71
  v_cvt_pk_bf16_f32 v98, v68, v69
  v_exp_f32 v72, v72
  v_exp_f32 v73, v73
  v_cvt_pk_bf16_f32 v99, v70, v71
  v_mfma_f32_32x32x16_bf16 v[80:95], v[36:39], v[204:207], v[80:95]
  v_exp_f32 v74, v74
  v_exp_f32 v75, v75
  ds_read_b128 v[56:59], v4 offset:34816
  v_cvt_pk_bf16_f32 v100, v72, v73
  v_exp_f32 v76, v76
  v_exp_f32 v77, v77
  ds_read_b128 v[60:63], v4 offset:35840
  v_cvt_pk_bf16_f32 v101, v74, v75
  v_exp_f32 v78, v78
  s_add_u32 m0, s31, 0
  s_add_u32 s29, s53, s27
  s_add_u32 s29, s29, 0
  buffer_load_dwordx4 v2, s[8:11], s29 offen sc1 lds
  v_exp_f32 v79, v79
  v_cvt_pk_bf16_f32 v102, v76, v77
  v_cvt_pk_bf16_f32 v103, v78, v79
  s_waitcnt lgkmcnt(4)
  v_mfma_f32_32x32x16_bf16 v[112:127], v[48:51], v[96:99], v[112:127]
  v_exp_f32 v80, v80
  v_exp_f32 v81, v81
  v_exp_f32 v82, v82
  v_exp_f32 v83, v83
  v_mfma_f32_32x32x16_bf16 v[112:127], v[52:55], v[100:103], v[112:127]
  v_cvt_pk_bf16_f32 v104, v80, v81
  v_exp_f32 v84, v84
  v_exp_f32 v85, v85
  v_cvt_pk_bf16_f32 v105, v82, v83
  v_exp_f32 v86, v86
  s_waitcnt lgkmcnt(2)
  v_mfma_f32_32x32x16_bf16 v[64:79], v[40:43], v[192:195], 0
  v_exp_f32 v87, v87
  v_cvt_pk_bf16_f32 v106, v84, v85
  v_exp_f32 v88, v88
  v_exp_f32 v89, v89
  v_cvt_pk_bf16_f32 v107, v86, v87
  v_mfma_f32_32x32x16_bf16 v[64:79], v[44:47], v[196:199], v[64:79]
  v_exp_f32 v90, v90
  v_exp_f32 v91, v91
  ds_read_b128 v[32:35], v4 offset:4096
  v_cvt_pk_bf16_f32 v108, v88, v89
  v_exp_f32 v92, v92
  v_exp_f32 v93, v93
  ds_read_b128 v[36:39], v4 offset:5120
  v_cvt_pk_bf16_f32 v109, v90, v91
  v_exp_f32 v94, v94
  v_exp_f32 v95, v95
  v_cvt_pk_bf16_f32 v110, v92, v93
  v_cvt_pk_bf16_f32 v111, v94, v95
  v_mfma_f32_32x32x16_bf16 v[128:143], v[48:51], v[104:107], v[128:143]
  v_exp_f32 v64, v64
  v_exp_f32 v65, v65
  v_exp_f32 v66, v66
  v_exp_f32 v67, v67
  v_mfma_f32_32x32x16_bf16 v[128:143], v[52:55], v[108:111], v[128:143]
  v_cvt_pk_bf16_f32 v96, v64, v65
  v_exp_f32 v68, v68
  v_exp_f32 v69, v69
  v_cvt_pk_bf16_f32 v97, v66, v67
  v_exp_f32 v70, v70
  v_mfma_f32_32x32x16_bf16 v[80:95], v[40:43], v[200:203], 0
  v_exp_f32 v71, v71
  v_cvt_pk_bf16_f32 v98, v68, v69
  v_exp_f32 v72, v72
  v_exp_f32 v73, v73
  v_cvt_pk_bf16_f32 v99, v70, v71
  v_mfma_f32_32x32x16_bf16 v[80:95], v[44:47], v[204:207], v[80:95]
  v_exp_f32 v74, v74
  v_exp_f32 v75, v75
  ds_read_b128 v[48:51], v4 offset:36864
  v_cvt_pk_bf16_f32 v100, v72, v73
  v_exp_f32 v76, v76
  v_exp_f32 v77, v77
  ds_read_b128 v[52:55], v4 offset:37888
  v_cvt_pk_bf16_f32 v101, v74, v75
  v_exp_f32 v78, v78
  s_add_u32 m0, s31, 1024
  s_add_u32 s29, s53, s27
  s_add_u32 s29, s29, 1024
  buffer_load_dwordx4 v2, s[8:11], s29 offen sc1 lds
  v_exp_f32 v79, v79
  v_cvt_pk_bf16_f32 v102, v76, v77
  v_cvt_pk_bf16_f32 v103, v78, v79
  s_waitcnt lgkmcnt(4)
  v_mfma_f32_32x32x16_bf16 v[112:127], v[56:59], v[96:99], v[112:127]
  v_exp_f32 v80, v80
  v_exp_f32 v81, v81
  v_exp_f32 v82, v82
  v_exp_f32 v83, v83
  v_mfma_f32_32x32x16_bf16 v[112:127], v[60:63], v[100:103], v[112:127]
  v_cvt_pk_bf16_f32 v104, v80, v81
  v_exp_f32 v84, v84
  v_exp_f32 v85, v85
  v_cvt_pk_bf16_f32 v105, v82, v83
  v_exp_f32 v86, v86
  s_waitcnt lgkmcnt(2)
  v_mfma_f32_32x32x16_bf16 v[64:79], v[32:35], v[192:195], 0
  v_exp_f32 v87, v87
  v_cvt_pk_bf16_f32 v106, v84, v85
  v_exp_f32 v88, v88
  v_exp_f32 v89, v89
  v_cvt_pk_bf16_f32 v107, v86, v87
  v_mfma_f32_32x32x16_bf16 v[64:79], v[36:39], v[196:199], v[64:79]
  v_exp_f32 v90, v90
  v_exp_f32 v91, v91
  ds_read_b128 v[40:43], v4 offset:6144
  v_cvt_pk_bf16_f32 v108, v88, v89
  v_exp_f32 v92, v92
  v_exp_f32 v93, v93
  ds_read_b128 v[44:47], v4 offset:7168
  v_cvt_pk_bf16_f32 v109, v90, v91
  v_exp_f32 v94, v94
  v_exp_f32 v95, v95
  v_cvt_pk_bf16_f32 v110, v92, v93
  v_cvt_pk_bf16_f32 v111, v94, v95
  v_mfma_f32_32x32x16_bf16 v[128:143], v[56:59], v[104:107], v[128:143]
  v_exp_f32 v64, v64
  v_exp_f32 v65, v65
  v_exp_f32 v66, v66
  v_exp_f32 v67, v67
  v_mfma_f32_32x32x16_bf16 v[128:143], v[60:63], v[108:111], v[128:143]
  v_cvt_pk_bf16_f32 v96, v64, v65
  v_exp_f32 v68, v68
  v_exp_f32 v69, v69
  v_cvt_pk_bf16_f32 v97, v66, v67
  v_exp_f32 v70, v70
  v_mfma_f32_32x32x16_bf16 v[80:95], v[32:35], v[200:203], 0
  v_exp_f32 v71, v71
  v_cvt_pk_bf16_f32 v98, v68, v69
  v_exp_f32 v72, v72
  v_exp_f32 v73, v73
  v_cvt_pk_bf16_f32 v99, v70, v71
  v_mfma_f32_32x32x16_bf16 v[80:95], v[36:39], v[204:207], v[80:95]
  v_exp_f32 v74, v74
  v_exp_f32 v75, v75
  ds_read_b128 v[56:59], v4 offset:38912
  v_cvt_pk_bf16_f32 v100, v72, v73
  v_exp_f32 v76, v76
  v_exp_f32 v77, v77
  ds_read_b128 v[60:63], v4 offset:39936
  v_cvt_pk_bf16_f32 v101, v74, v75
  v_exp_f32 v78, v78
  s_add_u32 m0, s31, 2048
  s_add_u32 s29, s53, s27
  s_add_u32 s29, s29, 2048
  buffer_load_dwordx4 v2, s[8:11], s29 offen sc1 lds
  v_exp_f32 v79, v79
  v_cvt_pk_bf16_f32 v102, v76, v77
  v_cvt_pk_bf16_f32 v103, v78, v79
  s_waitcnt lgkmcnt(4)
  v_mfma_f32_32x32x16_bf16 v[112:127], v[48:51], v[96:99], v[112:127]
  v_exp_f32 v80, v80
  v_exp_f32 v81, v81
  v_exp_f32 v82, v82
  v_exp_f32 v83, v83
  v_mfma_f32_32x32x16_bf16 v[112:127], v[52:55], v[100:103], v[112:127]
  v_cvt_pk_bf16_f32 v104, v80, v81
  v_exp_f32 v84, v84
  v_exp_f32 v85, v85
  v_cvt_pk_bf16_f32 v105, v82, v83
  v_exp_f32 v86, v86
  s_waitcnt lgkmcnt(2)
  v_mfma_f32_32x32x16_bf16 v[64:79], v[40:43], v[192:195], 0
  v_exp_f32 v87, v87
  v_cvt_pk_bf16_f32 v106, v84, v85
  v_exp_f32 v88, v88
  v_exp_f32 v89, v89
  v_cvt_pk_bf16_f32 v107, v86, v87
  v_mfma_f32_32x32x16_bf16 v[64:79], v[44:47], v[196:199], v[64:79]
  v_exp_f32 v90, v90
  v_exp_f32 v91, v91
  ds_read_b128 v[32:35], v4 offset:8192
  v_cvt_pk_bf16_f32 v108, v88, v89
  v_exp_f32 v92, v92
  v_exp_f32 v93, v93
  ds_read_b128 v[36:39], v4 offset:9216
  v_cvt_pk_bf16_f32 v109, v90, v91
  v_exp_f32 v94, v94
  v_exp_f32 v95, v95
  v_cvt_pk_bf16_f32 v110, v92, v93
  v_cvt_pk_bf16_f32 v111, v94, v95
  v_mfma_f32_32x32x16_bf16 v[128:143], v[48:51], v[104:107], v[128:143]
  v_exp_f32 v64, v64
  v_exp_f32 v65, v65
  v_exp_f32 v66, v66
  v_exp_f32 v67, v67
  v_mfma_f32_32x32x16_bf16 v[128:143], v[52:55], v[108:111], v[128:143]
  v_cvt_pk_bf16_f32 v96, v64, v65
  v_exp_f32 v68, v68
  v_exp_f32 v69, v69
  v_cvt_pk_bf16_f32 v97, v66, v67
  v_exp_f32 v70, v70
  v_mfma_f32_32x32x16_bf16 v[80:95], v[40:43], v[200:203], 0
  v_exp_f32 v71, v71
  v_cvt_pk_bf16_f32 v98, v68, v69
  v_exp_f32 v72, v72
  v_exp_f32 v73, v73
  v_cvt_pk_bf16_f32 v99, v70, v71
  v_mfma_f32_32x32x16_bf16 v[80:95], v[44:47], v[204:207], v[80:95]
  v_exp_f32 v74, v74
  v_exp_f32 v75, v75
  ds_read_b128 v[48:51], v4 offset:40960
  v_cvt_pk_bf16_f32 v100, v72, v73
  v_exp_f32 v76, v76
  v_exp_f32 v77, v77
  ds_read_b128 v[52:55], v4 offset:41984
  v_cvt_pk_bf16_f32 v101, v74, v75
  v_exp_f32 v78, v78
  s_add_u32 m0, s31, 3072
  s_add_u32 s29, s53, s27
  s_add_u32 s29, s29, 3072
  buffer_load_dwordx4 v2, s[8:11], s29 offen sc1 lds
  v_exp_f32 v79, v79
  v_cvt_pk_bf16_f32 v102, v76, v77
  v_cvt_pk_bf16_f32 v103, v78, v79
  s_waitcnt lgkmcnt(4)
  v_mfma_f32_32x32x16_bf16 v[112:127], v[56:59], v[96:99], v[112:127]
  v_exp_f32 v80, v80
  v_exp_f32 v81, v81
  v_exp_f32 v82, v82
  v_exp_f32 v83, v83
  v_mfma_f32_32x32x16_bf16 v[112:127], v[60:63], v[100:103], v[112:127]
  v_cvt_pk_bf16_f32 v104, v80, v81
  v_exp_f32 v84, v84
  v_exp_f32 v85, v85
  v_cvt_pk_bf16_f32 v105, v82, v83
  v_exp_f32 v86, v86
  s_waitcnt lgkmcnt(2)
  v_mfma_f32_32x32x16_bf16 v[64:79], v[32:35], v[192:195], 0
  v_exp_f32 v87, v87
  v_cvt_pk_bf16_f32 v106, v84, v85
  v_exp_f32 v88, v88
  v_exp_f32 v89, v89
  v_cvt_pk_bf16_f32 v107, v86, v87
  v_mfma_f32_32x32x16_bf16 v[64:79], v[36:39], v[196:199], v[64:79]
  v_exp_f32 v90, v90
  v_exp_f32 v91, v91
  ds_read_b128 v[40:43], v4 offset:10240
  v_cvt_pk_bf16_f32 v108, v88, v89
  v_exp_f32 v92, v92
  v_exp_f32 v93, v93
  ds_read_b128 v[44:47], v4 offset:11264
  v_cvt_pk_bf16_f32 v109, v90, v91
  v_exp_f32 v94, v94
  v_exp_f32 v95, v95
  v_cvt_pk_bf16_f32 v110, v92, v93
  v_cvt_pk_bf16_f32 v111, v94, v95
  v_mfma_f32_32x32x16_bf16 v[128:143], v[56:59], v[104:107], v[128:143]
  v_exp_f32 v64, v64
  v_exp_f32 v65, v65
  v_exp_f32 v66, v66
  v_exp_f32 v67, v67
  v_mfma_f32_32x32x16_bf16 v[128:143], v[60:63], v[108:111], v[128:143]
  v_cvt_pk_bf16_f32 v96, v64, v65
  v_exp_f32 v68, v68
  v_exp_f32 v69, v69
  v_cvt_pk_bf16_f32 v97, v66, v67
  v_exp_f32 v70, v70
  v_mfma_f32_32x32x16_bf16 v[80:95], v[32:35], v[200:203], 0
  v_exp_f32 v71, v71
  v_cvt_pk_bf16_f32 v98, v68, v69
  v_exp_f32 v72, v72
  v_exp_f32 v73, v73
  v_cvt_pk_bf16_f32 v99, v70, v71
  v_mfma_f32_32x32x16_bf16 v[80:95], v[36:39], v[204:207], v[80:95]
  v_exp_f32 v74, v74
  v_exp_f32 v75, v75
  ds_read_b128 v[56:59], v4 offset:43008
  v_cvt_pk_bf16_f32 v100, v72, v73
  v_exp_f32 v76, v76
  v_exp_f32 v77, v77
  ds_read_b128 v[60:63], v4 offset:44032
  v_cvt_pk_bf16_f32 v101, v74, v75
  v_exp_f32 v78, v78
  s_add_u32 m0, s31, 4096
  s_add_u32 s29, s53, s27
  s_add_u32 s29, s29, 4096
  buffer_load_dwordx4 v2, s[8:11], s29 offen sc1 lds
  v_exp_f32 v79, v79
  v_cvt_pk_bf16_f32 v102, v76, v77
  v_cvt_pk_bf16_f32 v103, v78, v79
  s_waitcnt lgkmcnt(4)
  v_mfma_f32_32x32x16_bf16 v[112:127], v[48:51], v[96:99], v[112:127]
  v_exp_f32 v80, v80
  v_exp_f32 v81, v81
  v_exp_f32 v82, v82
  v_exp_f32 v83, v83
  v_mfma_f32_32x32x16_bf16 v[112:127], v[52:55], v[100:103], v[112:127]
  v_cvt_pk_bf16_f32 v104, v80, v81
  v_exp_f32 v84, v84
  v_exp_f32 v85, v85
  v_cvt_pk_bf16_f32 v105, v82, v83
  v_exp_f32 v86, v86
  s_waitcnt lgkmcnt(2)
  v_mfma_f32_32x32x16_bf16 v[64:79], v[40:43], v[192:195], 0
  v_exp_f32 v87, v87
  v_cvt_pk_bf16_f32 v106, v84, v85
  v_exp_f32 v88, v88
  v_exp_f32 v89, v89
  v_cvt_pk_bf16_f32 v107, v86, v87
  v_mfma_f32_32x32x16_bf16 v[64:79], v[44:47], v[196:199], v[64:79]
  v_exp_f32 v90, v90
  v_exp_f32 v91, v91
  ds_read_b128 v[32:35], v4 offset:12288
  v_cvt_pk_bf16_f32 v108, v88, v89
  v_exp_f32 v92, v92
  v_exp_f32 v93, v93
  ds_read_b128 v[36:39], v4 offset:13312
  v_cvt_pk_bf16_f32 v109, v90, v91
  v_exp_f32 v94, v94
  v_exp_f32 v95, v95
  v_cvt_pk_bf16_f32 v110, v92, v93
  v_cvt_pk_bf16_f32 v111, v94, v95
  v_mfma_f32_32x32x16_bf16 v[128:143], v[48:51], v[104:107], v[128:143]
  v_exp_f32 v64, v64
  v_exp_f32 v65, v65
  v_exp_f32 v66, v66
  v_exp_f32 v67, v67
  v_mfma_f32_32x32x16_bf16 v[128:143], v[52:55], v[108:111], v[128:143]
  v_cvt_pk_bf16_f32 v96, v64, v65
  v_exp_f32 v68, v68
  v_exp_f32 v69, v69
  v_cvt_pk_bf16_f32 v97, v66, v67
  v_exp_f32 v70, v70
  v_mfma_f32_32x32x16_bf16 v[80:95], v[40:43], v[200:203], 0
  v_exp_f32 v71, v71
  v_cvt_pk_bf16_f32 v98, v68, v69
  v_exp_f32 v72, v72
  v_exp_f32 v73, v73
  v_cvt_pk_bf16_f32 v99, v70, v71
  v_mfma_f32_32x32x16_bf16 v[80:95], v[44:47], v[204:207], v[80:95]
  v_exp_f32 v74, v74
  v_exp_f32 v75, v75
  ds_read_b128 v[48:51], v4 offset:45056
  v_cvt_pk_bf16_f32 v100, v72, v73
  v_exp_f32 v76, v76
  v_exp_f32 v77, v77
  ds_read_b128 v[52:55], v4 offset:46080
  v_cvt_pk_bf16_f32 v101, v74, v75
  v_exp_f32 v78, v78
  s_add_u32 m0, s31, 5120
  s_add_u32 s29, s53, s27
  s_add_u32 s29, s29, 5120
  buffer_load_dwordx4 v2, s[8:11], s29 offen sc1 lds
  v_exp_f32 v79, v79
  v_cvt_pk_bf16_f32 v102, v76, v77
  v_cvt_pk_bf16_f32 v103, v78, v79
  s_waitcnt lgkmcnt(4)
  v_mfma_f32_32x32x16_bf16 v[112:127], v[56:59], v[96:99], v[112:127]
  v_exp_f32 v80, v80
  v_exp_f32 v81, v81
  v_exp_f32 v82, v82
  v_exp_f32 v83, v83
  v_mfma_f32_32x32x16_bf16 v[112:127], v[60:63], v[100:103], v[112:127]
  v_cvt_pk_bf16_f32 v104, v80, v81
  v_exp_f32 v84, v84
  v_exp_f32 v85, v85
  v_cvt_pk_bf16_f32 v105, v82, v83
  v_exp_f32 v86, v86
  s_waitcnt lgkmcnt(2)
  v_mfma_f32_32x32x16_bf16 v[64:79], v[32:35], v[192:195], 0
  v_exp_f32 v87, v87
  v_cvt_pk_bf16_f32 v106, v84, v85
  v_exp_f32 v88, v88
  v_exp_f32 v89, v89
  v_cvt_pk_bf16_f32 v107, v86, v87
  v_mfma_f32_32x32x16_bf16 v[64:79], v[36:39], v[196:199], v[64:79]
  v_exp_f32 v90, v90
  v_exp_f32 v91, v91
  ds_read_b128 v[40:43], v4 offset:14336
  v_cvt_pk_bf16_f32 v108, v88, v89
  v_exp_f32 v92, v92
  v_exp_f32 v93, v93
  ds_read_b128 v[44:47], v4 offset:15360
  v_cvt_pk_bf16_f32 v109, v90, v91
  v_exp_f32 v94, v94
  v_exp_f32 v95, v95
  v_cvt_pk_bf16_f32 v110, v92, v93
  v_cvt_pk_bf16_f32 v111, v94, v95
  v_mfma_f32_32x32x16_bf16 v[128:143], v[56:59], v[104:107], v[128:143]
  v_exp_f32 v64, v64
  v_exp_f32 v65, v65
  v_exp_f32 v66, v66
  v_exp_f32 v67, v67
  v_mfma_f32_32x32x16_bf16 v[128:143], v[60:63], v[108:111], v[128:143]
  v_cvt_pk_bf16_f32 v96, v64, v65
  v_exp_f32 v68, v68
  v_exp_f32 v69, v69
  v_cvt_pk_bf16_f32 v97, v66, v67
  v_exp_f32 v70, v70
  v_mfma_f32_32x32x16_bf16 v[80:95], v[32:35], v[200:203], 0
  v_exp_f32 v71, v71
  v_cvt_pk_bf16_f32 v98, v68, v69
  v_exp_f32 v72, v72
  v_exp_f32 v73, v73
  v_cvt_pk_bf16_f32 v99, v70, v71
  v_mfma_f32_32x32x16_bf16 v[80:95], v[36:39], v[204:207], v[80:95]
  v_exp_f32 v74, v74
  v_exp_f32 v75, v75
  ds_read_b128 v[56:59], v4 offset:47104
  v_cvt_pk_bf16_f32 v100, v72, v73
  v_exp_f32 v76, v76
  v_exp_f32 v77, v77
  ds_read_b128 v[60:63], v4 offset:48128
  v_cvt_pk_bf16_f32 v101, v74, v75
  v_exp_f32 v78, v78
  s_add_u32 m0, s31, 6144
  s_add_u32 s29, s53, s27
  s_add_u32 s29, s29, 6144
  buffer_load_dwordx4 v2, s[8:11], s29 offen sc1 lds
  v_exp_f32 v79, v79
  v_cvt_pk_bf16_f32 v102, v76, v77
  v_cvt_pk_bf16_f32 v103, v78, v79
  s_waitcnt lgkmcnt(4)
  v_mfma_f32_32x32x16_bf16 v[112:127], v[48:51], v[96:99], v[112:127]
  v_exp_f32 v80, v80
  v_exp_f32 v81, v81
  v_exp_f32 v82, v82
  v_exp_f32 v83, v83
  v_mfma_f32_32x32x16_bf16 v[112:127], v[52:55], v[100:103], v[112:127]
  v_cvt_pk_bf16_f32 v104, v80, v81
  v_exp_f32 v84, v84
  v_exp_f32 v85, v85
  v_cvt_pk_bf16_f32 v105, v82, v83
  v_exp_f32 v86, v86
  s_waitcnt lgkmcnt(2)
  v_mfma_f32_32x32x16_bf16 v[64:79], v[40:43], v[192:195], 0
  v_exp_f32 v87, v87
  v_cvt_pk_bf16_f32 v106, v84, v85
  v_exp_f32 v88, v88
  v_exp_f32 v89, v89
  v_cvt_pk_bf16_f32 v107, v86, v87
  v_mfma_f32_32x32x16_bf16 v[64:79], v[44:47], v[196:199], v[64:79]
  v_exp_f32 v90, v90
  v_exp_f32 v91, v91
  ds_read_b128 v[32:35], v4 offset:16384
  v_cvt_pk_bf16_f32 v108, v88, v89
  v_exp_f32 v92, v92
  v_exp_f32 v93, v93
  ds_read_b128 v[36:39], v4 offset:17408
  v_cvt_pk_bf16_f32 v109, v90, v91
  v_exp_f32 v94, v94
  v_exp_f32 v95, v95
  v_cvt_pk_bf16_f32 v110, v92, v93
  v_cvt_pk_bf16_f32 v111, v94, v95
  v_mfma_f32_32x32x16_bf16 v[128:143], v[48:51], v[104:107], v[128:143]
  v_exp_f32 v64, v64
  v_exp_f32 v65, v65
  v_exp_f32 v66, v66
  v_exp_f32 v67, v67
  v_mfma_f32_32x32x16_bf16 v[128:143], v[52:55], v[108:111], v[128:143]
  v_cvt_pk_bf16_f32 v96, v64, v65
  v_exp_f32 v68, v68
  v_exp_f32 v69, v69
  v_cvt_pk_bf16_f32 v97, v66, v67
  v_exp_f32 v70, v70
  v_mfma_f32_32x32x16_bf16 v[80:95], v[40:43], v[200:203], 0
  v_exp_f32 v71, v71
  v_cvt_pk_bf16_f32 v98, v68, v69
  v_exp_f32 v72, v72
  v_exp_f32 v73, v73
  v_cvt_pk_bf16_f32 v99, v70, v71
  v_mfma_f32_32x32x16_bf16 v[80:95], v[44:47], v[204:207], v[80:95]
  v_exp_f32 v74, v74
  v_exp_f32 v75, v75
  ds_read_b128 v[48:51], v4 offset:49152
  v_cvt_pk_bf16_f32 v100, v72, v73
  v_exp_f32 v76, v76
  v_exp_f32 v77, v77
  ds_read_b128 v[52:55], v4 offset:50176
  v_cvt_pk_bf16_f32 v101, v74, v75
  v_exp_f32 v78, v78
  s_add_u32 m0, s31, 7168
  s_add_u32 s29, s53, s27
  s_add_u32 s29, s29, 7168
  buffer_load_dwordx4 v2, s[8:11], s29 offen sc1 lds
  v_exp_f32 v79, v79
  v_cvt_pk_bf16_f32 v102, v76, v77
  v_cvt_pk_bf16_f32 v103, v78, v79
  s_waitcnt lgkmcnt(4)
  v_mfma_f32_32x32x16_bf16 v[112:127], v[56:59], v[96:99], v[112:127]
  v_exp_f32 v80, v80
  v_exp_f32 v81, v81
  v_exp_f32 v82, v82
  v_exp_f32 v83, v83
  v_mfma_f32_32x32x16_bf16 v[112:127], v[60:63], v[100:103], v[112:127]
  v_cvt_pk_bf16_f32 v104, v80, v81
  v_exp_f32 v84, v84
  v_exp_f32 v85, v85
  v_cvt_pk_bf16_f32 v105, v82, v83
  v_exp_f32 v86, v86
  s_waitcnt lgkmcnt(2)
  v_mfma_f32_32x32x16_bf16 v[64:79], v[32:35], v[192:195], 0
  v_exp_f32 v87, v87
  v_cvt_pk_bf16_f32 v106, v84, v85
  v_exp_f32 v88, v88
  v_exp_f32 v89, v89
  v_cvt_pk_bf16_f32 v107, v86, v87
  v_mfma_f32_32x32x16_bf16 v[64:79], v[36:39], v[196:199], v[64:79]
  v_exp_f32 v90, v90
  v_exp_f32 v91, v91
  ds_read_b128 v[40:43], v4 offset:18432
  v_cvt_pk_bf16_f32 v108, v88, v89
  v_exp_f32 v92, v92
  v_exp_f32 v93, v93
  ds_read_b128 v[44:47], v4 offset:19456
  v_cvt_pk_bf16_f32 v109, v90, v91
  v_exp_f32 v94, v94
  v_exp_f32 v95, v95
  v_cvt_pk_bf16_f32 v110, v92, v93
  v_cvt_pk_bf16_f32 v111, v94, v95
  v_mfma_f32_32x32x16_bf16 v[128:143], v[56:59], v[104:107], v[128:143]
  v_exp_f32 v64, v64
  v_exp_f32 v65, v65
  v_exp_f32 v66, v66
  v_exp_f32 v67, v67
  v_mfma_f32_32x32x16_bf16 v[128:143], v[60:63], v[108:111], v[128:143]
  v_cvt_pk_bf16_f32 v96, v64, v65
  v_exp_f32 v68, v68
  v_exp_f32 v69, v69
  v_cvt_pk_bf16_f32 v97, v66, v67
  v_exp_f32 v70, v70
  v_mfma_f32_32x32x16_bf16 v[80:95], v[32:35], v[200:203], 0
  v_exp_f32 v71, v71
  v_cvt_pk_bf16_f32 v98, v68, v69
  v_exp_f32 v72, v72
  v_exp_f32 v73, v73
  v_cvt_pk_bf16_f32 v99, v70, v71
  v_mfma_f32_32x32x16_bf16 v[80:95], v[36:39], v[204:207], v[80:95]
  v_exp_f32 v74, v74
  v_exp_f32 v75, v75
  ds_read_b128 v[56:59], v4 offset:51200
  v_cvt_pk_bf16_f32 v100, v72, v73
  v_exp_f32 v76, v76
  v_exp_f32 v77, v77
  ds_read_b128 v[60:63], v4 offset:52224
  v_cvt_pk_bf16_f32 v101, v74, v75
  v_exp_f32 v78, v78
  s_add_u32 m0, s31, 32768
  s_add_u32 s29, s53, s28
  s_add_u32 s29, s29, 0
  buffer_load_dwordx4 v2, s[8:11], s29 offen sc1 lds
  v_exp_f32 v79, v79
  v_cvt_pk_bf16_f32 v102, v76, v77
  v_cvt_pk_bf16_f32 v103, v78, v79
  s_waitcnt lgkmcnt(4)
  v_mfma_f32_32x32x16_bf16 v[112:127], v[48:51], v[96:99], v[112:127]
  v_exp_f32 v80, v80
  v_exp_f32 v81, v81
  v_exp_f32 v82, v82
  v_exp_f32 v83, v83
  v_mfma_f32_32x32x16_bf16 v[112:127], v[52:55], v[100:103], v[112:127]
  v_cvt_pk_bf16_f32 v104, v80, v81
  v_exp_f32 v84, v84
  v_exp_f32 v85, v85
  v_cvt_pk_bf16_f32 v105, v82, v83
  v_exp_f32 v86, v86
  s_waitcnt lgkmcnt(2)
  v_mfma_f32_32x32x16_bf16 v[64:79], v[40:43], v[192:195], 0
  v_exp_f32 v87, v87
  v_cvt_pk_bf16_f32 v106, v84, v85
  v_exp_f32 v88, v88
  v_exp_f32 v89, v89
  v_cvt_pk_bf16_f32 v107, v86, v87
  v_mfma_f32_32x32x16_bf16 v[64:79], v[44:47], v[196:199], v[64:79]
  v_exp_f32 v90, v90
  v_exp_f32 v91, v91
  ds_read_b128 v[32:35], v4 offset:20480
  v_cvt_pk_bf16_f32 v108, v88, v89
  v_exp_f32 v92, v92
  v_exp_f32 v93, v93
  ds_read_b128 v[36:39], v4 offset:21504
  v_cvt_pk_bf16_f32 v109, v90, v91
  v_exp_f32 v94, v94
  v_exp_f32 v95, v95
  v_cvt_pk_bf16_f32 v110, v92, v93
  v_cvt_pk_bf16_f32 v111, v94, v95
  v_mfma_f32_32x32x16_bf16 v[128:143], v[48:51], v[104:107], v[128:143]
  v_exp_f32 v64, v64
  v_exp_f32 v65, v65
  v_exp_f32 v66, v66
  v_exp_f32 v67, v67
  v_mfma_f32_32x32x16_bf16 v[128:143], v[52:55], v[108:111], v[128:143]
  v_cvt_pk_bf16_f32 v96, v64, v65
  v_exp_f32 v68, v68
  v_exp_f32 v69, v69
  v_cvt_pk_bf16_f32 v97, v66, v67
  v_exp_f32 v70, v70
  v_mfma_f32_32x32x16_bf16 v[80:95], v[40:43], v[200:203], 0
  v_exp_f32 v71, v71
  v_cvt_pk_bf16_f32 v98, v68, v69
  v_exp_f32 v72, v72
  v_exp_f32 v73, v73
  v_cvt_pk_bf16_f32 v99, v70, v71
  v_mfma_f32_32x32x16_bf16 v[80:95], v[44:47], v[204:207], v[80:95]
  v_exp_f32 v74, v74
  v_exp_f32 v75, v75
  ds_read_b128 v[48:51], v4 offset:53248
  v_cvt_pk_bf16_f32 v100, v72, v73
  v_exp_f32 v76, v76
  v_exp_f32 v77, v77
  ds_read_b128 v[52:55], v4 offset:54272
  v_cvt_pk_bf16_f32 v101, v74, v75
  v_exp_f32 v78, v78
  s_add_u32 m0, s31, 33792
  s_add_u32 s29, s53, s28
  s_add_u32 s29, s29, 1024
  buffer_load_dwordx4 v2, s[8:11], s29 offen sc1 lds
  v_exp_f32 v79, v79
  v_cvt_pk_bf16_f32 v102, v76, v77
  v_cvt_pk_bf16_f32 v103, v78, v79
  s_waitcnt lgkmcnt(4)
  v_mfma_f32_32x32x16_bf16 v[112:127], v[56:59], v[96:99], v[112:127]
  v_exp_f32 v80, v80
  v_exp_f32 v81, v81
  v_exp_f32 v82, v82
  v_exp_f32 v83, v83
  v_mfma_f32_32x32x16_bf16 v[112:127], v[60:63], v[100:103], v[112:127]
  v_cvt_pk_bf16_f32 v104, v80, v81
  v_exp_f32 v84, v84
  v_exp_f32 v85, v85
  v_cvt_pk_bf16_f32 v105, v82, v83
  v_exp_f32 v86, v86
  s_waitcnt lgkmcnt(2)
  v_mfma_f32_32x32x16_bf16 v[64:79], v[32:35], v[192:195], 0
  v_exp_f32 v87, v87
  v_cvt_pk_bf16_f32 v106, v84, v85
  v_exp_f32 v88, v88
  v_exp_f32 v89, v89
  v_cvt_pk_bf16_f32 v107, v86, v87
  v_mfma_f32_32x32x16_bf16 v[64:79], v[36:39], v[196:199], v[64:79]
  v_exp_f32 v90, v90
  v_exp_f32 v91, v91
  ds_read_b128 v[40:43], v4 offset:22528
  v_cvt_pk_bf16_f32 v108, v88, v89
  v_exp_f32 v92, v92
  v_exp_f32 v93, v93
  ds_read_b128 v[44:47], v4 offset:23552
  v_cvt_pk_bf16_f32 v109, v90, v91
  v_exp_f32 v94, v94
  v_exp_f32 v95, v95
  v_cvt_pk_bf16_f32 v110, v92, v93
  v_cvt_pk_bf16_f32 v111, v94, v95
  v_mfma_f32_32x32x16_bf16 v[128:143], v[56:59], v[104:107], v[128:143]
  v_exp_f32 v64, v64
  v_exp_f32 v65, v65
  v_exp_f32 v66, v66
  v_exp_f32 v67, v67
  v_mfma_f32_32x32x16_bf16 v[128:143], v[60:63], v[108:111], v[128:143]
  v_cvt_pk_bf16_f32 v96, v64, v65
  v_exp_f32 v68, v68
  v_exp_f32 v69, v69
  v_cvt_pk_bf16_f32 v97, v66, v67
  v_exp_f32 v70, v70
  v_mfma_f32_32x32x16_bf16 v[80:95], v[32:35], v[200:203], 0
  v_exp_f32 v71, v71
  v_cvt_pk_bf16_f32 v98, v68, v69
  v_exp_f32 v72, v72
  v_exp_f32 v73, v73
  v_cvt_pk_bf16_f32 v99, v70, v71
  v_mfma_f32_32x32x16_bf16 v[80:95], v[36:39], v[204:207], v[80:95]
  v_exp_f32 v74, v74
  v_exp_f32 v75, v75
  ds_read_b128 v[56:59], v4 offset:55296
  v_cvt_pk_bf16_f32 v100, v72, v73
  v_exp_f32 v76, v76
  v_exp_f32 v77, v77
  ds_read_b128 v[60:63], v4 offset:56320
  v_cvt_pk_bf16_f32 v101, v74, v75
  v_exp_f32 v78, v78
  s_add_u32 m0, s31, 34816
  s_add_u32 s29, s53, s28
  s_add_u32 s29, s29, 2048
  buffer_load_dwordx4 v2, s[8:11], s29 offen sc1 lds
  v_exp_f32 v79, v79
  v_cvt_pk_bf16_f32 v102, v76, v77
  v_cvt_pk_bf16_f32 v103, v78, v79
  s_waitcnt lgkmcnt(4)
  v_mfma_f32_32x32x16_bf16 v[112:127], v[48:51], v[96:99], v[112:127]
  v_exp_f32 v80, v80
  v_exp_f32 v81, v81
  v_exp_f32 v82, v82
  v_exp_f32 v83, v83
  v_mfma_f32_32x32x16_bf16 v[112:127], v[52:55], v[100:103], v[112:127]
  v_cvt_pk_bf16_f32 v104, v80, v81
  v_exp_f32 v84, v84
  v_exp_f32 v85, v85
  v_cvt_pk_bf16_f32 v105, v82, v83
  v_exp_f32 v86, v86
  s_waitcnt lgkmcnt(2)
  v_mfma_f32_32x32x16_bf16 v[64:79], v[40:43], v[192:195], 0
  v_exp_f32 v87, v87
  v_cvt_pk_bf16_f32 v106, v84, v85
  v_exp_f32 v88, v88
  v_exp_f32 v89, v89
  v_cvt_pk_bf16_f32 v107, v86, v87
  v_mfma_f32_32x32x16_bf16 v[64:79], v[44:47], v[196:199], v[64:79]
  v_exp_f32 v90, v90
  v_exp_f32 v91, v91
  ds_read_b128 v[32:35], v4 offset:24576
  v_cvt_pk_bf16_f32 v108, v88, v89
  v_exp_f32 v92, v92
  v_exp_f32 v93, v93
  ds_read_b128 v[36:39], v4 offset:25600
  v_cvt_pk_bf16_f32 v109, v90, v91
  v_exp_f32 v94, v94
  v_exp_f32 v95, v95
  v_cvt_pk_bf16_f32 v110, v92, v93
  v_cvt_pk_bf16_f32 v111, v94, v95
  v_mfma_f32_32x32x16_bf16 v[128:143], v[48:51], v[104:107], v[128:143]
  v_exp_f32 v64, v64
  v_exp_f32 v65, v65
  v_exp_f32 v66, v66
  v_exp_f32 v67, v67
  v_mfma_f32_32x32x16_bf16 v[128:143], v[52:55], v[108:111], v[128:143]
  v_cvt_pk_bf16_f32 v96, v64, v65
  v_exp_f32 v68, v68
  v_exp_f32 v69, v69
  v_cvt_pk_bf16_f32 v97, v66, v67
  v_exp_f32 v70, v70
  v_mfma_f32_32x32x16_bf16 v[80:95], v[40:43], v[200:203], 0
  v_exp_f32 v71, v71
  v_cvt_pk_bf16_f32 v98, v68, v69
  v_exp_f32 v72, v72
  v_exp_f32 v73, v73
  v_cvt_pk_bf16_f32 v99, v70, v71
  v_mfma_f32_32x32x16_bf16 v[80:95], v[44:47], v[204:207], v[80:95]
  v_exp_f32 v74, v74
  v_exp_f32 v75, v75
  ds_read_b128 v[48:51], v4 offset:57344
  v_cvt_pk_bf16_f32 v100, v72, v73
  v_exp_f32 v76, v76
  v_exp_f32 v77, v77
  ds_read_b128 v[52:55], v4 offset:58368
  v_cvt_pk_bf16_f32 v101, v74, v75
  v_exp_f32 v78, v78
  s_add_u32 m0, s31, 35840
  s_add_u32 s29, s53, s28
  s_add_u32 s29, s29, 3072
  buffer_load_dwordx4 v2, s[8:11], s29 offen sc1 lds
  v_exp_f32 v79, v79
  v_cvt_pk_bf16_f32 v102, v76, v77
  v_cvt_pk_bf16_f32 v103, v78, v79
  s_waitcnt lgkmcnt(4)
  v_mfma_f32_32x32x16_bf16 v[112:127], v[56:59], v[96:99], v[112:127]
  v_exp_f32 v80, v80
  v_exp_f32 v81, v81
  v_exp_f32 v82, v82
  v_exp_f32 v83, v83
  v_mfma_f32_32x32x16_bf16 v[112:127], v[60:63], v[100:103], v[112:127]
  v_cvt_pk_bf16_f32 v104, v80, v81
  v_exp_f32 v84, v84
  v_exp_f32 v85, v85
  v_cvt_pk_bf16_f32 v105, v82, v83
  v_exp_f32 v86, v86
  s_waitcnt lgkmcnt(2)
  v_mfma_f32_32x32x16_bf16 v[64:79], v[32:35], v[192:195], 0
  v_exp_f32 v87, v87
  v_cvt_pk_bf16_f32 v106, v84, v85
  v_exp_f32 v88, v88
  v_exp_f32 v89, v89
  v_cvt_pk_bf16_f32 v107, v86, v87
  v_mfma_f32_32x32x16_bf16 v[64:79], v[36:39], v[196:199], v[64:79]
  v_exp_f32 v90, v90
  v_exp_f32 v91, v91
  ds_read_b128 v[40:43], v4 offset:26624
  v_cvt_pk_bf16_f32 v108, v88, v89
  v_exp_f32 v92, v92
  v_exp_f32 v93, v93
  ds_read_b128 v[44:47], v4 offset:27648
  v_cvt_pk_bf16_f32 v109, v90, v91
  v_exp_f32 v94, v94
  v_exp_f32 v95, v95
  v_cvt_pk_bf16_f32 v110, v92, v93
  v_cvt_pk_bf16_f32 v111, v94, v95
  v_mfma_f32_32x32x16_bf16 v[128:143], v[56:59], v[104:107], v[128:143]
  v_exp_f32 v64, v64
  v_exp_f32 v65, v65
  v_exp_f32 v66, v66
  v_exp_f32 v67, v67
  v_mfma_f32_32x32x16_bf16 v[128:143], v[60:63], v[108:111], v[128:143]
  v_cvt_pk_bf16_f32 v96, v64, v65
  v_exp_f32 v68, v68
  v_exp_f32 v69, v69
  v_cvt_pk_bf16_f32 v97, v66, v67
  v_exp_f32 v70, v70
  v_mfma_f32_32x32x16_bf16 v[80:95], v[32:35], v[200:203], 0
  v_exp_f32 v71, v71
  v_cvt_pk_bf16_f32 v98, v68, v69
  v_exp_f32 v72, v72
  v_exp_f32 v73, v73
  v_cvt_pk_bf16_f32 v99, v70, v71
  v_mfma_f32_32x32x16_bf16 v[80:95], v[36:39], v[204:207], v[80:95]
  v_exp_f32 v74, v74
  v_exp_f32 v75, v75
  ds_read_b128 v[56:59], v4 offset:59392
  v_cvt_pk_bf16_f32 v100, v72, v73
  v_exp_f32 v76, v76
  v_exp_f32 v77, v77
  ds_read_b128 v[60:63], v4 offset:60416
  v_cvt_pk_bf16_f32 v101, v74, v75
  v_exp_f32 v78, v78
  s_add_u32 m0, s31, 36864
  s_add_u32 s29, s53, s28
  s_add_u32 s29, s29, 4096
  buffer_load_dwordx4 v2, s[8:11], s29 offen sc1 lds
  v_exp_f32 v79, v79
  v_cvt_pk_bf16_f32 v102, v76, v77
  v_cvt_pk_bf16_f32 v103, v78, v79
  s_waitcnt lgkmcnt(4)
  v_mfma_f32_32x32x16_bf16 v[112:127], v[48:51], v[96:99], v[112:127]
  v_exp_f32 v80, v80
  v_exp_f32 v81, v81
  v_exp_f32 v82, v82
  v_exp_f32 v83, v83
  v_mfma_f32_32x32x16_bf16 v[112:127], v[52:55], v[100:103], v[112:127]
  v_cvt_pk_bf16_f32 v104, v80, v81
  v_exp_f32 v84, v84
  v_exp_f32 v85, v85
  v_cvt_pk_bf16_f32 v105, v82, v83
  v_exp_f32 v86, v86
  s_waitcnt lgkmcnt(2)
  v_mfma_f32_32x32x16_bf16 v[64:79], v[40:43], v[192:195], 0
  v_exp_f32 v87, v87
  v_cvt_pk_bf16_f32 v106, v84, v85
  v_exp_f32 v88, v88
  v_exp_f32 v89, v89
  v_cvt_pk_bf16_f32 v107, v86, v87
  v_mfma_f32_32x32x16_bf16 v[64:79], v[44:47], v[196:199], v[64:79]
  v_exp_f32 v90, v90
  v_exp_f32 v91, v91
  ds_read_b128 v[32:35], v4 offset:28672
  v_cvt_pk_bf16_f32 v108, v88, v89
  v_exp_f32 v92, v92
  v_exp_f32 v93, v93
  ds_read_b128 v[36:39], v4 offset:29696
  v_cvt_pk_bf16_f32 v109, v90, v91
  v_exp_f32 v94, v94
  v_exp_f32 v95, v95
  v_cvt_pk_bf16_f32 v110, v92, v93
  v_cvt_pk_bf16_f32 v111, v94, v95
  v_mfma_f32_32x32x16_bf16 v[128:143], v[48:51], v[104:107], v[128:143]
  v_exp_f32 v64, v64
  v_exp_f32 v65, v65
  v_exp_f32 v66, v66
  v_exp_f32 v67, v67
  v_mfma_f32_32x32x16_bf16 v[128:143], v[52:55], v[108:111], v[128:143]
  v_cvt_pk_bf16_f32 v96, v64, v65
  v_exp_f32 v68, v68
  v_exp_f32 v69, v69
  v_cvt_pk_bf16_f32 v97, v66, v67
  v_exp_f32 v70, v70
  v_mfma_f32_32x32x16_bf16 v[80:95], v[40:43], v[200:203], 0
  v_exp_f32 v71, v71
  v_cvt_pk_bf16_f32 v98, v68, v69
  v_exp_f32 v72, v72
  v_exp_f32 v73, v73
  v_cvt_pk_bf16_f32 v99, v70, v71
  v_mfma_f32_32x32x16_bf16 v[80:95], v[44:47], v[204:207], v[80:95]
  v_exp_f32 v74, v74
  v_exp_f32 v75, v75
  ds_read_b128 v[48:51], v4 offset:61440
  v_cvt_pk_bf16_f32 v100, v72, v73
  v_exp_f32 v76, v76
  v_exp_f32 v77, v77
  ds_read_b128 v[52:55], v4 offset:62464
  v_cvt_pk_bf16_f32 v101, v74, v75
  v_exp_f32 v78, v78
  s_add_u32 m0, s31, 37888
  s_add_u32 s29, s53, s28
  s_add_u32 s29, s29, 5120
  buffer_load_dwordx4 v2, s[8:11], s29 offen sc1 lds
  v_exp_f32 v79, v79
  v_cvt_pk_bf16_f32 v102, v76, v77
  v_cvt_pk_bf16_f32 v103, v78, v79
  s_waitcnt lgkmcnt(4)
  v_mfma_f32_32x32x16_bf16 v[112:127], v[56:59], v[96:99], v[112:127]
  v_exp_f32 v80, v80
  v_exp_f32 v81, v81
  v_exp_f32 v82, v82
  v_exp_f32 v83, v83
  v_mfma_f32_32x32x16_bf16 v[112:127], v[60:63], v[100:103], v[112:127]
  v_cvt_pk_bf16_f32 v104, v80, v81
  v_exp_f32 v84, v84
  v_exp_f32 v85, v85
  v_cvt_pk_bf16_f32 v105, v82, v83
  v_exp_f32 v86, v86
  s_waitcnt lgkmcnt(2)
  v_mfma_f32_32x32x16_bf16 v[64:79], v[32:35], v[192:195], 0
  v_exp_f32 v87, v87
  v_cvt_pk_bf16_f32 v106, v84, v85
  v_exp_f32 v88, v88
  v_exp_f32 v89, v89
  v_cvt_pk_bf16_f32 v107, v86, v87
  v_mfma_f32_32x32x16_bf16 v[64:79], v[36:39], v[196:199], v[64:79]
  v_exp_f32 v90, v90
  v_exp_f32 v91, v91
  ds_read_b128 v[40:43], v4 offset:30720
  v_cvt_pk_bf16_f32 v108, v88, v89
  v_exp_f32 v92, v92
  v_exp_f32 v93, v93
  ds_read_b128 v[44:47], v4 offset:31744
  v_cvt_pk_bf16_f32 v109, v90, v91
  v_exp_f32 v94, v94
  v_exp_f32 v95, v95
  v_cvt_pk_bf16_f32 v110, v92, v93
  v_cvt_pk_bf16_f32 v111, v94, v95
  v_mfma_f32_32x32x16_bf16 v[128:143], v[56:59], v[104:107], v[128:143]
  v_exp_f32 v64, v64
  v_exp_f32 v65, v65
  v_exp_f32 v66, v66
  v_exp_f32 v67, v67
  v_mfma_f32_32x32x16_bf16 v[128:143], v[60:63], v[108:111], v[128:143]
  v_cvt_pk_bf16_f32 v96, v64, v65
  v_exp_f32 v68, v68
  v_exp_f32 v69, v69
  v_cvt_pk_bf16_f32 v97, v66, v67
  v_exp_f32 v70, v70
  v_mfma_f32_32x32x16_bf16 v[80:95], v[32:35], v[200:203], 0
  v_exp_f32 v71, v71
  v_cvt_pk_bf16_f32 v98, v68, v69
  v_exp_f32 v72, v72
  v_exp_f32 v73, v73
  v_cvt_pk_bf16_f32 v99, v70, v71
  v_mfma_f32_32x32x16_bf16 v[80:95], v[36:39], v[204:207], v[80:95]
  v_exp_f32 v74, v74
  v_exp_f32 v75, v75
  ds_read_b128 v[56:59], v4 offset:63488
  v_cvt_pk_bf16_f32 v100, v72, v73
  v_exp_f32 v76, v76
  v_exp_f32 v77, v77
  ds_read_b128 v[60:63], v4 offset:64512
  v_cvt_pk_bf16_f32 v101, v74, v75
  v_exp_f32 v78, v78
  s_add_u32 m0, s31, 38912
  s_add_u32 s29, s53, s28
  s_add_u32 s29, s29, 6144
  buffer_load_dwordx4 v2, s[8:11], s29 offen sc1 lds
  v_exp_f32 v79, v79
  v_cvt_pk_bf16_f32 v102, v76, v77
  v_cvt_pk_bf16_f32 v103, v78, v79
  s_waitcnt lgkmcnt(4)
  v_mfma_f32_32x32x16_bf16 v[112:127], v[48:51], v[96:99], v[112:127]
  v_exp_f32 v80, v80
  v_exp_f32 v81, v81
  v_exp_f32 v82, v82
  v_exp_f32 v83, v83
  v_mfma_f32_32x32x16_bf16 v[112:127], v[52:55], v[100:103], v[112:127]
  v_cvt_pk_bf16_f32 v104, v80, v81
  v_exp_f32 v84, v84
  v_exp_f32 v85, v85
  v_cvt_pk_bf16_f32 v105, v82, v83
  v_exp_f32 v86, v86
  s_waitcnt lgkmcnt(2)
  v_mfma_f32_32x32x16_bf16 v[64:79], v[40:43], v[192:195], 0
  v_exp_f32 v87, v87
  v_cvt_pk_bf16_f32 v106, v84, v85
  v_exp_f32 v88, v88
  v_exp_f32 v89, v89
  v_cvt_pk_bf16_f32 v107, v86, v87
  v_mfma_f32_32x32x16_bf16 v[64:79], v[44:47], v[196:199], v[64:79]
  v_exp_f32 v90, v90
  v_exp_f32 v91, v91
  v_cvt_pk_bf16_f32 v108, v88, v89
  v_exp_f32 v92, v92
  v_exp_f32 v93, v93
  v_cvt_pk_bf16_f32 v109, v90, v91
  v_exp_f32 v94, v94
  v_exp_f32 v95, v95
  v_cvt_pk_bf16_f32 v110, v92, v93
  v_cvt_pk_bf16_f32 v111, v94, v95
  v_mfma_f32_32x32x16_bf16 v[128:143], v[48:51], v[104:107], v[128:143]
  v_exp_f32 v64, v64
  v_exp_f32 v65, v65
  v_exp_f32 v66, v66
  v_exp_f32 v67, v67
  v_mfma_f32_32x32x16_bf16 v[128:143], v[52:55], v[108:111], v[128:143]
  v_cvt_pk_bf16_f32 v96, v64, v65
  v_exp_f32 v68, v68
  v_exp_f32 v69, v69
  v_cvt_pk_bf16_f32 v97, v66, v67
  v_exp_f32 v70, v70
  v_mfma_f32_32x32x16_bf16 v[80:95], v[40:43], v[200:203], 0
  v_exp_f32 v71, v71
  v_cvt_pk_bf16_f32 v98, v68, v69
  v_exp_f32 v72, v72
  v_exp_f32 v73, v73
  v_cvt_pk_bf16_f32 v99, v70, v71
  v_mfma_f32_32x32x16_bf16 v[80:95], v[44:47], v[204:207], v[80:95]
  v_exp_f32 v74, v74
  v_exp_f32 v75, v75
  v_cvt_pk_bf16_f32 v100, v72, v73
  v_exp_f32 v76, v76
  v_exp_f32 v77, v77
  v_cvt_pk_bf16_f32 v101, v74, v75
  v_exp_f32 v78, v78
  s_add_u32 m0, s31, 39936
  s_add_u32 s29, s53, s28
  s_add_u32 s29, s29, 7168
  buffer_load_dwordx4 v2, s[8:11], s29 offen sc1 lds
  v_exp_f32 v79, v79
  v_cvt_pk_bf16_f32 v102, v76, v77
  v_cvt_pk_bf16_f32 v103, v78, v79
  s_waitcnt lgkmcnt(0)
  v_mfma_f32_32x32x16_bf16 v[112:127], v[56:59], v[96:99], v[112:127]
  v_exp_f32 v80, v80
  v_exp_f32 v81, v81
  v_exp_f32 v82, v82
  v_exp_f32 v83, v83
  v_mfma_f32_32x32x16_bf16 v[112:127], v[60:63], v[100:103], v[112:127]
  v_cvt_pk_bf16_f32 v104, v80, v81
  v_exp_f32 v84, v84
  v_exp_f32 v85, v85
  v_cvt_pk_bf16_f32 v105, v82, v83
  v_exp_f32 v86, v86
  v_exp_f32 v87, v87
  v_cvt_pk_bf16_f32 v106, v84, v85
  v_exp_f32 v88, v88
  v_exp_f32 v89, v89
  v_cvt_pk_bf16_f32 v107, v86, v87
  v_exp_f32 v90, v90
  v_exp_f32 v91, v91
  v_cvt_pk_bf16_f32 v108, v88, v89
  v_exp_f32 v92, v92
  v_exp_f32 v93, v93
  v_cvt_pk_bf16_f32 v109, v90, v91
  v_exp_f32 v94, v94
  v_exp_f32 v95, v95
  v_cvt_pk_bf16_f32 v110, v92, v93
  v_cvt_pk_bf16_f32 v111, v94, v95
  s_nop 1
  v_mfma_f32_32x32x16_bf16 v[128:143], v[56:59], v[104:107], v[128:143]
  v_mfma_f32_32x32x16_bf16 v[128:143], v[60:63], v[108:111], v[128:143]
  s_cmp_lt_u32 s41, 4
  s_cbranch_scc1 kb2_chunk2
  s_nop 11
  v_mov_b32 v5, v120
  v_mov_b32 v6, v120
  s_nop 1
  v_permlane32_swap_b32 v5, v6
  v_mov_b32 v14, v6
  v_mov_b32 v5, v136
  v_mov_b32 v6, v136
  s_nop 1
  v_permlane32_swap_b32 v5, v6
  v_mov_b32 v15, v6
  s_cmp_eq_u32 s40, 0
  s_cbranch_scc0 kb2_fin
  v_min_f32 v5, v14, v15
  v_cmp_gt_f32 vcc, 0x12800000, v5
  v_cmp_u_f32 s[36:37], v5, v5
  s_nop 1
  s_or_b64 vcc, vcc, s[36:37]
  s_cmp_lg_u64 vcc, 0
  s_cselect_b32 s42, 1, 0
  v_mov_b32 v5, s42
  s_lshl_b32 s30, s21, 2
  s_add_u32 s30, s30, 131584
  v_mov_b32 v6, s30
  ds_write_b32 v6, v5
  s_waitcnt vmcnt(0) lgkmcnt(0)
  s_barrier
  v_mov_b32 v6, 131584
  ds_read_b128 v[8:11], v6
  s_waitcnt lgkmcnt(0)
  v_or_b32 v8, v8, v9
  v_or_b32 v10, v10, v11
  v_or_b32 v8, v8, v10
  s_nop 0
  v_readfirstlane_b32 s42, v8
  s_cmp_eq_u32 s42, 0
  s_cbranch_scc1 kb2_fin
  s_mov_b32 s40, 1
  v_and_b32 v5, 0xffff0000, v198
  v_cndmask_b32 v198, v198, v5, s[34:35]
  v_mov_b32 v12, 0xff7fffff
  v_and_b32 v5, 0xffff0000, v206
  v_cndmask_b32 v206, v206, v5, s[34:35]
  v_mov_b32 v13, 0xff7fffff
  s_mov_b32 s41, 0
kb2_mx:
  s_lshl_b32 s30, s41, 11
  s_add_u32 s30, s30, s27
  buffer_load_dwordx4 v[32:35], v2, s[8:11], s30 offen sc1
  buffer_load_dwordx4 v[36:39], v2, s[8:11], s30 offen offset:1024 sc1
  s_waitcnt vmcnt(0)
  v_mfma_f32_32x32x16_bf16 v[64:79], v[32:35], v[192:195], 0
  v_mfma_f32_32x32x16_bf16 v[64:79], v[36:39], v[196:199], v[64:79]
  v_mfma_f32_32x32x16_bf16 v[80:95], v[32:35], v[200:203], 0
  v_mfma_f32_32x32x16_bf16 v[80:95], v[36:39], v[204:207], v[80:95]
  s_nop 11
  v_max3_f32 v12, v12, v64, v65
  v_max3_f32 v12, v12, v66, v67
  v_max3_f32 v12, v12, v68, v69
  v_max3_f32 v12, v12, v70, v71
  v_max3_f32 v12, v12, v72, v73
  v_max3_f32 v12, v12, v74, v75
  v_max3_f32 v12, v12, v76, v77
  v_max3_f32 v12, v12, v78, v79
  v_max3_f32 v13, v13, v80, v81
  v_max3_f32 v13, v13, v82, v83
  v_max3_f32 v13, v13, v84, v85
  v_max3_f32 v13, v13, v86, v87
  v_max3_f32 v13, v13, v88, v89
  v_max3_f32 v13, v13, v90, v91
  v_max3_f32 v13, v13, v92, v93
  v_max3_f32 v13, v13, v94, v95
  s_add_u32 s41, s41, 1
  s_cmp_lt_u32 s41, 64
  s_cbranch_scc1 kb2_mx
  v_mov_b32 v5, v12
  s_nop 1
  v_permlane32_swap_b32 v12, v5
  v_max_f32 v12, v12, v5
  v_cvt_pk_bf16_f32 v5, v12, v12
  v_and_b32 v5, 0xffff, v5
  v_xor_b32 v5, 0x8000, v5
  v_and_b32 v6, 0xffff0000, v198
  v_or_b32 v5, v5, v6
  v_cndmask_b32 v198, v198, v5, s[34:35]
  v_mov_b32 v5, v13
  s_nop 1
  v_permlane32_swap_b32 v13, v5
  v_max_f32 v13, v13, v5
  v_cvt_pk_bf16_f32 v5, v13, v13
  v_and_b32 v5, 0xffff, v5
  v_xor_b32 v5, 0x8000, v5
  v_and_b32 v6, 0xffff0000, v206
  v_or_b32 v5, v5, v6
  v_cndmask_b32 v206, v206, v5, s[34:35]
  s_barrier
  s_mov_b32 s41, 0
  s_mul_i32 s53, s41, 32768
  s_lshl_b32 s31, s21, 13
  s_add_u32 s53, s53, s31
  s_add_u32 m0, s31, 0
  s_add_u32 s29, s53, s27
  s_add_u32 s29, s29, 0
  buffer_load_dwordx4 v2, s[8:11], s29 offen sc1 lds
  s_add_u32 m0, s31, 1024
  s_add_u32 s29, s53, s27
  s_add_u32 s29, s29, 1024
  buffer_load_dwordx4 v2, s[8:11], s29 offen sc1 lds
  s_add_u32 m0, s31, 2048
  s_add_u32 s29, s53, s27
  s_add_u32 s29, s29, 2048
  buffer_load_dwordx4 v2, s[8:11], s29 offen sc1 lds
  s_add_u32 m0, s31, 3072
  s_add_u32 s29, s53, s27
  s_add_u32 s29, s29, 3072
  buffer_load_dwordx4 v2, s[8:11], s29 offen sc1 lds
  s_add_u32 m0, s31, 4096
  s_add_u32 s29, s53, s27
  s_add_u32 s29, s29, 4096
  buffer_load_dwordx4 v2, s[8:11], s29 offen sc1 lds
  s_add_u32 m0, s31, 5120
  s_add_u32 s29, s53, s27
  s_add_u32 s29, s29, 5120
  buffer_load_dwordx4 v2, s[8:11], s29 offen sc1 lds
  s_add_u32 m0, s31, 6144
  s_add_u32 s29, s53, s27
  s_add_u32 s29, s29, 6144
  buffer_load_dwordx4 v2, s[8:11], s29 offen sc1 lds
  s_add_u32 m0, s31, 7168
  s_add_u32 s29, s53, s27
  s_add_u32 s29, s29, 7168
  buffer_load_dwordx4 v2, s[8:11], s29 offen sc1 lds
  s_add_u32 m0, s31, 32768
  s_add_u32 s29, s53, s28
  s_add_u32 s29, s29, 0
  buffer_load_dwordx4 v2, s[8:11], s29 offen sc1 lds
  s_add_u32 m0, s31, 33792
  s_add_u32 s29, s53, s28
  s_add_u32 s29, s29, 1024
  buffer_load_dwordx4 v2, s[8:11], s29 offen sc1 lds
  s_add_u32 m0, s31, 34816
  s_add_u32 s29, s53, s28
  s_add_u32 s29, s29, 2048
  buffer_load_dwordx4 v2, s[8:11], s29 offen sc1 lds
  s_add_u32 m0, s31, 35840
  s_add_u32 s29, s53, s28
  s_add_u32 s29, s29, 3072
  buffer_load_dwordx4 v2, s[8:11], s29 offen sc1 lds
  s_add_u32 m0, s31, 36864
  s_add_u32 s29, s53, s28
  s_add_u32 s29, s29, 4096
  buffer_load_dwordx4 v2, s[8:11], s29 offen sc1 lds
  s_add_u32 m0, s31, 37888
  s_add_u32 s29, s53, s28
  s_add_u32 s29, s29, 5120
  buffer_load_dwordx4 v2, s[8:11], s29 offen sc1 lds
  s_add_u32 m0, s31, 38912
  s_add_u32 s29, s53, s28
  s_add_u32 s29, s29, 6144
  buffer_load_dwordx4 v2, s[8:11], s29 offen sc1 lds
  s_add_u32 m0, s31, 39936
  s_add_u32 s29, s53, s28
  s_add_u32 s29, s29, 7168
  buffer_load_dwordx4 v2, s[8:11], s29 offen sc1 lds
  s_branch kb2_main2
kb2_fin:
  v_and_b32 v3, 15, v1
  v_bfe_u32 v11, v1, 4, 1
  v_mul_u32_u24 v11, 20480, v11
  v_lshrrev_b32 v4, 5, v1
  s_mul_i32 s30, s22, 20
  v_lshlrev_b32 v5, 2, v4
  v_add_u32 v5, 0, v5
  v_add_u32 v5, s30, v5
  v_lshrrev_b32 v6, 5, v5
  v_lshlrev_b32 v6, 10, v6
  v_bfe_u32 v7, v5, 3, 2
  v_lshlrev_b32 v7, 4, v7
  v_add_u32 v7, v7, v3
  v_lshlrev_b32 v7, 4, v7
  v_add_u32 v6, v6, v7
  v_bfe_u32 v7, v5, 2, 1
  v_lshlrev_b32 v7, 3, v7
  v_add_u32 v6, v6, v7
  v_add_u32 v32, v6, v11
  v_lshlrev_b32 v5, 2, v4
  v_add_u32 v5, 8, v5
  v_add_u32 v5, s30, v5
  v_lshrrev_b32 v6, 5, v5
  v_lshlrev_b32 v6, 10, v6
  v_bfe_u32 v7, v5, 3, 2
  v_lshlrev_b32 v7, 4, v7
  v_add_u32 v7, v7, v3
  v_lshlrev_b32 v7, 4, v7
  v_add_u32 v6, v6, v7
  v_bfe_u32 v7, v5, 2, 1
  v_lshlrev_b32 v7, 3, v7
  v_add_u32 v6, v6, v7
  v_add_u32 v33, v6, v11
  v_lshlrev_b32 v5, 2, v4
  v_add_u32 v5, 16, v5
  v_add_u32 v5, s30, v5
  v_lshrrev_b32 v6, 5, v5
  v_lshlrev_b32 v6, 10, v6
  v_bfe_u32 v7, v5, 3, 2
  v_lshlrev_b32 v7, 4, v7
  v_add_u32 v7, v7, v3
  v_lshlrev_b32 v7, 4, v7
  v_add_u32 v6, v6, v7
  v_bfe_u32 v7, v5, 2, 1
  v_lshlrev_b32 v7, 3, v7
  v_add_u32 v6, v6, v7
  v_add_u32 v34, v6, v11
  v_mov_b32 v5, 0x40000000
  v_cndmask_b32 v34, v5, v34, s[34:35]
  v_rcp_f32 v5, v14
  s_nop 0
  v_mul_f32 v112, v112, v5
  v_mul_f32 v113, v113, v5
  v_mul_f32 v114, v114, v5
  v_mul_f32 v115, v115, v5
  v_mul_f32 v116, v116, v5
  v_mul_f32 v117, v117, v5
  v_mul_f32 v118, v118, v5
  v_mul_f32 v119, v119, v5
  v_mul_f32 v120, v120, v5
  v_mul_f32 v121, v121, v5
  v_mul_f32 v122, v122, v5
  v_mul_f32 v123, v123, v5
  v_cvt_pk_bf16_f32 v40, v112, v113
  v_cvt_pk_bf16_f32 v41, v114, v115
  v_cvt_pk_bf16_f32 v42, v116, v117
  v_cvt_pk_bf16_f32 v43, v118, v119
  v_cvt_pk_bf16_f32 v44, v120, v121
  v_cvt_pk_bf16_f32 v45, v122, v123
  s_add_u32 s31, s52, 0
  s_mul_i32 s31, s31, 40960
  s_add_u32 s31, s31, 0xf200000
  buffer_store_dwordx2 v[40:41], v32, s[8:11], s31 offen sc1
  buffer_store_dwordx2 v[42:43], v33, s[8:11], s31 offen sc1
  buffer_store_dwordx2 v[44:45], v34, s[8:11], s31 offen sc1
  v_rcp_f32 v5, v15
  s_nop 0
  v_mul_f32 v128, v128, v5
  v_mul_f32 v129, v129, v5
  v_mul_f32 v130, v130, v5
  v_mul_f32 v131, v131, v5
  v_mul_f32 v132, v132, v5
  v_mul_f32 v133, v133, v5
  v_mul_f32 v134, v134, v5
  v_mul_f32 v135, v135, v5
  v_mul_f32 v136, v136, v5
  v_mul_f32 v137, v137, v5
  v_mul_f32 v138, v138, v5
  v_mul_f32 v139, v139, v5
  v_cvt_pk_bf16_f32 v48, v128, v129
  v_cvt_pk_bf16_f32 v49, v130, v131
  v_cvt_pk_bf16_f32 v50, v132, v133
  v_cvt_pk_bf16_f32 v51, v134, v135
  v_cvt_pk_bf16_f32 v52, v136, v137
  v_cvt_pk_bf16_f32 v53, v138, v139
  s_add_u32 s31, s52, 1
  s_mul_i32 s31, s31, 40960
  s_add_u32 s31, s31, 0xf200000
  buffer_store_dwordx2 v[48:49], v32, s[8:11], s31 offen sc1
  buffer_store_dwordx2 v[50:51], v33, s[8:11], s31 offen sc1
  buffer_store_dwordx2 v[52:53], v34, s[8:11], s31 offen sc1
  s_waitcnt vmcnt(0)
  s_barrier
  s_cmp_eq_u32 s21, 0
  s_cbranch_scc0 arr_125
  s_mov_b64 s[24:25], exec
  s_mov_b64 exec, 1
  v_mov_b32 v3, 0
  v_mov_b32 v4, 1
  buffer_atomic_add v4, v3, s[8:11], s48 offen
  s_mov_b64 exec, s[24:25]
arr_125:
  v_and_b32 v5, 15, v1
  v_lshrrev_b32 v6, 4, v1
  v_and_b32 v7, 1, v6
  v_lshlrev_b32 v7, 10, v7
  v_lshrrev_b32 v8, 1, v6
  v_lshlrev_b32 v8, 5, v8
  v_add_u32 v8, v8, v5
  v_lshlrev_b32 v8, 4, v8
  v_add_u32 v9, v7, v8
  s_lshr_b32 s26, s2, 2
  s_mul_i32 s27, s26, 81920
  s_lshl_b32 s28, s50, 11
  s_add_u32 s27, s27, s28
  s_add_u32 s27, s27, 0x1400000
  s_add_u32 s28, s27, 0
  buffer_load_dwordx4 v[16:19], v9, s[8:11], s28 offen sc1
  s_add_u32 s28, s27, 256
  buffer_load_dwordx4 v[20:23], v9, s[8:11], s28 offen sc1
  s_add_u32 s28, s27, 2048
  buffer_load_dwordx4 v[24:27], v9, s[8:11], s28 offen sc1
  s_add_u32 s28, s27, 2304
  buffer_load_dwordx4 v[28:31], v9, s[8:11], s28 offen sc1
  s_cmp_lt_u32 s21, 2
  s_cbranch_scc0 g3_126
  s_add_u32 s28, s27, 4096
  buffer_load_dwordx4 v[32:35], v9, s[8:11], s28 offen sc1
  s_add_u32 s28, s27, 4352
  buffer_load_dwordx4 v[36:39], v9, s[8:11], s28 offen sc1
g3_126:
  s_mov_b32 s45, 0
  v_mov_b32 v3, 0
aw_127:
  buffer_load_dword v4, v3, s[8:11], s48 offen sc1
  s_add_u32 s45, s45, 1
  s_waitcnt vmcnt(0)
  v_readfirstlane_b32 s29, v4
  s_cmp_ge_u32 s29, 32
  s_cbranch_scc1 aw_127_ok
  s_cmp_lt_u32 s45, 400000
  s_cbranch_scc1 aw_127
  s_branch kb2_abort
aw_127_ok:
  s_mul_i32 s28, s26, 40960
  s_mul_i32 s31, s21, 10240
  s_add_u32 s28, s28, s31
  s_add_u32 s28, s28, 0xf200000
  s_add_u32 m0, s31, 0
  s_add_u32 s29, s28, 0
  buffer_load_dwordx4 v2, s[8:11], s29 offen sc1 lds
  s_add_u32 m0, s31, 1024
  s_add_u32 s29, s28, 1024
  buffer_load_dwordx4 v2, s[8:11], s29 offen sc1 lds
  s_add_u32 m0, s31, 2048
  s_add_u32 s29, s28, 2048
  buffer_load_dwordx4 v2, s[8:11], s29 offen sc1 lds
  s_add_u32 m0, s31, 3072
  s_add_u32 s29, s28, 3072
  buffer_load_dwordx4 v2, s[8:11], s29 offen sc1 lds
  s_add_u32 m0, s31, 4096
  s_add_u32 s29, s28, 4096
  buffer_load_dwordx4 v2, s[8:11], s29 offen sc1 lds
  s_add_u32 m0, s31, 5120
  s_add_u32 s29, s28, 5120
  buffer_load_dwordx4 v2, s[8:11], s29 offen sc1 lds
  s_add_u32 m0, s31, 6144
  s_add_u32 s29, s28, 6144
  buffer_load_dwordx4 v2, s[8:11], s29 offen sc1 lds
  s_add_u32 m0, s31, 7168
  s_add_u32 s29, s28, 7168
  buffer_load_dwordx4 v2, s[8:11], s29 offen sc1 lds
  s_add_u32 m0, s31, 8192
  s_add_u32 s29, s28, 8192
  buffer_load_dwordx4 v2, s[8:11], s29 offen sc1 lds
  s_add_u32 m0, s31, 9216
  s_add_u32 s29, s28, 9216
  buffer_load_dwordx4 v2, s[8:11], s29 offen sc1 lds
  s_waitcnt vmcnt(0)
  s_barrier
  ds_read_b128 v[80:83], v2 offset:0
  ds_read_b128 v[84:87], v2 offset:20480
  ds_read_b128 v[88:91], v2 offset:1024
  ds_read_b128 v[92:95], v2 offset:21504
  ds_read_b128 v[96:99], v2 offset:2048
  ds_read_b128 v[100:103], v2 offset:22528
  s_waitcnt lgkmcnt(4)
  v_mfma_f32_16x16x32_bf16 v[48:51], a[0:3], v[80:83], 0
  v_mfma_f32_16x16x32_bf16 v[52:55], a[0:3], v[84:87], 0
  v_mfma_f32_16x16x32_bf16 v[56:59], a[80:83], v[80:83], 0
  v_mfma_f32_16x16x32_bf16 v[60:63], a[80:83], v[84:87], 0
  v_mfma_f32_16x16x32_bf16 v[64:67], a[160:163], v[80:83], 0
  v_mfma_f32_16x16x32_bf16 v[68:71], a[160:163], v[84:87], 0
  ds_read_b128 v[80:83], v2 offset:3072
  ds_read_b128 v[84:87], v2 offset:23552
  s_waitcnt lgkmcnt(4)
  v_mfma_f32_16x16x32_bf16 v[48:51], a[4:7], v[88:91], v[48:51]
  v_mfma_f32_16x16x32_bf16 v[52:55], a[4:7], v[92:95], v[52:55]
  v_mfma_f32_16x16x32_bf16 v[56:59], a[84:87], v[88:91], v[56:59]
  v_mfma_f32_16x16x32_bf16 v[60:63], a[84:87], v[92:95], v[60:63]
  v_mfma_f32_16x16x32_bf16 v[64:67], a[164:167], v[88:91], v[64:67]
  v_mfma_f32_16x16x32_bf16 v[68:71], a[164:167], v[92:95], v[68:71]
  ds_read_b128 v[88:91], v2 offset:4096
  ds_read_b128 v[92:95], v2 offset:24576
  s_waitcnt lgkmcnt(4)
  v_mfma_f32_16x16x32_bf16 v[48:51], a[8:11], v[96:99], v[48:51]
  v_mfma_f32_16x16x32_bf16 v[52:55], a[8:11], v[100:103], v[52:55]
  v_mfma_f32_16x16x32_bf16 v[56:59], a[88:91], v[96:99], v[56:59]
  v_mfma_f32_16x16x32_bf16 v[60:63], a[88:91], v[100:103], v[60:63]
  v_mfma_f32_16x16x32_bf16 v[64:67], a[168:171], v[96:99], v[64:67]
  v_mfma_f32_16x16x32_bf16 v[68:71], a[168:171], v[100:103], v[68:71]
  ds_read_b128 v[96:99], v2 offset:5120
  ds_read_b128 v[100:103], v2 offset:25600
  s_waitcnt lgkmcnt(4)
  v_mfma_f32_16x16x32_bf16 v[48:51], a[12:15], v[80:83], v[48:51]
  v_mfma_f32_16x16x32_bf16 v[52:55], a[12:15], v[84:87], v[52:55]
  v_mfma_f32_16x16x32_bf16 v[56:59], a[92:95], v[80:83], v[56:59]
  v_mfma_f32_16x16x32_bf16 v[60:63], a[92:95], v[84:87], v[60:63]
  v_mfma_f32_16x16x32_bf16 v[64:67], a[172:175], v[80:83], v[64:67]
  v_mfma_f32_16x16x32_bf16 v[68:71], a[172:175], v[84:87], v[68:71]
  ds_read_b128 v[80:83], v2 offset:6144
  ds_read_b128 v[84:87], v2 offset:26624
  s_waitcnt lgkmcnt(4)
  v_mfma_f32_16x16x32_bf16 v[48:51], a[16:19], v[88:91], v[48:51]
  v_mfma_f32_16x16x32_bf16 v[52:55], a[16:19], v[92:95], v[52:55]
  v_mfma_f32_16x16x32_bf16 v[56:59], a[96:99], v[88:91], v[56:59]
  v_mfma_f32_16x16x32_bf16 v[60:63], a[96:99], v[92:95], v[60:63]
  v_mfma_f32_16x16x32_bf16 v[64:67], a[176:179], v[88:91], v[64:67]
  v_mfma_f32_16x16x32_bf16 v[68:71], a[176:179], v[92:95], v[68:71]
  ds_read_b128 v[88:91], v2 offset:7168
  ds_read_b128 v[92:95], v2 offset:27648
  s_waitcnt lgkmcnt(4)
  v_mfma_f32_16x16x32_bf16 v[48:51], a[20:23], v[96:99], v[48:51]
  v_mfma_f32_16x16x32_bf16 v[52:55], a[20:23], v[100:103], v[52:55]
  v_mfma_f32_16x16x32_bf16 v[56:59], a[100:103], v[96:99], v[56:59]
  v_mfma_f32_16x16x32_bf16 v[60:63], a[100:103], v[100:103], v[60:63]
  v_mfma_f32_16x16x32_bf16 v[64:67], a[180:183], v[96:99], v[64:67]
  v_mfma_f32_16x16x32_bf16 v[68:71], a[180:183], v[100:103], v[68:71]
  ds_read_b128 v[96:99], v2 offset:8192
  ds_read_b128 v[100:103], v2 offset:28672
  s_waitcnt lgkmcnt(4)
  v_mfma_f32_16x16x32_bf16 v[48:51], a[24:27], v[80:83], v[48:51]
  v_mfma_f32_16x16x32_bf16 v[52:55], a[24:27], v[84:87], v[52:55]
  v_mfma_f32_16x16x32_bf16 v[56:59], a[104:107], v[80:83], v[56:59]
  v_mfma_f32_16x16x32_bf16 v[60:63], a[104:107], v[84:87], v[60:63]
  v_mfma_f32_16x16x32_bf16 v[64:67], a[184:187], v[80:83], v[64:67]
  v_mfma_f32_16x16x32_bf16 v[68:71], a[184:187], v[84:87], v[68:71]
  ds_read_b128 v[80:83], v2 offset:9216
  ds_read_b128 v[84:87], v2 offset:29696
  s_waitcnt lgkmcnt(4)
  v_mfma_f32_16x16x32_bf16 v[48:51], a[28:31], v[88:91], v[48:51]
  v_mfma_f32_16x16x32_bf16 v[52:55], a[28:31], v[92:95], v[52:55]
  v_mfma_f32_16x16x32_bf16 v[56:59], a[108:111], v[88:91], v[56:59]
  v_mfma_f32_16x16x32_bf16 v[60:63], a[108:111], v[92:95], v[60:63]
  v_mfma_f32_16x16x32_bf16 v[64:67], a[188:191], v[88:91], v[64:67]
  v_mfma_f32_16x16x32_bf16 v[68:71], a[188:191], v[92:95], v[68:71]
  ds_read_b128 v[88:91], v2 offset:10240
  ds_read_b128 v[92:95], v2 offset:30720
  s_waitcnt lgkmcnt(4)
  v_mfma_f32_16x16x32_bf16 v[48:51], a[32:35], v[96:99], v[48:51]
  v_mfma_f32_16x16x32_bf16 v[52:55], a[32:35], v[100:103], v[52:55]
  v_mfma_f32_16x16x32_bf16 v[56:59], a[112:115], v[96:99], v[56:59]
  v_mfma_f32_16x16x32_bf16 v[60:63], a[112:115], v[100:103], v[60:63]
  v_mfma_f32_16x16x32_bf16 v[64:67], a[192:195], v[96:99], v[64:67]
  v_mfma_f32_16x16x32_bf16 v[68:71], a[192:195], v[100:103], v[68:71]
  ds_read_b128 v[96:99], v2 offset:11264
  ds_read_b128 v[100:103], v2 offset:31744
  s_waitcnt lgkmcnt(4)
  v_mfma_f32_16x16x32_bf16 v[48:51], a[36:39], v[80:83], v[48:51]
  v_mfma_f32_16x16x32_bf16 v[52:55], a[36:39], v[84:87], v[52:55]
  v_mfma_f32_16x16x32_bf16 v[56:59], a[116:119], v[80:83], v[56:59]
  v_mfma_f32_16x16x32_bf16 v[60:63], a[116:119], v[84:87], v[60:63]
  v_mfma_f32_16x16x32_bf16 v[64:67], a[196:199], v[80:83], v[64:67]
  v_mfma_f32_16x16x32_bf16 v[68:71], a[196:199], v[84:87], v[68:71]
  ds_read_b128 v[80:83], v2 offset:12288
  ds_read_b128 v[84:87], v2 offset:32768
  s_waitcnt lgkmcnt(4)
  v_mfma_f32_16x16x32_bf16 v[48:51], a[40:43], v[88:91], v[48:51]
  v_mfma_f32_16x16x32_bf16 v[52:55], a[40:43], v[92:95], v[52:55]
  v_mfma_f32_16x16x32_bf16 v[56:59], a[120:123], v[88:91], v[56:59]
  v_mfma_f32_16x16x32_bf16 v[60:63], a[120:123], v[92:95], v[60:63]
  v_mfma_f32_16x16x32_bf16 v[64:67], a[200:203], v[88:91], v[64:67]
  v_mfma_f32_16x16x32_bf16 v[68:71], a[200:203], v[92:95], v[68:71]
  ds_read_b128 v[88:91], v2 offset:13312
  ds_read_b128 v[92:95], v2 offset:33792
  s_waitcnt lgkmcnt(4)
  v_mfma_f32_16x16x32_bf16 v[48:51], a[44:47], v[96:99], v[48:51]
  v_mfma_f32_16x16x32_bf16 v[52:55], a[44:47], v[100:103], v[52:55]
  v_mfma_f32_16x16x32_bf16 v[56:59], a[124:127], v[96:99], v[56:59]
  v_mfma_f32_16x16x32_bf16 v[60:63], a[124:127], v[100:103], v[60:63]
  v_mfma_f32_16x16x32_bf16 v[64:67], a[204:207], v[96:99], v[64:67]
  v_mfma_f32_16x16x32_bf16 v[68:71], a[204:207], v[100:103], v[68:71]
  ds_read_b128 v[96:99], v2 offset:14336
  ds_read_b128 v[100:103], v2 offset:34816
  s_waitcnt lgkmcnt(4)
  v_mfma_f32_16x16x32_bf16 v[48:51], a[48:51], v[80:83], v[48:51]
  v_mfma_f32_16x16x32_bf16 v[52:55], a[48:51], v[84:87], v[52:55]
  v_mfma_f32_16x16x32_bf16 v[56:59], a[128:131], v[80:83], v[56:59]
  v_mfma_f32_16x16x32_bf16 v[60:63], a[128:131], v[84:87], v[60:63]
  v_mfma_f32_16x16x32_bf16 v[64:67], a[208:211], v[80:83], v[64:67]
  v_mfma_f32_16x16x32_bf16 v[68:71], a[208:211], v[84:87], v[68:71]
  ds_read_b128 v[80:83], v2 offset:15360
  ds_read_b128 v[84:87], v2 offset:35840
  s_waitcnt lgkmcnt(4)
  v_mfma_f32_16x16x32_bf16 v[48:51], a[52:55], v[88:91], v[48:51]
  v_mfma_f32_16x16x32_bf16 v[52:55], a[52:55], v[92:95], v[52:55]
  v_mfma_f32_16x16x32_bf16 v[56:59], a[132:135], v[88:91], v[56:59]
  v_mfma_f32_16x16x32_bf16 v[60:63], a[132:135], v[92:95], v[60:63]
  v_mfma_f32_16x16x32_bf16 v[64:67], a[212:215], v[88:91], v[64:67]
  v_mfma_f32_16x16x32_bf16 v[68:71], a[212:215], v[92:95], v[68:71]
  ds_read_b128 v[88:91], v2 offset:16384
  ds_read_b128 v[92:95], v2 offset:36864
  s_waitcnt lgkmcnt(4)
  v_mfma_f32_16x16x32_bf16 v[48:51], a[56:59], v[96:99], v[48:51]
  v_mfma_f32_16x16x32_bf16 v[52:55], a[56:59], v[100:103], v[52:55]
  v_mfma_f32_16x16x32_bf16 v[56:59], a[136:139], v[96:99], v[56:59]
  v_mfma_f32_16x16x32_bf16 v[60:63], a[136:139], v[100:103], v[60:63]
  v_mfma_f32_16x16x32_bf16 v[64:67], a[216:219], v[96:99], v[64:67]
  v_mfma_f32_16x16x32_bf16 v[68:71], a[216:219], v[100:103], v[68:71]
  ds_read_b128 v[96:99], v2 offset:17408
  ds_read_b128 v[100:103], v2 offset:37888
  s_waitcnt lgkmcnt(4)
  v_mfma_f32_16x16x32_bf16 v[48:51], a[60:63], v[80:83], v[48:51]
  v_mfma_f32_16x16x32_bf16 v[52:55], a[60:63], v[84:87], v[52:55]
  v_mfma_f32_16x16x32_bf16 v[56:59], a[140:143], v[80:83], v[56:59]
  v_mfma_f32_16x16x32_bf16 v[60:63], a[140:143], v[84:87], v[60:63]
  v_mfma_f32_16x16x32_bf16 v[64:67], a[220:223], v[80:83], v[64:67]
  v_mfma_f32_16x16x32_bf16 v[68:71], a[220:223], v[84:87], v[68:71]
  ds_read_b128 v[80:83], v2 offset:18432
  ds_read_b128 v[84:87], v2 offset:38912
  s_waitcnt lgkmcnt(4)
  v_mfma_f32_16x16x32_bf16 v[48:51], a[64:67], v[88:91], v[48:51]
  v_mfma_f32_16x16x32_bf16 v[52:55], a[64:67], v[92:95], v[52:55]
  v_mfma_f32_16x16x32_bf16 v[56:59], a[144:147], v[88:91], v[56:59]
  v_mfma_f32_16x16x32_bf16 v[60:63], a[144:147], v[92:95], v[60:63]
  v_mfma_f32_16x16x32_bf16 v[64:67], a[224:227], v[88:91], v[64:67]
  v_mfma_f32_16x16x32_bf16 v[68:71], a[224:227], v[92:95], v[68:71]
  ds_read_b128 v[88:91], v2 offset:19456
  ds_read_b128 v[92:95], v2 offset:39936
  s_waitcnt lgkmcnt(4)
  v_mfma_f32_16x16x32_bf16 v[48:51], a[68:71], v[96:99], v[48:51]
  v_mfma_f32_16x16x32_bf16 v[52:55], a[68:71], v[100:103], v[52:55]
  v_mfma_f32_16x16x32_bf16 v[56:59], a[148:151], v[96:99], v[56:59]
  v_mfma_f32_16x16x32_bf16 v[60:63], a[148:151], v[100:103], v[60:63]
  v_mfma_f32_16x16x32_bf16 v[64:67], a[228:231], v[96:99], v[64:67]
  v_mfma_f32_16x16x32_bf16 v[68:71], a[228:231], v[100:103], v[68:71]
  s_waitcnt lgkmcnt(2)
  v_mfma_f32_16x16x32_bf16 v[48:51], a[72:75], v[80:83], v[48:51]
  v_mfma_f32_16x16x32_bf16 v[52:55], a[72:75], v[84:87], v[52:55]
  v_mfma_f32_16x16x32_bf16 v[56:59], a[152:155], v[80:83], v[56:59]
  v_mfma_f32_16x16x32_bf16 v[60:63], a[152:155], v[84:87], v[60:63]
  v_mfma_f32_16x16x32_bf16 v[64:67], a[232:235], v[80:83], v[64:67]
  v_mfma_f32_16x16x32_bf16 v[68:71], a[232:235], v[84:87], v[68:71]
  s_waitcnt lgkmcnt(0)
  v_mfma_f32_16x16x32_bf16 v[48:51], a[76:79], v[88:91], v[48:51]
  v_mfma_f32_16x16x32_bf16 v[52:55], a[76:79], v[92:95], v[52:55]
  v_mfma_f32_16x16x32_bf16 v[56:59], a[156:159], v[88:91], v[56:59]
  v_mfma_f32_16x16x32_bf16 v[60:63], a[156:159], v[92:95], v[60:63]
  v_mfma_f32_16x16x32_bf16 v[64:67], a[236:239], v[88:91], v[64:67]
  v_mfma_f32_16x16x32_bf16 v[68:71], a[236:239], v[92:95], v[68:71]
  s_nop 7
  v_mul_u32_u24 v10, 1280, v5
  v_lshlrev_b32 v11, 3, v6
  v_add_u32 v10, v10, v11
  s_mul_i32 s30, s26, 40960
  s_lshl_b32 s31, s50, 5
  s_add_u32 s30, s30, s31
  v_add_f32 v48, v48, v16
  v_add_f32 v49, v49, v17
  v_add_f32 v50, v50, v18
  v_add_f32 v51, v51, v19
  v_cvt_pk_bf16_f32 v48, v48, v49
  v_cvt_pk_bf16_f32 v49, v50, v51
  s_add_u32 s28, s30, 0
  buffer_store_dwordx2 v[48:49], v10, s[16:19], s28 offen
  v_add_f32 v52, v52, v20
  v_add_f32 v53, v53, v21
  v_add_f32 v54, v54, v22
  v_add_f32 v55, v55, v23
  v_cvt_pk_bf16_f32 v52, v52, v53
  v_cvt_pk_bf16_f32 v53, v54, v55
  s_add_u32 s28, s30, 20480
  buffer_store_dwordx2 v[52:53], v10, s[16:19], s28 offen
  v_add_f32 v56, v56, v24
  v_add_f32 v57, v57, v25
  v_add_f32 v58, v58, v26
  v_add_f32 v59, v59, v27
  v_cvt_pk_bf16_f32 v56, v56, v57
  v_cvt_pk_bf16_f32 v57, v58, v59
  s_add_u32 s28, s30, 32
  buffer_store_dwordx2 v[56:57], v10, s[16:19], s28 offen
  v_add_f32 v60, v60, v28
  v_add_f32 v61, v61, v29
  v_add_f32 v62, v62, v30
  v_add_f32 v63, v63, v31
  v_cvt_pk_bf16_f32 v60, v60, v61
  v_cvt_pk_bf16_f32 v61, v62, v63
  s_add_u32 s28, s30, 20512
  buffer_store_dwordx2 v[60:61], v10, s[16:19], s28 offen
  s_cmp_lt_u32 s21, 2
  s_cbranch_scc0 g3_128
  v_add_f32 v64, v64, v32
  v_add_f32 v65, v65, v33
  v_add_f32 v66, v66, v34
  v_add_f32 v67, v67, v35
  v_cvt_pk_bf16_f32 v64, v64, v65
  v_cvt_pk_bf16_f32 v65, v66, v67
  s_add_u32 s28, s30, 64
  buffer_store_dwordx2 v[64:65], v10, s[16:19], s28 offen
  v_add_f32 v68, v68, v36
  v_add_f32 v69, v69, v37
  v_add_f32 v70, v70, v38
  v_add_f32 v71, v71, v39
  v_cvt_pk_bf16_f32 v68, v68, v69
  v_cvt_pk_bf16_f32 v69, v70, v71
  s_add_u32 s28, s30, 20544
  buffer_store_dwordx2 v[68:69], v10, s[16:19], s28 offen
g3_128:
  s_endpgm
kb2_abort:
  s_load_dwordx2 s[6:7], s[0:1], 88
  v_mov_b32 v2, 80
  v_mov_b32 v3, 1
  s_waitcnt lgkmcnt(0)
  s_mov_b64 exec, 1
  global_atomic_add v2, v3, s[6:7]
  s_waitcnt vmcnt(0)
kb2_exit:
  s_endpgm

.section .rodata,"a"
.p2align 6
.amdhsa_kernel kb2_kernel
  .amdhsa_next_free_vgpr 512
  .amdhsa_next_free_sgpr 102
  .amdhsa_accum_offset 256
  .amdhsa_group_segment_fixed_size 0
  .amdhsa_kernarg_size 104
  .amdhsa_user_sgpr_count 2
  .amdhsa_user_sgpr_kernarg_segment_ptr 1
  .amdhsa_system_sgpr_workgroup_id_x 1
.end_amdhsa_kernel
```

```asm
; @launch kernel=prep_kernel grid=(256,1,1) block=(256,1,1) lds=32768
; @launch kernel=ka1_kernel grid=(256,1,1) block=(256,1,1) lds=163840
; @launch kernel=kb1_kernel grid=(256,1,1) block=(256,1,1) lds=135168
; @launch kernel=ka2_kernel grid=(256,1,1) block=(256,1,1) lds=163840
; @launch kernel=kb2_kernel grid=(256,1,1) block=(256,1,1) lds=135168
.amdgcn_target "amdgcn-amd-amdhsa--gfx950"
.text
.globl prep_kernel
.p2align 8
.type prep_kernel,@function
prep_kernel:
  s_cmp_ge_u32 s2, 256
  s_cbranch_scc1 k0_exit
  s_load_dwordx2 s[38:39], s[0:1], 8
  s_load_dwordx4 s[40:43], s[0:1], 32
  s_load_dwordx4 s[44:47], s[0:1], 16
  s_load_dwordx2 s[4:5], s[0:1], 96
  v_lshrrev_b32 v1, 6, v0
  s_nop 0
  v_readfirstlane_b32 s21, v1
  v_and_b32 v1, 63, v0
  v_lshlrev_b32 v2, 4, v1
  s_waitcnt lgkmcnt(0)
  s_mov_b32 s8, s4
  s_and_b32 s9, s5, 0xffff
  s_mov_b32 s10, 0x10000000
  s_mov_b32 s11, 0x20000
  s_mov_b32 s12, s40
  s_and_b32 s13, s41, 0xffff
  s_mov_b32 s14, 0x780000
  s_mov_b32 s15, 0x20000
  s_mov_b32 s16, s42
  s_and_b32 s17, s43, 0xffff
  s_mov_b32 s18, 0x780000
  s_mov_b32 s19, 0x20000
  v_mov_b32 v208, -1
  v_mov_b32 v209, -1
  v_mov_b32 v210, -1
  v_mov_b32 v211, -1
  s_lshl_b32 s28, s2, 2
  s_add_u32 s28, s28, s21
  s_add_u32 s29, s28, 0
  s_cmp_lt_u32 s29, 2560
  s_cbranch_scc0 f_1
  s_lshl_b32 s29, s29, 10
  s_add_u32 s29, s29, 0x400000
  buffer_store_dwordx4 v[208:211], v2, s[8:11], s29 offen
f_1:
  s_add_u32 s29, s28, 1024
  s_cmp_lt_u32 s29, 2560
  s_cbranch_scc0 f_2
  s_lshl_b32 s29, s29, 10
  s_add_u32 s29, s29, 0x400000
  buffer_store_dwordx4 v[208:211], v2, s[8:11], s29 offen
f_2:
  s_add_u32 s29, s28, 2048
  s_cmp_lt_u32 s29, 2560
  s_cbranch_scc0 f_3
  s_lshl_b32 s29, s29, 10
  s_add_u32 s29, s29, 0x400000
  buffer_store_dwordx4 v[208:211], v2, s[8:11], s29 offen
f_3:
  s_add_u32 s29, s28, 0
  s_cmp_lt_u32 s29, 1280
  s_cbranch_scc0 f_4
  s_lshl_b32 s29, s29, 10
  s_add_u32 s29, s29, 0x700000
  buffer_store_dwordx4 v[208:211], v2, s[8:11], s29 offen
f_4:
  s_add_u32 s29, s28, 1024
  s_cmp_lt_u32 s29, 1280
  s_cbranch_scc0 f_5
  s_lshl_b32 s29, s29, 10
  s_add_u32 s29, s29, 0x700000
  buffer_store_dwordx4 v[208:211], v2, s[8:11], s29 offen
f_5:
  s_add_u32 s29, s28, 0
  s_cmp_lt_u32 s29, 640
  s_cbranch_scc0 f_6
  s_lshl_b32 s29, s29, 10
  s_add_u32 s29, s29, 0xa00000
  buffer_store_dwordx4 v[208:211], v2, s[8:11], s29 offen
f_6:
  s_add_u32 s29, s28, 0
  s_cmp_lt_u32 s29, 5120
  s_cbranch_scc0 f_7
  s_lshl_b32 s29, s29, 10
  s_add_u32 s29, s29, 0xe00000
  buffer_store_dwordx4 v[208:211], v2, s[8:11], s29 offen
f_7:
  s_add_u32 s29, s28, 1024
  s_cmp_lt_u32 s29, 5120
  s_cbranch_scc0 f_8
  s_lshl_b32 s29, s29, 10
  s_add_u32 s29, s29, 0xe00000
  buffer_store_dwordx4 v[208:211], v2, s[8:11], s29 offen
f_8:
  s_add_u32 s29, s28, 2048
  s_cmp_lt_u32 s29, 5120
  s_cbranch_scc0 f_9
  s_lshl_b32 s29, s29, 10
  s_add_u32 s29, s29, 0xe00000
  buffer_store_dwordx4 v[208:211], v2, s[8:11], s29 offen
f_9:
  s_add_u32 s29, s28, 3072
  s_cmp_lt_u32 s29, 5120
  s_cbranch_scc0 f_10
  s_lshl_b32 s29, s29, 10
  s_add_u32 s29, s29, 0xe00000
  buffer_store_dwordx4 v[208:211], v2, s[8:11], s29 offen
f_10:
  s_add_u32 s29, s28, 4096
  s_cmp_lt_u32 s29, 5120
  s_cbranch_scc0 f_11
  s_lshl_b32 s29, s29, 10
  s_add_u32 s29, s29, 0xe00000
  buffer_store_dwordx4 v[208:211], v2, s[8:11], s29 offen
f_11:
  s_and_b32 s22, s2, 7
  s_lshl_b32 s22, s22, 2
  s_lshr_b32 s23, s2, 6
  s_add_u32 s22, s22, s23
  s_bfe_u32 s23, s2, 0x30003
  v_lshrrev_b32 v8, 3, v1
  v_bfe_u32 v9, v1, 1, 2
  v_and_b32 v10, 1, v1
  s_mul_i32 s24, s22, 245760
  s_mul_i32 s25, s23, 160
  s_add_u32 s24, s24, s25
  s_add_u32 s26, s21, 0
  s_cmp_lt_u32 s26, 30
  s_cbranch_scc0 wd_12
  s_lshl_b32 s27, s26, 3
  v_add_u32 v11, s27, v8
  v_mul_u32_u24 v12, 52429, v11
  v_lshrrev_b32 v12, 18, v12
  v_mul_u32_u24 v13, 5, v12
  v_sub_u32 v13, v11, v13
  v_lshlrev_b32 v12, 2, v12
  v_add_u32 v12, v12, v9
  v_mul_u32_u24 v12, 1280, v12
  v_lshlrev_b32 v13, 5, v13
  v_add_u32 v12, v12, v13
  v_lshlrev_b32 v13, 4, v10
  v_add_u32 v12, v12, v13
  s_lshl_b32 m0, s26, 10
  s_nop 0
  buffer_load_dwordx4 v12, s[16:19], s24 offen lds
wd_12:
  s_add_u32 s26, s21, 4
  s_cmp_lt_u32 s26, 30
  s_cbranch_scc0 wd_13
  s_lshl_b32 s27, s26, 3
  v_add_u32 v11, s27, v8
  v_mul_u32_u24 v12, 52429, v11
  v_lshrrev_b32 v12, 18, v12
  v_mul_u32_u24 v13, 5, v12
  v_sub_u32 v13, v11, v13
  v_lshlrev_b32 v12, 2, v12
  v_add_u32 v12, v12, v9
  v_mul_u32_u24 v12, 1280, v12
  v_lshlrev_b32 v13, 5, v13
  v_add_u32 v12, v12, v13
  v_lshlrev_b32 v13, 4, v10
  v_add_u32 v12, v12, v13
  s_lshl_b32 m0, s26, 10
  s_nop 0
  buffer_load_dwordx4 v12, s[16:19], s24 offen lds
wd_13:
  s_add_u32 s26, s21, 8
  s_cmp_lt_u32 s26, 30
  s_cbranch_scc0 wd_14
  s_lshl_b32 s27, s26, 3
  v_add_u32 v11, s27, v8
  v_mul_u32_u24 v12, 52429, v11
  v_lshrrev_b32 v12, 18, v12
  v_mul_u32_u24 v13, 5, v12
  v_sub_u32 v13, v11, v13
  v_lshlrev_b32 v12, 2, v12
  v_add_u32 v12, v12, v9
  v_mul_u32_u24 v12, 1280, v12
  v_lshlrev_b32 v13, 5, v13
  v_add_u32 v12, v12, v13
  v_lshlrev_b32 v13, 4, v10
  v_add_u32 v12, v12, v13
  s_lshl_b32 m0, s26, 10
  s_nop 0
  buffer_load_dwordx4 v12, s[16:19], s24 offen lds
wd_14:
  s_add_u32 s26, s21, 12
  s_cmp_lt_u32 s26, 30
  s_cbranch_scc0 wd_15
  s_lshl_b32 s27, s26, 3
  v_add_u32 v11, s27, v8
  v_mul_u32_u24 v12, 52429, v11
  v_lshrrev_b32 v12, 18, v12
  v_mul_u32_u24 v13, 5, v12
  v_sub_u32 v13, v11, v13
  v_lshlrev_b32 v12, 2, v12
  v_add_u32 v12, v12, v9
  v_mul_u32_u24 v12, 1280, v12
  v_lshlrev_b32 v13, 5, v13
  v_add_u32 v12, v12, v13
  v_lshlrev_b32 v13, 4, v10
  v_add_u32 v12, v12, v13
  s_lshl_b32 m0, s26, 10
  s_nop 0
  buffer_load_dwordx4 v12, s[16:19], s24 offen lds
wd_15:
  s_add_u32 s26, s21, 16
  s_cmp_lt_u32 s26, 30
  s_cbranch_scc0 wd_16
  s_lshl_b32 s27, s26, 3
  v_add_u32 v11, s27, v8
  v_mul_u32_u24 v12, 52429, v11
  v_lshrrev_b32 v12, 18, v12
  v_mul_u32_u24 v13, 5, v12
  v_sub_u32 v13, v11, v13
  v_lshlrev_b32 v12, 2, v12
  v_add_u32 v12, v12, v9
  v_mul_u32_u24 v12, 1280, v12
  v_lshlrev_b32 v13, 5, v13
  v_add_u32 v12, v12, v13
  v_lshlrev_b32 v13, 4, v10
  v_add_u32 v12, v12, v13
  s_lshl_b32 m0, s26, 10
  s_nop 0
  buffer_load_dwordx4 v12, s[16:19], s24 offen lds
wd_16:
  s_add_u32 s26, s21, 20
  s_cmp_lt_u32 s26, 30
  s_cbranch_scc0 wd_17
  s_lshl_b32 s27, s26, 3
  v_add_u32 v11, s27, v8
  v_mul_u32_u24 v12, 52429, v11
  v_lshrrev_b32 v12, 18, v12
  v_mul_u32_u24 v13, 5, v12
  v_sub_u32 v13, v11, v13
  v_lshlrev_b32 v12, 2, v12
  v_add_u32 v12, v12, v9
  v_mul_u32_u24 v12, 1280, v12
  v_lshlrev_b32 v13, 5, v13
  v_add_u32 v12, v12, v13
  v_lshlrev_b32 v13, 4, v10
  v_add_u32 v12, v12, v13
  s_lshl_b32 m0, s26, 10
  s_nop 0
  buffer_load_dwordx4 v12, s[16:19], s24 offen lds
wd_17:
  s_add_u32 s26, s21, 24
  s_cmp_lt_u32 s26, 30
  s_cbranch_scc0 wd_18
  s_lshl_b32 s27, s26, 3
  v_add_u32 v11, s27, v8
  v_mul_u32_u24 v12, 52429, v11
  v_lshrrev_b32 v12, 18, v12
  v_mul_u32_u24 v13, 5, v12
  v_sub_u32 v13, v11, v13
  v_lshlrev_b32 v12, 2, v12
  v_add_u32 v12, v12, v9
  v_mul_u32_u24 v12, 1280, v12
  v_lshlrev_b32 v13, 5, v13
  v_add_u32 v12, v12, v13
  v_lshlrev_b32 v13, 4, v10
  v_add_u32 v12, v12, v13
  s_lshl_b32 m0, s26, 10
  s_nop 0
  buffer_load_dwordx4 v12, s[16:19], s24 offen lds
wd_18:
  s_add_u32 s26, s21, 28
  s_cmp_lt_u32 s26, 30
  s_cbranch_scc0 wd_19
  s_lshl_b32 s27, s26, 3
  v_add_u32 v11, s27, v8
  v_mul_u32_u24 v12, 52429, v11
  v_lshrrev_b32 v12, 18, v12
  v_mul_u32_u24 v13, 5, v12
  v_sub_u32 v13, v11, v13
  v_lshlrev_b32 v12, 2, v12
  v_add_u32 v12, v12, v9
  v_mul_u32_u24 v12, 1280, v12
  v_lshlrev_b32 v13, 5, v13
  v_add_u32 v12, v12, v13
  v_lshlrev_b32 v13, 4, v10
  v_add_u32 v12, v12, v13
  s_lshl_b32 m0, s26, 10
  s_nop 0
  buffer_load_dwordx4 v12, s[16:19], s24 offen lds
wd_19:
  v_and_b32 v8, 15, v1
  v_lshrrev_b32 v9, 2, v8
  v_lshlrev_b32 v9, 3, v9
  v_and_b32 v10, 3, v8
  v_add_u32 v9, v9, v10
  v_mul_u32_u24 v9, 12288, v9
  v_lshrrev_b32 v10, 4, v1
  v_lshlrev_b32 v10, 4, v10
  v_add_u32 v9, v9, v10
  v_add_u32 v10, 49152, v9
  s_mul_i32 s24, s22, 384
  s_mul_i32 s25, s21, 1966080
  s_add_u32 s24, s24, s25
  s_add_u32 s27, s24, 0
  buffer_load_dwordx4 a[120:123], v9, s[12:15], s27 offen offset:0
  buffer_load_dwordx4 a[124:127], v9, s[12:15], s27 offen offset:64
  buffer_load_dwordx4 a[128:131], v9, s[12:15], s27 offen offset:128
  buffer_load_dwordx4 a[132:135], v9, s[12:15], s27 offen offset:192
  buffer_load_dwordx4 a[136:139], v9, s[12:15], s27 offen offset:256
  buffer_load_dwordx4 a[140:143], v9, s[12:15], s27 offen offset:320
  buffer_load_dwordx4 a[144:147], v10, s[12:15], s27 offen offset:0
  buffer_load_dwordx4 a[148:151], v10, s[12:15], s27 offen offset:64
  buffer_load_dwordx4 a[152:155], v10, s[12:15], s27 offen offset:128
  buffer_load_dwordx4 a[156:159], v10, s[12:15], s27 offen offset:192
  buffer_load_dwordx4 a[160:163], v10, s[12:15], s27 offen offset:256
  buffer_load_dwordx4 a[164:167], v10, s[12:15], s27 offen offset:320
  s_add_u32 s27, s24, 393216
  buffer_load_dwordx4 a[168:171], v9, s[12:15], s27 offen offset:0
  buffer_load_dwordx4 a[172:175], v9, s[12:15], s27 offen offset:64
  buffer_load_dwordx4 a[176:179], v9, s[12:15], s27 offen offset:128
  buffer_load_dwordx4 a[180:183], v9, s[12:15], s27 offen offset:192
  buffer_load_dwordx4 a[184:187], v9, s[12:15], s27 offen offset:256
  buffer_load_dwordx4 a[188:191], v9, s[12:15], s27 offen offset:320
  buffer_load_dwordx4 a[192:195], v10, s[12:15], s27 offen offset:0
  buffer_load_dwordx4 a[196:199], v10, s[12:15], s27 offen offset:64
  buffer_load_dwordx4 a[200:203], v10, s[12:15], s27 offen offset:128
  buffer_load_dwordx4 a[204:207], v10, s[12:15], s27 offen offset:192
  buffer_load_dwordx4 a[208:211], v10, s[12:15], s27 offen offset:256
  buffer_load_dwordx4 a[212:215], v10, s[12:15], s27 offen offset:320
  s_add_u32 s27, s24, 786432
  buffer_load_dwordx4 v[64:67], v9, s[12:15], s27 offen offset:0
  buffer_load_dwordx4 v[68:71], v9, s[12:15], s27 offen offset:64
  buffer_load_dwordx4 v[72:75], v9, s[12:15], s27 offen offset:128
  buffer_load_dwordx4 v[76:79], v9, s[12:15], s27 offen offset:192
  buffer_load_dwordx4 v[80:83], v9, s[12:15], s27 offen offset:256
  buffer_load_dwordx4 v[84:87], v9, s[12:15], s27 offen offset:320
  buffer_load_dwordx4 v[88:91], v10, s[12:15], s27 offen offset:0
  buffer_load_dwordx4 v[92:95], v10, s[12:15], s27 offen offset:64
  buffer_load_dwordx4 v[96:99], v10, s[12:15], s27 offen offset:128
  buffer_load_dwordx4 v[100:103], v10, s[12:15], s27 offen offset:192
  buffer_load_dwordx4 v[104:107], v10, s[12:15], s27 offen offset:256
  buffer_load_dwordx4 v[108:111], v10, s[12:15], s27 offen offset:320
  s_mul_i32 s26, s22, 40
  s_mul_i32 s27, s23, 5
  s_add_u32 s26, s26, s27
  s_mul_i32 s26, s26, 20
  s_mul_i32 s27, s21, 5
  s_add_u32 s26, s26, s27
  s_lshl_b32 s26, s26, 10
  s_add_u32 s26, s26, 0x2e00000
  v_lshrrev_b32 v8, 4, v1
  v_mul_u32_u24 v8, 1280, v8
  v_bfe_u32 v11, v1, 2, 2
  v_lshlrev_b32 v11, 5, v11
  v_add_u32 v8, v8, v11
  v_bfe_u32 v11, v1, 1, 1
  v_lshlrev_b32 v11, 4, v11
  v_add_u32 v8, v8, v11
  v_and_b32 v11, 1, v1
  v_lshlrev_b32 v11, 3, v11
  v_add_u32 v8, v8, v11
  s_waitcnt vmcnt(36)
  s_barrier
  ds_read_b64_tr_b16 a[0:1], v8 offset:0
  ds_read_b64_tr_b16 a[2:3], v8 offset:640
  ds_read_b64_tr_b16 a[4:5], v8 offset:128
  ds_read_b64_tr_b16 a[6:7], v8 offset:768
  ds_read_b64_tr_b16 a[8:9], v8 offset:256
  ds_read_b64_tr_b16 a[10:11], v8 offset:896
  ds_read_b64_tr_b16 a[12:13], v8 offset:384
  ds_read_b64_tr_b16 a[14:15], v8 offset:1024
  ds_read_b64_tr_b16 a[16:17], v8 offset:512
  ds_read_b64_tr_b16 a[18:19], v8 offset:1152
  ds_read_b64_tr_b16 a[20:21], v8 offset:5120
  ds_read_b64_tr_b16 a[22:23], v8 offset:5760
  s_waitcnt lgkmcnt(0)
  ds_read_b64_tr_b16 a[24:25], v8 offset:5248
  ds_read_b64_tr_b16 a[26:27], v8 offset:5888
  ds_read_b64_tr_b16 a[28:29], v8 offset:5376
  ds_read_b64_tr_b16 a[30:31], v8 offset:6016
  ds_read_b64_tr_b16 a[32:33], v8 offset:5504
  ds_read_b64_tr_b16 a[34:35], v8 offset:6144
  ds_read_b64_tr_b16 a[36:37], v8 offset:5632
  ds_read_b64_tr_b16 a[38:39], v8 offset:6272
  ds_read_b64_tr_b16 a[40:41], v8 offset:10240
  ds_read_b64_tr_b16 a[42:43], v8 offset:10880
  ds_read_b64_tr_b16 a[44:45], v8 offset:10368
  ds_read_b64_tr_b16 a[46:47], v8 offset:11008
  s_waitcnt lgkmcnt(0)
  ds_read_b64_tr_b16 a[48:49], v8 offset:10496
  ds_read_b64_tr_b16 a[50:51], v8 offset:11136
  ds_read_b64_tr_b16 a[52:53], v8 offset:10624
  ds_read_b64_tr_b16 a[54:55], v8 offset:11264
  ds_read_b64_tr_b16 a[56:57], v8 offset:10752
  ds_read_b64_tr_b16 a[58:59], v8 offset:11392
  ds_read_b64_tr_b16 a[60:61], v8 offset:15360
  ds_read_b64_tr_b16 a[62:63], v8 offset:16000
  ds_read_b64_tr_b16 a[64:65], v8 offset:15488
  ds_read_b64_tr_b16 a[66:67], v8 offset:16128
  ds_read_b64_tr_b16 a[68:69], v8 offset:15616
  ds_read_b64_tr_b16 a[70:71], v8 offset:16256
  s_waitcnt lgkmcnt(0)
  ds_read_b64_tr_b16 a[72:73], v8 offset:15744
  ds_read_b64_tr_b16 a[74:75], v8 offset:16384
  ds_read_b64_tr_b16 a[76:77], v8 offset:15872
  ds_read_b64_tr_b16 a[78:79], v8 offset:16512
  ds_read_b64_tr_b16 a[80:81], v8 offset:20480
  ds_read_b64_tr_b16 a[82:83], v8 offset:21120
  ds_read_b64_tr_b16 a[84:85], v8 offset:20608
  ds_read_b64_tr_b16 a[86:87], v8 offset:21248
  ds_read_b64_tr_b16 a[88:89], v8 offset:20736
  ds_read_b64_tr_b16 a[90:91], v8 offset:21376
  ds_read_b64_tr_b16 a[92:93], v8 offset:20864
  ds_read_b64_tr_b16 a[94:95], v8 offset:21504
  s_waitcnt lgkmcnt(0)
  ds_read_b64_tr_b16 a[96:97], v8 offset:20992
  ds_read_b64_tr_b16 a[98:99], v8 offset:21632
  ds_read_b64_tr_b16 a[100:101], v8 offset:25600
  ds_read_b64_tr_b16 a[102:103], v8 offset:26240
  ds_read_b64_tr_b16 a[104:105], v8 offset:25728
  ds_read_b64_tr_b16 a[106:107], v8 offset:26368
  ds_read_b64_tr_b16 a[108:109], v8 offset:25856
  ds_read_b64_tr_b16 a[110:111], v8 offset:26496
  ds_read_b64_tr_b16 a[112:113], v8 offset:25984
  ds_read_b64_tr_b16 a[114:115], v8 offset:26624
  ds_read_b64_tr_b16 a[116:117], v8 offset:26112
  ds_read_b64_tr_b16 a[118:119], v8 offset:26752
  s_waitcnt lgkmcnt(0)
  s_waitcnt lgkmcnt(0)
  s_add_u32 s27, s24, 1179648
  buffer_load_dwordx4 v[112:115], v9, s[12:15], s27 offen offset:0
  buffer_load_dwordx4 v[116:119], v9, s[12:15], s27 offen offset:64
  buffer_load_dwordx4 v[120:123], v9, s[12:15], s27 offen offset:128
  buffer_load_dwordx4 v[124:127], v9, s[12:15], s27 offen offset:192
  buffer_load_dwordx4 v[128:131], v9, s[12:15], s27 offen offset:256
  buffer_load_dwordx4 v[132:135], v9, s[12:15], s27 offen offset:320
  buffer_load_dwordx4 v[136:139], v10, s[12:15], s27 offen offset:0
  buffer_load_dwordx4 v[140:143], v10, s[12:15], s27 offen offset:64
  buffer_load_dwordx4 v[144:147], v10, s[12:15], s27 offen offset:128
  buffer_load_dwordx4 v[148:151], v10, s[12:15], s27 offen offset:192
  buffer_load_dwordx4 v[152:155], v10, s[12:15], s27 offen offset:256
  buffer_load_dwordx4 v[156:159], v10, s[12:15], s27 offen offset:320
  s_add_u32 s27, s24, 1572864
  buffer_load_dwordx4 v[160:163], v9, s[12:15], s27 offen offset:0
  buffer_load_dwordx4 v[164:167], v9, s[12:15], s27 offen offset:64
  buffer_load_dwordx4 v[168:171], v9, s[12:15], s27 offen offset:128
  buffer_load_dwordx4 v[172:175], v9, s[12:15], s27 offen offset:192
  buffer_load_dwordx4 v[176:179], v9, s[12:15], s27 offen offset:256
  buffer_load_dwordx4 v[180:183], v9, s[12:15], s27 offen offset:320
  buffer_load_dwordx4 v[184:187], v10, s[12:15], s27 offen offset:0
  buffer_load_dwordx4 v[188:191], v10, s[12:15], s27 offen offset:64
  buffer_load_dwordx4 v[192:195], v10, s[12:15], s27 offen offset:128
  buffer_load_dwordx4 v[196:199], v10, s[12:15], s27 offen offset:192
  buffer_load_dwordx4 v[200:203], v10, s[12:15], s27 offen offset:256
  buffer_load_dwordx4 v[204:207], v10, s[12:15], s27 offen offset:320
  s_waitcnt vmcnt(48)
  v_mfma_f32_16x16x32_bf16 v[16:19], a[120:123], a[0:3], 0
  v_mfma_f32_16x16x32_bf16 v[20:23], a[120:123], a[4:7], 0
  v_mfma_f32_16x16x32_bf16 v[24:27], a[120:123], a[8:11], 0
  v_mfma_f32_16x16x32_bf16 v[28:31], a[120:123], a[12:15], 0
  v_mfma_f32_16x16x32_bf16 v[32:35], a[120:123], a[16:19], 0
  v_mfma_f32_16x16x32_bf16 v[36:39], a[144:147], a[0:3], 0
  v_mfma_f32_16x16x32_bf16 v[40:43], a[144:147], a[4:7], 0
  v_mfma_f32_16x16x32_bf16 v[44:47], a[144:147], a[8:11], 0
  v_mfma_f32_16x16x32_bf16 v[48:51], a[144:147], a[12:15], 0
  v_mfma_f32_16x16x32_bf16 v[52:55], a[144:147], a[16:19], 0
  v_mfma_f32_16x16x32_bf16 v[16:19], a[124:127], a[20:23], v[16:19]
  v_mfma_f32_16x16x32_bf16 v[20:23], a[124:127], a[24:27], v[20:23]
  v_mfma_f32_16x16x32_bf16 v[24:27], a[124:127], a[28:31], v[24:27]
  v_mfma_f32_16x16x32_bf16 v[28:31], a[124:127], a[32:35], v[28:31]
  v_mfma_f32_16x16x32_bf16 v[32:35], a[124:127], a[36:39], v[32:35]
  v_mfma_f32_16x16x32_bf16 v[36:39], a[148:151], a[20:23], v[36:39]
  v_mfma_f32_16x16x32_bf16 v[40:43], a[148:151], a[24:27], v[40:43]
  v_mfma_f32_16x16x32_bf16 v[44:47], a[148:151], a[28:31], v[44:47]
  v_mfma_f32_16x16x32_bf16 v[48:51], a[148:151], a[32:35], v[48:51]
  v_mfma_f32_16x16x32_bf16 v[52:55], a[148:151], a[36:39], v[52:55]
  v_mfma_f32_16x16x32_bf16 v[16:19], a[128:131], a[40:43], v[16:19]
  v_mfma_f32_16x16x32_bf16 v[20:23], a[128:131], a[44:47], v[20:23]
  v_mfma_f32_16x16x32_bf16 v[24:27], a[128:131], a[48:51], v[24:27]
  v_mfma_f32_16x16x32_bf16 v[28:31], a[128:131], a[52:55], v[28:31]
  v_mfma_f32_16x16x32_bf16 v[32:35], a[128:131], a[56:59], v[32:35]
  v_mfma_f32_16x16x32_bf16 v[36:39], a[152:155], a[40:43], v[36:39]
  v_mfma_f32_16x16x32_bf16 v[40:43], a[152:155], a[44:47], v[40:43]
  v_mfma_f32_16x16x32_bf16 v[44:47], a[152:155], a[48:51], v[44:47]
  v_mfma_f32_16x16x32_bf16 v[48:51], a[152:155], a[52:55], v[48:51]
  v_mfma_f32_16x16x32_bf16 v[52:55], a[152:155], a[56:59], v[52:55]
  v_mfma_f32_16x16x32_bf16 v[16:19], a[132:135], a[60:63], v[16:19]
  v_mfma_f32_16x16x32_bf16 v[20:23], a[132:135], a[64:67], v[20:23]
  v_mfma_f32_16x16x32_bf16 v[24:27], a[132:135], a[68:71], v[24:27]
  v_mfma_f32_16x16x32_bf16 v[28:31], a[132:135], a[72:75], v[28:31]
  v_mfma_f32_16x16x32_bf16 v[32:35], a[132:135], a[76:79], v[32:35]
  v_mfma_f32_16x16x32_bf16 v[36:39], a[156:159], a[60:63], v[36:39]
  v_mfma_f32_16x16x32_bf16 v[40:43], a[156:159], a[64:67], v[40:43]
  v_mfma_f32_16x16x32_bf16 v[44:47], a[156:159], a[68:71], v[44:47]
  v_mfma_f32_16x16x32_bf16 v[48:51], a[156:159], a[72:75], v[48:51]
  v_mfma_f32_16x16x32_bf16 v[52:55], a[156:159], a[76:79], v[52:55]
  v_mfma_f32_16x16x32_bf16 v[16:19], a[136:139], a[80:83], v[16:19]
  v_mfma_f32_16x16x32_bf16 v[20:23], a[136:139], a[84:87], v[20:23]
  v_mfma_f32_16x16x32_bf16 v[24:27], a[136:139], a[88:91], v[24:27]
  v_mfma_f32_16x16x32_bf16 v[28:31], a[136:139], a[92:95], v[28:31]
  v_mfma_f32_16x16x32_bf16 v[32:35], a[136:139], a[96:99], v[32:35]
  v_mfma_f32_16x16x32_bf16 v[36:39], a[160:163], a[80:83], v[36:39]
  v_mfma_f32_16x16x32_bf16 v[40:43], a[160:163], a[84:87], v[40:43]
  v_mfma_f32_16x16x32_bf16 v[44:47], a[160:163], a[88:91], v[44:47]
  v_mfma_f32_16x16x32_bf16 v[48:51], a[160:163], a[92:95], v[48:51]
  v_mfma_f32_16x16x32_bf16 v[52:55], a[160:163], a[96:99], v[52:55]
  v_mfma_f32_16x16x32_bf16 v[16:19], a[140:143], a[100:103], v[16:19]
  v_mfma_f32_16x16x32_bf16 v[20:23], a[140:143], a[104:107], v[20:23]
  v_mfma_f32_16x16x32_bf16 v[24:27], a[140:143], a[108:111], v[24:27]
  v_mfma_f32_16x16x32_bf16 v[28:31], a[140:143], a[112:115], v[28:31]
  v_mfma_f32_16x16x32_bf16 v[32:35], a[140:143], a[116:119], v[32:35]
  v_mfma_f32_16x16x32_bf16 v[36:39], a[164:167], a[100:103], v[36:39]
  v_mfma_f32_16x16x32_bf16 v[40:43], a[164:167], a[104:107], v[40:43]
  v_mfma_f32_16x16x32_bf16 v[44:47], a[164:167], a[108:111], v[44:47]
  v_mfma_f32_16x16x32_bf16 v[48:51], a[164:167], a[112:115], v[48:51]
  v_mfma_f32_16x16x32_bf16 v[52:55], a[164:167], a[116:119], v[52:55]
  s_nop 7
  v_cvt_pk_bf16_f32 v212, v16, v17
  v_cvt_pk_bf16_f32 v213, v18, v19
  v_cvt_pk_bf16_f32 v214, v36, v37
  v_cvt_pk_bf16_f32 v215, v38, v39
  s_add_u32 s27, s26, 0
  buffer_store_dwordx4 v[212:215], v2, s[8:11], s27 offen
  v_cvt_pk_bf16_f32 v216, v20, v21
  v_cvt_pk_bf16_f32 v217, v22, v23
  v_cvt_pk_bf16_f32 v218, v40, v41
  v_cvt_pk_bf16_f32 v219, v42, v43
  s_add_u32 s27, s26, 20480
  buffer_store_dwordx4 v[216:219], v2, s[8:11], s27 offen
  v_cvt_pk_bf16_f32 v220, v24, v25
  v_cvt_pk_bf16_f32 v221, v26, v27
  v_cvt_pk_bf16_f32 v222, v44, v45
  v_cvt_pk_bf16_f32 v223, v46, v47
  s_add_u32 s27, s26, 40960
  buffer_store_dwordx4 v[220:223], v2, s[8:11], s27 offen
  v_cvt_pk_bf16_f32 v224, v28, v29
  v_cvt_pk_bf16_f32 v225, v30, v31
  v_cvt_pk_bf16_f32 v226, v48, v49
  v_cvt_pk_bf16_f32 v227, v50, v51
  s_add_u32 s27, s26, 61440
  buffer_store_dwordx4 v[224:227], v2, s[8:11], s27 offen
  v_cvt_pk_bf16_f32 v212, v32, v33
  v_cvt_pk_bf16_f32 v213, v34, v35
  v_cvt_pk_bf16_f32 v214, v52, v53
  v_cvt_pk_bf16_f32 v215, v54, v55
  s_add_u32 s27, s26, 81920
  buffer_store_dwordx4 v[212:215], v2, s[8:11], s27 offen
  s_waitcnt vmcnt(41)
  v_mfma_f32_16x16x32_bf16 v[16:19], a[168:171], a[0:3], 0
  v_mfma_f32_16x16x32_bf16 v[20:23], a[168:171], a[4:7], 0
  v_mfma_f32_16x16x32_bf16 v[24:27], a[168:171], a[8:11], 0
  v_mfma_f32_16x16x32_bf16 v[28:31], a[168:171], a[12:15], 0
  v_mfma_f32_16x16x32_bf16 v[32:35], a[168:171], a[16:19], 0
  v_mfma_f32_16x16x32_bf16 v[36:39], a[192:195], a[0:3], 0
  v_mfma_f32_16x16x32_bf16 v[40:43], a[192:195], a[4:7], 0
  v_mfma_f32_16x16x32_bf16 v[44:47], a[192:195], a[8:11], 0
  v_mfma_f32_16x16x32_bf16 v[48:51], a[192:195], a[12:15], 0
  v_mfma_f32_16x16x32_bf16 v[52:55], a[192:195], a[16:19], 0
  v_mfma_f32_16x16x32_bf16 v[16:19], a[172:175], a[20:23], v[16:19]
  v_mfma_f32_16x16x32_bf16 v[20:23], a[172:175], a[24:27], v[20:23]
  v_mfma_f32_16x16x32_bf16 v[24:27], a[172:175], a[28:31], v[24:27]
  v_mfma_f32_16x16x32_bf16 v[28:31], a[172:175], a[32:35], v[28:31]
  v_mfma_f32_16x16x32_bf16 v[32:35], a[172:175], a[36:39], v[32:35]
  v_mfma_f32_16x16x32_bf16 v[36:39], a[196:199], a[20:23], v[36:39]
  v_mfma_f32_16x16x32_bf16 v[40:43], a[196:199], a[24:27], v[40:43]
  v_mfma_f32_16x16x32_bf16 v[44:47], a[196:199], a[28:31], v[44:47]
  v_mfma_f32_16x16x32_bf16 v[48:51], a[196:199], a[32:35], v[48:51]
  v_mfma_f32_16x16x32_bf16 v[52:55], a[196:199], a[36:39], v[52:55]
  v_mfma_f32_16x16x32_bf16 v[16:19], a[176:179], a[40:43], v[16:19]
  v_mfma_f32_16x16x32_bf16 v[20:23], a[176:179], a[44:47], v[20:23]
  v_mfma_f32_16x16x32_bf16 v[24:27], a[176:179], a[48:51], v[24:27]
  v_mfma_f32_16x16x32_bf16 v[28:31], a[176:179], a[52:55], v[28:31]
  v_mfma_f32_16x16x32_bf16 v[32:35], a[176:179], a[56:59], v[32:35]
  v_mfma_f32_16x16x32_bf16 v[36:39], a[200:203], a[40:43], v[36:39]
  v_mfma_f32_16x16x32_bf16 v[40:43], a[200:203], a[44:47], v[40:43]
  v_mfma_f32_16x16x32_bf16 v[44:47], a[200:203], a[48:51], v[44:47]
  v_mfma_f32_16x16x32_bf16 v[48:51], a[200:203], a[52:55], v[48:51]
  v_mfma_f32_16x16x32_bf16 v[52:55], a[200:203], a[56:59], v[52:55]
  v_mfma_f32_16x16x32_bf16 v[16:19], a[180:183], a[60:63], v[16:19]
  v_mfma_f32_16x16x32_bf16 v[20:23], a[180:183], a[64:67], v[20:23]
  v_mfma_f32_16x16x32_bf16 v[24:27], a[180:183], a[68:71], v[24:27]
  v_mfma_f32_16x16x32_bf16 v[28:31], a[180:183], a[72:75], v[28:31]
  v_mfma_f32_16x16x32_bf16 v[32:35], a[180:183], a[76:79], v[32:35]
  v_mfma_f32_16x16x32_bf16 v[36:39], a[204:207], a[60:63], v[36:39]
  v_mfma_f32_16x16x32_bf16 v[40:43], a[204:207], a[64:67], v[40:43]
  v_mfma_f32_16x16x32_bf16 v[44:47], a[204:207], a[68:71], v[44:47]
  v_mfma_f32_16x16x32_bf16 v[48:51], a[204:207], a[72:75], v[48:51]
  v_mfma_f32_16x16x32_bf16 v[52:55], a[204:207], a[76:79], v[52:55]
  v_mfma_f32_16x16x32_bf16 v[16:19], a[184:187], a[80:83], v[16:19]
  v_mfma_f32_16x16x32_bf16 v[20:23], a[184:187], a[84:87], v[20:23]
  v_mfma_f32_16x16x32_bf16 v[24:27], a[184:187], a[88:91], v[24:27]
  v_mfma_f32_16x16x32_bf16 v[28:31], a[184:187], a[92:95], v[28:31]
  v_mfma_f32_16x16x32_bf16 v[32:35], a[184:187], a[96:99], v[32:35]
  v_mfma_f32_16x16x32_bf16 v[36:39], a[208:211], a[80:83], v[36:39]
  v_mfma_f32_16x16x32_bf16 v[40:43], a[208:211], a[84:87], v[40:43]
  v_mfma_f32_16x16x32_bf16 v[44:47], a[208:211], a[88:91], v[44:47]
  v_mfma_f32_16x16x32_bf16 v[48:51], a[208:211], a[92:95], v[48:51]
  v_mfma_f32_16x16x32_bf16 v[52:55], a[208:211], a[96:99], v[52:55]
  v_mfma_f32_16x16x32_bf16 v[16:19], a[188:191], a[100:103], v[16:19]
  v_mfma_f32_16x16x32_bf16 v[20:23], a[188:191], a[104:107], v[20:23]
  v_mfma_f32_16x16x32_bf16 v[24:27], a[188:191], a[108:111], v[24:27]
  v_mfma_f32_16x16x32_bf16 v[28:31], a[188:191], a[112:115], v[28:31]
  v_mfma_f32_16x16x32_bf16 v[32:35], a[188:191], a[116:119], v[32:35]
  v_mfma_f32_16x16x32_bf16 v[36:39], a[212:215], a[100:103], v[36:39]
  v_mfma_f32_16x16x32_bf16 v[40:43], a[212:215], a[104:107], v[40:43]
  v_mfma_f32_16x16x32_bf16 v[44:47], a[212:215], a[108:111], v[44:47]
  v_mfma_f32_16x16x32_bf16 v[48:51], a[212:215], a[112:115], v[48:51]
  v_mfma_f32_16x16x32_bf16 v[52:55], a[212:215], a[116:119], v[52:55]
  s_nop 7
  v_cvt_pk_bf16_f32 v212, v16, v17
  v_cvt_pk_bf16_f32 v213, v18, v19
  v_cvt_pk_bf16_f32 v214, v36, v37
  v_cvt_pk_bf16_f32 v215, v38, v39
  s_add_u32 s27, s26, 1024
  buffer_store_dwordx4 v[212:215], v2, s[8:11], s27 offen
  v_cvt_pk_bf16_f32 v216, v20, v21
  v_cvt_pk_bf16_f32 v217, v22, v23
  v_cvt_pk_bf16_f32 v218, v40, v41
  v_cvt_pk_bf16_f32 v219, v42, v43
  s_add_u32 s27, s26, 21504
  buffer_store_dwordx4 v[216:219], v2, s[8:11], s27 offen
  v_cvt_pk_bf16_f32 v220, v24, v25
  v_cvt_pk_bf16_f32 v221, v26, v27
  v_cvt_pk_bf16_f32 v222, v44, v45
  v_cvt_pk_bf16_f32 v223, v46, v47
  s_add_u32 s27, s26, 41984
  buffer_store_dwordx4 v[220:223], v2, s[8:11], s27 offen
  v_cvt_pk_bf16_f32 v224, v28, v29
  v_cvt_pk_bf16_f32 v225, v30, v31
  v_cvt_pk_bf16_f32 v226, v48, v49
  v_cvt_pk_bf16_f32 v227, v50, v51
  s_add_u32 s27, s26, 62464
  buffer_store_dwordx4 v[224:227], v2, s[8:11], s27 offen
  v_cvt_pk_bf16_f32 v212, v32, v33
  v_cvt_pk_bf16_f32 v213, v34, v35
  v_cvt_pk_bf16_f32 v214, v52, v53
  v_cvt_pk_bf16_f32 v215, v54, v55
  s_add_u32 s27, s26, 82944
  buffer_store_dwordx4 v[212:215], v2, s[8:11], s27 offen
  s_waitcnt vmcnt(34)
  v_mfma_f32_16x16x32_bf16 v[16:19], v[64:67], a[0:3], 0
  v_mfma_f32_16x16x32_bf16 v[20:23], v[64:67], a[4:7], 0
  v_mfma_f32_16x16x32_bf16 v[24:27], v[64:67], a[8:11], 0
  v_mfma_f32_16x16x32_bf16 v[28:31], v[64:67], a[12:15], 0
  v_mfma_f32_16x16x32_bf16 v[32:35], v[64:67], a[16:19], 0
  v_mfma_f32_16x16x32_bf16 v[36:39], v[88:91], a[0:3], 0
  v_mfma_f32_16x16x32_bf16 v[40:43], v[88:91], a[4:7], 0
  v_mfma_f32_16x16x32_bf16 v[44:47], v[88:91], a[8:11], 0
  v_mfma_f32_16x16x32_bf16 v[48:51], v[88:91], a[12:15], 0
  v_mfma_f32_16x16x32_bf16 v[52:55], v[88:91], a[16:19], 0
  v_mfma_f32_16x16x32_bf16 v[16:19], v[68:71], a[20:23], v[16:19]
  v_mfma_f32_16x16x32_bf16 v[20:23], v[68:71], a[24:27], v[20:23]
  v_mfma_f32_16x16x32_bf16 v[24:27], v[68:71], a[28:31], v[24:27]
  v_mfma_f32_16x16x32_bf16 v[28:31], v[68:71], a[32:35], v[28:31]
  v_mfma_f32_16x16x32_bf16 v[32:35], v[68:71], a[36:39], v[32:35]
  v_mfma_f32_16x16x32_bf16 v[36:39], v[92:95], a[20:23], v[36:39]
  v_mfma_f32_16x16x32_bf16 v[40:43], v[92:95], a[24:27], v[40:43]
  v_mfma_f32_16x16x32_bf16 v[44:47], v[92:95], a[28:31], v[44:47]
  v_mfma_f32_16x16x32_bf16 v[48:51], v[92:95], a[32:35], v[48:51]
  v_mfma_f32_16x16x32_bf16 v[52:55], v[92:95], a[36:39], v[52:55]
  v_mfma_f32_16x16x32_bf16 v[16:19], v[72:75], a[40:43], v[16:19]
  v_mfma_f32_16x16x32_bf16 v[20:23], v[72:75], a[44:47], v[20:23]
  v_mfma_f32_16x16x32_bf16 v[24:27], v[72:75], a[48:51], v[24:27]
  v_mfma_f32_16x16x32_bf16 v[28:31], v[72:75], a[52:55], v[28:31]
  v_mfma_f32_16x16x32_bf16 v[32:35], v[72:75], a[56:59], v[32:35]
  v_mfma_f32_16x16x32_bf16 v[36:39], v[96:99], a[40:43], v[36:39]
  v_mfma_f32_16x16x32_bf16 v[40:43], v[96:99], a[44:47], v[40:43]
  v_mfma_f32_16x16x32_bf16 v[44:47], v[96:99], a[48:51], v[44:47]
  v_mfma_f32_16x16x32_bf16 v[48:51], v[96:99], a[52:55], v[48:51]
  v_mfma_f32_16x16x32_bf16 v[52:55], v[96:99], a[56:59], v[52:55]
  v_mfma_f32_16x16x32_bf16 v[16:19], v[76:79], a[60:63], v[16:19]
  v_mfma_f32_16x16x32_bf16 v[20:23], v[76:79], a[64:67], v[20:23]
  v_mfma_f32_16x16x32_bf16 v[24:27], v[76:79], a[68:71], v[24:27]
  v_mfma_f32_16x16x32_bf16 v[28:31], v[76:79], a[72:75], v[28:31]
  v_mfma_f32_16x16x32_bf16 v[32:35], v[76:79], a[76:79], v[32:35]
  v_mfma_f32_16x16x32_bf16 v[36:39], v[100:103], a[60:63], v[36:39]
  v_mfma_f32_16x16x32_bf16 v[40:43], v[100:103], a[64:67], v[40:43]
  v_mfma_f32_16x16x32_bf16 v[44:47], v[100:103], a[68:71], v[44:47]
  v_mfma_f32_16x16x32_bf16 v[48:51], v[100:103], a[72:75], v[48:51]
  v_mfma_f32_16x16x32_bf16 v[52:55], v[100:103], a[76:79], v[52:55]
  v_mfma_f32_16x16x32_bf16 v[16:19], v[80:83], a[80:83], v[16:19]
  v_mfma_f32_16x16x32_bf16 v[20:23], v[80:83], a[84:87], v[20:23]
  v_mfma_f32_16x16x32_bf16 v[24:27], v[80:83], a[88:91], v[24:27]
  v_mfma_f32_16x16x32_bf16 v[28:31], v[80:83], a[92:95], v[28:31]
  v_mfma_f32_16x16x32_bf16 v[32:35], v[80:83], a[96:99], v[32:35]
  v_mfma_f32_16x16x32_bf16 v[36:39], v[104:107], a[80:83], v[36:39]
  v_mfma_f32_16x16x32_bf16 v[40:43], v[104:107], a[84:87], v[40:43]
  v_mfma_f32_16x16x32_bf16 v[44:47], v[104:107], a[88:91], v[44:47]
  v_mfma_f32_16x16x32_bf16 v[48:51], v[104:107], a[92:95], v[48:51]
  v_mfma_f32_16x16x32_bf16 v[52:55], v[104:107], a[96:99], v[52:55]
  v_mfma_f32_16x16x32_bf16 v[16:19], v[84:87], a[100:103], v[16:19]
  v_mfma_f32_16x16x32_bf16 v[20:23], v[84:87], a[104:107], v[20:23]
  v_mfma_f32_16x16x32_bf16 v[24:27], v[84:87], a[108:111], v[24:27]
  v_mfma_f32_16x16x32_bf16 v[28:31], v[84:87], a[112:115], v[28:31]
  v_mfma_f32_16x16x32_bf16 v[32:35], v[84:87], a[116:119], v[32:35]
  v_mfma_f32_16x16x32_bf16 v[36:39], v[108:111], a[100:103], v[36:39]
  v_mfma_f32_16x16x32_bf16 v[40:43], v[108:111], a[104:107], v[40:43]
  v_mfma_f32_16x16x32_bf16 v[44:47], v[108:111], a[108:111], v[44:47]
  v_mfma_f32_16x16x32_bf16 v[48:51], v[108:111], a[112:115], v[48:51]
  v_mfma_f32_16x16x32_bf16 v[52:55], v[108:111], a[116:119], v[52:55]
  s_nop 7
  v_cvt_pk_bf16_f32 v212, v16, v17
  v_cvt_pk_bf16_f32 v213, v18, v19
  v_cvt_pk_bf16_f32 v214, v36, v37
  v_cvt_pk_bf16_f32 v215, v38, v39
  s_add_u32 s27, s26, 2048
  buffer_store_dwordx4 v[212:215], v2, s[8:11], s27 offen
  v_cvt_pk_bf16_f32 v216, v20, v21
  v_cvt_pk_bf16_f32 v217, v22, v23
  v_cvt_pk_bf16_f32 v218, v40, v41
  v_cvt_pk_bf16_f32 v219, v42, v43
  s_add_u32 s27, s26, 22528
  buffer_store_dwordx4 v[216:219], v2, s[8:11], s27 offen
  v_cvt_pk_bf16_f32 v220, v24, v25
  v_cvt_pk_bf16_f32 v221, v26, v27
  v_cvt_pk_bf16_f32 v222, v44, v45
  v_cvt_pk_bf16_f32 v223, v46, v47
  s_add_u32 s27, s26, 43008
  buffer_store_dwordx4 v[220:223], v2, s[8:11], s27 offen
  v_cvt_pk_bf16_f32 v224, v28, v29
  v_cvt_pk_bf16_f32 v225, v30, v31
  v_cvt_pk_bf16_f32 v226, v48, v49
  v_cvt_pk_bf16_f32 v227, v50, v51
  s_add_u32 s27, s26, 63488
  buffer_store_dwordx4 v[224:227], v2, s[8:11], s27 offen
  v_cvt_pk_bf16_f32 v212, v32, v33
  v_cvt_pk_bf16_f32 v213, v34, v35
  v_cvt_pk_bf16_f32 v214, v52, v53
  v_cvt_pk_bf16_f32 v215, v54, v55
  s_add_u32 s27, s26, 83968
  buffer_store_dwordx4 v[212:215], v2, s[8:11], s27 offen
  s_waitcnt vmcnt(27)
  v_mfma_f32_16x16x32_bf16 v[16:19], v[112:115], a[0:3], 0
  v_mfma_f32_16x16x32_bf16 v[20:23], v[112:115], a[4:7], 0
  v_mfma_f32_16x16x32_bf16 v[24:27], v[112:115], a[8:11], 0
  v_mfma_f32_16x16x32_bf16 v[28:31], v[112:115], a[12:15], 0
  v_mfma_f32_16x16x32_bf16 v[32:35], v[112:115], a[16:19], 0
  v_mfma_f32_16x16x32_bf16 v[36:39], v[136:139], a[0:3], 0
  v_mfma_f32_16x16x32_bf16 v[40:43], v[136:139], a[4:7], 0
  v_mfma_f32_16x16x32_bf16 v[44:47], v[136:139], a[8:11], 0
  v_mfma_f32_16x16x32_bf16 v[48:51], v[136:139], a[12:15], 0
  v_mfma_f32_16x16x32_bf16 v[52:55], v[136:139], a[16:19], 0
  v_mfma_f32_16x16x32_bf16 v[16:19], v[116:119], a[20:23], v[16:19]
  v_mfma_f32_16x16x32_bf16 v[20:23], v[116:119], a[24:27], v[20:23]
  v_mfma_f32_16x16x32_bf16 v[24:27], v[116:119], a[28:31], v[24:27]
  v_mfma_f32_16x16x32_bf16 v[28:31], v[116:119], a[32:35], v[28:31]
  v_mfma_f32_16x16x32_bf16 v[32:35], v[116:119], a[36:39], v[32:35]
  v_mfma_f32_16x16x32_bf16 v[36:39], v[140:143], a[20:23], v[36:39]
  v_mfma_f32_16x16x32_bf16 v[40:43], v[140:143], a[24:27], v[40:43]
  v_mfma_f32_16x16x32_bf16 v[44:47], v[140:143], a[28:31], v[44:47]
  v_mfma_f32_16x16x32_bf16 v[48:51], v[140:143], a[32:35], v[48:51]
  v_mfma_f32_16x16x32_bf16 v[52:55], v[140:143], a[36:39], v[52:55]
  v_mfma_f32_16x16x32_bf16 v[16:19], v[120:123], a[40:43], v[16:19]
  v_mfma_f32_16x16x32_bf16 v[20:23], v[120:123], a[44:47], v[20:23]
  v_mfma_f32_16x16x32_bf16 v[24:27], v[120:123], a[48:51], v[24:27]
  v_mfma_f32_16x16x32_bf16 v[28:31], v[120:123], a[52:55], v[28:31]
  v_mfma_f32_16x16x32_bf16 v[32:35], v[120:123], a[56:59], v[32:35]
  v_mfma_f32_16x16x32_bf16 v[36:39], v[144:147], a[40:43], v[36:39]
  v_mfma_f32_16x16x32_bf16 v[40:43], v[144:147], a[44:47], v[40:43]
  v_mfma_f32_16x16x32_bf16 v[44:47], v[144:147], a[48:51], v[44:47]
  v_mfma_f32_16x16x32_bf16 v[48:51], v[144:147], a[52:55], v[48:51]
  v_mfma_f32_16x16x32_bf16 v[52:55], v[144:147], a[56:59], v[52:55]
  v_mfma_f32_16x16x32_bf16 v[16:19], v[124:127], a[60:63], v[16:19]
  v_mfma_f32_16x16x32_bf16 v[20:23], v[124:127], a[64:67], v[20:23]
  v_mfma_f32_16x16x32_bf16 v[24:27], v[124:127], a[68:71], v[24:27]
  v_mfma_f32_16x16x32_bf16 v[28:31], v[124:127], a[72:75], v[28:31]
  v_mfma_f32_16x16x32_bf16 v[32:35], v[124:127], a[76:79], v[32:35]
  v_mfma_f32_16x16x32_bf16 v[36:39], v[148:151], a[60:63], v[36:39]
  v_mfma_f32_16x16x32_bf16 v[40:43], v[148:151], a[64:67], v[40:43]
  v_mfma_f32_16x16x32_bf16 v[44:47], v[148:151], a[68:71], v[44:47]
  v_mfma_f32_16x16x32_bf16 v[48:51], v[148:151], a[72:75], v[48:51]
  v_mfma_f32_16x16x32_bf16 v[52:55], v[148:151], a[76:79], v[52:55]
  v_mfma_f32_16x16x32_bf16 v[16:19], v[128:131], a[80:83], v[16:19]
  v_mfma_f32_16x16x32_bf16 v[20:23], v[128:131], a[84:87], v[20:23]
  v_mfma_f32_16x16x32_bf16 v[24:27], v[128:131], a[88:91], v[24:27]
  v_mfma_f32_16x16x32_bf16 v[28:31], v[128:131], a[92:95], v[28:31]
  v_mfma_f32_16x16x32_bf16 v[32:35], v[128:131], a[96:99], v[32:35]
  v_mfma_f32_16x16x32_bf16 v[36:39], v[152:155], a[80:83], v[36:39]
  v_mfma_f32_16x16x32_bf16 v[40:43], v[152:155], a[84:87], v[40:43]
  v_mfma_f32_16x16x32_bf16 v[44:47], v[152:155], a[88:91], v[44:47]
  v_mfma_f32_16x16x32_bf16 v[48:51], v[152:155], a[92:95], v[48:51]
  v_mfma_f32_16x16x32_bf16 v[52:55], v[152:155], a[96:99], v[52:55]
  v_mfma_f32_16x16x32_bf16 v[16:19], v[132:135], a[100:103], v[16:19]
  v_mfma_f32_16x16x32_bf16 v[20:23], v[132:135], a[104:107], v[20:23]
  v_mfma_f32_16x16x32_bf16 v[24:27], v[132:135], a[108:111], v[24:27]
  v_mfma_f32_16x16x32_bf16 v[28:31], v[132:135], a[112:115], v[28:31]
  v_mfma_f32_16x16x32_bf16 v[32:35], v[132:135], a[116:119], v[32:35]
  v_mfma_f32_16x16x32_bf16 v[36:39], v[156:159], a[100:103], v[36:39]
  v_mfma_f32_16x16x32_bf16 v[40:43], v[156:159], a[104:107], v[40:43]
  v_mfma_f32_16x16x32_bf16 v[44:47], v[156:159], a[108:111], v[44:47]
  v_mfma_f32_16x16x32_bf16 v[48:51], v[156:159], a[112:115], v[48:51]
  v_mfma_f32_16x16x32_bf16 v[52:55], v[156:159], a[116:119], v[52:55]
  s_nop 7
  v_cvt_pk_bf16_f32 v212, v16, v17
  v_cvt_pk_bf16_f32 v213, v18, v19
  v_cvt_pk_bf16_f32 v214, v36, v37
  v_cvt_pk_bf16_f32 v215, v38, v39
  s_add_u32 s27, s26, 3072
  buffer_store_dwordx4 v[212:215], v2, s[8:11], s27 offen
  v_cvt_pk_bf16_f32 v216, v20, v21
  v_cvt_pk_bf16_f32 v217, v22, v23
  v_cvt_pk_bf16_f32 v218, v40, v41
  v_cvt_pk_bf16_f32 v219, v42, v43
  s_add_u32 s27, s26, 23552
  buffer_store_dwordx4 v[216:219], v2, s[8:11], s27 offen
  v_cvt_pk_bf16_f32 v220, v24, v25
  v_cvt_pk_bf16_f32 v221, v26, v27
  v_cvt_pk_bf16_f32 v222, v44, v45
  v_cvt_pk_bf16_f32 v223, v46, v47
  s_add_u32 s27, s26, 44032
  buffer_store_dwordx4 v[220:223], v2, s[8:11], s27 offen
  v_cvt_pk_bf16_f32 v224, v28, v29
  v_cvt_pk_bf16_f32 v225, v30, v31
  v_cvt_pk_bf16_f32 v226, v48, v49
  v_cvt_pk_bf16_f32 v227, v50, v51
  s_add_u32 s27, s26, 64512
  buffer_store_dwordx4 v[224:227], v2, s[8:11], s27 offen
  v_cvt_pk_bf16_f32 v212, v32, v33
  v_cvt_pk_bf16_f32 v213, v34, v35
  v_cvt_pk_bf16_f32 v214, v52, v53
  v_cvt_pk_bf16_f32 v215, v54, v55
  s_add_u32 s27, s26, 84992
  buffer_store_dwordx4 v[212:215], v2, s[8:11], s27 offen
  s_waitcnt vmcnt(20)
  v_mfma_f32_16x16x32_bf16 v[16:19], v[160:163], a[0:3], 0
  v_mfma_f32_16x16x32_bf16 v[20:23], v[160:163], a[4:7], 0
  v_mfma_f32_16x16x32_bf16 v[24:27], v[160:163], a[8:11], 0
  v_mfma_f32_16x16x32_bf16 v[28:31], v[160:163], a[12:15], 0
  v_mfma_f32_16x16x32_bf16 v[32:35], v[160:163], a[16:19], 0
  v_mfma_f32_16x16x32_bf16 v[36:39], v[184:187], a[0:3], 0
  v_mfma_f32_16x16x32_bf16 v[40:43], v[184:187], a[4:7], 0
  v_mfma_f32_16x16x32_bf16 v[44:47], v[184:187], a[8:11], 0
  v_mfma_f32_16x16x32_bf16 v[48:51], v[184:187], a[12:15], 0
  v_mfma_f32_16x16x32_bf16 v[52:55], v[184:187], a[16:19], 0
  v_mfma_f32_16x16x32_bf16 v[16:19], v[164:167], a[20:23], v[16:19]
  v_mfma_f32_16x16x32_bf16 v[20:23], v[164:167], a[24:27], v[20:23]
  v_mfma_f32_16x16x32_bf16 v[24:27], v[164:167], a[28:31], v[24:27]
  v_mfma_f32_16x16x32_bf16 v[28:31], v[164:167], a[32:35], v[28:31]
  v_mfma_f32_16x16x32_bf16 v[32:35], v[164:167], a[36:39], v[32:35]
  v_mfma_f32_16x16x32_bf16 v[36:39], v[188:191], a[20:23], v[36:39]
  v_mfma_f32_16x16x32_bf16 v[40:43], v[188:191], a[24:27], v[40:43]
  v_mfma_f32_16x16x32_bf16 v[44:47], v[188:191], a[28:31], v[44:47]
  v_mfma_f32_16x16x32_bf16 v[48:51], v[188:191], a[32:35], v[48:51]
  v_mfma_f32_16x16x32_bf16 v[52:55], v[188:191], a[36:39], v[52:55]
  v_mfma_f32_16x16x32_bf16 v[16:19], v[168:171], a[40:43], v[16:19]
  v_mfma_f32_16x16x32_bf16 v[20:23], v[168:171], a[44:47], v[20:23]
  v_mfma_f32_16x16x32_bf16 v[24:27], v[168:171], a[48:51], v[24:27]
  v_mfma_f32_16x16x32_bf16 v[28:31], v[168:171], a[52:55], v[28:31]
  v_mfma_f32_16x16x32_bf16 v[32:35], v[168:171], a[56:59], v[32:35]
  v_mfma_f32_16x16x32_bf16 v[36:39], v[192:195], a[40:43], v[36:39]
  v_mfma_f32_16x16x32_bf16 v[40:43], v[192:195], a[44:47], v[40:43]
  v_mfma_f32_16x16x32_bf16 v[44:47], v[192:195], a[48:51], v[44:47]
  v_mfma_f32_16x16x32_bf16 v[48:51], v[192:195], a[52:55], v[48:51]
  v_mfma_f32_16x16x32_bf16 v[52:55], v[192:195], a[56:59], v[52:55]
  v_mfma_f32_16x16x32_bf16 v[16:19], v[172:175], a[60:63], v[16:19]
  v_mfma_f32_16x16x32_bf16 v[20:23], v[172:175], a[64:67], v[20:23]
  v_mfma_f32_16x16x32_bf16 v[24:27], v[172:175], a[68:71], v[24:27]
  v_mfma_f32_16x16x32_bf16 v[28:31], v[172:175], a[72:75], v[28:31]
  v_mfma_f32_16x16x32_bf16 v[32:35], v[172:175], a[76:79], v[32:35]
  v_mfma_f32_16x16x32_bf16 v[36:39], v[196:199], a[60:63], v[36:39]
  v_mfma_f32_16x16x32_bf16 v[40:43], v[196:199], a[64:67], v[40:43]
  v_mfma_f32_16x16x32_bf16 v[44:47], v[196:199], a[68:71], v[44:47]
  v_mfma_f32_16x16x32_bf16 v[48:51], v[196:199], a[72:75], v[48:51]
  v_mfma_f32_16x16x32_bf16 v[52:55], v[196:199], a[76:79], v[52:55]
  v_mfma_f32_16x16x32_bf16 v[16:19], v[176:179], a[80:83], v[16:19]
  v_mfma_f32_16x16x32_bf16 v[20:23], v[176:179], a[84:87], v[20:23]
  v_mfma_f32_16x16x32_bf16 v[24:27], v[176:179], a[88:91], v[24:27]
  v_mfma_f32_16x16x32_bf16 v[28:31], v[176:179], a[92:95], v[28:31]
  v_mfma_f32_16x16x32_bf16 v[32:35], v[176:179], a[96:99], v[32:35]
  v_mfma_f32_16x16x32_bf16 v[36:39], v[200:203], a[80:83], v[36:39]
  v_mfma_f32_16x16x32_bf16 v[40:43], v[200:203], a[84:87], v[40:43]
  v_mfma_f32_16x16x32_bf16 v[44:47], v[200:203], a[88:91], v[44:47]
  v_mfma_f32_16x16x32_bf16 v[48:51], v[200:203], a[92:95], v[48:51]
  v_mfma_f32_16x16x32_bf16 v[52:55], v[200:203], a[96:99], v[52:55]
  v_mfma_f32_16x16x32_bf16 v[16:19], v[180:183], a[100:103], v[16:19]
  v_mfma_f32_16x16x32_bf16 v[20:23], v[180:183], a[104:107], v[20:23]
  v_mfma_f32_16x16x32_bf16 v[24:27], v[180:183], a[108:111], v[24:27]
  v_mfma_f32_16x16x32_bf16 v[28:31], v[180:183], a[112:115], v[28:31]
  v_mfma_f32_16x16x32_bf16 v[32:35], v[180:183], a[116:119], v[32:35]
  v_mfma_f32_16x16x32_bf16 v[36:39], v[204:207], a[100:103], v[36:39]
  v_mfma_f32_16x16x32_bf16 v[40:43], v[204:207], a[104:107], v[40:43]
  v_mfma_f32_16x16x32_bf16 v[44:47], v[204:207], a[108:111], v[44:47]
  v_mfma_f32_16x16x32_bf16 v[48:51], v[204:207], a[112:115], v[48:51]
  v_mfma_f32_16x16x32_bf16 v[52:55], v[204:207], a[116:119], v[52:55]
  s_nop 7
  v_cvt_pk_bf16_f32 v212, v16, v17
  v_cvt_pk_bf16_f32 v213, v18, v19
  v_cvt_pk_bf16_f32 v214, v36, v37
  v_cvt_pk_bf16_f32 v215, v38, v39
  s_add_u32 s27, s26, 4096
  buffer_store_dwordx4 v[212:215], v2, s[8:11], s27 offen
  v_cvt_pk_bf16_f32 v216, v20, v21
  v_cvt_pk_bf16_f32 v217, v22, v23
  v_cvt_pk_bf16_f32 v218, v40, v41
  v_cvt_pk_bf16_f32 v219, v42, v43
  s_add_u32 s27, s26, 24576
  buffer_store_dwordx4 v[216:219], v2, s[8:11], s27 offen
  v_cvt_pk_bf16_f32 v220, v24, v25
  v_cvt_pk_bf16_f32 v221, v26, v27
  v_cvt_pk_bf16_f32 v222, v44, v45
  v_cvt_pk_bf16_f32 v223, v46, v47
  s_add_u32 s27, s26, 45056
  buffer_store_dwordx4 v[220:223], v2, s[8:11], s27 offen
  v_cvt_pk_bf16_f32 v224, v28, v29
  v_cvt_pk_bf16_f32 v225, v30, v31
  v_cvt_pk_bf16_f32 v226, v48, v49
  v_cvt_pk_bf16_f32 v227, v50, v51
  s_add_u32 s27, s26, 65536
  buffer_store_dwordx4 v[224:227], v2, s[8:11], s27 offen
  v_cvt_pk_bf16_f32 v212, v32, v33
  v_cvt_pk_bf16_f32 v213, v34, v35
  v_cvt_pk_bf16_f32 v214, v52, v53
  v_cvt_pk_bf16_f32 v215, v54, v55
  s_add_u32 s27, s26, 86016
  buffer_store_dwordx4 v[212:215], v2, s[8:11], s27 offen
  s_cmp_eq_u32 s2, 0
  s_cbranch_scc0 z_20
  s_cmp_eq_u32 s21, 0
  s_cbranch_scc0 z_20
  v_mov_b32 v8, 0
  v_mov_b32 v9, 0
  v_mov_b32 v10, 0
  v_mov_b32 v11, 0
  s_mov_b32 s26, 0x0
  buffer_store_dwordx4 v[8:11], v2, s[8:11], s26 offen
  s_add_u32 s26, s26, 1024
  buffer_store_dwordx4 v[8:11], v2, s[8:11], s26 offen
  s_add_u32 s26, s26, 1024
  buffer_store_dwordx4 v[8:11], v2, s[8:11], s26 offen
  s_add_u32 s26, s26, 1024
  buffer_store_dwordx4 v[8:11], v2, s[8:11], s26 offen
  s_add_u32 s26, s26, 1024
  buffer_store_dwordx4 v[8:11], v2, s[8:11], s26 offen
  s_add_u32 s26, s26, 1024
  buffer_store_dwordx4 v[8:11], v2, s[8:11], s26 offen
  s_add_u32 s26, s26, 1024
  s_mov_b32 s26, 0x8000
  buffer_store_dwordx4 v[8:11], v2, s[8:11], s26 offen
  s_add_u32 s26, s26, 1024
  buffer_store_dwordx4 v[8:11], v2, s[8:11], s26 offen
  s_add_u32 s26, s26, 1024
  buffer_store_dwordx4 v[8:11], v2, s[8:11], s26 offen
  s_add_u32 s26, s26, 1024
  buffer_store_dwordx4 v[8:11], v2, s[8:11], s26 offen
  s_add_u32 s26, s26, 1024
  buffer_store_dwordx4 v[8:11], v2, s[8:11], s26 offen
  s_add_u32 s26, s26, 1024
  buffer_store_dwordx4 v[8:11], v2, s[8:11], s26 offen
  s_add_u32 s26, s26, 1024
  buffer_store_dwordx4 v[8:11], v2, s[8:11], s26 offen
  s_add_u32 s26, s26, 1024
  buffer_store_dwordx4 v[8:11], v2, s[8:11], s26 offen
  s_add_u32 s26, s26, 1024
  buffer_store_dwordx4 v[8:11], v2, s[8:11], s26 offen
  s_add_u32 s26, s26, 1024
  buffer_store_dwordx4 v[8:11], v2, s[8:11], s26 offen
  s_add_u32 s26, s26, 1024
  buffer_store_dwordx4 v[8:11], v2, s[8:11], s26 offen
  s_add_u32 s26, s26, 1024
  buffer_store_dwordx4 v[8:11], v2, s[8:11], s26 offen
  s_add_u32 s26, s26, 1024
  buffer_store_dwordx4 v[8:11], v2, s[8:11], s26 offen
  s_add_u32 s26, s26, 1024
  buffer_store_dwordx4 v[8:11], v2, s[8:11], s26 offen
  s_add_u32 s26, s26, 1024
  buffer_store_dwordx4 v[8:11], v2, s[8:11], s26 offen
  s_add_u32 s26, s26, 1024
  buffer_store_dwordx4 v[8:11], v2, s[8:11], s26 offen
  s_add_u32 s26, s26, 1024
z_20:
  s_cmp_eq_u32 s2, 1
  s_cbranch_scc0 m0_21
  s_cmp_eq_u32 s21, 0
  s_cbranch_scc0 m0_21
  s_mov_b32 s12, s38
  s_and_b32 s13, s39, 0xffff
  s_mov_b32 s14, 0x2800
  s_mov_b32 s15, 0x20000
  v_and_b32 v8, 7, v1
  v_mul_u32_u24 v8, 1280, v8
  v_lshrrev_b32 v9, 4, v1
  v_lshlrev_b32 v9, 5, v9
  v_add_u32 v8, v8, v9
  v_bfe_u32 v9, v1, 3, 1
  v_lshlrev_b32 v9, 2, v9
  v_add_u32 v8, v8, v9
  s_mov_b32 s26, 0x4000
  buffer_load_dword v16, v8, s[12:15], 0 offen offset:0
  buffer_load_dword v17, v8, s[12:15], 0 offen offset:8
  buffer_load_dword v18, v8, s[12:15], 0 offen offset:16
  buffer_load_dword v19, v8, s[12:15], 0 offen offset:24
  buffer_load_dword v20, v8, s[12:15], 0 offen offset:128
  buffer_load_dword v21, v8, s[12:15], 0 offen offset:136
  buffer_load_dword v22, v8, s[12:15], 0 offen offset:144
  buffer_load_dword v23, v8, s[12:15], 0 offen offset:152
  buffer_load_dword v24, v8, s[12:15], 0 offen offset:256
  buffer_load_dword v25, v8, s[12:15], 0 offen offset:264
  buffer_load_dword v26, v8, s[12:15], 0 offen offset:272
  buffer_load_dword v27, v8, s[12:15], 0 offen offset:280
  buffer_load_dword v28, v8, s[12:15], 0 offen offset:384
  buffer_load_dword v29, v8, s[12:15], 0 offen offset:392
  buffer_load_dword v30, v8, s[12:15], 0 offen offset:400
  buffer_load_dword v31, v8, s[12:15], 0 offen offset:408
  buffer_load_dword v32, v8, s[12:15], 0 offen offset:512
  buffer_load_dword v33, v8, s[12:15], 0 offen offset:520
  buffer_load_dword v34, v8, s[12:15], 0 offen offset:528
  buffer_load_dword v35, v8, s[12:15], 0 offen offset:536
  buffer_load_dword v36, v8, s[12:15], 0 offen offset:640
  buffer_load_dword v37, v8, s[12:15], 0 offen offset:648
  buffer_load_dword v38, v8, s[12:15], 0 offen offset:656
  buffer_load_dword v39, v8, s[12:15], 0 offen offset:664
  buffer_load_dword v40, v8, s[12:15], 0 offen offset:768
  buffer_load_dword v41, v8, s[12:15], 0 offen offset:776
  buffer_load_dword v42, v8, s[12:15], 0 offen offset:784
  buffer_load_dword v43, v8, s[12:15], 0 offen offset:792
  buffer_load_dword v44, v8, s[12:15], 0 offen offset:896
  buffer_load_dword v45, v8, s[12:15], 0 offen offset:904
  buffer_load_dword v46, v8, s[12:15], 0 offen offset:912
  buffer_load_dword v47, v8, s[12:15], 0 offen offset:920
  buffer_load_dword v48, v8, s[12:15], 0 offen offset:1024
  buffer_load_dword v49, v8, s[12:15], 0 offen offset:1032
  buffer_load_dword v50, v8, s[12:15], 0 offen offset:1040
  buffer_load_dword v51, v8, s[12:15], 0 offen offset:1048
  buffer_load_dword v52, v8, s[12:15], 0 offen offset:1152
  buffer_load_dword v53, v8, s[12:15], 0 offen offset:1160
  buffer_load_dword v54, v8, s[12:15], 0 offen offset:1168
  buffer_load_dword v55, v8, s[12:15], 0 offen offset:1176
  s_waitcnt vmcnt(0)
  buffer_store_dwordx4 v[16:19], v2, s[8:11], s26 offen
  s_add_u32 s26, s26, 1024
  buffer_store_dwordx4 v[20:23], v2, s[8:11], s26 offen
  s_add_u32 s26, s26, 1024
  buffer_store_dwordx4 v[24:27], v2, s[8:11], s26 offen
  s_add_u32 s26, s26, 1024
  buffer_store_dwordx4 v[28:31], v2, s[8:11], s26 offen
  s_add_u32 s26, s26, 1024
  buffer_store_dwordx4 v[32:35], v2, s[8:11], s26 offen
  s_add_u32 s26, s26, 1024
  buffer_store_dwordx4 v[36:39], v2, s[8:11], s26 offen
  s_add_u32 s26, s26, 1024
  buffer_store_dwordx4 v[40:43], v2, s[8:11], s26 offen
  s_add_u32 s26, s26, 1024
  buffer_store_dwordx4 v[44:47], v2, s[8:11], s26 offen
  s_add_u32 s26, s26, 1024
  buffer_store_dwordx4 v[48:51], v2, s[8:11], s26 offen
  s_add_u32 s26, s26, 1024
  buffer_store_dwordx4 v[52:55], v2, s[8:11], s26 offen
  s_add_u32 s26, s26, 1024
m0_21:
k0_exit:
  s_endpgm

.section .rodata,"a"
.p2align 6
.amdhsa_kernel prep_kernel
  .amdhsa_next_free_vgpr 512
  .amdhsa_next_free_sgpr 102
  .amdhsa_accum_offset 256
  .amdhsa_group_segment_fixed_size 0
  .amdhsa_kernarg_size 104
  .amdhsa_user_sgpr_count 2
  .amdhsa_user_sgpr_kernarg_segment_ptr 1
  .amdhsa_system_sgpr_workgroup_id_x 1
.end_amdhsa_kernel
.text
.globl ka1_kernel
.p2align 8
.type ka1_kernel,@function
ka1_kernel:
  s_mov_b32 s99, 0
  s_branch ka_body

.section .rodata,"a"
.p2align 6
.amdhsa_kernel ka1_kernel
  .amdhsa_next_free_vgpr 512
  .amdhsa_next_free_sgpr 102
  .amdhsa_accum_offset 256
  .amdhsa_group_segment_fixed_size 0
  .amdhsa_kernarg_size 104
  .amdhsa_user_sgpr_count 2
  .amdhsa_user_sgpr_kernarg_segment_ptr 1
  .amdhsa_system_sgpr_workgroup_id_x 1
.end_amdhsa_kernel
.text
.globl kb1_kernel
.p2align 8
.type kb1_kernel,@function
kb1_kernel:
  s_cmp_ge_u32 s2, 256
  s_cbranch_scc1 kb1_exit
  s_load_dwordx2 s[36:37], s[0:1], 0
  s_load_dwordx2 s[38:39], s[0:1], 80
  s_load_dwordx2 s[4:5], s[0:1], 96
  v_lshrrev_b32 v1, 6, v0
  s_nop 0
  v_readfirstlane_b32 s21, v1
  v_and_b32 v1, 63, v0
  v_lshlrev_b32 v2, 4, v1
  s_waitcnt lgkmcnt(0)
  s_mov_b32 s8, s4
  s_and_b32 s9, s5, 0xffff
  s_mov_b32 s10, 0x10000000
  s_mov_b32 s11, 0x20000
  s_mov_b32 s12, s36
  s_and_b32 s13, s37, 0xffff
  s_mov_b32 s14, 0x280000
  s_mov_b32 s15, 0x20000
  s_mov_b32 s16, s38
  s_and_b32 s17, s39, 0xffff
  s_mov_b32 s18, 0x280000
  s_mov_b32 s19, 0x20000
  s_and_b32 s22, s2, 7
  s_lshl_b32 s22, s22, 2
  s_bfe_u32 s23, s2, 0x20003
  s_add_u32 s22, s22, s23
  s_lshr_b32 s23, s2, 5
  s_lshl_b32 s46, s23, 7
  s_add_u32 s46, s46, 0x8000
  s_add_u32 s48, s46, 0x1400
  s_lshl_b32 s47, s22, 7
  s_add_u32 s47, s47, 0x8400
  s_lshr_b32 s26, s2, 2
  s_and_b32 s27, s2, 3
  s_lshl_b32 s27, s27, 3
  v_and_b32 v5, 7, v1
  v_bfe_u32 v6, v1, 3, 1
  v_lshrrev_b32 v7, 4, v1
  v_lshlrev_b32 v8, 5, v6
  v_add_u32 v8, v8, v5
  v_add_u32 v8, s27, v8
  v_lshlrev_b32 v8, 4, v8
  v_lshlrev_b32 v9, 11, v7
  v_add_u32 v9, v9, v8
  v_lshlrev_b32 v10, 10, v7
  v_add_u32 v10, v10, v8
  s_mul_i32 s28, s26, 81920
  s_lshl_b32 s29, s21, 13
  s_add_u32 s28, s28, s29
  s_cmp_lt_u32 s21, 2
  s_cselect_b32 s49, 3, 2
  v_mov_b32 v32, 0
  v_mov_b32 v33, 0
  v_mov_b32 v34, 0
  v_mov_b32 v35, 0
  v_mov_b32 v36, 0
  v_mov_b32 v37, 0
  v_mov_b32 v38, 0
  v_mov_b32 v39, 0
  v_mov_b32 v56, 0
  v_mov_b32 v57, 0
  v_mov_b32 v58, 0
  v_mov_b32 v59, 0
  v_mov_b32 v68, 0
  v_mov_b32 v69, 0
  v_mov_b32 v70, 0
  v_mov_b32 v71, 0
  v_mov_b32 v80, 0
  v_mov_b32 v81, 0
  v_mov_b32 v82, 0
  v_mov_b32 v83, 0
  v_mov_b32 v92, 0
  v_mov_b32 v93, 0
  v_mov_b32 v94, 0
  v_mov_b32 v95, 0
  s_mul_i32 s33, s26, 40960
  s_lshl_b32 s30, s21, 12
  s_add_u32 s33, s33, s30
  s_add_u32 s30, s33, 27262976
  buffer_load_dwordx4 v[48:51], v10, s[8:11], s30 offen
  s_add_u32 s30, s33, 29884416
  buffer_load_dwordx4 v[60:63], v10, s[8:11], s30 offen
  s_add_u32 s30, s33, 32505856
  buffer_load_dwordx4 v[72:75], v10, s[8:11], s30 offen
  s_add_u32 s30, s33, 35127296
  buffer_load_dwordx4 v[84:87], v10, s[8:11], s30 offen
  s_add_u32 s30, s33, 27279360
  buffer_load_dwordx4 v[52:55], v10, s[8:11], s30 offen
  s_add_u32 s30, s33, 29900800
  buffer_load_dwordx4 v[64:67], v10, s[8:11], s30 offen
  s_add_u32 s30, s33, 32522240
  buffer_load_dwordx4 v[76:79], v10, s[8:11], s30 offen
  s_add_u32 s30, s33, 35143680
  buffer_load_dwordx4 v[88:91], v10, s[8:11], s30 offen
  s_cmp_lt_u32 s21, 2
  s_cbranch_scc0 g3_22
  s_add_u32 s30, s33, 27295744
  buffer_load_dwordx4 v[56:59], v10, s[8:11], s30 offen
  s_add_u32 s30, s33, 29917184
  buffer_load_dwordx4 v[68:71], v10, s[8:11], s30 offen
  s_add_u32 s30, s33, 32538624
  buffer_load_dwordx4 v[80:83], v10, s[8:11], s30 offen
  s_add_u32 s30, s33, 35160064
  buffer_load_dwordx4 v[92:95], v10, s[8:11], s30 offen
g3_22:
  s_lshl_b32 s30, s26, 5
  s_add_u32 s30, s30, s27
  v_add_u32 v11, s30, v5
  v_mul_u32_u24 v11, 1280, v11
  v_lshlrev_b32 v12, 5, v7
  v_add_u32 v11, v11, v12
  v_lshlrev_b32 v12, 4, v6
  v_add_u32 v11, v11, v12
  s_lshl_b32 s30, s21, 7
  buffer_load_dwordx4 v[144:147], v11, s[12:15], s30 offen offset:0
  buffer_load_dwordx4 v[148:151], v11, s[12:15], s30 offen offset:512
  s_cmp_lt_u32 s21, 2
  s_cbranch_scc0 g3_23
  buffer_load_dwordx4 v[152:155], v11, s[12:15], s30 offen offset:1024
g3_23:
  s_mul_i32 s30, s22, 122880
  s_mul_i32 s31, s21, 30720
  s_add_u32 s30, s30, s31
  s_add_u32 s30, s30, 0xe100000
  s_add_u32 m0, s31, 0
  s_add_u32 s29, s30, 0
  buffer_load_dwordx4 v2, s[8:11], s29 offen lds
  s_add_u32 m0, s31, 1024
  s_add_u32 s29, s30, 1024
  buffer_load_dwordx4 v2, s[8:11], s29 offen lds
  s_add_u32 m0, s31, 2048
  s_add_u32 s29, s30, 2048
  buffer_load_dwordx4 v2, s[8:11], s29 offen lds
  s_add_u32 m0, s31, 3072
  s_add_u32 s29, s30, 3072
  buffer_load_dwordx4 v2, s[8:11], s29 offen lds
  s_add_u32 m0, s31, 4096
  s_add_u32 s29, s30, 4096
  buffer_load_dwordx4 v2, s[8:11], s29 offen lds
  s_add_u32 m0, s31, 5120
  s_add_u32 s29, s30, 5120
  buffer_load_dwordx4 v2, s[8:11], s29 offen lds
  s_add_u32 m0, s31, 6144
  s_add_u32 s29, s30, 6144
  buffer_load_dwordx4 v2, s[8:11], s29 offen lds
  s_add_u32 m0, s31, 7168
  s_add_u32 s29, s30, 7168
  buffer_load_dwordx4 v2, s[8:11], s29 offen lds
  s_add_u32 m0, s31, 8192
  s_add_u32 s29, s30, 8192
  buffer_load_dwordx4 v2, s[8:11], s29 offen lds
  s_add_u32 m0, s31, 9216
  s_add_u32 s29, s30, 9216
  buffer_load_dwordx4 v2, s[8:11], s29 offen lds
  s_add_u32 m0, s31, 10240
  s_add_u32 s29, s30, 10240
  buffer_load_dwordx4 v2, s[8:11], s29 offen lds
  s_add_u32 m0, s31, 11264
  s_add_u32 s29, s30, 11264
  buffer_load_dwordx4 v2, s[8:11], s29 offen lds
  s_add_u32 m0, s31, 12288
  s_add_u32 s29, s30, 12288
  buffer_load_dwordx4 v2, s[8:11], s29 offen lds
  s_add_u32 m0, s31, 13312
  s_add_u32 s29, s30, 13312
  buffer_load_dwordx4 v2, s[8:11], s29 offen lds
  s_add_u32 m0, s31, 14336
  s_add_u32 s29, s30, 14336
  buffer_load_dwordx4 v2, s[8:11], s29 offen lds
  s_add_u32 m0, s31, 15360
  s_add_u32 s29, s30, 15360
  buffer_load_dwordx4 v2, s[8:11], s29 offen lds
  s_add_u32 m0, s31, 16384
  s_add_u32 s29, s30, 16384
  buffer_load_dwordx4 v2, s[8:11], s29 offen lds
  s_add_u32 m0, s31, 17408
  s_add_u32 s29, s30, 17408
  buffer_load_dwordx4 v2, s[8:11], s29 offen lds
  s_add_u32 m0, s31, 18432
  s_add_u32 s29, s30, 18432
  buffer_load_dwordx4 v2, s[8:11], s29 offen lds
  s_add_u32 m0, s31, 19456
  s_add_u32 s29, s30, 19456
  buffer_load_dwordx4 v2, s[8:11], s29 offen lds
  s_add_u32 m0, s31, 20480
  s_add_u32 s29, s30, 20480
  buffer_load_dwordx4 v2, s[8:11], s29 offen lds
  s_add_u32 m0, s31, 21504
  s_add_u32 s29, s30, 21504
  buffer_load_dwordx4 v2, s[8:11], s29 offen lds
  s_add_u32 m0, s31, 22528
  s_add_u32 s29, s30, 22528
  buffer_load_dwordx4 v2, s[8:11], s29 offen lds
  s_add_u32 m0, s31, 23552
  s_add_u32 s29, s30, 23552
  buffer_load_dwordx4 v2, s[8:11], s29 offen lds
  s_add_u32 m0, s31, 24576
  s_add_u32 s29, s30, 24576
  buffer_load_dwordx4 v2, s[8:11], s29 offen lds
  s_add_u32 m0, s31, 25600
  s_add_u32 s29, s30, 25600
  buffer_load_dwordx4 v2, s[8:11], s29 offen lds
  s_add_u32 m0, s31, 26624
  s_add_u32 s29, s30, 26624
  buffer_load_dwordx4 v2, s[8:11], s29 offen lds
  s_add_u32 m0, s31, 27648
  s_add_u32 s29, s30, 27648
  buffer_load_dwordx4 v2, s[8:11], s29 offen lds
  s_add_u32 m0, s31, 28672
  s_add_u32 s29, s30, 28672
  buffer_load_dwordx4 v2, s[8:11], s29 offen lds
  s_add_u32 m0, s31, 29696
  s_add_u32 s29, s30, 29696
  buffer_load_dwordx4 v2, s[8:11], s29 offen lds
  s_waitcnt vmcnt(30)
  v_lshlrev_b32 v16, 16, v144
  v_and_b32 v17, 0xffff0000, v144
  v_lshlrev_b32 v18, 16, v145
  v_and_b32 v19, 0xffff0000, v145
  v_lshlrev_b32 v20, 16, v146
  v_and_b32 v21, 0xffff0000, v146
  v_lshlrev_b32 v22, 16, v147
  v_and_b32 v23, 0xffff0000, v147
  v_lshlrev_b32 v24, 16, v148
  v_and_b32 v25, 0xffff0000, v148
  v_lshlrev_b32 v26, 16, v149
  v_and_b32 v27, 0xffff0000, v149
  v_lshlrev_b32 v28, 16, v150
  v_and_b32 v29, 0xffff0000, v150
  v_lshlrev_b32 v30, 16, v151
  v_and_b32 v31, 0xffff0000, v151
  s_cmp_lt_u32 s21, 2
  s_cbranch_scc0 g3_24
  v_lshlrev_b32 v32, 16, v152
  v_and_b32 v33, 0xffff0000, v152
  v_lshlrev_b32 v34, 16, v153
  v_and_b32 v35, 0xffff0000, v153
  v_lshlrev_b32 v36, 16, v154
  v_and_b32 v37, 0xffff0000, v154
  v_lshlrev_b32 v38, 16, v155
  v_and_b32 v39, 0xffff0000, v155
g3_24:
  v_lshlrev_b32 v12, 16, v48
  v_and_b32 v13, 0xffff0000, v48
  v_pk_add_f32 v[16:17], v[16:17], v[12:13]
  v_lshlrev_b32 v12, 16, v49
  v_and_b32 v13, 0xffff0000, v49
  v_pk_add_f32 v[18:19], v[18:19], v[12:13]
  v_lshlrev_b32 v12, 16, v50
  v_and_b32 v13, 0xffff0000, v50
  v_pk_add_f32 v[20:21], v[20:21], v[12:13]
  v_lshlrev_b32 v12, 16, v51
  v_and_b32 v13, 0xffff0000, v51
  v_pk_add_f32 v[22:23], v[22:23], v[12:13]
  v_lshlrev_b32 v12, 16, v52
  v_and_b32 v13, 0xffff0000, v52
  v_pk_add_f32 v[24:25], v[24:25], v[12:13]
  v_lshlrev_b32 v12, 16, v53
  v_and_b32 v13, 0xffff0000, v53
  v_pk_add_f32 v[26:27], v[26:27], v[12:13]
  v_lshlrev_b32 v12, 16, v54
  v_and_b32 v13, 0xffff0000, v54
  v_pk_add_f32 v[28:29], v[28:29], v[12:13]
  v_lshlrev_b32 v12, 16, v55
  v_and_b32 v13, 0xffff0000, v55
  v_pk_add_f32 v[30:31], v[30:31], v[12:13]
  v_lshlrev_b32 v12, 16, v56
  v_and_b32 v13, 0xffff0000, v56
  v_pk_add_f32 v[32:33], v[32:33], v[12:13]
  v_lshlrev_b32 v12, 16, v57
  v_and_b32 v13, 0xffff0000, v57
  v_pk_add_f32 v[34:35], v[34:35], v[12:13]
  v_lshlrev_b32 v12, 16, v58
  v_and_b32 v13, 0xffff0000, v58
  v_pk_add_f32 v[36:37], v[36:37], v[12:13]
  v_lshlrev_b32 v12, 16, v59
  v_and_b32 v13, 0xffff0000, v59
  v_pk_add_f32 v[38:39], v[38:39], v[12:13]
  v_lshlrev_b32 v12, 16, v60
  v_and_b32 v13, 0xffff0000, v60
  v_pk_add_f32 v[16:17], v[16:17], v[12:13]
  v_lshlrev_b32 v12, 16, v61
  v_and_b32 v13, 0xffff0000, v61
  v_pk_add_f32 v[18:19], v[18:19], v[12:13]
  v_lshlrev_b32 v12, 16, v62
  v_and_b32 v13, 0xffff0000, v62
  v_pk_add_f32 v[20:21], v[20:21], v[12:13]
  v_lshlrev_b32 v12, 16, v63
  v_and_b32 v13, 0xffff0000, v63
  v_pk_add_f32 v[22:23], v[22:23], v[12:13]
  v_lshlrev_b32 v12, 16, v64
  v_and_b32 v13, 0xffff0000, v64
  v_pk_add_f32 v[24:25], v[24:25], v[12:13]
  v_lshlrev_b32 v12, 16, v65
  v_and_b32 v13, 0xffff0000, v65
  v_pk_add_f32 v[26:27], v[26:27], v[12:13]
  v_lshlrev_b32 v12, 16, v66
  v_and_b32 v13, 0xffff0000, v66
  v_pk_add_f32 v[28:29], v[28:29], v[12:13]
  v_lshlrev_b32 v12, 16, v67
  v_and_b32 v13, 0xffff0000, v67
  v_pk_add_f32 v[30:31], v[30:31], v[12:13]
  v_lshlrev_b32 v12, 16, v68
  v_and_b32 v13, 0xffff0000, v68
  v_pk_add_f32 v[32:33], v[32:33], v[12:13]
  v_lshlrev_b32 v12, 16, v69
  v_and_b32 v13, 0xffff0000, v69
  v_pk_add_f32 v[34:35], v[34:35], v[12:13]
  v_lshlrev_b32 v12, 16, v70
  v_and_b32 v13, 0xffff0000, v70
  v_pk_add_f32 v[36:37], v[36:37], v[12:13]
  v_lshlrev_b32 v12, 16, v71
  v_and_b32 v13, 0xffff0000, v71
  v_pk_add_f32 v[38:39], v[38:39], v[12:13]
  v_lshlrev_b32 v12, 16, v72
  v_and_b32 v13, 0xffff0000, v72
  v_pk_add_f32 v[16:17], v[16:17], v[12:13]
  v_lshlrev_b32 v12, 16, v73
  v_and_b32 v13, 0xffff0000, v73
  v_pk_add_f32 v[18:19], v[18:19], v[12:13]
  v_lshlrev_b32 v12, 16, v74
  v_and_b32 v13, 0xffff0000, v74
  v_pk_add_f32 v[20:21], v[20:21], v[12:13]
  v_lshlrev_b32 v12, 16, v75
  v_and_b32 v13, 0xffff0000, v75
  v_pk_add_f32 v[22:23], v[22:23], v[12:13]
  v_lshlrev_b32 v12, 16, v76
  v_and_b32 v13, 0xffff0000, v76
  v_pk_add_f32 v[24:25], v[24:25], v[12:13]
  v_lshlrev_b32 v12, 16, v77
  v_and_b32 v13, 0xffff0000, v77
  v_pk_add_f32 v[26:27], v[26:27], v[12:13]
  v_lshlrev_b32 v12, 16, v78
  v_and_b32 v13, 0xffff0000, v78
  v_pk_add_f32 v[28:29], v[28:29], v[12:13]
  v_lshlrev_b32 v12, 16, v79
  v_and_b32 v13, 0xffff0000, v79
  v_pk_add_f32 v[30:31], v[30:31], v[12:13]
  v_lshlrev_b32 v12, 16, v80
  v_and_b32 v13, 0xffff0000, v80
  v_pk_add_f32 v[32:33], v[32:33], v[12:13]
  v_lshlrev_b32 v12, 16, v81
  v_and_b32 v13, 0xffff0000, v81
  v_pk_add_f32 v[34:35], v[34:35], v[12:13]
  v_lshlrev_b32 v12, 16, v82
  v_and_b32 v13, 0xffff0000, v82
  v_pk_add_f32 v[36:37], v[36:37], v[12:13]
  v_lshlrev_b32 v12, 16, v83
  v_and_b32 v13, 0xffff0000, v83
  v_pk_add_f32 v[38:39], v[38:39], v[12:13]
  v_lshlrev_b32 v12, 16, v84
  v_and_b32 v13, 0xffff0000, v84
  v_pk_add_f32 v[16:17], v[16:17], v[12:13]
  v_lshlrev_b32 v12, 16, v85
  v_and_b32 v13, 0xffff0000, v85
  v_pk_add_f32 v[18:19], v[18:19], v[12:13]
  v_lshlrev_b32 v12, 16, v86
  v_and_b32 v13, 0xffff0000, v86
  v_pk_add_f32 v[20:21], v[20:21], v[12:13]
  v_lshlrev_b32 v12, 16, v87
  v_and_b32 v13, 0xffff0000, v87
  v_pk_add_f32 v[22:23], v[22:23], v[12:13]
  v_lshlrev_b32 v12, 16, v88
  v_and_b32 v13, 0xffff0000, v88
  v_pk_add_f32 v[24:25], v[24:25], v[12:13]
  v_lshlrev_b32 v12, 16, v89
  v_and_b32 v13, 0xffff0000, v89
  v_pk_add_f32 v[26:27], v[26:27], v[12:13]
  v_lshlrev_b32 v12, 16, v90
  v_and_b32 v13, 0xffff0000, v90
  v_pk_add_f32 v[28:29], v[28:29], v[12:13]
  v_lshlrev_b32 v12, 16, v91
  v_and_b32 v13, 0xffff0000, v91
  v_pk_add_f32 v[30:31], v[30:31], v[12:13]
  v_lshlrev_b32 v12, 16, v92
  v_and_b32 v13, 0xffff0000, v92
  v_pk_add_f32 v[32:33], v[32:33], v[12:13]
  v_lshlrev_b32 v12, 16, v93
  v_and_b32 v13, 0xffff0000, v93
  v_pk_add_f32 v[34:35], v[34:35], v[12:13]
  v_lshlrev_b32 v12, 16, v94
  v_and_b32 v13, 0xffff0000, v94
  v_pk_add_f32 v[36:37], v[36:37], v[12:13]
  v_lshlrev_b32 v12, 16, v95
  v_and_b32 v13, 0xffff0000, v95
  v_pk_add_f32 v[38:39], v[38:39], v[12:13]
  s_add_u32 s30, s28, 20971520
  buffer_store_dwordx4 v[16:19], v9, s[8:11], s30 offen sc1
  s_add_u32 s30, s28, 20972544
  buffer_store_dwordx4 v[20:23], v9, s[8:11], s30 offen sc1
  s_add_u32 s30, s28, 21004288
  buffer_store_dwordx4 v[24:27], v9, s[8:11], s30 offen sc1
  s_add_u32 s30, s28, 21005312
  buffer_store_dwordx4 v[28:31], v9, s[8:11], s30 offen sc1
  s_cmp_lt_u32 s21, 2
  s_cbranch_scc0 g3_25
  s_add_u32 s30, s28, 21037056
  buffer_store_dwordx4 v[32:35], v9, s[8:11], s30 offen sc1
  s_add_u32 s30, s28, 21038080
  buffer_store_dwordx4 v[36:39], v9, s[8:11], s30 offen sc1
g3_25:
  v_add_f32 v12, v16, v17
  v_add_f32 v12, v12, v18
  v_add_f32 v12, v12, v19
  v_add_f32 v12, v12, v20
  v_add_f32 v12, v12, v21
  v_add_f32 v12, v12, v22
  v_add_f32 v12, v12, v23
  v_add_f32 v12, v12, v24
  v_add_f32 v12, v12, v25
  v_add_f32 v12, v12, v26
  v_add_f32 v12, v12, v27
  v_add_f32 v12, v12, v28
  v_add_f32 v12, v12, v29
  v_add_f32 v12, v12, v30
  v_add_f32 v12, v12, v31
  v_add_f32 v12, v12, v32
  v_add_f32 v12, v12, v33
  v_add_f32 v12, v12, v34
  v_add_f32 v12, v12, v35
  v_add_f32 v12, v12, v36
  v_add_f32 v12, v12, v37
  v_add_f32 v12, v12, v38
  v_add_f32 v12, v12, v39
  s_nop 1
  v_add_f32_dpp v12, v12, v12 row_ror:8 row_mask:0xf bank_mask:0xf
  v_mov_b32 v13, v12
  s_nop 1
  v_permlane16_swap_b32 v12, v13
  v_add_f32 v12, v12, v13
  v_mov_b32 v13, v12
  s_nop 1
  v_permlane32_swap_b32 v12, v13
  v_add_f32 v12, v12, v13
  v_lshlrev_b32 v14, 2, v5
  v_add_u32 v14, 131072, v14
  s_lshl_b32 s30, s21, 5
  v_add_u32 v15, s30, v14
  ds_write_b32 v15, v12
  s_waitcnt lgkmcnt(0)
  s_barrier
  ds_read_b32 v48, v14
  ds_read_b32 v49, v14 offset:32
  ds_read_b32 v50, v14 offset:64
  ds_read_b32 v51, v14 offset:96
  s_waitcnt lgkmcnt(0)
  v_add_f32 v48, v48, v49
  v_add_f32 v50, v50, v51
  v_add_f32 v48, v48, v50
  v_mul_f32 v48, 0x3acccccd, v48
  v_sub_f32 v56, v16, v48
  v_sub_f32 v57, v17, v48
  v_sub_f32 v58, v18, v48
  v_sub_f32 v59, v19, v48
  v_sub_f32 v60, v20, v48
  v_sub_f32 v61, v21, v48
  v_sub_f32 v62, v22, v48
  v_sub_f32 v63, v23, v48
  v_sub_f32 v64, v24, v48
  v_sub_f32 v65, v25, v48
  v_sub_f32 v66, v26, v48
  v_sub_f32 v67, v27, v48
  v_sub_f32 v68, v28, v48
  v_sub_f32 v69, v29, v48
  v_sub_f32 v70, v30, v48
  v_sub_f32 v71, v31, v48
  v_sub_f32 v72, v32, v48
  v_sub_f32 v73, v33, v48
  v_sub_f32 v74, v34, v48
  v_sub_f32 v75, v35, v48
  v_sub_f32 v76, v36, v48
  v_sub_f32 v77, v37, v48
  v_sub_f32 v78, v38, v48
  v_sub_f32 v79, v39, v48
  s_cmp_lt_u32 s21, 2
  s_cbranch_scc1 g3z_26
  v_mov_b32 v72, 0
  v_mov_b32 v73, 0
  v_mov_b32 v74, 0
  v_mov_b32 v75, 0
  v_mov_b32 v76, 0
  v_mov_b32 v77, 0
  v_mov_b32 v78, 0
  v_mov_b32 v79, 0
g3z_26:
  v_mul_f32 v12, v56, v56
  v_fmac_f32 v12, v57, v57
  v_fmac_f32 v12, v58, v58
  v_fmac_f32 v12, v59, v59
  v_fmac_f32 v12, v60, v60
  v_fmac_f32 v12, v61, v61
  v_fmac_f32 v12, v62, v62
  v_fmac_f32 v12, v63, v63
  v_fmac_f32 v12, v64, v64
  v_fmac_f32 v12, v65, v65
  v_fmac_f32 v12, v66, v66
  v_fmac_f32 v12, v67, v67
  v_fmac_f32 v12, v68, v68
  v_fmac_f32 v12, v69, v69
  v_fmac_f32 v12, v70, v70
  v_fmac_f32 v12, v71, v71
  v_fmac_f32 v12, v72, v72
  v_fmac_f32 v12, v73, v73
  v_fmac_f32 v12, v74, v74
  v_fmac_f32 v12, v75, v75
  v_fmac_f32 v12, v76, v76
  v_fmac_f32 v12, v77, v77
  v_fmac_f32 v12, v78, v78
  v_fmac_f32 v12, v79, v79
  s_nop 1
  v_add_f32_dpp v12, v12, v12 row_ror:8 row_mask:0xf bank_mask:0xf
  v_mov_b32 v13, v12
  s_nop 1
  v_permlane16_swap_b32 v12, v13
  v_add_f32 v12, v12, v13
  v_mov_b32 v13, v12
  s_nop 1
  v_permlane32_swap_b32 v12, v13
  v_add_f32 v12, v12, v13
  v_lshlrev_b32 v14, 2, v5
  v_add_u32 v14, 131328, v14
  s_lshl_b32 s30, s21, 5
  v_add_u32 v15, s30, v14
  ds_write_b32 v15, v12
  s_waitcnt lgkmcnt(0)
  s_barrier
  ds_read_b32 v48, v14
  ds_read_b32 v49, v14 offset:32
  ds_read_b32 v50, v14 offset:64
  ds_read_b32 v51, v14 offset:96
  s_waitcnt lgkmcnt(0)
  v_add_f32 v48, v48, v49
  v_add_f32 v50, v50, v51
  v_add_f32 v48, v48, v50
  v_mov_b32 v49, 0x3727c5ac
  v_fmac_f32 v49, 0x3acccccd, v48
  v_rsq_f32 v49, v49
  s_nop 0
  v_mul_f32 v56, v56, v49
  v_mul_f32 v57, v57, v49
  v_mul_f32 v58, v58, v49
  v_mul_f32 v59, v59, v49
  v_mul_f32 v60, v60, v49
  v_mul_f32 v61, v61, v49
  v_mul_f32 v62, v62, v49
  v_mul_f32 v63, v63, v49
  v_mul_f32 v64, v64, v49
  v_mul_f32 v65, v65, v49
  v_mul_f32 v66, v66, v49
  v_mul_f32 v67, v67, v49
  v_mul_f32 v68, v68, v49
  v_mul_f32 v69, v69, v49
  v_mul_f32 v70, v70, v49
  v_mul_f32 v71, v71, v49
  v_mul_f32 v72, v72, v49
  v_mul_f32 v73, v73, v49
  v_mul_f32 v74, v74, v49
  v_mul_f32 v75, v75, v49
  v_mul_f32 v76, v76, v49
  v_mul_f32 v77, v77, v49
  v_mul_f32 v78, v78, v49
  v_mul_f32 v79, v79, v49
  v_cvt_pk_bf16_f32 v80, v56, v57
  v_cvt_pk_bf16_f32 v81, v58, v59
  v_cvt_pk_bf16_f32 v82, v60, v61
  v_cvt_pk_bf16_f32 v83, v62, v63
  v_cvt_pk_bf16_f32 v84, v64, v65
  v_cvt_pk_bf16_f32 v85, v66, v67
  v_cvt_pk_bf16_f32 v86, v68, v69
  v_cvt_pk_bf16_f32 v87, v70, v71
  v_cvt_pk_bf16_f32 v88, v72, v73
  v_cvt_pk_bf16_f32 v89, v74, v75
  v_cvt_pk_bf16_f32 v90, v76, v77
  v_cvt_pk_bf16_f32 v91, v78, v79
  s_mul_i32 s30, s26, 40960
  s_lshl_b32 s31, s21, 12
  s_add_u32 s30, s30, s31
  s_add_u32 s30, s30, 0x100000
  s_add_u32 s31, s30, 0
  buffer_store_dwordx4 v[80:83], v10, s[8:11], s31 offen sc1
  s_add_u32 s31, s30, 16384
  buffer_store_dwordx4 v[84:87], v10, s[8:11], s31 offen sc1
  s_cmp_lt_u32 s21, 2
  s_cbranch_scc0 g3_27
  s_add_u32 s31, s30, 32768
  buffer_store_dwordx4 v[88:91], v10, s[8:11], s31 offen sc1
g3_27:
  s_waitcnt vmcnt(0)
  s_barrier
  s_cmp_eq_u32 s21, 0
  s_cbranch_scc0 arr_28
  s_mov_b64 s[24:25], exec
  s_mov_b64 exec, 1
  v_mov_b32 v3, 0
  v_mov_b32 v4, 1
  buffer_atomic_add v4, v3, s[8:11], s46 offen
  s_mov_b64 exec, s[24:25]
arr_28:
  s_mov_b32 s45, 0
  v_mov_b32 v3, 0
aw_29:
  buffer_load_dword v4, v3, s[8:11], s46 offen sc1
  s_add_u32 s45, s45, 1
  s_waitcnt vmcnt(0)
  v_readfirstlane_b32 s29, v4
  s_cmp_ge_u32 s29, 32
  s_cbranch_scc1 aw_29_ok
  s_cmp_lt_u32 s45, 400000
  s_cbranch_scc1 aw_29
  s_branch kb1_abort
aw_29_ok:
  s_barrier
  s_lshl_b32 s26, s23, 3
  s_lshl_b32 s27, s21, 1
  s_add_u32 s24, s26, s27
  s_mul_i32 s27, s24, 40960
  s_add_u32 s27, s27, 0x100000
  s_add_u32 s28, s27, 40960
  v_mov_b32 v3, v2
  v_add_u32 v4, 65536, v2
  v_lshlrev_b32 v5, 7, v1
  s_add_u32 s29, s27, 0
  buffer_load_dword v6, v5, s[8:11], s29 offen sc1
  s_add_u32 s29, s27, 8192
  buffer_load_dword v6, v5, s[8:11], s29 offen sc1
  s_add_u32 s29, s27, 16384
  buffer_load_dword v6, v5, s[8:11], s29 offen sc1
  s_add_u32 s29, s27, 24576
  buffer_load_dword v6, v5, s[8:11], s29 offen sc1
  s_add_u32 s29, s27, 32768
  buffer_load_dword v6, v5, s[8:11], s29 offen sc1
  s_add_u32 s29, s27, 40960
  buffer_load_dword v6, v5, s[8:11], s29 offen sc1
  s_add_u32 s29, s27, 49152
  buffer_load_dword v6, v5, s[8:11], s29 offen sc1
  s_add_u32 s29, s27, 57344
  buffer_load_dword v6, v5, s[8:11], s29 offen sc1
  s_add_u32 s29, s27, 65536
  buffer_load_dword v6, v5, s[8:11], s29 offen sc1
  s_add_u32 s29, s27, 73728
  buffer_load_dword v6, v5, s[8:11], s29 offen sc1
  s_add_u32 s29, s27, 0
  buffer_load_dwordx4 v[16:19], v2, s[8:11], s29 offen sc1
  s_add_u32 s29, s28, 0
  buffer_load_dwordx4 v[20:23], v2, s[8:11], s29 offen sc1
  s_add_u32 s29, s27, 1024
  buffer_load_dwordx4 v[24:27], v2, s[8:11], s29 offen sc1
  s_add_u32 s29, s28, 1024
  buffer_load_dwordx4 v[28:31], v2, s[8:11], s29 offen sc1
  s_add_u32 s29, s27, 2048
  buffer_load_dwordx4 v[32:35], v2, s[8:11], s29 offen sc1
  s_add_u32 s29, s28, 2048
  buffer_load_dwordx4 v[36:39], v2, s[8:11], s29 offen sc1
  s_add_u32 s29, s27, 3072
  buffer_load_dwordx4 v[40:43], v2, s[8:11], s29 offen sc1
  s_add_u32 s29, s28, 3072
  buffer_load_dwordx4 v[44:47], v2, s[8:11], s29 offen sc1
  s_add_u32 s29, s27, 4096
  buffer_load_dwordx4 v[48:51], v2, s[8:11], s29 offen sc1
  s_add_u32 s29, s28, 4096
  buffer_load_dwordx4 v[52:55], v2, s[8:11], s29 offen sc1
  s_add_u32 s29, s27, 5120
  buffer_load_dwordx4 v[56:59], v2, s[8:11], s29 offen sc1
  s_add_u32 s29, s28, 5120
  buffer_load_dwordx4 v[60:63], v2, s[8:11], s29 offen sc1
  s_add_u32 s29, s27, 6144
  buffer_load_dwordx4 v[64:67], v2, s[8:11], s29 offen sc1
  s_add_u32 s29, s28, 6144
  buffer_load_dwordx4 v[68:71], v2, s[8:11], s29 offen sc1
  ds_read_b128 v[208:211], v3 offset:0
  ds_read_b128 v[212:215], v3 offset:40960
  ds_read_b128 v[216:219], v4 offset:16384
  s_add_u32 s29, s27, 7168
  buffer_load_dwordx4 v[72:75], v2, s[8:11], s29 offen sc1
  s_add_u32 s29, s28, 7168
  buffer_load_dwordx4 v[76:79], v2, s[8:11], s29 offen sc1
  ds_read_b128 v[220:223], v3 offset:1024
  ds_read_b128 v[224:227], v3 offset:41984
  ds_read_b128 v[228:231], v4 offset:17408
  s_waitcnt lgkmcnt(3)
  s_waitcnt vmcnt(14)
  v_mfma_f32_32x32x16_bf16 v[80:95], v[208:211], v[16:19], 0
  v_mfma_f32_32x32x16_bf16 v[96:111], v[212:215], v[16:19], 0
  v_mfma_f32_32x32x16_bf16 v[112:127], v[16:19], v[216:219], 0
  v_mfma_f32_32x32x16_bf16 v[128:143], v[208:211], v[20:23], 0
  v_mfma_f32_32x32x16_bf16 v[144:159], v[212:215], v[20:23], 0
  v_mfma_f32_32x32x16_bf16 v[160:175], v[20:23], v[216:219], 0
  s_add_u32 s29, s27, 8192
  buffer_load_dwordx4 v[16:19], v2, s[8:11], s29 offen sc1
  s_add_u32 s29, s28, 8192
  buffer_load_dwordx4 v[20:23], v2, s[8:11], s29 offen sc1
  ds_read_b128 v[208:211], v3 offset:2048
  ds_read_b128 v[212:215], v3 offset:43008
  ds_read_b128 v[216:219], v4 offset:18432
  s_waitcnt lgkmcnt(3)
  s_waitcnt vmcnt(14)
  v_mfma_f32_32x32x16_bf16 v[80:95], v[220:223], v[24:27], v[80:95]
  v_mfma_f32_32x32x16_bf16 v[96:111], v[224:227], v[24:27], v[96:111]
  v_mfma_f32_32x32x16_bf16 v[112:127], v[24:27], v[228:231], v[112:127]
  v_mfma_f32_32x32x16_bf16 v[128:143], v[220:223], v[28:31], v[128:143]
  v_mfma_f32_32x32x16_bf16 v[144:159], v[224:227], v[28:31], v[144:159]
  v_mfma_f32_32x32x16_bf16 v[160:175], v[28:31], v[228:231], v[160:175]
  s_add_u32 s29, s27, 9216
  buffer_load_dwordx4 v[24:27], v2, s[8:11], s29 offen sc1
  s_add_u32 s29, s28, 9216
  buffer_load_dwordx4 v[28:31], v2, s[8:11], s29 offen sc1
  ds_read_b128 v[220:223], v3 offset:3072
  ds_read_b128 v[224:227], v3 offset:44032
  ds_read_b128 v[228:231], v4 offset:19456
  s_waitcnt lgkmcnt(3)
  s_waitcnt vmcnt(14)
  v_mfma_f32_32x32x16_bf16 v[80:95], v[208:211], v[32:35], v[80:95]
  v_mfma_f32_32x32x16_bf16 v[96:111], v[212:215], v[32:35], v[96:111]
  v_mfma_f32_32x32x16_bf16 v[112:127], v[32:35], v[216:219], v[112:127]
  v_mfma_f32_32x32x16_bf16 v[128:143], v[208:211], v[36:39], v[128:143]
  v_mfma_f32_32x32x16_bf16 v[144:159], v[212:215], v[36:39], v[144:159]
  v_mfma_f32_32x32x16_bf16 v[160:175], v[36:39], v[216:219], v[160:175]
  s_add_u32 s29, s27, 10240
  buffer_load_dwordx4 v[32:35], v2, s[8:11], s29 offen sc1
  s_add_u32 s29, s28, 10240
  buffer_load_dwordx4 v[36:39], v2, s[8:11], s29 offen sc1
  ds_read_b128 v[208:211], v3 offset:4096
  ds_read_b128 v[212:215], v3 offset:45056
  ds_read_b128 v[216:219], v4 offset:20480
  s_waitcnt lgkmcnt(3)
  s_waitcnt vmcnt(14)
  v_mfma_f32_32x32x16_bf16 v[80:95], v[220:223], v[40:43], v[80:95]
  v_mfma_f32_32x32x16_bf16 v[96:111], v[224:227], v[40:43], v[96:111]
  v_mfma_f32_32x32x16_bf16 v[112:127], v[40:43], v[228:231], v[112:127]
  v_mfma_f32_32x32x16_bf16 v[128:143], v[220:223], v[44:47], v[128:143]
  v_mfma_f32_32x32x16_bf16 v[144:159], v[224:227], v[44:47], v[144:159]
  v_mfma_f32_32x32x16_bf16 v[160:175], v[44:47], v[228:231], v[160:175]
  s_add_u32 s29, s27, 11264
  buffer_load_dwordx4 v[40:43], v2, s[8:11], s29 offen sc1
  s_add_u32 s29, s28, 11264
  buffer_load_dwordx4 v[44:47], v2, s[8:11], s29 offen sc1
  ds_read_b128 v[220:223], v3 offset:5120
  ds_read_b128 v[224:227], v3 offset:46080
  ds_read_b128 v[228:231], v4 offset:21504
  s_waitcnt lgkmcnt(3)
  s_waitcnt vmcnt(14)
  v_mfma_f32_32x32x16_bf16 v[80:95], v[208:211], v[48:51], v[80:95]
  v_mfma_f32_32x32x16_bf16 v[96:111], v[212:215], v[48:51], v[96:111]
  v_mfma_f32_32x32x16_bf16 v[112:127], v[48:51], v[216:219], v[112:127]
  v_mfma_f32_32x32x16_bf16 v[128:143], v[208:211], v[52:55], v[128:143]
  v_mfma_f32_32x32x16_bf16 v[144:159], v[212:215], v[52:55], v[144:159]
  v_mfma_f32_32x32x16_bf16 v[160:175], v[52:55], v[216:219], v[160:175]
  s_add_u32 s29, s27, 12288
  buffer_load_dwordx4 v[48:51], v2, s[8:11], s29 offen sc1
  s_add_u32 s29, s28, 12288
  buffer_load_dwordx4 v[52:55], v2, s[8:11], s29 offen sc1
  ds_read_b128 v[208:211], v3 offset:6144
  ds_read_b128 v[212:215], v3 offset:47104
  ds_read_b128 v[216:219], v4 offset:22528
  s_waitcnt lgkmcnt(3)
  s_waitcnt vmcnt(14)
  v_mfma_f32_32x32x16_bf16 v[80:95], v[220:223], v[56:59], v[80:95]
  v_mfma_f32_32x32x16_bf16 v[96:111], v[224:227], v[56:59], v[96:111]
  v_mfma_f32_32x32x16_bf16 v[112:127], v[56:59], v[228:231], v[112:127]
  v_mfma_f32_32x32x16_bf16 v[128:143], v[220:223], v[60:63], v[128:143]
  v_mfma_f32_32x32x16_bf16 v[144:159], v[224:227], v[60:63], v[144:159]
  v_mfma_f32_32x32x16_bf16 v[160:175], v[60:63], v[228:231], v[160:175]
  s_add_u32 s29, s27, 13312
  buffer_load_dwordx4 v[56:59], v2, s[8:11], s29 offen sc1
  s_add_u32 s29, s28, 13312
  buffer_load_dwordx4 v[60:63], v2, s[8:11], s29 offen sc1
  ds_read_b128 v[220:223], v3 offset:7168
  ds_read_b128 v[224:227], v3 offset:48128
  ds_read_b128 v[228:231], v4 offset:23552
  s_waitcnt lgkmcnt(3)
  s_waitcnt vmcnt(14)
  v_mfma_f32_32x32x16_bf16 v[80:95], v[208:211], v[64:67], v[80:95]
  v_mfma_f32_32x32x16_bf16 v[96:111], v[212:215], v[64:67], v[96:111]
  v_mfma_f32_32x32x16_bf16 v[112:127], v[64:67], v[216:219], v[112:127]
  v_mfma_f32_32x32x16_bf16 v[128:143], v[208:211], v[68:71], v[128:143]
  v_mfma_f32_32x32x16_bf16 v[144:159], v[212:215], v[68:71], v[144:159]
  v_mfma_f32_32x32x16_bf16 v[160:175], v[68:71], v[216:219], v[160:175]
  s_add_u32 s29, s27, 14336
  buffer_load_dwordx4 v[64:67], v2, s[8:11], s29 offen sc1
  s_add_u32 s29, s28, 14336
  buffer_load_dwordx4 v[68:71], v2, s[8:11], s29 offen sc1
  ds_read_b128 v[208:211], v3 offset:8192
  ds_read_b128 v[212:215], v3 offset:49152
  ds_read_b128 v[216:219], v4 offset:24576
  s_waitcnt lgkmcnt(3)
  s_waitcnt vmcnt(14)
  v_mfma_f32_32x32x16_bf16 v[80:95], v[220:223], v[72:75], v[80:95]
  v_mfma_f32_32x32x16_bf16 v[96:111], v[224:227], v[72:75], v[96:111]
  v_mfma_f32_32x32x16_bf16 v[112:127], v[72:75], v[228:231], v[112:127]
  v_mfma_f32_32x32x16_bf16 v[128:143], v[220:223], v[76:79], v[128:143]
  v_mfma_f32_32x32x16_bf16 v[144:159], v[224:227], v[76:79], v[144:159]
  v_mfma_f32_32x32x16_bf16 v[160:175], v[76:79], v[228:231], v[160:175]
  s_add_u32 s29, s27, 15360
  buffer_load_dwordx4 v[72:75], v2, s[8:11], s29 offen sc1
  s_add_u32 s29, s28, 15360
  buffer_load_dwordx4 v[76:79], v2, s[8:11], s29 offen sc1
  ds_read_b128 v[220:223], v3 offset:9216
  ds_read_b128 v[224:227], v3 offset:50176
  ds_read_b128 v[228:231], v4 offset:25600
  s_waitcnt lgkmcnt(3)
  s_waitcnt vmcnt(14)
  v_mfma_f32_32x32x16_bf16 v[80:95], v[208:211], v[16:19], v[80:95]
  v_mfma_f32_32x32x16_bf16 v[96:111], v[212:215], v[16:19], v[96:111]
  v_mfma_f32_32x32x16_bf16 v[112:127], v[16:19], v[216:219], v[112:127]
  v_mfma_f32_32x32x16_bf16 v[128:143], v[208:211], v[20:23], v[128:143]
  v_mfma_f32_32x32x16_bf16 v[144:159], v[212:215], v[20:23], v[144:159]
  v_mfma_f32_32x32x16_bf16 v[160:175], v[20:23], v[216:219], v[160:175]
  s_add_u32 s29, s27, 16384
  buffer_load_dwordx4 v[16:19], v2, s[8:11], s29 offen sc1
  s_add_u32 s29, s28, 16384
  buffer_load_dwordx4 v[20:23], v2, s[8:11], s29 offen sc1
  ds_read_b128 v[208:211], v3 offset:10240
  ds_read_b128 v[212:215], v3 offset:51200
  ds_read_b128 v[216:219], v4 offset:26624
  s_waitcnt lgkmcnt(3)
  s_waitcnt vmcnt(14)
  v_mfma_f32_32x32x16_bf16 v[80:95], v[220:223], v[24:27], v[80:95]
  v_mfma_f32_32x32x16_bf16 v[96:111], v[224:227], v[24:27], v[96:111]
  v_mfma_f32_32x32x16_bf16 v[112:127], v[24:27], v[228:231], v[112:127]
  v_mfma_f32_32x32x16_bf16 v[128:143], v[220:223], v[28:31], v[128:143]
  v_mfma_f32_32x32x16_bf16 v[144:159], v[224:227], v[28:31], v[144:159]
  v_mfma_f32_32x32x16_bf16 v[160:175], v[28:31], v[228:231], v[160:175]
  s_add_u32 s29, s27, 17408
  buffer_load_dwordx4 v[24:27], v2, s[8:11], s29 offen sc1
  s_add_u32 s29, s28, 17408
  buffer_load_dwordx4 v[28:31], v2, s[8:11], s29 offen sc1
  ds_read_b128 v[220:223], v3 offset:11264
  ds_read_b128 v[224:227], v3 offset:52224
  ds_read_b128 v[228:231], v4 offset:27648
  s_waitcnt lgkmcnt(3)
  s_waitcnt vmcnt(14)
  v_mfma_f32_32x32x16_bf16 v[80:95], v[208:211], v[32:35], v[80:95]
  v_mfma_f32_32x32x16_bf16 v[96:111], v[212:215], v[32:35], v[96:111]
  v_mfma_f32_32x32x16_bf16 v[112:127], v[32:35], v[216:219], v[112:127]
  v_mfma_f32_32x32x16_bf16 v[128:143], v[208:211], v[36:39], v[128:143]
  v_mfma_f32_32x32x16_bf16 v[144:159], v[212:215], v[36:39], v[144:159]
  v_mfma_f32_32x32x16_bf16 v[160:175], v[36:39], v[216:219], v[160:175]
  s_add_u32 s29, s27, 18432
  buffer_load_dwordx4 v[32:35], v2, s[8:11], s29 offen sc1
  s_add_u32 s29, s28, 18432
  buffer_load_dwordx4 v[36:39], v2, s[8:11], s29 offen sc1
  ds_read_b128 v[208:211], v3 offset:12288
  ds_read_b128 v[212:215], v3 offset:53248
  ds_read_b128 v[216:219], v4 offset:28672
  s_waitcnt lgkmcnt(3)
  s_waitcnt vmcnt(14)
  v_mfma_f32_32x32x16_bf16 v[80:95], v[220:223], v[40:43], v[80:95]
  v_mfma_f32_32x32x16_bf16 v[96:111], v[224:227], v[40:43], v[96:111]
  v_mfma_f32_32x32x16_bf16 v[112:127], v[40:43], v[228:231], v[112:127]
  v_mfma_f32_32x32x16_bf16 v[128:143], v[220:223], v[44:47], v[128:143]
  v_mfma_f32_32x32x16_bf16 v[144:159], v[224:227], v[44:47], v[144:159]
  v_mfma_f32_32x32x16_bf16 v[160:175], v[44:47], v[228:231], v[160:175]
  s_add_u32 s29, s27, 19456
  buffer_load_dwordx4 v[40:43], v2, s[8:11], s29 offen sc1
  s_add_u32 s29, s28, 19456
  buffer_load_dwordx4 v[44:47], v2, s[8:11], s29 offen sc1
  ds_read_b128 v[220:223], v3 offset:13312
  ds_read_b128 v[224:227], v3 offset:54272
  ds_read_b128 v[228:231], v4 offset:29696
  s_waitcnt lgkmcnt(3)
  s_waitcnt vmcnt(14)
  v_mfma_f32_32x32x16_bf16 v[80:95], v[208:211], v[48:51], v[80:95]
  v_mfma_f32_32x32x16_bf16 v[96:111], v[212:215], v[48:51], v[96:111]
  v_mfma_f32_32x32x16_bf16 v[112:127], v[48:51], v[216:219], v[112:127]
  v_mfma_f32_32x32x16_bf16 v[128:143], v[208:211], v[52:55], v[128:143]
  v_mfma_f32_32x32x16_bf16 v[144:159], v[212:215], v[52:55], v[144:159]
  v_mfma_f32_32x32x16_bf16 v[160:175], v[52:55], v[216:219], v[160:175]
  s_add_u32 s29, s27, 20480
  buffer_load_dwordx4 v[48:51], v2, s[8:11], s29 offen sc1
  s_add_u32 s29, s28, 20480
  buffer_load_dwordx4 v[52:55], v2, s[8:11], s29 offen sc1
  ds_read_b128 v[208:211], v3 offset:14336
  ds_read_b128 v[212:215], v3 offset:55296
  ds_read_b128 v[216:219], v4 offset:30720
  s_waitcnt lgkmcnt(3)
  s_waitcnt vmcnt(14)
  v_mfma_f32_32x32x16_bf16 v[80:95], v[220:223], v[56:59], v[80:95]
  v_mfma_f32_32x32x16_bf16 v[96:111], v[224:227], v[56:59], v[96:111]
  v_mfma_f32_32x32x16_bf16 v[112:127], v[56:59], v[228:231], v[112:127]
  v_mfma_f32_32x32x16_bf16 v[128:143], v[220:223], v[60:63], v[128:143]
  v_mfma_f32_32x32x16_bf16 v[144:159], v[224:227], v[60:63], v[144:159]
  v_mfma_f32_32x32x16_bf16 v[160:175], v[60:63], v[228:231], v[160:175]
  s_add_u32 s29, s27, 21504
  buffer_load_dwordx4 v[56:59], v2, s[8:11], s29 offen sc1
  s_add_u32 s29, s28, 21504
  buffer_load_dwordx4 v[60:63], v2, s[8:11], s29 offen sc1
  ds_read_b128 v[220:223], v3 offset:15360
  ds_read_b128 v[224:227], v3 offset:56320
  ds_read_b128 v[228:231], v4 offset:31744
  s_waitcnt lgkmcnt(3)
  s_waitcnt vmcnt(14)
  v_mfma_f32_32x32x16_bf16 v[80:95], v[208:211], v[64:67], v[80:95]
  v_mfma_f32_32x32x16_bf16 v[96:111], v[212:215], v[64:67], v[96:111]
  v_mfma_f32_32x32x16_bf16 v[112:127], v[64:67], v[216:219], v[112:127]
  v_mfma_f32_32x32x16_bf16 v[128:143], v[208:211], v[68:71], v[128:143]
  v_mfma_f32_32x32x16_bf16 v[144:159], v[212:215], v[68:71], v[144:159]
  v_mfma_f32_32x32x16_bf16 v[160:175], v[68:71], v[216:219], v[160:175]
  s_add_u32 s29, s27, 22528
  buffer_load_dwordx4 v[64:67], v2, s[8:11], s29 offen sc1
  s_add_u32 s29, s28, 22528
  buffer_load_dwordx4 v[68:71], v2, s[8:11], s29 offen sc1
  ds_read_b128 v[208:211], v3 offset:16384
  ds_read_b128 v[212:215], v3 offset:57344
  ds_read_b128 v[216:219], v4 offset:32768
  s_waitcnt lgkmcnt(3)
  s_waitcnt vmcnt(14)
  v_mfma_f32_32x32x16_bf16 v[80:95], v[220:223], v[72:75], v[80:95]
  v_mfma_f32_32x32x16_bf16 v[96:111], v[224:227], v[72:75], v[96:111]
  v_mfma_f32_32x32x16_bf16 v[112:127], v[72:75], v[228:231], v[112:127]
  v_mfma_f32_32x32x16_bf16 v[128:143], v[220:223], v[76:79], v[128:143]
  v_mfma_f32_32x32x16_bf16 v[144:159], v[224:227], v[76:79], v[144:159]
  v_mfma_f32_32x32x16_bf16 v[160:175], v[76:79], v[228:231], v[160:175]
  s_add_u32 s29, s27, 23552
  buffer_load_dwordx4 v[72:75], v2, s[8:11], s29 offen sc1
  s_add_u32 s29, s28, 23552
  buffer_load_dwordx4 v[76:79], v2, s[8:11], s29 offen sc1
  ds_read_b128 v[220:223], v3 offset:17408
  ds_read_b128 v[224:227], v3 offset:58368
  ds_read_b128 v[228:231], v4 offset:33792
  s_waitcnt lgkmcnt(3)
  s_waitcnt vmcnt(14)
  v_mfma_f32_32x32x16_bf16 v[80:95], v[208:211], v[16:19], v[80:95]
  v_mfma_f32_32x32x16_bf16 v[96:111], v[212:215], v[16:19], v[96:111]
  v_mfma_f32_32x32x16_bf16 v[112:127], v[16:19], v[216:219], v[112:127]
  v_mfma_f32_32x32x16_bf16 v[128:143], v[208:211], v[20:23], v[128:143]
  v_mfma_f32_32x32x16_bf16 v[144:159], v[212:215], v[20:23], v[144:159]
  v_mfma_f32_32x32x16_bf16 v[160:175], v[20:23], v[216:219], v[160:175]
  s_add_u32 s29, s27, 24576
  buffer_load_dwordx4 v[16:19], v2, s[8:11], s29 offen sc1
  s_add_u32 s29, s28, 24576
  buffer_load_dwordx4 v[20:23], v2, s[8:11], s29 offen sc1
  ds_read_b128 v[208:211], v3 offset:18432
  ds_read_b128 v[212:215], v3 offset:59392
  ds_read_b128 v[216:219], v4 offset:34816
  s_waitcnt lgkmcnt(3)
  s_waitcnt vmcnt(14)
  v_mfma_f32_32x32x16_bf16 v[80:95], v[220:223], v[24:27], v[80:95]
  v_mfma_f32_32x32x16_bf16 v[96:111], v[224:227], v[24:27], v[96:111]
  v_mfma_f32_32x32x16_bf16 v[112:127], v[24:27], v[228:231], v[112:127]
  v_mfma_f32_32x32x16_bf16 v[128:143], v[220:223], v[28:31], v[128:143]
  v_mfma_f32_32x32x16_bf16 v[144:159], v[224:227], v[28:31], v[144:159]
  v_mfma_f32_32x32x16_bf16 v[160:175], v[28:31], v[228:231], v[160:175]
  s_add_u32 s29, s27, 25600
  buffer_load_dwordx4 v[24:27], v2, s[8:11], s29 offen sc1
  s_add_u32 s29, s28, 25600
  buffer_load_dwordx4 v[28:31], v2, s[8:11], s29 offen sc1
  ds_read_b128 v[220:223], v3 offset:19456
  ds_read_b128 v[224:227], v3 offset:60416
  ds_read_b128 v[228:231], v4 offset:35840
  s_waitcnt lgkmcnt(3)
  s_waitcnt vmcnt(14)
  v_mfma_f32_32x32x16_bf16 v[80:95], v[208:211], v[32:35], v[80:95]
  v_mfma_f32_32x32x16_bf16 v[96:111], v[212:215], v[32:35], v[96:111]
  v_mfma_f32_32x32x16_bf16 v[112:127], v[32:35], v[216:219], v[112:127]
  v_mfma_f32_32x32x16_bf16 v[128:143], v[208:211], v[36:39], v[128:143]
  v_mfma_f32_32x32x16_bf16 v[144:159], v[212:215], v[36:39], v[144:159]
  v_mfma_f32_32x32x16_bf16 v[160:175], v[36:39], v[216:219], v[160:175]
  s_add_u32 s29, s27, 26624
  buffer_load_dwordx4 v[32:35], v2, s[8:11], s29 offen sc1
  s_add_u32 s29, s28, 26624
  buffer_load_dwordx4 v[36:39], v2, s[8:11], s29 offen sc1
  ds_read_b128 v[208:211], v3 offset:20480
  ds_read_b128 v[212:215], v3 offset:61440
  ds_read_b128 v[216:219], v4 offset:36864
  s_waitcnt lgkmcnt(3)
  s_waitcnt vmcnt(14)
  v_mfma_f32_32x32x16_bf16 v[80:95], v[220:223], v[40:43], v[80:95]
  v_mfma_f32_32x32x16_bf16 v[96:111], v[224:227], v[40:43], v[96:111]
  v_mfma_f32_32x32x16_bf16 v[112:127], v[40:43], v[228:231], v[112:127]
  v_mfma_f32_32x32x16_bf16 v[128:143], v[220:223], v[44:47], v[128:143]
  v_mfma_f32_32x32x16_bf16 v[144:159], v[224:227], v[44:47], v[144:159]
  v_mfma_f32_32x32x16_bf16 v[160:175], v[44:47], v[228:231], v[160:175]
  s_add_u32 s29, s27, 27648
  buffer_load_dwordx4 v[40:43], v2, s[8:11], s29 offen sc1
  s_add_u32 s29, s28, 27648
  buffer_load_dwordx4 v[44:47], v2, s[8:11], s29 offen sc1
  ds_read_b128 v[220:223], v3 offset:21504
  ds_read_b128 v[224:227], v3 offset:62464
  ds_read_b128 v[228:231], v4 offset:37888
  s_waitcnt lgkmcnt(3)
  s_waitcnt vmcnt(14)
  v_mfma_f32_32x32x16_bf16 v[80:95], v[208:211], v[48:51], v[80:95]
  v_mfma_f32_32x32x16_bf16 v[96:111], v[212:215], v[48:51], v[96:111]
  v_mfma_f32_32x32x16_bf16 v[112:127], v[48:51], v[216:219], v[112:127]
  v_mfma_f32_32x32x16_bf16 v[128:143], v[208:211], v[52:55], v[128:143]
  v_mfma_f32_32x32x16_bf16 v[144:159], v[212:215], v[52:55], v[144:159]
  v_mfma_f32_32x32x16_bf16 v[160:175], v[52:55], v[216:219], v[160:175]
  s_add_u32 s29, s27, 28672
  buffer_load_dwordx4 v[48:51], v2, s[8:11], s29 offen sc1
  s_add_u32 s29, s28, 28672
  buffer_load_dwordx4 v[52:55], v2, s[8:11], s29 offen sc1
  ds_read_b128 v[208:211], v3 offset:22528
  ds_read_b128 v[212:215], v3 offset:63488
  ds_read_b128 v[216:219], v4 offset:38912
  s_waitcnt lgkmcnt(3)
  s_waitcnt vmcnt(14)
  v_mfma_f32_32x32x16_bf16 v[80:95], v[220:223], v[56:59], v[80:95]
  v_mfma_f32_32x32x16_bf16 v[96:111], v[224:227], v[56:59], v[96:111]
  v_mfma_f32_32x32x16_bf16 v[112:127], v[56:59], v[228:231], v[112:127]
  v_mfma_f32_32x32x16_bf16 v[128:143], v[220:223], v[60:63], v[128:143]
  v_mfma_f32_32x32x16_bf16 v[144:159], v[224:227], v[60:63], v[144:159]
  v_mfma_f32_32x32x16_bf16 v[160:175], v[60:63], v[228:231], v[160:175]
  s_add_u32 s29, s27, 29696
  buffer_load_dwordx4 v[56:59], v2, s[8:11], s29 offen sc1
  s_add_u32 s29, s28, 29696
  buffer_load_dwordx4 v[60:63], v2, s[8:11], s29 offen sc1
  ds_read_b128 v[220:223], v3 offset:23552
  ds_read_b128 v[224:227], v3 offset:64512
  ds_read_b128 v[228:231], v4 offset:39936
  s_waitcnt lgkmcnt(3)
  s_waitcnt vmcnt(14)
  v_mfma_f32_32x32x16_bf16 v[80:95], v[208:211], v[64:67], v[80:95]
  v_mfma_f32_32x32x16_bf16 v[96:111], v[212:215], v[64:67], v[96:111]
  v_mfma_f32_32x32x16_bf16 v[112:127], v[64:67], v[216:219], v[112:127]
  v_mfma_f32_32x32x16_bf16 v[128:143], v[208:211], v[68:71], v[128:143]
  v_mfma_f32_32x32x16_bf16 v[144:159], v[212:215], v[68:71], v[144:159]
  v_mfma_f32_32x32x16_bf16 v[160:175], v[68:71], v[216:219], v[160:175]
  s_add_u32 s29, s27, 30720
  buffer_load_dwordx4 v[64:67], v2, s[8:11], s29 offen sc1
  s_add_u32 s29, s28, 30720
  buffer_load_dwordx4 v[68:71], v2, s[8:11], s29 offen sc1
  ds_read_b128 v[208:211], v3 offset:24576
  ds_read_b128 v[212:215], v4 offset:0
  ds_read_b128 v[216:219], v4 offset:40960
  s_waitcnt lgkmcnt(3)
  s_waitcnt vmcnt(14)
  v_mfma_f32_32x32x16_bf16 v[80:95], v[220:223], v[72:75], v[80:95]
  v_mfma_f32_32x32x16_bf16 v[96:111], v[224:227], v[72:75], v[96:111]
  v_mfma_f32_32x32x16_bf16 v[112:127], v[72:75], v[228:231], v[112:127]
  v_mfma_f32_32x32x16_bf16 v[128:143], v[220:223], v[76:79], v[128:143]
  v_mfma_f32_32x32x16_bf16 v[144:159], v[224:227], v[76:79], v[144:159]
  v_mfma_f32_32x32x16_bf16 v[160:175], v[76:79], v[228:231], v[160:175]
  s_add_u32 s29, s27, 31744
  buffer_load_dwordx4 v[72:75], v2, s[8:11], s29 offen sc1
  s_add_u32 s29, s28, 31744
  buffer_load_dwordx4 v[76:79], v2, s[8:11], s29 offen sc1
  ds_read_b128 v[220:223], v3 offset:25600
  ds_read_b128 v[224:227], v4 offset:1024
  ds_read_b128 v[228:231], v4 offset:41984
  s_waitcnt lgkmcnt(3)
  s_waitcnt vmcnt(14)
  v_mfma_f32_32x32x16_bf16 v[80:95], v[208:211], v[16:19], v[80:95]
  v_mfma_f32_32x32x16_bf16 v[96:111], v[212:215], v[16:19], v[96:111]
  v_mfma_f32_32x32x16_bf16 v[112:127], v[16:19], v[216:219], v[112:127]
  v_mfma_f32_32x32x16_bf16 v[128:143], v[208:211], v[20:23], v[128:143]
  v_mfma_f32_32x32x16_bf16 v[144:159], v[212:215], v[20:23], v[144:159]
  v_mfma_f32_32x32x16_bf16 v[160:175], v[20:23], v[216:219], v[160:175]
  s_add_u32 s29, s27, 32768
  buffer_load_dwordx4 v[16:19], v2, s[8:11], s29 offen sc1
  s_add_u32 s29, s28, 32768
  buffer_load_dwordx4 v[20:23], v2, s[8:11], s29 offen sc1
  ds_read_b128 v[208:211], v3 offset:26624
  ds_read_b128 v[212:215], v4 offset:2048
  ds_read_b128 v[216:219], v4 offset:43008
  s_waitcnt lgkmcnt(3)
  s_waitcnt vmcnt(14)
  v_mfma_f32_32x32x16_bf16 v[80:95], v[220:223], v[24:27], v[80:95]
  v_mfma_f32_32x32x16_bf16 v[96:111], v[224:227], v[24:27], v[96:111]
  v_mfma_f32_32x32x16_bf16 v[112:127], v[24:27], v[228:231], v[112:127]
  v_mfma_f32_32x32x16_bf16 v[128:143], v[220:223], v[28:31], v[128:143]
  v_mfma_f32_32x32x16_bf16 v[144:159], v[224:227], v[28:31], v[144:159]
  v_mfma_f32_32x32x16_bf16 v[160:175], v[28:31], v[228:231], v[160:175]
  s_add_u32 s29, s27, 33792
  buffer_load_dwordx4 v[24:27], v2, s[8:11], s29 offen sc1
  s_add_u32 s29, s28, 33792
  buffer_load_dwordx4 v[28:31], v2, s[8:11], s29 offen sc1
  ds_read_b128 v[220:223], v3 offset:27648
  ds_read_b128 v[224:227], v4 offset:3072
  ds_read_b128 v[228:231], v4 offset:44032
  s_waitcnt lgkmcnt(3)
  s_waitcnt vmcnt(14)
  v_mfma_f32_32x32x16_bf16 v[80:95], v[208:211], v[32:35], v[80:95]
  v_mfma_f32_32x32x16_bf16 v[96:111], v[212:215], v[32:35], v[96:111]
  v_mfma_f32_32x32x16_bf16 v[112:127], v[32:35], v[216:219], v[112:127]
  v_mfma_f32_32x32x16_bf16 v[128:143], v[208:211], v[36:39], v[128:143]
  v_mfma_f32_32x32x16_bf16 v[144:159], v[212:215], v[36:39], v[144:159]
  v_mfma_f32_32x32x16_bf16 v[160:175], v[36:39], v[216:219], v[160:175]
  s_add_u32 s29, s27, 34816
  buffer_load_dwordx4 v[32:35], v2, s[8:11], s29 offen sc1
  s_add_u32 s29, s28, 34816
  buffer_load_dwordx4 v[36:39], v2, s[8:11], s29 offen sc1
  ds_read_b128 v[208:211], v3 offset:28672
  ds_read_b128 v[212:215], v4 offset:4096
  ds_read_b128 v[216:219], v4 offset:45056
  s_waitcnt lgkmcnt(3)
  s_waitcnt vmcnt(14)
  v_mfma_f32_32x32x16_bf16 v[80:95], v[220:223], v[40:43], v[80:95]
  v_mfma_f32_32x32x16_bf16 v[96:111], v[224:227], v[40:43], v[96:111]
  v_mfma_f32_32x32x16_bf16 v[112:127], v[40:43], v[228:231], v[112:127]
  v_mfma_f32_32x32x16_bf16 v[128:143], v[220:223], v[44:47], v[128:143]
  v_mfma_f32_32x32x16_bf16 v[144:159], v[224:227], v[44:47], v[144:159]
  v_mfma_f32_32x32x16_bf16 v[160:175], v[44:47], v[228:231], v[160:175]
  s_add_u32 s29, s27, 35840
  buffer_load_dwordx4 v[40:43], v2, s[8:11], s29 offen sc1
  s_add_u32 s29, s28, 35840
  buffer_load_dwordx4 v[44:47], v2, s[8:11], s29 offen sc1
  ds_read_b128 v[220:223], v3 offset:29696
  ds_read_b128 v[224:227], v4 offset:5120
  ds_read_b128 v[228:231], v4 offset:46080
  s_waitcnt lgkmcnt(3)
  s_waitcnt vmcnt(14)
  v_mfma_f32_32x32x16_bf16 v[80:95], v[208:211], v[48:51], v[80:95]
  v_mfma_f32_32x32x16_bf16 v[96:111], v[212:215], v[48:51], v[96:111]
  v_mfma_f32_32x32x16_bf16 v[112:127], v[48:51], v[216:219], v[112:127]
  v_mfma_f32_32x32x16_bf16 v[128:143], v[208:211], v[52:55], v[128:143]
  v_mfma_f32_32x32x16_bf16 v[144:159], v[212:215], v[52:55], v[144:159]
  v_mfma_f32_32x32x16_bf16 v[160:175], v[52:55], v[216:219], v[160:175]
  s_add_u32 s29, s27, 36864
  buffer_load_dwordx4 v[48:51], v2, s[8:11], s29 offen sc1
  s_add_u32 s29, s28, 36864
  buffer_load_dwordx4 v[52:55], v2, s[8:11], s29 offen sc1
  ds_read_b128 v[208:211], v3 offset:30720
  ds_read_b128 v[212:215], v4 offset:6144
  ds_read_b128 v[216:219], v4 offset:47104
  s_waitcnt lgkmcnt(3)
  s_waitcnt vmcnt(14)
  v_mfma_f32_32x32x16_bf16 v[80:95], v[220:223], v[56:59], v[80:95]
  v_mfma_f32_32x32x16_bf16 v[96:111], v[224:227], v[56:59], v[96:111]
  v_mfma_f32_32x32x16_bf16 v[112:127], v[56:59], v[228:231], v[112:127]
  v_mfma_f32_32x32x16_bf16 v[128:143], v[220:223], v[60:63], v[128:143]
  v_mfma_f32_32x32x16_bf16 v[144:159], v[224:227], v[60:63], v[144:159]
  v_mfma_f32_32x32x16_bf16 v[160:175], v[60:63], v[228:231], v[160:175]
  s_add_u32 s29, s27, 37888
  buffer_load_dwordx4 v[56:59], v2, s[8:11], s29 offen sc1
  s_add_u32 s29, s28, 37888
  buffer_load_dwordx4 v[60:63], v2, s[8:11], s29 offen sc1
  ds_read_b128 v[220:223], v3 offset:31744
  ds_read_b128 v[224:227], v4 offset:7168
  ds_read_b128 v[228:231], v4 offset:48128
  s_waitcnt lgkmcnt(3)
  s_waitcnt vmcnt(14)
  v_mfma_f32_32x32x16_bf16 v[80:95], v[208:211], v[64:67], v[80:95]
  v_mfma_f32_32x32x16_bf16 v[96:111], v[212:215], v[64:67], v[96:111]
  v_mfma_f32_32x32x16_bf16 v[112:127], v[64:67], v[216:219], v[112:127]
  v_mfma_f32_32x32x16_bf16 v[128:143], v[208:211], v[68:71], v[128:143]
  v_mfma_f32_32x32x16_bf16 v[144:159], v[212:215], v[68:71], v[144:159]
  v_mfma_f32_32x32x16_bf16 v[160:175], v[68:71], v[216:219], v[160:175]
  s_add_u32 s29, s27, 38912
  buffer_load_dwordx4 v[64:67], v2, s[8:11], s29 offen sc1
  s_add_u32 s29, s28, 38912
  buffer_load_dwordx4 v[68:71], v2, s[8:11], s29 offen sc1
  ds_read_b128 v[208:211], v3 offset:32768
  ds_read_b128 v[212:215], v4 offset:8192
  ds_read_b128 v[216:219], v4 offset:49152
  s_waitcnt lgkmcnt(3)
  s_waitcnt vmcnt(14)
  v_mfma_f32_32x32x16_bf16 v[80:95], v[220:223], v[72:75], v[80:95]
  v_mfma_f32_32x32x16_bf16 v[96:111], v[224:227], v[72:75], v[96:111]
  v_mfma_f32_32x32x16_bf16 v[112:127], v[72:75], v[228:231], v[112:127]
  v_mfma_f32_32x32x16_bf16 v[128:143], v[220:223], v[76:79], v[128:143]
  v_mfma_f32_32x32x16_bf16 v[144:159], v[224:227], v[76:79], v[144:159]
  v_mfma_f32_32x32x16_bf16 v[160:175], v[76:79], v[228:231], v[160:175]
  s_add_u32 s29, s27, 39936
  buffer_load_dwordx4 v[72:75], v2, s[8:11], s29 offen sc1
  s_add_u32 s29, s28, 39936
  buffer_load_dwordx4 v[76:79], v2, s[8:11], s29 offen sc1
  ds_read_b128 v[220:223], v3 offset:33792
  ds_read_b128 v[224:227], v4 offset:9216
  ds_read_b128 v[228:231], v4 offset:50176
  s_waitcnt lgkmcnt(3)
  s_waitcnt vmcnt(14)
  v_mfma_f32_32x32x16_bf16 v[80:95], v[208:211], v[16:19], v[80:95]
  v_mfma_f32_32x32x16_bf16 v[96:111], v[212:215], v[16:19], v[96:111]
  v_mfma_f32_32x32x16_bf16 v[112:127], v[16:19], v[216:219], v[112:127]
  v_mfma_f32_32x32x16_bf16 v[128:143], v[208:211], v[20:23], v[128:143]
  v_mfma_f32_32x32x16_bf16 v[144:159], v[212:215], v[20:23], v[144:159]
  v_mfma_f32_32x32x16_bf16 v[160:175], v[20:23], v[216:219], v[160:175]
  ds_read_b128 v[208:211], v3 offset:34816
  ds_read_b128 v[212:215], v4 offset:10240
  ds_read_b128 v[216:219], v4 offset:51200
  s_waitcnt lgkmcnt(3)
  s_waitcnt vmcnt(12)
  v_mfma_f32_32x32x16_bf16 v[80:95], v[220:223], v[24:27], v[80:95]
  v_mfma_f32_32x32x16_bf16 v[96:111], v[224:227], v[24:27], v[96:111]
  v_mfma_f32_32x32x16_bf16 v[112:127], v[24:27], v[228:231], v[112:127]
  v_mfma_f32_32x32x16_bf16 v[128:143], v[220:223], v[28:31], v[128:143]
  v_mfma_f32_32x32x16_bf16 v[144:159], v[224:227], v[28:31], v[144:159]
  v_mfma_f32_32x32x16_bf16 v[160:175], v[28:31], v[228:231], v[160:175]
  ds_read_b128 v[220:223], v3 offset:35840
  ds_read_b128 v[224:227], v4 offset:11264
  ds_read_b128 v[228:231], v4 offset:52224
  s_waitcnt lgkmcnt(3)
  s_waitcnt vmcnt(10)
  v_mfma_f32_32x32x16_bf16 v[80:95], v[208:211], v[32:35], v[80:95]
  v_mfma_f32_32x32x16_bf16 v[96:111], v[212:215], v[32:35], v[96:111]
  v_mfma_f32_32x32x16_bf16 v[112:127], v[32:35], v[216:219], v[112:127]
  v_mfma_f32_32x32x16_bf16 v[128:143], v[208:211], v[36:39], v[128:143]
  v_mfma_f32_32x32x16_bf16 v[144:159], v[212:215], v[36:39], v[144:159]
  v_mfma_f32_32x32x16_bf16 v[160:175], v[36:39], v[216:219], v[160:175]
  ds_read_b128 v[208:211], v3 offset:36864
  ds_read_b128 v[212:215], v4 offset:12288
  ds_read_b128 v[216:219], v4 offset:53248
  s_waitcnt lgkmcnt(3)
  s_waitcnt vmcnt(8)
  v_mfma_f32_32x32x16_bf16 v[80:95], v[220:223], v[40:43], v[80:95]
  v_mfma_f32_32x32x16_bf16 v[96:111], v[224:227], v[40:43], v[96:111]
  v_mfma_f32_32x32x16_bf16 v[112:127], v[40:43], v[228:231], v[112:127]
  v_mfma_f32_32x32x16_bf16 v[128:143], v[220:223], v[44:47], v[128:143]
  v_mfma_f32_32x32x16_bf16 v[144:159], v[224:227], v[44:47], v[144:159]
  v_mfma_f32_32x32x16_bf16 v[160:175], v[44:47], v[228:231], v[160:175]
  ds_read_b128 v[220:223], v3 offset:37888
  ds_read_b128 v[224:227], v4 offset:13312
  ds_read_b128 v[228:231], v4 offset:54272
  s_waitcnt lgkmcnt(3)
  s_waitcnt vmcnt(6)
  v_mfma_f32_32x32x16_bf16 v[80:95], v[208:211], v[48:51], v[80:95]
  v_mfma_f32_32x32x16_bf16 v[96:111], v[212:215], v[48:51], v[96:111]
  v_mfma_f32_32x32x16_bf16 v[112:127], v[48:51], v[216:219], v[112:127]
  v_mfma_f32_32x32x16_bf16 v[128:143], v[208:211], v[52:55], v[128:143]
  v_mfma_f32_32x32x16_bf16 v[144:159], v[212:215], v[52:55], v[144:159]
  v_mfma_f32_32x32x16_bf16 v[160:175], v[52:55], v[216:219], v[160:175]
  ds_read_b128 v[208:211], v3 offset:38912
  ds_read_b128 v[212:215], v4 offset:14336
  ds_read_b128 v[216:219], v4 offset:55296
  s_waitcnt lgkmcnt(3)
  s_waitcnt vmcnt(4)
  v_mfma_f32_32x32x16_bf16 v[80:95], v[220:223], v[56:59], v[80:95]
  v_mfma_f32_32x32x16_bf16 v[96:111], v[224:227], v[56:59], v[96:111]
  v_mfma_f32_32x32x16_bf16 v[112:127], v[56:59], v[228:231], v[112:127]
  v_mfma_f32_32x32x16_bf16 v[128:143], v[220:223], v[60:63], v[128:143]
  v_mfma_f32_32x32x16_bf16 v[144:159], v[224:227], v[60:63], v[144:159]
  v_mfma_f32_32x32x16_bf16 v[160:175], v[60:63], v[228:231], v[160:175]
  ds_read_b128 v[220:223], v3 offset:39936
  ds_read_b128 v[224:227], v4 offset:15360
  ds_read_b128 v[228:231], v4 offset:56320
  s_waitcnt lgkmcnt(3)
  s_waitcnt vmcnt(2)
  v_mfma_f32_32x32x16_bf16 v[80:95], v[208:211], v[64:67], v[80:95]
  v_mfma_f32_32x32x16_bf16 v[96:111], v[212:215], v[64:67], v[96:111]
  v_mfma_f32_32x32x16_bf16 v[112:127], v[64:67], v[216:219], v[112:127]
  v_mfma_f32_32x32x16_bf16 v[128:143], v[208:211], v[68:71], v[128:143]
  v_mfma_f32_32x32x16_bf16 v[144:159], v[212:215], v[68:71], v[144:159]
  v_mfma_f32_32x32x16_bf16 v[160:175], v[68:71], v[216:219], v[160:175]
  s_waitcnt lgkmcnt(0)
  s_waitcnt vmcnt(0)
  v_mfma_f32_32x32x16_bf16 v[80:95], v[220:223], v[72:75], v[80:95]
  v_mfma_f32_32x32x16_bf16 v[96:111], v[224:227], v[72:75], v[96:111]
  v_mfma_f32_32x32x16_bf16 v[112:127], v[72:75], v[228:231], v[112:127]
  v_mfma_f32_32x32x16_bf16 v[128:143], v[220:223], v[76:79], v[128:143]
  v_mfma_f32_32x32x16_bf16 v[144:159], v[224:227], v[76:79], v[144:159]
  v_mfma_f32_32x32x16_bf16 v[160:175], v[76:79], v[228:231], v[160:175]
  s_nop 11
  s_mov_b32 s30, 0x3ea52b5c
  v_mov_b32 v5, 0
  v_cmp_gt_u32 s[34:35], 32, v1
  v_mov_b32 v6, 1.0
  v_and_b32 v7, 31, v1
  v_cndmask_b32 v6, v5, v6, s[34:35]
  v_cmp_eq_u32 s[32:33], 20, v7
  v_mov_b32 v8, 1.0
  s_lshl_b32 s31, s22, 6
  s_add_u32 s31, s31, s24
  s_lshl_b32 s31, s31, 11
  v_mov_b32 v9, 0
  v_max3_f32 v9, v9, abs(v96), abs(v97)
  v_max3_f32 v9, v9, abs(v98), abs(v99)
  v_max3_f32 v9, v9, abs(v100), abs(v101)
  v_max3_f32 v9, v9, abs(v102), abs(v103)
  v_max3_f32 v9, v9, abs(v104), abs(v105)
  v_max3_f32 v9, v9, abs(v106), abs(v107)
  v_max3_f32 v9, v9, abs(v108), abs(v109)
  v_max3_f32 v9, v9, abs(v110), abs(v111)
  v_add_f32 v108, v108, v6
  v_cndmask_b32 v112, v112, v8, s[32:33]
  v_cndmask_b32 v113, v113, v8, s[32:33]
  v_cndmask_b32 v114, v114, v8, s[32:33]
  v_cndmask_b32 v115, v115, v8, s[32:33]
  v_cndmask_b32 v116, v116, v8, s[32:33]
  v_cndmask_b32 v117, v117, v8, s[32:33]
  v_cndmask_b32 v118, v118, v8, s[32:33]
  v_cndmask_b32 v119, v119, v8, s[32:33]
  v_cndmask_b32 v120, v120, v8, s[32:33]
  v_cndmask_b32 v121, v121, v8, s[32:33]
  v_cndmask_b32 v122, v122, v8, s[32:33]
  v_cndmask_b32 v123, v123, v8, s[32:33]
  v_cndmask_b32 v124, v124, v8, s[32:33]
  v_cndmask_b32 v125, v125, v8, s[32:33]
  v_cndmask_b32 v126, v126, v8, s[32:33]
  v_cndmask_b32 v127, v127, v8, s[32:33]
  v_cvt_pk_bf16_f32 v16, v96, v97
  v_cvt_pk_bf16_f32 v17, v98, v99
  v_cvt_pk_bf16_f32 v18, v100, v101
  v_cvt_pk_bf16_f32 v19, v102, v103
  v_cvt_pk_bf16_f32 v20, v104, v105
  v_cvt_pk_bf16_f32 v21, v106, v107
  v_cvt_pk_bf16_f32 v22, v108, v109
  v_cvt_pk_bf16_f32 v23, v110, v111
  s_add_u32 s29, s31, 245366784
  buffer_store_dwordx4 v[16:19], v2, s[8:11], s29 offen sc1
  buffer_store_dwordx4 v[20:23], v2, s[8:11], s29 offen offset:1024 sc1
  v_cvt_pk_bf16_f32 v24, v112, v113
  v_cvt_pk_bf16_f32 v25, v114, v115
  v_cvt_pk_bf16_f32 v26, v116, v117
  v_cvt_pk_bf16_f32 v27, v118, v119
  v_cvt_pk_bf16_f32 v28, v120, v121
  v_cvt_pk_bf16_f32 v29, v122, v123
  v_cvt_pk_bf16_f32 v30, v124, v125
  v_cvt_pk_bf16_f32 v31, v126, v127
  s_add_u32 s29, s31, 249561088
  buffer_store_dwordx4 v[24:27], v2, s[8:11], s29 offen sc1
  buffer_store_dwordx4 v[28:31], v2, s[8:11], s29 offen offset:1024 sc1
  v_mul_f32 v80, s30, v80
  v_mul_f32 v81, s30, v81
  v_mul_f32 v82, s30, v82
  v_mul_f32 v83, s30, v83
  v_mul_f32 v84, s30, v84
  v_mul_f32 v85, s30, v85
  v_mul_f32 v86, s30, v86
  v_mul_f32 v87, s30, v87
  v_mul_f32 v88, s30, v88
  v_mul_f32 v89, s30, v89
  v_mul_f32 v90, s30, v90
  v_mul_f32 v91, s30, v91
  v_mul_f32 v92, s30, v92
  v_mul_f32 v93, s30, v93
  v_mul_f32 v94, s30, v94
  v_mul_f32 v95, s30, v95
  v_cvt_pk_bf16_f32 v192, v80, v81
  v_cvt_pk_bf16_f32 v193, v82, v83
  v_cvt_pk_bf16_f32 v194, v84, v85
  v_cvt_pk_bf16_f32 v195, v86, v87
  v_cvt_pk_bf16_f32 v196, v88, v89
  v_cvt_pk_bf16_f32 v197, v90, v91
  v_cvt_pk_bf16_f32 v198, v92, v93
  v_cvt_pk_bf16_f32 v199, v94, v95
  v_max3_f32 v9, v9, abs(v144), abs(v145)
  v_max3_f32 v9, v9, abs(v146), abs(v147)
  v_max3_f32 v9, v9, abs(v148), abs(v149)
  v_max3_f32 v9, v9, abs(v150), abs(v151)
  v_max3_f32 v9, v9, abs(v152), abs(v153)
  v_max3_f32 v9, v9, abs(v154), abs(v155)
  v_max3_f32 v9, v9, abs(v156), abs(v157)
  v_max3_f32 v9, v9, abs(v158), abs(v159)
  v_add_f32 v156, v156, v6
  v_cndmask_b32 v160, v160, v8, s[32:33]
  v_cndmask_b32 v161, v161, v8, s[32:33]
  v_cndmask_b32 v162, v162, v8, s[32:33]
  v_cndmask_b32 v163, v163, v8, s[32:33]
  v_cndmask_b32 v164, v164, v8, s[32:33]
  v_cndmask_b32 v165, v165, v8, s[32:33]
  v_cndmask_b32 v166, v166, v8, s[32:33]
  v_cndmask_b32 v167, v167, v8, s[32:33]
  v_cndmask_b32 v168, v168, v8, s[32:33]
  v_cndmask_b32 v169, v169, v8, s[32:33]
  v_cndmask_b32 v170, v170, v8, s[32:33]
  v_cndmask_b32 v171, v171, v8, s[32:33]
  v_cndmask_b32 v172, v172, v8, s[32:33]
  v_cndmask_b32 v173, v173, v8, s[32:33]
  v_cndmask_b32 v174, v174, v8, s[32:33]
  v_cndmask_b32 v175, v175, v8, s[32:33]
  v_cvt_pk_bf16_f32 v32, v144, v145
  v_cvt_pk_bf16_f32 v33, v146, v147
  v_cvt_pk_bf16_f32 v34, v148, v149
  v_cvt_pk_bf16_f32 v35, v150, v151
  v_cvt_pk_bf16_f32 v36, v152, v153
  v_cvt_pk_bf16_f32 v37, v154, v155
  v_cvt_pk_bf16_f32 v38, v156, v157
  v_cvt_pk_bf16_f32 v39, v158, v159
  s_add_u32 s29, s31, 245368832
  buffer_store_dwordx4 v[32:35], v2, s[8:11], s29 offen sc1
  buffer_store_dwordx4 v[36:39], v2, s[8:11], s29 offen offset:1024 sc1
  v_cvt_pk_bf16_f32 v40, v160, v161
  v_cvt_pk_bf16_f32 v41, v162, v163
  v_cvt_pk_bf16_f32 v42, v164, v165
  v_cvt_pk_bf16_f32 v43, v166, v167
  v_cvt_pk_bf16_f32 v44, v168, v169
  v_cvt_pk_bf16_f32 v45, v170, v171
  v_cvt_pk_bf16_f32 v46, v172, v173
  v_cvt_pk_bf16_f32 v47, v174, v175
  s_add_u32 s29, s31, 249563136
  buffer_store_dwordx4 v[40:43], v2, s[8:11], s29 offen sc1
  buffer_store_dwordx4 v[44:47], v2, s[8:11], s29 offen offset:1024 sc1
  v_mul_f32 v128, s30, v128
  v_mul_f32 v129, s30, v129
  v_mul_f32 v130, s30, v130
  v_mul_f32 v131, s30, v131
  v_mul_f32 v132, s30, v132
  v_mul_f32 v133, s30, v133
  v_mul_f32 v134, s30, v134
  v_mul_f32 v135, s30, v135
  v_mul_f32 v136, s30, v136
  v_mul_f32 v137, s30, v137
  v_mul_f32 v138, s30, v138
  v_mul_f32 v139, s30, v139
  v_mul_f32 v140, s30, v140
  v_mul_f32 v141, s30, v141
  v_mul_f32 v142, s30, v142
  v_mul_f32 v143, s30, v143
  v_cvt_pk_bf16_f32 v200, v128, v129
  v_cvt_pk_bf16_f32 v201, v130, v131
  v_cvt_pk_bf16_f32 v202, v132, v133
  v_cvt_pk_bf16_f32 v203, v134, v135
  v_cvt_pk_bf16_f32 v204, v136, v137
  v_cvt_pk_bf16_f32 v205, v138, v139
  v_cvt_pk_bf16_f32 v206, v140, v141
  v_cvt_pk_bf16_f32 v207, v142, v143
  s_nop 1
  v_max_f32_dpp v10, v9, v9 quad_perm:[1,0,3,2] row_mask:0xf bank_mask:0xf
  s_nop 1
  v_max_f32_dpp v9, v10, v10 quad_perm:[2,3,0,1] row_mask:0xf bank_mask:0xf
  s_nop 1
  v_max_f32_dpp v10, v9, v9 row_half_mirror row_mask:0xf bank_mask:0xf
  s_nop 1
  v_max_f32_dpp v9, v10, v10 row_mirror row_mask:0xf bank_mask:0xf
  v_mov_b32 v10, v9
  s_nop 1
  v_permlane16_swap_b32 v9, v10
  v_max_f32 v9, v9, v10
  v_mov_b32 v10, v9
  s_nop 1
  v_permlane32_swap_b32 v9, v10
  v_max_f32 v9, v9, v10
  s_lshl_b32 s51, s22, 2
  s_add_u32 s51, s51, 0x9800
  v_mov_b32 v11, 0
  s_mov_b64 s[40:41], exec
  s_mov_b64 exec, 1
  buffer_atomic_umax v9, v11, s[8:11], s51 offen
  s_mov_b64 exec, s[40:41]
  s_mov_b32 s52, s24
  s_waitcnt vmcnt(0)
  s_barrier
  s_cmp_eq_u32 s21, 0
  s_cbranch_scc0 arr_30
  s_mov_b64 s[24:25], exec
  s_mov_b64 exec, 1
  v_mov_b32 v3, 0
  v_mov_b32 v4, 1
  buffer_atomic_add v4, v3, s[8:11], s47 offen
  s_mov_b64 exec, s[24:25]
arr_30:
  s_and_b32 s26, s2, 3
  s_mul_i32 s26, s26, 10
  s_mul_i32 s27, s21, 3
  s_cmp_eq_u32 s21, 3
  s_cselect_b32 s27, 8, s27
  s_add_u32 s50, s26, s27
  s_mul_i32 s26, s50, 20480
  s_add_u32 s26, s26, 0xe000000
  s_add_u32 s27, s26, 0
  buffer_load_dwordx4 a[0:3], v2, s[8:11], s27 offen
  s_add_u32 s27, s26, 1024
  buffer_load_dwordx4 a[4:7], v2, s[8:11], s27 offen
  s_add_u32 s27, s26, 2048
  buffer_load_dwordx4 a[8:11], v2, s[8:11], s27 offen
  s_add_u32 s27, s26, 3072
  buffer_load_dwordx4 a[12:15], v2, s[8:11], s27 offen
  s_add_u32 s27, s26, 4096
  buffer_load_dwordx4 a[16:19], v2, s[8:11], s27 offen
  s_add_u32 s27, s26, 5120
  buffer_load_dwordx4 a[20:23], v2, s[8:11], s27 offen
  s_add_u32 s27, s26, 6144
  buffer_load_dwordx4 a[24:27], v2, s[8:11], s27 offen
  s_add_u32 s27, s26, 7168
  buffer_load_dwordx4 a[28:31], v2, s[8:11], s27 offen
  s_add_u32 s27, s26, 8192
  buffer_load_dwordx4 a[32:35], v2, s[8:11], s27 offen
  s_add_u32 s27, s26, 9216
  buffer_load_dwordx4 a[36:39], v2, s[8:11], s27 offen
  s_add_u32 s27, s26, 10240
  buffer_load_dwordx4 a[40:43], v2, s[8:11], s27 offen
  s_add_u32 s27, s26, 11264
  buffer_load_dwordx4 a[44:47], v2, s[8:11], s27 offen
  s_add_u32 s27, s26, 12288
  buffer_load_dwordx4 a[48:51], v2, s[8:11], s27 offen
  s_add_u32 s27, s26, 13312
  buffer_load_dwordx4 a[52:55], v2, s[8:11], s27 offen
  s_add_u32 s27, s26, 14336
  buffer_load_dwordx4 a[56:59], v2, s[8:11], s27 offen
  s_add_u32 s27, s26, 15360
  buffer_load_dwordx4 a[60:63], v2, s[8:11], s27 offen
  s_add_u32 s27, s26, 16384
  buffer_load_dwordx4 a[64:67], v2, s[8:11], s27 offen
  s_add_u32 s27, s26, 17408
  buffer_load_dwordx4 a[68:71], v2, s[8:11], s27 offen
  s_add_u32 s27, s26, 18432
  buffer_load_dwordx4 a[72:75], v2, s[8:11], s27 offen
  s_add_u32 s27, s26, 19456
  buffer_load_dwordx4 a[76:79], v2, s[8:11], s27 offen
  s_add_u32 s27, s26, 20480
  buffer_load_dwordx4 a[80:83], v2, s[8:11], s27 offen
  s_add_u32 s27, s26, 21504
  buffer_load_dwordx4 a[84:87], v2, s[8:11], s27 offen
  s_add_u32 s27, s26, 22528
  buffer_load_dwordx4 a[88:91], v2, s[8:11], s27 offen
  s_add_u32 s27, s26, 23552
  buffer_load_dwordx4 a[92:95], v2, s[8:11], s27 offen
  s_add_u32 s27, s26, 24576
  buffer_load_dwordx4 a[96:99], v2, s[8:11], s27 offen
  s_add_u32 s27, s26, 25600
  buffer_load_dwordx4 a[100:103], v2, s[8:11], s27 offen
  s_add_u32 s27, s26, 26624
  buffer_load_dwordx4 a[104:107], v2, s[8:11], s27 offen
  s_add_u32 s27, s26, 27648
  buffer_load_dwordx4 a[108:111], v2, s[8:11], s27 offen
  s_add_u32 s27, s26, 28672
  buffer_load_dwordx4 a[112:115], v2, s[8:11], s27 offen
  s_add_u32 s27, s26, 29696
  buffer_load_dwordx4 a[116:119], v2, s[8:11], s27 offen
  s_add_u32 s27, s26, 30720
  buffer_load_dwordx4 a[120:123], v2, s[8:11], s27 offen
  s_add_u32 s27, s26, 31744
  buffer_load_dwordx4 a[124:127], v2, s[8:11], s27 offen
  s_add_u32 s27, s26, 32768
  buffer_load_dwordx4 a[128:131], v2, s[8:11], s27 offen
  s_add_u32 s27, s26, 33792
  buffer_load_dwordx4 a[132:135], v2, s[8:11], s27 offen
  s_add_u32 s27, s26, 34816
  buffer_load_dwordx4 a[136:139], v2, s[8:11], s27 offen
  s_add_u32 s27, s26, 35840
  buffer_load_dwordx4 a[140:143], v2, s[8:11], s27 offen
  s_add_u32 s27, s26, 36864
  buffer_load_dwordx4 a[144:147], v2, s[8:11], s27 offen
  s_add_u32 s27, s26, 37888
  buffer_load_dwordx4 a[148:151], v2, s[8:11], s27 offen
  s_add_u32 s27, s26, 38912
  buffer_load_dwordx4 a[152:155], v2, s[8:11], s27 offen
  s_add_u32 s27, s26, 39936
  buffer_load_dwordx4 a[156:159], v2, s[8:11], s27 offen
  s_cmp_lt_u32 s21, 2
  s_cbranch_scc0 g3_31
  s_add_u32 s27, s26, 40960
  buffer_load_dwordx4 a[160:163], v2, s[8:11], s27 offen
  s_add_u32 s27, s26, 41984
  buffer_load_dwordx4 a[164:167], v2, s[8:11], s27 offen
  s_add_u32 s27, s26, 43008
  buffer_load_dwordx4 a[168:171], v2, s[8:11], s27 offen
  s_add_u32 s27, s26, 44032
  buffer_load_dwordx4 a[172:175], v2, s[8:11], s27 offen
  s_add_u32 s27, s26, 45056
  buffer_load_dwordx4 a[176:179], v2, s[8:11], s27 offen
  s_add_u32 s27, s26, 46080
  buffer_load_dwordx4 a[180:183], v2, s[8:11], s27 offen
  s_add_u32 s27, s26, 47104
  buffer_load_dwordx4 a[184:187], v2, s[8:11], s27 offen
  s_add_u32 s27, s26, 48128
  buffer_load_dwordx4 a[188:191], v2, s[8:11], s27 offen
  s_add_u32 s27, s26, 49152
  buffer_load_dwordx4 a[192:195], v2, s[8:11], s27 offen
  s_add_u32 s27, s26, 50176
  buffer_load_dwordx4 a[196:199], v2, s[8:11], s27 offen
  s_add_u32 s27, s26, 51200
  buffer_load_dwordx4 a[200:203], v2, s[8:11], s27 offen
  s_add_u32 s27, s26, 52224
  buffer_load_dwordx4 a[204:207], v2, s[8:11], s27 offen
  s_add_u32 s27, s26, 53248
  buffer_load_dwordx4 a[208:211], v2, s[8:11], s27 offen
  s_add_u32 s27, s26, 54272
  buffer_load_dwordx4 a[212:215], v2, s[8:11], s27 offen
  s_add_u32 s27, s26, 55296
  buffer_load_dwordx4 a[216:219], v2, s[8:11], s27 offen
  s_add_u32 s27, s26, 56320
  buffer_load_dwordx4 a[220:223], v2, s[8:11], s27 offen
  s_add_u32 s27, s26, 57344
  buffer_load_dwordx4 a[224:227], v2, s[8:11], s27 offen
  s_add_u32 s27, s26, 58368
  buffer_load_dwordx4 a[228:231], v2, s[8:11], s27 offen
  s_add_u32 s27, s26, 59392
  buffer_load_dwordx4 a[232:235], v2, s[8:11], s27 offen
  s_add_u32 s27, s26, 60416
  buffer_load_dwordx4 a[236:239], v2, s[8:11], s27 offen
g3_31:
  v_mov_b32 v12, 0
  v_lshlrev_b32 v6, 16, v192
  v_and_b32 v7, 0xffff0000, v192
  v_add_f32_e64 v12, v12, abs(v6)
  v_add_f32_e64 v12, v12, abs(v7)
  v_lshlrev_b32 v6, 16, v193
  v_and_b32 v7, 0xffff0000, v193
  v_add_f32_e64 v12, v12, abs(v6)
  v_add_f32_e64 v12, v12, abs(v7)
  v_lshlrev_b32 v6, 16, v194
  v_and_b32 v7, 0xffff0000, v194
  v_add_f32_e64 v12, v12, abs(v6)
  v_add_f32_e64 v12, v12, abs(v7)
  v_lshlrev_b32 v6, 16, v195
  v_and_b32 v7, 0xffff0000, v195
  v_add_f32_e64 v12, v12, abs(v6)
  v_add_f32_e64 v12, v12, abs(v7)
  v_lshlrev_b32 v6, 16, v196
  v_and_b32 v7, 0xffff0000, v196
  v_add_f32_e64 v12, v12, abs(v6)
  v_add_f32_e64 v12, v12, abs(v7)
  v_lshlrev_b32 v6, 16, v197
  v_and_b32 v7, 0xffff0000, v197
  v_add_f32_e64 v12, v12, abs(v6)
  v_add_f32_e64 v12, v12, abs(v7)
  v_lshlrev_b32 v6, 16, v198
  v_and_b32 v7, 0xffff0000, v198
  v_add_f32_e64 v12, v12, abs(v6)
  v_add_f32_e64 v12, v12, abs(v7)
  v_lshlrev_b32 v6, 16, v199
  v_and_b32 v7, 0xffff0000, v199
  v_add_f32_e64 v12, v12, abs(v6)
  v_add_f32_e64 v12, v12, abs(v7)
  v_mov_b32 v6, v12
  s_nop 1
  v_permlane32_swap_b32 v12, v6
  v_add_f32 v12, v12, v6
  v_mov_b32 v13, 0
  v_lshlrev_b32 v6, 16, v200
  v_and_b32 v7, 0xffff0000, v200
  v_add_f32_e64 v13, v13, abs(v6)
  v_add_f32_e64 v13, v13, abs(v7)
  v_lshlrev_b32 v6, 16, v201
  v_and_b32 v7, 0xffff0000, v201
  v_add_f32_e64 v13, v13, abs(v6)
  v_add_f32_e64 v13, v13, abs(v7)
  v_lshlrev_b32 v6, 16, v202
  v_and_b32 v7, 0xffff0000, v202
  v_add_f32_e64 v13, v13, abs(v6)
  v_add_f32_e64 v13, v13, abs(v7)
  v_lshlrev_b32 v6, 16, v203
  v_and_b32 v7, 0xffff0000, v203
  v_add_f32_e64 v13, v13, abs(v6)
  v_add_f32_e64 v13, v13, abs(v7)
  v_lshlrev_b32 v6, 16, v204
  v_and_b32 v7, 0xffff0000, v204
  v_add_f32_e64 v13, v13, abs(v6)
  v_add_f32_e64 v13, v13, abs(v7)
  v_lshlrev_b32 v6, 16, v205
  v_and_b32 v7, 0xffff0000, v205
  v_add_f32_e64 v13, v13, abs(v6)
  v_add_f32_e64 v13, v13, abs(v7)
  v_lshlrev_b32 v6, 16, v206
  v_and_b32 v7, 0xffff0000, v206
  v_add_f32_e64 v13, v13, abs(v6)
  v_add_f32_e64 v13, v13, abs(v7)
  v_lshlrev_b32 v6, 16, v207
  v_and_b32 v7, 0xffff0000, v207
  v_add_f32_e64 v13, v13, abs(v6)
  v_add_f32_e64 v13, v13, abs(v7)
  v_mov_b32 v6, v13
  s_nop 1
  v_permlane32_swap_b32 v13, v6
  v_add_f32 v13, v13, v6
  v_mov_b32 v8, -1
  v_mov_b32 v9, -1
  v_mov_b32 v10, -1
  v_mov_b32 v11, -1
  s_lshl_b32 s30, s2, 2
  s_add_u32 s30, s30, s21
  s_add_u32 s31, s30, 0
  s_cmp_lt_u32 s31, 2560
  s_cbranch_scc0 f_32
  s_lshl_b32 s31, s31, 10
  s_add_u32 s31, s31, 0x400000
  buffer_store_dwordx4 v[8:11], v2, s[8:11], s31 offen
f_32:
  s_add_u32 s31, s30, 1024
  s_cmp_lt_u32 s31, 2560
  s_cbranch_scc0 f_33
  s_lshl_b32 s31, s31, 10
  s_add_u32 s31, s31, 0x400000
  buffer_store_dwordx4 v[8:11], v2, s[8:11], s31 offen
f_33:
  s_add_u32 s31, s30, 2048
  s_cmp_lt_u32 s31, 2560
  s_cbranch_scc0 f_34
  s_lshl_b32 s31, s31, 10
  s_add_u32 s31, s31, 0x400000
  buffer_store_dwordx4 v[8:11], v2, s[8:11], s31 offen
f_34:
  s_add_u32 s31, s30, 0
  s_cmp_lt_u32 s31, 1280
  s_cbranch_scc0 f_35
  s_lshl_b32 s31, s31, 10
  s_add_u32 s31, s31, 0x700000
  buffer_store_dwordx4 v[8:11], v2, s[8:11], s31 offen
f_35:
  s_add_u32 s31, s30, 1024
  s_cmp_lt_u32 s31, 1280
  s_cbranch_scc0 f_36
  s_lshl_b32 s31, s31, 10
  s_add_u32 s31, s31, 0x700000
  buffer_store_dwordx4 v[8:11], v2, s[8:11], s31 offen
f_36:
  s_add_u32 s31, s30, 0
  s_cmp_lt_u32 s31, 640
  s_cbranch_scc0 f_37
  s_lshl_b32 s31, s31, 10
  s_add_u32 s31, s31, 0xa00000
  buffer_store_dwordx4 v[8:11], v2, s[8:11], s31 offen
f_37:
  s_add_u32 s31, s30, 0
  s_cmp_lt_u32 s31, 5120
  s_cbranch_scc0 f_38
  s_lshl_b32 s31, s31, 10
  s_add_u32 s31, s31, 0xe00000
  buffer_store_dwordx4 v[8:11], v2, s[8:11], s31 offen
f_38:
  s_add_u32 s31, s30, 1024
  s_cmp_lt_u32 s31, 5120
  s_cbranch_scc0 f_39
  s_lshl_b32 s31, s31, 10
  s_add_u32 s31, s31, 0xe00000
  buffer_store_dwordx4 v[8:11], v2, s[8:11], s31 offen
f_39:
  s_add_u32 s31, s30, 2048
  s_cmp_lt_u32 s31, 5120
  s_cbranch_scc0 f_40
  s_lshl_b32 s31, s31, 10
  s_add_u32 s31, s31, 0xe00000
  buffer_store_dwordx4 v[8:11], v2, s[8:11], s31 offen
f_40:
  s_add_u32 s31, s30, 3072
  s_cmp_lt_u32 s31, 5120
  s_cbranch_scc0 f_41
  s_lshl_b32 s31, s31, 10
  s_add_u32 s31, s31, 0xe00000
  buffer_store_dwordx4 v[8:11], v2, s[8:11], s31 offen
f_41:
  s_add_u32 s31, s30, 4096
  s_cmp_lt_u32 s31, 5120
  s_cbranch_scc0 f_42
  s_lshl_b32 s31, s31, 10
  s_add_u32 s31, s31, 0xe00000
  buffer_store_dwordx4 v[8:11], v2, s[8:11], s31 offen
f_42:
  s_cmp_eq_u32 s2, 0
  s_cbranch_scc0 z_43
  s_cmp_eq_u32 s21, 0
  s_cbranch_scc0 z_43
  v_mov_b32 v8, 0
  v_mov_b32 v9, 0
  v_mov_b32 v10, 0
  v_mov_b32 v11, 0
  s_mov_b32 s30, 0x0
  buffer_store_dwordx4 v[8:11], v2, s[8:11], s30 offen
  s_add_u32 s30, s30, 1024
  buffer_store_dwordx4 v[8:11], v2, s[8:11], s30 offen
  s_add_u32 s30, s30, 1024
  buffer_store_dwordx4 v[8:11], v2, s[8:11], s30 offen
  s_add_u32 s30, s30, 1024
  buffer_store_dwordx4 v[8:11], v2, s[8:11], s30 offen
  s_add_u32 s30, s30, 1024
  buffer_store_dwordx4 v[8:11], v2, s[8:11], s30 offen
  s_add_u32 s30, s30, 1024
z_43:
  s_mov_b32 s45, 0
  v_mov_b32 v3, 0
aw_44:
  buffer_load_dword v4, v3, s[8:11], s47 offen sc1
  s_add_u32 s45, s45, 1
  s_waitcnt vmcnt(0)
  v_readfirstlane_b32 s29, v4
  s_cmp_ge_u32 s29, 8
  s_cbranch_scc1 aw_44_ok
  s_cmp_lt_u32 s45, 400000
  s_cbranch_scc1 aw_44
  s_branch kb1_abort
aw_44_ok:
  v_mov_b32 v3, 0
  buffer_load_dword v4, v3, s[8:11], s51 offen sc1
  s_lshl_b32 s25, s22, 6
  s_lshl_b32 s27, s25, 11
  s_add_u32 s28, s27, 0xee00000
  s_add_u32 s27, s27, 0xea00000
  s_mov_b32 s41, 0
  s_mul_i32 s53, s41, 32768
  s_lshl_b32 s31, s21, 13
  s_add_u32 s53, s53, s31
  s_add_u32 m0, s31, 0
  s_add_u32 s29, s53, s27
  s_add_u32 s29, s29, 0
  buffer_load_dwordx4 v2, s[8:11], s29 offen sc1 lds
  s_add_u32 m0, s31, 1024
  s_add_u32 s29, s53, s27
  s_add_u32 s29, s29, 1024
  buffer_load_dwordx4 v2, s[8:11], s29 offen sc1 lds
  s_add_u32 m0, s31, 2048
  s_add_u32 s29, s53, s27
  s_add_u32 s29, s29, 2048
  buffer_load_dwordx4 v2, s[8:11], s29 offen sc1 lds
  s_add_u32 m0, s31, 3072
  s_add_u32 s29, s53, s27
  s_add_u32 s29, s29, 3072
  buffer_load_dwordx4 v2, s[8:11], s29 offen sc1 lds
  s_add_u32 m0, s31, 4096
  s_add_u32 s29, s53, s27
  s_add_u32 s29, s29, 4096
  buffer_load_dwordx4 v2, s[8:11], s29 offen sc1 lds
  s_add_u32 m0, s31, 5120
  s_add_u32 s29, s53, s27
  s_add_u32 s29, s29, 5120
  buffer_load_dwordx4 v2, s[8:11], s29 offen sc1 lds
  s_add_u32 m0, s31, 6144
  s_add_u32 s29, s53, s27
  s_add_u32 s29, s29, 6144
  buffer_load_dwordx4 v2, s[8:11], s29 offen sc1 lds
  s_add_u32 m0, s31, 7168
  s_add_u32 s29, s53, s27
  s_add_u32 s29, s29, 7168
  buffer_load_dwordx4 v2, s[8:11], s29 offen sc1 lds
  s_add_u32 m0, s31, 32768
  s_add_u32 s29, s53, s28
  s_add_u32 s29, s29, 0
  buffer_load_dwordx4 v2, s[8:11], s29 offen sc1 lds
  s_add_u32 m0, s31, 33792
  s_add_u32 s29, s53, s28
  s_add_u32 s29, s29, 1024
  buffer_load_dwordx4 v2, s[8:11], s29 offen sc1 lds
  s_add_u32 m0, s31, 34816
  s_add_u32 s29, s53, s28
  s_add_u32 s29, s29, 2048
  buffer_load_dwordx4 v2, s[8:11], s29 offen sc1 lds
  s_add_u32 m0, s31, 35840
  s_add_u32 s29, s53, s28
  s_add_u32 s29, s29, 3072
  buffer_load_dwordx4 v2, s[8:11], s29 offen sc1 lds
  s_add_u32 m0, s31, 36864
  s_add_u32 s29, s53, s28
  s_add_u32 s29, s29, 4096
  buffer_load_dwordx4 v2, s[8:11], s29 offen sc1 lds
  s_add_u32 m0, s31, 37888
  s_add_u32 s29, s53, s28
  s_add_u32 s29, s29, 5120
  buffer_load_dwordx4 v2, s[8:11], s29 offen sc1 lds
  s_add_u32 m0, s31, 38912
  s_add_u32 s29, s53, s28
  s_add_u32 s29, s29, 6144
  buffer_load_dwordx4 v2, s[8:11], s29 offen sc1 lds
  s_add_u32 m0, s31, 39936
  s_add_u32 s29, s53, s28
  s_add_u32 s29, s29, 7168
  buffer_load_dwordx4 v2, s[8:11], s29 offen sc1 lds
  s_waitcnt vmcnt(16)
  v_mul_f32 v12, v12, v4
  v_mul_f32 v12, 0x3f820000, v12
  v_mul_f32 v13, v13, v4
  v_mul_f32 v13, 0x3f820000, v13
  s_mov_b32 s40, 0
kb1_main:
  v_lshrrev_b32 v5, 16, v12
  v_or_b32 v5, 0x8000, v5
  v_and_b32 v6, 0xffff0000, v198
  v_or_b32 v5, v5, v6
  v_cndmask_b32 v198, v198, v5, s[34:35]
  v_lshrrev_b32 v5, 16, v13
  v_or_b32 v5, 0x8000, v5
  v_and_b32 v6, 0xffff0000, v206
  v_or_b32 v5, v5, v6
  v_cndmask_b32 v206, v206, v5, s[34:35]
kb1_main2:
  v_mov_b32 v112, 0
  v_mov_b32 v113, 0
  v_mov_b32 v114, 0
  v_mov_b32 v115, 0
  v_mov_b32 v116, 0
  v_mov_b32 v117, 0
  v_mov_b32 v118, 0
  v_mov_b32 v119, 0
  v_mov_b32 v120, 0
  v_mov_b32 v121, 0
  v_mov_b32 v122, 0
  v_mov_b32 v123, 0
  v_mov_b32 v124, 0
  v_mov_b32 v125, 0
  v_mov_b32 v126, 0
  v_mov_b32 v127, 0
  v_mov_b32 v128, 0
  v_mov_b32 v129, 0
  v_mov_b32 v130, 0
  v_mov_b32 v131, 0
  v_mov_b32 v132, 0
  v_mov_b32 v133, 0
  v_mov_b32 v134, 0
  v_mov_b32 v135, 0
  v_mov_b32 v136, 0
  v_mov_b32 v137, 0
  v_mov_b32 v138, 0
  v_mov_b32 v139, 0
  v_mov_b32 v140, 0
  v_mov_b32 v141, 0
  v_mov_b32 v142, 0
  v_mov_b32 v143, 0
  v_mov_b32 v3, v2
  v_add_u32 v4, 65536, v2
kb1_chunk2:
  s_waitcnt vmcnt(0)
  s_barrier
  s_add_u32 s41, s41, 1
  s_min_u32 s29, s41, 3
  s_mul_i32 s53, s29, 32768
  s_lshl_b32 s31, s21, 13
  s_add_u32 s53, s53, s31
  ds_read_b128 v[32:35], v3 offset:0
  ds_read_b128 v[36:39], v3 offset:1024
  ds_read_b128 v[48:51], v3 offset:32768
  ds_read_b128 v[52:55], v3 offset:33792
  ds_read_b128 v[40:43], v3 offset:2048
  ds_read_b128 v[44:47], v3 offset:3072
  s_waitcnt lgkmcnt(4)
  v_mfma_f32_32x32x16_bf16 v[64:79], v[32:35], v[192:195], 0
  v_mfma_f32_32x32x16_bf16 v[64:79], v[36:39], v[196:199], v[64:79]
  s_nop 11
  v_exp_f32 v64, v64
  v_exp_f32 v65, v65
  v_exp_f32 v66, v66
  v_exp_f32 v67, v67
  v_cvt_pk_bf16_f32 v96, v64, v65
  v_exp_f32 v68, v68
  v_exp_f32 v69, v69
  v_cvt_pk_bf16_f32 v97, v66, v67
  v_exp_f32 v70, v70
  v_mfma_f32_32x32x16_bf16 v[80:95], v[32:35], v[200:203], 0
  v_exp_f32 v71, v71
  v_cvt_pk_bf16_f32 v98, v68, v69
  v_exp_f32 v72, v72
  v_exp_f32 v73, v73
  v_cvt_pk_bf16_f32 v99, v70, v71
  v_mfma_f32_32x32x16_bf16 v[80:95], v[36:39], v[204:207], v[80:95]
  v_exp_f32 v74, v74
  v_exp_f32 v75, v75
  ds_read_b128 v[56:59], v3 offset:34816
  v_cvt_pk_bf16_f32 v100, v72, v73
  v_exp_f32 v76, v76
  v_exp_f32 v77, v77
  ds_read_b128 v[60:63], v3 offset:35840
  v_cvt_pk_bf16_f32 v101, v74, v75
  v_exp_f32 v78, v78
  s_add_u32 m0, s31, 65536
  s_add_u32 s29, s53, s27
  s_add_u32 s29, s29, 0
  buffer_load_dwordx4 v2, s[8:11], s29 offen sc1 lds
  v_exp_f32 v79, v79
  v_cvt_pk_bf16_f32 v102, v76, v77
  v_cvt_pk_bf16_f32 v103, v78, v79
  s_waitcnt lgkmcnt(4)
  v_mfma_f32_32x32x16_bf16 v[112:127], v[48:51], v[96:99], v[112:127]
  v_exp_f32 v80, v80
  v_exp_f32 v81, v81
  v_exp_f32 v82, v82
  v_exp_f32 v83, v83
  v_mfma_f32_32x32x16_bf16 v[112:127], v[52:55], v[100:103], v[112:127]
  v_cvt_pk_bf16_f32 v104, v80, v81
  v_exp_f32 v84, v84
  v_exp_f32 v85, v85
  v_cvt_pk_bf16_f32 v105, v82, v83
  v_exp_f32 v86, v86
  s_waitcnt lgkmcnt(2)
  v_mfma_f32_32x32x16_bf16 v[64:79], v[40:43], v[192:195], 0
  v_exp_f32 v87, v87
  v_cvt_pk_bf16_f32 v106, v84, v85
  v_exp_f32 v88, v88
  v_exp_f32 v89, v89
  v_cvt_pk_bf16_f32 v107, v86, v87
  v_mfma_f32_32x32x16_bf16 v[64:79], v[44:47], v[196:199], v[64:79]
  v_exp_f32 v90, v90
  v_exp_f32 v91, v91
  ds_read_b128 v[32:35], v3 offset:4096
  v_cvt_pk_bf16_f32 v108, v88, v89
  v_exp_f32 v92, v92
  v_exp_f32 v93, v93
  ds_read_b128 v[36:39], v3 offset:5120
  v_cvt_pk_bf16_f32 v109, v90, v91
  v_exp_f32 v94, v94
  v_exp_f32 v95, v95
  v_cvt_pk_bf16_f32 v110, v92, v93
  v_cvt_pk_bf16_f32 v111, v94, v95
  v_mfma_f32_32x32x16_bf16 v[128:143], v[48:51], v[104:107], v[128:143]
  v_exp_f32 v64, v64
  v_exp_f32 v65, v65
  v_exp_f32 v66, v66
  v_exp_f32 v67, v67
  v_mfma_f32_32x32x16_bf16 v[128:143], v[52:55], v[108:111], v[128:143]
  v_cvt_pk_bf16_f32 v96, v64, v65
  v_exp_f32 v68, v68
  v_exp_f32 v69, v69
  v_cvt_pk_bf16_f32 v97, v66, v67
  v_exp_f32 v70, v70
  v_mfma_f32_32x32x16_bf16 v[80:95], v[40:43], v[200:203], 0
  v_exp_f32 v71, v71
  v_cvt_pk_bf16_f32 v98, v68, v69
  v_exp_f32 v72, v72
  v_exp_f32 v73, v73
  v_cvt_pk_bf16_f32 v99, v70, v71
  v_mfma_f32_32x32x16_bf16 v[80:95], v[44:47], v[204:207], v[80:95]
  v_exp_f32 v74, v74
  v_exp_f32 v75, v75
  ds_read_b128 v[48:51], v3 offset:36864
  v_cvt_pk_bf16_f32 v100, v72, v73
  v_exp_f32 v76, v76
  v_exp_f32 v77, v77
  ds_read_b128 v[52:55], v3 offset:37888
  v_cvt_pk_bf16_f32 v101, v74, v75
  v_exp_f32 v78, v78
  s_add_u32 m0, s31, 66560
  s_add_u32 s29, s53, s27
  s_add_u32 s29, s29, 1024
  buffer_load_dwordx4 v2, s[8:11], s29 offen sc1 lds
  v_exp_f32 v79, v79
  v_cvt_pk_bf16_f32 v102, v76, v77
  v_cvt_pk_bf16_f32 v103, v78, v79
  s_waitcnt lgkmcnt(4)
  v_mfma_f32_32x32x16_bf16 v[112:127], v[56:59], v[96:99], v[112:127]
  v_exp_f32 v80, v80
  v_exp_f32 v81, v81
  v_exp_f32 v82, v82
  v_exp_f32 v83, v83
  v_mfma_f32_32x32x16_bf16 v[112:127], v[60:63], v[100:103], v[112:127]
  v_cvt_pk_bf16_f32 v104, v80, v81
  v_exp_f32 v84, v84
  v_exp_f32 v85, v85
  v_cvt_pk_bf16_f32 v105, v82, v83
  v_exp_f32 v86, v86
  s_waitcnt lgkmcnt(2)
  v_mfma_f32_32x32x16_bf16 v[64:79], v[32:35], v[192:195], 0
  v_exp_f32 v87, v87
  v_cvt_pk_bf16_f32 v106, v84, v85
  v_exp_f32 v88, v88
  v_exp_f32 v89, v89
  v_cvt_pk_bf16_f32 v107, v86, v87
  v_mfma_f32_32x32x16_bf16 v[64:79], v[36:39], v[196:199], v[64:79]
  v_exp_f32 v90, v90
  v_exp_f32 v91, v91
  ds_read_b128 v[40:43], v3 offset:6144
  v_cvt_pk_bf16_f32 v108, v88, v89
  v_exp_f32 v92, v92
  v_exp_f32 v93, v93
  ds_read_b128 v[44:47], v3 offset:7168
  v_cvt_pk_bf16_f32 v109, v90, v91
  v_exp_f32 v94, v94
  v_exp_f32 v95, v95
  v_cvt_pk_bf16_f32 v110, v92, v93
  v_cvt_pk_bf16_f32 v111, v94, v95
  v_mfma_f32_32x32x16_bf16 v[128:143], v[56:59], v[104:107], v[128:143]
  v_exp_f32 v64, v64
  v_exp_f32 v65, v65
  v_exp_f32 v66, v66
  v_exp_f32 v67, v67
  v_mfma_f32_32x32x16_bf16 v[128:143], v[60:63], v[108:111], v[128:143]
  v_cvt_pk_bf16_f32 v96, v64, v65
  v_exp_f32 v68, v68
  v_exp_f32 v69, v69
  v_cvt_pk_bf16_f32 v97, v66, v67
  v_exp_f32 v70, v70
  v_mfma_f32_32x32x16_bf16 v[80:95], v[32:35], v[200:203], 0
  v_exp_f32 v71, v71
  v_cvt_pk_bf16_f32 v98, v68, v69
  v_exp_f32 v72, v72
  v_exp_f32 v73, v73
  v_cvt_pk_bf16_f32 v99, v70, v71
  v_mfma_f32_32x32x16_bf16 v[80:95], v[36:39], v[204:207], v[80:95]
  v_exp_f32 v74, v74
  v_exp_f32 v75, v75
  ds_read_b128 v[56:59], v3 offset:38912
  v_cvt_pk_bf16_f32 v100, v72, v73
  v_exp_f32 v76, v76
  v_exp_f32 v77, v77
  ds_read_b128 v[60:63], v3 offset:39936
  v_cvt_pk_bf16_f32 v101, v74, v75
  v_exp_f32 v78, v78
  s_add_u32 m0, s31, 67584
  s_add_u32 s29, s53, s27
  s_add_u32 s29, s29, 2048
  buffer_load_dwordx4 v2, s[8:11], s29 offen sc1 lds
  v_exp_f32 v79, v79
  v_cvt_pk_bf16_f32 v102, v76, v77
  v_cvt_pk_bf16_f32 v103, v78, v79
  s_waitcnt lgkmcnt(4)
  v_mfma_f32_32x32x16_bf16 v[112:127], v[48:51], v[96:99], v[112:127]
  v_exp_f32 v80, v80
  v_exp_f32 v81, v81
  v_exp_f32 v82, v82
  v_exp_f32 v83, v83
  v_mfma_f32_32x32x16_bf16 v[112:127], v[52:55], v[100:103], v[112:127]
  v_cvt_pk_bf16_f32 v104, v80, v81
  v_exp_f32 v84, v84
  v_exp_f32 v85, v85
  v_cvt_pk_bf16_f32 v105, v82, v83
  v_exp_f32 v86, v86
  s_waitcnt lgkmcnt(2)
  v_mfma_f32_32x32x16_bf16 v[64:79], v[40:43], v[192:195], 0
  v_exp_f32 v87, v87
  v_cvt_pk_bf16_f32 v106, v84, v85
  v_exp_f32 v88, v88
  v_exp_f32 v89, v89
  v_cvt_pk_bf16_f32 v107, v86, v87
  v_mfma_f32_32x32x16_bf16 v[64:79], v[44:47], v[196:199], v[64:79]
  v_exp_f32 v90, v90
  v_exp_f32 v91, v91
  ds_read_b128 v[32:35], v3 offset:8192
  v_cvt_pk_bf16_f32 v108, v88, v89
  v_exp_f32 v92, v92
  v_exp_f32 v93, v93
  ds_read_b128 v[36:39], v3 offset:9216
  v_cvt_pk_bf16_f32 v109, v90, v91
  v_exp_f32 v94, v94
  v_exp_f32 v95, v95
  v_cvt_pk_bf16_f32 v110, v92, v93
  v_cvt_pk_bf16_f32 v111, v94, v95
  v_mfma_f32_32x32x16_bf16 v[128:143], v[48:51], v[104:107], v[128:143]
  v_exp_f32 v64, v64
  v_exp_f32 v65, v65
  v_exp_f32 v66, v66
  v_exp_f32 v67, v67
  v_mfma_f32_32x32x16_bf16 v[128:143], v[52:55], v[108:111], v[128:143]
  v_cvt_pk_bf16_f32 v96, v64, v65
  v_exp_f32 v68, v68
  v_exp_f32 v69, v69
  v_cvt_pk_bf16_f32 v97, v66, v67
  v_exp_f32 v70, v70
  v_mfma_f32_32x32x16_bf16 v[80:95], v[40:43], v[200:203], 0
  v_exp_f32 v71, v71
  v_cvt_pk_bf16_f32 v98, v68, v69
  v_exp_f32 v72, v72
  v_exp_f32 v73, v73
  v_cvt_pk_bf16_f32 v99, v70, v71
  v_mfma_f32_32x32x16_bf16 v[80:95], v[44:47], v[204:207], v[80:95]
  v_exp_f32 v74, v74
  v_exp_f32 v75, v75
  ds_read_b128 v[48:51], v3 offset:40960
  v_cvt_pk_bf16_f32 v100, v72, v73
  v_exp_f32 v76, v76
  v_exp_f32 v77, v77
  ds_read_b128 v[52:55], v3 offset:41984
  v_cvt_pk_bf16_f32 v101, v74, v75
  v_exp_f32 v78, v78
  s_add_u32 m0, s31, 68608
  s_add_u32 s29, s53, s27
  s_add_u32 s29, s29, 3072
  buffer_load_dwordx4 v2, s[8:11], s29 offen sc1 lds
  v_exp_f32 v79, v79
  v_cvt_pk_bf16_f32 v102, v76, v77
  v_cvt_pk_bf16_f32 v103, v78, v79
  s_waitcnt lgkmcnt(4)
  v_mfma_f32_32x32x16_bf16 v[112:127], v[56:59], v[96:99], v[112:127]
  v_exp_f32 v80, v80
  v_exp_f32 v81, v81
  v_exp_f32 v82, v82
  v_exp_f32 v83, v83
  v_mfma_f32_32x32x16_bf16 v[112:127], v[60:63], v[100:103], v[112:127]
  v_cvt_pk_bf16_f32 v104, v80, v81
  v_exp_f32 v84, v84
  v_exp_f32 v85, v85
  v_cvt_pk_bf16_f32 v105, v82, v83
  v_exp_f32 v86, v86
  s_waitcnt lgkmcnt(2)
  v_mfma_f32_32x32x16_bf16 v[64:79], v[32:35], v[192:195], 0
  v_exp_f32 v87, v87
  v_cvt_pk_bf16_f32 v106, v84, v85
  v_exp_f32 v88, v88
  v_exp_f32 v89, v89
  v_cvt_pk_bf16_f32 v107, v86, v87
  v_mfma_f32_32x32x16_bf16 v[64:79], v[36:39], v[196:199], v[64:79]
  v_exp_f32 v90, v90
  v_exp_f32 v91, v91
  ds_read_b128 v[40:43], v3 offset:10240
  v_cvt_pk_bf16_f32 v108, v88, v89
  v_exp_f32 v92, v92
  v_exp_f32 v93, v93
  ds_read_b128 v[44:47], v3 offset:11264
  v_cvt_pk_bf16_f32 v109, v90, v91
  v_exp_f32 v94, v94
  v_exp_f32 v95, v95
  v_cvt_pk_bf16_f32 v110, v92, v93
  v_cvt_pk_bf16_f32 v111, v94, v95
  v_mfma_f32_32x32x16_bf16 v[128:143], v[56:59], v[104:107], v[128:143]
  v_exp_f32 v64, v64
  v_exp_f32 v65, v65
  v_exp_f32 v66, v66
  v_exp_f32 v67, v67
  v_mfma_f32_32x32x16_bf16 v[128:143], v[60:63], v[108:111], v[128:143]
  v_cvt_pk_bf16_f32 v96, v64, v65
  v_exp_f32 v68, v68
  v_exp_f32 v69, v69
  v_cvt_pk_bf16_f32 v97, v66, v67
  v_exp_f32 v70, v70
  v_mfma_f32_32x32x16_bf16 v[80:95], v[32:35], v[200:203], 0
  v_exp_f32 v71, v71
  v_cvt_pk_bf16_f32 v98, v68, v69
  v_exp_f32 v72, v72
  v_exp_f32 v73, v73
  v_cvt_pk_bf16_f32 v99, v70, v71
  v_mfma_f32_32x32x16_bf16 v[80:95], v[36:39], v[204:207], v[80:95]
  v_exp_f32 v74, v74
  v_exp_f32 v75, v75
  ds_read_b128 v[56:59], v3 offset:43008
  v_cvt_pk_bf16_f32 v100, v72, v73
  v_exp_f32 v76, v76
  v_exp_f32 v77, v77
  ds_read_b128 v[60:63], v3 offset:44032
  v_cvt_pk_bf16_f32 v101, v74, v75
  v_exp_f32 v78, v78
  s_add_u32 m0, s31, 69632
  s_add_u32 s29, s53, s27
  s_add_u32 s29, s29, 4096
  buffer_load_dwordx4 v2, s[8:11], s29 offen sc1 lds
  v_exp_f32 v79, v79
  v_cvt_pk_bf16_f32 v102, v76, v77
  v_cvt_pk_bf16_f32 v103, v78, v79
  s_waitcnt lgkmcnt(4)
  v_mfma_f32_32x32x16_bf16 v[112:127], v[48:51], v[96:99], v[112:127]
  v_exp_f32 v80, v80
  v_exp_f32 v81, v81
  v_exp_f32 v82, v82
  v_exp_f32 v83, v83
  v_mfma_f32_32x32x16_bf16 v[112:127], v[52:55], v[100:103], v[112:127]
  v_cvt_pk_bf16_f32 v104, v80, v81
  v_exp_f32 v84, v84
  v_exp_f32 v85, v85
  v_cvt_pk_bf16_f32 v105, v82, v83
  v_exp_f32 v86, v86
  s_waitcnt lgkmcnt(2)
  v_mfma_f32_32x32x16_bf16 v[64:79], v[40:43], v[192:195], 0
  v_exp_f32 v87, v87
  v_cvt_pk_bf16_f32 v106, v84, v85
  v_exp_f32 v88, v88
  v_exp_f32 v89, v89
  v_cvt_pk_bf16_f32 v107, v86, v87
  v_mfma_f32_32x32x16_bf16 v[64:79], v[44:47], v[196:199], v[64:79]
  v_exp_f32 v90, v90
  v_exp_f32 v91, v91
  ds_read_b128 v[32:35], v3 offset:12288
  v_cvt_pk_bf16_f32 v108, v88, v89
  v_exp_f32 v92, v92
  v_exp_f32 v93, v93
  ds_read_b128 v[36:39], v3 offset:13312
  v_cvt_pk_bf16_f32 v109, v90, v91
  v_exp_f32 v94, v94
  v_exp_f32 v95, v95
  v_cvt_pk_bf16_f32 v110, v92, v93
  v_cvt_pk_bf16_f32 v111, v94, v95
  v_mfma_f32_32x32x16_bf16 v[128:143], v[48:51], v[104:107], v[128:143]
  v_exp_f32 v64, v64
  v_exp_f32 v65, v65
  v_exp_f32 v66, v66
  v_exp_f32 v67, v67
  v_mfma_f32_32x32x16_bf16 v[128:143], v[52:55], v[108:111], v[128:143]
  v_cvt_pk_bf16_f32 v96, v64, v65
  v_exp_f32 v68, v68
  v_exp_f32 v69, v69
  v_cvt_pk_bf16_f32 v97, v66, v67
  v_exp_f32 v70, v70
  v_mfma_f32_32x32x16_bf16 v[80:95], v[40:43], v[200:203], 0
  v_exp_f32 v71, v71
  v_cvt_pk_bf16_f32 v98, v68, v69
  v_exp_f32 v72, v72
  v_exp_f32 v73, v73
  v_cvt_pk_bf16_f32 v99, v70, v71
  v_mfma_f32_32x32x16_bf16 v[80:95], v[44:47], v[204:207], v[80:95]
  v_exp_f32 v74, v74
  v_exp_f32 v75, v75
  ds_read_b128 v[48:51], v3 offset:45056
  v_cvt_pk_bf16_f32 v100, v72, v73
  v_exp_f32 v76, v76
  v_exp_f32 v77, v77
  ds_read_b128 v[52:55], v3 offset:46080
  v_cvt_pk_bf16_f32 v101, v74, v75
  v_exp_f32 v78, v78
  s_add_u32 m0, s31, 70656
  s_add_u32 s29, s53, s27
  s_add_u32 s29, s29, 5120
  buffer_load_dwordx4 v2, s[8:11], s29 offen sc1 lds
  v_exp_f32 v79, v79
  v_cvt_pk_bf16_f32 v102, v76, v77
  v_cvt_pk_bf16_f32 v103, v78, v79
  s_waitcnt lgkmcnt(4)
  v_mfma_f32_32x32x16_bf16 v[112:127], v[56:59], v[96:99], v[112:127]
  v_exp_f32 v80, v80
  v_exp_f32 v81, v81
  v_exp_f32 v82, v82
  v_exp_f32 v83, v83
  v_mfma_f32_32x32x16_bf16 v[112:127], v[60:63], v[100:103], v[112:127]
  v_cvt_pk_bf16_f32 v104, v80, v81
  v_exp_f32 v84, v84
  v_exp_f32 v85, v85
  v_cvt_pk_bf16_f32 v105, v82, v83
  v_exp_f32 v86, v86
  s_waitcnt lgkmcnt(2)
  v_mfma_f32_32x32x16_bf16 v[64:79], v[32:35], v[192:195], 0
  v_exp_f32 v87, v87
  v_cvt_pk_bf16_f32 v106, v84, v85
  v_exp_f32 v88, v88
  v_exp_f32 v89, v89
  v_cvt_pk_bf16_f32 v107, v86, v87
  v_mfma_f32_32x32x16_bf16 v[64:79], v[36:39], v[196:199], v[64:79]
  v_exp_f32 v90, v90
  v_exp_f32 v91, v91
  ds_read_b128 v[40:43], v3 offset:14336
  v_cvt_pk_bf16_f32 v108, v88, v89
  v_exp_f32 v92, v92
  v_exp_f32 v93, v93
  ds_read_b128 v[44:47], v3 offset:15360
  v_cvt_pk_bf16_f32 v109, v90, v91
  v_exp_f32 v94, v94
  v_exp_f32 v95, v95
  v_cvt_pk_bf16_f32 v110, v92, v93
  v_cvt_pk_bf16_f32 v111, v94, v95
  v_mfma_f32_32x32x16_bf16 v[128:143], v[56:59], v[104:107], v[128:143]
  v_exp_f32 v64, v64
  v_exp_f32 v65, v65
  v_exp_f32 v66, v66
  v_exp_f32 v67, v67
  v_mfma_f32_32x32x16_bf16 v[128:143], v[60:63], v[108:111], v[128:143]
  v_cvt_pk_bf16_f32 v96, v64, v65
  v_exp_f32 v68, v68
  v_exp_f32 v69, v69
  v_cvt_pk_bf16_f32 v97, v66, v67
  v_exp_f32 v70, v70
  v_mfma_f32_32x32x16_bf16 v[80:95], v[32:35], v[200:203], 0
  v_exp_f32 v71, v71
  v_cvt_pk_bf16_f32 v98, v68, v69
  v_exp_f32 v72, v72
  v_exp_f32 v73, v73
  v_cvt_pk_bf16_f32 v99, v70, v71
  v_mfma_f32_32x32x16_bf16 v[80:95], v[36:39], v[204:207], v[80:95]
  v_exp_f32 v74, v74
  v_exp_f32 v75, v75
  ds_read_b128 v[56:59], v3 offset:47104
  v_cvt_pk_bf16_f32 v100, v72, v73
  v_exp_f32 v76, v76
  v_exp_f32 v77, v77
  ds_read_b128 v[60:63], v3 offset:48128
  v_cvt_pk_bf16_f32 v101, v74, v75
  v_exp_f32 v78, v78
  s_add_u32 m0, s31, 71680
  s_add_u32 s29, s53, s27
  s_add_u32 s29, s29, 6144
  buffer_load_dwordx4 v2, s[8:11], s29 offen sc1 lds
  v_exp_f32 v79, v79
  v_cvt_pk_bf16_f32 v102, v76, v77
  v_cvt_pk_bf16_f32 v103, v78, v79
  s_waitcnt lgkmcnt(4)
  v_mfma_f32_32x32x16_bf16 v[112:127], v[48:51], v[96:99], v[112:127]
  v_exp_f32 v80, v80
  v_exp_f32 v81, v81
  v_exp_f32 v82, v82
  v_exp_f32 v83, v83
  v_mfma_f32_32x32x16_bf16 v[112:127], v[52:55], v[100:103], v[112:127]
  v_cvt_pk_bf16_f32 v104, v80, v81
  v_exp_f32 v84, v84
  v_exp_f32 v85, v85
  v_cvt_pk_bf16_f32 v105, v82, v83
  v_exp_f32 v86, v86
  s_waitcnt lgkmcnt(2)
  v_mfma_f32_32x32x16_bf16 v[64:79], v[40:43], v[192:195], 0
  v_exp_f32 v87, v87
  v_cvt_pk_bf16_f32 v106, v84, v85
  v_exp_f32 v88, v88
  v_exp_f32 v89, v89
  v_cvt_pk_bf16_f32 v107, v86, v87
  v_mfma_f32_32x32x16_bf16 v[64:79], v[44:47], v[196:199], v[64:79]
  v_exp_f32 v90, v90
  v_exp_f32 v91, v91
  ds_read_b128 v[32:35], v3 offset:16384
  v_cvt_pk_bf16_f32 v108, v88, v89
  v_exp_f32 v92, v92
  v_exp_f32 v93, v93
  ds_read_b128 v[36:39], v3 offset:17408
  v_cvt_pk_bf16_f32 v109, v90, v91
  v_exp_f32 v94, v94
  v_exp_f32 v95, v95
  v_cvt_pk_bf16_f32 v110, v92, v93
  v_cvt_pk_bf16_f32 v111, v94, v95
  v_mfma_f32_32x32x16_bf16 v[128:143], v[48:51], v[104:107], v[128:143]
  v_exp_f32 v64, v64
  v_exp_f32 v65, v65
  v_exp_f32 v66, v66
  v_exp_f32 v67, v67
  v_mfma_f32_32x32x16_bf16 v[128:143], v[52:55], v[108:111], v[128:143]
  v_cvt_pk_bf16_f32 v96, v64, v65
  v_exp_f32 v68, v68
  v_exp_f32 v69, v69
  v_cvt_pk_bf16_f32 v97, v66, v67
  v_exp_f32 v70, v70
  v_mfma_f32_32x32x16_bf16 v[80:95], v[40:43], v[200:203], 0
  v_exp_f32 v71, v71
  v_cvt_pk_bf16_f32 v98, v68, v69
  v_exp_f32 v72, v72
  v_exp_f32 v73, v73
  v_cvt_pk_bf16_f32 v99, v70, v71
  v_mfma_f32_32x32x16_bf16 v[80:95], v[44:47], v[204:207], v[80:95]
  v_exp_f32 v74, v74
  v_exp_f32 v75, v75
  ds_read_b128 v[48:51], v3 offset:49152
  v_cvt_pk_bf16_f32 v100, v72, v73
  v_exp_f32 v76, v76
  v_exp_f32 v77, v77
  ds_read_b128 v[52:55], v3 offset:50176
  v_cvt_pk_bf16_f32 v101, v74, v75
  v_exp_f32 v78, v78
  s_add_u32 m0, s31, 72704
  s_add_u32 s29, s53, s27
  s_add_u32 s29, s29, 7168
  buffer_load_dwordx4 v2, s[8:11], s29 offen sc1 lds
  v_exp_f32 v79, v79
  v_cvt_pk_bf16_f32 v102, v76, v77
  v_cvt_pk_bf16_f32 v103, v78, v79
  s_waitcnt lgkmcnt(4)
  v_mfma_f32_32x32x16_bf16 v[112:127], v[56:59], v[96:99], v[112:127]
  v_exp_f32 v80, v80
  v_exp_f32 v81, v81
  v_exp_f32 v82, v82
  v_exp_f32 v83, v83
  v_mfma_f32_32x32x16_bf16 v[112:127], v[60:63], v[100:103], v[112:127]
  v_cvt_pk_bf16_f32 v104, v80, v81
  v_exp_f32 v84, v84
  v_exp_f32 v85, v85
  v_cvt_pk_bf16_f32 v105, v82, v83
  v_exp_f32 v86, v86
  s_waitcnt lgkmcnt(2)
  v_mfma_f32_32x32x16_bf16 v[64:79], v[32:35], v[192:195], 0
  v_exp_f32 v87, v87
  v_cvt_pk_bf16_f32 v106, v84, v85
  v_exp_f32 v88, v88
  v_exp_f32 v89, v89
  v_cvt_pk_bf16_f32 v107, v86, v87
  v_mfma_f32_32x32x16_bf16 v[64:79], v[36:39], v[196:199], v[64:79]
  v_exp_f32 v90, v90
  v_exp_f32 v91, v91
  ds_read_b128 v[40:43], v3 offset:18432
  v_cvt_pk_bf16_f32 v108, v88, v89
  v_exp_f32 v92, v92
  v_exp_f32 v93, v93
  ds_read_b128 v[44:47], v3 offset:19456
  v_cvt_pk_bf16_f32 v109, v90, v91
  v_exp_f32 v94, v94
  v_exp_f32 v95, v95
  v_cvt_pk_bf16_f32 v110, v92, v93
  v_cvt_pk_bf16_f32 v111, v94, v95
  v_mfma_f32_32x32x16_bf16 v[128:143], v[56:59], v[104:107], v[128:143]
  v_exp_f32 v64, v64
  v_exp_f32 v65, v65
  v_exp_f32 v66, v66
  v_exp_f32 v67, v67
  v_mfma_f32_32x32x16_bf16 v[128:143], v[60:63], v[108:111], v[128:143]
  v_cvt_pk_bf16_f32 v96, v64, v65
  v_exp_f32 v68, v68
  v_exp_f32 v69, v69
  v_cvt_pk_bf16_f32 v97, v66, v67
  v_exp_f32 v70, v70
  v_mfma_f32_32x32x16_bf16 v[80:95], v[32:35], v[200:203], 0
  v_exp_f32 v71, v71
  v_cvt_pk_bf16_f32 v98, v68, v69
  v_exp_f32 v72, v72
  v_exp_f32 v73, v73
  v_cvt_pk_bf16_f32 v99, v70, v71
  v_mfma_f32_32x32x16_bf16 v[80:95], v[36:39], v[204:207], v[80:95]
  v_exp_f32 v74, v74
  v_exp_f32 v75, v75
  ds_read_b128 v[56:59], v3 offset:51200
  v_cvt_pk_bf16_f32 v100, v72, v73
  v_exp_f32 v76, v76
  v_exp_f32 v77, v77
  ds_read_b128 v[60:63], v3 offset:52224
  v_cvt_pk_bf16_f32 v101, v74, v75
  v_exp_f32 v78, v78
  s_add_u32 m0, s31, 98304
  s_add_u32 s29, s53, s28
  s_add_u32 s29, s29, 0
  buffer_load_dwordx4 v2, s[8:11], s29 offen sc1 lds
  v_exp_f32 v79, v79
  v_cvt_pk_bf16_f32 v102, v76, v77
  v_cvt_pk_bf16_f32 v103, v78, v79
  s_waitcnt lgkmcnt(4)
  v_mfma_f32_32x32x16_bf16 v[112:127], v[48:51], v[96:99], v[112:127]
  v_exp_f32 v80, v80
  v_exp_f32 v81, v81
  v_exp_f32 v82, v82
  v_exp_f32 v83, v83
  v_mfma_f32_32x32x16_bf16 v[112:127], v[52:55], v[100:103], v[112:127]
  v_cvt_pk_bf16_f32 v104, v80, v81
  v_exp_f32 v84, v84
  v_exp_f32 v85, v85
  v_cvt_pk_bf16_f32 v105, v82, v83
  v_exp_f32 v86, v86
  s_waitcnt lgkmcnt(2)
  v_mfma_f32_32x32x16_bf16 v[64:79], v[40:43], v[192:195], 0
  v_exp_f32 v87, v87
  v_cvt_pk_bf16_f32 v106, v84, v85
  v_exp_f32 v88, v88
  v_exp_f32 v89, v89
  v_cvt_pk_bf16_f32 v107, v86, v87
  v_mfma_f32_32x32x16_bf16 v[64:79], v[44:47], v[196:199], v[64:79]
  v_exp_f32 v90, v90
  v_exp_f32 v91, v91
  ds_read_b128 v[32:35], v3 offset:20480
  v_cvt_pk_bf16_f32 v108, v88, v89
  v_exp_f32 v92, v92
  v_exp_f32 v93, v93
  ds_read_b128 v[36:39], v3 offset:21504
  v_cvt_pk_bf16_f32 v109, v90, v91
  v_exp_f32 v94, v94
  v_exp_f32 v95, v95
  v_cvt_pk_bf16_f32 v110, v92, v93
  v_cvt_pk_bf16_f32 v111, v94, v95
  v_mfma_f32_32x32x16_bf16 v[128:143], v[48:51], v[104:107], v[128:143]
  v_exp_f32 v64, v64
  v_exp_f32 v65, v65
  v_exp_f32 v66, v66
  v_exp_f32 v67, v67
  v_mfma_f32_32x32x16_bf16 v[128:143], v[52:55], v[108:111], v[128:143]
  v_cvt_pk_bf16_f32 v96, v64, v65
  v_exp_f32 v68, v68
  v_exp_f32 v69, v69
  v_cvt_pk_bf16_f32 v97, v66, v67
  v_exp_f32 v70, v70
  v_mfma_f32_32x32x16_bf16 v[80:95], v[40:43], v[200:203], 0
  v_exp_f32 v71, v71
  v_cvt_pk_bf16_f32 v98, v68, v69
  v_exp_f32 v72, v72
  v_exp_f32 v73, v73
  v_cvt_pk_bf16_f32 v99, v70, v71
  v_mfma_f32_32x32x16_bf16 v[80:95], v[44:47], v[204:207], v[80:95]
  v_exp_f32 v74, v74
  v_exp_f32 v75, v75
  ds_read_b128 v[48:51], v3 offset:53248
  v_cvt_pk_bf16_f32 v100, v72, v73
  v_exp_f32 v76, v76
  v_exp_f32 v77, v77
  ds_read_b128 v[52:55], v3 offset:54272
  v_cvt_pk_bf16_f32 v101, v74, v75
  v_exp_f32 v78, v78
  s_add_u32 m0, s31, 99328
  s_add_u32 s29, s53, s28
  s_add_u32 s29, s29, 1024
  buffer_load_dwordx4 v2, s[8:11], s29 offen sc1 lds
  v_exp_f32 v79, v79
  v_cvt_pk_bf16_f32 v102, v76, v77
  v_cvt_pk_bf16_f32 v103, v78, v79
  s_waitcnt lgkmcnt(4)
  v_mfma_f32_32x32x16_bf16 v[112:127], v[56:59], v[96:99], v[112:127]
  v_exp_f32 v80, v80
  v_exp_f32 v81, v81
  v_exp_f32 v82, v82
  v_exp_f32 v83, v83
  v_mfma_f32_32x32x16_bf16 v[112:127], v[60:63], v[100:103], v[112:127]
  v_cvt_pk_bf16_f32 v104, v80, v81
  v_exp_f32 v84, v84
  v_exp_f32 v85, v85
  v_cvt_pk_bf16_f32 v105, v82, v83
  v_exp_f32 v86, v86
  s_waitcnt lgkmcnt(2)
  v_mfma_f32_32x32x16_bf16 v[64:79], v[32:35], v[192:195], 0
  v_exp_f32 v87, v87
  v_cvt_pk_bf16_f32 v106, v84, v85
  v_exp_f32 v88, v88
  v_exp_f32 v89, v89
  v_cvt_pk_bf16_f32 v107, v86, v87
  v_mfma_f32_32x32x16_bf16 v[64:79], v[36:39], v[196:199], v[64:79]
  v_exp_f32 v90, v90
  v_exp_f32 v91, v91
  ds_read_b128 v[40:43], v3 offset:22528
  v_cvt_pk_bf16_f32 v108, v88, v89
  v_exp_f32 v92, v92
  v_exp_f32 v93, v93
  ds_read_b128 v[44:47], v3 offset:23552
  v_cvt_pk_bf16_f32 v109, v90, v91
  v_exp_f32 v94, v94
  v_exp_f32 v95, v95
  v_cvt_pk_bf16_f32 v110, v92, v93
  v_cvt_pk_bf16_f32 v111, v94, v95
  v_mfma_f32_32x32x16_bf16 v[128:143], v[56:59], v[104:107], v[128:143]
  v_exp_f32 v64, v64
  v_exp_f32 v65, v65
  v_exp_f32 v66, v66
  v_exp_f32 v67, v67
  v_mfma_f32_32x32x16_bf16 v[128:143], v[60:63], v[108:111], v[128:143]
  v_cvt_pk_bf16_f32 v96, v64, v65
  v_exp_f32 v68, v68
  v_exp_f32 v69, v69
  v_cvt_pk_bf16_f32 v97, v66, v67
  v_exp_f32 v70, v70
  v_mfma_f32_32x32x16_bf16 v[80:95], v[32:35], v[200:203], 0
  v_exp_f32 v71, v71
  v_cvt_pk_bf16_f32 v98, v68, v69
  v_exp_f32 v72, v72
  v_exp_f32 v73, v73
  v_cvt_pk_bf16_f32 v99, v70, v71
  v_mfma_f32_32x32x16_bf16 v[80:95], v[36:39], v[204:207], v[80:95]
  v_exp_f32 v74, v74
  v_exp_f32 v75, v75
  ds_read_b128 v[56:59], v3 offset:55296
  v_cvt_pk_bf16_f32 v100, v72, v73
  v_exp_f32 v76, v76
  v_exp_f32 v77, v77
  ds_read_b128 v[60:63], v3 offset:56320
  v_cvt_pk_bf16_f32 v101, v74, v75
  v_exp_f32 v78, v78
  s_add_u32 m0, s31, 100352
  s_add_u32 s29, s53, s28
  s_add_u32 s29, s29, 2048
  buffer_load_dwordx4 v2, s[8:11], s29 offen sc1 lds
  v_exp_f32 v79, v79
  v_cvt_pk_bf16_f32 v102, v76, v77
  v_cvt_pk_bf16_f32 v103, v78, v79
  s_waitcnt lgkmcnt(4)
  v_mfma_f32_32x32x16_bf16 v[112:127], v[48:51], v[96:99], v[112:127]
  v_exp_f32 v80, v80
  v_exp_f32 v81, v81
  v_exp_f32 v82, v82
  v_exp_f32 v83, v83
  v_mfma_f32_32x32x16_bf16 v[112:127], v[52:55], v[100:103], v[112:127]
  v_cvt_pk_bf16_f32 v104, v80, v81
  v_exp_f32 v84, v84
  v_exp_f32 v85, v85
  v_cvt_pk_bf16_f32 v105, v82, v83
  v_exp_f32 v86, v86
  s_waitcnt lgkmcnt(2)
  v_mfma_f32_32x32x16_bf16 v[64:79], v[40:43], v[192:195], 0
  v_exp_f32 v87, v87
  v_cvt_pk_bf16_f32 v106, v84, v85
  v_exp_f32 v88, v88
  v_exp_f32 v89, v89
  v_cvt_pk_bf16_f32 v107, v86, v87
  v_mfma_f32_32x32x16_bf16 v[64:79], v[44:47], v[196:199], v[64:79]
  v_exp_f32 v90, v90
  v_exp_f32 v91, v91
  ds_read_b128 v[32:35], v3 offset:24576
  v_cvt_pk_bf16_f32 v108, v88, v89
  v_exp_f32 v92, v92
  v_exp_f32 v93, v93
  ds_read_b128 v[36:39], v3 offset:25600
  v_cvt_pk_bf16_f32 v109, v90, v91
  v_exp_f32 v94, v94
  v_exp_f32 v95, v95
  v_cvt_pk_bf16_f32 v110, v92, v93
  v_cvt_pk_bf16_f32 v111, v94, v95
  v_mfma_f32_32x32x16_bf16 v[128:143], v[48:51], v[104:107], v[128:143]
  v_exp_f32 v64, v64
  v_exp_f32 v65, v65
  v_exp_f32 v66, v66
  v_exp_f32 v67, v67
  v_mfma_f32_32x32x16_bf16 v[128:143], v[52:55], v[108:111], v[128:143]
  v_cvt_pk_bf16_f32 v96, v64, v65
  v_exp_f32 v68, v68
  v_exp_f32 v69, v69
  v_cvt_pk_bf16_f32 v97, v66, v67
  v_exp_f32 v70, v70
  v_mfma_f32_32x32x16_bf16 v[80:95], v[40:43], v[200:203], 0
  v_exp_f32 v71, v71
  v_cvt_pk_bf16_f32 v98, v68, v69
  v_exp_f32 v72, v72
  v_exp_f32 v73, v73
  v_cvt_pk_bf16_f32 v99, v70, v71
  v_mfma_f32_32x32x16_bf16 v[80:95], v[44:47], v[204:207], v[80:95]
  v_exp_f32 v74, v74
  v_exp_f32 v75, v75
  ds_read_b128 v[48:51], v3 offset:57344
  v_cvt_pk_bf16_f32 v100, v72, v73
  v_exp_f32 v76, v76
  v_exp_f32 v77, v77
  ds_read_b128 v[52:55], v3 offset:58368
  v_cvt_pk_bf16_f32 v101, v74, v75
  v_exp_f32 v78, v78
  s_add_u32 m0, s31, 101376
  s_add_u32 s29, s53, s28
  s_add_u32 s29, s29, 3072
  buffer_load_dwordx4 v2, s[8:11], s29 offen sc1 lds
  v_exp_f32 v79, v79
  v_cvt_pk_bf16_f32 v102, v76, v77
  v_cvt_pk_bf16_f32 v103, v78, v79
  s_waitcnt lgkmcnt(4)
  v_mfma_f32_32x32x16_bf16 v[112:127], v[56:59], v[96:99], v[112:127]
  v_exp_f32 v80, v80
  v_exp_f32 v81, v81
  v_exp_f32 v82, v82
  v_exp_f32 v83, v83
  v_mfma_f32_32x32x16_bf16 v[112:127], v[60:63], v[100:103], v[112:127]
  v_cvt_pk_bf16_f32 v104, v80, v81
  v_exp_f32 v84, v84
  v_exp_f32 v85, v85
  v_cvt_pk_bf16_f32 v105, v82, v83
  v_exp_f32 v86, v86
  s_waitcnt lgkmcnt(2)
  v_mfma_f32_32x32x16_bf16 v[64:79], v[32:35], v[192:195], 0
  v_exp_f32 v87, v87
  v_cvt_pk_bf16_f32 v106, v84, v85
  v_exp_f32 v88, v88
  v_exp_f32 v89, v89
  v_cvt_pk_bf16_f32 v107, v86, v87
  v_mfma_f32_32x32x16_bf16 v[64:79], v[36:39], v[196:199], v[64:79]
  v_exp_f32 v90, v90
  v_exp_f32 v91, v91
  ds_read_b128 v[40:43], v3 offset:26624
  v_cvt_pk_bf16_f32 v108, v88, v89
  v_exp_f32 v92, v92
  v_exp_f32 v93, v93
  ds_read_b128 v[44:47], v3 offset:27648
  v_cvt_pk_bf16_f32 v109, v90, v91
  v_exp_f32 v94, v94
  v_exp_f32 v95, v95
  v_cvt_pk_bf16_f32 v110, v92, v93
  v_cvt_pk_bf16_f32 v111, v94, v95
  v_mfma_f32_32x32x16_bf16 v[128:143], v[56:59], v[104:107], v[128:143]
  v_exp_f32 v64, v64
  v_exp_f32 v65, v65
  v_exp_f32 v66, v66
  v_exp_f32 v67, v67
  v_mfma_f32_32x32x16_bf16 v[128:143], v[60:63], v[108:111], v[128:143]
  v_cvt_pk_bf16_f32 v96, v64, v65
  v_exp_f32 v68, v68
  v_exp_f32 v69, v69
  v_cvt_pk_bf16_f32 v97, v66, v67
  v_exp_f32 v70, v70
  v_mfma_f32_32x32x16_bf16 v[80:95], v[32:35], v[200:203], 0
  v_exp_f32 v71, v71
  v_cvt_pk_bf16_f32 v98, v68, v69
  v_exp_f32 v72, v72
  v_exp_f32 v73, v73
  v_cvt_pk_bf16_f32 v99, v70, v71
  v_mfma_f32_32x32x16_bf16 v[80:95], v[36:39], v[204:207], v[80:95]
  v_exp_f32 v74, v74
  v_exp_f32 v75, v75
  ds_read_b128 v[56:59], v3 offset:59392
  v_cvt_pk_bf16_f32 v100, v72, v73
  v_exp_f32 v76, v76
  v_exp_f32 v77, v77
  ds_read_b128 v[60:63], v3 offset:60416
  v_cvt_pk_bf16_f32 v101, v74, v75
  v_exp_f32 v78, v78
  s_add_u32 m0, s31, 102400
  s_add_u32 s29, s53, s28
  s_add_u32 s29, s29, 4096
  buffer_load_dwordx4 v2, s[8:11], s29 offen sc1 lds
  v_exp_f32 v79, v79
  v_cvt_pk_bf16_f32 v102, v76, v77
  v_cvt_pk_bf16_f32 v103, v78, v79
  s_waitcnt lgkmcnt(4)
  v_mfma_f32_32x32x16_bf16 v[112:127], v[48:51], v[96:99], v[112:127]
  v_exp_f32 v80, v80
  v_exp_f32 v81, v81
  v_exp_f32 v82, v82
  v_exp_f32 v83, v83
  v_mfma_f32_32x32x16_bf16 v[112:127], v[52:55], v[100:103], v[112:127]
  v_cvt_pk_bf16_f32 v104, v80, v81
  v_exp_f32 v84, v84
  v_exp_f32 v85, v85
  v_cvt_pk_bf16_f32 v105, v82, v83
  v_exp_f32 v86, v86
  s_waitcnt lgkmcnt(2)
  v_mfma_f32_32x32x16_bf16 v[64:79], v[40:43], v[192:195], 0
  v_exp_f32 v87, v87
  v_cvt_pk_bf16_f32 v106, v84, v85
  v_exp_f32 v88, v88
  v_exp_f32 v89, v89
  v_cvt_pk_bf16_f32 v107, v86, v87
  v_mfma_f32_32x32x16_bf16 v[64:79], v[44:47], v[196:199], v[64:79]
  v_exp_f32 v90, v90
  v_exp_f32 v91, v91
  ds_read_b128 v[32:35], v3 offset:28672
  v_cvt_pk_bf16_f32 v108, v88, v89
  v_exp_f32 v92, v92
  v_exp_f32 v93, v93
  ds_read_b128 v[36:39], v3 offset:29696
  v_cvt_pk_bf16_f32 v109, v90, v91
  v_exp_f32 v94, v94
  v_exp_f32 v95, v95
  v_cvt_pk_bf16_f32 v110, v92, v93
  v_cvt_pk_bf16_f32 v111, v94, v95
  v_mfma_f32_32x32x16_bf16 v[128:143], v[48:51], v[104:107], v[128:143]
  v_exp_f32 v64, v64
  v_exp_f32 v65, v65
  v_exp_f32 v66, v66
  v_exp_f32 v67, v67
  v_mfma_f32_32x32x16_bf16 v[128:143], v[52:55], v[108:111], v[128:143]
  v_cvt_pk_bf16_f32 v96, v64, v65
  v_exp_f32 v68, v68
  v_exp_f32 v69, v69
  v_cvt_pk_bf16_f32 v97, v66, v67
  v_exp_f32 v70, v70
  v_mfma_f32_32x32x16_bf16 v[80:95], v[40:43], v[200:203], 0
  v_exp_f32 v71, v71
  v_cvt_pk_bf16_f32 v98, v68, v69
  v_exp_f32 v72, v72
  v_exp_f32 v73, v73
  v_cvt_pk_bf16_f32 v99, v70, v71
  v_mfma_f32_32x32x16_bf16 v[80:95], v[44:47], v[204:207], v[80:95]
  v_exp_f32 v74, v74
  v_exp_f32 v75, v75
  ds_read_b128 v[48:51], v3 offset:61440
  v_cvt_pk_bf16_f32 v100, v72, v73
  v_exp_f32 v76, v76
  v_exp_f32 v77, v77
  ds_read_b128 v[52:55], v3 offset:62464
  v_cvt_pk_bf16_f32 v101, v74, v75
  v_exp_f32 v78, v78
  s_add_u32 m0, s31, 103424
  s_add_u32 s29, s53, s28
  s_add_u32 s29, s29, 5120
  buffer_load_dwordx4 v2, s[8:11], s29 offen sc1 lds
  v_exp_f32 v79, v79
  v_cvt_pk_bf16_f32 v102, v76, v77
  v_cvt_pk_bf16_f32 v103, v78, v79
  s_waitcnt lgkmcnt(4)
  v_mfma_f32_32x32x16_bf16 v[112:127], v[56:59], v[96:99], v[112:127]
  v_exp_f32 v80, v80
  v_exp_f32 v81, v81
  v_exp_f32 v82, v82
  v_exp_f32 v83, v83
  v_mfma_f32_32x32x16_bf16 v[112:127], v[60:63], v[100:103], v[112:127]
  v_cvt_pk_bf16_f32 v104, v80, v81
  v_exp_f32 v84, v84
  v_exp_f32 v85, v85
  v_cvt_pk_bf16_f32 v105, v82, v83
  v_exp_f32 v86, v86
  s_waitcnt lgkmcnt(2)
  v_mfma_f32_32x32x16_bf16 v[64:79], v[32:35], v[192:195], 0
  v_exp_f32 v87, v87
  v_cvt_pk_bf16_f32 v106, v84, v85
  v_exp_f32 v88, v88
  v_exp_f32 v89, v89
  v_cvt_pk_bf16_f32 v107, v86, v87
  v_mfma_f32_32x32x16_bf16 v[64:79], v[36:39], v[196:199], v[64:79]
  v_exp_f32 v90, v90
  v_exp_f32 v91, v91
  ds_read_b128 v[40:43], v3 offset:30720
  v_cvt_pk_bf16_f32 v108, v88, v89
  v_exp_f32 v92, v92
  v_exp_f32 v93, v93
  ds_read_b128 v[44:47], v3 offset:31744
  v_cvt_pk_bf16_f32 v109, v90, v91
  v_exp_f32 v94, v94
  v_exp_f32 v95, v95
  v_cvt_pk_bf16_f32 v110, v92, v93
  v_cvt_pk_bf16_f32 v111, v94, v95
  v_mfma_f32_32x32x16_bf16 v[128:143], v[56:59], v[104:107], v[128:143]
  v_exp_f32 v64, v64
  v_exp_f32 v65, v65
  v_exp_f32 v66, v66
  v_exp_f32 v67, v67
  v_mfma_f32_32x32x16_bf16 v[128:143], v[60:63], v[108:111], v[128:143]
  v_cvt_pk_bf16_f32 v96, v64, v65
  v_exp_f32 v68, v68
  v_exp_f32 v69, v69
  v_cvt_pk_bf16_f32 v97, v66, v67
  v_exp_f32 v70, v70
  v_mfma_f32_32x32x16_bf16 v[80:95], v[32:35], v[200:203], 0
  v_exp_f32 v71, v71
  v_cvt_pk_bf16_f32 v98, v68, v69
  v_exp_f32 v72, v72
  v_exp_f32 v73, v73
  v_cvt_pk_bf16_f32 v99, v70, v71
  v_mfma_f32_32x32x16_bf16 v[80:95], v[36:39], v[204:207], v[80:95]
  v_exp_f32 v74, v74
  v_exp_f32 v75, v75
  ds_read_b128 v[56:59], v3 offset:63488
  v_cvt_pk_bf16_f32 v100, v72, v73
  v_exp_f32 v76, v76
  v_exp_f32 v77, v77
  ds_read_b128 v[60:63], v3 offset:64512
  v_cvt_pk_bf16_f32 v101, v74, v75
  v_exp_f32 v78, v78
  s_add_u32 m0, s31, 104448
  s_add_u32 s29, s53, s28
  s_add_u32 s29, s29, 6144
  buffer_load_dwordx4 v2, s[8:11], s29 offen sc1 lds
  v_exp_f32 v79, v79
  v_cvt_pk_bf16_f32 v102, v76, v77
  v_cvt_pk_bf16_f32 v103, v78, v79
  s_waitcnt lgkmcnt(4)
  v_mfma_f32_32x32x16_bf16 v[112:127], v[48:51], v[96:99], v[112:127]
  v_exp_f32 v80, v80
  v_exp_f32 v81, v81
  v_exp_f32 v82, v82
  v_exp_f32 v83, v83
  v_mfma_f32_32x32x16_bf16 v[112:127], v[52:55], v[100:103], v[112:127]
  v_cvt_pk_bf16_f32 v104, v80, v81
  v_exp_f32 v84, v84
  v_exp_f32 v85, v85
  v_cvt_pk_bf16_f32 v105, v82, v83
  v_exp_f32 v86, v86
  s_waitcnt lgkmcnt(2)
  v_mfma_f32_32x32x16_bf16 v[64:79], v[40:43], v[192:195], 0
  v_exp_f32 v87, v87
  v_cvt_pk_bf16_f32 v106, v84, v85
  v_exp_f32 v88, v88
  v_exp_f32 v89, v89
  v_cvt_pk_bf16_f32 v107, v86, v87
  v_mfma_f32_32x32x16_bf16 v[64:79], v[44:47], v[196:199], v[64:79]
  v_exp_f32 v90, v90
  v_exp_f32 v91, v91
  v_cvt_pk_bf16_f32 v108, v88, v89
  v_exp_f32 v92, v92
  v_exp_f32 v93, v93
  v_cvt_pk_bf16_f32 v109, v90, v91
  v_exp_f32 v94, v94
  v_exp_f32 v95, v95
  v_cvt_pk_bf16_f32 v110, v92, v93
  v_cvt_pk_bf16_f32 v111, v94, v95
  v_mfma_f32_32x32x16_bf16 v[128:143], v[48:51], v[104:107], v[128:143]
  v_exp_f32 v64, v64
  v_exp_f32 v65, v65
  v_exp_f32 v66, v66
  v_exp_f32 v67, v67
  v_mfma_f32_32x32x16_bf16 v[128:143], v[52:55], v[108:111], v[128:143]
  v_cvt_pk_bf16_f32 v96, v64, v65
  v_exp_f32 v68, v68
  v_exp_f32 v69, v69
  v_cvt_pk_bf16_f32 v97, v66, v67
  v_exp_f32 v70, v70
  v_mfma_f32_32x32x16_bf16 v[80:95], v[40:43], v[200:203], 0
  v_exp_f32 v71, v71
  v_cvt_pk_bf16_f32 v98, v68, v69
  v_exp_f32 v72, v72
  v_exp_f32 v73, v73
  v_cvt_pk_bf16_f32 v99, v70, v71
  v_mfma_f32_32x32x16_bf16 v[80:95], v[44:47], v[204:207], v[80:95]
  v_exp_f32 v74, v74
  v_exp_f32 v75, v75
  v_cvt_pk_bf16_f32 v100, v72, v73
  v_exp_f32 v76, v76
  v_exp_f32 v77, v77
  v_cvt_pk_bf16_f32 v101, v74, v75
  v_exp_f32 v78, v78
  s_add_u32 m0, s31, 105472
  s_add_u32 s29, s53, s28
  s_add_u32 s29, s29, 7168
  buffer_load_dwordx4 v2, s[8:11], s29 offen sc1 lds
  v_exp_f32 v79, v79
  v_cvt_pk_bf16_f32 v102, v76, v77
  v_cvt_pk_bf16_f32 v103, v78, v79
  s_waitcnt lgkmcnt(0)
  v_mfma_f32_32x32x16_bf16 v[112:127], v[56:59], v[96:99], v[112:127]
  v_exp_f32 v80, v80
  v_exp_f32 v81, v81
  v_exp_f32 v82, v82
  v_exp_f32 v83, v83
  v_mfma_f32_32x32x16_bf16 v[112:127], v[60:63], v[100:103], v[112:127]
  v_cvt_pk_bf16_f32 v104, v80, v81
  v_exp_f32 v84, v84
  v_exp_f32 v85, v85
  v_cvt_pk_bf16_f32 v105, v82, v83
  v_exp_f32 v86, v86
  v_exp_f32 v87, v87
  v_cvt_pk_bf16_f32 v106, v84, v85
  v_exp_f32 v88, v88
  v_exp_f32 v89, v89
  v_cvt_pk_bf16_f32 v107, v86, v87
  v_exp_f32 v90, v90
  v_exp_f32 v91, v91
  v_cvt_pk_bf16_f32 v108, v88, v89
  v_exp_f32 v92, v92
  v_exp_f32 v93, v93
  v_cvt_pk_bf16_f32 v109, v90, v91
  v_exp_f32 v94, v94
  v_exp_f32 v95, v95
  v_cvt_pk_bf16_f32 v110, v92, v93
  v_cvt_pk_bf16_f32 v111, v94, v95
  s_nop 1
  v_mfma_f32_32x32x16_bf16 v[128:143], v[56:59], v[104:107], v[128:143]
  v_mfma_f32_32x32x16_bf16 v[128:143], v[60:63], v[108:111], v[128:143]
  s_waitcnt vmcnt(0)
  s_barrier
  s_add_u32 s41, s41, 1
  s_min_u32 s29, s41, 3
  s_mul_i32 s53, s29, 32768
  s_lshl_b32 s31, s21, 13
  s_add_u32 s53, s53, s31
  ds_read_b128 v[32:35], v4 offset:0
  ds_read_b128 v[36:39], v4 offset:1024
  ds_read_b128 v[48:51], v4 offset:32768
  ds_read_b128 v[52:55], v4 offset:33792
  ds_read_b128 v[40:43], v4 offset:2048
  ds_read_b128 v[44:47], v4 offset:3072
  s_waitcnt lgkmcnt(4)
  v_mfma_f32_32x32x16_bf16 v[64:79], v[32:35], v[192:195], 0
  v_mfma_f32_32x32x16_bf16 v[64:79], v[36:39], v[196:199], v[64:79]
  s_nop 11
  v_exp_f32 v64, v64
  v_exp_f32 v65, v65
  v_exp_f32 v66, v66
  v_exp_f32 v67, v67
  v_cvt_pk_bf16_f32 v96, v64, v65
  v_exp_f32 v68, v68
  v_exp_f32 v69, v69
  v_cvt_pk_bf16_f32 v97, v66, v67
  v_exp_f32 v70, v70
  v_mfma_f32_32x32x16_bf16 v[80:95], v[32:35], v[200:203], 0
  v_exp_f32 v71, v71
  v_cvt_pk_bf16_f32 v98, v68, v69
  v_exp_f32 v72, v72
  v_exp_f32 v73, v73
  v_cvt_pk_bf16_f32 v99, v70, v71
  v_mfma_f32_32x32x16_bf16 v[80:95], v[36:39], v[204:207], v[80:95]
  v_exp_f32 v74, v74
  v_exp_f32 v75, v75
  ds_read_b128 v[56:59], v4 offset:34816
  v_cvt_pk_bf16_f32 v100, v72, v73
  v_exp_f32 v76, v76
  v_exp_f32 v77, v77
  ds_read_b128 v[60:63], v4 offset:35840
  v_cvt_pk_bf16_f32 v101, v74, v75
  v_exp_f32 v78, v78
  s_add_u32 m0, s31, 0
  s_add_u32 s29, s53, s27
  s_add_u32 s29, s29, 0
  buffer_load_dwordx4 v2, s[8:11], s29 offen sc1 lds
  v_exp_f32 v79, v79
  v_cvt_pk_bf16_f32 v102, v76, v77
  v_cvt_pk_bf16_f32 v103, v78, v79
  s_waitcnt lgkmcnt(4)
  v_mfma_f32_32x32x16_bf16 v[112:127], v[48:51], v[96:99], v[112:127]
  v_exp_f32 v80, v80
  v_exp_f32 v81, v81
  v_exp_f32 v82, v82
  v_exp_f32 v83, v83
  v_mfma_f32_32x32x16_bf16 v[112:127], v[52:55], v[100:103], v[112:127]
  v_cvt_pk_bf16_f32 v104, v80, v81
  v_exp_f32 v84, v84
  v_exp_f32 v85, v85
  v_cvt_pk_bf16_f32 v105, v82, v83
  v_exp_f32 v86, v86
  s_waitcnt lgkmcnt(2)
  v_mfma_f32_32x32x16_bf16 v[64:79], v[40:43], v[192:195], 0
  v_exp_f32 v87, v87
  v_cvt_pk_bf16_f32 v106, v84, v85
  v_exp_f32 v88, v88
  v_exp_f32 v89, v89
  v_cvt_pk_bf16_f32 v107, v86, v87
  v_mfma_f32_32x32x16_bf16 v[64:79], v[44:47], v[196:199], v[64:79]
  v_exp_f32 v90, v90
  v_exp_f32 v91, v91
  ds_read_b128 v[32:35], v4 offset:4096
  v_cvt_pk_bf16_f32 v108, v88, v89
  v_exp_f32 v92, v92
  v_exp_f32 v93, v93
  ds_read_b128 v[36:39], v4 offset:5120
  v_cvt_pk_bf16_f32 v109, v90, v91
  v_exp_f32 v94, v94
  v_exp_f32 v95, v95
  v_cvt_pk_bf16_f32 v110, v92, v93
  v_cvt_pk_bf16_f32 v111, v94, v95
  v_mfma_f32_32x32x16_bf16 v[128:143], v[48:51], v[104:107], v[128:143]
  v_exp_f32 v64, v64
  v_exp_f32 v65, v65
  v_exp_f32 v66, v66
  v_exp_f32 v67, v67
  v_mfma_f32_32x32x16_bf16 v[128:143], v[52:55], v[108:111], v[128:143]
  v_cvt_pk_bf16_f32 v96, v64, v65
  v_exp_f32 v68, v68
  v_exp_f32 v69, v69
  v_cvt_pk_bf16_f32 v97, v66, v67
  v_exp_f32 v70, v70
  v_mfma_f32_32x32x16_bf16 v[80:95], v[40:43], v[200:203], 0
  v_exp_f32 v71, v71
  v_cvt_pk_bf16_f32 v98, v68, v69
  v_exp_f32 v72, v72
  v_exp_f32 v73, v73
  v_cvt_pk_bf16_f32 v99, v70, v71
  v_mfma_f32_32x32x16_bf16 v[80:95], v[44:47], v[204:207], v[80:95]
  v_exp_f32 v74, v74
  v_exp_f32 v75, v75
  ds_read_b128 v[48:51], v4 offset:36864
  v_cvt_pk_bf16_f32 v100, v72, v73
  v_exp_f32 v76, v76
  v_exp_f32 v77, v77
  ds_read_b128 v[52:55], v4 offset:37888
  v_cvt_pk_bf16_f32 v101, v74, v75
  v_exp_f32 v78, v78
  s_add_u32 m0, s31, 1024
  s_add_u32 s29, s53, s27
  s_add_u32 s29, s29, 1024
  buffer_load_dwordx4 v2, s[8:11], s29 offen sc1 lds
  v_exp_f32 v79, v79
  v_cvt_pk_bf16_f32 v102, v76, v77
  v_cvt_pk_bf16_f32 v103, v78, v79
  s_waitcnt lgkmcnt(4)
  v_mfma_f32_32x32x16_bf16 v[112:127], v[56:59], v[96:99], v[112:127]
  v_exp_f32 v80, v80
  v_exp_f32 v81, v81
  v_exp_f32 v82, v82
  v_exp_f32 v83, v83
  v_mfma_f32_32x32x16_bf16 v[112:127], v[60:63], v[100:103], v[112:127]
  v_cvt_pk_bf16_f32 v104, v80, v81
  v_exp_f32 v84, v84
  v_exp_f32 v85, v85
  v_cvt_pk_bf16_f32 v105, v82, v83
  v_exp_f32 v86, v86
  s_waitcnt lgkmcnt(2)
  v_mfma_f32_32x32x16_bf16 v[64:79], v[32:35], v[192:195], 0
  v_exp_f32 v87, v87
  v_cvt_pk_bf16_f32 v106, v84, v85
  v_exp_f32 v88, v88
  v_exp_f32 v89, v89
  v_cvt_pk_bf16_f32 v107, v86, v87
  v_mfma_f32_32x32x16_bf16 v[64:79], v[36:39], v[196:199], v[64:79]
  v_exp_f32 v90, v90
  v_exp_f32 v91, v91
  ds_read_b128 v[40:43], v4 offset:6144
  v_cvt_pk_bf16_f32 v108, v88, v89
  v_exp_f32 v92, v92
  v_exp_f32 v93, v93
  ds_read_b128 v[44:47], v4 offset:7168
  v_cvt_pk_bf16_f32 v109, v90, v91
  v_exp_f32 v94, v94
  v_exp_f32 v95, v95
  v_cvt_pk_bf16_f32 v110, v92, v93
  v_cvt_pk_bf16_f32 v111, v94, v95
  v_mfma_f32_32x32x16_bf16 v[128:143], v[56:59], v[104:107], v[128:143]
  v_exp_f32 v64, v64
  v_exp_f32 v65, v65
  v_exp_f32 v66, v66
  v_exp_f32 v67, v67
  v_mfma_f32_32x32x16_bf16 v[128:143], v[60:63], v[108:111], v[128:143]
  v_cvt_pk_bf16_f32 v96, v64, v65
  v_exp_f32 v68, v68
  v_exp_f32 v69, v69
  v_cvt_pk_bf16_f32 v97, v66, v67
  v_exp_f32 v70, v70
  v_mfma_f32_32x32x16_bf16 v[80:95], v[32:35], v[200:203], 0
  v_exp_f32 v71, v71
  v_cvt_pk_bf16_f32 v98, v68, v69
  v_exp_f32 v72, v72
  v_exp_f32 v73, v73
  v_cvt_pk_bf16_f32 v99, v70, v71
  v_mfma_f32_32x32x16_bf16 v[80:95], v[36:39], v[204:207], v[80:95]
  v_exp_f32 v74, v74
  v_exp_f32 v75, v75
  ds_read_b128 v[56:59], v4 offset:38912
  v_cvt_pk_bf16_f32 v100, v72, v73
  v_exp_f32 v76, v76
  v_exp_f32 v77, v77
  ds_read_b128 v[60:63], v4 offset:39936
  v_cvt_pk_bf16_f32 v101, v74, v75
  v_exp_f32 v78, v78
  s_add_u32 m0, s31, 2048
  s_add_u32 s29, s53, s27
  s_add_u32 s29, s29, 2048
  buffer_load_dwordx4 v2, s[8:11], s29 offen sc1 lds
  v_exp_f32 v79, v79
  v_cvt_pk_bf16_f32 v102, v76, v77
  v_cvt_pk_bf16_f32 v103, v78, v79
  s_waitcnt lgkmcnt(4)
  v_mfma_f32_32x32x16_bf16 v[112:127], v[48:51], v[96:99], v[112:127]
  v_exp_f32 v80, v80
  v_exp_f32 v81, v81
  v_exp_f32 v82, v82
  v_exp_f32 v83, v83
  v_mfma_f32_32x32x16_bf16 v[112:127], v[52:55], v[100:103], v[112:127]
  v_cvt_pk_bf16_f32 v104, v80, v81
  v_exp_f32 v84, v84
  v_exp_f32 v85, v85
  v_cvt_pk_bf16_f32 v105, v82, v83
  v_exp_f32 v86, v86
  s_waitcnt lgkmcnt(2)
  v_mfma_f32_32x32x16_bf16 v[64:79], v[40:43], v[192:195], 0
  v_exp_f32 v87, v87
  v_cvt_pk_bf16_f32 v106, v84, v85
  v_exp_f32 v88, v88
  v_exp_f32 v89, v89
  v_cvt_pk_bf16_f32 v107, v86, v87
  v_mfma_f32_32x32x16_bf16 v[64:79], v[44:47], v[196:199], v[64:79]
  v_exp_f32 v90, v90
  v_exp_f32 v91, v91
  ds_read_b128 v[32:35], v4 offset:8192
  v_cvt_pk_bf16_f32 v108, v88, v89
  v_exp_f32 v92, v92
  v_exp_f32 v93, v93
  ds_read_b128 v[36:39], v4 offset:9216
  v_cvt_pk_bf16_f32 v109, v90, v91
  v_exp_f32 v94, v94
  v_exp_f32 v95, v95
  v_cvt_pk_bf16_f32 v110, v92, v93
  v_cvt_pk_bf16_f32 v111, v94, v95
  v_mfma_f32_32x32x16_bf16 v[128:143], v[48:51], v[104:107], v[128:143]
  v_exp_f32 v64, v64
  v_exp_f32 v65, v65
  v_exp_f32 v66, v66
  v_exp_f32 v67, v67
  v_mfma_f32_32x32x16_bf16 v[128:143], v[52:55], v[108:111], v[128:143]
  v_cvt_pk_bf16_f32 v96, v64, v65
  v_exp_f32 v68, v68
  v_exp_f32 v69, v69
  v_cvt_pk_bf16_f32 v97, v66, v67
  v_exp_f32 v70, v70
  v_mfma_f32_32x32x16_bf16 v[80:95], v[40:43], v[200:203], 0
  v_exp_f32 v71, v71
  v_cvt_pk_bf16_f32 v98, v68, v69
  v_exp_f32 v72, v72
  v_exp_f32 v73, v73
  v_cvt_pk_bf16_f32 v99, v70, v71
  v_mfma_f32_32x32x16_bf16 v[80:95], v[44:47], v[204:207], v[80:95]
  v_exp_f32 v74, v74
  v_exp_f32 v75, v75
  ds_read_b128 v[48:51], v4 offset:40960
  v_cvt_pk_bf16_f32 v100, v72, v73
  v_exp_f32 v76, v76
  v_exp_f32 v77, v77
  ds_read_b128 v[52:55], v4 offset:41984
  v_cvt_pk_bf16_f32 v101, v74, v75
  v_exp_f32 v78, v78
  s_add_u32 m0, s31, 3072
  s_add_u32 s29, s53, s27
  s_add_u32 s29, s29, 3072
  buffer_load_dwordx4 v2, s[8:11], s29 offen sc1 lds
  v_exp_f32 v79, v79
  v_cvt_pk_bf16_f32 v102, v76, v77
  v_cvt_pk_bf16_f32 v103, v78, v79
  s_waitcnt lgkmcnt(4)
  v_mfma_f32_32x32x16_bf16 v[112:127], v[56:59], v[96:99], v[112:127]
  v_exp_f32 v80, v80
  v_exp_f32 v81, v81
  v_exp_f32 v82, v82
  v_exp_f32 v83, v83
  v_mfma_f32_32x32x16_bf16 v[112:127], v[60:63], v[100:103], v[112:127]
  v_cvt_pk_bf16_f32 v104, v80, v81
  v_exp_f32 v84, v84
  v_exp_f32 v85, v85
  v_cvt_pk_bf16_f32 v105, v82, v83
  v_exp_f32 v86, v86
  s_waitcnt lgkmcnt(2)
  v_mfma_f32_32x32x16_bf16 v[64:79], v[32:35], v[192:195], 0
  v_exp_f32 v87, v87
  v_cvt_pk_bf16_f32 v106, v84, v85
  v_exp_f32 v88, v88
  v_exp_f32 v89, v89
  v_cvt_pk_bf16_f32 v107, v86, v87
  v_mfma_f32_32x32x16_bf16 v[64:79], v[36:39], v[196:199], v[64:79]
  v_exp_f32 v90, v90
  v_exp_f32 v91, v91
  ds_read_b128 v[40:43], v4 offset:10240
  v_cvt_pk_bf16_f32 v108, v88, v89
  v_exp_f32 v92, v92
  v_exp_f32 v93, v93
  ds_read_b128 v[44:47], v4 offset:11264
  v_cvt_pk_bf16_f32 v109, v90, v91
  v_exp_f32 v94, v94
  v_exp_f32 v95, v95
  v_cvt_pk_bf16_f32 v110, v92, v93
  v_cvt_pk_bf16_f32 v111, v94, v95
  v_mfma_f32_32x32x16_bf16 v[128:143], v[56:59], v[104:107], v[128:143]
  v_exp_f32 v64, v64
  v_exp_f32 v65, v65
  v_exp_f32 v66, v66
  v_exp_f32 v67, v67
  v_mfma_f32_32x32x16_bf16 v[128:143], v[60:63], v[108:111], v[128:143]
  v_cvt_pk_bf16_f32 v96, v64, v65
  v_exp_f32 v68, v68
  v_exp_f32 v69, v69
  v_cvt_pk_bf16_f32 v97, v66, v67
  v_exp_f32 v70, v70
  v_mfma_f32_32x32x16_bf16 v[80:95], v[32:35], v[200:203], 0
  v_exp_f32 v71, v71
  v_cvt_pk_bf16_f32 v98, v68, v69
  v_exp_f32 v72, v72
  v_exp_f32 v73, v73
  v_cvt_pk_bf16_f32 v99, v70, v71
  v_mfma_f32_32x32x16_bf16 v[80:95], v[36:39], v[204:207], v[80:95]
  v_exp_f32 v74, v74
  v_exp_f32 v75, v75
  ds_read_b128 v[56:59], v4 offset:43008
  v_cvt_pk_bf16_f32 v100, v72, v73
  v_exp_f32 v76, v76
  v_exp_f32 v77, v77
  ds_read_b128 v[60:63], v4 offset:44032
  v_cvt_pk_bf16_f32 v101, v74, v75
  v_exp_f32 v78, v78
  s_add_u32 m0, s31, 4096
  s_add_u32 s29, s53, s27
  s_add_u32 s29, s29, 4096
  buffer_load_dwordx4 v2, s[8:11], s29 offen sc1 lds
  v_exp_f32 v79, v79
  v_cvt_pk_bf16_f32 v102, v76, v77
  v_cvt_pk_bf16_f32 v103, v78, v79
  s_waitcnt lgkmcnt(4)
  v_mfma_f32_32x32x16_bf16 v[112:127], v[48:51], v[96:99], v[112:127]
  v_exp_f32 v80, v80
  v_exp_f32 v81, v81
  v_exp_f32 v82, v82
  v_exp_f32 v83, v83
  v_mfma_f32_32x32x16_bf16 v[112:127], v[52:55], v[100:103], v[112:127]
  v_cvt_pk_bf16_f32 v104, v80, v81
  v_exp_f32 v84, v84
  v_exp_f32 v85, v85
  v_cvt_pk_bf16_f32 v105, v82, v83
  v_exp_f32 v86, v86
  s_waitcnt lgkmcnt(2)
  v_mfma_f32_32x32x16_bf16 v[64:79], v[40:43], v[192:195], 0
  v_exp_f32 v87, v87
  v_cvt_pk_bf16_f32 v106, v84, v85
  v_exp_f32 v88, v88
  v_exp_f32 v89, v89
  v_cvt_pk_bf16_f32 v107, v86, v87
  v_mfma_f32_32x32x16_bf16 v[64:79], v[44:47], v[196:199], v[64:79]
  v_exp_f32 v90, v90
  v_exp_f32 v91, v91
  ds_read_b128 v[32:35], v4 offset:12288
  v_cvt_pk_bf16_f32 v108, v88, v89
  v_exp_f32 v92, v92
  v_exp_f32 v93, v93
  ds_read_b128 v[36:39], v4 offset:13312
  v_cvt_pk_bf16_f32 v109, v90, v91
  v_exp_f32 v94, v94
  v_exp_f32 v95, v95
  v_cvt_pk_bf16_f32 v110, v92, v93
  v_cvt_pk_bf16_f32 v111, v94, v95
  v_mfma_f32_32x32x16_bf16 v[128:143], v[48:51], v[104:107], v[128:143]
  v_exp_f32 v64, v64
  v_exp_f32 v65, v65
  v_exp_f32 v66, v66
  v_exp_f32 v67, v67
  v_mfma_f32_32x32x16_bf16 v[128:143], v[52:55], v[108:111], v[128:143]
  v_cvt_pk_bf16_f32 v96, v64, v65
  v_exp_f32 v68, v68
  v_exp_f32 v69, v69
  v_cvt_pk_bf16_f32 v97, v66, v67
  v_exp_f32 v70, v70
  v_mfma_f32_32x32x16_bf16 v[80:95], v[40:43], v[200:203], 0
  v_exp_f32 v71, v71
  v_cvt_pk_bf16_f32 v98, v68, v69
  v_exp_f32 v72, v72
  v_exp_f32 v73, v73
  v_cvt_pk_bf16_f32 v99, v70, v71
  v_mfma_f32_32x32x16_bf16 v[80:95], v[44:47], v[204:207], v[80:95]
  v_exp_f32 v74, v74
  v_exp_f32 v75, v75
  ds_read_b128 v[48:51], v4 offset:45056
  v_cvt_pk_bf16_f32 v100, v72, v73
  v_exp_f32 v76, v76
  v_exp_f32 v77, v77
  ds_read_b128 v[52:55], v4 offset:46080
  v_cvt_pk_bf16_f32 v101, v74, v75
  v_exp_f32 v78, v78
  s_add_u32 m0, s31, 5120
  s_add_u32 s29, s53, s27
  s_add_u32 s29, s29, 5120
  buffer_load_dwordx4 v2, s[8:11], s29 offen sc1 lds
  v_exp_f32 v79, v79
  v_cvt_pk_bf16_f32 v102, v76, v77
  v_cvt_pk_bf16_f32 v103, v78, v79
  s_waitcnt lgkmcnt(4)
  v_mfma_f32_32x32x16_bf16 v[112:127], v[56:59], v[96:99], v[112:127]
  v_exp_f32 v80, v80
  v_exp_f32 v81, v81
  v_exp_f32 v82, v82
  v_exp_f32 v83, v83
  v_mfma_f32_32x32x16_bf16 v[112:127], v[60:63], v[100:103], v[112:127]
  v_cvt_pk_bf16_f32 v104, v80, v81
  v_exp_f32 v84, v84
  v_exp_f32 v85, v85
  v_cvt_pk_bf16_f32 v105, v82, v83
  v_exp_f32 v86, v86
  s_waitcnt lgkmcnt(2)
  v_mfma_f32_32x32x16_bf16 v[64:79], v[32:35], v[192:195], 0
  v_exp_f32 v87, v87
  v_cvt_pk_bf16_f32 v106, v84, v85
  v_exp_f32 v88, v88
  v_exp_f32 v89, v89
  v_cvt_pk_bf16_f32 v107, v86, v87
  v_mfma_f32_32x32x16_bf16 v[64:79], v[36:39], v[196:199], v[64:79]
  v_exp_f32 v90, v90
  v_exp_f32 v91, v91
  ds_read_b128 v[40:43], v4 offset:14336
  v_cvt_pk_bf16_f32 v108, v88, v89
  v_exp_f32 v92, v92
  v_exp_f32 v93, v93
  ds_read_b128 v[44:47], v4 offset:15360
  v_cvt_pk_bf16_f32 v109, v90, v91
  v_exp_f32 v94, v94
  v_exp_f32 v95, v95
  v_cvt_pk_bf16_f32 v110, v92, v93
  v_cvt_pk_bf16_f32 v111, v94, v95
  v_mfma_f32_32x32x16_bf16 v[128:143], v[56:59], v[104:107], v[128:143]
  v_exp_f32 v64, v64
  v_exp_f32 v65, v65
  v_exp_f32 v66, v66
  v_exp_f32 v67, v67
  v_mfma_f32_32x32x16_bf16 v[128:143], v[60:63], v[108:111], v[128:143]
  v_cvt_pk_bf16_f32 v96, v64, v65
  v_exp_f32 v68, v68
  v_exp_f32 v69, v69
  v_cvt_pk_bf16_f32 v97, v66, v67
  v_exp_f32 v70, v70
  v_mfma_f32_32x32x16_bf16 v[80:95], v[32:35], v[200:203], 0
  v_exp_f32 v71, v71
  v_cvt_pk_bf16_f32 v98, v68, v69
  v_exp_f32 v72, v72
  v_exp_f32 v73, v73
  v_cvt_pk_bf16_f32 v99, v70, v71
  v_mfma_f32_32x32x16_bf16 v[80:95], v[36:39], v[204:207], v[80:95]
  v_exp_f32 v74, v74
  v_exp_f32 v75, v75
  ds_read_b128 v[56:59], v4 offset:47104
  v_cvt_pk_bf16_f32 v100, v72, v73
  v_exp_f32 v76, v76
  v_exp_f32 v77, v77
  ds_read_b128 v[60:63], v4 offset:48128
  v_cvt_pk_bf16_f32 v101, v74, v75
  v_exp_f32 v78, v78
  s_add_u32 m0, s31, 6144
  s_add_u32 s29, s53, s27
  s_add_u32 s29, s29, 6144
  buffer_load_dwordx4 v2, s[8:11], s29 offen sc1 lds
  v_exp_f32 v79, v79
  v_cvt_pk_bf16_f32 v102, v76, v77
  v_cvt_pk_bf16_f32 v103, v78, v79
  s_waitcnt lgkmcnt(4)
  v_mfma_f32_32x32x16_bf16 v[112:127], v[48:51], v[96:99], v[112:127]
  v_exp_f32 v80, v80
  v_exp_f32 v81, v81
  v_exp_f32 v82, v82
  v_exp_f32 v83, v83
  v_mfma_f32_32x32x16_bf16 v[112:127], v[52:55], v[100:103], v[112:127]
  v_cvt_pk_bf16_f32 v104, v80, v81
  v_exp_f32 v84, v84
  v_exp_f32 v85, v85
  v_cvt_pk_bf16_f32 v105, v82, v83
  v_exp_f32 v86, v86
  s_waitcnt lgkmcnt(2)
  v_mfma_f32_32x32x16_bf16 v[64:79], v[40:43], v[192:195], 0
  v_exp_f32 v87, v87
  v_cvt_pk_bf16_f32 v106, v84, v85
  v_exp_f32 v88, v88
  v_exp_f32 v89, v89
  v_cvt_pk_bf16_f32 v107, v86, v87
  v_mfma_f32_32x32x16_bf16 v[64:79], v[44:47], v[196:199], v[64:79]
  v_exp_f32 v90, v90
  v_exp_f32 v91, v91
  ds_read_b128 v[32:35], v4 offset:16384
  v_cvt_pk_bf16_f32 v108, v88, v89
  v_exp_f32 v92, v92
  v_exp_f32 v93, v93
  ds_read_b128 v[36:39], v4 offset:17408
  v_cvt_pk_bf16_f32 v109, v90, v91
  v_exp_f32 v94, v94
  v_exp_f32 v95, v95
  v_cvt_pk_bf16_f32 v110, v92, v93
  v_cvt_pk_bf16_f32 v111, v94, v95
  v_mfma_f32_32x32x16_bf16 v[128:143], v[48:51], v[104:107], v[128:143]
  v_exp_f32 v64, v64
  v_exp_f32 v65, v65
  v_exp_f32 v66, v66
  v_exp_f32 v67, v67
  v_mfma_f32_32x32x16_bf16 v[128:143], v[52:55], v[108:111], v[128:143]
  v_cvt_pk_bf16_f32 v96, v64, v65
  v_exp_f32 v68, v68
  v_exp_f32 v69, v69
  v_cvt_pk_bf16_f32 v97, v66, v67
  v_exp_f32 v70, v70
  v_mfma_f32_32x32x16_bf16 v[80:95], v[40:43], v[200:203], 0
  v_exp_f32 v71, v71
  v_cvt_pk_bf16_f32 v98, v68, v69
  v_exp_f32 v72, v72
  v_exp_f32 v73, v73
  v_cvt_pk_bf16_f32 v99, v70, v71
  v_mfma_f32_32x32x16_bf16 v[80:95], v[44:47], v[204:207], v[80:95]
  v_exp_f32 v74, v74
  v_exp_f32 v75, v75
  ds_read_b128 v[48:51], v4 offset:49152
  v_cvt_pk_bf16_f32 v100, v72, v73
  v_exp_f32 v76, v76
  v_exp_f32 v77, v77
  ds_read_b128 v[52:55], v4 offset:50176
  v_cvt_pk_bf16_f32 v101, v74, v75
  v_exp_f32 v78, v78
  s_add_u32 m0, s31, 7168
  s_add_u32 s29, s53, s27
  s_add_u32 s29, s29, 7168
  buffer_load_dwordx4 v2, s[8:11], s29 offen sc1 lds
  v_exp_f32 v79, v79
  v_cvt_pk_bf16_f32 v102, v76, v77
  v_cvt_pk_bf16_f32 v103, v78, v79
  s_waitcnt lgkmcnt(4)
  v_mfma_f32_32x32x16_bf16 v[112:127], v[56:59], v[96:99], v[112:127]
  v_exp_f32 v80, v80
  v_exp_f32 v81, v81
  v_exp_f32 v82, v82
  v_exp_f32 v83, v83
  v_mfma_f32_32x32x16_bf16 v[112:127], v[60:63], v[100:103], v[112:127]
  v_cvt_pk_bf16_f32 v104, v80, v81
  v_exp_f32 v84, v84
  v_exp_f32 v85, v85
  v_cvt_pk_bf16_f32 v105, v82, v83
  v_exp_f32 v86, v86
  s_waitcnt lgkmcnt(2)
  v_mfma_f32_32x32x16_bf16 v[64:79], v[32:35], v[192:195], 0
  v_exp_f32 v87, v87
  v_cvt_pk_bf16_f32 v106, v84, v85
  v_exp_f32 v88, v88
  v_exp_f32 v89, v89
  v_cvt_pk_bf16_f32 v107, v86, v87
  v_mfma_f32_32x32x16_bf16 v[64:79], v[36:39], v[196:199], v[64:79]
  v_exp_f32 v90, v90
  v_exp_f32 v91, v91
  ds_read_b128 v[40:43], v4 offset:18432
  v_cvt_pk_bf16_f32 v108, v88, v89
  v_exp_f32 v92, v92
  v_exp_f32 v93, v93
  ds_read_b128 v[44:47], v4 offset:19456
  v_cvt_pk_bf16_f32 v109, v90, v91
  v_exp_f32 v94, v94
  v_exp_f32 v95, v95
  v_cvt_pk_bf16_f32 v110, v92, v93
  v_cvt_pk_bf16_f32 v111, v94, v95
  v_mfma_f32_32x32x16_bf16 v[128:143], v[56:59], v[104:107], v[128:143]
  v_exp_f32 v64, v64
  v_exp_f32 v65, v65
  v_exp_f32 v66, v66
  v_exp_f32 v67, v67
  v_mfma_f32_32x32x16_bf16 v[128:143], v[60:63], v[108:111], v[128:143]
  v_cvt_pk_bf16_f32 v96, v64, v65
  v_exp_f32 v68, v68
  v_exp_f32 v69, v69
  v_cvt_pk_bf16_f32 v97, v66, v67
  v_exp_f32 v70, v70
  v_mfma_f32_32x32x16_bf16 v[80:95], v[32:35], v[200:203], 0
  v_exp_f32 v71, v71
  v_cvt_pk_bf16_f32 v98, v68, v69
  v_exp_f32 v72, v72
  v_exp_f32 v73, v73
  v_cvt_pk_bf16_f32 v99, v70, v71
  v_mfma_f32_32x32x16_bf16 v[80:95], v[36:39], v[204:207], v[80:95]
  v_exp_f32 v74, v74
  v_exp_f32 v75, v75
  ds_read_b128 v[56:59], v4 offset:51200
  v_cvt_pk_bf16_f32 v100, v72, v73
  v_exp_f32 v76, v76
  v_exp_f32 v77, v77
  ds_read_b128 v[60:63], v4 offset:52224
  v_cvt_pk_bf16_f32 v101, v74, v75
  v_exp_f32 v78, v78
  s_add_u32 m0, s31, 32768
  s_add_u32 s29, s53, s28
  s_add_u32 s29, s29, 0
  buffer_load_dwordx4 v2, s[8:11], s29 offen sc1 lds
  v_exp_f32 v79, v79
  v_cvt_pk_bf16_f32 v102, v76, v77
  v_cvt_pk_bf16_f32 v103, v78, v79
  s_waitcnt lgkmcnt(4)
  v_mfma_f32_32x32x16_bf16 v[112:127], v[48:51], v[96:99], v[112:127]
  v_exp_f32 v80, v80
  v_exp_f32 v81, v81
  v_exp_f32 v82, v82
  v_exp_f32 v83, v83
  v_mfma_f32_32x32x16_bf16 v[112:127], v[52:55], v[100:103], v[112:127]
  v_cvt_pk_bf16_f32 v104, v80, v81
  v_exp_f32 v84, v84
  v_exp_f32 v85, v85
  v_cvt_pk_bf16_f32 v105, v82, v83
  v_exp_f32 v86, v86
  s_waitcnt lgkmcnt(2)
  v_mfma_f32_32x32x16_bf16 v[64:79], v[40:43], v[192:195], 0
  v_exp_f32 v87, v87
  v_cvt_pk_bf16_f32 v106, v84, v85
  v_exp_f32 v88, v88
  v_exp_f32 v89, v89
  v_cvt_pk_bf16_f32 v107, v86, v87
  v_mfma_f32_32x32x16_bf16 v[64:79], v[44:47], v[196:199], v[64:79]
  v_exp_f32 v90, v90
  v_exp_f32 v91, v91
  ds_read_b128 v[32:35], v4 offset:20480
  v_cvt_pk_bf16_f32 v108, v88, v89
  v_exp_f32 v92, v92
  v_exp_f32 v93, v93
  ds_read_b128 v[36:39], v4 offset:21504
  v_cvt_pk_bf16_f32 v109, v90, v91
  v_exp_f32 v94, v94
  v_exp_f32 v95, v95
  v_cvt_pk_bf16_f32 v110, v92, v93
  v_cvt_pk_bf16_f32 v111, v94, v95
  v_mfma_f32_32x32x16_bf16 v[128:143], v[48:51], v[104:107], v[128:143]
  v_exp_f32 v64, v64
  v_exp_f32 v65, v65
  v_exp_f32 v66, v66
  v_exp_f32 v67, v67
  v_mfma_f32_32x32x16_bf16 v[128:143], v[52:55], v[108:111], v[128:143]
  v_cvt_pk_bf16_f32 v96, v64, v65
  v_exp_f32 v68, v68
  v_exp_f32 v69, v69
  v_cvt_pk_bf16_f32 v97, v66, v67
  v_exp_f32 v70, v70
  v_mfma_f32_32x32x16_bf16 v[80:95], v[40:43], v[200:203], 0
  v_exp_f32 v71, v71
  v_cvt_pk_bf16_f32 v98, v68, v69
  v_exp_f32 v72, v72
  v_exp_f32 v73, v73
  v_cvt_pk_bf16_f32 v99, v70, v71
  v_mfma_f32_32x32x16_bf16 v[80:95], v[44:47], v[204:207], v[80:95]
  v_exp_f32 v74, v74
  v_exp_f32 v75, v75
  ds_read_b128 v[48:51], v4 offset:53248
  v_cvt_pk_bf16_f32 v100, v72, v73
  v_exp_f32 v76, v76
  v_exp_f32 v77, v77
  ds_read_b128 v[52:55], v4 offset:54272
  v_cvt_pk_bf16_f32 v101, v74, v75
  v_exp_f32 v78, v78
  s_add_u32 m0, s31, 33792
  s_add_u32 s29, s53, s28
  s_add_u32 s29, s29, 1024
  buffer_load_dwordx4 v2, s[8:11], s29 offen sc1 lds
  v_exp_f32 v79, v79
  v_cvt_pk_bf16_f32 v102, v76, v77
  v_cvt_pk_bf16_f32 v103, v78, v79
  s_waitcnt lgkmcnt(4)
  v_mfma_f32_32x32x16_bf16 v[112:127], v[56:59], v[96:99], v[112:127]
  v_exp_f32 v80, v80
  v_exp_f32 v81, v81
  v_exp_f32 v82, v82
  v_exp_f32 v83, v83
  v_mfma_f32_32x32x16_bf16 v[112:127], v[60:63], v[100:103], v[112:127]
  v_cvt_pk_bf16_f32 v104, v80, v81
  v_exp_f32 v84, v84
  v_exp_f32 v85, v85
  v_cvt_pk_bf16_f32 v105, v82, v83
  v_exp_f32 v86, v86
  s_waitcnt lgkmcnt(2)
  v_mfma_f32_32x32x16_bf16 v[64:79], v[32:35], v[192:195], 0
  v_exp_f32 v87, v87
  v_cvt_pk_bf16_f32 v106, v84, v85
  v_exp_f32 v88, v88
  v_exp_f32 v89, v89
  v_cvt_pk_bf16_f32 v107, v86, v87
  v_mfma_f32_32x32x16_bf16 v[64:79], v[36:39], v[196:199], v[64:79]
  v_exp_f32 v90, v90
  v_exp_f32 v91, v91
  ds_read_b128 v[40:43], v4 offset:22528
  v_cvt_pk_bf16_f32 v108, v88, v89
  v_exp_f32 v92, v92
  v_exp_f32 v93, v93
  ds_read_b128 v[44:47], v4 offset:23552
  v_cvt_pk_bf16_f32 v109, v90, v91
  v_exp_f32 v94, v94
  v_exp_f32 v95, v95
  v_cvt_pk_bf16_f32 v110, v92, v93
  v_cvt_pk_bf16_f32 v111, v94, v95
  v_mfma_f32_32x32x16_bf16 v[128:143], v[56:59], v[104:107], v[128:143]
  v_exp_f32 v64, v64
  v_exp_f32 v65, v65
  v_exp_f32 v66, v66
  v_exp_f32 v67, v67
  v_mfma_f32_32x32x16_bf16 v[128:143], v[60:63], v[108:111], v[128:143]
  v_cvt_pk_bf16_f32 v96, v64, v65
  v_exp_f32 v68, v68
  v_exp_f32 v69, v69
  v_cvt_pk_bf16_f32 v97, v66, v67
  v_exp_f32 v70, v70
  v_mfma_f32_32x32x16_bf16 v[80:95], v[32:35], v[200:203], 0
  v_exp_f32 v71, v71
  v_cvt_pk_bf16_f32 v98, v68, v69
  v_exp_f32 v72, v72
  v_exp_f32 v73, v73
  v_cvt_pk_bf16_f32 v99, v70, v71
  v_mfma_f32_32x32x16_bf16 v[80:95], v[36:39], v[204:207], v[80:95]
  v_exp_f32 v74, v74
  v_exp_f32 v75, v75
  ds_read_b128 v[56:59], v4 offset:55296
  v_cvt_pk_bf16_f32 v100, v72, v73
  v_exp_f32 v76, v76
  v_exp_f32 v77, v77
  ds_read_b128 v[60:63], v4 offset:56320
  v_cvt_pk_bf16_f32 v101, v74, v75
  v_exp_f32 v78, v78
  s_add_u32 m0, s31, 34816
  s_add_u32 s29, s53, s28
  s_add_u32 s29, s29, 2048
  buffer_load_dwordx4 v2, s[8:11], s29 offen sc1 lds
  v_exp_f32 v79, v79
  v_cvt_pk_bf16_f32 v102, v76, v77
  v_cvt_pk_bf16_f32 v103, v78, v79
  s_waitcnt lgkmcnt(4)
  v_mfma_f32_32x32x16_bf16 v[112:127], v[48:51], v[96:99], v[112:127]
  v_exp_f32 v80, v80
  v_exp_f32 v81, v81
  v_exp_f32 v82, v82
  v_exp_f32 v83, v83
  v_mfma_f32_32x32x16_bf16 v[112:127], v[52:55], v[100:103], v[112:127]
  v_cvt_pk_bf16_f32 v104, v80, v81
  v_exp_f32 v84, v84
  v_exp_f32 v85, v85
  v_cvt_pk_bf16_f32 v105, v82, v83
  v_exp_f32 v86, v86
  s_waitcnt lgkmcnt(2)
  v_mfma_f32_32x32x16_bf16 v[64:79], v[40:43], v[192:195], 0
  v_exp_f32 v87, v87
  v_cvt_pk_bf16_f32 v106, v84, v85
  v_exp_f32 v88, v88
  v_exp_f32 v89, v89
  v_cvt_pk_bf16_f32 v107, v86, v87
  v_mfma_f32_32x32x16_bf16 v[64:79], v[44:47], v[196:199], v[64:79]
  v_exp_f32 v90, v90
  v_exp_f32 v91, v91
  ds_read_b128 v[32:35], v4 offset:24576
  v_cvt_pk_bf16_f32 v108, v88, v89
  v_exp_f32 v92, v92
  v_exp_f32 v93, v93
  ds_read_b128 v[36:39], v4 offset:25600
  v_cvt_pk_bf16_f32 v109, v90, v91
  v_exp_f32 v94, v94
  v_exp_f32 v95, v95
  v_cvt_pk_bf16_f32 v110, v92, v93
  v_cvt_pk_bf16_f32 v111, v94, v95
  v_mfma_f32_32x32x16_bf16 v[128:143], v[48:51], v[104:107], v[128:143]
  v_exp_f32 v64, v64
  v_exp_f32 v65, v65
  v_exp_f32 v66, v66
  v_exp_f32 v67, v67
  v_mfma_f32_32x32x16_bf16 v[128:143], v[52:55], v[108:111], v[128:143]
  v_cvt_pk_bf16_f32 v96, v64, v65
  v_exp_f32 v68, v68
  v_exp_f32 v69, v69
  v_cvt_pk_bf16_f32 v97, v66, v67
  v_exp_f32 v70, v70
  v_mfma_f32_32x32x16_bf16 v[80:95], v[40:43], v[200:203], 0
  v_exp_f32 v71, v71
  v_cvt_pk_bf16_f32 v98, v68, v69
  v_exp_f32 v72, v72
  v_exp_f32 v73, v73
  v_cvt_pk_bf16_f32 v99, v70, v71
  v_mfma_f32_32x32x16_bf16 v[80:95], v[44:47], v[204:207], v[80:95]
  v_exp_f32 v74, v74
  v_exp_f32 v75, v75
  ds_read_b128 v[48:51], v4 offset:57344
  v_cvt_pk_bf16_f32 v100, v72, v73
  v_exp_f32 v76, v76
  v_exp_f32 v77, v77
  ds_read_b128 v[52:55], v4 offset:58368
  v_cvt_pk_bf16_f32 v101, v74, v75
  v_exp_f32 v78, v78
  s_add_u32 m0, s31, 35840
  s_add_u32 s29, s53, s28
  s_add_u32 s29, s29, 3072
  buffer_load_dwordx4 v2, s[8:11], s29 offen sc1 lds
  v_exp_f32 v79, v79
  v_cvt_pk_bf16_f32 v102, v76, v77
  v_cvt_pk_bf16_f32 v103, v78, v79
  s_waitcnt lgkmcnt(4)
  v_mfma_f32_32x32x16_bf16 v[112:127], v[56:59], v[96:99], v[112:127]
  v_exp_f32 v80, v80
  v_exp_f32 v81, v81
  v_exp_f32 v82, v82
  v_exp_f32 v83, v83
  v_mfma_f32_32x32x16_bf16 v[112:127], v[60:63], v[100:103], v[112:127]
  v_cvt_pk_bf16_f32 v104, v80, v81
  v_exp_f32 v84, v84
  v_exp_f32 v85, v85
  v_cvt_pk_bf16_f32 v105, v82, v83
  v_exp_f32 v86, v86
  s_waitcnt lgkmcnt(2)
  v_mfma_f32_32x32x16_bf16 v[64:79], v[32:35], v[192:195], 0
  v_exp_f32 v87, v87
  v_cvt_pk_bf16_f32 v106, v84, v85
  v_exp_f32 v88, v88
  v_exp_f32 v89, v89
  v_cvt_pk_bf16_f32 v107, v86, v87
  v_mfma_f32_32x32x16_bf16 v[64:79], v[36:39], v[196:199], v[64:79]
  v_exp_f32 v90, v90
  v_exp_f32 v91, v91
  ds_read_b128 v[40:43], v4 offset:26624
  v_cvt_pk_bf16_f32 v108, v88, v89
  v_exp_f32 v92, v92
  v_exp_f32 v93, v93
  ds_read_b128 v[44:47], v4 offset:27648
  v_cvt_pk_bf16_f32 v109, v90, v91
  v_exp_f32 v94, v94
  v_exp_f32 v95, v95
  v_cvt_pk_bf16_f32 v110, v92, v93
  v_cvt_pk_bf16_f32 v111, v94, v95
  v_mfma_f32_32x32x16_bf16 v[128:143], v[56:59], v[104:107], v[128:143]
  v_exp_f32 v64, v64
  v_exp_f32 v65, v65
  v_exp_f32 v66, v66
  v_exp_f32 v67, v67
  v_mfma_f32_32x32x16_bf16 v[128:143], v[60:63], v[108:111], v[128:143]
  v_cvt_pk_bf16_f32 v96, v64, v65
  v_exp_f32 v68, v68
  v_exp_f32 v69, v69
  v_cvt_pk_bf16_f32 v97, v66, v67
  v_exp_f32 v70, v70
  v_mfma_f32_32x32x16_bf16 v[80:95], v[32:35], v[200:203], 0
  v_exp_f32 v71, v71
  v_cvt_pk_bf16_f32 v98, v68, v69
  v_exp_f32 v72, v72
  v_exp_f32 v73, v73
  v_cvt_pk_bf16_f32 v99, v70, v71
  v_mfma_f32_32x32x16_bf16 v[80:95], v[36:39], v[204:207], v[80:95]
  v_exp_f32 v74, v74
  v_exp_f32 v75, v75
  ds_read_b128 v[56:59], v4 offset:59392
  v_cvt_pk_bf16_f32 v100, v72, v73
  v_exp_f32 v76, v76
  v_exp_f32 v77, v77
  ds_read_b128 v[60:63], v4 offset:60416
  v_cvt_pk_bf16_f32 v101, v74, v75
  v_exp_f32 v78, v78
  s_add_u32 m0, s31, 36864
  s_add_u32 s29, s53, s28
  s_add_u32 s29, s29, 4096
  buffer_load_dwordx4 v2, s[8:11], s29 offen sc1 lds
  v_exp_f32 v79, v79
  v_cvt_pk_bf16_f32 v102, v76, v77
  v_cvt_pk_bf16_f32 v103, v78, v79
  s_waitcnt lgkmcnt(4)
  v_mfma_f32_32x32x16_bf16 v[112:127], v[48:51], v[96:99], v[112:127]
  v_exp_f32 v80, v80
  v_exp_f32 v81, v81
  v_exp_f32 v82, v82
  v_exp_f32 v83, v83
  v_mfma_f32_32x32x16_bf16 v[112:127], v[52:55], v[100:103], v[112:127]
  v_cvt_pk_bf16_f32 v104, v80, v81
  v_exp_f32 v84, v84
  v_exp_f32 v85, v85
  v_cvt_pk_bf16_f32 v105, v82, v83
  v_exp_f32 v86, v86
  s_waitcnt lgkmcnt(2)
  v_mfma_f32_32x32x16_bf16 v[64:79], v[40:43], v[192:195], 0
  v_exp_f32 v87, v87
  v_cvt_pk_bf16_f32 v106, v84, v85
  v_exp_f32 v88, v88
  v_exp_f32 v89, v89
  v_cvt_pk_bf16_f32 v107, v86, v87
  v_mfma_f32_32x32x16_bf16 v[64:79], v[44:47], v[196:199], v[64:79]
  v_exp_f32 v90, v90
  v_exp_f32 v91, v91
  ds_read_b128 v[32:35], v4 offset:28672
  v_cvt_pk_bf16_f32 v108, v88, v89
  v_exp_f32 v92, v92
  v_exp_f32 v93, v93
  ds_read_b128 v[36:39], v4 offset:29696
  v_cvt_pk_bf16_f32 v109, v90, v91
  v_exp_f32 v94, v94
  v_exp_f32 v95, v95
  v_cvt_pk_bf16_f32 v110, v92, v93
  v_cvt_pk_bf16_f32 v111, v94, v95
  v_mfma_f32_32x32x16_bf16 v[128:143], v[48:51], v[104:107], v[128:143]
  v_exp_f32 v64, v64
  v_exp_f32 v65, v65
  v_exp_f32 v66, v66
  v_exp_f32 v67, v67
  v_mfma_f32_32x32x16_bf16 v[128:143], v[52:55], v[108:111], v[128:143]
  v_cvt_pk_bf16_f32 v96, v64, v65
  v_exp_f32 v68, v68
  v_exp_f32 v69, v69
  v_cvt_pk_bf16_f32 v97, v66, v67
  v_exp_f32 v70, v70
  v_mfma_f32_32x32x16_bf16 v[80:95], v[40:43], v[200:203], 0
  v_exp_f32 v71, v71
  v_cvt_pk_bf16_f32 v98, v68, v69
  v_exp_f32 v72, v72
  v_exp_f32 v73, v73
  v_cvt_pk_bf16_f32 v99, v70, v71
  v_mfma_f32_32x32x16_bf16 v[80:95], v[44:47], v[204:207], v[80:95]
  v_exp_f32 v74, v74
  v_exp_f32 v75, v75
  ds_read_b128 v[48:51], v4 offset:61440
  v_cvt_pk_bf16_f32 v100, v72, v73
  v_exp_f32 v76, v76
  v_exp_f32 v77, v77
  ds_read_b128 v[52:55], v4 offset:62464
  v_cvt_pk_bf16_f32 v101, v74, v75
  v_exp_f32 v78, v78
  s_add_u32 m0, s31, 37888
  s_add_u32 s29, s53, s28
  s_add_u32 s29, s29, 5120
  buffer_load_dwordx4 v2, s[8:11], s29 offen sc1 lds
  v_exp_f32 v79, v79
  v_cvt_pk_bf16_f32 v102, v76, v77
  v_cvt_pk_bf16_f32 v103, v78, v79
  s_waitcnt lgkmcnt(4)
  v_mfma_f32_32x32x16_bf16 v[112:127], v[56:59], v[96:99], v[112:127]
  v_exp_f32 v80, v80
  v_exp_f32 v81, v81
  v_exp_f32 v82, v82
  v_exp_f32 v83, v83
  v_mfma_f32_32x32x16_bf16 v[112:127], v[60:63], v[100:103], v[112:127]
  v_cvt_pk_bf16_f32 v104, v80, v81
  v_exp_f32 v84, v84
  v_exp_f32 v85, v85
  v_cvt_pk_bf16_f32 v105, v82, v83
  v_exp_f32 v86, v86
  s_waitcnt lgkmcnt(2)
  v_mfma_f32_32x32x16_bf16 v[64:79], v[32:35], v[192:195], 0
  v_exp_f32 v87, v87
  v_cvt_pk_bf16_f32 v106, v84, v85
  v_exp_f32 v88, v88
  v_exp_f32 v89, v89
  v_cvt_pk_bf16_f32 v107, v86, v87
  v_mfma_f32_32x32x16_bf16 v[64:79], v[36:39], v[196:199], v[64:79]
  v_exp_f32 v90, v90
  v_exp_f32 v91, v91
  ds_read_b128 v[40:43], v4 offset:30720
  v_cvt_pk_bf16_f32 v108, v88, v89
  v_exp_f32 v92, v92
  v_exp_f32 v93, v93
  ds_read_b128 v[44:47], v4 offset:31744
  v_cvt_pk_bf16_f32 v109, v90, v91
  v_exp_f32 v94, v94
  v_exp_f32 v95, v95
  v_cvt_pk_bf16_f32 v110, v92, v93
  v_cvt_pk_bf16_f32 v111, v94, v95
  v_mfma_f32_32x32x16_bf16 v[128:143], v[56:59], v[104:107], v[128:143]
  v_exp_f32 v64, v64
  v_exp_f32 v65, v65
  v_exp_f32 v66, v66
  v_exp_f32 v67, v67
  v_mfma_f32_32x32x16_bf16 v[128:143], v[60:63], v[108:111], v[128:143]
  v_cvt_pk_bf16_f32 v96, v64, v65
  v_exp_f32 v68, v68
  v_exp_f32 v69, v69
  v_cvt_pk_bf16_f32 v97, v66, v67
  v_exp_f32 v70, v70
  v_mfma_f32_32x32x16_bf16 v[80:95], v[32:35], v[200:203], 0
  v_exp_f32 v71, v71
  v_cvt_pk_bf16_f32 v98, v68, v69
  v_exp_f32 v72, v72
  v_exp_f32 v73, v73
  v_cvt_pk_bf16_f32 v99, v70, v71
  v_mfma_f32_32x32x16_bf16 v[80:95], v[36:39], v[204:207], v[80:95]
  v_exp_f32 v74, v74
  v_exp_f32 v75, v75
  ds_read_b128 v[56:59], v4 offset:63488
  v_cvt_pk_bf16_f32 v100, v72, v73
  v_exp_f32 v76, v76
  v_exp_f32 v77, v77
  ds_read_b128 v[60:63], v4 offset:64512
  v_cvt_pk_bf16_f32 v101, v74, v75
  v_exp_f32 v78, v78
  s_add_u32 m0, s31, 38912
  s_add_u32 s29, s53, s28
  s_add_u32 s29, s29, 6144
  buffer_load_dwordx4 v2, s[8:11], s29 offen sc1 lds
  v_exp_f32 v79, v79
  v_cvt_pk_bf16_f32 v102, v76, v77
  v_cvt_pk_bf16_f32 v103, v78, v79
  s_waitcnt lgkmcnt(4)
  v_mfma_f32_32x32x16_bf16 v[112:127], v[48:51], v[96:99], v[112:127]
  v_exp_f32 v80, v80
  v_exp_f32 v81, v81
  v_exp_f32 v82, v82
  v_exp_f32 v83, v83
  v_mfma_f32_32x32x16_bf16 v[112:127], v[52:55], v[100:103], v[112:127]
  v_cvt_pk_bf16_f32 v104, v80, v81
  v_exp_f32 v84, v84
  v_exp_f32 v85, v85
  v_cvt_pk_bf16_f32 v105, v82, v83
  v_exp_f32 v86, v86
  s_waitcnt lgkmcnt(2)
  v_mfma_f32_32x32x16_bf16 v[64:79], v[40:43], v[192:195], 0
  v_exp_f32 v87, v87
  v_cvt_pk_bf16_f32 v106, v84, v85
  v_exp_f32 v88, v88
  v_exp_f32 v89, v89
  v_cvt_pk_bf16_f32 v107, v86, v87
  v_mfma_f32_32x32x16_bf16 v[64:79], v[44:47], v[196:199], v[64:79]
  v_exp_f32 v90, v90
  v_exp_f32 v91, v91
  v_cvt_pk_bf16_f32 v108, v88, v89
  v_exp_f32 v92, v92
  v_exp_f32 v93, v93
  v_cvt_pk_bf16_f32 v109, v90, v91
  v_exp_f32 v94, v94
  v_exp_f32 v95, v95
  v_cvt_pk_bf16_f32 v110, v92, v93
  v_cvt_pk_bf16_f32 v111, v94, v95
  v_mfma_f32_32x32x16_bf16 v[128:143], v[48:51], v[104:107], v[128:143]
  v_exp_f32 v64, v64
  v_exp_f32 v65, v65
  v_exp_f32 v66, v66
  v_exp_f32 v67, v67
  v_mfma_f32_32x32x16_bf16 v[128:143], v[52:55], v[108:111], v[128:143]
  v_cvt_pk_bf16_f32 v96, v64, v65
  v_exp_f32 v68, v68
  v_exp_f32 v69, v69
  v_cvt_pk_bf16_f32 v97, v66, v67
  v_exp_f32 v70, v70
  v_mfma_f32_32x32x16_bf16 v[80:95], v[40:43], v[200:203], 0
  v_exp_f32 v71, v71
  v_cvt_pk_bf16_f32 v98, v68, v69
  v_exp_f32 v72, v72
  v_exp_f32 v73, v73
  v_cvt_pk_bf16_f32 v99, v70, v71
  v_mfma_f32_32x32x16_bf16 v[80:95], v[44:47], v[204:207], v[80:95]
  v_exp_f32 v74, v74
  v_exp_f32 v75, v75
  v_cvt_pk_bf16_f32 v100, v72, v73
  v_exp_f32 v76, v76
  v_exp_f32 v77, v77
  v_cvt_pk_bf16_f32 v101, v74, v75
  v_exp_f32 v78, v78
  s_add_u32 m0, s31, 39936
  s_add_u32 s29, s53, s28
  s_add_u32 s29, s29, 7168
  buffer_load_dwordx4 v2, s[8:11], s29 offen sc1 lds
  v_exp_f32 v79, v79
  v_cvt_pk_bf16_f32 v102, v76, v77
  v_cvt_pk_bf16_f32 v103, v78, v79
  s_waitcnt lgkmcnt(0)
  v_mfma_f32_32x32x16_bf16 v[112:127], v[56:59], v[96:99], v[112:127]
  v_exp_f32 v80, v80
  v_exp_f32 v81, v81
  v_exp_f32 v82, v82
  v_exp_f32 v83, v83
  v_mfma_f32_32x32x16_bf16 v[112:127], v[60:63], v[100:103], v[112:127]
  v_cvt_pk_bf16_f32 v104, v80, v81
  v_exp_f32 v84, v84
  v_exp_f32 v85, v85
  v_cvt_pk_bf16_f32 v105, v82, v83
  v_exp_f32 v86, v86
  v_exp_f32 v87, v87
  v_cvt_pk_bf16_f32 v106, v84, v85
  v_exp_f32 v88, v88
  v_exp_f32 v89, v89
  v_cvt_pk_bf16_f32 v107, v86, v87
  v_exp_f32 v90, v90
  v_exp_f32 v91, v91
  v_cvt_pk_bf16_f32 v108, v88, v89
  v_exp_f32 v92, v92
  v_exp_f32 v93, v93
  v_cvt_pk_bf16_f32 v109, v90, v91
  v_exp_f32 v94, v94
  v_exp_f32 v95, v95
  v_cvt_pk_bf16_f32 v110, v92, v93
  v_cvt_pk_bf16_f32 v111, v94, v95
  s_nop 1
  v_mfma_f32_32x32x16_bf16 v[128:143], v[56:59], v[104:107], v[128:143]
  v_mfma_f32_32x32x16_bf16 v[128:143], v[60:63], v[108:111], v[128:143]
  s_cmp_lt_u32 s41, 4
  s_cbranch_scc1 kb1_chunk2
  s_nop 11
  v_mov_b32 v5, v120
  v_mov_b32 v6, v120
  s_nop 1
  v_permlane32_swap_b32 v5, v6
  v_mov_b32 v14, v6
  v_mov_b32 v5, v136
  v_mov_b32 v6, v136
  s_nop 1
  v_permlane32_swap_b32 v5, v6
  v_mov_b32 v15, v6
  s_cmp_eq_u32 s40, 0
  s_cbranch_scc0 kb1_fin
  v_min_f32 v5, v14, v15
  v_cmp_gt_f32 vcc, 0x12800000, v5
  v_cmp_u_f32 s[36:37], v5, v5
  s_nop 1
  s_or_b64 vcc, vcc, s[36:37]
  s_cmp_lg_u64 vcc, 0
  s_cselect_b32 s42, 1, 0
  v_mov_b32 v5, s42
  s_lshl_b32 s30, s21, 2
  s_add_u32 s30, s30, 131584
  v_mov_b32 v6, s30
  ds_write_b32 v6, v5
  s_waitcnt vmcnt(0) lgkmcnt(0)
  s_barrier
  v_mov_b32 v6, 131584
  ds_read_b128 v[8:11], v6
  s_waitcnt lgkmcnt(0)
  v_or_b32 v8, v8, v9
  v_or_b32 v10, v10, v11
  v_or_b32 v8, v8, v10
  s_nop 0
  v_readfirstlane_b32 s42, v8
  s_cmp_eq_u32 s42, 0
  s_cbranch_scc1 kb1_fin
  s_mov_b32 s40, 1
  v_and_b32 v5, 0xffff0000, v198
  v_cndmask_b32 v198, v198, v5, s[34:35]
  v_mov_b32 v12, 0xff7fffff
  v_and_b32 v5, 0xffff0000, v206
  v_cndmask_b32 v206, v206, v5, s[34:35]
  v_mov_b32 v13, 0xff7fffff
  s_mov_b32 s41, 0
kb1_mx:
  s_lshl_b32 s30, s41, 11
  s_add_u32 s30, s30, s27
  buffer_load_dwordx4 v[32:35], v2, s[8:11], s30 offen sc1
  buffer_load_dwordx4 v[36:39], v2, s[8:11], s30 offen offset:1024 sc1
  s_waitcnt vmcnt(0)
  v_mfma_f32_32x32x16_bf16 v[64:79], v[32:35], v[192:195], 0
  v_mfma_f32_32x32x16_bf16 v[64:79], v[36:39], v[196:199], v[64:79]
  v_mfma_f32_32x32x16_bf16 v[80:95], v[32:35], v[200:203], 0
  v_mfma_f32_32x32x16_bf16 v[80:95], v[36:39], v[204:207], v[80:95]
  s_nop 11
  v_max3_f32 v12, v12, v64, v65
  v_max3_f32 v12, v12, v66, v67
  v_max3_f32 v12, v12, v68, v69
  v_max3_f32 v12, v12, v70, v71
  v_max3_f32 v12, v12, v72, v73
  v_max3_f32 v12, v12, v74, v75
  v_max3_f32 v12, v12, v76, v77
  v_max3_f32 v12, v12, v78, v79
  v_max3_f32 v13, v13, v80, v81
  v_max3_f32 v13, v13, v82, v83
  v_max3_f32 v13, v13, v84, v85
  v_max3_f32 v13, v13, v86, v87
  v_max3_f32 v13, v13, v88, v89
  v_max3_f32 v13, v13, v90, v91
  v_max3_f32 v13, v13, v92, v93
  v_max3_f32 v13, v13, v94, v95
  s_add_u32 s41, s41, 1
  s_cmp_lt_u32 s41, 64
  s_cbranch_scc1 kb1_mx
  v_mov_b32 v5, v12
  s_nop 1
  v_permlane32_swap_b32 v12, v5
  v_max_f32 v12, v12, v5
  v_cvt_pk_bf16_f32 v5, v12, v12
  v_and_b32 v5, 0xffff, v5
  v_xor_b32 v5, 0x8000, v5
  v_and_b32 v6, 0xffff0000, v198
  v_or_b32 v5, v5, v6
  v_cndmask_b32 v198, v198, v5, s[34:35]
  v_mov_b32 v5, v13
  s_nop 1
  v_permlane32_swap_b32 v13, v5
  v_max_f32 v13, v13, v5
  v_cvt_pk_bf16_f32 v5, v13, v13
  v_and_b32 v5, 0xffff, v5
  v_xor_b32 v5, 0x8000, v5
  v_and_b32 v6, 0xffff0000, v206
  v_or_b32 v5, v5, v6
  v_cndmask_b32 v206, v206, v5, s[34:35]
  s_barrier
  s_mov_b32 s41, 0
  s_mul_i32 s53, s41, 32768
  s_lshl_b32 s31, s21, 13
  s_add_u32 s53, s53, s31
  s_add_u32 m0, s31, 0
  s_add_u32 s29, s53, s27
  s_add_u32 s29, s29, 0
  buffer_load_dwordx4 v2, s[8:11], s29 offen sc1 lds
  s_add_u32 m0, s31, 1024
  s_add_u32 s29, s53, s27
  s_add_u32 s29, s29, 1024
  buffer_load_dwordx4 v2, s[8:11], s29 offen sc1 lds
  s_add_u32 m0, s31, 2048
  s_add_u32 s29, s53, s27
  s_add_u32 s29, s29, 2048
  buffer_load_dwordx4 v2, s[8:11], s29 offen sc1 lds
  s_add_u32 m0, s31, 3072
  s_add_u32 s29, s53, s27
  s_add_u32 s29, s29, 3072
  buffer_load_dwordx4 v2, s[8:11], s29 offen sc1 lds
  s_add_u32 m0, s31, 4096
  s_add_u32 s29, s53, s27
  s_add_u32 s29, s29, 4096
  buffer_load_dwordx4 v2, s[8:11], s29 offen sc1 lds
  s_add_u32 m0, s31, 5120
  s_add_u32 s29, s53, s27
  s_add_u32 s29, s29, 5120
  buffer_load_dwordx4 v2, s[8:11], s29 offen sc1 lds
  s_add_u32 m0, s31, 6144
  s_add_u32 s29, s53, s27
  s_add_u32 s29, s29, 6144
  buffer_load_dwordx4 v2, s[8:11], s29 offen sc1 lds
  s_add_u32 m0, s31, 7168
  s_add_u32 s29, s53, s27
  s_add_u32 s29, s29, 7168
  buffer_load_dwordx4 v2, s[8:11], s29 offen sc1 lds
  s_add_u32 m0, s31, 32768
  s_add_u32 s29, s53, s28
  s_add_u32 s29, s29, 0
  buffer_load_dwordx4 v2, s[8:11], s29 offen sc1 lds
  s_add_u32 m0, s31, 33792
  s_add_u32 s29, s53, s28
  s_add_u32 s29, s29, 1024
  buffer_load_dwordx4 v2, s[8:11], s29 offen sc1 lds
  s_add_u32 m0, s31, 34816
  s_add_u32 s29, s53, s28
  s_add_u32 s29, s29, 2048
  buffer_load_dwordx4 v2, s[8:11], s29 offen sc1 lds
  s_add_u32 m0, s31, 35840
  s_add_u32 s29, s53, s28
  s_add_u32 s29, s29, 3072
  buffer_load_dwordx4 v2, s[8:11], s29 offen sc1 lds
  s_add_u32 m0, s31, 36864
  s_add_u32 s29, s53, s28
  s_add_u32 s29, s29, 4096
  buffer_load_dwordx4 v2, s[8:11], s29 offen sc1 lds
  s_add_u32 m0, s31, 37888
  s_add_u32 s29, s53, s28
  s_add_u32 s29, s29, 5120
  buffer_load_dwordx4 v2, s[8:11], s29 offen sc1 lds
  s_add_u32 m0, s31, 38912
  s_add_u32 s29, s53, s28
  s_add_u32 s29, s29, 6144
  buffer_load_dwordx4 v2, s[8:11], s29 offen sc1 lds
  s_add_u32 m0, s31, 39936
  s_add_u32 s29, s53, s28
  s_add_u32 s29, s29, 7168
  buffer_load_dwordx4 v2, s[8:11], s29 offen sc1 lds
  s_branch kb1_main2
kb1_fin:
  v_and_b32 v3, 15, v1
  v_bfe_u32 v11, v1, 4, 1
  v_mul_u32_u24 v11, 20480, v11
  v_lshrrev_b32 v4, 5, v1
  s_mul_i32 s30, s22, 20
  v_lshlrev_b32 v5, 2, v4
  v_add_u32 v5, 0, v5
  v_add_u32 v5, s30, v5
  v_lshrrev_b32 v6, 5, v5
  v_lshlrev_b32 v6, 10, v6
  v_bfe_u32 v7, v5, 3, 2
  v_lshlrev_b32 v7, 4, v7
  v_add_u32 v7, v7, v3
  v_lshlrev_b32 v7, 4, v7
  v_add_u32 v6, v6, v7
  v_bfe_u32 v7, v5, 2, 1
  v_lshlrev_b32 v7, 3, v7
  v_add_u32 v6, v6, v7
  v_add_u32 v32, v6, v11
  v_lshlrev_b32 v5, 2, v4
  v_add_u32 v5, 8, v5
  v_add_u32 v5, s30, v5
  v_lshrrev_b32 v6, 5, v5
  v_lshlrev_b32 v6, 10, v6
  v_bfe_u32 v7, v5, 3, 2
  v_lshlrev_b32 v7, 4, v7
  v_add_u32 v7, v7, v3
  v_lshlrev_b32 v7, 4, v7
  v_add_u32 v6, v6, v7
  v_bfe_u32 v7, v5, 2, 1
  v_lshlrev_b32 v7, 3, v7
  v_add_u32 v6, v6, v7
  v_add_u32 v33, v6, v11
  v_lshlrev_b32 v5, 2, v4
  v_add_u32 v5, 16, v5
  v_add_u32 v5, s30, v5
  v_lshrrev_b32 v6, 5, v5
  v_lshlrev_b32 v6, 10, v6
  v_bfe_u32 v7, v5, 3, 2
  v_lshlrev_b32 v7, 4, v7
  v_add_u32 v7, v7, v3
  v_lshlrev_b32 v7, 4, v7
  v_add_u32 v6, v6, v7
  v_bfe_u32 v7, v5, 2, 1
  v_lshlrev_b32 v7, 3, v7
  v_add_u32 v6, v6, v7
  v_add_u32 v34, v6, v11
  v_mov_b32 v5, 0x40000000
  v_cndmask_b32 v34, v5, v34, s[34:35]
  v_rcp_f32 v5, v14
  s_nop 0
  v_mul_f32 v112, v112, v5
  v_mul_f32 v113, v113, v5
  v_mul_f32 v114, v114, v5
  v_mul_f32 v115, v115, v5
  v_mul_f32 v116, v116, v5
  v_mul_f32 v117, v117, v5
  v_mul_f32 v118, v118, v5
  v_mul_f32 v119, v119, v5
  v_mul_f32 v120, v120, v5
  v_mul_f32 v121, v121, v5
  v_mul_f32 v122, v122, v5
  v_mul_f32 v123, v123, v5
  v_cvt_pk_bf16_f32 v40, v112, v113
  v_cvt_pk_bf16_f32 v41, v114, v115
  v_cvt_pk_bf16_f32 v42, v116, v117
  v_cvt_pk_bf16_f32 v43, v118, v119
  v_cvt_pk_bf16_f32 v44, v120, v121
  v_cvt_pk_bf16_f32 v45, v122, v123
  s_add_u32 s31, s52, 0
  s_mul_i32 s31, s31, 40960
  s_add_u32 s31, s31, 0xf200000
  buffer_store_dwordx2 v[40:41], v32, s[8:11], s31 offen sc1
  buffer_store_dwordx2 v[42:43], v33, s[8:11], s31 offen sc1
  buffer_store_dwordx2 v[44:45], v34, s[8:11], s31 offen sc1
  v_rcp_f32 v5, v15
  s_nop 0
  v_mul_f32 v128, v128, v5
  v_mul_f32 v129, v129, v5
  v_mul_f32 v130, v130, v5
  v_mul_f32 v131, v131, v5
  v_mul_f32 v132, v132, v5
  v_mul_f32 v133, v133, v5
  v_mul_f32 v134, v134, v5
  v_mul_f32 v135, v135, v5
  v_mul_f32 v136, v136, v5
  v_mul_f32 v137, v137, v5
  v_mul_f32 v138, v138, v5
  v_mul_f32 v139, v139, v5
  v_cvt_pk_bf16_f32 v48, v128, v129
  v_cvt_pk_bf16_f32 v49, v130, v131
  v_cvt_pk_bf16_f32 v50, v132, v133
  v_cvt_pk_bf16_f32 v51, v134, v135
  v_cvt_pk_bf16_f32 v52, v136, v137
  v_cvt_pk_bf16_f32 v53, v138, v139
  s_add_u32 s31, s52, 1
  s_mul_i32 s31, s31, 40960
  s_add_u32 s31, s31, 0xf200000
  buffer_store_dwordx2 v[48:49], v32, s[8:11], s31 offen sc1
  buffer_store_dwordx2 v[50:51], v33, s[8:11], s31 offen sc1
  buffer_store_dwordx2 v[52:53], v34, s[8:11], s31 offen sc1
  s_waitcnt vmcnt(0)
  s_barrier
  s_cmp_eq_u32 s21, 0
  s_cbranch_scc0 arr_45
  s_mov_b64 s[24:25], exec
  s_mov_b64 exec, 1
  v_mov_b32 v3, 0
  v_mov_b32 v4, 1
  buffer_atomic_add v4, v3, s[8:11], s48 offen
  s_mov_b64 exec, s[24:25]
arr_45:
  v_and_b32 v5, 15, v1
  v_lshrrev_b32 v6, 4, v1
  v_and_b32 v7, 1, v6
  v_lshlrev_b32 v7, 10, v7
  v_lshrrev_b32 v8, 1, v6
  v_lshlrev_b32 v8, 5, v8
  v_add_u32 v8, v8, v5
  v_lshlrev_b32 v8, 4, v8
  v_add_u32 v9, v7, v8
  s_lshr_b32 s26, s2, 2
  s_mul_i32 s27, s26, 81920
  s_lshl_b32 s28, s50, 11
  s_add_u32 s27, s27, s28
  s_add_u32 s27, s27, 0x1400000
  s_add_u32 s28, s27, 0
  buffer_load_dwordx4 v[16:19], v9, s[8:11], s28 offen sc1
  s_add_u32 s28, s27, 256
  buffer_load_dwordx4 v[20:23], v9, s[8:11], s28 offen sc1
  s_add_u32 s28, s27, 2048
  buffer_load_dwordx4 v[24:27], v9, s[8:11], s28 offen sc1
  s_add_u32 s28, s27, 2304
  buffer_load_dwordx4 v[28:31], v9, s[8:11], s28 offen sc1
  s_cmp_lt_u32 s21, 2
  s_cbranch_scc0 g3_46
  s_add_u32 s28, s27, 4096
  buffer_load_dwordx4 v[32:35], v9, s[8:11], s28 offen sc1
  s_add_u32 s28, s27, 4352
  buffer_load_dwordx4 v[36:39], v9, s[8:11], s28 offen sc1
g3_46:
  s_mov_b32 s45, 0
  v_mov_b32 v3, 0
aw_47:
  buffer_load_dword v4, v3, s[8:11], s48 offen sc1
  s_add_u32 s45, s45, 1
  s_waitcnt vmcnt(0)
  v_readfirstlane_b32 s29, v4
  s_cmp_ge_u32 s29, 32
  s_cbranch_scc1 aw_47_ok
  s_cmp_lt_u32 s45, 400000
  s_cbranch_scc1 aw_47
  s_branch kb1_abort
aw_47_ok:
  s_mul_i32 s28, s26, 40960
  s_mul_i32 s31, s21, 10240
  s_add_u32 s28, s28, s31
  s_add_u32 s28, s28, 0xf200000
  s_add_u32 m0, s31, 0
  s_add_u32 s29, s28, 0
  buffer_load_dwordx4 v2, s[8:11], s29 offen sc1 lds
  s_add_u32 m0, s31, 1024
  s_add_u32 s29, s28, 1024
  buffer_load_dwordx4 v2, s[8:11], s29 offen sc1 lds
  s_add_u32 m0, s31, 2048
  s_add_u32 s29, s28, 2048
  buffer_load_dwordx4 v2, s[8:11], s29 offen sc1 lds
  s_add_u32 m0, s31, 3072
  s_add_u32 s29, s28, 3072
  buffer_load_dwordx4 v2, s[8:11], s29 offen sc1 lds
  s_add_u32 m0, s31, 4096
  s_add_u32 s29, s28, 4096
  buffer_load_dwordx4 v2, s[8:11], s29 offen sc1 lds
  s_add_u32 m0, s31, 5120
  s_add_u32 s29, s28, 5120
  buffer_load_dwordx4 v2, s[8:11], s29 offen sc1 lds
  s_add_u32 m0, s31, 6144
  s_add_u32 s29, s28, 6144
  buffer_load_dwordx4 v2, s[8:11], s29 offen sc1 lds
  s_add_u32 m0, s31, 7168
  s_add_u32 s29, s28, 7168
  buffer_load_dwordx4 v2, s[8:11], s29 offen sc1 lds
  s_add_u32 m0, s31, 8192
  s_add_u32 s29, s28, 8192
  buffer_load_dwordx4 v2, s[8:11], s29 offen sc1 lds
  s_add_u32 m0, s31, 9216
  s_add_u32 s29, s28, 9216
  buffer_load_dwordx4 v2, s[8:11], s29 offen sc1 lds
  s_waitcnt vmcnt(0)
  s_barrier
  ds_read_b128 v[80:83], v2 offset:0
  ds_read_b128 v[84:87], v2 offset:20480
  ds_read_b128 v[88:91], v2 offset:1024
  ds_read_b128 v[92:95], v2 offset:21504
  ds_read_b128 v[96:99], v2 offset:2048
  ds_read_b128 v[100:103], v2 offset:22528
  s_waitcnt lgkmcnt(4)
  v_mfma_f32_16x16x32_bf16 v[48:51], a[0:3], v[80:83], 0
  v_mfma_f32_16x16x32_bf16 v[52:55], a[0:3], v[84:87], 0
  v_mfma_f32_16x16x32_bf16 v[56:59], a[80:83], v[80:83], 0
  v_mfma_f32_16x16x32_bf16 v[60:63], a[80:83], v[84:87], 0
  v_mfma_f32_16x16x32_bf16 v[64:67], a[160:163], v[80:83], 0
  v_mfma_f32_16x16x32_bf16 v[68:71], a[160:163], v[84:87], 0
  ds_read_b128 v[80:83], v2 offset:3072
  ds_read_b128 v[84:87], v2 offset:23552
  s_waitcnt lgkmcnt(4)
  v_mfma_f32_16x16x32_bf16 v[48:51], a[4:7], v[88:91], v[48:51]
  v_mfma_f32_16x16x32_bf16 v[52:55], a[4:7], v[92:95], v[52:55]
  v_mfma_f32_16x16x32_bf16 v[56:59], a[84:87], v[88:91], v[56:59]
  v_mfma_f32_16x16x32_bf16 v[60:63], a[84:87], v[92:95], v[60:63]
  v_mfma_f32_16x16x32_bf16 v[64:67], a[164:167], v[88:91], v[64:67]
  v_mfma_f32_16x16x32_bf16 v[68:71], a[164:167], v[92:95], v[68:71]
  ds_read_b128 v[88:91], v2 offset:4096
  ds_read_b128 v[92:95], v2 offset:24576
  s_waitcnt lgkmcnt(4)
  v_mfma_f32_16x16x32_bf16 v[48:51], a[8:11], v[96:99], v[48:51]
  v_mfma_f32_16x16x32_bf16 v[52:55], a[8:11], v[100:103], v[52:55]
  v_mfma_f32_16x16x32_bf16 v[56:59], a[88:91], v[96:99], v[56:59]
  v_mfma_f32_16x16x32_bf16 v[60:63], a[88:91], v[100:103], v[60:63]
  v_mfma_f32_16x16x32_bf16 v[64:67], a[168:171], v[96:99], v[64:67]
  v_mfma_f32_16x16x32_bf16 v[68:71], a[168:171], v[100:103], v[68:71]
  ds_read_b128 v[96:99], v2 offset:5120
  ds_read_b128 v[100:103], v2 offset:25600
  s_waitcnt lgkmcnt(4)
  v_mfma_f32_16x16x32_bf16 v[48:51], a[12:15], v[80:83], v[48:51]
  v_mfma_f32_16x16x32_bf16 v[52:55], a[12:15], v[84:87], v[52:55]
  v_mfma_f32_16x16x32_bf16 v[56:59], a[92:95], v[80:83], v[56:59]
  v_mfma_f32_16x16x32_bf16 v[60:63], a[92:95], v[84:87], v[60:63]
  v_mfma_f32_16x16x32_bf16 v[64:67], a[172:175], v[80:83], v[64:67]
  v_mfma_f32_16x16x32_bf16 v[68:71], a[172:175], v[84:87], v[68:71]
  ds_read_b128 v[80:83], v2 offset:6144
  ds_read_b128 v[84:87], v2 offset:26624
  s_waitcnt lgkmcnt(4)
  v_mfma_f32_16x16x32_bf16 v[48:51], a[16:19], v[88:91], v[48:51]
  v_mfma_f32_16x16x32_bf16 v[52:55], a[16:19], v[92:95], v[52:55]
  v_mfma_f32_16x16x32_bf16 v[56:59], a[96:99], v[88:91], v[56:59]
  v_mfma_f32_16x16x32_bf16 v[60:63], a[96:99], v[92:95], v[60:63]
  v_mfma_f32_16x16x32_bf16 v[64:67], a[176:179], v[88:91], v[64:67]
  v_mfma_f32_16x16x32_bf16 v[68:71], a[176:179], v[92:95], v[68:71]
  ds_read_b128 v[88:91], v2 offset:7168
  ds_read_b128 v[92:95], v2 offset:27648
  s_waitcnt lgkmcnt(4)
  v_mfma_f32_16x16x32_bf16 v[48:51], a[20:23], v[96:99], v[48:51]
  v_mfma_f32_16x16x32_bf16 v[52:55], a[20:23], v[100:103], v[52:55]
  v_mfma_f32_16x16x32_bf16 v[56:59], a[100:103], v[96:99], v[56:59]
  v_mfma_f32_16x16x32_bf16 v[60:63], a[100:103], v[100:103], v[60:63]
  v_mfma_f32_16x16x32_bf16 v[64:67], a[180:183], v[96:99], v[64:67]
  v_mfma_f32_16x16x32_bf16 v[68:71], a[180:183], v[100:103], v[68:71]
  ds_read_b128 v[96:99], v2 offset:8192
  ds_read_b128 v[100:103], v2 offset:28672
  s_waitcnt lgkmcnt(4)
  v_mfma_f32_16x16x32_bf16 v[48:51], a[24:27], v[80:83], v[48:51]
  v_mfma_f32_16x16x32_bf16 v[52:55], a[24:27], v[84:87], v[52:55]
  v_mfma_f32_16x16x32_bf16 v[56:59], a[104:107], v[80:83], v[56:59]
  v_mfma_f32_16x16x32_bf16 v[60:63], a[104:107], v[84:87], v[60:63]
  v_mfma_f32_16x16x32_bf16 v[64:67], a[184:187], v[80:83], v[64:67]
  v_mfma_f32_16x16x32_bf16 v[68:71], a[184:187], v[84:87], v[68:71]
  ds_read_b128 v[80:83], v2 offset:9216
  ds_read_b128 v[84:87], v2 offset:29696
  s_waitcnt lgkmcnt(4)
  v_mfma_f32_16x16x32_bf16 v[48:51], a[28:31], v[88:91], v[48:51]
  v_mfma_f32_16x16x32_bf16 v[52:55], a[28:31], v[92:95], v[52:55]
  v_mfma_f32_16x16x32_bf16 v[56:59], a[108:111], v[88:91], v[56:59]
  v_mfma_f32_16x16x32_bf16 v[60:63], a[108:111], v[92:95], v[60:63]
  v_mfma_f32_16x16x32_bf16 v[64:67], a[188:191], v[88:91], v[64:67]
  v_mfma_f32_16x16x32_bf16 v[68:71], a[188:191], v[92:95], v[68:71]
  ds_read_b128 v[88:91], v2 offset:10240
  ds_read_b128 v[92:95], v2 offset:30720
  s_waitcnt lgkmcnt(4)
  v_mfma_f32_16x16x32_bf16 v[48:51], a[32:35], v[96:99], v[48:51]
  v_mfma_f32_16x16x32_bf16 v[52:55], a[32:35], v[100:103], v[52:55]
  v_mfma_f32_16x16x32_bf16 v[56:59], a[112:115], v[96:99], v[56:59]
  v_mfma_f32_16x16x32_bf16 v[60:63], a[112:115], v[100:103], v[60:63]
  v_mfma_f32_16x16x32_bf16 v[64:67], a[192:195], v[96:99], v[64:67]
  v_mfma_f32_16x16x32_bf16 v[68:71], a[192:195], v[100:103], v[68:71]
  ds_read_b128 v[96:99], v2 offset:11264
  ds_read_b128 v[100:103], v2 offset:31744
  s_waitcnt lgkmcnt(4)
  v_mfma_f32_16x16x32_bf16 v[48:51], a[36:39], v[80:83], v[48:51]
  v_mfma_f32_16x16x32_bf16 v[52:55], a[36:39], v[84:87], v[52:55]
  v_mfma_f32_16x16x32_bf16 v[56:59], a[116:119], v[80:83], v[56:59]
  v_mfma_f32_16x16x32_bf16 v[60:63], a[116:119], v[84:87], v[60:63]
  v_mfma_f32_16x16x32_bf16 v[64:67], a[196:199], v[80:83], v[64:67]
  v_mfma_f32_16x16x32_bf16 v[68:71], a[196:199], v[84:87], v[68:71]
  ds_read_b128 v[80:83], v2 offset:12288
  ds_read_b128 v[84:87], v2 offset:32768
  s_waitcnt lgkmcnt(4)
  v_mfma_f32_16x16x32_bf16 v[48:51], a[40:43], v[88:91], v[48:51]
  v_mfma_f32_16x16x32_bf16 v[52:55], a[40:43], v[92:95], v[52:55]
  v_mfma_f32_16x16x32_bf16 v[56:59], a[120:123], v[88:91], v[56:59]
  v_mfma_f32_16x16x32_bf16 v[60:63], a[120:123], v[92:95], v[60:63]
  v_mfma_f32_16x16x32_bf16 v[64:67], a[200:203], v[88:91], v[64:67]
  v_mfma_f32_16x16x32_bf16 v[68:71], a[200:203], v[92:95], v[68:71]
  ds_read_b128 v[88:91], v2 offset:13312
  ds_read_b128 v[92:95], v2 offset:33792
  s_waitcnt lgkmcnt(4)
  v_mfma_f32_16x16x32_bf16 v[48:51], a[44:47], v[96:99], v[48:51]
  v_mfma_f32_16x16x32_bf16 v[52:55], a[44:47], v[100:103], v[52:55]
  v_mfma_f32_16x16x32_bf16 v[56:59], a[124:127], v[96:99], v[56:59]
  v_mfma_f32_16x16x32_bf16 v[60:63], a[124:127], v[100:103], v[60:63]
  v_mfma_f32_16x16x32_bf16 v[64:67], a[204:207], v[96:99], v[64:67]
  v_mfma_f32_16x16x32_bf16 v[68:71], a[204:207], v[100:103], v[68:71]
  ds_read_b128 v[96:99], v2 offset:14336
  ds_read_b128 v[100:103], v2 offset:34816
  s_waitcnt lgkmcnt(4)
  v_mfma_f32_16x16x32_bf16 v[48:51], a[48:51], v[80:83], v[48:51]
  v_mfma_f32_16x16x32_bf16 v[52:55], a[48:51], v[84:87], v[52:55]
  v_mfma_f32_16x16x32_bf16 v[56:59], a[128:131], v[80:83], v[56:59]
  v_mfma_f32_16x16x32_bf16 v[60:63], a[128:131], v[84:87], v[60:63]
  v_mfma_f32_16x16x32_bf16 v[64:67], a[208:211], v[80:83], v[64:67]
  v_mfma_f32_16x16x32_bf16 v[68:71], a[208:211], v[84:87], v[68:71]
  ds_read_b128 v[80:83], v2 offset:15360
  ds_read_b128 v[84:87], v2 offset:35840
  s_waitcnt lgkmcnt(4)
  v_mfma_f32_16x16x32_bf16 v[48:51], a[52:55], v[88:91], v[48:51]
  v_mfma_f32_16x16x32_bf16 v[52:55], a[52:55], v[92:95], v[52:55]
  v_mfma_f32_16x16x32_bf16 v[56:59], a[132:135], v[88:91], v[56:59]
  v_mfma_f32_16x16x32_bf16 v[60:63], a[132:135], v[92:95], v[60:63]
  v_mfma_f32_16x16x32_bf16 v[64:67], a[212:215], v[88:91], v[64:67]
  v_mfma_f32_16x16x32_bf16 v[68:71], a[212:215], v[92:95], v[68:71]
  ds_read_b128 v[88:91], v2 offset:16384
  ds_read_b128 v[92:95], v2 offset:36864
  s_waitcnt lgkmcnt(4)
  v_mfma_f32_16x16x32_bf16 v[48:51], a[56:59], v[96:99], v[48:51]
  v_mfma_f32_16x16x32_bf16 v[52:55], a[56:59], v[100:103], v[52:55]
  v_mfma_f32_16x16x32_bf16 v[56:59], a[136:139], v[96:99], v[56:59]
  v_mfma_f32_16x16x32_bf16 v[60:63], a[136:139], v[100:103], v[60:63]
  v_mfma_f32_16x16x32_bf16 v[64:67], a[216:219], v[96:99], v[64:67]
  v_mfma_f32_16x16x32_bf16 v[68:71], a[216:219], v[100:103], v[68:71]
  ds_read_b128 v[96:99], v2 offset:17408
  ds_read_b128 v[100:103], v2 offset:37888
  s_waitcnt lgkmcnt(4)
  v_mfma_f32_16x16x32_bf16 v[48:51], a[60:63], v[80:83], v[48:51]
  v_mfma_f32_16x16x32_bf16 v[52:55], a[60:63], v[84:87], v[52:55]
  v_mfma_f32_16x16x32_bf16 v[56:59], a[140:143], v[80:83], v[56:59]
  v_mfma_f32_16x16x32_bf16 v[60:63], a[140:143], v[84:87], v[60:63]
  v_mfma_f32_16x16x32_bf16 v[64:67], a[220:223], v[80:83], v[64:67]
  v_mfma_f32_16x16x32_bf16 v[68:71], a[220:223], v[84:87], v[68:71]
  ds_read_b128 v[80:83], v2 offset:18432
  ds_read_b128 v[84:87], v2 offset:38912
  s_waitcnt lgkmcnt(4)
  v_mfma_f32_16x16x32_bf16 v[48:51], a[64:67], v[88:91], v[48:51]
  v_mfma_f32_16x16x32_bf16 v[52:55], a[64:67], v[92:95], v[52:55]
  v_mfma_f32_16x16x32_bf16 v[56:59], a[144:147], v[88:91], v[56:59]
  v_mfma_f32_16x16x32_bf16 v[60:63], a[144:147], v[92:95], v[60:63]
  v_mfma_f32_16x16x32_bf16 v[64:67], a[224:227], v[88:91], v[64:67]
  v_mfma_f32_16x16x32_bf16 v[68:71], a[224:227], v[92:95], v[68:71]
  ds_read_b128 v[88:91], v2 offset:19456
  ds_read_b128 v[92:95], v2 offset:39936
  s_waitcnt lgkmcnt(4)
  v_mfma_f32_16x16x32_bf16 v[48:51], a[68:71], v[96:99], v[48:51]
  v_mfma_f32_16x16x32_bf16 v[52:55], a[68:71], v[100:103], v[52:55]
  v_mfma_f32_16x16x32_bf16 v[56:59], a[148:151], v[96:99], v[56:59]
  v_mfma_f32_16x16x32_bf16 v[60:63], a[148:151], v[100:103], v[60:63]
  v_mfma_f32_16x16x32_bf16 v[64:67], a[228:231], v[96:99], v[64:67]
  v_mfma_f32_16x16x32_bf16 v[68:71], a[228:231], v[100:103], v[68:71]
  s_waitcnt lgkmcnt(2)
  v_mfma_f32_16x16x32_bf16 v[48:51], a[72:75], v[80:83], v[48:51]
  v_mfma_f32_16x16x32_bf16 v[52:55], a[72:75], v[84:87], v[52:55]
  v_mfma_f32_16x16x32_bf16 v[56:59], a[152:155], v[80:83], v[56:59]
  v_mfma_f32_16x16x32_bf16 v[60:63], a[152:155], v[84:87], v[60:63]
  v_mfma_f32_16x16x32_bf16 v[64:67], a[232:235], v[80:83], v[64:67]
  v_mfma_f32_16x16x32_bf16 v[68:71], a[232:235], v[84:87], v[68:71]
  s_waitcnt lgkmcnt(0)
  v_mfma_f32_16x16x32_bf16 v[48:51], a[76:79], v[88:91], v[48:51]
  v_mfma_f32_16x16x32_bf16 v[52:55], a[76:79], v[92:95], v[52:55]
  v_mfma_f32_16x16x32_bf16 v[56:59], a[156:159], v[88:91], v[56:59]
  v_mfma_f32_16x16x32_bf16 v[60:63], a[156:159], v[92:95], v[60:63]
  v_mfma_f32_16x16x32_bf16 v[64:67], a[236:239], v[88:91], v[64:67]
  v_mfma_f32_16x16x32_bf16 v[68:71], a[236:239], v[92:95], v[68:71]
  s_nop 7
  v_add_f32 v48, v48, v16
  v_add_f32 v49, v49, v17
  v_add_f32 v50, v50, v18
  v_add_f32 v51, v51, v19
  s_add_u32 s28, s27, 0
  buffer_store_dwordx4 v[48:51], v9, s[8:11], s28 offen
  v_add_f32 v52, v52, v20
  v_add_f32 v53, v53, v21
  v_add_f32 v54, v54, v22
  v_add_f32 v55, v55, v23
  s_add_u32 s28, s27, 256
  buffer_store_dwordx4 v[52:55], v9, s[8:11], s28 offen
  v_add_f32 v56, v56, v24
  v_add_f32 v57, v57, v25
  v_add_f32 v58, v58, v26
  v_add_f32 v59, v59, v27
  s_add_u32 s28, s27, 2048
  buffer_store_dwordx4 v[56:59], v9, s[8:11], s28 offen
  v_add_f32 v60, v60, v28
  v_add_f32 v61, v61, v29
  v_add_f32 v62, v62, v30
  v_add_f32 v63, v63, v31
  s_add_u32 s28, s27, 2304
  buffer_store_dwordx4 v[60:63], v9, s[8:11], s28 offen
  s_cmp_lt_u32 s21, 2
  s_cbranch_scc0 g3_48
  v_add_f32 v64, v64, v32
  v_add_f32 v65, v65, v33
  v_add_f32 v66, v66, v34
  v_add_f32 v67, v67, v35
  s_add_u32 s28, s27, 4096
  buffer_store_dwordx4 v[64:67], v9, s[8:11], s28 offen
  v_add_f32 v68, v68, v36
  v_add_f32 v69, v69, v37
  v_add_f32 v70, v70, v38
  v_add_f32 v71, v71, v39
  s_add_u32 s28, s27, 4352
  buffer_store_dwordx4 v[68:71], v9, s[8:11], s28 offen
g3_48:
  s_endpgm
kb1_abort:
  s_load_dwordx2 s[6:7], s[0:1], 88
  v_mov_b32 v2, 80
  v_mov_b32 v3, 1
  s_waitcnt lgkmcnt(0)
  s_mov_b64 exec, 1
  global_atomic_add v2, v3, s[6:7]
  s_waitcnt vmcnt(0)
kb1_exit:
  s_endpgm

.section .rodata,"a"
.p2align 6
.amdhsa_kernel kb1_kernel
  .amdhsa_next_free_vgpr 512
  .amdhsa_next_free_sgpr 102
  .amdhsa_accum_offset 256
  .amdhsa_group_segment_fixed_size 0
  .amdhsa_kernarg_size 104
  .amdhsa_user_sgpr_count 2
  .amdhsa_user_sgpr_kernarg_segment_ptr 1
  .amdhsa_system_sgpr_workgroup_id_x 1
.end_amdhsa_kernel
.text
.globl ka2_kernel
.p2align 8
.type ka2_kernel,@function
ka2_kernel:
  s_mov_b32 s99, 1
ka_body:
  s_cmp_ge_u32 s2, 256
  s_cbranch_scc1 ka_exit

  s_load_dwordx2 s[4:5], s[0:1], 96
  s_load_dwordx2 s[6:7], s[0:1], 88
  s_load_dwordx4 s[36:39], s[0:1], 16
  s_load_dwordx4 s[40:43], s[0:1], 32
  s_getreg_b32 s26, hwreg(HW_REG_XCC_ID)
  s_and_b32 s26, s26, 15
  v_lshrrev_b32 v1, 6, v0
  s_nop 0
  v_readfirstlane_b32 s21, v1
  s_waitcnt lgkmcnt(0)
  s_mov_b32 s8, s4
  s_and_b32 s9, s5, 0xffff
  s_mov_b32 s10, 0x10000000
  s_mov_b32 s11, 0x20000
  s_cmp_eq_u32 s21, 3
  s_cbranch_scc0 lnu_49_x
  v_and_b32 v1, 63, v0
  v_and_b32 v5, 7, v1
  v_bfe_u32 v6, v1, 3, 1
  v_lshrrev_b32 v7, 4, v1
  v_lshlrev_b32 v8, 5, v6
  v_add_u32 v8, v8, v5
  v_lshlrev_b32 v8, 4, v8
  v_lshlrev_b32 v10, 10, v7
  v_add_u32 v10, v10, v8
  s_lshr_b32 s46, s2, 2
  s_and_b32 s47, s2, 3
  s_lshl_b32 s47, s47, 7
  s_cmp_eq_u32 s99, 1
  s_cbranch_scc0 lnu_49_b
  v_lshlrev_b32 v9, 11, v7
  v_add_u32 v9, v9, v8
  s_mul_i32 s48, s46, 81920
  s_add_u32 s48, s48, s47
  s_add_u32 s48, s48, 0x1400000
  s_add_u32 s49, s48, 0
  buffer_load_dwordx4 v[16:19], v9, s[8:11], s49 offen
  s_add_u32 s49, s48, 1024
  buffer_load_dwordx4 v[20:23], v9, s[8:11], s49 offen
  s_add_u32 s49, s48, 8192
  buffer_load_dwordx4 v[24:27], v9, s[8:11], s49 offen
  s_add_u32 s49, s48, 9216
  buffer_load_dwordx4 v[28:31], v9, s[8:11], s49 offen
  s_add_u32 s49, s48, 16384
  buffer_load_dwordx4 v[32:35], v9, s[8:11], s49 offen
  s_add_u32 s49, s48, 17408
  buffer_load_dwordx4 v[36:39], v9, s[8:11], s49 offen
  s_add_u32 s49, s48, 24576
  buffer_load_dwordx4 v[40:43], v9, s[8:11], s49 offen
  s_add_u32 s49, s48, 25600
  buffer_load_dwordx4 v[44:47], v9, s[8:11], s49 offen
  s_add_u32 s49, s48, 32768
  buffer_load_dwordx4 v[48:51], v9, s[8:11], s49 offen
  s_add_u32 s49, s48, 33792
  buffer_load_dwordx4 v[52:55], v9, s[8:11], s49 offen
  s_add_u32 s49, s48, 40960
  buffer_load_dwordx4 v[56:59], v9, s[8:11], s49 offen
  s_add_u32 s49, s48, 41984
  buffer_load_dwordx4 v[60:63], v9, s[8:11], s49 offen
  s_add_u32 s49, s48, 49152
  buffer_load_dwordx4 v[64:67], v9, s[8:11], s49 offen
  s_add_u32 s49, s48, 50176
  buffer_load_dwordx4 v[68:71], v9, s[8:11], s49 offen
  s_add_u32 s49, s48, 57344
  buffer_load_dwordx4 v[72:75], v9, s[8:11], s49 offen
  s_add_u32 s49, s48, 58368
  buffer_load_dwordx4 v[76:79], v9, s[8:11], s49 offen
  s_add_u32 s49, s48, 65536
  buffer_load_dwordx4 v[80:83], v9, s[8:11], s49 offen
  s_add_u32 s49, s48, 66560
  buffer_load_dwordx4 v[84:87], v9, s[8:11], s49 offen
  s_add_u32 s49, s48, 73728
  buffer_load_dwordx4 v[88:91], v9, s[8:11], s49 offen
  s_add_u32 s49, s48, 74752
  buffer_load_dwordx4 v[92:95], v9, s[8:11], s49 offen
  s_waitcnt vmcnt(0)
  s_branch lnu_49_f
lnu_49_b:
  s_load_dwordx2 s[48:49], s[0:1], 0
  v_mul_u32_u24 v11, 1280, v5
  v_lshlrev_b32 v12, 5, v7
  v_add_u32 v11, v11, v12
  v_lshlrev_b32 v12, 4, v6
  v_add_u32 v11, v11, v12
  s_waitcnt lgkmcnt(0)
  s_mov_b32 s12, s48
  s_and_b32 s13, s49, 0xffff
  s_mov_b32 s14, 0x280000
  s_mov_b32 s15, 0x20000
  s_mul_i32 s49, s2, 10240
  buffer_load_dwordx4 v[56:59], v11, s[12:15], s49 offen offset:0
  buffer_load_dwordx4 v[60:63], v11, s[12:15], s49 offen offset:128
  buffer_load_dwordx4 v[64:67], v11, s[12:15], s49 offen offset:256
  buffer_load_dwordx4 v[68:71], v11, s[12:15], s49 offen offset:384
  buffer_load_dwordx4 v[72:75], v11, s[12:15], s49 offen offset:512
  buffer_load_dwordx4 v[76:79], v11, s[12:15], s49 offen offset:640
  buffer_load_dwordx4 v[80:83], v11, s[12:15], s49 offen offset:768
  buffer_load_dwordx4 v[84:87], v11, s[12:15], s49 offen offset:896
  buffer_load_dwordx4 v[88:91], v11, s[12:15], s49 offen offset:1024
  buffer_load_dwordx4 v[92:95], v11, s[12:15], s49 offen offset:1152
  s_waitcnt vmcnt(0)
  v_mov_b32 v4, v56
  v_lshlrev_b32 v16, 16, v4
  v_and_b32 v17, 0xffff0000, v4
  v_mov_b32 v4, v57
  v_lshlrev_b32 v18, 16, v4
  v_and_b32 v19, 0xffff0000, v4
  v_mov_b32 v4, v58
  v_lshlrev_b32 v20, 16, v4
  v_and_b32 v21, 0xffff0000, v4
  v_mov_b32 v4, v59
  v_lshlrev_b32 v22, 16, v4
  v_and_b32 v23, 0xffff0000, v4
  v_mov_b32 v4, v60
  v_lshlrev_b32 v24, 16, v4
  v_and_b32 v25, 0xffff0000, v4
  v_mov_b32 v4, v61
  v_lshlrev_b32 v26, 16, v4
  v_and_b32 v27, 0xffff0000, v4
  v_mov_b32 v4, v62
  v_lshlrev_b32 v28, 16, v4
  v_and_b32 v29, 0xffff0000, v4
  v_mov_b32 v4, v63
  v_lshlrev_b32 v30, 16, v4
  v_and_b32 v31, 0xffff0000, v4
  v_mov_b32 v4, v64
  v_lshlrev_b32 v32, 16, v4
  v_and_b32 v33, 0xffff0000, v4
  v_mov_b32 v4, v65
  v_lshlrev_b32 v34, 16, v4
  v_and_b32 v35, 0xffff0000, v4
  v_mov_b32 v4, v66
  v_lshlrev_b32 v36, 16, v4
  v_and_b32 v37, 0xffff0000, v4
  v_mov_b32 v4, v67
  v_lshlrev_b32 v38, 16, v4
  v_and_b32 v39, 0xffff0000, v4
  v_mov_b32 v4, v68
  v_lshlrev_b32 v40, 16, v4
  v_and_b32 v41, 0xffff0000, v4
  v_mov_b32 v4, v69
  v_lshlrev_b32 v42, 16, v4
  v_and_b32 v43, 0xffff0000, v4
  v_mov_b32 v4, v70
  v_lshlrev_b32 v44, 16, v4
  v_and_b32 v45, 0xffff0000, v4
  v_mov_b32 v4, v71
  v_lshlrev_b32 v46, 16, v4
  v_and_b32 v47, 0xffff0000, v4
  v_mov_b32 v4, v72
  v_lshlrev_b32 v48, 16, v4
  v_and_b32 v49, 0xffff0000, v4
  v_mov_b32 v4, v73
  v_lshlrev_b32 v50, 16, v4
  v_and_b32 v51, 0xffff0000, v4
  v_mov_b32 v4, v74
  v_lshlrev_b32 v52, 16, v4
  v_and_b32 v53, 0xffff0000, v4
  v_mov_b32 v4, v75
  v_lshlrev_b32 v54, 16, v4
  v_and_b32 v55, 0xffff0000, v4
  v_mov_b32 v4, v76
  v_lshlrev_b32 v56, 16, v4
  v_and_b32 v57, 0xffff0000, v4
  v_mov_b32 v4, v77
  v_lshlrev_b32 v58, 16, v4
  v_and_b32 v59, 0xffff0000, v4
  v_mov_b32 v4, v78
  v_lshlrev_b32 v60, 16, v4
  v_and_b32 v61, 0xffff0000, v4
  v_mov_b32 v4, v79
  v_lshlrev_b32 v62, 16, v4
  v_and_b32 v63, 0xffff0000, v4
  v_mov_b32 v4, v80
  v_lshlrev_b32 v64, 16, v4
  v_and_b32 v65, 0xffff0000, v4
  v_mov_b32 v4, v81
  v_lshlrev_b32 v66, 16, v4
  v_and_b32 v67, 0xffff0000, v4
  v_mov_b32 v4, v82
  v_lshlrev_b32 v68, 16, v4
  v_and_b32 v69, 0xffff0000, v4
  v_mov_b32 v4, v83
  v_lshlrev_b32 v70, 16, v4
  v_and_b32 v71, 0xffff0000, v4
  v_mov_b32 v4, v84
  v_lshlrev_b32 v72, 16, v4
  v_and_b32 v73, 0xffff0000, v4
  v_mov_b32 v4, v85
  v_lshlrev_b32 v74, 16, v4
  v_and_b32 v75, 0xffff0000, v4
  v_mov_b32 v4, v86
  v_lshlrev_b32 v76, 16, v4
  v_and_b32 v77, 0xffff0000, v4
  v_mov_b32 v4, v87
  v_lshlrev_b32 v78, 16, v4
  v_and_b32 v79, 0xffff0000, v4
  v_mov_b32 v4, v88
  v_lshlrev_b32 v80, 16, v4
  v_and_b32 v81, 0xffff0000, v4
  v_mov_b32 v4, v89
  v_lshlrev_b32 v82, 16, v4
  v_and_b32 v83, 0xffff0000, v4
  v_mov_b32 v4, v90
  v_lshlrev_b32 v84, 16, v4
  v_and_b32 v85, 0xffff0000, v4
  v_mov_b32 v4, v91
  v_lshlrev_b32 v86, 16, v4
  v_and_b32 v87, 0xffff0000, v4
  v_mov_b32 v4, v92
  v_lshlrev_b32 v88, 16, v4
  v_and_b32 v89, 0xffff0000, v4
  v_mov_b32 v4, v93
  v_lshlrev_b32 v90, 16, v4
  v_and_b32 v91, 0xffff0000, v4
  v_mov_b32 v4, v94
  v_lshlrev_b32 v92, 16, v4
  v_and_b32 v93, 0xffff0000, v4
  v_mov_b32 v4, v95
  v_lshlrev_b32 v94, 16, v4
  v_and_b32 v95, 0xffff0000, v4
lnu_49_f:
  v_pk_add_f32 v[12:13], v[16:17], v[18:19]
  v_pk_add_f32 v[12:13], v[12:13], v[20:21]
  v_pk_add_f32 v[12:13], v[12:13], v[22:23]
  v_pk_add_f32 v[12:13], v[12:13], v[24:25]
  v_pk_add_f32 v[12:13], v[12:13], v[26:27]
  v_pk_add_f32 v[12:13], v[12:13], v[28:29]
  v_pk_add_f32 v[12:13], v[12:13], v[30:31]
  v_pk_add_f32 v[12:13], v[12:13], v[32:33]
  v_pk_add_f32 v[12:13], v[12:13], v[34:35]
  v_pk_add_f32 v[12:13], v[12:13], v[36:37]
  v_pk_add_f32 v[12:13], v[12:13], v[38:39]
  v_pk_add_f32 v[12:13], v[12:13], v[40:41]
  v_pk_add_f32 v[12:13], v[12:13], v[42:43]
  v_pk_add_f32 v[12:13], v[12:13], v[44:45]
  v_pk_add_f32 v[12:13], v[12:13], v[46:47]
  v_pk_add_f32 v[12:13], v[12:13], v[48:49]
  v_pk_add_f32 v[12:13], v[12:13], v[50:51]
  v_pk_add_f32 v[12:13], v[12:13], v[52:53]
  v_pk_add_f32 v[12:13], v[12:13], v[54:55]
  v_pk_add_f32 v[12:13], v[12:13], v[56:57]
  v_pk_add_f32 v[12:13], v[12:13], v[58:59]
  v_pk_add_f32 v[12:13], v[12:13], v[60:61]
  v_pk_add_f32 v[12:13], v[12:13], v[62:63]
  v_pk_add_f32 v[12:13], v[12:13], v[64:65]
  v_pk_add_f32 v[12:13], v[12:13], v[66:67]
  v_pk_add_f32 v[12:13], v[12:13], v[68:69]
  v_pk_add_f32 v[12:13], v[12:13], v[70:71]
  v_pk_add_f32 v[12:13], v[12:13], v[72:73]
  v_pk_add_f32 v[12:13], v[12:13], v[74:75]
  v_pk_add_f32 v[12:13], v[12:13], v[76:77]
  v_pk_add_f32 v[12:13], v[12:13], v[78:79]
  v_pk_add_f32 v[12:13], v[12:13], v[80:81]
  v_pk_add_f32 v[12:13], v[12:13], v[82:83]
  v_pk_add_f32 v[12:13], v[12:13], v[84:85]
  v_pk_add_f32 v[12:13], v[12:13], v[86:87]
  v_pk_add_f32 v[12:13], v[12:13], v[88:89]
  v_pk_add_f32 v[12:13], v[12:13], v[90:91]
  v_pk_add_f32 v[12:13], v[12:13], v[92:93]
  v_pk_add_f32 v[12:13], v[12:13], v[94:95]
  v_add_f32 v12, v12, v13
  s_nop 1
  v_add_f32_dpp v12, v12, v12 row_ror:8 row_mask:0xf bank_mask:0xf
  v_mov_b32 v13, v12
  s_nop 1
  v_permlane16_swap_b32 v12, v13
  v_add_f32 v12, v12, v13
  v_mov_b32 v13, v12
  s_nop 1
  v_permlane32_swap_b32 v12, v13
  v_add_f32 v12, v12, v13
  v_mul_f32 v12, 0xbacccccd, v12
  v_mov_b32 v13, v12
  v_pk_add_f32 v[16:17], v[16:17], v[12:13]
  v_pk_add_f32 v[18:19], v[18:19], v[12:13]
  v_pk_add_f32 v[20:21], v[20:21], v[12:13]
  v_pk_add_f32 v[22:23], v[22:23], v[12:13]
  v_pk_add_f32 v[24:25], v[24:25], v[12:13]
  v_pk_add_f32 v[26:27], v[26:27], v[12:13]
  v_pk_add_f32 v[28:29], v[28:29], v[12:13]
  v_pk_add_f32 v[30:31], v[30:31], v[12:13]
  v_pk_add_f32 v[32:33], v[32:33], v[12:13]
  v_pk_add_f32 v[34:35], v[34:35], v[12:13]
  v_pk_add_f32 v[36:37], v[36:37], v[12:13]
  v_pk_add_f32 v[38:39], v[38:39], v[12:13]
  v_pk_add_f32 v[40:41], v[40:41], v[12:13]
  v_pk_add_f32 v[42:43], v[42:43], v[12:13]
  v_pk_add_f32 v[44:45], v[44:45], v[12:13]
  v_pk_add_f32 v[46:47], v[46:47], v[12:13]
  v_pk_add_f32 v[48:49], v[48:49], v[12:13]
  v_pk_add_f32 v[50:51], v[50:51], v[12:13]
  v_pk_add_f32 v[52:53], v[52:53], v[12:13]
  v_pk_add_f32 v[54:55], v[54:55], v[12:13]
  v_pk_add_f32 v[56:57], v[56:57], v[12:13]
  v_pk_add_f32 v[58:59], v[58:59], v[12:13]
  v_pk_add_f32 v[60:61], v[60:61], v[12:13]
  v_pk_add_f32 v[62:63], v[62:63], v[12:13]
  v_pk_add_f32 v[64:65], v[64:65], v[12:13]
  v_pk_add_f32 v[66:67], v[66:67], v[12:13]
  v_pk_add_f32 v[68:69], v[68:69], v[12:13]
  v_pk_add_f32 v[70:71], v[70:71], v[12:13]
  v_pk_add_f32 v[72:73], v[72:73], v[12:13]
  v_pk_add_f32 v[74:75], v[74:75], v[12:13]
  v_pk_add_f32 v[76:77], v[76:77], v[12:13]
  v_pk_add_f32 v[78:79], v[78:79], v[12:13]
  v_pk_add_f32 v[80:81], v[80:81], v[12:13]
  v_pk_add_f32 v[82:83], v[82:83], v[12:13]
  v_pk_add_f32 v[84:85], v[84:85], v[12:13]
  v_pk_add_f32 v[86:87], v[86:87], v[12:13]
  v_pk_add_f32 v[88:89], v[88:89], v[12:13]
  v_pk_add_f32 v[90:91], v[90:91], v[12:13]
  v_pk_add_f32 v[92:93], v[92:93], v[12:13]
  v_pk_add_f32 v[94:95], v[94:95], v[12:13]
  v_pk_mul_f32 v[12:13], v[16:17], v[16:17]
  v_pk_fma_f32 v[12:13], v[18:19], v[18:19], v[12:13]
  v_pk_fma_f32 v[12:13], v[20:21], v[20:21], v[12:13]
  v_pk_fma_f32 v[12:13], v[22:23], v[22:23], v[12:13]
  v_pk_fma_f32 v[12:13], v[24:25], v[24:25], v[12:13]
  v_pk_fma_f32 v[12:13], v[26:27], v[26:27], v[12:13]
  v_pk_fma_f32 v[12:13], v[28:29], v[28:29], v[12:13]
  v_pk_fma_f32 v[12:13], v[30:31], v[30:31], v[12:13]
  v_pk_fma_f32 v[12:13], v[32:33], v[32:33], v[12:13]
  v_pk_fma_f32 v[12:13], v[34:35], v[34:35], v[12:13]
  v_pk_fma_f32 v[12:13], v[36:37], v[36:37], v[12:13]
  v_pk_fma_f32 v[12:13], v[38:39], v[38:39], v[12:13]
  v_pk_fma_f32 v[12:13], v[40:41], v[40:41], v[12:13]
  v_pk_fma_f32 v[12:13], v[42:43], v[42:43], v[12:13]
  v_pk_fma_f32 v[12:13], v[44:45], v[44:45], v[12:13]
  v_pk_fma_f32 v[12:13], v[46:47], v[46:47], v[12:13]
  v_pk_fma_f32 v[12:13], v[48:49], v[48:49], v[12:13]
  v_pk_fma_f32 v[12:13], v[50:51], v[50:51], v[12:13]
  v_pk_fma_f32 v[12:13], v[52:53], v[52:53], v[12:13]
  v_pk_fma_f32 v[12:13], v[54:55], v[54:55], v[12:13]
  v_pk_fma_f32 v[12:13], v[56:57], v[56:57], v[12:13]
  v_pk_fma_f32 v[12:13], v[58:59], v[58:59], v[12:13]
  v_pk_fma_f32 v[12:13], v[60:61], v[60:61], v[12:13]
  v_pk_fma_f32 v[12:13], v[62:63], v[62:63], v[12:13]
  v_pk_fma_f32 v[12:13], v[64:65], v[64:65], v[12:13]
  v_pk_fma_f32 v[12:13], v[66:67], v[66:67], v[12:13]
  v_pk_fma_f32 v[12:13], v[68:69], v[68:69], v[12:13]
  v_pk_fma_f32 v[12:13], v[70:71], v[70:71], v[12:13]
  v_pk_fma_f32 v[12:13], v[72:73], v[72:73], v[12:13]
  v_pk_fma_f32 v[12:13], v[74:75], v[74:75], v[12:13]
  v_pk_fma_f32 v[12:13], v[76:77], v[76:77], v[12:13]
  v_pk_fma_f32 v[12:13], v[78:79], v[78:79], v[12:13]
  v_pk_fma_f32 v[12:13], v[80:81], v[80:81], v[12:13]
  v_pk_fma_f32 v[12:13], v[82:83], v[82:83], v[12:13]
  v_pk_fma_f32 v[12:13], v[84:85], v[84:85], v[12:13]
  v_pk_fma_f32 v[12:13], v[86:87], v[86:87], v[12:13]
  v_pk_fma_f32 v[12:13], v[88:89], v[88:89], v[12:13]
  v_pk_fma_f32 v[12:13], v[90:91], v[90:91], v[12:13]
  v_pk_fma_f32 v[12:13], v[92:93], v[92:93], v[12:13]
  v_pk_fma_f32 v[12:13], v[94:95], v[94:95], v[12:13]
  v_add_f32 v12, v12, v13
  s_nop 1
  v_add_f32_dpp v12, v12, v12 row_ror:8 row_mask:0xf bank_mask:0xf
  v_mov_b32 v13, v12
  s_nop 1
  v_permlane16_swap_b32 v12, v13
  v_add_f32 v12, v12, v13
  v_mov_b32 v13, v12
  s_nop 1
  v_permlane32_swap_b32 v12, v13
  v_add_f32 v12, v12, v13
  v_mov_b32 v13, 0x3727c5ac
  v_fmac_f32 v13, 0x3acccccd, v12
  v_rsq_f32 v12, v13
  s_nop 0
  v_mov_b32 v13, v12
  v_pk_mul_f32 v[16:17], v[16:17], v[12:13]
  v_pk_mul_f32 v[18:19], v[18:19], v[12:13]
  v_pk_mul_f32 v[20:21], v[20:21], v[12:13]
  v_pk_mul_f32 v[22:23], v[22:23], v[12:13]
  v_pk_mul_f32 v[24:25], v[24:25], v[12:13]
  v_pk_mul_f32 v[26:27], v[26:27], v[12:13]
  v_pk_mul_f32 v[28:29], v[28:29], v[12:13]
  v_pk_mul_f32 v[30:31], v[30:31], v[12:13]
  v_pk_mul_f32 v[32:33], v[32:33], v[12:13]
  v_pk_mul_f32 v[34:35], v[34:35], v[12:13]
  v_pk_mul_f32 v[36:37], v[36:37], v[12:13]
  v_pk_mul_f32 v[38:39], v[38:39], v[12:13]
  v_pk_mul_f32 v[40:41], v[40:41], v[12:13]
  v_pk_mul_f32 v[42:43], v[42:43], v[12:13]
  v_pk_mul_f32 v[44:45], v[44:45], v[12:13]
  v_pk_mul_f32 v[46:47], v[46:47], v[12:13]
  v_pk_mul_f32 v[48:49], v[48:49], v[12:13]
  v_pk_mul_f32 v[50:51], v[50:51], v[12:13]
  v_pk_mul_f32 v[52:53], v[52:53], v[12:13]
  v_pk_mul_f32 v[54:55], v[54:55], v[12:13]
  v_pk_mul_f32 v[56:57], v[56:57], v[12:13]
  v_pk_mul_f32 v[58:59], v[58:59], v[12:13]
  v_pk_mul_f32 v[60:61], v[60:61], v[12:13]
  v_pk_mul_f32 v[62:63], v[62:63], v[12:13]
  v_pk_mul_f32 v[64:65], v[64:65], v[12:13]
  v_pk_mul_f32 v[66:67], v[66:67], v[12:13]
  v_pk_mul_f32 v[68:69], v[68:69], v[12:13]
  v_pk_mul_f32 v[70:71], v[70:71], v[12:13]
  v_pk_mul_f32 v[72:73], v[72:73], v[12:13]
  v_pk_mul_f32 v[74:75], v[74:75], v[12:13]
  v_pk_mul_f32 v[76:77], v[76:77], v[12:13]
  v_pk_mul_f32 v[78:79], v[78:79], v[12:13]
  v_pk_mul_f32 v[80:81], v[80:81], v[12:13]
  v_pk_mul_f32 v[82:83], v[82:83], v[12:13]
  v_pk_mul_f32 v[84:85], v[84:85], v[12:13]
  v_pk_mul_f32 v[86:87], v[86:87], v[12:13]
  v_pk_mul_f32 v[88:89], v[88:89], v[12:13]
  v_pk_mul_f32 v[90:91], v[90:91], v[12:13]
  v_pk_mul_f32 v[92:93], v[92:93], v[12:13]
  v_pk_mul_f32 v[94:95], v[94:95], v[12:13]
  v_cvt_pk_bf16_f32 v16, v16, v17
  v_cvt_pk_bf16_f32 v17, v18, v19
  v_cvt_pk_bf16_f32 v18, v20, v21
  v_cvt_pk_bf16_f32 v19, v22, v23
  v_cvt_pk_bf16_f32 v20, v24, v25
  v_cvt_pk_bf16_f32 v21, v26, v27
  v_cvt_pk_bf16_f32 v22, v28, v29
  v_cvt_pk_bf16_f32 v23, v30, v31
  v_cvt_pk_bf16_f32 v24, v32, v33
  v_cvt_pk_bf16_f32 v25, v34, v35
  v_cvt_pk_bf16_f32 v26, v36, v37
  v_cvt_pk_bf16_f32 v27, v38, v39
  v_cvt_pk_bf16_f32 v28, v40, v41
  v_cvt_pk_bf16_f32 v29, v42, v43
  v_cvt_pk_bf16_f32 v30, v44, v45
  v_cvt_pk_bf16_f32 v31, v46, v47
  v_cvt_pk_bf16_f32 v32, v48, v49
  v_cvt_pk_bf16_f32 v33, v50, v51
  v_cvt_pk_bf16_f32 v34, v52, v53
  v_cvt_pk_bf16_f32 v35, v54, v55
  v_cvt_pk_bf16_f32 v36, v56, v57
  v_cvt_pk_bf16_f32 v37, v58, v59
  v_cvt_pk_bf16_f32 v38, v60, v61
  v_cvt_pk_bf16_f32 v39, v62, v63
  v_cvt_pk_bf16_f32 v40, v64, v65
  v_cvt_pk_bf16_f32 v41, v66, v67
  v_cvt_pk_bf16_f32 v42, v68, v69
  v_cvt_pk_bf16_f32 v43, v70, v71
  v_cvt_pk_bf16_f32 v44, v72, v73
  v_cvt_pk_bf16_f32 v45, v74, v75
  v_cvt_pk_bf16_f32 v46, v76, v77
  v_cvt_pk_bf16_f32 v47, v78, v79
  v_cvt_pk_bf16_f32 v48, v80, v81
  v_cvt_pk_bf16_f32 v49, v82, v83
  v_cvt_pk_bf16_f32 v50, v84, v85
  v_cvt_pk_bf16_f32 v51, v86, v87
  v_cvt_pk_bf16_f32 v52, v88, v89
  v_cvt_pk_bf16_f32 v53, v90, v91
  v_cvt_pk_bf16_f32 v54, v92, v93
  v_cvt_pk_bf16_f32 v55, v94, v95
  s_mul_i32 s48, s46, 40960
  s_add_u32 s48, s48, s47
  s_add_u32 s48, s48, 0x100000
  s_add_u32 s49, s48, 0
  buffer_store_dwordx4 v[16:19], v10, s[8:11], s49 offen sc1
  s_add_u32 s49, s48, 4096
  buffer_store_dwordx4 v[20:23], v10, s[8:11], s49 offen sc1
  s_add_u32 s49, s48, 8192
  buffer_store_dwordx4 v[24:27], v10, s[8:11], s49 offen sc1
  s_add_u32 s49, s48, 12288
  buffer_store_dwordx4 v[28:31], v10, s[8:11], s49 offen sc1
  s_add_u32 s49, s48, 16384
  buffer_store_dwordx4 v[32:35], v10, s[8:11], s49 offen sc1
  s_add_u32 s49, s48, 20480
  buffer_store_dwordx4 v[36:39], v10, s[8:11], s49 offen sc1
  s_add_u32 s49, s48, 24576
  buffer_store_dwordx4 v[40:43], v10, s[8:11], s49 offen sc1
  s_add_u32 s49, s48, 28672
  buffer_store_dwordx4 v[44:47], v10, s[8:11], s49 offen sc1
  s_add_u32 s49, s48, 32768
  buffer_store_dwordx4 v[48:51], v10, s[8:11], s49 offen sc1
  s_add_u32 s49, s48, 36864
  buffer_store_dwordx4 v[52:55], v10, s[8:11], s49 offen sc1
lnu_49_x:
  s_cmp_eq_u32 s21, 0
  s_cbranch_scc0 ka_cen_done
  s_mov_b64 s[24:25], exec
  s_mov_b64 exec, 1
  v_mov_b32 v3, 1
  s_lshl_b32 s27, s26, 2
  v_mov_b32 v4, s27
  global_atomic_add v5, v4, v3, s[6:7] sc0
  v_mov_b32 v4, 64
  s_waitcnt vmcnt(0)
  global_atomic_add v6, v4, v3, s[6:7] sc0
  s_mov_b32 s45, 0
  s_waitcnt vmcnt(0)
ka_cen_spin:
  global_load_dword v7, v4, s[6:7] sc1
  s_add_u32 s45, s45, 1
  s_waitcnt vmcnt(0)
  v_readfirstlane_b32 s27, v7
  s_cmp_ge_u32 s27, 256
  s_cbranch_scc1 ka_cen_ok
  s_cmp_lt_u32 s45, 400000
  s_cbranch_scc1 ka_cen_spin
ka_cen_ok:
  s_mov_b64 exec, 0xff
  v_lshlrev_b32 v4, 2, v0
  global_load_dword v7, v4, s[6:7] sc1
  s_waitcnt vmcnt(0)
  v_cmp_ne_u32 vcc, 32, v7
  s_nop 1
  s_cmp_eq_u64 vcc, 0
  s_cselect_b32 s27, 1, 0
  s_cmp_ge_u32 s27, 1
  s_cselect_b32 s27, 1, 0
  s_mov_b64 exec, 1
  v_mov_b32 v8, s27
  v_mov_b32 v4, 0
  v_mov_b32 v9, 0
  ds_write_b128 v4, v[6:9]
  ds_write_b32 v4, v5 offset:16
  s_waitcnt lgkmcnt(0)
  s_mov_b64 exec, s[24:25]
ka_cen_done:
  s_barrier
  v_mov_b32 v4, 0
  ds_read_b128 v[6:9], v4
  ds_read_b32 v5, v4 offset:16
  s_waitcnt lgkmcnt(0)
  v_readfirstlane_b32 s27, v6
  v_readfirstlane_b32 s44, v8
  v_readfirstlane_b32 s28, v5
  s_barrier
  s_cmp_eq_u32 s44, 1
  s_cbranch_scc1 ka_cen_fast
  s_lshr_b32 s20, s27, 5
  s_and_b32 s22, s27, 31
  s_branch ka_cen_end
ka_cen_fast:
  s_mov_b32 s20, s26
  s_mov_b32 s22, s28
ka_cen_end:
  s_and_b32 s20, s20, 7
  s_and_b32 s22, s22, 31
  s_cmp_lt_u32 s20, 4
  s_cbranch_scc0 ka_bulk
  s_cmp_lt_u32 s22, 8
  s_cbranch_scc0 ka_noty
  s_lshl_b32 s23, s20, 3
  s_add_u32 s23, s23, s22
  s_cmp_eq_u32 s44, 1
  s_cbranch_scc1 kaf_x
  s_branch kas_x
ka_noty:
  s_cmp_lt_u32 s22, 28
  s_cbranch_scc0 ka_spare
  s_sub_u32 s23, s22, 8
  s_cmp_eq_u32 s44, 1
  s_cbranch_scc1 kaf_y
  s_branch kas_y
ka_bulk:
  s_sub_u32 s28, s20, 4
  s_lshl_b32 s23, s22, 2
  s_add_u32 s23, s23, s28
  s_cmp_lt_u32 s23, 72
  s_cbranch_scc1 ka_qkv
  s_sub_u32 s23, s23, 72
  s_cmp_lt_u32 s23, 32
  s_cbranch_scc1 ka_u
  s_sub_u32 s23, s23, 32
  s_branch ka_ln
ka_ln:
  v_and_b32 v1, 63, v0
  s_lshl_b32 s46, s23, 2
  s_add_u32 s46, s46, s21
  v_and_b32 v5, 7, v1
  v_bfe_u32 v6, v1, 3, 1
  v_lshrrev_b32 v7, 4, v1
  v_lshlrev_b32 v8, 5, v6
  v_add_u32 v8, v8, v5
  v_lshlrev_b32 v8, 4, v8
  v_lshlrev_b32 v9, 11, v7
  v_add_u32 v9, v9, v8
  v_lshlrev_b32 v10, 10, v7
  v_add_u32 v10, v10, v8
  v_mul_u32_u24 v11, 1280, v5
  v_lshlrev_b32 v12, 5, v7
  v_add_u32 v11, v11, v12
  v_lshlrev_b32 v12, 4, v6
  v_add_u32 v11, v11, v12
  s_load_dwordx2 s[36:37], s[0:1], 0
  s_load_dwordx4 s[40:43], s[0:1], 64
  s_waitcnt lgkmcnt(0)
  s_mov_b32 s12, s36
  s_and_b32 s13, s37, 0xffff
  s_mov_b32 s14, 0x280000
  s_mov_b32 s15, 0x20000

  s_cmp_eq_u32 s21, 3
  s_cbranch_scc0 lna_50
  s_waitcnt vmcnt(0)
  s_mov_b64 s[24:25], exec
  s_mov_b64 exec, 1
  v_mov_b32 v2, 4992
  v_mov_b32 v3, 1
  buffer_atomic_add v3, v2, s[8:11], 0 offen
  s_mov_b64 exec, s[24:25]
lna_50:
  s_cmp_eq_u32 s99, 0
  s_cbranch_scc0 ka_lnx
  s_mov_b32 s12, s42
  s_and_b32 s13, s43, 0xffff
  s_mov_b32 s14, 0xc8000
  s_mov_b32 s15, 0x20000
  s_mov_b32 s16, s40
  s_and_b32 s17, s41, 0xffff
  s_mov_b32 s18, 0x258000
  s_mov_b32 s19, 0x20000
  v_lshlrev_b32 v2, 4, v1
  v_and_b32 v8, 31, v1
  v_lshrrev_b32 v9, 5, v1
  v_lshrrev_b32 v10, 4, v8
  v_lshlrev_b32 v10, 4, v10
  v_bfe_u32 v11, v8, 2, 1
  v_lshlrev_b32 v11, 3, v11
  v_add_u32 v10, v10, v11
  v_bfe_u32 v11, v8, 3, 1
  v_lshlrev_b32 v11, 2, v11
  v_add_u32 v10, v10, v11
  v_and_b32 v11, 3, v8
  v_add_u32 v10, v10, v11
  v_mul_u32_u24 v12, 30720, v9
  v_lshlrev_b32 v13, 1, v10
  v_add_u32 v13, v13, v12
  v_lshlrev_b32 v14, 1, v8
  v_add_u32 v14, v14, v12
  v_cmp_gt_u32 s[50:51], 20, v10
  v_cmp_gt_u32 s[52:53], 20, v8
  v_lshrrev_b32 v15, 4, v1
  v_mul_u32_u24 v15, 10240, v15
  v_and_b32 v16, 15, v1
  v_lshlrev_b32 v16, 1, v16
  v_add_u32 v15, v15, v16
  s_mov_b32 s46, s23
ka_gl:
  s_barrier
  s_cmp_lt_u32 s46, 40
  s_cbranch_scc0 ka_gwo
  s_mul_i32 s28, s46, 61440
  s_lshl_b32 s29, s21, 10
  s_add_u32 s29, s29, 0
  s_mov_b32 m0, s29
  s_add_u32 s30, s28, s29
  buffer_load_dwordx4 v2, s[16:19], s30 offen lds
  s_lshl_b32 s29, s21, 10
  s_add_u32 s29, s29, 4096
  s_mov_b32 m0, s29
  s_add_u32 s30, s28, s29
  buffer_load_dwordx4 v2, s[16:19], s30 offen lds
  s_lshl_b32 s29, s21, 10
  s_add_u32 s29, s29, 8192
  s_mov_b32 m0, s29
  s_add_u32 s30, s28, s29
  buffer_load_dwordx4 v2, s[16:19], s30 offen lds
  s_lshl_b32 s29, s21, 10
  s_add_u32 s29, s29, 12288
  s_mov_b32 m0, s29
  s_add_u32 s30, s28, s29
  buffer_load_dwordx4 v2, s[16:19], s30 offen lds
  s_lshl_b32 s29, s21, 10
  s_add_u32 s29, s29, 16384
  s_mov_b32 m0, s29
  s_add_u32 s30, s28, s29
  buffer_load_dwordx4 v2, s[16:19], s30 offen lds
  s_lshl_b32 s29, s21, 10
  s_add_u32 s29, s29, 20480
  s_mov_b32 m0, s29
  s_add_u32 s30, s28, s29
  buffer_load_dwordx4 v2, s[16:19], s30 offen lds
  s_lshl_b32 s29, s21, 10
  s_add_u32 s29, s29, 24576
  s_mov_b32 m0, s29
  s_add_u32 s30, s28, s29
  buffer_load_dwordx4 v2, s[16:19], s30 offen lds
  s_lshl_b32 s29, s21, 10
  s_add_u32 s29, s29, 28672
  s_mov_b32 m0, s29
  s_add_u32 s30, s28, s29
  buffer_load_dwordx4 v2, s[16:19], s30 offen lds
  s_lshl_b32 s29, s21, 10
  s_add_u32 s29, s29, 32768
  s_mov_b32 m0, s29
  s_add_u32 s30, s28, s29
  buffer_load_dwordx4 v2, s[16:19], s30 offen lds
  s_lshl_b32 s29, s21, 10
  s_add_u32 s29, s29, 36864
  s_mov_b32 m0, s29
  s_add_u32 s30, s28, s29
  buffer_load_dwordx4 v2, s[16:19], s30 offen lds
  s_lshl_b32 s29, s21, 10
  s_add_u32 s29, s29, 40960
  s_mov_b32 m0, s29
  s_add_u32 s30, s28, s29
  buffer_load_dwordx4 v2, s[16:19], s30 offen lds
  s_lshl_b32 s29, s21, 10
  s_add_u32 s29, s29, 45056
  s_mov_b32 m0, s29
  s_add_u32 s30, s28, s29
  buffer_load_dwordx4 v2, s[16:19], s30 offen lds
  s_lshl_b32 s29, s21, 10
  s_add_u32 s29, s29, 49152
  s_mov_b32 m0, s29
  s_add_u32 s30, s28, s29
  buffer_load_dwordx4 v2, s[16:19], s30 offen lds
  s_lshl_b32 s29, s21, 10
  s_add_u32 s29, s29, 53248
  s_mov_b32 m0, s29
  s_add_u32 s30, s28, s29
  buffer_load_dwordx4 v2, s[16:19], s30 offen lds
  s_lshl_b32 s29, s21, 10
  s_add_u32 s29, s29, 57344
  s_mov_b32 m0, s29
  s_add_u32 s30, s28, s29
  buffer_load_dwordx4 v2, s[16:19], s30 offen lds
  s_waitcnt vmcnt(0)
  s_barrier
  s_lshl_b32 s47, s21, 3
ka_gh:
  s_mul_i32 s28, s47, 40
  s_add_u32 s28, s28, 0
  v_add_u32 v17, s28, v13
  ds_read_u16 v20, v17 offset:0
  ds_read_u16 v21, v17 offset:3840
  ds_read_u16 v22, v17 offset:7680
  ds_read_u16 v23, v17 offset:11520
  ds_read_u16 v24, v17 offset:15360
  ds_read_u16 v25, v17 offset:19200
  ds_read_u16 v26, v17 offset:23040
  ds_read_u16 v27, v17 offset:26880
  s_waitcnt lgkmcnt(0)
  v_lshl_or_b32 v28, v21, 16, v20
  v_cndmask_b32 v28, 0, v28, s[50:51]
  v_lshl_or_b32 v29, v23, 16, v22
  v_cndmask_b32 v29, 0, v29, s[50:51]
  v_lshl_or_b32 v30, v25, 16, v24
  v_cndmask_b32 v30, 0, v30, s[50:51]
  v_lshl_or_b32 v31, v27, 16, v26
  v_cndmask_b32 v31, 0, v31, s[50:51]
  s_mul_i32 s28, s47, 3
  s_add_u32 s28, s28, 0
  s_mul_i32 s28, s28, 40
  s_add_u32 s28, s28, s46
  s_lshl_b32 s28, s28, 10
  s_add_u32 s28, s28, 0xe100000
  buffer_store_dwordx4 v[28:31], v2, s[8:11], s28 offen
  s_nop 1
  s_mul_i32 s28, s47, 40
  s_add_u32 s28, s28, 1280
  v_add_u32 v17, s28, v13
  ds_read_u16 v20, v17 offset:0
  ds_read_u16 v21, v17 offset:3840
  ds_read_u16 v22, v17 offset:7680
  ds_read_u16 v23, v17 offset:11520
  ds_read_u16 v24, v17 offset:15360
  ds_read_u16 v25, v17 offset:19200
  ds_read_u16 v26, v17 offset:23040
  ds_read_u16 v27, v17 offset:26880
  s_waitcnt lgkmcnt(0)
  v_lshl_or_b32 v28, v21, 16, v20
  v_cndmask_b32 v28, 0, v28, s[50:51]
  v_lshl_or_b32 v29, v23, 16, v22
  v_cndmask_b32 v29, 0, v29, s[50:51]
  v_lshl_or_b32 v30, v25, 16, v24
  v_cndmask_b32 v30, 0, v30, s[50:51]
  v_lshl_or_b32 v31, v27, 16, v26
  v_cndmask_b32 v31, 0, v31, s[50:51]
  s_mul_i32 s28, s47, 3
  s_add_u32 s28, s28, 1
  s_mul_i32 s28, s28, 40
  s_add_u32 s28, s28, s46
  s_lshl_b32 s28, s28, 10
  s_add_u32 s28, s28, 0xe100000
  buffer_store_dwordx4 v[28:31], v2, s[8:11], s28 offen
  s_nop 1
  s_mul_i32 s28, s47, 40
  s_add_u32 s28, s28, 2560
  v_add_u32 v17, s28, v14
  ds_read_u16 v20, v17 offset:0
  ds_read_u16 v21, v17 offset:3840
  ds_read_u16 v22, v17 offset:7680
  ds_read_u16 v23, v17 offset:11520
  ds_read_u16 v24, v17 offset:15360
  ds_read_u16 v25, v17 offset:19200
  ds_read_u16 v26, v17 offset:23040
  ds_read_u16 v27, v17 offset:26880
  s_waitcnt lgkmcnt(0)
  v_lshl_or_b32 v28, v21, 16, v20
  v_cndmask_b32 v28, 0, v28, s[52:53]
  v_lshl_or_b32 v29, v23, 16, v22
  v_cndmask_b32 v29, 0, v29, s[52:53]
  v_lshl_or_b32 v30, v25, 16, v24
  v_cndmask_b32 v30, 0, v30, s[52:53]
  v_lshl_or_b32 v31, v27, 16, v26
  v_cndmask_b32 v31, 0, v31, s[52:53]
  s_mul_i32 s28, s47, 3
  s_add_u32 s28, s28, 2
  s_mul_i32 s28, s28, 40
  s_add_u32 s28, s28, s46
  s_lshl_b32 s28, s28, 10
  s_add_u32 s28, s28, 0xe100000
  buffer_store_dwordx4 v[28:31], v2, s[8:11], s28 offen
  s_nop 1
  s_add_u32 s47, s47, 1
  s_and_b32 s28, s47, 7
  s_cmp_lg_u32 s28, 0
  s_cbranch_scc1 ka_gh
  s_branch ka_gn
ka_gwo:
  s_sub_u32 s48, s46, 40
  s_mul_i32 s28, s48, 40960
  s_lshl_b32 s29, s21, 10
  s_add_u32 s29, s29, 0
  s_mov_b32 m0, s29
  s_add_u32 s30, s28, s29
  buffer_load_dwordx4 v2, s[12:15], s30 offen lds
  s_lshl_b32 s29, s21, 10
  s_add_u32 s29, s29, 4096
  s_mov_b32 m0, s29
  s_add_u32 s30, s28, s29
  buffer_load_dwordx4 v2, s[12:15], s30 offen lds
  s_lshl_b32 s29, s21, 10
  s_add_u32 s29, s29, 8192
  s_mov_b32 m0, s29
  s_add_u32 s30, s28, s29
  buffer_load_dwordx4 v2, s[12:15], s30 offen lds
  s_lshl_b32 s29, s21, 10
  s_add_u32 s29, s29, 12288
  s_mov_b32 m0, s29
  s_add_u32 s30, s28, s29
  buffer_load_dwordx4 v2, s[12:15], s30 offen lds
  s_lshl_b32 s29, s21, 10
  s_add_u32 s29, s29, 16384
  s_mov_b32 m0, s29
  s_add_u32 s30, s28, s29
  buffer_load_dwordx4 v2, s[12:15], s30 offen lds
  s_lshl_b32 s29, s21, 10
  s_add_u32 s29, s29, 20480
  s_mov_b32 m0, s29
  s_add_u32 s30, s28, s29
  buffer_load_dwordx4 v2, s[12:15], s30 offen lds
  s_lshl_b32 s29, s21, 10
  s_add_u32 s29, s29, 24576
  s_mov_b32 m0, s29
  s_add_u32 s30, s28, s29
  buffer_load_dwordx4 v2, s[12:15], s30 offen lds
  s_lshl_b32 s29, s21, 10
  s_add_u32 s29, s29, 28672
  s_mov_b32 m0, s29
  s_add_u32 s30, s28, s29
  buffer_load_dwordx4 v2, s[12:15], s30 offen lds
  s_lshl_b32 s29, s21, 10
  s_add_u32 s29, s29, 32768
  s_mov_b32 m0, s29
  s_add_u32 s30, s28, s29
  buffer_load_dwordx4 v2, s[12:15], s30 offen lds
  s_lshl_b32 s29, s21, 10
  s_add_u32 s29, s29, 36864
  s_mov_b32 m0, s29
  s_add_u32 s30, s28, s29
  buffer_load_dwordx4 v2, s[12:15], s30 offen lds
  s_waitcnt vmcnt(0)
  s_barrier
  s_mul_i32 s47, s21, 10
  s_add_u32 s49, s47, 10
ka_gc:
  s_lshl_b32 s28, s47, 5
  v_add_u32 v17, s28, v15
  ds_read_u16 v20, v17 offset:0
  ds_read_u16 v21, v17 offset:1280
  ds_read_u16 v22, v17 offset:2560
  ds_read_u16 v23, v17 offset:3840
  ds_read_u16 v24, v17 offset:5120
  ds_read_u16 v25, v17 offset:6400
  ds_read_u16 v26, v17 offset:7680
  ds_read_u16 v27, v17 offset:8960
  s_waitcnt lgkmcnt(0)
  v_lshl_or_b32 v28, v21, 16, v20
  v_lshl_or_b32 v29, v23, 16, v22
  v_lshl_or_b32 v30, v25, 16, v24
  v_lshl_or_b32 v31, v27, 16, v26
  s_mul_i32 s28, s47, 20
  s_add_u32 s28, s28, s48
  s_lshl_b32 s28, s28, 10
  s_add_u32 s28, s28, 0xe000000
  buffer_store_dwordx4 v[28:31], v2, s[8:11], s28 offen
  s_add_u32 s47, s47, 1
  s_cmp_lt_u32 s47, s49
  s_cbranch_scc1 ka_gc
ka_gn:
  s_add_u32 s46, s46, 24
  s_cmp_lt_u32 s46, 60
  s_cbranch_scc1 ka_gl
ka_lnx:
  s_waitcnt vmcnt(0)
  s_branch ka_exit
ka_spare:
  s_cmp_eq_u32 s21, 3
  s_cbranch_scc0 lna_51
  s_waitcnt vmcnt(0)
  s_mov_b64 s[24:25], exec
  s_mov_b64 exec, 1
  v_mov_b32 v2, 4992
  v_mov_b32 v3, 1
  buffer_atomic_add v3, v2, s[8:11], 0 offen
  s_mov_b64 exec, s[24:25]
lna_51:
ka_pf:
  v_and_b32 v1, 63, v0
  v_lshlrev_b32 v4, 6, v1
  s_sub_u32 s46, s22, 28
  s_lshl_b32 s46, s46, 2
  s_add_u32 s46, s46, s21
  s_mul_i32 s28, s20, 24
  v_and_b32 v5, 15, v1
  v_min_u32 v5, 11, v5
  v_cmp_le_u32 vcc, 6, v5
  v_subrev_u32 v6, 6, v5
  v_mov_b32 v7, 0x400
  v_cndmask_b32 v5, v5, v6, vcc
  v_cndmask_b32 v7, 0, v7, vcc
  v_lshlrev_b32 v5, 2, v5
  v_add_u32 v5, v5, v7
  s_add_u32 s28, s28, 0
  v_add_u32 v5, s28, v5
  v_and_b32 v6, 7, v1
  v_lshlrev_b32 v6, 2, v6
  s_lshl_b32 s28, s20, 5
  s_add_u32 s28, s28, 3072
  v_add_u32 v6, s28, v6
  s_mul_i32 s47, s20, 327680
  s_mul_i32 s28, s46, 20480
  s_add_u32 s47, s47, s28
  s_add_u32 s47, s47, 0x9000000
  s_mul_i32 s28, s46, 3
  s_add_u32 s28, s28, 0
  s_cmp_ge_u32 s28, 24
  s_cselect_b32 s29, 0x1800000, 0
  s_cselect_b32 s30, 24, 0
  s_sub_u32 s28, s28, s30
  s_mul_i32 s30, s28, 43
  s_lshr_b32 s30, s30, 7
  s_mul_i32 s31, s30, 3
  s_sub_u32 s31, s28, s31
  s_lshl_b32 s28, s20, 3
  s_add_u32 s30, s30, s28
  s_mul_i32 s30, s30, 786432
  s_lshl_b32 s31, s31, 12
  s_add_u32 s30, s30, s31
  s_add_u32 s30, s30, 0x4800000
  s_add_u32 s48, s30, s29
  s_mul_i32 s28, s46, 3
  s_add_u32 s28, s28, 1
  s_cmp_ge_u32 s28, 24
  s_cselect_b32 s29, 0x1800000, 0
  s_cselect_b32 s30, 24, 0
  s_sub_u32 s28, s28, s30
  s_mul_i32 s30, s28, 43
  s_lshr_b32 s30, s30, 7
  s_mul_i32 s31, s30, 3
  s_sub_u32 s31, s28, s31
  s_lshl_b32 s28, s20, 3
  s_add_u32 s30, s30, s28
  s_mul_i32 s30, s30, 786432
  s_lshl_b32 s31, s31, 12
  s_add_u32 s30, s30, s31
  s_add_u32 s30, s30, 0x4800000
  s_add_u32 s49, s30, s29
  s_mul_i32 s28, s46, 3
  s_add_u32 s28, s28, 2
  s_cmp_ge_u32 s28, 24
  s_cselect_b32 s29, 0x1800000, 0
  s_cselect_b32 s30, 24, 0
  s_sub_u32 s28, s28, s30
  s_mul_i32 s30, s28, 43
  s_lshr_b32 s30, s30, 7
  s_mul_i32 s31, s30, 3
  s_sub_u32 s31, s28, s31
  s_lshl_b32 s28, s20, 3
  s_add_u32 s30, s30, s28
  s_mul_i32 s30, s30, 786432
  s_lshl_b32 s31, s31, 12
  s_add_u32 s30, s30, s31
  s_add_u32 s30, s30, 0x4800000
  s_add_u32 s50, s30, s29
  s_mul_i32 s28, s20, 327680
  s_add_u32 s28, s28, 0x700000
  s_lshl_b32 s29, s46, 12
  s_add_u32 s51, s28, s29
  s_mov_b32 s52, 5120
  s_cmp_ge_u32 s46, 2
  s_cbranch_scc0 ka_pf1
  s_mul_i32 s28, s20, 655360
  s_add_u32 s28, s28, 0x402800
  s_sub_u32 s29, s46, 2
  s_lshl_b32 s29, s29, 12
  s_add_u32 s51, s28, s29
  s_mov_b32 s52, 10240
  s_cmp_ge_u32 s46, 5
  s_cbranch_scc0 ka_pf1
  s_mul_i32 s28, s20, 1310720
  s_add_u32 s28, s28, 0xe00000
  s_sub_u32 s29, s46, 5
  s_lshl_b32 s29, s29, 12
  s_add_u32 s51, s28, s29
  s_mov_b32 s52, 20480
ka_pf1:
  s_mul_i32 s53, s20, 655360
  s_add_u32 s53, s53, 0x400000
  s_mov_b32 s54, 0
  s_mov_b32 s55, 0
  s_mov_b32 s56, 0
  v_mov_b32 v7, 0
ka_pfl:
  s_cmp_gt_u32 s54, 3
  s_cbranch_scc0 ka_pfgo
  s_sub_u32 s28, s54, 3
  s_mul_i32 s28, s28, 10240
  s_add_u32 s28, s28, s53
  s_mov_b32 s45, 0
ka_pfw:
  buffer_load_dword v8, v7, s[8:11], s28 offen sc1
  s_add_u32 s45, s45, 1
  s_waitcnt vmcnt(0)
  v_readfirstlane_b32 s29, v8
  s_cmp_lg_u32 s29, -1
  s_cbranch_scc1 ka_pfgo
  s_sleep 4
  s_cmp_lt_u32 s45, 400000
  s_cbranch_scc1 ka_pfw
  s_branch ka_exit
ka_pfgo:
  s_cmp_eq_u32 s54, 6
  s_cbranch_scc0 ka_pfnm
  s_cmp_eq_u32 s20, 0
  s_cbranch_scc0 ka_pfnm
  s_cmp_eq_u32 s46, 15
  s_cbranch_scc0 ka_pfnm
  v_and_b32 v8, 7, v1
  v_lshlrev_b32 v8, 8, v8
  v_bfe_u32 v9, v1, 3, 1
  v_lshlrev_b32 v9, 13, v9
  v_add_u32 v8, v8, v9
  s_mov_b32 s28, 0xaa0000
  buffer_store_dword v7, v8, s[8:11], s28 offen sc1
  s_waitcnt vmcnt(0)
  s_mov_b64 s[24:25], exec
  s_mov_b64 exec, 1
  s_mov_b32 s30, -1
  s_mov_b32 s31, -1
  s_mov_b32 s28, 0xaa0000
  s_memtime s[32:33]
  s_waitcnt lgkmcnt(0)
  buffer_load_dword v9, v7, s[8:11], s28 offen sc1
  s_waitcnt vmcnt(0)
  s_memtime s[34:35]
  s_waitcnt lgkmcnt(0)
  s_sub_u32 s34, s34, s32
  s_min_u32 s30, s30, s34
  s_mov_b32 s28, 0xaa2000
  s_memtime s[32:33]
  s_waitcnt lgkmcnt(0)
  buffer_load_dword v9, v7, s[8:11], s28 offen sc1
  s_waitcnt vmcnt(0)
  s_memtime s[34:35]
  s_waitcnt lgkmcnt(0)
  s_sub_u32 s34, s34, s32
  s_min_u32 s31, s31, s34
  s_mov_b32 s28, 0xaa0100
  s_memtime s[32:33]
  s_waitcnt lgkmcnt(0)
  buffer_load_dword v9, v7, s[8:11], s28 offen sc1
  s_waitcnt vmcnt(0)
  s_memtime s[34:35]
  s_waitcnt lgkmcnt(0)
  s_sub_u32 s34, s34, s32
  s_min_u32 s30, s30, s34
  s_mov_b32 s28, 0xaa2100
  s_memtime s[32:33]
  s_waitcnt lgkmcnt(0)
  buffer_load_dword v9, v7, s[8:11], s28 offen sc1
  s_waitcnt vmcnt(0)
  s_memtime s[34:35]
  s_waitcnt lgkmcnt(0)
  s_sub_u32 s34, s34, s32
  s_min_u32 s31, s31, s34
  s_mov_b32 s28, 0xaa0200
  s_memtime s[32:33]
  s_waitcnt lgkmcnt(0)
  buffer_load_dword v9, v7, s[8:11], s28 offen sc1
  s_waitcnt vmcnt(0)
  s_memtime s[34:35]
  s_waitcnt lgkmcnt(0)
  s_sub_u32 s34, s34, s32
  s_min_u32 s30, s30, s34
  s_mov_b32 s28, 0xaa2200
  s_memtime s[32:33]
  s_waitcnt lgkmcnt(0)
  buffer_load_dword v9, v7, s[8:11], s28 offen sc1
  s_waitcnt vmcnt(0)
  s_memtime s[34:35]
  s_waitcnt lgkmcnt(0)
  s_sub_u32 s34, s34, s32
  s_min_u32 s31, s31, s34
  s_mov_b32 s28, 0xaa0300
  s_memtime s[32:33]
  s_waitcnt lgkmcnt(0)
  buffer_load_dword v9, v7, s[8:11], s28 offen sc1
  s_waitcnt vmcnt(0)
  s_memtime s[34:35]
  s_waitcnt lgkmcnt(0)
  s_sub_u32 s34, s34, s32
  s_min_u32 s30, s30, s34
  s_mov_b32 s28, 0xaa2300
  s_memtime s[32:33]
  s_waitcnt lgkmcnt(0)
  buffer_load_dword v9, v7, s[8:11], s28 offen sc1
  s_waitcnt vmcnt(0)
  s_memtime s[34:35]
  s_waitcnt lgkmcnt(0)
  s_sub_u32 s34, s34, s32
  s_min_u32 s31, s31, s34
  s_mov_b32 s28, 0xaa0400
  s_memtime s[32:33]
  s_waitcnt lgkmcnt(0)
  buffer_load_dword v9, v7, s[8:11], s28 offen sc1
  s_waitcnt vmcnt(0)
  s_memtime s[34:35]
  s_waitcnt lgkmcnt(0)
  s_sub_u32 s34, s34, s32
  s_min_u32 s30, s30, s34
  s_mov_b32 s28, 0xaa2400
  s_memtime s[32:33]
  s_waitcnt lgkmcnt(0)
  buffer_load_dword v9, v7, s[8:11], s28 offen sc1
  s_waitcnt vmcnt(0)
  s_memtime s[34:35]
  s_waitcnt lgkmcnt(0)
  s_sub_u32 s34, s34, s32
  s_min_u32 s31, s31, s34
  s_mov_b32 s28, 0xaa0500
  s_memtime s[32:33]
  s_waitcnt lgkmcnt(0)
  buffer_load_dword v9, v7, s[8:11], s28 offen sc1
  s_waitcnt vmcnt(0)
  s_memtime s[34:35]
  s_waitcnt lgkmcnt(0)
  s_sub_u32 s34, s34, s32
  s_min_u32 s30, s30, s34
  s_mov_b32 s28, 0xaa2500
  s_memtime s[32:33]
  s_waitcnt lgkmcnt(0)
  buffer_load_dword v9, v7, s[8:11], s28 offen sc1
  s_waitcnt vmcnt(0)
  s_memtime s[34:35]
  s_waitcnt lgkmcnt(0)
  s_sub_u32 s34, s34, s32
  s_min_u32 s31, s31, s34
  s_cmp_le_u32 s30, s31
  s_cselect_b32 s28, 1, 2
  v_mov_b32 v9, s28
  v_mov_b32 v8, 5056
  buffer_store_dword v9, v8, s[8:11], 0 offen sc1
  v_mov_b32 v9, s30
  buffer_store_dword v9, v8, s[8:11], 0 offen offset:4 sc1
  v_mov_b32 v9, s31
  buffer_store_dword v9, v8, s[8:11], 0 offen offset:8 sc1
  s_mov_b64 exec, s[24:25]
ka_pfnm:
  s_cmp_lt_u32 s46, 10
  s_cbranch_scc0 ka_pf2
  buffer_load_dword v9, v4, s[8:11], s51 offen sc1
ka_pf2:
  s_cmp_gt_u32 s55, s54
  s_cbranch_scc1 ka_wp_52_ok
  s_mov_b32 s45, 0
ka_wp_52_spin:
  buffer_load_dword v2, v5, s[8:11], 0 offen sc1
  s_add_u32 s45, s45, 1
  s_waitcnt vmcnt(0)
  v_min_u32_dpp v3, v2, v2 quad_perm:[1,0,3,2] row_mask:0xf bank_mask:0xf
  s_nop 1
  v_min_u32_dpp v2, v3, v3 quad_perm:[2,3,0,1] row_mask:0xf bank_mask:0xf
  s_nop 1
  v_min_u32_dpp v3, v2, v2 row_half_mirror row_mask:0xf bank_mask:0xf
  s_nop 1
  v_min_u32_dpp v2, v3, v3 row_mirror row_mask:0xf bank_mask:0xf
  s_nop 0
  v_readfirstlane_b32 s55, v2
  s_cmp_gt_u32 s55, s54
  s_cbranch_scc1 ka_wp_52_ok
  s_cmp_lt_u32 s45, 400000
  s_cbranch_scc1 ka_wp_52_spin
  s_branch ka_abort
ka_wp_52_ok:
  buffer_load_dword v10, v4, s[8:11], s48 offen sc1
  buffer_load_dword v11, v4, s[8:11], s49 offen sc1
  buffer_load_dword v12, v4, s[8:11], s50 offen sc1
  s_cmp_gt_u32 s56, s54
  s_cbranch_scc1 ka_wp_53_ok
  s_mov_b32 s45, 0
ka_wp_53_spin:
  buffer_load_dword v2, v6, s[8:11], 0 offen sc1
  s_add_u32 s45, s45, 1
  s_waitcnt vmcnt(0)
  v_min_u32_dpp v3, v2, v2 quad_perm:[1,0,3,2] row_mask:0xf bank_mask:0xf
  s_nop 1
  v_min_u32_dpp v2, v3, v3 quad_perm:[2,3,0,1] row_mask:0xf bank_mask:0xf
  s_nop 1
  v_min_u32_dpp v3, v2, v2 row_half_mirror row_mask:0xf bank_mask:0xf
  s_nop 1
  v_min_u32_dpp v2, v3, v3 quad_perm:[0,1,2,3] row_mask:0xf bank_mask:0xf
  s_nop 0
  v_readfirstlane_b32 s56, v2
  s_cmp_gt_u32 s56, s54
  s_cbranch_scc1 ka_wp_53_ok
  s_cmp_lt_u32 s45, 400000
  s_cbranch_scc1 ka_wp_53_spin
  s_branch ka_abort
ka_wp_53_ok:
  s_add_u32 s28, s47, 0
  buffer_load_dword v13, v4, s[8:11], s28 offen sc1
  s_add_u32 s28, s47, 4096
  buffer_load_dword v14, v4, s[8:11], s28 offen sc1
  s_add_u32 s28, s47, 8192
  buffer_load_dword v15, v4, s[8:11], s28 offen sc1
  s_add_u32 s28, s47, 12288
  buffer_load_dword v16, v4, s[8:11], s28 offen sc1
  s_add_u32 s28, s47, 16384
  buffer_load_dword v17, v4, s[8:11], s28 offen sc1
  s_add_u32 s47, s47, 1310720
  s_add_u32 s48, s48, 12288
  s_add_u32 s49, s49, 12288
  s_add_u32 s50, s50, 12288
  s_add_u32 s51, s51, s52
  s_add_u32 s54, s54, 1
  s_waitcnt vmcnt(0)
  s_cmp_lt_u32 s54, 64
  s_cbranch_scc1 ka_pfl
  s_branch ka_exit
ka_qkv:
  s_mul_i32 s26, s23, 43
  s_lshr_b32 s26, s26, 10
  s_mul_i32 s27, s26, 24
  s_sub_u32 s27, s23, s27
  s_cmp_eq_u32 s26, 0
  s_cselect_b32 s28, s36, s38
  s_cselect_b32 s29, s37, s39
  s_cmp_eq_u32 s26, 2
  s_cselect_b32 s28, s40, s28
  s_cselect_b32 s29, s41, s29
  s_mov_b32 s12, s28
  s_and_b32 s13, s29, 0xffff
  s_mov_b32 s14, 0x780000
  s_mov_b32 s15, 0x20000
  s_mul_i32 s46, s26, 0x1800000
  s_add_u32 s46, s46, 0x4800000
  s_lshl_b32 s47, s26, 10
  s_lshl_b32 s28, s27, 2
  s_add_u32 s47, s47, s28
  s_add_u32 s47, s47, 0
  s_lshl_b32 s28, s27, 3
  s_lshl_b32 s29, s21, 1
  s_add_u32 s28, s28, s29
  s_add_u32 s29, s28, 0
  s_mul_i32 s30, s29, 171
  s_lshr_b32 s30, s30, 10
  s_mul_i32 s31, s30, 6
  s_sub_u32 s31, s29, s31
  s_mul_i32 s30, s30, 786432
  s_lshl_b32 s31, s31, 11
  s_add_u32 s30, s30, s31
  s_add_u32 s48, s30, s46
  s_add_u32 s29, s28, 1
  s_mul_i32 s30, s29, 171
  s_lshr_b32 s30, s30, 10
  s_mul_i32 s31, s30, 6
  s_sub_u32 s31, s29, s31
  s_mul_i32 s30, s30, 786432
  s_lshl_b32 s31, s31, 11
  s_add_u32 s30, s30, s31
  s_add_u32 s49, s30, s46
  v_and_b32 v1, 63, v0
  v_lshrrev_b32 v2, 4, v1
  v_bfe_u32 v3, v1, 2, 2
  v_and_b32 v4, 3, v1
  s_lshr_b32 s28, s21, 1
  s_lshl_b32 s28, s28, 2
  v_add_u32 v5, s28, v3
  v_mul_u32_u24 v5, 12288, v5
  s_and_b32 s28, s21, 1
  s_lshl_b32 s28, s28, 8
  s_lshl_b32 s29, s27, 9
  s_add_u32 s28, s28, s29
  v_add_u32 v5, s28, v5
  v_lshlrev_b32 v6, 6, v2
  v_add_u32 v5, v5, v6
  v_lshlrev_b32 v6, 4, v4
  v_add_u32 v5, v5, v6
  v_lshrrev_b32 v6, 1, v2
  v_lshlrev_b32 v7, 12, v6
  v_lshlrev_b32 v6, 6, v3
  v_add_u32 v7, v7, v6
  v_and_b32 v6, 1, v2
  v_lshlrev_b32 v6, 5, v6
  v_add_u32 v7, v7, v6
  v_lshrrev_b32 v6, 1, v4
  v_lshlrev_b32 v6, 4, v6
  v_add_u32 v7, v7, v6
  v_and_b32 v6, 1, v4
  v_lshlrev_b32 v6, 3, v6
  v_add_u32 v7, v7, v6
  s_lshl_b32 s28, s21, 9
  v_add_u32 v7, s28, v7
  v_lshlrev_b32 v14, 4, v1
  s_lshl_b32 s28, s21, 10
  v_add_u32 v6, s28, v14
  v_mov_b32 v15, 4992
  s_mov_b32 s51, 0x100000
  s_lshl_b32 s29, s21, 10
  s_add_u32 m0, s29, 0
  s_mov_b32 s28, 0
  buffer_load_dwordx4 v5, s[12:15], s28 offen lds
  s_lshl_b32 s29, s21, 10
  s_add_u32 m0, s29, 4096
  s_mov_b32 s28, 98304
  buffer_load_dwordx4 v5, s[12:15], s28 offen lds
  s_lshl_b32 s29, s21, 10
  s_add_u32 m0, s29, 8192
  s_mov_b32 s28, 196608
  buffer_load_dwordx4 v5, s[12:15], s28 offen lds
  s_lshl_b32 s29, s21, 10
  s_add_u32 m0, s29, 12288
  s_mov_b32 s28, 294912
  buffer_load_dwordx4 v5, s[12:15], s28 offen lds
  s_lshl_b32 s29, s21, 10
  s_add_u32 m0, s29, 16384
  s_mov_b32 s28, 393216
  buffer_load_dwordx4 v5, s[12:15], s28 offen lds
  s_lshl_b32 s29, s21, 10
  s_add_u32 m0, s29, 20480
  s_mov_b32 s28, 491520
  buffer_load_dwordx4 v5, s[12:15], s28 offen lds
  s_lshl_b32 s29, s21, 10
  s_add_u32 m0, s29, 24576
  s_mov_b32 s28, 589824
  buffer_load_dwordx4 v5, s[12:15], s28 offen lds
  s_lshl_b32 s29, s21, 10
  s_add_u32 m0, s29, 28672
  s_mov_b32 s28, 688128
  buffer_load_dwordx4 v5, s[12:15], s28 offen lds
  s_lshl_b32 s29, s21, 10
  s_add_u32 m0, s29, 32768
  s_mov_b32 s28, 786432
  buffer_load_dwordx4 v5, s[12:15], s28 offen lds
  s_lshl_b32 s29, s21, 10
  s_add_u32 m0, s29, 36864
  s_mov_b32 s28, 884736
  buffer_load_dwordx4 v5, s[12:15], s28 offen lds
  s_lshl_b32 s29, s21, 10
  s_add_u32 m0, s29, 40960
  s_mov_b32 s28, 983040
  buffer_load_dwordx4 v5, s[12:15], s28 offen lds
  s_lshl_b32 s29, s21, 10
  s_add_u32 m0, s29, 45056
  s_mov_b32 s28, 1081344
  buffer_load_dwordx4 v5, s[12:15], s28 offen lds
  s_lshl_b32 s29, s21, 10
  s_add_u32 m0, s29, 49152
  s_mov_b32 s28, 1179648
  buffer_load_dwordx4 v5, s[12:15], s28 offen lds
  s_lshl_b32 s29, s21, 10
  s_add_u32 m0, s29, 53248
  s_mov_b32 s28, 1277952
  buffer_load_dwordx4 v5, s[12:15], s28 offen lds
  s_lshl_b32 s29, s21, 10
  s_add_u32 m0, s29, 57344
  s_mov_b32 s28, 1376256
  buffer_load_dwordx4 v5, s[12:15], s28 offen lds
  s_lshl_b32 s29, s21, 10
  s_add_u32 m0, s29, 61440
  s_mov_b32 s28, 1474560
  buffer_load_dwordx4 v5, s[12:15], s28 offen lds
  s_lshl_b32 s29, s21, 10
  s_add_u32 m0, s29, 65536
  s_mov_b32 s28, 1572864
  buffer_load_dwordx4 v5, s[12:15], s28 offen lds
  s_lshl_b32 s29, s21, 10
  s_add_u32 m0, s29, 69632
  s_mov_b32 s28, 1671168
  buffer_load_dwordx4 v5, s[12:15], s28 offen lds
  s_lshl_b32 s29, s21, 10
  s_add_u32 m0, s29, 73728
  s_mov_b32 s28, 1769472
  buffer_load_dwordx4 v5, s[12:15], s28 offen lds
  s_lshl_b32 s29, s21, 10
  s_add_u32 m0, s29, 77824
  s_mov_b32 s28, 1867776
  buffer_load_dwordx4 v5, s[12:15], s28 offen lds
  s_lshl_b32 s29, s21, 10
  s_add_u32 m0, s29, 81920
  s_mov_b32 s28, 1966080
  buffer_load_dwordx4 v5, s[12:15], s28 offen lds
  s_lshl_b32 s29, s21, 10
  s_add_u32 m0, s29, 86016
  s_mov_b32 s28, 2064384
  buffer_load_dwordx4 v5, s[12:15], s28 offen lds
  s_lshl_b32 s29, s21, 10
  s_add_u32 m0, s29, 90112
  s_mov_b32 s28, 2162688
  buffer_load_dwordx4 v5, s[12:15], s28 offen lds
  s_lshl_b32 s29, s21, 10
  s_add_u32 m0, s29, 94208
  s_mov_b32 s28, 2260992
  buffer_load_dwordx4 v5, s[12:15], s28 offen lds
  s_waitcnt vmcnt(20)
  s_cmp_eq_u32 s21, 3
  s_cbranch_scc0 lna_54
  s_mov_b64 s[24:25], exec
  s_mov_b64 exec, 1
  v_mov_b32 v2, 4992
  v_mov_b32 v3, 1
  buffer_atomic_add v3, v2, s[8:11], 0 offen
  s_mov_b64 exec, s[24:25]
lna_54:
  s_barrier
  s_lshl_b32 s29, s21, 10
  s_add_u32 m0, s29, 98304
  s_mov_b32 s28, 2359296
  buffer_load_dwordx4 v5, s[12:15], s28 offen lds
  s_lshl_b32 s29, s21, 10
  s_add_u32 m0, s29, 102400
  s_mov_b32 s28, 2457600
  buffer_load_dwordx4 v5, s[12:15], s28 offen lds
  s_lshl_b32 s29, s21, 10
  s_add_u32 m0, s29, 106496
  s_mov_b32 s28, 2555904
  buffer_load_dwordx4 v5, s[12:15], s28 offen lds
  s_lshl_b32 s29, s21, 10
  s_add_u32 m0, s29, 110592
  s_mov_b32 s28, 2654208
  buffer_load_dwordx4 v5, s[12:15], s28 offen lds
  v_add_u32 v8, 0, v7
  ds_read_b64_tr_b16 a[0:1], v8 offset:0
  ds_read_b64_tr_b16 a[2:3], v8 offset:2048
  ds_read_b64_tr_b16 a[4:5], v8 offset:8192
  ds_read_b64_tr_b16 a[6:7], v8 offset:10240
  ds_read_b64_tr_b16 a[160:161], v8 offset:256
  ds_read_b64_tr_b16 a[162:163], v8 offset:2304
  ds_read_b64_tr_b16 a[164:165], v8 offset:8448
  ds_read_b64_tr_b16 a[166:167], v8 offset:10496
  s_waitcnt lgkmcnt(0)
  s_waitcnt vmcnt(20)
  s_barrier
  s_lshl_b32 s29, s21, 10
  s_add_u32 m0, s29, 0
  s_mov_b32 s28, 2752512
  buffer_load_dwordx4 v5, s[12:15], s28 offen lds
  s_lshl_b32 s29, s21, 10
  s_add_u32 m0, s29, 4096
  s_mov_b32 s28, 2850816
  buffer_load_dwordx4 v5, s[12:15], s28 offen lds
  s_lshl_b32 s29, s21, 10
  s_add_u32 m0, s29, 8192
  s_mov_b32 s28, 2949120
  buffer_load_dwordx4 v5, s[12:15], s28 offen lds
  s_lshl_b32 s29, s21, 10
  s_add_u32 m0, s29, 12288
  s_mov_b32 s28, 3047424
  buffer_load_dwordx4 v5, s[12:15], s28 offen lds
  v_add_u32 v8, 16384, v7
  ds_read_b64_tr_b16 a[8:9], v8 offset:0
  ds_read_b64_tr_b16 a[10:11], v8 offset:2048
  ds_read_b64_tr_b16 a[12:13], v8 offset:8192
  ds_read_b64_tr_b16 a[14:15], v8 offset:10240
  ds_read_b64_tr_b16 a[168:169], v8 offset:256
  ds_read_b64_tr_b16 a[170:171], v8 offset:2304
  ds_read_b64_tr_b16 a[172:173], v8 offset:8448
  ds_read_b64_tr_b16 a[174:175], v8 offset:10496
  s_waitcnt lgkmcnt(0)
  s_waitcnt vmcnt(20)
  s_barrier
  s_lshl_b32 s29, s21, 10
  s_add_u32 m0, s29, 16384
  s_mov_b32 s28, 3145728
  buffer_load_dwordx4 v5, s[12:15], s28 offen lds
  s_lshl_b32 s29, s21, 10
  s_add_u32 m0, s29, 20480
  s_mov_b32 s28, 3244032
  buffer_load_dwordx4 v5, s[12:15], s28 offen lds
  s_lshl_b32 s29, s21, 10
  s_add_u32 m0, s29, 24576
  s_mov_b32 s28, 3342336
  buffer_load_dwordx4 v5, s[12:15], s28 offen lds
  s_lshl_b32 s29, s21, 10
  s_add_u32 m0, s29, 28672
  s_mov_b32 s28, 3440640
  buffer_load_dwordx4 v5, s[12:15], s28 offen lds
  v_add_u32 v8, 32768, v7
  ds_read_b64_tr_b16 a[16:17], v8 offset:0
  ds_read_b64_tr_b16 a[18:19], v8 offset:2048
  ds_read_b64_tr_b16 a[20:21], v8 offset:8192
  ds_read_b64_tr_b16 a[22:23], v8 offset:10240
  ds_read_b64_tr_b16 a[176:177], v8 offset:256
  ds_read_b64_tr_b16 a[178:179], v8 offset:2304
  ds_read_b64_tr_b16 a[180:181], v8 offset:8448
  ds_read_b64_tr_b16 a[182:183], v8 offset:10496
  s_waitcnt lgkmcnt(0)
  s_waitcnt vmcnt(20)
  s_barrier
  s_lshl_b32 s29, s21, 10
  s_add_u32 m0, s29, 32768
  s_mov_b32 s28, 3538944
  buffer_load_dwordx4 v5, s[12:15], s28 offen lds
  s_lshl_b32 s29, s21, 10
  s_add_u32 m0, s29, 36864
  s_mov_b32 s28, 3637248
  buffer_load_dwordx4 v5, s[12:15], s28 offen lds
  s_lshl_b32 s29, s21, 10
  s_add_u32 m0, s29, 40960
  s_mov_b32 s28, 3735552
  buffer_load_dwordx4 v5, s[12:15], s28 offen lds
  s_lshl_b32 s29, s21, 10
  s_add_u32 m0, s29, 45056
  s_mov_b32 s28, 3833856
  buffer_load_dwordx4 v5, s[12:15], s28 offen lds
  v_add_u32 v8, 49152, v7
  ds_read_b64_tr_b16 a[24:25], v8 offset:0
  ds_read_b64_tr_b16 a[26:27], v8 offset:2048
  ds_read_b64_tr_b16 a[28:29], v8 offset:8192
  ds_read_b64_tr_b16 a[30:31], v8 offset:10240
  ds_read_b64_tr_b16 a[184:185], v8 offset:256
  ds_read_b64_tr_b16 a[186:187], v8 offset:2304
  ds_read_b64_tr_b16 a[188:189], v8 offset:8448
  ds_read_b64_tr_b16 a[190:191], v8 offset:10496
  s_waitcnt lgkmcnt(0)
  s_waitcnt vmcnt(20)
  s_barrier
  s_lshl_b32 s29, s21, 10
  s_add_u32 m0, s29, 49152
  s_mov_b32 s28, 3932160
  buffer_load_dwordx4 v5, s[12:15], s28 offen lds
  s_lshl_b32 s29, s21, 10
  s_add_u32 m0, s29, 53248
  s_mov_b32 s28, 4030464
  buffer_load_dwordx4 v5, s[12:15], s28 offen lds
  s_lshl_b32 s29, s21, 10
  s_add_u32 m0, s29, 57344
  s_mov_b32 s28, 4128768
  buffer_load_dwordx4 v5, s[12:15], s28 offen lds
  s_lshl_b32 s29, s21, 10
  s_add_u32 m0, s29, 61440
  s_mov_b32 s28, 4227072
  buffer_load_dwordx4 v5, s[12:15], s28 offen lds
  v_add_u32 v8, 65536, v7
  ds_read_b64_tr_b16 a[32:33], v8 offset:0
  ds_read_b64_tr_b16 a[34:35], v8 offset:2048
  ds_read_b64_tr_b16 a[36:37], v8 offset:8192
  ds_read_b64_tr_b16 a[38:39], v8 offset:10240
  ds_read_b64_tr_b16 a[192:193], v8 offset:256
  ds_read_b64_tr_b16 a[194:195], v8 offset:2304
  ds_read_b64_tr_b16 a[196:197], v8 offset:8448
  ds_read_b64_tr_b16 a[198:199], v8 offset:10496
  s_waitcnt lgkmcnt(0)
  s_waitcnt vmcnt(20)
  s_barrier
  s_lshl_b32 s29, s21, 10
  s_add_u32 m0, s29, 65536
  s_mov_b32 s28, 4325376
  buffer_load_dwordx4 v5, s[12:15], s28 offen lds
  s_lshl_b32 s29, s21, 10
  s_add_u32 m0, s29, 69632
  s_mov_b32 s28, 4423680
  buffer_load_dwordx4 v5, s[12:15], s28 offen lds
  s_lshl_b32 s29, s21, 10
  s_add_u32 m0, s29, 73728
  s_mov_b32 s28, 4521984
  buffer_load_dwordx4 v5, s[12:15], s28 offen lds
  s_lshl_b32 s29, s21, 10
  s_add_u32 m0, s29, 77824
  s_mov_b32 s28, 4620288
  buffer_load_dwordx4 v5, s[12:15], s28 offen lds
  v_add_u32 v8, 81920, v7
  ds_read_b64_tr_b16 a[40:41], v8 offset:0
  ds_read_b64_tr_b16 a[42:43], v8 offset:2048
  ds_read_b64_tr_b16 a[44:45], v8 offset:8192
  ds_read_b64_tr_b16 a[46:47], v8 offset:10240
  ds_read_b64_tr_b16 a[200:201], v8 offset:256
  ds_read_b64_tr_b16 a[202:203], v8 offset:2304
  ds_read_b64_tr_b16 a[204:205], v8 offset:8448
  ds_read_b64_tr_b16 a[206:207], v8 offset:10496
  s_waitcnt lgkmcnt(0)
  s_waitcnt vmcnt(20)
  s_barrier
  s_lshl_b32 s29, s21, 10
  s_add_u32 m0, s29, 81920
  s_mov_b32 s28, 4718592
  buffer_load_dwordx4 v5, s[12:15], s28 offen lds
  s_lshl_b32 s29, s21, 10
  s_add_u32 m0, s29, 86016
  s_mov_b32 s28, 4816896
  buffer_load_dwordx4 v5, s[12:15], s28 offen lds
  s_lshl_b32 s29, s21, 10
  s_add_u32 m0, s29, 90112
  s_mov_b32 s28, 4915200
  buffer_load_dwordx4 v5, s[12:15], s28 offen lds
  s_lshl_b32 s29, s21, 10
  s_add_u32 m0, s29, 94208
  s_mov_b32 s28, 5013504
  buffer_load_dwordx4 v5, s[12:15], s28 offen lds
  buffer_load_dword v13, v15, s[8:11], 0 offen sc1
  v_add_u32 v8, 98304, v7
  ds_read_b64_tr_b16 a[48:49], v8 offset:0
  ds_read_b64_tr_b16 a[50:51], v8 offset:2048
  ds_read_b64_tr_b16 a[52:53], v8 offset:8192
  ds_read_b64_tr_b16 a[54:55], v8 offset:10240
  ds_read_b64_tr_b16 a[208:209], v8 offset:256
  ds_read_b64_tr_b16 a[210:211], v8 offset:2304
  ds_read_b64_tr_b16 a[212:213], v8 offset:8448
  ds_read_b64_tr_b16 a[214:215], v8 offset:10496
  s_waitcnt lgkmcnt(0)
  s_waitcnt vmcnt(21)
  s_barrier
  s_lshl_b32 s29, s21, 10
  s_add_u32 m0, s29, 98304
  s_mov_b32 s28, 5111808
  buffer_load_dwordx4 v5, s[12:15], s28 offen lds
  s_lshl_b32 s29, s21, 10
  s_add_u32 m0, s29, 102400
  s_mov_b32 s28, 5210112
  buffer_load_dwordx4 v5, s[12:15], s28 offen lds
  s_lshl_b32 s29, s21, 10
  s_add_u32 m0, s29, 106496
  s_mov_b32 s28, 5308416
  buffer_load_dwordx4 v5, s[12:15], s28 offen lds
  s_lshl_b32 s29, s21, 10
  s_add_u32 m0, s29, 110592
  s_mov_b32 s28, 5406720
  buffer_load_dwordx4 v5, s[12:15], s28 offen lds
  v_add_u32 v8, 0, v7
  ds_read_b64_tr_b16 a[56:57], v8 offset:0
  ds_read_b64_tr_b16 a[58:59], v8 offset:2048
  ds_read_b64_tr_b16 a[60:61], v8 offset:8192
  ds_read_b64_tr_b16 a[62:63], v8 offset:10240
  ds_read_b64_tr_b16 a[216:217], v8 offset:256
  ds_read_b64_tr_b16 a[218:219], v8 offset:2304
  ds_read_b64_tr_b16 a[220:221], v8 offset:8448
  ds_read_b64_tr_b16 a[222:223], v8 offset:10496
  s_waitcnt lgkmcnt(0)
  s_waitcnt vmcnt(21)
  s_barrier
  s_lshl_b32 s29, s21, 10
  s_add_u32 m0, s29, 0
  s_mov_b32 s28, 5505024
  buffer_load_dwordx4 v5, s[12:15], s28 offen lds
  s_lshl_b32 s29, s21, 10
  s_add_u32 m0, s29, 4096
  s_mov_b32 s28, 5603328
  buffer_load_dwordx4 v5, s[12:15], s28 offen lds
  s_lshl_b32 s29, s21, 10
  s_add_u32 m0, s29, 8192
  s_mov_b32 s28, 5701632
  buffer_load_dwordx4 v5, s[12:15], s28 offen lds
  s_lshl_b32 s29, s21, 10
  s_add_u32 m0, s29, 12288
  s_mov_b32 s28, 5799936
  buffer_load_dwordx4 v5, s[12:15], s28 offen lds
  v_add_u32 v8, 16384, v7
  ds_read_b64_tr_b16 a[64:65], v8 offset:0
  ds_read_b64_tr_b16 a[66:67], v8 offset:2048
  ds_read_b64_tr_b16 a[68:69], v8 offset:8192
  ds_read_b64_tr_b16 a[70:71], v8 offset:10240
  ds_read_b64_tr_b16 a[224:225], v8 offset:256
  ds_read_b64_tr_b16 a[226:227], v8 offset:2304
  ds_read_b64_tr_b16 a[228:229], v8 offset:8448
  ds_read_b64_tr_b16 a[230:231], v8 offset:10496
  s_waitcnt lgkmcnt(0)
  s_waitcnt vmcnt(21)
  s_barrier
  s_lshl_b32 s29, s21, 10
  s_add_u32 m0, s29, 16384
  s_mov_b32 s28, 5898240
  buffer_load_dwordx4 v5, s[12:15], s28 offen lds
  s_lshl_b32 s29, s21, 10
  s_add_u32 m0, s29, 20480
  s_mov_b32 s28, 5996544
  buffer_load_dwordx4 v5, s[12:15], s28 offen lds
  s_lshl_b32 s29, s21, 10
  s_add_u32 m0, s29, 24576
  s_mov_b32 s28, 6094848
  buffer_load_dwordx4 v5, s[12:15], s28 offen lds
  s_lshl_b32 s29, s21, 10
  s_add_u32 m0, s29, 28672
  s_mov_b32 s28, 6193152
  buffer_load_dwordx4 v5, s[12:15], s28 offen lds
  v_add_u32 v8, 32768, v7
  ds_read_b64_tr_b16 a[72:73], v8 offset:0
  ds_read_b64_tr_b16 a[74:75], v8 offset:2048
  ds_read_b64_tr_b16 a[76:77], v8 offset:8192
  ds_read_b64_tr_b16 a[78:79], v8 offset:10240
  ds_read_b64_tr_b16 a[232:233], v8 offset:256
  ds_read_b64_tr_b16 a[234:235], v8 offset:2304
  ds_read_b64_tr_b16 a[236:237], v8 offset:8448
  ds_read_b64_tr_b16 a[238:239], v8 offset:10496
  s_waitcnt lgkmcnt(0)
  s_waitcnt vmcnt(21)
  s_barrier
  s_lshl_b32 s29, s21, 10
  s_add_u32 m0, s29, 32768
  s_mov_b32 s28, 6291456
  buffer_load_dwordx4 v5, s[12:15], s28 offen lds
  s_lshl_b32 s29, s21, 10
  s_add_u32 m0, s29, 36864
  s_mov_b32 s28, 6389760
  buffer_load_dwordx4 v5, s[12:15], s28 offen lds
  s_lshl_b32 s29, s21, 10
  s_add_u32 m0, s29, 40960
  s_mov_b32 s28, 6488064
  buffer_load_dwordx4 v5, s[12:15], s28 offen lds
  s_lshl_b32 s29, s21, 10
  s_add_u32 m0, s29, 45056
  s_mov_b32 s28, 6586368
  buffer_load_dwordx4 v5, s[12:15], s28 offen lds
  v_add_u32 v8, 49152, v7
  ds_read_b64_tr_b16 a[80:81], v8 offset:0
  ds_read_b64_tr_b16 a[82:83], v8 offset:2048
  ds_read_b64_tr_b16 a[84:85], v8 offset:8192
  ds_read_b64_tr_b16 a[86:87], v8 offset:10240
  ds_read_b64_tr_b16 a[240:241], v8 offset:256
  ds_read_b64_tr_b16 a[242:243], v8 offset:2304
  ds_read_b64_tr_b16 a[244:245], v8 offset:8448
  ds_read_b64_tr_b16 a[246:247], v8 offset:10496
  s_waitcnt lgkmcnt(0)
  s_waitcnt vmcnt(21)
  s_barrier
  s_lshl_b32 s29, s21, 10
  s_add_u32 m0, s29, 49152
  s_mov_b32 s28, 6684672
  buffer_load_dwordx4 v5, s[12:15], s28 offen lds
  s_lshl_b32 s29, s21, 10
  s_add_u32 m0, s29, 53248
  s_mov_b32 s28, 6782976
  buffer_load_dwordx4 v5, s[12:15], s28 offen lds
  s_lshl_b32 s29, s21, 10
  s_add_u32 m0, s29, 57344
  s_mov_b32 s28, 6881280
  buffer_load_dwordx4 v5, s[12:15], s28 offen lds
  s_lshl_b32 s29, s21, 10
  s_add_u32 m0, s29, 61440
  s_mov_b32 s28, 6979584
  buffer_load_dwordx4 v5, s[12:15], s28 offen lds
  v_add_u32 v8, 65536, v7
  ds_read_b64_tr_b16 a[88:89], v8 offset:0
  ds_read_b64_tr_b16 a[90:91], v8 offset:2048
  ds_read_b64_tr_b16 a[92:93], v8 offset:8192
  ds_read_b64_tr_b16 a[94:95], v8 offset:10240
  ds_read_b64_tr_b16 a[248:249], v8 offset:256
  ds_read_b64_tr_b16 a[250:251], v8 offset:2304
  ds_read_b64_tr_b16 a[252:253], v8 offset:8448
  ds_read_b64_tr_b16 a[254:255], v8 offset:10496
  s_waitcnt lgkmcnt(0)
  s_waitcnt vmcnt(21)
  s_barrier
  s_lshl_b32 s29, s21, 10
  s_add_u32 m0, s29, 65536
  s_mov_b32 s28, 7077888
  buffer_load_dwordx4 v5, s[12:15], s28 offen lds
  s_lshl_b32 s29, s21, 10
  s_add_u32 m0, s29, 69632
  s_mov_b32 s28, 7176192
  buffer_load_dwordx4 v5, s[12:15], s28 offen lds
  s_lshl_b32 s29, s21, 10
  s_add_u32 m0, s29, 73728
  s_mov_b32 s28, 7274496
  buffer_load_dwordx4 v5, s[12:15], s28 offen lds
  s_lshl_b32 s29, s21, 10
  s_add_u32 m0, s29, 77824
  s_mov_b32 s28, 7372800
  buffer_load_dwordx4 v5, s[12:15], s28 offen lds
  v_add_u32 v8, 81920, v7
  ds_read_b64_tr_b16 a[96:97], v8 offset:0
  ds_read_b64_tr_b16 a[98:99], v8 offset:2048
  ds_read_b64_tr_b16 a[100:101], v8 offset:8192
  ds_read_b64_tr_b16 a[102:103], v8 offset:10240
  ds_read_b64_tr_b16 v[192:193], v8 offset:256
  ds_read_b64_tr_b16 v[194:195], v8 offset:2304
  ds_read_b64_tr_b16 v[196:197], v8 offset:8448
  ds_read_b64_tr_b16 v[198:199], v8 offset:10496
  s_waitcnt lgkmcnt(0)
  s_waitcnt vmcnt(20)
  s_nop 0
  v_readfirstlane_b32 s28, v13
  s_cmp_ge_u32 s28, 256
  s_cbranch_scc1 xw_55_ok
  s_mov_b32 s45, 0
xw_55:
  buffer_load_dword v13, v15, s[8:11], 0 offen sc1
  s_add_u32 s45, s45, 1
  s_waitcnt vmcnt(0)
  v_readfirstlane_b32 s28, v13
  s_cmp_ge_u32 s28, 256
  s_cbranch_scc1 xw_55_ok
  s_cmp_lt_u32 s45, 400000
  s_cbranch_scc1 xw_55
  s_branch ka_abort
xw_55_ok:
  s_lshl_b32 s29, s21, 10
  s_add_u32 m0, s29, 122880
  s_add_u32 s28, s51, 0
  buffer_load_dwordx4 v6, s[8:11], s28 offen sc1 lds
  s_lshl_b32 s29, s21, 10
  s_add_u32 m0, s29, 126976
  s_add_u32 s28, s51, 4096
  buffer_load_dwordx4 v6, s[8:11], s28 offen sc1 lds
  s_lshl_b32 s29, s21, 10
  s_add_u32 m0, s29, 131072
  s_add_u32 s28, s51, 8192
  buffer_load_dwordx4 v6, s[8:11], s28 offen sc1 lds
  s_lshl_b32 s29, s21, 10
  s_add_u32 m0, s29, 135168
  s_add_u32 s28, s51, 12288
  buffer_load_dwordx4 v6, s[8:11], s28 offen sc1 lds
  s_lshl_b32 s29, s21, 10
  s_add_u32 m0, s29, 139264
  s_add_u32 s28, s51, 16384
  buffer_load_dwordx4 v6, s[8:11], s28 offen sc1 lds
  s_lshl_b32 s29, s21, 10
  s_add_u32 m0, s29, 143360
  s_add_u32 s28, s51, 20480
  buffer_load_dwordx4 v6, s[8:11], s28 offen sc1 lds
  s_lshl_b32 s29, s21, 10
  s_add_u32 m0, s29, 147456
  s_add_u32 s28, s51, 24576
  buffer_load_dwordx4 v6, s[8:11], s28 offen sc1 lds
  s_lshl_b32 s29, s21, 10
  s_add_u32 m0, s29, 151552
  s_add_u32 s28, s51, 28672
  buffer_load_dwordx4 v6, s[8:11], s28 offen sc1 lds
  s_lshl_b32 s29, s21, 10
  s_add_u32 m0, s29, 155648
  s_add_u32 s28, s51, 32768
  buffer_load_dwordx4 v6, s[8:11], s28 offen sc1 lds
  s_lshl_b32 s29, s21, 10
  s_add_u32 m0, s29, 159744
  s_add_u32 s28, s51, 36864
  buffer_load_dwordx4 v6, s[8:11], s28 offen sc1 lds
  s_add_u32 s51, s51, 40960
  s_barrier
  s_lshl_b32 s29, s21, 10
  s_add_u32 m0, s29, 81920
  s_mov_b32 s28, 7471104
  buffer_load_dwordx4 v5, s[12:15], s28 offen lds
  s_lshl_b32 s29, s21, 10
  s_add_u32 m0, s29, 86016
  s_mov_b32 s28, 7569408
  buffer_load_dwordx4 v5, s[12:15], s28 offen lds
  s_lshl_b32 s29, s21, 10
  s_add_u32 m0, s29, 90112
  s_mov_b32 s28, 7667712
  buffer_load_dwordx4 v5, s[12:15], s28 offen lds
  s_lshl_b32 s29, s21, 10
  s_add_u32 m0, s29, 94208
  s_mov_b32 s28, 7766016
  buffer_load_dwordx4 v5, s[12:15], s28 offen lds
  v_add_u32 v8, 98304, v7
  ds_read_b64_tr_b16 a[104:105], v8 offset:0
  ds_read_b64_tr_b16 a[106:107], v8 offset:2048
  ds_read_b64_tr_b16 a[108:109], v8 offset:8192
  ds_read_b64_tr_b16 a[110:111], v8 offset:10240
  ds_read_b64_tr_b16 v[200:201], v8 offset:256
  ds_read_b64_tr_b16 v[202:203], v8 offset:2304
  ds_read_b64_tr_b16 v[204:205], v8 offset:8448
  ds_read_b64_tr_b16 v[206:207], v8 offset:10496
  s_waitcnt lgkmcnt(0)
  s_waitcnt vmcnt(30)
  s_barrier
  v_add_u32 v8, 0, v7
  ds_read_b64_tr_b16 a[112:113], v8 offset:0
  ds_read_b64_tr_b16 a[114:115], v8 offset:2048
  ds_read_b64_tr_b16 a[116:117], v8 offset:8192
  ds_read_b64_tr_b16 a[118:119], v8 offset:10240
  ds_read_b64_tr_b16 v[208:209], v8 offset:256
  ds_read_b64_tr_b16 v[210:211], v8 offset:2304
  ds_read_b64_tr_b16 v[212:213], v8 offset:8448
  ds_read_b64_tr_b16 v[214:215], v8 offset:10496
  s_waitcnt lgkmcnt(0)
  s_waitcnt vmcnt(26)
  s_barrier
  v_add_u32 v8, 16384, v7
  ds_read_b64_tr_b16 a[120:121], v8 offset:0
  ds_read_b64_tr_b16 a[122:123], v8 offset:2048
  ds_read_b64_tr_b16 a[124:125], v8 offset:8192
  ds_read_b64_tr_b16 a[126:127], v8 offset:10240
  ds_read_b64_tr_b16 v[216:217], v8 offset:256
  ds_read_b64_tr_b16 v[218:219], v8 offset:2304
  ds_read_b64_tr_b16 v[220:221], v8 offset:8448
  ds_read_b64_tr_b16 v[222:223], v8 offset:10496
  s_waitcnt lgkmcnt(0)
  s_waitcnt vmcnt(22)
  s_barrier
  v_add_u32 v8, 32768, v7
  ds_read_b64_tr_b16 a[128:129], v8 offset:0
  ds_read_b64_tr_b16 a[130:131], v8 offset:2048
  ds_read_b64_tr_b16 a[132:133], v8 offset:8192
  ds_read_b64_tr_b16 a[134:135], v8 offset:10240
  ds_read_b64_tr_b16 v[224:225], v8 offset:256
  ds_read_b64_tr_b16 v[226:227], v8 offset:2304
  ds_read_b64_tr_b16 v[228:229], v8 offset:8448
  ds_read_b64_tr_b16 v[230:231], v8 offset:10496
  s_waitcnt lgkmcnt(0)
  s_waitcnt vmcnt(18)
  s_barrier
  v_add_u32 v8, 49152, v7
  ds_read_b64_tr_b16 a[136:137], v8 offset:0
  ds_read_b64_tr_b16 a[138:139], v8 offset:2048
  ds_read_b64_tr_b16 a[140:141], v8 offset:8192
  ds_read_b64_tr_b16 a[142:143], v8 offset:10240
  ds_read_b64_tr_b16 v[232:233], v8 offset:256
  ds_read_b64_tr_b16 v[234:235], v8 offset:2304
  ds_read_b64_tr_b16 v[236:237], v8 offset:8448
  ds_read_b64_tr_b16 v[238:239], v8 offset:10496
  s_waitcnt lgkmcnt(0)
  s_waitcnt vmcnt(14)
  s_barrier
  v_add_u32 v8, 65536, v7
  ds_read_b64_tr_b16 a[144:145], v8 offset:0
  ds_read_b64_tr_b16 a[146:147], v8 offset:2048
  ds_read_b64_tr_b16 a[148:149], v8 offset:8192
  ds_read_b64_tr_b16 a[150:151], v8 offset:10240
  ds_read_b64_tr_b16 v[240:241], v8 offset:256
  ds_read_b64_tr_b16 v[242:243], v8 offset:2304
  ds_read_b64_tr_b16 v[244:245], v8 offset:8448
  ds_read_b64_tr_b16 v[246:247], v8 offset:10496
  s_waitcnt lgkmcnt(0)
  s_waitcnt vmcnt(0)
  s_barrier
  v_add_u32 v8, 81920, v7
  ds_read_b64_tr_b16 a[152:153], v8 offset:0
  ds_read_b64_tr_b16 a[154:155], v8 offset:2048
  ds_read_b64_tr_b16 a[156:157], v8 offset:8192
  ds_read_b64_tr_b16 a[158:159], v8 offset:10240
  ds_read_b64_tr_b16 v[248:249], v8 offset:256
  ds_read_b64_tr_b16 v[250:251], v8 offset:2304
  ds_read_b64_tr_b16 v[252:253], v8 offset:8448
  ds_read_b64_tr_b16 v[254:255], v8 offset:10496
  s_waitcnt lgkmcnt(0)
  s_barrier
  v_lshlrev_b32 v5, 4, v1
  v_add_u32 v9, 122880, v5
  v_mov_b32 v10, v5
  v_bfe_u32 v2, v1, 4, 1
  v_lshlrev_b32 v11, 10, v2
  v_and_b32 v2, 15, v1
  v_lshlrev_b32 v2, 4, v2
  v_add_u32 v11, v11, v2
  v_lshrrev_b32 v2, 5, v1
  v_lshlrev_b32 v2, 9, v2
  v_add_u32 v11, v11, v2
  v_mov_b32 v12, s47
  s_mov_b32 s50, 0
ka_qkv_loop:
  s_cmp_eq_u32 s50, 0
  s_cbranch_scc0 q0_56
  s_waitcnt vmcnt(0)
q0_56:
  s_waitcnt vmcnt(4)
  s_barrier
  s_cmp_ge_u32 s50, 63
  s_cbranch_scc1 qn_57_n
  s_lshl_b32 s29, s21, 10
  s_add_u32 m0, s29, 0
  s_add_u32 s28, s51, 0
  buffer_load_dwordx4 v6, s[8:11], s28 offen sc1 lds
  s_lshl_b32 s29, s21, 10
  s_add_u32 m0, s29, 4096
  s_add_u32 s28, s51, 4096
  buffer_load_dwordx4 v6, s[8:11], s28 offen sc1 lds
  s_lshl_b32 s29, s21, 10
  s_add_u32 m0, s29, 8192
  s_add_u32 s28, s51, 8192
  buffer_load_dwordx4 v6, s[8:11], s28 offen sc1 lds
  s_lshl_b32 s29, s21, 10
  s_add_u32 m0, s29, 12288
  s_add_u32 s28, s51, 12288
  buffer_load_dwordx4 v6, s[8:11], s28 offen sc1 lds
  s_lshl_b32 s29, s21, 10
  s_add_u32 m0, s29, 16384
  s_add_u32 s28, s51, 16384
  buffer_load_dwordx4 v6, s[8:11], s28 offen sc1 lds
  s_lshl_b32 s29, s21, 10
  s_add_u32 m0, s29, 20480
  s_add_u32 s28, s51, 20480
  buffer_load_dwordx4 v6, s[8:11], s28 offen sc1 lds
  s_lshl_b32 s29, s21, 10
  s_add_u32 m0, s29, 24576
  s_add_u32 s28, s51, 24576
  buffer_load_dwordx4 v6, s[8:11], s28 offen sc1 lds
  s_lshl_b32 s29, s21, 10
  s_add_u32 m0, s29, 28672
  s_add_u32 s28, s51, 28672
  buffer_load_dwordx4 v6, s[8:11], s28 offen sc1 lds
  s_lshl_b32 s29, s21, 10
  s_add_u32 m0, s29, 32768
  s_add_u32 s28, s51, 32768
  buffer_load_dwordx4 v6, s[8:11], s28 offen sc1 lds
  s_lshl_b32 s29, s21, 10
  s_add_u32 m0, s29, 36864
  s_add_u32 s28, s51, 36864
  buffer_load_dwordx4 v6, s[8:11], s28 offen sc1 lds
  s_add_u32 s51, s51, 40960
  s_branch qn_57
qn_57_n:
  s_waitcnt vmcnt(0)
qn_57:
  ds_read_b128 v[128:131], v9 offset:0
  ds_read_b128 v[132:135], v9 offset:1024
  ds_read_b128 v[136:139], v9 offset:2048
  ds_read_b128 v[140:143], v9 offset:3072
  s_waitcnt lgkmcnt(3)
  v_mfma_f32_32x32x16_bf16 v[64:79], a[0:3], v[128:131], 0
  v_mfma_f32_32x32x16_bf16 v[80:95], a[160:163], v[128:131], 0
  ds_read_b128 v[128:131], v9 offset:4096
  s_waitcnt lgkmcnt(3)
  v_mfma_f32_32x32x16_bf16 v[64:79], a[4:7], v[132:135], v[64:79]
  v_mfma_f32_32x32x16_bf16 v[80:95], a[164:167], v[132:135], v[80:95]
  ds_read_b128 v[132:135], v9 offset:5120
  s_waitcnt lgkmcnt(3)
  v_mfma_f32_32x32x16_bf16 v[64:79], a[8:11], v[136:139], v[64:79]
  v_mfma_f32_32x32x16_bf16 v[80:95], a[168:171], v[136:139], v[80:95]
  ds_read_b128 v[136:139], v9 offset:6144
  s_waitcnt lgkmcnt(3)
  v_mfma_f32_32x32x16_bf16 v[64:79], a[12:15], v[140:143], v[64:79]
  v_mfma_f32_32x32x16_bf16 v[80:95], a[172:175], v[140:143], v[80:95]
  ds_read_b128 v[140:143], v9 offset:7168
  s_waitcnt lgkmcnt(3)
  v_mfma_f32_32x32x16_bf16 v[64:79], a[16:19], v[128:131], v[64:79]
  v_mfma_f32_32x32x16_bf16 v[80:95], a[176:179], v[128:131], v[80:95]
  ds_read_b128 v[128:131], v9 offset:8192
  s_waitcnt lgkmcnt(3)
  v_mfma_f32_32x32x16_bf16 v[64:79], a[20:23], v[132:135], v[64:79]
  v_mfma_f32_32x32x16_bf16 v[80:95], a[180:183], v[132:135], v[80:95]
  ds_read_b128 v[132:135], v9 offset:9216
  s_waitcnt lgkmcnt(3)
  v_mfma_f32_32x32x16_bf16 v[64:79], a[24:27], v[136:139], v[64:79]
  v_mfma_f32_32x32x16_bf16 v[80:95], a[184:187], v[136:139], v[80:95]
  ds_read_b128 v[136:139], v9 offset:10240
  s_waitcnt lgkmcnt(3)
  v_mfma_f32_32x32x16_bf16 v[64:79], a[28:31], v[140:143], v[64:79]
  v_mfma_f32_32x32x16_bf16 v[80:95], a[188:191], v[140:143], v[80:95]
  ds_read_b128 v[140:143], v9 offset:11264
  s_waitcnt lgkmcnt(3)
  v_mfma_f32_32x32x16_bf16 v[64:79], a[32:35], v[128:131], v[64:79]
  v_mfma_f32_32x32x16_bf16 v[80:95], a[192:195], v[128:131], v[80:95]
  ds_read_b128 v[128:131], v9 offset:12288
  s_waitcnt lgkmcnt(3)
  v_mfma_f32_32x32x16_bf16 v[64:79], a[36:39], v[132:135], v[64:79]
  v_mfma_f32_32x32x16_bf16 v[80:95], a[196:199], v[132:135], v[80:95]
  ds_read_b128 v[132:135], v9 offset:13312
  s_waitcnt lgkmcnt(3)
  v_mfma_f32_32x32x16_bf16 v[64:79], a[40:43], v[136:139], v[64:79]
  v_mfma_f32_32x32x16_bf16 v[80:95], a[200:203], v[136:139], v[80:95]
  ds_read_b128 v[136:139], v9 offset:14336
  s_waitcnt lgkmcnt(3)
  v_mfma_f32_32x32x16_bf16 v[64:79], a[44:47], v[140:143], v[64:79]
  v_mfma_f32_32x32x16_bf16 v[80:95], a[204:207], v[140:143], v[80:95]
  ds_read_b128 v[140:143], v9 offset:15360
  s_waitcnt lgkmcnt(3)
  v_mfma_f32_32x32x16_bf16 v[64:79], a[48:51], v[128:131], v[64:79]
  v_mfma_f32_32x32x16_bf16 v[80:95], a[208:211], v[128:131], v[80:95]
  ds_read_b128 v[128:131], v9 offset:16384
  s_waitcnt lgkmcnt(3)
  v_mfma_f32_32x32x16_bf16 v[64:79], a[52:55], v[132:135], v[64:79]
  v_mfma_f32_32x32x16_bf16 v[80:95], a[212:215], v[132:135], v[80:95]
  ds_read_b128 v[132:135], v9 offset:17408
  s_waitcnt lgkmcnt(3)
  v_mfma_f32_32x32x16_bf16 v[64:79], a[56:59], v[136:139], v[64:79]
  v_mfma_f32_32x32x16_bf16 v[80:95], a[216:219], v[136:139], v[80:95]
  ds_read_b128 v[136:139], v9 offset:18432
  s_waitcnt lgkmcnt(3)
  v_mfma_f32_32x32x16_bf16 v[64:79], a[60:63], v[140:143], v[64:79]
  v_mfma_f32_32x32x16_bf16 v[80:95], a[220:223], v[140:143], v[80:95]
  ds_read_b128 v[140:143], v9 offset:19456
  s_waitcnt lgkmcnt(3)
  v_mfma_f32_32x32x16_bf16 v[64:79], a[64:67], v[128:131], v[64:79]
  v_mfma_f32_32x32x16_bf16 v[80:95], a[224:227], v[128:131], v[80:95]
  ds_read_b128 v[128:131], v9 offset:20480
  s_waitcnt lgkmcnt(3)
  v_mfma_f32_32x32x16_bf16 v[64:79], a[68:71], v[132:135], v[64:79]
  v_mfma_f32_32x32x16_bf16 v[80:95], a[228:231], v[132:135], v[80:95]
  ds_read_b128 v[132:135], v9 offset:21504
  s_waitcnt lgkmcnt(3)
  v_mfma_f32_32x32x16_bf16 v[64:79], a[72:75], v[136:139], v[64:79]
  v_mfma_f32_32x32x16_bf16 v[80:95], a[232:235], v[136:139], v[80:95]
  ds_read_b128 v[136:139], v9 offset:22528
  s_waitcnt lgkmcnt(3)
  v_mfma_f32_32x32x16_bf16 v[64:79], a[76:79], v[140:143], v[64:79]
  v_mfma_f32_32x32x16_bf16 v[80:95], a[236:239], v[140:143], v[80:95]
  ds_read_b128 v[140:143], v9 offset:23552
  s_waitcnt lgkmcnt(3)
  v_mfma_f32_32x32x16_bf16 v[64:79], a[80:83], v[128:131], v[64:79]
  v_mfma_f32_32x32x16_bf16 v[80:95], a[240:243], v[128:131], v[80:95]
  ds_read_b128 v[128:131], v9 offset:24576
  s_waitcnt lgkmcnt(3)
  v_mfma_f32_32x32x16_bf16 v[64:79], a[84:87], v[132:135], v[64:79]
  v_mfma_f32_32x32x16_bf16 v[80:95], a[244:247], v[132:135], v[80:95]
  ds_read_b128 v[132:135], v9 offset:25600
  s_waitcnt lgkmcnt(3)
  v_mfma_f32_32x32x16_bf16 v[64:79], a[88:91], v[136:139], v[64:79]
  v_mfma_f32_32x32x16_bf16 v[80:95], a[248:251], v[136:139], v[80:95]
  ds_read_b128 v[136:139], v9 offset:26624
  s_waitcnt lgkmcnt(3)
  v_mfma_f32_32x32x16_bf16 v[64:79], a[92:95], v[140:143], v[64:79]
  v_mfma_f32_32x32x16_bf16 v[80:95], a[252:255], v[140:143], v[80:95]
  ds_read_b128 v[140:143], v9 offset:27648
  s_waitcnt vmcnt(10)
  s_barrier
  s_cmp_eq_u32 s21, 0
  s_cbranch_scc0 mp_58
  v_mov_b32 v13, s50
  s_mov_b64 s[24:25], exec
  s_mov_b64 exec, 1
  buffer_store_dword v13, v12, s[8:11], 0 offen sc1
  s_mov_b64 exec, s[24:25]
mp_58:
  s_waitcnt lgkmcnt(3)
  v_mfma_f32_32x32x16_bf16 v[64:79], a[96:99], v[128:131], v[64:79]
  v_mfma_f32_32x32x16_bf16 v[80:95], v[192:195], v[128:131], v[80:95]
  ds_read_b128 v[128:131], v9 offset:28672
  s_waitcnt lgkmcnt(3)
  v_mfma_f32_32x32x16_bf16 v[64:79], a[100:103], v[132:135], v[64:79]
  v_mfma_f32_32x32x16_bf16 v[80:95], v[196:199], v[132:135], v[80:95]
  ds_read_b128 v[132:135], v9 offset:29696
  s_waitcnt lgkmcnt(3)
  v_mfma_f32_32x32x16_bf16 v[64:79], a[104:107], v[136:139], v[64:79]
  v_mfma_f32_32x32x16_bf16 v[80:95], v[200:203], v[136:139], v[80:95]
  ds_read_b128 v[136:139], v9 offset:30720
  s_waitcnt lgkmcnt(3)
  v_mfma_f32_32x32x16_bf16 v[64:79], a[108:111], v[140:143], v[64:79]
  v_mfma_f32_32x32x16_bf16 v[80:95], v[204:207], v[140:143], v[80:95]
  ds_read_b128 v[140:143], v9 offset:31744
  s_waitcnt lgkmcnt(3)
  v_mfma_f32_32x32x16_bf16 v[64:79], a[112:115], v[128:131], v[64:79]
  v_mfma_f32_32x32x16_bf16 v[80:95], v[208:211], v[128:131], v[80:95]
  ds_read_b128 v[128:131], v9 offset:32768
  s_waitcnt lgkmcnt(3)
  v_mfma_f32_32x32x16_bf16 v[64:79], a[116:119], v[132:135], v[64:79]
  v_mfma_f32_32x32x16_bf16 v[80:95], v[212:215], v[132:135], v[80:95]
  ds_read_b128 v[132:135], v9 offset:33792
  s_waitcnt lgkmcnt(3)
  v_mfma_f32_32x32x16_bf16 v[64:79], a[120:123], v[136:139], v[64:79]
  v_mfma_f32_32x32x16_bf16 v[80:95], v[216:219], v[136:139], v[80:95]
  ds_read_b128 v[136:139], v9 offset:34816
  s_waitcnt lgkmcnt(3)
  v_mfma_f32_32x32x16_bf16 v[64:79], a[124:127], v[140:143], v[64:79]
  v_mfma_f32_32x32x16_bf16 v[80:95], v[220:223], v[140:143], v[80:95]
  ds_read_b128 v[140:143], v9 offset:35840
  s_waitcnt lgkmcnt(3)
  v_mfma_f32_32x32x16_bf16 v[64:79], a[128:131], v[128:131], v[64:79]
  v_mfma_f32_32x32x16_bf16 v[80:95], v[224:227], v[128:131], v[80:95]
  ds_read_b128 v[128:131], v9 offset:36864
  s_waitcnt lgkmcnt(3)
  v_mfma_f32_32x32x16_bf16 v[64:79], a[132:135], v[132:135], v[64:79]
  v_mfma_f32_32x32x16_bf16 v[80:95], v[228:231], v[132:135], v[80:95]
  ds_read_b128 v[132:135], v9 offset:37888
  s_waitcnt lgkmcnt(3)
  v_mfma_f32_32x32x16_bf16 v[64:79], a[136:139], v[136:139], v[64:79]
  v_mfma_f32_32x32x16_bf16 v[80:95], v[232:235], v[136:139], v[80:95]
  ds_read_b128 v[136:139], v9 offset:38912
  s_waitcnt lgkmcnt(3)
  v_mfma_f32_32x32x16_bf16 v[64:79], a[140:143], v[140:143], v[64:79]
  v_mfma_f32_32x32x16_bf16 v[80:95], v[236:239], v[140:143], v[80:95]
  ds_read_b128 v[140:143], v9 offset:39936
  s_waitcnt lgkmcnt(3)
  v_mfma_f32_32x32x16_bf16 v[64:79], a[144:147], v[128:131], v[64:79]
  v_mfma_f32_32x32x16_bf16 v[80:95], v[240:243], v[128:131], v[80:95]
  s_waitcnt lgkmcnt(2)
  v_mfma_f32_32x32x16_bf16 v[64:79], a[148:151], v[132:135], v[64:79]
  v_mfma_f32_32x32x16_bf16 v[80:95], v[244:247], v[132:135], v[80:95]
  s_waitcnt lgkmcnt(1)
  v_mfma_f32_32x32x16_bf16 v[64:79], a[152:155], v[136:139], v[64:79]
  v_mfma_f32_32x32x16_bf16 v[80:95], v[248:251], v[136:139], v[80:95]
  s_waitcnt lgkmcnt(0)
  v_mfma_f32_32x32x16_bf16 v[64:79], a[156:159], v[140:143], v[64:79]
  v_mfma_f32_32x32x16_bf16 v[80:95], v[252:255], v[140:143], v[80:95]
  s_nop 11
  v_cvt_pk_bf16_f32 v144, v64, v65
  v_cvt_pk_bf16_f32 v145, v66, v67
  v_cvt_pk_bf16_f32 v146, v68, v69
  v_cvt_pk_bf16_f32 v147, v70, v71
  v_cvt_pk_bf16_f32 v148, v72, v73
  v_cvt_pk_bf16_f32 v149, v74, v75
  v_cvt_pk_bf16_f32 v150, v76, v77
  v_cvt_pk_bf16_f32 v151, v78, v79
  v_cvt_pk_bf16_f32 v152, v80, v81
  v_cvt_pk_bf16_f32 v153, v82, v83
  v_cvt_pk_bf16_f32 v154, v84, v85
  v_cvt_pk_bf16_f32 v155, v86, v87
  v_cvt_pk_bf16_f32 v156, v88, v89
  v_cvt_pk_bf16_f32 v157, v90, v91
  v_cvt_pk_bf16_f32 v158, v92, v93
  v_cvt_pk_bf16_f32 v159, v94, v95
  s_mul_i32 s28, s50, 12288
  s_add_u32 s29, s28, s48
  buffer_store_dwordx4 v[144:147], v11, s[8:11], s29 offen offset:0 sc1
  buffer_store_dwordx4 v[148:151], v11, s[8:11], s29 offen offset:256 sc1
  s_add_u32 s29, s28, s49
  buffer_store_dwordx4 v[152:155], v11, s[8:11], s29 offen offset:0 sc1
  buffer_store_dwordx4 v[156:159], v11, s[8:11], s29 offen offset:256 sc1
  s_add_u32 s50, s50, 1
  s_waitcnt vmcnt(4)
  s_barrier
  s_cmp_ge_u32 s50, 63
  s_cbranch_scc1 qn_59_n
  s_lshl_b32 s29, s21, 10
  s_add_u32 m0, s29, 122880
  s_add_u32 s28, s51, 0
  buffer_load_dwordx4 v6, s[8:11], s28 offen sc1 lds
  s_lshl_b32 s29, s21, 10
  s_add_u32 m0, s29, 126976
  s_add_u32 s28, s51, 4096
  buffer_load_dwordx4 v6, s[8:11], s28 offen sc1 lds
  s_lshl_b32 s29, s21, 10
  s_add_u32 m0, s29, 131072
  s_add_u32 s28, s51, 8192
  buffer_load_dwordx4 v6, s[8:11], s28 offen sc1 lds
  s_lshl_b32 s29, s21, 10
  s_add_u32 m0, s29, 135168
  s_add_u32 s28, s51, 12288
  buffer_load_dwordx4 v6, s[8:11], s28 offen sc1 lds
  s_lshl_b32 s29, s21, 10
  s_add_u32 m0, s29, 139264
  s_add_u32 s28, s51, 16384
  buffer_load_dwordx4 v6, s[8:11], s28 offen sc1 lds
  s_lshl_b32 s29, s21, 10
  s_add_u32 m0, s29, 143360
  s_add_u32 s28, s51, 20480
  buffer_load_dwordx4 v6, s[8:11], s28 offen sc1 lds
  s_lshl_b32 s29, s21, 10
  s_add_u32 m0, s29, 147456
  s_add_u32 s28, s51, 24576
  buffer_load_dwordx4 v6, s[8:11], s28 offen sc1 lds
  s_lshl_b32 s29, s21, 10
  s_add_u32 m0, s29, 151552
  s_add_u32 s28, s51, 28672
  buffer_load_dwordx4 v6, s[8:11], s28 offen sc1 lds
  s_lshl_b32 s29, s21, 10
  s_add_u32 m0, s29, 155648
  s_add_u32 s28, s51, 32768
  buffer_load_dwordx4 v6, s[8:11], s28 offen sc1 lds
  s_lshl_b32 s29, s21, 10
  s_add_u32 m0, s29, 159744
  s_add_u32 s28, s51, 36864
  buffer_load_dwordx4 v6, s[8:11], s28 offen sc1 lds
  s_add_u32 s51, s51, 40960
  s_branch qn_59
qn_59_n:
  s_waitcnt vmcnt(0)
qn_59:
  ds_read_b128 v[128:131], v10 offset:0
  ds_read_b128 v[132:135], v10 offset:1024
  ds_read_b128 v[136:139], v10 offset:2048
  ds_read_b128 v[140:143], v10 offset:3072
  s_waitcnt lgkmcnt(3)
  v_mfma_f32_32x32x16_bf16 v[64:79], a[0:3], v[128:131], 0
  v_mfma_f32_32x32x16_bf16 v[80:95], a[160:163], v[128:131], 0
  ds_read_b128 v[128:131], v10 offset:4096
  s_waitcnt lgkmcnt(3)
  v_mfma_f32_32x32x16_bf16 v[64:79], a[4:7], v[132:135], v[64:79]
  v_mfma_f32_32x32x16_bf16 v[80:95], a[164:167], v[132:135], v[80:95]
  ds_read_b128 v[132:135], v10 offset:5120
  s_waitcnt lgkmcnt(3)
  v_mfma_f32_32x32x16_bf16 v[64:79], a[8:11], v[136:139], v[64:79]
  v_mfma_f32_32x32x16_bf16 v[80:95], a[168:171], v[136:139], v[80:95]
  ds_read_b128 v[136:139], v10 offset:6144
  s_waitcnt lgkmcnt(3)
  v_mfma_f32_32x32x16_bf16 v[64:79], a[12:15], v[140:143], v[64:79]
  v_mfma_f32_32x32x16_bf16 v[80:95], a[172:175], v[140:143], v[80:95]
  ds_read_b128 v[140:143], v10 offset:7168
  s_waitcnt lgkmcnt(3)
  v_mfma_f32_32x32x16_bf16 v[64:79], a[16:19], v[128:131], v[64:79]
  v_mfma_f32_32x32x16_bf16 v[80:95], a[176:179], v[128:131], v[80:95]
  ds_read_b128 v[128:131], v10 offset:8192
  s_waitcnt lgkmcnt(3)
  v_mfma_f32_32x32x16_bf16 v[64:79], a[20:23], v[132:135], v[64:79]
  v_mfma_f32_32x32x16_bf16 v[80:95], a[180:183], v[132:135], v[80:95]
  ds_read_b128 v[132:135], v10 offset:9216
  s_waitcnt lgkmcnt(3)
  v_mfma_f32_32x32x16_bf16 v[64:79], a[24:27], v[136:139], v[64:79]
  v_mfma_f32_32x32x16_bf16 v[80:95], a[184:187], v[136:139], v[80:95]
  ds_read_b128 v[136:139], v10 offset:10240
  s_waitcnt lgkmcnt(3)
  v_mfma_f32_32x32x16_bf16 v[64:79], a[28:31], v[140:143], v[64:79]
  v_mfma_f32_32x32x16_bf16 v[80:95], a[188:191], v[140:143], v[80:95]
  ds_read_b128 v[140:143], v10 offset:11264
  s_waitcnt lgkmcnt(3)
  v_mfma_f32_32x32x16_bf16 v[64:79], a[32:35], v[128:131], v[64:79]
  v_mfma_f32_32x32x16_bf16 v[80:95], a[192:195], v[128:131], v[80:95]
  ds_read_b128 v[128:131], v10 offset:12288
  s_waitcnt lgkmcnt(3)
  v_mfma_f32_32x32x16_bf16 v[64:79], a[36:39], v[132:135], v[64:79]
  v_mfma_f32_32x32x16_bf16 v[80:95], a[196:199], v[132:135], v[80:95]
  ds_read_b128 v[132:135], v10 offset:13312
  s_waitcnt lgkmcnt(3)
  v_mfma_f32_32x32x16_bf16 v[64:79], a[40:43], v[136:139], v[64:79]
  v_mfma_f32_32x32x16_bf16 v[80:95], a[200:203], v[136:139], v[80:95]
  ds_read_b128 v[136:139], v10 offset:14336
  s_waitcnt lgkmcnt(3)
  v_mfma_f32_32x32x16_bf16 v[64:79], a[44:47], v[140:143], v[64:79]
  v_mfma_f32_32x32x16_bf16 v[80:95], a[204:207], v[140:143], v[80:95]
  ds_read_b128 v[140:143], v10 offset:15360
  s_waitcnt lgkmcnt(3)
  v_mfma_f32_32x32x16_bf16 v[64:79], a[48:51], v[128:131], v[64:79]
  v_mfma_f32_32x32x16_bf16 v[80:95], a[208:211], v[128:131], v[80:95]
  ds_read_b128 v[128:131], v10 offset:16384
  s_waitcnt lgkmcnt(3)
  v_mfma_f32_32x32x16_bf16 v[64:79], a[52:55], v[132:135], v[64:79]
  v_mfma_f32_32x32x16_bf16 v[80:95], a[212:215], v[132:135], v[80:95]
  ds_read_b128 v[132:135], v10 offset:17408
  s_waitcnt lgkmcnt(3)
  v_mfma_f32_32x32x16_bf16 v[64:79], a[56:59], v[136:139], v[64:79]
  v_mfma_f32_32x32x16_bf16 v[80:95], a[216:219], v[136:139], v[80:95]
  ds_read_b128 v[136:139], v10 offset:18432
  s_waitcnt lgkmcnt(3)
  v_mfma_f32_32x32x16_bf16 v[64:79], a[60:63], v[140:143], v[64:79]
  v_mfma_f32_32x32x16_bf16 v[80:95], a[220:223], v[140:143], v[80:95]
  ds_read_b128 v[140:143], v10 offset:19456
  s_waitcnt lgkmcnt(3)
  v_mfma_f32_32x32x16_bf16 v[64:79], a[64:67], v[128:131], v[64:79]
  v_mfma_f32_32x32x16_bf16 v[80:95], a[224:227], v[128:131], v[80:95]
  ds_read_b128 v[128:131], v10 offset:20480
  s_waitcnt lgkmcnt(3)
  v_mfma_f32_32x32x16_bf16 v[64:79], a[68:71], v[132:135], v[64:79]
  v_mfma_f32_32x32x16_bf16 v[80:95], a[228:231], v[132:135], v[80:95]
  ds_read_b128 v[132:135], v10 offset:21504
  s_waitcnt lgkmcnt(3)
  v_mfma_f32_32x32x16_bf16 v[64:79], a[72:75], v[136:139], v[64:79]
  v_mfma_f32_32x32x16_bf16 v[80:95], a[232:235], v[136:139], v[80:95]
  ds_read_b128 v[136:139], v10 offset:22528
  s_waitcnt lgkmcnt(3)
  v_mfma_f32_32x32x16_bf16 v[64:79], a[76:79], v[140:143], v[64:79]
  v_mfma_f32_32x32x16_bf16 v[80:95], a[236:239], v[140:143], v[80:95]
  ds_read_b128 v[140:143], v10 offset:23552
  s_waitcnt lgkmcnt(3)
  v_mfma_f32_32x32x16_bf16 v[64:79], a[80:83], v[128:131], v[64:79]
  v_mfma_f32_32x32x16_bf16 v[80:95], a[240:243], v[128:131], v[80:95]
  ds_read_b128 v[128:131], v10 offset:24576
  s_waitcnt lgkmcnt(3)
  v_mfma_f32_32x32x16_bf16 v[64:79], a[84:87], v[132:135], v[64:79]
  v_mfma_f32_32x32x16_bf16 v[80:95], a[244:247], v[132:135], v[80:95]
  ds_read_b128 v[132:135], v10 offset:25600
  s_waitcnt lgkmcnt(3)
  v_mfma_f32_32x32x16_bf16 v[64:79], a[88:91], v[136:139], v[64:79]
  v_mfma_f32_32x32x16_bf16 v[80:95], a[248:251], v[136:139], v[80:95]
  ds_read_b128 v[136:139], v10 offset:26624
  s_waitcnt lgkmcnt(3)
  v_mfma_f32_32x32x16_bf16 v[64:79], a[92:95], v[140:143], v[64:79]
  v_mfma_f32_32x32x16_bf16 v[80:95], a[252:255], v[140:143], v[80:95]
  ds_read_b128 v[140:143], v10 offset:27648
  s_waitcnt vmcnt(10)
  s_barrier
  s_cmp_eq_u32 s21, 0
  s_cbranch_scc0 mp_60
  v_mov_b32 v13, s50
  s_mov_b64 s[24:25], exec
  s_mov_b64 exec, 1
  buffer_store_dword v13, v12, s[8:11], 0 offen sc1
  s_mov_b64 exec, s[24:25]
mp_60:
  s_waitcnt lgkmcnt(3)
  v_mfma_f32_32x32x16_bf16 v[64:79], a[96:99], v[128:131], v[64:79]
  v_mfma_f32_32x32x16_bf16 v[80:95], v[192:195], v[128:131], v[80:95]
  ds_read_b128 v[128:131], v10 offset:28672
  s_waitcnt lgkmcnt(3)
  v_mfma_f32_32x32x16_bf16 v[64:79], a[100:103], v[132:135], v[64:79]
  v_mfma_f32_32x32x16_bf16 v[80:95], v[196:199], v[132:135], v[80:95]
  ds_read_b128 v[132:135], v10 offset:29696
  s_waitcnt lgkmcnt(3)
  v_mfma_f32_32x32x16_bf16 v[64:79], a[104:107], v[136:139], v[64:79]
  v_mfma_f32_32x32x16_bf16 v[80:95], v[200:203], v[136:139], v[80:95]
  ds_read_b128 v[136:139], v10 offset:30720
  s_waitcnt lgkmcnt(3)
  v_mfma_f32_32x32x16_bf16 v[64:79], a[108:111], v[140:143], v[64:79]
  v_mfma_f32_32x32x16_bf16 v[80:95], v[204:207], v[140:143], v[80:95]
  ds_read_b128 v[140:143], v10 offset:31744
  s_waitcnt lgkmcnt(3)
  v_mfma_f32_32x32x16_bf16 v[64:79], a[112:115], v[128:131], v[64:79]
  v_mfma_f32_32x32x16_bf16 v[80:95], v[208:211], v[128:131], v[80:95]
  ds_read_b128 v[128:131], v10 offset:32768
  s_waitcnt lgkmcnt(3)
  v_mfma_f32_32x32x16_bf16 v[64:79], a[116:119], v[132:135], v[64:79]
  v_mfma_f32_32x32x16_bf16 v[80:95], v[212:215], v[132:135], v[80:95]
  ds_read_b128 v[132:135], v10 offset:33792
  s_waitcnt lgkmcnt(3)
  v_mfma_f32_32x32x16_bf16 v[64:79], a[120:123], v[136:139], v[64:79]
  v_mfma_f32_32x32x16_bf16 v[80:95], v[216:219], v[136:139], v[80:95]
  ds_read_b128 v[136:139], v10 offset:34816
  s_waitcnt lgkmcnt(3)
  v_mfma_f32_32x32x16_bf16 v[64:79], a[124:127], v[140:143], v[64:79]
  v_mfma_f32_32x32x16_bf16 v[80:95], v[220:223], v[140:143], v[80:95]
  ds_read_b128 v[140:143], v10 offset:35840
  s_waitcnt lgkmcnt(3)
  v_mfma_f32_32x32x16_bf16 v[64:79], a[128:131], v[128:131], v[64:79]
  v_mfma_f32_32x32x16_bf16 v[80:95], v[224:227], v[128:131], v[80:95]
  ds_read_b128 v[128:131], v10 offset:36864
  s_waitcnt lgkmcnt(3)
  v_mfma_f32_32x32x16_bf16 v[64:79], a[132:135], v[132:135], v[64:79]
  v_mfma_f32_32x32x16_bf16 v[80:95], v[228:231], v[132:135], v[80:95]
  ds_read_b128 v[132:135], v10 offset:37888
  s_waitcnt lgkmcnt(3)
  v_mfma_f32_32x32x16_bf16 v[64:79], a[136:139], v[136:139], v[64:79]
  v_mfma_f32_32x32x16_bf16 v[80:95], v[232:235], v[136:139], v[80:95]
  ds_read_b128 v[136:139], v10 offset:38912
  s_waitcnt lgkmcnt(3)
  v_mfma_f32_32x32x16_bf16 v[64:79], a[140:143], v[140:143], v[64:79]
  v_mfma_f32_32x32x16_bf16 v[80:95], v[236:239], v[140:143], v[80:95]
  ds_read_b128 v[140:143], v10 offset:39936
  s_waitcnt lgkmcnt(3)
  v_mfma_f32_32x32x16_bf16 v[64:79], a[144:147], v[128:131], v[64:79]
  v_mfma_f32_32x32x16_bf16 v[80:95], v[240:243], v[128:131], v[80:95]
  s_waitcnt lgkmcnt(2)
  v_mfma_f32_32x32x16_bf16 v[64:79], a[148:151], v[132:135], v[64:79]
  v_mfma_f32_32x32x16_bf16 v[80:95], v[244:247], v[132:135], v[80:95]
  s_waitcnt lgkmcnt(1)
  v_mfma_f32_32x32x16_bf16 v[64:79], a[152:155], v[136:139], v[64:79]
  v_mfma_f32_32x32x16_bf16 v[80:95], v[248:251], v[136:139], v[80:95]
  s_waitcnt lgkmcnt(0)
  v_mfma_f32_32x32x16_bf16 v[64:79], a[156:159], v[140:143], v[64:79]
  v_mfma_f32_32x32x16_bf16 v[80:95], v[252:255], v[140:143], v[80:95]
  s_nop 11
  v_cvt_pk_bf16_f32 v144, v64, v65
  v_cvt_pk_bf16_f32 v145, v66, v67
  v_cvt_pk_bf16_f32 v146, v68, v69
  v_cvt_pk_bf16_f32 v147, v70, v71
  v_cvt_pk_bf16_f32 v148, v72, v73
  v_cvt_pk_bf16_f32 v149, v74, v75
  v_cvt_pk_bf16_f32 v150, v76, v77
  v_cvt_pk_bf16_f32 v151, v78, v79
  v_cvt_pk_bf16_f32 v152, v80, v81
  v_cvt_pk_bf16_f32 v153, v82, v83
  v_cvt_pk_bf16_f32 v154, v84, v85
  v_cvt_pk_bf16_f32 v155, v86, v87
  v_cvt_pk_bf16_f32 v156, v88, v89
  v_cvt_pk_bf16_f32 v157, v90, v91
  v_cvt_pk_bf16_f32 v158, v92, v93
  v_cvt_pk_bf16_f32 v159, v94, v95
  s_mul_i32 s28, s50, 12288
  s_add_u32 s29, s28, s48
  buffer_store_dwordx4 v[144:147], v11, s[8:11], s29 offen offset:0 sc1
  buffer_store_dwordx4 v[148:151], v11, s[8:11], s29 offen offset:256 sc1
  s_add_u32 s29, s28, s49
  buffer_store_dwordx4 v[152:155], v11, s[8:11], s29 offen offset:0 sc1
  buffer_store_dwordx4 v[156:159], v11, s[8:11], s29 offen offset:256 sc1
  s_add_u32 s50, s50, 1
  s_cmp_lt_u32 s50, 64
  s_cbranch_scc1 ka_qkv_loop
  s_waitcnt vmcnt(0)
  s_barrier
  s_cmp_eq_u32 s21, 0
  s_cbranch_scc0 ka_exit
  v_mov_b32 v13, 64
  s_mov_b64 exec, 1
  buffer_store_dword v13, v12, s[8:11], 0 offen sc1
  s_waitcnt vmcnt(0)
  s_branch ka_exit
ka_u:
  s_mov_b32 s12, s42
  s_and_b32 s13, s43, 0xffff
  s_mov_b32 s14, 0x780000
  s_mov_b32 s15, 0x20000
  v_and_b32 v1, 63, v0
  v_lshrrev_b32 v2, 4, v1
  v_bfe_u32 v3, v1, 2, 2
  v_and_b32 v4, 3, v1
  s_lshl_b32 s28, s21, 3
  v_add_u32 v5, s28, v3
  v_mul_u32_u24 v5, 1280, v5
  v_lshlrev_b32 v6, 6, v2
  v_add_u32 v5, v5, v6
  v_lshlrev_b32 v6, 4, v4
  v_add_u32 v5, v5, v6
  v_lshrrev_b32 v6, 1, v2
  v_mul_u32_u24 v7, 20480, v6
  v_lshlrev_b32 v6, 6, v3
  v_add_u32 v7, v7, v6
  v_and_b32 v6, 1, v2
  v_lshlrev_b32 v6, 5, v6
  v_add_u32 v7, v7, v6
  v_lshrrev_b32 v6, 1, v4
  v_lshlrev_b32 v6, 4, v6
  v_add_u32 v7, v7, v6
  v_and_b32 v6, 1, v4
  v_lshlrev_b32 v6, 3, v6
  v_add_u32 v7, v7, v6
  s_mul_i32 s28, s21, 1280
  v_add_u32 v7, s28, v7
  s_mul_i32 s46, s23, 245760
  s_mul_i32 s29, s21, 10240
  s_add_u32 m0, s29, 0
  s_add_u32 s28, s46, 0
  buffer_load_dwordx4 v5, s[12:15], s28 offen lds
  s_mul_i32 s29, s21, 10240
  s_add_u32 m0, s29, 1024
  s_add_u32 s28, s46, 256
  buffer_load_dwordx4 v5, s[12:15], s28 offen lds
  s_mul_i32 s29, s21, 10240
  s_add_u32 m0, s29, 2048
  s_add_u32 s28, s46, 512
  buffer_load_dwordx4 v5, s[12:15], s28 offen lds
  s_mul_i32 s29, s21, 10240
  s_add_u32 m0, s29, 3072
  s_add_u32 s28, s46, 768
  buffer_load_dwordx4 v5, s[12:15], s28 offen lds
  s_mul_i32 s29, s21, 10240
  s_add_u32 m0, s29, 4096
  s_add_u32 s28, s46, 1024
  buffer_load_dwordx4 v5, s[12:15], s28 offen lds
  s_mul_i32 s29, s21, 10240
  s_add_u32 m0, s29, 5120
  s_add_u32 s28, s46, 5120
  buffer_load_dwordx4 v5, s[12:15], s28 offen lds
  s_mul_i32 s29, s21, 10240
  s_add_u32 m0, s29, 6144
  s_add_u32 s28, s46, 5376
  buffer_load_dwordx4 v5, s[12:15], s28 offen lds
  s_mul_i32 s29, s21, 10240
  s_add_u32 m0, s29, 7168
  s_add_u32 s28, s46, 5632
  buffer_load_dwordx4 v5, s[12:15], s28 offen lds
  s_mul_i32 s29, s21, 10240
  s_add_u32 m0, s29, 8192
  s_add_u32 s28, s46, 5888
  buffer_load_dwordx4 v5, s[12:15], s28 offen lds
  s_mul_i32 s29, s21, 10240
  s_add_u32 m0, s29, 9216
  s_add_u32 s28, s46, 6144
  buffer_load_dwordx4 v5, s[12:15], s28 offen lds
  s_mul_i32 s29, s21, 10240
  s_add_u32 m0, s29, 40960
  s_add_u32 s28, s46, 40960
  buffer_load_dwordx4 v5, s[12:15], s28 offen lds
  s_mul_i32 s29, s21, 10240
  s_add_u32 m0, s29, 41984
  s_add_u32 s28, s46, 41216
  buffer_load_dwordx4 v5, s[12:15], s28 offen lds
  s_mul_i32 s29, s21, 10240
  s_add_u32 m0, s29, 43008
  s_add_u32 s28, s46, 41472
  buffer_load_dwordx4 v5, s[12:15], s28 offen lds
  s_mul_i32 s29, s21, 10240
  s_add_u32 m0, s29, 44032
  s_add_u32 s28, s46, 41728
  buffer_load_dwordx4 v5, s[12:15], s28 offen lds
  s_mul_i32 s29, s21, 10240
  s_add_u32 m0, s29, 45056
  s_add_u32 s28, s46, 41984
  buffer_load_dwordx4 v5, s[12:15], s28 offen lds
  s_mul_i32 s29, s21, 10240
  s_add_u32 m0, s29, 46080
  s_add_u32 s28, s46, 46080
  buffer_load_dwordx4 v5, s[12:15], s28 offen lds
  s_mul_i32 s29, s21, 10240
  s_add_u32 m0, s29, 47104
  s_add_u32 s28, s46, 46336
  buffer_load_dwordx4 v5, s[12:15], s28 offen lds
  s_mul_i32 s29, s21, 10240
  s_add_u32 m0, s29, 48128
  s_add_u32 s28, s46, 46592
  buffer_load_dwordx4 v5, s[12:15], s28 offen lds
  s_mul_i32 s29, s21, 10240
  s_add_u32 m0, s29, 49152
  s_add_u32 s28, s46, 46848
  buffer_load_dwordx4 v5, s[12:15], s28 offen lds
  s_mul_i32 s29, s21, 10240
  s_add_u32 m0, s29, 50176
  s_add_u32 s28, s46, 47104
  buffer_load_dwordx4 v5, s[12:15], s28 offen lds
  s_waitcnt vmcnt(10)
  s_cmp_eq_u32 s21, 3
  s_cbranch_scc0 lna_61
  s_mov_b64 s[24:25], exec
  s_mov_b64 exec, 1
  v_mov_b32 v2, 4992
  v_mov_b32 v3, 1
  buffer_atomic_add v3, v2, s[8:11], 0 offen
  s_mov_b64 exec, s[24:25]
lna_61:
  s_barrier
  s_mul_i32 s29, s21, 10240
  s_add_u32 m0, s29, 81920
  s_add_u32 s28, s46, 81920
  buffer_load_dwordx4 v5, s[12:15], s28 offen lds
  s_mul_i32 s29, s21, 10240
  s_add_u32 m0, s29, 82944
  s_add_u32 s28, s46, 82176
  buffer_load_dwordx4 v5, s[12:15], s28 offen lds
  s_mul_i32 s29, s21, 10240
  s_add_u32 m0, s29, 83968
  s_add_u32 s28, s46, 82432
  buffer_load_dwordx4 v5, s[12:15], s28 offen lds
  s_mul_i32 s29, s21, 10240
  s_add_u32 m0, s29, 84992
  s_add_u32 s28, s46, 82688
  buffer_load_dwordx4 v5, s[12:15], s28 offen lds
  s_mul_i32 s29, s21, 10240
  s_add_u32 m0, s29, 86016
  s_add_u32 s28, s46, 82944
  buffer_load_dwordx4 v5, s[12:15], s28 offen lds
  s_mul_i32 s29, s21, 10240
  s_add_u32 m0, s29, 87040
  s_add_u32 s28, s46, 87040
  buffer_load_dwordx4 v5, s[12:15], s28 offen lds
  s_mul_i32 s29, s21, 10240
  s_add_u32 m0, s29, 88064
  s_add_u32 s28, s46, 87296
  buffer_load_dwordx4 v5, s[12:15], s28 offen lds
  s_mul_i32 s29, s21, 10240
  s_add_u32 m0, s29, 89088
  s_add_u32 s28, s46, 87552
  buffer_load_dwordx4 v5, s[12:15], s28 offen lds
  s_mul_i32 s29, s21, 10240
  s_add_u32 m0, s29, 90112
  s_add_u32 s28, s46, 87808
  buffer_load_dwordx4 v5, s[12:15], s28 offen lds
  s_mul_i32 s29, s21, 10240
  s_add_u32 m0, s29, 91136
  s_add_u32 s28, s46, 88064
  buffer_load_dwordx4 v5, s[12:15], s28 offen lds
  v_add_u32 v8, 0, v7
  ds_read_b64_tr_b16 a[0:1], v8 offset:0
  ds_read_b64_tr_b16 a[2:3], v8 offset:10240
  ds_read_b64_tr_b16 a[4:5], v8 offset:5120
  ds_read_b64_tr_b16 a[6:7], v8 offset:15360
  ds_read_b64_tr_b16 a[48:49], v8 offset:256
  ds_read_b64_tr_b16 a[50:51], v8 offset:10496
  ds_read_b64_tr_b16 a[52:53], v8 offset:5376
  ds_read_b64_tr_b16 a[54:55], v8 offset:15616
  ds_read_b64_tr_b16 a[96:97], v8 offset:512
  ds_read_b64_tr_b16 a[98:99], v8 offset:10752
  ds_read_b64_tr_b16 a[100:101], v8 offset:5632
  ds_read_b64_tr_b16 a[102:103], v8 offset:15872
  s_waitcnt lgkmcnt(0)
  ds_read_b64_tr_b16 a[144:145], v8 offset:768
  ds_read_b64_tr_b16 a[146:147], v8 offset:11008
  ds_read_b64_tr_b16 a[148:149], v8 offset:5888
  ds_read_b64_tr_b16 a[150:151], v8 offset:16128
  ds_read_b64_tr_b16 a[192:193], v8 offset:1024
  ds_read_b64_tr_b16 a[194:195], v8 offset:11264
  ds_read_b64_tr_b16 a[196:197], v8 offset:6144
  ds_read_b64_tr_b16 a[198:199], v8 offset:16384
  s_waitcnt lgkmcnt(0)
  s_waitcnt vmcnt(10)
  s_barrier
  s_mul_i32 s29, s21, 10240
  s_add_u32 m0, s29, 0
  s_add_u32 s28, s46, 122880
  buffer_load_dwordx4 v5, s[12:15], s28 offen lds
  s_mul_i32 s29, s21, 10240
  s_add_u32 m0, s29, 1024
  s_add_u32 s28, s46, 123136
  buffer_load_dwordx4 v5, s[12:15], s28 offen lds
  s_mul_i32 s29, s21, 10240
  s_add_u32 m0, s29, 2048
  s_add_u32 s28, s46, 123392
  buffer_load_dwordx4 v5, s[12:15], s28 offen lds
  s_mul_i32 s29, s21, 10240
  s_add_u32 m0, s29, 3072
  s_add_u32 s28, s46, 123648
  buffer_load_dwordx4 v5, s[12:15], s28 offen lds
  s_mul_i32 s29, s21, 10240
  s_add_u32 m0, s29, 4096
  s_add_u32 s28, s46, 123904
  buffer_load_dwordx4 v5, s[12:15], s28 offen lds
  s_mul_i32 s29, s21, 10240
  s_add_u32 m0, s29, 5120
  s_add_u32 s28, s46, 128000
  buffer_load_dwordx4 v5, s[12:15], s28 offen lds
  s_mul_i32 s29, s21, 10240
  s_add_u32 m0, s29, 6144
  s_add_u32 s28, s46, 128256
  buffer_load_dwordx4 v5, s[12:15], s28 offen lds
  s_mul_i32 s29, s21, 10240
  s_add_u32 m0, s29, 7168
  s_add_u32 s28, s46, 128512
  buffer_load_dwordx4 v5, s[12:15], s28 offen lds
  s_mul_i32 s29, s21, 10240
  s_add_u32 m0, s29, 8192
  s_add_u32 s28, s46, 128768
  buffer_load_dwordx4 v5, s[12:15], s28 offen lds
  s_mul_i32 s29, s21, 10240
  s_add_u32 m0, s29, 9216
  s_add_u32 s28, s46, 129024
  buffer_load_dwordx4 v5, s[12:15], s28 offen lds
  v_add_u32 v8, 40960, v7
  ds_read_b64_tr_b16 a[8:9], v8 offset:0
  ds_read_b64_tr_b16 a[10:11], v8 offset:10240
  ds_read_b64_tr_b16 a[12:13], v8 offset:5120
  ds_read_b64_tr_b16 a[14:15], v8 offset:15360
  ds_read_b64_tr_b16 a[56:57], v8 offset:256
  ds_read_b64_tr_b16 a[58:59], v8 offset:10496
  ds_read_b64_tr_b16 a[60:61], v8 offset:5376
  ds_read_b64_tr_b16 a[62:63], v8 offset:15616
  ds_read_b64_tr_b16 a[104:105], v8 offset:512
  ds_read_b64_tr_b16 a[106:107], v8 offset:10752
  ds_read_b64_tr_b16 a[108:109], v8 offset:5632
  ds_read_b64_tr_b16 a[110:111], v8 offset:15872
  s_waitcnt lgkmcnt(0)
  ds_read_b64_tr_b16 a[152:153], v8 offset:768
  ds_read_b64_tr_b16 a[154:155], v8 offset:11008
  ds_read_b64_tr_b16 a[156:157], v8 offset:5888
  ds_read_b64_tr_b16 a[158:159], v8 offset:16128
  ds_read_b64_tr_b16 a[200:201], v8 offset:1024
  ds_read_b64_tr_b16 a[202:203], v8 offset:11264
  ds_read_b64_tr_b16 a[204:205], v8 offset:6144
  ds_read_b64_tr_b16 a[206:207], v8 offset:16384
  s_waitcnt lgkmcnt(0)
  s_waitcnt vmcnt(10)
  s_barrier
  s_mul_i32 s29, s21, 10240
  s_add_u32 m0, s29, 40960
  s_add_u32 s28, s46, 163840
  buffer_load_dwordx4 v5, s[12:15], s28 offen lds
  s_mul_i32 s29, s21, 10240
  s_add_u32 m0, s29, 41984
  s_add_u32 s28, s46, 164096
  buffer_load_dwordx4 v5, s[12:15], s28 offen lds
  s_mul_i32 s29, s21, 10240
  s_add_u32 m0, s29, 43008
  s_add_u32 s28, s46, 164352
  buffer_load_dwordx4 v5, s[12:15], s28 offen lds
  s_mul_i32 s29, s21, 10240
  s_add_u32 m0, s29, 44032
  s_add_u32 s28, s46, 164608
  buffer_load_dwordx4 v5, s[12:15], s28 offen lds
  s_mul_i32 s29, s21, 10240
  s_add_u32 m0, s29, 45056
  s_add_u32 s28, s46, 164864
  buffer_load_dwordx4 v5, s[12:15], s28 offen lds
  s_mul_i32 s29, s21, 10240
  s_add_u32 m0, s29, 46080
  s_add_u32 s28, s46, 168960
  buffer_load_dwordx4 v5, s[12:15], s28 offen lds
  s_mul_i32 s29, s21, 10240
  s_add_u32 m0, s29, 47104
  s_add_u32 s28, s46, 169216
  buffer_load_dwordx4 v5, s[12:15], s28 offen lds
  s_mul_i32 s29, s21, 10240
  s_add_u32 m0, s29, 48128
  s_add_u32 s28, s46, 169472
  buffer_load_dwordx4 v5, s[12:15], s28 offen lds
  s_mul_i32 s29, s21, 10240
  s_add_u32 m0, s29, 49152
  s_add_u32 s28, s46, 169728
  buffer_load_dwordx4 v5, s[12:15], s28 offen lds
  s_mul_i32 s29, s21, 10240
  s_add_u32 m0, s29, 50176
  s_add_u32 s28, s46, 169984
  buffer_load_dwordx4 v5, s[12:15], s28 offen lds
  v_add_u32 v8, 81920, v7
  ds_read_b64_tr_b16 a[16:17], v8 offset:0
  ds_read_b64_tr_b16 a[18:19], v8 offset:10240
  ds_read_b64_tr_b16 a[20:21], v8 offset:5120
  ds_read_b64_tr_b16 a[22:23], v8 offset:15360
  ds_read_b64_tr_b16 a[64:65], v8 offset:256
  ds_read_b64_tr_b16 a[66:67], v8 offset:10496
  ds_read_b64_tr_b16 a[68:69], v8 offset:5376
  ds_read_b64_tr_b16 a[70:71], v8 offset:15616
  ds_read_b64_tr_b16 a[112:113], v8 offset:512
  ds_read_b64_tr_b16 a[114:115], v8 offset:10752
  ds_read_b64_tr_b16 a[116:117], v8 offset:5632
  ds_read_b64_tr_b16 a[118:119], v8 offset:15872
  s_waitcnt lgkmcnt(0)
  ds_read_b64_tr_b16 a[160:161], v8 offset:768
  ds_read_b64_tr_b16 a[162:163], v8 offset:11008
  ds_read_b64_tr_b16 a[164:165], v8 offset:5888
  ds_read_b64_tr_b16 a[166:167], v8 offset:16128
  ds_read_b64_tr_b16 a[208:209], v8 offset:1024
  ds_read_b64_tr_b16 a[210:211], v8 offset:11264
  ds_read_b64_tr_b16 a[212:213], v8 offset:6144
  ds_read_b64_tr_b16 a[214:215], v8 offset:16384
  s_waitcnt lgkmcnt(0)
  s_waitcnt vmcnt(10)
  s_barrier
  s_mul_i32 s29, s21, 10240
  s_add_u32 m0, s29, 81920
  s_add_u32 s28, s46, 204800
  buffer_load_dwordx4 v5, s[12:15], s28 offen lds
  s_mul_i32 s29, s21, 10240
  s_add_u32 m0, s29, 82944
  s_add_u32 s28, s46, 205056
  buffer_load_dwordx4 v5, s[12:15], s28 offen lds
  s_mul_i32 s29, s21, 10240
  s_add_u32 m0, s29, 83968
  s_add_u32 s28, s46, 205312
  buffer_load_dwordx4 v5, s[12:15], s28 offen lds
  s_mul_i32 s29, s21, 10240
  s_add_u32 m0, s29, 84992
  s_add_u32 s28, s46, 205568
  buffer_load_dwordx4 v5, s[12:15], s28 offen lds
  s_mul_i32 s29, s21, 10240
  s_add_u32 m0, s29, 86016
  s_add_u32 s28, s46, 205824
  buffer_load_dwordx4 v5, s[12:15], s28 offen lds
  s_mul_i32 s29, s21, 10240
  s_add_u32 m0, s29, 87040
  s_add_u32 s28, s46, 209920
  buffer_load_dwordx4 v5, s[12:15], s28 offen lds
  s_mul_i32 s29, s21, 10240
  s_add_u32 m0, s29, 88064
  s_add_u32 s28, s46, 210176
  buffer_load_dwordx4 v5, s[12:15], s28 offen lds
  s_mul_i32 s29, s21, 10240
  s_add_u32 m0, s29, 89088
  s_add_u32 s28, s46, 210432
  buffer_load_dwordx4 v5, s[12:15], s28 offen lds
  s_mul_i32 s29, s21, 10240
  s_add_u32 m0, s29, 90112
  s_add_u32 s28, s46, 210688
  buffer_load_dwordx4 v5, s[12:15], s28 offen lds
  s_mul_i32 s29, s21, 10240
  s_add_u32 m0, s29, 91136
  s_add_u32 s28, s46, 210944
  buffer_load_dwordx4 v5, s[12:15], s28 offen lds
  v_add_u32 v8, 0, v7
  ds_read_b64_tr_b16 a[24:25], v8 offset:0
  ds_read_b64_tr_b16 a[26:27], v8 offset:10240
  ds_read_b64_tr_b16 a[28:29], v8 offset:5120
  ds_read_b64_tr_b16 a[30:31], v8 offset:15360
  ds_read_b64_tr_b16 a[72:73], v8 offset:256
  ds_read_b64_tr_b16 a[74:75], v8 offset:10496
  ds_read_b64_tr_b16 a[76:77], v8 offset:5376
  ds_read_b64_tr_b16 a[78:79], v8 offset:15616
  ds_read_b64_tr_b16 a[120:121], v8 offset:512
  ds_read_b64_tr_b16 a[122:123], v8 offset:10752
  ds_read_b64_tr_b16 a[124:125], v8 offset:5632
  ds_read_b64_tr_b16 a[126:127], v8 offset:15872
  s_waitcnt lgkmcnt(0)
  ds_read_b64_tr_b16 a[168:169], v8 offset:768
  ds_read_b64_tr_b16 a[170:171], v8 offset:11008
  ds_read_b64_tr_b16 a[172:173], v8 offset:5888
  ds_read_b64_tr_b16 a[174:175], v8 offset:16128
  ds_read_b64_tr_b16 a[216:217], v8 offset:1024
  ds_read_b64_tr_b16 a[218:219], v8 offset:11264
  ds_read_b64_tr_b16 a[220:221], v8 offset:6144
  ds_read_b64_tr_b16 a[222:223], v8 offset:16384
  s_waitcnt lgkmcnt(0)
  s_waitcnt vmcnt(10)
  s_barrier
  v_add_u32 v8, 40960, v7
  ds_read_b64_tr_b16 a[32:33], v8 offset:0
  ds_read_b64_tr_b16 a[34:35], v8 offset:10240
  ds_read_b64_tr_b16 a[36:37], v8 offset:5120
  ds_read_b64_tr_b16 a[38:39], v8 offset:15360
  ds_read_b64_tr_b16 a[80:81], v8 offset:256
  ds_read_b64_tr_b16 a[82:83], v8 offset:10496
  ds_read_b64_tr_b16 a[84:85], v8 offset:5376
  ds_read_b64_tr_b16 a[86:87], v8 offset:15616
  ds_read_b64_tr_b16 a[128:129], v8 offset:512
  ds_read_b64_tr_b16 a[130:131], v8 offset:10752
  ds_read_b64_tr_b16 a[132:133], v8 offset:5632
  ds_read_b64_tr_b16 a[134:135], v8 offset:15872
  s_waitcnt lgkmcnt(0)
  ds_read_b64_tr_b16 a[176:177], v8 offset:768
  ds_read_b64_tr_b16 a[178:179], v8 offset:11008
  ds_read_b64_tr_b16 a[180:181], v8 offset:5888
  ds_read_b64_tr_b16 a[182:183], v8 offset:16128
  ds_read_b64_tr_b16 a[224:225], v8 offset:1024
  ds_read_b64_tr_b16 a[226:227], v8 offset:11264
  ds_read_b64_tr_b16 a[228:229], v8 offset:6144
  ds_read_b64_tr_b16 a[230:231], v8 offset:16384
  s_waitcnt lgkmcnt(0)
  s_waitcnt vmcnt(0)
  s_barrier
  v_add_u32 v8, 81920, v7
  ds_read_b64_tr_b16 a[40:41], v8 offset:0
  ds_read_b64_tr_b16 a[42:43], v8 offset:10240
  ds_read_b64_tr_b16 a[44:45], v8 offset:5120
  ds_read_b64_tr_b16 a[46:47], v8 offset:15360
  ds_read_b64_tr_b16 a[88:89], v8 offset:256
  ds_read_b64_tr_b16 a[90:91], v8 offset:10496
  ds_read_b64_tr_b16 a[92:93], v8 offset:5376
  ds_read_b64_tr_b16 a[94:95], v8 offset:15616
  ds_read_b64_tr_b16 a[136:137], v8 offset:512
  ds_read_b64_tr_b16 a[138:139], v8 offset:10752
  ds_read_b64_tr_b16 a[140:141], v8 offset:5632
  ds_read_b64_tr_b16 a[142:143], v8 offset:15872
  s_waitcnt lgkmcnt(0)
  ds_read_b64_tr_b16 a[184:185], v8 offset:768
  ds_read_b64_tr_b16 a[186:187], v8 offset:11008
  ds_read_b64_tr_b16 a[188:189], v8 offset:5888
  ds_read_b64_tr_b16 a[190:191], v8 offset:16128
  ds_read_b64_tr_b16 a[232:233], v8 offset:1024
  ds_read_b64_tr_b16 a[234:235], v8 offset:11264
  ds_read_b64_tr_b16 a[236:237], v8 offset:6144
  ds_read_b64_tr_b16 a[238:239], v8 offset:16384
  s_waitcnt lgkmcnt(0)
  s_barrier
  v_lshlrev_b32 v5, 4, v1
  s_lshl_b32 s28, s21, 10
  v_add_u32 v6, s28, v5
  v_bfe_u32 v2, v1, 4, 1
  v_lshlrev_b32 v9, 10, v2
  v_and_b32 v2, 15, v1
  v_lshlrev_b32 v2, 4, v2
  v_add_u32 v9, v9, v2
  v_lshrrev_b32 v3, 5, v1
  v_lshlrev_b32 v3, 8, v3
  v_add_u32 v9, v9, v3
  v_add_u32 v10, 12288, v9
  v_bfe_u32 v3, v1, 4, 1
  v_lshlrev_b32 v11, 10, v3
  v_add_u32 v11, v11, v2
  v_lshrrev_b32 v3, 5, v1
  v_lshlrev_b32 v3, 9, v3
  v_add_u32 v11, v11, v3
  s_mul_i32 s28, s23, 6
  s_lshr_b32 s29, s28, 3
  s_add_u32 s28, s28, 5
  s_lshr_b32 s28, s28, 3
  v_and_b32 v2, 1, v1
  v_mov_b32 v12, s29
  v_mov_b32 v13, s28
  v_cmp_eq_u32 vcc, 1, v2
  s_nop 1
  v_cndmask_b32 v12, v12, v13, vcc
  v_lshlrev_b32 v12, 2, v12
  v_add_u32 v12, 2048, v12
  s_lshl_b32 s28, s23, 2
  s_add_u32 s28, s28, 3072
  v_mov_b32 v14, s28
  s_mul_i32 s47, s23, 786432
  s_add_u32 s47, s47, 0x7800000
  s_mul_i32 s48, s23, 40960
  s_mul_i32 s28, s21, 10240
  s_add_u32 s48, s48, s28
  s_add_u32 s48, s48, 0x9000000
  s_mov_b32 s50, 0
  s_mov_b32 s52, 0
  s_mov_b32 s54, 0
  s_mov_b32 s53, 0
  s_cmp_gt_u32 s52, s53
  s_cbranch_scc1 ka_wp_62_ok
  s_mov_b32 s45, 0
ka_wp_62_spin:
  buffer_load_dword v2, v12, s[8:11], 0 offen sc1
  s_add_u32 s45, s45, 1
  s_waitcnt vmcnt(0)
  v_min_u32_dpp v3, v2, v2 quad_perm:[1,0,3,2] row_mask:0xf bank_mask:0xf
  s_nop 1
  v_min_u32_dpp v2, v3, v3 quad_perm:[2,3,0,1] row_mask:0xf bank_mask:0xf
  s_nop 1
  v_min_u32_dpp v3, v2, v2 row_half_mirror row_mask:0xf bank_mask:0xf
  s_nop 1
  v_min_u32_dpp v2, v3, v3 quad_perm:[0,1,2,3] row_mask:0xf bank_mask:0xf
  s_nop 0
  v_readfirstlane_b32 s52, v2
  s_cmp_gt_u32 s52, s53
  s_cbranch_scc1 ka_wp_62_ok
  s_cmp_lt_u32 s45, 400000
  s_cbranch_scc1 ka_wp_62_spin
  s_branch ka_abort
ka_wp_62_ok:
  s_lshl_b32 s29, s21, 10
  s_add_u32 m0, s29, 0
  s_add_u32 s28, s47, 0
  buffer_load_dwordx4 v6, s[8:11], s28 offen sc1 lds
  s_lshl_b32 s29, s21, 10
  s_add_u32 m0, s29, 4096
  s_add_u32 s28, s47, 4096
  buffer_load_dwordx4 v6, s[8:11], s28 offen sc1 lds
  s_lshl_b32 s29, s21, 10
  s_add_u32 m0, s29, 8192
  s_add_u32 s28, s47, 8192
  buffer_load_dwordx4 v6, s[8:11], s28 offen sc1 lds
  s_add_u32 s47, s47, 12288
ka_u_loop:
  s_cmp_eq_u32 s50, 0
  s_cbranch_scc0 u0_63
  s_waitcnt vmcnt(0)
u0_63:
  s_waitcnt vmcnt(10)
  s_cmp_eq_u32 s54, 0
  s_cbranch_scc1 ud_64
  s_waitcnt vmcnt(0)
ud_64:
  s_barrier
  ds_read_b128 v[16:19], v9 offset:0
  ds_read_b128 v[20:23], v9 offset:512
  ds_read_b128 v[24:27], v9 offset:2048
  ds_read_b128 v[28:31], v9 offset:2560
  ds_read_b128 v[32:35], v9 offset:4096
  ds_read_b128 v[36:39], v9 offset:4608
  ds_read_b128 v[40:43], v9 offset:6144
  ds_read_b128 v[44:47], v9 offset:6656
  ds_read_b128 v[48:51], v9 offset:8192
  ds_read_b128 v[52:55], v9 offset:8704
  ds_read_b128 v[56:59], v9 offset:10240
  ds_read_b128 v[60:63], v9 offset:10752
  s_mov_b32 s54, 0
  s_cmp_ge_u32 s50, 63
  s_cbranch_scc1 un_65_n
  s_add_u32 s53, s50, 1
  s_cmp_gt_u32 s52, s53
  s_cbranch_scc1 un_65_go
  buffer_load_dword v2, v12, s[8:11], 0 offen sc1
  s_waitcnt vmcnt(0)
  v_min_u32_dpp v3, v2, v2 quad_perm:[1,0,3,2] row_mask:0xf bank_mask:0xf
  s_nop 0
  v_readfirstlane_b32 s52, v3
  s_cmp_gt_u32 s52, s53
  s_cbranch_scc1 un_65_go2
  s_mov_b32 s54, 1
  s_branch un_65
un_65_go2:
un_65_go:
  s_lshl_b32 s29, s21, 10
  s_add_u32 m0, s29, 12288
  s_add_u32 s28, s47, 0
  buffer_load_dwordx4 v6, s[8:11], s28 offen sc1 lds
  s_lshl_b32 s29, s21, 10
  s_add_u32 m0, s29, 16384
  s_add_u32 s28, s47, 4096
  buffer_load_dwordx4 v6, s[8:11], s28 offen sc1 lds
  s_lshl_b32 s29, s21, 10
  s_add_u32 m0, s29, 20480
  s_add_u32 s28, s47, 8192
  buffer_load_dwordx4 v6, s[8:11], s28 offen sc1 lds
  s_add_u32 s47, s47, 12288
  s_branch un_65
un_65_n:
  s_waitcnt vmcnt(0)
un_65:
  s_mul_i32 s30, s50, 1310720
  s_add_u32 s30, s30, s48
  s_waitcnt lgkmcnt(11)
  v_mfma_f32_32x32x16_bf16 v[64:79], v[16:19], a[0:3], 0
  s_waitcnt lgkmcnt(10)
  v_mfma_f32_32x32x16_bf16 v[64:79], v[20:23], a[4:7], v[64:79]
  s_waitcnt lgkmcnt(9)
  v_mfma_f32_32x32x16_bf16 v[64:79], v[24:27], a[8:11], v[64:79]
  s_waitcnt lgkmcnt(8)
  v_mfma_f32_32x32x16_bf16 v[64:79], v[28:31], a[12:15], v[64:79]
  s_waitcnt lgkmcnt(7)
  v_mfma_f32_32x32x16_bf16 v[64:79], v[32:35], a[16:19], v[64:79]
  s_waitcnt lgkmcnt(6)
  v_mfma_f32_32x32x16_bf16 v[64:79], v[36:39], a[20:23], v[64:79]
  s_waitcnt lgkmcnt(5)
  v_mfma_f32_32x32x16_bf16 v[64:79], v[40:43], a[24:27], v[64:79]
  s_waitcnt lgkmcnt(4)
  v_mfma_f32_32x32x16_bf16 v[64:79], v[44:47], a[28:31], v[64:79]
  s_waitcnt lgkmcnt(3)
  v_mfma_f32_32x32x16_bf16 v[64:79], v[48:51], a[32:35], v[64:79]
  s_waitcnt lgkmcnt(2)
  v_mfma_f32_32x32x16_bf16 v[64:79], v[52:55], a[36:39], v[64:79]
  s_waitcnt lgkmcnt(1)
  v_mfma_f32_32x32x16_bf16 v[64:79], v[56:59], a[40:43], v[64:79]
  s_waitcnt lgkmcnt(0)
  v_mfma_f32_32x32x16_bf16 v[64:79], v[60:63], a[44:47], v[64:79]
  v_mfma_f32_32x32x16_bf16 v[80:95], v[16:19], a[48:51], 0
  v_mfma_f32_32x32x16_bf16 v[80:95], v[20:23], a[52:55], v[80:95]
  v_mfma_f32_32x32x16_bf16 v[80:95], v[24:27], a[56:59], v[80:95]
  v_cvt_pk_bf16_f32 v96, v64, v65
  v_cvt_pk_bf16_f32 v97, v66, v67
  v_mfma_f32_32x32x16_bf16 v[80:95], v[28:31], a[60:63], v[80:95]
  v_cvt_pk_bf16_f32 v98, v68, v69
  v_cvt_pk_bf16_f32 v99, v70, v71
  v_mfma_f32_32x32x16_bf16 v[80:95], v[32:35], a[64:67], v[80:95]
  v_cvt_pk_bf16_f32 v100, v72, v73
  v_cvt_pk_bf16_f32 v101, v74, v75
  v_mfma_f32_32x32x16_bf16 v[80:95], v[36:39], a[68:71], v[80:95]
  v_cvt_pk_bf16_f32 v102, v76, v77
  v_cvt_pk_bf16_f32 v103, v78, v79
  v_mfma_f32_32x32x16_bf16 v[80:95], v[40:43], a[72:75], v[80:95]
  s_add_u32 s29, s30, 0
  buffer_store_dwordx4 v[96:99], v11, s[8:11], s29 offen offset:0 sc1
  v_mfma_f32_32x32x16_bf16 v[80:95], v[44:47], a[76:79], v[80:95]
  buffer_store_dwordx4 v[100:103], v11, s[8:11], s29 offen offset:256 sc1
  v_mfma_f32_32x32x16_bf16 v[80:95], v[48:51], a[80:83], v[80:95]
  v_mfma_f32_32x32x16_bf16 v[80:95], v[52:55], a[84:87], v[80:95]
  v_mfma_f32_32x32x16_bf16 v[80:95], v[56:59], a[88:91], v[80:95]
  v_mfma_f32_32x32x16_bf16 v[80:95], v[60:63], a[92:95], v[80:95]
  v_mfma_f32_32x32x16_bf16 v[64:79], v[16:19], a[96:99], 0
  v_mfma_f32_32x32x16_bf16 v[64:79], v[20:23], a[100:103], v[64:79]
  v_mfma_f32_32x32x16_bf16 v[64:79], v[24:27], a[104:107], v[64:79]
  v_cvt_pk_bf16_f32 v96, v80, v81
  v_cvt_pk_bf16_f32 v97, v82, v83
  v_mfma_f32_32x32x16_bf16 v[64:79], v[28:31], a[108:111], v[64:79]
  v_cvt_pk_bf16_f32 v98, v84, v85
  v_cvt_pk_bf16_f32 v99, v86, v87
  v_mfma_f32_32x32x16_bf16 v[64:79], v[32:35], a[112:115], v[64:79]
  v_cvt_pk_bf16_f32 v100, v88, v89
  v_cvt_pk_bf16_f32 v101, v90, v91
  v_mfma_f32_32x32x16_bf16 v[64:79], v[36:39], a[116:119], v[64:79]
  v_cvt_pk_bf16_f32 v102, v92, v93
  v_cvt_pk_bf16_f32 v103, v94, v95
  v_mfma_f32_32x32x16_bf16 v[64:79], v[40:43], a[120:123], v[64:79]
  s_add_u32 s29, s30, 2048
  buffer_store_dwordx4 v[96:99], v11, s[8:11], s29 offen offset:0 sc1
  v_mfma_f32_32x32x16_bf16 v[64:79], v[44:47], a[124:127], v[64:79]
  buffer_store_dwordx4 v[100:103], v11, s[8:11], s29 offen offset:256 sc1
  v_mfma_f32_32x32x16_bf16 v[64:79], v[48:51], a[128:131], v[64:79]
  v_mfma_f32_32x32x16_bf16 v[64:79], v[52:55], a[132:135], v[64:79]
  v_mfma_f32_32x32x16_bf16 v[64:79], v[56:59], a[136:139], v[64:79]
  v_mfma_f32_32x32x16_bf16 v[64:79], v[60:63], a[140:143], v[64:79]
  s_waitcnt vmcnt(7)
  s_barrier
  s_cmp_eq_u32 s21, 0
  s_cbranch_scc0 mp_66
  v_mov_b32 v13, s50
  s_mov_b64 s[24:25], exec
  s_mov_b64 exec, 1
  buffer_store_dword v13, v14, s[8:11], 0 offen sc1
  s_mov_b64 exec, s[24:25]
mp_66:
  v_mfma_f32_32x32x16_bf16 v[80:95], v[16:19], a[144:147], 0
  v_mfma_f32_32x32x16_bf16 v[80:95], v[20:23], a[148:151], v[80:95]
  v_mfma_f32_32x32x16_bf16 v[80:95], v[24:27], a[152:155], v[80:95]
  v_cvt_pk_bf16_f32 v96, v64, v65
  v_cvt_pk_bf16_f32 v97, v66, v67
  v_mfma_f32_32x32x16_bf16 v[80:95], v[28:31], a[156:159], v[80:95]
  v_cvt_pk_bf16_f32 v98, v68, v69
  v_cvt_pk_bf16_f32 v99, v70, v71
  v_mfma_f32_32x32x16_bf16 v[80:95], v[32:35], a[160:163], v[80:95]
  v_cvt_pk_bf16_f32 v100, v72, v73
  v_cvt_pk_bf16_f32 v101, v74, v75
  v_mfma_f32_32x32x16_bf16 v[80:95], v[36:39], a[164:167], v[80:95]
  v_cvt_pk_bf16_f32 v102, v76, v77
  v_cvt_pk_bf16_f32 v103, v78, v79
  v_mfma_f32_32x32x16_bf16 v[80:95], v[40:43], a[168:171], v[80:95]
  s_add_u32 s29, s30, 4096
  buffer_store_dwordx4 v[96:99], v11, s[8:11], s29 offen offset:0 sc1
  v_mfma_f32_32x32x16_bf16 v[80:95], v[44:47], a[172:175], v[80:95]
  buffer_store_dwordx4 v[100:103], v11, s[8:11], s29 offen offset:256 sc1
  v_mfma_f32_32x32x16_bf16 v[80:95], v[48:51], a[176:179], v[80:95]
  v_mfma_f32_32x32x16_bf16 v[80:95], v[52:55], a[180:183], v[80:95]
  v_mfma_f32_32x32x16_bf16 v[80:95], v[56:59], a[184:187], v[80:95]
  v_mfma_f32_32x32x16_bf16 v[80:95], v[60:63], a[188:191], v[80:95]
  v_mfma_f32_32x32x16_bf16 v[64:79], v[16:19], a[192:195], 0
  v_mfma_f32_32x32x16_bf16 v[64:79], v[20:23], a[196:199], v[64:79]
  v_mfma_f32_32x32x16_bf16 v[64:79], v[24:27], a[200:203], v[64:79]
  v_cvt_pk_bf16_f32 v96, v80, v81
  v_cvt_pk_bf16_f32 v97, v82, v83
  v_mfma_f32_32x32x16_bf16 v[64:79], v[28:31], a[204:207], v[64:79]
  v_cvt_pk_bf16_f32 v98, v84, v85
  v_cvt_pk_bf16_f32 v99, v86, v87
  v_mfma_f32_32x32x16_bf16 v[64:79], v[32:35], a[208:211], v[64:79]
  v_cvt_pk_bf16_f32 v100, v88, v89
  v_cvt_pk_bf16_f32 v101, v90, v91
  v_mfma_f32_32x32x16_bf16 v[64:79], v[36:39], a[212:215], v[64:79]
  v_cvt_pk_bf16_f32 v102, v92, v93
  v_cvt_pk_bf16_f32 v103, v94, v95
  v_mfma_f32_32x32x16_bf16 v[64:79], v[40:43], a[216:219], v[64:79]
  s_add_u32 s29, s30, 6144
  buffer_store_dwordx4 v[96:99], v11, s[8:11], s29 offen offset:0 sc1
  v_mfma_f32_32x32x16_bf16 v[64:79], v[44:47], a[220:223], v[64:79]
  buffer_store_dwordx4 v[100:103], v11, s[8:11], s29 offen offset:256 sc1
  v_mfma_f32_32x32x16_bf16 v[64:79], v[48:51], a[224:227], v[64:79]
  v_mfma_f32_32x32x16_bf16 v[64:79], v[52:55], a[228:231], v[64:79]
  v_mfma_f32_32x32x16_bf16 v[64:79], v[56:59], a[232:235], v[64:79]
  v_mfma_f32_32x32x16_bf16 v[64:79], v[60:63], a[236:239], v[64:79]
  s_nop 11
  v_cvt_pk_bf16_f32 v96, v64, v65
  v_cvt_pk_bf16_f32 v97, v66, v67
  v_cvt_pk_bf16_f32 v98, v68, v69
  v_cvt_pk_bf16_f32 v99, v70, v71
  v_cvt_pk_bf16_f32 v100, v72, v73
  v_cvt_pk_bf16_f32 v101, v74, v75
  v_cvt_pk_bf16_f32 v102, v76, v77
  v_cvt_pk_bf16_f32 v103, v78, v79
  s_add_u32 s29, s30, 8192
  buffer_store_dwordx4 v[96:99], v11, s[8:11], s29 offen offset:0 sc1
  buffer_store_dwordx4 v[100:103], v11, s[8:11], s29 offen offset:256 sc1
  s_cmp_eq_u32 s54, 0
  s_cbranch_scc1 udf_67
  s_cmp_gt_u32 s52, s53
  s_cbranch_scc1 ka_wp_68_ok
  s_mov_b32 s45, 0
ka_wp_68_spin:
  buffer_load_dword v2, v12, s[8:11], 0 offen sc1
  s_add_u32 s45, s45, 1
  s_waitcnt vmcnt(0)
  v_min_u32_dpp v3, v2, v2 quad_perm:[1,0,3,2] row_mask:0xf bank_mask:0xf
  s_nop 1
  v_min_u32_dpp v2, v3, v3 quad_perm:[2,3,0,1] row_mask:0xf bank_mask:0xf
  s_nop 1
  v_min_u32_dpp v3, v2, v2 row_half_mirror row_mask:0xf bank_mask:0xf
  s_nop 1
  v_min_u32_dpp v2, v3, v3 quad_perm:[0,1,2,3] row_mask:0xf bank_mask:0xf
  s_nop 0
  v_readfirstlane_b32 s52, v2
  s_cmp_gt_u32 s52, s53
  s_cbranch_scc1 ka_wp_68_ok
  s_cmp_lt_u32 s45, 400000
  s_cbranch_scc1 ka_wp_68_spin
  s_branch ka_abort
ka_wp_68_ok:
  s_lshl_b32 s29, s21, 10
  s_add_u32 m0, s29, 12288
  s_add_u32 s28, s47, 0
  buffer_load_dwordx4 v6, s[8:11], s28 offen sc1 lds
  s_lshl_b32 s29, s21, 10
  s_add_u32 m0, s29, 16384
  s_add_u32 s28, s47, 4096
  buffer_load_dwordx4 v6, s[8:11], s28 offen sc1 lds
  s_lshl_b32 s29, s21, 10
  s_add_u32 m0, s29, 20480
  s_add_u32 s28, s47, 8192
  buffer_load_dwordx4 v6, s[8:11], s28 offen sc1 lds
  s_add_u32 s47, s47, 12288
udf_67:
  s_add_u32 s50, s50, 1
  s_waitcnt vmcnt(10)
  s_cmp_eq_u32 s54, 0
  s_cbranch_scc1 ud_69
  s_waitcnt vmcnt(0)
ud_69:
  s_barrier
  ds_read_b128 v[16:19], v10 offset:0
  ds_read_b128 v[20:23], v10 offset:512
  ds_read_b128 v[24:27], v10 offset:2048
  ds_read_b128 v[28:31], v10 offset:2560
  ds_read_b128 v[32:35], v10 offset:4096
  ds_read_b128 v[36:39], v10 offset:4608
  ds_read_b128 v[40:43], v10 offset:6144
  ds_read_b128 v[44:47], v10 offset:6656
  ds_read_b128 v[48:51], v10 offset:8192
  ds_read_b128 v[52:55], v10 offset:8704
  ds_read_b128 v[56:59], v10 offset:10240
  ds_read_b128 v[60:63], v10 offset:10752
  s_mov_b32 s54, 0
  s_cmp_ge_u32 s50, 63
  s_cbranch_scc1 un_70_n
  s_add_u32 s53, s50, 1
  s_cmp_gt_u32 s52, s53
  s_cbranch_scc1 un_70_go
  buffer_load_dword v2, v12, s[8:11], 0 offen sc1
  s_waitcnt vmcnt(0)
  v_min_u32_dpp v3, v2, v2 quad_perm:[1,0,3,2] row_mask:0xf bank_mask:0xf
  s_nop 0
  v_readfirstlane_b32 s52, v3
  s_cmp_gt_u32 s52, s53
  s_cbranch_scc1 un_70_go2
  s_mov_b32 s54, 1
  s_branch un_70
un_70_go2:
un_70_go:
  s_lshl_b32 s29, s21, 10
  s_add_u32 m0, s29, 0
  s_add_u32 s28, s47, 0
  buffer_load_dwordx4 v6, s[8:11], s28 offen sc1 lds
  s_lshl_b32 s29, s21, 10
  s_add_u32 m0, s29, 4096
  s_add_u32 s28, s47, 4096
  buffer_load_dwordx4 v6, s[8:11], s28 offen sc1 lds
  s_lshl_b32 s29, s21, 10
  s_add_u32 m0, s29, 8192
  s_add_u32 s28, s47, 8192
  buffer_load_dwordx4 v6, s[8:11], s28 offen sc1 lds
  s_add_u32 s47, s47, 12288
  s_branch un_70
un_70_n:
  s_waitcnt vmcnt(0)
un_70:
  s_mul_i32 s30, s50, 1310720
  s_add_u32 s30, s30, s48
  s_waitcnt lgkmcnt(11)
  v_mfma_f32_32x32x16_bf16 v[64:79], v[16:19], a[0:3], 0
  s_waitcnt lgkmcnt(10)
  v_mfma_f32_32x32x16_bf16 v[64:79], v[20:23], a[4:7], v[64:79]
  s_waitcnt lgkmcnt(9)
  v_mfma_f32_32x32x16_bf16 v[64:79], v[24:27], a[8:11], v[64:79]
  s_waitcnt lgkmcnt(8)
  v_mfma_f32_32x32x16_bf16 v[64:79], v[28:31], a[12:15], v[64:79]
  s_waitcnt lgkmcnt(7)
  v_mfma_f32_32x32x16_bf16 v[64:79], v[32:35], a[16:19], v[64:79]
  s_waitcnt lgkmcnt(6)
  v_mfma_f32_32x32x16_bf16 v[64:79], v[36:39], a[20:23], v[64:79]
  s_waitcnt lgkmcnt(5)
  v_mfma_f32_32x32x16_bf16 v[64:79], v[40:43], a[24:27], v[64:79]
  s_waitcnt lgkmcnt(4)
  v_mfma_f32_32x32x16_bf16 v[64:79], v[44:47], a[28:31], v[64:79]
  s_waitcnt lgkmcnt(3)
  v_mfma_f32_32x32x16_bf16 v[64:79], v[48:51], a[32:35], v[64:79]
  s_waitcnt lgkmcnt(2)
  v_mfma_f32_32x32x16_bf16 v[64:79], v[52:55], a[36:39], v[64:79]
  s_waitcnt lgkmcnt(1)
  v_mfma_f32_32x32x16_bf16 v[64:79], v[56:59], a[40:43], v[64:79]
  s_waitcnt lgkmcnt(0)
  v_mfma_f32_32x32x16_bf16 v[64:79], v[60:63], a[44:47], v[64:79]
  v_mfma_f32_32x32x16_bf16 v[80:95], v[16:19], a[48:51], 0
  v_mfma_f32_32x32x16_bf16 v[80:95], v[20:23], a[52:55], v[80:95]
  v_mfma_f32_32x32x16_bf16 v[80:95], v[24:27], a[56:59], v[80:95]
  v_cvt_pk_bf16_f32 v96, v64, v65
  v_cvt_pk_bf16_f32 v97, v66, v67
  v_mfma_f32_32x32x16_bf16 v[80:95], v[28:31], a[60:63], v[80:95]
  v_cvt_pk_bf16_f32 v98, v68, v69
  v_cvt_pk_bf16_f32 v99, v70, v71
  v_mfma_f32_32x32x16_bf16 v[80:95], v[32:35], a[64:67], v[80:95]
  v_cvt_pk_bf16_f32 v100, v72, v73
  v_cvt_pk_bf16_f32 v101, v74, v75
  v_mfma_f32_32x32x16_bf16 v[80:95], v[36:39], a[68:71], v[80:95]
  v_cvt_pk_bf16_f32 v102, v76, v77
  v_cvt_pk_bf16_f32 v103, v78, v79
  v_mfma_f32_32x32x16_bf16 v[80:95], v[40:43], a[72:75], v[80:95]
  s_add_u32 s29, s30, 0
  buffer_store_dwordx4 v[96:99], v11, s[8:11], s29 offen offset:0 sc1
  v_mfma_f32_32x32x16_bf16 v[80:95], v[44:47], a[76:79], v[80:95]
  buffer_store_dwordx4 v[100:103], v11, s[8:11], s29 offen offset:256 sc1
  v_mfma_f32_32x32x16_bf16 v[80:95], v[48:51], a[80:83], v[80:95]
  v_mfma_f32_32x32x16_bf16 v[80:95], v[52:55], a[84:87], v[80:95]
  v_mfma_f32_32x32x16_bf16 v[80:95], v[56:59], a[88:91], v[80:95]
  v_mfma_f32_32x32x16_bf16 v[80:95], v[60:63], a[92:95], v[80:95]
  v_mfma_f32_32x32x16_bf16 v[64:79], v[16:19], a[96:99], 0
  v_mfma_f32_32x32x16_bf16 v[64:79], v[20:23], a[100:103], v[64:79]
  v_mfma_f32_32x32x16_bf16 v[64:79], v[24:27], a[104:107], v[64:79]
  v_cvt_pk_bf16_f32 v96, v80, v81
  v_cvt_pk_bf16_f32 v97, v82, v83
  v_mfma_f32_32x32x16_bf16 v[64:79], v[28:31], a[108:111], v[64:79]
  v_cvt_pk_bf16_f32 v98, v84, v85
  v_cvt_pk_bf16_f32 v99, v86, v87
  v_mfma_f32_32x32x16_bf16 v[64:79], v[32:35], a[112:115], v[64:79]
  v_cvt_pk_bf16_f32 v100, v88, v89
  v_cvt_pk_bf16_f32 v101, v90, v91
  v_mfma_f32_32x32x16_bf16 v[64:79], v[36:39], a[116:119], v[64:79]
  v_cvt_pk_bf16_f32 v102, v92, v93
  v_cvt_pk_bf16_f32 v103, v94, v95
  v_mfma_f32_32x32x16_bf16 v[64:79], v[40:43], a[120:123], v[64:79]
  s_add_u32 s29, s30, 2048
  buffer_store_dwordx4 v[96:99], v11, s[8:11], s29 offen offset:0 sc1
  v_mfma_f32_32x32x16_bf16 v[64:79], v[44:47], a[124:127], v[64:79]
  buffer_store_dwordx4 v[100:103], v11, s[8:11], s29 offen offset:256 sc1
  v_mfma_f32_32x32x16_bf16 v[64:79], v[48:51], a[128:131], v[64:79]
  v_mfma_f32_32x32x16_bf16 v[64:79], v[52:55], a[132:135], v[64:79]
  v_mfma_f32_32x32x16_bf16 v[64:79], v[56:59], a[136:139], v[64:79]
  v_mfma_f32_32x32x16_bf16 v[64:79], v[60:63], a[140:143], v[64:79]
  s_waitcnt vmcnt(7)
  s_barrier
  s_cmp_eq_u32 s21, 0
  s_cbranch_scc0 mp_71
  v_mov_b32 v13, s50
  s_mov_b64 s[24:25], exec
  s_mov_b64 exec, 1
  buffer_store_dword v13, v14, s[8:11], 0 offen sc1
  s_mov_b64 exec, s[24:25]
mp_71:
  v_mfma_f32_32x32x16_bf16 v[80:95], v[16:19], a[144:147], 0
  v_mfma_f32_32x32x16_bf16 v[80:95], v[20:23], a[148:151], v[80:95]
  v_mfma_f32_32x32x16_bf16 v[80:95], v[24:27], a[152:155], v[80:95]
  v_cvt_pk_bf16_f32 v96, v64, v65
  v_cvt_pk_bf16_f32 v97, v66, v67
  v_mfma_f32_32x32x16_bf16 v[80:95], v[28:31], a[156:159], v[80:95]
  v_cvt_pk_bf16_f32 v98, v68, v69
  v_cvt_pk_bf16_f32 v99, v70, v71
  v_mfma_f32_32x32x16_bf16 v[80:95], v[32:35], a[160:163], v[80:95]
  v_cvt_pk_bf16_f32 v100, v72, v73
  v_cvt_pk_bf16_f32 v101, v74, v75
  v_mfma_f32_32x32x16_bf16 v[80:95], v[36:39], a[164:167], v[80:95]
  v_cvt_pk_bf16_f32 v102, v76, v77
  v_cvt_pk_bf16_f32 v103, v78, v79
  v_mfma_f32_32x32x16_bf16 v[80:95], v[40:43], a[168:171], v[80:95]
  s_add_u32 s29, s30, 4096
  buffer_store_dwordx4 v[96:99], v11, s[8:11], s29 offen offset:0 sc1
  v_mfma_f32_32x32x16_bf16 v[80:95], v[44:47], a[172:175], v[80:95]
  buffer_store_dwordx4 v[100:103], v11, s[8:11], s29 offen offset:256 sc1
  v_mfma_f32_32x32x16_bf16 v[80:95], v[48:51], a[176:179], v[80:95]
  v_mfma_f32_32x32x16_bf16 v[80:95], v[52:55], a[180:183], v[80:95]
  v_mfma_f32_32x32x16_bf16 v[80:95], v[56:59], a[184:187], v[80:95]
  v_mfma_f32_32x32x16_bf16 v[80:95], v[60:63], a[188:191], v[80:95]
  v_mfma_f32_32x32x16_bf16 v[64:79], v[16:19], a[192:195], 0
  v_mfma_f32_32x32x16_bf16 v[64:79], v[20:23], a[196:199], v[64:79]
  v_mfma_f32_32x32x16_bf16 v[64:79], v[24:27], a[200:203], v[64:79]
  v_cvt_pk_bf16_f32 v96, v80, v81
  v_cvt_pk_bf16_f32 v97, v82, v83
  v_mfma_f32_32x32x16_bf16 v[64:79], v[28:31], a[204:207], v[64:79]
  v_cvt_pk_bf16_f32 v98, v84, v85
  v_cvt_pk_bf16_f32 v99, v86, v87
  v_mfma_f32_32x32x16_bf16 v[64:79], v[32:35], a[208:211], v[64:79]
  v_cvt_pk_bf16_f32 v100, v88, v89
  v_cvt_pk_bf16_f32 v101, v90, v91
  v_mfma_f32_32x32x16_bf16 v[64:79], v[36:39], a[212:215], v[64:79]
  v_cvt_pk_bf16_f32 v102, v92, v93
  v_cvt_pk_bf16_f32 v103, v94, v95
  v_mfma_f32_32x32x16_bf16 v[64:79], v[40:43], a[216:219], v[64:79]
  s_add_u32 s29, s30, 6144
  buffer_store_dwordx4 v[96:99], v11, s[8:11], s29 offen offset:0 sc1
  v_mfma_f32_32x32x16_bf16 v[64:79], v[44:47], a[220:223], v[64:79]
  buffer_store_dwordx4 v[100:103], v11, s[8:11], s29 offen offset:256 sc1
  v_mfma_f32_32x32x16_bf16 v[64:79], v[48:51], a[224:227], v[64:79]
  v_mfma_f32_32x32x16_bf16 v[64:79], v[52:55], a[228:231], v[64:79]
  v_mfma_f32_32x32x16_bf16 v[64:79], v[56:59], a[232:235], v[64:79]
  v_mfma_f32_32x32x16_bf16 v[64:79], v[60:63], a[236:239], v[64:79]
  s_nop 11
  v_cvt_pk_bf16_f32 v96, v64, v65
  v_cvt_pk_bf16_f32 v97, v66, v67
  v_cvt_pk_bf16_f32 v98, v68, v69
  v_cvt_pk_bf16_f32 v99, v70, v71
  v_cvt_pk_bf16_f32 v100, v72, v73
  v_cvt_pk_bf16_f32 v101, v74, v75
  v_cvt_pk_bf16_f32 v102, v76, v77
  v_cvt_pk_bf16_f32 v103, v78, v79
  s_add_u32 s29, s30, 8192
  buffer_store_dwordx4 v[96:99], v11, s[8:11], s29 offen offset:0 sc1
  buffer_store_dwordx4 v[100:103], v11, s[8:11], s29 offen offset:256 sc1
  s_cmp_eq_u32 s54, 0
  s_cbranch_scc1 udf_72
  s_cmp_gt_u32 s52, s53
  s_cbranch_scc1 ka_wp_73_ok
  s_mov_b32 s45, 0
ka_wp_73_spin:
  buffer_load_dword v2, v12, s[8:11], 0 offen sc1
  s_add_u32 s45, s45, 1
  s_waitcnt vmcnt(0)
  v_min_u32_dpp v3, v2, v2 quad_perm:[1,0,3,2] row_mask:0xf bank_mask:0xf
  s_nop 1
  v_min_u32_dpp v2, v3, v3 quad_perm:[2,3,0,1] row_mask:0xf bank_mask:0xf
  s_nop 1
  v_min_u32_dpp v3, v2, v2 row_half_mirror row_mask:0xf bank_mask:0xf
  s_nop 1
  v_min_u32_dpp v2, v3, v3 quad_perm:[0,1,2,3] row_mask:0xf bank_mask:0xf
  s_nop 0
  v_readfirstlane_b32 s52, v2
  s_cmp_gt_u32 s52, s53
  s_cbranch_scc1 ka_wp_73_ok
  s_cmp_lt_u32 s45, 400000
  s_cbranch_scc1 ka_wp_73_spin
  s_branch ka_abort
ka_wp_73_ok:
  s_lshl_b32 s29, s21, 10
  s_add_u32 m0, s29, 0
  s_add_u32 s28, s47, 0
  buffer_load_dwordx4 v6, s[8:11], s28 offen sc1 lds
  s_lshl_b32 s29, s21, 10
  s_add_u32 m0, s29, 4096
  s_add_u32 s28, s47, 4096
  buffer_load_dwordx4 v6, s[8:11], s28 offen sc1 lds
  s_lshl_b32 s29, s21, 10
  s_add_u32 m0, s29, 8192
  s_add_u32 s28, s47, 8192
  buffer_load_dwordx4 v6, s[8:11], s28 offen sc1 lds
  s_add_u32 s47, s47, 12288
udf_72:
  s_add_u32 s50, s50, 1
  s_cmp_lt_u32 s50, 64
  s_cbranch_scc1 ka_u_loop
  s_waitcnt vmcnt(0)
  s_barrier
  s_cmp_eq_u32 s21, 0
  s_cbranch_scc0 ka_exit
  v_mov_b32 v13, 64
  s_mov_b64 exec, 1
  buffer_store_dword v13, v14, s[8:11], 0 offen sc1
  s_waitcnt vmcnt(0)
  s_branch ka_exit
.macro CHAINROLES sfx, pol
ka\sfx\()_x:
  s_mov_b32 s12, s36
  s_and_b32 s13, s37, 0xffff
  s_mov_b32 s14, 0x780000
  s_mov_b32 s15, 0x20000
  s_mov_b32 s16, s38
  s_and_b32 s17, s39, 0xffff
  s_mov_b32 s18, 0x780000
  s_mov_b32 s19, 0x20000
  v_and_b32 v1, 63, v0
  v_lshrrev_b32 v2, 4, v1
  v_bfe_u32 v3, v1, 3, 1
  v_bfe_u32 v4, v1, 1, 2
  v_and_b32 v5, 1, v1
  s_mul_i32 s46, s23, 384
  s_lshl_b32 s28, s21, 2
  s_add_u32 s28, s28, 0
  v_add_u32 v6, s28, v2
  v_mul_u32_u24 v7, 43, v6
  v_lshrrev_b32 v7, 9, v7
  v_mul_u32_u24 v8, 12, v7
  v_sub_u32 v8, v6, v8
  v_lshrrev_b32 v9, 1, v7
  v_lshlrev_b32 v9, 4, v9
  v_and_b32 v10, 1, v7
  v_lshlrev_b32 v10, 2, v10
  v_add_u32 v9, v9, v10
  v_lshlrev_b32 v10, 3, v3
  v_add_u32 v9, v9, v10
  v_add_u32 v9, v9, v4
  v_mul_u32_u24 v9, 12288, v9
  v_lshrrev_b32 v10, 1, v8
  v_lshlrev_b32 v10, 2, v10
  v_lshlrev_b32 v11, 1, v5
  v_add_u32 v10, v10, v11
  v_and_b32 v11, 1, v8
  v_add_u32 v10, v10, v11
  v_lshlrev_b32 v10, 4, v10
  v_add_u32 v9, v9, v10
  v_add_u32 v136, s46, v9
  s_lshl_b32 s28, s21, 2
  s_add_u32 s28, s28, 16
  v_add_u32 v6, s28, v2
  v_mul_u32_u24 v7, 43, v6
  v_lshrrev_b32 v7, 9, v7
  v_mul_u32_u24 v8, 12, v7
  v_sub_u32 v8, v6, v8
  v_lshrrev_b32 v9, 1, v7
  v_lshlrev_b32 v9, 4, v9
  v_and_b32 v10, 1, v7
  v_lshlrev_b32 v10, 2, v10
  v_add_u32 v9, v9, v10
  v_lshlrev_b32 v10, 3, v3
  v_add_u32 v9, v9, v10
  v_add_u32 v9, v9, v4
  v_mul_u32_u24 v9, 12288, v9
  v_lshrrev_b32 v10, 1, v8
  v_lshlrev_b32 v10, 2, v10
  v_lshlrev_b32 v11, 1, v5
  v_add_u32 v10, v10, v11
  v_and_b32 v11, 1, v8
  v_add_u32 v10, v10, v11
  v_lshlrev_b32 v10, 4, v10
  v_add_u32 v9, v9, v10
  v_add_u32 v137, s46, v9
  s_lshl_b32 s28, s21, 2
  s_add_u32 s28, s28, 32
  v_add_u32 v6, s28, v2
  v_mul_u32_u24 v7, 43, v6
  v_lshrrev_b32 v7, 9, v7
  v_mul_u32_u24 v8, 12, v7
  v_sub_u32 v8, v6, v8
  v_lshrrev_b32 v9, 1, v7
  v_lshlrev_b32 v9, 4, v9
  v_and_b32 v10, 1, v7
  v_lshlrev_b32 v10, 2, v10
  v_add_u32 v9, v9, v10
  v_lshlrev_b32 v10, 3, v3
  v_add_u32 v9, v9, v10
  v_add_u32 v9, v9, v4
  v_mul_u32_u24 v9, 12288, v9
  v_lshrrev_b32 v10, 1, v8
  v_lshlrev_b32 v10, 2, v10
  v_lshlrev_b32 v11, 1, v5
  v_add_u32 v10, v10, v11
  v_and_b32 v11, 1, v8
  v_add_u32 v10, v10, v11
  v_lshlrev_b32 v10, 4, v10
  v_add_u32 v9, v9, v10
  v_add_u32 v138, s46, v9
  s_lshl_b32 s28, s21, 2
  s_add_u32 s28, s28, 48
  v_add_u32 v6, s28, v2
  v_mul_u32_u24 v7, 43, v6
  v_lshrrev_b32 v7, 9, v7
  v_mul_u32_u24 v8, 12, v7
  v_sub_u32 v8, v6, v8
  v_lshrrev_b32 v9, 1, v7
  v_lshlrev_b32 v9, 4, v9
  v_and_b32 v10, 1, v7
  v_lshlrev_b32 v10, 2, v10
  v_add_u32 v9, v9, v10
  v_lshlrev_b32 v10, 3, v3
  v_add_u32 v9, v9, v10
  v_add_u32 v9, v9, v4
  v_mul_u32_u24 v9, 12288, v9
  v_lshrrev_b32 v10, 1, v8
  v_lshlrev_b32 v10, 2, v10
  v_lshlrev_b32 v11, 1, v5
  v_add_u32 v10, v10, v11
  v_and_b32 v11, 1, v8
  v_add_u32 v10, v10, v11
  v_lshlrev_b32 v10, 4, v10
  v_add_u32 v9, v9, v10
  v_add_u32 v139, s46, v9
  s_lshl_b32 s28, s21, 2
  s_add_u32 s28, s28, 64
  v_add_u32 v6, s28, v2
  v_mul_u32_u24 v7, 43, v6
  v_lshrrev_b32 v7, 9, v7
  v_mul_u32_u24 v8, 12, v7
  v_sub_u32 v8, v6, v8
  v_lshrrev_b32 v9, 1, v7
  v_lshlrev_b32 v9, 4, v9
  v_and_b32 v10, 1, v7
  v_lshlrev_b32 v10, 2, v10
  v_add_u32 v9, v9, v10
  v_lshlrev_b32 v10, 3, v3
  v_add_u32 v9, v9, v10
  v_add_u32 v9, v9, v4
  v_mul_u32_u24 v9, 12288, v9
  v_lshrrev_b32 v10, 1, v8
  v_lshlrev_b32 v10, 2, v10
  v_lshlrev_b32 v11, 1, v5
  v_add_u32 v10, v10, v11
  v_and_b32 v11, 1, v8
  v_add_u32 v10, v10, v11
  v_lshlrev_b32 v10, 4, v10
  v_add_u32 v9, v9, v10
  v_add_u32 v140, s46, v9
  s_lshl_b32 s28, s21, 2
  s_add_u32 s28, s28, 80
  v_add_u32 v6, s28, v2
  v_mul_u32_u24 v7, 43, v6
  v_lshrrev_b32 v7, 9, v7
  v_mul_u32_u24 v8, 12, v7
  v_sub_u32 v8, v6, v8
  v_lshrrev_b32 v9, 1, v7
  v_lshlrev_b32 v9, 4, v9
  v_and_b32 v10, 1, v7
  v_lshlrev_b32 v10, 2, v10
  v_add_u32 v9, v9, v10
  v_lshlrev_b32 v10, 3, v3
  v_add_u32 v9, v9, v10
  v_add_u32 v9, v9, v4
  v_mul_u32_u24 v9, 12288, v9
  v_lshrrev_b32 v10, 1, v8
  v_lshlrev_b32 v10, 2, v10
  v_lshlrev_b32 v11, 1, v5
  v_add_u32 v10, v10, v11
  v_and_b32 v11, 1, v8
  v_add_u32 v10, v10, v11
  v_lshlrev_b32 v10, 4, v10
  v_add_u32 v9, v9, v10
  v_add_u32 v141, s46, v9
  v_lshrrev_b32 v6, 1, v2
  v_mul_u32_u24 v142, 6144, v6
  v_and_b32 v6, 1, v2
  v_lshlrev_b32 v6, 7, v6
  v_add_u32 v142, v142, v6
  v_bfe_u32 v6, v1, 2, 2
  v_lshlrev_b32 v6, 5, v6
  v_add_u32 v142, v142, v6
  v_and_b32 v6, 1, v1
  v_lshlrev_b32 v6, 4, v6
  v_add_u32 v142, v142, v6
  v_bfe_u32 v6, v1, 1, 1
  v_lshlrev_b32 v6, 3, v6
  v_add_u32 v142, v142, v6
  s_mul_i32 s28, s21, 768
  v_add_u32 v142, s28, v142
  s_lshl_b32 s29, s21, 10
  s_add_u32 m0, s29, 0
  s_mov_b32 s28, 0
  buffer_load_dwordx4 v136, s[12:15], s28 offen lds
  s_lshl_b32 s29, s21, 10
  s_add_u32 m0, s29, 4096
  s_mov_b32 s28, 0
  buffer_load_dwordx4 v137, s[12:15], s28 offen lds
  s_lshl_b32 s29, s21, 10
  s_add_u32 m0, s29, 8192
  s_mov_b32 s28, 0
  buffer_load_dwordx4 v138, s[12:15], s28 offen lds
  s_lshl_b32 s29, s21, 10
  s_add_u32 m0, s29, 12288
  s_mov_b32 s28, 0
  buffer_load_dwordx4 v139, s[12:15], s28 offen lds
  s_lshl_b32 s29, s21, 10
  s_add_u32 m0, s29, 16384
  s_mov_b32 s28, 0
  buffer_load_dwordx4 v140, s[12:15], s28 offen lds
  s_lshl_b32 s29, s21, 10
  s_add_u32 m0, s29, 20480
  s_mov_b32 s28, 0
  buffer_load_dwordx4 v141, s[12:15], s28 offen lds
  s_lshl_b32 s29, s21, 10
  s_add_u32 m0, s29, 24576
  s_mov_b32 s28, 786432
  buffer_load_dwordx4 v136, s[12:15], s28 offen lds
  s_lshl_b32 s29, s21, 10
  s_add_u32 m0, s29, 28672
  s_mov_b32 s28, 786432
  buffer_load_dwordx4 v137, s[12:15], s28 offen lds
  s_lshl_b32 s29, s21, 10
  s_add_u32 m0, s29, 32768
  s_mov_b32 s28, 786432
  buffer_load_dwordx4 v138, s[12:15], s28 offen lds
  s_lshl_b32 s29, s21, 10
  s_add_u32 m0, s29, 36864
  s_mov_b32 s28, 786432
  buffer_load_dwordx4 v139, s[12:15], s28 offen lds
  s_lshl_b32 s29, s21, 10
  s_add_u32 m0, s29, 40960
  s_mov_b32 s28, 786432
  buffer_load_dwordx4 v140, s[12:15], s28 offen lds
  s_lshl_b32 s29, s21, 10
  s_add_u32 m0, s29, 45056
  s_mov_b32 s28, 786432
  buffer_load_dwordx4 v141, s[12:15], s28 offen lds
  s_lshl_b32 s29, s21, 10
  s_add_u32 m0, s29, 49152
  s_mov_b32 s28, 1572864
  buffer_load_dwordx4 v136, s[12:15], s28 offen lds
  s_lshl_b32 s29, s21, 10
  s_add_u32 m0, s29, 53248
  s_mov_b32 s28, 1572864
  buffer_load_dwordx4 v137, s[12:15], s28 offen lds
  s_lshl_b32 s29, s21, 10
  s_add_u32 m0, s29, 57344
  s_mov_b32 s28, 1572864
  buffer_load_dwordx4 v138, s[12:15], s28 offen lds
  s_lshl_b32 s29, s21, 10
  s_add_u32 m0, s29, 61440
  s_mov_b32 s28, 1572864
  buffer_load_dwordx4 v139, s[12:15], s28 offen lds
  s_lshl_b32 s29, s21, 10
  s_add_u32 m0, s29, 65536
  s_mov_b32 s28, 1572864
  buffer_load_dwordx4 v140, s[12:15], s28 offen lds
  s_lshl_b32 s29, s21, 10
  s_add_u32 m0, s29, 69632
  s_mov_b32 s28, 1572864
  buffer_load_dwordx4 v141, s[12:15], s28 offen lds
  s_lshl_b32 s29, s21, 10
  s_add_u32 m0, s29, 73728
  s_mov_b32 s28, 2359296
  buffer_load_dwordx4 v136, s[12:15], s28 offen lds
  s_lshl_b32 s29, s21, 10
  s_add_u32 m0, s29, 77824
  s_mov_b32 s28, 2359296
  buffer_load_dwordx4 v137, s[12:15], s28 offen lds
  s_lshl_b32 s29, s21, 10
  s_add_u32 m0, s29, 81920
  s_mov_b32 s28, 2359296
  buffer_load_dwordx4 v138, s[12:15], s28 offen lds
  s_lshl_b32 s29, s21, 10
  s_add_u32 m0, s29, 86016
  s_mov_b32 s28, 2359296
  buffer_load_dwordx4 v139, s[12:15], s28 offen lds
  s_lshl_b32 s29, s21, 10
  s_add_u32 m0, s29, 90112
  s_mov_b32 s28, 2359296
  buffer_load_dwordx4 v140, s[12:15], s28 offen lds
  s_lshl_b32 s29, s21, 10
  s_add_u32 m0, s29, 94208
  s_mov_b32 s28, 2359296
  buffer_load_dwordx4 v141, s[12:15], s28 offen lds
  s_lshl_b32 s29, s21, 10
  s_add_u32 m0, s29, 98304
  s_mov_b32 s28, 3145728
  buffer_load_dwordx4 v136, s[12:15], s28 offen lds
  s_lshl_b32 s29, s21, 10
  s_add_u32 m0, s29, 102400
  s_mov_b32 s28, 3145728
  buffer_load_dwordx4 v137, s[12:15], s28 offen lds
  s_lshl_b32 s29, s21, 10
  s_add_u32 m0, s29, 106496
  s_mov_b32 s28, 3145728
  buffer_load_dwordx4 v138, s[12:15], s28 offen lds
  s_lshl_b32 s29, s21, 10
  s_add_u32 m0, s29, 110592
  s_mov_b32 s28, 3145728
  buffer_load_dwordx4 v139, s[12:15], s28 offen lds
  s_lshl_b32 s29, s21, 10
  s_add_u32 m0, s29, 114688
  s_mov_b32 s28, 3145728
  buffer_load_dwordx4 v140, s[12:15], s28 offen lds
  s_lshl_b32 s29, s21, 10
  s_add_u32 m0, s29, 118784
  s_mov_b32 s28, 3145728
  buffer_load_dwordx4 v141, s[12:15], s28 offen lds
  s_waitcnt vmcnt(24)
  s_cmp_eq_u32 s21, 3
  s_cbranch_scc0 lna_74_\sfx\()
  s_mov_b64 s[24:25], exec
  s_mov_b64 exec, 1
  v_mov_b32 v2, 4992
  v_mov_b32 v3, 1
  buffer_atomic_add v3, v2, s[8:11], 0 offen
  s_mov_b64 exec, s[24:25]
lna_74_\sfx\():
  s_barrier
  s_lshl_b32 s29, s21, 10
  s_add_u32 m0, s29, 122880
  s_mov_b32 s28, 3932160
  buffer_load_dwordx4 v136, s[12:15], s28 offen lds
  s_lshl_b32 s29, s21, 10
  s_add_u32 m0, s29, 126976
  s_mov_b32 s28, 3932160
  buffer_load_dwordx4 v137, s[12:15], s28 offen lds
  s_lshl_b32 s29, s21, 10
  s_add_u32 m0, s29, 131072
  s_mov_b32 s28, 3932160
  buffer_load_dwordx4 v138, s[12:15], s28 offen lds
  s_lshl_b32 s29, s21, 10
  s_add_u32 m0, s29, 135168
  s_mov_b32 s28, 3932160
  buffer_load_dwordx4 v139, s[12:15], s28 offen lds
  s_lshl_b32 s29, s21, 10
  s_add_u32 m0, s29, 139264
  s_mov_b32 s28, 3932160
  buffer_load_dwordx4 v140, s[12:15], s28 offen lds
  s_lshl_b32 s29, s21, 10
  s_add_u32 m0, s29, 143360
  s_mov_b32 s28, 3932160
  buffer_load_dwordx4 v141, s[12:15], s28 offen lds
  v_add_u32 v143, 0, v142
  ds_read_b64_tr_b16 a[0:1], v143 offset:0
  ds_read_b64_tr_b16 a[2:3], v143 offset:3072
  ds_read_b64_tr_b16 a[4:5], v143 offset:12288
  ds_read_b64_tr_b16 a[6:7], v143 offset:15360
  ds_read_b64_tr_b16 a[80:81], v143 offset:256
  ds_read_b64_tr_b16 a[82:83], v143 offset:3328
  ds_read_b64_tr_b16 a[84:85], v143 offset:12544
  ds_read_b64_tr_b16 a[86:87], v143 offset:15616
  ds_read_b64_tr_b16 a[160:161], v143 offset:512
  ds_read_b64_tr_b16 a[162:163], v143 offset:3584
  ds_read_b64_tr_b16 a[164:165], v143 offset:12800
  ds_read_b64_tr_b16 a[166:167], v143 offset:15872
  s_waitcnt lgkmcnt(0)
  s_waitcnt vmcnt(24)
  s_barrier
  s_lshl_b32 s29, s21, 10
  s_add_u32 m0, s29, 0
  s_mov_b32 s28, 4718592
  buffer_load_dwordx4 v136, s[12:15], s28 offen lds
  s_lshl_b32 s29, s21, 10
  s_add_u32 m0, s29, 4096
  s_mov_b32 s28, 4718592
  buffer_load_dwordx4 v137, s[12:15], s28 offen lds
  s_lshl_b32 s29, s21, 10
  s_add_u32 m0, s29, 8192
  s_mov_b32 s28, 4718592
  buffer_load_dwordx4 v138, s[12:15], s28 offen lds
  s_lshl_b32 s29, s21, 10
  s_add_u32 m0, s29, 12288
  s_mov_b32 s28, 4718592
  buffer_load_dwordx4 v139, s[12:15], s28 offen lds
  s_lshl_b32 s29, s21, 10
  s_add_u32 m0, s29, 16384
  s_mov_b32 s28, 4718592
  buffer_load_dwordx4 v140, s[12:15], s28 offen lds
  s_lshl_b32 s29, s21, 10
  s_add_u32 m0, s29, 20480
  s_mov_b32 s28, 4718592
  buffer_load_dwordx4 v141, s[12:15], s28 offen lds
  v_add_u32 v143, 24576, v142
  ds_read_b64_tr_b16 a[8:9], v143 offset:0
  ds_read_b64_tr_b16 a[10:11], v143 offset:3072
  ds_read_b64_tr_b16 a[12:13], v143 offset:12288
  ds_read_b64_tr_b16 a[14:15], v143 offset:15360
  ds_read_b64_tr_b16 a[88:89], v143 offset:256
  ds_read_b64_tr_b16 a[90:91], v143 offset:3328
  ds_read_b64_tr_b16 a[92:93], v143 offset:12544
  ds_read_b64_tr_b16 a[94:95], v143 offset:15616
  ds_read_b64_tr_b16 a[168:169], v143 offset:512
  ds_read_b64_tr_b16 a[170:171], v143 offset:3584
  ds_read_b64_tr_b16 a[172:173], v143 offset:12800
  ds_read_b64_tr_b16 a[174:175], v143 offset:15872
  s_waitcnt lgkmcnt(0)
  s_waitcnt vmcnt(24)
  s_barrier
  s_lshl_b32 s29, s21, 10
  s_add_u32 m0, s29, 24576
  s_mov_b32 s28, 5505024
  buffer_load_dwordx4 v136, s[12:15], s28 offen lds
  s_lshl_b32 s29, s21, 10
  s_add_u32 m0, s29, 28672
  s_mov_b32 s28, 5505024
  buffer_load_dwordx4 v137, s[12:15], s28 offen lds
  s_lshl_b32 s29, s21, 10
  s_add_u32 m0, s29, 32768
  s_mov_b32 s28, 5505024
  buffer_load_dwordx4 v138, s[12:15], s28 offen lds
  s_lshl_b32 s29, s21, 10
  s_add_u32 m0, s29, 36864
  s_mov_b32 s28, 5505024
  buffer_load_dwordx4 v139, s[12:15], s28 offen lds
  s_lshl_b32 s29, s21, 10
  s_add_u32 m0, s29, 40960
  s_mov_b32 s28, 5505024
  buffer_load_dwordx4 v140, s[12:15], s28 offen lds
  s_lshl_b32 s29, s21, 10
  s_add_u32 m0, s29, 45056
  s_mov_b32 s28, 5505024
  buffer_load_dwordx4 v141, s[12:15], s28 offen lds
  v_add_u32 v143, 49152, v142
  ds_read_b64_tr_b16 a[16:17], v143 offset:0
  ds_read_b64_tr_b16 a[18:19], v143 offset:3072
  ds_read_b64_tr_b16 a[20:21], v143 offset:12288
  ds_read_b64_tr_b16 a[22:23], v143 offset:15360
  ds_read_b64_tr_b16 a[96:97], v143 offset:256
  ds_read_b64_tr_b16 a[98:99], v143 offset:3328
  ds_read_b64_tr_b16 a[100:101], v143 offset:12544
  ds_read_b64_tr_b16 a[102:103], v143 offset:15616
  ds_read_b64_tr_b16 a[176:177], v143 offset:512
  ds_read_b64_tr_b16 a[178:179], v143 offset:3584
  ds_read_b64_tr_b16 a[180:181], v143 offset:12800
  ds_read_b64_tr_b16 a[182:183], v143 offset:15872
  s_waitcnt lgkmcnt(0)
  s_waitcnt vmcnt(24)
  s_barrier
  s_lshl_b32 s29, s21, 10
  s_add_u32 m0, s29, 49152
  s_mov_b32 s28, 6291456
  buffer_load_dwordx4 v136, s[12:15], s28 offen lds
  s_lshl_b32 s29, s21, 10
  s_add_u32 m0, s29, 53248
  s_mov_b32 s28, 6291456
  buffer_load_dwordx4 v137, s[12:15], s28 offen lds
  s_lshl_b32 s29, s21, 10
  s_add_u32 m0, s29, 57344
  s_mov_b32 s28, 6291456
  buffer_load_dwordx4 v138, s[12:15], s28 offen lds
  s_lshl_b32 s29, s21, 10
  s_add_u32 m0, s29, 61440
  s_mov_b32 s28, 6291456
  buffer_load_dwordx4 v139, s[12:15], s28 offen lds
  s_lshl_b32 s29, s21, 10
  s_add_u32 m0, s29, 65536
  s_mov_b32 s28, 6291456
  buffer_load_dwordx4 v140, s[12:15], s28 offen lds
  s_lshl_b32 s29, s21, 10
  s_add_u32 m0, s29, 69632
  s_mov_b32 s28, 6291456
  buffer_load_dwordx4 v141, s[12:15], s28 offen lds
  v_add_u32 v143, 73728, v142
  ds_read_b64_tr_b16 a[24:25], v143 offset:0
  ds_read_b64_tr_b16 a[26:27], v143 offset:3072
  ds_read_b64_tr_b16 a[28:29], v143 offset:12288
  ds_read_b64_tr_b16 a[30:31], v143 offset:15360
  ds_read_b64_tr_b16 a[104:105], v143 offset:256
  ds_read_b64_tr_b16 a[106:107], v143 offset:3328
  ds_read_b64_tr_b16 a[108:109], v143 offset:12544
  ds_read_b64_tr_b16 a[110:111], v143 offset:15616
  ds_read_b64_tr_b16 a[184:185], v143 offset:512
  ds_read_b64_tr_b16 a[186:187], v143 offset:3584
  ds_read_b64_tr_b16 a[188:189], v143 offset:12800
  ds_read_b64_tr_b16 a[190:191], v143 offset:15872
  s_waitcnt lgkmcnt(0)
  s_waitcnt vmcnt(24)
  s_barrier
  s_lshl_b32 s29, s21, 10
  s_add_u32 m0, s29, 73728
  s_mov_b32 s28, 7077888
  buffer_load_dwordx4 v136, s[12:15], s28 offen lds
  s_lshl_b32 s29, s21, 10
  s_add_u32 m0, s29, 77824
  s_mov_b32 s28, 7077888
  buffer_load_dwordx4 v137, s[12:15], s28 offen lds
  s_lshl_b32 s29, s21, 10
  s_add_u32 m0, s29, 81920
  s_mov_b32 s28, 7077888
  buffer_load_dwordx4 v138, s[12:15], s28 offen lds
  s_lshl_b32 s29, s21, 10
  s_add_u32 m0, s29, 86016
  s_mov_b32 s28, 7077888
  buffer_load_dwordx4 v139, s[12:15], s28 offen lds
  s_lshl_b32 s29, s21, 10
  s_add_u32 m0, s29, 90112
  s_mov_b32 s28, 7077888
  buffer_load_dwordx4 v140, s[12:15], s28 offen lds
  s_lshl_b32 s29, s21, 10
  s_add_u32 m0, s29, 94208
  s_mov_b32 s28, 7077888
  buffer_load_dwordx4 v141, s[12:15], s28 offen lds
  v_add_u32 v143, 98304, v142
  ds_read_b64_tr_b16 a[32:33], v143 offset:0
  ds_read_b64_tr_b16 a[34:35], v143 offset:3072
  ds_read_b64_tr_b16 a[36:37], v143 offset:12288
  ds_read_b64_tr_b16 a[38:39], v143 offset:15360
  ds_read_b64_tr_b16 a[112:113], v143 offset:256
  ds_read_b64_tr_b16 a[114:115], v143 offset:3328
  ds_read_b64_tr_b16 a[116:117], v143 offset:12544
  ds_read_b64_tr_b16 a[118:119], v143 offset:15616
  ds_read_b64_tr_b16 a[192:193], v143 offset:512
  ds_read_b64_tr_b16 a[194:195], v143 offset:3584
  ds_read_b64_tr_b16 a[196:197], v143 offset:12800
  ds_read_b64_tr_b16 a[198:199], v143 offset:15872
  s_waitcnt lgkmcnt(0)
  s_waitcnt vmcnt(24)
  s_barrier
  s_lshl_b32 s29, s21, 10
  s_add_u32 m0, s29, 98304
  s_mov_b32 s28, 0
  buffer_load_dwordx4 v136, s[16:19], s28 offen lds
  s_lshl_b32 s29, s21, 10
  s_add_u32 m0, s29, 102400
  s_mov_b32 s28, 0
  buffer_load_dwordx4 v137, s[16:19], s28 offen lds
  s_lshl_b32 s29, s21, 10
  s_add_u32 m0, s29, 106496
  s_mov_b32 s28, 0
  buffer_load_dwordx4 v138, s[16:19], s28 offen lds
  s_lshl_b32 s29, s21, 10
  s_add_u32 m0, s29, 110592
  s_mov_b32 s28, 0
  buffer_load_dwordx4 v139, s[16:19], s28 offen lds
  s_lshl_b32 s29, s21, 10
  s_add_u32 m0, s29, 114688
  s_mov_b32 s28, 0
  buffer_load_dwordx4 v140, s[16:19], s28 offen lds
  s_lshl_b32 s29, s21, 10
  s_add_u32 m0, s29, 118784
  s_mov_b32 s28, 0
  buffer_load_dwordx4 v141, s[16:19], s28 offen lds
  v_add_u32 v143, 122880, v142
  ds_read_b64_tr_b16 a[40:41], v143 offset:0
  ds_read_b64_tr_b16 a[42:43], v143 offset:3072
  ds_read_b64_tr_b16 a[44:45], v143 offset:12288
  ds_read_b64_tr_b16 a[46:47], v143 offset:15360
  ds_read_b64_tr_b16 a[120:121], v143 offset:256
  ds_read_b64_tr_b16 a[122:123], v143 offset:3328
  ds_read_b64_tr_b16 a[124:125], v143 offset:12544
  ds_read_b64_tr_b16 a[126:127], v143 offset:15616
  ds_read_b64_tr_b16 a[200:201], v143 offset:512
  ds_read_b64_tr_b16 a[202:203], v143 offset:3584
  ds_read_b64_tr_b16 a[204:205], v143 offset:12800
  ds_read_b64_tr_b16 a[206:207], v143 offset:15872
  s_waitcnt lgkmcnt(0)
  s_waitcnt vmcnt(24)
  s_barrier
  s_lshl_b32 s29, s21, 10
  s_add_u32 m0, s29, 122880
  s_mov_b32 s28, 1572864
  buffer_load_dwordx4 v136, s[16:19], s28 offen lds
  s_lshl_b32 s29, s21, 10
  s_add_u32 m0, s29, 126976
  s_mov_b32 s28, 1572864
  buffer_load_dwordx4 v137, s[16:19], s28 offen lds
  s_lshl_b32 s29, s21, 10
  s_add_u32 m0, s29, 131072
  s_mov_b32 s28, 1572864
  buffer_load_dwordx4 v138, s[16:19], s28 offen lds
  s_lshl_b32 s29, s21, 10
  s_add_u32 m0, s29, 135168
  s_mov_b32 s28, 1572864
  buffer_load_dwordx4 v139, s[16:19], s28 offen lds
  s_lshl_b32 s29, s21, 10
  s_add_u32 m0, s29, 139264
  s_mov_b32 s28, 1572864
  buffer_load_dwordx4 v140, s[16:19], s28 offen lds
  s_lshl_b32 s29, s21, 10
  s_add_u32 m0, s29, 143360
  s_mov_b32 s28, 1572864
  buffer_load_dwordx4 v141, s[16:19], s28 offen lds
  v_add_u32 v143, 0, v142
  ds_read_b64_tr_b16 a[48:49], v143 offset:0
  ds_read_b64_tr_b16 a[50:51], v143 offset:3072
  ds_read_b64_tr_b16 a[52:53], v143 offset:12288
  ds_read_b64_tr_b16 a[54:55], v143 offset:15360
  ds_read_b64_tr_b16 a[128:129], v143 offset:256
  ds_read_b64_tr_b16 a[130:131], v143 offset:3328
  ds_read_b64_tr_b16 a[132:133], v143 offset:12544
  ds_read_b64_tr_b16 a[134:135], v143 offset:15616
  ds_read_b64_tr_b16 a[208:209], v143 offset:512
  ds_read_b64_tr_b16 a[210:211], v143 offset:3584
  ds_read_b64_tr_b16 a[212:213], v143 offset:12800
  ds_read_b64_tr_b16 a[214:215], v143 offset:15872
  s_waitcnt lgkmcnt(0)
  s_waitcnt vmcnt(24)
  s_barrier
  s_lshl_b32 s29, s21, 10
  s_add_u32 m0, s29, 0
  s_mov_b32 s28, 3145728
  buffer_load_dwordx4 v136, s[16:19], s28 offen lds
  s_lshl_b32 s29, s21, 10
  s_add_u32 m0, s29, 4096
  s_mov_b32 s28, 3145728
  buffer_load_dwordx4 v137, s[16:19], s28 offen lds
  s_lshl_b32 s29, s21, 10
  s_add_u32 m0, s29, 8192
  s_mov_b32 s28, 3145728
  buffer_load_dwordx4 v138, s[16:19], s28 offen lds
  s_lshl_b32 s29, s21, 10
  s_add_u32 m0, s29, 12288
  s_mov_b32 s28, 3145728
  buffer_load_dwordx4 v139, s[16:19], s28 offen lds
  s_lshl_b32 s29, s21, 10
  s_add_u32 m0, s29, 16384
  s_mov_b32 s28, 3145728
  buffer_load_dwordx4 v140, s[16:19], s28 offen lds
  s_lshl_b32 s29, s21, 10
  s_add_u32 m0, s29, 20480
  s_mov_b32 s28, 3145728
  buffer_load_dwordx4 v141, s[16:19], s28 offen lds
  v_add_u32 v143, 24576, v142
  ds_read_b64_tr_b16 a[56:57], v143 offset:0
  ds_read_b64_tr_b16 a[58:59], v143 offset:3072
  ds_read_b64_tr_b16 a[60:61], v143 offset:12288
  ds_read_b64_tr_b16 a[62:63], v143 offset:15360
  ds_read_b64_tr_b16 a[136:137], v143 offset:256
  ds_read_b64_tr_b16 a[138:139], v143 offset:3328
  ds_read_b64_tr_b16 a[140:141], v143 offset:12544
  ds_read_b64_tr_b16 a[142:143], v143 offset:15616
  ds_read_b64_tr_b16 a[216:217], v143 offset:512
  ds_read_b64_tr_b16 a[218:219], v143 offset:3584
  ds_read_b64_tr_b16 a[220:221], v143 offset:12800
  ds_read_b64_tr_b16 a[222:223], v143 offset:15872
  s_waitcnt lgkmcnt(0)
  s_waitcnt vmcnt(24)
  s_barrier
  s_lshl_b32 s29, s21, 10
  s_add_u32 m0, s29, 24576
  s_mov_b32 s28, 4718592
  buffer_load_dwordx4 v136, s[16:19], s28 offen lds
  s_lshl_b32 s29, s21, 10
  s_add_u32 m0, s29, 28672
  s_mov_b32 s28, 4718592
  buffer_load_dwordx4 v137, s[16:19], s28 offen lds
  s_lshl_b32 s29, s21, 10
  s_add_u32 m0, s29, 32768
  s_mov_b32 s28, 4718592
  buffer_load_dwordx4 v138, s[16:19], s28 offen lds
  s_lshl_b32 s29, s21, 10
  s_add_u32 m0, s29, 36864
  s_mov_b32 s28, 4718592
  buffer_load_dwordx4 v139, s[16:19], s28 offen lds
  s_lshl_b32 s29, s21, 10
  s_add_u32 m0, s29, 40960
  s_mov_b32 s28, 4718592
  buffer_load_dwordx4 v140, s[16:19], s28 offen lds
  s_lshl_b32 s29, s21, 10
  s_add_u32 m0, s29, 45056
  s_mov_b32 s28, 4718592
  buffer_load_dwordx4 v141, s[16:19], s28 offen lds
  v_add_u32 v143, 49152, v142
  ds_read_b64_tr_b16 a[64:65], v143 offset:0
  ds_read_b64_tr_b16 a[66:67], v143 offset:3072
  ds_read_b64_tr_b16 a[68:69], v143 offset:12288
  ds_read_b64_tr_b16 a[70:71], v143 offset:15360
  ds_read_b64_tr_b16 a[144:145], v143 offset:256
  ds_read_b64_tr_b16 a[146:147], v143 offset:3328
  ds_read_b64_tr_b16 a[148:149], v143 offset:12544
  ds_read_b64_tr_b16 a[150:151], v143 offset:15616
  ds_read_b64_tr_b16 a[224:225], v143 offset:512
  ds_read_b64_tr_b16 a[226:227], v143 offset:3584
  ds_read_b64_tr_b16 a[228:229], v143 offset:12800
  ds_read_b64_tr_b16 a[230:231], v143 offset:15872
  s_waitcnt lgkmcnt(0)
  s_waitcnt vmcnt(24)
  s_barrier
  s_lshl_b32 s29, s21, 10
  s_add_u32 m0, s29, 49152
  s_mov_b32 s28, 6291456
  buffer_load_dwordx4 v136, s[16:19], s28 offen lds
  s_lshl_b32 s29, s21, 10
  s_add_u32 m0, s29, 53248
  s_mov_b32 s28, 6291456
  buffer_load_dwordx4 v137, s[16:19], s28 offen lds
  s_lshl_b32 s29, s21, 10
  s_add_u32 m0, s29, 57344
  s_mov_b32 s28, 6291456
  buffer_load_dwordx4 v138, s[16:19], s28 offen lds
  s_lshl_b32 s29, s21, 10
  s_add_u32 m0, s29, 61440
  s_mov_b32 s28, 6291456
  buffer_load_dwordx4 v139, s[16:19], s28 offen lds
  s_lshl_b32 s29, s21, 10
  s_add_u32 m0, s29, 65536
  s_mov_b32 s28, 6291456
  buffer_load_dwordx4 v140, s[16:19], s28 offen lds
  s_lshl_b32 s29, s21, 10
  s_add_u32 m0, s29, 69632
  s_mov_b32 s28, 6291456
  buffer_load_dwordx4 v141, s[16:19], s28 offen lds
  v_add_u32 v143, 73728, v142
  ds_read_b64_tr_b16 a[72:73], v143 offset:0
  ds_read_b64_tr_b16 a[74:75], v143 offset:3072
  ds_read_b64_tr_b16 a[76:77], v143 offset:12288
  ds_read_b64_tr_b16 a[78:79], v143 offset:15360
  ds_read_b64_tr_b16 a[152:153], v143 offset:256
  ds_read_b64_tr_b16 a[154:155], v143 offset:3328
  ds_read_b64_tr_b16 a[156:157], v143 offset:12544
  ds_read_b64_tr_b16 a[158:159], v143 offset:15616
  ds_read_b64_tr_b16 a[232:233], v143 offset:512
  ds_read_b64_tr_b16 a[234:235], v143 offset:3584
  ds_read_b64_tr_b16 a[236:237], v143 offset:12800
  ds_read_b64_tr_b16 a[238:239], v143 offset:15872
  s_waitcnt lgkmcnt(0)
  s_waitcnt vmcnt(24)
  s_barrier
  s_lshl_b32 s29, s21, 10
  s_add_u32 m0, s29, 73728
  s_mov_b32 s28, 786432
  buffer_load_dwordx4 v136, s[16:19], s28 offen lds
  s_lshl_b32 s29, s21, 10
  s_add_u32 m0, s29, 77824
  s_mov_b32 s28, 786432
  buffer_load_dwordx4 v137, s[16:19], s28 offen lds
  s_lshl_b32 s29, s21, 10
  s_add_u32 m0, s29, 81920
  s_mov_b32 s28, 786432
  buffer_load_dwordx4 v138, s[16:19], s28 offen lds
  s_lshl_b32 s29, s21, 10
  s_add_u32 m0, s29, 86016
  s_mov_b32 s28, 786432
  buffer_load_dwordx4 v139, s[16:19], s28 offen lds
  s_lshl_b32 s29, s21, 10
  s_add_u32 m0, s29, 90112
  s_mov_b32 s28, 786432
  buffer_load_dwordx4 v140, s[16:19], s28 offen lds
  s_lshl_b32 s29, s21, 10
  s_add_u32 m0, s29, 94208
  s_mov_b32 s28, 786432
  buffer_load_dwordx4 v141, s[16:19], s28 offen lds
  v_add_u32 v143, 98304, v142
  ds_read_b64_tr_b16 a[240:241], v143 offset:0
  ds_read_b64_tr_b16 a[242:243], v143 offset:3072
  ds_read_b64_tr_b16 a[244:245], v143 offset:12288
  ds_read_b64_tr_b16 a[246:247], v143 offset:15360
  ds_read_b64_tr_b16 v[176:177], v143 offset:256
  ds_read_b64_tr_b16 v[178:179], v143 offset:3328
  ds_read_b64_tr_b16 v[180:181], v143 offset:12544
  ds_read_b64_tr_b16 v[182:183], v143 offset:15616
  ds_read_b64_tr_b16 v[216:217], v143 offset:512
  ds_read_b64_tr_b16 v[218:219], v143 offset:3584
  ds_read_b64_tr_b16 v[220:221], v143 offset:12800
  ds_read_b64_tr_b16 v[222:223], v143 offset:15872
  s_waitcnt lgkmcnt(0)
  s_waitcnt vmcnt(24)
  s_barrier
  s_lshl_b32 s29, s21, 10
  s_add_u32 m0, s29, 98304
  s_mov_b32 s28, 2359296
  buffer_load_dwordx4 v136, s[16:19], s28 offen lds
  s_lshl_b32 s29, s21, 10
  s_add_u32 m0, s29, 102400
  s_mov_b32 s28, 2359296
  buffer_load_dwordx4 v137, s[16:19], s28 offen lds
  s_lshl_b32 s29, s21, 10
  s_add_u32 m0, s29, 106496
  s_mov_b32 s28, 2359296
  buffer_load_dwordx4 v138, s[16:19], s28 offen lds
  s_lshl_b32 s29, s21, 10
  s_add_u32 m0, s29, 110592
  s_mov_b32 s28, 2359296
  buffer_load_dwordx4 v139, s[16:19], s28 offen lds
  s_lshl_b32 s29, s21, 10
  s_add_u32 m0, s29, 114688
  s_mov_b32 s28, 2359296
  buffer_load_dwordx4 v140, s[16:19], s28 offen lds
  s_lshl_b32 s29, s21, 10
  s_add_u32 m0, s29, 118784
  s_mov_b32 s28, 2359296
  buffer_load_dwordx4 v141, s[16:19], s28 offen lds
  v_add_u32 v143, 122880, v142
  ds_read_b64_tr_b16 a[248:249], v143 offset:0
  ds_read_b64_tr_b16 a[250:251], v143 offset:3072
  ds_read_b64_tr_b16 a[252:253], v143 offset:12288
  ds_read_b64_tr_b16 a[254:255], v143 offset:15360
  ds_read_b64_tr_b16 v[184:185], v143 offset:256
  ds_read_b64_tr_b16 v[186:187], v143 offset:3328
  ds_read_b64_tr_b16 v[188:189], v143 offset:12544
  ds_read_b64_tr_b16 v[190:191], v143 offset:15616
  ds_read_b64_tr_b16 v[224:225], v143 offset:512
  ds_read_b64_tr_b16 v[226:227], v143 offset:3584
  ds_read_b64_tr_b16 v[228:229], v143 offset:12800
  ds_read_b64_tr_b16 v[230:231], v143 offset:15872
  s_waitcnt lgkmcnt(0)
  s_waitcnt vmcnt(24)
  s_barrier
  s_lshl_b32 s29, s21, 10
  s_add_u32 m0, s29, 122880
  s_mov_b32 s28, 3932160
  buffer_load_dwordx4 v136, s[16:19], s28 offen lds
  s_lshl_b32 s29, s21, 10
  s_add_u32 m0, s29, 126976
  s_mov_b32 s28, 3932160
  buffer_load_dwordx4 v137, s[16:19], s28 offen lds
  s_lshl_b32 s29, s21, 10
  s_add_u32 m0, s29, 131072
  s_mov_b32 s28, 3932160
  buffer_load_dwordx4 v138, s[16:19], s28 offen lds
  s_lshl_b32 s29, s21, 10
  s_add_u32 m0, s29, 135168
  s_mov_b32 s28, 3932160
  buffer_load_dwordx4 v139, s[16:19], s28 offen lds
  s_lshl_b32 s29, s21, 10
  s_add_u32 m0, s29, 139264
  s_mov_b32 s28, 3932160
  buffer_load_dwordx4 v140, s[16:19], s28 offen lds
  s_lshl_b32 s29, s21, 10
  s_add_u32 m0, s29, 143360
  s_mov_b32 s28, 3932160
  buffer_load_dwordx4 v141, s[16:19], s28 offen lds
  v_add_u32 v143, 0, v142
  ds_read_b64_tr_b16 v[152:153], v143 offset:0
  ds_read_b64_tr_b16 v[154:155], v143 offset:3072
  ds_read_b64_tr_b16 v[156:157], v143 offset:12288
  ds_read_b64_tr_b16 v[158:159], v143 offset:15360
  ds_read_b64_tr_b16 v[192:193], v143 offset:256
  ds_read_b64_tr_b16 v[194:195], v143 offset:3328
  ds_read_b64_tr_b16 v[196:197], v143 offset:12544
  ds_read_b64_tr_b16 v[198:199], v143 offset:15616
  ds_read_b64_tr_b16 v[232:233], v143 offset:512
  ds_read_b64_tr_b16 v[234:235], v143 offset:3584
  ds_read_b64_tr_b16 v[236:237], v143 offset:12800
  ds_read_b64_tr_b16 v[238:239], v143 offset:15872
  s_waitcnt lgkmcnt(0)
  s_waitcnt vmcnt(24)
  s_barrier
  s_lshl_b32 s29, s21, 10
  s_add_u32 m0, s29, 0
  s_mov_b32 s28, 5505024
  buffer_load_dwordx4 v136, s[16:19], s28 offen lds
  s_lshl_b32 s29, s21, 10
  s_add_u32 m0, s29, 4096
  s_mov_b32 s28, 5505024
  buffer_load_dwordx4 v137, s[16:19], s28 offen lds
  s_lshl_b32 s29, s21, 10
  s_add_u32 m0, s29, 8192
  s_mov_b32 s28, 5505024
  buffer_load_dwordx4 v138, s[16:19], s28 offen lds
  s_lshl_b32 s29, s21, 10
  s_add_u32 m0, s29, 12288
  s_mov_b32 s28, 5505024
  buffer_load_dwordx4 v139, s[16:19], s28 offen lds
  s_lshl_b32 s29, s21, 10
  s_add_u32 m0, s29, 16384
  s_mov_b32 s28, 5505024
  buffer_load_dwordx4 v140, s[16:19], s28 offen lds
  s_lshl_b32 s29, s21, 10
  s_add_u32 m0, s29, 20480
  s_mov_b32 s28, 5505024
  buffer_load_dwordx4 v141, s[16:19], s28 offen lds
  v_add_u32 v143, 24576, v142
  ds_read_b64_tr_b16 v[160:161], v143 offset:0
  ds_read_b64_tr_b16 v[162:163], v143 offset:3072
  ds_read_b64_tr_b16 v[164:165], v143 offset:12288
  ds_read_b64_tr_b16 v[166:167], v143 offset:15360
  ds_read_b64_tr_b16 v[200:201], v143 offset:256
  ds_read_b64_tr_b16 v[202:203], v143 offset:3328
  ds_read_b64_tr_b16 v[204:205], v143 offset:12544
  ds_read_b64_tr_b16 v[206:207], v143 offset:15616
  ds_read_b64_tr_b16 v[240:241], v143 offset:512
  ds_read_b64_tr_b16 v[242:243], v143 offset:3584
  ds_read_b64_tr_b16 v[244:245], v143 offset:12800
  ds_read_b64_tr_b16 v[246:247], v143 offset:15872
  s_waitcnt lgkmcnt(0)
  s_waitcnt vmcnt(24)
  s_barrier
  s_lshl_b32 s29, s21, 10
  s_add_u32 m0, s29, 24576
  s_mov_b32 s28, 7077888
  buffer_load_dwordx4 v136, s[16:19], s28 offen lds
  s_lshl_b32 s29, s21, 10
  s_add_u32 m0, s29, 28672
  s_mov_b32 s28, 7077888
  buffer_load_dwordx4 v137, s[16:19], s28 offen lds
  s_lshl_b32 s29, s21, 10
  s_add_u32 m0, s29, 32768
  s_mov_b32 s28, 7077888
  buffer_load_dwordx4 v138, s[16:19], s28 offen lds
  s_lshl_b32 s29, s21, 10
  s_add_u32 m0, s29, 36864
  s_mov_b32 s28, 7077888
  buffer_load_dwordx4 v139, s[16:19], s28 offen lds
  s_lshl_b32 s29, s21, 10
  s_add_u32 m0, s29, 40960
  s_mov_b32 s28, 7077888
  buffer_load_dwordx4 v140, s[16:19], s28 offen lds
  s_lshl_b32 s29, s21, 10
  s_add_u32 m0, s29, 45056
  s_mov_b32 s28, 7077888
  buffer_load_dwordx4 v141, s[16:19], s28 offen lds
  v_add_u32 v143, 49152, v142
  ds_read_b64_tr_b16 v[168:169], v143 offset:0
  ds_read_b64_tr_b16 v[170:171], v143 offset:3072
  ds_read_b64_tr_b16 v[172:173], v143 offset:12288
  ds_read_b64_tr_b16 v[174:175], v143 offset:15360
  ds_read_b64_tr_b16 v[208:209], v143 offset:256
  ds_read_b64_tr_b16 v[210:211], v143 offset:3328
  ds_read_b64_tr_b16 v[212:213], v143 offset:12544
  ds_read_b64_tr_b16 v[214:215], v143 offset:15616
  ds_read_b64_tr_b16 v[248:249], v143 offset:512
  ds_read_b64_tr_b16 v[250:251], v143 offset:3584
  ds_read_b64_tr_b16 v[252:253], v143 offset:12800
  ds_read_b64_tr_b16 v[254:255], v143 offset:15872
  s_waitcnt lgkmcnt(0)
  s_waitcnt vmcnt(24)
  s_barrier
  v_add_u32 v143, 73728, v142
  ds_read_b64_tr_b16 v[16:17], v143 offset:0
  ds_read_b64_tr_b16 v[18:19], v143 offset:3072
  ds_read_b64_tr_b16 v[20:21], v143 offset:12288
  ds_read_b64_tr_b16 v[22:23], v143 offset:15360
  ds_read_b64_tr_b16 v[24:25], v143 offset:256
  ds_read_b64_tr_b16 v[26:27], v143 offset:3328
  ds_read_b64_tr_b16 v[28:29], v143 offset:12544
  ds_read_b64_tr_b16 v[30:31], v143 offset:15616
  ds_read_b64_tr_b16 v[32:33], v143 offset:512
  ds_read_b64_tr_b16 v[34:35], v143 offset:3584
  ds_read_b64_tr_b16 v[36:37], v143 offset:12800
  ds_read_b64_tr_b16 v[38:39], v143 offset:15872
  s_waitcnt lgkmcnt(0)
  s_waitcnt vmcnt(18)
  s_barrier
  v_add_u32 v143, 98304, v142
  ds_read_b64_tr_b16 v[40:41], v143 offset:0
  ds_read_b64_tr_b16 v[42:43], v143 offset:3072
  ds_read_b64_tr_b16 v[44:45], v143 offset:12288
  ds_read_b64_tr_b16 v[46:47], v143 offset:15360
  ds_read_b64_tr_b16 v[48:49], v143 offset:256
  ds_read_b64_tr_b16 v[50:51], v143 offset:3328
  ds_read_b64_tr_b16 v[52:53], v143 offset:12544
  ds_read_b64_tr_b16 v[54:55], v143 offset:15616
  ds_read_b64_tr_b16 v[56:57], v143 offset:512
  ds_read_b64_tr_b16 v[58:59], v143 offset:3584
  ds_read_b64_tr_b16 v[60:61], v143 offset:12800
  ds_read_b64_tr_b16 v[62:63], v143 offset:15872
  s_waitcnt lgkmcnt(0)
  s_waitcnt vmcnt(12)
  s_barrier
  v_add_u32 v143, 122880, v142
  ds_read_b64_tr_b16 v[64:65], v143 offset:0
  ds_read_b64_tr_b16 v[66:67], v143 offset:3072
  ds_read_b64_tr_b16 v[68:69], v143 offset:12288
  ds_read_b64_tr_b16 v[70:71], v143 offset:15360
  ds_read_b64_tr_b16 v[72:73], v143 offset:256
  ds_read_b64_tr_b16 v[74:75], v143 offset:3328
  ds_read_b64_tr_b16 v[76:77], v143 offset:12544
  ds_read_b64_tr_b16 v[78:79], v143 offset:15616
  ds_read_b64_tr_b16 v[80:81], v143 offset:512
  ds_read_b64_tr_b16 v[82:83], v143 offset:3584
  ds_read_b64_tr_b16 v[84:85], v143 offset:12800
  ds_read_b64_tr_b16 v[86:87], v143 offset:15872
  s_waitcnt lgkmcnt(0)
  s_waitcnt vmcnt(6)
  s_barrier
  v_add_u32 v143, 0, v142
  ds_read_b64_tr_b16 v[88:89], v143 offset:0
  ds_read_b64_tr_b16 v[90:91], v143 offset:3072
  ds_read_b64_tr_b16 v[92:93], v143 offset:12288
  ds_read_b64_tr_b16 v[94:95], v143 offset:15360
  ds_read_b64_tr_b16 v[96:97], v143 offset:256
  ds_read_b64_tr_b16 v[98:99], v143 offset:3328
  ds_read_b64_tr_b16 v[100:101], v143 offset:12544
  ds_read_b64_tr_b16 v[102:103], v143 offset:15616
  ds_read_b64_tr_b16 v[104:105], v143 offset:512
  ds_read_b64_tr_b16 v[106:107], v143 offset:3584
  ds_read_b64_tr_b16 v[108:109], v143 offset:12800
  ds_read_b64_tr_b16 v[110:111], v143 offset:15872
  s_waitcnt lgkmcnt(0)
  s_waitcnt vmcnt(0)
  s_barrier
  v_add_u32 v143, 24576, v142
  ds_read_b64_tr_b16 v[112:113], v143 offset:0
  ds_read_b64_tr_b16 v[114:115], v143 offset:3072
  ds_read_b64_tr_b16 v[116:117], v143 offset:12288
  ds_read_b64_tr_b16 v[118:119], v143 offset:15360
  ds_read_b64_tr_b16 v[120:121], v143 offset:256
  ds_read_b64_tr_b16 v[122:123], v143 offset:3328
  ds_read_b64_tr_b16 v[124:125], v143 offset:12544
  ds_read_b64_tr_b16 v[126:127], v143 offset:15616
  ds_read_b64_tr_b16 v[128:129], v143 offset:512
  ds_read_b64_tr_b16 v[130:131], v143 offset:3584
  ds_read_b64_tr_b16 v[132:133], v143 offset:12800
  ds_read_b64_tr_b16 v[134:135], v143 offset:15872
  s_waitcnt lgkmcnt(0)
  s_barrier
  v_lshlrev_b32 v2, 4, v1
  s_mul_i32 s28, s21, 30720
  v_add_u32 v143, s28, v2
  ds_write_b128 v143, v[16:19] offset:0
  ds_write_b128 v143, v[20:23] offset:1024
  ds_write_b128 v143, v[24:27] offset:10240
  ds_write_b128 v143, v[28:31] offset:11264
  ds_write_b128 v143, v[32:35] offset:20480
  ds_write_b128 v143, v[36:39] offset:21504
  ds_write_b128 v143, v[40:43] offset:2048
  ds_write_b128 v143, v[44:47] offset:3072
  ds_write_b128 v143, v[48:51] offset:12288
  ds_write_b128 v143, v[52:55] offset:13312
  ds_write_b128 v143, v[56:59] offset:22528
  ds_write_b128 v143, v[60:63] offset:23552
  ds_write_b128 v143, v[64:67] offset:4096
  ds_write_b128 v143, v[68:71] offset:5120
  ds_write_b128 v143, v[72:75] offset:14336
  ds_write_b128 v143, v[76:79] offset:15360
  ds_write_b128 v143, v[80:83] offset:24576
  ds_write_b128 v143, v[84:87] offset:25600
  ds_write_b128 v143, v[88:91] offset:6144
  ds_write_b128 v143, v[92:95] offset:7168
  ds_write_b128 v143, v[96:99] offset:16384
  ds_write_b128 v143, v[100:103] offset:17408
  ds_write_b128 v143, v[104:107] offset:26624
  ds_write_b128 v143, v[108:111] offset:27648
  ds_write_b128 v143, v[112:115] offset:8192
  ds_write_b128 v143, v[116:119] offset:9216
  ds_write_b128 v143, v[120:123] offset:18432
  ds_write_b128 v143, v[124:127] offset:19456
  ds_write_b128 v143, v[128:131] offset:28672
  ds_write_b128 v143, v[132:135] offset:29696
  s_waitcnt lgkmcnt(0)
  v_and_b32 v1, 63, v0
  v_lshlrev_b32 v132, 4, v1
  s_mul_i32 s28, s21, 30720
  v_add_u32 v129, s28, v132
  s_lshl_b32 s28, s21, 10
  v_add_u32 v124, s28, v132
  v_add_u32 v125, 4096, v124
  v_add_u32 v126, 8192, v124
  v_add_u32 v127, 122880, v124
  v_add_u32 v128, 122880, v132
  v_lshrrev_b32 v2, 3, v1
  s_cmp_lt_u32 s21, 2
  s_cselect_b32 s28, 2, 1
  v_min_u32 v2, s28, v2
  v_lshlrev_b32 v2, 12, v2
  v_and_b32 v3, 7, v1
  v_lshlrev_b32 v3, 7, v3
  v_add_u32 v2, v2, v3
  s_lshl_b32 s28, s21, 10
  v_add_u32 v141, s28, v2
  v_and_b32 v2, 15, v1
  v_lshrrev_b32 v3, 4, v1
  v_add_u32 v3, v3, v2
  v_and_b32 v3, 3, v3
  v_lshlrev_b32 v3, 4, v3
  v_lshlrev_b32 v2, 6, v2
  v_add_u32 v2, v2, v3
  s_mul_i32 s28, s21, 3072
  s_add_u32 s28, s28, 133120
  v_add_u32 v130, s28, v2
  s_mul_i32 s28, s21, 1536
  s_add_u32 s28, s28, 145408
  v_lshlrev_b32 v2, 3, v1
  v_add_u32 v131, s28, v2
  v_mov_b32 v110, 0x44444444
  v_mov_b32 v2, 0xeeeeeeee
  v_and_b32 v3, 8, v1
  v_cmp_ne_u32 vcc, 0, v3
  s_nop 1
  v_cndmask_b32 v110, v110, v2, vcc
  v_and_b32 v4, 15, v1
  v_lshrrev_b32 v5, 4, v1
  v_lshlrev_b32 v6, 2, v5
  v_sub_u32 v6, v4, v6
  v_mov_b32 v7, 0x3f80
  v_mov_b32 v8, 0x3f800000
  v_mov_b32 v108, 0
  v_mov_b32 v109, 0
  v_cmp_eq_u32 vcc, 0, v6
  s_nop 1
  v_cndmask_b32 v108, v108, v7, vcc
  v_cmp_eq_u32 vcc, 1, v6
  s_nop 1
  v_cndmask_b32 v108, v108, v8, vcc
  v_cmp_eq_u32 vcc, 2, v6
  s_nop 1
  v_cndmask_b32 v109, v109, v7, vcc
  v_cmp_eq_u32 vcc, 3, v6
  s_nop 1
  v_cndmask_b32 v109, v109, v8, vcc
  s_mul_i32 s28, s23, 6
  s_lshr_b32 s29, s28, 3
  s_add_u32 s28, s28, 5
  s_lshr_b32 s28, s28, 3
  v_mov_b32 v6, s29
  v_mov_b32 v7, s28
  v_and_b32 v8, 1, v1
  v_cmp_eq_u32 vcc, 1, v8
  s_nop 1
  v_cndmask_b32 v6, v6, v7, vcc
  v_lshlrev_b32 v6, 2, v6
  v_bfe_u32 v8, v1, 1, 1
  v_lshlrev_b32 v8, 10, v8
  v_add_u32 v6, v6, v8
  v_add_u32 v138, 0, v6
  s_mul_i32 s97, s20, 655360
  s_add_u32 s97, s97, 0x400000
  s_mov_b32 s48, 0x4000
  s_mul_i32 s49, s20, 327680
  s_add_u32 s49, s49, 0x700000
  s_mul_i32 s50, s23, 786432
  s_add_u32 s63, s50, 0x4800000
  s_add_u32 s50, s50, 0x6000000
  s_mov_b32 s51, 0
  s_mov_b32 s52, 0
  s_mul_i32 s28, s21, 3
  s_add_u32 s28, s28, 0
  s_lshr_b32 s29, s28, 1
  s_lshl_b32 s29, s29, 11
  s_and_b32 s28, s28, 1
  s_lshl_b32 s28, s28, 3
  s_add_u32 s53, s29, s28
  s_mul_i32 s28, s21, 3
  s_add_u32 s28, s28, 1
  s_lshr_b32 s29, s28, 1
  s_lshl_b32 s29, s29, 11
  s_and_b32 s28, s28, 1
  s_lshl_b32 s28, s28, 3
  s_add_u32 s54, s29, s28
  s_mul_i32 s28, s21, 3
  s_add_u32 s28, s28, 2
  s_lshr_b32 s29, s28, 1
  s_lshl_b32 s29, s29, 11
  s_and_b32 s28, s28, 1
  s_lshl_b32 s28, s28, 3
  s_add_u32 s55, s29, s28
  v_mov_b32 v60, 0
  v_mov_b32 v61, 0
  v_mov_b32 v62, 0
  v_mov_b32 v63, 0
  v_mov_b32 v64, 0
  v_mov_b32 v65, 0
  v_mov_b32 v66, 0
  v_mov_b32 v67, 0
  v_mov_b32 v68, 0
  v_mov_b32 v69, 0
  v_mov_b32 v70, 0
  v_mov_b32 v71, 0
  v_mov_b32 v72, 0
  v_mov_b32 v73, 0
  v_mov_b32 v74, 0
  v_mov_b32 v75, 0
  v_mov_b32 v36, 0
  v_mov_b32 v37, 0
  v_mov_b32 v38, 0
  v_mov_b32 v39, 0
  v_mov_b32 v40, 0
  v_mov_b32 v41, 0
  v_mov_b32 v42, 0
  v_mov_b32 v43, 0
  s_barrier
  s_cmp_gt_u32 s52, s51
  s_cbranch_scc1 ka\sfx\()_x_wp_75_ok
  s_mov_b32 s45, 0
ka\sfx\()_x_wp_75_spin:
  buffer_load_dword v2, v138, s[8:11], 0 offen sc1
  s_add_u32 s45, s45, 1
  s_waitcnt vmcnt(0)
  v_min_u32_dpp v3, v2, v2 quad_perm:[1,0,3,2] row_mask:0xf bank_mask:0xf
  s_nop 1
  v_min_u32_dpp v2, v3, v3 quad_perm:[2,3,0,1] row_mask:0xf bank_mask:0xf
  s_nop 1
  v_min_u32_dpp v3, v2, v2 row_half_mirror row_mask:0xf bank_mask:0xf
  s_nop 1
  v_min_u32_dpp v2, v3, v3 quad_perm:[0,1,2,3] row_mask:0xf bank_mask:0xf
  s_nop 0
  v_readfirstlane_b32 s52, v2
  s_cmp_gt_u32 s52, s51
  s_cbranch_scc1 ka\sfx\()_x_wp_75_ok
  s_cmp_lt_u32 s45, 400000
  s_cbranch_scc1 ka\sfx\()_x_wp_75_spin
  s_branch ka\sfx\()_abort
ka\sfx\()_x_wp_75_ok:
  s_add_u32 s28, s50, s53
  buffer_load_dwordx2 v[88:89], v132, s[8:11], s28 offen offset:0 sc1
  buffer_load_dwordx2 v[92:93], v132, s[8:11], s28 offen offset:1024 sc1
  s_add_u32 s28, s50, s54
  buffer_load_dwordx2 v[90:91], v132, s[8:11], s28 offen offset:0 sc1
  buffer_load_dwordx2 v[94:95], v132, s[8:11], s28 offen offset:1024 sc1
  s_add_u32 s28, s50, s55
  buffer_load_dwordx2 v[96:97], v132, s[8:11], s28 offen offset:0 sc1
  buffer_load_dwordx2 v[98:99], v132, s[8:11], s28 offen offset:1024 sc1
  s_cmp_eq_u32 s21, 0
  s_cbranch_scc1 ka\sfx\()_x_w0
  s_cmp_eq_u32 s21, 1
  s_cbranch_scc1 ka\sfx\()_x_w1
  s_branch ka\sfx\()_x_w23
ka\sfx\()_x_w0:
  v_lshrrev_b32 v4, 3, v1
  v_and_b32 v5, 7, v1
  v_lshrrev_b32 v6, 2, v5
  v_and_b32 v7, 3, v5
  v_lshlrev_b32 v8, 10, v6
  v_lshlrev_b32 v9, 6, v4
  v_add_u32 v8, v8, v9
  v_add_u32 v9, v7, v4
  v_and_b32 v9, 3, v9
  v_lshlrev_b32 v9, 4, v9
  v_add_u32 v8, v8, v9
  v_add_u32 v133, 134144, v8
  v_add_u32 v8, 2, v6
  v_add_u32 v8, v8, v4
  v_and_b32 v8, 3, v8
  v_lshlrev_b32 v8, 4, v8
  v_lshlrev_b32 v9, 6, v4
  v_add_u32 v8, v8, v9
  v_lshlrev_b32 v9, 2, v7
  v_add_u32 v8, v8, v9
  v_add_u32 v134, 133120, v8
  s_and_b32 s26, s23, 7
  v_and_b32 v8, 1, v7
  v_lshlrev_b32 v8, 1, v8
  v_add_u32 v8, v8, v6
  v_lshlrev_b32 v8, 4, v8
  v_add_u32 v8, v8, v4
  v_lshlrev_b32 v8, 4, v8
  v_lshrrev_b32 v9, 1, v7
  v_lshlrev_b32 v9, 3, v9
  v_add_u32 v8, v8, v9
  s_lshr_b32 s28, s26, 1
  s_lshl_b32 s28, s28, 10
  s_and_b32 s29, s26, 1
  s_lshl_b32 s29, s29, 7
  s_add_u32 s28, s28, s29
  v_add_u32 v135, s28, v8
  v_lshlrev_b32 v8, 4, v6
  v_add_u32 v8, v8, v4
  v_lshlrev_b32 v8, 4, v8
  v_lshlrev_b32 v9, 1, v7
  v_add_u32 v8, v8, v9
  s_lshr_b32 s28, s26, 2
  s_lshl_b32 s28, s28, 7
  s_and_b32 s29, s26, 1
  s_lshl_b32 s29, s29, 9
  s_add_u32 s28, s28, s29
  s_bfe_u32 s29, s26, 0x10001
  s_lshl_b32 s29, s29, 3
  s_add_u32 s28, s28, s29
  s_add_u32 s28, s28, 4096
  v_add_u32 v8, s28, v8
  v_mov_b32 v9, 0x40000000
  v_and_b32 v10, 1, v5
  v_cmp_eq_u32 vcc, 0, v10
  s_nop 1
  v_cndmask_b32 v136, v9, v8, vcc
  s_mov_b32 s64, 0x3dd53b95
  s_mov_b32 s65, 0x3dd53b95
  v_mov_b32 v137, 0x42800000
ka\sfx\()_x_w0l:
  ds_read_b128 v[44:47], v129 offset:0
  ds_read_b128 v[48:51], v129 offset:1024
  ds_read_b128 v[52:55], v129 offset:2048
  ds_read_b128 v[56:59], v129 offset:3072
  s_waitcnt lgkmcnt(0)
  s_mov_b32 s45, 0
ka\sfx\()_x_pf_76_pr:
  buffer_load_dword v139, v141, s[8:11], s48 offen sc1
  s_add_u32 s45, s45, 1
  s_waitcnt vmcnt(0)
  v_cmp_eq_u32 vcc, -1, v139
  s_cbranch_vccz ka\sfx\()_x_pf_76
  s_cmp_lt_u32 s45, 400000
  s_cbranch_scc1 ka\sfx\()_x_pf_76_pr
  s_branch ka\sfx\()_abort
ka\sfx\()_x_pf_76:
  buffer_load_dwordx4 v[112:115], v124, s[8:11], s48 offen sc1
  buffer_load_dwordx4 v[116:119], v125, s[8:11], s48 offen sc1
  buffer_load_dwordx4 v[120:123], v126, s[8:11], s48 offen sc1
  s_add_u32 s45, s45, 1
  s_waitcnt vmcnt(2)
  ds_write_b128 v127, v[112:115] offset:0
  v_max3_u32 v139, v112, v113, v114
  v_max_u32 v139, v139, v115
  s_waitcnt vmcnt(1)
  ds_write_b128 v127, v[116:119] offset:4096
  v_max3_u32 v139, v139, v116, v117
  v_max3_u32 v139, v139, v118, v119
  s_waitcnt vmcnt(0)
  ds_write_b128 v127, v[120:123] offset:8192
  v_max3_u32 v139, v139, v120, v121
  v_max3_u32 v139, v139, v122, v123
  v_cmp_eq_u32 vcc, -1, v139
  s_cbranch_vccz ka\sfx\()_x_pf_76_ok
  s_cmp_lt_u32 s45, 400000
  s_cbranch_scc1 ka\sfx\()_x_pf_76
  s_branch ka\sfx\()_abort
ka\sfx\()_x_pf_76_ok:
  v_smfmac_f32_16x16x64_bf16 v[60:63], v[112:115], a[0:7], v110
  v_smfmac_f32_16x16x64_bf16 v[64:67], v[112:115], a[240:247], v110
  v_smfmac_f32_16x16x64_bf16 v[68:71], v[112:115], a[80:87], v110
  v_smfmac_f32_16x16x64_bf16 v[72:75], v[112:115], v[176:183], v110
  s_waitcnt lgkmcnt(0)
  s_barrier
  v_smfmac_f32_16x16x64_bf16 v[36:39], v[112:115], a[160:167], v110
  ds_read_b128 v[4:7], v128 offset:1024
  v_smfmac_f32_16x16x64_bf16 v[40:43], v[112:115], v[216:223], v110
  ds_read_b128 v[8:11], v128 offset:2048
  v_smfmac_f32_16x16x64_bf16 v[60:63], v[116:119], a[32:39], v110
  ds_read_b128 v[12:15], v128 offset:3072
  v_smfmac_f32_16x16x64_bf16 v[64:67], v[116:119], v[152:159], v110
  ds_read_b128 v[16:19], v128 offset:5120
  v_smfmac_f32_16x16x64_bf16 v[68:71], v[116:119], a[112:119], v110
  ds_read_b128 v[20:23], v128 offset:6144
  v_smfmac_f32_16x16x64_bf16 v[72:75], v[116:119], v[192:199], v110
  ds_read_b128 v[24:27], v128 offset:7168
  v_smfmac_f32_16x16x64_bf16 v[36:39], v[116:119], a[192:199], v110
  ds_read_b128 v[28:31], v128 offset:9216
  v_smfmac_f32_16x16x64_bf16 v[40:43], v[116:119], v[232:239], v110
  v_smfmac_f32_16x16x64_bf16 v[60:63], v[120:123], a[64:71], v110
  v_smfmac_f32_16x16x64_bf16 v[64:67], v[120:123], v[168:175], v110
  v_smfmac_f32_16x16x64_bf16 v[68:71], v[120:123], a[144:151], v110
  v_smfmac_f32_16x16x64_bf16 v[72:75], v[120:123], v[208:215], v110
  v_smfmac_f32_16x16x64_bf16 v[36:39], v[120:123], a[224:231], v110
  v_smfmac_f32_16x16x64_bf16 v[40:43], v[120:123], v[248:255], v110
  s_waitcnt lgkmcnt(6)
  v_smfmac_f32_16x16x64_bf16 v[60:63], v[4:7], a[8:15], v110
  v_smfmac_f32_16x16x64_bf16 v[64:67], v[4:7], v[44:51], v110
  ds_read_b128 v[44:47], v129 offset:4096
  s_waitcnt lgkmcnt(6)
  v_smfmac_f32_16x16x64_bf16 v[60:63], v[8:11], a[16:23], v110
  ds_read_b128 v[48:51], v129 offset:5120
  v_smfmac_f32_16x16x64_bf16 v[64:67], v[8:11], a[248:255], v110
  s_waitcnt lgkmcnt(6)
  v_smfmac_f32_16x16x64_bf16 v[60:63], v[12:15], a[24:31], v110
  v_smfmac_f32_16x16x64_bf16 v[64:67], v[12:15], v[52:59], v110
  ds_read_b128 v[52:55], v129 offset:6144
  s_waitcnt lgkmcnt(6)
  v_smfmac_f32_16x16x64_bf16 v[60:63], v[16:19], a[40:47], v110
  ds_read_b128 v[56:59], v129 offset:7168
  s_waitcnt lgkmcnt(2)
  v_smfmac_f32_16x16x64_bf16 v[64:67], v[16:19], v[44:51], v110
  ds_read_b128 v[44:47], v129 offset:8192
  v_smfmac_f32_16x16x64_bf16 v[60:63], v[20:23], a[48:55], v110
  ds_read_b128 v[48:51], v129 offset:9216
  v_smfmac_f32_16x16x64_bf16 v[64:67], v[20:23], v[160:167], v110
  v_smfmac_f32_16x16x64_bf16 v[60:63], v[24:27], a[56:63], v110
  s_waitcnt lgkmcnt(2)
  v_smfmac_f32_16x16x64_bf16 v[64:67], v[24:27], v[52:59], v110
  ds_read_b128 v[52:55], v129 offset:10240
  v_smfmac_f32_16x16x64_bf16 v[60:63], v[28:31], a[72:79], v110
  ds_read_b128 v[56:59], v129 offset:11264
  s_waitcnt lgkmcnt(2)
  v_smfmac_f32_16x16x64_bf16 v[64:67], v[28:31], v[44:51], v110
  ds_read_b128 v[44:47], v129 offset:12288
  v_smfmac_f32_16x16x64_bf16 v[68:71], v[4:7], a[88:95], v110
  ds_read_b128 v[48:51], v129 offset:13312
  s_waitcnt lgkmcnt(2)
  v_smfmac_f32_16x16x64_bf16 v[72:75], v[4:7], v[52:59], v110
  ds_read_b128 v[52:55], v129 offset:14336
  v_permlane32_swap_b32 v60, v64
  v_smfmac_f32_16x16x64_bf16 v[68:71], v[8:11], a[96:103], v110
  ds_read_b128 v[56:59], v129 offset:15360
  v_smfmac_f32_16x16x64_bf16 v[72:75], v[8:11], v[184:191], v110
  v_permlane32_swap_b32 v61, v65
  v_smfmac_f32_16x16x64_bf16 v[68:71], v[12:15], a[104:111], v110
  s_waitcnt lgkmcnt(2)
  v_smfmac_f32_16x16x64_bf16 v[72:75], v[12:15], v[44:51], v110
  ds_read_b128 v[44:47], v129 offset:16384
  v_permlane32_swap_b32 v62, v66
  v_smfmac_f32_16x16x64_bf16 v[68:71], v[16:19], a[120:127], v110
  ds_read_b128 v[48:51], v129 offset:17408
  v_permlane32_swap_b32 v63, v67
  s_waitcnt lgkmcnt(2)
  v_smfmac_f32_16x16x64_bf16 v[72:75], v[16:19], v[52:59], v110
  ds_read_b128 v[52:55], v129 offset:18432
  v_add_f32 v60, v60, v64
  v_smfmac_f32_16x16x64_bf16 v[68:71], v[20:23], a[128:135], v110
  ds_read_b128 v[56:59], v129 offset:19456
  v_add_f32 v61, v61, v65
  v_smfmac_f32_16x16x64_bf16 v[72:75], v[20:23], v[200:207], v110
  v_add_f32 v62, v62, v66
  v_smfmac_f32_16x16x64_bf16 v[68:71], v[24:27], a[136:143], v110
  v_add_f32 v63, v63, v67
  s_waitcnt lgkmcnt(2)
  v_smfmac_f32_16x16x64_bf16 v[72:75], v[24:27], v[44:51], v110
  ds_read_b128 v[44:47], v129 offset:20480
  v_cvt_pk_bf16_f32 v100, v60, v61
  v_smfmac_f32_16x16x64_bf16 v[68:71], v[28:31], a[152:159], v110
  ds_read_b128 v[48:51], v129 offset:21504
  v_cvt_pk_bf16_f32 v101, v62, v63
  s_waitcnt lgkmcnt(2)
  v_smfmac_f32_16x16x64_bf16 v[72:75], v[28:31], v[52:59], v110
  ds_read_b128 v[52:55], v129 offset:22528
  v_smfmac_f32_16x16x64_bf16 v[36:39], v[4:7], a[168:175], v110
  ds_read_b128 v[56:59], v129 offset:23552
  s_waitcnt lgkmcnt(2)
  v_smfmac_f32_16x16x64_bf16 v[40:43], v[4:7], v[44:51], v110
  ds_read_b128 v[44:47], v129 offset:24576
  v_permlane32_swap_b32 v68, v72
  v_smfmac_f32_16x16x64_bf16 v[36:39], v[8:11], a[176:183], v110
  ds_read_b128 v[48:51], v129 offset:25600
  v_smfmac_f32_16x16x64_bf16 v[40:43], v[8:11], v[224:231], v110
  v_permlane32_swap_b32 v69, v73
  v_smfmac_f32_16x16x64_bf16 v[36:39], v[12:15], a[184:191], v110
  s_waitcnt lgkmcnt(2)
  v_smfmac_f32_16x16x64_bf16 v[40:43], v[12:15], v[52:59], v110
  ds_read_b128 v[52:55], v129 offset:26624
  v_permlane32_swap_b32 v70, v74
  v_smfmac_f32_16x16x64_bf16 v[36:39], v[16:19], a[200:207], v110
  ds_read_b128 v[56:59], v129 offset:27648
  v_permlane32_swap_b32 v71, v75
  s_waitcnt lgkmcnt(2)
  v_smfmac_f32_16x16x64_bf16 v[40:43], v[16:19], v[44:51], v110
  ds_read_b128 v[44:47], v129 offset:28672
  v_add_f32 v68, v68, v72
  v_smfmac_f32_16x16x64_bf16 v[36:39], v[20:23], a[208:215], v110
  ds_read_b128 v[48:51], v129 offset:29696
  v_add_f32 v69, v69, v73
  v_smfmac_f32_16x16x64_bf16 v[40:43], v[20:23], v[240:247], v110
  v_add_f32 v70, v70, v74
  v_smfmac_f32_16x16x64_bf16 v[36:39], v[24:27], a[216:223], v110
  v_add_f32 v71, v71, v75
  s_waitcnt lgkmcnt(2)
  v_smfmac_f32_16x16x64_bf16 v[40:43], v[24:27], v[52:59], v110
  v_cvt_pk_bf16_f32 v102, v68, v69
  v_smfmac_f32_16x16x64_bf16 v[36:39], v[28:31], a[232:239], v110
  v_cvt_pk_bf16_f32 v103, v70, v71
  s_waitcnt lgkmcnt(0)
  v_smfmac_f32_16x16x64_bf16 v[40:43], v[28:31], v[44:51], v110
  v_mfma_f32_16x16x16_bf16 v[142:145], v[100:101], v[108:109], 0
  v_mfma_f32_16x16x16_bf16 v[146:149], v[102:103], v[108:109], 0
  s_nop 1
  v_permlane32_swap_b32 v36, v40
  v_permlane32_swap_b32 v37, v41
  v_permlane32_swap_b32 v38, v42
  v_permlane32_swap_b32 v39, v43
  v_add_f32 v36, v36, v40
  v_add_f32 v37, v37, v41
  v_add_f32 v38, v38, v42
  v_add_f32 v39, v39, v43
  v_cvt_pk_bf16_f32 v104, v36, v37
  v_cvt_pk_bf16_f32 v105, v38, v39
  v_cvt_pk_bf16_f32 v44, v142, v143
  v_cvt_pk_bf16_f32 v45, v144, v145
  v_mfma_f32_16x16x16_bf16 v[142:145], v[104:105], v[108:109], 0
  v_cvt_pk_bf16_f32 v46, v146, v147
  v_cvt_pk_bf16_f32 v47, v148, v149
  s_nop 1
  v_mfma_f32_16x16x32_bf16 v[76:79], v[44:47], v[44:47], 0
  v_mfma_f32_16x16x32_bf16 v[80:83], v[88:91], v[44:47], 0
  v_cvt_pk_bf16_f32 v106, v142, v143
  v_cvt_pk_bf16_f32 v107, v144, v145
  v_mfma_f32_16x16x32_bf16 v[84:87], v[92:95], v[44:47], 0
  s_nop 0
  v_mfma_f32_16x16x16_bf16 v[76:79], v[106:107], v[106:107], v[76:79]
  v_mfma_f32_16x16x16_bf16 v[80:83], v[96:97], v[106:107], v[80:83]
  v_mfma_f32_16x16x16_bf16 v[84:87], v[98:99], v[106:107], v[84:87]
  s_mov_b32 exec_lo, 0
  s_mov_b32 exec_hi, 0x00ff00ff
  s_nop 3
  ds_write_b128 v130, v[76:79]
  s_mov_b32 exec_lo, 0x00ff00ff
  ds_write_b128 v130, v[80:83] offset:1024
  s_nop 0
  ds_write_b128 v130, v[84:87] offset:2048
  s_mov_b64 exec, -1
  s_waitcnt lgkmcnt(0)
  s_barrier
  s_cmp_ge_u32 s51, 63
  s_cbranch_scc0 x63_77_\sfx\()
  ds_write_b64 v131, v[44:45]
  ds_write_b64 v131, v[46:47] offset:512
  ds_write_b64 v131, v[106:107] offset:1024
  s_branch ka\sfx\()_x_done
x63_77_\sfx\():
  ds_read_b128 v[4:7], v133 offset:0
  ds_read_b32 v20, v134 offset:0
  ds_read_b128 v[8:11], v133 offset:3072
  ds_read_b32 v21, v134 offset:3072
  ds_read_b128 v[12:15], v133 offset:6144
  ds_read_b32 v22, v134 offset:6144
  ds_read_b128 v[16:19], v133 offset:9216
  ds_read_b32 v23, v134 offset:9216
  s_waitcnt lgkmcnt(4)
  v_pk_add_f32 v[4:5], v[4:5], v[8:9]
  v_pk_add_f32 v[6:7], v[6:7], v[10:11]
  v_add_f32 v20, v20, v21
  s_waitcnt lgkmcnt(0)
  v_pk_add_f32 v[12:13], v[12:13], v[16:17]
  v_pk_add_f32 v[14:15], v[14:15], v[18:19]
  v_add_f32 v22, v22, v23
  v_pk_add_f32 v[4:5], v[4:5], v[12:13]
  v_pk_add_f32 v[6:7], v[6:7], v[14:15]
  v_add_f32 v8, v20, v22
  v_pk_mul_f32 v[4:5], v[4:5], s[64:65]
  v_pk_mul_f32 v[6:7], v[6:7], s[64:65]
  v_mul_f32 v8, s64, v8
  v_max3_f32 v24, abs(v4), abs(v5), abs(v6)
  v_max3_f32 v24, v24, abs(v7), abs(v8)
  v_cmp_nlt_f32 vcc, v24, v137
  s_cbranch_vccz smx_78_go_\sfx\()
  v_max3_f32 v24, v4, v5, v6
  v_max3_f32 v24, v24, v7, v8
  s_nop 1
  v_max_f32_dpp v25, v24, v24 quad_perm:[1,0,3,2] row_mask:0xf bank_mask:0xf
  s_nop 1
  v_max_f32_dpp v24, v25, v25 quad_perm:[2,3,0,1] row_mask:0xf bank_mask:0xf
  s_nop 1
  v_max_f32_dpp v25, v24, v24 row_half_mirror row_mask:0xf bank_mask:0xf
  v_sub_f32 v4, v4, v25
  v_sub_f32 v5, v5, v25
  v_sub_f32 v6, v6, v25
  v_sub_f32 v7, v7, v25
  v_sub_f32 v8, v8, v25
smx_78_go_\sfx\():
  v_exp_f32 v4, v4
  v_exp_f32 v5, v5
  v_exp_f32 v6, v6
  v_exp_f32 v7, v7
  v_exp_f32 v8, v8
  v_add_f32 v24, v4, v5
  v_add_f32 v25, v6, v7
  v_add_f32 v24, v24, v8
  v_add_f32 v24, v24, v25
  s_nop 1
  v_add_f32_dpp v25, v24, v24 quad_perm:[1,0,3,2] row_mask:0xf bank_mask:0xf
  s_nop 1
  v_add_f32_dpp v24, v25, v25 quad_perm:[2,3,0,1] row_mask:0xf bank_mask:0xf
  s_nop 1
  v_add_f32_dpp v25, v24, v24 row_half_mirror row_mask:0xf bank_mask:0xf
  v_rcp_f32 v24, v25
  s_nop 0
  v_mul_f32 v8, v8, v24
  v_pk_mul_f32 v[4:5], v[4:5], v[24:25] op_sel_hi:[1,0]
  v_pk_mul_f32 v[6:7], v[6:7], v[24:25] op_sel_hi:[1,0]
  v_mov_b32_dpp v9, v8 quad_perm:[1,0,3,2] row_mask:0xf bank_mask:0xf
  v_cvt_pk_bf16_f32 v10, v4, v5
  v_cvt_pk_bf16_f32 v11, v6, v7
  buffer_store_dwordx2 v[10:11], v135, s[8:11], s49 offen \pol
  v_cvt_pk_bf16_f32 v12, v8, v9
  buffer_store_dword v12, v136, s[8:11], s49 offen \pol
  ds_write_b64 v131, v[44:45]
  ds_write_b64 v131, v[46:47] offset:512
  ds_write_b64 v131, v[106:107] offset:1024
  s_waitcnt lgkmcnt(0)
  s_barrier
  v_mov_b32 v60, 0
  v_mov_b32 v61, 0
  v_mov_b32 v62, 0
  v_mov_b32 v63, 0
  v_mov_b32 v64, 0
  v_mov_b32 v65, 0
  v_mov_b32 v66, 0
  v_mov_b32 v67, 0
  v_mov_b32 v68, 0
  v_mov_b32 v69, 0
  v_mov_b32 v70, 0
  v_mov_b32 v71, 0
  v_mov_b32 v72, 0
  v_mov_b32 v73, 0
  v_mov_b32 v74, 0
  v_mov_b32 v75, 0
  v_mov_b32 v36, 0
  v_mov_b32 v37, 0
  v_mov_b32 v38, 0
  v_mov_b32 v39, 0
  v_mov_b32 v40, 0
  v_mov_b32 v41, 0
  v_mov_b32 v42, 0
  v_mov_b32 v43, 0
  s_add_u32 s97, s97, 10240
  s_mov_b32 s48, s97
  s_add_u32 s49, s49, 5120
  s_add_u32 s50, s50, 12288
  s_add_u32 s63, s63, 12288
  s_add_u32 s51, s51, 1
  s_cmp_gt_u32 s52, s51
  s_cbranch_scc1 ka\sfx\()_x_wp_79_ok
  s_mov_b32 s45, 0
ka\sfx\()_x_wp_79_spin:
  buffer_load_dword v2, v138, s[8:11], 0 offen sc1
  s_add_u32 s45, s45, 1
  s_waitcnt vmcnt(0)
  v_min_u32_dpp v3, v2, v2 quad_perm:[1,0,3,2] row_mask:0xf bank_mask:0xf
  s_nop 1
  v_min_u32_dpp v2, v3, v3 quad_perm:[2,3,0,1] row_mask:0xf bank_mask:0xf
  s_nop 1
  v_min_u32_dpp v3, v2, v2 row_half_mirror row_mask:0xf bank_mask:0xf
  s_nop 1
  v_min_u32_dpp v2, v3, v3 quad_perm:[0,1,2,3] row_mask:0xf bank_mask:0xf
  s_nop 0
  v_readfirstlane_b32 s52, v2
  s_cmp_gt_u32 s52, s51
  s_cbranch_scc1 ka\sfx\()_x_wp_79_ok
  s_cmp_lt_u32 s45, 400000
  s_cbranch_scc1 ka\sfx\()_x_wp_79_spin
  s_branch ka\sfx\()_abort
ka\sfx\()_x_wp_79_ok:
  s_add_u32 s28, s50, s53
  buffer_load_dwordx2 v[88:89], v132, s[8:11], s28 offen offset:0 sc1
  buffer_load_dwordx2 v[92:93], v132, s[8:11], s28 offen offset:1024 sc1
  s_add_u32 s28, s50, s54
  buffer_load_dwordx2 v[90:91], v132, s[8:11], s28 offen offset:0 sc1
  buffer_load_dwordx2 v[94:95], v132, s[8:11], s28 offen offset:1024 sc1
  s_add_u32 s28, s50, s55
  buffer_load_dwordx2 v[96:97], v132, s[8:11], s28 offen offset:0 sc1
  buffer_load_dwordx2 v[98:99], v132, s[8:11], s28 offen offset:1024 sc1
  s_branch ka\sfx\()_x_w0l
ka\sfx\()_x_w1:
ka\sfx\()_x_w1l:
  ds_read_b128 v[44:47], v129 offset:0
  ds_read_b128 v[48:51], v129 offset:1024
  ds_read_b128 v[52:55], v129 offset:10240
  ds_read_b128 v[56:59], v129 offset:11264
  s_waitcnt lgkmcnt(0)
  s_mov_b32 s45, 0
ka\sfx\()_x_pf_80_pr:
  buffer_load_dword v139, v141, s[8:11], s48 offen sc1
  s_add_u32 s45, s45, 1
  s_waitcnt vmcnt(0)
  v_cmp_eq_u32 vcc, -1, v139
  s_cbranch_vccz ka\sfx\()_x_pf_80
  s_cmp_lt_u32 s45, 400000
  s_cbranch_scc1 ka\sfx\()_x_pf_80_pr
  s_branch ka\sfx\()_abort
ka\sfx\()_x_pf_80:
  buffer_load_dwordx4 v[112:115], v124, s[8:11], s48 offen sc1
  buffer_load_dwordx4 v[116:119], v125, s[8:11], s48 offen sc1
  buffer_load_dwordx4 v[120:123], v126, s[8:11], s48 offen sc1
  s_add_u32 s45, s45, 1
  s_waitcnt vmcnt(2)
  ds_write_b128 v127, v[112:115] offset:0
  v_max3_u32 v139, v112, v113, v114
  v_max_u32 v139, v139, v115
  s_waitcnt vmcnt(1)
  ds_write_b128 v127, v[116:119] offset:4096
  v_max3_u32 v139, v139, v116, v117
  v_max3_u32 v139, v139, v118, v119
  s_waitcnt vmcnt(0)
  ds_write_b128 v127, v[120:123] offset:8192
  v_max3_u32 v139, v139, v120, v121
  v_max3_u32 v139, v139, v122, v123
  v_cmp_eq_u32 vcc, -1, v139
  s_cbranch_vccz ka\sfx\()_x_pf_80_ok
  s_cmp_lt_u32 s45, 400000
  s_cbranch_scc1 ka\sfx\()_x_pf_80
  s_branch ka\sfx\()_abort
ka\sfx\()_x_pf_80_ok:
  v_smfmac_f32_16x16x64_bf16 v[60:63], v[112:115], a[8:15], v110
  v_smfmac_f32_16x16x64_bf16 v[64:67], v[112:115], v[44:51], v110
  ds_read_b128 v[44:47], v129 offset:20480
  v_smfmac_f32_16x16x64_bf16 v[68:71], v[112:115], a[88:95], v110
  ds_read_b128 v[48:51], v129 offset:21504
  v_smfmac_f32_16x16x64_bf16 v[72:75], v[112:115], v[52:59], v110
  ds_read_b128 v[52:55], v129 offset:4096
  s_waitcnt lgkmcnt(3)
  s_barrier
  v_smfmac_f32_16x16x64_bf16 v[36:39], v[112:115], a[168:175], v110
  ds_read_b128 v[56:59], v129 offset:5120
  ds_read_b128 v[4:7], v128 offset:0
  s_waitcnt lgkmcnt(3)
  v_smfmac_f32_16x16x64_bf16 v[40:43], v[112:115], v[44:51], v110
  ds_read_b128 v[44:47], v129 offset:14336
  ds_read_b128 v[8:11], v128 offset:2048
  v_smfmac_f32_16x16x64_bf16 v[60:63], v[116:119], a[40:47], v110
  ds_read_b128 v[48:51], v129 offset:15360
  ds_read_b128 v[12:15], v128 offset:3072
  s_waitcnt lgkmcnt(5)
  v_smfmac_f32_16x16x64_bf16 v[64:67], v[116:119], v[52:59], v110
  ds_read_b128 v[52:55], v129 offset:24576
  ds_read_b128 v[16:19], v128 offset:4096
  v_smfmac_f32_16x16x64_bf16 v[68:71], v[116:119], a[120:127], v110
  ds_read_b128 v[56:59], v129 offset:25600
  ds_read_b128 v[20:23], v128 offset:6144
  s_waitcnt lgkmcnt(5)
  v_smfmac_f32_16x16x64_bf16 v[72:75], v[116:119], v[44:51], v110
  ds_read_b128 v[44:47], v129 offset:8192
  ds_read_b128 v[24:27], v128 offset:7168
  v_smfmac_f32_16x16x64_bf16 v[36:39], v[116:119], a[200:207], v110
  ds_read_b128 v[48:51], v129 offset:9216
  ds_read_b128 v[28:31], v128 offset:8192
  s_waitcnt lgkmcnt(5)
  v_smfmac_f32_16x16x64_bf16 v[40:43], v[116:119], v[52:59], v110
  ds_read_b128 v[52:55], v129 offset:18432
  v_smfmac_f32_16x16x64_bf16 v[60:63], v[120:123], a[72:79], v110
  ds_read_b128 v[56:59], v129 offset:19456
  s_waitcnt lgkmcnt(3)
  v_smfmac_f32_16x16x64_bf16 v[64:67], v[120:123], v[44:51], v110
  ds_read_b128 v[44:47], v129 offset:28672
  v_smfmac_f32_16x16x64_bf16 v[68:71], v[120:123], a[152:159], v110
  ds_read_b128 v[48:51], v129 offset:29696
  s_waitcnt lgkmcnt(2)
  v_smfmac_f32_16x16x64_bf16 v[72:75], v[120:123], v[52:59], v110
  ds_read_b128 v[52:55], v129 offset:2048
  v_smfmac_f32_16x16x64_bf16 v[36:39], v[120:123], a[232:239], v110
  ds_read_b128 v[56:59], v129 offset:3072
  s_waitcnt lgkmcnt(2)
  v_smfmac_f32_16x16x64_bf16 v[40:43], v[120:123], v[44:51], v110
  ds_read_b128 v[44:47], v129 offset:6144
  v_smfmac_f32_16x16x64_bf16 v[60:63], v[4:7], a[0:7], v110
  ds_read_b128 v[48:51], v129 offset:7168
  v_smfmac_f32_16x16x64_bf16 v[64:67], v[4:7], a[240:247], v110
  v_smfmac_f32_16x16x64_bf16 v[60:63], v[8:11], a[16:23], v110
  v_smfmac_f32_16x16x64_bf16 v[64:67], v[8:11], a[248:255], v110
  v_smfmac_f32_16x16x64_bf16 v[60:63], v[12:15], a[24:31], v110
  s_waitcnt lgkmcnt(2)
  v_smfmac_f32_16x16x64_bf16 v[64:67], v[12:15], v[52:59], v110
  ds_read_b128 v[52:55], v129 offset:12288
  v_smfmac_f32_16x16x64_bf16 v[60:63], v[16:19], a[32:39], v110
  ds_read_b128 v[56:59], v129 offset:13312
  v_smfmac_f32_16x16x64_bf16 v[64:67], v[16:19], v[152:159], v110
  v_smfmac_f32_16x16x64_bf16 v[60:63], v[20:23], a[48:55], v110
  v_smfmac_f32_16x16x64_bf16 v[64:67], v[20:23], v[160:167], v110
  v_smfmac_f32_16x16x64_bf16 v[60:63], v[24:27], a[56:63], v110
  s_waitcnt lgkmcnt(2)
  v_smfmac_f32_16x16x64_bf16 v[64:67], v[24:27], v[44:51], v110
  ds_read_b128 v[44:47], v129 offset:16384
  v_smfmac_f32_16x16x64_bf16 v[60:63], v[28:31], a[64:71], v110
  ds_read_b128 v[48:51], v129 offset:17408
  v_smfmac_f32_16x16x64_bf16 v[64:67], v[28:31], v[168:175], v110
  v_smfmac_f32_16x16x64_bf16 v[68:71], v[4:7], a[80:87], v110
  v_smfmac_f32_16x16x64_bf16 v[72:75], v[4:7], v[176:183], v110
  v_permlane32_swap_b32 v60, v64
  v_smfmac_f32_16x16x64_bf16 v[68:71], v[8:11], a[96:103], v110
  v_smfmac_f32_16x16x64_bf16 v[72:75], v[8:11], v[184:191], v110
  v_permlane32_swap_b32 v61, v65
  v_smfmac_f32_16x16x64_bf16 v[68:71], v[12:15], a[104:111], v110
  s_waitcnt lgkmcnt(2)
  v_smfmac_f32_16x16x64_bf16 v[72:75], v[12:15], v[52:59], v110
  ds_read_b128 v[52:55], v129 offset:22528
  v_permlane32_swap_b32 v62, v66
  v_smfmac_f32_16x16x64_bf16 v[68:71], v[16:19], a[112:119], v110
  ds_read_b128 v[56:59], v129 offset:23552
  v_permlane32_swap_b32 v63, v67
  v_smfmac_f32_16x16x64_bf16 v[72:75], v[16:19], v[192:199], v110
  v_add_f32 v60, v60, v64
  v_smfmac_f32_16x16x64_bf16 v[68:71], v[20:23], a[128:135], v110
  v_add_f32 v61, v61, v65
  v_smfmac_f32_16x16x64_bf16 v[72:75], v[20:23], v[200:207], v110
  v_add_f32 v62, v62, v66
  v_smfmac_f32_16x16x64_bf16 v[68:71], v[24:27], a[136:143], v110
  v_add_f32 v63, v63, v67
  s_waitcnt lgkmcnt(2)
  v_smfmac_f32_16x16x64_bf16 v[72:75], v[24:27], v[44:51], v110
  ds_read_b128 v[44:47], v129 offset:26624
  v_cvt_pk_bf16_f32 v100, v60, v61
  v_smfmac_f32_16x16x64_bf16 v[68:71], v[28:31], a[144:151], v110
  ds_read_b128 v[48:51], v129 offset:27648
  v_cvt_pk_bf16_f32 v101, v62, v63
  v_smfmac_f32_16x16x64_bf16 v[72:75], v[28:31], v[208:215], v110
  v_smfmac_f32_16x16x64_bf16 v[36:39], v[4:7], a[160:167], v110
  v_smfmac_f32_16x16x64_bf16 v[40:43], v[4:7], v[216:223], v110
  v_permlane32_swap_b32 v68, v72
  v_smfmac_f32_16x16x64_bf16 v[36:39], v[8:11], a[176:183], v110
  v_smfmac_f32_16x16x64_bf16 v[40:43], v[8:11], v[224:231], v110
  v_permlane32_swap_b32 v69, v73
  v_smfmac_f32_16x16x64_bf16 v[36:39], v[12:15], a[184:191], v110
  s_waitcnt lgkmcnt(2)
  v_smfmac_f32_16x16x64_bf16 v[40:43], v[12:15], v[52:59], v110
  v_permlane32_swap_b32 v70, v74
  v_smfmac_f32_16x16x64_bf16 v[36:39], v[16:19], a[192:199], v110
  v_permlane32_swap_b32 v71, v75
  v_smfmac_f32_16x16x64_bf16 v[40:43], v[16:19], v[232:239], v110
  v_add_f32 v68, v68, v72
  v_smfmac_f32_16x16x64_bf16 v[36:39], v[20:23], a[208:215], v110
  v_add_f32 v69, v69, v73
  v_smfmac_f32_16x16x64_bf16 v[40:43], v[20:23], v[240:247], v110
  v_add_f32 v70, v70, v74
  v_smfmac_f32_16x16x64_bf16 v[36:39], v[24:27], a[216:223], v110
  v_add_f32 v71, v71, v75
  s_waitcnt lgkmcnt(0)
  v_smfmac_f32_16x16x64_bf16 v[40:43], v[24:27], v[44:51], v110
  v_cvt_pk_bf16_f32 v102, v68, v69
  v_smfmac_f32_16x16x64_bf16 v[36:39], v[28:31], a[224:231], v110
  v_cvt_pk_bf16_f32 v103, v70, v71
  v_smfmac_f32_16x16x64_bf16 v[40:43], v[28:31], v[248:255], v110
  v_mfma_f32_16x16x16_bf16 v[142:145], v[100:101], v[108:109], 0
  v_mfma_f32_16x16x16_bf16 v[146:149], v[102:103], v[108:109], 0
  s_nop 1
  v_permlane32_swap_b32 v36, v40
  v_permlane32_swap_b32 v37, v41
  v_permlane32_swap_b32 v38, v42
  v_permlane32_swap_b32 v39, v43
  v_add_f32 v36, v36, v40
  v_add_f32 v37, v37, v41
  v_add_f32 v38, v38, v42
  v_add_f32 v39, v39, v43
  v_cvt_pk_bf16_f32 v104, v36, v37
  v_cvt_pk_bf16_f32 v105, v38, v39
  v_cvt_pk_bf16_f32 v44, v142, v143
  v_cvt_pk_bf16_f32 v45, v144, v145
  v_mfma_f32_16x16x16_bf16 v[142:145], v[104:105], v[108:109], 0
  v_cvt_pk_bf16_f32 v46, v146, v147
  v_cvt_pk_bf16_f32 v47, v148, v149
  s_nop 1
  v_mfma_f32_16x16x32_bf16 v[76:79], v[44:47], v[44:47], 0
  v_mfma_f32_16x16x32_bf16 v[80:83], v[88:91], v[44:47], 0
  v_cvt_pk_bf16_f32 v106, v142, v143
  v_cvt_pk_bf16_f32 v107, v144, v145
  v_mfma_f32_16x16x32_bf16 v[84:87], v[92:95], v[44:47], 0
  s_nop 0
  v_mfma_f32_16x16x16_bf16 v[76:79], v[106:107], v[106:107], v[76:79]
  v_mfma_f32_16x16x16_bf16 v[80:83], v[96:97], v[106:107], v[80:83]
  v_mfma_f32_16x16x16_bf16 v[84:87], v[98:99], v[106:107], v[84:87]
  s_mov_b32 exec_lo, 0
  s_mov_b32 exec_hi, 0x00ff00ff
  s_nop 3
  ds_write_b128 v130, v[76:79]
  s_mov_b32 exec_lo, 0x00ff00ff
  ds_write_b128 v130, v[80:83] offset:1024
  s_nop 0
  ds_write_b128 v130, v[84:87] offset:2048
  s_mov_b64 exec, -1
  s_waitcnt lgkmcnt(0)
  s_barrier
  ds_write_b64 v131, v[44:45]
  ds_write_b64 v131, v[46:47] offset:512
  ds_write_b64 v131, v[106:107] offset:1024
  s_waitcnt lgkmcnt(0)
  s_cmp_ge_u32 s51, 63
  s_cbranch_scc1 ka\sfx\()_x_done
  s_barrier
  v_mov_b32 v60, 0
  v_mov_b32 v61, 0
  v_mov_b32 v62, 0
  v_mov_b32 v63, 0
  v_mov_b32 v64, 0
  v_mov_b32 v65, 0
  v_mov_b32 v66, 0
  v_mov_b32 v67, 0
  v_mov_b32 v68, 0
  v_mov_b32 v69, 0
  v_mov_b32 v70, 0
  v_mov_b32 v71, 0
  v_mov_b32 v72, 0
  v_mov_b32 v73, 0
  v_mov_b32 v74, 0
  v_mov_b32 v75, 0
  v_mov_b32 v36, 0
  v_mov_b32 v37, 0
  v_mov_b32 v38, 0
  v_mov_b32 v39, 0
  v_mov_b32 v40, 0
  v_mov_b32 v41, 0
  v_mov_b32 v42, 0
  v_mov_b32 v43, 0
  s_add_u32 s97, s97, 10240
  s_mov_b32 s48, s97
  s_add_u32 s49, s49, 5120
  s_add_u32 s50, s50, 12288
  s_add_u32 s63, s63, 12288
  s_add_u32 s51, s51, 1
  s_cmp_gt_u32 s52, s51
  s_cbranch_scc1 ka\sfx\()_x_wp_81_ok
  s_mov_b32 s45, 0
ka\sfx\()_x_wp_81_spin:
  buffer_load_dword v2, v138, s[8:11], 0 offen sc1
  s_add_u32 s45, s45, 1
  s_waitcnt vmcnt(0)
  v_min_u32_dpp v3, v2, v2 quad_perm:[1,0,3,2] row_mask:0xf bank_mask:0xf
  s_nop 1
  v_min_u32_dpp v2, v3, v3 quad_perm:[2,3,0,1] row_mask:0xf bank_mask:0xf
  s_nop 1
  v_min_u32_dpp v3, v2, v2 row_half_mirror row_mask:0xf bank_mask:0xf
  s_nop 1
  v_min_u32_dpp v2, v3, v3 quad_perm:[0,1,2,3] row_mask:0xf bank_mask:0xf
  s_nop 0
  v_readfirstlane_b32 s52, v2
  s_cmp_gt_u32 s52, s51
  s_cbranch_scc1 ka\sfx\()_x_wp_81_ok
  s_cmp_lt_u32 s45, 400000
  s_cbranch_scc1 ka\sfx\()_x_wp_81_spin
  s_branch ka\sfx\()_abort
ka\sfx\()_x_wp_81_ok:
  s_add_u32 s28, s50, s53
  buffer_load_dwordx2 v[88:89], v132, s[8:11], s28 offen offset:0 sc1
  buffer_load_dwordx2 v[92:93], v132, s[8:11], s28 offen offset:1024 sc1
  s_add_u32 s28, s50, s54
  buffer_load_dwordx2 v[90:91], v132, s[8:11], s28 offen offset:0 sc1
  buffer_load_dwordx2 v[94:95], v132, s[8:11], s28 offen offset:1024 sc1
  s_add_u32 s28, s50, s55
  buffer_load_dwordx2 v[96:97], v132, s[8:11], s28 offen offset:0 sc1
  buffer_load_dwordx2 v[98:99], v132, s[8:11], s28 offen offset:1024 sc1
  s_branch ka\sfx\()_x_w1l
ka\sfx\()_x_w23:
  s_sub_u32 s65, s21, 2
  s_and_b32 s26, s23, 7
  v_and_b32 v4, 15, v1
  v_lshrrev_b32 v5, 4, v1
  v_and_b32 v6, 1, v5
  v_lshlrev_b32 v6, 5, v6
  v_add_u32 v6, v6, v4
  v_lshlrev_b32 v6, 4, v6
  v_lshrrev_b32 v7, 1, v5
  v_lshlrev_b32 v7, 3, v7
  v_add_u32 v6, v6, v7
  s_lshl_b32 s28, s26, 1
  s_add_u32 s28, s28, s65
  s_lshl_b32 s28, s28, 10
  v_add_u32 v133, s28, v6
  s_lshr_b32 s28, s26, 2
  s_lshl_b32 s28, s28, 1
  s_add_u32 s28, s28, s65
  s_lshl_b32 s28, s28, 10
  s_and_b32 s29, s26, 1
  s_lshl_b32 s29, s29, 9
  s_add_u32 s28, s28, s29
  s_bfe_u32 s29, s26, 0x10001
  s_lshl_b32 s29, s29, 3
  s_add_u32 s28, s28, s29
  s_add_u32 s28, s28, 15872
  v_lshlrev_b32 v6, 4, v5
  v_add_u32 v6, v6, v4
  v_lshlrev_b32 v6, 4, v6
  v_add_u32 v6, s28, v6
  v_mov_b32 v7, 0x40000000
  v_cmp_le_u32 vcc, 2, v5
  s_nop 1
  v_cndmask_b32 v134, v7, v6, vcc
  v_mov_b32 v135, 0xf149f2ca
  v_lshlrev_b32 v6, 3, v1
  v_add_u32 v136, 145408, v6
  s_mul_i32 s94, s65, 6144
  s_add_u32 s94, s94, 151552
  v_add_u32 v137, s94, v132
  v_cmp_le_u32 s[66:67], 2, v5
  v_lshlrev_b32 v6, 2, v5
  v_sub_u32 v6, v4, v6
  v_cmp_le_i32 s[68:69], 0, v6
  v_cmp_le_i32 s[70:71], 1, v6
  v_cmp_le_i32 s[72:73], 2, v6
  v_cmp_le_i32 s[74:75], 3, v6
  s_nop 1
  s_cmp_eq_u32 s65, 0
  s_cselect_b64 s[76:77], s[68:69], -1
  s_cselect_b64 s[84:85], 0, s[68:69]
  s_cselect_b64 s[78:79], s[70:71], -1
  s_cselect_b64 s[86:87], 0, s[70:71]
  s_cselect_b64 s[80:81], s[72:73], -1
  s_cselect_b64 s[88:89], 0, s[72:73]
  s_cselect_b64 s[82:83], s[74:75], -1
  s_cselect_b64 s[90:91], 0, s[74:75]
  s_mul_i32 s92, s20, 1310720
  s_add_u32 s92, s92, 0xe00000
  s_lshl_b32 s93, s65, 10
  s_mov_b32 s64, 0x3dd53b95
  s_add_u32 s95, s63, s93
  s_add_u32 m0, s94, 0
  s_add_u32 s28, s95, 0
  buffer_load_dwordx4 v132, s[8:11], s28 offen sc1 lds
  s_add_u32 m0, s94, 1024
  s_add_u32 s28, s95, 2048
  buffer_load_dwordx4 v132, s[8:11], s28 offen sc1 lds
  s_add_u32 m0, s94, 2048
  s_add_u32 s28, s95, 4096
  buffer_load_dwordx4 v132, s[8:11], s28 offen sc1 lds
  s_add_u32 m0, s94, 3072
  s_add_u32 s28, s95, 6144
  buffer_load_dwordx4 v132, s[8:11], s28 offen sc1 lds
  s_add_u32 m0, s94, 4096
  s_add_u32 s28, s95, 8192
  buffer_load_dwordx4 v132, s[8:11], s28 offen sc1 lds
  s_add_u32 m0, s94, 5120
  s_add_u32 s28, s95, 10240
  buffer_load_dwordx4 v132, s[8:11], s28 offen sc1 lds
  s_cmp_eq_u32 s21, 3
  s_cbranch_scc1 ka\sfx\()_x_w3l
ka\sfx\()_x_w2l:
  ds_read_b128 v[44:47], v129 offset:0
  ds_read_b128 v[48:51], v129 offset:1024
  ds_read_b128 v[52:55], v129 offset:2048
  ds_read_b128 v[56:59], v129 offset:3072
  s_waitcnt lgkmcnt(0)
  s_mov_b32 s45, 0
ka\sfx\()_x_pf_82_pr:
  buffer_load_dword v139, v141, s[8:11], s48 offen sc1
  s_add_u32 s45, s45, 1
  s_waitcnt vmcnt(0)
  v_cmp_eq_u32 vcc, -1, v139
  s_cbranch_vccz ka\sfx\()_x_pf_82
  s_cmp_lt_u32 s45, 400000
  s_cbranch_scc1 ka\sfx\()_x_pf_82_pr
  s_branch ka\sfx\()_abort
ka\sfx\()_x_pf_82:
  buffer_load_dwordx4 v[112:115], v124, s[8:11], s48 offen sc1
  buffer_load_dwordx4 v[116:119], v125, s[8:11], s48 offen sc1
  s_add_u32 s45, s45, 1
  s_waitcnt vmcnt(1)
  ds_write_b128 v127, v[112:115] offset:0
  v_max3_u32 v139, v112, v113, v114
  v_max_u32 v139, v139, v115
  s_waitcnt vmcnt(0)
  ds_write_b128 v127, v[116:119] offset:4096
  v_max3_u32 v139, v139, v116, v117
  v_max3_u32 v139, v139, v118, v119
  v_cmp_eq_u32 vcc, -1, v139
  s_cbranch_vccz ka\sfx\()_x_pf_82_ok
  s_cmp_lt_u32 s45, 400000
  s_cbranch_scc1 ka\sfx\()_x_pf_82
  s_branch ka\sfx\()_abort
ka\sfx\()_x_pf_82_ok:
  v_smfmac_f32_16x16x64_bf16 v[60:63], v[112:115], a[16:23], v110
  v_smfmac_f32_16x16x64_bf16 v[64:67], v[112:115], a[248:255], v110
  v_smfmac_f32_16x16x64_bf16 v[68:71], v[112:115], a[96:103], v110
  v_smfmac_f32_16x16x64_bf16 v[72:75], v[112:115], v[184:191], v110
  s_waitcnt lgkmcnt(0)
  s_barrier
  v_smfmac_f32_16x16x64_bf16 v[36:39], v[112:115], a[176:183], v110
  ds_read_b128 v[4:7], v128 offset:0
  v_smfmac_f32_16x16x64_bf16 v[40:43], v[112:115], v[224:231], v110
  ds_read_b128 v[8:11], v128 offset:1024
  v_smfmac_f32_16x16x64_bf16 v[60:63], v[116:119], a[48:55], v110
  ds_read_b128 v[12:15], v128 offset:3072
  v_smfmac_f32_16x16x64_bf16 v[64:67], v[116:119], v[160:167], v110
  ds_read_b128 v[16:19], v128 offset:4096
  v_smfmac_f32_16x16x64_bf16 v[68:71], v[116:119], a[128:135], v110
  ds_read_b128 v[20:23], v128 offset:5120
  v_smfmac_f32_16x16x64_bf16 v[72:75], v[116:119], v[200:207], v110
  ds_read_b128 v[24:27], v128 offset:7168
  v_smfmac_f32_16x16x64_bf16 v[36:39], v[116:119], a[208:215], v110
  ds_read_b128 v[28:31], v128 offset:8192
  v_smfmac_f32_16x16x64_bf16 v[40:43], v[116:119], v[240:247], v110
  ds_read_b128 v[32:35], v128 offset:9216
  s_waitcnt lgkmcnt(7)
  v_smfmac_f32_16x16x64_bf16 v[60:63], v[4:7], a[0:7], v110
  v_smfmac_f32_16x16x64_bf16 v[64:67], v[4:7], a[240:247], v110
  s_waitcnt lgkmcnt(6)
  v_smfmac_f32_16x16x64_bf16 v[60:63], v[8:11], a[8:15], v110
  v_smfmac_f32_16x16x64_bf16 v[64:67], v[8:11], v[44:51], v110
  ds_read_b128 v[44:47], v129 offset:4096
  s_waitcnt lgkmcnt(6)
  v_smfmac_f32_16x16x64_bf16 v[60:63], v[12:15], a[24:31], v110
  ds_read_b128 v[48:51], v129 offset:5120
  v_smfmac_f32_16x16x64_bf16 v[64:67], v[12:15], v[52:59], v110
  ds_read_b128 v[52:55], v129 offset:6144
  s_waitcnt lgkmcnt(7)
  v_smfmac_f32_16x16x64_bf16 v[60:63], v[16:19], a[32:39], v110
  ds_read_b128 v[56:59], v129 offset:7168
  v_smfmac_f32_16x16x64_bf16 v[64:67], v[16:19], v[152:159], v110
  s_waitcnt lgkmcnt(7)
  v_smfmac_f32_16x16x64_bf16 v[60:63], v[20:23], a[40:47], v110
  s_waitcnt lgkmcnt(2)
  v_smfmac_f32_16x16x64_bf16 v[64:67], v[20:23], v[44:51], v110
  ds_read_b128 v[44:47], v129 offset:8192
  v_smfmac_f32_16x16x64_bf16 v[60:63], v[24:27], a[56:63], v110
  ds_read_b128 v[48:51], v129 offset:9216
  s_waitcnt lgkmcnt(2)
  v_smfmac_f32_16x16x64_bf16 v[64:67], v[24:27], v[52:59], v110
  ds_read_b128 v[52:55], v129 offset:10240
  v_smfmac_f32_16x16x64_bf16 v[60:63], v[28:31], a[64:71], v110
  ds_read_b128 v[56:59], v129 offset:11264
  v_smfmac_f32_16x16x64_bf16 v[64:67], v[28:31], v[168:175], v110
  v_smfmac_f32_16x16x64_bf16 v[60:63], v[32:35], a[72:79], v110
  s_waitcnt lgkmcnt(2)
  v_smfmac_f32_16x16x64_bf16 v[64:67], v[32:35], v[44:51], v110
  ds_read_b128 v[44:47], v129 offset:12288
  v_smfmac_f32_16x16x64_bf16 v[68:71], v[4:7], a[80:87], v110
  ds_read_b128 v[48:51], v129 offset:13312
  v_smfmac_f32_16x16x64_bf16 v[72:75], v[4:7], v[176:183], v110
  v_permlane32_swap_b32 v60, v64
  v_smfmac_f32_16x16x64_bf16 v[68:71], v[8:11], a[88:95], v110
  s_waitcnt lgkmcnt(2)
  v_smfmac_f32_16x16x64_bf16 v[72:75], v[8:11], v[52:59], v110
  ds_read_b128 v[52:55], v129 offset:14336
  v_permlane32_swap_b32 v61, v65
  v_smfmac_f32_16x16x64_bf16 v[68:71], v[12:15], a[104:111], v110
  ds_read_b128 v[56:59], v129 offset:15360
  s_waitcnt lgkmcnt(2)
  v_smfmac_f32_16x16x64_bf16 v[72:75], v[12:15], v[44:51], v110
  ds_read_b128 v[44:47], v129 offset:16384
  v_permlane32_swap_b32 v62, v66
  v_smfmac_f32_16x16x64_bf16 v[68:71], v[16:19], a[112:119], v110
  ds_read_b128 v[48:51], v129 offset:17408
  v_permlane32_swap_b32 v63, v67
  v_smfmac_f32_16x16x64_bf16 v[72:75], v[16:19], v[192:199], v110
  v_add_f32 v60, v60, v64
  v_smfmac_f32_16x16x64_bf16 v[68:71], v[20:23], a[120:127], v110
  v_add_f32 v61, v61, v65
  s_waitcnt lgkmcnt(2)
  v_smfmac_f32_16x16x64_bf16 v[72:75], v[20:23], v[52:59], v110
  ds_read_b128 v[52:55], v129 offset:18432
  v_add_f32 v62, v62, v66
  v_smfmac_f32_16x16x64_bf16 v[68:71], v[24:27], a[136:143], v110
  ds_read_b128 v[56:59], v129 offset:19456
  v_add_f32 v63, v63, v67
  s_waitcnt lgkmcnt(2)
  v_smfmac_f32_16x16x64_bf16 v[72:75], v[24:27], v[44:51], v110
  ds_read_b128 v[44:47], v129 offset:20480
  v_cvt_pk_bf16_f32 v100, v60, v61
  v_smfmac_f32_16x16x64_bf16 v[68:71], v[28:31], a[144:151], v110
  ds_read_b128 v[48:51], v129 offset:21504
  v_cvt_pk_bf16_f32 v101, v62, v63
  v_smfmac_f32_16x16x64_bf16 v[72:75], v[28:31], v[208:215], v110
  v_smfmac_f32_16x16x64_bf16 v[68:71], v[32:35], a[152:159], v110
  s_waitcnt lgkmcnt(2)
  v_smfmac_f32_16x16x64_bf16 v[72:75], v[32:35], v[52:59], v110
  ds_read_b128 v[52:55], v129 offset:22528
  v_smfmac_f32_16x16x64_bf16 v[36:39], v[4:7], a[160:167], v110
  ds_read_b128 v[56:59], v129 offset:23552
  v_smfmac_f32_16x16x64_bf16 v[40:43], v[4:7], v[216:223], v110
  v_permlane32_swap_b32 v68, v72
  v_smfmac_f32_16x16x64_bf16 v[36:39], v[8:11], a[168:175], v110
  s_waitcnt lgkmcnt(2)
  v_smfmac_f32_16x16x64_bf16 v[40:43], v[8:11], v[44:51], v110
  ds_read_b128 v[44:47], v129 offset:24576
  v_permlane32_swap_b32 v69, v73
  v_smfmac_f32_16x16x64_bf16 v[36:39], v[12:15], a[184:191], v110
  ds_read_b128 v[48:51], v129 offset:25600
  s_waitcnt lgkmcnt(2)
  v_smfmac_f32_16x16x64_bf16 v[40:43], v[12:15], v[52:59], v110
  ds_read_b128 v[52:55], v129 offset:26624
  v_permlane32_swap_b32 v70, v74
  v_smfmac_f32_16x16x64_bf16 v[36:39], v[16:19], a[192:199], v110
  ds_read_b128 v[56:59], v129 offset:27648
  v_permlane32_swap_b32 v71, v75
  v_smfmac_f32_16x16x64_bf16 v[40:43], v[16:19], v[232:239], v110
  v_add_f32 v68, v68, v72
  v_smfmac_f32_16x16x64_bf16 v[36:39], v[20:23], a[200:207], v110
  v_add_f32 v69, v69, v73
  s_waitcnt lgkmcnt(2)
  v_smfmac_f32_16x16x64_bf16 v[40:43], v[20:23], v[44:51], v110
  ds_read_b128 v[44:47], v129 offset:28672
  v_add_f32 v70, v70, v74
  v_smfmac_f32_16x16x64_bf16 v[36:39], v[24:27], a[216:223], v110
  ds_read_b128 v[48:51], v129 offset:29696
  v_add_f32 v71, v71, v75
  s_waitcnt lgkmcnt(2)
  v_smfmac_f32_16x16x64_bf16 v[40:43], v[24:27], v[52:59], v110
  v_cvt_pk_bf16_f32 v102, v68, v69
  v_smfmac_f32_16x16x64_bf16 v[36:39], v[28:31], a[224:231], v110
  v_cvt_pk_bf16_f32 v103, v70, v71
  v_smfmac_f32_16x16x64_bf16 v[40:43], v[28:31], v[248:255], v110
  v_smfmac_f32_16x16x64_bf16 v[36:39], v[32:35], a[232:239], v110
  s_waitcnt lgkmcnt(0)
  v_smfmac_f32_16x16x64_bf16 v[40:43], v[32:35], v[44:51], v110
  v_mfma_f32_16x16x16_bf16 v[142:145], v[100:101], v[108:109], 0
  v_mfma_f32_16x16x16_bf16 v[146:149], v[102:103], v[108:109], 0
  s_nop 1
  v_permlane32_swap_b32 v36, v40
  v_permlane32_swap_b32 v37, v41
  v_permlane32_swap_b32 v38, v42
  v_permlane32_swap_b32 v39, v43
  v_add_f32 v36, v36, v40
  v_add_f32 v37, v37, v41
  v_add_f32 v38, v38, v42
  v_add_f32 v39, v39, v43
  v_cvt_pk_bf16_f32 v104, v36, v37
  v_cvt_pk_bf16_f32 v105, v38, v39
  v_cvt_pk_bf16_f32 v44, v142, v143
  v_cvt_pk_bf16_f32 v45, v144, v145
  v_mfma_f32_16x16x16_bf16 v[142:145], v[104:105], v[108:109], 0
  v_cvt_pk_bf16_f32 v46, v146, v147
  v_cvt_pk_bf16_f32 v47, v148, v149
  s_nop 1
  v_mfma_f32_16x16x32_bf16 v[76:79], v[44:47], v[44:47], 0
  v_mfma_f32_16x16x32_bf16 v[80:83], v[88:91], v[44:47], 0
  v_cvt_pk_bf16_f32 v106, v142, v143
  v_cvt_pk_bf16_f32 v107, v144, v145
  v_mfma_f32_16x16x32_bf16 v[84:87], v[92:95], v[44:47], 0
  s_nop 0
  v_mfma_f32_16x16x16_bf16 v[76:79], v[106:107], v[106:107], v[76:79]
  v_mfma_f32_16x16x16_bf16 v[80:83], v[96:97], v[106:107], v[80:83]
  v_mfma_f32_16x16x16_bf16 v[84:87], v[98:99], v[106:107], v[84:87]
  s_mov_b32 exec_lo, 0
  s_mov_b32 exec_hi, 0x00ff00ff
  s_nop 3
  ds_write_b128 v130, v[76:79]
  s_mov_b32 exec_lo, 0x00ff00ff
  ds_write_b128 v130, v[80:83] offset:1024
  s_nop 0
  ds_write_b128 v130, v[84:87] offset:2048
  s_mov_b64 exec, -1
  s_waitcnt lgkmcnt(0)
  s_barrier
  ds_write_b64 v131, v[44:45]
  ds_write_b64 v131, v[46:47] offset:512
  ds_write_b64 v131, v[106:107] offset:1024
  ds_read_b128 v[44:47], v137 offset:0
  ds_read_b128 v[48:51], v137 offset:1024
  ds_read_b128 v[52:55], v137 offset:2048
  ds_read_b128 v[56:59], v137 offset:3072
  ds_read_b128 v[68:71], v137 offset:4096
  ds_read_b128 v[72:75], v137 offset:5120
  s_waitcnt lgkmcnt(0)
  s_barrier
  s_mov_b32 s28, s50
  buffer_load_dwordx4 v[4:7], v132, s[8:11], s28 offen sc1
  buffer_load_dwordx4 v[8:11], v132, s[8:11], s28 offen offset:1024 sc1
  s_add_u32 s28, s28, 2048
  buffer_load_dwordx4 v[12:15], v132, s[8:11], s28 offen sc1
  buffer_load_dwordx4 v[16:19], v132, s[8:11], s28 offen offset:1024 sc1
  s_add_u32 s28, s28, 2048
  buffer_load_dwordx4 v[20:23], v132, s[8:11], s28 offen sc1
  buffer_load_dwordx4 v[24:27], v132, s[8:11], s28 offen offset:1024 sc1
  s_add_u32 s28, s28, 2048
  buffer_load_dwordx4 v[28:31], v132, s[8:11], s28 offen sc1
  buffer_load_dwordx4 v[32:35], v132, s[8:11], s28 offen offset:1024 sc1
  s_add_u32 s28, s28, 2048
  buffer_load_dwordx4 v[36:39], v132, s[8:11], s28 offen sc1
  buffer_load_dwordx4 v[40:43], v132, s[8:11], s28 offen offset:1024 sc1
  s_add_u32 s28, s28, 2048
  buffer_load_dwordx4 v[60:63], v132, s[8:11], s28 offen sc1
  buffer_load_dwordx4 v[64:67], v132, s[8:11], s28 offen offset:1024 sc1
  s_add_u32 s28, s28, 2048
  ds_read_b64 v[76:77], v136 offset:0
  ds_read_b64 v[78:79], v136 offset:512
  ds_read_b64 v[80:81], v136 offset:1024
  ds_read_b64 v[82:83], v136 offset:1536
  ds_read_b64 v[84:85], v136 offset:2048
  ds_read_b64 v[86:87], v136 offset:2560
  ds_read_b64 v[88:89], v136 offset:3072
  ds_read_b64 v[90:91], v136 offset:3584
  ds_read_b64 v[92:93], v136 offset:4096
  ds_read_b64 v[94:95], v136 offset:4608
  ds_read_b64 v[96:97], v136 offset:5120
  ds_read_b64 v[98:99], v136 offset:5632
  s_waitcnt lgkmcnt(0)
  s_cmp_ge_u32 s51, 63
  s_cbranch_scc1 xq_83_\sfx\()
  s_add_u32 s96, s51, 1
  s_cmp_gt_u32 s52, s96
  s_cbranch_scc1 ka\sfx\()_x_wp_84_ok
  s_mov_b32 s45, 0
ka\sfx\()_x_wp_84_spin:
  buffer_load_dword v2, v138, s[8:11], 0 offen sc1
  s_add_u32 s45, s45, 1
  s_waitcnt vmcnt(0)
  v_min_u32_dpp v3, v2, v2 quad_perm:[1,0,3,2] row_mask:0xf bank_mask:0xf
  s_nop 1
  v_min_u32_dpp v2, v3, v3 quad_perm:[2,3,0,1] row_mask:0xf bank_mask:0xf
  s_nop 1
  v_min_u32_dpp v3, v2, v2 row_half_mirror row_mask:0xf bank_mask:0xf
  s_nop 1
  v_min_u32_dpp v2, v3, v3 quad_perm:[0,1,2,3] row_mask:0xf bank_mask:0xf
  s_nop 0
  v_readfirstlane_b32 s52, v2
  s_cmp_gt_u32 s52, s96
  s_cbranch_scc1 ka\sfx\()_x_wp_84_ok
  s_cmp_lt_u32 s45, 400000
  s_cbranch_scc1 ka\sfx\()_x_wp_84_spin
  s_branch ka\sfx\()_abort
ka\sfx\()_x_wp_84_ok:
  s_add_u32 s95, s63, s93
  s_add_u32 s95, s95, 12288
  s_add_u32 m0, s94, 0
  s_add_u32 s28, s95, 0
  buffer_load_dwordx4 v132, s[8:11], s28 offen sc1 lds
  s_add_u32 m0, s94, 1024
  s_add_u32 s28, s95, 2048
  buffer_load_dwordx4 v132, s[8:11], s28 offen sc1 lds
  s_add_u32 m0, s94, 2048
  s_add_u32 s28, s95, 4096
  buffer_load_dwordx4 v132, s[8:11], s28 offen sc1 lds
  s_add_u32 m0, s94, 3072
  s_add_u32 s28, s95, 6144
  buffer_load_dwordx4 v132, s[8:11], s28 offen sc1 lds
  s_add_u32 m0, s94, 4096
  s_add_u32 s28, s95, 8192
  buffer_load_dwordx4 v132, s[8:11], s28 offen sc1 lds
  s_add_u32 m0, s94, 5120
  s_add_u32 s28, s95, 10240
  buffer_load_dwordx4 v132, s[8:11], s28 offen sc1 lds
  s_branch xq_83_j_\sfx\()
xq_83_\sfx\():
  s_waitcnt vmcnt(0)
xq_83_j_\sfx\():
  s_waitcnt vmcnt(16)
  v_mfma_f32_16x16x32_bf16 v[112:115], v[76:79], v[44:47], 0
  v_mfma_f32_16x16x32_bf16 v[116:119], v[4:7], v[44:47], 0
  v_mfma_f32_16x16x32_bf16 v[120:123], v[8:11], v[44:47], 0
  s_waitcnt vmcnt(14)
  v_mfma_f32_16x16x32_bf16 v[112:115], v[80:83], v[48:51], v[112:115]
  v_mfma_f32_16x16x32_bf16 v[116:119], v[12:15], v[48:51], v[116:119]
  v_mfma_f32_16x16x32_bf16 v[120:123], v[16:19], v[48:51], v[120:123]
  s_waitcnt vmcnt(12)
  v_mfma_f32_16x16x32_bf16 v[112:115], v[84:87], v[52:55], v[112:115]
  v_mfma_f32_16x16x32_bf16 v[116:119], v[20:23], v[52:55], v[116:119]
  v_mfma_f32_16x16x32_bf16 v[120:123], v[24:27], v[52:55], v[120:123]
  s_waitcnt vmcnt(10)
  v_mfma_f32_16x16x32_bf16 v[112:115], v[88:91], v[56:59], v[112:115]
  v_mfma_f32_16x16x32_bf16 v[116:119], v[28:31], v[56:59], v[116:119]
  v_mfma_f32_16x16x32_bf16 v[120:123], v[32:35], v[56:59], v[120:123]
  s_waitcnt vmcnt(8)
  v_mfma_f32_16x16x32_bf16 v[112:115], v[92:95], v[68:71], v[112:115]
  v_mfma_f32_16x16x32_bf16 v[116:119], v[36:39], v[68:71], v[116:119]
  v_mfma_f32_16x16x32_bf16 v[120:123], v[40:43], v[68:71], v[120:123]
  s_waitcnt vmcnt(6)
  v_mfma_f32_16x16x32_bf16 v[112:115], v[96:99], v[72:75], v[112:115]
  v_mfma_f32_16x16x32_bf16 v[116:119], v[60:63], v[72:75], v[116:119]
  v_mfma_f32_16x16x32_bf16 v[120:123], v[64:67], v[72:75], v[120:123]
  s_nop 8
  v_cndmask_b32 v112, v135, v112, s[66:67]
  v_cndmask_b32 v113, v135, v113, s[66:67]
  v_cndmask_b32 v114, v135, v114, s[66:67]
  v_cndmask_b32 v115, v135, v115, s[66:67]
  v_cndmask_b32 v116, v135, v116, s[76:77]
  v_cndmask_b32 v120, v135, v120, s[84:85]
  v_cndmask_b32 v117, v135, v117, s[78:79]
  v_cndmask_b32 v121, v135, v121, s[86:87]
  v_cndmask_b32 v118, v135, v118, s[80:81]
  v_cndmask_b32 v122, v135, v122, s[88:89]
  v_cndmask_b32 v119, v135, v119, s[82:83]
  v_cndmask_b32 v123, v135, v123, s[90:91]
  v_max3_f32 v4, v112, v113, v114
  v_max3_f32 v5, v115, v116, v117
  v_max3_f32 v6, v118, v119, v120
  v_max3_f32 v7, v121, v122, v123
  v_max3_f32 v4, v4, v5, v6
  v_max_f32 v4, v4, v7
  v_mov_b32 v5, v4
  s_nop 1
  v_permlane16_swap_b32 v4, v5
  v_max_f32 v4, v4, v5
  v_mov_b32 v5, v4
  s_nop 1
  v_permlane32_swap_b32 v4, v5
  v_max_f32 v4, v4, v5
  v_mul_f32 v4, s64, v4
  v_fma_f32 v112, v112, s64, -v4
  v_fma_f32 v113, v113, s64, -v4
  v_fma_f32 v114, v114, s64, -v4
  v_fma_f32 v115, v115, s64, -v4
  v_fma_f32 v116, v116, s64, -v4
  v_fma_f32 v117, v117, s64, -v4
  v_fma_f32 v118, v118, s64, -v4
  v_fma_f32 v119, v119, s64, -v4
  v_fma_f32 v120, v120, s64, -v4
  v_fma_f32 v121, v121, s64, -v4
  v_fma_f32 v122, v122, s64, -v4
  v_fma_f32 v123, v123, s64, -v4
  v_exp_f32 v112, v112
  v_exp_f32 v113, v113
  v_exp_f32 v114, v114
  v_exp_f32 v115, v115
  v_exp_f32 v116, v116
  v_exp_f32 v117, v117
  v_exp_f32 v118, v118
  v_exp_f32 v119, v119
  v_exp_f32 v120, v120
  v_exp_f32 v121, v121
  v_exp_f32 v122, v122
  v_exp_f32 v123, v123
  v_add_f32 v5, v112, v113
  v_add_f32 v6, v114, v115
  v_add_f32 v7, v116, v117
  v_add_f32 v8, v118, v119
  v_add_f32 v9, v120, v121
  v_add_f32 v10, v122, v123
  v_add_f32 v5, v5, v6
  v_add_f32 v7, v7, v8
  v_add_f32 v9, v9, v10
  v_add_f32 v5, v5, v7
  v_add_f32 v5, v5, v9
  v_mov_b32 v6, v5
  s_nop 1
  v_permlane16_swap_b32 v5, v6
  v_add_f32 v5, v5, v6
  v_mov_b32 v6, v5
  s_nop 1
  v_permlane32_swap_b32 v5, v6
  v_add_f32 v5, v5, v6
  v_rcp_f32 v5, v5
  s_nop 0
  v_mul_f32 v112, v112, v5
  v_mul_f32 v113, v113, v5
  v_mul_f32 v114, v114, v5
  v_mul_f32 v115, v115, v5
  v_mul_f32 v116, v116, v5
  v_mul_f32 v117, v117, v5
  v_mul_f32 v118, v118, v5
  v_mul_f32 v119, v119, v5
  v_mul_f32 v120, v120, v5
  v_mul_f32 v121, v121, v5
  v_mul_f32 v122, v122, v5
  v_mul_f32 v123, v123, v5
  v_cvt_pk_bf16_f32 v8, v112, v113
  v_cvt_pk_bf16_f32 v9, v114, v115
  v_cvt_pk_bf16_f32 v10, v116, v117
  v_cvt_pk_bf16_f32 v11, v118, v119
  v_cvt_pk_bf16_f32 v12, v120, v121
  v_cvt_pk_bf16_f32 v13, v122, v123
  buffer_store_dwordx2 v[10:11], v133, s[8:11], s92 offen \pol
  buffer_store_dwordx2 v[12:13], v133, s[8:11], s92 offen offset:256 \pol
  buffer_store_dwordx2 v[8:9], v134, s[8:11], s92 offen \pol
  s_add_u32 s92, s92, 20480
  s_cmp_ge_u32 s51, 63
  s_cbranch_scc1 ka\sfx\()_x_done
  v_mov_b32 v60, 0
  v_mov_b32 v61, 0
  v_mov_b32 v62, 0
  v_mov_b32 v63, 0
  v_mov_b32 v64, 0
  v_mov_b32 v65, 0
  v_mov_b32 v66, 0
  v_mov_b32 v67, 0
  v_mov_b32 v68, 0
  v_mov_b32 v69, 0
  v_mov_b32 v70, 0
  v_mov_b32 v71, 0
  v_mov_b32 v72, 0
  v_mov_b32 v73, 0
  v_mov_b32 v74, 0
  v_mov_b32 v75, 0
  v_mov_b32 v36, 0
  v_mov_b32 v37, 0
  v_mov_b32 v38, 0
  v_mov_b32 v39, 0
  v_mov_b32 v40, 0
  v_mov_b32 v41, 0
  v_mov_b32 v42, 0
  v_mov_b32 v43, 0
  s_add_u32 s97, s97, 10240
  s_mov_b32 s48, s97
  s_add_u32 s49, s49, 5120
  s_add_u32 s50, s50, 12288
  s_add_u32 s63, s63, 12288
  s_add_u32 s51, s51, 1
  s_cmp_gt_u32 s52, s51
  s_cbranch_scc1 ka\sfx\()_x_wp_85_ok
  s_mov_b32 s45, 0
ka\sfx\()_x_wp_85_spin:
  buffer_load_dword v2, v138, s[8:11], 0 offen sc1
  s_add_u32 s45, s45, 1
  s_waitcnt vmcnt(0)
  v_min_u32_dpp v3, v2, v2 quad_perm:[1,0,3,2] row_mask:0xf bank_mask:0xf
  s_nop 1
  v_min_u32_dpp v2, v3, v3 quad_perm:[2,3,0,1] row_mask:0xf bank_mask:0xf
  s_nop 1
  v_min_u32_dpp v3, v2, v2 row_half_mirror row_mask:0xf bank_mask:0xf
  s_nop 1
  v_min_u32_dpp v2, v3, v3 quad_perm:[0,1,2,3] row_mask:0xf bank_mask:0xf
  s_nop 0
  v_readfirstlane_b32 s52, v2
  s_cmp_gt_u32 s52, s51
  s_cbranch_scc1 ka\sfx\()_x_wp_85_ok
  s_cmp_lt_u32 s45, 400000
  s_cbranch_scc1 ka\sfx\()_x_wp_85_spin
  s_branch ka\sfx\()_abort
ka\sfx\()_x_wp_85_ok:
  s_add_u32 s28, s50, s53
  buffer_load_dwordx2 v[88:89], v132, s[8:11], s28 offen offset:0 sc1
  buffer_load_dwordx2 v[92:93], v132, s[8:11], s28 offen offset:1024 sc1
  s_add_u32 s28, s50, s54
  buffer_load_dwordx2 v[90:91], v132, s[8:11], s28 offen offset:0 sc1
  buffer_load_dwordx2 v[94:95], v132, s[8:11], s28 offen offset:1024 sc1
  s_add_u32 s28, s50, s55
  buffer_load_dwordx2 v[96:97], v132, s[8:11], s28 offen offset:0 sc1
  buffer_load_dwordx2 v[98:99], v132, s[8:11], s28 offen offset:1024 sc1
  s_branch ka\sfx\()_x_w2l
ka\sfx\()_x_w3l:
  ds_read_b128 v[44:47], v129 offset:2048
  ds_read_b128 v[48:51], v129 offset:3072
  ds_read_b128 v[52:55], v129 offset:12288
  ds_read_b128 v[56:59], v129 offset:13312
  s_waitcnt lgkmcnt(0)
  s_mov_b32 s45, 0
ka\sfx\()_x_pf_86_pr:
  buffer_load_dword v139, v141, s[8:11], s48 offen sc1
  s_add_u32 s45, s45, 1
  s_waitcnt vmcnt(0)
  v_cmp_eq_u32 vcc, -1, v139
  s_cbranch_vccz ka\sfx\()_x_pf_86
  s_cmp_lt_u32 s45, 400000
  s_cbranch_scc1 ka\sfx\()_x_pf_86_pr
  s_branch ka\sfx\()_abort
ka\sfx\()_x_pf_86:
  buffer_load_dwordx4 v[112:115], v124, s[8:11], s48 offen sc1
  buffer_load_dwordx4 v[116:119], v125, s[8:11], s48 offen sc1
  s_add_u32 s45, s45, 1
  s_waitcnt vmcnt(1)
  ds_write_b128 v127, v[112:115] offset:0
  v_max3_u32 v139, v112, v113, v114
  v_max_u32 v139, v139, v115
  s_waitcnt vmcnt(0)
  ds_write_b128 v127, v[116:119] offset:4096
  v_max3_u32 v139, v139, v116, v117
  v_max3_u32 v139, v139, v118, v119
  v_cmp_eq_u32 vcc, -1, v139
  s_cbranch_vccz ka\sfx\()_x_pf_86_ok
  s_cmp_lt_u32 s45, 400000
  s_cbranch_scc1 ka\sfx\()_x_pf_86
  s_branch ka\sfx\()_abort
ka\sfx\()_x_pf_86_ok:
  v_smfmac_f32_16x16x64_bf16 v[60:63], v[112:115], a[24:31], v110
  v_smfmac_f32_16x16x64_bf16 v[64:67], v[112:115], v[44:51], v110
  ds_read_b128 v[44:47], v129 offset:22528
  v_smfmac_f32_16x16x64_bf16 v[68:71], v[112:115], a[104:111], v110
  ds_read_b128 v[48:51], v129 offset:23552
  v_smfmac_f32_16x16x64_bf16 v[72:75], v[112:115], v[52:59], v110
  ds_read_b128 v[52:55], v129 offset:6144
  s_waitcnt lgkmcnt(3)
  s_barrier
  v_smfmac_f32_16x16x64_bf16 v[36:39], v[112:115], a[184:191], v110
  ds_read_b128 v[56:59], v129 offset:7168
  ds_read_b128 v[4:7], v128 offset:0
  s_waitcnt lgkmcnt(3)
  v_smfmac_f32_16x16x64_bf16 v[40:43], v[112:115], v[44:51], v110
  ds_read_b128 v[44:47], v129 offset:16384
  ds_read_b128 v[8:11], v128 offset:1024
  v_smfmac_f32_16x16x64_bf16 v[60:63], v[116:119], a[56:63], v110
  ds_read_b128 v[48:51], v129 offset:17408
  ds_read_b128 v[12:15], v128 offset:2048
  s_waitcnt lgkmcnt(5)
  v_smfmac_f32_16x16x64_bf16 v[64:67], v[116:119], v[52:59], v110
  ds_read_b128 v[52:55], v129 offset:26624
  ds_read_b128 v[16:19], v128 offset:4096
  v_smfmac_f32_16x16x64_bf16 v[68:71], v[116:119], a[136:143], v110
  ds_read_b128 v[56:59], v129 offset:27648
  ds_read_b128 v[20:23], v128 offset:5120
  s_waitcnt lgkmcnt(5)
  v_smfmac_f32_16x16x64_bf16 v[72:75], v[116:119], v[44:51], v110
  ds_read_b128 v[44:47], v129 offset:0
  ds_read_b128 v[24:27], v128 offset:6144
  v_smfmac_f32_16x16x64_bf16 v[36:39], v[116:119], a[216:223], v110
  ds_read_b128 v[48:51], v129 offset:1024
  ds_read_b128 v[28:31], v128 offset:8192
  s_waitcnt lgkmcnt(5)
  v_smfmac_f32_16x16x64_bf16 v[40:43], v[116:119], v[52:59], v110
  ds_read_b128 v[52:55], v129 offset:4096
  ds_read_b128 v[32:35], v128 offset:9216
  v_smfmac_f32_16x16x64_bf16 v[60:63], v[4:7], a[0:7], v110
  ds_read_b128 v[56:59], v129 offset:5120
  v_smfmac_f32_16x16x64_bf16 v[64:67], v[4:7], a[240:247], v110
  v_smfmac_f32_16x16x64_bf16 v[60:63], v[8:11], a[8:15], v110
  s_waitcnt lgkmcnt(4)
  v_smfmac_f32_16x16x64_bf16 v[64:67], v[8:11], v[44:51], v110
  ds_read_b128 v[44:47], v129 offset:8192
  v_smfmac_f32_16x16x64_bf16 v[60:63], v[12:15], a[16:23], v110
  ds_read_b128 v[48:51], v129 offset:9216
  v_smfmac_f32_16x16x64_bf16 v[64:67], v[12:15], a[248:255], v110
  v_smfmac_f32_16x16x64_bf16 v[60:63], v[16:19], a[32:39], v110
  v_smfmac_f32_16x16x64_bf16 v[64:67], v[16:19], v[152:159], v110
  v_smfmac_f32_16x16x64_bf16 v[60:63], v[20:23], a[40:47], v110
  s_waitcnt lgkmcnt(2)
  v_smfmac_f32_16x16x64_bf16 v[64:67], v[20:23], v[52:59], v110
  ds_read_b128 v[52:55], v129 offset:10240
  v_smfmac_f32_16x16x64_bf16 v[60:63], v[24:27], a[48:55], v110
  ds_read_b128 v[56:59], v129 offset:11264
  v_smfmac_f32_16x16x64_bf16 v[64:67], v[24:27], v[160:167], v110
  v_smfmac_f32_16x16x64_bf16 v[60:63], v[28:31], a[64:71], v110
  v_smfmac_f32_16x16x64_bf16 v[64:67], v[28:31], v[168:175], v110
  v_smfmac_f32_16x16x64_bf16 v[60:63], v[32:35], a[72:79], v110
  s_waitcnt lgkmcnt(2)
  v_smfmac_f32_16x16x64_bf16 v[64:67], v[32:35], v[44:51], v110
  ds_read_b128 v[44:47], v129 offset:14336
  v_smfmac_f32_16x16x64_bf16 v[68:71], v[4:7], a[80:87], v110
  ds_read_b128 v[48:51], v129 offset:15360
  v_smfmac_f32_16x16x64_bf16 v[72:75], v[4:7], v[176:183], v110
  v_permlane32_swap_b32 v60, v64
  v_smfmac_f32_16x16x64_bf16 v[68:71], v[8:11], a[88:95], v110
  s_waitcnt lgkmcnt(2)
  v_smfmac_f32_16x16x64_bf16 v[72:75], v[8:11], v[52:59], v110
  ds_read_b128 v[52:55], v129 offset:18432
  v_permlane32_swap_b32 v61, v65
  v_smfmac_f32_16x16x64_bf16 v[68:71], v[12:15], a[96:103], v110
  ds_read_b128 v[56:59], v129 offset:19456
  v_smfmac_f32_16x16x64_bf16 v[72:75], v[12:15], v[184:191], v110
  v_permlane32_swap_b32 v62, v66
  v_smfmac_f32_16x16x64_bf16 v[68:71], v[16:19], a[112:119], v110
  v_permlane32_swap_b32 v63, v67
  v_smfmac_f32_16x16x64_bf16 v[72:75], v[16:19], v[192:199], v110
  v_add_f32 v60, v60, v64
  v_smfmac_f32_16x16x64_bf16 v[68:71], v[20:23], a[120:127], v110
  v_add_f32 v61, v61, v65
  s_waitcnt lgkmcnt(2)
  v_smfmac_f32_16x16x64_bf16 v[72:75], v[20:23], v[44:51], v110
  ds_read_b128 v[44:47], v129 offset:20480
  v_add_f32 v62, v62, v66
  v_smfmac_f32_16x16x64_bf16 v[68:71], v[24:27], a[128:135], v110
  ds_read_b128 v[48:51], v129 offset:21504
  v_add_f32 v63, v63, v67
  v_smfmac_f32_16x16x64_bf16 v[72:75], v[24:27], v[200:207], v110
  v_cvt_pk_bf16_f32 v100, v60, v61
  v_smfmac_f32_16x16x64_bf16 v[68:71], v[28:31], a[144:151], v110
  v_cvt_pk_bf16_f32 v101, v62, v63
  v_smfmac_f32_16x16x64_bf16 v[72:75], v[28:31], v[208:215], v110
  v_smfmac_f32_16x16x64_bf16 v[68:71], v[32:35], a[152:159], v110
  s_waitcnt lgkmcnt(2)
  v_smfmac_f32_16x16x64_bf16 v[72:75], v[32:35], v[52:59], v110
  ds_read_b128 v[52:55], v129 offset:24576
  v_smfmac_f32_16x16x64_bf16 v[36:39], v[4:7], a[160:167], v110
  ds_read_b128 v[56:59], v129 offset:25600
  v_smfmac_f32_16x16x64_bf16 v[40:43], v[4:7], v[216:223], v110
  v_permlane32_swap_b32 v68, v72
  v_smfmac_f32_16x16x64_bf16 v[36:39], v[8:11], a[168:175], v110
  s_waitcnt lgkmcnt(2)
  v_smfmac_f32_16x16x64_bf16 v[40:43], v[8:11], v[44:51], v110
  ds_read_b128 v[44:47], v129 offset:28672
  v_permlane32_swap_b32 v69, v73
  v_smfmac_f32_16x16x64_bf16 v[36:39], v[12:15], a[176:183], v110
  ds_read_b128 v[48:51], v129 offset:29696
  v_smfmac_f32_16x16x64_bf16 v[40:43], v[12:15], v[224:231], v110
  v_permlane32_swap_b32 v70, v74
  v_smfmac_f32_16x16x64_bf16 v[36:39], v[16:19], a[192:199], v110
  v_permlane32_swap_b32 v71, v75
  v_smfmac_f32_16x16x64_bf16 v[40:43], v[16:19], v[232:239], v110
  v_add_f32 v68, v68, v72
  v_smfmac_f32_16x16x64_bf16 v[36:39], v[20:23], a[200:207], v110
  v_add_f32 v69, v69, v73
  s_waitcnt lgkmcnt(2)
  v_smfmac_f32_16x16x64_bf16 v[40:43], v[20:23], v[52:59], v110
  v_add_f32 v70, v70, v74
  v_smfmac_f32_16x16x64_bf16 v[36:39], v[24:27], a[208:215], v110
  v_add_f32 v71, v71, v75
  v_smfmac_f32_16x16x64_bf16 v[40:43], v[24:27], v[240:247], v110
  v_cvt_pk_bf16_f32 v102, v68, v69
  v_smfmac_f32_16x16x64_bf16 v[36:39], v[28:31], a[224:231], v110
  v_cvt_pk_bf16_f32 v103, v70, v71
  v_smfmac_f32_16x16x64_bf16 v[40:43], v[28:31], v[248:255], v110
  v_smfmac_f32_16x16x64_bf16 v[36:39], v[32:35], a[232:239], v110
  s_waitcnt lgkmcnt(0)
  v_smfmac_f32_16x16x64_bf16 v[40:43], v[32:35], v[44:51], v110
  v_mfma_f32_16x16x16_bf16 v[142:145], v[100:101], v[108:109], 0
  v_mfma_f32_16x16x16_bf16 v[146:149], v[102:103], v[108:109], 0
  s_nop 1
  v_permlane32_swap_b32 v36, v40
  v_permlane32_swap_b32 v37, v41
  v_permlane32_swap_b32 v38, v42
  v_permlane32_swap_b32 v39, v43
  v_add_f32 v36, v36, v40
  v_add_f32 v37, v37, v41
  v_add_f32 v38, v38, v42
  v_add_f32 v39, v39, v43
  v_cvt_pk_bf16_f32 v104, v36, v37
  v_cvt_pk_bf16_f32 v105, v38, v39
  v_cvt_pk_bf16_f32 v44, v142, v143
  v_cvt_pk_bf16_f32 v45, v144, v145
  v_mfma_f32_16x16x16_bf16 v[142:145], v[104:105], v[108:109], 0
  v_cvt_pk_bf16_f32 v46, v146, v147
  v_cvt_pk_bf16_f32 v47, v148, v149
  s_nop 1
  v_mfma_f32_16x16x32_bf16 v[76:79], v[44:47], v[44:47], 0
  v_mfma_f32_16x16x32_bf16 v[80:83], v[88:91], v[44:47], 0
  v_cvt_pk_bf16_f32 v106, v142, v143
  v_cvt_pk_bf16_f32 v107, v144, v145
  v_mfma_f32_16x16x32_bf16 v[84:87], v[92:95], v[44:47], 0
  s_nop 0
  v_mfma_f32_16x16x16_bf16 v[76:79], v[106:107], v[106:107], v[76:79]
  v_mfma_f32_16x16x16_bf16 v[80:83], v[96:97], v[106:107], v[80:83]
  v_mfma_f32_16x16x16_bf16 v[84:87], v[98:99], v[106:107], v[84:87]
  s_mov_b32 exec_lo, 0
  s_mov_b32 exec_hi, 0x00ff00ff
  s_nop 3
  ds_write_b128 v130, v[76:79]
  s_mov_b32 exec_lo, 0x00ff00ff
  ds_write_b128 v130, v[80:83] offset:1024
  s_nop 0
  ds_write_b128 v130, v[84:87] offset:2048
  s_mov_b64 exec, -1
  s_waitcnt lgkmcnt(0)
  s_barrier
  ds_write_b64 v131, v[44:45]
  ds_write_b64 v131, v[46:47] offset:512
  ds_write_b64 v131, v[106:107] offset:1024
  ds_read_b128 v[44:47], v137 offset:0
  ds_read_b128 v[48:51], v137 offset:1024
  ds_read_b128 v[52:55], v137 offset:2048
  ds_read_b128 v[56:59], v137 offset:3072
  ds_read_b128 v[68:71], v137 offset:4096
  ds_read_b128 v[72:75], v137 offset:5120
  s_waitcnt lgkmcnt(0)
  s_barrier
  s_mov_b32 s28, s50
  buffer_load_dwordx4 v[4:7], v132, s[8:11], s28 offen sc1
  buffer_load_dwordx4 v[8:11], v132, s[8:11], s28 offen offset:1024 sc1
  s_add_u32 s28, s28, 2048
  buffer_load_dwordx4 v[12:15], v132, s[8:11], s28 offen sc1
  buffer_load_dwordx4 v[16:19], v132, s[8:11], s28 offen offset:1024 sc1
  s_add_u32 s28, s28, 2048
  buffer_load_dwordx4 v[20:23], v132, s[8:11], s28 offen sc1
  buffer_load_dwordx4 v[24:27], v132, s[8:11], s28 offen offset:1024 sc1
  s_add_u32 s28, s28, 2048
  buffer_load_dwordx4 v[28:31], v132, s[8:11], s28 offen sc1
  buffer_load_dwordx4 v[32:35], v132, s[8:11], s28 offen offset:1024 sc1
  s_add_u32 s28, s28, 2048
  buffer_load_dwordx4 v[36:39], v132, s[8:11], s28 offen sc1
  buffer_load_dwordx4 v[40:43], v132, s[8:11], s28 offen offset:1024 sc1
  s_add_u32 s28, s28, 2048
  buffer_load_dwordx4 v[60:63], v132, s[8:11], s28 offen sc1
  buffer_load_dwordx4 v[64:67], v132, s[8:11], s28 offen offset:1024 sc1
  s_add_u32 s28, s28, 2048
  ds_read_b64 v[76:77], v136 offset:0
  ds_read_b64 v[78:79], v136 offset:512
  ds_read_b64 v[80:81], v136 offset:1024
  ds_read_b64 v[82:83], v136 offset:1536
  ds_read_b64 v[84:85], v136 offset:2048
  ds_read_b64 v[86:87], v136 offset:2560
  ds_read_b64 v[88:89], v136 offset:3072
  ds_read_b64 v[90:91], v136 offset:3584
  ds_read_b64 v[92:93], v136 offset:4096
  ds_read_b64 v[94:95], v136 offset:4608
  ds_read_b64 v[96:97], v136 offset:5120
  ds_read_b64 v[98:99], v136 offset:5632
  s_waitcnt lgkmcnt(0)
  s_cmp_ge_u32 s51, 63
  s_cbranch_scc1 xq_87_\sfx\()
  s_add_u32 s96, s51, 1
  s_cmp_gt_u32 s52, s96
  s_cbranch_scc1 ka\sfx\()_x_wp_88_ok
  s_mov_b32 s45, 0
ka\sfx\()_x_wp_88_spin:
  buffer_load_dword v2, v138, s[8:11], 0 offen sc1
  s_add_u32 s45, s45, 1
  s_waitcnt vmcnt(0)
  v_min_u32_dpp v3, v2, v2 quad_perm:[1,0,3,2] row_mask:0xf bank_mask:0xf
  s_nop 1
  v_min_u32_dpp v2, v3, v3 quad_perm:[2,3,0,1] row_mask:0xf bank_mask:0xf
  s_nop 1
  v_min_u32_dpp v3, v2, v2 row_half_mirror row_mask:0xf bank_mask:0xf
  s_nop 1
  v_min_u32_dpp v2, v3, v3 quad_perm:[0,1,2,3] row_mask:0xf bank_mask:0xf
  s_nop 0
  v_readfirstlane_b32 s52, v2
  s_cmp_gt_u32 s52, s96
  s_cbranch_scc1 ka\sfx\()_x_wp_88_ok
  s_cmp_lt_u32 s45, 400000
  s_cbranch_scc1 ka\sfx\()_x_wp_88_spin
  s_branch ka\sfx\()_abort
ka\sfx\()_x_wp_88_ok:
  s_add_u32 s95, s63, s93
  s_add_u32 s95, s95, 12288
  s_add_u32 m0, s94, 0
  s_add_u32 s28, s95, 0
  buffer_load_dwordx4 v132, s[8:11], s28 offen sc1 lds
  s_add_u32 m0, s94, 1024
  s_add_u32 s28, s95, 2048
  buffer_load_dwordx4 v132, s[8:11], s28 offen sc1 lds
  s_add_u32 m0, s94, 2048
  s_add_u32 s28, s95, 4096
  buffer_load_dwordx4 v132, s[8:11], s28 offen sc1 lds
  s_add_u32 m0, s94, 3072
  s_add_u32 s28, s95, 6144
  buffer_load_dwordx4 v132, s[8:11], s28 offen sc1 lds
  s_add_u32 m0, s94, 4096
  s_add_u32 s28, s95, 8192
  buffer_load_dwordx4 v132, s[8:11], s28 offen sc1 lds
  s_add_u32 m0, s94, 5120
  s_add_u32 s28, s95, 10240
  buffer_load_dwordx4 v132, s[8:11], s28 offen sc1 lds
  s_branch xq_87_j_\sfx\()
xq_87_\sfx\():
  s_waitcnt vmcnt(0)
xq_87_j_\sfx\():
  s_waitcnt vmcnt(16)
  v_mfma_f32_16x16x32_bf16 v[112:115], v[76:79], v[44:47], 0
  v_mfma_f32_16x16x32_bf16 v[116:119], v[4:7], v[44:47], 0
  v_mfma_f32_16x16x32_bf16 v[120:123], v[8:11], v[44:47], 0
  s_waitcnt vmcnt(14)
  v_mfma_f32_16x16x32_bf16 v[112:115], v[80:83], v[48:51], v[112:115]
  v_mfma_f32_16x16x32_bf16 v[116:119], v[12:15], v[48:51], v[116:119]
  v_mfma_f32_16x16x32_bf16 v[120:123], v[16:19], v[48:51], v[120:123]
  s_waitcnt vmcnt(12)
  v_mfma_f32_16x16x32_bf16 v[112:115], v[84:87], v[52:55], v[112:115]
  v_mfma_f32_16x16x32_bf16 v[116:119], v[20:23], v[52:55], v[116:119]
  v_mfma_f32_16x16x32_bf16 v[120:123], v[24:27], v[52:55], v[120:123]
  s_waitcnt vmcnt(10)
  v_mfma_f32_16x16x32_bf16 v[112:115], v[88:91], v[56:59], v[112:115]
  v_mfma_f32_16x16x32_bf16 v[116:119], v[28:31], v[56:59], v[116:119]
  v_mfma_f32_16x16x32_bf16 v[120:123], v[32:35], v[56:59], v[120:123]
  s_waitcnt vmcnt(8)
  v_mfma_f32_16x16x32_bf16 v[112:115], v[92:95], v[68:71], v[112:115]
  v_mfma_f32_16x16x32_bf16 v[116:119], v[36:39], v[68:71], v[116:119]
  v_mfma_f32_16x16x32_bf16 v[120:123], v[40:43], v[68:71], v[120:123]
  s_waitcnt vmcnt(6)
  v_mfma_f32_16x16x32_bf16 v[112:115], v[96:99], v[72:75], v[112:115]
  v_mfma_f32_16x16x32_bf16 v[116:119], v[60:63], v[72:75], v[116:119]
  v_mfma_f32_16x16x32_bf16 v[120:123], v[64:67], v[72:75], v[120:123]
  s_nop 8
  v_cndmask_b32 v112, v135, v112, s[66:67]
  v_cndmask_b32 v113, v135, v113, s[66:67]
  v_cndmask_b32 v114, v135, v114, s[66:67]
  v_cndmask_b32 v115, v135, v115, s[66:67]
  v_cndmask_b32 v116, v135, v116, s[76:77]
  v_cndmask_b32 v120, v135, v120, s[84:85]
  v_cndmask_b32 v117, v135, v117, s[78:79]
  v_cndmask_b32 v121, v135, v121, s[86:87]
  v_cndmask_b32 v118, v135, v118, s[80:81]
  v_cndmask_b32 v122, v135, v122, s[88:89]
  v_cndmask_b32 v119, v135, v119, s[82:83]
  v_cndmask_b32 v123, v135, v123, s[90:91]
  v_max3_f32 v4, v112, v113, v114
  v_max3_f32 v5, v115, v116, v117
  v_max3_f32 v6, v118, v119, v120
  v_max3_f32 v7, v121, v122, v123
  v_max3_f32 v4, v4, v5, v6
  v_max_f32 v4, v4, v7
  v_mov_b32 v5, v4
  s_nop 1
  v_permlane16_swap_b32 v4, v5
  v_max_f32 v4, v4, v5
  v_mov_b32 v5, v4
  s_nop 1
  v_permlane32_swap_b32 v4, v5
  v_max_f32 v4, v4, v5
  v_mul_f32 v4, s64, v4
  v_fma_f32 v112, v112, s64, -v4
  v_fma_f32 v113, v113, s64, -v4
  v_fma_f32 v114, v114, s64, -v4
  v_fma_f32 v115, v115, s64, -v4
  v_fma_f32 v116, v116, s64, -v4
  v_fma_f32 v117, v117, s64, -v4
  v_fma_f32 v118, v118, s64, -v4
  v_fma_f32 v119, v119, s64, -v4
  v_fma_f32 v120, v120, s64, -v4
  v_fma_f32 v121, v121, s64, -v4
  v_fma_f32 v122, v122, s64, -v4
  v_fma_f32 v123, v123, s64, -v4
  v_exp_f32 v112, v112
  v_exp_f32 v113, v113
  v_exp_f32 v114, v114
  v_exp_f32 v115, v115
  v_exp_f32 v116, v116
  v_exp_f32 v117, v117
  v_exp_f32 v118, v118
  v_exp_f32 v119, v119
  v_exp_f32 v120, v120
  v_exp_f32 v121, v121
  v_exp_f32 v122, v122
  v_exp_f32 v123, v123
  v_add_f32 v5, v112, v113
  v_add_f32 v6, v114, v115
  v_add_f32 v7, v116, v117
  v_add_f32 v8, v118, v119
  v_add_f32 v9, v120, v121
  v_add_f32 v10, v122, v123
  v_add_f32 v5, v5, v6
  v_add_f32 v7, v7, v8
  v_add_f32 v9, v9, v10
  v_add_f32 v5, v5, v7
  v_add_f32 v5, v5, v9
  v_mov_b32 v6, v5
  s_nop 1
  v_permlane16_swap_b32 v5, v6
  v_add_f32 v5, v5, v6
  v_mov_b32 v6, v5
  s_nop 1
  v_permlane32_swap_b32 v5, v6
  v_add_f32 v5, v5, v6
  v_rcp_f32 v5, v5
  s_nop 0
  v_mul_f32 v112, v112, v5
  v_mul_f32 v113, v113, v5
  v_mul_f32 v114, v114, v5
  v_mul_f32 v115, v115, v5
  v_mul_f32 v116, v116, v5
  v_mul_f32 v117, v117, v5
  v_mul_f32 v118, v118, v5
  v_mul_f32 v119, v119, v5
  v_mul_f32 v120, v120, v5
  v_mul_f32 v121, v121, v5
  v_mul_f32 v122, v122, v5
  v_mul_f32 v123, v123, v5
  v_cvt_pk_bf16_f32 v8, v112, v113
  v_cvt_pk_bf16_f32 v9, v114, v115
  v_cvt_pk_bf16_f32 v10, v116, v117
  v_cvt_pk_bf16_f32 v11, v118, v119
  v_cvt_pk_bf16_f32 v12, v120, v121
  v_cvt_pk_bf16_f32 v13, v122, v123
  buffer_store_dwordx2 v[10:11], v133, s[8:11], s92 offen \pol
  buffer_store_dwordx2 v[12:13], v133, s[8:11], s92 offen offset:256 \pol
  buffer_store_dwordx2 v[8:9], v134, s[8:11], s92 offen \pol
  s_add_u32 s92, s92, 20480
  s_cmp_ge_u32 s51, 63
  s_cbranch_scc1 ka\sfx\()_x_done
  v_mov_b32 v60, 0
  v_mov_b32 v61, 0
  v_mov_b32 v62, 0
  v_mov_b32 v63, 0
  v_mov_b32 v64, 0
  v_mov_b32 v65, 0
  v_mov_b32 v66, 0
  v_mov_b32 v67, 0
  v_mov_b32 v68, 0
  v_mov_b32 v69, 0
  v_mov_b32 v70, 0
  v_mov_b32 v71, 0
  v_mov_b32 v72, 0
  v_mov_b32 v73, 0
  v_mov_b32 v74, 0
  v_mov_b32 v75, 0
  v_mov_b32 v36, 0
  v_mov_b32 v37, 0
  v_mov_b32 v38, 0
  v_mov_b32 v39, 0
  v_mov_b32 v40, 0
  v_mov_b32 v41, 0
  v_mov_b32 v42, 0
  v_mov_b32 v43, 0
  s_add_u32 s97, s97, 10240
  s_mov_b32 s48, s97
  s_add_u32 s49, s49, 5120
  s_add_u32 s50, s50, 12288
  s_add_u32 s63, s63, 12288
  s_add_u32 s51, s51, 1
  s_cmp_gt_u32 s52, s51
  s_cbranch_scc1 ka\sfx\()_x_wp_89_ok
  s_mov_b32 s45, 0
ka\sfx\()_x_wp_89_spin:
  buffer_load_dword v2, v138, s[8:11], 0 offen sc1
  s_add_u32 s45, s45, 1
  s_waitcnt vmcnt(0)
  v_min_u32_dpp v3, v2, v2 quad_perm:[1,0,3,2] row_mask:0xf bank_mask:0xf
  s_nop 1
  v_min_u32_dpp v2, v3, v3 quad_perm:[2,3,0,1] row_mask:0xf bank_mask:0xf
  s_nop 1
  v_min_u32_dpp v3, v2, v2 row_half_mirror row_mask:0xf bank_mask:0xf
  s_nop 1
  v_min_u32_dpp v2, v3, v3 quad_perm:[0,1,2,3] row_mask:0xf bank_mask:0xf
  s_nop 0
  v_readfirstlane_b32 s52, v2
  s_cmp_gt_u32 s52, s51
  s_cbranch_scc1 ka\sfx\()_x_wp_89_ok
  s_cmp_lt_u32 s45, 400000
  s_cbranch_scc1 ka\sfx\()_x_wp_89_spin
  s_branch ka\sfx\()_abort
ka\sfx\()_x_wp_89_ok:
  s_add_u32 s28, s50, s53
  buffer_load_dwordx2 v[88:89], v132, s[8:11], s28 offen offset:0 sc1
  buffer_load_dwordx2 v[92:93], v132, s[8:11], s28 offen offset:1024 sc1
  s_add_u32 s28, s50, s54
  buffer_load_dwordx2 v[90:91], v132, s[8:11], s28 offen offset:0 sc1
  buffer_load_dwordx2 v[94:95], v132, s[8:11], s28 offen offset:1024 sc1
  s_add_u32 s28, s50, s55
  buffer_load_dwordx2 v[96:97], v132, s[8:11], s28 offen offset:0 sc1
  buffer_load_dwordx2 v[98:99], v132, s[8:11], s28 offen offset:1024 sc1
  s_branch ka\sfx\()_x_w3l
ka\sfx\()_x_done:
  s_waitcnt vmcnt(0) lgkmcnt(0)
  s_branch ka\sfx\()_exit
ka\sfx\()_y:
  v_and_b32 v1, 63, v0
  v_lshlrev_b32 v178, 4, v1
  s_and_b32 s28, s21, 1
  s_lshl_b32 s46, s23, 1
  s_add_u32 s46, s46, s28
  s_lshr_b32 s28, s21, 1
  s_lshl_b32 s28, s28, 2
  s_lshl_b32 s47, s20, 3
  s_add_u32 s47, s47, s28
  s_mul_i32 s28, s47, 40
  s_add_u32 s28, s28, s46
  s_mul_i32 s28, s28, 20480
  s_add_u32 s28, s28, 0x2e00000
  s_add_u32 s29, s28, 0
  buffer_load_dwordx4 a[0:3], v178, s[8:11], s29 offen
  buffer_load_dwordx4 a[4:7], v178, s[8:11], s29 offen offset:1024
  s_add_u32 s29, s28, 2048
  buffer_load_dwordx4 a[8:11], v178, s[8:11], s29 offen
  buffer_load_dwordx4 a[12:15], v178, s[8:11], s29 offen offset:1024
  s_add_u32 s29, s28, 4096
  buffer_load_dwordx4 a[16:19], v178, s[8:11], s29 offen
  buffer_load_dwordx4 a[20:23], v178, s[8:11], s29 offen offset:1024
  s_add_u32 s29, s28, 6144
  buffer_load_dwordx4 a[24:27], v178, s[8:11], s29 offen
  buffer_load_dwordx4 a[28:31], v178, s[8:11], s29 offen offset:1024
  s_add_u32 s29, s28, 8192
  buffer_load_dwordx4 a[32:35], v178, s[8:11], s29 offen
  buffer_load_dwordx4 a[36:39], v178, s[8:11], s29 offen offset:1024
  s_add_u32 s29, s28, 10240
  buffer_load_dwordx4 a[40:43], v178, s[8:11], s29 offen
  buffer_load_dwordx4 a[44:47], v178, s[8:11], s29 offen offset:1024
  s_add_u32 s29, s28, 12288
  buffer_load_dwordx4 a[48:51], v178, s[8:11], s29 offen
  buffer_load_dwordx4 a[52:55], v178, s[8:11], s29 offen offset:1024
  s_add_u32 s29, s28, 14336
  buffer_load_dwordx4 a[56:59], v178, s[8:11], s29 offen
  buffer_load_dwordx4 a[60:63], v178, s[8:11], s29 offen offset:1024
  s_add_u32 s29, s28, 16384
  buffer_load_dwordx4 a[64:67], v178, s[8:11], s29 offen
  buffer_load_dwordx4 a[68:71], v178, s[8:11], s29 offen offset:1024
  s_add_u32 s29, s28, 18432
  buffer_load_dwordx4 a[72:75], v178, s[8:11], s29 offen
  buffer_load_dwordx4 a[76:79], v178, s[8:11], s29 offen offset:1024
  s_add_u32 s29, s28, 819200
  buffer_load_dwordx4 a[80:83], v178, s[8:11], s29 offen
  buffer_load_dwordx4 a[84:87], v178, s[8:11], s29 offen offset:1024
  s_add_u32 s29, s28, 821248
  buffer_load_dwordx4 a[88:91], v178, s[8:11], s29 offen
  buffer_load_dwordx4 a[92:95], v178, s[8:11], s29 offen offset:1024
  s_add_u32 s29, s28, 823296
  buffer_load_dwordx4 a[96:99], v178, s[8:11], s29 offen
  buffer_load_dwordx4 a[100:103], v178, s[8:11], s29 offen offset:1024
  s_add_u32 s29, s28, 825344
  buffer_load_dwordx4 a[104:107], v178, s[8:11], s29 offen
  buffer_load_dwordx4 a[108:111], v178, s[8:11], s29 offen offset:1024
  s_add_u32 s29, s28, 827392
  buffer_load_dwordx4 a[112:115], v178, s[8:11], s29 offen
  buffer_load_dwordx4 a[116:119], v178, s[8:11], s29 offen offset:1024
  s_add_u32 s29, s28, 829440
  buffer_load_dwordx4 a[120:123], v178, s[8:11], s29 offen
  buffer_load_dwordx4 a[124:127], v178, s[8:11], s29 offen offset:1024
  s_add_u32 s29, s28, 831488
  buffer_load_dwordx4 a[128:131], v178, s[8:11], s29 offen
  buffer_load_dwordx4 a[132:135], v178, s[8:11], s29 offen offset:1024
  s_add_u32 s29, s28, 833536
  buffer_load_dwordx4 a[136:139], v178, s[8:11], s29 offen
  buffer_load_dwordx4 a[140:143], v178, s[8:11], s29 offen offset:1024
  s_add_u32 s29, s28, 835584
  buffer_load_dwordx4 a[144:147], v178, s[8:11], s29 offen
  buffer_load_dwordx4 a[148:151], v178, s[8:11], s29 offen offset:1024
  s_add_u32 s29, s28, 837632
  buffer_load_dwordx4 a[152:155], v178, s[8:11], s29 offen
  buffer_load_dwordx4 a[156:159], v178, s[8:11], s29 offen offset:1024
  s_waitcnt vmcnt(30)
  s_cmp_eq_u32 s21, 3
  s_cbranch_scc0 lna_90_\sfx\()
  s_mov_b64 s[24:25], exec
  s_mov_b64 exec, 1
  v_mov_b32 v2, 4992
  v_mov_b32 v3, 1
  buffer_atomic_add v3, v2, s[8:11], 0 offen
  s_mov_b64 exec, s[24:25]
lna_90_\sfx\():
  s_add_u32 s29, s28, 1638400
  buffer_load_dwordx4 a[160:163], v178, s[8:11], s29 offen
  buffer_load_dwordx4 a[164:167], v178, s[8:11], s29 offen offset:1024
  s_add_u32 s29, s28, 1640448
  buffer_load_dwordx4 a[168:171], v178, s[8:11], s29 offen
  buffer_load_dwordx4 a[172:175], v178, s[8:11], s29 offen offset:1024
  s_add_u32 s29, s28, 1642496
  buffer_load_dwordx4 a[176:179], v178, s[8:11], s29 offen
  buffer_load_dwordx4 a[180:183], v178, s[8:11], s29 offen offset:1024
  s_add_u32 s29, s28, 1644544
  buffer_load_dwordx4 a[184:187], v178, s[8:11], s29 offen
  buffer_load_dwordx4 a[188:191], v178, s[8:11], s29 offen offset:1024
  s_add_u32 s29, s28, 1646592
  buffer_load_dwordx4 a[192:195], v178, s[8:11], s29 offen
  buffer_load_dwordx4 a[196:199], v178, s[8:11], s29 offen offset:1024
  s_add_u32 s29, s28, 1648640
  buffer_load_dwordx4 a[200:203], v178, s[8:11], s29 offen
  buffer_load_dwordx4 a[204:207], v178, s[8:11], s29 offen offset:1024
  s_add_u32 s29, s28, 1650688
  buffer_load_dwordx4 a[208:211], v178, s[8:11], s29 offen
  buffer_load_dwordx4 a[212:215], v178, s[8:11], s29 offen offset:1024
  s_add_u32 s29, s28, 1652736
  buffer_load_dwordx4 a[216:219], v178, s[8:11], s29 offen
  buffer_load_dwordx4 a[220:223], v178, s[8:11], s29 offen offset:1024
  s_add_u32 s29, s28, 1654784
  buffer_load_dwordx4 a[224:227], v178, s[8:11], s29 offen
  buffer_load_dwordx4 a[228:231], v178, s[8:11], s29 offen offset:1024
  s_add_u32 s29, s28, 1656832
  buffer_load_dwordx4 a[232:235], v178, s[8:11], s29 offen
  buffer_load_dwordx4 a[236:239], v178, s[8:11], s29 offen offset:1024
  s_waitcnt vmcnt(30)
  s_add_u32 s29, s28, 2457600
  buffer_load_dwordx4 a[240:243], v178, s[8:11], s29 offen
  buffer_load_dwordx4 a[244:247], v178, s[8:11], s29 offen offset:1024
  s_add_u32 s29, s28, 2459648
  buffer_load_dwordx4 a[248:251], v178, s[8:11], s29 offen
  buffer_load_dwordx4 a[252:255], v178, s[8:11], s29 offen offset:1024
  s_add_u32 s29, s28, 2461696
  buffer_load_dwordx4 v[192:195], v178, s[8:11], s29 offen
  buffer_load_dwordx4 v[196:199], v178, s[8:11], s29 offen offset:1024
  s_add_u32 s29, s28, 2463744
  buffer_load_dwordx4 v[200:203], v178, s[8:11], s29 offen
  buffer_load_dwordx4 v[204:207], v178, s[8:11], s29 offen offset:1024
  s_add_u32 s29, s28, 2465792
  buffer_load_dwordx4 v[208:211], v178, s[8:11], s29 offen
  buffer_load_dwordx4 v[212:215], v178, s[8:11], s29 offen offset:1024
  s_add_u32 s29, s28, 2467840
  buffer_load_dwordx4 v[216:219], v178, s[8:11], s29 offen
  buffer_load_dwordx4 v[220:223], v178, s[8:11], s29 offen offset:1024
  s_add_u32 s29, s28, 2469888
  buffer_load_dwordx4 v[224:227], v178, s[8:11], s29 offen
  buffer_load_dwordx4 v[228:231], v178, s[8:11], s29 offen offset:1024
  s_add_u32 s29, s28, 2471936
  buffer_load_dwordx4 v[232:235], v178, s[8:11], s29 offen
  buffer_load_dwordx4 v[236:239], v178, s[8:11], s29 offen offset:1024
  s_add_u32 s29, s28, 2473984
  buffer_load_dwordx4 v[240:243], v178, s[8:11], s29 offen
  buffer_load_dwordx4 v[244:247], v178, s[8:11], s29 offen offset:1024
  s_add_u32 s29, s28, 2476032
  buffer_load_dwordx4 v[248:251], v178, s[8:11], s29 offen
  buffer_load_dwordx4 v[252:255], v178, s[8:11], s29 offen offset:1024
  s_waitcnt vmcnt(30)
  v_mov_b32 v172, 0x44444444
  v_mov_b32 v2, 0xeeeeeeee
  v_and_b32 v3, 8, v1
  v_cmp_ne_u32 vcc, 0, v3
  s_nop 1
  v_cndmask_b32 v172, v172, v2, vcc
  s_lshl_b32 s28, s21, 10
  v_add_u32 v173, s28, v178
  v_add_u32 v174, 4096, v173
  v_add_u32 v175, 8192, v173
  v_add_u32 v176, 0, v173
  v_add_u32 v177, 0, v178
  v_add_u32 v179, 10240, v173
  s_xor_b32 s28, s21, 2
  s_lshl_b32 s28, s28, 10
  s_add_u32 s28, s28, 10240
  v_add_u32 v180, s28, v178
  v_and_b32 v4, 15, v1
  v_lshrrev_b32 v5, 4, v1
  v_and_b32 v6, 7, v1
  v_lshlrev_b32 v7, 3, v5
  v_add_u32 v7, v7, v6
  v_lshlrev_b32 v185, 4, v7
  v_add_u32 v182, 4096, v178
  v_mov_b32 v8, 0x40000000
  v_cmp_gt_u32 vcc, 8, v4
  s_nop 1
  v_cndmask_b32 v184, v8, v185, vcc
  v_lshlrev_b32 v7, 4, v4
  v_lshlrev_b32 v9, 2, v5
  v_add_u32 v7, v7, v9
  v_cndmask_b32 v186, v8, v7, vcc
  s_lshl_b32 s28, s20, 5
  s_add_u32 s28, s28, 3072
  v_lshlrev_b32 v7, 2, v6
  v_add_u32 v187, s28, v7
  v_and_b32 v7, 1, v5
  v_lshlrev_b32 v7, 3, v7
  v_lshrrev_b32 v9, 1, v5
  v_lshlrev_b32 v9, 5, v9
  v_add_u32 v9, v9, v4
  v_lshlrev_b32 v9, 4, v9
  v_add_u32 v189, v7, v9
  v_mov_b32 v44, 0
  v_mov_b32 v45, 0
  v_mov_b32 v46, 0
  v_mov_b32 v47, 0
  v_mov_b32 v48, 0
  v_mov_b32 v49, 0
  v_mov_b32 v50, 0
  v_mov_b32 v51, 0
  v_mov_b32 v52, 0
  v_mov_b32 v53, 0
  v_mov_b32 v54, 0
  v_mov_b32 v55, 0
  v_mov_b32 v56, 0
  v_mov_b32 v57, 0
  v_mov_b32 v58, 0
  v_mov_b32 v59, 0
  s_mul_i32 s97, s20, 655360
  s_add_u32 s97, s97, 0x400000
  s_mov_b32 s48, 0x4000
  s_mul_i32 s49, s20, 327680
  s_add_u32 s49, s49, 0x700000
  s_mul_i32 s50, s20, 327680
  s_lshl_b32 s28, s46, 10
  s_add_u32 s50, s50, s28
  s_add_u32 s50, s50, 0x9000000
  s_mov_b32 s51, 0
  s_mov_b32 s52, 0
  s_mov_b32 s53, 0
  s_mov_b32 s61, 0
  s_add_u32 s29, s20, 0
  s_and_b32 s29, s29, 3
  s_mul_i32 s29, s29, 20
  s_add_u32 s29, s29, s23
  s_lshr_b32 s28, s29, 3
  s_lshl_b32 s28, s28, 14
  s_and_b32 s29, s29, 7
  s_lshl_b32 s29, s29, 10
  s_add_u32 s28, s28, s29
  s_and_b32 s29, s21, 1
  s_lshl_b32 s29, s29, 9
  s_add_u32 s28, s28, s29
  s_add_u32 s28, s28, s61
  s_add_u32 s56, s28, 0xa00000
  s_mov_b32 s66, s56
  s_add_u32 s29, s20, 1
  s_and_b32 s29, s29, 3
  s_mul_i32 s29, s29, 20
  s_add_u32 s29, s29, s23
  s_lshr_b32 s28, s29, 3
  s_lshl_b32 s28, s28, 14
  s_and_b32 s29, s29, 7
  s_lshl_b32 s29, s29, 10
  s_add_u32 s28, s28, s29
  s_and_b32 s29, s21, 1
  s_lshl_b32 s29, s29, 9
  s_add_u32 s28, s28, s29
  s_add_u32 s28, s28, s61
  s_add_u32 s57, s28, 0xa00000
  s_mov_b32 s67, s57
  s_add_u32 s29, s20, 2
  s_and_b32 s29, s29, 3
  s_mul_i32 s29, s29, 20
  s_add_u32 s29, s29, s23
  s_lshr_b32 s28, s29, 3
  s_lshl_b32 s28, s28, 14
  s_and_b32 s29, s29, 7
  s_lshl_b32 s29, s29, 10
  s_add_u32 s28, s28, s29
  s_and_b32 s29, s21, 1
  s_lshl_b32 s29, s29, 9
  s_add_u32 s28, s28, s29
  s_add_u32 s28, s28, s61
  s_add_u32 s58, s28, 0xa00000
  s_mov_b32 s68, s58
  s_add_u32 s29, s20, 3
  s_and_b32 s29, s29, 3
  s_mul_i32 s29, s29, 20
  s_add_u32 s29, s29, s23
  s_lshr_b32 s28, s29, 3
  s_lshl_b32 s28, s28, 14
  s_and_b32 s29, s29, 7
  s_lshl_b32 s29, s29, 10
  s_add_u32 s28, s28, s29
  s_and_b32 s29, s21, 1
  s_lshl_b32 s29, s29, 9
  s_add_u32 s28, s28, s29
  s_add_u32 s28, s28, s61
  s_add_u32 s59, s28, 0xa00000
  s_mov_b32 s69, s59
  v_mov_b32 v124, -1
  v_mov_b32 v125, -1
  v_mov_b32 v126, -1
  v_mov_b32 v127, -1
  s_lshr_b32 s28, s46, 2
  s_lshl_b32 s28, s28, 10
  s_and_b32 s29, s46, 3
  s_lshl_b32 s29, s29, 8
  s_add_u32 s28, s28, s29
  s_add_u32 s60, s28, s97
  s_add_u32 s60, s60, 10240
  s_and_b32 s28, s21, 1
  s_lshl_b32 s28, s28, 10
  s_add_u32 s28, s28, 32768
  v_add_u32 v181, s28, v178
  v_add_u32 v183, 65536, v178
  s_waitcnt vmcnt(0)
  s_cmp_ge_u32 s21, 2
  s_cbranch_scc1 ka\sfx\()_y_tok
ka\sfx\()_y_crit:
  s_add_u32 s98, s48, 4096
  s_add_u32 s100, s48, 8192
  s_mov_b32 s45, 0
ka\sfx\()_y_pf_91:
  buffer_load_dwordx4 v[160:163], v173, s[8:11], s48 offen sc1
  buffer_load_dwordx4 v[164:167], v173, s[8:11], s48 offen offset:2048 sc1
  buffer_load_dwordx4 v[168:171], v173, s[8:11], s98 offen sc1
  buffer_load_dwordx4 v[68:71], v173, s[8:11], s98 offen offset:2048 sc1
  buffer_load_dwordx4 v[72:75], v173, s[8:11], s100 offen sc1
  s_add_u32 s45, s45, 1
  s_waitcnt vmcnt(4)
  ds_write_b128 v176, v[160:163] offset:0
  v_max3_u32 v190, v160, v161, v162
  v_max_u32 v190, v190, v163
  s_waitcnt vmcnt(3)
  ds_write_b128 v176, v[164:167] offset:2048
  v_max3_u32 v190, v190, v164, v165
  v_max3_u32 v190, v190, v166, v167
  s_waitcnt vmcnt(2)
  ds_write_b128 v176, v[168:171] offset:4096
  v_max3_u32 v190, v190, v168, v169
  v_max3_u32 v190, v190, v170, v171
  s_waitcnt vmcnt(1)
  ds_write_b128 v176, v[68:71] offset:6144
  v_max3_u32 v190, v190, v68, v69
  v_max3_u32 v190, v190, v70, v71
  s_waitcnt vmcnt(0)
  ds_write_b128 v176, v[72:75] offset:8192
  v_max3_u32 v190, v190, v72, v73
  v_max3_u32 v190, v190, v74, v75
  v_cmp_eq_u32 vcc, -1, v190
  s_cbranch_vccz ka\sfx\()_y_pf_91_ok
  s_cmp_lt_u32 s45, 400000
  s_cbranch_scc1 ka\sfx\()_y_pf_91
  s_branch ka\sfx\()_abort
ka\sfx\()_y_pf_91_ok:
  s_waitcnt lgkmcnt(0)
  s_barrier
  ds_read_b128 v[4:7], v177 offset:0
  ds_read_b128 v[8:11], v177 offset:1024
  ds_read_b128 v[12:15], v177 offset:2048
  ds_read_b128 v[16:19], v177 offset:3072
  ds_read_b128 v[20:23], v177 offset:4096
  ds_read_b128 v[24:27], v177 offset:5120
  ds_read_b128 v[28:31], v177 offset:6144
  ds_read_b128 v[32:35], v177 offset:7168
  ds_read_b128 v[36:39], v177 offset:8192
  ds_read_b128 v[40:43], v177 offset:9216
  s_cmp_eq_u32 s51, 7
  s_cbranch_scc0 ka\sfx\()_y_nosel
  v_mov_b32 v2, 5056
  s_mov_b32 s45, 0
ka\sfx\()_y_sel:
  buffer_load_dword v3, v2, s[8:11], 0 offen sc1
  s_add_u32 s45, s45, 1
  s_waitcnt vmcnt(0)
  v_readfirstlane_b32 s61, v3
  s_cmp_lg_u32 s61, 0
  s_cbranch_scc1 ka\sfx\()_y_selok
  s_cmp_lt_u32 s45, 400000
  s_cbranch_scc1 ka\sfx\()_y_sel
  s_branch ka\sfx\()_abort
ka\sfx\()_y_selok:
  s_and_b32 s61, s61, 2
  s_lshl_b32 s61, s61, 12
ka\sfx\()_y_nosel:
  s_cmp_lt_u32 s51, 2
  s_cbranch_scc1 ka\sfx\()_y_norst
  s_sub_u32 s28, s51, 2
  s_and_b32 s28, s28, 3
  s_mul_i32 s28, s28, 163840
  s_add_u32 s28, s28, s56
  v_mov_b32 v160, -1
  v_mov_b32 v161, -1
  v_mov_b32 v162, -1
  v_mov_b32 v163, -1
  buffer_store_dwordx4 v[160:163], v184, s[8:11], s28 offen sc1
ka\sfx\()_y_norst:
  s_waitcnt lgkmcnt(9)
  v_smfmac_f32_16x16x64_bf16 v[44:47], v[4:7], a[0:7], v172
  v_smfmac_f32_16x16x64_bf16 v[48:51], v[4:7], a[80:87], v172
  v_smfmac_f32_16x16x64_bf16 v[52:55], v[4:7], a[160:167], v172
  v_smfmac_f32_16x16x64_bf16 v[56:59], v[4:7], a[240:247], v172
  s_waitcnt lgkmcnt(8)
  v_smfmac_f32_16x16x64_bf16 v[44:47], v[8:11], a[8:15], v172
  v_smfmac_f32_16x16x64_bf16 v[48:51], v[8:11], a[88:95], v172
  v_smfmac_f32_16x16x64_bf16 v[52:55], v[8:11], a[168:175], v172
  v_smfmac_f32_16x16x64_bf16 v[56:59], v[8:11], a[248:255], v172
  s_waitcnt lgkmcnt(7)
  v_smfmac_f32_16x16x64_bf16 v[44:47], v[12:15], a[16:23], v172
  v_smfmac_f32_16x16x64_bf16 v[48:51], v[12:15], a[96:103], v172
  v_smfmac_f32_16x16x64_bf16 v[52:55], v[12:15], a[176:183], v172
  v_smfmac_f32_16x16x64_bf16 v[56:59], v[12:15], v[192:199], v172
  s_waitcnt lgkmcnt(6)
  v_smfmac_f32_16x16x64_bf16 v[44:47], v[16:19], a[24:31], v172
  v_smfmac_f32_16x16x64_bf16 v[48:51], v[16:19], a[104:111], v172
  v_smfmac_f32_16x16x64_bf16 v[52:55], v[16:19], a[184:191], v172
  v_smfmac_f32_16x16x64_bf16 v[56:59], v[16:19], v[200:207], v172
  s_waitcnt lgkmcnt(5)
  v_smfmac_f32_16x16x64_bf16 v[44:47], v[20:23], a[32:39], v172
  v_smfmac_f32_16x16x64_bf16 v[48:51], v[20:23], a[112:119], v172
  v_smfmac_f32_16x16x64_bf16 v[52:55], v[20:23], a[192:199], v172
  v_smfmac_f32_16x16x64_bf16 v[56:59], v[20:23], v[208:215], v172
  s_waitcnt lgkmcnt(4)
  v_smfmac_f32_16x16x64_bf16 v[44:47], v[24:27], a[40:47], v172
  v_smfmac_f32_16x16x64_bf16 v[48:51], v[24:27], a[120:127], v172
  v_smfmac_f32_16x16x64_bf16 v[52:55], v[24:27], a[200:207], v172
  v_smfmac_f32_16x16x64_bf16 v[56:59], v[24:27], v[216:223], v172
  s_waitcnt lgkmcnt(3)
  v_smfmac_f32_16x16x64_bf16 v[44:47], v[28:31], a[48:55], v172
  v_smfmac_f32_16x16x64_bf16 v[48:51], v[28:31], a[128:135], v172
  v_smfmac_f32_16x16x64_bf16 v[52:55], v[28:31], a[208:215], v172
  v_smfmac_f32_16x16x64_bf16 v[56:59], v[28:31], v[224:231], v172
  s_waitcnt lgkmcnt(2)
  v_smfmac_f32_16x16x64_bf16 v[44:47], v[32:35], a[56:63], v172
  v_smfmac_f32_16x16x64_bf16 v[48:51], v[32:35], a[136:143], v172
  v_smfmac_f32_16x16x64_bf16 v[52:55], v[32:35], a[216:223], v172
  v_smfmac_f32_16x16x64_bf16 v[56:59], v[32:35], v[232:239], v172
  s_waitcnt lgkmcnt(1)
  v_smfmac_f32_16x16x64_bf16 v[44:47], v[36:39], a[64:71], v172
  v_smfmac_f32_16x16x64_bf16 v[48:51], v[36:39], a[144:151], v172
  v_smfmac_f32_16x16x64_bf16 v[52:55], v[36:39], a[224:231], v172
  v_smfmac_f32_16x16x64_bf16 v[56:59], v[36:39], v[240:247], v172
  s_waitcnt lgkmcnt(0)
  v_smfmac_f32_16x16x64_bf16 v[44:47], v[40:43], a[72:79], v172
  v_smfmac_f32_16x16x64_bf16 v[48:51], v[40:43], a[152:159], v172
  v_smfmac_f32_16x16x64_bf16 v[52:55], v[40:43], a[232:239], v172
  v_smfmac_f32_16x16x64_bf16 v[56:59], v[40:43], v[248:255], v172
  s_nop 9
  v_permlane32_swap_b32 v44, v48
  v_permlane32_swap_b32 v45, v49
  v_permlane32_swap_b32 v46, v50
  v_permlane32_swap_b32 v47, v51
  v_permlane32_swap_b32 v52, v56
  v_permlane32_swap_b32 v53, v57
  v_permlane32_swap_b32 v54, v58
  v_permlane32_swap_b32 v55, v59
  v_add_f32 v44, v44, v48
  v_add_f32 v45, v45, v49
  v_add_f32 v46, v46, v50
  v_add_f32 v47, v47, v51
  v_add_f32 v52, v52, v56
  v_add_f32 v53, v53, v57
  v_add_f32 v54, v54, v58
  v_add_f32 v55, v55, v59
  v_cvt_pk_bf16_f32 v60, v44, v45
  v_cvt_pk_bf16_f32 v61, v46, v47
  v_cvt_pk_bf16_f32 v62, v52, v53
  v_cvt_pk_bf16_f32 v63, v54, v55
  ds_write_b128 v179, v[60:63]
  v_mov_b32 v44, 0
  v_mov_b32 v45, 0
  v_mov_b32 v46, 0
  v_mov_b32 v47, 0
  v_mov_b32 v48, 0
  v_mov_b32 v49, 0
  v_mov_b32 v50, 0
  v_mov_b32 v51, 0
  v_mov_b32 v52, 0
  v_mov_b32 v53, 0
  v_mov_b32 v54, 0
  v_mov_b32 v55, 0
  v_mov_b32 v56, 0
  v_mov_b32 v57, 0
  v_mov_b32 v58, 0
  v_mov_b32 v59, 0
  s_waitcnt lgkmcnt(0)
  s_barrier
  s_cmp_ge_u32 s51, 63
  s_cbranch_scc1 ka\sfx\()_y_crit_end
  ds_read_b128 v[64:67], v180
  ds_read_b128 v[68:71], v181 offset:0
  ds_read_b128 v[72:75], v181 offset:2048
  ds_read_b128 v[76:79], v181 offset:4096
  ds_read_b128 v[80:83], v181 offset:6144
  ds_read_b128 v[84:87], v181 offset:8192
  ds_read_b128 v[88:91], v181 offset:10240
  ds_read_b128 v[92:95], v181 offset:12288
  ds_read_b128 v[96:99], v181 offset:14336
  v_xor_b32 v181, 0x4000, v181
  s_mov_b32 s45, 0
  buffer_load_dwordx4 v[100:103], v178, s[8:11], s49 offen offset:0 sc1
  buffer_load_dwordx4 v[104:107], v178, s[8:11], s49 offen offset:1024 sc1
  buffer_load_dwordx4 v[108:111], v178, s[8:11], s49 offen offset:2048 sc1
  buffer_load_dwordx4 v[112:115], v178, s[8:11], s49 offen offset:3072 sc1
  buffer_load_dwordx4 v[116:119], v182, s[8:11], s49 offen sc1
yp_92_\sfx\():
  buffer_load_dwordx4 v[120:123], v178, s[8:11], s49 offen offset:0 sc1
  buffer_load_dwordx4 v[124:127], v178, s[8:11], s49 offen offset:1024 sc1
  buffer_load_dwordx4 v[128:131], v178, s[8:11], s49 offen offset:2048 sc1
  buffer_load_dwordx4 v[132:135], v178, s[8:11], s49 offen offset:3072 sc1
  buffer_load_dwordx4 v[136:139], v182, s[8:11], s49 offen sc1
  s_waitcnt vmcnt(9) lgkmcnt(0)
  v_mfma_f32_16x16x32_bf16 v[140:143], v[68:71], v[100:103], 0
  v_max_u32 v190, v100, v102
  v_mfma_f32_16x16x32_bf16 v[144:147], v[72:75], v[100:103], 0
  s_waitcnt vmcnt(8)
  v_mfma_f32_16x16x32_bf16 v[140:143], v[76:79], v[104:107], v[140:143]
  v_max3_u32 v190, v190, v104, v106
  v_mfma_f32_16x16x32_bf16 v[144:147], v[80:83], v[104:107], v[144:147]
  s_waitcnt vmcnt(7)
  v_mfma_f32_16x16x32_bf16 v[140:143], v[84:87], v[108:111], v[140:143]
  v_max3_u32 v190, v190, v108, v110
  v_mfma_f32_16x16x32_bf16 v[144:147], v[88:91], v[108:111], v[144:147]
  s_waitcnt vmcnt(6)
  v_mfma_f32_16x16x32_bf16 v[140:143], v[92:95], v[112:115], v[140:143]
  v_max3_u32 v190, v190, v112, v114
  v_mfma_f32_16x16x32_bf16 v[144:147], v[96:99], v[112:115], v[144:147]
  s_waitcnt vmcnt(5)
  v_mfma_f32_16x16x32_bf16 v[140:143], v[60:63], v[116:119], v[140:143]
  v_max3_u32 v190, v190, v116, v117
  v_mfma_f32_16x16x32_bf16 v[144:147], v[64:67], v[116:119], v[144:147]
  v_max3_u32 v190, v190, v118, v119
  v_cmp_eq_u32 vcc, -1, v190
  s_cbranch_vccz yp_92_okA_\sfx\()
  buffer_load_dwordx4 v[100:103], v178, s[8:11], s49 offen offset:0 sc1
  buffer_load_dwordx4 v[104:107], v178, s[8:11], s49 offen offset:1024 sc1
  buffer_load_dwordx4 v[108:111], v178, s[8:11], s49 offen offset:2048 sc1
  buffer_load_dwordx4 v[112:115], v178, s[8:11], s49 offen offset:3072 sc1
  buffer_load_dwordx4 v[116:119], v182, s[8:11], s49 offen sc1
  s_waitcnt vmcnt(9) lgkmcnt(0)
  v_mfma_f32_16x16x32_bf16 v[148:151], v[68:71], v[120:123], 0
  v_max_u32 v190, v120, v122
  v_mfma_f32_16x16x32_bf16 v[152:155], v[72:75], v[120:123], 0
  s_waitcnt vmcnt(8)
  v_mfma_f32_16x16x32_bf16 v[148:151], v[76:79], v[124:127], v[148:151]
  v_max3_u32 v190, v190, v124, v126
  v_mfma_f32_16x16x32_bf16 v[152:155], v[80:83], v[124:127], v[152:155]
  s_waitcnt vmcnt(7)
  v_mfma_f32_16x16x32_bf16 v[148:151], v[84:87], v[128:131], v[148:151]
  v_max3_u32 v190, v190, v128, v130
  v_mfma_f32_16x16x32_bf16 v[152:155], v[88:91], v[128:131], v[152:155]
  s_waitcnt vmcnt(6)
  v_mfma_f32_16x16x32_bf16 v[148:151], v[92:95], v[132:135], v[148:151]
  v_max3_u32 v190, v190, v132, v134
  v_mfma_f32_16x16x32_bf16 v[152:155], v[96:99], v[132:135], v[152:155]
  s_waitcnt vmcnt(5)
  v_mfma_f32_16x16x32_bf16 v[148:151], v[60:63], v[136:139], v[148:151]
  v_max3_u32 v190, v190, v136, v137
  v_mfma_f32_16x16x32_bf16 v[152:155], v[64:67], v[136:139], v[152:155]
  v_max3_u32 v190, v190, v138, v139
  v_cmp_eq_u32 vcc, -1, v190
  s_cbranch_vccz yp_92_okB_\sfx\()
  s_add_u32 s45, s45, 1
  s_cmp_lt_u32 s45, 400000
  s_cbranch_scc1 yp_92_c_\sfx\()
  s_branch ka\sfx\()_abort
yp_92_c_\sfx\():
  s_branch yp_92_\sfx\()
yp_92_okB_\sfx\():
  s_nop 4
  v_add_f32_dpp v140, v152, v148 row_ror:8 row_mask:0xf bank_mask:0xf
  v_add_f32_dpp v141, v153, v149 row_ror:8 row_mask:0xf bank_mask:0xf
  v_add_f32_dpp v142, v154, v150 row_ror:8 row_mask:0xf bank_mask:0xf
  v_add_f32_dpp v143, v155, v151 row_ror:8 row_mask:0xf bank_mask:0xf
  s_branch yp_92_j_\sfx\()
yp_92_okA_\sfx\():
  s_nop 4
  v_add_f32_dpp v140, v144, v140 row_ror:8 row_mask:0xf bank_mask:0xf
  v_add_f32_dpp v141, v145, v141 row_ror:8 row_mask:0xf bank_mask:0xf
  v_add_f32_dpp v142, v146, v142 row_ror:8 row_mask:0xf bank_mask:0xf
  v_add_f32_dpp v143, v147, v143 row_ror:8 row_mask:0xf bank_mask:0xf
yp_92_j_\sfx\():
  buffer_load_dwordx4 v[4:7], v185, s[8:11], s67 offen sc1
  buffer_load_dwordx4 v[8:11], v185, s[8:11], s68 offen sc1
  buffer_load_dwordx4 v[12:15], v185, s[8:11], s69 offen sc1
  buffer_store_dwordx4 v[140:143], v184, s[8:11], s66 offen sc1
  s_mov_b32 s45, 0
  buffer_load_dwordx4 v[148:151], v185, s[8:11], s67 offen sc1
  buffer_load_dwordx4 v[152:155], v185, s[8:11], s68 offen sc1
  buffer_load_dwordx4 v[156:159], v185, s[8:11], s69 offen sc1
  s_waitcnt vmcnt(4)
  v_max3_u32 v190, v4, v7, v8
  v_max3_u32 v190, v190, v11, v12
  v_max_u32 v190, v190, v15
  v_add_f32 v160, v140, v4
  v_add_f32 v161, v141, v5
  v_add_f32 v162, v142, v6
  v_add_f32 v163, v143, v7
  v_cmp_eq_u32 vcc, -1, v190
  v_add_f32 v164, v8, v12
  v_add_f32 v165, v9, v13
  v_add_f32 v166, v10, v14
  v_add_f32 v167, v11, v15
  s_cbranch_vccz yc_93_ok_\sfx\()
yc_93_\sfx\():
  buffer_load_dwordx4 v[4:7], v185, s[8:11], s67 offen sc1
  buffer_load_dwordx4 v[8:11], v185, s[8:11], s68 offen sc1
  buffer_load_dwordx4 v[12:15], v185, s[8:11], s69 offen sc1
  s_waitcnt vmcnt(3)
  v_max3_u32 v190, v148, v151, v152
  v_max3_u32 v190, v190, v155, v156
  v_max_u32 v190, v190, v159
  v_add_f32 v160, v140, v148
  v_add_f32 v161, v141, v149
  v_add_f32 v162, v142, v150
  v_add_f32 v163, v143, v151
  v_cmp_eq_u32 vcc, -1, v190
  v_add_f32 v164, v152, v156
  v_add_f32 v165, v153, v157
  v_add_f32 v166, v154, v158
  v_add_f32 v167, v155, v159
  s_cbranch_vccz yc_93_ok_\sfx\()
  buffer_load_dwordx4 v[148:151], v185, s[8:11], s67 offen sc1
  buffer_load_dwordx4 v[152:155], v185, s[8:11], s68 offen sc1
  buffer_load_dwordx4 v[156:159], v185, s[8:11], s69 offen sc1
  s_waitcnt vmcnt(3)
  v_max3_u32 v190, v4, v7, v8
  v_max3_u32 v190, v190, v11, v12
  v_max_u32 v190, v190, v15
  v_add_f32 v160, v140, v4
  v_add_f32 v161, v141, v5
  v_add_f32 v162, v142, v6
  v_add_f32 v163, v143, v7
  v_cmp_eq_u32 vcc, -1, v190
  v_add_f32 v164, v8, v12
  v_add_f32 v165, v9, v13
  v_add_f32 v166, v10, v14
  v_add_f32 v167, v11, v15
  s_cbranch_vccz yc_93_ok_\sfx\()
  s_add_u32 s45, s45, 1
  s_cmp_lt_u32 s45, 400000
  s_cbranch_scc1 yc_93_\sfx\()
  s_branch ka\sfx\()_abort
yc_93_ok_\sfx\():
  v_add_f32 v160, v160, v164
  v_add_f32 v161, v161, v165
  v_add_f32 v162, v162, v166
  v_add_f32 v163, v163, v167
  v_cvt_pk_bf16_f32 v168, v160, v161
  v_cvt_pk_bf16_f32 v169, v162, v163
  buffer_store_dword v168, v186, s[8:11], s60 offen \pol
  buffer_store_dword v169, v186, s[8:11], s60 offen offset:128 \pol
  s_add_u32 s97, s97, 10240
  s_mov_b32 s48, s97
  s_add_u32 s60, s60, 10240
  s_add_u32 s49, s49, 5120
  s_add_u32 s56, s56, s61
  s_add_u32 s57, s57, s61
  s_add_u32 s58, s58, s61
  s_add_u32 s59, s59, s61
  s_mov_b32 s61, 0
  s_add_u32 s28, s51, 1
  s_and_b32 s28, s28, 3
  s_mul_i32 s28, s28, 163840
  s_add_u32 s66, s56, s28
  s_add_u32 s67, s57, s28
  s_add_u32 s68, s58, s28
  s_add_u32 s69, s59, s28
  s_add_u32 s51, s51, 1
  s_branch ka\sfx\()_y_crit
ka\sfx\()_y_crit_end:
  s_waitcnt vmcnt(0) lgkmcnt(0)
  s_branch ka\sfx\()_exit
ka\sfx\()_y_tok:
  s_mul_i32 s61, s20, 1310720
  s_add_u32 s61, s61, 0xe00000
  s_mul_i32 s62, s20, 2621440
  s_lshl_b32 s28, s46, 10
  s_add_u32 s62, s62, s28
  s_add_u32 s62, s62, 0x1a00000
  s_mov_b32 s54, 0
  s_and_b32 s63, s21, 1
  s_lshl_b32 s63, s63, 10
  s_add_u32 s63, s63, 32768
  s_and_b32 s64, s21, 1
  s_mul_i32 s64, s64, 10240
ka\sfx\()_y_tokl:
  s_barrier
  ds_read_b128 v[4:7], v177 offset:0
  ds_read_b128 v[8:11], v177 offset:1024
  ds_read_b128 v[12:15], v177 offset:2048
  ds_read_b128 v[16:19], v177 offset:3072
  ds_read_b128 v[20:23], v177 offset:4096
  ds_read_b128 v[24:27], v177 offset:5120
  ds_read_b128 v[28:31], v177 offset:6144
  ds_read_b128 v[32:35], v177 offset:7168
  ds_read_b128 v[36:39], v177 offset:8192
  ds_read_b128 v[40:43], v177 offset:9216
  s_cmp_gt_u32 s52, s51
  s_cbranch_scc1 ka\sfx\()_y_wp_94_ok
  s_mov_b32 s45, 0
ka\sfx\()_y_wp_94_spin:
  buffer_load_dword v2, v187, s[8:11], 0 offen sc1
  s_add_u32 s45, s45, 1
  s_waitcnt vmcnt(0)
  v_min_u32_dpp v3, v2, v2 quad_perm:[1,0,3,2] row_mask:0xf bank_mask:0xf
  s_nop 1
  v_min_u32_dpp v2, v3, v3 quad_perm:[2,3,0,1] row_mask:0xf bank_mask:0xf
  s_nop 1
  v_min_u32_dpp v3, v2, v2 row_half_mirror row_mask:0xf bank_mask:0xf
  s_nop 1
  v_min_u32_dpp v2, v3, v3 quad_perm:[0,1,2,3] row_mask:0xf bank_mask:0xf
  s_nop 0
  v_readfirstlane_b32 s52, v2
  s_cmp_gt_u32 s52, s51
  s_cbranch_scc1 ka\sfx\()_y_wp_94_ok
  s_cmp_lt_u32 s45, 400000
  s_cbranch_scc1 ka\sfx\()_y_wp_94_spin
  s_branch ka\sfx\()_abort
ka\sfx\()_y_wp_94_ok:
  s_add_u32 s65, s61, s64
  s_waitcnt lgkmcnt(9)
  v_smfmac_f32_16x16x64_bf16 v[44:47], v[4:7], a[0:7], v172
  s_add_u32 m0, s63, 0
  s_add_u32 s28, s50, 0
  buffer_load_dwordx4 v178, s[8:11], s28 offen sc1 lds
  v_smfmac_f32_16x16x64_bf16 v[48:51], v[4:7], a[80:87], v172
  v_smfmac_f32_16x16x64_bf16 v[52:55], v[4:7], a[160:167], v172
  s_add_u32 m0, s63, 2048
  s_add_u32 s28, s50, 40960
  buffer_load_dwordx4 v178, s[8:11], s28 offen sc1 lds
  v_smfmac_f32_16x16x64_bf16 v[56:59], v[4:7], a[240:247], v172
  s_waitcnt lgkmcnt(8)
  v_smfmac_f32_16x16x64_bf16 v[44:47], v[8:11], a[8:15], v172
  s_add_u32 m0, s63, 4096
  s_add_u32 s28, s50, 81920
  buffer_load_dwordx4 v178, s[8:11], s28 offen sc1 lds
  v_smfmac_f32_16x16x64_bf16 v[48:51], v[8:11], a[88:95], v172
  v_smfmac_f32_16x16x64_bf16 v[52:55], v[8:11], a[168:175], v172
  s_add_u32 m0, s63, 6144
  s_add_u32 s28, s50, 122880
  buffer_load_dwordx4 v178, s[8:11], s28 offen sc1 lds
  v_smfmac_f32_16x16x64_bf16 v[56:59], v[8:11], a[248:255], v172
  s_waitcnt lgkmcnt(7)
  v_smfmac_f32_16x16x64_bf16 v[44:47], v[12:15], a[16:23], v172
  s_add_u32 m0, s63, 8192
  s_add_u32 s28, s50, 163840
  buffer_load_dwordx4 v178, s[8:11], s28 offen sc1 lds
  v_smfmac_f32_16x16x64_bf16 v[48:51], v[12:15], a[96:103], v172
  v_smfmac_f32_16x16x64_bf16 v[52:55], v[12:15], a[176:183], v172
  s_add_u32 m0, s63, 10240
  s_add_u32 s28, s50, 204800
  buffer_load_dwordx4 v178, s[8:11], s28 offen sc1 lds
  v_smfmac_f32_16x16x64_bf16 v[56:59], v[12:15], v[192:199], v172
  s_waitcnt lgkmcnt(6)
  v_smfmac_f32_16x16x64_bf16 v[44:47], v[16:19], a[24:31], v172
  s_add_u32 m0, s63, 12288
  s_add_u32 s28, s50, 245760
  buffer_load_dwordx4 v178, s[8:11], s28 offen sc1 lds
  v_smfmac_f32_16x16x64_bf16 v[48:51], v[16:19], a[104:111], v172
  v_smfmac_f32_16x16x64_bf16 v[52:55], v[16:19], a[184:191], v172
  s_add_u32 m0, s63, 14336
  s_add_u32 s28, s50, 286720
  buffer_load_dwordx4 v178, s[8:11], s28 offen sc1 lds
  v_smfmac_f32_16x16x64_bf16 v[56:59], v[16:19], v[200:207], v172
  s_waitcnt lgkmcnt(5)
  v_smfmac_f32_16x16x64_bf16 v[44:47], v[20:23], a[32:39], v172
  s_add_u32 m0, s64, 65536
  s_add_u32 s28, s65, 0
  buffer_load_dwordx4 v178, s[8:11], s28 offen sc1 lds
  v_smfmac_f32_16x16x64_bf16 v[48:51], v[20:23], a[112:119], v172
  v_smfmac_f32_16x16x64_bf16 v[52:55], v[20:23], a[192:199], v172
  s_add_u32 m0, s64, 66560
  s_add_u32 s28, s65, 1024
  buffer_load_dwordx4 v178, s[8:11], s28 offen sc1 lds
  v_smfmac_f32_16x16x64_bf16 v[56:59], v[20:23], v[208:215], v172
  s_waitcnt lgkmcnt(4)
  v_smfmac_f32_16x16x64_bf16 v[44:47], v[24:27], a[40:47], v172
  s_add_u32 m0, s64, 67584
  s_add_u32 s28, s65, 2048
  buffer_load_dwordx4 v178, s[8:11], s28 offen sc1 lds
  v_smfmac_f32_16x16x64_bf16 v[48:51], v[24:27], a[120:127], v172
  v_smfmac_f32_16x16x64_bf16 v[52:55], v[24:27], a[200:207], v172
  s_add_u32 m0, s64, 68608
  s_add_u32 s28, s65, 3072
  buffer_load_dwordx4 v178, s[8:11], s28 offen sc1 lds
  v_smfmac_f32_16x16x64_bf16 v[56:59], v[24:27], v[216:223], v172
  s_waitcnt lgkmcnt(3)
  v_smfmac_f32_16x16x64_bf16 v[44:47], v[28:31], a[48:55], v172
  s_add_u32 m0, s64, 69632
  s_add_u32 s28, s65, 4096
  buffer_load_dwordx4 v178, s[8:11], s28 offen sc1 lds
  v_smfmac_f32_16x16x64_bf16 v[48:51], v[28:31], a[128:135], v172
  v_smfmac_f32_16x16x64_bf16 v[52:55], v[28:31], a[208:215], v172
  s_add_u32 m0, s64, 70656
  s_add_u32 s28, s65, 5120
  buffer_load_dwordx4 v178, s[8:11], s28 offen sc1 lds
  v_smfmac_f32_16x16x64_bf16 v[56:59], v[28:31], v[224:231], v172
  s_waitcnt lgkmcnt(2)
  v_smfmac_f32_16x16x64_bf16 v[44:47], v[32:35], a[56:63], v172
  s_add_u32 m0, s64, 71680
  s_add_u32 s28, s65, 6144
  buffer_load_dwordx4 v178, s[8:11], s28 offen sc1 lds
  v_smfmac_f32_16x16x64_bf16 v[48:51], v[32:35], a[136:143], v172
  v_smfmac_f32_16x16x64_bf16 v[52:55], v[32:35], a[216:223], v172
  s_add_u32 m0, s64, 72704
  s_add_u32 s28, s65, 7168
  buffer_load_dwordx4 v178, s[8:11], s28 offen sc1 lds
  v_smfmac_f32_16x16x64_bf16 v[56:59], v[32:35], v[232:239], v172
  s_waitcnt lgkmcnt(1)
  v_smfmac_f32_16x16x64_bf16 v[44:47], v[36:39], a[64:71], v172
  s_add_u32 m0, s64, 73728
  s_add_u32 s28, s65, 8192
  buffer_load_dwordx4 v178, s[8:11], s28 offen sc1 lds
  v_smfmac_f32_16x16x64_bf16 v[48:51], v[36:39], a[144:151], v172
  v_smfmac_f32_16x16x64_bf16 v[52:55], v[36:39], a[224:231], v172
  s_add_u32 m0, s64, 74752
  s_add_u32 s28, s65, 9216
  buffer_load_dwordx4 v178, s[8:11], s28 offen sc1 lds
  v_smfmac_f32_16x16x64_bf16 v[56:59], v[36:39], v[240:247], v172
  s_waitcnt lgkmcnt(0)
  v_smfmac_f32_16x16x64_bf16 v[44:47], v[40:43], a[72:79], v172
  v_smfmac_f32_16x16x64_bf16 v[48:51], v[40:43], a[152:159], v172
  v_smfmac_f32_16x16x64_bf16 v[52:55], v[40:43], a[232:239], v172
  v_smfmac_f32_16x16x64_bf16 v[56:59], v[40:43], v[248:255], v172
  s_xor_b32 s63, s63, 0x4000
  s_add_u32 s50, s50, 1310720
  s_nop 9
  v_permlane32_swap_b32 v44, v48
  v_permlane32_swap_b32 v45, v49
  v_permlane32_swap_b32 v46, v50
  v_permlane32_swap_b32 v47, v51
  v_permlane32_swap_b32 v52, v56
  v_permlane32_swap_b32 v53, v57
  v_permlane32_swap_b32 v54, v58
  v_permlane32_swap_b32 v55, v59
  v_add_f32 v44, v44, v48
  v_add_f32 v45, v45, v49
  v_add_f32 v46, v46, v50
  v_add_f32 v47, v47, v51
  v_add_f32 v52, v52, v56
  v_add_f32 v53, v53, v57
  v_add_f32 v54, v54, v58
  v_add_f32 v55, v55, v59
  v_cvt_pk_bf16_f32 v64, v44, v45
  v_cvt_pk_bf16_f32 v65, v46, v47
  v_cvt_pk_bf16_f32 v66, v52, v53
  v_cvt_pk_bf16_f32 v67, v54, v55
  ds_write_b128 v179, v[64:67]
  v_mov_b32 v44, 0
  v_mov_b32 v45, 0
  v_mov_b32 v46, 0
  v_mov_b32 v47, 0
  v_mov_b32 v48, 0
  v_mov_b32 v49, 0
  v_mov_b32 v50, 0
  v_mov_b32 v51, 0
  v_mov_b32 v52, 0
  v_mov_b32 v53, 0
  v_mov_b32 v54, 0
  v_mov_b32 v55, 0
  v_mov_b32 v56, 0
  v_mov_b32 v57, 0
  v_mov_b32 v58, 0
  v_mov_b32 v59, 0
  s_waitcnt vmcnt(0) lgkmcnt(0)
  s_barrier
  ds_read_b128 v[60:63], v180
  s_cmp_eq_u32 s51, 0
  s_cbranch_scc1 yt_95_\sfx\()
  ds_read_b128 v[68:71], v181 offset:0
  ds_read_b128 v[72:75], v181 offset:2048
  ds_read_b128 v[76:79], v181 offset:4096
  ds_read_b128 v[80:83], v181 offset:6144
  ds_read_b128 v[84:87], v181 offset:8192
  ds_read_b128 v[88:91], v181 offset:10240
  ds_read_b128 v[92:95], v181 offset:12288
  ds_read_b128 v[96:99], v181 offset:14336
  s_mov_b32 s45, 0
ytp_96_\sfx\():
  s_waitcnt lgkmcnt(0)
  ds_read_b128 v[100:103], v183 offset:0
  ds_read_b128 v[104:107], v183 offset:2048
  ds_read_b128 v[108:111], v183 offset:4096
  ds_read_b128 v[112:115], v183 offset:6144
  ds_read_b128 v[116:119], v183 offset:8192
  ds_read_b128 v[120:123], v183 offset:10240
  ds_read_b128 v[124:127], v183 offset:12288
  ds_read_b128 v[128:131], v183 offset:14336
  ds_read_b128 v[132:135], v183 offset:16384
  ds_read_b128 v[136:139], v183 offset:18432
  s_waitcnt lgkmcnt(0)
  v_max_u32 v190, v100, v102
  v_max3_u32 v190, v190, v104, v106
  v_max3_u32 v190, v190, v108, v110
  v_max3_u32 v190, v190, v112, v114
  v_max3_u32 v190, v190, v116, v118
  v_max3_u32 v190, v190, v120, v122
  v_max3_u32 v190, v190, v124, v126
  v_max3_u32 v190, v190, v128, v130
  v_max3_u32 v190, v190, v132, v134
  v_max3_u32 v190, v190, v136, v138
  v_cmp_eq_u32 vcc, -1, v190
  s_cbranch_vccz ytp_96_ok_\sfx\()
  s_add_u32 s45, s45, 1
  s_cmp_lt_u32 s45, 400000
  s_cbranch_scc0 ka\sfx\()_abort
ytp_96_dma_\sfx\():
  s_mov_b32 m0, 65536
  s_add_u32 s28, s61, 0
  buffer_load_dwordx4 v178, s[8:11], s28 offen sc1 lds
  s_mov_b32 m0, 66560
  s_add_u32 s28, s61, 1024
  buffer_load_dwordx4 v178, s[8:11], s28 offen sc1 lds
  s_mov_b32 m0, 67584
  s_add_u32 s28, s61, 2048
  buffer_load_dwordx4 v178, s[8:11], s28 offen sc1 lds
  s_mov_b32 m0, 68608
  s_add_u32 s28, s61, 3072
  buffer_load_dwordx4 v178, s[8:11], s28 offen sc1 lds
  s_mov_b32 m0, 69632
  s_add_u32 s28, s61, 4096
  buffer_load_dwordx4 v178, s[8:11], s28 offen sc1 lds
  s_mov_b32 m0, 70656
  s_add_u32 s28, s61, 5120
  buffer_load_dwordx4 v178, s[8:11], s28 offen sc1 lds
  s_mov_b32 m0, 71680
  s_add_u32 s28, s61, 6144
  buffer_load_dwordx4 v178, s[8:11], s28 offen sc1 lds
  s_mov_b32 m0, 72704
  s_add_u32 s28, s61, 7168
  buffer_load_dwordx4 v178, s[8:11], s28 offen sc1 lds
  s_mov_b32 m0, 73728
  s_add_u32 s28, s61, 8192
  buffer_load_dwordx4 v178, s[8:11], s28 offen sc1 lds
  s_mov_b32 m0, 74752
  s_add_u32 s28, s61, 9216
  buffer_load_dwordx4 v178, s[8:11], s28 offen sc1 lds
  s_mov_b32 m0, 75776
  s_add_u32 s28, s61, 10240
  buffer_load_dwordx4 v178, s[8:11], s28 offen sc1 lds
  s_mov_b32 m0, 76800
  s_add_u32 s28, s61, 11264
  buffer_load_dwordx4 v178, s[8:11], s28 offen sc1 lds
  s_mov_b32 m0, 77824
  s_add_u32 s28, s61, 12288
  buffer_load_dwordx4 v178, s[8:11], s28 offen sc1 lds
  s_mov_b32 m0, 78848
  s_add_u32 s28, s61, 13312
  buffer_load_dwordx4 v178, s[8:11], s28 offen sc1 lds
  s_mov_b32 m0, 79872
  s_add_u32 s28, s61, 14336
  buffer_load_dwordx4 v178, s[8:11], s28 offen sc1 lds
  s_mov_b32 m0, 80896
  s_add_u32 s28, s61, 15360
  buffer_load_dwordx4 v178, s[8:11], s28 offen sc1 lds
  s_mov_b32 m0, 81920
  s_add_u32 s28, s61, 16384
  buffer_load_dwordx4 v178, s[8:11], s28 offen sc1 lds
  s_mov_b32 m0, 82944
  s_add_u32 s28, s61, 17408
  buffer_load_dwordx4 v178, s[8:11], s28 offen sc1 lds
  s_mov_b32 m0, 83968
  s_add_u32 s28, s61, 18432
  buffer_load_dwordx4 v178, s[8:11], s28 offen sc1 lds
  s_mov_b32 m0, 84992
  s_add_u32 s28, s61, 19456
  buffer_load_dwordx4 v178, s[8:11], s28 offen sc1 lds
  s_waitcnt vmcnt(0)
  s_branch ytp_96_\sfx\()
ytp_96_ok_\sfx\():
  v_mfma_f32_16x16x32_bf16 v[140:143], v[68:71], v[100:103], 0
  v_mfma_f32_16x16x32_bf16 v[140:143], v[72:75], v[104:107], v[140:143]
  v_mfma_f32_16x16x32_bf16 v[140:143], v[76:79], v[108:111], v[140:143]
  v_mfma_f32_16x16x32_bf16 v[140:143], v[80:83], v[112:115], v[140:143]
  v_mfma_f32_16x16x32_bf16 v[140:143], v[84:87], v[116:119], v[140:143]
  v_mfma_f32_16x16x32_bf16 v[140:143], v[88:91], v[120:123], v[140:143]
  v_mfma_f32_16x16x32_bf16 v[140:143], v[92:95], v[124:127], v[140:143]
  v_mfma_f32_16x16x32_bf16 v[140:143], v[96:99], v[128:131], v[140:143]
  v_mfma_f32_16x16x32_bf16 v[140:143], v[148:151], v[132:135], v[140:143]
  v_mfma_f32_16x16x32_bf16 v[140:143], v[152:155], v[136:139], v[140:143]
  s_nop 8
  v_cvt_pk_bf16_f32 v144, v140, v141
  v_cvt_pk_bf16_f32 v145, v142, v143
  s_add_u32 s28, s62, 0
  buffer_store_dwordx2 v[144:145], v189, s[8:11], s28 offen
  s_nop 1
  s_mov_b32 s45, 0
ytp_97_\sfx\():
  s_waitcnt lgkmcnt(0)
  ds_read_b128 v[100:103], v183 offset:1024
  ds_read_b128 v[104:107], v183 offset:3072
  ds_read_b128 v[108:111], v183 offset:5120
  ds_read_b128 v[112:115], v183 offset:7168
  ds_read_b128 v[116:119], v183 offset:9216
  ds_read_b128 v[120:123], v183 offset:11264
  ds_read_b128 v[124:127], v183 offset:13312
  ds_read_b128 v[128:131], v183 offset:15360
  ds_read_b128 v[132:135], v183 offset:17408
  ds_read_b128 v[136:139], v183 offset:19456
  s_waitcnt lgkmcnt(0)
  v_max_u32 v190, v100, v102
  v_max3_u32 v190, v190, v104, v106
  v_max3_u32 v190, v190, v108, v110
  v_max3_u32 v190, v190, v112, v114
  v_max3_u32 v190, v190, v116, v118
  v_max3_u32 v190, v190, v120, v122
  v_max3_u32 v190, v190, v124, v126
  v_max3_u32 v190, v190, v128, v130
  v_max3_u32 v190, v190, v132, v134
  v_max3_u32 v190, v190, v136, v138
  v_cmp_eq_u32 vcc, -1, v190
  s_cbranch_vccz ytp_97_ok_\sfx\()
  s_add_u32 s45, s45, 1
  s_cmp_lt_u32 s45, 400000
  s_cbranch_scc0 ka\sfx\()_abort
ytp_97_dma_\sfx\():
  s_mov_b32 m0, 65536
  s_add_u32 s28, s61, 0
  buffer_load_dwordx4 v178, s[8:11], s28 offen sc1 lds
  s_mov_b32 m0, 66560
  s_add_u32 s28, s61, 1024
  buffer_load_dwordx4 v178, s[8:11], s28 offen sc1 lds
  s_mov_b32 m0, 67584
  s_add_u32 s28, s61, 2048
  buffer_load_dwordx4 v178, s[8:11], s28 offen sc1 lds
  s_mov_b32 m0, 68608
  s_add_u32 s28, s61, 3072
  buffer_load_dwordx4 v178, s[8:11], s28 offen sc1 lds
  s_mov_b32 m0, 69632
  s_add_u32 s28, s61, 4096
  buffer_load_dwordx4 v178, s[8:11], s28 offen sc1 lds
  s_mov_b32 m0, 70656
  s_add_u32 s28, s61, 5120
  buffer_load_dwordx4 v178, s[8:11], s28 offen sc1 lds
  s_mov_b32 m0, 71680
  s_add_u32 s28, s61, 6144
  buffer_load_dwordx4 v178, s[8:11], s28 offen sc1 lds
  s_mov_b32 m0, 72704
  s_add_u32 s28, s61, 7168
  buffer_load_dwordx4 v178, s[8:11], s28 offen sc1 lds
  s_mov_b32 m0, 73728
  s_add_u32 s28, s61, 8192
  buffer_load_dwordx4 v178, s[8:11], s28 offen sc1 lds
  s_mov_b32 m0, 74752
  s_add_u32 s28, s61, 9216
  buffer_load_dwordx4 v178, s[8:11], s28 offen sc1 lds
  s_mov_b32 m0, 75776
  s_add_u32 s28, s61, 10240
  buffer_load_dwordx4 v178, s[8:11], s28 offen sc1 lds
  s_mov_b32 m0, 76800
  s_add_u32 s28, s61, 11264
  buffer_load_dwordx4 v178, s[8:11], s28 offen sc1 lds
  s_mov_b32 m0, 77824
  s_add_u32 s28, s61, 12288
  buffer_load_dwordx4 v178, s[8:11], s28 offen sc1 lds
  s_mov_b32 m0, 78848
  s_add_u32 s28, s61, 13312
  buffer_load_dwordx4 v178, s[8:11], s28 offen sc1 lds
  s_mov_b32 m0, 79872
  s_add_u32 s28, s61, 14336
  buffer_load_dwordx4 v178, s[8:11], s28 offen sc1 lds
  s_mov_b32 m0, 80896
  s_add_u32 s28, s61, 15360
  buffer_load_dwordx4 v178, s[8:11], s28 offen sc1 lds
  s_mov_b32 m0, 81920
  s_add_u32 s28, s61, 16384
  buffer_load_dwordx4 v178, s[8:11], s28 offen sc1 lds
  s_mov_b32 m0, 82944
  s_add_u32 s28, s61, 17408
  buffer_load_dwordx4 v178, s[8:11], s28 offen sc1 lds
  s_mov_b32 m0, 83968
  s_add_u32 s28, s61, 18432
  buffer_load_dwordx4 v178, s[8:11], s28 offen sc1 lds
  s_mov_b32 m0, 84992
  s_add_u32 s28, s61, 19456
  buffer_load_dwordx4 v178, s[8:11], s28 offen sc1 lds
  s_waitcnt vmcnt(0)
  s_branch ytp_97_\sfx\()
ytp_97_ok_\sfx\():
  v_mfma_f32_16x16x32_bf16 v[140:143], v[68:71], v[100:103], 0
  v_mfma_f32_16x16x32_bf16 v[140:143], v[72:75], v[104:107], v[140:143]
  v_mfma_f32_16x16x32_bf16 v[140:143], v[76:79], v[108:111], v[140:143]
  v_mfma_f32_16x16x32_bf16 v[140:143], v[80:83], v[112:115], v[140:143]
  v_mfma_f32_16x16x32_bf16 v[140:143], v[84:87], v[116:119], v[140:143]
  v_mfma_f32_16x16x32_bf16 v[140:143], v[88:91], v[120:123], v[140:143]
  v_mfma_f32_16x16x32_bf16 v[140:143], v[92:95], v[124:127], v[140:143]
  v_mfma_f32_16x16x32_bf16 v[140:143], v[96:99], v[128:131], v[140:143]
  v_mfma_f32_16x16x32_bf16 v[140:143], v[148:151], v[132:135], v[140:143]
  v_mfma_f32_16x16x32_bf16 v[140:143], v[152:155], v[136:139], v[140:143]
  s_nop 8
  v_cvt_pk_bf16_f32 v144, v140, v141
  v_cvt_pk_bf16_f32 v145, v142, v143
  s_add_u32 s28, s62, 256
  buffer_store_dwordx2 v[144:145], v189, s[8:11], s28 offen
  s_nop 1
  s_add_u32 s61, s61, 20480
  s_add_u32 s62, s62, 40960
  s_add_u32 s54, s54, 1
  v_xor_b32 v181, 0x4000, v181
yt_95_\sfx\():
  s_waitcnt lgkmcnt(0)
  v_mov_b32 v148, v60
  v_mov_b32 v149, v61
  v_mov_b32 v150, v62
  v_mov_b32 v151, v63
  v_mov_b32 v152, v64
  v_mov_b32 v153, v65
  v_mov_b32 v154, v66
  v_mov_b32 v155, v67
  s_add_u32 s97, s97, 10240
  s_mov_b32 s48, s97
  s_add_u32 s51, s51, 1
  s_cmp_lt_u32 s51, 64
  s_cbranch_scc1 ka\sfx\()_y_tokl
  s_barrier
  ds_read_b128 v[68:71], v181 offset:0
  ds_read_b128 v[72:75], v181 offset:2048
  ds_read_b128 v[76:79], v181 offset:4096
  ds_read_b128 v[80:83], v181 offset:6144
  ds_read_b128 v[84:87], v181 offset:8192
  ds_read_b128 v[88:91], v181 offset:10240
  ds_read_b128 v[92:95], v181 offset:12288
  ds_read_b128 v[96:99], v181 offset:14336
  s_mov_b32 s45, 0
  s_branch ytp_98_dma_\sfx\()
ytp_98_\sfx\():
  s_waitcnt lgkmcnt(0)
  ds_read_b128 v[100:103], v183 offset:0
  ds_read_b128 v[104:107], v183 offset:2048
  ds_read_b128 v[108:111], v183 offset:4096
  ds_read_b128 v[112:115], v183 offset:6144
  ds_read_b128 v[116:119], v183 offset:8192
  ds_read_b128 v[120:123], v183 offset:10240
  ds_read_b128 v[124:127], v183 offset:12288
  ds_read_b128 v[128:131], v183 offset:14336
  ds_read_b128 v[132:135], v183 offset:16384
  ds_read_b128 v[136:139], v183 offset:18432
  s_waitcnt lgkmcnt(0)
  v_max_u32 v190, v100, v102
  v_max3_u32 v190, v190, v104, v106
  v_max3_u32 v190, v190, v108, v110
  v_max3_u32 v190, v190, v112, v114
  v_max3_u32 v190, v190, v116, v118
  v_max3_u32 v190, v190, v120, v122
  v_max3_u32 v190, v190, v124, v126
  v_max3_u32 v190, v190, v128, v130
  v_max3_u32 v190, v190, v132, v134
  v_max3_u32 v190, v190, v136, v138
  v_cmp_eq_u32 vcc, -1, v190
  s_cbranch_vccz ytp_98_ok_\sfx\()
  s_add_u32 s45, s45, 1
  s_cmp_lt_u32 s45, 400000
  s_cbranch_scc0 ka\sfx\()_abort
ytp_98_dma_\sfx\():
  s_mov_b32 m0, 65536
  s_add_u32 s28, s61, 0
  buffer_load_dwordx4 v178, s[8:11], s28 offen sc1 lds
  s_mov_b32 m0, 66560
  s_add_u32 s28, s61, 1024
  buffer_load_dwordx4 v178, s[8:11], s28 offen sc1 lds
  s_mov_b32 m0, 67584
  s_add_u32 s28, s61, 2048
  buffer_load_dwordx4 v178, s[8:11], s28 offen sc1 lds
  s_mov_b32 m0, 68608
  s_add_u32 s28, s61, 3072
  buffer_load_dwordx4 v178, s[8:11], s28 offen sc1 lds
  s_mov_b32 m0, 69632
  s_add_u32 s28, s61, 4096
  buffer_load_dwordx4 v178, s[8:11], s28 offen sc1 lds
  s_mov_b32 m0, 70656
  s_add_u32 s28, s61, 5120
  buffer_load_dwordx4 v178, s[8:11], s28 offen sc1 lds
  s_mov_b32 m0, 71680
  s_add_u32 s28, s61, 6144
  buffer_load_dwordx4 v178, s[8:11], s28 offen sc1 lds
  s_mov_b32 m0, 72704
  s_add_u32 s28, s61, 7168
  buffer_load_dwordx4 v178, s[8:11], s28 offen sc1 lds
  s_mov_b32 m0, 73728
  s_add_u32 s28, s61, 8192
  buffer_load_dwordx4 v178, s[8:11], s28 offen sc1 lds
  s_mov_b32 m0, 74752
  s_add_u32 s28, s61, 9216
  buffer_load_dwordx4 v178, s[8:11], s28 offen sc1 lds
  s_mov_b32 m0, 75776
  s_add_u32 s28, s61, 10240
  buffer_load_dwordx4 v178, s[8:11], s28 offen sc1 lds
  s_mov_b32 m0, 76800
  s_add_u32 s28, s61, 11264
  buffer_load_dwordx4 v178, s[8:11], s28 offen sc1 lds
  s_mov_b32 m0, 77824
  s_add_u32 s28, s61, 12288
  buffer_load_dwordx4 v178, s[8:11], s28 offen sc1 lds
  s_mov_b32 m0, 78848
  s_add_u32 s28, s61, 13312
  buffer_load_dwordx4 v178, s[8:11], s28 offen sc1 lds
  s_mov_b32 m0, 79872
  s_add_u32 s28, s61, 14336
  buffer_load_dwordx4 v178, s[8:11], s28 offen sc1 lds
  s_mov_b32 m0, 80896
  s_add_u32 s28, s61, 15360
  buffer_load_dwordx4 v178, s[8:11], s28 offen sc1 lds
  s_mov_b32 m0, 81920
  s_add_u32 s28, s61, 16384
  buffer_load_dwordx4 v178, s[8:11], s28 offen sc1 lds
  s_mov_b32 m0, 82944
  s_add_u32 s28, s61, 17408
  buffer_load_dwordx4 v178, s[8:11], s28 offen sc1 lds
  s_mov_b32 m0, 83968
  s_add_u32 s28, s61, 18432
  buffer_load_dwordx4 v178, s[8:11], s28 offen sc1 lds
  s_mov_b32 m0, 84992
  s_add_u32 s28, s61, 19456
  buffer_load_dwordx4 v178, s[8:11], s28 offen sc1 lds
  s_waitcnt vmcnt(0)
  s_branch ytp_98_\sfx\()
ytp_98_ok_\sfx\():
  v_mfma_f32_16x16x32_bf16 v[140:143], v[68:71], v[100:103], 0
  v_mfma_f32_16x16x32_bf16 v[140:143], v[72:75], v[104:107], v[140:143]
  v_mfma_f32_16x16x32_bf16 v[140:143], v[76:79], v[108:111], v[140:143]
  v_mfma_f32_16x16x32_bf16 v[140:143], v[80:83], v[112:115], v[140:143]
  v_mfma_f32_16x16x32_bf16 v[140:143], v[84:87], v[116:119], v[140:143]
  v_mfma_f32_16x16x32_bf16 v[140:143], v[88:91], v[120:123], v[140:143]
  v_mfma_f32_16x16x32_bf16 v[140:143], v[92:95], v[124:127], v[140:143]
  v_mfma_f32_16x16x32_bf16 v[140:143], v[96:99], v[128:131], v[140:143]
  v_mfma_f32_16x16x32_bf16 v[140:143], v[148:151], v[132:135], v[140:143]
  v_mfma_f32_16x16x32_bf16 v[140:143], v[152:155], v[136:139], v[140:143]
  s_nop 8
  v_cvt_pk_bf16_f32 v144, v140, v141
  v_cvt_pk_bf16_f32 v145, v142, v143
  s_add_u32 s28, s62, 0
  buffer_store_dwordx2 v[144:145], v189, s[8:11], s28 offen
  s_nop 1
  s_mov_b32 s45, 0
ytp_99_\sfx\():
  s_waitcnt lgkmcnt(0)
  ds_read_b128 v[100:103], v183 offset:1024
  ds_read_b128 v[104:107], v183 offset:3072
  ds_read_b128 v[108:111], v183 offset:5120
  ds_read_b128 v[112:115], v183 offset:7168
  ds_read_b128 v[116:119], v183 offset:9216
  ds_read_b128 v[120:123], v183 offset:11264
  ds_read_b128 v[124:127], v183 offset:13312
  ds_read_b128 v[128:131], v183 offset:15360
  ds_read_b128 v[132:135], v183 offset:17408
  ds_read_b128 v[136:139], v183 offset:19456
  s_waitcnt lgkmcnt(0)
  v_max_u32 v190, v100, v102
  v_max3_u32 v190, v190, v104, v106
  v_max3_u32 v190, v190, v108, v110
  v_max3_u32 v190, v190, v112, v114
  v_max3_u32 v190, v190, v116, v118
  v_max3_u32 v190, v190, v120, v122
  v_max3_u32 v190, v190, v124, v126
  v_max3_u32 v190, v190, v128, v130
  v_max3_u32 v190, v190, v132, v134
  v_max3_u32 v190, v190, v136, v138
  v_cmp_eq_u32 vcc, -1, v190
  s_cbranch_vccz ytp_99_ok_\sfx\()
  s_add_u32 s45, s45, 1
  s_cmp_lt_u32 s45, 400000
  s_cbranch_scc0 ka\sfx\()_abort
ytp_99_dma_\sfx\():
  s_mov_b32 m0, 65536
  s_add_u32 s28, s61, 0
  buffer_load_dwordx4 v178, s[8:11], s28 offen sc1 lds
  s_mov_b32 m0, 66560
  s_add_u32 s28, s61, 1024
  buffer_load_dwordx4 v178, s[8:11], s28 offen sc1 lds
  s_mov_b32 m0, 67584
  s_add_u32 s28, s61, 2048
  buffer_load_dwordx4 v178, s[8:11], s28 offen sc1 lds
  s_mov_b32 m0, 68608
  s_add_u32 s28, s61, 3072
  buffer_load_dwordx4 v178, s[8:11], s28 offen sc1 lds
  s_mov_b32 m0, 69632
  s_add_u32 s28, s61, 4096
  buffer_load_dwordx4 v178, s[8:11], s28 offen sc1 lds
  s_mov_b32 m0, 70656
  s_add_u32 s28, s61, 5120
  buffer_load_dwordx4 v178, s[8:11], s28 offen sc1 lds
  s_mov_b32 m0, 71680
  s_add_u32 s28, s61, 6144
  buffer_load_dwordx4 v178, s[8:11], s28 offen sc1 lds
  s_mov_b32 m0, 72704
  s_add_u32 s28, s61, 7168
  buffer_load_dwordx4 v178, s[8:11], s28 offen sc1 lds
  s_mov_b32 m0, 73728
  s_add_u32 s28, s61, 8192
  buffer_load_dwordx4 v178, s[8:11], s28 offen sc1 lds
  s_mov_b32 m0, 74752
  s_add_u32 s28, s61, 9216
  buffer_load_dwordx4 v178, s[8:11], s28 offen sc1 lds
  s_mov_b32 m0, 75776
  s_add_u32 s28, s61, 10240
  buffer_load_dwordx4 v178, s[8:11], s28 offen sc1 lds
  s_mov_b32 m0, 76800
  s_add_u32 s28, s61, 11264
  buffer_load_dwordx4 v178, s[8:11], s28 offen sc1 lds
  s_mov_b32 m0, 77824
  s_add_u32 s28, s61, 12288
  buffer_load_dwordx4 v178, s[8:11], s28 offen sc1 lds
  s_mov_b32 m0, 78848
  s_add_u32 s28, s61, 13312
  buffer_load_dwordx4 v178, s[8:11], s28 offen sc1 lds
  s_mov_b32 m0, 79872
  s_add_u32 s28, s61, 14336
  buffer_load_dwordx4 v178, s[8:11], s28 offen sc1 lds
  s_mov_b32 m0, 80896
  s_add_u32 s28, s61, 15360
  buffer_load_dwordx4 v178, s[8:11], s28 offen sc1 lds
  s_mov_b32 m0, 81920
  s_add_u32 s28, s61, 16384
  buffer_load_dwordx4 v178, s[8:11], s28 offen sc1 lds
  s_mov_b32 m0, 82944
  s_add_u32 s28, s61, 17408
  buffer_load_dwordx4 v178, s[8:11], s28 offen sc1 lds
  s_mov_b32 m0, 83968
  s_add_u32 s28, s61, 18432
  buffer_load_dwordx4 v178, s[8:11], s28 offen sc1 lds
  s_mov_b32 m0, 84992
  s_add_u32 s28, s61, 19456
  buffer_load_dwordx4 v178, s[8:11], s28 offen sc1 lds
  s_waitcnt vmcnt(0)
  s_branch ytp_99_\sfx\()
ytp_99_ok_\sfx\():
  v_mfma_f32_16x16x32_bf16 v[140:143], v[68:71], v[100:103], 0
  v_mfma_f32_16x16x32_bf16 v[140:143], v[72:75], v[104:107], v[140:143]
  v_mfma_f32_16x16x32_bf16 v[140:143], v[76:79], v[108:111], v[140:143]
  v_mfma_f32_16x16x32_bf16 v[140:143], v[80:83], v[112:115], v[140:143]
  v_mfma_f32_16x16x32_bf16 v[140:143], v[84:87], v[116:119], v[140:143]
  v_mfma_f32_16x16x32_bf16 v[140:143], v[88:91], v[120:123], v[140:143]
  v_mfma_f32_16x16x32_bf16 v[140:143], v[92:95], v[124:127], v[140:143]
  v_mfma_f32_16x16x32_bf16 v[140:143], v[96:99], v[128:131], v[140:143]
  v_mfma_f32_16x16x32_bf16 v[140:143], v[148:151], v[132:135], v[140:143]
  v_mfma_f32_16x16x32_bf16 v[140:143], v[152:155], v[136:139], v[140:143]
  s_nop 8
  v_cvt_pk_bf16_f32 v144, v140, v141
  v_cvt_pk_bf16_f32 v145, v142, v143
  s_add_u32 s28, s62, 256
  buffer_store_dwordx2 v[144:145], v189, s[8:11], s28 offen
  s_nop 1
  s_add_u32 s61, s61, 20480
  s_add_u32 s62, s62, 40960
  s_add_u32 s54, s54, 1
  v_xor_b32 v181, 0x4000, v181
  s_waitcnt vmcnt(0)
  s_branch ka\sfx\()_exit
ka\sfx\()_abort:
  s_branch ka_abort
ka\sfx\()_exit:
  s_branch ka_exit
.endm
CHAINROLES f,
CHAINROLES s, sc1
ka_abort:
  s_load_dwordx2 s[6:7], s[0:1], 88
  v_mov_b32 v2, 80
  v_mov_b32 v3, 1
  s_waitcnt lgkmcnt(0)
  s_mov_b64 exec, 1
  global_atomic_add v2, v3, s[6:7]
  s_waitcnt vmcnt(0)
ka_exit:
  s_endpgm

.section .rodata,"a"
.p2align 6
.amdhsa_kernel ka2_kernel
  .amdhsa_next_free_vgpr 512
  .amdhsa_next_free_sgpr 102
  .amdhsa_accum_offset 256
  .amdhsa_group_segment_fixed_size 0
  .amdhsa_kernarg_size 104
  .amdhsa_user_sgpr_count 2
  .amdhsa_user_sgpr_kernarg_segment_ptr 1
  .amdhsa_system_sgpr_workgroup_id_x 1
.end_amdhsa_kernel
.text
.globl kb2_kernel
.p2align 8
.type kb2_kernel,@function
kb2_kernel:
  s_cmp_ge_u32 s2, 256
  s_cbranch_scc1 kb2_exit
  s_load_dwordx2 s[36:37], s[0:1], 0
  s_load_dwordx2 s[38:39], s[0:1], 80
  s_load_dwordx2 s[4:5], s[0:1], 96
  v_lshrrev_b32 v1, 6, v0
  s_nop 0
  v_readfirstlane_b32 s21, v1
  v_and_b32 v1, 63, v0
  v_lshlrev_b32 v2, 4, v1
  s_waitcnt lgkmcnt(0)
  s_mov_b32 s8, s4
  s_and_b32 s9, s5, 0xffff
  s_mov_b32 s10, 0x10000000
  s_mov_b32 s11, 0x20000
  s_mov_b32 s12, s36
  s_and_b32 s13, s37, 0xffff
  s_mov_b32 s14, 0x280000
  s_mov_b32 s15, 0x20000
  s_mov_b32 s16, s38
  s_and_b32 s17, s39, 0xffff
  s_mov_b32 s18, 0x280000
  s_mov_b32 s19, 0x20000
  s_and_b32 s22, s2, 7
  s_lshl_b32 s22, s22, 2
  s_bfe_u32 s23, s2, 0x20003
  s_add_u32 s22, s22, s23
  s_lshr_b32 s23, s2, 5
  s_lshl_b32 s46, s23, 7
  s_add_u32 s46, s46, 0xa000
  s_add_u32 s48, s46, 0x1400
  s_lshl_b32 s47, s22, 7
  s_add_u32 s47, s47, 0xa400
  s_lshr_b32 s26, s2, 2
  s_and_b32 s27, s2, 3
  s_lshl_b32 s27, s27, 3
  v_and_b32 v5, 7, v1
  v_bfe_u32 v6, v1, 3, 1
  v_lshrrev_b32 v7, 4, v1
  v_lshlrev_b32 v8, 5, v6
  v_add_u32 v8, v8, v5
  v_add_u32 v8, s27, v8
  v_lshlrev_b32 v8, 4, v8
  v_lshlrev_b32 v9, 11, v7
  v_add_u32 v9, v9, v8
  v_lshlrev_b32 v10, 10, v7
  v_add_u32 v10, v10, v8
  s_mul_i32 s28, s26, 81920
  s_lshl_b32 s29, s21, 13
  s_add_u32 s28, s28, s29
  s_cmp_lt_u32 s21, 2
  s_cselect_b32 s49, 3, 2
  v_mov_b32 v32, 0
  v_mov_b32 v33, 0
  v_mov_b32 v34, 0
  v_mov_b32 v35, 0
  v_mov_b32 v36, 0
  v_mov_b32 v37, 0
  v_mov_b32 v38, 0
  v_mov_b32 v39, 0
  v_mov_b32 v56, 0
  v_mov_b32 v57, 0
  v_mov_b32 v58, 0
  v_mov_b32 v59, 0
  v_mov_b32 v68, 0
  v_mov_b32 v69, 0
  v_mov_b32 v70, 0
  v_mov_b32 v71, 0
  v_mov_b32 v80, 0
  v_mov_b32 v81, 0
  v_mov_b32 v82, 0
  v_mov_b32 v83, 0
  v_mov_b32 v92, 0
  v_mov_b32 v93, 0
  v_mov_b32 v94, 0
  v_mov_b32 v95, 0
  s_mul_i32 s33, s26, 40960
  s_lshl_b32 s30, s21, 12
  s_add_u32 s33, s33, s30
  s_add_u32 s30, s33, 27262976
  buffer_load_dwordx4 v[48:51], v10, s[8:11], s30 offen
  s_add_u32 s30, s33, 29884416
  buffer_load_dwordx4 v[60:63], v10, s[8:11], s30 offen
  s_add_u32 s30, s33, 32505856
  buffer_load_dwordx4 v[72:75], v10, s[8:11], s30 offen
  s_add_u32 s30, s33, 35127296
  buffer_load_dwordx4 v[84:87], v10, s[8:11], s30 offen
  s_add_u32 s30, s28, 20971520
  buffer_load_dwordx4 v[16:19], v9, s[8:11], s30 offen
  s_add_u32 s30, s28, 20972544
  buffer_load_dwordx4 v[20:23], v9, s[8:11], s30 offen
  s_add_u32 s30, s33, 27279360
  buffer_load_dwordx4 v[52:55], v10, s[8:11], s30 offen
  s_add_u32 s30, s33, 29900800
  buffer_load_dwordx4 v[64:67], v10, s[8:11], s30 offen
  s_add_u32 s30, s33, 32522240
  buffer_load_dwordx4 v[76:79], v10, s[8:11], s30 offen
  s_add_u32 s30, s33, 35143680
  buffer_load_dwordx4 v[88:91], v10, s[8:11], s30 offen
  s_add_u32 s30, s28, 21004288
  buffer_load_dwordx4 v[24:27], v9, s[8:11], s30 offen
  s_add_u32 s30, s28, 21005312
  buffer_load_dwordx4 v[28:31], v9, s[8:11], s30 offen
  s_cmp_lt_u32 s21, 2
  s_cbranch_scc0 g3_100
  s_add_u32 s30, s33, 27295744
  buffer_load_dwordx4 v[56:59], v10, s[8:11], s30 offen
  s_add_u32 s30, s33, 29917184
  buffer_load_dwordx4 v[68:71], v10, s[8:11], s30 offen
  s_add_u32 s30, s33, 32538624
  buffer_load_dwordx4 v[80:83], v10, s[8:11], s30 offen
  s_add_u32 s30, s33, 35160064
  buffer_load_dwordx4 v[92:95], v10, s[8:11], s30 offen
  s_add_u32 s30, s28, 21037056
  buffer_load_dwordx4 v[32:35], v9, s[8:11], s30 offen
  s_add_u32 s30, s28, 21038080
  buffer_load_dwordx4 v[36:39], v9, s[8:11], s30 offen
g3_100:
  s_mul_i32 s30, s22, 122880
  s_mul_i32 s31, s21, 30720
  s_add_u32 s30, s30, s31
  s_add_u32 s30, s30, 0xe100000
  s_add_u32 m0, s31, 0
  s_add_u32 s29, s30, 0
  buffer_load_dwordx4 v2, s[8:11], s29 offen lds
  s_add_u32 m0, s31, 1024
  s_add_u32 s29, s30, 1024
  buffer_load_dwordx4 v2, s[8:11], s29 offen lds
  s_add_u32 m0, s31, 2048
  s_add_u32 s29, s30, 2048
  buffer_load_dwordx4 v2, s[8:11], s29 offen lds
  s_add_u32 m0, s31, 3072
  s_add_u32 s29, s30, 3072
  buffer_load_dwordx4 v2, s[8:11], s29 offen lds
  s_add_u32 m0, s31, 4096
  s_add_u32 s29, s30, 4096
  buffer_load_dwordx4 v2, s[8:11], s29 offen lds
  s_add_u32 m0, s31, 5120
  s_add_u32 s29, s30, 5120
  buffer_load_dwordx4 v2, s[8:11], s29 offen lds
  s_add_u32 m0, s31, 6144
  s_add_u32 s29, s30, 6144
  buffer_load_dwordx4 v2, s[8:11], s29 offen lds
  s_add_u32 m0, s31, 7168
  s_add_u32 s29, s30, 7168
  buffer_load_dwordx4 v2, s[8:11], s29 offen lds
  s_add_u32 m0, s31, 8192
  s_add_u32 s29, s30, 8192
  buffer_load_dwordx4 v2, s[8:11], s29 offen lds
  s_add_u32 m0, s31, 9216
  s_add_u32 s29, s30, 9216
  buffer_load_dwordx4 v2, s[8:11], s29 offen lds
  s_add_u32 m0, s31, 10240
  s_add_u32 s29, s30, 10240
  buffer_load_dwordx4 v2, s[8:11], s29 offen lds
  s_add_u32 m0, s31, 11264
  s_add_u32 s29, s30, 11264
  buffer_load_dwordx4 v2, s[8:11], s29 offen lds
  s_add_u32 m0, s31, 12288
  s_add_u32 s29, s30, 12288
  buffer_load_dwordx4 v2, s[8:11], s29 offen lds
  s_add_u32 m0, s31, 13312
  s_add_u32 s29, s30, 13312
  buffer_load_dwordx4 v2, s[8:11], s29 offen lds
  s_add_u32 m0, s31, 14336
  s_add_u32 s29, s30, 14336
  buffer_load_dwordx4 v2, s[8:11], s29 offen lds
  s_add_u32 m0, s31, 15360
  s_add_u32 s29, s30, 15360
  buffer_load_dwordx4 v2, s[8:11], s29 offen lds
  s_add_u32 m0, s31, 16384
  s_add_u32 s29, s30, 16384
  buffer_load_dwordx4 v2, s[8:11], s29 offen lds
  s_add_u32 m0, s31, 17408
  s_add_u32 s29, s30, 17408
  buffer_load_dwordx4 v2, s[8:11], s29 offen lds
  s_add_u32 m0, s31, 18432
  s_add_u32 s29, s30, 18432
  buffer_load_dwordx4 v2, s[8:11], s29 offen lds
  s_add_u32 m0, s31, 19456
  s_add_u32 s29, s30, 19456
  buffer_load_dwordx4 v2, s[8:11], s29 offen lds
  s_add_u32 m0, s31, 20480
  s_add_u32 s29, s30, 20480
  buffer_load_dwordx4 v2, s[8:11], s29 offen lds
  s_add_u32 m0, s31, 21504
  s_add_u32 s29, s30, 21504
  buffer_load_dwordx4 v2, s[8:11], s29 offen lds
  s_add_u32 m0, s31, 22528
  s_add_u32 s29, s30, 22528
  buffer_load_dwordx4 v2, s[8:11], s29 offen lds
  s_add_u32 m0, s31, 23552
  s_add_u32 s29, s30, 23552
  buffer_load_dwordx4 v2, s[8:11], s29 offen lds
  s_add_u32 m0, s31, 24576
  s_add_u32 s29, s30, 24576
  buffer_load_dwordx4 v2, s[8:11], s29 offen lds
  s_add_u32 m0, s31, 25600
  s_add_u32 s29, s30, 25600
  buffer_load_dwordx4 v2, s[8:11], s29 offen lds
  s_add_u32 m0, s31, 26624
  s_add_u32 s29, s30, 26624
  buffer_load_dwordx4 v2, s[8:11], s29 offen lds
  s_add_u32 m0, s31, 27648
  s_add_u32 s29, s30, 27648
  buffer_load_dwordx4 v2, s[8:11], s29 offen lds
  s_add_u32 m0, s31, 28672
  s_add_u32 s29, s30, 28672
  buffer_load_dwordx4 v2, s[8:11], s29 offen lds
  s_add_u32 m0, s31, 29696
  s_add_u32 s29, s30, 29696
  buffer_load_dwordx4 v2, s[8:11], s29 offen lds
  s_waitcnt vmcnt(30)
  v_lshlrev_b32 v12, 16, v48
  v_and_b32 v13, 0xffff0000, v48
  v_pk_add_f32 v[16:17], v[16:17], v[12:13]
  v_lshlrev_b32 v12, 16, v49
  v_and_b32 v13, 0xffff0000, v49
  v_pk_add_f32 v[18:19], v[18:19], v[12:13]
  v_lshlrev_b32 v12, 16, v50
  v_and_b32 v13, 0xffff0000, v50
  v_pk_add_f32 v[20:21], v[20:21], v[12:13]
  v_lshlrev_b32 v12, 16, v51
  v_and_b32 v13, 0xffff0000, v51
  v_pk_add_f32 v[22:23], v[22:23], v[12:13]
  v_lshlrev_b32 v12, 16, v52
  v_and_b32 v13, 0xffff0000, v52
  v_pk_add_f32 v[24:25], v[24:25], v[12:13]
  v_lshlrev_b32 v12, 16, v53
  v_and_b32 v13, 0xffff0000, v53
  v_pk_add_f32 v[26:27], v[26:27], v[12:13]
  v_lshlrev_b32 v12, 16, v54
  v_and_b32 v13, 0xffff0000, v54
  v_pk_add_f32 v[28:29], v[28:29], v[12:13]
  v_lshlrev_b32 v12, 16, v55
  v_and_b32 v13, 0xffff0000, v55
  v_pk_add_f32 v[30:31], v[30:31], v[12:13]
  v_lshlrev_b32 v12, 16, v56
  v_and_b32 v13, 0xffff0000, v56
  v_pk_add_f32 v[32:33], v[32:33], v[12:13]
  v_lshlrev_b32 v12, 16, v57
  v_and_b32 v13, 0xffff0000, v57
  v_pk_add_f32 v[34:35], v[34:35], v[12:13]
  v_lshlrev_b32 v12, 16, v58
  v_and_b32 v13, 0xffff0000, v58
  v_pk_add_f32 v[36:37], v[36:37], v[12:13]
  v_lshlrev_b32 v12, 16, v59
  v_and_b32 v13, 0xffff0000, v59
  v_pk_add_f32 v[38:39], v[38:39], v[12:13]
  v_lshlrev_b32 v12, 16, v60
  v_and_b32 v13, 0xffff0000, v60
  v_pk_add_f32 v[16:17], v[16:17], v[12:13]
  v_lshlrev_b32 v12, 16, v61
  v_and_b32 v13, 0xffff0000, v61
  v_pk_add_f32 v[18:19], v[18:19], v[12:13]
  v_lshlrev_b32 v12, 16, v62
  v_and_b32 v13, 0xffff0000, v62
  v_pk_add_f32 v[20:21], v[20:21], v[12:13]
  v_lshlrev_b32 v12, 16, v63
  v_and_b32 v13, 0xffff0000, v63
  v_pk_add_f32 v[22:23], v[22:23], v[12:13]
  v_lshlrev_b32 v12, 16, v64
  v_and_b32 v13, 0xffff0000, v64
  v_pk_add_f32 v[24:25], v[24:25], v[12:13]
  v_lshlrev_b32 v12, 16, v65
  v_and_b32 v13, 0xffff0000, v65
  v_pk_add_f32 v[26:27], v[26:27], v[12:13]
  v_lshlrev_b32 v12, 16, v66
  v_and_b32 v13, 0xffff0000, v66
  v_pk_add_f32 v[28:29], v[28:29], v[12:13]
  v_lshlrev_b32 v12, 16, v67
  v_and_b32 v13, 0xffff0000, v67
  v_pk_add_f32 v[30:31], v[30:31], v[12:13]
  v_lshlrev_b32 v12, 16, v68
  v_and_b32 v13, 0xffff0000, v68
  v_pk_add_f32 v[32:33], v[32:33], v[12:13]
  v_lshlrev_b32 v12, 16, v69
  v_and_b32 v13, 0xffff0000, v69
  v_pk_add_f32 v[34:35], v[34:35], v[12:13]
  v_lshlrev_b32 v12, 16, v70
  v_and_b32 v13, 0xffff0000, v70
  v_pk_add_f32 v[36:37], v[36:37], v[12:13]
  v_lshlrev_b32 v12, 16, v71
  v_and_b32 v13, 0xffff0000, v71
  v_pk_add_f32 v[38:39], v[38:39], v[12:13]
  v_lshlrev_b32 v12, 16, v72
  v_and_b32 v13, 0xffff0000, v72
  v_pk_add_f32 v[16:17], v[16:17], v[12:13]
  v_lshlrev_b32 v12, 16, v73
  v_and_b32 v13, 0xffff0000, v73
  v_pk_add_f32 v[18:19], v[18:19], v[12:13]
  v_lshlrev_b32 v12, 16, v74
  v_and_b32 v13, 0xffff0000, v74
  v_pk_add_f32 v[20:21], v[20:21], v[12:13]
  v_lshlrev_b32 v12, 16, v75
  v_and_b32 v13, 0xffff0000, v75
  v_pk_add_f32 v[22:23], v[22:23], v[12:13]
  v_lshlrev_b32 v12, 16, v76
  v_and_b32 v13, 0xffff0000, v76
  v_pk_add_f32 v[24:25], v[24:25], v[12:13]
  v_lshlrev_b32 v12, 16, v77
  v_and_b32 v13, 0xffff0000, v77
  v_pk_add_f32 v[26:27], v[26:27], v[12:13]
  v_lshlrev_b32 v12, 16, v78
  v_and_b32 v13, 0xffff0000, v78
  v_pk_add_f32 v[28:29], v[28:29], v[12:13]
  v_lshlrev_b32 v12, 16, v79
  v_and_b32 v13, 0xffff0000, v79
  v_pk_add_f32 v[30:31], v[30:31], v[12:13]
  v_lshlrev_b32 v12, 16, v80
  v_and_b32 v13, 0xffff0000, v80
  v_pk_add_f32 v[32:33], v[32:33], v[12:13]
  v_lshlrev_b32 v12, 16, v81
  v_and_b32 v13, 0xffff0000, v81
  v_pk_add_f32 v[34:35], v[34:35], v[12:13]
  v_lshlrev_b32 v12, 16, v82
  v_and_b32 v13, 0xffff0000, v82
  v_pk_add_f32 v[36:37], v[36:37], v[12:13]
  v_lshlrev_b32 v12, 16, v83
  v_and_b32 v13, 0xffff0000, v83
  v_pk_add_f32 v[38:39], v[38:39], v[12:13]
  v_lshlrev_b32 v12, 16, v84
  v_and_b32 v13, 0xffff0000, v84
  v_pk_add_f32 v[16:17], v[16:17], v[12:13]
  v_lshlrev_b32 v12, 16, v85
  v_and_b32 v13, 0xffff0000, v85
  v_pk_add_f32 v[18:19], v[18:19], v[12:13]
  v_lshlrev_b32 v12, 16, v86
  v_and_b32 v13, 0xffff0000, v86
  v_pk_add_f32 v[20:21], v[20:21], v[12:13]
  v_lshlrev_b32 v12, 16, v87
  v_and_b32 v13, 0xffff0000, v87
  v_pk_add_f32 v[22:23], v[22:23], v[12:13]
  v_lshlrev_b32 v12, 16, v88
  v_and_b32 v13, 0xffff0000, v88
  v_pk_add_f32 v[24:25], v[24:25], v[12:13]
  v_lshlrev_b32 v12, 16, v89
  v_and_b32 v13, 0xffff0000, v89
  v_pk_add_f32 v[26:27], v[26:27], v[12:13]
  v_lshlrev_b32 v12, 16, v90
  v_and_b32 v13, 0xffff0000, v90
  v_pk_add_f32 v[28:29], v[28:29], v[12:13]
  v_lshlrev_b32 v12, 16, v91
  v_and_b32 v13, 0xffff0000, v91
  v_pk_add_f32 v[30:31], v[30:31], v[12:13]
  v_lshlrev_b32 v12, 16, v92
  v_and_b32 v13, 0xffff0000, v92
  v_pk_add_f32 v[32:33], v[32:33], v[12:13]
  v_lshlrev_b32 v12, 16, v93
  v_and_b32 v13, 0xffff0000, v93
  v_pk_add_f32 v[34:35], v[34:35], v[12:13]
  v_lshlrev_b32 v12, 16, v94
  v_and_b32 v13, 0xffff0000, v94
  v_pk_add_f32 v[36:37], v[36:37], v[12:13]
  v_lshlrev_b32 v12, 16, v95
  v_and_b32 v13, 0xffff0000, v95
  v_pk_add_f32 v[38:39], v[38:39], v[12:13]
  s_add_u32 s30, s28, 20971520
  buffer_store_dwordx4 v[16:19], v9, s[8:11], s30 offen sc1
  s_add_u32 s30, s28, 20972544
  buffer_store_dwordx4 v[20:23], v9, s[8:11], s30 offen sc1
  s_add_u32 s30, s28, 21004288
  buffer_store_dwordx4 v[24:27], v9, s[8:11], s30 offen sc1
  s_add_u32 s30, s28, 21005312
  buffer_store_dwordx4 v[28:31], v9, s[8:11], s30 offen sc1
  s_cmp_lt_u32 s21, 2
  s_cbranch_scc0 g3_101
  s_add_u32 s30, s28, 21037056
  buffer_store_dwordx4 v[32:35], v9, s[8:11], s30 offen sc1
  s_add_u32 s30, s28, 21038080
  buffer_store_dwordx4 v[36:39], v9, s[8:11], s30 offen sc1
g3_101:
  v_add_f32 v12, v16, v17
  v_add_f32 v12, v12, v18
  v_add_f32 v12, v12, v19
  v_add_f32 v12, v12, v20
  v_add_f32 v12, v12, v21
  v_add_f32 v12, v12, v22
  v_add_f32 v12, v12, v23
  v_add_f32 v12, v12, v24
  v_add_f32 v12, v12, v25
  v_add_f32 v12, v12, v26
  v_add_f32 v12, v12, v27
  v_add_f32 v12, v12, v28
  v_add_f32 v12, v12, v29
  v_add_f32 v12, v12, v30
  v_add_f32 v12, v12, v31
  v_add_f32 v12, v12, v32
  v_add_f32 v12, v12, v33
  v_add_f32 v12, v12, v34
  v_add_f32 v12, v12, v35
  v_add_f32 v12, v12, v36
  v_add_f32 v12, v12, v37
  v_add_f32 v12, v12, v38
  v_add_f32 v12, v12, v39
  s_nop 1
  v_add_f32_dpp v12, v12, v12 row_ror:8 row_mask:0xf bank_mask:0xf
  v_mov_b32 v13, v12
  s_nop 1
  v_permlane16_swap_b32 v12, v13
  v_add_f32 v12, v12, v13
  v_mov_b32 v13, v12
  s_nop 1
  v_permlane32_swap_b32 v12, v13
  v_add_f32 v12, v12, v13
  v_lshlrev_b32 v14, 2, v5
  v_add_u32 v14, 131072, v14
  s_lshl_b32 s30, s21, 5
  v_add_u32 v15, s30, v14
  ds_write_b32 v15, v12
  s_waitcnt lgkmcnt(0)
  s_barrier
  ds_read_b32 v48, v14
  ds_read_b32 v49, v14 offset:32
  ds_read_b32 v50, v14 offset:64
  ds_read_b32 v51, v14 offset:96
  s_waitcnt lgkmcnt(0)
  v_add_f32 v48, v48, v49
  v_add_f32 v50, v50, v51
  v_add_f32 v48, v48, v50
  v_mul_f32 v48, 0x3acccccd, v48
  v_sub_f32 v56, v16, v48
  v_sub_f32 v57, v17, v48
  v_sub_f32 v58, v18, v48
  v_sub_f32 v59, v19, v48
  v_sub_f32 v60, v20, v48
  v_sub_f32 v61, v21, v48
  v_sub_f32 v62, v22, v48
  v_sub_f32 v63, v23, v48
  v_sub_f32 v64, v24, v48
  v_sub_f32 v65, v25, v48
  v_sub_f32 v66, v26, v48
  v_sub_f32 v67, v27, v48
  v_sub_f32 v68, v28, v48
  v_sub_f32 v69, v29, v48
  v_sub_f32 v70, v30, v48
  v_sub_f32 v71, v31, v48
  v_sub_f32 v72, v32, v48
  v_sub_f32 v73, v33, v48
  v_sub_f32 v74, v34, v48
  v_sub_f32 v75, v35, v48
  v_sub_f32 v76, v36, v48
  v_sub_f32 v77, v37, v48
  v_sub_f32 v78, v38, v48
  v_sub_f32 v79, v39, v48
  s_cmp_lt_u32 s21, 2
  s_cbranch_scc1 g3z_102
  v_mov_b32 v72, 0
  v_mov_b32 v73, 0
  v_mov_b32 v74, 0
  v_mov_b32 v75, 0
  v_mov_b32 v76, 0
  v_mov_b32 v77, 0
  v_mov_b32 v78, 0
  v_mov_b32 v79, 0
g3z_102:
  v_mul_f32 v12, v56, v56
  v_fmac_f32 v12, v57, v57
  v_fmac_f32 v12, v58, v58
  v_fmac_f32 v12, v59, v59
  v_fmac_f32 v12, v60, v60
  v_fmac_f32 v12, v61, v61
  v_fmac_f32 v12, v62, v62
  v_fmac_f32 v12, v63, v63
  v_fmac_f32 v12, v64, v64
  v_fmac_f32 v12, v65, v65
  v_fmac_f32 v12, v66, v66
  v_fmac_f32 v12, v67, v67
  v_fmac_f32 v12, v68, v68
  v_fmac_f32 v12, v69, v69
  v_fmac_f32 v12, v70, v70
  v_fmac_f32 v12, v71, v71
  v_fmac_f32 v12, v72, v72
  v_fmac_f32 v12, v73, v73
  v_fmac_f32 v12, v74, v74
  v_fmac_f32 v12, v75, v75
  v_fmac_f32 v12, v76, v76
  v_fmac_f32 v12, v77, v77
  v_fmac_f32 v12, v78, v78
  v_fmac_f32 v12, v79, v79
  s_nop 1
  v_add_f32_dpp v12, v12, v12 row_ror:8 row_mask:0xf bank_mask:0xf
  v_mov_b32 v13, v12
  s_nop 1
  v_permlane16_swap_b32 v12, v13
  v_add_f32 v12, v12, v13
  v_mov_b32 v13, v12
  s_nop 1
  v_permlane32_swap_b32 v12, v13
  v_add_f32 v12, v12, v13
  v_lshlrev_b32 v14, 2, v5
  v_add_u32 v14, 131328, v14
  s_lshl_b32 s30, s21, 5
  v_add_u32 v15, s30, v14
  ds_write_b32 v15, v12
  s_waitcnt lgkmcnt(0)
  s_barrier
  ds_read_b32 v48, v14
  ds_read_b32 v49, v14 offset:32
  ds_read_b32 v50, v14 offset:64
  ds_read_b32 v51, v14 offset:96
  s_waitcnt lgkmcnt(0)
  v_add_f32 v48, v48, v49
  v_add_f32 v50, v50, v51
  v_add_f32 v48, v48, v50
  v_mov_b32 v49, 0x3727c5ac
  v_fmac_f32 v49, 0x3acccccd, v48
  v_rsq_f32 v49, v49
  s_nop 0
  v_mul_f32 v56, v56, v49
  v_mul_f32 v57, v57, v49
  v_mul_f32 v58, v58, v49
  v_mul_f32 v59, v59, v49
  v_mul_f32 v60, v60, v49
  v_mul_f32 v61, v61, v49
  v_mul_f32 v62, v62, v49
  v_mul_f32 v63, v63, v49
  v_mul_f32 v64, v64, v49
  v_mul_f32 v65, v65, v49
  v_mul_f32 v66, v66, v49
  v_mul_f32 v67, v67, v49
  v_mul_f32 v68, v68, v49
  v_mul_f32 v69, v69, v49
  v_mul_f32 v70, v70, v49
  v_mul_f32 v71, v71, v49
  v_mul_f32 v72, v72, v49
  v_mul_f32 v73, v73, v49
  v_mul_f32 v74, v74, v49
  v_mul_f32 v75, v75, v49
  v_mul_f32 v76, v76, v49
  v_mul_f32 v77, v77, v49
  v_mul_f32 v78, v78, v49
  v_mul_f32 v79, v79, v49
  v_cvt_pk_bf16_f32 v80, v56, v57
  v_cvt_pk_bf16_f32 v81, v58, v59
  v_cvt_pk_bf16_f32 v82, v60, v61
  v_cvt_pk_bf16_f32 v83, v62, v63
  v_cvt_pk_bf16_f32 v84, v64, v65
  v_cvt_pk_bf16_f32 v85, v66, v67
  v_cvt_pk_bf16_f32 v86, v68, v69
  v_cvt_pk_bf16_f32 v87, v70, v71
  v_cvt_pk_bf16_f32 v88, v72, v73
  v_cvt_pk_bf16_f32 v89, v74, v75
  v_cvt_pk_bf16_f32 v90, v76, v77
  v_cvt_pk_bf16_f32 v91, v78, v79
  s_mul_i32 s30, s26, 40960
  s_lshl_b32 s31, s21, 12
  s_add_u32 s30, s30, s31
  s_add_u32 s30, s30, 0x100000
  s_add_u32 s31, s30, 0
  buffer_store_dwordx4 v[80:83], v10, s[8:11], s31 offen sc1
  s_add_u32 s31, s30, 16384
  buffer_store_dwordx4 v[84:87], v10, s[8:11], s31 offen sc1
  s_cmp_lt_u32 s21, 2
  s_cbranch_scc0 g3_103
  s_add_u32 s31, s30, 32768
  buffer_store_dwordx4 v[88:91], v10, s[8:11], s31 offen sc1
g3_103:
  s_waitcnt vmcnt(0)
  s_barrier
  s_cmp_eq_u32 s21, 0
  s_cbranch_scc0 arr_104
  s_mov_b64 s[24:25], exec
  s_mov_b64 exec, 1
  v_mov_b32 v3, 0
  v_mov_b32 v4, 1
  buffer_atomic_add v4, v3, s[8:11], s46 offen
  s_mov_b64 exec, s[24:25]
arr_104:
  s_mov_b32 s45, 0
  v_mov_b32 v3, 0
aw_105:
  buffer_load_dword v4, v3, s[8:11], s46 offen sc1
  s_add_u32 s45, s45, 1
  s_waitcnt vmcnt(0)
  v_readfirstlane_b32 s29, v4
  s_cmp_ge_u32 s29, 32
  s_cbranch_scc1 aw_105_ok
  s_cmp_lt_u32 s45, 400000
  s_cbranch_scc1 aw_105
  s_branch kb2_abort
aw_105_ok:
  s_barrier
  s_lshl_b32 s26, s23, 3
  s_lshl_b32 s27, s21, 1
  s_add_u32 s24, s26, s27
  s_mul_i32 s27, s24, 40960
  s_add_u32 s27, s27, 0x100000
  s_add_u32 s28, s27, 40960
  v_mov_b32 v3, v2
  v_add_u32 v4, 65536, v2
  v_lshlrev_b32 v5, 7, v1
  s_add_u32 s29, s27, 0
  buffer_load_dword v6, v5, s[8:11], s29 offen sc1
  s_add_u32 s29, s27, 8192
  buffer_load_dword v6, v5, s[8:11], s29 offen sc1
  s_add_u32 s29, s27, 16384
  buffer_load_dword v6, v5, s[8:11], s29 offen sc1
  s_add_u32 s29, s27, 24576
  buffer_load_dword v6, v5, s[8:11], s29 offen sc1
  s_add_u32 s29, s27, 32768
  buffer_load_dword v6, v5, s[8:11], s29 offen sc1
  s_add_u32 s29, s27, 40960
  buffer_load_dword v6, v5, s[8:11], s29 offen sc1
  s_add_u32 s29, s27, 49152
  buffer_load_dword v6, v5, s[8:11], s29 offen sc1
  s_add_u32 s29, s27, 57344
  buffer_load_dword v6, v5, s[8:11], s29 offen sc1
  s_add_u32 s29, s27, 65536
  buffer_load_dword v6, v5, s[8:11], s29 offen sc1
  s_add_u32 s29, s27, 73728
  buffer_load_dword v6, v5, s[8:11], s29 offen sc1
  s_add_u32 s29, s27, 0
  buffer_load_dwordx4 v[16:19], v2, s[8:11], s29 offen sc1
  s_add_u32 s29, s28, 0
  buffer_load_dwordx4 v[20:23], v2, s[8:11], s29 offen sc1
  s_add_u32 s29, s27, 1024
  buffer_load_dwordx4 v[24:27], v2, s[8:11], s29 offen sc1
  s_add_u32 s29, s28, 1024
  buffer_load_dwordx4 v[28:31], v2, s[8:11], s29 offen sc1
  s_add_u32 s29, s27, 2048
  buffer_load_dwordx4 v[32:35], v2, s[8:11], s29 offen sc1
  s_add_u32 s29, s28, 2048
  buffer_load_dwordx4 v[36:39], v2, s[8:11], s29 offen sc1
  s_add_u32 s29, s27, 3072
  buffer_load_dwordx4 v[40:43], v2, s[8:11], s29 offen sc1
  s_add_u32 s29, s28, 3072
  buffer_load_dwordx4 v[44:47], v2, s[8:11], s29 offen sc1
  s_add_u32 s29, s27, 4096
  buffer_load_dwordx4 v[48:51], v2, s[8:11], s29 offen sc1
  s_add_u32 s29, s28, 4096
  buffer_load_dwordx4 v[52:55], v2, s[8:11], s29 offen sc1
  s_add_u32 s29, s27, 5120
  buffer_load_dwordx4 v[56:59], v2, s[8:11], s29 offen sc1
  s_add_u32 s29, s28, 5120
  buffer_load_dwordx4 v[60:63], v2, s[8:11], s29 offen sc1
  s_add_u32 s29, s27, 6144
  buffer_load_dwordx4 v[64:67], v2, s[8:11], s29 offen sc1
  s_add_u32 s29, s28, 6144
  buffer_load_dwordx4 v[68:71], v2, s[8:11], s29 offen sc1
  ds_read_b128 v[208:211], v3 offset:0
  ds_read_b128 v[212:215], v3 offset:40960
  ds_read_b128 v[216:219], v4 offset:16384
  s_add_u32 s29, s27, 7168
  buffer_load_dwordx4 v[72:75], v2, s[8:11], s29 offen sc1
  s_add_u32 s29, s28, 7168
  buffer_load_dwordx4 v[76:79], v2, s[8:11], s29 offen sc1
  ds_read_b128 v[220:223], v3 offset:1024
  ds_read_b128 v[224:227], v3 offset:41984
  ds_read_b128 v[228:231], v4 offset:17408
  s_waitcnt lgkmcnt(3)
  s_waitcnt vmcnt(14)
  v_mfma_f32_32x32x16_bf16 v[80:95], v[208:211], v[16:19], 0
  v_mfma_f32_32x32x16_bf16 v[96:111], v[212:215], v[16:19], 0
  v_mfma_f32_32x32x16_bf16 v[112:127], v[16:19], v[216:219], 0
  v_mfma_f32_32x32x16_bf16 v[128:143], v[208:211], v[20:23], 0
  v_mfma_f32_32x32x16_bf16 v[144:159], v[212:215], v[20:23], 0
  v_mfma_f32_32x32x16_bf16 v[160:175], v[20:23], v[216:219], 0
  s_add_u32 s29, s27, 8192
  buffer_load_dwordx4 v[16:19], v2, s[8:11], s29 offen sc1
  s_add_u32 s29, s28, 8192
  buffer_load_dwordx4 v[20:23], v2, s[8:11], s29 offen sc1
  ds_read_b128 v[208:211], v3 offset:2048
  ds_read_b128 v[212:215], v3 offset:43008
  ds_read_b128 v[216:219], v4 offset:18432
  s_waitcnt lgkmcnt(3)
  s_waitcnt vmcnt(14)
  v_mfma_f32_32x32x16_bf16 v[80:95], v[220:223], v[24:27], v[80:95]
  v_mfma_f32_32x32x16_bf16 v[96:111], v[224:227], v[24:27], v[96:111]
  v_mfma_f32_32x32x16_bf16 v[112:127], v[24:27], v[228:231], v[112:127]
  v_mfma_f32_32x32x16_bf16 v[128:143], v[220:223], v[28:31], v[128:143]
  v_mfma_f32_32x32x16_bf16 v[144:159], v[224:227], v[28:31], v[144:159]
  v_mfma_f32_32x32x16_bf16 v[160:175], v[28:31], v[228:231], v[160:175]
  s_add_u32 s29, s27, 9216
  buffer_load_dwordx4 v[24:27], v2, s[8:11], s29 offen sc1
  s_add_u32 s29, s28, 9216
  buffer_load_dwordx4 v[28:31], v2, s[8:11], s29 offen sc1
  ds_read_b128 v[220:223], v3 offset:3072
  ds_read_b128 v[224:227], v3 offset:44032
  ds_read_b128 v[228:231], v4 offset:19456
  s_waitcnt lgkmcnt(3)
  s_waitcnt vmcnt(14)
  v_mfma_f32_32x32x16_bf16 v[80:95], v[208:211], v[32:35], v[80:95]
  v_mfma_f32_32x32x16_bf16 v[96:111], v[212:215], v[32:35], v[96:111]
  v_mfma_f32_32x32x16_bf16 v[112:127], v[32:35], v[216:219], v[112:127]
  v_mfma_f32_32x32x16_bf16 v[128:143], v[208:211], v[36:39], v[128:143]
  v_mfma_f32_32x32x16_bf16 v[144:159], v[212:215], v[36:39], v[144:159]
  v_mfma_f32_32x32x16_bf16 v[160:175], v[36:39], v[216:219], v[160:175]
  s_add_u32 s29, s27, 10240
  buffer_load_dwordx4 v[32:35], v2, s[8:11], s29 offen sc1
  s_add_u32 s29, s28, 10240
  buffer_load_dwordx4 v[36:39], v2, s[8:11], s29 offen sc1
  ds_read_b128 v[208:211], v3 offset:4096
  ds_read_b128 v[212:215], v3 offset:45056
  ds_read_b128 v[216:219], v4 offset:20480
  s_waitcnt lgkmcnt(3)
  s_waitcnt vmcnt(14)
  v_mfma_f32_32x32x16_bf16 v[80:95], v[220:223], v[40:43], v[80:95]
  v_mfma_f32_32x32x16_bf16 v[96:111], v[224:227], v[40:43], v[96:111]
  v_mfma_f32_32x32x16_bf16 v[112:127], v[40:43], v[228:231], v[112:127]
  v_mfma_f32_32x32x16_bf16 v[128:143], v[220:223], v[44:47], v[128:143]
  v_mfma_f32_32x32x16_bf16 v[144:159], v[224:227], v[44:47], v[144:159]
  v_mfma_f32_32x32x16_bf16 v[160:175], v[44:47], v[228:231], v[160:175]
  s_add_u32 s29, s27, 11264
  buffer_load_dwordx4 v[40:43], v2, s[8:11], s29 offen sc1
  s_add_u32 s29, s28, 11264
  buffer_load_dwordx4 v[44:47], v2, s[8:11], s29 offen sc1
  ds_read_b128 v[220:223], v3 offset:5120
  ds_read_b128 v[224:227], v3 offset:46080
  ds_read_b128 v[228:231], v4 offset:21504
  s_waitcnt lgkmcnt(3)
  s_waitcnt vmcnt(14)
  v_mfma_f32_32x32x16_bf16 v[80:95], v[208:211], v[48:51], v[80:95]
  v_mfma_f32_32x32x16_bf16 v[96:111], v[212:215], v[48:51], v[96:111]
  v_mfma_f32_32x32x16_bf16 v[112:127], v[48:51], v[216:219], v[112:127]
  v_mfma_f32_32x32x16_bf16 v[128:143], v[208:211], v[52:55], v[128:143]
  v_mfma_f32_32x32x16_bf16 v[144:159], v[212:215], v[52:55], v[144:159]
  v_mfma_f32_32x32x16_bf16 v[160:175], v[52:55], v[216:219], v[160:175]
  s_add_u32 s29, s27, 12288
  buffer_load_dwordx4 v[48:51], v2, s[8:11], s29 offen sc1
  s_add_u32 s29, s28, 12288
  buffer_load_dwordx4 v[52:55], v2, s[8:11], s29 offen sc1
  ds_read_b128 v[208:211], v3 offset:6144
  ds_read_b128 v[212:215], v3 offset:47104
  ds_read_b128 v[216:219], v4 offset:22528
  s_waitcnt lgkmcnt(3)
  s_waitcnt vmcnt(14)
  v_mfma_f32_32x32x16_bf16 v[80:95], v[220:223], v[56:59], v[80:95]
  v_mfma_f32_32x32x16_bf16 v[96:111], v[224:227], v[56:59], v[96:111]
  v_mfma_f32_32x32x16_bf16 v[112:127], v[56:59], v[228:231], v[112:127]
  v_mfma_f32_32x32x16_bf16 v[128:143], v[220:223], v[60:63], v[128:143]
  v_mfma_f32_32x32x16_bf16 v[144:159], v[224:227], v[60:63], v[144:159]
  v_mfma_f32_32x32x16_bf16 v[160:175], v[60:63], v[228:231], v[160:175]
  s_add_u32 s29, s27, 13312
  buffer_load_dwordx4 v[56:59], v2, s[8:11], s29 offen sc1
  s_add_u32 s29, s28, 13312
  buffer_load_dwordx4 v[60:63], v2, s[8:11], s29 offen sc1
  ds_read_b128 v[220:223], v3 offset:7168
  ds_read_b128 v[224:227], v3 offset:48128
  ds_read_b128 v[228:231], v4 offset:23552
  s_waitcnt lgkmcnt(3)
  s_waitcnt vmcnt(14)
  v_mfma_f32_32x32x16_bf16 v[80:95], v[208:211], v[64:67], v[80:95]
  v_mfma_f32_32x32x16_bf16 v[96:111], v[212:215], v[64:67], v[96:111]
  v_mfma_f32_32x32x16_bf16 v[112:127], v[64:67], v[216:219], v[112:127]
  v_mfma_f32_32x32x16_bf16 v[128:143], v[208:211], v[68:71], v[128:143]
  v_mfma_f32_32x32x16_bf16 v[144:159], v[212:215], v[68:71], v[144:159]
  v_mfma_f32_32x32x16_bf16 v[160:175], v[68:71], v[216:219], v[160:175]
  s_add_u32 s29, s27, 14336
  buffer_load_dwordx4 v[64:67], v2, s[8:11], s29 offen sc1
  s_add_u32 s29, s28, 14336
  buffer_load_dwordx4 v[68:71], v2, s[8:11], s29 offen sc1
  ds_read_b128 v[208:211], v3 offset:8192
  ds_read_b128 v[212:215], v3 offset:49152
  ds_read_b128 v[216:219], v4 offset:24576
  s_waitcnt lgkmcnt(3)
  s_waitcnt vmcnt(14)
  v_mfma_f32_32x32x16_bf16 v[80:95], v[220:223], v[72:75], v[80:95]
  v_mfma_f32_32x32x16_bf16 v[96:111], v[224:227], v[72:75], v[96:111]
  v_mfma_f32_32x32x16_bf16 v[112:127], v[72:75], v[228:231], v[112:127]
  v_mfma_f32_32x32x16_bf16 v[128:143], v[220:223], v[76:79], v[128:143]
  v_mfma_f32_32x32x16_bf16 v[144:159], v[224:227], v[76:79], v[144:159]
  v_mfma_f32_32x32x16_bf16 v[160:175], v[76:79], v[228:231], v[160:175]
  s_add_u32 s29, s27, 15360
  buffer_load_dwordx4 v[72:75], v2, s[8:11], s29 offen sc1
  s_add_u32 s29, s28, 15360
  buffer_load_dwordx4 v[76:79], v2, s[8:11], s29 offen sc1
  ds_read_b128 v[220:223], v3 offset:9216
  ds_read_b128 v[224:227], v3 offset:50176
  ds_read_b128 v[228:231], v4 offset:25600
  s_waitcnt lgkmcnt(3)
  s_waitcnt vmcnt(14)
  v_mfma_f32_32x32x16_bf16 v[80:95], v[208:211], v[16:19], v[80:95]
  v_mfma_f32_32x32x16_bf16 v[96:111], v[212:215], v[16:19], v[96:111]
  v_mfma_f32_32x32x16_bf16 v[112:127], v[16:19], v[216:219], v[112:127]
  v_mfma_f32_32x32x16_bf16 v[128:143], v[208:211], v[20:23], v[128:143]
  v_mfma_f32_32x32x16_bf16 v[144:159], v[212:215], v[20:23], v[144:159]
  v_mfma_f32_32x32x16_bf16 v[160:175], v[20:23], v[216:219], v[160:175]
  s_add_u32 s29, s27, 16384
  buffer_load_dwordx4 v[16:19], v2, s[8:11], s29 offen sc1
  s_add_u32 s29, s28, 16384
  buffer_load_dwordx4 v[20:23], v2, s[8:11], s29 offen sc1
  ds_read_b128 v[208:211], v3 offset:10240
  ds_read_b128 v[212:215], v3 offset:51200
  ds_read_b128 v[216:219], v4 offset:26624
  s_waitcnt lgkmcnt(3)
  s_waitcnt vmcnt(14)
  v_mfma_f32_32x32x16_bf16 v[80:95], v[220:223], v[24:27], v[80:95]
  v_mfma_f32_32x32x16_bf16 v[96:111], v[224:227], v[24:27], v[96:111]
  v_mfma_f32_32x32x16_bf16 v[112:127], v[24:27], v[228:231], v[112:127]
  v_mfma_f32_32x32x16_bf16 v[128:143], v[220:223], v[28:31], v[128:143]
  v_mfma_f32_32x32x16_bf16 v[144:159], v[224:227], v[28:31], v[144:159]
  v_mfma_f32_32x32x16_bf16 v[160:175], v[28:31], v[228:231], v[160:175]
  s_add_u32 s29, s27, 17408
  buffer_load_dwordx4 v[24:27], v2, s[8:11], s29 offen sc1
  s_add_u32 s29, s28, 17408
  buffer_load_dwordx4 v[28:31], v2, s[8:11], s29 offen sc1
  ds_read_b128 v[220:223], v3 offset:11264
  ds_read_b128 v[224:227], v3 offset:52224
  ds_read_b128 v[228:231], v4 offset:27648
  s_waitcnt lgkmcnt(3)
  s_waitcnt vmcnt(14)
  v_mfma_f32_32x32x16_bf16 v[80:95], v[208:211], v[32:35], v[80:95]
  v_mfma_f32_32x32x16_bf16 v[96:111], v[212:215], v[32:35], v[96:111]
  v_mfma_f32_32x32x16_bf16 v[112:127], v[32:35], v[216:219], v[112:127]
  v_mfma_f32_32x32x16_bf16 v[128:143], v[208:211], v[36:39], v[128:143]
  v_mfma_f32_32x32x16_bf16 v[144:159], v[212:215], v[36:39], v[144:159]
  v_mfma_f32_32x32x16_bf16 v[160:175], v[36:39], v[216:219], v[160:175]
  s_add_u32 s29, s27, 18432
  buffer_load_dwordx4 v[32:35], v2, s[8:11], s29 offen sc1
  s_add_u32 s29, s28, 18432
  buffer_load_dwordx4 v[36:39], v2, s[8:11], s29 offen sc1
  ds_read_b128 v[208:211], v3 offset:12288
  ds_read_b128 v[212:215], v3 offset:53248
  ds_read_b128 v[216:219], v4 offset:28672
  s_waitcnt lgkmcnt(3)
  s_waitcnt vmcnt(14)
  v_mfma_f32_32x32x16_bf16 v[80:95], v[220:223], v[40:43], v[80:95]
  v_mfma_f32_32x32x16_bf16 v[96:111], v[224:227], v[40:43], v[96:111]
  v_mfma_f32_32x32x16_bf16 v[112:127], v[40:43], v[228:231], v[112:127]
  v_mfma_f32_32x32x16_bf16 v[128:143], v[220:223], v[44:47], v[128:143]
  v_mfma_f32_32x32x16_bf16 v[144:159], v[224:227], v[44:47], v[144:159]
  v_mfma_f32_32x32x16_bf16 v[160:175], v[44:47], v[228:231], v[160:175]
  s_add_u32 s29, s27, 19456
  buffer_load_dwordx4 v[40:43], v2, s[8:11], s29 offen sc1
  s_add_u32 s29, s28, 19456
  buffer_load_dwordx4 v[44:47], v2, s[8:11], s29 offen sc1
  ds_read_b128 v[220:223], v3 offset:13312
  ds_read_b128 v[224:227], v3 offset:54272
  ds_read_b128 v[228:231], v4 offset:29696
  s_waitcnt lgkmcnt(3)
  s_waitcnt vmcnt(14)
  v_mfma_f32_32x32x16_bf16 v[80:95], v[208:211], v[48:51], v[80:95]
  v_mfma_f32_32x32x16_bf16 v[96:111], v[212:215], v[48:51], v[96:111]
  v_mfma_f32_32x32x16_bf16 v[112:127], v[48:51], v[216:219], v[112:127]
  v_mfma_f32_32x32x16_bf16 v[128:143], v[208:211], v[52:55], v[128:143]
  v_mfma_f32_32x32x16_bf16 v[144:159], v[212:215], v[52:55], v[144:159]
  v_mfma_f32_32x32x16_bf16 v[160:175], v[52:55], v[216:219], v[160:175]
  s_add_u32 s29, s27, 20480
  buffer_load_dwordx4 v[48:51], v2, s[8:11], s29 offen sc1
  s_add_u32 s29, s28, 20480
  buffer_load_dwordx4 v[52:55], v2, s[8:11], s29 offen sc1
  ds_read_b128 v[208:211], v3 offset:14336
  ds_read_b128 v[212:215], v3 offset:55296
  ds_read_b128 v[216:219], v4 offset:30720
  s_waitcnt lgkmcnt(3)
  s_waitcnt vmcnt(14)
  v_mfma_f32_32x32x16_bf16 v[80:95], v[220:223], v[56:59], v[80:95]
  v_mfma_f32_32x32x16_bf16 v[96:111], v[224:227], v[56:59], v[96:111]
  v_mfma_f32_32x32x16_bf16 v[112:127], v[56:59], v[228:231], v[112:127]
  v_mfma_f32_32x32x16_bf16 v[128:143], v[220:223], v[60:63], v[128:143]
  v_mfma_f32_32x32x16_bf16 v[144:159], v[224:227], v[60:63], v[144:159]
  v_mfma_f32_32x32x16_bf16 v[160:175], v[60:63], v[228:231], v[160:175]
  s_add_u32 s29, s27, 21504
  buffer_load_dwordx4 v[56:59], v2, s[8:11], s29 offen sc1
  s_add_u32 s29, s28, 21504
  buffer_load_dwordx4 v[60:63], v2, s[8:11], s29 offen sc1
  ds_read_b128 v[220:223], v3 offset:15360
  ds_read_b128 v[224:227], v3 offset:56320
  ds_read_b128 v[228:231], v4 offset:31744
  s_waitcnt lgkmcnt(3)
  s_waitcnt vmcnt(14)
  v_mfma_f32_32x32x16_bf16 v[80:95], v[208:211], v[64:67], v[80:95]
  v_mfma_f32_32x32x16_bf16 v[96:111], v[212:215], v[64:67], v[96:111]
  v_mfma_f32_32x32x16_bf16 v[112:127], v[64:67], v[216:219], v[112:127]
  v_mfma_f32_32x32x16_bf16 v[128:143], v[208:211], v[68:71], v[128:143]
  v_mfma_f32_32x32x16_bf16 v[144:159], v[212:215], v[68:71], v[144:159]
  v_mfma_f32_32x32x16_bf16 v[160:175], v[68:71], v[216:219], v[160:175]
  s_add_u32 s29, s27, 22528
  buffer_load_dwordx4 v[64:67], v2, s[8:11], s29 offen sc1
  s_add_u32 s29, s28, 22528
  buffer_load_dwordx4 v[68:71], v2, s[8:11], s29 offen sc1
  ds_read_b128 v[208:211], v3 offset:16384
  ds_read_b128 v[212:215], v3 offset:57344
  ds_read_b128 v[216:219], v4 offset:32768
  s_waitcnt lgkmcnt(3)
  s_waitcnt vmcnt(14)
  v_mfma_f32_32x32x16_bf16 v[80:95], v[220:223], v[72:75], v[80:95]
  v_mfma_f32_32x32x16_bf16 v[96:111], v[224:227], v[72:75], v[96:111]
  v_mfma_f32_32x32x16_bf16 v[112:127], v[72:75], v[228:231], v[112:127]
  v_mfma_f32_32x32x16_bf16 v[128:143], v[220:223], v[76:79], v[128:143]
  v_mfma_f32_32x32x16_bf16 v[144:159], v[224:227], v[76:79], v[144:159]
  v_mfma_f32_32x32x16_bf16 v[160:175], v[76:79], v[228:231], v[160:175]
  s_add_u32 s29, s27, 23552
  buffer_load_dwordx4 v[72:75], v2, s[8:11], s29 offen sc1
  s_add_u32 s29, s28, 23552
  buffer_load_dwordx4 v[76:79], v2, s[8:11], s29 offen sc1
  ds_read_b128 v[220:223], v3 offset:17408
  ds_read_b128 v[224:227], v3 offset:58368
  ds_read_b128 v[228:231], v4 offset:33792
  s_waitcnt lgkmcnt(3)
  s_waitcnt vmcnt(14)
  v_mfma_f32_32x32x16_bf16 v[80:95], v[208:211], v[16:19], v[80:95]
  v_mfma_f32_32x32x16_bf16 v[96:111], v[212:215], v[16:19], v[96:111]
  v_mfma_f32_32x32x16_bf16 v[112:127], v[16:19], v[216:219], v[112:127]
  v_mfma_f32_32x32x16_bf16 v[128:143], v[208:211], v[20:23], v[128:143]
  v_mfma_f32_32x32x16_bf16 v[144:159], v[212:215], v[20:23], v[144:159]
  v_mfma_f32_32x32x16_bf16 v[160:175], v[20:23], v[216:219], v[160:175]
  s_add_u32 s29, s27, 24576
  buffer_load_dwordx4 v[16:19], v2, s[8:11], s29 offen sc1
  s_add_u32 s29, s28, 24576
  buffer_load_dwordx4 v[20:23], v2, s[8:11], s29 offen sc1
  ds_read_b128 v[208:211], v3 offset:18432
  ds_read_b128 v[212:215], v3 offset:59392
  ds_read_b128 v[216:219], v4 offset:34816
  s_waitcnt lgkmcnt(3)
  s_waitcnt vmcnt(14)
  v_mfma_f32_32x32x16_bf16 v[80:95], v[220:223], v[24:27], v[80:95]
  v_mfma_f32_32x32x16_bf16 v[96:111], v[224:227], v[24:27], v[96:111]
  v_mfma_f32_32x32x16_bf16 v[112:127], v[24:27], v[228:231], v[112:127]
  v_mfma_f32_32x32x16_bf16 v[128:143], v[220:223], v[28:31], v[128:143]
  v_mfma_f32_32x32x16_bf16 v[144:159], v[224:227], v[28:31], v[144:159]
  v_mfma_f32_32x32x16_bf16 v[160:175], v[28:31], v[228:231], v[160:175]
  s_add_u32 s29, s27, 25600
  buffer_load_dwordx4 v[24:27], v2, s[8:11], s29 offen sc1
  s_add_u32 s29, s28, 25600
  buffer_load_dwordx4 v[28:31], v2, s[8:11], s29 offen sc1
  ds_read_b128 v[220:223], v3 offset:19456
  ds_read_b128 v[224:227], v3 offset:60416
  ds_read_b128 v[228:231], v4 offset:35840
  s_waitcnt lgkmcnt(3)
  s_waitcnt vmcnt(14)
  v_mfma_f32_32x32x16_bf16 v[80:95], v[208:211], v[32:35], v[80:95]
  v_mfma_f32_32x32x16_bf16 v[96:111], v[212:215], v[32:35], v[96:111]
  v_mfma_f32_32x32x16_bf16 v[112:127], v[32:35], v[216:219], v[112:127]
  v_mfma_f32_32x32x16_bf16 v[128:143], v[208:211], v[36:39], v[128:143]
  v_mfma_f32_32x32x16_bf16 v[144:159], v[212:215], v[36:39], v[144:159]
  v_mfma_f32_32x32x16_bf16 v[160:175], v[36:39], v[216:219], v[160:175]
  s_add_u32 s29, s27, 26624
  buffer_load_dwordx4 v[32:35], v2, s[8:11], s29 offen sc1
  s_add_u32 s29, s28, 26624
  buffer_load_dwordx4 v[36:39], v2, s[8:11], s29 offen sc1
  ds_read_b128 v[208:211], v3 offset:20480
  ds_read_b128 v[212:215], v3 offset:61440
  ds_read_b128 v[216:219], v4 offset:36864
  s_waitcnt lgkmcnt(3)
  s_waitcnt vmcnt(14)
  v_mfma_f32_32x32x16_bf16 v[80:95], v[220:223], v[40:43], v[80:95]
  v_mfma_f32_32x32x16_bf16 v[96:111], v[224:227], v[40:43], v[96:111]
  v_mfma_f32_32x32x16_bf16 v[112:127], v[40:43], v[228:231], v[112:127]
  v_mfma_f32_32x32x16_bf16 v[128:143], v[220:223], v[44:47], v[128:143]
  v_mfma_f32_32x32x16_bf16 v[144:159], v[224:227], v[44:47], v[144:159]
  v_mfma_f32_32x32x16_bf16 v[160:175], v[44:47], v[228:231], v[160:175]
  s_add_u32 s29, s27, 27648
  buffer_load_dwordx4 v[40:43], v2, s[8:11], s29 offen sc1
  s_add_u32 s29, s28, 27648
  buffer_load_dwordx4 v[44:47], v2, s[8:11], s29 offen sc1
  ds_read_b128 v[220:223], v3 offset:21504
  ds_read_b128 v[224:227], v3 offset:62464
  ds_read_b128 v[228:231], v4 offset:37888
  s_waitcnt lgkmcnt(3)
  s_waitcnt vmcnt(14)
  v_mfma_f32_32x32x16_bf16 v[80:95], v[208:211], v[48:51], v[80:95]
  v_mfma_f32_32x32x16_bf16 v[96:111], v[212:215], v[48:51], v[96:111]
  v_mfma_f32_32x32x16_bf16 v[112:127], v[48:51], v[216:219], v[112:127]
  v_mfma_f32_32x32x16_bf16 v[128:143], v[208:211], v[52:55], v[128:143]
  v_mfma_f32_32x32x16_bf16 v[144:159], v[212:215], v[52:55], v[144:159]
  v_mfma_f32_32x32x16_bf16 v[160:175], v[52:55], v[216:219], v[160:175]
  s_add_u32 s29, s27, 28672
  buffer_load_dwordx4 v[48:51], v2, s[8:11], s29 offen sc1
  s_add_u32 s29, s28, 28672
  buffer_load_dwordx4 v[52:55], v2, s[8:11], s29 offen sc1
  ds_read_b128 v[208:211], v3 offset:22528
  ds_read_b128 v[212:215], v3 offset:63488
  ds_read_b128 v[216:219], v4 offset:38912
  s_waitcnt lgkmcnt(3)
  s_waitcnt vmcnt(14)
  v_mfma_f32_32x32x16_bf16 v[80:95], v[220:223], v[56:59], v[80:95]
  v_mfma_f32_32x32x16_bf16 v[96:111], v[224:227], v[56:59], v[96:111]
  v_mfma_f32_32x32x16_bf16 v[112:127], v[56:59], v[228:231], v[112:127]
  v_mfma_f32_32x32x16_bf16 v[128:143], v[220:223], v[60:63], v[128:143]
  v_mfma_f32_32x32x16_bf16 v[144:159], v[224:227], v[60:63], v[144:159]
  v_mfma_f32_32x32x16_bf16 v[160:175], v[60:63], v[228:231], v[160:175]
  s_add_u32 s29, s27, 29696
  buffer_load_dwordx4 v[56:59], v2, s[8:11], s29 offen sc1
  s_add_u32 s29, s28, 29696
  buffer_load_dwordx4 v[60:63], v2, s[8:11], s29 offen sc1
  ds_read_b128 v[220:223], v3 offset:23552
  ds_read_b128 v[224:227], v3 offset:64512
  ds_read_b128 v[228:231], v4 offset:39936
  s_waitcnt lgkmcnt(3)
  s_waitcnt vmcnt(14)
  v_mfma_f32_32x32x16_bf16 v[80:95], v[208:211], v[64:67], v[80:95]
  v_mfma_f32_32x32x16_bf16 v[96:111], v[212:215], v[64:67], v[96:111]
  v_mfma_f32_32x32x16_bf16 v[112:127], v[64:67], v[216:219], v[112:127]
  v_mfma_f32_32x32x16_bf16 v[128:143], v[208:211], v[68:71], v[128:143]
  v_mfma_f32_32x32x16_bf16 v[144:159], v[212:215], v[68:71], v[144:159]
  v_mfma_f32_32x32x16_bf16 v[160:175], v[68:71], v[216:219], v[160:175]
  s_add_u32 s29, s27, 30720
  buffer_load_dwordx4 v[64:67], v2, s[8:11], s29 offen sc1
  s_add_u32 s29, s28, 30720
  buffer_load_dwordx4 v[68:71], v2, s[8:11], s29 offen sc1
  ds_read_b128 v[208:211], v3 offset:24576
  ds_read_b128 v[212:215], v4 offset:0
  ds_read_b128 v[216:219], v4 offset:40960
  s_waitcnt lgkmcnt(3)
  s_waitcnt vmcnt(14)
  v_mfma_f32_32x32x16_bf16 v[80:95], v[220:223], v[72:75], v[80:95]
  v_mfma_f32_32x32x16_bf16 v[96:111], v[224:227], v[72:75], v[96:111]
  v_mfma_f32_32x32x16_bf16 v[112:127], v[72:75], v[228:231], v[112:127]
  v_mfma_f32_32x32x16_bf16 v[128:143], v[220:223], v[76:79], v[128:143]
  v_mfma_f32_32x32x16_bf16 v[144:159], v[224:227], v[76:79], v[144:159]
  v_mfma_f32_32x32x16_bf16 v[160:175], v[76:79], v[228:231], v[160:175]
  s_add_u32 s29, s27, 31744
  buffer_load_dwordx4 v[72:75], v2, s[8:11], s29 offen sc1
  s_add_u32 s29, s28, 31744
  buffer_load_dwordx4 v[76:79], v2, s[8:11], s29 offen sc1
  ds_read_b128 v[220:223], v3 offset:25600
  ds_read_b128 v[224:227], v4 offset:1024
  ds_read_b128 v[228:231], v4 offset:41984
  s_waitcnt lgkmcnt(3)
  s_waitcnt vmcnt(14)
  v_mfma_f32_32x32x16_bf16 v[80:95], v[208:211], v[16:19], v[80:95]
  v_mfma_f32_32x32x16_bf16 v[96:111], v[212:215], v[16:19], v[96:111]
  v_mfma_f32_32x32x16_bf16 v[112:127], v[16:19], v[216:219], v[112:127]
  v_mfma_f32_32x32x16_bf16 v[128:143], v[208:211], v[20:23], v[128:143]
  v_mfma_f32_32x32x16_bf16 v[144:159], v[212:215], v[20:23], v[144:159]
  v_mfma_f32_32x32x16_bf16 v[160:175], v[20:23], v[216:219], v[160:175]
  s_add_u32 s29, s27, 32768
  buffer_load_dwordx4 v[16:19], v2, s[8:11], s29 offen sc1
  s_add_u32 s29, s28, 32768
  buffer_load_dwordx4 v[20:23], v2, s[8:11], s29 offen sc1
  ds_read_b128 v[208:211], v3 offset:26624
  ds_read_b128 v[212:215], v4 offset:2048
  ds_read_b128 v[216:219], v4 offset:43008
  s_waitcnt lgkmcnt(3)
  s_waitcnt vmcnt(14)
  v_mfma_f32_32x32x16_bf16 v[80:95], v[220:223], v[24:27], v[80:95]
  v_mfma_f32_32x32x16_bf16 v[96:111], v[224:227], v[24:27], v[96:111]
  v_mfma_f32_32x32x16_bf16 v[112:127], v[24:27], v[228:231], v[112:127]
  v_mfma_f32_32x32x16_bf16 v[128:143], v[220:223], v[28:31], v[128:143]
  v_mfma_f32_32x32x16_bf16 v[144:159], v[224:227], v[28:31], v[144:159]
  v_mfma_f32_32x32x16_bf16 v[160:175], v[28:31], v[228:231], v[160:175]
  s_add_u32 s29, s27, 33792
  buffer_load_dwordx4 v[24:27], v2, s[8:11], s29 offen sc1
  s_add_u32 s29, s28, 33792
  buffer_load_dwordx4 v[28:31], v2, s[8:11], s29 offen sc1
  ds_read_b128 v[220:223], v3 offset:27648
  ds_read_b128 v[224:227], v4 offset:3072
  ds_read_b128 v[228:231], v4 offset:44032
  s_waitcnt lgkmcnt(3)
  s_waitcnt vmcnt(14)
  v_mfma_f32_32x32x16_bf16 v[80:95], v[208:211], v[32:35], v[80:95]
  v_mfma_f32_32x32x16_bf16 v[96:111], v[212:215], v[32:35], v[96:111]
  v_mfma_f32_32x32x16_bf16 v[112:127], v[32:35], v[216:219], v[112:127]
  v_mfma_f32_32x32x16_bf16 v[128:143], v[208:211], v[36:39], v[128:143]
  v_mfma_f32_32x32x16_bf16 v[144:159], v[212:215], v[36:39], v[144:159]
  v_mfma_f32_32x32x16_bf16 v[160:175], v[36:39], v[216:219], v[160:175]
  s_add_u32 s29, s27, 34816
  buffer_load_dwordx4 v[32:35], v2, s[8:11], s29 offen sc1
  s_add_u32 s29, s28, 34816
  buffer_load_dwordx4 v[36:39], v2, s[8:11], s29 offen sc1
  ds_read_b128 v[208:211], v3 offset:28672
  ds_read_b128 v[212:215], v4 offset:4096
  ds_read_b128 v[216:219], v4 offset:45056
  s_waitcnt lgkmcnt(3)
  s_waitcnt vmcnt(14)
  v_mfma_f32_32x32x16_bf16 v[80:95], v[220:223], v[40:43], v[80:95]
  v_mfma_f32_32x32x16_bf16 v[96:111], v[224:227], v[40:43], v[96:111]
  v_mfma_f32_32x32x16_bf16 v[112:127], v[40:43], v[228:231], v[112:127]
  v_mfma_f32_32x32x16_bf16 v[128:143], v[220:223], v[44:47], v[128:143]
  v_mfma_f32_32x32x16_bf16 v[144:159], v[224:227], v[44:47], v[144:159]
  v_mfma_f32_32x32x16_bf16 v[160:175], v[44:47], v[228:231], v[160:175]
  s_add_u32 s29, s27, 35840
  buffer_load_dwordx4 v[40:43], v2, s[8:11], s29 offen sc1
  s_add_u32 s29, s28, 35840
  buffer_load_dwordx4 v[44:47], v2, s[8:11], s29 offen sc1
  ds_read_b128 v[220:223], v3 offset:29696
  ds_read_b128 v[224:227], v4 offset:5120
  ds_read_b128 v[228:231], v4 offset:46080
  s_waitcnt lgkmcnt(3)
  s_waitcnt vmcnt(14)
  v_mfma_f32_32x32x16_bf16 v[80:95], v[208:211], v[48:51], v[80:95]
  v_mfma_f32_32x32x16_bf16 v[96:111], v[212:215], v[48:51], v[96:111]
  v_mfma_f32_32x32x16_bf16 v[112:127], v[48:51], v[216:219], v[112:127]
  v_mfma_f32_32x32x16_bf16 v[128:143], v[208:211], v[52:55], v[128:143]
  v_mfma_f32_32x32x16_bf16 v[144:159], v[212:215], v[52:55], v[144:159]
  v_mfma_f32_32x32x16_bf16 v[160:175], v[52:55], v[216:219], v[160:175]
  s_add_u32 s29, s27, 36864
  buffer_load_dwordx4 v[48:51], v2, s[8:11], s29 offen sc1
  s_add_u32 s29, s28, 36864
  buffer_load_dwordx4 v[52:55], v2, s[8:11], s29 offen sc1
  ds_read_b128 v[208:211], v3 offset:30720
  ds_read_b128 v[212:215], v4 offset:6144
  ds_read_b128 v[216:219], v4 offset:47104
  s_waitcnt lgkmcnt(3)
  s_waitcnt vmcnt(14)
  v_mfma_f32_32x32x16_bf16 v[80:95], v[220:223], v[56:59], v[80:95]
  v_mfma_f32_32x32x16_bf16 v[96:111], v[224:227], v[56:59], v[96:111]
  v_mfma_f32_32x32x16_bf16 v[112:127], v[56:59], v[228:231], v[112:127]
  v_mfma_f32_32x32x16_bf16 v[128:143], v[220:223], v[60:63], v[128:143]
  v_mfma_f32_32x32x16_bf16 v[144:159], v[224:227], v[60:63], v[144:159]
  v_mfma_f32_32x32x16_bf16 v[160:175], v[60:63], v[228:231], v[160:175]
  s_add_u32 s29, s27, 37888
  buffer_load_dwordx4 v[56:59], v2, s[8:11], s29 offen sc1
  s_add_u32 s29, s28, 37888
  buffer_load_dwordx4 v[60:63], v2, s[8:11], s29 offen sc1
  ds_read_b128 v[220:223], v3 offset:31744
  ds_read_b128 v[224:227], v4 offset:7168
  ds_read_b128 v[228:231], v4 offset:48128
  s_waitcnt lgkmcnt(3)
  s_waitcnt vmcnt(14)
  v_mfma_f32_32x32x16_bf16 v[80:95], v[208:211], v[64:67], v[80:95]
  v_mfma_f32_32x32x16_bf16 v[96:111], v[212:215], v[64:67], v[96:111]
  v_mfma_f32_32x32x16_bf16 v[112:127], v[64:67], v[216:219], v[112:127]
  v_mfma_f32_32x32x16_bf16 v[128:143], v[208:211], v[68:71], v[128:143]
  v_mfma_f32_32x32x16_bf16 v[144:159], v[212:215], v[68:71], v[144:159]
  v_mfma_f32_32x32x16_bf16 v[160:175], v[68:71], v[216:219], v[160:175]
  s_add_u32 s29, s27, 38912
  buffer_load_dwordx4 v[64:67], v2, s[8:11], s29 offen sc1
  s_add_u32 s29, s28, 38912
  buffer_load_dwordx4 v[68:71], v2, s[8:11], s29 offen sc1
  ds_read_b128 v[208:211], v3 offset:32768
  ds_read_b128 v[212:215], v4 offset:8192
  ds_read_b128 v[216:219], v4 offset:49152
  s_waitcnt lgkmcnt(3)
  s_waitcnt vmcnt(14)
  v_mfma_f32_32x32x16_bf16 v[80:95], v[220:223], v[72:75], v[80:95]
  v_mfma_f32_32x32x16_bf16 v[96:111], v[224:227], v[72:75], v[96:111]
  v_mfma_f32_32x32x16_bf16 v[112:127], v[72:75], v[228:231], v[112:127]
  v_mfma_f32_32x32x16_bf16 v[128:143], v[220:223], v[76:79], v[128:143]
  v_mfma_f32_32x32x16_bf16 v[144:159], v[224:227], v[76:79], v[144:159]
  v_mfma_f32_32x32x16_bf16 v[160:175], v[76:79], v[228:231], v[160:175]
  s_add_u32 s29, s27, 39936
  buffer_load_dwordx4 v[72:75], v2, s[8:11], s29 offen sc1
  s_add_u32 s29, s28, 39936
  buffer_load_dwordx4 v[76:79], v2, s[8:11], s29 offen sc1
  ds_read_b128 v[220:223], v3 offset:33792
  ds_read_b128 v[224:227], v4 offset:9216
  ds_read_b128 v[228:231], v4 offset:50176
  s_waitcnt lgkmcnt(3)
  s_waitcnt vmcnt(14)
  v_mfma_f32_32x32x16_bf16 v[80:95], v[208:211], v[16:19], v[80:95]
  v_mfma_f32_32x32x16_bf16 v[96:111], v[212:215], v[16:19], v[96:111]
  v_mfma_f32_32x32x16_bf16 v[112:127], v[16:19], v[216:219], v[112:127]
  v_mfma_f32_32x32x16_bf16 v[128:143], v[208:211], v[20:23], v[128:143]
  v_mfma_f32_32x32x16_bf16 v[144:159], v[212:215], v[20:23], v[144:159]
  v_mfma_f32_32x32x16_bf16 v[160:175], v[20:23], v[216:219], v[160:175]
  ds_read_b128 v[208:211], v3 offset:34816
  ds_read_b128 v[212:215], v4 offset:10240
  ds_read_b128 v[216:219], v4 offset:51200
  s_waitcnt lgkmcnt(3)
  s_waitcnt vmcnt(12)
  v_mfma_f32_32x32x16_bf16 v[80:95], v[220:223], v[24:27], v[80:95]
  v_mfma_f32_32x32x16_bf16 v[96:111], v[224:227], v[24:27], v[96:111]
  v_mfma_f32_32x32x16_bf16 v[112:127], v[24:27], v[228:231], v[112:127]
  v_mfma_f32_32x32x16_bf16 v[128:143], v[220:223], v[28:31], v[128:143]
  v_mfma_f32_32x32x16_bf16 v[144:159], v[224:227], v[28:31], v[144:159]
  v_mfma_f32_32x32x16_bf16 v[160:175], v[28:31], v[228:231], v[160:175]
  ds_read_b128 v[220:223], v3 offset:35840
  ds_read_b128 v[224:227], v4 offset:11264
  ds_read_b128 v[228:231], v4 offset:52224
  s_waitcnt lgkmcnt(3)
  s_waitcnt vmcnt(10)
  v_mfma_f32_32x32x16_bf16 v[80:95], v[208:211], v[32:35], v[80:95]
  v_mfma_f32_32x32x16_bf16 v[96:111], v[212:215], v[32:35], v[96:111]
  v_mfma_f32_32x32x16_bf16 v[112:127], v[32:35], v[216:219], v[112:127]
  v_mfma_f32_32x32x16_bf16 v[128:143], v[208:211], v[36:39], v[128:143]
  v_mfma_f32_32x32x16_bf16 v[144:159], v[212:215], v[36:39], v[144:159]
  v_mfma_f32_32x32x16_bf16 v[160:175], v[36:39], v[216:219], v[160:175]
  ds_read_b128 v[208:211], v3 offset:36864
  ds_read_b128 v[212:215], v4 offset:12288
  ds_read_b128 v[216:219], v4 offset:53248
  s_waitcnt lgkmcnt(3)
  s_waitcnt vmcnt(8)
  v_mfma_f32_32x32x16_bf16 v[80:95], v[220:223], v[40:43], v[80:95]
  v_mfma_f32_32x32x16_bf16 v[96:111], v[224:227], v[40:43], v[96:111]
  v_mfma_f32_32x32x16_bf16 v[112:127], v[40:43], v[228:231], v[112:127]
  v_mfma_f32_32x32x16_bf16 v[128:143], v[220:223], v[44:47], v[128:143]
  v_mfma_f32_32x32x16_bf16 v[144:159], v[224:227], v[44:47], v[144:159]
  v_mfma_f32_32x32x16_bf16 v[160:175], v[44:47], v[228:231], v[160:175]
  ds_read_b128 v[220:223], v3 offset:37888
  ds_read_b128 v[224:227], v4 offset:13312
  ds_read_b128 v[228:231], v4 offset:54272
  s_waitcnt lgkmcnt(3)
  s_waitcnt vmcnt(6)
  v_mfma_f32_32x32x16_bf16 v[80:95], v[208:211], v[48:51], v[80:95]
  v_mfma_f32_32x32x16_bf16 v[96:111], v[212:215], v[48:51], v[96:111]
  v_mfma_f32_32x32x16_bf16 v[112:127], v[48:51], v[216:219], v[112:127]
  v_mfma_f32_32x32x16_bf16 v[128:143], v[208:211], v[52:55], v[128:143]
  v_mfma_f32_32x32x16_bf16 v[144:159], v[212:215], v[52:55], v[144:159]
  v_mfma_f32_32x32x16_bf16 v[160:175], v[52:55], v[216:219], v[160:175]
  ds_read_b128 v[208:211], v3 offset:38912
  ds_read_b128 v[212:215], v4 offset:14336
  ds_read_b128 v[216:219], v4 offset:55296
  s_waitcnt lgkmcnt(3)
  s_waitcnt vmcnt(4)
  v_mfma_f32_32x32x16_bf16 v[80:95], v[220:223], v[56:59], v[80:95]
  v_mfma_f32_32x32x16_bf16 v[96:111], v[224:227], v[56:59], v[96:111]
  v_mfma_f32_32x32x16_bf16 v[112:127], v[56:59], v[228:231], v[112:127]
  v_mfma_f32_32x32x16_bf16 v[128:143], v[220:223], v[60:63], v[128:143]
  v_mfma_f32_32x32x16_bf16 v[144:159], v[224:227], v[60:63], v[144:159]
  v_mfma_f32_32x32x16_bf16 v[160:175], v[60:63], v[228:231], v[160:175]
  ds_read_b128 v[220:223], v3 offset:39936
  ds_read_b128 v[224:227], v4 offset:15360
  ds_read_b128 v[228:231], v4 offset:56320
  s_waitcnt lgkmcnt(3)
  s_waitcnt vmcnt(2)
  v_mfma_f32_32x32x16_bf16 v[80:95], v[208:211], v[64:67], v[80:95]
  v_mfma_f32_32x32x16_bf16 v[96:111], v[212:215], v[64:67], v[96:111]
  v_mfma_f32_32x32x16_bf16 v[112:127], v[64:67], v[216:219], v[112:127]
  v_mfma_f32_32x32x16_bf16 v[128:143], v[208:211], v[68:71], v[128:143]
  v_mfma_f32_32x32x16_bf16 v[144:159], v[212:215], v[68:71], v[144:159]
  v_mfma_f32_32x32x16_bf16 v[160:175], v[68:71], v[216:219], v[160:175]
  s_waitcnt lgkmcnt(0)
  s_waitcnt vmcnt(0)
  v_mfma_f32_32x32x16_bf16 v[80:95], v[220:223], v[72:75], v[80:95]
  v_mfma_f32_32x32x16_bf16 v[96:111], v[224:227], v[72:75], v[96:111]
  v_mfma_f32_32x32x16_bf16 v[112:127], v[72:75], v[228:231], v[112:127]
  v_mfma_f32_32x32x16_bf16 v[128:143], v[220:223], v[76:79], v[128:143]
  v_mfma_f32_32x32x16_bf16 v[144:159], v[224:227], v[76:79], v[144:159]
  v_mfma_f32_32x32x16_bf16 v[160:175], v[76:79], v[228:231], v[160:175]
  s_nop 11
  s_mov_b32 s30, 0x3ea52b5c
  v_mov_b32 v5, 0
  v_cmp_gt_u32 s[34:35], 32, v1
  v_mov_b32 v6, 1.0
  v_and_b32 v7, 31, v1
  v_cndmask_b32 v6, v5, v6, s[34:35]
  v_cmp_eq_u32 s[32:33], 20, v7
  v_mov_b32 v8, 1.0
  s_lshl_b32 s31, s22, 6
  s_add_u32 s31, s31, s24
  s_lshl_b32 s31, s31, 11
  v_mov_b32 v9, 0
  v_max3_f32 v9, v9, abs(v96), abs(v97)
  v_max3_f32 v9, v9, abs(v98), abs(v99)
  v_max3_f32 v9, v9, abs(v100), abs(v101)
  v_max3_f32 v9, v9, abs(v102), abs(v103)
  v_max3_f32 v9, v9, abs(v104), abs(v105)
  v_max3_f32 v9, v9, abs(v106), abs(v107)
  v_max3_f32 v9, v9, abs(v108), abs(v109)
  v_max3_f32 v9, v9, abs(v110), abs(v111)
  v_add_f32 v108, v108, v6
  v_cndmask_b32 v112, v112, v8, s[32:33]
  v_cndmask_b32 v113, v113, v8, s[32:33]
  v_cndmask_b32 v114, v114, v8, s[32:33]
  v_cndmask_b32 v115, v115, v8, s[32:33]
  v_cndmask_b32 v116, v116, v8, s[32:33]
  v_cndmask_b32 v117, v117, v8, s[32:33]
  v_cndmask_b32 v118, v118, v8, s[32:33]
  v_cndmask_b32 v119, v119, v8, s[32:33]
  v_cndmask_b32 v120, v120, v8, s[32:33]
  v_cndmask_b32 v121, v121, v8, s[32:33]
  v_cndmask_b32 v122, v122, v8, s[32:33]
  v_cndmask_b32 v123, v123, v8, s[32:33]
  v_cndmask_b32 v124, v124, v8, s[32:33]
  v_cndmask_b32 v125, v125, v8, s[32:33]
  v_cndmask_b32 v126, v126, v8, s[32:33]
  v_cndmask_b32 v127, v127, v8, s[32:33]
  v_cvt_pk_bf16_f32 v16, v96, v97
  v_cvt_pk_bf16_f32 v17, v98, v99
  v_cvt_pk_bf16_f32 v18, v100, v101
  v_cvt_pk_bf16_f32 v19, v102, v103
  v_cvt_pk_bf16_f32 v20, v104, v105
  v_cvt_pk_bf16_f32 v21, v106, v107
  v_cvt_pk_bf16_f32 v22, v108, v109
  v_cvt_pk_bf16_f32 v23, v110, v111
  s_add_u32 s29, s31, 245366784
  buffer_store_dwordx4 v[16:19], v2, s[8:11], s29 offen sc1
  buffer_store_dwordx4 v[20:23], v2, s[8:11], s29 offen offset:1024 sc1
  v_cvt_pk_bf16_f32 v24, v112, v113
  v_cvt_pk_bf16_f32 v25, v114, v115
  v_cvt_pk_bf16_f32 v26, v116, v117
  v_cvt_pk_bf16_f32 v27, v118, v119
  v_cvt_pk_bf16_f32 v28, v120, v121
  v_cvt_pk_bf16_f32 v29, v122, v123
  v_cvt_pk_bf16_f32 v30, v124, v125
  v_cvt_pk_bf16_f32 v31, v126, v127
  s_add_u32 s29, s31, 249561088
  buffer_store_dwordx4 v[24:27], v2, s[8:11], s29 offen sc1
  buffer_store_dwordx4 v[28:31], v2, s[8:11], s29 offen offset:1024 sc1
  v_mul_f32 v80, s30, v80
  v_mul_f32 v81, s30, v81
  v_mul_f32 v82, s30, v82
  v_mul_f32 v83, s30, v83
  v_mul_f32 v84, s30, v84
  v_mul_f32 v85, s30, v85
  v_mul_f32 v86, s30, v86
  v_mul_f32 v87, s30, v87
  v_mul_f32 v88, s30, v88
  v_mul_f32 v89, s30, v89
  v_mul_f32 v90, s30, v90
  v_mul_f32 v91, s30, v91
  v_mul_f32 v92, s30, v92
  v_mul_f32 v93, s30, v93
  v_mul_f32 v94, s30, v94
  v_mul_f32 v95, s30, v95
  v_cvt_pk_bf16_f32 v192, v80, v81
  v_cvt_pk_bf16_f32 v193, v82, v83
  v_cvt_pk_bf16_f32 v194, v84, v85
  v_cvt_pk_bf16_f32 v195, v86, v87
  v_cvt_pk_bf16_f32 v196, v88, v89
  v_cvt_pk_bf16_f32 v197, v90, v91
  v_cvt_pk_bf16_f32 v198, v92, v93
  v_cvt_pk_bf16_f32 v199, v94, v95
  v_max3_f32 v9, v9, abs(v144), abs(v145)
  v_max3_f32 v9, v9, abs(v146), abs(v147)
  v_max3_f32 v9, v9, abs(v148), abs(v149)
  v_max3_f32 v9, v9, abs(v150), abs(v151)
  v_max3_f32 v9, v9, abs(v152), abs(v153)
  v_max3_f32 v9, v9, abs(v154), abs(v155)
  v_max3_f32 v9, v9, abs(v156), abs(v157)
  v_max3_f32 v9, v9, abs(v158), abs(v159)
  v_add_f32 v156, v156, v6
  v_cndmask_b32 v160, v160, v8, s[32:33]
  v_cndmask_b32 v161, v161, v8, s[32:33]
  v_cndmask_b32 v162, v162, v8, s[32:33]
  v_cndmask_b32 v163, v163, v8, s[32:33]
  v_cndmask_b32 v164, v164, v8, s[32:33]
  v_cndmask_b32 v165, v165, v8, s[32:33]
  v_cndmask_b32 v166, v166, v8, s[32:33]
  v_cndmask_b32 v167, v167, v8, s[32:33]
  v_cndmask_b32 v168, v168, v8, s[32:33]
  v_cndmask_b32 v169, v169, v8, s[32:33]
  v_cndmask_b32 v170, v170, v8, s[32:33]
  v_cndmask_b32 v171, v171, v8, s[32:33]
  v_cndmask_b32 v172, v172, v8, s[32:33]
  v_cndmask_b32 v173, v173, v8, s[32:33]
  v_cndmask_b32 v174, v174, v8, s[32:33]
  v_cndmask_b32 v175, v175, v8, s[32:33]
  v_cvt_pk_bf16_f32 v32, v144, v145
  v_cvt_pk_bf16_f32 v33, v146, v147
  v_cvt_pk_bf16_f32 v34, v148, v149
  v_cvt_pk_bf16_f32 v35, v150, v151
  v_cvt_pk_bf16_f32 v36, v152, v153
  v_cvt_pk_bf16_f32 v37, v154, v155
  v_cvt_pk_bf16_f32 v38, v156, v157
  v_cvt_pk_bf16_f32 v39, v158, v159
  s_add_u32 s29, s31, 245368832
  buffer_store_dwordx4 v[32:35], v2, s[8:11], s29 offen sc1
  buffer_store_dwordx4 v[36:39], v2, s[8:11], s29 offen offset:1024 sc1
  v_cvt_pk_bf16_f32 v40, v160, v161
  v_cvt_pk_bf16_f32 v41, v162, v163
  v_cvt_pk_bf16_f32 v42, v164, v165
  v_cvt_pk_bf16_f32 v43, v166, v167
  v_cvt_pk_bf16_f32 v44, v168, v169
  v_cvt_pk_bf16_f32 v45, v170, v171
  v_cvt_pk_bf16_f32 v46, v172, v173
  v_cvt_pk_bf16_f32 v47, v174, v175
  s_add_u32 s29, s31, 249563136
  buffer_store_dwordx4 v[40:43], v2, s[8:11], s29 offen sc1
  buffer_store_dwordx4 v[44:47], v2, s[8:11], s29 offen offset:1024 sc1
  v_mul_f32 v128, s30, v128
  v_mul_f32 v129, s30, v129
  v_mul_f32 v130, s30, v130
  v_mul_f32 v131, s30, v131
  v_mul_f32 v132, s30, v132
  v_mul_f32 v133, s30, v133
  v_mul_f32 v134, s30, v134
  v_mul_f32 v135, s30, v135
  v_mul_f32 v136, s30, v136
  v_mul_f32 v137, s30, v137
  v_mul_f32 v138, s30, v138
  v_mul_f32 v139, s30, v139
  v_mul_f32 v140, s30, v140
  v_mul_f32 v141, s30, v141
  v_mul_f32 v142, s30, v142
  v_mul_f32 v143, s30, v143
  v_cvt_pk_bf16_f32 v200, v128, v129
  v_cvt_pk_bf16_f32 v201, v130, v131
  v_cvt_pk_bf16_f32 v202, v132, v133
  v_cvt_pk_bf16_f32 v203, v134, v135
  v_cvt_pk_bf16_f32 v204, v136, v137
  v_cvt_pk_bf16_f32 v205, v138, v139
  v_cvt_pk_bf16_f32 v206, v140, v141
  v_cvt_pk_bf16_f32 v207, v142, v143
  s_nop 1
  v_max_f32_dpp v10, v9, v9 quad_perm:[1,0,3,2] row_mask:0xf bank_mask:0xf
  s_nop 1
  v_max_f32_dpp v9, v10, v10 quad_perm:[2,3,0,1] row_mask:0xf bank_mask:0xf
  s_nop 1
  v_max_f32_dpp v10, v9, v9 row_half_mirror row_mask:0xf bank_mask:0xf
  s_nop 1
  v_max_f32_dpp v9, v10, v10 row_mirror row_mask:0xf bank_mask:0xf
  v_mov_b32 v10, v9
  s_nop 1
  v_permlane16_swap_b32 v9, v10
  v_max_f32 v9, v9, v10
  v_mov_b32 v10, v9
  s_nop 1
  v_permlane32_swap_b32 v9, v10
  v_max_f32 v9, v9, v10
  s_lshl_b32 s51, s22, 2
  s_add_u32 s51, s51, 0xb800
  v_mov_b32 v11, 0
  s_mov_b64 s[40:41], exec
  s_mov_b64 exec, 1
  buffer_atomic_umax v9, v11, s[8:11], s51 offen
  s_mov_b64 exec, s[40:41]
  s_mov_b32 s52, s24
  s_waitcnt vmcnt(0)
  s_barrier
  s_cmp_eq_u32 s21, 0
  s_cbranch_scc0 arr_106
  s_mov_b64 s[24:25], exec
  s_mov_b64 exec, 1
  v_mov_b32 v3, 0
  v_mov_b32 v4, 1
  buffer_atomic_add v4, v3, s[8:11], s47 offen
  s_mov_b64 exec, s[24:25]
arr_106:
  s_and_b32 s26, s2, 3
  s_mul_i32 s26, s26, 10
  s_mul_i32 s27, s21, 3
  s_cmp_eq_u32 s21, 3
  s_cselect_b32 s27, 8, s27
  s_add_u32 s50, s26, s27
  s_mul_i32 s26, s50, 20480
  s_add_u32 s26, s26, 0xe000000
  s_add_u32 s27, s26, 0
  buffer_load_dwordx4 a[0:3], v2, s[8:11], s27 offen
  s_add_u32 s27, s26, 1024
  buffer_load_dwordx4 a[4:7], v2, s[8:11], s27 offen
  s_add_u32 s27, s26, 2048
  buffer_load_dwordx4 a[8:11], v2, s[8:11], s27 offen
  s_add_u32 s27, s26, 3072
  buffer_load_dwordx4 a[12:15], v2, s[8:11], s27 offen
  s_add_u32 s27, s26, 4096
  buffer_load_dwordx4 a[16:19], v2, s[8:11], s27 offen
  s_add_u32 s27, s26, 5120
  buffer_load_dwordx4 a[20:23], v2, s[8:11], s27 offen
  s_add_u32 s27, s26, 6144
  buffer_load_dwordx4 a[24:27], v2, s[8:11], s27 offen
  s_add_u32 s27, s26, 7168
  buffer_load_dwordx4 a[28:31], v2, s[8:11], s27 offen
  s_add_u32 s27, s26, 8192
  buffer_load_dwordx4 a[32:35], v2, s[8:11], s27 offen
  s_add_u32 s27, s26, 9216
  buffer_load_dwordx4 a[36:39], v2, s[8:11], s27 offen
  s_add_u32 s27, s26, 10240
  buffer_load_dwordx4 a[40:43], v2, s[8:11], s27 offen
  s_add_u32 s27, s26, 11264
  buffer_load_dwordx4 a[44:47], v2, s[8:11], s27 offen
  s_add_u32 s27, s26, 12288
  buffer_load_dwordx4 a[48:51], v2, s[8:11], s27 offen
  s_add_u32 s27, s26, 13312
  buffer_load_dwordx4 a[52:55], v2, s[8:11], s27 offen
  s_add_u32 s27, s26, 14336
  buffer_load_dwordx4 a[56:59], v2, s[8:11], s27 offen
  s_add_u32 s27, s26, 15360
  buffer_load_dwordx4 a[60:63], v2, s[8:11], s27 offen
  s_add_u32 s27, s26, 16384
  buffer_load_dwordx4 a[64:67], v2, s[8:11], s27 offen
  s_add_u32 s27, s26, 17408
  buffer_load_dwordx4 a[68:71], v2, s[8:11], s27 offen
  s_add_u32 s27, s26, 18432
  buffer_load_dwordx4 a[72:75], v2, s[8:11], s27 offen
  s_add_u32 s27, s26, 19456
  buffer_load_dwordx4 a[76:79], v2, s[8:11], s27 offen
  s_add_u32 s27, s26, 20480
  buffer_load_dwordx4 a[80:83], v2, s[8:11], s27 offen
  s_add_u32 s27, s26, 21504
  buffer_load_dwordx4 a[84:87], v2, s[8:11], s27 offen
  s_add_u32 s27, s26, 22528
  buffer_load_dwordx4 a[88:91], v2, s[8:11], s27 offen
  s_add_u32 s27, s26, 23552
  buffer_load_dwordx4 a[92:95], v2, s[8:11], s27 offen
  s_add_u32 s27, s26, 24576
  buffer_load_dwordx4 a[96:99], v2, s[8:11], s27 offen
  s_add_u32 s27, s26, 25600
  buffer_load_dwordx4 a[100:103], v2, s[8:11], s27 offen
  s_add_u32 s27, s26, 26624
  buffer_load_dwordx4 a[104:107], v2, s[8:11], s27 offen
  s_add_u32 s27, s26, 27648
  buffer_load_dwordx4 a[108:111], v2, s[8:11], s27 offen
  s_add_u32 s27, s26, 28672
  buffer_load_dwordx4 a[112:115], v2, s[8:11], s27 offen
  s_add_u32 s27, s26, 29696
  buffer_load_dwordx4 a[116:119], v2, s[8:11], s27 offen
  s_add_u32 s27, s26, 30720
  buffer_load_dwordx4 a[120:123], v2, s[8:11], s27 offen
  s_add_u32 s27, s26, 31744
  buffer_load_dwordx4 a[124:127], v2, s[8:11], s27 offen
  s_add_u32 s27, s26, 32768
  buffer_load_dwordx4 a[128:131], v2, s[8:11], s27 offen
  s_add_u32 s27, s26, 33792
  buffer_load_dwordx4 a[132:135], v2, s[8:11], s27 offen
  s_add_u32 s27, s26, 34816
  buffer_load_dwordx4 a[136:139], v2, s[8:11], s27 offen
  s_add_u32 s27, s26, 35840
  buffer_load_dwordx4 a[140:143], v2, s[8:11], s27 offen
  s_add_u32 s27, s26, 36864
  buffer_load_dwordx4 a[144:147], v2, s[8:11], s27 offen
  s_add_u32 s27, s26, 37888
  buffer_load_dwordx4 a[148:151], v2, s[8:11], s27 offen
  s_add_u32 s27, s26, 38912
  buffer_load_dwordx4 a[152:155], v2, s[8:11], s27 offen
  s_add_u32 s27, s26, 39936
  buffer_load_dwordx4 a[156:159], v2, s[8:11], s27 offen
  s_cmp_lt_u32 s21, 2
  s_cbranch_scc0 g3_107
  s_add_u32 s27, s26, 40960
  buffer_load_dwordx4 a[160:163], v2, s[8:11], s27 offen
  s_add_u32 s27, s26, 41984
  buffer_load_dwordx4 a[164:167], v2, s[8:11], s27 offen
  s_add_u32 s27, s26, 43008
  buffer_load_dwordx4 a[168:171], v2, s[8:11], s27 offen
  s_add_u32 s27, s26, 44032
  buffer_load_dwordx4 a[172:175], v2, s[8:11], s27 offen
  s_add_u32 s27, s26, 45056
  buffer_load_dwordx4 a[176:179], v2, s[8:11], s27 offen
  s_add_u32 s27, s26, 46080
  buffer_load_dwordx4 a[180:183], v2, s[8:11], s27 offen
  s_add_u32 s27, s26, 47104
  buffer_load_dwordx4 a[184:187], v2, s[8:11], s27 offen
  s_add_u32 s27, s26, 48128
  buffer_load_dwordx4 a[188:191], v2, s[8:11], s27 offen
  s_add_u32 s27, s26, 49152
  buffer_load_dwordx4 a[192:195], v2, s[8:11], s27 offen
  s_add_u32 s27, s26, 50176
  buffer_load_dwordx4 a[196:199], v2, s[8:11], s27 offen
  s_add_u32 s27, s26, 51200
  buffer_load_dwordx4 a[200:203], v2, s[8:11], s27 offen
  s_add_u32 s27, s26, 52224
  buffer_load_dwordx4 a[204:207], v2, s[8:11], s27 offen
  s_add_u32 s27, s26, 53248
  buffer_load_dwordx4 a[208:211], v2, s[8:11], s27 offen
  s_add_u32 s27, s26, 54272
  buffer_load_dwordx4 a[212:215], v2, s[8:11], s27 offen
  s_add_u32 s27, s26, 55296
  buffer_load_dwordx4 a[216:219], v2, s[8:11], s27 offen
  s_add_u32 s27, s26, 56320
  buffer_load_dwordx4 a[220:223], v2, s[8:11], s27 offen
  s_add_u32 s27, s26, 57344
  buffer_load_dwordx4 a[224:227], v2, s[8:11], s27 offen
  s_add_u32 s27, s26, 58368
  buffer_load_dwordx4 a[228:231], v2, s[8:11], s27 offen
  s_add_u32 s27, s26, 59392
  buffer_load_dwordx4 a[232:235], v2, s[8:11], s27 offen
  s_add_u32 s27, s26, 60416
  buffer_load_dwordx4 a[236:239], v2, s[8:11], s27 offen
g3_107:
  v_mov_b32 v12, 0
  v_lshlrev_b32 v6, 16, v192
  v_and_b32 v7, 0xffff0000, v192
  v_add_f32_e64 v12, v12, abs(v6)
  v_add_f32_e64 v12, v12, abs(v7)
  v_lshlrev_b32 v6, 16, v193
  v_and_b32 v7, 0xffff0000, v193
  v_add_f32_e64 v12, v12, abs(v6)
  v_add_f32_e64 v12, v12, abs(v7)
  v_lshlrev_b32 v6, 16, v194
  v_and_b32 v7, 0xffff0000, v194
  v_add_f32_e64 v12, v12, abs(v6)
  v_add_f32_e64 v12, v12, abs(v7)
  v_lshlrev_b32 v6, 16, v195
  v_and_b32 v7, 0xffff0000, v195
  v_add_f32_e64 v12, v12, abs(v6)
  v_add_f32_e64 v12, v12, abs(v7)
  v_lshlrev_b32 v6, 16, v196
  v_and_b32 v7, 0xffff0000, v196
  v_add_f32_e64 v12, v12, abs(v6)
  v_add_f32_e64 v12, v12, abs(v7)
  v_lshlrev_b32 v6, 16, v197
  v_and_b32 v7, 0xffff0000, v197
  v_add_f32_e64 v12, v12, abs(v6)
  v_add_f32_e64 v12, v12, abs(v7)
  v_lshlrev_b32 v6, 16, v198
  v_and_b32 v7, 0xffff0000, v198
  v_add_f32_e64 v12, v12, abs(v6)
  v_add_f32_e64 v12, v12, abs(v7)
  v_lshlrev_b32 v6, 16, v199
  v_and_b32 v7, 0xffff0000, v199
  v_add_f32_e64 v12, v12, abs(v6)
  v_add_f32_e64 v12, v12, abs(v7)
  v_mov_b32 v6, v12
  s_nop 1
  v_permlane32_swap_b32 v12, v6
  v_add_f32 v12, v12, v6
  v_mov_b32 v13, 0
  v_lshlrev_b32 v6, 16, v200
  v_and_b32 v7, 0xffff0000, v200
  v_add_f32_e64 v13, v13, abs(v6)
  v_add_f32_e64 v13, v13, abs(v7)
  v_lshlrev_b32 v6, 16, v201
  v_and_b32 v7, 0xffff0000, v201
  v_add_f32_e64 v13, v13, abs(v6)
  v_add_f32_e64 v13, v13, abs(v7)
  v_lshlrev_b32 v6, 16, v202
  v_and_b32 v7, 0xffff0000, v202
  v_add_f32_e64 v13, v13, abs(v6)
  v_add_f32_e64 v13, v13, abs(v7)
  v_lshlrev_b32 v6, 16, v203
  v_and_b32 v7, 0xffff0000, v203
  v_add_f32_e64 v13, v13, abs(v6)
  v_add_f32_e64 v13, v13, abs(v7)
  v_lshlrev_b32 v6, 16, v204
  v_and_b32 v7, 0xffff0000, v204
  v_add_f32_e64 v13, v13, abs(v6)
  v_add_f32_e64 v13, v13, abs(v7)
  v_lshlrev_b32 v6, 16, v205
  v_and_b32 v7, 0xffff0000, v205
  v_add_f32_e64 v13, v13, abs(v6)
  v_add_f32_e64 v13, v13, abs(v7)
  v_lshlrev_b32 v6, 16, v206
  v_and_b32 v7, 0xffff0000, v206
  v_add_f32_e64 v13, v13, abs(v6)
  v_add_f32_e64 v13, v13, abs(v7)
  v_lshlrev_b32 v6, 16, v207
  v_and_b32 v7, 0xffff0000, v207
  v_add_f32_e64 v13, v13, abs(v6)
  v_add_f32_e64 v13, v13, abs(v7)
  v_mov_b32 v6, v13
  s_nop 1
  v_permlane32_swap_b32 v13, v6
  v_add_f32 v13, v13, v6
  s_mov_b32 s45, 0
  v_mov_b32 v3, 0
aw_108:
  buffer_load_dword v4, v3, s[8:11], s47 offen sc1
  s_add_u32 s45, s45, 1
  s_waitcnt vmcnt(0)
  v_readfirstlane_b32 s29, v4
  s_cmp_ge_u32 s29, 8
  s_cbranch_scc1 aw_108_ok
  s_cmp_lt_u32 s45, 400000
  s_cbranch_scc1 aw_108
  s_branch kb2_abort
aw_108_ok:
  v_mov_b32 v3, 0
  buffer_load_dword v4, v3, s[8:11], s51 offen sc1
  s_lshl_b32 s25, s22, 6
  s_lshl_b32 s27, s25, 11
  s_add_u32 s28, s27, 0xee00000
  s_add_u32 s27, s27, 0xea00000
  s_mov_b32 s41, 0
  s_mul_i32 s53, s41, 32768
  s_lshl_b32 s31, s21, 13
  s_add_u32 s53, s53, s31
  s_add_u32 m0, s31, 0
  s_add_u32 s29, s53, s27
  s_add_u32 s29, s29, 0
  buffer_load_dwordx4 v2, s[8:11], s29 offen sc1 lds
  s_add_u32 m0, s31, 1024
  s_add_u32 s29, s53, s27
  s_add_u32 s29, s29, 1024
  buffer_load_dwordx4 v2, s[8:11], s29 offen sc1 lds
  s_add_u32 m0, s31, 2048
  s_add_u32 s29, s53, s27
  s_add_u32 s29, s29, 2048
  buffer_load_dwordx4 v2, s[8:11], s29 offen sc1 lds
  s_add_u32 m0, s31, 3072
  s_add_u32 s29, s53, s27
  s_add_u32 s29, s29, 3072
  buffer_load_dwordx4 v2, s[8:11], s29 offen sc1 lds
  s_add_u32 m0, s31, 4096
  s_add_u32 s29, s53, s27
  s_add_u32 s29, s29, 4096
  buffer_load_dwordx4 v2, s[8:11], s29 offen sc1 lds
  s_add_u32 m0, s31, 5120
  s_add_u32 s29, s53, s27
  s_add_u32 s29, s29, 5120
  buffer_load_dwordx4 v2, s[8:11], s29 offen sc1 lds
  s_add_u32 m0, s31, 6144
  s_add_u32 s29, s53, s27
  s_add_u32 s29, s29, 6144
  buffer_load_dwordx4 v2, s[8:11], s29 offen sc1 lds
  s_add_u32 m0, s31, 7168
  s_add_u32 s29, s53, s27
  s_add_u32 s29, s29, 7168
  buffer_load_dwordx4 v2, s[8:11], s29 offen sc1 lds
  s_add_u32 m0, s31, 32768
  s_add_u32 s29, s53, s28
  s_add_u32 s29, s29, 0
  buffer_load_dwordx4 v2, s[8:11], s29 offen sc1 lds
  s_add_u32 m0, s31, 33792
  s_add_u32 s29, s53, s28
  s_add_u32 s29, s29, 1024
  buffer_load_dwordx4 v2, s[8:11], s29 offen sc1 lds
  s_add_u32 m0, s31, 34816
  s_add_u32 s29, s53, s28
  s_add_u32 s29, s29, 2048
  buffer_load_dwordx4 v2, s[8:11], s29 offen sc1 lds
  s_add_u32 m0, s31, 35840
  s_add_u32 s29, s53, s28
  s_add_u32 s29, s29, 3072
  buffer_load_dwordx4 v2, s[8:11], s29 offen sc1 lds
  s_add_u32 m0, s31, 36864
  s_add_u32 s29, s53, s28
  s_add_u32 s29, s29, 4096
  buffer_load_dwordx4 v2, s[8:11], s29 offen sc1 lds
  s_add_u32 m0, s31, 37888
  s_add_u32 s29, s53, s28
  s_add_u32 s29, s29, 5120
  buffer_load_dwordx4 v2, s[8:11], s29 offen sc1 lds
  s_add_u32 m0, s31, 38912
  s_add_u32 s29, s53, s28
  s_add_u32 s29, s29, 6144
  buffer_load_dwordx4 v2, s[8:11], s29 offen sc1 lds
  s_add_u32 m0, s31, 39936
  s_add_u32 s29, s53, s28
  s_add_u32 s29, s29, 7168
  buffer_load_dwordx4 v2, s[8:11], s29 offen sc1 lds
  s_waitcnt vmcnt(16)
  v_mul_f32 v12, v12, v4
  v_mul_f32 v12, 0x3f820000, v12
  v_mul_f32 v13, v13, v4
  v_mul_f32 v13, 0x3f820000, v13
  s_mov_b32 s40, 0
kb2_main:
  v_lshrrev_b32 v5, 16, v12
  v_or_b32 v5, 0x8000, v5
  v_and_b32 v6, 0xffff0000, v198
  v_or_b32 v5, v5, v6
  v_cndmask_b32 v198, v198, v5, s[34:35]
  v_lshrrev_b32 v5, 16, v13
  v_or_b32 v5, 0x8000, v5
  v_and_b32 v6, 0xffff0000, v206
  v_or_b32 v5, v5, v6
  v_cndmask_b32 v206, v206, v5, s[34:35]
kb2_main2:
  v_mov_b32 v112, 0
  v_mov_b32 v113, 0
  v_mov_b32 v114, 0
  v_mov_b32 v115, 0
  v_mov_b32 v116, 0
  v_mov_b32 v117, 0
  v_mov_b32 v118, 0
  v_mov_b32 v119, 0
  v_mov_b32 v120, 0
  v_mov_b32 v121, 0
  v_mov_b32 v122, 0
  v_mov_b32 v123, 0
  v_mov_b32 v124, 0
  v_mov_b32 v125, 0
  v_mov_b32 v126, 0
  v_mov_b32 v127, 0
  v_mov_b32 v128, 0
  v_mov_b32 v129, 0
  v_mov_b32 v130, 0
  v_mov_b32 v131, 0
  v_mov_b32 v132, 0
  v_mov_b32 v133, 0
  v_mov_b32 v134, 0
  v_mov_b32 v135, 0
  v_mov_b32 v136, 0
  v_mov_b32 v137, 0
  v_mov_b32 v138, 0
  v_mov_b32 v139, 0
  v_mov_b32 v140, 0
  v_mov_b32 v141, 0
  v_mov_b32 v142, 0
  v_mov_b32 v143, 0
  v_mov_b32 v3, v2
  v_add_u32 v4, 65536, v2
kb2_chunk2:
  s_waitcnt vmcnt(0)
  s_barrier
  s_add_u32 s41, s41, 1
  s_min_u32 s29, s41, 3
  s_mul_i32 s53, s29, 32768
  s_lshl_b32 s31, s21, 13
  s_add_u32 s53, s53, s31
  ds_read_b128 v[32:35], v3 offset:0
  ds_read_b128 v[36:39], v3 offset:1024
  ds_read_b128 v[48:51], v3 offset:32768
  ds_read_b128 v[52:55], v3 offset:33792
  ds_read_b128 v[40:43], v3 offset:2048
  ds_read_b128 v[44:47], v3 offset:3072
  s_waitcnt lgkmcnt(4)
  v_mfma_f32_32x32x16_bf16 v[64:79], v[32:35], v[192:195], 0
  v_mfma_f32_32x32x16_bf16 v[64:79], v[36:39], v[196:199], v[64:79]
  s_nop 11
  v_exp_f32 v64, v64
  v_exp_f32 v65, v65
  v_exp_f32 v66, v66
  v_exp_f32 v67, v67
  v_cvt_pk_bf16_f32 v96, v64, v65
  v_exp_f32 v68, v68
  v_exp_f32 v69, v69
  v_cvt_pk_bf16_f32 v97, v66, v67
  v_exp_f32 v70, v70
  v_mfma_f32_32x32x16_bf16 v[80:95], v[32:35], v[200:203], 0
  v_exp_f32 v71, v71
  v_cvt_pk_bf16_f32 v98, v68, v69
  v_exp_f32 v72, v72
  v_exp_f32 v73, v73
  v_cvt_pk_bf16_f32 v99, v70, v71
  v_mfma_f32_32x32x16_bf16 v[80:95], v[36:39], v[204:207], v[80:95]
  v_exp_f32 v74, v74
  v_exp_f32 v75, v75
  ds_read_b128 v[56:59], v3 offset:34816
  v_cvt_pk_bf16_f32 v100, v72, v73
  v_exp_f32 v76, v76
  v_exp_f32 v77, v77
  ds_read_b128 v[60:63], v3 offset:35840
  v_cvt_pk_bf16_f32 v101, v74, v75
  v_exp_f32 v78, v78
  s_add_u32 m0, s31, 65536
  s_add_u32 s29, s53, s27
  s_add_u32 s29, s29, 0
  buffer_load_dwordx4 v2, s[8:11], s29 offen sc1 lds
  v_exp_f32 v79, v79
  v_cvt_pk_bf16_f32 v102, v76, v77
  v_cvt_pk_bf16_f32 v103, v78, v79
  s_waitcnt lgkmcnt(4)
  v_mfma_f32_32x32x16_bf16 v[112:127], v[48:51], v[96:99], v[112:127]
  v_exp_f32 v80, v80
  v_exp_f32 v81, v81
  v_exp_f32 v82, v82
  v_exp_f32 v83, v83
  v_mfma_f32_32x32x16_bf16 v[112:127], v[52:55], v[100:103], v[112:127]
  v_cvt_pk_bf16_f32 v104, v80, v81
  v_exp_f32 v84, v84
  v_exp_f32 v85, v85
  v_cvt_pk_bf16_f32 v105, v82, v83
  v_exp_f32 v86, v86
  s_waitcnt lgkmcnt(2)
  v_mfma_f32_32x32x16_bf16 v[64:79], v[40:43], v[192:195], 0
  v_exp_f32 v87, v87
  v_cvt_pk_bf16_f32 v106, v84, v85
  v_exp_f32 v88, v88
  v_exp_f32 v89, v89
  v_cvt_pk_bf16_f32 v107, v86, v87
  v_mfma_f32_32x32x16_bf16 v[64:79], v[44:47], v[196:199], v[64:79]
  v_exp_f32 v90, v90
  v_exp_f32 v91, v91
  ds_read_b128 v[32:35], v3 offset:4096
  v_cvt_pk_bf16_f32 v108, v88, v89
  v_exp_f32 v92, v92
  v_exp_f32 v93, v93
  ds_read_b128 v[36:39], v3 offset:5120
  v_cvt_pk_bf16_f32 v109, v90, v91
  v_exp_f32 v94, v94
  v_exp_f32 v95, v95
  v_cvt_pk_bf16_f32 v110, v92, v93
  v_cvt_pk_bf16_f32 v111, v94, v95
  v_mfma_f32_32x32x16_bf16 v[128:143], v[48:51], v[104:107], v[128:143]
  v_exp_f32 v64, v64
  v_exp_f32 v65, v65
  v_exp_f32 v66, v66
  v_exp_f32 v67, v67
  v_mfma_f32_32x32x16_bf16 v[128:143], v[52:55], v[108:111], v[128:143]
  v_cvt_pk_bf16_f32 v96, v64, v65
  v_exp_f32 v68, v68
  v_exp_f32 v69, v69
  v_cvt_pk_bf16_f32 v97, v66, v67
  v_exp_f32 v70, v70
  v_mfma_f32_32x32x16_bf16 v[80:95], v[40:43], v[200:203], 0
  v_exp_f32 v71, v71
  v_cvt_pk_bf16_f32 v98, v68, v69
  v_exp_f32 v72, v72
  v_exp_f32 v73, v73
  v_cvt_pk_bf16_f32 v99, v70, v71
  v_mfma_f32_32x32x16_bf16 v[80:95], v[44:47], v[204:207], v[80:95]
  v_exp_f32 v74, v74
  v_exp_f32 v75, v75
  ds_read_b128 v[48:51], v3 offset:36864
  v_cvt_pk_bf16_f32 v100, v72, v73
  v_exp_f32 v76, v76
  v_exp_f32 v77, v77
  ds_read_b128 v[52:55], v3 offset:37888
  v_cvt_pk_bf16_f32 v101, v74, v75
  v_exp_f32 v78, v78
  s_add_u32 m0, s31, 66560
  s_add_u32 s29, s53, s27
  s_add_u32 s29, s29, 1024
  buffer_load_dwordx4 v2, s[8:11], s29 offen sc1 lds
  v_exp_f32 v79, v79
  v_cvt_pk_bf16_f32 v102, v76, v77
  v_cvt_pk_bf16_f32 v103, v78, v79
  s_waitcnt lgkmcnt(4)
  v_mfma_f32_32x32x16_bf16 v[112:127], v[56:59], v[96:99], v[112:127]
  v_exp_f32 v80, v80
  v_exp_f32 v81, v81
  v_exp_f32 v82, v82
  v_exp_f32 v83, v83
  v_mfma_f32_32x32x16_bf16 v[112:127], v[60:63], v[100:103], v[112:127]
  v_cvt_pk_bf16_f32 v104, v80, v81
  v_exp_f32 v84, v84
  v_exp_f32 v85, v85
  v_cvt_pk_bf16_f32 v105, v82, v83
  v_exp_f32 v86, v86
  s_waitcnt lgkmcnt(2)
  v_mfma_f32_32x32x16_bf16 v[64:79], v[32:35], v[192:195], 0
  v_exp_f32 v87, v87
  v_cvt_pk_bf16_f32 v106, v84, v85
  v_exp_f32 v88, v88
  v_exp_f32 v89, v89
  v_cvt_pk_bf16_f32 v107, v86, v87
  v_mfma_f32_32x32x16_bf16 v[64:79], v[36:39], v[196:199], v[64:79]
  v_exp_f32 v90, v90
  v_exp_f32 v91, v91
  ds_read_b128 v[40:43], v3 offset:6144
  v_cvt_pk_bf16_f32 v108, v88, v89
  v_exp_f32 v92, v92
  v_exp_f32 v93, v93
  ds_read_b128 v[44:47], v3 offset:7168
  v_cvt_pk_bf16_f32 v109, v90, v91
  v_exp_f32 v94, v94
  v_exp_f32 v95, v95
  v_cvt_pk_bf16_f32 v110, v92, v93
  v_cvt_pk_bf16_f32 v111, v94, v95
  v_mfma_f32_32x32x16_bf16 v[128:143], v[56:59], v[104:107], v[128:143]
  v_exp_f32 v64, v64
  v_exp_f32 v65, v65
  v_exp_f32 v66, v66
  v_exp_f32 v67, v67
  v_mfma_f32_32x32x16_bf16 v[128:143], v[60:63], v[108:111], v[128:143]
  v_cvt_pk_bf16_f32 v96, v64, v65
  v_exp_f32 v68, v68
  v_exp_f32 v69, v69
  v_cvt_pk_bf16_f32 v97, v66, v67
  v_exp_f32 v70, v70
  v_mfma_f32_32x32x16_bf16 v[80:95], v[32:35], v[200:203], 0
  v_exp_f32 v71, v71
  v_cvt_pk_bf16_f32 v98, v68, v69
  v_exp_f32 v72, v72
  v_exp_f32 v73, v73
  v_cvt_pk_bf16_f32 v99, v70, v71
  v_mfma_f32_32x32x16_bf16 v[80:95], v[36:39], v[204:207], v[80:95]
  v_exp_f32 v74, v74
  v_exp_f32 v75, v75
  ds_read_b128 v[56:59], v3 offset:38912
  v_cvt_pk_bf16_f32 v100, v72, v73
  v_exp_f32 v76, v76
  v_exp_f32 v77, v77
  ds_read_b128 v[60:63], v3 offset:39936
  v_cvt_pk_bf16_f32 v101, v74, v75
  v_exp_f32 v78, v78
  s_add_u32 m0, s31, 67584
  s_add_u32 s29, s53, s27
  s_add_u32 s29, s29, 2048
  buffer_load_dwordx4 v2, s[8:11], s29 offen sc1 lds
  v_exp_f32 v79, v79
  v_cvt_pk_bf16_f32 v102, v76, v77
  v_cvt_pk_bf16_f32 v103, v78, v79
  s_waitcnt lgkmcnt(4)
  v_mfma_f32_32x32x16_bf16 v[112:127], v[48:51], v[96:99], v[112:127]
  v_exp_f32 v80, v80
  v_exp_f32 v81, v81
  v_exp_f32 v82, v82
  v_exp_f32 v83, v83
  v_mfma_f32_32x32x16_bf16 v[112:127], v[52:55], v[100:103], v[112:127]
  v_cvt_pk_bf16_f32 v104, v80, v81
  v_exp_f32 v84, v84
  v_exp_f32 v85, v85
  v_cvt_pk_bf16_f32 v105, v82, v83
  v_exp_f32 v86, v86
  s_waitcnt lgkmcnt(2)
  v_mfma_f32_32x32x16_bf16 v[64:79], v[40:43], v[192:195], 0
  v_exp_f32 v87, v87
  v_cvt_pk_bf16_f32 v106, v84, v85
  v_exp_f32 v88, v88
  v_exp_f32 v89, v89
  v_cvt_pk_bf16_f32 v107, v86, v87
  v_mfma_f32_32x32x16_bf16 v[64:79], v[44:47], v[196:199], v[64:79]
  v_exp_f32 v90, v90
  v_exp_f32 v91, v91
  ds_read_b128 v[32:35], v3 offset:8192
  v_cvt_pk_bf16_f32 v108, v88, v89
  v_exp_f32 v92, v92
  v_exp_f32 v93, v93
  ds_read_b128 v[36:39], v3 offset:9216
  v_cvt_pk_bf16_f32 v109, v90, v91
  v_exp_f32 v94, v94
  v_exp_f32 v95, v95
  v_cvt_pk_bf16_f32 v110, v92, v93
  v_cvt_pk_bf16_f32 v111, v94, v95
  v_mfma_f32_32x32x16_bf16 v[128:143], v[48:51], v[104:107], v[128:143]
  v_exp_f32 v64, v64
  v_exp_f32 v65, v65
  v_exp_f32 v66, v66
  v_exp_f32 v67, v67
  v_mfma_f32_32x32x16_bf16 v[128:143], v[52:55], v[108:111], v[128:143]
  v_cvt_pk_bf16_f32 v96, v64, v65
  v_exp_f32 v68, v68
  v_exp_f32 v69, v69
  v_cvt_pk_bf16_f32 v97, v66, v67
  v_exp_f32 v70, v70
  v_mfma_f32_32x32x16_bf16 v[80:95], v[40:43], v[200:203], 0
  v_exp_f32 v71, v71
  v_cvt_pk_bf16_f32 v98, v68, v69
  v_exp_f32 v72, v72
  v_exp_f32 v73, v73
  v_cvt_pk_bf16_f32 v99, v70, v71
  v_mfma_f32_32x32x16_bf16 v[80:95], v[44:47], v[204:207], v[80:95]
  v_exp_f32 v74, v74
  v_exp_f32 v75, v75
  ds_read_b128 v[48:51], v3 offset:40960
  v_cvt_pk_bf16_f32 v100, v72, v73
  v_exp_f32 v76, v76
  v_exp_f32 v77, v77
  ds_read_b128 v[52:55], v3 offset:41984
  v_cvt_pk_bf16_f32 v101, v74, v75
  v_exp_f32 v78, v78
  s_add_u32 m0, s31, 68608
  s_add_u32 s29, s53, s27
  s_add_u32 s29, s29, 3072
  buffer_load_dwordx4 v2, s[8:11], s29 offen sc1 lds
  v_exp_f32 v79, v79
  v_cvt_pk_bf16_f32 v102, v76, v77
  v_cvt_pk_bf16_f32 v103, v78, v79
  s_waitcnt lgkmcnt(4)
  v_mfma_f32_32x32x16_bf16 v[112:127], v[56:59], v[96:99], v[112:127]
  v_exp_f32 v80, v80
  v_exp_f32 v81, v81
  v_exp_f32 v82, v82
  v_exp_f32 v83, v83
  v_mfma_f32_32x32x16_bf16 v[112:127], v[60:63], v[100:103], v[112:127]
  v_cvt_pk_bf16_f32 v104, v80, v81
  v_exp_f32 v84, v84
  v_exp_f32 v85, v85
  v_cvt_pk_bf16_f32 v105, v82, v83
  v_exp_f32 v86, v86
  s_waitcnt lgkmcnt(2)
  v_mfma_f32_32x32x16_bf16 v[64:79], v[32:35], v[192:195], 0
  v_exp_f32 v87, v87
  v_cvt_pk_bf16_f32 v106, v84, v85
  v_exp_f32 v88, v88
  v_exp_f32 v89, v89
  v_cvt_pk_bf16_f32 v107, v86, v87
  v_mfma_f32_32x32x16_bf16 v[64:79], v[36:39], v[196:199], v[64:79]
  v_exp_f32 v90, v90
  v_exp_f32 v91, v91
  ds_read_b128 v[40:43], v3 offset:10240
  v_cvt_pk_bf16_f32 v108, v88, v89
  v_exp_f32 v92, v92
  v_exp_f32 v93, v93
  ds_read_b128 v[44:47], v3 offset:11264
  v_cvt_pk_bf16_f32 v109, v90, v91
  v_exp_f32 v94, v94
  v_exp_f32 v95, v95
  v_cvt_pk_bf16_f32 v110, v92, v93
  v_cvt_pk_bf16_f32 v111, v94, v95
  v_mfma_f32_32x32x16_bf16 v[128:143], v[56:59], v[104:107], v[128:143]
  v_exp_f32 v64, v64
  v_exp_f32 v65, v65
  v_exp_f32 v66, v66
  v_exp_f32 v67, v67
  v_mfma_f32_32x32x16_bf16 v[128:143], v[60:63], v[108:111], v[128:143]
  v_cvt_pk_bf16_f32 v96, v64, v65
  v_exp_f32 v68, v68
  v_exp_f32 v69, v69
  v_cvt_pk_bf16_f32 v97, v66, v67
  v_exp_f32 v70, v70
  v_mfma_f32_32x32x16_bf16 v[80:95], v[32:35], v[200:203], 0
  v_exp_f32 v71, v71
  v_cvt_pk_bf16_f32 v98, v68, v69
  v_exp_f32 v72, v72
  v_exp_f32 v73, v73
  v_cvt_pk_bf16_f32 v99, v70, v71
  v_mfma_f32_32x32x16_bf16 v[80:95], v[36:39], v[204:207], v[80:95]
  v_exp_f32 v74, v74
  v_exp_f32 v75, v75
  ds_read_b128 v[56:59], v3 offset:43008
  v_cvt_pk_bf16_f32 v100, v72, v73
  v_exp_f32 v76, v76
  v_exp_f32 v77, v77
  ds_read_b128 v[60:63], v3 offset:44032
  v_cvt_pk_bf16_f32 v101, v74, v75
  v_exp_f32 v78, v78
  s_add_u32 m0, s31, 69632
  s_add_u32 s29, s53, s27
  s_add_u32 s29, s29, 4096
  buffer_load_dwordx4 v2, s[8:11], s29 offen sc1 lds
  v_exp_f32 v79, v79
  v_cvt_pk_bf16_f32 v102, v76, v77
  v_cvt_pk_bf16_f32 v103, v78, v79
  s_waitcnt lgkmcnt(4)
  v_mfma_f32_32x32x16_bf16 v[112:127], v[48:51], v[96:99], v[112:127]
  v_exp_f32 v80, v80
  v_exp_f32 v81, v81
  v_exp_f32 v82, v82
  v_exp_f32 v83, v83
  v_mfma_f32_32x32x16_bf16 v[112:127], v[52:55], v[100:103], v[112:127]
  v_cvt_pk_bf16_f32 v104, v80, v81
  v_exp_f32 v84, v84
  v_exp_f32 v85, v85
  v_cvt_pk_bf16_f32 v105, v82, v83
  v_exp_f32 v86, v86
  s_waitcnt lgkmcnt(2)
  v_mfma_f32_32x32x16_bf16 v[64:79], v[40:43], v[192:195], 0
  v_exp_f32 v87, v87
  v_cvt_pk_bf16_f32 v106, v84, v85
  v_exp_f32 v88, v88
  v_exp_f32 v89, v89
  v_cvt_pk_bf16_f32 v107, v86, v87
  v_mfma_f32_32x32x16_bf16 v[64:79], v[44:47], v[196:199], v[64:79]
  v_exp_f32 v90, v90
  v_exp_f32 v91, v91
  ds_read_b128 v[32:35], v3 offset:12288
  v_cvt_pk_bf16_f32 v108, v88, v89
  v_exp_f32 v92, v92
  v_exp_f32 v93, v93
  ds_read_b128 v[36:39], v3 offset:13312
  v_cvt_pk_bf16_f32 v109, v90, v91
  v_exp_f32 v94, v94
  v_exp_f32 v95, v95
  v_cvt_pk_bf16_f32 v110, v92, v93
  v_cvt_pk_bf16_f32 v111, v94, v95
  v_mfma_f32_32x32x16_bf16 v[128:143], v[48:51], v[104:107], v[128:143]
  v_exp_f32 v64, v64
  v_exp_f32 v65, v65
  v_exp_f32 v66, v66
  v_exp_f32 v67, v67
  v_mfma_f32_32x32x16_bf16 v[128:143], v[52:55], v[108:111], v[128:143]
  v_cvt_pk_bf16_f32 v96, v64, v65
  v_exp_f32 v68, v68
  v_exp_f32 v69, v69
  v_cvt_pk_bf16_f32 v97, v66, v67
  v_exp_f32 v70, v70
  v_mfma_f32_32x32x16_bf16 v[80:95], v[40:43], v[200:203], 0
  v_exp_f32 v71, v71
  v_cvt_pk_bf16_f32 v98, v68, v69
  v_exp_f32 v72, v72
  v_exp_f32 v73, v73
  v_cvt_pk_bf16_f32 v99, v70, v71
  v_mfma_f32_32x32x16_bf16 v[80:95], v[44:47], v[204:207], v[80:95]
  v_exp_f32 v74, v74
  v_exp_f32 v75, v75
  ds_read_b128 v[48:51], v3 offset:45056
  v_cvt_pk_bf16_f32 v100, v72, v73
  v_exp_f32 v76, v76
  v_exp_f32 v77, v77
  ds_read_b128 v[52:55], v3 offset:46080
  v_cvt_pk_bf16_f32 v101, v74, v75
  v_exp_f32 v78, v78
  s_add_u32 m0, s31, 70656
  s_add_u32 s29, s53, s27
  s_add_u32 s29, s29, 5120
  buffer_load_dwordx4 v2, s[8:11], s29 offen sc1 lds
  v_exp_f32 v79, v79
  v_cvt_pk_bf16_f32 v102, v76, v77
  v_cvt_pk_bf16_f32 v103, v78, v79
  s_waitcnt lgkmcnt(4)
  v_mfma_f32_32x32x16_bf16 v[112:127], v[56:59], v[96:99], v[112:127]
  v_exp_f32 v80, v80
  v_exp_f32 v81, v81
  v_exp_f32 v82, v82
  v_exp_f32 v83, v83
  v_mfma_f32_32x32x16_bf16 v[112:127], v[60:63], v[100:103], v[112:127]
  v_cvt_pk_bf16_f32 v104, v80, v81
  v_exp_f32 v84, v84
  v_exp_f32 v85, v85
  v_cvt_pk_bf16_f32 v105, v82, v83
  v_exp_f32 v86, v86
  s_waitcnt lgkmcnt(2)
  v_mfma_f32_32x32x16_bf16 v[64:79], v[32:35], v[192:195], 0
  v_exp_f32 v87, v87
  v_cvt_pk_bf16_f32 v106, v84, v85
  v_exp_f32 v88, v88
  v_exp_f32 v89, v89
  v_cvt_pk_bf16_f32 v107, v86, v87
  v_mfma_f32_32x32x16_bf16 v[64:79], v[36:39], v[196:199], v[64:79]
  v_exp_f32 v90, v90
  v_exp_f32 v91, v91
  ds_read_b128 v[40:43], v3 offset:14336
  v_cvt_pk_bf16_f32 v108, v88, v89
  v_exp_f32 v92, v92
  v_exp_f32 v93, v93
  ds_read_b128 v[44:47], v3 offset:15360
  v_cvt_pk_bf16_f32 v109, v90, v91
  v_exp_f32 v94, v94
  v_exp_f32 v95, v95
  v_cvt_pk_bf16_f32 v110, v92, v93
  v_cvt_pk_bf16_f32 v111, v94, v95
  v_mfma_f32_32x32x16_bf16 v[128:143], v[56:59], v[104:107], v[128:143]
  v_exp_f32 v64, v64
  v_exp_f32 v65, v65
  v_exp_f32 v66, v66
  v_exp_f32 v67, v67
  v_mfma_f32_32x32x16_bf16 v[128:143], v[60:63], v[108:111], v[128:143]
  v_cvt_pk_bf16_f32 v96, v64, v65
  v_exp_f32 v68, v68
  v_exp_f32 v69, v69
  v_cvt_pk_bf16_f32 v97, v66, v67
  v_exp_f32 v70, v70
  v_mfma_f32_32x32x16_bf16 v[80:95], v[32:35], v[200:203], 0
  v_exp_f32 v71, v71
  v_cvt_pk_bf16_f32 v98, v68, v69
  v_exp_f32 v72, v72
  v_exp_f32 v73, v73
  v_cvt_pk_bf16_f32 v99, v70, v71
  v_mfma_f32_32x32x16_bf16 v[80:95], v[36:39], v[204:207], v[80:95]
  v_exp_f32 v74, v74
  v_exp_f32 v75, v75
  ds_read_b128 v[56:59], v3 offset:47104
  v_cvt_pk_bf16_f32 v100, v72, v73
  v_exp_f32 v76, v76
  v_exp_f32 v77, v77
  ds_read_b128 v[60:63], v3 offset:48128
  v_cvt_pk_bf16_f32 v101, v74, v75
  v_exp_f32 v78, v78
  s_add_u32 m0, s31, 71680
  s_add_u32 s29, s53, s27
  s_add_u32 s29, s29, 6144
  buffer_load_dwordx4 v2, s[8:11], s29 offen sc1 lds
  v_exp_f32 v79, v79
  v_cvt_pk_bf16_f32 v102, v76, v77
  v_cvt_pk_bf16_f32 v103, v78, v79
  s_waitcnt lgkmcnt(4)
  v_mfma_f32_32x32x16_bf16 v[112:127], v[48:51], v[96:99], v[112:127]
  v_exp_f32 v80, v80
  v_exp_f32 v81, v81
  v_exp_f32 v82, v82
  v_exp_f32 v83, v83
  v_mfma_f32_32x32x16_bf16 v[112:127], v[52:55], v[100:103], v[112:127]
  v_cvt_pk_bf16_f32 v104, v80, v81
  v_exp_f32 v84, v84
  v_exp_f32 v85, v85
  v_cvt_pk_bf16_f32 v105, v82, v83
  v_exp_f32 v86, v86
  s_waitcnt lgkmcnt(2)
  v_mfma_f32_32x32x16_bf16 v[64:79], v[40:43], v[192:195], 0
  v_exp_f32 v87, v87
  v_cvt_pk_bf16_f32 v106, v84, v85
  v_exp_f32 v88, v88
  v_exp_f32 v89, v89
  v_cvt_pk_bf16_f32 v107, v86, v87
  v_mfma_f32_32x32x16_bf16 v[64:79], v[44:47], v[196:199], v[64:79]
  v_exp_f32 v90, v90
  v_exp_f32 v91, v91
  ds_read_b128 v[32:35], v3 offset:16384
  v_cvt_pk_bf16_f32 v108, v88, v89
  v_exp_f32 v92, v92
  v_exp_f32 v93, v93
  ds_read_b128 v[36:39], v3 offset:17408
  v_cvt_pk_bf16_f32 v109, v90, v91
  v_exp_f32 v94, v94
  v_exp_f32 v95, v95
  v_cvt_pk_bf16_f32 v110, v92, v93
  v_cvt_pk_bf16_f32 v111, v94, v95
  v_mfma_f32_32x32x16_bf16 v[128:143], v[48:51], v[104:107], v[128:143]
  v_exp_f32 v64, v64
  v_exp_f32 v65, v65
  v_exp_f32 v66, v66
  v_exp_f32 v67, v67
  v_mfma_f32_32x32x16_bf16 v[128:143], v[52:55], v[108:111], v[128:143]
  v_cvt_pk_bf16_f32 v96, v64, v65
  v_exp_f32 v68, v68
  v_exp_f32 v69, v69
  v_cvt_pk_bf16_f32 v97, v66, v67
  v_exp_f32 v70, v70
  v_mfma_f32_32x32x16_bf16 v[80:95], v[40:43], v[200:203], 0
  v_exp_f32 v71, v71
  v_cvt_pk_bf16_f32 v98, v68, v69
  v_exp_f32 v72, v72
  v_exp_f32 v73, v73
  v_cvt_pk_bf16_f32 v99, v70, v71
  v_mfma_f32_32x32x16_bf16 v[80:95], v[44:47], v[204:207], v[80:95]
  v_exp_f32 v74, v74
  v_exp_f32 v75, v75
  ds_read_b128 v[48:51], v3 offset:49152
  v_cvt_pk_bf16_f32 v100, v72, v73
  v_exp_f32 v76, v76
  v_exp_f32 v77, v77
  ds_read_b128 v[52:55], v3 offset:50176
  v_cvt_pk_bf16_f32 v101, v74, v75
  v_exp_f32 v78, v78
  s_add_u32 m0, s31, 72704
  s_add_u32 s29, s53, s27
  s_add_u32 s29, s29, 7168
  buffer_load_dwordx4 v2, s[8:11], s29 offen sc1 lds
  v_exp_f32 v79, v79
  v_cvt_pk_bf16_f32 v102, v76, v77
  v_cvt_pk_bf16_f32 v103, v78, v79
  s_waitcnt lgkmcnt(4)
  v_mfma_f32_32x32x16_bf16 v[112:127], v[56:59], v[96:99], v[112:127]
  v_exp_f32 v80, v80
  v_exp_f32 v81, v81
  v_exp_f32 v82, v82
  v_exp_f32 v83, v83
  v_mfma_f32_32x32x16_bf16 v[112:127], v[60:63], v[100:103], v[112:127]
  v_cvt_pk_bf16_f32 v104, v80, v81
  v_exp_f32 v84, v84
  v_exp_f32 v85, v85
  v_cvt_pk_bf16_f32 v105, v82, v83
  v_exp_f32 v86, v86
  s_waitcnt lgkmcnt(2)
  v_mfma_f32_32x32x16_bf16 v[64:79], v[32:35], v[192:195], 0
  v_exp_f32 v87, v87
  v_cvt_pk_bf16_f32 v106, v84, v85
  v_exp_f32 v88, v88
  v_exp_f32 v89, v89
  v_cvt_pk_bf16_f32 v107, v86, v87
  v_mfma_f32_32x32x16_bf16 v[64:79], v[36:39], v[196:199], v[64:79]
  v_exp_f32 v90, v90
  v_exp_f32 v91, v91
  ds_read_b128 v[40:43], v3 offset:18432
  v_cvt_pk_bf16_f32 v108, v88, v89
  v_exp_f32 v92, v92
  v_exp_f32 v93, v93
  ds_read_b128 v[44:47], v3 offset:19456
  v_cvt_pk_bf16_f32 v109, v90, v91
  v_exp_f32 v94, v94
  v_exp_f32 v95, v95
  v_cvt_pk_bf16_f32 v110, v92, v93
  v_cvt_pk_bf16_f32 v111, v94, v95
  v_mfma_f32_32x32x16_bf16 v[128:143], v[56:59], v[104:107], v[128:143]
  v_exp_f32 v64, v64
  v_exp_f32 v65, v65
  v_exp_f32 v66, v66
  v_exp_f32 v67, v67
  v_mfma_f32_32x32x16_bf16 v[128:143], v[60:63], v[108:111], v[128:143]
  v_cvt_pk_bf16_f32 v96, v64, v65
  v_exp_f32 v68, v68
  v_exp_f32 v69, v69
  v_cvt_pk_bf16_f32 v97, v66, v67
  v_exp_f32 v70, v70
  v_mfma_f32_32x32x16_bf16 v[80:95], v[32:35], v[200:203], 0
  v_exp_f32 v71, v71
  v_cvt_pk_bf16_f32 v98, v68, v69
  v_exp_f32 v72, v72
  v_exp_f32 v73, v73
  v_cvt_pk_bf16_f32 v99, v70, v71
  v_mfma_f32_32x32x16_bf16 v[80:95], v[36:39], v[204:207], v[80:95]
  v_exp_f32 v74, v74
  v_exp_f32 v75, v75
  ds_read_b128 v[56:59], v3 offset:51200
  v_cvt_pk_bf16_f32 v100, v72, v73
  v_exp_f32 v76, v76
  v_exp_f32 v77, v77
  ds_read_b128 v[60:63], v3 offset:52224
  v_cvt_pk_bf16_f32 v101, v74, v75
  v_exp_f32 v78, v78
  s_add_u32 m0, s31, 98304
  s_add_u32 s29, s53, s28
  s_add_u32 s29, s29, 0
  buffer_load_dwordx4 v2, s[8:11], s29 offen sc1 lds
  v_exp_f32 v79, v79
  v_cvt_pk_bf16_f32 v102, v76, v77
  v_cvt_pk_bf16_f32 v103, v78, v79
  s_waitcnt lgkmcnt(4)
  v_mfma_f32_32x32x16_bf16 v[112:127], v[48:51], v[96:99], v[112:127]
  v_exp_f32 v80, v80
  v_exp_f32 v81, v81
  v_exp_f32 v82, v82
  v_exp_f32 v83, v83
  v_mfma_f32_32x32x16_bf16 v[112:127], v[52:55], v[100:103], v[112:127]
  v_cvt_pk_bf16_f32 v104, v80, v81
  v_exp_f32 v84, v84
  v_exp_f32 v85, v85
  v_cvt_pk_bf16_f32 v105, v82, v83
  v_exp_f32 v86, v86
  s_waitcnt lgkmcnt(2)
  v_mfma_f32_32x32x16_bf16 v[64:79], v[40:43], v[192:195], 0
  v_exp_f32 v87, v87
  v_cvt_pk_bf16_f32 v106, v84, v85
  v_exp_f32 v88, v88
  v_exp_f32 v89, v89
  v_cvt_pk_bf16_f32 v107, v86, v87
  v_mfma_f32_32x32x16_bf16 v[64:79], v[44:47], v[196:199], v[64:79]
  v_exp_f32 v90, v90
  v_exp_f32 v91, v91
  ds_read_b128 v[32:35], v3 offset:20480
  v_cvt_pk_bf16_f32 v108, v88, v89
  v_exp_f32 v92, v92
  v_exp_f32 v93, v93
  ds_read_b128 v[36:39], v3 offset:21504
  v_cvt_pk_bf16_f32 v109, v90, v91
  v_exp_f32 v94, v94
  v_exp_f32 v95, v95
  v_cvt_pk_bf16_f32 v110, v92, v93
  v_cvt_pk_bf16_f32 v111, v94, v95
  v_mfma_f32_32x32x16_bf16 v[128:143], v[48:51], v[104:107], v[128:143]
  v_exp_f32 v64, v64
  v_exp_f32 v65, v65
  v_exp_f32 v66, v66
  v_exp_f32 v67, v67
  v_mfma_f32_32x32x16_bf16 v[128:143], v[52:55], v[108:111], v[128:143]
  v_cvt_pk_bf16_f32 v96, v64, v65
  v_exp_f32 v68, v68
  v_exp_f32 v69, v69
  v_cvt_pk_bf16_f32 v97, v66, v67
  v_exp_f32 v70, v70
  v_mfma_f32_32x32x16_bf16 v[80:95], v[40:43], v[200:203], 0
  v_exp_f32 v71, v71
  v_cvt_pk_bf16_f32 v98, v68, v69
  v_exp_f32 v72, v72
  v_exp_f32 v73, v73
  v_cvt_pk_bf16_f32 v99, v70, v71
  v_mfma_f32_32x32x16_bf16 v[80:95], v[44:47], v[204:207], v[80:95]
  v_exp_f32 v74, v74
  v_exp_f32 v75, v75
  ds_read_b128 v[48:51], v3 offset:53248
  v_cvt_pk_bf16_f32 v100, v72, v73
  v_exp_f32 v76, v76
  v_exp_f32 v77, v77
  ds_read_b128 v[52:55], v3 offset:54272
  v_cvt_pk_bf16_f32 v101, v74, v75
  v_exp_f32 v78, v78
  s_add_u32 m0, s31, 99328
  s_add_u32 s29, s53, s28
  s_add_u32 s29, s29, 1024
  buffer_load_dwordx4 v2, s[8:11], s29 offen sc1 lds
  v_exp_f32 v79, v79
  v_cvt_pk_bf16_f32 v102, v76, v77
  v_cvt_pk_bf16_f32 v103, v78, v79
  s_waitcnt lgkmcnt(4)
  v_mfma_f32_32x32x16_bf16 v[112:127], v[56:59], v[96:99], v[112:127]
  v_exp_f32 v80, v80
  v_exp_f32 v81, v81
  v_exp_f32 v82, v82
  v_exp_f32 v83, v83
  v_mfma_f32_32x32x16_bf16 v[112:127], v[60:63], v[100:103], v[112:127]
  v_cvt_pk_bf16_f32 v104, v80, v81
  v_exp_f32 v84, v84
  v_exp_f32 v85, v85
  v_cvt_pk_bf16_f32 v105, v82, v83
  v_exp_f32 v86, v86
  s_waitcnt lgkmcnt(2)
  v_mfma_f32_32x32x16_bf16 v[64:79], v[32:35], v[192:195], 0
  v_exp_f32 v87, v87
  v_cvt_pk_bf16_f32 v106, v84, v85
  v_exp_f32 v88, v88
  v_exp_f32 v89, v89
  v_cvt_pk_bf16_f32 v107, v86, v87
  v_mfma_f32_32x32x16_bf16 v[64:79], v[36:39], v[196:199], v[64:79]
  v_exp_f32 v90, v90
  v_exp_f32 v91, v91
  ds_read_b128 v[40:43], v3 offset:22528
  v_cvt_pk_bf16_f32 v108, v88, v89
  v_exp_f32 v92, v92
  v_exp_f32 v93, v93
  ds_read_b128 v[44:47], v3 offset:23552
  v_cvt_pk_bf16_f32 v109, v90, v91
  v_exp_f32 v94, v94
  v_exp_f32 v95, v95
  v_cvt_pk_bf16_f32 v110, v92, v93
  v_cvt_pk_bf16_f32 v111, v94, v95
  v_mfma_f32_32x32x16_bf16 v[128:143], v[56:59], v[104:107], v[128:143]
  v_exp_f32 v64, v64
  v_exp_f32 v65, v65
  v_exp_f32 v66, v66
  v_exp_f32 v67, v67
  v_mfma_f32_32x32x16_bf16 v[128:143], v[60:63], v[108:111], v[128:143]
  v_cvt_pk_bf16_f32 v96, v64, v65
  v_exp_f32 v68, v68
  v_exp_f32 v69, v69
  v_cvt_pk_bf16_f32 v97, v66, v67
  v_exp_f32 v70, v70
  v_mfma_f32_32x32x16_bf16 v[80:95], v[32:35], v[200:203], 0
  v_exp_f32 v71, v71
  v_cvt_pk_bf16_f32 v98, v68, v69
  v_exp_f32 v72, v72
  v_exp_f32 v73, v73
  v_cvt_pk_bf16_f32 v99, v70, v71
  v_mfma_f32_32x32x16_bf16 v[80:95], v[36:39], v[204:207], v[80:95]
  v_exp_f32 v74, v74
  v_exp_f32 v75, v75
  ds_read_b128 v[56:59], v3 offset:55296
  v_cvt_pk_bf16_f32 v100, v72, v73
  v_exp_f32 v76, v76
  v_exp_f32 v77, v77
  ds_read_b128 v[60:63], v3 offset:56320
  v_cvt_pk_bf16_f32 v101, v74, v75
  v_exp_f32 v78, v78
  s_add_u32 m0, s31, 100352
  s_add_u32 s29, s53, s28
  s_add_u32 s29, s29, 2048
  buffer_load_dwordx4 v2, s[8:11], s29 offen sc1 lds
  v_exp_f32 v79, v79
  v_cvt_pk_bf16_f32 v102, v76, v77
  v_cvt_pk_bf16_f32 v103, v78, v79
  s_waitcnt lgkmcnt(4)
  v_mfma_f32_32x32x16_bf16 v[112:127], v[48:51], v[96:99], v[112:127]
  v_exp_f32 v80, v80
  v_exp_f32 v81, v81
  v_exp_f32 v82, v82
  v_exp_f32 v83, v83
  v_mfma_f32_32x32x16_bf16 v[112:127], v[52:55], v[100:103], v[112:127]
  v_cvt_pk_bf16_f32 v104, v80, v81
  v_exp_f32 v84, v84
  v_exp_f32 v85, v85
  v_cvt_pk_bf16_f32 v105, v82, v83
  v_exp_f32 v86, v86
  s_waitcnt lgkmcnt(2)
  v_mfma_f32_32x32x16_bf16 v[64:79], v[40:43], v[192:195], 0
  v_exp_f32 v87, v87
  v_cvt_pk_bf16_f32 v106, v84, v85
  v_exp_f32 v88, v88
  v_exp_f32 v89, v89
  v_cvt_pk_bf16_f32 v107, v86, v87
  v_mfma_f32_32x32x16_bf16 v[64:79], v[44:47], v[196:199], v[64:79]
  v_exp_f32 v90, v90
  v_exp_f32 v91, v91
  ds_read_b128 v[32:35], v3 offset:24576
  v_cvt_pk_bf16_f32 v108, v88, v89
  v_exp_f32 v92, v92
  v_exp_f32 v93, v93
  ds_read_b128 v[36:39], v3 offset:25600
  v_cvt_pk_bf16_f32 v109, v90, v91
  v_exp_f32 v94, v94
  v_exp_f32 v95, v95
  v_cvt_pk_bf16_f32 v110, v92, v93
  v_cvt_pk_bf16_f32 v111, v94, v95
  v_mfma_f32_32x32x16_bf16 v[128:143], v[48:51], v[104:107], v[128:143]
  v_exp_f32 v64, v64
  v_exp_f32 v65, v65
  v_exp_f32 v66, v66
  v_exp_f32 v67, v67
  v_mfma_f32_32x32x16_bf16 v[128:143], v[52:55], v[108:111], v[128:143]
  v_cvt_pk_bf16_f32 v96, v64, v65
  v_exp_f32 v68, v68
  v_exp_f32 v69, v69
  v_cvt_pk_bf16_f32 v97, v66, v67
  v_exp_f32 v70, v70
  v_mfma_f32_32x32x16_bf16 v[80:95], v[40:43], v[200:203], 0
  v_exp_f32 v71, v71
  v_cvt_pk_bf16_f32 v98, v68, v69
  v_exp_f32 v72, v72
  v_exp_f32 v73, v73
  v_cvt_pk_bf16_f32 v99, v70, v71
  v_mfma_f32_32x32x16_bf16 v[80:95], v[44:47], v[204:207], v[80:95]
  v_exp_f32 v74, v74
  v_exp_f32 v75, v75
  ds_read_b128 v[48:51], v3 offset:57344
  v_cvt_pk_bf16_f32 v100, v72, v73
  v_exp_f32 v76, v76
  v_exp_f32 v77, v77
  ds_read_b128 v[52:55], v3 offset:58368
  v_cvt_pk_bf16_f32 v101, v74, v75
  v_exp_f32 v78, v78
  s_add_u32 m0, s31, 101376
  s_add_u32 s29, s53, s28
  s_add_u32 s29, s29, 3072
  buffer_load_dwordx4 v2, s[8:11], s29 offen sc1 lds
  v_exp_f32 v79, v79
  v_cvt_pk_bf16_f32 v102, v76, v77
  v_cvt_pk_bf16_f32 v103, v78, v79
  s_waitcnt lgkmcnt(4)
  v_mfma_f32_32x32x16_bf16 v[112:127], v[56:59], v[96:99], v[112:127]
  v_exp_f32 v80, v80
  v_exp_f32 v81, v81
  v_exp_f32 v82, v82
  v_exp_f32 v83, v83
  v_mfma_f32_32x32x16_bf16 v[112:127], v[60:63], v[100:103], v[112:127]
  v_cvt_pk_bf16_f32 v104, v80, v81
  v_exp_f32 v84, v84
  v_exp_f32 v85, v85
  v_cvt_pk_bf16_f32 v105, v82, v83
  v_exp_f32 v86, v86
  s_waitcnt lgkmcnt(2)
  v_mfma_f32_32x32x16_bf16 v[64:79], v[32:35], v[192:195], 0
  v_exp_f32 v87, v87
  v_cvt_pk_bf16_f32 v106, v84, v85
  v_exp_f32 v88, v88
  v_exp_f32 v89, v89
  v_cvt_pk_bf16_f32 v107, v86, v87
  v_mfma_f32_32x32x16_bf16 v[64:79], v[36:39], v[196:199], v[64:79]
  v_exp_f32 v90, v90
  v_exp_f32 v91, v91
  ds_read_b128 v[40:43], v3 offset:26624
  v_cvt_pk_bf16_f32 v108, v88, v89
  v_exp_f32 v92, v92
  v_exp_f32 v93, v93
  ds_read_b128 v[44:47], v3 offset:27648
  v_cvt_pk_bf16_f32 v109, v90, v91
  v_exp_f32 v94, v94
  v_exp_f32 v95, v95
  v_cvt_pk_bf16_f32 v110, v92, v93
  v_cvt_pk_bf16_f32 v111, v94, v95
  v_mfma_f32_32x32x16_bf16 v[128:143], v[56:59], v[104:107], v[128:143]
  v_exp_f32 v64, v64
  v_exp_f32 v65, v65
  v_exp_f32 v66, v66
  v_exp_f32 v67, v67
  v_mfma_f32_32x32x16_bf16 v[128:143], v[60:63], v[108:111], v[128:143]
  v_cvt_pk_bf16_f32 v96, v64, v65
  v_exp_f32 v68, v68
  v_exp_f32 v69, v69
  v_cvt_pk_bf16_f32 v97, v66, v67
  v_exp_f32 v70, v70
  v_mfma_f32_32x32x16_bf16 v[80:95], v[32:35], v[200:203], 0
  v_exp_f32 v71, v71
  v_cvt_pk_bf16_f32 v98, v68, v69
  v_exp_f32 v72, v72
  v_exp_f32 v73, v73
  v_cvt_pk_bf16_f32 v99, v70, v71
  v_mfma_f32_32x32x16_bf16 v[80:95], v[36:39], v[204:207], v[80:95]
  v_exp_f32 v74, v74
  v_exp_f32 v75, v75
  ds_read_b128 v[56:59], v3 offset:59392
  v_cvt_pk_bf16_f32 v100, v72, v73
  v_exp_f32 v76, v76
  v_exp_f32 v77, v77
  ds_read_b128 v[60:63], v3 offset:60416
  v_cvt_pk_bf16_f32 v101, v74, v75
  v_exp_f32 v78, v78
  s_add_u32 m0, s31, 102400
  s_add_u32 s29, s53, s28
  s_add_u32 s29, s29, 4096
  buffer_load_dwordx4 v2, s[8:11], s29 offen sc1 lds
  v_exp_f32 v79, v79
  v_cvt_pk_bf16_f32 v102, v76, v77
  v_cvt_pk_bf16_f32 v103, v78, v79
  s_waitcnt lgkmcnt(4)
  v_mfma_f32_32x32x16_bf16 v[112:127], v[48:51], v[96:99], v[112:127]
  v_exp_f32 v80, v80
  v_exp_f32 v81, v81
  v_exp_f32 v82, v82
  v_exp_f32 v83, v83
  v_mfma_f32_32x32x16_bf16 v[112:127], v[52:55], v[100:103], v[112:127]
  v_cvt_pk_bf16_f32 v104, v80, v81
  v_exp_f32 v84, v84
  v_exp_f32 v85, v85
  v_cvt_pk_bf16_f32 v105, v82, v83
  v_exp_f32 v86, v86
  s_waitcnt lgkmcnt(2)
  v_mfma_f32_32x32x16_bf16 v[64:79], v[40:43], v[192:195], 0
  v_exp_f32 v87, v87
  v_cvt_pk_bf16_f32 v106, v84, v85
  v_exp_f32 v88, v88
  v_exp_f32 v89, v89
  v_cvt_pk_bf16_f32 v107, v86, v87
  v_mfma_f32_32x32x16_bf16 v[64:79], v[44:47], v[196:199], v[64:79]
  v_exp_f32 v90, v90
  v_exp_f32 v91, v91
  ds_read_b128 v[32:35], v3 offset:28672
  v_cvt_pk_bf16_f32 v108, v88, v89
  v_exp_f32 v92, v92
  v_exp_f32 v93, v93
  ds_read_b128 v[36:39], v3 offset:29696
  v_cvt_pk_bf16_f32 v109, v90, v91
  v_exp_f32 v94, v94
  v_exp_f32 v95, v95
  v_cvt_pk_bf16_f32 v110, v92, v93
  v_cvt_pk_bf16_f32 v111, v94, v95
  v_mfma_f32_32x32x16_bf16 v[128:143], v[48:51], v[104:107], v[128:143]
  v_exp_f32 v64, v64
  v_exp_f32 v65, v65
  v_exp_f32 v66, v66
  v_exp_f32 v67, v67
  v_mfma_f32_32x32x16_bf16 v[128:143], v[52:55], v[108:111], v[128:143]
  v_cvt_pk_bf16_f32 v96, v64, v65
  v_exp_f32 v68, v68
  v_exp_f32 v69, v69
  v_cvt_pk_bf16_f32 v97, v66, v67
  v_exp_f32 v70, v70
  v_mfma_f32_32x32x16_bf16 v[80:95], v[40:43], v[200:203], 0
  v_exp_f32 v71, v71
  v_cvt_pk_bf16_f32 v98, v68, v69
  v_exp_f32 v72, v72
  v_exp_f32 v73, v73
  v_cvt_pk_bf16_f32 v99, v70, v71
  v_mfma_f32_32x32x16_bf16 v[80:95], v[44:47], v[204:207], v[80:95]
  v_exp_f32 v74, v74
  v_exp_f32 v75, v75
  ds_read_b128 v[48:51], v3 offset:61440
  v_cvt_pk_bf16_f32 v100, v72, v73
  v_exp_f32 v76, v76
  v_exp_f32 v77, v77
  ds_read_b128 v[52:55], v3 offset:62464
  v_cvt_pk_bf16_f32 v101, v74, v75
  v_exp_f32 v78, v78
  s_add_u32 m0, s31, 103424
  s_add_u32 s29, s53, s28
  s_add_u32 s29, s29, 5120
  buffer_load_dwordx4 v2, s[8:11], s29 offen sc1 lds
  v_exp_f32 v79, v79
  v_cvt_pk_bf16_f32 v102, v76, v77
  v_cvt_pk_bf16_f32 v103, v78, v79
  s_waitcnt lgkmcnt(4)
  v_mfma_f32_32x32x16_bf16 v[112:127], v[56:59], v[96:99], v[112:127]
  v_exp_f32 v80, v80
  v_exp_f32 v81, v81
  v_exp_f32 v82, v82
  v_exp_f32 v83, v83
  v_mfma_f32_32x32x16_bf16 v[112:127], v[60:63], v[100:103], v[112:127]
  v_cvt_pk_bf16_f32 v104, v80, v81
  v_exp_f32 v84, v84
  v_exp_f32 v85, v85
  v_cvt_pk_bf16_f32 v105, v82, v83
  v_exp_f32 v86, v86
  s_waitcnt lgkmcnt(2)
  v_mfma_f32_32x32x16_bf16 v[64:79], v[32:35], v[192:195], 0
  v_exp_f32 v87, v87
  v_cvt_pk_bf16_f32 v106, v84, v85
  v_exp_f32 v88, v88
  v_exp_f32 v89, v89
  v_cvt_pk_bf16_f32 v107, v86, v87
  v_mfma_f32_32x32x16_bf16 v[64:79], v[36:39], v[196:199], v[64:79]
  v_exp_f32 v90, v90
  v_exp_f32 v91, v91
  ds_read_b128 v[40:43], v3 offset:30720
  v_cvt_pk_bf16_f32 v108, v88, v89
  v_exp_f32 v92, v92
  v_exp_f32 v93, v93
  ds_read_b128 v[44:47], v3 offset:31744
  v_cvt_pk_bf16_f32 v109, v90, v91
  v_exp_f32 v94, v94
  v_exp_f32 v95, v95
  v_cvt_pk_bf16_f32 v110, v92, v93
  v_cvt_pk_bf16_f32 v111, v94, v95
  v_mfma_f32_32x32x16_bf16 v[128:143], v[56:59], v[104:107], v[128:143]
  v_exp_f32 v64, v64
  v_exp_f32 v65, v65
  v_exp_f32 v66, v66
  v_exp_f32 v67, v67
  v_mfma_f32_32x32x16_bf16 v[128:143], v[60:63], v[108:111], v[128:143]
  v_cvt_pk_bf16_f32 v96, v64, v65
  v_exp_f32 v68, v68
  v_exp_f32 v69, v69
  v_cvt_pk_bf16_f32 v97, v66, v67
  v_exp_f32 v70, v70
  v_mfma_f32_32x32x16_bf16 v[80:95], v[32:35], v[200:203], 0
  v_exp_f32 v71, v71
  v_cvt_pk_bf16_f32 v98, v68, v69
  v_exp_f32 v72, v72
  v_exp_f32 v73, v73
  v_cvt_pk_bf16_f32 v99, v70, v71
  v_mfma_f32_32x32x16_bf16 v[80:95], v[36:39], v[204:207], v[80:95]
  v_exp_f32 v74, v74
  v_exp_f32 v75, v75
  ds_read_b128 v[56:59], v3 offset:63488
  v_cvt_pk_bf16_f32 v100, v72, v73
  v_exp_f32 v76, v76
  v_exp_f32 v77, v77
  ds_read_b128 v[60:63], v3 offset:64512
  v_cvt_pk_bf16_f32 v101, v74, v75
  v_exp_f32 v78, v78
  s_add_u32 m0, s31, 104448
  s_add_u32 s29, s53, s28
  s_add_u32 s29, s29, 6144
  buffer_load_dwordx4 v2, s[8:11], s29 offen sc1 lds
  v_exp_f32 v79, v79
  v_cvt_pk_bf16_f32 v102, v76, v77
  v_cvt_pk_bf16_f32 v103, v78, v79
  s_waitcnt lgkmcnt(4)
  v_mfma_f32_32x32x16_bf16 v[112:127], v[48:51], v[96:99], v[112:127]
  v_exp_f32 v80, v80
  v_exp_f32 v81, v81
  v_exp_f32 v82, v82
  v_exp_f32 v83, v83
  v_mfma_f32_32x32x16_bf16 v[112:127], v[52:55], v[100:103], v[112:127]
  v_cvt_pk_bf16_f32 v104, v80, v81
  v_exp_f32 v84, v84
  v_exp_f32 v85, v85
  v_cvt_pk_bf16_f32 v105, v82, v83
  v_exp_f32 v86, v86
  s_waitcnt lgkmcnt(2)
  v_mfma_f32_32x32x16_bf16 v[64:79], v[40:43], v[192:195], 0
  v_exp_f32 v87, v87
  v_cvt_pk_bf16_f32 v106, v84, v85
  v_exp_f32 v88, v88
  v_exp_f32 v89, v89
  v_cvt_pk_bf16_f32 v107, v86, v87
  v_mfma_f32_32x32x16_bf16 v[64:79], v[44:47], v[196:199], v[64:79]
  v_exp_f32 v90, v90
  v_exp_f32 v91, v91
  v_cvt_pk_bf16_f32 v108, v88, v89
  v_exp_f32 v92, v92
  v_exp_f32 v93, v93
  v_cvt_pk_bf16_f32 v109, v90, v91
  v_exp_f32 v94, v94
  v_exp_f32 v95, v95
  v_cvt_pk_bf16_f32 v110, v92, v93
  v_cvt_pk_bf16_f32 v111, v94, v95
  v_mfma_f32_32x32x16_bf16 v[128:143], v[48:51], v[104:107], v[128:143]
  v_exp_f32 v64, v64
  v_exp_f32 v65, v65
  v_exp_f32 v66, v66
  v_exp_f32 v67, v67
  v_mfma_f32_32x32x16_bf16 v[128:143], v[52:55], v[108:111], v[128:143]
  v_cvt_pk_bf16_f32 v96, v64, v65
  v_exp_f32 v68, v68
  v_exp_f32 v69, v69
  v_cvt_pk_bf16_f32 v97, v66, v67
  v_exp_f32 v70, v70
  v_mfma_f32_32x32x16_bf16 v[80:95], v[40:43], v[200:203], 0
  v_exp_f32 v71, v71
  v_cvt_pk_bf16_f32 v98, v68, v69
  v_exp_f32 v72, v72
  v_exp_f32 v73, v73
  v_cvt_pk_bf16_f32 v99, v70, v71
  v_mfma_f32_32x32x16_bf16 v[80:95], v[44:47], v[204:207], v[80:95]
  v_exp_f32 v74, v74
  v_exp_f32 v75, v75
  v_cvt_pk_bf16_f32 v100, v72, v73
  v_exp_f32 v76, v76
  v_exp_f32 v77, v77
  v_cvt_pk_bf16_f32 v101, v74, v75
  v_exp_f32 v78, v78
  s_add_u32 m0, s31, 105472
  s_add_u32 s29, s53, s28
  s_add_u32 s29, s29, 7168
  buffer_load_dwordx4 v2, s[8:11], s29 offen sc1 lds
  v_exp_f32 v79, v79
  v_cvt_pk_bf16_f32 v102, v76, v77
  v_cvt_pk_bf16_f32 v103, v78, v79
  s_waitcnt lgkmcnt(0)
  v_mfma_f32_32x32x16_bf16 v[112:127], v[56:59], v[96:99], v[112:127]
  v_exp_f32 v80, v80
  v_exp_f32 v81, v81
  v_exp_f32 v82, v82
  v_exp_f32 v83, v83
  v_mfma_f32_32x32x16_bf16 v[112:127], v[60:63], v[100:103], v[112:127]
  v_cvt_pk_bf16_f32 v104, v80, v81
  v_exp_f32 v84, v84
  v_exp_f32 v85, v85
  v_cvt_pk_bf16_f32 v105, v82, v83
  v_exp_f32 v86, v86
  v_exp_f32 v87, v87
  v_cvt_pk_bf16_f32 v106, v84, v85
  v_exp_f32 v88, v88
  v_exp_f32 v89, v89
  v_cvt_pk_bf16_f32 v107, v86, v87
  v_exp_f32 v90, v90
  v_exp_f32 v91, v91
  v_cvt_pk_bf16_f32 v108, v88, v89
  v_exp_f32 v92, v92
  v_exp_f32 v93, v93
  v_cvt_pk_bf16_f32 v109, v90, v91
  v_exp_f32 v94, v94
  v_exp_f32 v95, v95
  v_cvt_pk_bf16_f32 v110, v92, v93
  v_cvt_pk_bf16_f32 v111, v94, v95
  s_nop 1
  v_mfma_f32_32x32x16_bf16 v[128:143], v[56:59], v[104:107], v[128:143]
  v_mfma_f32_32x32x16_bf16 v[128:143], v[60:63], v[108:111], v[128:143]
  s_waitcnt vmcnt(0)
  s_barrier
  s_add_u32 s41, s41, 1
  s_min_u32 s29, s41, 3
  s_mul_i32 s53, s29, 32768
  s_lshl_b32 s31, s21, 13
  s_add_u32 s53, s53, s31
  ds_read_b128 v[32:35], v4 offset:0
  ds_read_b128 v[36:39], v4 offset:1024
  ds_read_b128 v[48:51], v4 offset:32768
  ds_read_b128 v[52:55], v4 offset:33792
  ds_read_b128 v[40:43], v4 offset:2048
  ds_read_b128 v[44:47], v4 offset:3072
  s_waitcnt lgkmcnt(4)
  v_mfma_f32_32x32x16_bf16 v[64:79], v[32:35], v[192:195], 0
  v_mfma_f32_32x32x16_bf16 v[64:79], v[36:39], v[196:199], v[64:79]
  s_nop 11
  v_exp_f32 v64, v64
  v_exp_f32 v65, v65
  v_exp_f32 v66, v66
  v_exp_f32 v67, v67
  v_cvt_pk_bf16_f32 v96, v64, v65
  v_exp_f32 v68, v68
  v_exp_f32 v69, v69
  v_cvt_pk_bf16_f32 v97, v66, v67
  v_exp_f32 v70, v70
  v_mfma_f32_32x32x16_bf16 v[80:95], v[32:35], v[200:203], 0
  v_exp_f32 v71, v71
  v_cvt_pk_bf16_f32 v98, v68, v69
  v_exp_f32 v72, v72
  v_exp_f32 v73, v73
  v_cvt_pk_bf16_f32 v99, v70, v71
  v_mfma_f32_32x32x16_bf16 v[80:95], v[36:39], v[204:207], v[80:95]
  v_exp_f32 v74, v74
  v_exp_f32 v75, v75
  ds_read_b128 v[56:59], v4 offset:34816
  v_cvt_pk_bf16_f32 v100, v72, v73
  v_exp_f32 v76, v76
  v_exp_f32 v77, v77
  ds_read_b128 v[60:63], v4 offset:35840
  v_cvt_pk_bf16_f32 v101, v74, v75
  v_exp_f32 v78, v78
  s_add_u32 m0, s31, 0
  s_add_u32 s29, s53, s27
  s_add_u32 s29, s29, 0
  buffer_load_dwordx4 v2, s[8:11], s29 offen sc1 lds
  v_exp_f32 v79, v79
  v_cvt_pk_bf16_f32 v102, v76, v77
  v_cvt_pk_bf16_f32 v103, v78, v79
  s_waitcnt lgkmcnt(4)
  v_mfma_f32_32x32x16_bf16 v[112:127], v[48:51], v[96:99], v[112:127]
  v_exp_f32 v80, v80
  v_exp_f32 v81, v81
  v_exp_f32 v82, v82
  v_exp_f32 v83, v83
  v_mfma_f32_32x32x16_bf16 v[112:127], v[52:55], v[100:103], v[112:127]
  v_cvt_pk_bf16_f32 v104, v80, v81
  v_exp_f32 v84, v84
  v_exp_f32 v85, v85
  v_cvt_pk_bf16_f32 v105, v82, v83
  v_exp_f32 v86, v86
  s_waitcnt lgkmcnt(2)
  v_mfma_f32_32x32x16_bf16 v[64:79], v[40:43], v[192:195], 0
  v_exp_f32 v87, v87
  v_cvt_pk_bf16_f32 v106, v84, v85
  v_exp_f32 v88, v88
  v_exp_f32 v89, v89
  v_cvt_pk_bf16_f32 v107, v86, v87
  v_mfma_f32_32x32x16_bf16 v[64:79], v[44:47], v[196:199], v[64:79]
  v_exp_f32 v90, v90
  v_exp_f32 v91, v91
  ds_read_b128 v[32:35], v4 offset:4096
  v_cvt_pk_bf16_f32 v108, v88, v89
  v_exp_f32 v92, v92
  v_exp_f32 v93, v93
  ds_read_b128 v[36:39], v4 offset:5120
  v_cvt_pk_bf16_f32 v109, v90, v91
  v_exp_f32 v94, v94
  v_exp_f32 v95, v95
  v_cvt_pk_bf16_f32 v110, v92, v93
  v_cvt_pk_bf16_f32 v111, v94, v95
  v_mfma_f32_32x32x16_bf16 v[128:143], v[48:51], v[104:107], v[128:143]
  v_exp_f32 v64, v64
  v_exp_f32 v65, v65
  v_exp_f32 v66, v66
  v_exp_f32 v67, v67
  v_mfma_f32_32x32x16_bf16 v[128:143], v[52:55], v[108:111], v[128:143]
  v_cvt_pk_bf16_f32 v96, v64, v65
  v_exp_f32 v68, v68
  v_exp_f32 v69, v69
  v_cvt_pk_bf16_f32 v97, v66, v67
  v_exp_f32 v70, v70
  v_mfma_f32_32x32x16_bf16 v[80:95], v[40:43], v[200:203], 0
  v_exp_f32 v71, v71
  v_cvt_pk_bf16_f32 v98, v68, v69
  v_exp_f32 v72, v72
  v_exp_f32 v73, v73
  v_cvt_pk_bf16_f32 v99, v70, v71
  v_mfma_f32_32x32x16_bf16 v[80:95], v[44:47], v[204:207], v[80:95]
  v_exp_f32 v74, v74
  v_exp_f32 v75, v75
  ds_read_b128 v[48:51], v4 offset:36864
  v_cvt_pk_bf16_f32 v100, v72, v73
  v_exp_f32 v76, v76
  v_exp_f32 v77, v77
  ds_read_b128 v[52:55], v4 offset:37888
  v_cvt_pk_bf16_f32 v101, v74, v75
  v_exp_f32 v78, v78
  s_add_u32 m0, s31, 1024
  s_add_u32 s29, s53, s27
  s_add_u32 s29, s29, 1024
  buffer_load_dwordx4 v2, s[8:11], s29 offen sc1 lds
  v_exp_f32 v79, v79
  v_cvt_pk_bf16_f32 v102, v76, v77
  v_cvt_pk_bf16_f32 v103, v78, v79
  s_waitcnt lgkmcnt(4)
  v_mfma_f32_32x32x16_bf16 v[112:127], v[56:59], v[96:99], v[112:127]
  v_exp_f32 v80, v80
  v_exp_f32 v81, v81
  v_exp_f32 v82, v82
  v_exp_f32 v83, v83
  v_mfma_f32_32x32x16_bf16 v[112:127], v[60:63], v[100:103], v[112:127]
  v_cvt_pk_bf16_f32 v104, v80, v81
  v_exp_f32 v84, v84
  v_exp_f32 v85, v85
  v_cvt_pk_bf16_f32 v105, v82, v83
  v_exp_f32 v86, v86
  s_waitcnt lgkmcnt(2)
  v_mfma_f32_32x32x16_bf16 v[64:79], v[32:35], v[192:195], 0
  v_exp_f32 v87, v87
  v_cvt_pk_bf16_f32 v106, v84, v85
  v_exp_f32 v88, v88
  v_exp_f32 v89, v89
  v_cvt_pk_bf16_f32 v107, v86, v87
  v_mfma_f32_32x32x16_bf16 v[64:79], v[36:39], v[196:199], v[64:79]
  v_exp_f32 v90, v90
  v_exp_f32 v91, v91
  ds_read_b128 v[40:43], v4 offset:6144
  v_cvt_pk_bf16_f32 v108, v88, v89
  v_exp_f32 v92, v92
  v_exp_f32 v93, v93
  ds_read_b128 v[44:47], v4 offset:7168
  v_cvt_pk_bf16_f32 v109, v90, v91
  v_exp_f32 v94, v94
  v_exp_f32 v95, v95
  v_cvt_pk_bf16_f32 v110, v92, v93
  v_cvt_pk_bf16_f32 v111, v94, v95
  v_mfma_f32_32x32x16_bf16 v[128:143], v[56:59], v[104:107], v[128:143]
  v_exp_f32 v64, v64
  v_exp_f32 v65, v65
  v_exp_f32 v66, v66
  v_exp_f32 v67, v67
  v_mfma_f32_32x32x16_bf16 v[128:143], v[60:63], v[108:111], v[128:143]
  v_cvt_pk_bf16_f32 v96, v64, v65
  v_exp_f32 v68, v68
  v_exp_f32 v69, v69
  v_cvt_pk_bf16_f32 v97, v66, v67
  v_exp_f32 v70, v70
  v_mfma_f32_32x32x16_bf16 v[80:95], v[32:35], v[200:203], 0
  v_exp_f32 v71, v71
  v_cvt_pk_bf16_f32 v98, v68, v69
  v_exp_f32 v72, v72
  v_exp_f32 v73, v73
  v_cvt_pk_bf16_f32 v99, v70, v71
  v_mfma_f32_32x32x16_bf16 v[80:95], v[36:39], v[204:207], v[80:95]
  v_exp_f32 v74, v74
  v_exp_f32 v75, v75
  ds_read_b128 v[56:59], v4 offset:38912
  v_cvt_pk_bf16_f32 v100, v72, v73
  v_exp_f32 v76, v76
  v_exp_f32 v77, v77
  ds_read_b128 v[60:63], v4 offset:39936
  v_cvt_pk_bf16_f32 v101, v74, v75
  v_exp_f32 v78, v78
  s_add_u32 m0, s31, 2048
  s_add_u32 s29, s53, s27
  s_add_u32 s29, s29, 2048
  buffer_load_dwordx4 v2, s[8:11], s29 offen sc1 lds
  v_exp_f32 v79, v79
  v_cvt_pk_bf16_f32 v102, v76, v77
  v_cvt_pk_bf16_f32 v103, v78, v79
  s_waitcnt lgkmcnt(4)
  v_mfma_f32_32x32x16_bf16 v[112:127], v[48:51], v[96:99], v[112:127]
  v_exp_f32 v80, v80
  v_exp_f32 v81, v81
  v_exp_f32 v82, v82
  v_exp_f32 v83, v83
  v_mfma_f32_32x32x16_bf16 v[112:127], v[52:55], v[100:103], v[112:127]
  v_cvt_pk_bf16_f32 v104, v80, v81
  v_exp_f32 v84, v84
  v_exp_f32 v85, v85
  v_cvt_pk_bf16_f32 v105, v82, v83
  v_exp_f32 v86, v86
  s_waitcnt lgkmcnt(2)
  v_mfma_f32_32x32x16_bf16 v[64:79], v[40:43], v[192:195], 0
  v_exp_f32 v87, v87
  v_cvt_pk_bf16_f32 v106, v84, v85
  v_exp_f32 v88, v88
  v_exp_f32 v89, v89
  v_cvt_pk_bf16_f32 v107, v86, v87
  v_mfma_f32_32x32x16_bf16 v[64:79], v[44:47], v[196:199], v[64:79]
  v_exp_f32 v90, v90
  v_exp_f32 v91, v91
  ds_read_b128 v[32:35], v4 offset:8192
  v_cvt_pk_bf16_f32 v108, v88, v89
  v_exp_f32 v92, v92
  v_exp_f32 v93, v93
  ds_read_b128 v[36:39], v4 offset:9216
  v_cvt_pk_bf16_f32 v109, v90, v91
  v_exp_f32 v94, v94
  v_exp_f32 v95, v95
  v_cvt_pk_bf16_f32 v110, v92, v93
  v_cvt_pk_bf16_f32 v111, v94, v95
  v_mfma_f32_32x32x16_bf16 v[128:143], v[48:51], v[104:107], v[128:143]
  v_exp_f32 v64, v64
  v_exp_f32 v65, v65
  v_exp_f32 v66, v66
  v_exp_f32 v67, v67
  v_mfma_f32_32x32x16_bf16 v[128:143], v[52:55], v[108:111], v[128:143]
  v_cvt_pk_bf16_f32 v96, v64, v65
  v_exp_f32 v68, v68
  v_exp_f32 v69, v69
  v_cvt_pk_bf16_f32 v97, v66, v67
  v_exp_f32 v70, v70
  v_mfma_f32_32x32x16_bf16 v[80:95], v[40:43], v[200:203], 0
  v_exp_f32 v71, v71
  v_cvt_pk_bf16_f32 v98, v68, v69
  v_exp_f32 v72, v72
  v_exp_f32 v73, v73
  v_cvt_pk_bf16_f32 v99, v70, v71
  v_mfma_f32_32x32x16_bf16 v[80:95], v[44:47], v[204:207], v[80:95]
  v_exp_f32 v74, v74
  v_exp_f32 v75, v75
  ds_read_b128 v[48:51], v4 offset:40960
  v_cvt_pk_bf16_f32 v100, v72, v73
  v_exp_f32 v76, v76
  v_exp_f32 v77, v77
  ds_read_b128 v[52:55], v4 offset:41984
  v_cvt_pk_bf16_f32 v101, v74, v75
  v_exp_f32 v78, v78
  s_add_u32 m0, s31, 3072
  s_add_u32 s29, s53, s27
  s_add_u32 s29, s29, 3072
  buffer_load_dwordx4 v2, s[8:11], s29 offen sc1 lds
  v_exp_f32 v79, v79
  v_cvt_pk_bf16_f32 v102, v76, v77
  v_cvt_pk_bf16_f32 v103, v78, v79
  s_waitcnt lgkmcnt(4)
  v_mfma_f32_32x32x16_bf16 v[112:127], v[56:59], v[96:99], v[112:127]
  v_exp_f32 v80, v80
  v_exp_f32 v81, v81
  v_exp_f32 v82, v82
  v_exp_f32 v83, v83
  v_mfma_f32_32x32x16_bf16 v[112:127], v[60:63], v[100:103], v[112:127]
  v_cvt_pk_bf16_f32 v104, v80, v81
  v_exp_f32 v84, v84
  v_exp_f32 v85, v85
  v_cvt_pk_bf16_f32 v105, v82, v83
  v_exp_f32 v86, v86
  s_waitcnt lgkmcnt(2)
  v_mfma_f32_32x32x16_bf16 v[64:79], v[32:35], v[192:195], 0
  v_exp_f32 v87, v87
  v_cvt_pk_bf16_f32 v106, v84, v85
  v_exp_f32 v88, v88
  v_exp_f32 v89, v89
  v_cvt_pk_bf16_f32 v107, v86, v87
  v_mfma_f32_32x32x16_bf16 v[64:79], v[36:39], v[196:199], v[64:79]
  v_exp_f32 v90, v90
  v_exp_f32 v91, v91
  ds_read_b128 v[40:43], v4 offset:10240
  v_cvt_pk_bf16_f32 v108, v88, v89
  v_exp_f32 v92, v92
  v_exp_f32 v93, v93
  ds_read_b128 v[44:47], v4 offset:11264
  v_cvt_pk_bf16_f32 v109, v90, v91
  v_exp_f32 v94, v94
  v_exp_f32 v95, v95
  v_cvt_pk_bf16_f32 v110, v92, v93
  v_cvt_pk_bf16_f32 v111, v94, v95
  v_mfma_f32_32x32x16_bf16 v[128:143], v[56:59], v[104:107], v[128:143]
  v_exp_f32 v64, v64
  v_exp_f32 v65, v65
  v_exp_f32 v66, v66
  v_exp_f32 v67, v67
  v_mfma_f32_32x32x16_bf16 v[128:143], v[60:63], v[108:111], v[128:143]
  v_cvt_pk_bf16_f32 v96, v64, v65
  v_exp_f32 v68, v68
  v_exp_f32 v69, v69
  v_cvt_pk_bf16_f32 v97, v66, v67
  v_exp_f32 v70, v70
  v_mfma_f32_32x32x16_bf16 v[80:95], v[32:35], v[200:203], 0
  v_exp_f32 v71, v71
  v_cvt_pk_bf16_f32 v98, v68, v69
  v_exp_f32 v72, v72
  v_exp_f32 v73, v73
  v_cvt_pk_bf16_f32 v99, v70, v71
  v_mfma_f32_32x32x16_bf16 v[80:95], v[36:39], v[204:207], v[80:95]
  v_exp_f32 v74, v74
  v_exp_f32 v75, v75
  ds_read_b128 v[56:59], v4 offset:43008
  v_cvt_pk_bf16_f32 v100, v72, v73
  v_exp_f32 v76, v76
  v_exp_f32 v77, v77
  ds_read_b128 v[60:63], v4 offset:44032
  v_cvt_pk_bf16_f32 v101, v74, v75
  v_exp_f32 v78, v78
  s_add_u32 m0, s31, 4096
  s_add_u32 s29, s53, s27
  s_add_u32 s29, s29, 4096
  buffer_load_dwordx4 v2, s[8:11], s29 offen sc1 lds
  v_exp_f32 v79, v79
  v_cvt_pk_bf16_f32 v102, v76, v77
  v_cvt_pk_bf16_f32 v103, v78, v79
  s_waitcnt lgkmcnt(4)
  v_mfma_f32_32x32x16_bf16 v[112:127], v[48:51], v[96:99], v[112:127]
  v_exp_f32 v80, v80
  v_exp_f32 v81, v81
  v_exp_f32 v82, v82
  v_exp_f32 v83, v83
  v_mfma_f32_32x32x16_bf16 v[112:127], v[52:55], v[100:103], v[112:127]
  v_cvt_pk_bf16_f32 v104, v80, v81
  v_exp_f32 v84, v84
  v_exp_f32 v85, v85
  v_cvt_pk_bf16_f32 v105, v82, v83
  v_exp_f32 v86, v86
  s_waitcnt lgkmcnt(2)
  v_mfma_f32_32x32x16_bf16 v[64:79], v[40:43], v[192:195], 0
  v_exp_f32 v87, v87
  v_cvt_pk_bf16_f32 v106, v84, v85
  v_exp_f32 v88, v88
  v_exp_f32 v89, v89
  v_cvt_pk_bf16_f32 v107, v86, v87
  v_mfma_f32_32x32x16_bf16 v[64:79], v[44:47], v[196:199], v[64:79]
  v_exp_f32 v90, v90
  v_exp_f32 v91, v91
  ds_read_b128 v[32:35], v4 offset:12288
  v_cvt_pk_bf16_f32 v108, v88, v89
  v_exp_f32 v92, v92
  v_exp_f32 v93, v93
  ds_read_b128 v[36:39], v4 offset:13312
  v_cvt_pk_bf16_f32 v109, v90, v91
  v_exp_f32 v94, v94
  v_exp_f32 v95, v95
  v_cvt_pk_bf16_f32 v110, v92, v93
  v_cvt_pk_bf16_f32 v111, v94, v95
  v_mfma_f32_32x32x16_bf16 v[128:143], v[48:51], v[104:107], v[128:143]
  v_exp_f32 v64, v64
  v_exp_f32 v65, v65
  v_exp_f32 v66, v66
  v_exp_f32 v67, v67
  v_mfma_f32_32x32x16_bf16 v[128:143], v[52:55], v[108:111], v[128:143]
  v_cvt_pk_bf16_f32 v96, v64, v65
  v_exp_f32 v68, v68
  v_exp_f32 v69, v69
  v_cvt_pk_bf16_f32 v97, v66, v67
  v_exp_f32 v70, v70
  v_mfma_f32_32x32x16_bf16 v[80:95], v[40:43], v[200:203], 0
  v_exp_f32 v71, v71
  v_cvt_pk_bf16_f32 v98, v68, v69
  v_exp_f32 v72, v72
  v_exp_f32 v73, v73
  v_cvt_pk_bf16_f32 v99, v70, v71
  v_mfma_f32_32x32x16_bf16 v[80:95], v[44:47], v[204:207], v[80:95]
  v_exp_f32 v74, v74
  v_exp_f32 v75, v75
  ds_read_b128 v[48:51], v4 offset:45056
  v_cvt_pk_bf16_f32 v100, v72, v73
  v_exp_f32 v76, v76
  v_exp_f32 v77, v77
  ds_read_b128 v[52:55], v4 offset:46080
  v_cvt_pk_bf16_f32 v101, v74, v75
  v_exp_f32 v78, v78
  s_add_u32 m0, s31, 5120
  s_add_u32 s29, s53, s27
  s_add_u32 s29, s29, 5120
  buffer_load_dwordx4 v2, s[8:11], s29 offen sc1 lds
  v_exp_f32 v79, v79
  v_cvt_pk_bf16_f32 v102, v76, v77
  v_cvt_pk_bf16_f32 v103, v78, v79
  s_waitcnt lgkmcnt(4)
  v_mfma_f32_32x32x16_bf16 v[112:127], v[56:59], v[96:99], v[112:127]
  v_exp_f32 v80, v80
  v_exp_f32 v81, v81
  v_exp_f32 v82, v82
  v_exp_f32 v83, v83
  v_mfma_f32_32x32x16_bf16 v[112:127], v[60:63], v[100:103], v[112:127]
  v_cvt_pk_bf16_f32 v104, v80, v81
  v_exp_f32 v84, v84
  v_exp_f32 v85, v85
  v_cvt_pk_bf16_f32 v105, v82, v83
  v_exp_f32 v86, v86
  s_waitcnt lgkmcnt(2)
  v_mfma_f32_32x32x16_bf16 v[64:79], v[32:35], v[192:195], 0
  v_exp_f32 v87, v87
  v_cvt_pk_bf16_f32 v106, v84, v85
  v_exp_f32 v88, v88
  v_exp_f32 v89, v89
  v_cvt_pk_bf16_f32 v107, v86, v87
  v_mfma_f32_32x32x16_bf16 v[64:79], v[36:39], v[196:199], v[64:79]
  v_exp_f32 v90, v90
  v_exp_f32 v91, v91
  ds_read_b128 v[40:43], v4 offset:14336
  v_cvt_pk_bf16_f32 v108, v88, v89
  v_exp_f32 v92, v92
  v_exp_f32 v93, v93
  ds_read_b128 v[44:47], v4 offset:15360
  v_cvt_pk_bf16_f32 v109, v90, v91
  v_exp_f32 v94, v94
  v_exp_f32 v95, v95
  v_cvt_pk_bf16_f32 v110, v92, v93
  v_cvt_pk_bf16_f32 v111, v94, v95
  v_mfma_f32_32x32x16_bf16 v[128:143], v[56:59], v[104:107], v[128:143]
  v_exp_f32 v64, v64
  v_exp_f32 v65, v65
  v_exp_f32 v66, v66
  v_exp_f32 v67, v67
  v_mfma_f32_32x32x16_bf16 v[128:143], v[60:63], v[108:111], v[128:143]
  v_cvt_pk_bf16_f32 v96, v64, v65
  v_exp_f32 v68, v68
  v_exp_f32 v69, v69
  v_cvt_pk_bf16_f32 v97, v66, v67
  v_exp_f32 v70, v70
  v_mfma_f32_32x32x16_bf16 v[80:95], v[32:35], v[200:203], 0
  v_exp_f32 v71, v71
  v_cvt_pk_bf16_f32 v98, v68, v69
  v_exp_f32 v72, v72
  v_exp_f32 v73, v73
  v_cvt_pk_bf16_f32 v99, v70, v71
  v_mfma_f32_32x32x16_bf16 v[80:95], v[36:39], v[204:207], v[80:95]
  v_exp_f32 v74, v74
  v_exp_f32 v75, v75
  ds_read_b128 v[56:59], v4 offset:47104
  v_cvt_pk_bf16_f32 v100, v72, v73
  v_exp_f32 v76, v76
  v_exp_f32 v77, v77
  ds_read_b128 v[60:63], v4 offset:48128
  v_cvt_pk_bf16_f32 v101, v74, v75
  v_exp_f32 v78, v78
  s_add_u32 m0, s31, 6144
  s_add_u32 s29, s53, s27
  s_add_u32 s29, s29, 6144
  buffer_load_dwordx4 v2, s[8:11], s29 offen sc1 lds
  v_exp_f32 v79, v79
  v_cvt_pk_bf16_f32 v102, v76, v77
  v_cvt_pk_bf16_f32 v103, v78, v79
  s_waitcnt lgkmcnt(4)
  v_mfma_f32_32x32x16_bf16 v[112:127], v[48:51], v[96:99], v[112:127]
  v_exp_f32 v80, v80
  v_exp_f32 v81, v81
  v_exp_f32 v82, v82
  v_exp_f32 v83, v83
  v_mfma_f32_32x32x16_bf16 v[112:127], v[52:55], v[100:103], v[112:127]
  v_cvt_pk_bf16_f32 v104, v80, v81
  v_exp_f32 v84, v84
  v_exp_f32 v85, v85
  v_cvt_pk_bf16_f32 v105, v82, v83
  v_exp_f32 v86, v86
  s_waitcnt lgkmcnt(2)
  v_mfma_f32_32x32x16_bf16 v[64:79], v[40:43], v[192:195], 0
  v_exp_f32 v87, v87
  v_cvt_pk_bf16_f32 v106, v84, v85
  v_exp_f32 v88, v88
  v_exp_f32 v89, v89
  v_cvt_pk_bf16_f32 v107, v86, v87
  v_mfma_f32_32x32x16_bf16 v[64:79], v[44:47], v[196:199], v[64:79]
  v_exp_f32 v90, v90
  v_exp_f32 v91, v91
  ds_read_b128 v[32:35], v4 offset:16384
  v_cvt_pk_bf16_f32 v108, v88, v89
  v_exp_f32 v92, v92
  v_exp_f32 v93, v93
  ds_read_b128 v[36:39], v4 offset:17408
  v_cvt_pk_bf16_f32 v109, v90, v91
  v_exp_f32 v94, v94
  v_exp_f32 v95, v95
  v_cvt_pk_bf16_f32 v110, v92, v93
  v_cvt_pk_bf16_f32 v111, v94, v95
  v_mfma_f32_32x32x16_bf16 v[128:143], v[48:51], v[104:107], v[128:143]
  v_exp_f32 v64, v64
  v_exp_f32 v65, v65
  v_exp_f32 v66, v66
  v_exp_f32 v67, v67
  v_mfma_f32_32x32x16_bf16 v[128:143], v[52:55], v[108:111], v[128:143]
  v_cvt_pk_bf16_f32 v96, v64, v65
  v_exp_f32 v68, v68
  v_exp_f32 v69, v69
  v_cvt_pk_bf16_f32 v97, v66, v67
  v_exp_f32 v70, v70
  v_mfma_f32_32x32x16_bf16 v[80:95], v[40:43], v[200:203], 0
  v_exp_f32 v71, v71
  v_cvt_pk_bf16_f32 v98, v68, v69
  v_exp_f32 v72, v72
  v_exp_f32 v73, v73
  v_cvt_pk_bf16_f32 v99, v70, v71
  v_mfma_f32_32x32x16_bf16 v[80:95], v[44:47], v[204:207], v[80:95]
  v_exp_f32 v74, v74
  v_exp_f32 v75, v75
  ds_read_b128 v[48:51], v4 offset:49152
  v_cvt_pk_bf16_f32 v100, v72, v73
  v_exp_f32 v76, v76
  v_exp_f32 v77, v77
  ds_read_b128 v[52:55], v4 offset:50176
  v_cvt_pk_bf16_f32 v101, v74, v75
  v_exp_f32 v78, v78
  s_add_u32 m0, s31, 7168
  s_add_u32 s29, s53, s27
  s_add_u32 s29, s29, 7168
  buffer_load_dwordx4 v2, s[8:11], s29 offen sc1 lds
  v_exp_f32 v79, v79
  v_cvt_pk_bf16_f32 v102, v76, v77
  v_cvt_pk_bf16_f32 v103, v78, v79
  s_waitcnt lgkmcnt(4)
  v_mfma_f32_32x32x16_bf16 v[112:127], v[56:59], v[96:99], v[112:127]
  v_exp_f32 v80, v80
  v_exp_f32 v81, v81
  v_exp_f32 v82, v82
  v_exp_f32 v83, v83
  v_mfma_f32_32x32x16_bf16 v[112:127], v[60:63], v[100:103], v[112:127]
  v_cvt_pk_bf16_f32 v104, v80, v81
  v_exp_f32 v84, v84
  v_exp_f32 v85, v85
  v_cvt_pk_bf16_f32 v105, v82, v83
  v_exp_f32 v86, v86
  s_waitcnt lgkmcnt(2)
  v_mfma_f32_32x32x16_bf16 v[64:79], v[32:35], v[192:195], 0
  v_exp_f32 v87, v87
  v_cvt_pk_bf16_f32 v106, v84, v85
  v_exp_f32 v88, v88
  v_exp_f32 v89, v89
  v_cvt_pk_bf16_f32 v107, v86, v87
  v_mfma_f32_32x32x16_bf16 v[64:79], v[36:39], v[196:199], v[64:79]
  v_exp_f32 v90, v90
  v_exp_f32 v91, v91
  ds_read_b128 v[40:43], v4 offset:18432
  v_cvt_pk_bf16_f32 v108, v88, v89
  v_exp_f32 v92, v92
  v_exp_f32 v93, v93
  ds_read_b128 v[44:47], v4 offset:19456
  v_cvt_pk_bf16_f32 v109, v90, v91
  v_exp_f32 v94, v94
  v_exp_f32 v95, v95
  v_cvt_pk_bf16_f32 v110, v92, v93
  v_cvt_pk_bf16_f32 v111, v94, v95
  v_mfma_f32_32x32x16_bf16 v[128:143], v[56:59], v[104:107], v[128:143]
  v_exp_f32 v64, v64
  v_exp_f32 v65, v65
  v_exp_f32 v66, v66
  v_exp_f32 v67, v67
  v_mfma_f32_32x32x16_bf16 v[128:143], v[60:63], v[108:111], v[128:143]
  v_cvt_pk_bf16_f32 v96, v64, v65
  v_exp_f32 v68, v68
  v_exp_f32 v69, v69
  v_cvt_pk_bf16_f32 v97, v66, v67
  v_exp_f32 v70, v70
  v_mfma_f32_32x32x16_bf16 v[80:95], v[32:35], v[200:203], 0
  v_exp_f32 v71, v71
  v_cvt_pk_bf16_f32 v98, v68, v69
  v_exp_f32 v72, v72
  v_exp_f32 v73, v73
  v_cvt_pk_bf16_f32 v99, v70, v71
  v_mfma_f32_32x32x16_bf16 v[80:95], v[36:39], v[204:207], v[80:95]
  v_exp_f32 v74, v74
  v_exp_f32 v75, v75
  ds_read_b128 v[56:59], v4 offset:51200
  v_cvt_pk_bf16_f32 v100, v72, v73
  v_exp_f32 v76, v76
  v_exp_f32 v77, v77
  ds_read_b128 v[60:63], v4 offset:52224
  v_cvt_pk_bf16_f32 v101, v74, v75
  v_exp_f32 v78, v78
  s_add_u32 m0, s31, 32768
  s_add_u32 s29, s53, s28
  s_add_u32 s29, s29, 0
  buffer_load_dwordx4 v2, s[8:11], s29 offen sc1 lds
  v_exp_f32 v79, v79
  v_cvt_pk_bf16_f32 v102, v76, v77
  v_cvt_pk_bf16_f32 v103, v78, v79
  s_waitcnt lgkmcnt(4)
  v_mfma_f32_32x32x16_bf16 v[112:127], v[48:51], v[96:99], v[112:127]
  v_exp_f32 v80, v80
  v_exp_f32 v81, v81
  v_exp_f32 v82, v82
  v_exp_f32 v83, v83
  v_mfma_f32_32x32x16_bf16 v[112:127], v[52:55], v[100:103], v[112:127]
  v_cvt_pk_bf16_f32 v104, v80, v81
  v_exp_f32 v84, v84
  v_exp_f32 v85, v85
  v_cvt_pk_bf16_f32 v105, v82, v83
  v_exp_f32 v86, v86
  s_waitcnt lgkmcnt(2)
  v_mfma_f32_32x32x16_bf16 v[64:79], v[40:43], v[192:195], 0
  v_exp_f32 v87, v87
  v_cvt_pk_bf16_f32 v106, v84, v85
  v_exp_f32 v88, v88
  v_exp_f32 v89, v89
  v_cvt_pk_bf16_f32 v107, v86, v87
  v_mfma_f32_32x32x16_bf16 v[64:79], v[44:47], v[196:199], v[64:79]
  v_exp_f32 v90, v90
  v_exp_f32 v91, v91
  ds_read_b128 v[32:35], v4 offset:20480
  v_cvt_pk_bf16_f32 v108, v88, v89
  v_exp_f32 v92, v92
  v_exp_f32 v93, v93
  ds_read_b128 v[36:39], v4 offset:21504
  v_cvt_pk_bf16_f32 v109, v90, v91
  v_exp_f32 v94, v94
  v_exp_f32 v95, v95
  v_cvt_pk_bf16_f32 v110, v92, v93
  v_cvt_pk_bf16_f32 v111, v94, v95
  v_mfma_f32_32x32x16_bf16 v[128:143], v[48:51], v[104:107], v[128:143]
  v_exp_f32 v64, v64
  v_exp_f32 v65, v65
  v_exp_f32 v66, v66
  v_exp_f32 v67, v67
  v_mfma_f32_32x32x16_bf16 v[128:143], v[52:55], v[108:111], v[128:143]
  v_cvt_pk_bf16_f32 v96, v64, v65
  v_exp_f32 v68, v68
  v_exp_f32 v69, v69
  v_cvt_pk_bf16_f32 v97, v66, v67
  v_exp_f32 v70, v70
  v_mfma_f32_32x32x16_bf16 v[80:95], v[40:43], v[200:203], 0
  v_exp_f32 v71, v71
  v_cvt_pk_bf16_f32 v98, v68, v69
  v_exp_f32 v72, v72
  v_exp_f32 v73, v73
  v_cvt_pk_bf16_f32 v99, v70, v71
  v_mfma_f32_32x32x16_bf16 v[80:95], v[44:47], v[204:207], v[80:95]
  v_exp_f32 v74, v74
  v_exp_f32 v75, v75
  ds_read_b128 v[48:51], v4 offset:53248
  v_cvt_pk_bf16_f32 v100, v72, v73
  v_exp_f32 v76, v76
  v_exp_f32 v77, v77
  ds_read_b128 v[52:55], v4 offset:54272
  v_cvt_pk_bf16_f32 v101, v74, v75
  v_exp_f32 v78, v78
  s_add_u32 m0, s31, 33792
  s_add_u32 s29, s53, s28
  s_add_u32 s29, s29, 1024
  buffer_load_dwordx4 v2, s[8:11], s29 offen sc1 lds
  v_exp_f32 v79, v79
  v_cvt_pk_bf16_f32 v102, v76, v77
  v_cvt_pk_bf16_f32 v103, v78, v79
  s_waitcnt lgkmcnt(4)
  v_mfma_f32_32x32x16_bf16 v[112:127], v[56:59], v[96:99], v[112:127]
  v_exp_f32 v80, v80
  v_exp_f32 v81, v81
  v_exp_f32 v82, v82
  v_exp_f32 v83, v83
  v_mfma_f32_32x32x16_bf16 v[112:127], v[60:63], v[100:103], v[112:127]
  v_cvt_pk_bf16_f32 v104, v80, v81
  v_exp_f32 v84, v84
  v_exp_f32 v85, v85
  v_cvt_pk_bf16_f32 v105, v82, v83
  v_exp_f32 v86, v86
  s_waitcnt lgkmcnt(2)
  v_mfma_f32_32x32x16_bf16 v[64:79], v[32:35], v[192:195], 0
  v_exp_f32 v87, v87
  v_cvt_pk_bf16_f32 v106, v84, v85
  v_exp_f32 v88, v88
  v_exp_f32 v89, v89
  v_cvt_pk_bf16_f32 v107, v86, v87
  v_mfma_f32_32x32x16_bf16 v[64:79], v[36:39], v[196:199], v[64:79]
  v_exp_f32 v90, v90
  v_exp_f32 v91, v91
  ds_read_b128 v[40:43], v4 offset:22528
  v_cvt_pk_bf16_f32 v108, v88, v89
  v_exp_f32 v92, v92
  v_exp_f32 v93, v93
  ds_read_b128 v[44:47], v4 offset:23552
  v_cvt_pk_bf16_f32 v109, v90, v91
  v_exp_f32 v94, v94
  v_exp_f32 v95, v95
  v_cvt_pk_bf16_f32 v110, v92, v93
  v_cvt_pk_bf16_f32 v111, v94, v95
  v_mfma_f32_32x32x16_bf16 v[128:143], v[56:59], v[104:107], v[128:143]
  v_exp_f32 v64, v64
  v_exp_f32 v65, v65
  v_exp_f32 v66, v66
  v_exp_f32 v67, v67
  v_mfma_f32_32x32x16_bf16 v[128:143], v[60:63], v[108:111], v[128:143]
  v_cvt_pk_bf16_f32 v96, v64, v65
  v_exp_f32 v68, v68
  v_exp_f32 v69, v69
  v_cvt_pk_bf16_f32 v97, v66, v67
  v_exp_f32 v70, v70
  v_mfma_f32_32x32x16_bf16 v[80:95], v[32:35], v[200:203], 0
  v_exp_f32 v71, v71
  v_cvt_pk_bf16_f32 v98, v68, v69
  v_exp_f32 v72, v72
  v_exp_f32 v73, v73
  v_cvt_pk_bf16_f32 v99, v70, v71
  v_mfma_f32_32x32x16_bf16 v[80:95], v[36:39], v[204:207], v[80:95]
  v_exp_f32 v74, v74
  v_exp_f32 v75, v75
  ds_read_b128 v[56:59], v4 offset:55296
  v_cvt_pk_bf16_f32 v100, v72, v73
  v_exp_f32 v76, v76
  v_exp_f32 v77, v77
  ds_read_b128 v[60:63], v4 offset:56320
  v_cvt_pk_bf16_f32 v101, v74, v75
  v_exp_f32 v78, v78
  s_add_u32 m0, s31, 34816
  s_add_u32 s29, s53, s28
  s_add_u32 s29, s29, 2048
  buffer_load_dwordx4 v2, s[8:11], s29 offen sc1 lds
  v_exp_f32 v79, v79
  v_cvt_pk_bf16_f32 v102, v76, v77
  v_cvt_pk_bf16_f32 v103, v78, v79
  s_waitcnt lgkmcnt(4)
  v_mfma_f32_32x32x16_bf16 v[112:127], v[48:51], v[96:99], v[112:127]
  v_exp_f32 v80, v80
  v_exp_f32 v81, v81
  v_exp_f32 v82, v82
  v_exp_f32 v83, v83
  v_mfma_f32_32x32x16_bf16 v[112:127], v[52:55], v[100:103], v[112:127]
  v_cvt_pk_bf16_f32 v104, v80, v81
  v_exp_f32 v84, v84
  v_exp_f32 v85, v85
  v_cvt_pk_bf16_f32 v105, v82, v83
  v_exp_f32 v86, v86
  s_waitcnt lgkmcnt(2)
  v_mfma_f32_32x32x16_bf16 v[64:79], v[40:43], v[192:195], 0
  v_exp_f32 v87, v87
  v_cvt_pk_bf16_f32 v106, v84, v85
  v_exp_f32 v88, v88
  v_exp_f32 v89, v89
  v_cvt_pk_bf16_f32 v107, v86, v87
  v_mfma_f32_32x32x16_bf16 v[64:79], v[44:47], v[196:199], v[64:79]
  v_exp_f32 v90, v90
  v_exp_f32 v91, v91
  ds_read_b128 v[32:35], v4 offset:24576
  v_cvt_pk_bf16_f32 v108, v88, v89
  v_exp_f32 v92, v92
  v_exp_f32 v93, v93
  ds_read_b128 v[36:39], v4 offset:25600
  v_cvt_pk_bf16_f32 v109, v90, v91
  v_exp_f32 v94, v94
  v_exp_f32 v95, v95
  v_cvt_pk_bf16_f32 v110, v92, v93
  v_cvt_pk_bf16_f32 v111, v94, v95
  v_mfma_f32_32x32x16_bf16 v[128:143], v[48:51], v[104:107], v[128:143]
  v_exp_f32 v64, v64
  v_exp_f32 v65, v65
  v_exp_f32 v66, v66
  v_exp_f32 v67, v67
  v_mfma_f32_32x32x16_bf16 v[128:143], v[52:55], v[108:111], v[128:143]
  v_cvt_pk_bf16_f32 v96, v64, v65
  v_exp_f32 v68, v68
  v_exp_f32 v69, v69
  v_cvt_pk_bf16_f32 v97, v66, v67
  v_exp_f32 v70, v70
  v_mfma_f32_32x32x16_bf16 v[80:95], v[40:43], v[200:203], 0
  v_exp_f32 v71, v71
  v_cvt_pk_bf16_f32 v98, v68, v69
  v_exp_f32 v72, v72
  v_exp_f32 v73, v73
  v_cvt_pk_bf16_f32 v99, v70, v71
  v_mfma_f32_32x32x16_bf16 v[80:95], v[44:47], v[204:207], v[80:95]
  v_exp_f32 v74, v74
  v_exp_f32 v75, v75
  ds_read_b128 v[48:51], v4 offset:57344
  v_cvt_pk_bf16_f32 v100, v72, v73
  v_exp_f32 v76, v76
  v_exp_f32 v77, v77
  ds_read_b128 v[52:55], v4 offset:58368
  v_cvt_pk_bf16_f32 v101, v74, v75
  v_exp_f32 v78, v78
  s_add_u32 m0, s31, 35840
  s_add_u32 s29, s53, s28
  s_add_u32 s29, s29, 3072
  buffer_load_dwordx4 v2, s[8:11], s29 offen sc1 lds
  v_exp_f32 v79, v79
  v_cvt_pk_bf16_f32 v102, v76, v77
  v_cvt_pk_bf16_f32 v103, v78, v79
  s_waitcnt lgkmcnt(4)
  v_mfma_f32_32x32x16_bf16 v[112:127], v[56:59], v[96:99], v[112:127]
  v_exp_f32 v80, v80
  v_exp_f32 v81, v81
  v_exp_f32 v82, v82
  v_exp_f32 v83, v83
  v_mfma_f32_32x32x16_bf16 v[112:127], v[60:63], v[100:103], v[112:127]
  v_cvt_pk_bf16_f32 v104, v80, v81
  v_exp_f32 v84, v84
  v_exp_f32 v85, v85
  v_cvt_pk_bf16_f32 v105, v82, v83
  v_exp_f32 v86, v86
  s_waitcnt lgkmcnt(2)
  v_mfma_f32_32x32x16_bf16 v[64:79], v[32:35], v[192:195], 0
  v_exp_f32 v87, v87
  v_cvt_pk_bf16_f32 v106, v84, v85
  v_exp_f32 v88, v88
  v_exp_f32 v89, v89
  v_cvt_pk_bf16_f32 v107, v86, v87
  v_mfma_f32_32x32x16_bf16 v[64:79], v[36:39], v[196:199], v[64:79]
  v_exp_f32 v90, v90
  v_exp_f32 v91, v91
  ds_read_b128 v[40:43], v4 offset:26624
  v_cvt_pk_bf16_f32 v108, v88, v89
  v_exp_f32 v92, v92
  v_exp_f32 v93, v93
  ds_read_b128 v[44:47], v4 offset:27648
  v_cvt_pk_bf16_f32 v109, v90, v91
  v_exp_f32 v94, v94
  v_exp_f32 v95, v95
  v_cvt_pk_bf16_f32 v110, v92, v93
  v_cvt_pk_bf16_f32 v111, v94, v95
  v_mfma_f32_32x32x16_bf16 v[128:143], v[56:59], v[104:107], v[128:143]
  v_exp_f32 v64, v64
  v_exp_f32 v65, v65
  v_exp_f32 v66, v66
  v_exp_f32 v67, v67
  v_mfma_f32_32x32x16_bf16 v[128:143], v[60:63], v[108:111], v[128:143]
  v_cvt_pk_bf16_f32 v96, v64, v65
  v_exp_f32 v68, v68
  v_exp_f32 v69, v69
  v_cvt_pk_bf16_f32 v97, v66, v67
  v_exp_f32 v70, v70
  v_mfma_f32_32x32x16_bf16 v[80:95], v[32:35], v[200:203], 0
  v_exp_f32 v71, v71
  v_cvt_pk_bf16_f32 v98, v68, v69
  v_exp_f32 v72, v72
  v_exp_f32 v73, v73
  v_cvt_pk_bf16_f32 v99, v70, v71
  v_mfma_f32_32x32x16_bf16 v[80:95], v[36:39], v[204:207], v[80:95]
  v_exp_f32 v74, v74
  v_exp_f32 v75, v75
  ds_read_b128 v[56:59], v4 offset:59392
  v_cvt_pk_bf16_f32 v100, v72, v73
  v_exp_f32 v76, v76
  v_exp_f32 v77, v77
  ds_read_b128 v[60:63], v4 offset:60416
  v_cvt_pk_bf16_f32 v101, v74, v75
  v_exp_f32 v78, v78
  s_add_u32 m0, s31, 36864
  s_add_u32 s29, s53, s28
  s_add_u32 s29, s29, 4096
  buffer_load_dwordx4 v2, s[8:11], s29 offen sc1 lds
  v_exp_f32 v79, v79
  v_cvt_pk_bf16_f32 v102, v76, v77
  v_cvt_pk_bf16_f32 v103, v78, v79
  s_waitcnt lgkmcnt(4)
  v_mfma_f32_32x32x16_bf16 v[112:127], v[48:51], v[96:99], v[112:127]
  v_exp_f32 v80, v80
  v_exp_f32 v81, v81
  v_exp_f32 v82, v82
  v_exp_f32 v83, v83
  v_mfma_f32_32x32x16_bf16 v[112:127], v[52:55], v[100:103], v[112:127]
  v_cvt_pk_bf16_f32 v104, v80, v81
  v_exp_f32 v84, v84
  v_exp_f32 v85, v85
  v_cvt_pk_bf16_f32 v105, v82, v83
  v_exp_f32 v86, v86
  s_waitcnt lgkmcnt(2)
  v_mfma_f32_32x32x16_bf16 v[64:79], v[40:43], v[192:195], 0
  v_exp_f32 v87, v87
  v_cvt_pk_bf16_f32 v106, v84, v85
  v_exp_f32 v88, v88
  v_exp_f32 v89, v89
  v_cvt_pk_bf16_f32 v107, v86, v87
  v_mfma_f32_32x32x16_bf16 v[64:79], v[44:47], v[196:199], v[64:79]
  v_exp_f32 v90, v90
  v_exp_f32 v91, v91
  ds_read_b128 v[32:35], v4 offset:28672
  v_cvt_pk_bf16_f32 v108, v88, v89
  v_exp_f32 v92, v92
  v_exp_f32 v93, v93
  ds_read_b128 v[36:39], v4 offset:29696
  v_cvt_pk_bf16_f32 v109, v90, v91
  v_exp_f32 v94, v94
  v_exp_f32 v95, v95
  v_cvt_pk_bf16_f32 v110, v92, v93
  v_cvt_pk_bf16_f32 v111, v94, v95
  v_mfma_f32_32x32x16_bf16 v[128:143], v[48:51], v[104:107], v[128:143]
  v_exp_f32 v64, v64
  v_exp_f32 v65, v65
  v_exp_f32 v66, v66
  v_exp_f32 v67, v67
  v_mfma_f32_32x32x16_bf16 v[128:143], v[52:55], v[108:111], v[128:143]
  v_cvt_pk_bf16_f32 v96, v64, v65
  v_exp_f32 v68, v68
  v_exp_f32 v69, v69
  v_cvt_pk_bf16_f32 v97, v66, v67
  v_exp_f32 v70, v70
  v_mfma_f32_32x32x16_bf16 v[80:95], v[40:43], v[200:203], 0
  v_exp_f32 v71, v71
  v_cvt_pk_bf16_f32 v98, v68, v69
  v_exp_f32 v72, v72
  v_exp_f32 v73, v73
  v_cvt_pk_bf16_f32 v99, v70, v71
  v_mfma_f32_32x32x16_bf16 v[80:95], v[44:47], v[204:207], v[80:95]
  v_exp_f32 v74, v74
  v_exp_f32 v75, v75
  ds_read_b128 v[48:51], v4 offset:61440
  v_cvt_pk_bf16_f32 v100, v72, v73
  v_exp_f32 v76, v76
  v_exp_f32 v77, v77
  ds_read_b128 v[52:55], v4 offset:62464
  v_cvt_pk_bf16_f32 v101, v74, v75
  v_exp_f32 v78, v78
  s_add_u32 m0, s31, 37888
  s_add_u32 s29, s53, s28
  s_add_u32 s29, s29, 5120
  buffer_load_dwordx4 v2, s[8:11], s29 offen sc1 lds
  v_exp_f32 v79, v79
  v_cvt_pk_bf16_f32 v102, v76, v77
  v_cvt_pk_bf16_f32 v103, v78, v79
  s_waitcnt lgkmcnt(4)
  v_mfma_f32_32x32x16_bf16 v[112:127], v[56:59], v[96:99], v[112:127]
  v_exp_f32 v80, v80
  v_exp_f32 v81, v81
  v_exp_f32 v82, v82
  v_exp_f32 v83, v83
  v_mfma_f32_32x32x16_bf16 v[112:127], v[60:63], v[100:103], v[112:127]
  v_cvt_pk_bf16_f32 v104, v80, v81
  v_exp_f32 v84, v84
  v_exp_f32 v85, v85
  v_cvt_pk_bf16_f32 v105, v82, v83
  v_exp_f32 v86, v86
  s_waitcnt lgkmcnt(2)
  v_mfma_f32_32x32x16_bf16 v[64:79], v[32:35], v[192:195], 0
  v_exp_f32 v87, v87
  v_cvt_pk_bf16_f32 v106, v84, v85
  v_exp_f32 v88, v88
  v_exp_f32 v89, v89
  v_cvt_pk_bf16_f32 v107, v86, v87
  v_mfma_f32_32x32x16_bf16 v[64:79], v[36:39], v[196:199], v[64:79]
  v_exp_f32 v90, v90
  v_exp_f32 v91, v91
  ds_read_b128 v[40:43], v4 offset:30720
  v_cvt_pk_bf16_f32 v108, v88, v89
  v_exp_f32 v92, v92
  v_exp_f32 v93, v93
  ds_read_b128 v[44:47], v4 offset:31744
  v_cvt_pk_bf16_f32 v109, v90, v91
  v_exp_f32 v94, v94
  v_exp_f32 v95, v95
  v_cvt_pk_bf16_f32 v110, v92, v93
  v_cvt_pk_bf16_f32 v111, v94, v95
  v_mfma_f32_32x32x16_bf16 v[128:143], v[56:59], v[104:107], v[128:143]
  v_exp_f32 v64, v64
  v_exp_f32 v65, v65
  v_exp_f32 v66, v66
  v_exp_f32 v67, v67
  v_mfma_f32_32x32x16_bf16 v[128:143], v[60:63], v[108:111], v[128:143]
  v_cvt_pk_bf16_f32 v96, v64, v65
  v_exp_f32 v68, v68
  v_exp_f32 v69, v69
  v_cvt_pk_bf16_f32 v97, v66, v67
  v_exp_f32 v70, v70
  v_mfma_f32_32x32x16_bf16 v[80:95], v[32:35], v[200:203], 0
  v_exp_f32 v71, v71
  v_cvt_pk_bf16_f32 v98, v68, v69
  v_exp_f32 v72, v72
  v_exp_f32 v73, v73
  v_cvt_pk_bf16_f32 v99, v70, v71
  v_mfma_f32_32x32x16_bf16 v[80:95], v[36:39], v[204:207], v[80:95]
  v_exp_f32 v74, v74
  v_exp_f32 v75, v75
  ds_read_b128 v[56:59], v4 offset:63488
  v_cvt_pk_bf16_f32 v100, v72, v73
  v_exp_f32 v76, v76
  v_exp_f32 v77, v77
  ds_read_b128 v[60:63], v4 offset:64512
  v_cvt_pk_bf16_f32 v101, v74, v75
  v_exp_f32 v78, v78
  s_add_u32 m0, s31, 38912
  s_add_u32 s29, s53, s28
  s_add_u32 s29, s29, 6144
  buffer_load_dwordx4 v2, s[8:11], s29 offen sc1 lds
  v_exp_f32 v79, v79
  v_cvt_pk_bf16_f32 v102, v76, v77
  v_cvt_pk_bf16_f32 v103, v78, v79
  s_waitcnt lgkmcnt(4)
  v_mfma_f32_32x32x16_bf16 v[112:127], v[48:51], v[96:99], v[112:127]
  v_exp_f32 v80, v80
  v_exp_f32 v81, v81
  v_exp_f32 v82, v82
  v_exp_f32 v83, v83
  v_mfma_f32_32x32x16_bf16 v[112:127], v[52:55], v[100:103], v[112:127]
  v_cvt_pk_bf16_f32 v104, v80, v81
  v_exp_f32 v84, v84
  v_exp_f32 v85, v85
  v_cvt_pk_bf16_f32 v105, v82, v83
  v_exp_f32 v86, v86
  s_waitcnt lgkmcnt(2)
  v_mfma_f32_32x32x16_bf16 v[64:79], v[40:43], v[192:195], 0
  v_exp_f32 v87, v87
  v_cvt_pk_bf16_f32 v106, v84, v85
  v_exp_f32 v88, v88
  v_exp_f32 v89, v89
  v_cvt_pk_bf16_f32 v107, v86, v87
  v_mfma_f32_32x32x16_bf16 v[64:79], v[44:47], v[196:199], v[64:79]
  v_exp_f32 v90, v90
  v_exp_f32 v91, v91
  v_cvt_pk_bf16_f32 v108, v88, v89
  v_exp_f32 v92, v92
  v_exp_f32 v93, v93
  v_cvt_pk_bf16_f32 v109, v90, v91
  v_exp_f32 v94, v94
  v_exp_f32 v95, v95
  v_cvt_pk_bf16_f32 v110, v92, v93
  v_cvt_pk_bf16_f32 v111, v94, v95
  v_mfma_f32_32x32x16_bf16 v[128:143], v[48:51], v[104:107], v[128:143]
  v_exp_f32 v64, v64
  v_exp_f32 v65, v65
  v_exp_f32 v66, v66
  v_exp_f32 v67, v67
  v_mfma_f32_32x32x16_bf16 v[128:143], v[52:55], v[108:111], v[128:143]
  v_cvt_pk_bf16_f32 v96, v64, v65
  v_exp_f32 v68, v68
  v_exp_f32 v69, v69
  v_cvt_pk_bf16_f32 v97, v66, v67
  v_exp_f32 v70, v70
  v_mfma_f32_32x32x16_bf16 v[80:95], v[40:43], v[200:203], 0
  v_exp_f32 v71, v71
  v_cvt_pk_bf16_f32 v98, v68, v69
  v_exp_f32 v72, v72
  v_exp_f32 v73, v73
  v_cvt_pk_bf16_f32 v99, v70, v71
  v_mfma_f32_32x32x16_bf16 v[80:95], v[44:47], v[204:207], v[80:95]
  v_exp_f32 v74, v74
  v_exp_f32 v75, v75
  v_cvt_pk_bf16_f32 v100, v72, v73
  v_exp_f32 v76, v76
  v_exp_f32 v77, v77
  v_cvt_pk_bf16_f32 v101, v74, v75
  v_exp_f32 v78, v78
  s_add_u32 m0, s31, 39936
  s_add_u32 s29, s53, s28
  s_add_u32 s29, s29, 7168
  buffer_load_dwordx4 v2, s[8:11], s29 offen sc1 lds
  v_exp_f32 v79, v79
  v_cvt_pk_bf16_f32 v102, v76, v77
  v_cvt_pk_bf16_f32 v103, v78, v79
  s_waitcnt lgkmcnt(0)
  v_mfma_f32_32x32x16_bf16 v[112:127], v[56:59], v[96:99], v[112:127]
  v_exp_f32 v80, v80
  v_exp_f32 v81, v81
  v_exp_f32 v82, v82
  v_exp_f32 v83, v83
  v_mfma_f32_32x32x16_bf16 v[112:127], v[60:63], v[100:103], v[112:127]
  v_cvt_pk_bf16_f32 v104, v80, v81
  v_exp_f32 v84, v84
  v_exp_f32 v85, v85
  v_cvt_pk_bf16_f32 v105, v82, v83
  v_exp_f32 v86, v86
  v_exp_f32 v87, v87
  v_cvt_pk_bf16_f32 v106, v84, v85
  v_exp_f32 v88, v88
  v_exp_f32 v89, v89
  v_cvt_pk_bf16_f32 v107, v86, v87
  v_exp_f32 v90, v90
  v_exp_f32 v91, v91
  v_cvt_pk_bf16_f32 v108, v88, v89
  v_exp_f32 v92, v92
  v_exp_f32 v93, v93
  v_cvt_pk_bf16_f32 v109, v90, v91
  v_exp_f32 v94, v94
  v_exp_f32 v95, v95
  v_cvt_pk_bf16_f32 v110, v92, v93
  v_cvt_pk_bf16_f32 v111, v94, v95
  s_nop 1
  v_mfma_f32_32x32x16_bf16 v[128:143], v[56:59], v[104:107], v[128:143]
  v_mfma_f32_32x32x16_bf16 v[128:143], v[60:63], v[108:111], v[128:143]
  s_cmp_lt_u32 s41, 4
  s_cbranch_scc1 kb2_chunk2
  s_nop 11
  v_mov_b32 v5, v120
  v_mov_b32 v6, v120
  s_nop 1
  v_permlane32_swap_b32 v5, v6
  v_mov_b32 v14, v6
  v_mov_b32 v5, v136
  v_mov_b32 v6, v136
  s_nop 1
  v_permlane32_swap_b32 v5, v6
  v_mov_b32 v15, v6
  s_cmp_eq_u32 s40, 0
  s_cbranch_scc0 kb2_fin
  v_min_f32 v5, v14, v15
  v_cmp_gt_f32 vcc, 0x12800000, v5
  v_cmp_u_f32 s[36:37], v5, v5
  s_nop 1
  s_or_b64 vcc, vcc, s[36:37]
  s_cmp_lg_u64 vcc, 0
  s_cselect_b32 s42, 1, 0
  v_mov_b32 v5, s42
  s_lshl_b32 s30, s21, 2
  s_add_u32 s30, s30, 131584
  v_mov_b32 v6, s30
  ds_write_b32 v6, v5
  s_waitcnt vmcnt(0) lgkmcnt(0)
  s_barrier
  v_mov_b32 v6, 131584
  ds_read_b128 v[8:11], v6
  s_waitcnt lgkmcnt(0)
  v_or_b32 v8, v8, v9
  v_or_b32 v10, v10, v11
  v_or_b32 v8, v8, v10
  s_nop 0
  v_readfirstlane_b32 s42, v8
  s_cmp_eq_u32 s42, 0
  s_cbranch_scc1 kb2_fin
  s_mov_b32 s40, 1
  v_and_b32 v5, 0xffff0000, v198
  v_cndmask_b32 v198, v198, v5, s[34:35]
  v_mov_b32 v12, 0xff7fffff
  v_and_b32 v5, 0xffff0000, v206
  v_cndmask_b32 v206, v206, v5, s[34:35]
  v_mov_b32 v13, 0xff7fffff
  s_mov_b32 s41, 0
kb2_mx:
  s_lshl_b32 s30, s41, 11
  s_add_u32 s30, s30, s27
  buffer_load_dwordx4 v[32:35], v2, s[8:11], s30 offen sc1
  buffer_load_dwordx4 v[36:39], v2, s[8:11], s30 offen offset:1024 sc1
  s_waitcnt vmcnt(0)
  v_mfma_f32_32x32x16_bf16 v[64:79], v[32:35], v[192:195], 0
  v_mfma_f32_32x32x16_bf16 v[64:79], v[36:39], v[196:199], v[64:79]
  v_mfma_f32_32x32x16_bf16 v[80:95], v[32:35], v[200:203], 0
  v_mfma_f32_32x32x16_bf16 v[80:95], v[36:39], v[204:207], v[80:95]
  s_nop 11
  v_max3_f32 v12, v12, v64, v65
  v_max3_f32 v12, v12, v66, v67
  v_max3_f32 v12, v12, v68, v69
  v_max3_f32 v12, v12, v70, v71
  v_max3_f32 v12, v12, v72, v73
  v_max3_f32 v12, v12, v74, v75
  v_max3_f32 v12, v12, v76, v77
  v_max3_f32 v12, v12, v78, v79
  v_max3_f32 v13, v13, v80, v81
  v_max3_f32 v13, v13, v82, v83
  v_max3_f32 v13, v13, v84, v85
  v_max3_f32 v13, v13, v86, v87
  v_max3_f32 v13, v13, v88, v89
  v_max3_f32 v13, v13, v90, v91
  v_max3_f32 v13, v13, v92, v93
  v_max3_f32 v13, v13, v94, v95
  s_add_u32 s41, s41, 1
  s_cmp_lt_u32 s41, 64
  s_cbranch_scc1 kb2_mx
  v_mov_b32 v5, v12
  s_nop 1
  v_permlane32_swap_b32 v12, v5
  v_max_f32 v12, v12, v5
  v_cvt_pk_bf16_f32 v5, v12, v12
  v_and_b32 v5, 0xffff, v5
  v_xor_b32 v5, 0x8000, v5
  v_and_b32 v6, 0xffff0000, v198
  v_or_b32 v5, v5, v6
  v_cndmask_b32 v198, v198, v5, s[34:35]
  v_mov_b32 v5, v13
  s_nop 1
  v_permlane32_swap_b32 v13, v5
  v_max_f32 v13, v13, v5
  v_cvt_pk_bf16_f32 v5, v13, v13
  v_and_b32 v5, 0xffff, v5
  v_xor_b32 v5, 0x8000, v5
  v_and_b32 v6, 0xffff0000, v206
  v_or_b32 v5, v5, v6
  v_cndmask_b32 v206, v206, v5, s[34:35]
  s_barrier
  s_mov_b32 s41, 0
  s_mul_i32 s53, s41, 32768
  s_lshl_b32 s31, s21, 13
  s_add_u32 s53, s53, s31
  s_add_u32 m0, s31, 0
  s_add_u32 s29, s53, s27
  s_add_u32 s29, s29, 0
  buffer_load_dwordx4 v2, s[8:11], s29 offen sc1 lds
  s_add_u32 m0, s31, 1024
  s_add_u32 s29, s53, s27
  s_add_u32 s29, s29, 1024
  buffer_load_dwordx4 v2, s[8:11], s29 offen sc1 lds
  s_add_u32 m0, s31, 2048
  s_add_u32 s29, s53, s27
  s_add_u32 s29, s29, 2048
  buffer_load_dwordx4 v2, s[8:11], s29 offen sc1 lds
  s_add_u32 m0, s31, 3072
  s_add_u32 s29, s53, s27
  s_add_u32 s29, s29, 3072
  buffer_load_dwordx4 v2, s[8:11], s29 offen sc1 lds
  s_add_u32 m0, s31, 4096
  s_add_u32 s29, s53, s27
  s_add_u32 s29, s29, 4096
  buffer_load_dwordx4 v2, s[8:11], s29 offen sc1 lds
  s_add_u32 m0, s31, 5120
  s_add_u32 s29, s53, s27
  s_add_u32 s29, s29, 5120
  buffer_load_dwordx4 v2, s[8:11], s29 offen sc1 lds
  s_add_u32 m0, s31, 6144
  s_add_u32 s29, s53, s27
  s_add_u32 s29, s29, 6144
  buffer_load_dwordx4 v2, s[8:11], s29 offen sc1 lds
  s_add_u32 m0, s31, 7168
  s_add_u32 s29, s53, s27
  s_add_u32 s29, s29, 7168
  buffer_load_dwordx4 v2, s[8:11], s29 offen sc1 lds
  s_add_u32 m0, s31, 32768
  s_add_u32 s29, s53, s28
  s_add_u32 s29, s29, 0
  buffer_load_dwordx4 v2, s[8:11], s29 offen sc1 lds
  s_add_u32 m0, s31, 33792
  s_add_u32 s29, s53, s28
  s_add_u32 s29, s29, 1024
  buffer_load_dwordx4 v2, s[8:11], s29 offen sc1 lds
  s_add_u32 m0, s31, 34816
  s_add_u32 s29, s53, s28
  s_add_u32 s29, s29, 2048
  buffer_load_dwordx4 v2, s[8:11], s29 offen sc1 lds
  s_add_u32 m0, s31, 35840
  s_add_u32 s29, s53, s28
  s_add_u32 s29, s29, 3072
  buffer_load_dwordx4 v2, s[8:11], s29 offen sc1 lds
  s_add_u32 m0, s31, 36864
  s_add_u32 s29, s53, s28
  s_add_u32 s29, s29, 4096
  buffer_load_dwordx4 v2, s[8:11], s29 offen sc1 lds
  s_add_u32 m0, s31, 37888
  s_add_u32 s29, s53, s28
  s_add_u32 s29, s29, 5120
  buffer_load_dwordx4 v2, s[8:11], s29 offen sc1 lds
  s_add_u32 m0, s31, 38912
  s_add_u32 s29, s53, s28
  s_add_u32 s29, s29, 6144
  buffer_load_dwordx4 v2, s[8:11], s29 offen sc1 lds
  s_add_u32 m0, s31, 39936
  s_add_u32 s29, s53, s28
  s_add_u32 s29, s29, 7168
  buffer_load_dwordx4 v2, s[8:11], s29 offen sc1 lds
  s_branch kb2_main2
kb2_fin:
  v_and_b32 v3, 15, v1
  v_bfe_u32 v11, v1, 4, 1
  v_mul_u32_u24 v11, 20480, v11
  v_lshrrev_b32 v4, 5, v1
  s_mul_i32 s30, s22, 20
  v_lshlrev_b32 v5, 2, v4
  v_add_u32 v5, 0, v5
  v_add_u32 v5, s30, v5
  v_lshrrev_b32 v6, 5, v5
  v_lshlrev_b32 v6, 10, v6
  v_bfe_u32 v7, v5, 3, 2
  v_lshlrev_b32 v7, 4, v7
  v_add_u32 v7, v7, v3
  v_lshlrev_b32 v7, 4, v7
  v_add_u32 v6, v6, v7
  v_bfe_u32 v7, v5, 2, 1
  v_lshlrev_b32 v7, 3, v7
  v_add_u32 v6, v6, v7
  v_add_u32 v32, v6, v11
  v_lshlrev_b32 v5, 2, v4
  v_add_u32 v5, 8, v5
  v_add_u32 v5, s30, v5
  v_lshrrev_b32 v6, 5, v5
  v_lshlrev_b32 v6, 10, v6
  v_bfe_u32 v7, v5, 3, 2
  v_lshlrev_b32 v7, 4, v7
  v_add_u32 v7, v7, v3
  v_lshlrev_b32 v7, 4, v7
  v_add_u32 v6, v6, v7
  v_bfe_u32 v7, v5, 2, 1
  v_lshlrev_b32 v7, 3, v7
  v_add_u32 v6, v6, v7
  v_add_u32 v33, v6, v11
  v_lshlrev_b32 v5, 2, v4
  v_add_u32 v5, 16, v5
  v_add_u32 v5, s30, v5
  v_lshrrev_b32 v6, 5, v5
  v_lshlrev_b32 v6, 10, v6
  v_bfe_u32 v7, v5, 3, 2
  v_lshlrev_b32 v7, 4, v7
  v_add_u32 v7, v7, v3
  v_lshlrev_b32 v7, 4, v7
  v_add_u32 v6, v6, v7
  v_bfe_u32 v7, v5, 2, 1
  v_lshlrev_b32 v7, 3, v7
  v_add_u32 v6, v6, v7
  v_add_u32 v34, v6, v11
  v_mov_b32 v5, 0x40000000
  v_cndmask_b32 v34, v5, v34, s[34:35]
  v_rcp_f32 v5, v14
  s_nop 0
  v_mul_f32 v112, v112, v5
  v_mul_f32 v113, v113, v5
  v_mul_f32 v114, v114, v5
  v_mul_f32 v115, v115, v5
  v_mul_f32 v116, v116, v5
  v_mul_f32 v117, v117, v5
  v_mul_f32 v118, v118, v5
  v_mul_f32 v119, v119, v5
  v_mul_f32 v120, v120, v5
  v_mul_f32 v121, v121, v5
  v_mul_f32 v122, v122, v5
  v_mul_f32 v123, v123, v5
  v_cvt_pk_bf16_f32 v40, v112, v113
  v_cvt_pk_bf16_f32 v41, v114, v115
  v_cvt_pk_bf16_f32 v42, v116, v117
  v_cvt_pk_bf16_f32 v43, v118, v119
  v_cvt_pk_bf16_f32 v44, v120, v121
  v_cvt_pk_bf16_f32 v45, v122, v123
  s_add_u32 s31, s52, 0
  s_mul_i32 s31, s31, 40960
  s_add_u32 s31, s31, 0xf200000
  buffer_store_dwordx2 v[40:41], v32, s[8:11], s31 offen sc1
  buffer_store_dwordx2 v[42:43], v33, s[8:11], s31 offen sc1
  buffer_store_dwordx2 v[44:45], v34, s[8:11], s31 offen sc1
  v_rcp_f32 v5, v15
  s_nop 0
  v_mul_f32 v128, v128, v5
  v_mul_f32 v129, v129, v5
  v_mul_f32 v130, v130, v5
  v_mul_f32 v131, v131, v5
  v_mul_f32 v132, v132, v5
  v_mul_f32 v133, v133, v5
  v_mul_f32 v134, v134, v5
  v_mul_f32 v135, v135, v5
  v_mul_f32 v136, v136, v5
  v_mul_f32 v137, v137, v5
  v_mul_f32 v138, v138, v5
  v_mul_f32 v139, v139, v5
  v_cvt_pk_bf16_f32 v48, v128, v129
  v_cvt_pk_bf16_f32 v49, v130, v131
  v_cvt_pk_bf16_f32 v50, v132, v133
  v_cvt_pk_bf16_f32 v51, v134, v135
  v_cvt_pk_bf16_f32 v52, v136, v137
  v_cvt_pk_bf16_f32 v53, v138, v139
  s_add_u32 s31, s52, 1
  s_mul_i32 s31, s31, 40960
  s_add_u32 s31, s31, 0xf200000
  buffer_store_dwordx2 v[48:49], v32, s[8:11], s31 offen sc1
  buffer_store_dwordx2 v[50:51], v33, s[8:11], s31 offen sc1
  buffer_store_dwordx2 v[52:53], v34, s[8:11], s31 offen sc1
  s_waitcnt vmcnt(0)
  s_barrier
  s_cmp_eq_u32 s21, 0
  s_cbranch_scc0 arr_109
  s_mov_b64 s[24:25], exec
  s_mov_b64 exec, 1
  v_mov_b32 v3, 0
  v_mov_b32 v4, 1
  buffer_atomic_add v4, v3, s[8:11], s48 offen
  s_mov_b64 exec, s[24:25]
arr_109:
  v_and_b32 v5, 15, v1
  v_lshrrev_b32 v6, 4, v1
  v_and_b32 v7, 1, v6
  v_lshlrev_b32 v7, 10, v7
  v_lshrrev_b32 v8, 1, v6
  v_lshlrev_b32 v8, 5, v8
  v_add_u32 v8, v8, v5
  v_lshlrev_b32 v8, 4, v8
  v_add_u32 v9, v7, v8
  s_lshr_b32 s26, s2, 2
  s_mul_i32 s27, s26, 81920
  s_lshl_b32 s28, s50, 11
  s_add_u32 s27, s27, s28
  s_add_u32 s27, s27, 0x1400000
  s_add_u32 s28, s27, 0
  buffer_load_dwordx4 v[16:19], v9, s[8:11], s28 offen sc1
  s_add_u32 s28, s27, 256
  buffer_load_dwordx4 v[20:23], v9, s[8:11], s28 offen sc1
  s_add_u32 s28, s27, 2048
  buffer_load_dwordx4 v[24:27], v9, s[8:11], s28 offen sc1
  s_add_u32 s28, s27, 2304
  buffer_load_dwordx4 v[28:31], v9, s[8:11], s28 offen sc1
  s_cmp_lt_u32 s21, 2
  s_cbranch_scc0 g3_110
  s_add_u32 s28, s27, 4096
  buffer_load_dwordx4 v[32:35], v9, s[8:11], s28 offen sc1
  s_add_u32 s28, s27, 4352
  buffer_load_dwordx4 v[36:39], v9, s[8:11], s28 offen sc1
g3_110:
  s_mov_b32 s45, 0
  v_mov_b32 v3, 0
aw_111:
  buffer_load_dword v4, v3, s[8:11], s48 offen sc1
  s_add_u32 s45, s45, 1
  s_waitcnt vmcnt(0)
  v_readfirstlane_b32 s29, v4
  s_cmp_ge_u32 s29, 32
  s_cbranch_scc1 aw_111_ok
  s_cmp_lt_u32 s45, 400000
  s_cbranch_scc1 aw_111
  s_branch kb2_abort
aw_111_ok:
  s_mul_i32 s28, s26, 40960
  s_mul_i32 s31, s21, 10240
  s_add_u32 s28, s28, s31
  s_add_u32 s28, s28, 0xf200000
  s_add_u32 m0, s31, 0
  s_add_u32 s29, s28, 0
  buffer_load_dwordx4 v2, s[8:11], s29 offen sc1 lds
  s_add_u32 m0, s31, 1024
  s_add_u32 s29, s28, 1024
  buffer_load_dwordx4 v2, s[8:11], s29 offen sc1 lds
  s_add_u32 m0, s31, 2048
  s_add_u32 s29, s28, 2048
  buffer_load_dwordx4 v2, s[8:11], s29 offen sc1 lds
  s_add_u32 m0, s31, 3072
  s_add_u32 s29, s28, 3072
  buffer_load_dwordx4 v2, s[8:11], s29 offen sc1 lds
  s_add_u32 m0, s31, 4096
  s_add_u32 s29, s28, 4096
  buffer_load_dwordx4 v2, s[8:11], s29 offen sc1 lds
  s_add_u32 m0, s31, 5120
  s_add_u32 s29, s28, 5120
  buffer_load_dwordx4 v2, s[8:11], s29 offen sc1 lds
  s_add_u32 m0, s31, 6144
  s_add_u32 s29, s28, 6144
  buffer_load_dwordx4 v2, s[8:11], s29 offen sc1 lds
  s_add_u32 m0, s31, 7168
  s_add_u32 s29, s28, 7168
  buffer_load_dwordx4 v2, s[8:11], s29 offen sc1 lds
  s_add_u32 m0, s31, 8192
  s_add_u32 s29, s28, 8192
  buffer_load_dwordx4 v2, s[8:11], s29 offen sc1 lds
  s_add_u32 m0, s31, 9216
  s_add_u32 s29, s28, 9216
  buffer_load_dwordx4 v2, s[8:11], s29 offen sc1 lds
  s_waitcnt vmcnt(0)
  s_barrier
  ds_read_b128 v[80:83], v2 offset:0
  ds_read_b128 v[84:87], v2 offset:20480
  ds_read_b128 v[88:91], v2 offset:1024
  ds_read_b128 v[92:95], v2 offset:21504
  ds_read_b128 v[96:99], v2 offset:2048
  ds_read_b128 v[100:103], v2 offset:22528
  s_waitcnt lgkmcnt(4)
  v_mfma_f32_16x16x32_bf16 v[48:51], a[0:3], v[80:83], 0
  v_mfma_f32_16x16x32_bf16 v[52:55], a[0:3], v[84:87], 0
  v_mfma_f32_16x16x32_bf16 v[56:59], a[80:83], v[80:83], 0
  v_mfma_f32_16x16x32_bf16 v[60:63], a[80:83], v[84:87], 0
  v_mfma_f32_16x16x32_bf16 v[64:67], a[160:163], v[80:83], 0
  v_mfma_f32_16x16x32_bf16 v[68:71], a[160:163], v[84:87], 0
  ds_read_b128 v[80:83], v2 offset:3072
  ds_read_b128 v[84:87], v2 offset:23552
  s_waitcnt lgkmcnt(4)
  v_mfma_f32_16x16x32_bf16 v[48:51], a[4:7], v[88:91], v[48:51]
  v_mfma_f32_16x16x32_bf16 v[52:55], a[4:7], v[92:95], v[52:55]
  v_mfma_f32_16x16x32_bf16 v[56:59], a[84:87], v[88:91], v[56:59]
  v_mfma_f32_16x16x32_bf16 v[60:63], a[84:87], v[92:95], v[60:63]
  v_mfma_f32_16x16x32_bf16 v[64:67], a[164:167], v[88:91], v[64:67]
  v_mfma_f32_16x16x32_bf16 v[68:71], a[164:167], v[92:95], v[68:71]
  ds_read_b128 v[88:91], v2 offset:4096
  ds_read_b128 v[92:95], v2 offset:24576
  s_waitcnt lgkmcnt(4)
  v_mfma_f32_16x16x32_bf16 v[48:51], a[8:11], v[96:99], v[48:51]
  v_mfma_f32_16x16x32_bf16 v[52:55], a[8:11], v[100:103], v[52:55]
  v_mfma_f32_16x16x32_bf16 v[56:59], a[88:91], v[96:99], v[56:59]
  v_mfma_f32_16x16x32_bf16 v[60:63], a[88:91], v[100:103], v[60:63]
  v_mfma_f32_16x16x32_bf16 v[64:67], a[168:171], v[96:99], v[64:67]
  v_mfma_f32_16x16x32_bf16 v[68:71], a[168:171], v[100:103], v[68:71]
  ds_read_b128 v[96:99], v2 offset:5120
  ds_read_b128 v[100:103], v2 offset:25600
  s_waitcnt lgkmcnt(4)
  v_mfma_f32_16x16x32_bf16 v[48:51], a[12:15], v[80:83], v[48:51]
  v_mfma_f32_16x16x32_bf16 v[52:55], a[12:15], v[84:87], v[52:55]
  v_mfma_f32_16x16x32_bf16 v[56:59], a[92:95], v[80:83], v[56:59]
  v_mfma_f32_16x16x32_bf16 v[60:63], a[92:95], v[84:87], v[60:63]
  v_mfma_f32_16x16x32_bf16 v[64:67], a[172:175], v[80:83], v[64:67]
  v_mfma_f32_16x16x32_bf16 v[68:71], a[172:175], v[84:87], v[68:71]
  ds_read_b128 v[80:83], v2 offset:6144
  ds_read_b128 v[84:87], v2 offset:26624
  s_waitcnt lgkmcnt(4)
  v_mfma_f32_16x16x32_bf16 v[48:51], a[16:19], v[88:91], v[48:51]
  v_mfma_f32_16x16x32_bf16 v[52:55], a[16:19], v[92:95], v[52:55]
  v_mfma_f32_16x16x32_bf16 v[56:59], a[96:99], v[88:91], v[56:59]
  v_mfma_f32_16x16x32_bf16 v[60:63], a[96:99], v[92:95], v[60:63]
  v_mfma_f32_16x16x32_bf16 v[64:67], a[176:179], v[88:91], v[64:67]
  v_mfma_f32_16x16x32_bf16 v[68:71], a[176:179], v[92:95], v[68:71]
  ds_read_b128 v[88:91], v2 offset:7168
  ds_read_b128 v[92:95], v2 offset:27648
  s_waitcnt lgkmcnt(4)
  v_mfma_f32_16x16x32_bf16 v[48:51], a[20:23], v[96:99], v[48:51]
  v_mfma_f32_16x16x32_bf16 v[52:55], a[20:23], v[100:103], v[52:55]
  v_mfma_f32_16x16x32_bf16 v[56:59], a[100:103], v[96:99], v[56:59]
  v_mfma_f32_16x16x32_bf16 v[60:63], a[100:103], v[100:103], v[60:63]
  v_mfma_f32_16x16x32_bf16 v[64:67], a[180:183], v[96:99], v[64:67]
  v_mfma_f32_16x16x32_bf16 v[68:71], a[180:183], v[100:103], v[68:71]
  ds_read_b128 v[96:99], v2 offset:8192
  ds_read_b128 v[100:103], v2 offset:28672
  s_waitcnt lgkmcnt(4)
  v_mfma_f32_16x16x32_bf16 v[48:51], a[24:27], v[80:83], v[48:51]
  v_mfma_f32_16x16x32_bf16 v[52:55], a[24:27], v[84:87], v[52:55]
  v_mfma_f32_16x16x32_bf16 v[56:59], a[104:107], v[80:83], v[56:59]
  v_mfma_f32_16x16x32_bf16 v[60:63], a[104:107], v[84:87], v[60:63]
  v_mfma_f32_16x16x32_bf16 v[64:67], a[184:187], v[80:83], v[64:67]
  v_mfma_f32_16x16x32_bf16 v[68:71], a[184:187], v[84:87], v[68:71]
  ds_read_b128 v[80:83], v2 offset:9216
  ds_read_b128 v[84:87], v2 offset:29696
  s_waitcnt lgkmcnt(4)
  v_mfma_f32_16x16x32_bf16 v[48:51], a[28:31], v[88:91], v[48:51]
  v_mfma_f32_16x16x32_bf16 v[52:55], a[28:31], v[92:95], v[52:55]
  v_mfma_f32_16x16x32_bf16 v[56:59], a[108:111], v[88:91], v[56:59]
  v_mfma_f32_16x16x32_bf16 v[60:63], a[108:111], v[92:95], v[60:63]
  v_mfma_f32_16x16x32_bf16 v[64:67], a[188:191], v[88:91], v[64:67]
  v_mfma_f32_16x16x32_bf16 v[68:71], a[188:191], v[92:95], v[68:71]
  ds_read_b128 v[88:91], v2 offset:10240
  ds_read_b128 v[92:95], v2 offset:30720
  s_waitcnt lgkmcnt(4)
  v_mfma_f32_16x16x32_bf16 v[48:51], a[32:35], v[96:99], v[48:51]
  v_mfma_f32_16x16x32_bf16 v[52:55], a[32:35], v[100:103], v[52:55]
  v_mfma_f32_16x16x32_bf16 v[56:59], a[112:115], v[96:99], v[56:59]
  v_mfma_f32_16x16x32_bf16 v[60:63], a[112:115], v[100:103], v[60:63]
  v_mfma_f32_16x16x32_bf16 v[64:67], a[192:195], v[96:99], v[64:67]
  v_mfma_f32_16x16x32_bf16 v[68:71], a[192:195], v[100:103], v[68:71]
  ds_read_b128 v[96:99], v2 offset:11264
  ds_read_b128 v[100:103], v2 offset:31744
  s_waitcnt lgkmcnt(4)
  v_mfma_f32_16x16x32_bf16 v[48:51], a[36:39], v[80:83], v[48:51]
  v_mfma_f32_16x16x32_bf16 v[52:55], a[36:39], v[84:87], v[52:55]
  v_mfma_f32_16x16x32_bf16 v[56:59], a[116:119], v[80:83], v[56:59]
  v_mfma_f32_16x16x32_bf16 v[60:63], a[116:119], v[84:87], v[60:63]
  v_mfma_f32_16x16x32_bf16 v[64:67], a[196:199], v[80:83], v[64:67]
  v_mfma_f32_16x16x32_bf16 v[68:71], a[196:199], v[84:87], v[68:71]
  ds_read_b128 v[80:83], v2 offset:12288
  ds_read_b128 v[84:87], v2 offset:32768
  s_waitcnt lgkmcnt(4)
  v_mfma_f32_16x16x32_bf16 v[48:51], a[40:43], v[88:91], v[48:51]
  v_mfma_f32_16x16x32_bf16 v[52:55], a[40:43], v[92:95], v[52:55]
  v_mfma_f32_16x16x32_bf16 v[56:59], a[120:123], v[88:91], v[56:59]
  v_mfma_f32_16x16x32_bf16 v[60:63], a[120:123], v[92:95], v[60:63]
  v_mfma_f32_16x16x32_bf16 v[64:67], a[200:203], v[88:91], v[64:67]
  v_mfma_f32_16x16x32_bf16 v[68:71], a[200:203], v[92:95], v[68:71]
  ds_read_b128 v[88:91], v2 offset:13312
  ds_read_b128 v[92:95], v2 offset:33792
  s_waitcnt lgkmcnt(4)
  v_mfma_f32_16x16x32_bf16 v[48:51], a[44:47], v[96:99], v[48:51]
  v_mfma_f32_16x16x32_bf16 v[52:55], a[44:47], v[100:103], v[52:55]
  v_mfma_f32_16x16x32_bf16 v[56:59], a[124:127], v[96:99], v[56:59]
  v_mfma_f32_16x16x32_bf16 v[60:63], a[124:127], v[100:103], v[60:63]
  v_mfma_f32_16x16x32_bf16 v[64:67], a[204:207], v[96:99], v[64:67]
  v_mfma_f32_16x16x32_bf16 v[68:71], a[204:207], v[100:103], v[68:71]
  ds_read_b128 v[96:99], v2 offset:14336
  ds_read_b128 v[100:103], v2 offset:34816
  s_waitcnt lgkmcnt(4)
  v_mfma_f32_16x16x32_bf16 v[48:51], a[48:51], v[80:83], v[48:51]
  v_mfma_f32_16x16x32_bf16 v[52:55], a[48:51], v[84:87], v[52:55]
  v_mfma_f32_16x16x32_bf16 v[56:59], a[128:131], v[80:83], v[56:59]
  v_mfma_f32_16x16x32_bf16 v[60:63], a[128:131], v[84:87], v[60:63]
  v_mfma_f32_16x16x32_bf16 v[64:67], a[208:211], v[80:83], v[64:67]
  v_mfma_f32_16x16x32_bf16 v[68:71], a[208:211], v[84:87], v[68:71]
  ds_read_b128 v[80:83], v2 offset:15360
  ds_read_b128 v[84:87], v2 offset:35840
  s_waitcnt lgkmcnt(4)
  v_mfma_f32_16x16x32_bf16 v[48:51], a[52:55], v[88:91], v[48:51]
  v_mfma_f32_16x16x32_bf16 v[52:55], a[52:55], v[92:95], v[52:55]
  v_mfma_f32_16x16x32_bf16 v[56:59], a[132:135], v[88:91], v[56:59]
  v_mfma_f32_16x16x32_bf16 v[60:63], a[132:135], v[92:95], v[60:63]
  v_mfma_f32_16x16x32_bf16 v[64:67], a[212:215], v[88:91], v[64:67]
  v_mfma_f32_16x16x32_bf16 v[68:71], a[212:215], v[92:95], v[68:71]
  ds_read_b128 v[88:91], v2 offset:16384
  ds_read_b128 v[92:95], v2 offset:36864
  s_waitcnt lgkmcnt(4)
  v_mfma_f32_16x16x32_bf16 v[48:51], a[56:59], v[96:99], v[48:51]
  v_mfma_f32_16x16x32_bf16 v[52:55], a[56:59], v[100:103], v[52:55]
  v_mfma_f32_16x16x32_bf16 v[56:59], a[136:139], v[96:99], v[56:59]
  v_mfma_f32_16x16x32_bf16 v[60:63], a[136:139], v[100:103], v[60:63]
  v_mfma_f32_16x16x32_bf16 v[64:67], a[216:219], v[96:99], v[64:67]
  v_mfma_f32_16x16x32_bf16 v[68:71], a[216:219], v[100:103], v[68:71]
  ds_read_b128 v[96:99], v2 offset:17408
  ds_read_b128 v[100:103], v2 offset:37888
  s_waitcnt lgkmcnt(4)
  v_mfma_f32_16x16x32_bf16 v[48:51], a[60:63], v[80:83], v[48:51]
  v_mfma_f32_16x16x32_bf16 v[52:55], a[60:63], v[84:87], v[52:55]
  v_mfma_f32_16x16x32_bf16 v[56:59], a[140:143], v[80:83], v[56:59]
  v_mfma_f32_16x16x32_bf16 v[60:63], a[140:143], v[84:87], v[60:63]
  v_mfma_f32_16x16x32_bf16 v[64:67], a[220:223], v[80:83], v[64:67]
  v_mfma_f32_16x16x32_bf16 v[68:71], a[220:223], v[84:87], v[68:71]
  ds_read_b128 v[80:83], v2 offset:18432
  ds_read_b128 v[84:87], v2 offset:38912
  s_waitcnt lgkmcnt(4)
  v_mfma_f32_16x16x32_bf16 v[48:51], a[64:67], v[88:91], v[48:51]
  v_mfma_f32_16x16x32_bf16 v[52:55], a[64:67], v[92:95], v[52:55]
  v_mfma_f32_16x16x32_bf16 v[56:59], a[144:147], v[88:91], v[56:59]
  v_mfma_f32_16x16x32_bf16 v[60:63], a[144:147], v[92:95], v[60:63]
  v_mfma_f32_16x16x32_bf16 v[64:67], a[224:227], v[88:91], v[64:67]
  v_mfma_f32_16x16x32_bf16 v[68:71], a[224:227], v[92:95], v[68:71]
  ds_read_b128 v[88:91], v2 offset:19456
  ds_read_b128 v[92:95], v2 offset:39936
  s_waitcnt lgkmcnt(4)
  v_mfma_f32_16x16x32_bf16 v[48:51], a[68:71], v[96:99], v[48:51]
  v_mfma_f32_16x16x32_bf16 v[52:55], a[68:71], v[100:103], v[52:55]
  v_mfma_f32_16x16x32_bf16 v[56:59], a[148:151], v[96:99], v[56:59]
  v_mfma_f32_16x16x32_bf16 v[60:63], a[148:151], v[100:103], v[60:63]
  v_mfma_f32_16x16x32_bf16 v[64:67], a[228:231], v[96:99], v[64:67]
  v_mfma_f32_16x16x32_bf16 v[68:71], a[228:231], v[100:103], v[68:71]
  s_waitcnt lgkmcnt(2)
  v_mfma_f32_16x16x32_bf16 v[48:51], a[72:75], v[80:83], v[48:51]
  v_mfma_f32_16x16x32_bf16 v[52:55], a[72:75], v[84:87], v[52:55]
  v_mfma_f32_16x16x32_bf16 v[56:59], a[152:155], v[80:83], v[56:59]
  v_mfma_f32_16x16x32_bf16 v[60:63], a[152:155], v[84:87], v[60:63]
  v_mfma_f32_16x16x32_bf16 v[64:67], a[232:235], v[80:83], v[64:67]
  v_mfma_f32_16x16x32_bf16 v[68:71], a[232:235], v[84:87], v[68:71]
  s_waitcnt lgkmcnt(0)
  v_mfma_f32_16x16x32_bf16 v[48:51], a[76:79], v[88:91], v[48:51]
  v_mfma_f32_16x16x32_bf16 v[52:55], a[76:79], v[92:95], v[52:55]
  v_mfma_f32_16x16x32_bf16 v[56:59], a[156:159], v[88:91], v[56:59]
  v_mfma_f32_16x16x32_bf16 v[60:63], a[156:159], v[92:95], v[60:63]
  v_mfma_f32_16x16x32_bf16 v[64:67], a[236:239], v[88:91], v[64:67]
  v_mfma_f32_16x16x32_bf16 v[68:71], a[236:239], v[92:95], v[68:71]
  s_nop 7
  v_mul_u32_u24 v10, 1280, v5
  v_lshlrev_b32 v11, 3, v6
  v_add_u32 v10, v10, v11
  s_mul_i32 s30, s26, 40960
  s_lshl_b32 s31, s50, 5
  s_add_u32 s30, s30, s31
  v_add_f32 v48, v48, v16
  v_add_f32 v49, v49, v17
  v_add_f32 v50, v50, v18
  v_add_f32 v51, v51, v19
  v_cvt_pk_bf16_f32 v48, v48, v49
  v_cvt_pk_bf16_f32 v49, v50, v51
  s_add_u32 s28, s30, 0
  buffer_store_dwordx2 v[48:49], v10, s[16:19], s28 offen
  v_add_f32 v52, v52, v20
  v_add_f32 v53, v53, v21
  v_add_f32 v54, v54, v22
  v_add_f32 v55, v55, v23
  v_cvt_pk_bf16_f32 v52, v52, v53
  v_cvt_pk_bf16_f32 v53, v54, v55
  s_add_u32 s28, s30, 20480
  buffer_store_dwordx2 v[52:53], v10, s[16:19], s28 offen
  v_add_f32 v56, v56, v24
  v_add_f32 v57, v57, v25
  v_add_f32 v58, v58, v26
  v_add_f32 v59, v59, v27
  v_cvt_pk_bf16_f32 v56, v56, v57
  v_cvt_pk_bf16_f32 v57, v58, v59
  s_add_u32 s28, s30, 32
  buffer_store_dwordx2 v[56:57], v10, s[16:19], s28 offen
  v_add_f32 v60, v60, v28
  v_add_f32 v61, v61, v29
  v_add_f32 v62, v62, v30
  v_add_f32 v63, v63, v31
  v_cvt_pk_bf16_f32 v60, v60, v61
  v_cvt_pk_bf16_f32 v61, v62, v63
  s_add_u32 s28, s30, 20512
  buffer_store_dwordx2 v[60:61], v10, s[16:19], s28 offen
  s_cmp_lt_u32 s21, 2
  s_cbranch_scc0 g3_112
  v_add_f32 v64, v64, v32
  v_add_f32 v65, v65, v33
  v_add_f32 v66, v66, v34
  v_add_f32 v67, v67, v35
  v_cvt_pk_bf16_f32 v64, v64, v65
  v_cvt_pk_bf16_f32 v65, v66, v67
  s_add_u32 s28, s30, 64
  buffer_store_dwordx2 v[64:65], v10, s[16:19], s28 offen
  v_add_f32 v68, v68, v36
  v_add_f32 v69, v69, v37
  v_add_f32 v70, v70, v38
  v_add_f32 v71, v71, v39
  v_cvt_pk_bf16_f32 v68, v68, v69
  v_cvt_pk_bf16_f32 v69, v70, v71
  s_add_u32 s28, s30, 20544
  buffer_store_dwordx2 v[68:69], v10, s[16:19], s28 offen
g3_112:
  s_endpgm
kb2_abort:
  s_load_dwordx2 s[6:7], s[0:1], 88
  v_mov_b32 v2, 80
  v_mov_b32 v3, 1
  s_waitcnt lgkmcnt(0)
  s_mov_b64 exec, 1
  global_atomic_add v2, v3, s[6:7]
  s_waitcnt vmcnt(0)
kb2_exit:
  s_endpgm

.section .rodata,"a"
.p2align 6
.amdhsa_kernel kb2_kernel
  .amdhsa_next_free_vgpr 512
  .amdhsa_next_free_sgpr 102
  .amdhsa_accum_offset 256
  .amdhsa_group_segment_fixed_size 0
  .amdhsa_kernarg_size 104
  .amdhsa_user_sgpr_count 2
  .amdhsa_user_sgpr_kernarg_segment_ptr 1
  .amdhsa_system_sgpr_workgroup_id_x 1
.end_amdhsa_kernel
```

```asm
; @launch kernel=prep_kernel grid=(256,1,1) block=(256,1,1) lds=32768
; @launch kernel=ka1_kernel grid=(256,1,1) block=(256,1,1) lds=163840
; @launch kernel=kb1_kernel grid=(256,1,1) block=(256,1,1) lds=135168
; @launch kernel=ka2_kernel grid=(256,1,1) block=(256,1,1) lds=163840
; @launch kernel=kb2_kernel grid=(256,1,1) block=(256,1,1) lds=135168
.amdgcn_target "amdgcn-amd-amdhsa--gfx950"
.text
.globl prep_kernel
.p2align 8
.type prep_kernel,@function
prep_kernel:
  s_cmp_ge_u32 s2, 256
  s_cbranch_scc1 k0_exit
  s_load_dwordx2 s[38:39], s[0:1], 8
  s_load_dwordx4 s[40:43], s[0:1], 32
  s_load_dwordx4 s[44:47], s[0:1], 16
  s_load_dwordx2 s[4:5], s[0:1], 96
  v_lshrrev_b32 v1, 6, v0
  s_nop 0
  v_readfirstlane_b32 s21, v1
  v_and_b32 v1, 63, v0
  v_lshlrev_b32 v2, 4, v1
  s_waitcnt lgkmcnt(0)
  s_mov_b32 s8, s4
  s_and_b32 s9, s5, 0xffff
  s_mov_b32 s10, 0x10000000
  s_mov_b32 s11, 0x20000
  s_mov_b32 s12, s40
  s_and_b32 s13, s41, 0xffff
  s_mov_b32 s14, 0x780000
  s_mov_b32 s15, 0x20000
  s_mov_b32 s16, s42
  s_and_b32 s17, s43, 0xffff
  s_mov_b32 s18, 0x780000
  s_mov_b32 s19, 0x20000
  v_mov_b32 v208, -1
  v_mov_b32 v209, -1
  v_mov_b32 v210, -1
  v_mov_b32 v211, -1
  s_lshl_b32 s28, s2, 2
  s_add_u32 s28, s28, s21
  s_add_u32 s29, s28, 0
  s_cmp_lt_u32 s29, 2560
  s_cbranch_scc0 f_1
  s_lshl_b32 s29, s29, 10
  s_add_u32 s29, s29, 0x400000
  buffer_store_dwordx4 v[208:211], v2, s[8:11], s29 offen
f_1:
  s_add_u32 s29, s28, 1024
  s_cmp_lt_u32 s29, 2560
  s_cbranch_scc0 f_2
  s_lshl_b32 s29, s29, 10
  s_add_u32 s29, s29, 0x400000
  buffer_store_dwordx4 v[208:211], v2, s[8:11], s29 offen
f_2:
  s_add_u32 s29, s28, 2048
  s_cmp_lt_u32 s29, 2560
  s_cbranch_scc0 f_3
  s_lshl_b32 s29, s29, 10
  s_add_u32 s29, s29, 0x400000
  buffer_store_dwordx4 v[208:211], v2, s[8:11], s29 offen
f_3:
  s_add_u32 s29, s28, 0
  s_cmp_lt_u32 s29, 1280
  s_cbranch_scc0 f_4
  s_lshl_b32 s29, s29, 10
  s_add_u32 s29, s29, 0x700000
  buffer_store_dwordx4 v[208:211], v2, s[8:11], s29 offen
f_4:
  s_add_u32 s29, s28, 1024
  s_cmp_lt_u32 s29, 1280
  s_cbranch_scc0 f_5
  s_lshl_b32 s29, s29, 10
  s_add_u32 s29, s29, 0x700000
  buffer_store_dwordx4 v[208:211], v2, s[8:11], s29 offen
f_5:
  s_add_u32 s29, s28, 0
  s_cmp_lt_u32 s29, 640
  s_cbranch_scc0 f_6
  s_lshl_b32 s29, s29, 10
  s_add_u32 s29, s29, 0xa00000
  buffer_store_dwordx4 v[208:211], v2, s[8:11], s29 offen
f_6:
  s_add_u32 s29, s28, 0
  s_cmp_lt_u32 s29, 5120
  s_cbranch_scc0 f_7
  s_lshl_b32 s29, s29, 10
  s_add_u32 s29, s29, 0xe00000
  buffer_store_dwordx4 v[208:211], v2, s[8:11], s29 offen
f_7:
  s_add_u32 s29, s28, 1024
  s_cmp_lt_u32 s29, 5120
  s_cbranch_scc0 f_8
  s_lshl_b32 s29, s29, 10
  s_add_u32 s29, s29, 0xe00000
  buffer_store_dwordx4 v[208:211], v2, s[8:11], s29 offen
f_8:
  s_add_u32 s29, s28, 2048
  s_cmp_lt_u32 s29, 5120
  s_cbranch_scc0 f_9
  s_lshl_b32 s29, s29, 10
  s_add_u32 s29, s29, 0xe00000
  buffer_store_dwordx4 v[208:211], v2, s[8:11], s29 offen
f_9:
  s_add_u32 s29, s28, 3072
  s_cmp_lt_u32 s29, 5120
  s_cbranch_scc0 f_10
  s_lshl_b32 s29, s29, 10
  s_add_u32 s29, s29, 0xe00000
  buffer_store_dwordx4 v[208:211], v2, s[8:11], s29 offen
f_10:
  s_add_u32 s29, s28, 4096
  s_cmp_lt_u32 s29, 5120
  s_cbranch_scc0 f_11
  s_lshl_b32 s29, s29, 10
  s_add_u32 s29, s29, 0xe00000
  buffer_store_dwordx4 v[208:211], v2, s[8:11], s29 offen
f_11:
  s_and_b32 s22, s2, 7
  s_lshl_b32 s22, s22, 2
  s_lshr_b32 s23, s2, 6
  s_add_u32 s22, s22, s23
  s_bfe_u32 s23, s2, 0x30003
  v_lshrrev_b32 v8, 3, v1
  v_bfe_u32 v9, v1, 1, 2
  v_and_b32 v10, 1, v1
  s_mul_i32 s24, s22, 245760
  s_mul_i32 s25, s23, 160
  s_add_u32 s24, s24, s25
  s_add_u32 s26, s21, 0
  s_cmp_lt_u32 s26, 30
  s_cbranch_scc0 wd_12
  s_lshl_b32 s27, s26, 3
  v_add_u32 v11, s27, v8
  v_mul_u32_u24 v12, 52429, v11
  v_lshrrev_b32 v12, 18, v12
  v_mul_u32_u24 v13, 5, v12
  v_sub_u32 v13, v11, v13
  v_lshlrev_b32 v12, 2, v12
  v_add_u32 v12, v12, v9
  v_mul_u32_u24 v12, 1280, v12
  v_lshlrev_b32 v13, 5, v13
  v_add_u32 v12, v12, v13
  v_lshlrev_b32 v13, 4, v10
  v_add_u32 v12, v12, v13
  s_lshl_b32 m0, s26, 10
  s_nop 0
  buffer_load_dwordx4 v12, s[16:19], s24 offen lds
wd_12:
  s_add_u32 s26, s21, 4
  s_cmp_lt_u32 s26, 30
  s_cbranch_scc0 wd_13
  s_lshl_b32 s27, s26, 3
  v_add_u32 v11, s27, v8
  v_mul_u32_u24 v12, 52429, v11
  v_lshrrev_b32 v12, 18, v12
  v_mul_u32_u24 v13, 5, v12
  v_sub_u32 v13, v11, v13
  v_lshlrev_b32 v12, 2, v12
  v_add_u32 v12, v12, v9
  v_mul_u32_u24 v12, 1280, v12
  v_lshlrev_b32 v13, 5, v13
  v_add_u32 v12, v12, v13
  v_lshlrev_b32 v13, 4, v10
  v_add_u32 v12, v12, v13
  s_lshl_b32 m0, s26, 10
  s_nop 0
  buffer_load_dwordx4 v12, s[16:19], s24 offen lds
wd_13:
  s_add_u32 s26, s21, 8
  s_cmp_lt_u32 s26, 30
  s_cbranch_scc0 wd_14
  s_lshl_b32 s27, s26, 3
  v_add_u32 v11, s27, v8
  v_mul_u32_u24 v12, 52429, v11
  v_lshrrev_b32 v12, 18, v12
  v_mul_u32_u24 v13, 5, v12
  v_sub_u32 v13, v11, v13
  v_lshlrev_b32 v12, 2, v12
  v_add_u32 v12, v12, v9
  v_mul_u32_u24 v12, 1280, v12
  v_lshlrev_b32 v13, 5, v13
  v_add_u32 v12, v12, v13
  v_lshlrev_b32 v13, 4, v10
  v_add_u32 v12, v12, v13
  s_lshl_b32 m0, s26, 10
  s_nop 0
  buffer_load_dwordx4 v12, s[16:19], s24 offen lds
wd_14:
  s_add_u32 s26, s21, 12
  s_cmp_lt_u32 s26, 30
  s_cbranch_scc0 wd_15
  s_lshl_b32 s27, s26, 3
  v_add_u32 v11, s27, v8
  v_mul_u32_u24 v12, 52429, v11
  v_lshrrev_b32 v12, 18, v12
  v_mul_u32_u24 v13, 5, v12
  v_sub_u32 v13, v11, v13
  v_lshlrev_b32 v12, 2, v12
  v_add_u32 v12, v12, v9
  v_mul_u32_u24 v12, 1280, v12
  v_lshlrev_b32 v13, 5, v13
  v_add_u32 v12, v12, v13
  v_lshlrev_b32 v13, 4, v10
  v_add_u32 v12, v12, v13
  s_lshl_b32 m0, s26, 10
  s_nop 0
  buffer_load_dwordx4 v12, s[16:19], s24 offen lds
wd_15:
  s_add_u32 s26, s21, 16
  s_cmp_lt_u32 s26, 30
  s_cbranch_scc0 wd_16
  s_lshl_b32 s27, s26, 3
  v_add_u32 v11, s27, v8
  v_mul_u32_u24 v12, 52429, v11
  v_lshrrev_b32 v12, 18, v12
  v_mul_u32_u24 v13, 5, v12
  v_sub_u32 v13, v11, v13
  v_lshlrev_b32 v12, 2, v12
  v_add_u32 v12, v12, v9
  v_mul_u32_u24 v12, 1280, v12
  v_lshlrev_b32 v13, 5, v13
  v_add_u32 v12, v12, v13
  v_lshlrev_b32 v13, 4, v10
  v_add_u32 v12, v12, v13
  s_lshl_b32 m0, s26, 10
  s_nop 0
  buffer_load_dwordx4 v12, s[16:19], s24 offen lds
wd_16:
  s_add_u32 s26, s21, 20
  s_cmp_lt_u32 s26, 30
  s_cbranch_scc0 wd_17
  s_lshl_b32 s27, s26, 3
  v_add_u32 v11, s27, v8
  v_mul_u32_u24 v12, 52429, v11
  v_lshrrev_b32 v12, 18, v12
  v_mul_u32_u24 v13, 5, v12
  v_sub_u32 v13, v11, v13
  v_lshlrev_b32 v12, 2, v12
  v_add_u32 v12, v12, v9
  v_mul_u32_u24 v12, 1280, v12
  v_lshlrev_b32 v13, 5, v13
  v_add_u32 v12, v12, v13
  v_lshlrev_b32 v13, 4, v10
  v_add_u32 v12, v12, v13
  s_lshl_b32 m0, s26, 10
  s_nop 0
  buffer_load_dwordx4 v12, s[16:19], s24 offen lds
wd_17:
  s_add_u32 s26, s21, 24
  s_cmp_lt_u32 s26, 30
  s_cbranch_scc0 wd_18
  s_lshl_b32 s27, s26, 3
  v_add_u32 v11, s27, v8
  v_mul_u32_u24 v12, 52429, v11
  v_lshrrev_b32 v12, 18, v12
  v_mul_u32_u24 v13, 5, v12
  v_sub_u32 v13, v11, v13
  v_lshlrev_b32 v12, 2, v12
  v_add_u32 v12, v12, v9
  v_mul_u32_u24 v12, 1280, v12
  v_lshlrev_b32 v13, 5, v13
  v_add_u32 v12, v12, v13
  v_lshlrev_b32 v13, 4, v10
  v_add_u32 v12, v12, v13
  s_lshl_b32 m0, s26, 10
  s_nop 0
  buffer_load_dwordx4 v12, s[16:19], s24 offen lds
wd_18:
  s_add_u32 s26, s21, 28
  s_cmp_lt_u32 s26, 30
  s_cbranch_scc0 wd_19
  s_lshl_b32 s27, s26, 3
  v_add_u32 v11, s27, v8
  v_mul_u32_u24 v12, 52429, v11
  v_lshrrev_b32 v12, 18, v12
  v_mul_u32_u24 v13, 5, v12
  v_sub_u32 v13, v11, v13
  v_lshlrev_b32 v12, 2, v12
  v_add_u32 v12, v12, v9
  v_mul_u32_u24 v12, 1280, v12
  v_lshlrev_b32 v13, 5, v13
  v_add_u32 v12, v12, v13
  v_lshlrev_b32 v13, 4, v10
  v_add_u32 v12, v12, v13
  s_lshl_b32 m0, s26, 10
  s_nop 0
  buffer_load_dwordx4 v12, s[16:19], s24 offen lds
wd_19:
  v_and_b32 v8, 15, v1
  v_lshrrev_b32 v9, 2, v8
  v_lshlrev_b32 v9, 3, v9
  v_and_b32 v10, 3, v8
  v_add_u32 v9, v9, v10
  v_mul_u32_u24 v9, 12288, v9
  v_lshrrev_b32 v10, 4, v1
  v_lshlrev_b32 v10, 4, v10
  v_add_u32 v9, v9, v10
  v_add_u32 v10, 49152, v9
  s_mul_i32 s24, s22, 384
  s_mul_i32 s25, s21, 1966080
  s_add_u32 s24, s24, s25
  s_add_u32 s27, s24, 0
  buffer_load_dwordx4 a[120:123], v9, s[12:15], s27 offen offset:0
  buffer_load_dwordx4 a[124:127], v9, s[12:15], s27 offen offset:64
  buffer_load_dwordx4 a[128:131], v9, s[12:15], s27 offen offset:128
  buffer_load_dwordx4 a[132:135], v9, s[12:15], s27 offen offset:192
  buffer_load_dwordx4 a[136:139], v9, s[12:15], s27 offen offset:256
  buffer_load_dwordx4 a[140:143], v9, s[12:15], s27 offen offset:320
  buffer_load_dwordx4 a[144:147], v10, s[12:15], s27 offen offset:0
  buffer_load_dwordx4 a[148:151], v10, s[12:15], s27 offen offset:64
  buffer_load_dwordx4 a[152:155], v10, s[12:15], s27 offen offset:128
  buffer_load_dwordx4 a[156:159], v10, s[12:15], s27 offen offset:192
  buffer_load_dwordx4 a[160:163], v10, s[12:15], s27 offen offset:256
  buffer_load_dwordx4 a[164:167], v10, s[12:15], s27 offen offset:320
  s_add_u32 s27, s24, 393216
  buffer_load_dwordx4 a[168:171], v9, s[12:15], s27 offen offset:0
  buffer_load_dwordx4 a[172:175], v9, s[12:15], s27 offen offset:64
  buffer_load_dwordx4 a[176:179], v9, s[12:15], s27 offen offset:128
  buffer_load_dwordx4 a[180:183], v9, s[12:15], s27 offen offset:192
  buffer_load_dwordx4 a[184:187], v9, s[12:15], s27 offen offset:256
  buffer_load_dwordx4 a[188:191], v9, s[12:15], s27 offen offset:320
  buffer_load_dwordx4 a[192:195], v10, s[12:15], s27 offen offset:0
  buffer_load_dwordx4 a[196:199], v10, s[12:15], s27 offen offset:64
  buffer_load_dwordx4 a[200:203], v10, s[12:15], s27 offen offset:128
  buffer_load_dwordx4 a[204:207], v10, s[12:15], s27 offen offset:192
  buffer_load_dwordx4 a[208:211], v10, s[12:15], s27 offen offset:256
  buffer_load_dwordx4 a[212:215], v10, s[12:15], s27 offen offset:320
  s_add_u32 s27, s24, 786432
  buffer_load_dwordx4 v[64:67], v9, s[12:15], s27 offen offset:0
  buffer_load_dwordx4 v[68:71], v9, s[12:15], s27 offen offset:64
  buffer_load_dwordx4 v[72:75], v9, s[12:15], s27 offen offset:128
  buffer_load_dwordx4 v[76:79], v9, s[12:15], s27 offen offset:192
  buffer_load_dwordx4 v[80:83], v9, s[12:15], s27 offen offset:256
  buffer_load_dwordx4 v[84:87], v9, s[12:15], s27 offen offset:320
  buffer_load_dwordx4 v[88:91], v10, s[12:15], s27 offen offset:0
  buffer_load_dwordx4 v[92:95], v10, s[12:15], s27 offen offset:64
  buffer_load_dwordx4 v[96:99], v10, s[12:15], s27 offen offset:128
  buffer_load_dwordx4 v[100:103], v10, s[12:15], s27 offen offset:192
  buffer_load_dwordx4 v[104:107], v10, s[12:15], s27 offen offset:256
  buffer_load_dwordx4 v[108:111], v10, s[12:15], s27 offen offset:320
  s_mul_i32 s26, s22, 40
  s_mul_i32 s27, s23, 5
  s_add_u32 s26, s26, s27
  s_mul_i32 s26, s26, 20
  s_mul_i32 s27, s21, 5
  s_add_u32 s26, s26, s27
  s_lshl_b32 s26, s26, 10
  s_add_u32 s26, s26, 0x2e00000
  v_lshrrev_b32 v8, 4, v1
  v_mul_u32_u24 v8, 1280, v8
  v_bfe_u32 v11, v1, 2, 2
  v_lshlrev_b32 v11, 5, v11
  v_add_u32 v8, v8, v11
  v_bfe_u32 v11, v1, 1, 1
  v_lshlrev_b32 v11, 4, v11
  v_add_u32 v8, v8, v11
  v_and_b32 v11, 1, v1
  v_lshlrev_b32 v11, 3, v11
  v_add_u32 v8, v8, v11
  s_waitcnt vmcnt(36)
  s_barrier
  ds_read_b64_tr_b16 a[0:1], v8 offset:0
  ds_read_b64_tr_b16 a[2:3], v8 offset:640
  ds_read_b64_tr_b16 a[4:5], v8 offset:128
  ds_read_b64_tr_b16 a[6:7], v8 offset:768
  ds_read_b64_tr_b16 a[8:9], v8 offset:256
  ds_read_b64_tr_b16 a[10:11], v8 offset:896
  ds_read_b64_tr_b16 a[12:13], v8 offset:384
  ds_read_b64_tr_b16 a[14:15], v8 offset:1024
  ds_read_b64_tr_b16 a[16:17], v8 offset:512
  ds_read_b64_tr_b16 a[18:19], v8 offset:1152
  ds_read_b64_tr_b16 a[20:21], v8 offset:5120
  ds_read_b64_tr_b16 a[22:23], v8 offset:5760
  s_waitcnt lgkmcnt(0)
  ds_read_b64_tr_b16 a[24:25], v8 offset:5248
  ds_read_b64_tr_b16 a[26:27], v8 offset:5888
  ds_read_b64_tr_b16 a[28:29], v8 offset:5376
  ds_read_b64_tr_b16 a[30:31], v8 offset:6016
  ds_read_b64_tr_b16 a[32:33], v8 offset:5504
  ds_read_b64_tr_b16 a[34:35], v8 offset:6144
  ds_read_b64_tr_b16 a[36:37], v8 offset:5632
  ds_read_b64_tr_b16 a[38:39], v8 offset:6272
  ds_read_b64_tr_b16 a[40:41], v8 offset:10240
  ds_read_b64_tr_b16 a[42:43], v8 offset:10880
  ds_read_b64_tr_b16 a[44:45], v8 offset:10368
  ds_read_b64_tr_b16 a[46:47], v8 offset:11008
  s_waitcnt lgkmcnt(0)
  ds_read_b64_tr_b16 a[48:49], v8 offset:10496
  ds_read_b64_tr_b16 a[50:51], v8 offset:11136
  ds_read_b64_tr_b16 a[52:53], v8 offset:10624
  ds_read_b64_tr_b16 a[54:55], v8 offset:11264
  ds_read_b64_tr_b16 a[56:57], v8 offset:10752
  ds_read_b64_tr_b16 a[58:59], v8 offset:11392
  ds_read_b64_tr_b16 a[60:61], v8 offset:15360
  ds_read_b64_tr_b16 a[62:63], v8 offset:16000
  ds_read_b64_tr_b16 a[64:65], v8 offset:15488
  ds_read_b64_tr_b16 a[66:67], v8 offset:16128
  ds_read_b64_tr_b16 a[68:69], v8 offset:15616
  ds_read_b64_tr_b16 a[70:71], v8 offset:16256
  s_waitcnt lgkmcnt(0)
  ds_read_b64_tr_b16 a[72:73], v8 offset:15744
  ds_read_b64_tr_b16 a[74:75], v8 offset:16384
  ds_read_b64_tr_b16 a[76:77], v8 offset:15872
  ds_read_b64_tr_b16 a[78:79], v8 offset:16512
  ds_read_b64_tr_b16 a[80:81], v8 offset:20480
  ds_read_b64_tr_b16 a[82:83], v8 offset:21120
  ds_read_b64_tr_b16 a[84:85], v8 offset:20608
  ds_read_b64_tr_b16 a[86:87], v8 offset:21248
  ds_read_b64_tr_b16 a[88:89], v8 offset:20736
  ds_read_b64_tr_b16 a[90:91], v8 offset:21376
  ds_read_b64_tr_b16 a[92:93], v8 offset:20864
  ds_read_b64_tr_b16 a[94:95], v8 offset:21504
  s_waitcnt lgkmcnt(0)
  ds_read_b64_tr_b16 a[96:97], v8 offset:20992
  ds_read_b64_tr_b16 a[98:99], v8 offset:21632
  ds_read_b64_tr_b16 a[100:101], v8 offset:25600
  ds_read_b64_tr_b16 a[102:103], v8 offset:26240
  ds_read_b64_tr_b16 a[104:105], v8 offset:25728
  ds_read_b64_tr_b16 a[106:107], v8 offset:26368
  ds_read_b64_tr_b16 a[108:109], v8 offset:25856
  ds_read_b64_tr_b16 a[110:111], v8 offset:26496
  ds_read_b64_tr_b16 a[112:113], v8 offset:25984
  ds_read_b64_tr_b16 a[114:115], v8 offset:26624
  ds_read_b64_tr_b16 a[116:117], v8 offset:26112
  ds_read_b64_tr_b16 a[118:119], v8 offset:26752
  s_waitcnt lgkmcnt(0)
  s_waitcnt lgkmcnt(0)
  s_add_u32 s27, s24, 1179648
  buffer_load_dwordx4 v[112:115], v9, s[12:15], s27 offen offset:0
  buffer_load_dwordx4 v[116:119], v9, s[12:15], s27 offen offset:64
  buffer_load_dwordx4 v[120:123], v9, s[12:15], s27 offen offset:128
  buffer_load_dwordx4 v[124:127], v9, s[12:15], s27 offen offset:192
  buffer_load_dwordx4 v[128:131], v9, s[12:15], s27 offen offset:256
  buffer_load_dwordx4 v[132:135], v9, s[12:15], s27 offen offset:320
  buffer_load_dwordx4 v[136:139], v10, s[12:15], s27 offen offset:0
  buffer_load_dwordx4 v[140:143], v10, s[12:15], s27 offen offset:64
  buffer_load_dwordx4 v[144:147], v10, s[12:15], s27 offen offset:128
  buffer_load_dwordx4 v[148:151], v10, s[12:15], s27 offen offset:192
  buffer_load_dwordx4 v[152:155], v10, s[12:15], s27 offen offset:256
  buffer_load_dwordx4 v[156:159], v10, s[12:15], s27 offen offset:320
  s_add_u32 s27, s24, 1572864
  buffer_load_dwordx4 v[160:163], v9, s[12:15], s27 offen offset:0
  buffer_load_dwordx4 v[164:167], v9, s[12:15], s27 offen offset:64
  buffer_load_dwordx4 v[168:171], v9, s[12:15], s27 offen offset:128
  buffer_load_dwordx4 v[172:175], v9, s[12:15], s27 offen offset:192
  buffer_load_dwordx4 v[176:179], v9, s[12:15], s27 offen offset:256
  buffer_load_dwordx4 v[180:183], v9, s[12:15], s27 offen offset:320
  buffer_load_dwordx4 v[184:187], v10, s[12:15], s27 offen offset:0
  buffer_load_dwordx4 v[188:191], v10, s[12:15], s27 offen offset:64
  buffer_load_dwordx4 v[192:195], v10, s[12:15], s27 offen offset:128
  buffer_load_dwordx4 v[196:199], v10, s[12:15], s27 offen offset:192
  buffer_load_dwordx4 v[200:203], v10, s[12:15], s27 offen offset:256
  buffer_load_dwordx4 v[204:207], v10, s[12:15], s27 offen offset:320
  s_waitcnt vmcnt(48)
  v_mfma_f32_16x16x32_bf16 v[16:19], a[120:123], a[0:3], 0
  v_mfma_f32_16x16x32_bf16 v[20:23], a[120:123], a[4:7], 0
  v_mfma_f32_16x16x32_bf16 v[24:27], a[120:123], a[8:11], 0
  v_mfma_f32_16x16x32_bf16 v[28:31], a[120:123], a[12:15], 0
  v_mfma_f32_16x16x32_bf16 v[32:35], a[120:123], a[16:19], 0
  v_mfma_f32_16x16x32_bf16 v[36:39], a[144:147], a[0:3], 0
  v_mfma_f32_16x16x32_bf16 v[40:43], a[144:147], a[4:7], 0
  v_mfma_f32_16x16x32_bf16 v[44:47], a[144:147], a[8:11], 0
  v_mfma_f32_16x16x32_bf16 v[48:51], a[144:147], a[12:15], 0
  v_mfma_f32_16x16x32_bf16 v[52:55], a[144:147], a[16:19], 0
  v_mfma_f32_16x16x32_bf16 v[16:19], a[124:127], a[20:23], v[16:19]
  v_mfma_f32_16x16x32_bf16 v[20:23], a[124:127], a[24:27], v[20:23]
  v_mfma_f32_16x16x32_bf16 v[24:27], a[124:127], a[28:31], v[24:27]
  v_mfma_f32_16x16x32_bf16 v[28:31], a[124:127], a[32:35], v[28:31]
  v_mfma_f32_16x16x32_bf16 v[32:35], a[124:127], a[36:39], v[32:35]
  v_mfma_f32_16x16x32_bf16 v[36:39], a[148:151], a[20:23], v[36:39]
  v_mfma_f32_16x16x32_bf16 v[40:43], a[148:151], a[24:27], v[40:43]
  v_mfma_f32_16x16x32_bf16 v[44:47], a[148:151], a[28:31], v[44:47]
  v_mfma_f32_16x16x32_bf16 v[48:51], a[148:151], a[32:35], v[48:51]
  v_mfma_f32_16x16x32_bf16 v[52:55], a[148:151], a[36:39], v[52:55]
  v_mfma_f32_16x16x32_bf16 v[16:19], a[128:131], a[40:43], v[16:19]
  v_mfma_f32_16x16x32_bf16 v[20:23], a[128:131], a[44:47], v[20:23]
  v_mfma_f32_16x16x32_bf16 v[24:27], a[128:131], a[48:51], v[24:27]
  v_mfma_f32_16x16x32_bf16 v[28:31], a[128:131], a[52:55], v[28:31]
  v_mfma_f32_16x16x32_bf16 v[32:35], a[128:131], a[56:59], v[32:35]
  v_mfma_f32_16x16x32_bf16 v[36:39], a[152:155], a[40:43], v[36:39]
  v_mfma_f32_16x16x32_bf16 v[40:43], a[152:155], a[44:47], v[40:43]
  v_mfma_f32_16x16x32_bf16 v[44:47], a[152:155], a[48:51], v[44:47]
  v_mfma_f32_16x16x32_bf16 v[48:51], a[152:155], a[52:55], v[48:51]
  v_mfma_f32_16x16x32_bf16 v[52:55], a[152:155], a[56:59], v[52:55]
  v_mfma_f32_16x16x32_bf16 v[16:19], a[132:135], a[60:63], v[16:19]
  v_mfma_f32_16x16x32_bf16 v[20:23], a[132:135], a[64:67], v[20:23]
  v_mfma_f32_16x16x32_bf16 v[24:27], a[132:135], a[68:71], v[24:27]
  v_mfma_f32_16x16x32_bf16 v[28:31], a[132:135], a[72:75], v[28:31]
  v_mfma_f32_16x16x32_bf16 v[32:35], a[132:135], a[76:79], v[32:35]
  v_mfma_f32_16x16x32_bf16 v[36:39], a[156:159], a[60:63], v[36:39]
  v_mfma_f32_16x16x32_bf16 v[40:43], a[156:159], a[64:67], v[40:43]
  v_mfma_f32_16x16x32_bf16 v[44:47], a[156:159], a[68:71], v[44:47]
  v_mfma_f32_16x16x32_bf16 v[48:51], a[156:159], a[72:75], v[48:51]
  v_mfma_f32_16x16x32_bf16 v[52:55], a[156:159], a[76:79], v[52:55]
  v_mfma_f32_16x16x32_bf16 v[16:19], a[136:139], a[80:83], v[16:19]
  v_mfma_f32_16x16x32_bf16 v[20:23], a[136:139], a[84:87], v[20:23]
  v_mfma_f32_16x16x32_bf16 v[24:27], a[136:139], a[88:91], v[24:27]
  v_mfma_f32_16x16x32_bf16 v[28:31], a[136:139], a[92:95], v[28:31]
  v_mfma_f32_16x16x32_bf16 v[32:35], a[136:139], a[96:99], v[32:35]
  v_mfma_f32_16x16x32_bf16 v[36:39], a[160:163], a[80:83], v[36:39]
  v_mfma_f32_16x16x32_bf16 v[40:43], a[160:163], a[84:87], v[40:43]
  v_mfma_f32_16x16x32_bf16 v[44:47], a[160:163], a[88:91], v[44:47]
  v_mfma_f32_16x16x32_bf16 v[48:51], a[160:163], a[92:95], v[48:51]
  v_mfma_f32_16x16x32_bf16 v[52:55], a[160:163], a[96:99], v[52:55]
  v_mfma_f32_16x16x32_bf16 v[16:19], a[140:143], a[100:103], v[16:19]
  v_mfma_f32_16x16x32_bf16 v[20:23], a[140:143], a[104:107], v[20:23]
  v_mfma_f32_16x16x32_bf16 v[24:27], a[140:143], a[108:111], v[24:27]
  v_mfma_f32_16x16x32_bf16 v[28:31], a[140:143], a[112:115], v[28:31]
  v_mfma_f32_16x16x32_bf16 v[32:35], a[140:143], a[116:119], v[32:35]
  v_mfma_f32_16x16x32_bf16 v[36:39], a[164:167], a[100:103], v[36:39]
  v_mfma_f32_16x16x32_bf16 v[40:43], a[164:167], a[104:107], v[40:43]
  v_mfma_f32_16x16x32_bf16 v[44:47], a[164:167], a[108:111], v[44:47]
  v_mfma_f32_16x16x32_bf16 v[48:51], a[164:167], a[112:115], v[48:51]
  v_mfma_f32_16x16x32_bf16 v[52:55], a[164:167], a[116:119], v[52:55]
  s_nop 7
  v_cvt_pk_bf16_f32 v212, v16, v17
  v_cvt_pk_bf16_f32 v213, v18, v19
  v_cvt_pk_bf16_f32 v214, v36, v37
  v_cvt_pk_bf16_f32 v215, v38, v39
  s_add_u32 s27, s26, 0
  buffer_store_dwordx4 v[212:215], v2, s[8:11], s27 offen
  v_cvt_pk_bf16_f32 v216, v20, v21
  v_cvt_pk_bf16_f32 v217, v22, v23
  v_cvt_pk_bf16_f32 v218, v40, v41
  v_cvt_pk_bf16_f32 v219, v42, v43
  s_add_u32 s27, s26, 20480
  buffer_store_dwordx4 v[216:219], v2, s[8:11], s27 offen
  v_cvt_pk_bf16_f32 v220, v24, v25
  v_cvt_pk_bf16_f32 v221, v26, v27
  v_cvt_pk_bf16_f32 v222, v44, v45
  v_cvt_pk_bf16_f32 v223, v46, v47
  s_add_u32 s27, s26, 40960
  buffer_store_dwordx4 v[220:223], v2, s[8:11], s27 offen
  v_cvt_pk_bf16_f32 v224, v28, v29
  v_cvt_pk_bf16_f32 v225, v30, v31
  v_cvt_pk_bf16_f32 v226, v48, v49
  v_cvt_pk_bf16_f32 v227, v50, v51
  s_add_u32 s27, s26, 61440
  buffer_store_dwordx4 v[224:227], v2, s[8:11], s27 offen
  v_cvt_pk_bf16_f32 v212, v32, v33
  v_cvt_pk_bf16_f32 v213, v34, v35
  v_cvt_pk_bf16_f32 v214, v52, v53
  v_cvt_pk_bf16_f32 v215, v54, v55
  s_add_u32 s27, s26, 81920
  buffer_store_dwordx4 v[212:215], v2, s[8:11], s27 offen
  s_waitcnt vmcnt(41)
  v_mfma_f32_16x16x32_bf16 v[16:19], a[168:171], a[0:3], 0
  v_mfma_f32_16x16x32_bf16 v[20:23], a[168:171], a[4:7], 0
  v_mfma_f32_16x16x32_bf16 v[24:27], a[168:171], a[8:11], 0
  v_mfma_f32_16x16x32_bf16 v[28:31], a[168:171], a[12:15], 0
  v_mfma_f32_16x16x32_bf16 v[32:35], a[168:171], a[16:19], 0
  v_mfma_f32_16x16x32_bf16 v[36:39], a[192:195], a[0:3], 0
  v_mfma_f32_16x16x32_bf16 v[40:43], a[192:195], a[4:7], 0
  v_mfma_f32_16x16x32_bf16 v[44:47], a[192:195], a[8:11], 0
  v_mfma_f32_16x16x32_bf16 v[48:51], a[192:195], a[12:15], 0
  v_mfma_f32_16x16x32_bf16 v[52:55], a[192:195], a[16:19], 0
  v_mfma_f32_16x16x32_bf16 v[16:19], a[172:175], a[20:23], v[16:19]
  v_mfma_f32_16x16x32_bf16 v[20:23], a[172:175], a[24:27], v[20:23]
  v_mfma_f32_16x16x32_bf16 v[24:27], a[172:175], a[28:31], v[24:27]
  v_mfma_f32_16x16x32_bf16 v[28:31], a[172:175], a[32:35], v[28:31]
  v_mfma_f32_16x16x32_bf16 v[32:35], a[172:175], a[36:39], v[32:35]
  v_mfma_f32_16x16x32_bf16 v[36:39], a[196:199], a[20:23], v[36:39]
  v_mfma_f32_16x16x32_bf16 v[40:43], a[196:199], a[24:27], v[40:43]
  v_mfma_f32_16x16x32_bf16 v[44:47], a[196:199], a[28:31], v[44:47]
  v_mfma_f32_16x16x32_bf16 v[48:51], a[196:199], a[32:35], v[48:51]
  v_mfma_f32_16x16x32_bf16 v[52:55], a[196:199], a[36:39], v[52:55]
  v_mfma_f32_16x16x32_bf16 v[16:19], a[176:179], a[40:43], v[16:19]
  v_mfma_f32_16x16x32_bf16 v[20:23], a[176:179], a[44:47], v[20:23]
  v_mfma_f32_16x16x32_bf16 v[24:27], a[176:179], a[48:51], v[24:27]
  v_mfma_f32_16x16x32_bf16 v[28:31], a[176:179], a[52:55], v[28:31]
  v_mfma_f32_16x16x32_bf16 v[32:35], a[176:179], a[56:59], v[32:35]
  v_mfma_f32_16x16x32_bf16 v[36:39], a[200:203], a[40:43], v[36:39]
  v_mfma_f32_16x16x32_bf16 v[40:43], a[200:203], a[44:47], v[40:43]
  v_mfma_f32_16x16x32_bf16 v[44:47], a[200:203], a[48:51], v[44:47]
  v_mfma_f32_16x16x32_bf16 v[48:51], a[200:203], a[52:55], v[48:51]
  v_mfma_f32_16x16x32_bf16 v[52:55], a[200:203], a[56:59], v[52:55]
  v_mfma_f32_16x16x32_bf16 v[16:19], a[180:183], a[60:63], v[16:19]
  v_mfma_f32_16x16x32_bf16 v[20:23], a[180:183], a[64:67], v[20:23]
  v_mfma_f32_16x16x32_bf16 v[24:27], a[180:183], a[68:71], v[24:27]
  v_mfma_f32_16x16x32_bf16 v[28:31], a[180:183], a[72:75], v[28:31]
  v_mfma_f32_16x16x32_bf16 v[32:35], a[180:183], a[76:79], v[32:35]
  v_mfma_f32_16x16x32_bf16 v[36:39], a[204:207], a[60:63], v[36:39]
  v_mfma_f32_16x16x32_bf16 v[40:43], a[204:207], a[64:67], v[40:43]
  v_mfma_f32_16x16x32_bf16 v[44:47], a[204:207], a[68:71], v[44:47]
  v_mfma_f32_16x16x32_bf16 v[48:51], a[204:207], a[72:75], v[48:51]
  v_mfma_f32_16x16x32_bf16 v[52:55], a[204:207], a[76:79], v[52:55]
  v_mfma_f32_16x16x32_bf16 v[16:19], a[184:187], a[80:83], v[16:19]
  v_mfma_f32_16x16x32_bf16 v[20:23], a[184:187], a[84:87], v[20:23]
  v_mfma_f32_16x16x32_bf16 v[24:27], a[184:187], a[88:91], v[24:27]
  v_mfma_f32_16x16x32_bf16 v[28:31], a[184:187], a[92:95], v[28:31]
  v_mfma_f32_16x16x32_bf16 v[32:35], a[184:187], a[96:99], v[32:35]
  v_mfma_f32_16x16x32_bf16 v[36:39], a[208:211], a[80:83], v[36:39]
  v_mfma_f32_16x16x32_bf16 v[40:43], a[208:211], a[84:87], v[40:43]
  v_mfma_f32_16x16x32_bf16 v[44:47], a[208:211], a[88:91], v[44:47]
  v_mfma_f32_16x16x32_bf16 v[48:51], a[208:211], a[92:95], v[48:51]
  v_mfma_f32_16x16x32_bf16 v[52:55], a[208:211], a[96:99], v[52:55]
  v_mfma_f32_16x16x32_bf16 v[16:19], a[188:191], a[100:103], v[16:19]
  v_mfma_f32_16x16x32_bf16 v[20:23], a[188:191], a[104:107], v[20:23]
  v_mfma_f32_16x16x32_bf16 v[24:27], a[188:191], a[108:111], v[24:27]
  v_mfma_f32_16x16x32_bf16 v[28:31], a[188:191], a[112:115], v[28:31]
  v_mfma_f32_16x16x32_bf16 v[32:35], a[188:191], a[116:119], v[32:35]
  v_mfma_f32_16x16x32_bf16 v[36:39], a[212:215], a[100:103], v[36:39]
  v_mfma_f32_16x16x32_bf16 v[40:43], a[212:215], a[104:107], v[40:43]
  v_mfma_f32_16x16x32_bf16 v[44:47], a[212:215], a[108:111], v[44:47]
  v_mfma_f32_16x16x32_bf16 v[48:51], a[212:215], a[112:115], v[48:51]
  v_mfma_f32_16x16x32_bf16 v[52:55], a[212:215], a[116:119], v[52:55]
  s_nop 7
  v_cvt_pk_bf16_f32 v212, v16, v17
  v_cvt_pk_bf16_f32 v213, v18, v19
  v_cvt_pk_bf16_f32 v214, v36, v37
  v_cvt_pk_bf16_f32 v215, v38, v39
  s_add_u32 s27, s26, 1024
  buffer_store_dwordx4 v[212:215], v2, s[8:11], s27 offen
  v_cvt_pk_bf16_f32 v216, v20, v21
  v_cvt_pk_bf16_f32 v217, v22, v23
  v_cvt_pk_bf16_f32 v218, v40, v41
  v_cvt_pk_bf16_f32 v219, v42, v43
  s_add_u32 s27, s26, 21504
  buffer_store_dwordx4 v[216:219], v2, s[8:11], s27 offen
  v_cvt_pk_bf16_f32 v220, v24, v25
  v_cvt_pk_bf16_f32 v221, v26, v27
  v_cvt_pk_bf16_f32 v222, v44, v45
  v_cvt_pk_bf16_f32 v223, v46, v47
  s_add_u32 s27, s26, 41984
  buffer_store_dwordx4 v[220:223], v2, s[8:11], s27 offen
  v_cvt_pk_bf16_f32 v224, v28, v29
  v_cvt_pk_bf16_f32 v225, v30, v31
  v_cvt_pk_bf16_f32 v226, v48, v49
  v_cvt_pk_bf16_f32 v227, v50, v51
  s_add_u32 s27, s26, 62464
  buffer_store_dwordx4 v[224:227], v2, s[8:11], s27 offen
  v_cvt_pk_bf16_f32 v212, v32, v33
  v_cvt_pk_bf16_f32 v213, v34, v35
  v_cvt_pk_bf16_f32 v214, v52, v53
  v_cvt_pk_bf16_f32 v215, v54, v55
  s_add_u32 s27, s26, 82944
  buffer_store_dwordx4 v[212:215], v2, s[8:11], s27 offen
  s_waitcnt vmcnt(34)
  v_mfma_f32_16x16x32_bf16 v[16:19], v[64:67], a[0:3], 0
  v_mfma_f32_16x16x32_bf16 v[20:23], v[64:67], a[4:7], 0
  v_mfma_f32_16x16x32_bf16 v[24:27], v[64:67], a[8:11], 0
  v_mfma_f32_16x16x32_bf16 v[28:31], v[64:67], a[12:15], 0
  v_mfma_f32_16x16x32_bf16 v[32:35], v[64:67], a[16:19], 0
  v_mfma_f32_16x16x32_bf16 v[36:39], v[88:91], a[0:3], 0
  v_mfma_f32_16x16x32_bf16 v[40:43], v[88:91], a[4:7], 0
  v_mfma_f32_16x16x32_bf16 v[44:47], v[88:91], a[8:11], 0
  v_mfma_f32_16x16x32_bf16 v[48:51], v[88:91], a[12:15], 0
  v_mfma_f32_16x16x32_bf16 v[52:55], v[88:91], a[16:19], 0
  v_mfma_f32_16x16x32_bf16 v[16:19], v[68:71], a[20:23], v[16:19]
  v_mfma_f32_16x16x32_bf16 v[20:23], v[68:71], a[24:27], v[20:23]
  v_mfma_f32_16x16x32_bf16 v[24:27], v[68:71], a[28:31], v[24:27]
  v_mfma_f32_16x16x32_bf16 v[28:31], v[68:71], a[32:35], v[28:31]
  v_mfma_f32_16x16x32_bf16 v[32:35], v[68:71], a[36:39], v[32:35]
  v_mfma_f32_16x16x32_bf16 v[36:39], v[92:95], a[20:23], v[36:39]
  v_mfma_f32_16x16x32_bf16 v[40:43], v[92:95], a[24:27], v[40:43]
  v_mfma_f32_16x16x32_bf16 v[44:47], v[92:95], a[28:31], v[44:47]
  v_mfma_f32_16x16x32_bf16 v[48:51], v[92:95], a[32:35], v[48:51]
  v_mfma_f32_16x16x32_bf16 v[52:55], v[92:95], a[36:39], v[52:55]
  v_mfma_f32_16x16x32_bf16 v[16:19], v[72:75], a[40:43], v[16:19]
  v_mfma_f32_16x16x32_bf16 v[20:23], v[72:75], a[44:47], v[20:23]
  v_mfma_f32_16x16x32_bf16 v[24:27], v[72:75], a[48:51], v[24:27]
  v_mfma_f32_16x16x32_bf16 v[28:31], v[72:75], a[52:55], v[28:31]
  v_mfma_f32_16x16x32_bf16 v[32:35], v[72:75], a[56:59], v[32:35]
  v_mfma_f32_16x16x32_bf16 v[36:39], v[96:99], a[40:43], v[36:39]
  v_mfma_f32_16x16x32_bf16 v[40:43], v[96:99], a[44:47], v[40:43]
  v_mfma_f32_16x16x32_bf16 v[44:47], v[96:99], a[48:51], v[44:47]
  v_mfma_f32_16x16x32_bf16 v[48:51], v[96:99], a[52:55], v[48:51]
  v_mfma_f32_16x16x32_bf16 v[52:55], v[96:99], a[56:59], v[52:55]
  v_mfma_f32_16x16x32_bf16 v[16:19], v[76:79], a[60:63], v[16:19]
  v_mfma_f32_16x16x32_bf16 v[20:23], v[76:79], a[64:67], v[20:23]
  v_mfma_f32_16x16x32_bf16 v[24:27], v[76:79], a[68:71], v[24:27]
  v_mfma_f32_16x16x32_bf16 v[28:31], v[76:79], a[72:75], v[28:31]
  v_mfma_f32_16x16x32_bf16 v[32:35], v[76:79], a[76:79], v[32:35]
  v_mfma_f32_16x16x32_bf16 v[36:39], v[100:103], a[60:63], v[36:39]
  v_mfma_f32_16x16x32_bf16 v[40:43], v[100:103], a[64:67], v[40:43]
  v_mfma_f32_16x16x32_bf16 v[44:47], v[100:103], a[68:71], v[44:47]
  v_mfma_f32_16x16x32_bf16 v[48:51], v[100:103], a[72:75], v[48:51]
  v_mfma_f32_16x16x32_bf16 v[52:55], v[100:103], a[76:79], v[52:55]
  v_mfma_f32_16x16x32_bf16 v[16:19], v[80:83], a[80:83], v[16:19]
  v_mfma_f32_16x16x32_bf16 v[20:23], v[80:83], a[84:87], v[20:23]
  v_mfma_f32_16x16x32_bf16 v[24:27], v[80:83], a[88:91], v[24:27]
  v_mfma_f32_16x16x32_bf16 v[28:31], v[80:83], a[92:95], v[28:31]
  v_mfma_f32_16x16x32_bf16 v[32:35], v[80:83], a[96:99], v[32:35]
  v_mfma_f32_16x16x32_bf16 v[36:39], v[104:107], a[80:83], v[36:39]
  v_mfma_f32_16x16x32_bf16 v[40:43], v[104:107], a[84:87], v[40:43]
  v_mfma_f32_16x16x32_bf16 v[44:47], v[104:107], a[88:91], v[44:47]
  v_mfma_f32_16x16x32_bf16 v[48:51], v[104:107], a[92:95], v[48:51]
  v_mfma_f32_16x16x32_bf16 v[52:55], v[104:107], a[96:99], v[52:55]
  v_mfma_f32_16x16x32_bf16 v[16:19], v[84:87], a[100:103], v[16:19]
  v_mfma_f32_16x16x32_bf16 v[20:23], v[84:87], a[104:107], v[20:23]
  v_mfma_f32_16x16x32_bf16 v[24:27], v[84:87], a[108:111], v[24:27]
  v_mfma_f32_16x16x32_bf16 v[28:31], v[84:87], a[112:115], v[28:31]
  v_mfma_f32_16x16x32_bf16 v[32:35], v[84:87], a[116:119], v[32:35]
  v_mfma_f32_16x16x32_bf16 v[36:39], v[108:111], a[100:103], v[36:39]
  v_mfma_f32_16x16x32_bf16 v[40:43], v[108:111], a[104:107], v[40:43]
  v_mfma_f32_16x16x32_bf16 v[44:47], v[108:111], a[108:111], v[44:47]
  v_mfma_f32_16x16x32_bf16 v[48:51], v[108:111], a[112:115], v[48:51]
  v_mfma_f32_16x16x32_bf16 v[52:55], v[108:111], a[116:119], v[52:55]
  s_nop 7
  v_cvt_pk_bf16_f32 v212, v16, v17
  v_cvt_pk_bf16_f32 v213, v18, v19
  v_cvt_pk_bf16_f32 v214, v36, v37
  v_cvt_pk_bf16_f32 v215, v38, v39
  s_add_u32 s27, s26, 2048
  buffer_store_dwordx4 v[212:215], v2, s[8:11], s27 offen
  v_cvt_pk_bf16_f32 v216, v20, v21
  v_cvt_pk_bf16_f32 v217, v22, v23
  v_cvt_pk_bf16_f32 v218, v40, v41
  v_cvt_pk_bf16_f32 v219, v42, v43
  s_add_u32 s27, s26, 22528
  buffer_store_dwordx4 v[216:219], v2, s[8:11], s27 offen
  v_cvt_pk_bf16_f32 v220, v24, v25
  v_cvt_pk_bf16_f32 v221, v26, v27
  v_cvt_pk_bf16_f32 v222, v44, v45
  v_cvt_pk_bf16_f32 v223, v46, v47
  s_add_u32 s27, s26, 43008
  buffer_store_dwordx4 v[220:223], v2, s[8:11], s27 offen
  v_cvt_pk_bf16_f32 v224, v28, v29
  v_cvt_pk_bf16_f32 v225, v30, v31
  v_cvt_pk_bf16_f32 v226, v48, v49
  v_cvt_pk_bf16_f32 v227, v50, v51
  s_add_u32 s27, s26, 63488
  buffer_store_dwordx4 v[224:227], v2, s[8:11], s27 offen
  v_cvt_pk_bf16_f32 v212, v32, v33
  v_cvt_pk_bf16_f32 v213, v34, v35
  v_cvt_pk_bf16_f32 v214, v52, v53
  v_cvt_pk_bf16_f32 v215, v54, v55
  s_add_u32 s27, s26, 83968
  buffer_store_dwordx4 v[212:215], v2, s[8:11], s27 offen
  s_waitcnt vmcnt(27)
  v_mfma_f32_16x16x32_bf16 v[16:19], v[112:115], a[0:3], 0
  v_mfma_f32_16x16x32_bf16 v[20:23], v[112:115], a[4:7], 0
  v_mfma_f32_16x16x32_bf16 v[24:27], v[112:115], a[8:11], 0
  v_mfma_f32_16x16x32_bf16 v[28:31], v[112:115], a[12:15], 0
  v_mfma_f32_16x16x32_bf16 v[32:35], v[112:115], a[16:19], 0
  v_mfma_f32_16x16x32_bf16 v[36:39], v[136:139], a[0:3], 0
  v_mfma_f32_16x16x32_bf16 v[40:43], v[136:139], a[4:7], 0
  v_mfma_f32_16x16x32_bf16 v[44:47], v[136:139], a[8:11], 0
  v_mfma_f32_16x16x32_bf16 v[48:51], v[136:139], a[12:15], 0
  v_mfma_f32_16x16x32_bf16 v[52:55], v[136:139], a[16:19], 0
  v_mfma_f32_16x16x32_bf16 v[16:19], v[116:119], a[20:23], v[16:19]
  v_mfma_f32_16x16x32_bf16 v[20:23], v[116:119], a[24:27], v[20:23]
  v_mfma_f32_16x16x32_bf16 v[24:27], v[116:119], a[28:31], v[24:27]
  v_mfma_f32_16x16x32_bf16 v[28:31], v[116:119], a[32:35], v[28:31]
  v_mfma_f32_16x16x32_bf16 v[32:35], v[116:119], a[36:39], v[32:35]
  v_mfma_f32_16x16x32_bf16 v[36:39], v[140:143], a[20:23], v[36:39]
  v_mfma_f32_16x16x32_bf16 v[40:43], v[140:143], a[24:27], v[40:43]
  v_mfma_f32_16x16x32_bf16 v[44:47], v[140:143], a[28:31], v[44:47]
  v_mfma_f32_16x16x32_bf16 v[48:51], v[140:143], a[32:35], v[48:51]
  v_mfma_f32_16x16x32_bf16 v[52:55], v[140:143], a[36:39], v[52:55]
  v_mfma_f32_16x16x32_bf16 v[16:19], v[120:123], a[40:43], v[16:19]
  v_mfma_f32_16x16x32_bf16 v[20:23], v[120:123], a[44:47], v[20:23]
  v_mfma_f32_16x16x32_bf16 v[24:27], v[120:123], a[48:51], v[24:27]
  v_mfma_f32_16x16x32_bf16 v[28:31], v[120:123], a[52:55], v[28:31]
  v_mfma_f32_16x16x32_bf16 v[32:35], v[120:123], a[56:59], v[32:35]
  v_mfma_f32_16x16x32_bf16 v[36:39], v[144:147], a[40:43], v[36:39]
  v_mfma_f32_16x16x32_bf16 v[40:43], v[144:147], a[44:47], v[40:43]
  v_mfma_f32_16x16x32_bf16 v[44:47], v[144:147], a[48:51], v[44:47]
  v_mfma_f32_16x16x32_bf16 v[48:51], v[144:147], a[52:55], v[48:51]
  v_mfma_f32_16x16x32_bf16 v[52:55], v[144:147], a[56:59], v[52:55]
  v_mfma_f32_16x16x32_bf16 v[16:19], v[124:127], a[60:63], v[16:19]
  v_mfma_f32_16x16x32_bf16 v[20:23], v[124:127], a[64:67], v[20:23]
  v_mfma_f32_16x16x32_bf16 v[24:27], v[124:127], a[68:71], v[24:27]
  v_mfma_f32_16x16x32_bf16 v[28:31], v[124:127], a[72:75], v[28:31]
  v_mfma_f32_16x16x32_bf16 v[32:35], v[124:127], a[76:79], v[32:35]
  v_mfma_f32_16x16x32_bf16 v[36:39], v[148:151], a[60:63], v[36:39]
  v_mfma_f32_16x16x32_bf16 v[40:43], v[148:151], a[64:67], v[40:43]
  v_mfma_f32_16x16x32_bf16 v[44:47], v[148:151], a[68:71], v[44:47]
  v_mfma_f32_16x16x32_bf16 v[48:51], v[148:151], a[72:75], v[48:51]
  v_mfma_f32_16x16x32_bf16 v[52:55], v[148:151], a[76:79], v[52:55]
  v_mfma_f32_16x16x32_bf16 v[16:19], v[128:131], a[80:83], v[16:19]
  v_mfma_f32_16x16x32_bf16 v[20:23], v[128:131], a[84:87], v[20:23]
  v_mfma_f32_16x16x32_bf16 v[24:27], v[128:131], a[88:91], v[24:27]
  v_mfma_f32_16x16x32_bf16 v[28:31], v[128:131], a[92:95], v[28:31]
  v_mfma_f32_16x16x32_bf16 v[32:35], v[128:131], a[96:99], v[32:35]
  v_mfma_f32_16x16x32_bf16 v[36:39], v[152:155], a[80:83], v[36:39]
  v_mfma_f32_16x16x32_bf16 v[40:43], v[152:155], a[84:87], v[40:43]
  v_mfma_f32_16x16x32_bf16 v[44:47], v[152:155], a[88:91], v[44:47]
  v_mfma_f32_16x16x32_bf16 v[48:51], v[152:155], a[92:95], v[48:51]
  v_mfma_f32_16x16x32_bf16 v[52:55], v[152:155], a[96:99], v[52:55]
  v_mfma_f32_16x16x32_bf16 v[16:19], v[132:135], a[100:103], v[16:19]
  v_mfma_f32_16x16x32_bf16 v[20:23], v[132:135], a[104:107], v[20:23]
  v_mfma_f32_16x16x32_bf16 v[24:27], v[132:135], a[108:111], v[24:27]
  v_mfma_f32_16x16x32_bf16 v[28:31], v[132:135], a[112:115], v[28:31]
  v_mfma_f32_16x16x32_bf16 v[32:35], v[132:135], a[116:119], v[32:35]
  v_mfma_f32_16x16x32_bf16 v[36:39], v[156:159], a[100:103], v[36:39]
  v_mfma_f32_16x16x32_bf16 v[40:43], v[156:159], a[104:107], v[40:43]
  v_mfma_f32_16x16x32_bf16 v[44:47], v[156:159], a[108:111], v[44:47]
  v_mfma_f32_16x16x32_bf16 v[48:51], v[156:159], a[112:115], v[48:51]
  v_mfma_f32_16x16x32_bf16 v[52:55], v[156:159], a[116:119], v[52:55]
  s_nop 7
  v_cvt_pk_bf16_f32 v212, v16, v17
  v_cvt_pk_bf16_f32 v213, v18, v19
  v_cvt_pk_bf16_f32 v214, v36, v37
  v_cvt_pk_bf16_f32 v215, v38, v39
  s_add_u32 s27, s26, 3072
  buffer_store_dwordx4 v[212:215], v2, s[8:11], s27 offen
  v_cvt_pk_bf16_f32 v216, v20, v21
  v_cvt_pk_bf16_f32 v217, v22, v23
  v_cvt_pk_bf16_f32 v218, v40, v41
  v_cvt_pk_bf16_f32 v219, v42, v43
  s_add_u32 s27, s26, 23552
  buffer_store_dwordx4 v[216:219], v2, s[8:11], s27 offen
  v_cvt_pk_bf16_f32 v220, v24, v25
  v_cvt_pk_bf16_f32 v221, v26, v27
  v_cvt_pk_bf16_f32 v222, v44, v45
  v_cvt_pk_bf16_f32 v223, v46, v47
  s_add_u32 s27, s26, 44032
  buffer_store_dwordx4 v[220:223], v2, s[8:11], s27 offen
  v_cvt_pk_bf16_f32 v224, v28, v29
  v_cvt_pk_bf16_f32 v225, v30, v31
  v_cvt_pk_bf16_f32 v226, v48, v49
  v_cvt_pk_bf16_f32 v227, v50, v51
  s_add_u32 s27, s26, 64512
  buffer_store_dwordx4 v[224:227], v2, s[8:11], s27 offen
  v_cvt_pk_bf16_f32 v212, v32, v33
  v_cvt_pk_bf16_f32 v213, v34, v35
  v_cvt_pk_bf16_f32 v214, v52, v53
  v_cvt_pk_bf16_f32 v215, v54, v55
  s_add_u32 s27, s26, 84992
  buffer_store_dwordx4 v[212:215], v2, s[8:11], s27 offen
  s_waitcnt vmcnt(20)
  v_mfma_f32_16x16x32_bf16 v[16:19], v[160:163], a[0:3], 0
  v_mfma_f32_16x16x32_bf16 v[20:23], v[160:163], a[4:7], 0
  v_mfma_f32_16x16x32_bf16 v[24:27], v[160:163], a[8:11], 0
  v_mfma_f32_16x16x32_bf16 v[28:31], v[160:163], a[12:15], 0
  v_mfma_f32_16x16x32_bf16 v[32:35], v[160:163], a[16:19], 0
  v_mfma_f32_16x16x32_bf16 v[36:39], v[184:187], a[0:3], 0
  v_mfma_f32_16x16x32_bf16 v[40:43], v[184:187], a[4:7], 0
  v_mfma_f32_16x16x32_bf16 v[44:47], v[184:187], a[8:11], 0
  v_mfma_f32_16x16x32_bf16 v[48:51], v[184:187], a[12:15], 0
  v_mfma_f32_16x16x32_bf16 v[52:55], v[184:187], a[16:19], 0
  v_mfma_f32_16x16x32_bf16 v[16:19], v[164:167], a[20:23], v[16:19]
  v_mfma_f32_16x16x32_bf16 v[20:23], v[164:167], a[24:27], v[20:23]
  v_mfma_f32_16x16x32_bf16 v[24:27], v[164:167], a[28:31], v[24:27]
  v_mfma_f32_16x16x32_bf16 v[28:31], v[164:167], a[32:35], v[28:31]
  v_mfma_f32_16x16x32_bf16 v[32:35], v[164:167], a[36:39], v[32:35]
  v_mfma_f32_16x16x32_bf16 v[36:39], v[188:191], a[20:23], v[36:39]
  v_mfma_f32_16x16x32_bf16 v[40:43], v[188:191], a[24:27], v[40:43]
  v_mfma_f32_16x16x32_bf16 v[44:47], v[188:191], a[28:31], v[44:47]
  v_mfma_f32_16x16x32_bf16 v[48:51], v[188:191], a[32:35], v[48:51]
  v_mfma_f32_16x16x32_bf16 v[52:55], v[188:191], a[36:39], v[52:55]
  v_mfma_f32_16x16x32_bf16 v[16:19], v[168:171], a[40:43], v[16:19]
  v_mfma_f32_16x16x32_bf16 v[20:23], v[168:171], a[44:47], v[20:23]
  v_mfma_f32_16x16x32_bf16 v[24:27], v[168:171], a[48:51], v[24:27]
  v_mfma_f32_16x16x32_bf16 v[28:31], v[168:171], a[52:55], v[28:31]
  v_mfma_f32_16x16x32_bf16 v[32:35], v[168:171], a[56:59], v[32:35]
  v_mfma_f32_16x16x32_bf16 v[36:39], v[192:195], a[40:43], v[36:39]
  v_mfma_f32_16x16x32_bf16 v[40:43], v[192:195], a[44:47], v[40:43]
  v_mfma_f32_16x16x32_bf16 v[44:47], v[192:195], a[48:51], v[44:47]
  v_mfma_f32_16x16x32_bf16 v[48:51], v[192:195], a[52:55], v[48:51]
  v_mfma_f32_16x16x32_bf16 v[52:55], v[192:195], a[56:59], v[52:55]
  v_mfma_f32_16x16x32_bf16 v[16:19], v[172:175], a[60:63], v[16:19]
  v_mfma_f32_16x16x32_bf16 v[20:23], v[172:175], a[64:67], v[20:23]
  v_mfma_f32_16x16x32_bf16 v[24:27], v[172:175], a[68:71], v[24:27]
  v_mfma_f32_16x16x32_bf16 v[28:31], v[172:175], a[72:75], v[28:31]
  v_mfma_f32_16x16x32_bf16 v[32:35], v[172:175], a[76:79], v[32:35]
  v_mfma_f32_16x16x32_bf16 v[36:39], v[196:199], a[60:63], v[36:39]
  v_mfma_f32_16x16x32_bf16 v[40:43], v[196:199], a[64:67], v[40:43]
  v_mfma_f32_16x16x32_bf16 v[44:47], v[196:199], a[68:71], v[44:47]
  v_mfma_f32_16x16x32_bf16 v[48:51], v[196:199], a[72:75], v[48:51]
  v_mfma_f32_16x16x32_bf16 v[52:55], v[196:199], a[76:79], v[52:55]
  v_mfma_f32_16x16x32_bf16 v[16:19], v[176:179], a[80:83], v[16:19]
  v_mfma_f32_16x16x32_bf16 v[20:23], v[176:179], a[84:87], v[20:23]
  v_mfma_f32_16x16x32_bf16 v[24:27], v[176:179], a[88:91], v[24:27]
  v_mfma_f32_16x16x32_bf16 v[28:31], v[176:179], a[92:95], v[28:31]
  v_mfma_f32_16x16x32_bf16 v[32:35], v[176:179], a[96:99], v[32:35]
  v_mfma_f32_16x16x32_bf16 v[36:39], v[200:203], a[80:83], v[36:39]
  v_mfma_f32_16x16x32_bf16 v[40:43], v[200:203], a[84:87], v[40:43]
  v_mfma_f32_16x16x32_bf16 v[44:47], v[200:203], a[88:91], v[44:47]
  v_mfma_f32_16x16x32_bf16 v[48:51], v[200:203], a[92:95], v[48:51]
  v_mfma_f32_16x16x32_bf16 v[52:55], v[200:203], a[96:99], v[52:55]
  v_mfma_f32_16x16x32_bf16 v[16:19], v[180:183], a[100:103], v[16:19]
  v_mfma_f32_16x16x32_bf16 v[20:23], v[180:183], a[104:107], v[20:23]
  v_mfma_f32_16x16x32_bf16 v[24:27], v[180:183], a[108:111], v[24:27]
  v_mfma_f32_16x16x32_bf16 v[28:31], v[180:183], a[112:115], v[28:31]
  v_mfma_f32_16x16x32_bf16 v[32:35], v[180:183], a[116:119], v[32:35]
  v_mfma_f32_16x16x32_bf16 v[36:39], v[204:207], a[100:103], v[36:39]
  v_mfma_f32_16x16x32_bf16 v[40:43], v[204:207], a[104:107], v[40:43]
  v_mfma_f32_16x16x32_bf16 v[44:47], v[204:207], a[108:111], v[44:47]
  v_mfma_f32_16x16x32_bf16 v[48:51], v[204:207], a[112:115], v[48:51]
  v_mfma_f32_16x16x32_bf16 v[52:55], v[204:207], a[116:119], v[52:55]
  s_nop 7
  v_cvt_pk_bf16_f32 v212, v16, v17
  v_cvt_pk_bf16_f32 v213, v18, v19
  v_cvt_pk_bf16_f32 v214, v36, v37
  v_cvt_pk_bf16_f32 v215, v38, v39
  s_add_u32 s27, s26, 4096
  buffer_store_dwordx4 v[212:215], v2, s[8:11], s27 offen
  v_cvt_pk_bf16_f32 v216, v20, v21
  v_cvt_pk_bf16_f32 v217, v22, v23
  v_cvt_pk_bf16_f32 v218, v40, v41
  v_cvt_pk_bf16_f32 v219, v42, v43
  s_add_u32 s27, s26, 24576
  buffer_store_dwordx4 v[216:219], v2, s[8:11], s27 offen
  v_cvt_pk_bf16_f32 v220, v24, v25
  v_cvt_pk_bf16_f32 v221, v26, v27
  v_cvt_pk_bf16_f32 v222, v44, v45
  v_cvt_pk_bf16_f32 v223, v46, v47
  s_add_u32 s27, s26, 45056
  buffer_store_dwordx4 v[220:223], v2, s[8:11], s27 offen
  v_cvt_pk_bf16_f32 v224, v28, v29
  v_cvt_pk_bf16_f32 v225, v30, v31
  v_cvt_pk_bf16_f32 v226, v48, v49
  v_cvt_pk_bf16_f32 v227, v50, v51
  s_add_u32 s27, s26, 65536
  buffer_store_dwordx4 v[224:227], v2, s[8:11], s27 offen
  v_cvt_pk_bf16_f32 v212, v32, v33
  v_cvt_pk_bf16_f32 v213, v34, v35
  v_cvt_pk_bf16_f32 v214, v52, v53
  v_cvt_pk_bf16_f32 v215, v54, v55
  s_add_u32 s27, s26, 86016
  buffer_store_dwordx4 v[212:215], v2, s[8:11], s27 offen
  s_cmp_eq_u32 s2, 0
  s_cbranch_scc0 z_20
  s_cmp_eq_u32 s21, 0
  s_cbranch_scc0 z_20
  v_mov_b32 v8, 0
  v_mov_b32 v9, 0
  v_mov_b32 v10, 0
  v_mov_b32 v11, 0
  s_mov_b32 s26, 0x0
  buffer_store_dwordx4 v[8:11], v2, s[8:11], s26 offen
  s_add_u32 s26, s26, 1024
  buffer_store_dwordx4 v[8:11], v2, s[8:11], s26 offen
  s_add_u32 s26, s26, 1024
  buffer_store_dwordx4 v[8:11], v2, s[8:11], s26 offen
  s_add_u32 s26, s26, 1024
  buffer_store_dwordx4 v[8:11], v2, s[8:11], s26 offen
  s_add_u32 s26, s26, 1024
  buffer_store_dwordx4 v[8:11], v2, s[8:11], s26 offen
  s_add_u32 s26, s26, 1024
  buffer_store_dwordx4 v[8:11], v2, s[8:11], s26 offen
  s_add_u32 s26, s26, 1024
  s_mov_b32 s26, 0x2000
  buffer_store_dwordx4 v[8:11], v2, s[8:11], s26 offen
  s_add_u32 s26, s26, 1024
  buffer_store_dwordx4 v[8:11], v2, s[8:11], s26 offen
  s_add_u32 s26, s26, 1024
  s_mov_b32 s26, 0x8000
  buffer_store_dwordx4 v[8:11], v2, s[8:11], s26 offen
  s_add_u32 s26, s26, 1024
  buffer_store_dwordx4 v[8:11], v2, s[8:11], s26 offen
  s_add_u32 s26, s26, 1024
  buffer_store_dwordx4 v[8:11], v2, s[8:11], s26 offen
  s_add_u32 s26, s26, 1024
  buffer_store_dwordx4 v[8:11], v2, s[8:11], s26 offen
  s_add_u32 s26, s26, 1024
  buffer_store_dwordx4 v[8:11], v2, s[8:11], s26 offen
  s_add_u32 s26, s26, 1024
  buffer_store_dwordx4 v[8:11], v2, s[8:11], s26 offen
  s_add_u32 s26, s26, 1024
  buffer_store_dwordx4 v[8:11], v2, s[8:11], s26 offen
  s_add_u32 s26, s26, 1024
  buffer_store_dwordx4 v[8:11], v2, s[8:11], s26 offen
  s_add_u32 s26, s26, 1024
  buffer_store_dwordx4 v[8:11], v2, s[8:11], s26 offen
  s_add_u32 s26, s26, 1024
  buffer_store_dwordx4 v[8:11], v2, s[8:11], s26 offen
  s_add_u32 s26, s26, 1024
  buffer_store_dwordx4 v[8:11], v2, s[8:11], s26 offen
  s_add_u32 s26, s26, 1024
  buffer_store_dwordx4 v[8:11], v2, s[8:11], s26 offen
  s_add_u32 s26, s26, 1024
  buffer_store_dwordx4 v[8:11], v2, s[8:11], s26 offen
  s_add_u32 s26, s26, 1024
  buffer_store_dwordx4 v[8:11], v2, s[8:11], s26 offen
  s_add_u32 s26, s26, 1024
  buffer_store_dwordx4 v[8:11], v2, s[8:11], s26 offen
  s_add_u32 s26, s26, 1024
  buffer_store_dwordx4 v[8:11], v2, s[8:11], s26 offen
  s_add_u32 s26, s26, 1024
z_20:
  s_cmp_eq_u32 s2, 1
  s_cbranch_scc0 m0_21
  s_cmp_eq_u32 s21, 0
  s_cbranch_scc0 m0_21
  s_mov_b32 s12, s38
  s_and_b32 s13, s39, 0xffff
  s_mov_b32 s14, 0x2800
  s_mov_b32 s15, 0x20000
  v_and_b32 v8, 7, v1
  v_mul_u32_u24 v8, 1280, v8
  v_lshrrev_b32 v9, 4, v1
  v_lshlrev_b32 v9, 5, v9
  v_add_u32 v8, v8, v9
  v_bfe_u32 v9, v1, 3, 1
  v_lshlrev_b32 v9, 2, v9
  v_add_u32 v8, v8, v9
  s_mov_b32 s26, 0x4000
  buffer_load_dword v16, v8, s[12:15], 0 offen offset:0
  buffer_load_dword v17, v8, s[12:15], 0 offen offset:8
  buffer_load_dword v18, v8, s[12:15], 0 offen offset:16
  buffer_load_dword v19, v8, s[12:15], 0 offen offset:24
  buffer_load_dword v20, v8, s[12:15], 0 offen offset:128
  buffer_load_dword v21, v8, s[12:15], 0 offen offset:136
  buffer_load_dword v22, v8, s[12:15], 0 offen offset:144
  buffer_load_dword v23, v8, s[12:15], 0 offen offset:152
  buffer_load_dword v24, v8, s[12:15], 0 offen offset:256
  buffer_load_dword v25, v8, s[12:15], 0 offen offset:264
  buffer_load_dword v26, v8, s[12:15], 0 offen offset:272
  buffer_load_dword v27, v8, s[12:15], 0 offen offset:280
  buffer_load_dword v28, v8, s[12:15], 0 offen offset:384
  buffer_load_dword v29, v8, s[12:15], 0 offen offset:392
  buffer_load_dword v30, v8, s[12:15], 0 offen offset:400
  buffer_load_dword v31, v8, s[12:15], 0 offen offset:408
  buffer_load_dword v32, v8, s[12:15], 0 offen offset:512
  buffer_load_dword v33, v8, s[12:15], 0 offen offset:520
  buffer_load_dword v34, v8, s[12:15], 0 offen offset:528
  buffer_load_dword v35, v8, s[12:15], 0 offen offset:536
  buffer_load_dword v36, v8, s[12:15], 0 offen offset:640
  buffer_load_dword v37, v8, s[12:15], 0 offen offset:648
  buffer_load_dword v38, v8, s[12:15], 0 offen offset:656
  buffer_load_dword v39, v8, s[12:15], 0 offen offset:664
  buffer_load_dword v40, v8, s[12:15], 0 offen offset:768
  buffer_load_dword v41, v8, s[12:15], 0 offen offset:776
  buffer_load_dword v42, v8, s[12:15], 0 offen offset:784
  buffer_load_dword v43, v8, s[12:15], 0 offen offset:792
  buffer_load_dword v44, v8, s[12:15], 0 offen offset:896
  buffer_load_dword v45, v8, s[12:15], 0 offen offset:904
  buffer_load_dword v46, v8, s[12:15], 0 offen offset:912
  buffer_load_dword v47, v8, s[12:15], 0 offen offset:920
  buffer_load_dword v48, v8, s[12:15], 0 offen offset:1024
  buffer_load_dword v49, v8, s[12:15], 0 offen offset:1032
  buffer_load_dword v50, v8, s[12:15], 0 offen offset:1040
  buffer_load_dword v51, v8, s[12:15], 0 offen offset:1048
  buffer_load_dword v52, v8, s[12:15], 0 offen offset:1152
  buffer_load_dword v53, v8, s[12:15], 0 offen offset:1160
  buffer_load_dword v54, v8, s[12:15], 0 offen offset:1168
  buffer_load_dword v55, v8, s[12:15], 0 offen offset:1176
  s_waitcnt vmcnt(0)
  buffer_store_dwordx4 v[16:19], v2, s[8:11], s26 offen
  s_add_u32 s26, s26, 1024
  buffer_store_dwordx4 v[20:23], v2, s[8:11], s26 offen
  s_add_u32 s26, s26, 1024
  buffer_store_dwordx4 v[24:27], v2, s[8:11], s26 offen
  s_add_u32 s26, s26, 1024
  buffer_store_dwordx4 v[28:31], v2, s[8:11], s26 offen
  s_add_u32 s26, s26, 1024
  buffer_store_dwordx4 v[32:35], v2, s[8:11], s26 offen
  s_add_u32 s26, s26, 1024
  buffer_store_dwordx4 v[36:39], v2, s[8:11], s26 offen
  s_add_u32 s26, s26, 1024
  buffer_store_dwordx4 v[40:43], v2, s[8:11], s26 offen
  s_add_u32 s26, s26, 1024
  buffer_store_dwordx4 v[44:47], v2, s[8:11], s26 offen
  s_add_u32 s26, s26, 1024
  buffer_store_dwordx4 v[48:51], v2, s[8:11], s26 offen
  s_add_u32 s26, s26, 1024
  buffer_store_dwordx4 v[52:55], v2, s[8:11], s26 offen
  s_add_u32 s26, s26, 1024
m0_21:
k0_exit:
  s_endpgm

.section .rodata,"a"
.p2align 6
.amdhsa_kernel prep_kernel
  .amdhsa_next_free_vgpr 512
  .amdhsa_next_free_sgpr 102
  .amdhsa_accum_offset 256
  .amdhsa_group_segment_fixed_size 0
  .amdhsa_kernarg_size 104
  .amdhsa_user_sgpr_count 2
  .amdhsa_user_sgpr_kernarg_segment_ptr 1
  .amdhsa_system_sgpr_workgroup_id_x 1
.end_amdhsa_kernel
.text
.globl ka1_kernel
.p2align 8
.type ka1_kernel,@function
ka1_kernel:
  s_mov_b32 s99, 0
  s_branch ka_body

.section .rodata,"a"
.p2align 6
.amdhsa_kernel ka1_kernel
  .amdhsa_next_free_vgpr 512
  .amdhsa_next_free_sgpr 102
  .amdhsa_accum_offset 256
  .amdhsa_group_segment_fixed_size 0
  .amdhsa_kernarg_size 104
  .amdhsa_user_sgpr_count 2
  .amdhsa_user_sgpr_kernarg_segment_ptr 1
  .amdhsa_system_sgpr_workgroup_id_x 1
.end_amdhsa_kernel
.text
.globl kb1_kernel
.p2align 8
.type kb1_kernel,@function
kb1_kernel:
  s_cmp_ge_u32 s2, 256
  s_cbranch_scc1 kb1_exit
  s_load_dwordx2 s[36:37], s[0:1], 0
  s_load_dwordx2 s[38:39], s[0:1], 80
  s_load_dwordx2 s[4:5], s[0:1], 96
  v_lshrrev_b32 v1, 6, v0
  s_nop 0
  v_readfirstlane_b32 s21, v1
  v_and_b32 v1, 63, v0
  v_lshlrev_b32 v2, 4, v1
  s_waitcnt lgkmcnt(0)
  s_mov_b32 s8, s4
  s_and_b32 s9, s5, 0xffff
  s_mov_b32 s10, 0x10000000
  s_mov_b32 s11, 0x20000
  s_mov_b32 s12, s36
  s_and_b32 s13, s37, 0xffff
  s_mov_b32 s14, 0x280000
  s_mov_b32 s15, 0x20000
  s_mov_b32 s16, s38
  s_and_b32 s17, s39, 0xffff
  s_mov_b32 s18, 0x280000
  s_mov_b32 s19, 0x20000
  s_and_b32 s22, s2, 7
  s_lshl_b32 s22, s22, 2
  s_bfe_u32 s23, s2, 0x20003
  s_add_u32 s22, s22, s23
  s_lshr_b32 s23, s2, 5
  s_lshl_b32 s46, s23, 7
  s_add_u32 s46, s46, 0x8000
  s_add_u32 s48, s46, 0x1400
  s_lshl_b32 s47, s22, 7
  s_add_u32 s47, s47, 0x8400
  s_lshr_b32 s26, s2, 2
  s_and_b32 s27, s2, 3
  s_lshl_b32 s27, s27, 3
  v_and_b32 v5, 7, v1
  v_bfe_u32 v6, v1, 3, 1
  v_lshrrev_b32 v7, 4, v1
  v_lshlrev_b32 v8, 5, v6
  v_add_u32 v8, v8, v5
  v_add_u32 v8, s27, v8
  v_lshlrev_b32 v8, 4, v8
  v_lshlrev_b32 v9, 11, v7
  v_add_u32 v9, v9, v8
  v_lshlrev_b32 v10, 10, v7
  v_add_u32 v10, v10, v8
  s_mul_i32 s28, s26, 81920
  s_lshl_b32 s29, s21, 13
  s_add_u32 s28, s28, s29
  s_cmp_lt_u32 s21, 2
  s_cselect_b32 s49, 3, 2
  v_mov_b32 v32, 0
  v_mov_b32 v33, 0
  v_mov_b32 v34, 0
  v_mov_b32 v35, 0
  v_mov_b32 v36, 0
  v_mov_b32 v37, 0
  v_mov_b32 v38, 0
  v_mov_b32 v39, 0
  v_mov_b32 v56, 0
  v_mov_b32 v57, 0
  v_mov_b32 v58, 0
  v_mov_b32 v59, 0
  v_mov_b32 v68, 0
  v_mov_b32 v69, 0
  v_mov_b32 v70, 0
  v_mov_b32 v71, 0
  v_mov_b32 v80, 0
  v_mov_b32 v81, 0
  v_mov_b32 v82, 0
  v_mov_b32 v83, 0
  v_mov_b32 v92, 0
  v_mov_b32 v93, 0
  v_mov_b32 v94, 0
  v_mov_b32 v95, 0
  s_mul_i32 s33, s26, 40960
  s_lshl_b32 s30, s21, 12
  s_add_u32 s33, s33, s30
  s_add_u32 s30, s33, 27262976
  buffer_load_dwordx4 v[48:51], v10, s[8:11], s30 offen
  s_add_u32 s30, s33, 29884416
  buffer_load_dwordx4 v[60:63], v10, s[8:11], s30 offen
  s_add_u32 s30, s33, 32505856
  buffer_load_dwordx4 v[72:75], v10, s[8:11], s30 offen
  s_add_u32 s30, s33, 35127296
  buffer_load_dwordx4 v[84:87], v10, s[8:11], s30 offen
  s_add_u32 s30, s33, 27279360
  buffer_load_dwordx4 v[52:55], v10, s[8:11], s30 offen
  s_add_u32 s30, s33, 29900800
  buffer_load_dwordx4 v[64:67], v10, s[8:11], s30 offen
  s_add_u32 s30, s33, 32522240
  buffer_load_dwordx4 v[76:79], v10, s[8:11], s30 offen
  s_add_u32 s30, s33, 35143680
  buffer_load_dwordx4 v[88:91], v10, s[8:11], s30 offen
  s_cmp_lt_u32 s21, 2
  s_cbranch_scc0 g3_22
  s_add_u32 s30, s33, 27295744
  buffer_load_dwordx4 v[56:59], v10, s[8:11], s30 offen
  s_add_u32 s30, s33, 29917184
  buffer_load_dwordx4 v[68:71], v10, s[8:11], s30 offen
  s_add_u32 s30, s33, 32538624
  buffer_load_dwordx4 v[80:83], v10, s[8:11], s30 offen
  s_add_u32 s30, s33, 35160064
  buffer_load_dwordx4 v[92:95], v10, s[8:11], s30 offen
g3_22:
  s_lshl_b32 s30, s26, 5
  s_add_u32 s30, s30, s27
  v_add_u32 v11, s30, v5
  v_mul_u32_u24 v11, 1280, v11
  v_lshlrev_b32 v12, 5, v7
  v_add_u32 v11, v11, v12
  v_lshlrev_b32 v12, 4, v6
  v_add_u32 v11, v11, v12
  s_lshl_b32 s30, s21, 7
  buffer_load_dwordx4 v[144:147], v11, s[12:15], s30 offen offset:0
  buffer_load_dwordx4 v[148:151], v11, s[12:15], s30 offen offset:512
  s_cmp_lt_u32 s21, 2
  s_cbranch_scc0 g3_23
  buffer_load_dwordx4 v[152:155], v11, s[12:15], s30 offen offset:1024
g3_23:
  s_mul_i32 s30, s22, 122880
  s_mul_i32 s31, s21, 30720
  s_add_u32 s30, s30, s31
  s_add_u32 s30, s30, 0xe100000
  s_add_u32 m0, s31, 0
  s_add_u32 s29, s30, 0
  buffer_load_dwordx4 v2, s[8:11], s29 offen lds
  s_add_u32 m0, s31, 1024
  s_add_u32 s29, s30, 1024
  buffer_load_dwordx4 v2, s[8:11], s29 offen lds
  s_add_u32 m0, s31, 2048
  s_add_u32 s29, s30, 2048
  buffer_load_dwordx4 v2, s[8:11], s29 offen lds
  s_add_u32 m0, s31, 3072
  s_add_u32 s29, s30, 3072
  buffer_load_dwordx4 v2, s[8:11], s29 offen lds
  s_add_u32 m0, s31, 4096
  s_add_u32 s29, s30, 4096
  buffer_load_dwordx4 v2, s[8:11], s29 offen lds
  s_add_u32 m0, s31, 5120
  s_add_u32 s29, s30, 5120
  buffer_load_dwordx4 v2, s[8:11], s29 offen lds
  s_add_u32 m0, s31, 6144
  s_add_u32 s29, s30, 6144
  buffer_load_dwordx4 v2, s[8:11], s29 offen lds
  s_add_u32 m0, s31, 7168
  s_add_u32 s29, s30, 7168
  buffer_load_dwordx4 v2, s[8:11], s29 offen lds
  s_add_u32 m0, s31, 8192
  s_add_u32 s29, s30, 8192
  buffer_load_dwordx4 v2, s[8:11], s29 offen lds
  s_add_u32 m0, s31, 9216
  s_add_u32 s29, s30, 9216
  buffer_load_dwordx4 v2, s[8:11], s29 offen lds
  s_add_u32 m0, s31, 10240
  s_add_u32 s29, s30, 10240
  buffer_load_dwordx4 v2, s[8:11], s29 offen lds
  s_add_u32 m0, s31, 11264
  s_add_u32 s29, s30, 11264
  buffer_load_dwordx4 v2, s[8:11], s29 offen lds
  s_add_u32 m0, s31, 12288
  s_add_u32 s29, s30, 12288
  buffer_load_dwordx4 v2, s[8:11], s29 offen lds
  s_add_u32 m0, s31, 13312
  s_add_u32 s29, s30, 13312
  buffer_load_dwordx4 v2, s[8:11], s29 offen lds
  s_add_u32 m0, s31, 14336
  s_add_u32 s29, s30, 14336
  buffer_load_dwordx4 v2, s[8:11], s29 offen lds
  s_add_u32 m0, s31, 15360
  s_add_u32 s29, s30, 15360
  buffer_load_dwordx4 v2, s[8:11], s29 offen lds
  s_add_u32 m0, s31, 16384
  s_add_u32 s29, s30, 16384
  buffer_load_dwordx4 v2, s[8:11], s29 offen lds
  s_add_u32 m0, s31, 17408
  s_add_u32 s29, s30, 17408
  buffer_load_dwordx4 v2, s[8:11], s29 offen lds
  s_add_u32 m0, s31, 18432
  s_add_u32 s29, s30, 18432
  buffer_load_dwordx4 v2, s[8:11], s29 offen lds
  s_add_u32 m0, s31, 19456
  s_add_u32 s29, s30, 19456
  buffer_load_dwordx4 v2, s[8:11], s29 offen lds
  s_add_u32 m0, s31, 20480
  s_add_u32 s29, s30, 20480
  buffer_load_dwordx4 v2, s[8:11], s29 offen lds
  s_add_u32 m0, s31, 21504
  s_add_u32 s29, s30, 21504
  buffer_load_dwordx4 v2, s[8:11], s29 offen lds
  s_add_u32 m0, s31, 22528
  s_add_u32 s29, s30, 22528
  buffer_load_dwordx4 v2, s[8:11], s29 offen lds
  s_add_u32 m0, s31, 23552
  s_add_u32 s29, s30, 23552
  buffer_load_dwordx4 v2, s[8:11], s29 offen lds
  s_add_u32 m0, s31, 24576
  s_add_u32 s29, s30, 24576
  buffer_load_dwordx4 v2, s[8:11], s29 offen lds
  s_add_u32 m0, s31, 25600
  s_add_u32 s29, s30, 25600
  buffer_load_dwordx4 v2, s[8:11], s29 offen lds
  s_add_u32 m0, s31, 26624
  s_add_u32 s29, s30, 26624
  buffer_load_dwordx4 v2, s[8:11], s29 offen lds
  s_add_u32 m0, s31, 27648
  s_add_u32 s29, s30, 27648
  buffer_load_dwordx4 v2, s[8:11], s29 offen lds
  s_add_u32 m0, s31, 28672
  s_add_u32 s29, s30, 28672
  buffer_load_dwordx4 v2, s[8:11], s29 offen lds
  s_add_u32 m0, s31, 29696
  s_add_u32 s29, s30, 29696
  buffer_load_dwordx4 v2, s[8:11], s29 offen lds
  s_waitcnt vmcnt(30)
  v_lshlrev_b32 v16, 16, v144
  v_and_b32 v17, 0xffff0000, v144
  v_lshlrev_b32 v18, 16, v145
  v_and_b32 v19, 0xffff0000, v145
  v_lshlrev_b32 v20, 16, v146
  v_and_b32 v21, 0xffff0000, v146
  v_lshlrev_b32 v22, 16, v147
  v_and_b32 v23, 0xffff0000, v147
  v_lshlrev_b32 v24, 16, v148
  v_and_b32 v25, 0xffff0000, v148
  v_lshlrev_b32 v26, 16, v149
  v_and_b32 v27, 0xffff0000, v149
  v_lshlrev_b32 v28, 16, v150
  v_and_b32 v29, 0xffff0000, v150
  v_lshlrev_b32 v30, 16, v151
  v_and_b32 v31, 0xffff0000, v151
  s_cmp_lt_u32 s21, 2
  s_cbranch_scc0 g3_24
  v_lshlrev_b32 v32, 16, v152
  v_and_b32 v33, 0xffff0000, v152
  v_lshlrev_b32 v34, 16, v153
  v_and_b32 v35, 0xffff0000, v153
  v_lshlrev_b32 v36, 16, v154
  v_and_b32 v37, 0xffff0000, v154
  v_lshlrev_b32 v38, 16, v155
  v_and_b32 v39, 0xffff0000, v155
g3_24:
  v_lshlrev_b32 v12, 16, v48
  v_and_b32 v13, 0xffff0000, v48
  v_pk_add_f32 v[16:17], v[16:17], v[12:13]
  v_lshlrev_b32 v12, 16, v49
  v_and_b32 v13, 0xffff0000, v49
  v_pk_add_f32 v[18:19], v[18:19], v[12:13]
  v_lshlrev_b32 v12, 16, v50
  v_and_b32 v13, 0xffff0000, v50
  v_pk_add_f32 v[20:21], v[20:21], v[12:13]
  v_lshlrev_b32 v12, 16, v51
  v_and_b32 v13, 0xffff0000, v51
  v_pk_add_f32 v[22:23], v[22:23], v[12:13]
  v_lshlrev_b32 v12, 16, v52
  v_and_b32 v13, 0xffff0000, v52
  v_pk_add_f32 v[24:25], v[24:25], v[12:13]
  v_lshlrev_b32 v12, 16, v53
  v_and_b32 v13, 0xffff0000, v53
  v_pk_add_f32 v[26:27], v[26:27], v[12:13]
  v_lshlrev_b32 v12, 16, v54
  v_and_b32 v13, 0xffff0000, v54
  v_pk_add_f32 v[28:29], v[28:29], v[12:13]
  v_lshlrev_b32 v12, 16, v55
  v_and_b32 v13, 0xffff0000, v55
  v_pk_add_f32 v[30:31], v[30:31], v[12:13]
  v_lshlrev_b32 v12, 16, v56
  v_and_b32 v13, 0xffff0000, v56
  v_pk_add_f32 v[32:33], v[32:33], v[12:13]
  v_lshlrev_b32 v12, 16, v57
  v_and_b32 v13, 0xffff0000, v57
  v_pk_add_f32 v[34:35], v[34:35], v[12:13]
  v_lshlrev_b32 v12, 16, v58
  v_and_b32 v13, 0xffff0000, v58
  v_pk_add_f32 v[36:37], v[36:37], v[12:13]
  v_lshlrev_b32 v12, 16, v59
  v_and_b32 v13, 0xffff0000, v59
  v_pk_add_f32 v[38:39], v[38:39], v[12:13]
  v_lshlrev_b32 v12, 16, v60
  v_and_b32 v13, 0xffff0000, v60
  v_pk_add_f32 v[16:17], v[16:17], v[12:13]
  v_lshlrev_b32 v12, 16, v61
  v_and_b32 v13, 0xffff0000, v61
  v_pk_add_f32 v[18:19], v[18:19], v[12:13]
  v_lshlrev_b32 v12, 16, v62
  v_and_b32 v13, 0xffff0000, v62
  v_pk_add_f32 v[20:21], v[20:21], v[12:13]
  v_lshlrev_b32 v12, 16, v63
  v_and_b32 v13, 0xffff0000, v63
  v_pk_add_f32 v[22:23], v[22:23], v[12:13]
  v_lshlrev_b32 v12, 16, v64
  v_and_b32 v13, 0xffff0000, v64
  v_pk_add_f32 v[24:25], v[24:25], v[12:13]
  v_lshlrev_b32 v12, 16, v65
  v_and_b32 v13, 0xffff0000, v65
  v_pk_add_f32 v[26:27], v[26:27], v[12:13]
  v_lshlrev_b32 v12, 16, v66
  v_and_b32 v13, 0xffff0000, v66
  v_pk_add_f32 v[28:29], v[28:29], v[12:13]
  v_lshlrev_b32 v12, 16, v67
  v_and_b32 v13, 0xffff0000, v67
  v_pk_add_f32 v[30:31], v[30:31], v[12:13]
  v_lshlrev_b32 v12, 16, v68
  v_and_b32 v13, 0xffff0000, v68
  v_pk_add_f32 v[32:33], v[32:33], v[12:13]
  v_lshlrev_b32 v12, 16, v69
  v_and_b32 v13, 0xffff0000, v69
  v_pk_add_f32 v[34:35], v[34:35], v[12:13]
  v_lshlrev_b32 v12, 16, v70
  v_and_b32 v13, 0xffff0000, v70
  v_pk_add_f32 v[36:37], v[36:37], v[12:13]
  v_lshlrev_b32 v12, 16, v71
  v_and_b32 v13, 0xffff0000, v71
  v_pk_add_f32 v[38:39], v[38:39], v[12:13]
  v_lshlrev_b32 v12, 16, v72
  v_and_b32 v13, 0xffff0000, v72
  v_pk_add_f32 v[16:17], v[16:17], v[12:13]
  v_lshlrev_b32 v12, 16, v73
  v_and_b32 v13, 0xffff0000, v73
  v_pk_add_f32 v[18:19], v[18:19], v[12:13]
  v_lshlrev_b32 v12, 16, v74
  v_and_b32 v13, 0xffff0000, v74
  v_pk_add_f32 v[20:21], v[20:21], v[12:13]
  v_lshlrev_b32 v12, 16, v75
  v_and_b32 v13, 0xffff0000, v75
  v_pk_add_f32 v[22:23], v[22:23], v[12:13]
  v_lshlrev_b32 v12, 16, v76
  v_and_b32 v13, 0xffff0000, v76
  v_pk_add_f32 v[24:25], v[24:25], v[12:13]
  v_lshlrev_b32 v12, 16, v77
  v_and_b32 v13, 0xffff0000, v77
  v_pk_add_f32 v[26:27], v[26:27], v[12:13]
  v_lshlrev_b32 v12, 16, v78
  v_and_b32 v13, 0xffff0000, v78
  v_pk_add_f32 v[28:29], v[28:29], v[12:13]
  v_lshlrev_b32 v12, 16, v79
  v_and_b32 v13, 0xffff0000, v79
  v_pk_add_f32 v[30:31], v[30:31], v[12:13]
  v_lshlrev_b32 v12, 16, v80
  v_and_b32 v13, 0xffff0000, v80
  v_pk_add_f32 v[32:33], v[32:33], v[12:13]
  v_lshlrev_b32 v12, 16, v81
  v_and_b32 v13, 0xffff0000, v81
  v_pk_add_f32 v[34:35], v[34:35], v[12:13]
  v_lshlrev_b32 v12, 16, v82
  v_and_b32 v13, 0xffff0000, v82
  v_pk_add_f32 v[36:37], v[36:37], v[12:13]
  v_lshlrev_b32 v12, 16, v83
  v_and_b32 v13, 0xffff0000, v83
  v_pk_add_f32 v[38:39], v[38:39], v[12:13]
  v_lshlrev_b32 v12, 16, v84
  v_and_b32 v13, 0xffff0000, v84
  v_pk_add_f32 v[16:17], v[16:17], v[12:13]
  v_lshlrev_b32 v12, 16, v85
  v_and_b32 v13, 0xffff0000, v85
  v_pk_add_f32 v[18:19], v[18:19], v[12:13]
  v_lshlrev_b32 v12, 16, v86
  v_and_b32 v13, 0xffff0000, v86
  v_pk_add_f32 v[20:21], v[20:21], v[12:13]
  v_lshlrev_b32 v12, 16, v87
  v_and_b32 v13, 0xffff0000, v87
  v_pk_add_f32 v[22:23], v[22:23], v[12:13]
  v_lshlrev_b32 v12, 16, v88
  v_and_b32 v13, 0xffff0000, v88
  v_pk_add_f32 v[24:25], v[24:25], v[12:13]
  v_lshlrev_b32 v12, 16, v89
  v_and_b32 v13, 0xffff0000, v89
  v_pk_add_f32 v[26:27], v[26:27], v[12:13]
  v_lshlrev_b32 v12, 16, v90
  v_and_b32 v13, 0xffff0000, v90
  v_pk_add_f32 v[28:29], v[28:29], v[12:13]
  v_lshlrev_b32 v12, 16, v91
  v_and_b32 v13, 0xffff0000, v91
  v_pk_add_f32 v[30:31], v[30:31], v[12:13]
  v_lshlrev_b32 v12, 16, v92
  v_and_b32 v13, 0xffff0000, v92
  v_pk_add_f32 v[32:33], v[32:33], v[12:13]
  v_lshlrev_b32 v12, 16, v93
  v_and_b32 v13, 0xffff0000, v93
  v_pk_add_f32 v[34:35], v[34:35], v[12:13]
  v_lshlrev_b32 v12, 16, v94
  v_and_b32 v13, 0xffff0000, v94
  v_pk_add_f32 v[36:37], v[36:37], v[12:13]
  v_lshlrev_b32 v12, 16, v95
  v_and_b32 v13, 0xffff0000, v95
  v_pk_add_f32 v[38:39], v[38:39], v[12:13]
  s_add_u32 s30, s28, 20971520
  buffer_store_dwordx4 v[16:19], v9, s[8:11], s30 offen sc1
  s_add_u32 s30, s28, 20972544
  buffer_store_dwordx4 v[20:23], v9, s[8:11], s30 offen sc1
  s_add_u32 s30, s28, 21004288
  buffer_store_dwordx4 v[24:27], v9, s[8:11], s30 offen sc1
  s_add_u32 s30, s28, 21005312
  buffer_store_dwordx4 v[28:31], v9, s[8:11], s30 offen sc1
  s_cmp_lt_u32 s21, 2
  s_cbranch_scc0 g3_25
  s_add_u32 s30, s28, 21037056
  buffer_store_dwordx4 v[32:35], v9, s[8:11], s30 offen sc1
  s_add_u32 s30, s28, 21038080
  buffer_store_dwordx4 v[36:39], v9, s[8:11], s30 offen sc1
g3_25:
  v_add_f32 v12, v16, v17
  v_add_f32 v12, v12, v18
  v_add_f32 v12, v12, v19
  v_add_f32 v12, v12, v20
  v_add_f32 v12, v12, v21
  v_add_f32 v12, v12, v22
  v_add_f32 v12, v12, v23
  v_add_f32 v12, v12, v24
  v_add_f32 v12, v12, v25
  v_add_f32 v12, v12, v26
  v_add_f32 v12, v12, v27
  v_add_f32 v12, v12, v28
  v_add_f32 v12, v12, v29
  v_add_f32 v12, v12, v30
  v_add_f32 v12, v12, v31
  v_add_f32 v12, v12, v32
  v_add_f32 v12, v12, v33
  v_add_f32 v12, v12, v34
  v_add_f32 v12, v12, v35
  v_add_f32 v12, v12, v36
  v_add_f32 v12, v12, v37
  v_add_f32 v12, v12, v38
  v_add_f32 v12, v12, v39
  s_nop 1
  v_add_f32_dpp v12, v12, v12 row_ror:8 row_mask:0xf bank_mask:0xf
  v_mov_b32 v13, v12
  s_nop 1
  v_permlane16_swap_b32 v12, v13
  v_add_f32 v12, v12, v13
  v_mov_b32 v13, v12
  s_nop 1
  v_permlane32_swap_b32 v12, v13
  v_add_f32 v12, v12, v13
  v_lshlrev_b32 v14, 2, v5
  v_add_u32 v14, 131072, v14
  s_lshl_b32 s30, s21, 5
  v_add_u32 v15, s30, v14
  ds_write_b32 v15, v12
  s_waitcnt lgkmcnt(0)
  s_barrier
  ds_read_b32 v48, v14
  ds_read_b32 v49, v14 offset:32
  ds_read_b32 v50, v14 offset:64
  ds_read_b32 v51, v14 offset:96
  s_waitcnt lgkmcnt(0)
  v_add_f32 v48, v48, v49
  v_add_f32 v50, v50, v51
  v_add_f32 v48, v48, v50
  v_mul_f32 v48, 0x3acccccd, v48
  v_sub_f32 v56, v16, v48
  v_sub_f32 v57, v17, v48
  v_sub_f32 v58, v18, v48
  v_sub_f32 v59, v19, v48
  v_sub_f32 v60, v20, v48
  v_sub_f32 v61, v21, v48
  v_sub_f32 v62, v22, v48
  v_sub_f32 v63, v23, v48
  v_sub_f32 v64, v24, v48
  v_sub_f32 v65, v25, v48
  v_sub_f32 v66, v26, v48
  v_sub_f32 v67, v27, v48
  v_sub_f32 v68, v28, v48
  v_sub_f32 v69, v29, v48
  v_sub_f32 v70, v30, v48
  v_sub_f32 v71, v31, v48
  v_sub_f32 v72, v32, v48
  v_sub_f32 v73, v33, v48
  v_sub_f32 v74, v34, v48
  v_sub_f32 v75, v35, v48
  v_sub_f32 v76, v36, v48
  v_sub_f32 v77, v37, v48
  v_sub_f32 v78, v38, v48
  v_sub_f32 v79, v39, v48
  s_cmp_lt_u32 s21, 2
  s_cbranch_scc1 g3z_26
  v_mov_b32 v72, 0
  v_mov_b32 v73, 0
  v_mov_b32 v74, 0
  v_mov_b32 v75, 0
  v_mov_b32 v76, 0
  v_mov_b32 v77, 0
  v_mov_b32 v78, 0
  v_mov_b32 v79, 0
g3z_26:
  v_mul_f32 v12, v56, v56
  v_fmac_f32 v12, v57, v57
  v_fmac_f32 v12, v58, v58
  v_fmac_f32 v12, v59, v59
  v_fmac_f32 v12, v60, v60
  v_fmac_f32 v12, v61, v61
  v_fmac_f32 v12, v62, v62
  v_fmac_f32 v12, v63, v63
  v_fmac_f32 v12, v64, v64
  v_fmac_f32 v12, v65, v65
  v_fmac_f32 v12, v66, v66
  v_fmac_f32 v12, v67, v67
  v_fmac_f32 v12, v68, v68
  v_fmac_f32 v12, v69, v69
  v_fmac_f32 v12, v70, v70
  v_fmac_f32 v12, v71, v71
  v_fmac_f32 v12, v72, v72
  v_fmac_f32 v12, v73, v73
  v_fmac_f32 v12, v74, v74
  v_fmac_f32 v12, v75, v75
  v_fmac_f32 v12, v76, v76
  v_fmac_f32 v12, v77, v77
  v_fmac_f32 v12, v78, v78
  v_fmac_f32 v12, v79, v79
  s_nop 1
  v_add_f32_dpp v12, v12, v12 row_ror:8 row_mask:0xf bank_mask:0xf
  v_mov_b32 v13, v12
  s_nop 1
  v_permlane16_swap_b32 v12, v13
  v_add_f32 v12, v12, v13
  v_mov_b32 v13, v12
  s_nop 1
  v_permlane32_swap_b32 v12, v13
  v_add_f32 v12, v12, v13
  v_lshlrev_b32 v14, 2, v5
  v_add_u32 v14, 131328, v14
  s_lshl_b32 s30, s21, 5
  v_add_u32 v15, s30, v14
  ds_write_b32 v15, v12
  s_waitcnt lgkmcnt(0)
  s_barrier
  ds_read_b32 v48, v14
  ds_read_b32 v49, v14 offset:32
  ds_read_b32 v50, v14 offset:64
  ds_read_b32 v51, v14 offset:96
  s_waitcnt lgkmcnt(0)
  v_add_f32 v48, v48, v49
  v_add_f32 v50, v50, v51
  v_add_f32 v48, v48, v50
  v_mov_b32 v49, 0x3727c5ac
  v_fmac_f32 v49, 0x3acccccd, v48
  v_rsq_f32 v49, v49
  s_nop 0
  v_mul_f32 v56, v56, v49
  v_mul_f32 v57, v57, v49
  v_mul_f32 v58, v58, v49
  v_mul_f32 v59, v59, v49
  v_mul_f32 v60, v60, v49
  v_mul_f32 v61, v61, v49
  v_mul_f32 v62, v62, v49
  v_mul_f32 v63, v63, v49
  v_mul_f32 v64, v64, v49
  v_mul_f32 v65, v65, v49
  v_mul_f32 v66, v66, v49
  v_mul_f32 v67, v67, v49
  v_mul_f32 v68, v68, v49
  v_mul_f32 v69, v69, v49
  v_mul_f32 v70, v70, v49
  v_mul_f32 v71, v71, v49
  v_mul_f32 v72, v72, v49
  v_mul_f32 v73, v73, v49
  v_mul_f32 v74, v74, v49
  v_mul_f32 v75, v75, v49
  v_mul_f32 v76, v76, v49
  v_mul_f32 v77, v77, v49
  v_mul_f32 v78, v78, v49
  v_mul_f32 v79, v79, v49
  v_cvt_pk_bf16_f32 v80, v56, v57
  v_cvt_pk_bf16_f32 v81, v58, v59
  v_cvt_pk_bf16_f32 v82, v60, v61
  v_cvt_pk_bf16_f32 v83, v62, v63
  v_cvt_pk_bf16_f32 v84, v64, v65
  v_cvt_pk_bf16_f32 v85, v66, v67
  v_cvt_pk_bf16_f32 v86, v68, v69
  v_cvt_pk_bf16_f32 v87, v70, v71
  v_cvt_pk_bf16_f32 v88, v72, v73
  v_cvt_pk_bf16_f32 v89, v74, v75
  v_cvt_pk_bf16_f32 v90, v76, v77
  v_cvt_pk_bf16_f32 v91, v78, v79
  s_mul_i32 s30, s26, 40960
  s_lshl_b32 s31, s21, 12
  s_add_u32 s30, s30, s31
  s_add_u32 s30, s30, 0x100000
  s_add_u32 s31, s30, 0
  buffer_store_dwordx4 v[80:83], v10, s[8:11], s31 offen sc1
  s_add_u32 s31, s30, 16384
  buffer_store_dwordx4 v[84:87], v10, s[8:11], s31 offen sc1
  s_cmp_lt_u32 s21, 2
  s_cbranch_scc0 g3_27
  s_add_u32 s31, s30, 32768
  buffer_store_dwordx4 v[88:91], v10, s[8:11], s31 offen sc1
g3_27:
  s_waitcnt vmcnt(0)
  s_barrier
  s_cmp_eq_u32 s21, 0
  s_cbranch_scc0 arr_28
  s_mov_b64 s[24:25], exec
  s_mov_b64 exec, 1
  v_mov_b32 v3, 0
  v_mov_b32 v4, 1
  buffer_atomic_add v4, v3, s[8:11], s46 offen
  s_mov_b64 exec, s[24:25]
arr_28:
  s_mov_b32 s45, 0
  v_mov_b32 v3, 0
aw_29:
  buffer_load_dword v4, v3, s[8:11], s46 offen sc1
  s_add_u32 s45, s45, 1
  s_waitcnt vmcnt(0)
  v_readfirstlane_b32 s29, v4
  s_cmp_ge_u32 s29, 32
  s_cbranch_scc1 aw_29_ok
  s_cmp_lt_u32 s45, 400000
  s_cbranch_scc1 aw_29
  s_branch kb1_abort
aw_29_ok:
  s_barrier
  s_lshl_b32 s26, s23, 3
  s_lshl_b32 s27, s21, 1
  s_add_u32 s24, s26, s27
  s_mul_i32 s27, s24, 40960
  s_add_u32 s27, s27, 0x100000
  s_add_u32 s28, s27, 40960
  v_mov_b32 v3, v2
  v_add_u32 v4, 65536, v2
  v_lshlrev_b32 v5, 7, v1
  s_add_u32 s29, s27, 0
  buffer_load_dword v10, v5, s[8:11], s29 offen sc1
  s_add_u32 s29, s27, 8192
  buffer_load_dword v10, v5, s[8:11], s29 offen sc1
  s_add_u32 s29, s27, 16384
  buffer_load_dword v10, v5, s[8:11], s29 offen sc1
  s_add_u32 s29, s27, 24576
  buffer_load_dword v10, v5, s[8:11], s29 offen sc1
  s_add_u32 s29, s27, 32768
  buffer_load_dword v10, v5, s[8:11], s29 offen sc1
  s_add_u32 s29, s27, 40960
  buffer_load_dword v10, v5, s[8:11], s29 offen sc1
  s_add_u32 s29, s27, 49152
  buffer_load_dword v10, v5, s[8:11], s29 offen sc1
  s_add_u32 s29, s27, 57344
  buffer_load_dword v10, v5, s[8:11], s29 offen sc1
  s_add_u32 s29, s27, 65536
  buffer_load_dword v10, v5, s[8:11], s29 offen sc1
  s_add_u32 s29, s27, 73728
  buffer_load_dword v10, v5, s[8:11], s29 offen sc1
  s_mov_b32 s30, 0x3ea52b5c
  v_mov_b32 v5, 0
  v_cmp_gt_u32 s[34:35], 32, v1
  v_mov_b32 v6, 1.0
  v_and_b32 v7, 31, v1
  v_cndmask_b32 v6, v5, v6, s[34:35]
  v_cmp_eq_u32 s[32:33], 20, v7
  v_mov_b32 v8, 1.0
  s_lshl_b32 s31, s22, 6
  s_add_u32 s31, s31, s24
  s_lshl_b32 s31, s31, 11
  v_mov_b32 v9, 0
  s_add_u32 s29, s27, 0
  buffer_load_dwordx4 v[16:19], v2, s[8:11], s29 offen sc1
  s_add_u32 s29, s27, 1024
  buffer_load_dwordx4 v[20:23], v2, s[8:11], s29 offen sc1
  s_add_u32 s29, s27, 2048
  buffer_load_dwordx4 v[24:27], v2, s[8:11], s29 offen sc1
  s_add_u32 s29, s27, 3072
  buffer_load_dwordx4 v[28:31], v2, s[8:11], s29 offen sc1
  s_add_u32 s29, s27, 4096
  buffer_load_dwordx4 v[32:35], v2, s[8:11], s29 offen sc1
  s_add_u32 s29, s27, 5120
  buffer_load_dwordx4 v[36:39], v2, s[8:11], s29 offen sc1
  s_add_u32 s29, s27, 6144
  buffer_load_dwordx4 v[40:43], v2, s[8:11], s29 offen sc1
  s_add_u32 s29, s27, 7168
  buffer_load_dwordx4 v[44:47], v2, s[8:11], s29 offen sc1
  s_add_u32 s29, s27, 8192
  buffer_load_dwordx4 v[48:51], v2, s[8:11], s29 offen sc1
  s_add_u32 s29, s27, 9216
  buffer_load_dwordx4 v[52:55], v2, s[8:11], s29 offen sc1
  s_add_u32 s29, s27, 10240
  buffer_load_dwordx4 v[56:59], v2, s[8:11], s29 offen sc1
  s_add_u32 s29, s27, 11264
  buffer_load_dwordx4 v[60:63], v2, s[8:11], s29 offen sc1
  s_add_u32 s29, s27, 12288
  buffer_load_dwordx4 v[64:67], v2, s[8:11], s29 offen sc1
  s_add_u32 s29, s27, 13312
  buffer_load_dwordx4 v[68:71], v2, s[8:11], s29 offen sc1
  s_add_u32 s29, s27, 14336
  buffer_load_dwordx4 v[72:75], v2, s[8:11], s29 offen sc1
  ds_read_b128 v[208:211], v3 offset:0
  ds_read_b128 v[212:215], v3 offset:40960
  ds_read_b128 v[216:219], v4 offset:16384
  s_add_u32 s29, s27, 15360
  buffer_load_dwordx4 v[76:79], v2, s[8:11], s29 offen sc1
  ds_read_b128 v[220:223], v3 offset:1024
  ds_read_b128 v[224:227], v3 offset:41984
  ds_read_b128 v[228:231], v4 offset:17408
  s_waitcnt lgkmcnt(3)
  s_waitcnt vmcnt(15)
  v_mfma_f32_32x32x16_bf16 v[80:95], v[208:211], v[16:19], 0
  v_mfma_f32_32x32x16_bf16 v[96:111], v[212:215], v[16:19], 0
  v_mfma_f32_32x32x16_bf16 v[112:127], v[16:19], v[216:219], 0
  s_add_u32 s29, s27, 16384
  buffer_load_dwordx4 v[16:19], v2, s[8:11], s29 offen sc1
  ds_read_b128 v[208:211], v3 offset:2048
  ds_read_b128 v[212:215], v3 offset:43008
  ds_read_b128 v[216:219], v4 offset:18432
  s_waitcnt lgkmcnt(3)
  s_waitcnt vmcnt(15)
  v_mfma_f32_32x32x16_bf16 v[80:95], v[220:223], v[20:23], v[80:95]
  v_mfma_f32_32x32x16_bf16 v[96:111], v[224:227], v[20:23], v[96:111]
  v_mfma_f32_32x32x16_bf16 v[112:127], v[20:23], v[228:231], v[112:127]
  s_add_u32 s29, s27, 17408
  buffer_load_dwordx4 v[20:23], v2, s[8:11], s29 offen sc1
  ds_read_b128 v[220:223], v3 offset:3072
  ds_read_b128 v[224:227], v3 offset:44032
  ds_read_b128 v[228:231], v4 offset:19456
  s_waitcnt lgkmcnt(3)
  s_waitcnt vmcnt(15)
  v_mfma_f32_32x32x16_bf16 v[80:95], v[208:211], v[24:27], v[80:95]
  v_mfma_f32_32x32x16_bf16 v[96:111], v[212:215], v[24:27], v[96:111]
  v_mfma_f32_32x32x16_bf16 v[112:127], v[24:27], v[216:219], v[112:127]
  s_add_u32 s29, s27, 18432
  buffer_load_dwordx4 v[24:27], v2, s[8:11], s29 offen sc1
  ds_read_b128 v[208:211], v3 offset:4096
  ds_read_b128 v[212:215], v3 offset:45056
  ds_read_b128 v[216:219], v4 offset:20480
  s_waitcnt lgkmcnt(3)
  s_waitcnt vmcnt(15)
  v_mfma_f32_32x32x16_bf16 v[80:95], v[220:223], v[28:31], v[80:95]
  v_mfma_f32_32x32x16_bf16 v[96:111], v[224:227], v[28:31], v[96:111]
  v_mfma_f32_32x32x16_bf16 v[112:127], v[28:31], v[228:231], v[112:127]
  s_add_u32 s29, s27, 19456
  buffer_load_dwordx4 v[28:31], v2, s[8:11], s29 offen sc1
  ds_read_b128 v[220:223], v3 offset:5120
  ds_read_b128 v[224:227], v3 offset:46080
  ds_read_b128 v[228:231], v4 offset:21504
  s_waitcnt lgkmcnt(3)
  s_waitcnt vmcnt(15)
  v_mfma_f32_32x32x16_bf16 v[80:95], v[208:211], v[32:35], v[80:95]
  v_mfma_f32_32x32x16_bf16 v[96:111], v[212:215], v[32:35], v[96:111]
  v_mfma_f32_32x32x16_bf16 v[112:127], v[32:35], v[216:219], v[112:127]
  s_add_u32 s29, s27, 20480
  buffer_load_dwordx4 v[32:35], v2, s[8:11], s29 offen sc1
  ds_read_b128 v[208:211], v3 offset:6144
  ds_read_b128 v[212:215], v3 offset:47104
  ds_read_b128 v[216:219], v4 offset:22528
  s_waitcnt lgkmcnt(3)
  s_waitcnt vmcnt(15)
  v_mfma_f32_32x32x16_bf16 v[80:95], v[220:223], v[36:39], v[80:95]
  v_mfma_f32_32x32x16_bf16 v[96:111], v[224:227], v[36:39], v[96:111]
  v_mfma_f32_32x32x16_bf16 v[112:127], v[36:39], v[228:231], v[112:127]
  s_add_u32 s29, s27, 21504
  buffer_load_dwordx4 v[36:39], v2, s[8:11], s29 offen sc1
  ds_read_b128 v[220:223], v3 offset:7168
  ds_read_b128 v[224:227], v3 offset:48128
  ds_read_b128 v[228:231], v4 offset:23552
  s_waitcnt lgkmcnt(3)
  s_waitcnt vmcnt(15)
  v_mfma_f32_32x32x16_bf16 v[80:95], v[208:211], v[40:43], v[80:95]
  v_mfma_f32_32x32x16_bf16 v[96:111], v[212:215], v[40:43], v[96:111]
  v_mfma_f32_32x32x16_bf16 v[112:127], v[40:43], v[216:219], v[112:127]
  s_add_u32 s29, s27, 22528
  buffer_load_dwordx4 v[40:43], v2, s[8:11], s29 offen sc1
  ds_read_b128 v[208:211], v3 offset:8192
  ds_read_b128 v[212:215], v3 offset:49152
  ds_read_b128 v[216:219], v4 offset:24576
  s_waitcnt lgkmcnt(3)
  s_waitcnt vmcnt(15)
  v_mfma_f32_32x32x16_bf16 v[80:95], v[220:223], v[44:47], v[80:95]
  v_mfma_f32_32x32x16_bf16 v[96:111], v[224:227], v[44:47], v[96:111]
  v_mfma_f32_32x32x16_bf16 v[112:127], v[44:47], v[228:231], v[112:127]
  s_add_u32 s29, s27, 23552
  buffer_load_dwordx4 v[44:47], v2, s[8:11], s29 offen sc1
  ds_read_b128 v[220:223], v3 offset:9216
  ds_read_b128 v[224:227], v3 offset:50176
  ds_read_b128 v[228:231], v4 offset:25600
  s_waitcnt lgkmcnt(3)
  s_waitcnt vmcnt(15)
  v_mfma_f32_32x32x16_bf16 v[80:95], v[208:211], v[48:51], v[80:95]
  v_mfma_f32_32x32x16_bf16 v[96:111], v[212:215], v[48:51], v[96:111]
  v_mfma_f32_32x32x16_bf16 v[112:127], v[48:51], v[216:219], v[112:127]
  s_add_u32 s29, s27, 24576
  buffer_load_dwordx4 v[48:51], v2, s[8:11], s29 offen sc1
  ds_read_b128 v[208:211], v3 offset:10240
  ds_read_b128 v[212:215], v3 offset:51200
  ds_read_b128 v[216:219], v4 offset:26624
  s_waitcnt lgkmcnt(3)
  s_waitcnt vmcnt(15)
  v_mfma_f32_32x32x16_bf16 v[80:95], v[220:223], v[52:55], v[80:95]
  v_mfma_f32_32x32x16_bf16 v[96:111], v[224:227], v[52:55], v[96:111]
  v_mfma_f32_32x32x16_bf16 v[112:127], v[52:55], v[228:231], v[112:127]
  s_add_u32 s29, s27, 25600
  buffer_load_dwordx4 v[52:55], v2, s[8:11], s29 offen sc1
  ds_read_b128 v[220:223], v3 offset:11264
  ds_read_b128 v[224:227], v3 offset:52224
  ds_read_b128 v[228:231], v4 offset:27648
  s_waitcnt lgkmcnt(3)
  s_waitcnt vmcnt(15)
  v_mfma_f32_32x32x16_bf16 v[80:95], v[208:211], v[56:59], v[80:95]
  v_mfma_f32_32x32x16_bf16 v[96:111], v[212:215], v[56:59], v[96:111]
  v_mfma_f32_32x32x16_bf16 v[112:127], v[56:59], v[216:219], v[112:127]
  s_add_u32 s29, s27, 26624
  buffer_load_dwordx4 v[56:59], v2, s[8:11], s29 offen sc1
  ds_read_b128 v[208:211], v3 offset:12288
  ds_read_b128 v[212:215], v3 offset:53248
  ds_read_b128 v[216:219], v4 offset:28672
  s_waitcnt lgkmcnt(3)
  s_waitcnt vmcnt(15)
  v_mfma_f32_32x32x16_bf16 v[80:95], v[220:223], v[60:63], v[80:95]
  v_mfma_f32_32x32x16_bf16 v[96:111], v[224:227], v[60:63], v[96:111]
  v_mfma_f32_32x32x16_bf16 v[112:127], v[60:63], v[228:231], v[112:127]
  s_add_u32 s29, s27, 27648
  buffer_load_dwordx4 v[60:63], v2, s[8:11], s29 offen sc1
  ds_read_b128 v[220:223], v3 offset:13312
  ds_read_b128 v[224:227], v3 offset:54272
  ds_read_b128 v[228:231], v4 offset:29696
  s_waitcnt lgkmcnt(3)
  s_waitcnt vmcnt(15)
  v_mfma_f32_32x32x16_bf16 v[80:95], v[208:211], v[64:67], v[80:95]
  v_mfma_f32_32x32x16_bf16 v[96:111], v[212:215], v[64:67], v[96:111]
  v_mfma_f32_32x32x16_bf16 v[112:127], v[64:67], v[216:219], v[112:127]
  s_add_u32 s29, s27, 28672
  buffer_load_dwordx4 v[64:67], v2, s[8:11], s29 offen sc1
  ds_read_b128 v[208:211], v3 offset:14336
  ds_read_b128 v[212:215], v3 offset:55296
  ds_read_b128 v[216:219], v4 offset:30720
  s_waitcnt lgkmcnt(3)
  s_waitcnt vmcnt(15)
  v_mfma_f32_32x32x16_bf16 v[80:95], v[220:223], v[68:71], v[80:95]
  v_mfma_f32_32x32x16_bf16 v[96:111], v[224:227], v[68:71], v[96:111]
  v_mfma_f32_32x32x16_bf16 v[112:127], v[68:71], v[228:231], v[112:127]
  s_add_u32 s29, s27, 29696
  buffer_load_dwordx4 v[68:71], v2, s[8:11], s29 offen sc1
  ds_read_b128 v[220:223], v3 offset:15360
  ds_read_b128 v[224:227], v3 offset:56320
  ds_read_b128 v[228:231], v4 offset:31744
  s_waitcnt lgkmcnt(3)
  s_waitcnt vmcnt(15)
  v_mfma_f32_32x32x16_bf16 v[80:95], v[208:211], v[72:75], v[80:95]
  v_mfma_f32_32x32x16_bf16 v[96:111], v[212:215], v[72:75], v[96:111]
  v_mfma_f32_32x32x16_bf16 v[112:127], v[72:75], v[216:219], v[112:127]
  s_add_u32 s29, s27, 30720
  buffer_load_dwordx4 v[72:75], v2, s[8:11], s29 offen sc1
  ds_read_b128 v[208:211], v3 offset:16384
  ds_read_b128 v[212:215], v3 offset:57344
  ds_read_b128 v[216:219], v4 offset:32768
  s_waitcnt lgkmcnt(3)
  s_waitcnt vmcnt(15)
  v_mfma_f32_32x32x16_bf16 v[80:95], v[220:223], v[76:79], v[80:95]
  v_mfma_f32_32x32x16_bf16 v[96:111], v[224:227], v[76:79], v[96:111]
  v_mfma_f32_32x32x16_bf16 v[112:127], v[76:79], v[228:231], v[112:127]
  s_add_u32 s29, s27, 31744
  buffer_load_dwordx4 v[76:79], v2, s[8:11], s29 offen sc1
  ds_read_b128 v[220:223], v3 offset:17408
  ds_read_b128 v[224:227], v3 offset:58368
  ds_read_b128 v[228:231], v4 offset:33792
  s_waitcnt lgkmcnt(3)
  s_waitcnt vmcnt(15)
  v_mfma_f32_32x32x16_bf16 v[80:95], v[208:211], v[16:19], v[80:95]
  v_mfma_f32_32x32x16_bf16 v[96:111], v[212:215], v[16:19], v[96:111]
  v_mfma_f32_32x32x16_bf16 v[112:127], v[16:19], v[216:219], v[112:127]
  s_add_u32 s29, s27, 32768
  buffer_load_dwordx4 v[16:19], v2, s[8:11], s29 offen sc1
  ds_read_b128 v[208:211], v3 offset:18432
  ds_read_b128 v[212:215], v3 offset:59392
  ds_read_b128 v[216:219], v4 offset:34816
  s_waitcnt lgkmcnt(3)
  s_waitcnt vmcnt(15)
  v_mfma_f32_32x32x16_bf16 v[80:95], v[220:223], v[20:23], v[80:95]
  v_mfma_f32_32x32x16_bf16 v[96:111], v[224:227], v[20:23], v[96:111]
  v_mfma_f32_32x32x16_bf16 v[112:127], v[20:23], v[228:231], v[112:127]
  s_add_u32 s29, s27, 33792
  buffer_load_dwordx4 v[20:23], v2, s[8:11], s29 offen sc1
  ds_read_b128 v[220:223], v3 offset:19456
  ds_read_b128 v[224:227], v3 offset:60416
  ds_read_b128 v[228:231], v4 offset:35840
  s_waitcnt lgkmcnt(3)
  s_waitcnt vmcnt(15)
  v_mfma_f32_32x32x16_bf16 v[80:95], v[208:211], v[24:27], v[80:95]
  v_mfma_f32_32x32x16_bf16 v[96:111], v[212:215], v[24:27], v[96:111]
  v_mfma_f32_32x32x16_bf16 v[112:127], v[24:27], v[216:219], v[112:127]
  s_add_u32 s29, s27, 34816
  buffer_load_dwordx4 v[24:27], v2, s[8:11], s29 offen sc1
  ds_read_b128 v[208:211], v3 offset:20480
  ds_read_b128 v[212:215], v3 offset:61440
  ds_read_b128 v[216:219], v4 offset:36864
  s_waitcnt lgkmcnt(3)
  s_waitcnt vmcnt(15)
  v_mfma_f32_32x32x16_bf16 v[80:95], v[220:223], v[28:31], v[80:95]
  v_mfma_f32_32x32x16_bf16 v[96:111], v[224:227], v[28:31], v[96:111]
  v_mfma_f32_32x32x16_bf16 v[112:127], v[28:31], v[228:231], v[112:127]
  s_add_u32 s29, s27, 35840
  buffer_load_dwordx4 v[28:31], v2, s[8:11], s29 offen sc1
  ds_read_b128 v[220:223], v3 offset:21504
  ds_read_b128 v[224:227], v3 offset:62464
  ds_read_b128 v[228:231], v4 offset:37888
  s_waitcnt lgkmcnt(3)
  s_waitcnt vmcnt(15)
  v_mfma_f32_32x32x16_bf16 v[80:95], v[208:211], v[32:35], v[80:95]
  v_mfma_f32_32x32x16_bf16 v[96:111], v[212:215], v[32:35], v[96:111]
  v_mfma_f32_32x32x16_bf16 v[112:127], v[32:35], v[216:219], v[112:127]
  s_add_u32 s29, s27, 36864
  buffer_load_dwordx4 v[32:35], v2, s[8:11], s29 offen sc1
  ds_read_b128 v[208:211], v3 offset:22528
  ds_read_b128 v[212:215], v3 offset:63488
  ds_read_b128 v[216:219], v4 offset:38912
  s_waitcnt lgkmcnt(3)
  s_waitcnt vmcnt(15)
  v_mfma_f32_32x32x16_bf16 v[80:95], v[220:223], v[36:39], v[80:95]
  v_mfma_f32_32x32x16_bf16 v[96:111], v[224:227], v[36:39], v[96:111]
  v_mfma_f32_32x32x16_bf16 v[112:127], v[36:39], v[228:231], v[112:127]
  s_add_u32 s29, s27, 37888
  buffer_load_dwordx4 v[36:39], v2, s[8:11], s29 offen sc1
  ds_read_b128 v[220:223], v3 offset:23552
  ds_read_b128 v[224:227], v3 offset:64512
  ds_read_b128 v[228:231], v4 offset:39936
  s_waitcnt lgkmcnt(3)
  s_waitcnt vmcnt(15)
  v_mfma_f32_32x32x16_bf16 v[80:95], v[208:211], v[40:43], v[80:95]
  v_mfma_f32_32x32x16_bf16 v[96:111], v[212:215], v[40:43], v[96:111]
  v_mfma_f32_32x32x16_bf16 v[112:127], v[40:43], v[216:219], v[112:127]
  s_add_u32 s29, s27, 38912
  buffer_load_dwordx4 v[40:43], v2, s[8:11], s29 offen sc1
  ds_read_b128 v[208:211], v3 offset:24576
  ds_read_b128 v[212:215], v4 offset:0
  ds_read_b128 v[216:219], v4 offset:40960
  s_waitcnt lgkmcnt(3)
  s_waitcnt vmcnt(15)
  v_mfma_f32_32x32x16_bf16 v[80:95], v[220:223], v[44:47], v[80:95]
  v_mfma_f32_32x32x16_bf16 v[96:111], v[224:227], v[44:47], v[96:111]
  v_mfma_f32_32x32x16_bf16 v[112:127], v[44:47], v[228:231], v[112:127]
  s_add_u32 s29, s27, 39936
  buffer_load_dwordx4 v[44:47], v2, s[8:11], s29 offen sc1
  ds_read_b128 v[220:223], v3 offset:25600
  ds_read_b128 v[224:227], v4 offset:1024
  ds_read_b128 v[228:231], v4 offset:41984
  s_waitcnt lgkmcnt(3)
  s_waitcnt vmcnt(15)
  v_mfma_f32_32x32x16_bf16 v[80:95], v[208:211], v[48:51], v[80:95]
  v_mfma_f32_32x32x16_bf16 v[96:111], v[212:215], v[48:51], v[96:111]
  v_mfma_f32_32x32x16_bf16 v[112:127], v[48:51], v[216:219], v[112:127]
  s_add_u32 s29, s28, 0
  buffer_load_dwordx4 v[48:51], v2, s[8:11], s29 offen sc1
  ds_read_b128 v[208:211], v3 offset:26624
  ds_read_b128 v[212:215], v4 offset:2048
  ds_read_b128 v[216:219], v4 offset:43008
  s_waitcnt lgkmcnt(3)
  s_waitcnt vmcnt(15)
  v_mfma_f32_32x32x16_bf16 v[80:95], v[220:223], v[52:55], v[80:95]
  v_mfma_f32_32x32x16_bf16 v[96:111], v[224:227], v[52:55], v[96:111]
  v_mfma_f32_32x32x16_bf16 v[112:127], v[52:55], v[228:231], v[112:127]
  s_add_u32 s29, s28, 1024
  buffer_load_dwordx4 v[52:55], v2, s[8:11], s29 offen sc1
  ds_read_b128 v[220:223], v3 offset:27648
  ds_read_b128 v[224:227], v4 offset:3072
  ds_read_b128 v[228:231], v4 offset:44032
  s_waitcnt lgkmcnt(3)
  s_waitcnt vmcnt(15)
  v_mfma_f32_32x32x16_bf16 v[80:95], v[208:211], v[56:59], v[80:95]
  v_mfma_f32_32x32x16_bf16 v[96:111], v[212:215], v[56:59], v[96:111]
  v_mfma_f32_32x32x16_bf16 v[112:127], v[56:59], v[216:219], v[112:127]
  s_add_u32 s29, s28, 2048
  buffer_load_dwordx4 v[56:59], v2, s[8:11], s29 offen sc1
  ds_read_b128 v[208:211], v3 offset:28672
  ds_read_b128 v[212:215], v4 offset:4096
  ds_read_b128 v[216:219], v4 offset:45056
  s_waitcnt lgkmcnt(3)
  s_waitcnt vmcnt(15)
  v_mfma_f32_32x32x16_bf16 v[80:95], v[220:223], v[60:63], v[80:95]
  v_mfma_f32_32x32x16_bf16 v[96:111], v[224:227], v[60:63], v[96:111]
  v_mfma_f32_32x32x16_bf16 v[112:127], v[60:63], v[228:231], v[112:127]
  s_add_u32 s29, s28, 3072
  buffer_load_dwordx4 v[60:63], v2, s[8:11], s29 offen sc1
  ds_read_b128 v[220:223], v3 offset:29696
  ds_read_b128 v[224:227], v4 offset:5120
  ds_read_b128 v[228:231], v4 offset:46080
  s_waitcnt lgkmcnt(3)
  s_waitcnt vmcnt(15)
  v_mfma_f32_32x32x16_bf16 v[80:95], v[208:211], v[64:67], v[80:95]
  v_mfma_f32_32x32x16_bf16 v[96:111], v[212:215], v[64:67], v[96:111]
  v_mfma_f32_32x32x16_bf16 v[112:127], v[64:67], v[216:219], v[112:127]
  s_add_u32 s29, s28, 4096
  buffer_load_dwordx4 v[64:67], v2, s[8:11], s29 offen sc1
  ds_read_b128 v[208:211], v3 offset:30720
  ds_read_b128 v[212:215], v4 offset:6144
  ds_read_b128 v[216:219], v4 offset:47104
  s_waitcnt lgkmcnt(3)
  s_waitcnt vmcnt(15)
  v_mfma_f32_32x32x16_bf16 v[80:95], v[220:223], v[68:71], v[80:95]
  v_mfma_f32_32x32x16_bf16 v[96:111], v[224:227], v[68:71], v[96:111]
  v_mfma_f32_32x32x16_bf16 v[112:127], v[68:71], v[228:231], v[112:127]
  s_add_u32 s29, s28, 5120
  buffer_load_dwordx4 v[68:71], v2, s[8:11], s29 offen sc1
  ds_read_b128 v[220:223], v3 offset:31744
  ds_read_b128 v[224:227], v4 offset:7168
  ds_read_b128 v[228:231], v4 offset:48128
  s_waitcnt lgkmcnt(3)
  s_waitcnt vmcnt(15)
  v_mfma_f32_32x32x16_bf16 v[80:95], v[208:211], v[72:75], v[80:95]
  v_mfma_f32_32x32x16_bf16 v[96:111], v[212:215], v[72:75], v[96:111]
  v_mfma_f32_32x32x16_bf16 v[112:127], v[72:75], v[216:219], v[112:127]
  s_add_u32 s29, s28, 6144
  buffer_load_dwordx4 v[72:75], v2, s[8:11], s29 offen sc1
  ds_read_b128 v[208:211], v3 offset:32768
  ds_read_b128 v[212:215], v4 offset:8192
  ds_read_b128 v[216:219], v4 offset:49152
  s_waitcnt lgkmcnt(3)
  s_waitcnt vmcnt(15)
  v_mfma_f32_32x32x16_bf16 v[80:95], v[220:223], v[76:79], v[80:95]
  v_mfma_f32_32x32x16_bf16 v[96:111], v[224:227], v[76:79], v[96:111]
  v_mfma_f32_32x32x16_bf16 v[112:127], v[76:79], v[228:231], v[112:127]
  s_add_u32 s29, s28, 7168
  buffer_load_dwordx4 v[76:79], v2, s[8:11], s29 offen sc1
  ds_read_b128 v[220:223], v3 offset:33792
  ds_read_b128 v[224:227], v4 offset:9216
  ds_read_b128 v[228:231], v4 offset:50176
  s_waitcnt lgkmcnt(3)
  s_waitcnt vmcnt(15)
  v_mfma_f32_32x32x16_bf16 v[80:95], v[208:211], v[16:19], v[80:95]
  v_mfma_f32_32x32x16_bf16 v[96:111], v[212:215], v[16:19], v[96:111]
  v_mfma_f32_32x32x16_bf16 v[112:127], v[16:19], v[216:219], v[112:127]
  s_add_u32 s29, s28, 8192
  buffer_load_dwordx4 v[16:19], v2, s[8:11], s29 offen sc1
  ds_read_b128 v[208:211], v3 offset:34816
  ds_read_b128 v[212:215], v4 offset:10240
  ds_read_b128 v[216:219], v4 offset:51200
  s_waitcnt lgkmcnt(3)
  s_waitcnt vmcnt(15)
  v_mfma_f32_32x32x16_bf16 v[80:95], v[220:223], v[20:23], v[80:95]
  v_mfma_f32_32x32x16_bf16 v[96:111], v[224:227], v[20:23], v[96:111]
  v_mfma_f32_32x32x16_bf16 v[112:127], v[20:23], v[228:231], v[112:127]
  s_add_u32 s29, s28, 9216
  buffer_load_dwordx4 v[20:23], v2, s[8:11], s29 offen sc1
  ds_read_b128 v[220:223], v3 offset:35840
  ds_read_b128 v[224:227], v4 offset:11264
  ds_read_b128 v[228:231], v4 offset:52224
  s_waitcnt lgkmcnt(3)
  s_waitcnt vmcnt(15)
  v_mfma_f32_32x32x16_bf16 v[80:95], v[208:211], v[24:27], v[80:95]
  v_mfma_f32_32x32x16_bf16 v[96:111], v[212:215], v[24:27], v[96:111]
  v_mfma_f32_32x32x16_bf16 v[112:127], v[24:27], v[216:219], v[112:127]
  s_add_u32 s29, s28, 10240
  buffer_load_dwordx4 v[24:27], v2, s[8:11], s29 offen sc1
  ds_read_b128 v[208:211], v3 offset:36864
  ds_read_b128 v[212:215], v4 offset:12288
  ds_read_b128 v[216:219], v4 offset:53248
  s_waitcnt lgkmcnt(3)
  s_waitcnt vmcnt(15)
  v_mfma_f32_32x32x16_bf16 v[80:95], v[220:223], v[28:31], v[80:95]
  v_mfma_f32_32x32x16_bf16 v[96:111], v[224:227], v[28:31], v[96:111]
  v_mfma_f32_32x32x16_bf16 v[112:127], v[28:31], v[228:231], v[112:127]
  s_add_u32 s29, s28, 11264
  buffer_load_dwordx4 v[28:31], v2, s[8:11], s29 offen sc1
  ds_read_b128 v[220:223], v3 offset:37888
  ds_read_b128 v[224:227], v4 offset:13312
  ds_read_b128 v[228:231], v4 offset:54272
  s_waitcnt lgkmcnt(3)
  s_waitcnt vmcnt(15)
  v_mfma_f32_32x32x16_bf16 v[80:95], v[208:211], v[32:35], v[80:95]
  v_mfma_f32_32x32x16_bf16 v[96:111], v[212:215], v[32:35], v[96:111]
  v_mfma_f32_32x32x16_bf16 v[112:127], v[32:35], v[216:219], v[112:127]
  s_add_u32 s29, s28, 12288
  buffer_load_dwordx4 v[32:35], v2, s[8:11], s29 offen sc1
  ds_read_b128 v[208:211], v3 offset:38912
  ds_read_b128 v[212:215], v4 offset:14336
  ds_read_b128 v[216:219], v4 offset:55296
  s_waitcnt lgkmcnt(3)
  s_waitcnt vmcnt(15)
  v_mfma_f32_32x32x16_bf16 v[80:95], v[220:223], v[36:39], v[80:95]
  v_mfma_f32_32x32x16_bf16 v[96:111], v[224:227], v[36:39], v[96:111]
  v_mfma_f32_32x32x16_bf16 v[112:127], v[36:39], v[228:231], v[112:127]
  s_add_u32 s29, s28, 13312
  buffer_load_dwordx4 v[36:39], v2, s[8:11], s29 offen sc1
  ds_read_b128 v[220:223], v3 offset:39936
  ds_read_b128 v[224:227], v4 offset:15360
  ds_read_b128 v[228:231], v4 offset:56320
  s_waitcnt lgkmcnt(3)
  s_waitcnt vmcnt(15)
  v_mfma_f32_32x32x16_bf16 v[80:95], v[208:211], v[40:43], v[80:95]
  v_mfma_f32_32x32x16_bf16 v[96:111], v[212:215], v[40:43], v[96:111]
  v_mfma_f32_32x32x16_bf16 v[112:127], v[40:43], v[216:219], v[112:127]
  s_add_u32 s29, s28, 14336
  buffer_load_dwordx4 v[40:43], v2, s[8:11], s29 offen sc1
  ds_read_b128 v[208:211], v3 offset:0
  ds_read_b128 v[212:215], v3 offset:40960
  ds_read_b128 v[216:219], v4 offset:16384
  s_waitcnt lgkmcnt(3)
  s_waitcnt vmcnt(15)
  v_mfma_f32_32x32x16_bf16 v[80:95], v[220:223], v[44:47], v[80:95]
  v_mfma_f32_32x32x16_bf16 v[96:111], v[224:227], v[44:47], v[96:111]
  v_mfma_f32_32x32x16_bf16 v[112:127], v[44:47], v[228:231], v[112:127]
  s_add_u32 s29, s28, 15360
  buffer_load_dwordx4 v[44:47], v2, s[8:11], s29 offen sc1
  ds_read_b128 v[220:223], v3 offset:1024
  ds_read_b128 v[224:227], v3 offset:41984
  ds_read_b128 v[228:231], v4 offset:17408
  s_waitcnt lgkmcnt(3)
  s_waitcnt vmcnt(15)
  v_mfma_f32_32x32x16_bf16 v[128:143], v[208:211], v[48:51], 0
  v_mfma_f32_32x32x16_bf16 v[144:159], v[212:215], v[48:51], 0
  v_mfma_f32_32x32x16_bf16 v[160:175], v[48:51], v[216:219], 0
  s_add_u32 s29, s28, 16384
  buffer_load_dwordx4 v[48:51], v2, s[8:11], s29 offen sc1
  ds_read_b128 v[208:211], v3 offset:2048
  ds_read_b128 v[212:215], v3 offset:43008
  ds_read_b128 v[216:219], v4 offset:18432
  s_waitcnt lgkmcnt(3)
  s_waitcnt vmcnt(15)
  v_mfma_f32_32x32x16_bf16 v[128:143], v[220:223], v[52:55], v[128:143]
  v_mfma_f32_32x32x16_bf16 v[144:159], v[224:227], v[52:55], v[144:159]
  v_mfma_f32_32x32x16_bf16 v[160:175], v[52:55], v[228:231], v[160:175]
  s_add_u32 s29, s28, 17408
  buffer_load_dwordx4 v[52:55], v2, s[8:11], s29 offen sc1
  ds_read_b128 v[220:223], v3 offset:3072
  ds_read_b128 v[224:227], v3 offset:44032
  ds_read_b128 v[228:231], v4 offset:19456
  s_waitcnt lgkmcnt(3)
  s_waitcnt vmcnt(15)
  v_mfma_f32_32x32x16_bf16 v[128:143], v[208:211], v[56:59], v[128:143]
  v_max3_f32 v9, v9, abs(v96), abs(v97)
  v_max3_f32 v9, v9, abs(v98), abs(v99)
  v_mfma_f32_32x32x16_bf16 v[144:159], v[212:215], v[56:59], v[144:159]
  v_max3_f32 v9, v9, abs(v100), abs(v101)
  v_max3_f32 v9, v9, abs(v102), abs(v103)
  v_mfma_f32_32x32x16_bf16 v[160:175], v[56:59], v[216:219], v[160:175]
  v_max3_f32 v9, v9, abs(v104), abs(v105)
  v_max3_f32 v9, v9, abs(v106), abs(v107)
  s_add_u32 s29, s28, 18432
  buffer_load_dwordx4 v[56:59], v2, s[8:11], s29 offen sc1
  ds_read_b128 v[208:211], v3 offset:4096
  ds_read_b128 v[212:215], v3 offset:45056
  ds_read_b128 v[216:219], v4 offset:20480
  s_waitcnt lgkmcnt(3)
  s_waitcnt vmcnt(15)
  v_mfma_f32_32x32x16_bf16 v[128:143], v[220:223], v[60:63], v[128:143]
  v_max3_f32 v9, v9, abs(v108), abs(v109)
  v_max3_f32 v9, v9, abs(v110), abs(v111)
  v_mfma_f32_32x32x16_bf16 v[144:159], v[224:227], v[60:63], v[144:159]
  v_add_f32 v108, v108, v6
  v_cvt_pk_bf16_f32 v232, v96, v97
  v_mfma_f32_32x32x16_bf16 v[160:175], v[60:63], v[228:231], v[160:175]
  v_cvt_pk_bf16_f32 v233, v98, v99
  v_cvt_pk_bf16_f32 v234, v100, v101
  s_add_u32 s29, s28, 19456
  buffer_load_dwordx4 v[60:63], v2, s[8:11], s29 offen sc1
  ds_read_b128 v[220:223], v3 offset:5120
  ds_read_b128 v[224:227], v3 offset:46080
  ds_read_b128 v[228:231], v4 offset:21504
  s_waitcnt lgkmcnt(3)
  s_waitcnt vmcnt(15)
  v_mfma_f32_32x32x16_bf16 v[128:143], v[208:211], v[64:67], v[128:143]
  v_cvt_pk_bf16_f32 v235, v102, v103
  v_cvt_pk_bf16_f32 v236, v104, v105
  v_mfma_f32_32x32x16_bf16 v[144:159], v[212:215], v[64:67], v[144:159]
  v_cvt_pk_bf16_f32 v237, v106, v107
  v_cvt_pk_bf16_f32 v238, v108, v109
  v_mfma_f32_32x32x16_bf16 v[160:175], v[64:67], v[216:219], v[160:175]
  v_cvt_pk_bf16_f32 v239, v110, v111
  s_add_u32 s26, s31, 245366784
  s_add_u32 s29, s28, 20480
  buffer_load_dwordx4 v[64:67], v2, s[8:11], s29 offen sc1
  ds_read_b128 v[208:211], v3 offset:6144
  ds_read_b128 v[212:215], v3 offset:47104
  ds_read_b128 v[216:219], v4 offset:22528
  s_waitcnt lgkmcnt(3)
  s_waitcnt vmcnt(15)
  v_mfma_f32_32x32x16_bf16 v[128:143], v[220:223], v[68:71], v[128:143]
  buffer_store_dwordx4 v[232:235], v2, s[8:11], s26 offen sc1
  buffer_store_dwordx4 v[236:239], v2, s[8:11], s26 offen offset:1024 sc1
  v_mfma_f32_32x32x16_bf16 v[144:159], v[224:227], v[68:71], v[144:159]
  v_cndmask_b32 v112, v112, v8, s[32:33]
  v_cndmask_b32 v113, v113, v8, s[32:33]
  v_mfma_f32_32x32x16_bf16 v[160:175], v[68:71], v[228:231], v[160:175]
  v_cndmask_b32 v114, v114, v8, s[32:33]
  v_cndmask_b32 v115, v115, v8, s[32:33]
  s_add_u32 s29, s28, 21504
  buffer_load_dwordx4 v[68:71], v2, s[8:11], s29 offen sc1
  ds_read_b128 v[220:223], v3 offset:7168
  ds_read_b128 v[224:227], v3 offset:48128
  ds_read_b128 v[228:231], v4 offset:23552
  s_waitcnt lgkmcnt(3)
  s_waitcnt vmcnt(17)
  v_mfma_f32_32x32x16_bf16 v[128:143], v[208:211], v[72:75], v[128:143]
  v_cndmask_b32 v116, v116, v8, s[32:33]
  v_cndmask_b32 v117, v117, v8, s[32:33]
  v_mfma_f32_32x32x16_bf16 v[144:159], v[212:215], v[72:75], v[144:159]
  v_cndmask_b32 v118, v118, v8, s[32:33]
  v_cndmask_b32 v119, v119, v8, s[32:33]
  v_mfma_f32_32x32x16_bf16 v[160:175], v[72:75], v[216:219], v[160:175]
  v_cndmask_b32 v120, v120, v8, s[32:33]
  v_cndmask_b32 v121, v121, v8, s[32:33]
  s_add_u32 s29, s28, 22528
  buffer_load_dwordx4 v[72:75], v2, s[8:11], s29 offen sc1
  ds_read_b128 v[208:211], v3 offset:8192
  ds_read_b128 v[212:215], v3 offset:49152
  ds_read_b128 v[216:219], v4 offset:24576
  s_waitcnt lgkmcnt(3)
  s_waitcnt vmcnt(17)
  v_mfma_f32_32x32x16_bf16 v[128:143], v[220:223], v[76:79], v[128:143]
  v_cndmask_b32 v122, v122, v8, s[32:33]
  v_cndmask_b32 v123, v123, v8, s[32:33]
  v_mfma_f32_32x32x16_bf16 v[144:159], v[224:227], v[76:79], v[144:159]
  v_cndmask_b32 v124, v124, v8, s[32:33]
  v_cndmask_b32 v125, v125, v8, s[32:33]
  v_mfma_f32_32x32x16_bf16 v[160:175], v[76:79], v[228:231], v[160:175]
  v_cndmask_b32 v126, v126, v8, s[32:33]
  v_cndmask_b32 v127, v127, v8, s[32:33]
  s_add_u32 s29, s28, 23552
  buffer_load_dwordx4 v[76:79], v2, s[8:11], s29 offen sc1
  ds_read_b128 v[220:223], v3 offset:9216
  ds_read_b128 v[224:227], v3 offset:50176
  ds_read_b128 v[228:231], v4 offset:25600
  s_waitcnt lgkmcnt(3)
  s_waitcnt vmcnt(17)
  v_mfma_f32_32x32x16_bf16 v[128:143], v[208:211], v[16:19], v[128:143]
  v_cvt_pk_bf16_f32 v240, v112, v113
  v_cvt_pk_bf16_f32 v241, v114, v115
  v_mfma_f32_32x32x16_bf16 v[144:159], v[212:215], v[16:19], v[144:159]
  v_cvt_pk_bf16_f32 v242, v116, v117
  v_cvt_pk_bf16_f32 v243, v118, v119
  v_mfma_f32_32x32x16_bf16 v[160:175], v[16:19], v[216:219], v[160:175]
  v_cvt_pk_bf16_f32 v244, v120, v121
  v_cvt_pk_bf16_f32 v245, v122, v123
  s_add_u32 s29, s28, 24576
  buffer_load_dwordx4 v[16:19], v2, s[8:11], s29 offen sc1
  ds_read_b128 v[208:211], v3 offset:10240
  ds_read_b128 v[212:215], v3 offset:51200
  ds_read_b128 v[216:219], v4 offset:26624
  s_waitcnt lgkmcnt(3)
  s_waitcnt vmcnt(17)
  v_mfma_f32_32x32x16_bf16 v[128:143], v[220:223], v[20:23], v[128:143]
  v_cvt_pk_bf16_f32 v246, v124, v125
  v_cvt_pk_bf16_f32 v247, v126, v127
  v_mfma_f32_32x32x16_bf16 v[144:159], v[224:227], v[20:23], v[144:159]
  s_add_u32 s26, s31, 249561088
  buffer_store_dwordx4 v[240:243], v2, s[8:11], s26 offen sc1
  v_mfma_f32_32x32x16_bf16 v[160:175], v[20:23], v[228:231], v[160:175]
  buffer_store_dwordx4 v[244:247], v2, s[8:11], s26 offen offset:1024 sc1
  v_mul_f32 v80, s30, v80
  s_add_u32 s29, s28, 25600
  buffer_load_dwordx4 v[20:23], v2, s[8:11], s29 offen sc1
  ds_read_b128 v[220:223], v3 offset:11264
  ds_read_b128 v[224:227], v3 offset:52224
  ds_read_b128 v[228:231], v4 offset:27648
  s_waitcnt lgkmcnt(3)
  s_waitcnt vmcnt(19)
  v_mfma_f32_32x32x16_bf16 v[128:143], v[208:211], v[24:27], v[128:143]
  v_mul_f32 v81, s30, v81
  v_mul_f32 v82, s30, v82
  v_mfma_f32_32x32x16_bf16 v[144:159], v[212:215], v[24:27], v[144:159]
  v_mul_f32 v83, s30, v83
  v_mul_f32 v84, s30, v84
  v_mfma_f32_32x32x16_bf16 v[160:175], v[24:27], v[216:219], v[160:175]
  v_mul_f32 v85, s30, v85
  v_mul_f32 v86, s30, v86
  s_add_u32 s29, s28, 26624
  buffer_load_dwordx4 v[24:27], v2, s[8:11], s29 offen sc1
  ds_read_b128 v[208:211], v3 offset:12288
  ds_read_b128 v[212:215], v3 offset:53248
  ds_read_b128 v[216:219], v4 offset:28672
  s_waitcnt lgkmcnt(3)
  s_waitcnt vmcnt(19)
  v_mfma_f32_32x32x16_bf16 v[128:143], v[220:223], v[28:31], v[128:143]
  v_mul_f32 v87, s30, v87
  v_mul_f32 v88, s30, v88
  v_mfma_f32_32x32x16_bf16 v[144:159], v[224:227], v[28:31], v[144:159]
  v_mul_f32 v89, s30, v89
  v_mul_f32 v90, s30, v90
  v_mfma_f32_32x32x16_bf16 v[160:175], v[28:31], v[228:231], v[160:175]
  v_mul_f32 v91, s30, v91
  v_mul_f32 v92, s30, v92
  s_add_u32 s29, s28, 27648
  buffer_load_dwordx4 v[28:31], v2, s[8:11], s29 offen sc1
  ds_read_b128 v[220:223], v3 offset:13312
  ds_read_b128 v[224:227], v3 offset:54272
  ds_read_b128 v[228:231], v4 offset:29696
  s_waitcnt lgkmcnt(3)
  s_waitcnt vmcnt(19)
  v_mfma_f32_32x32x16_bf16 v[128:143], v[208:211], v[32:35], v[128:143]
  v_mul_f32 v93, s30, v93
  v_mul_f32 v94, s30, v94
  v_mfma_f32_32x32x16_bf16 v[144:159], v[212:215], v[32:35], v[144:159]
  v_mul_f32 v95, s30, v95
  v_cvt_pk_bf16_f32 v192, v80, v81
  v_mfma_f32_32x32x16_bf16 v[160:175], v[32:35], v[216:219], v[160:175]
  v_cvt_pk_bf16_f32 v193, v82, v83
  v_cvt_pk_bf16_f32 v194, v84, v85
  s_add_u32 s29, s28, 28672
  buffer_load_dwordx4 v[32:35], v2, s[8:11], s29 offen sc1
  ds_read_b128 v[208:211], v3 offset:14336
  ds_read_b128 v[212:215], v3 offset:55296
  ds_read_b128 v[216:219], v4 offset:30720
  s_waitcnt lgkmcnt(3)
  s_waitcnt vmcnt(19)
  v_mfma_f32_32x32x16_bf16 v[128:143], v[220:223], v[36:39], v[128:143]
  v_cvt_pk_bf16_f32 v195, v86, v87
  v_cvt_pk_bf16_f32 v196, v88, v89
  v_mfma_f32_32x32x16_bf16 v[144:159], v[224:227], v[36:39], v[144:159]
  v_cvt_pk_bf16_f32 v197, v90, v91
  v_cvt_pk_bf16_f32 v198, v92, v93
  v_mfma_f32_32x32x16_bf16 v[160:175], v[36:39], v[228:231], v[160:175]
  v_cvt_pk_bf16_f32 v199, v94, v95
  s_add_u32 s29, s28, 29696
  buffer_load_dwordx4 v[36:39], v2, s[8:11], s29 offen sc1
  ds_read_b128 v[220:223], v3 offset:15360
  ds_read_b128 v[224:227], v3 offset:56320
  ds_read_b128 v[228:231], v4 offset:31744
  s_waitcnt lgkmcnt(3)
  s_waitcnt vmcnt(19)
  v_mfma_f32_32x32x16_bf16 v[128:143], v[208:211], v[40:43], v[128:143]
  v_mfma_f32_32x32x16_bf16 v[144:159], v[212:215], v[40:43], v[144:159]
  v_mfma_f32_32x32x16_bf16 v[160:175], v[40:43], v[216:219], v[160:175]
  s_add_u32 s29, s28, 30720
  buffer_load_dwordx4 v[40:43], v2, s[8:11], s29 offen sc1
  ds_read_b128 v[208:211], v3 offset:16384
  ds_read_b128 v[212:215], v3 offset:57344
  ds_read_b128 v[216:219], v4 offset:32768
  s_waitcnt lgkmcnt(3)
  s_waitcnt vmcnt(19)
  v_mfma_f32_32x32x16_bf16 v[128:143], v[220:223], v[44:47], v[128:143]
  v_mfma_f32_32x32x16_bf16 v[144:159], v[224:227], v[44:47], v[144:159]
  v_mfma_f32_32x32x16_bf16 v[160:175], v[44:47], v[228:231], v[160:175]
  s_add_u32 s29, s28, 31744
  buffer_load_dwordx4 v[44:47], v2, s[8:11], s29 offen sc1
  ds_read_b128 v[220:223], v3 offset:17408
  ds_read_b128 v[224:227], v3 offset:58368
  ds_read_b128 v[228:231], v4 offset:33792
  s_waitcnt lgkmcnt(3)
  s_waitcnt vmcnt(19)
  v_mfma_f32_32x32x16_bf16 v[128:143], v[208:211], v[48:51], v[128:143]
  v_mfma_f32_32x32x16_bf16 v[144:159], v[212:215], v[48:51], v[144:159]
  v_mfma_f32_32x32x16_bf16 v[160:175], v[48:51], v[216:219], v[160:175]
  s_add_u32 s29, s28, 32768
  buffer_load_dwordx4 v[48:51], v2, s[8:11], s29 offen sc1
  ds_read_b128 v[208:211], v3 offset:18432
  ds_read_b128 v[212:215], v3 offset:59392
  ds_read_b128 v[216:219], v4 offset:34816
  s_waitcnt lgkmcnt(3)
  s_waitcnt vmcnt(19)
  v_mfma_f32_32x32x16_bf16 v[128:143], v[220:223], v[52:55], v[128:143]
  v_mfma_f32_32x32x16_bf16 v[144:159], v[224:227], v[52:55], v[144:159]
  v_mfma_f32_32x32x16_bf16 v[160:175], v[52:55], v[228:231], v[160:175]
  s_add_u32 s29, s28, 33792
  buffer_load_dwordx4 v[52:55], v2, s[8:11], s29 offen sc1
  ds_read_b128 v[220:223], v3 offset:19456
  ds_read_b128 v[224:227], v3 offset:60416
  ds_read_b128 v[228:231], v4 offset:35840
  s_waitcnt lgkmcnt(3)
  s_waitcnt vmcnt(19)
  v_mfma_f32_32x32x16_bf16 v[128:143], v[208:211], v[56:59], v[128:143]
  v_mfma_f32_32x32x16_bf16 v[144:159], v[212:215], v[56:59], v[144:159]
  v_mfma_f32_32x32x16_bf16 v[160:175], v[56:59], v[216:219], v[160:175]
  s_add_u32 s29, s28, 34816
  buffer_load_dwordx4 v[56:59], v2, s[8:11], s29 offen sc1
  ds_read_b128 v[208:211], v3 offset:20480
  ds_read_b128 v[212:215], v3 offset:61440
  ds_read_b128 v[216:219], v4 offset:36864
  s_waitcnt lgkmcnt(3)
  s_waitcnt vmcnt(19)
  v_mfma_f32_32x32x16_bf16 v[128:143], v[220:223], v[60:63], v[128:143]
  v_mfma_f32_32x32x16_bf16 v[144:159], v[224:227], v[60:63], v[144:159]
  v_mfma_f32_32x32x16_bf16 v[160:175], v[60:63], v[228:231], v[160:175]
  s_add_u32 s29, s28, 35840
  buffer_load_dwordx4 v[60:63], v2, s[8:11], s29 offen sc1
  ds_read_b128 v[220:223], v3 offset:21504
  ds_read_b128 v[224:227], v3 offset:62464
  ds_read_b128 v[228:231], v4 offset:37888
  s_waitcnt lgkmcnt(3)
  s_waitcnt vmcnt(19)
  v_mfma_f32_32x32x16_bf16 v[128:143], v[208:211], v[64:67], v[128:143]
  v_mfma_f32_32x32x16_bf16 v[144:159], v[212:215], v[64:67], v[144:159]
  v_mfma_f32_32x32x16_bf16 v[160:175], v[64:67], v[216:219], v[160:175]
  s_add_u32 s29, s28, 36864
  buffer_load_dwordx4 v[64:67], v2, s[8:11], s29 offen sc1
  ds_read_b128 v[208:211], v3 offset:22528
  ds_read_b128 v[212:215], v3 offset:63488
  ds_read_b128 v[216:219], v4 offset:38912
  s_waitcnt lgkmcnt(3)
  s_waitcnt vmcnt(17)
  v_mfma_f32_32x32x16_bf16 v[128:143], v[220:223], v[68:71], v[128:143]
  v_mfma_f32_32x32x16_bf16 v[144:159], v[224:227], v[68:71], v[144:159]
  v_mfma_f32_32x32x16_bf16 v[160:175], v[68:71], v[228:231], v[160:175]
  s_add_u32 s29, s28, 37888
  buffer_load_dwordx4 v[68:71], v2, s[8:11], s29 offen sc1
  ds_read_b128 v[220:223], v3 offset:23552
  ds_read_b128 v[224:227], v3 offset:64512
  ds_read_b128 v[228:231], v4 offset:39936
  s_waitcnt lgkmcnt(3)
  s_waitcnt vmcnt(17)
  v_mfma_f32_32x32x16_bf16 v[128:143], v[208:211], v[72:75], v[128:143]
  v_mfma_f32_32x32x16_bf16 v[144:159], v[212:215], v[72:75], v[144:159]
  v_mfma_f32_32x32x16_bf16 v[160:175], v[72:75], v[216:219], v[160:175]
  s_add_u32 s29, s28, 38912
  buffer_load_dwordx4 v[72:75], v2, s[8:11], s29 offen sc1
  ds_read_b128 v[208:211], v3 offset:24576
  ds_read_b128 v[212:215], v4 offset:0
  ds_read_b128 v[216:219], v4 offset:40960
  s_waitcnt lgkmcnt(3)
  s_waitcnt vmcnt(17)
  v_mfma_f32_32x32x16_bf16 v[128:143], v[220:223], v[76:79], v[128:143]
  v_mfma_f32_32x32x16_bf16 v[144:159], v[224:227], v[76:79], v[144:159]
  v_mfma_f32_32x32x16_bf16 v[160:175], v[76:79], v[228:231], v[160:175]
  s_add_u32 s29, s28, 39936
  buffer_load_dwordx4 v[76:79], v2, s[8:11], s29 offen sc1
  ds_read_b128 v[220:223], v3 offset:25600
  ds_read_b128 v[224:227], v4 offset:1024
  ds_read_b128 v[228:231], v4 offset:41984
  s_waitcnt lgkmcnt(3)
  s_waitcnt vmcnt(17)
  v_mfma_f32_32x32x16_bf16 v[128:143], v[208:211], v[16:19], v[128:143]
  v_mfma_f32_32x32x16_bf16 v[144:159], v[212:215], v[16:19], v[144:159]
  v_mfma_f32_32x32x16_bf16 v[160:175], v[16:19], v[216:219], v[160:175]
  ds_read_b128 v[208:211], v3 offset:26624
  ds_read_b128 v[212:215], v4 offset:2048
  ds_read_b128 v[216:219], v4 offset:43008
  s_waitcnt lgkmcnt(3)
  s_waitcnt vmcnt(14)
  v_mfma_f32_32x32x16_bf16 v[128:143], v[220:223], v[20:23], v[128:143]
  v_mfma_f32_32x32x16_bf16 v[144:159], v[224:227], v[20:23], v[144:159]
  v_mfma_f32_32x32x16_bf16 v[160:175], v[20:23], v[228:231], v[160:175]
  ds_read_b128 v[220:223], v3 offset:27648
  ds_read_b128 v[224:227], v4 offset:3072
  ds_read_b128 v[228:231], v4 offset:44032
  s_waitcnt lgkmcnt(3)
  s_waitcnt vmcnt(13)
  v_mfma_f32_32x32x16_bf16 v[128:143], v[208:211], v[24:27], v[128:143]
  v_mfma_f32_32x32x16_bf16 v[144:159], v[212:215], v[24:27], v[144:159]
  v_mfma_f32_32x32x16_bf16 v[160:175], v[24:27], v[216:219], v[160:175]
  ds_read_b128 v[208:211], v3 offset:28672
  ds_read_b128 v[212:215], v4 offset:4096
  ds_read_b128 v[216:219], v4 offset:45056
  s_waitcnt lgkmcnt(3)
  s_waitcnt vmcnt(12)
  v_mfma_f32_32x32x16_bf16 v[128:143], v[220:223], v[28:31], v[128:143]
  v_mfma_f32_32x32x16_bf16 v[144:159], v[224:227], v[28:31], v[144:159]
  v_mfma_f32_32x32x16_bf16 v[160:175], v[28:31], v[228:231], v[160:175]
  ds_read_b128 v[220:223], v3 offset:29696
  ds_read_b128 v[224:227], v4 offset:5120
  ds_read_b128 v[228:231], v4 offset:46080
  s_waitcnt lgkmcnt(3)
  s_waitcnt vmcnt(11)
  v_mfma_f32_32x32x16_bf16 v[128:143], v[208:211], v[32:35], v[128:143]
  v_mfma_f32_32x32x16_bf16 v[144:159], v[212:215], v[32:35], v[144:159]
  v_mfma_f32_32x32x16_bf16 v[160:175], v[32:35], v[216:219], v[160:175]
  ds_read_b128 v[208:211], v3 offset:30720
  ds_read_b128 v[212:215], v4 offset:6144
  ds_read_b128 v[216:219], v4 offset:47104
  s_waitcnt lgkmcnt(3)
  s_waitcnt vmcnt(10)
  v_mfma_f32_32x32x16_bf16 v[128:143], v[220:223], v[36:39], v[128:143]
  v_mfma_f32_32x32x16_bf16 v[144:159], v[224:227], v[36:39], v[144:159]
  v_mfma_f32_32x32x16_bf16 v[160:175], v[36:39], v[228:231], v[160:175]
  ds_read_b128 v[220:223], v3 offset:31744
  ds_read_b128 v[224:227], v4 offset:7168
  ds_read_b128 v[228:231], v4 offset:48128
  s_waitcnt lgkmcnt(3)
  s_waitcnt vmcnt(9)
  v_mfma_f32_32x32x16_bf16 v[128:143], v[208:211], v[40:43], v[128:143]
  v_mfma_f32_32x32x16_bf16 v[144:159], v[212:215], v[40:43], v[144:159]
  v_mfma_f32_32x32x16_bf16 v[160:175], v[40:43], v[216:219], v[160:175]
  ds_read_b128 v[208:211], v3 offset:32768
  ds_read_b128 v[212:215], v4 offset:8192
  ds_read_b128 v[216:219], v4 offset:49152
  s_waitcnt lgkmcnt(3)
  s_waitcnt vmcnt(8)
  v_mfma_f32_32x32x16_bf16 v[128:143], v[220:223], v[44:47], v[128:143]
  v_mfma_f32_32x32x16_bf16 v[144:159], v[224:227], v[44:47], v[144:159]
  v_mfma_f32_32x32x16_bf16 v[160:175], v[44:47], v[228:231], v[160:175]
  ds_read_b128 v[220:223], v3 offset:33792
  ds_read_b128 v[224:227], v4 offset:9216
  ds_read_b128 v[228:231], v4 offset:50176
  s_waitcnt lgkmcnt(3)
  s_waitcnt vmcnt(7)
  v_mfma_f32_32x32x16_bf16 v[128:143], v[208:211], v[48:51], v[128:143]
  v_mfma_f32_32x32x16_bf16 v[144:159], v[212:215], v[48:51], v[144:159]
  v_mfma_f32_32x32x16_bf16 v[160:175], v[48:51], v[216:219], v[160:175]
  ds_read_b128 v[208:211], v3 offset:34816
  ds_read_b128 v[212:215], v4 offset:10240
  ds_read_b128 v[216:219], v4 offset:51200
  s_waitcnt lgkmcnt(3)
  s_waitcnt vmcnt(6)
  v_mfma_f32_32x32x16_bf16 v[128:143], v[220:223], v[52:55], v[128:143]
  v_mfma_f32_32x32x16_bf16 v[144:159], v[224:227], v[52:55], v[144:159]
  v_mfma_f32_32x32x16_bf16 v[160:175], v[52:55], v[228:231], v[160:175]
  ds_read_b128 v[220:223], v3 offset:35840
  ds_read_b128 v[224:227], v4 offset:11264
  ds_read_b128 v[228:231], v4 offset:52224
  s_waitcnt lgkmcnt(3)
  s_waitcnt vmcnt(5)
  v_mfma_f32_32x32x16_bf16 v[128:143], v[208:211], v[56:59], v[128:143]
  v_mfma_f32_32x32x16_bf16 v[144:159], v[212:215], v[56:59], v[144:159]
  v_mfma_f32_32x32x16_bf16 v[160:175], v[56:59], v[216:219], v[160:175]
  ds_read_b128 v[208:211], v3 offset:36864
  ds_read_b128 v[212:215], v4 offset:12288
  ds_read_b128 v[216:219], v4 offset:53248
  s_waitcnt lgkmcnt(3)
  s_waitcnt vmcnt(4)
  v_mfma_f32_32x32x16_bf16 v[128:143], v[220:223], v[60:63], v[128:143]
  v_mfma_f32_32x32x16_bf16 v[144:159], v[224:227], v[60:63], v[144:159]
  v_mfma_f32_32x32x16_bf16 v[160:175], v[60:63], v[228:231], v[160:175]
  ds_read_b128 v[220:223], v3 offset:37888
  ds_read_b128 v[224:227], v4 offset:13312
  ds_read_b128 v[228:231], v4 offset:54272
  s_waitcnt lgkmcnt(3)
  s_waitcnt vmcnt(3)
  v_mfma_f32_32x32x16_bf16 v[128:143], v[208:211], v[64:67], v[128:143]
  v_mfma_f32_32x32x16_bf16 v[144:159], v[212:215], v[64:67], v[144:159]
  v_mfma_f32_32x32x16_bf16 v[160:175], v[64:67], v[216:219], v[160:175]
  ds_read_b128 v[208:211], v3 offset:38912
  ds_read_b128 v[212:215], v4 offset:14336
  ds_read_b128 v[216:219], v4 offset:55296
  s_waitcnt lgkmcnt(3)
  s_waitcnt vmcnt(2)
  v_mfma_f32_32x32x16_bf16 v[128:143], v[220:223], v[68:71], v[128:143]
  v_mfma_f32_32x32x16_bf16 v[144:159], v[224:227], v[68:71], v[144:159]
  v_mfma_f32_32x32x16_bf16 v[160:175], v[68:71], v[228:231], v[160:175]
  ds_read_b128 v[220:223], v3 offset:39936
  ds_read_b128 v[224:227], v4 offset:15360
  ds_read_b128 v[228:231], v4 offset:56320
  s_waitcnt lgkmcnt(3)
  s_waitcnt vmcnt(1)
  v_mfma_f32_32x32x16_bf16 v[128:143], v[208:211], v[72:75], v[128:143]
  v_mfma_f32_32x32x16_bf16 v[144:159], v[212:215], v[72:75], v[144:159]
  v_mfma_f32_32x32x16_bf16 v[160:175], v[72:75], v[216:219], v[160:175]
  s_waitcnt lgkmcnt(0)
  s_waitcnt vmcnt(0)
  v_mfma_f32_32x32x16_bf16 v[128:143], v[220:223], v[76:79], v[128:143]
  v_mfma_f32_32x32x16_bf16 v[144:159], v[224:227], v[76:79], v[144:159]
  v_mfma_f32_32x32x16_bf16 v[160:175], v[76:79], v[228:231], v[160:175]
  s_nop 11
  v_max3_f32 v9, v9, abs(v144), abs(v145)
  v_max3_f32 v9, v9, abs(v146), abs(v147)
  v_max3_f32 v9, v9, abs(v148), abs(v149)
  v_max3_f32 v9, v9, abs(v150), abs(v151)
  v_max3_f32 v9, v9, abs(v152), abs(v153)
  v_max3_f32 v9, v9, abs(v154), abs(v155)
  v_max3_f32 v9, v9, abs(v156), abs(v157)
  v_max3_f32 v9, v9, abs(v158), abs(v159)
  v_add_f32 v156, v156, v6
  v_cvt_pk_bf16_f32 v232, v144, v145
  v_cvt_pk_bf16_f32 v233, v146, v147
  v_cvt_pk_bf16_f32 v234, v148, v149
  v_cvt_pk_bf16_f32 v235, v150, v151
  v_cvt_pk_bf16_f32 v236, v152, v153
  v_cvt_pk_bf16_f32 v237, v154, v155
  v_cvt_pk_bf16_f32 v238, v156, v157
  v_cvt_pk_bf16_f32 v239, v158, v159
  s_add_u32 s26, s31, 245368832
  buffer_store_dwordx4 v[232:235], v2, s[8:11], s26 offen sc1
  buffer_store_dwordx4 v[236:239], v2, s[8:11], s26 offen offset:1024 sc1
  v_cndmask_b32 v160, v160, v8, s[32:33]
  v_cndmask_b32 v161, v161, v8, s[32:33]
  v_cndmask_b32 v162, v162, v8, s[32:33]
  v_cndmask_b32 v163, v163, v8, s[32:33]
  v_cndmask_b32 v164, v164, v8, s[32:33]
  v_cndmask_b32 v165, v165, v8, s[32:33]
  v_cndmask_b32 v166, v166, v8, s[32:33]
  v_cndmask_b32 v167, v167, v8, s[32:33]
  v_cndmask_b32 v168, v168, v8, s[32:33]
  v_cndmask_b32 v169, v169, v8, s[32:33]
  v_cndmask_b32 v170, v170, v8, s[32:33]
  v_cndmask_b32 v171, v171, v8, s[32:33]
  v_cndmask_b32 v172, v172, v8, s[32:33]
  v_cndmask_b32 v173, v173, v8, s[32:33]
  v_cndmask_b32 v174, v174, v8, s[32:33]
  v_cndmask_b32 v175, v175, v8, s[32:33]
  v_cvt_pk_bf16_f32 v240, v160, v161
  v_cvt_pk_bf16_f32 v241, v162, v163
  v_cvt_pk_bf16_f32 v242, v164, v165
  v_cvt_pk_bf16_f32 v243, v166, v167
  v_cvt_pk_bf16_f32 v244, v168, v169
  v_cvt_pk_bf16_f32 v245, v170, v171
  v_cvt_pk_bf16_f32 v246, v172, v173
  v_cvt_pk_bf16_f32 v247, v174, v175
  s_add_u32 s26, s31, 249563136
  buffer_store_dwordx4 v[240:243], v2, s[8:11], s26 offen sc1
  buffer_store_dwordx4 v[244:247], v2, s[8:11], s26 offen offset:1024 sc1
  v_mul_f32 v128, s30, v128
  v_mul_f32 v129, s30, v129
  v_mul_f32 v130, s30, v130
  v_mul_f32 v131, s30, v131
  v_mul_f32 v132, s30, v132
  v_mul_f32 v133, s30, v133
  v_mul_f32 v134, s30, v134
  v_mul_f32 v135, s30, v135
  v_mul_f32 v136, s30, v136
  v_mul_f32 v137, s30, v137
  v_mul_f32 v138, s30, v138
  v_mul_f32 v139, s30, v139
  v_mul_f32 v140, s30, v140
  v_mul_f32 v141, s30, v141
  v_mul_f32 v142, s30, v142
  v_mul_f32 v143, s30, v143
  v_cvt_pk_bf16_f32 v200, v128, v129
  v_cvt_pk_bf16_f32 v201, v130, v131
  v_cvt_pk_bf16_f32 v202, v132, v133
  v_cvt_pk_bf16_f32 v203, v134, v135
  v_cvt_pk_bf16_f32 v204, v136, v137
  v_cvt_pk_bf16_f32 v205, v138, v139
  v_cvt_pk_bf16_f32 v206, v140, v141
  v_cvt_pk_bf16_f32 v207, v142, v143
  s_nop 1
  v_max_f32_dpp v10, v9, v9 quad_perm:[1,0,3,2] row_mask:0xf bank_mask:0xf
  s_nop 1
  v_max_f32_dpp v9, v10, v10 quad_perm:[2,3,0,1] row_mask:0xf bank_mask:0xf
  s_nop 1
  v_max_f32_dpp v10, v9, v9 row_half_mirror row_mask:0xf bank_mask:0xf
  s_nop 1
  v_max_f32_dpp v9, v10, v10 row_mirror row_mask:0xf bank_mask:0xf
  v_mov_b32 v10, v9
  s_nop 1
  v_permlane16_swap_b32 v9, v10
  v_max_f32 v9, v9, v10
  v_mov_b32 v10, v9
  s_nop 1
  v_permlane32_swap_b32 v9, v10
  v_max_f32 v9, v9, v10
  s_lshl_b32 s51, s22, 7
  s_add_u32 s51, s51, 0xf600000
  s_lshl_b32 s26, s23, 4
  s_lshl_b32 s29, s21, 2
  s_add_u32 s26, s26, s29
  v_mov_b32 v11, s26
  s_mov_b64 s[40:41], exec
  s_mov_b64 exec, 1
  buffer_store_dword v9, v11, s[8:11], s51 offen sc1
  s_mov_b64 exec, s[40:41]
  s_mov_b32 s52, s24
  s_waitcnt vmcnt(0)
  s_barrier
  s_cmp_eq_u32 s21, 0
  s_cbranch_scc0 arr_30
  s_mov_b64 s[24:25], exec
  s_mov_b64 exec, 1
  v_mov_b32 v3, 0
  v_mov_b32 v4, 1
  buffer_atomic_add v4, v3, s[8:11], s47 offen
  s_mov_b64 exec, s[24:25]
arr_30:
  s_and_b32 s26, s2, 3
  s_mul_i32 s26, s26, 10
  s_mul_i32 s27, s21, 3
  s_cmp_eq_u32 s21, 3
  s_cselect_b32 s27, 8, s27
  s_add_u32 s50, s26, s27
  s_mul_i32 s26, s50, 20480
  s_add_u32 s26, s26, 0xe000000
  s_add_u32 s27, s26, 0
  buffer_load_dwordx4 a[0:3], v2, s[8:11], s27 offen
  s_add_u32 s27, s26, 1024
  buffer_load_dwordx4 a[4:7], v2, s[8:11], s27 offen
  s_add_u32 s27, s26, 2048
  buffer_load_dwordx4 a[8:11], v2, s[8:11], s27 offen
  s_add_u32 s27, s26, 3072
  buffer_load_dwordx4 a[12:15], v2, s[8:11], s27 offen
  s_add_u32 s27, s26, 4096
  buffer_load_dwordx4 a[16:19], v2, s[8:11], s27 offen
  s_add_u32 s27, s26, 5120
  buffer_load_dwordx4 a[20:23], v2, s[8:11], s27 offen
  s_add_u32 s27, s26, 6144
  buffer_load_dwordx4 a[24:27], v2, s[8:11], s27 offen
  s_add_u32 s27, s26, 7168
  buffer_load_dwordx4 a[28:31], v2, s[8:11], s27 offen
  s_add_u32 s27, s26, 8192
  buffer_load_dwordx4 a[32:35], v2, s[8:11], s27 offen
  s_add_u32 s27, s26, 9216
  buffer_load_dwordx4 a[36:39], v2, s[8:11], s27 offen
  s_add_u32 s27, s26, 10240
  buffer_load_dwordx4 a[40:43], v2, s[8:11], s27 offen
  s_add_u32 s27, s26, 11264
  buffer_load_dwordx4 a[44:47], v2, s[8:11], s27 offen
  s_add_u32 s27, s26, 12288
  buffer_load_dwordx4 a[48:51], v2, s[8:11], s27 offen
  s_add_u32 s27, s26, 13312
  buffer_load_dwordx4 a[52:55], v2, s[8:11], s27 offen
  s_add_u32 s27, s26, 14336
  buffer_load_dwordx4 a[56:59], v2, s[8:11], s27 offen
  s_add_u32 s27, s26, 15360
  buffer_load_dwordx4 a[60:63], v2, s[8:11], s27 offen
  s_add_u32 s27, s26, 16384
  buffer_load_dwordx4 a[64:67], v2, s[8:11], s27 offen
  s_add_u32 s27, s26, 17408
  buffer_load_dwordx4 a[68:71], v2, s[8:11], s27 offen
  s_add_u32 s27, s26, 18432
  buffer_load_dwordx4 a[72:75], v2, s[8:11], s27 offen
  s_add_u32 s27, s26, 19456
  buffer_load_dwordx4 a[76:79], v2, s[8:11], s27 offen
  s_add_u32 s27, s26, 20480
  buffer_load_dwordx4 a[80:83], v2, s[8:11], s27 offen
  s_add_u32 s27, s26, 21504
  buffer_load_dwordx4 a[84:87], v2, s[8:11], s27 offen
  s_add_u32 s27, s26, 22528
  buffer_load_dwordx4 a[88:91], v2, s[8:11], s27 offen
  s_add_u32 s27, s26, 23552
  buffer_load_dwordx4 a[92:95], v2, s[8:11], s27 offen
  s_add_u32 s27, s26, 24576
  buffer_load_dwordx4 a[96:99], v2, s[8:11], s27 offen
  s_add_u32 s27, s26, 25600
  buffer_load_dwordx4 a[100:103], v2, s[8:11], s27 offen
  s_add_u32 s27, s26, 26624
  buffer_load_dwordx4 a[104:107], v2, s[8:11], s27 offen
  s_add_u32 s27, s26, 27648
  buffer_load_dwordx4 a[108:111], v2, s[8:11], s27 offen
  s_add_u32 s27, s26, 28672
  buffer_load_dwordx4 a[112:115], v2, s[8:11], s27 offen
  s_add_u32 s27, s26, 29696
  buffer_load_dwordx4 a[116:119], v2, s[8:11], s27 offen
  s_add_u32 s27, s26, 30720
  buffer_load_dwordx4 a[120:123], v2, s[8:11], s27 offen
  s_add_u32 s27, s26, 31744
  buffer_load_dwordx4 a[124:127], v2, s[8:11], s27 offen
  s_add_u32 s27, s26, 32768
  buffer_load_dwordx4 a[128:131], v2, s[8:11], s27 offen
  s_add_u32 s27, s26, 33792
  buffer_load_dwordx4 a[132:135], v2, s[8:11], s27 offen
  s_add_u32 s27, s26, 34816
  buffer_load_dwordx4 a[136:139], v2, s[8:11], s27 offen
  s_add_u32 s27, s26, 35840
  buffer_load_dwordx4 a[140:143], v2, s[8:11], s27 offen
  s_add_u32 s27, s26, 36864
  buffer_load_dwordx4 a[144:147], v2, s[8:11], s27 offen
  s_add_u32 s27, s26, 37888
  buffer_load_dwordx4 a[148:151], v2, s[8:11], s27 offen
  s_add_u32 s27, s26, 38912
  buffer_load_dwordx4 a[152:155], v2, s[8:11], s27 offen
  s_add_u32 s27, s26, 39936
  buffer_load_dwordx4 a[156:159], v2, s[8:11], s27 offen
  s_cmp_lt_u32 s21, 2
  s_cbranch_scc0 g3_31
  s_add_u32 s27, s26, 40960
  buffer_load_dwordx4 a[160:163], v2, s[8:11], s27 offen
  s_add_u32 s27, s26, 41984
  buffer_load_dwordx4 a[164:167], v2, s[8:11], s27 offen
  s_add_u32 s27, s26, 43008
  buffer_load_dwordx4 a[168:171], v2, s[8:11], s27 offen
  s_add_u32 s27, s26, 44032
  buffer_load_dwordx4 a[172:175], v2, s[8:11], s27 offen
  s_add_u32 s27, s26, 45056
  buffer_load_dwordx4 a[176:179], v2, s[8:11], s27 offen
  s_add_u32 s27, s26, 46080
  buffer_load_dwordx4 a[180:183], v2, s[8:11], s27 offen
  s_add_u32 s27, s26, 47104
  buffer_load_dwordx4 a[184:187], v2, s[8:11], s27 offen
  s_add_u32 s27, s26, 48128
  buffer_load_dwordx4 a[188:191], v2, s[8:11], s27 offen
  s_add_u32 s27, s26, 49152
  buffer_load_dwordx4 a[192:195], v2, s[8:11], s27 offen
  s_add_u32 s27, s26, 50176
  buffer_load_dwordx4 a[196:199], v2, s[8:11], s27 offen
  s_add_u32 s27, s26, 51200
  buffer_load_dwordx4 a[200:203], v2, s[8:11], s27 offen
  s_add_u32 s27, s26, 52224
  buffer_load_dwordx4 a[204:207], v2, s[8:11], s27 offen
  s_add_u32 s27, s26, 53248
  buffer_load_dwordx4 a[208:211], v2, s[8:11], s27 offen
  s_add_u32 s27, s26, 54272
  buffer_load_dwordx4 a[212:215], v2, s[8:11], s27 offen
  s_add_u32 s27, s26, 55296
  buffer_load_dwordx4 a[216:219], v2, s[8:11], s27 offen
  s_add_u32 s27, s26, 56320
  buffer_load_dwordx4 a[220:223], v2, s[8:11], s27 offen
  s_add_u32 s27, s26, 57344
  buffer_load_dwordx4 a[224:227], v2, s[8:11], s27 offen
  s_add_u32 s27, s26, 58368
  buffer_load_dwordx4 a[228:231], v2, s[8:11], s27 offen
  s_add_u32 s27, s26, 59392
  buffer_load_dwordx4 a[232:235], v2, s[8:11], s27 offen
  s_add_u32 s27, s26, 60416
  buffer_load_dwordx4 a[236:239], v2, s[8:11], s27 offen
g3_31:
  v_mov_b32 v12, 0
  v_lshlrev_b32 v6, 16, v192
  v_and_b32 v7, 0xffff0000, v192
  v_add_f32_e64 v12, v12, abs(v6)
  v_add_f32_e64 v12, v12, abs(v7)
  v_lshlrev_b32 v6, 16, v193
  v_and_b32 v7, 0xffff0000, v193
  v_add_f32_e64 v12, v12, abs(v6)
  v_add_f32_e64 v12, v12, abs(v7)
  v_lshlrev_b32 v6, 16, v194
  v_and_b32 v7, 0xffff0000, v194
  v_add_f32_e64 v12, v12, abs(v6)
  v_add_f32_e64 v12, v12, abs(v7)
  v_lshlrev_b32 v6, 16, v195
  v_and_b32 v7, 0xffff0000, v195
  v_add_f32_e64 v12, v12, abs(v6)
  v_add_f32_e64 v12, v12, abs(v7)
  v_lshlrev_b32 v6, 16, v196
  v_and_b32 v7, 0xffff0000, v196
  v_add_f32_e64 v12, v12, abs(v6)
  v_add_f32_e64 v12, v12, abs(v7)
  v_lshlrev_b32 v6, 16, v197
  v_and_b32 v7, 0xffff0000, v197
  v_add_f32_e64 v12, v12, abs(v6)
  v_add_f32_e64 v12, v12, abs(v7)
  v_lshlrev_b32 v6, 16, v198
  v_and_b32 v7, 0xffff0000, v198
  v_add_f32_e64 v12, v12, abs(v6)
  v_add_f32_e64 v12, v12, abs(v7)
  v_lshlrev_b32 v6, 16, v199
  v_and_b32 v7, 0xffff0000, v199
  v_add_f32_e64 v12, v12, abs(v6)
  v_add_f32_e64 v12, v12, abs(v7)
  v_mov_b32 v6, v12
  s_nop 1
  v_permlane32_swap_b32 v12, v6
  v_add_f32 v12, v12, v6
  v_mov_b32 v13, 0
  v_lshlrev_b32 v6, 16, v200
  v_and_b32 v7, 0xffff0000, v200
  v_add_f32_e64 v13, v13, abs(v6)
  v_add_f32_e64 v13, v13, abs(v7)
  v_lshlrev_b32 v6, 16, v201
  v_and_b32 v7, 0xffff0000, v201
  v_add_f32_e64 v13, v13, abs(v6)
  v_add_f32_e64 v13, v13, abs(v7)
  v_lshlrev_b32 v6, 16, v202
  v_and_b32 v7, 0xffff0000, v202
  v_add_f32_e64 v13, v13, abs(v6)
  v_add_f32_e64 v13, v13, abs(v7)
  v_lshlrev_b32 v6, 16, v203
  v_and_b32 v7, 0xffff0000, v203
  v_add_f32_e64 v13, v13, abs(v6)
  v_add_f32_e64 v13, v13, abs(v7)
  v_lshlrev_b32 v6, 16, v204
  v_and_b32 v7, 0xffff0000, v204
  v_add_f32_e64 v13, v13, abs(v6)
  v_add_f32_e64 v13, v13, abs(v7)
  v_lshlrev_b32 v6, 16, v205
  v_and_b32 v7, 0xffff0000, v205
  v_add_f32_e64 v13, v13, abs(v6)
  v_add_f32_e64 v13, v13, abs(v7)
  v_lshlrev_b32 v6, 16, v206
  v_and_b32 v7, 0xffff0000, v206
  v_add_f32_e64 v13, v13, abs(v6)
  v_add_f32_e64 v13, v13, abs(v7)
  v_lshlrev_b32 v6, 16, v207
  v_and_b32 v7, 0xffff0000, v207
  v_add_f32_e64 v13, v13, abs(v6)
  v_add_f32_e64 v13, v13, abs(v7)
  v_mov_b32 v6, v13
  s_nop 1
  v_permlane32_swap_b32 v13, v6
  v_add_f32 v13, v13, v6
  v_mov_b32 v8, -1
  v_mov_b32 v9, -1
  v_mov_b32 v10, -1
  v_mov_b32 v11, -1
  s_lshl_b32 s30, s2, 2
  s_add_u32 s30, s30, s21
  s_add_u32 s31, s30, 0
  s_cmp_lt_u32 s31, 2560
  s_cbranch_scc0 f_32
  s_lshl_b32 s31, s31, 10
  s_add_u32 s31, s31, 0x400000
  buffer_store_dwordx4 v[8:11], v2, s[8:11], s31 offen
f_32:
  s_add_u32 s31, s30, 1024
  s_cmp_lt_u32 s31, 2560
  s_cbranch_scc0 f_33
  s_lshl_b32 s31, s31, 10
  s_add_u32 s31, s31, 0x400000
  buffer_store_dwordx4 v[8:11], v2, s[8:11], s31 offen
f_33:
  s_add_u32 s31, s30, 2048
  s_cmp_lt_u32 s31, 2560
  s_cbranch_scc0 f_34
  s_lshl_b32 s31, s31, 10
  s_add_u32 s31, s31, 0x400000
  buffer_store_dwordx4 v[8:11], v2, s[8:11], s31 offen
f_34:
  s_add_u32 s31, s30, 0
  s_cmp_lt_u32 s31, 1280
  s_cbranch_scc0 f_35
  s_lshl_b32 s31, s31, 10
  s_add_u32 s31, s31, 0x700000
  buffer_store_dwordx4 v[8:11], v2, s[8:11], s31 offen
f_35:
  s_add_u32 s31, s30, 1024
  s_cmp_lt_u32 s31, 1280
  s_cbranch_scc0 f_36
  s_lshl_b32 s31, s31, 10
  s_add_u32 s31, s31, 0x700000
  buffer_store_dwordx4 v[8:11], v2, s[8:11], s31 offen
f_36:
  s_add_u32 s31, s30, 0
  s_cmp_lt_u32 s31, 640
  s_cbranch_scc0 f_37
  s_lshl_b32 s31, s31, 10
  s_add_u32 s31, s31, 0xa00000
  buffer_store_dwordx4 v[8:11], v2, s[8:11], s31 offen
f_37:
  s_add_u32 s31, s30, 0
  s_cmp_lt_u32 s31, 5120
  s_cbranch_scc0 f_38
  s_lshl_b32 s31, s31, 10
  s_add_u32 s31, s31, 0xe00000
  buffer_store_dwordx4 v[8:11], v2, s[8:11], s31 offen
f_38:
  s_add_u32 s31, s30, 1024
  s_cmp_lt_u32 s31, 5120
  s_cbranch_scc0 f_39
  s_lshl_b32 s31, s31, 10
  s_add_u32 s31, s31, 0xe00000
  buffer_store_dwordx4 v[8:11], v2, s[8:11], s31 offen
f_39:
  s_add_u32 s31, s30, 2048
  s_cmp_lt_u32 s31, 5120
  s_cbranch_scc0 f_40
  s_lshl_b32 s31, s31, 10
  s_add_u32 s31, s31, 0xe00000
  buffer_store_dwordx4 v[8:11], v2, s[8:11], s31 offen
f_40:
  s_add_u32 s31, s30, 3072
  s_cmp_lt_u32 s31, 5120
  s_cbranch_scc0 f_41
  s_lshl_b32 s31, s31, 10
  s_add_u32 s31, s31, 0xe00000
  buffer_store_dwordx4 v[8:11], v2, s[8:11], s31 offen
f_41:
  s_add_u32 s31, s30, 4096
  s_cmp_lt_u32 s31, 5120
  s_cbranch_scc0 f_42
  s_lshl_b32 s31, s31, 10
  s_add_u32 s31, s31, 0xe00000
  buffer_store_dwordx4 v[8:11], v2, s[8:11], s31 offen
f_42:
  s_cmp_eq_u32 s2, 0
  s_cbranch_scc0 z_43
  s_cmp_eq_u32 s21, 0
  s_cbranch_scc0 z_43
  v_mov_b32 v8, 0
  v_mov_b32 v9, 0
  v_mov_b32 v10, 0
  v_mov_b32 v11, 0
  s_mov_b32 s30, 0x0
  buffer_store_dwordx4 v[8:11], v2, s[8:11], s30 offen
  s_add_u32 s30, s30, 1024
  buffer_store_dwordx4 v[8:11], v2, s[8:11], s30 offen
  s_add_u32 s30, s30, 1024
  buffer_store_dwordx4 v[8:11], v2, s[8:11], s30 offen
  s_add_u32 s30, s30, 1024
  buffer_store_dwordx4 v[8:11], v2, s[8:11], s30 offen
  s_add_u32 s30, s30, 1024
  buffer_store_dwordx4 v[8:11], v2, s[8:11], s30 offen
  s_add_u32 s30, s30, 1024
  s_mov_b32 s30, 0x2000
  buffer_store_dwordx4 v[8:11], v2, s[8:11], s30 offen
  s_add_u32 s30, s30, 1024
  buffer_store_dwordx4 v[8:11], v2, s[8:11], s30 offen
  s_add_u32 s30, s30, 1024
z_43:
  s_mov_b32 s45, 0
  v_mov_b32 v3, 0
aw_44:
  buffer_load_dword v4, v3, s[8:11], s47 offen sc1
  s_add_u32 s45, s45, 1
  s_waitcnt vmcnt(0)
  v_readfirstlane_b32 s29, v4
  s_cmp_ge_u32 s29, 8
  s_cbranch_scc1 aw_44_ok
  s_cmp_lt_u32 s45, 400000
  s_cbranch_scc1 aw_44
  s_branch kb1_abort
aw_44_ok:
  v_and_b32 v3, 31, v1
  v_lshlrev_b32 v3, 2, v3
  buffer_load_dword v4, v3, s[8:11], s51 offen sc1
  s_lshl_b32 s25, s22, 6
  s_lshl_b32 s27, s25, 11
  s_add_u32 s28, s27, 0xee00000
  s_add_u32 s27, s27, 0xea00000
  s_mov_b32 s41, 0
  s_mul_i32 s53, s41, 32768
  s_lshl_b32 s31, s21, 13
  s_add_u32 s53, s53, s31
  s_add_u32 m0, s31, 0
  s_add_u32 s29, s53, s27
  s_add_u32 s29, s29, 0
  buffer_load_dwordx4 v2, s[8:11], s29 offen sc1 lds
  s_add_u32 m0, s31, 1024
  s_add_u32 s29, s53, s27
  s_add_u32 s29, s29, 1024
  buffer_load_dwordx4 v2, s[8:11], s29 offen sc1 lds
  s_add_u32 m0, s31, 2048
  s_add_u32 s29, s53, s27
  s_add_u32 s29, s29, 2048
  buffer_load_dwordx4 v2, s[8:11], s29 offen sc1 lds
  s_add_u32 m0, s31, 3072
  s_add_u32 s29, s53, s27
  s_add_u32 s29, s29, 3072
  buffer_load_dwordx4 v2, s[8:11], s29 offen sc1 lds
  s_add_u32 m0, s31, 4096
  s_add_u32 s29, s53, s27
  s_add_u32 s29, s29, 4096
  buffer_load_dwordx4 v2, s[8:11], s29 offen sc1 lds
  s_add_u32 m0, s31, 5120
  s_add_u32 s29, s53, s27
  s_add_u32 s29, s29, 5120
  buffer_load_dwordx4 v2, s[8:11], s29 offen sc1 lds
  s_add_u32 m0, s31, 6144
  s_add_u32 s29, s53, s27
  s_add_u32 s29, s29, 6144
  buffer_load_dwordx4 v2, s[8:11], s29 offen sc1 lds
  s_add_u32 m0, s31, 7168
  s_add_u32 s29, s53, s27
  s_add_u32 s29, s29, 7168
  buffer_load_dwordx4 v2, s[8:11], s29 offen sc1 lds
  s_add_u32 m0, s31, 32768
  s_add_u32 s29, s53, s28
  s_add_u32 s29, s29, 0
  buffer_load_dwordx4 v2, s[8:11], s29 offen sc1 lds
  s_add_u32 m0, s31, 33792
  s_add_u32 s29, s53, s28
  s_add_u32 s29, s29, 1024
  buffer_load_dwordx4 v2, s[8:11], s29 offen sc1 lds
  s_add_u32 m0, s31, 34816
  s_add_u32 s29, s53, s28
  s_add_u32 s29, s29, 2048
  buffer_load_dwordx4 v2, s[8:11], s29 offen sc1 lds
  s_add_u32 m0, s31, 35840
  s_add_u32 s29, s53, s28
  s_add_u32 s29, s29, 3072
  buffer_load_dwordx4 v2, s[8:11], s29 offen sc1 lds
  s_add_u32 m0, s31, 36864
  s_add_u32 s29, s53, s28
  s_add_u32 s29, s29, 4096
  buffer_load_dwordx4 v2, s[8:11], s29 offen sc1 lds
  s_add_u32 m0, s31, 37888
  s_add_u32 s29, s53, s28
  s_add_u32 s29, s29, 5120
  buffer_load_dwordx4 v2, s[8:11], s29 offen sc1 lds
  s_add_u32 m0, s31, 38912
  s_add_u32 s29, s53, s28
  s_add_u32 s29, s29, 6144
  buffer_load_dwordx4 v2, s[8:11], s29 offen sc1 lds
  s_add_u32 m0, s31, 39936
  s_add_u32 s29, s53, s28
  s_add_u32 s29, s29, 7168
  buffer_load_dwordx4 v2, s[8:11], s29 offen sc1 lds
  s_waitcnt vmcnt(16)
  v_max_f32_dpp v5, v4, v4 quad_perm:[1,0,3,2] row_mask:0xf bank_mask:0xf
  s_nop 1
  v_max_f32_dpp v4, v5, v5 quad_perm:[2,3,0,1] row_mask:0xf bank_mask:0xf
  s_nop 1
  v_max_f32_dpp v5, v4, v4 row_half_mirror row_mask:0xf bank_mask:0xf
  s_nop 1
  v_max_f32_dpp v4, v5, v5 row_mirror row_mask:0xf bank_mask:0xf
  v_mov_b32 v5, v4
  s_nop 1
  v_permlane16_swap_b32 v4, v5
  v_max_f32 v4, v4, v5
  v_mul_f32 v12, v12, v4
  v_mul_f32 v12, 0x3f820000, v12
  v_mul_f32 v13, v13, v4
  v_mul_f32 v13, 0x3f820000, v13
  s_mov_b32 s40, 0
kb1_main:
  v_lshrrev_b32 v5, 16, v12
  v_or_b32 v5, 0x8000, v5
  v_and_b32 v6, 0xffff0000, v198
  v_or_b32 v5, v5, v6
  v_cndmask_b32 v198, v198, v5, s[34:35]
  v_lshrrev_b32 v5, 16, v13
  v_or_b32 v5, 0x8000, v5
  v_and_b32 v6, 0xffff0000, v206
  v_or_b32 v5, v5, v6
  v_cndmask_b32 v206, v206, v5, s[34:35]
kb1_main2:
  v_mov_b32 v112, 0
  v_mov_b32 v113, 0
  v_mov_b32 v114, 0
  v_mov_b32 v115, 0
  v_mov_b32 v116, 0
  v_mov_b32 v117, 0
  v_mov_b32 v118, 0
  v_mov_b32 v119, 0
  v_mov_b32 v120, 0
  v_mov_b32 v121, 0
  v_mov_b32 v122, 0
  v_mov_b32 v123, 0
  v_mov_b32 v124, 0
  v_mov_b32 v125, 0
  v_mov_b32 v126, 0
  v_mov_b32 v127, 0
  v_mov_b32 v128, 0
  v_mov_b32 v129, 0
  v_mov_b32 v130, 0
  v_mov_b32 v131, 0
  v_mov_b32 v132, 0
  v_mov_b32 v133, 0
  v_mov_b32 v134, 0
  v_mov_b32 v135, 0
  v_mov_b32 v136, 0
  v_mov_b32 v137, 0
  v_mov_b32 v138, 0
  v_mov_b32 v139, 0
  v_mov_b32 v140, 0
  v_mov_b32 v141, 0
  v_mov_b32 v142, 0
  v_mov_b32 v143, 0
  v_mov_b32 v3, v2
  v_add_u32 v4, 65536, v2
kb1_chunk2:
  s_waitcnt vmcnt(0)
  s_barrier
  s_add_u32 s41, s41, 1
  s_min_u32 s29, s41, 3
  s_mul_i32 s53, s29, 32768
  s_lshl_b32 s31, s21, 13
  s_add_u32 s53, s53, s31
  ds_read_b128 v[32:35], v3 offset:0
  ds_read_b128 v[36:39], v3 offset:1024
  ds_read_b128 v[48:51], v3 offset:32768
  ds_read_b128 v[52:55], v3 offset:33792
  ds_read_b128 v[40:43], v3 offset:2048
  ds_read_b128 v[44:47], v3 offset:3072
  s_waitcnt lgkmcnt(4)
  v_mfma_f32_32x32x16_bf16 v[64:79], v[32:35], v[192:195], 0
  v_mfma_f32_32x32x16_bf16 v[64:79], v[36:39], v[196:199], v[64:79]
  s_nop 11
  v_exp_f32 v64, v64
  v_exp_f32 v65, v65
  v_exp_f32 v66, v66
  v_exp_f32 v67, v67
  v_cvt_pk_bf16_f32 v96, v64, v65
  v_exp_f32 v68, v68
  v_exp_f32 v69, v69
  v_cvt_pk_bf16_f32 v97, v66, v67
  v_exp_f32 v70, v70
  v_mfma_f32_32x32x16_bf16 v[80:95], v[32:35], v[200:203], 0
  v_exp_f32 v71, v71
  v_cvt_pk_bf16_f32 v98, v68, v69
  v_exp_f32 v72, v72
  v_exp_f32 v73, v73
  v_cvt_pk_bf16_f32 v99, v70, v71
  v_mfma_f32_32x32x16_bf16 v[80:95], v[36:39], v[204:207], v[80:95]
  v_exp_f32 v74, v74
  v_exp_f32 v75, v75
  ds_read_b128 v[56:59], v3 offset:34816
  v_cvt_pk_bf16_f32 v100, v72, v73
  v_exp_f32 v76, v76
  v_exp_f32 v77, v77
  ds_read_b128 v[60:63], v3 offset:35840
  v_cvt_pk_bf16_f32 v101, v74, v75
  v_exp_f32 v78, v78
  s_add_u32 m0, s31, 65536
  s_add_u32 s29, s53, s27
  s_add_u32 s29, s29, 0
  buffer_load_dwordx4 v2, s[8:11], s29 offen sc1 lds
  v_exp_f32 v79, v79
  v_cvt_pk_bf16_f32 v102, v76, v77
  v_cvt_pk_bf16_f32 v103, v78, v79
  s_waitcnt lgkmcnt(4)
  v_mfma_f32_32x32x16_bf16 v[112:127], v[48:51], v[96:99], v[112:127]
  v_exp_f32 v80, v80
  v_exp_f32 v81, v81
  v_exp_f32 v82, v82
  v_exp_f32 v83, v83
  v_mfma_f32_32x32x16_bf16 v[112:127], v[52:55], v[100:103], v[112:127]
  v_cvt_pk_bf16_f32 v104, v80, v81
  v_exp_f32 v84, v84
  v_exp_f32 v85, v85
  v_cvt_pk_bf16_f32 v105, v82, v83
  v_exp_f32 v86, v86
  s_waitcnt lgkmcnt(2)
  v_mfma_f32_32x32x16_bf16 v[64:79], v[40:43], v[192:195], 0
  v_exp_f32 v87, v87
  v_cvt_pk_bf16_f32 v106, v84, v85
  v_exp_f32 v88, v88
  v_exp_f32 v89, v89
  v_cvt_pk_bf16_f32 v107, v86, v87
  v_mfma_f32_32x32x16_bf16 v[64:79], v[44:47], v[196:199], v[64:79]
  v_exp_f32 v90, v90
  v_exp_f32 v91, v91
  ds_read_b128 v[32:35], v3 offset:4096
  v_cvt_pk_bf16_f32 v108, v88, v89
  v_exp_f32 v92, v92
  v_exp_f32 v93, v93
  ds_read_b128 v[36:39], v3 offset:5120
  v_cvt_pk_bf16_f32 v109, v90, v91
  v_exp_f32 v94, v94
  v_exp_f32 v95, v95
  v_cvt_pk_bf16_f32 v110, v92, v93
  v_cvt_pk_bf16_f32 v111, v94, v95
  v_mfma_f32_32x32x16_bf16 v[128:143], v[48:51], v[104:107], v[128:143]
  v_exp_f32 v64, v64
  v_exp_f32 v65, v65
  v_exp_f32 v66, v66
  v_exp_f32 v67, v67
  v_mfma_f32_32x32x16_bf16 v[128:143], v[52:55], v[108:111], v[128:143]
  v_cvt_pk_bf16_f32 v96, v64, v65
  v_exp_f32 v68, v68
  v_exp_f32 v69, v69
  v_cvt_pk_bf16_f32 v97, v66, v67
  v_exp_f32 v70, v70
  v_mfma_f32_32x32x16_bf16 v[80:95], v[40:43], v[200:203], 0
  v_exp_f32 v71, v71
  v_cvt_pk_bf16_f32 v98, v68, v69
  v_exp_f32 v72, v72
  v_exp_f32 v73, v73
  v_cvt_pk_bf16_f32 v99, v70, v71
  v_mfma_f32_32x32x16_bf16 v[80:95], v[44:47], v[204:207], v[80:95]
  v_exp_f32 v74, v74
  v_exp_f32 v75, v75
  ds_read_b128 v[48:51], v3 offset:36864
  v_cvt_pk_bf16_f32 v100, v72, v73
  v_exp_f32 v76, v76
  v_exp_f32 v77, v77
  ds_read_b128 v[52:55], v3 offset:37888
  v_cvt_pk_bf16_f32 v101, v74, v75
  v_exp_f32 v78, v78
  s_add_u32 m0, s31, 66560
  s_add_u32 s29, s53, s27
  s_add_u32 s29, s29, 1024
  buffer_load_dwordx4 v2, s[8:11], s29 offen sc1 lds
  v_exp_f32 v79, v79
  v_cvt_pk_bf16_f32 v102, v76, v77
  v_cvt_pk_bf16_f32 v103, v78, v79
  s_waitcnt lgkmcnt(4)
  v_mfma_f32_32x32x16_bf16 v[112:127], v[56:59], v[96:99], v[112:127]
  v_exp_f32 v80, v80
  v_exp_f32 v81, v81
  v_exp_f32 v82, v82
  v_exp_f32 v83, v83
  v_mfma_f32_32x32x16_bf16 v[112:127], v[60:63], v[100:103], v[112:127]
  v_cvt_pk_bf16_f32 v104, v80, v81
  v_exp_f32 v84, v84
  v_exp_f32 v85, v85
  v_cvt_pk_bf16_f32 v105, v82, v83
  v_exp_f32 v86, v86
  s_waitcnt lgkmcnt(2)
  v_mfma_f32_32x32x16_bf16 v[64:79], v[32:35], v[192:195], 0
  v_exp_f32 v87, v87
  v_cvt_pk_bf16_f32 v106, v84, v85
  v_exp_f32 v88, v88
  v_exp_f32 v89, v89
  v_cvt_pk_bf16_f32 v107, v86, v87
  v_mfma_f32_32x32x16_bf16 v[64:79], v[36:39], v[196:199], v[64:79]
  v_exp_f32 v90, v90
  v_exp_f32 v91, v91
  ds_read_b128 v[40:43], v3 offset:6144
  v_cvt_pk_bf16_f32 v108, v88, v89
  v_exp_f32 v92, v92
  v_exp_f32 v93, v93
  ds_read_b128 v[44:47], v3 offset:7168
  v_cvt_pk_bf16_f32 v109, v90, v91
  v_exp_f32 v94, v94
  v_exp_f32 v95, v95
  v_cvt_pk_bf16_f32 v110, v92, v93
  v_cvt_pk_bf16_f32 v111, v94, v95
  v_mfma_f32_32x32x16_bf16 v[128:143], v[56:59], v[104:107], v[128:143]
  v_exp_f32 v64, v64
  v_exp_f32 v65, v65
  v_exp_f32 v66, v66
  v_exp_f32 v67, v67
  v_mfma_f32_32x32x16_bf16 v[128:143], v[60:63], v[108:111], v[128:143]
  v_cvt_pk_bf16_f32 v96, v64, v65
  v_exp_f32 v68, v68
  v_exp_f32 v69, v69
  v_cvt_pk_bf16_f32 v97, v66, v67
  v_exp_f32 v70, v70
  v_mfma_f32_32x32x16_bf16 v[80:95], v[32:35], v[200:203], 0
  v_exp_f32 v71, v71
  v_cvt_pk_bf16_f32 v98, v68, v69
  v_exp_f32 v72, v72
  v_exp_f32 v73, v73
  v_cvt_pk_bf16_f32 v99, v70, v71
  v_mfma_f32_32x32x16_bf16 v[80:95], v[36:39], v[204:207], v[80:95]
  v_exp_f32 v74, v74
  v_exp_f32 v75, v75
  ds_read_b128 v[56:59], v3 offset:38912
  v_cvt_pk_bf16_f32 v100, v72, v73
  v_exp_f32 v76, v76
  v_exp_f32 v77, v77
  ds_read_b128 v[60:63], v3 offset:39936
  v_cvt_pk_bf16_f32 v101, v74, v75
  v_exp_f32 v78, v78
  s_add_u32 m0, s31, 67584
  s_add_u32 s29, s53, s27
  s_add_u32 s29, s29, 2048
  buffer_load_dwordx4 v2, s[8:11], s29 offen sc1 lds
  v_exp_f32 v79, v79
  v_cvt_pk_bf16_f32 v102, v76, v77
  v_cvt_pk_bf16_f32 v103, v78, v79
  s_waitcnt lgkmcnt(4)
  v_mfma_f32_32x32x16_bf16 v[112:127], v[48:51], v[96:99], v[112:127]
  v_exp_f32 v80, v80
  v_exp_f32 v81, v81
  v_exp_f32 v82, v82
  v_exp_f32 v83, v83
  v_mfma_f32_32x32x16_bf16 v[112:127], v[52:55], v[100:103], v[112:127]
  v_cvt_pk_bf16_f32 v104, v80, v81
  v_exp_f32 v84, v84
  v_exp_f32 v85, v85
  v_cvt_pk_bf16_f32 v105, v82, v83
  v_exp_f32 v86, v86
  s_waitcnt lgkmcnt(2)
  v_mfma_f32_32x32x16_bf16 v[64:79], v[40:43], v[192:195], 0
  v_exp_f32 v87, v87
  v_cvt_pk_bf16_f32 v106, v84, v85
  v_exp_f32 v88, v88
  v_exp_f32 v89, v89
  v_cvt_pk_bf16_f32 v107, v86, v87
  v_mfma_f32_32x32x16_bf16 v[64:79], v[44:47], v[196:199], v[64:79]
  v_exp_f32 v90, v90
  v_exp_f32 v91, v91
  ds_read_b128 v[32:35], v3 offset:8192
  v_cvt_pk_bf16_f32 v108, v88, v89
  v_exp_f32 v92, v92
  v_exp_f32 v93, v93
  ds_read_b128 v[36:39], v3 offset:9216
  v_cvt_pk_bf16_f32 v109, v90, v91
  v_exp_f32 v94, v94
  v_exp_f32 v95, v95
  v_cvt_pk_bf16_f32 v110, v92, v93
  v_cvt_pk_bf16_f32 v111, v94, v95
  v_mfma_f32_32x32x16_bf16 v[128:143], v[48:51], v[104:107], v[128:143]
  v_exp_f32 v64, v64
  v_exp_f32 v65, v65
  v_exp_f32 v66, v66
  v_exp_f32 v67, v67
  v_mfma_f32_32x32x16_bf16 v[128:143], v[52:55], v[108:111], v[128:143]
  v_cvt_pk_bf16_f32 v96, v64, v65
  v_exp_f32 v68, v68
  v_exp_f32 v69, v69
  v_cvt_pk_bf16_f32 v97, v66, v67
  v_exp_f32 v70, v70
  v_mfma_f32_32x32x16_bf16 v[80:95], v[40:43], v[200:203], 0
  v_exp_f32 v71, v71
  v_cvt_pk_bf16_f32 v98, v68, v69
  v_exp_f32 v72, v72
  v_exp_f32 v73, v73
  v_cvt_pk_bf16_f32 v99, v70, v71
  v_mfma_f32_32x32x16_bf16 v[80:95], v[44:47], v[204:207], v[80:95]
  v_exp_f32 v74, v74
  v_exp_f32 v75, v75
  ds_read_b128 v[48:51], v3 offset:40960
  v_cvt_pk_bf16_f32 v100, v72, v73
  v_exp_f32 v76, v76
  v_exp_f32 v77, v77
  ds_read_b128 v[52:55], v3 offset:41984
  v_cvt_pk_bf16_f32 v101, v74, v75
  v_exp_f32 v78, v78
  s_add_u32 m0, s31, 68608
  s_add_u32 s29, s53, s27
  s_add_u32 s29, s29, 3072
  buffer_load_dwordx4 v2, s[8:11], s29 offen sc1 lds
  v_exp_f32 v79, v79
  v_cvt_pk_bf16_f32 v102, v76, v77
  v_cvt_pk_bf16_f32 v103, v78, v79
  s_waitcnt lgkmcnt(4)
  v_mfma_f32_32x32x16_bf16 v[112:127], v[56:59], v[96:99], v[112:127]
  v_exp_f32 v80, v80
  v_exp_f32 v81, v81
  v_exp_f32 v82, v82
  v_exp_f32 v83, v83
  v_mfma_f32_32x32x16_bf16 v[112:127], v[60:63], v[100:103], v[112:127]
  v_cvt_pk_bf16_f32 v104, v80, v81
  v_exp_f32 v84, v84
  v_exp_f32 v85, v85
  v_cvt_pk_bf16_f32 v105, v82, v83
  v_exp_f32 v86, v86
  s_waitcnt lgkmcnt(2)
  v_mfma_f32_32x32x16_bf16 v[64:79], v[32:35], v[192:195], 0
  v_exp_f32 v87, v87
  v_cvt_pk_bf16_f32 v106, v84, v85
  v_exp_f32 v88, v88
  v_exp_f32 v89, v89
  v_cvt_pk_bf16_f32 v107, v86, v87
  v_mfma_f32_32x32x16_bf16 v[64:79], v[36:39], v[196:199], v[64:79]
  v_exp_f32 v90, v90
  v_exp_f32 v91, v91
  ds_read_b128 v[40:43], v3 offset:10240
  v_cvt_pk_bf16_f32 v108, v88, v89
  v_exp_f32 v92, v92
  v_exp_f32 v93, v93
  ds_read_b128 v[44:47], v3 offset:11264
  v_cvt_pk_bf16_f32 v109, v90, v91
  v_exp_f32 v94, v94
  v_exp_f32 v95, v95
  v_cvt_pk_bf16_f32 v110, v92, v93
  v_cvt_pk_bf16_f32 v111, v94, v95
  v_mfma_f32_32x32x16_bf16 v[128:143], v[56:59], v[104:107], v[128:143]
  v_exp_f32 v64, v64
  v_exp_f32 v65, v65
  v_exp_f32 v66, v66
  v_exp_f32 v67, v67
  v_mfma_f32_32x32x16_bf16 v[128:143], v[60:63], v[108:111], v[128:143]
  v_cvt_pk_bf16_f32 v96, v64, v65
  v_exp_f32 v68, v68
  v_exp_f32 v69, v69
  v_cvt_pk_bf16_f32 v97, v66, v67
  v_exp_f32 v70, v70
  v_mfma_f32_32x32x16_bf16 v[80:95], v[32:35], v[200:203], 0
  v_exp_f32 v71, v71
  v_cvt_pk_bf16_f32 v98, v68, v69
  v_exp_f32 v72, v72
  v_exp_f32 v73, v73
  v_cvt_pk_bf16_f32 v99, v70, v71
  v_mfma_f32_32x32x16_bf16 v[80:95], v[36:39], v[204:207], v[80:95]
  v_exp_f32 v74, v74
  v_exp_f32 v75, v75
  ds_read_b128 v[56:59], v3 offset:43008
  v_cvt_pk_bf16_f32 v100, v72, v73
  v_exp_f32 v76, v76
  v_exp_f32 v77, v77
  ds_read_b128 v[60:63], v3 offset:44032
  v_cvt_pk_bf16_f32 v101, v74, v75
  v_exp_f32 v78, v78
  s_add_u32 m0, s31, 69632
  s_add_u32 s29, s53, s27
  s_add_u32 s29, s29, 4096
  buffer_load_dwordx4 v2, s[8:11], s29 offen sc1 lds
  v_exp_f32 v79, v79
  v_cvt_pk_bf16_f32 v102, v76, v77
  v_cvt_pk_bf16_f32 v103, v78, v79
  s_waitcnt lgkmcnt(4)
  v_mfma_f32_32x32x16_bf16 v[112:127], v[48:51], v[96:99], v[112:127]
  v_exp_f32 v80, v80
  v_exp_f32 v81, v81
  v_exp_f32 v82, v82
  v_exp_f32 v83, v83
  v_mfma_f32_32x32x16_bf16 v[112:127], v[52:55], v[100:103], v[112:127]
  v_cvt_pk_bf16_f32 v104, v80, v81
  v_exp_f32 v84, v84
  v_exp_f32 v85, v85
  v_cvt_pk_bf16_f32 v105, v82, v83
  v_exp_f32 v86, v86
  s_waitcnt lgkmcnt(2)
  v_mfma_f32_32x32x16_bf16 v[64:79], v[40:43], v[192:195], 0
  v_exp_f32 v87, v87
  v_cvt_pk_bf16_f32 v106, v84, v85
  v_exp_f32 v88, v88
  v_exp_f32 v89, v89
  v_cvt_pk_bf16_f32 v107, v86, v87
  v_mfma_f32_32x32x16_bf16 v[64:79], v[44:47], v[196:199], v[64:79]
  v_exp_f32 v90, v90
  v_exp_f32 v91, v91
  ds_read_b128 v[32:35], v3 offset:12288
  v_cvt_pk_bf16_f32 v108, v88, v89
  v_exp_f32 v92, v92
  v_exp_f32 v93, v93
  ds_read_b128 v[36:39], v3 offset:13312
  v_cvt_pk_bf16_f32 v109, v90, v91
  v_exp_f32 v94, v94
  v_exp_f32 v95, v95
  v_cvt_pk_bf16_f32 v110, v92, v93
  v_cvt_pk_bf16_f32 v111, v94, v95
  v_mfma_f32_32x32x16_bf16 v[128:143], v[48:51], v[104:107], v[128:143]
  v_exp_f32 v64, v64
  v_exp_f32 v65, v65
  v_exp_f32 v66, v66
  v_exp_f32 v67, v67
  v_mfma_f32_32x32x16_bf16 v[128:143], v[52:55], v[108:111], v[128:143]
  v_cvt_pk_bf16_f32 v96, v64, v65
  v_exp_f32 v68, v68
  v_exp_f32 v69, v69
  v_cvt_pk_bf16_f32 v97, v66, v67
  v_exp_f32 v70, v70
  v_mfma_f32_32x32x16_bf16 v[80:95], v[40:43], v[200:203], 0
  v_exp_f32 v71, v71
  v_cvt_pk_bf16_f32 v98, v68, v69
  v_exp_f32 v72, v72
  v_exp_f32 v73, v73
  v_cvt_pk_bf16_f32 v99, v70, v71
  v_mfma_f32_32x32x16_bf16 v[80:95], v[44:47], v[204:207], v[80:95]
  v_exp_f32 v74, v74
  v_exp_f32 v75, v75
  ds_read_b128 v[48:51], v3 offset:45056
  v_cvt_pk_bf16_f32 v100, v72, v73
  v_exp_f32 v76, v76
  v_exp_f32 v77, v77
  ds_read_b128 v[52:55], v3 offset:46080
  v_cvt_pk_bf16_f32 v101, v74, v75
  v_exp_f32 v78, v78
  s_add_u32 m0, s31, 70656
  s_add_u32 s29, s53, s27
  s_add_u32 s29, s29, 5120
  buffer_load_dwordx4 v2, s[8:11], s29 offen sc1 lds
  v_exp_f32 v79, v79
  v_cvt_pk_bf16_f32 v102, v76, v77
  v_cvt_pk_bf16_f32 v103, v78, v79
  s_waitcnt lgkmcnt(4)
  v_mfma_f32_32x32x16_bf16 v[112:127], v[56:59], v[96:99], v[112:127]
  v_exp_f32 v80, v80
  v_exp_f32 v81, v81
  v_exp_f32 v82, v82
  v_exp_f32 v83, v83
  v_mfma_f32_32x32x16_bf16 v[112:127], v[60:63], v[100:103], v[112:127]
  v_cvt_pk_bf16_f32 v104, v80, v81
  v_exp_f32 v84, v84
  v_exp_f32 v85, v85
  v_cvt_pk_bf16_f32 v105, v82, v83
  v_exp_f32 v86, v86
  s_waitcnt lgkmcnt(2)
  v_mfma_f32_32x32x16_bf16 v[64:79], v[32:35], v[192:195], 0
  v_exp_f32 v87, v87
  v_cvt_pk_bf16_f32 v106, v84, v85
  v_exp_f32 v88, v88
  v_exp_f32 v89, v89
  v_cvt_pk_bf16_f32 v107, v86, v87
  v_mfma_f32_32x32x16_bf16 v[64:79], v[36:39], v[196:199], v[64:79]
  v_exp_f32 v90, v90
  v_exp_f32 v91, v91
  ds_read_b128 v[40:43], v3 offset:14336
  v_cvt_pk_bf16_f32 v108, v88, v89
  v_exp_f32 v92, v92
  v_exp_f32 v93, v93
  ds_read_b128 v[44:47], v3 offset:15360
  v_cvt_pk_bf16_f32 v109, v90, v91
  v_exp_f32 v94, v94
  v_exp_f32 v95, v95
  v_cvt_pk_bf16_f32 v110, v92, v93
  v_cvt_pk_bf16_f32 v111, v94, v95
  v_mfma_f32_32x32x16_bf16 v[128:143], v[56:59], v[104:107], v[128:143]
  v_exp_f32 v64, v64
  v_exp_f32 v65, v65
  v_exp_f32 v66, v66
  v_exp_f32 v67, v67
  v_mfma_f32_32x32x16_bf16 v[128:143], v[60:63], v[108:111], v[128:143]
  v_cvt_pk_bf16_f32 v96, v64, v65
  v_exp_f32 v68, v68
  v_exp_f32 v69, v69
  v_cvt_pk_bf16_f32 v97, v66, v67
  v_exp_f32 v70, v70
  v_mfma_f32_32x32x16_bf16 v[80:95], v[32:35], v[200:203], 0
  v_exp_f32 v71, v71
  v_cvt_pk_bf16_f32 v98, v68, v69
  v_exp_f32 v72, v72
  v_exp_f32 v73, v73
  v_cvt_pk_bf16_f32 v99, v70, v71
  v_mfma_f32_32x32x16_bf16 v[80:95], v[36:39], v[204:207], v[80:95]
  v_exp_f32 v74, v74
  v_exp_f32 v75, v75
  ds_read_b128 v[56:59], v3 offset:47104
  v_cvt_pk_bf16_f32 v100, v72, v73
  v_exp_f32 v76, v76
  v_exp_f32 v77, v77
  ds_read_b128 v[60:63], v3 offset:48128
  v_cvt_pk_bf16_f32 v101, v74, v75
  v_exp_f32 v78, v78
  s_add_u32 m0, s31, 71680
  s_add_u32 s29, s53, s27
  s_add_u32 s29, s29, 6144
  buffer_load_dwordx4 v2, s[8:11], s29 offen sc1 lds
  v_exp_f32 v79, v79
  v_cvt_pk_bf16_f32 v102, v76, v77
  v_cvt_pk_bf16_f32 v103, v78, v79
  s_waitcnt lgkmcnt(4)
  v_mfma_f32_32x32x16_bf16 v[112:127], v[48:51], v[96:99], v[112:127]
  v_exp_f32 v80, v80
  v_exp_f32 v81, v81
  v_exp_f32 v82, v82
  v_exp_f32 v83, v83
  v_mfma_f32_32x32x16_bf16 v[112:127], v[52:55], v[100:103], v[112:127]
  v_cvt_pk_bf16_f32 v104, v80, v81
  v_exp_f32 v84, v84
  v_exp_f32 v85, v85
  v_cvt_pk_bf16_f32 v105, v82, v83
  v_exp_f32 v86, v86
  s_waitcnt lgkmcnt(2)
  v_mfma_f32_32x32x16_bf16 v[64:79], v[40:43], v[192:195], 0
  v_exp_f32 v87, v87
  v_cvt_pk_bf16_f32 v106, v84, v85
  v_exp_f32 v88, v88
  v_exp_f32 v89, v89
  v_cvt_pk_bf16_f32 v107, v86, v87
  v_mfma_f32_32x32x16_bf16 v[64:79], v[44:47], v[196:199], v[64:79]
  v_exp_f32 v90, v90
  v_exp_f32 v91, v91
  ds_read_b128 v[32:35], v3 offset:16384
  v_cvt_pk_bf16_f32 v108, v88, v89
  v_exp_f32 v92, v92
  v_exp_f32 v93, v93
  ds_read_b128 v[36:39], v3 offset:17408
  v_cvt_pk_bf16_f32 v109, v90, v91
  v_exp_f32 v94, v94
  v_exp_f32 v95, v95
  v_cvt_pk_bf16_f32 v110, v92, v93
  v_cvt_pk_bf16_f32 v111, v94, v95
  v_mfma_f32_32x32x16_bf16 v[128:143], v[48:51], v[104:107], v[128:143]
  v_exp_f32 v64, v64
  v_exp_f32 v65, v65
  v_exp_f32 v66, v66
  v_exp_f32 v67, v67
  v_mfma_f32_32x32x16_bf16 v[128:143], v[52:55], v[108:111], v[128:143]
  v_cvt_pk_bf16_f32 v96, v64, v65
  v_exp_f32 v68, v68
  v_exp_f32 v69, v69
  v_cvt_pk_bf16_f32 v97, v66, v67
  v_exp_f32 v70, v70
  v_mfma_f32_32x32x16_bf16 v[80:95], v[40:43], v[200:203], 0
  v_exp_f32 v71, v71
  v_cvt_pk_bf16_f32 v98, v68, v69
  v_exp_f32 v72, v72
  v_exp_f32 v73, v73
  v_cvt_pk_bf16_f32 v99, v70, v71
  v_mfma_f32_32x32x16_bf16 v[80:95], v[44:47], v[204:207], v[80:95]
  v_exp_f32 v74, v74
  v_exp_f32 v75, v75
  ds_read_b128 v[48:51], v3 offset:49152
  v_cvt_pk_bf16_f32 v100, v72, v73
  v_exp_f32 v76, v76
  v_exp_f32 v77, v77
  ds_read_b128 v[52:55], v3 offset:50176
  v_cvt_pk_bf16_f32 v101, v74, v75
  v_exp_f32 v78, v78
  s_add_u32 m0, s31, 72704
  s_add_u32 s29, s53, s27
  s_add_u32 s29, s29, 7168
  buffer_load_dwordx4 v2, s[8:11], s29 offen sc1 lds
  v_exp_f32 v79, v79
  v_cvt_pk_bf16_f32 v102, v76, v77
  v_cvt_pk_bf16_f32 v103, v78, v79
  s_waitcnt lgkmcnt(4)
  v_mfma_f32_32x32x16_bf16 v[112:127], v[56:59], v[96:99], v[112:127]
  v_exp_f32 v80, v80
  v_exp_f32 v81, v81
  v_exp_f32 v82, v82
  v_exp_f32 v83, v83
  v_mfma_f32_32x32x16_bf16 v[112:127], v[60:63], v[100:103], v[112:127]
  v_cvt_pk_bf16_f32 v104, v80, v81
  v_exp_f32 v84, v84
  v_exp_f32 v85, v85
  v_cvt_pk_bf16_f32 v105, v82, v83
  v_exp_f32 v86, v86
  s_waitcnt lgkmcnt(2)
  v_mfma_f32_32x32x16_bf16 v[64:79], v[32:35], v[192:195], 0
  v_exp_f32 v87, v87
  v_cvt_pk_bf16_f32 v106, v84, v85
  v_exp_f32 v88, v88
  v_exp_f32 v89, v89
  v_cvt_pk_bf16_f32 v107, v86, v87
  v_mfma_f32_32x32x16_bf16 v[64:79], v[36:39], v[196:199], v[64:79]
  v_exp_f32 v90, v90
  v_exp_f32 v91, v91
  ds_read_b128 v[40:43], v3 offset:18432
  v_cvt_pk_bf16_f32 v108, v88, v89
  v_exp_f32 v92, v92
  v_exp_f32 v93, v93
  ds_read_b128 v[44:47], v3 offset:19456
  v_cvt_pk_bf16_f32 v109, v90, v91
  v_exp_f32 v94, v94
  v_exp_f32 v95, v95
  v_cvt_pk_bf16_f32 v110, v92, v93
  v_cvt_pk_bf16_f32 v111, v94, v95
  v_mfma_f32_32x32x16_bf16 v[128:143], v[56:59], v[104:107], v[128:143]
  v_exp_f32 v64, v64
  v_exp_f32 v65, v65
  v_exp_f32 v66, v66
  v_exp_f32 v67, v67
  v_mfma_f32_32x32x16_bf16 v[128:143], v[60:63], v[108:111], v[128:143]
  v_cvt_pk_bf16_f32 v96, v64, v65
  v_exp_f32 v68, v68
  v_exp_f32 v69, v69
  v_cvt_pk_bf16_f32 v97, v66, v67
  v_exp_f32 v70, v70
  v_mfma_f32_32x32x16_bf16 v[80:95], v[32:35], v[200:203], 0
  v_exp_f32 v71, v71
  v_cvt_pk_bf16_f32 v98, v68, v69
  v_exp_f32 v72, v72
  v_exp_f32 v73, v73
  v_cvt_pk_bf16_f32 v99, v70, v71
  v_mfma_f32_32x32x16_bf16 v[80:95], v[36:39], v[204:207], v[80:95]
  v_exp_f32 v74, v74
  v_exp_f32 v75, v75
  ds_read_b128 v[56:59], v3 offset:51200
  v_cvt_pk_bf16_f32 v100, v72, v73
  v_exp_f32 v76, v76
  v_exp_f32 v77, v77
  ds_read_b128 v[60:63], v3 offset:52224
  v_cvt_pk_bf16_f32 v101, v74, v75
  v_exp_f32 v78, v78
  s_add_u32 m0, s31, 98304
  s_add_u32 s29, s53, s28
  s_add_u32 s29, s29, 0
  buffer_load_dwordx4 v2, s[8:11], s29 offen sc1 lds
  v_exp_f32 v79, v79
  v_cvt_pk_bf16_f32 v102, v76, v77
  v_cvt_pk_bf16_f32 v103, v78, v79
  s_waitcnt lgkmcnt(4)
  v_mfma_f32_32x32x16_bf16 v[112:127], v[48:51], v[96:99], v[112:127]
  v_exp_f32 v80, v80
  v_exp_f32 v81, v81
  v_exp_f32 v82, v82
  v_exp_f32 v83, v83
  v_mfma_f32_32x32x16_bf16 v[112:127], v[52:55], v[100:103], v[112:127]
  v_cvt_pk_bf16_f32 v104, v80, v81
  v_exp_f32 v84, v84
  v_exp_f32 v85, v85
  v_cvt_pk_bf16_f32 v105, v82, v83
  v_exp_f32 v86, v86
  s_waitcnt lgkmcnt(2)
  v_mfma_f32_32x32x16_bf16 v[64:79], v[40:43], v[192:195], 0
  v_exp_f32 v87, v87
  v_cvt_pk_bf16_f32 v106, v84, v85
  v_exp_f32 v88, v88
  v_exp_f32 v89, v89
  v_cvt_pk_bf16_f32 v107, v86, v87
  v_mfma_f32_32x32x16_bf16 v[64:79], v[44:47], v[196:199], v[64:79]
  v_exp_f32 v90, v90
  v_exp_f32 v91, v91
  ds_read_b128 v[32:35], v3 offset:20480
  v_cvt_pk_bf16_f32 v108, v88, v89
  v_exp_f32 v92, v92
  v_exp_f32 v93, v93
  ds_read_b128 v[36:39], v3 offset:21504
  v_cvt_pk_bf16_f32 v109, v90, v91
  v_exp_f32 v94, v94
  v_exp_f32 v95, v95
  v_cvt_pk_bf16_f32 v110, v92, v93
  v_cvt_pk_bf16_f32 v111, v94, v95
  v_mfma_f32_32x32x16_bf16 v[128:143], v[48:51], v[104:107], v[128:143]
  v_exp_f32 v64, v64
  v_exp_f32 v65, v65
  v_exp_f32 v66, v66
  v_exp_f32 v67, v67
  v_mfma_f32_32x32x16_bf16 v[128:143], v[52:55], v[108:111], v[128:143]
  v_cvt_pk_bf16_f32 v96, v64, v65
  v_exp_f32 v68, v68
  v_exp_f32 v69, v69
  v_cvt_pk_bf16_f32 v97, v66, v67
  v_exp_f32 v70, v70
  v_mfma_f32_32x32x16_bf16 v[80:95], v[40:43], v[200:203], 0
  v_exp_f32 v71, v71
  v_cvt_pk_bf16_f32 v98, v68, v69
  v_exp_f32 v72, v72
  v_exp_f32 v73, v73
  v_cvt_pk_bf16_f32 v99, v70, v71
  v_mfma_f32_32x32x16_bf16 v[80:95], v[44:47], v[204:207], v[80:95]
  v_exp_f32 v74, v74
  v_exp_f32 v75, v75
  ds_read_b128 v[48:51], v3 offset:53248
  v_cvt_pk_bf16_f32 v100, v72, v73
  v_exp_f32 v76, v76
  v_exp_f32 v77, v77
  ds_read_b128 v[52:55], v3 offset:54272
  v_cvt_pk_bf16_f32 v101, v74, v75
  v_exp_f32 v78, v78
  s_add_u32 m0, s31, 99328
  s_add_u32 s29, s53, s28
  s_add_u32 s29, s29, 1024
  buffer_load_dwordx4 v2, s[8:11], s29 offen sc1 lds
  v_exp_f32 v79, v79
  v_cvt_pk_bf16_f32 v102, v76, v77
  v_cvt_pk_bf16_f32 v103, v78, v79
  s_waitcnt lgkmcnt(4)
  v_mfma_f32_32x32x16_bf16 v[112:127], v[56:59], v[96:99], v[112:127]
  v_exp_f32 v80, v80
  v_exp_f32 v81, v81
  v_exp_f32 v82, v82
  v_exp_f32 v83, v83
  v_mfma_f32_32x32x16_bf16 v[112:127], v[60:63], v[100:103], v[112:127]
  v_cvt_pk_bf16_f32 v104, v80, v81
  v_exp_f32 v84, v84
  v_exp_f32 v85, v85
  v_cvt_pk_bf16_f32 v105, v82, v83
  v_exp_f32 v86, v86
  s_waitcnt lgkmcnt(2)
  v_mfma_f32_32x32x16_bf16 v[64:79], v[32:35], v[192:195], 0
  v_exp_f32 v87, v87
  v_cvt_pk_bf16_f32 v106, v84, v85
  v_exp_f32 v88, v88
  v_exp_f32 v89, v89
  v_cvt_pk_bf16_f32 v107, v86, v87
  v_mfma_f32_32x32x16_bf16 v[64:79], v[36:39], v[196:199], v[64:79]
  v_exp_f32 v90, v90
  v_exp_f32 v91, v91
  ds_read_b128 v[40:43], v3 offset:22528
  v_cvt_pk_bf16_f32 v108, v88, v89
  v_exp_f32 v92, v92
  v_exp_f32 v93, v93
  ds_read_b128 v[44:47], v3 offset:23552
  v_cvt_pk_bf16_f32 v109, v90, v91
  v_exp_f32 v94, v94
  v_exp_f32 v95, v95
  v_cvt_pk_bf16_f32 v110, v92, v93
  v_cvt_pk_bf16_f32 v111, v94, v95
  v_mfma_f32_32x32x16_bf16 v[128:143], v[56:59], v[104:107], v[128:143]
  v_exp_f32 v64, v64
  v_exp_f32 v65, v65
  v_exp_f32 v66, v66
  v_exp_f32 v67, v67
  v_mfma_f32_32x32x16_bf16 v[128:143], v[60:63], v[108:111], v[128:143]
  v_cvt_pk_bf16_f32 v96, v64, v65
  v_exp_f32 v68, v68
  v_exp_f32 v69, v69
  v_cvt_pk_bf16_f32 v97, v66, v67
  v_exp_f32 v70, v70
  v_mfma_f32_32x32x16_bf16 v[80:95], v[32:35], v[200:203], 0
  v_exp_f32 v71, v71
  v_cvt_pk_bf16_f32 v98, v68, v69
  v_exp_f32 v72, v72
  v_exp_f32 v73, v73
  v_cvt_pk_bf16_f32 v99, v70, v71
  v_mfma_f32_32x32x16_bf16 v[80:95], v[36:39], v[204:207], v[80:95]
  v_exp_f32 v74, v74
  v_exp_f32 v75, v75
  ds_read_b128 v[56:59], v3 offset:55296
  v_cvt_pk_bf16_f32 v100, v72, v73
  v_exp_f32 v76, v76
  v_exp_f32 v77, v77
  ds_read_b128 v[60:63], v3 offset:56320
  v_cvt_pk_bf16_f32 v101, v74, v75
  v_exp_f32 v78, v78
  s_add_u32 m0, s31, 100352
  s_add_u32 s29, s53, s28
  s_add_u32 s29, s29, 2048
  buffer_load_dwordx4 v2, s[8:11], s29 offen sc1 lds
  v_exp_f32 v79, v79
  v_cvt_pk_bf16_f32 v102, v76, v77
  v_cvt_pk_bf16_f32 v103, v78, v79
  s_waitcnt lgkmcnt(4)
  v_mfma_f32_32x32x16_bf16 v[112:127], v[48:51], v[96:99], v[112:127]
  v_exp_f32 v80, v80
  v_exp_f32 v81, v81
  v_exp_f32 v82, v82
  v_exp_f32 v83, v83
  v_mfma_f32_32x32x16_bf16 v[112:127], v[52:55], v[100:103], v[112:127]
  v_cvt_pk_bf16_f32 v104, v80, v81
  v_exp_f32 v84, v84
  v_exp_f32 v85, v85
  v_cvt_pk_bf16_f32 v105, v82, v83
  v_exp_f32 v86, v86
  s_waitcnt lgkmcnt(2)
  v_mfma_f32_32x32x16_bf16 v[64:79], v[40:43], v[192:195], 0
  v_exp_f32 v87, v87
  v_cvt_pk_bf16_f32 v106, v84, v85
  v_exp_f32 v88, v88
  v_exp_f32 v89, v89
  v_cvt_pk_bf16_f32 v107, v86, v87
  v_mfma_f32_32x32x16_bf16 v[64:79], v[44:47], v[196:199], v[64:79]
  v_exp_f32 v90, v90
  v_exp_f32 v91, v91
  ds_read_b128 v[32:35], v3 offset:24576
  v_cvt_pk_bf16_f32 v108, v88, v89
  v_exp_f32 v92, v92
  v_exp_f32 v93, v93
  ds_read_b128 v[36:39], v3 offset:25600
  v_cvt_pk_bf16_f32 v109, v90, v91
  v_exp_f32 v94, v94
  v_exp_f32 v95, v95
  v_cvt_pk_bf16_f32 v110, v92, v93
  v_cvt_pk_bf16_f32 v111, v94, v95
  v_mfma_f32_32x32x16_bf16 v[128:143], v[48:51], v[104:107], v[128:143]
  v_exp_f32 v64, v64
  v_exp_f32 v65, v65
  v_exp_f32 v66, v66
  v_exp_f32 v67, v67
  v_mfma_f32_32x32x16_bf16 v[128:143], v[52:55], v[108:111], v[128:143]
  v_cvt_pk_bf16_f32 v96, v64, v65
  v_exp_f32 v68, v68
  v_exp_f32 v69, v69
  v_cvt_pk_bf16_f32 v97, v66, v67
  v_exp_f32 v70, v70
  v_mfma_f32_32x32x16_bf16 v[80:95], v[40:43], v[200:203], 0
  v_exp_f32 v71, v71
  v_cvt_pk_bf16_f32 v98, v68, v69
  v_exp_f32 v72, v72
  v_exp_f32 v73, v73
  v_cvt_pk_bf16_f32 v99, v70, v71
  v_mfma_f32_32x32x16_bf16 v[80:95], v[44:47], v[204:207], v[80:95]
  v_exp_f32 v74, v74
  v_exp_f32 v75, v75
  ds_read_b128 v[48:51], v3 offset:57344
  v_cvt_pk_bf16_f32 v100, v72, v73
  v_exp_f32 v76, v76
  v_exp_f32 v77, v77
  ds_read_b128 v[52:55], v3 offset:58368
  v_cvt_pk_bf16_f32 v101, v74, v75
  v_exp_f32 v78, v78
  s_add_u32 m0, s31, 101376
  s_add_u32 s29, s53, s28
  s_add_u32 s29, s29, 3072
  buffer_load_dwordx4 v2, s[8:11], s29 offen sc1 lds
  v_exp_f32 v79, v79
  v_cvt_pk_bf16_f32 v102, v76, v77
  v_cvt_pk_bf16_f32 v103, v78, v79
  s_waitcnt lgkmcnt(4)
  v_mfma_f32_32x32x16_bf16 v[112:127], v[56:59], v[96:99], v[112:127]
  v_exp_f32 v80, v80
  v_exp_f32 v81, v81
  v_exp_f32 v82, v82
  v_exp_f32 v83, v83
  v_mfma_f32_32x32x16_bf16 v[112:127], v[60:63], v[100:103], v[112:127]
  v_cvt_pk_bf16_f32 v104, v80, v81
  v_exp_f32 v84, v84
  v_exp_f32 v85, v85
  v_cvt_pk_bf16_f32 v105, v82, v83
  v_exp_f32 v86, v86
  s_waitcnt lgkmcnt(2)
  v_mfma_f32_32x32x16_bf16 v[64:79], v[32:35], v[192:195], 0
  v_exp_f32 v87, v87
  v_cvt_pk_bf16_f32 v106, v84, v85
  v_exp_f32 v88, v88
  v_exp_f32 v89, v89
  v_cvt_pk_bf16_f32 v107, v86, v87
  v_mfma_f32_32x32x16_bf16 v[64:79], v[36:39], v[196:199], v[64:79]
  v_exp_f32 v90, v90
  v_exp_f32 v91, v91
  ds_read_b128 v[40:43], v3 offset:26624
  v_cvt_pk_bf16_f32 v108, v88, v89
  v_exp_f32 v92, v92
  v_exp_f32 v93, v93
  ds_read_b128 v[44:47], v3 offset:27648
  v_cvt_pk_bf16_f32 v109, v90, v91
  v_exp_f32 v94, v94
  v_exp_f32 v95, v95
  v_cvt_pk_bf16_f32 v110, v92, v93
  v_cvt_pk_bf16_f32 v111, v94, v95
  v_mfma_f32_32x32x16_bf16 v[128:143], v[56:59], v[104:107], v[128:143]
  v_exp_f32 v64, v64
  v_exp_f32 v65, v65
  v_exp_f32 v66, v66
  v_exp_f32 v67, v67
  v_mfma_f32_32x32x16_bf16 v[128:143], v[60:63], v[108:111], v[128:143]
  v_cvt_pk_bf16_f32 v96, v64, v65
  v_exp_f32 v68, v68
  v_exp_f32 v69, v69
  v_cvt_pk_bf16_f32 v97, v66, v67
  v_exp_f32 v70, v70
  v_mfma_f32_32x32x16_bf16 v[80:95], v[32:35], v[200:203], 0
  v_exp_f32 v71, v71
  v_cvt_pk_bf16_f32 v98, v68, v69
  v_exp_f32 v72, v72
  v_exp_f32 v73, v73
  v_cvt_pk_bf16_f32 v99, v70, v71
  v_mfma_f32_32x32x16_bf16 v[80:95], v[36:39], v[204:207], v[80:95]
  v_exp_f32 v74, v74
  v_exp_f32 v75, v75
  ds_read_b128 v[56:59], v3 offset:59392
  v_cvt_pk_bf16_f32 v100, v72, v73
  v_exp_f32 v76, v76
  v_exp_f32 v77, v77
  ds_read_b128 v[60:63], v3 offset:60416
  v_cvt_pk_bf16_f32 v101, v74, v75
  v_exp_f32 v78, v78
  s_add_u32 m0, s31, 102400
  s_add_u32 s29, s53, s28
  s_add_u32 s29, s29, 4096
  buffer_load_dwordx4 v2, s[8:11], s29 offen sc1 lds
  v_exp_f32 v79, v79
  v_cvt_pk_bf16_f32 v102, v76, v77
  v_cvt_pk_bf16_f32 v103, v78, v79
  s_waitcnt lgkmcnt(4)
  v_mfma_f32_32x32x16_bf16 v[112:127], v[48:51], v[96:99], v[112:127]
  v_exp_f32 v80, v80
  v_exp_f32 v81, v81
  v_exp_f32 v82, v82
  v_exp_f32 v83, v83
  v_mfma_f32_32x32x16_bf16 v[112:127], v[52:55], v[100:103], v[112:127]
  v_cvt_pk_bf16_f32 v104, v80, v81
  v_exp_f32 v84, v84
  v_exp_f32 v85, v85
  v_cvt_pk_bf16_f32 v105, v82, v83
  v_exp_f32 v86, v86
  s_waitcnt lgkmcnt(2)
  v_mfma_f32_32x32x16_bf16 v[64:79], v[40:43], v[192:195], 0
  v_exp_f32 v87, v87
  v_cvt_pk_bf16_f32 v106, v84, v85
  v_exp_f32 v88, v88
  v_exp_f32 v89, v89
  v_cvt_pk_bf16_f32 v107, v86, v87
  v_mfma_f32_32x32x16_bf16 v[64:79], v[44:47], v[196:199], v[64:79]
  v_exp_f32 v90, v90
  v_exp_f32 v91, v91
  ds_read_b128 v[32:35], v3 offset:28672
  v_cvt_pk_bf16_f32 v108, v88, v89
  v_exp_f32 v92, v92
  v_exp_f32 v93, v93
  ds_read_b128 v[36:39], v3 offset:29696
  v_cvt_pk_bf16_f32 v109, v90, v91
  v_exp_f32 v94, v94
  v_exp_f32 v95, v95
  v_cvt_pk_bf16_f32 v110, v92, v93
  v_cvt_pk_bf16_f32 v111, v94, v95
  v_mfma_f32_32x32x16_bf16 v[128:143], v[48:51], v[104:107], v[128:143]
  v_exp_f32 v64, v64
  v_exp_f32 v65, v65
  v_exp_f32 v66, v66
  v_exp_f32 v67, v67
  v_mfma_f32_32x32x16_bf16 v[128:143], v[52:55], v[108:111], v[128:143]
  v_cvt_pk_bf16_f32 v96, v64, v65
  v_exp_f32 v68, v68
  v_exp_f32 v69, v69
  v_cvt_pk_bf16_f32 v97, v66, v67
  v_exp_f32 v70, v70
  v_mfma_f32_32x32x16_bf16 v[80:95], v[40:43], v[200:203], 0
  v_exp_f32 v71, v71
  v_cvt_pk_bf16_f32 v98, v68, v69
  v_exp_f32 v72, v72
  v_exp_f32 v73, v73
  v_cvt_pk_bf16_f32 v99, v70, v71
  v_mfma_f32_32x32x16_bf16 v[80:95], v[44:47], v[204:207], v[80:95]
  v_exp_f32 v74, v74
  v_exp_f32 v75, v75
  ds_read_b128 v[48:51], v3 offset:61440
  v_cvt_pk_bf16_f32 v100, v72, v73
  v_exp_f32 v76, v76
  v_exp_f32 v77, v77
  ds_read_b128 v[52:55], v3 offset:62464
  v_cvt_pk_bf16_f32 v101, v74, v75
  v_exp_f32 v78, v78
  s_add_u32 m0, s31, 103424
  s_add_u32 s29, s53, s28
  s_add_u32 s29, s29, 5120
  buffer_load_dwordx4 v2, s[8:11], s29 offen sc1 lds
  v_exp_f32 v79, v79
  v_cvt_pk_bf16_f32 v102, v76, v77
  v_cvt_pk_bf16_f32 v103, v78, v79
  s_waitcnt lgkmcnt(4)
  v_mfma_f32_32x32x16_bf16 v[112:127], v[56:59], v[96:99], v[112:127]
  v_exp_f32 v80, v80
  v_exp_f32 v81, v81
  v_exp_f32 v82, v82
  v_exp_f32 v83, v83
  v_mfma_f32_32x32x16_bf16 v[112:127], v[60:63], v[100:103], v[112:127]
  v_cvt_pk_bf16_f32 v104, v80, v81
  v_exp_f32 v84, v84
  v_exp_f32 v85, v85
  v_cvt_pk_bf16_f32 v105, v82, v83
  v_exp_f32 v86, v86
  s_waitcnt lgkmcnt(2)
  v_mfma_f32_32x32x16_bf16 v[64:79], v[32:35], v[192:195], 0
  v_exp_f32 v87, v87
  v_cvt_pk_bf16_f32 v106, v84, v85
  v_exp_f32 v88, v88
  v_exp_f32 v89, v89
  v_cvt_pk_bf16_f32 v107, v86, v87
  v_mfma_f32_32x32x16_bf16 v[64:79], v[36:39], v[196:199], v[64:79]
  v_exp_f32 v90, v90
  v_exp_f32 v91, v91
  ds_read_b128 v[40:43], v3 offset:30720
  v_cvt_pk_bf16_f32 v108, v88, v89
  v_exp_f32 v92, v92
  v_exp_f32 v93, v93
  ds_read_b128 v[44:47], v3 offset:31744
  v_cvt_pk_bf16_f32 v109, v90, v91
  v_exp_f32 v94, v94
  v_exp_f32 v95, v95
  v_cvt_pk_bf16_f32 v110, v92, v93
  v_cvt_pk_bf16_f32 v111, v94, v95
  v_mfma_f32_32x32x16_bf16 v[128:143], v[56:59], v[104:107], v[128:143]
  v_exp_f32 v64, v64
  v_exp_f32 v65, v65
  v_exp_f32 v66, v66
  v_exp_f32 v67, v67
  v_mfma_f32_32x32x16_bf16 v[128:143], v[60:63], v[108:111], v[128:143]
  v_cvt_pk_bf16_f32 v96, v64, v65
  v_exp_f32 v68, v68
  v_exp_f32 v69, v69
  v_cvt_pk_bf16_f32 v97, v66, v67
  v_exp_f32 v70, v70
  v_mfma_f32_32x32x16_bf16 v[80:95], v[32:35], v[200:203], 0
  v_exp_f32 v71, v71
  v_cvt_pk_bf16_f32 v98, v68, v69
  v_exp_f32 v72, v72
  v_exp_f32 v73, v73
  v_cvt_pk_bf16_f32 v99, v70, v71
  v_mfma_f32_32x32x16_bf16 v[80:95], v[36:39], v[204:207], v[80:95]
  v_exp_f32 v74, v74
  v_exp_f32 v75, v75
  ds_read_b128 v[56:59], v3 offset:63488
  v_cvt_pk_bf16_f32 v100, v72, v73
  v_exp_f32 v76, v76
  v_exp_f32 v77, v77
  ds_read_b128 v[60:63], v3 offset:64512
  v_cvt_pk_bf16_f32 v101, v74, v75
  v_exp_f32 v78, v78
  s_add_u32 m0, s31, 104448
  s_add_u32 s29, s53, s28
  s_add_u32 s29, s29, 6144
  buffer_load_dwordx4 v2, s[8:11], s29 offen sc1 lds
  v_exp_f32 v79, v79
  v_cvt_pk_bf16_f32 v102, v76, v77
  v_cvt_pk_bf16_f32 v103, v78, v79
  s_waitcnt lgkmcnt(4)
  v_mfma_f32_32x32x16_bf16 v[112:127], v[48:51], v[96:99], v[112:127]
  v_exp_f32 v80, v80
  v_exp_f32 v81, v81
  v_exp_f32 v82, v82
  v_exp_f32 v83, v83
  v_mfma_f32_32x32x16_bf16 v[112:127], v[52:55], v[100:103], v[112:127]
  v_cvt_pk_bf16_f32 v104, v80, v81
  v_exp_f32 v84, v84
  v_exp_f32 v85, v85
  v_cvt_pk_bf16_f32 v105, v82, v83
  v_exp_f32 v86, v86
  s_waitcnt lgkmcnt(2)
  v_mfma_f32_32x32x16_bf16 v[64:79], v[40:43], v[192:195], 0
  v_exp_f32 v87, v87
  v_cvt_pk_bf16_f32 v106, v84, v85
  v_exp_f32 v88, v88
  v_exp_f32 v89, v89
  v_cvt_pk_bf16_f32 v107, v86, v87
  v_mfma_f32_32x32x16_bf16 v[64:79], v[44:47], v[196:199], v[64:79]
  v_exp_f32 v90, v90
  v_exp_f32 v91, v91
  v_cvt_pk_bf16_f32 v108, v88, v89
  v_exp_f32 v92, v92
  v_exp_f32 v93, v93
  v_cvt_pk_bf16_f32 v109, v90, v91
  v_exp_f32 v94, v94
  v_exp_f32 v95, v95
  v_cvt_pk_bf16_f32 v110, v92, v93
  v_cvt_pk_bf16_f32 v111, v94, v95
  v_mfma_f32_32x32x16_bf16 v[128:143], v[48:51], v[104:107], v[128:143]
  v_exp_f32 v64, v64
  v_exp_f32 v65, v65
  v_exp_f32 v66, v66
  v_exp_f32 v67, v67
  v_mfma_f32_32x32x16_bf16 v[128:143], v[52:55], v[108:111], v[128:143]
  v_cvt_pk_bf16_f32 v96, v64, v65
  v_exp_f32 v68, v68
  v_exp_f32 v69, v69
  v_cvt_pk_bf16_f32 v97, v66, v67
  v_exp_f32 v70, v70
  v_mfma_f32_32x32x16_bf16 v[80:95], v[40:43], v[200:203], 0
  v_exp_f32 v71, v71
  v_cvt_pk_bf16_f32 v98, v68, v69
  v_exp_f32 v72, v72
  v_exp_f32 v73, v73
  v_cvt_pk_bf16_f32 v99, v70, v71
  v_mfma_f32_32x32x16_bf16 v[80:95], v[44:47], v[204:207], v[80:95]
  v_exp_f32 v74, v74
  v_exp_f32 v75, v75
  v_cvt_pk_bf16_f32 v100, v72, v73
  v_exp_f32 v76, v76
  v_exp_f32 v77, v77
  v_cvt_pk_bf16_f32 v101, v74, v75
  v_exp_f32 v78, v78
  s_add_u32 m0, s31, 105472
  s_add_u32 s29, s53, s28
  s_add_u32 s29, s29, 7168
  buffer_load_dwordx4 v2, s[8:11], s29 offen sc1 lds
  v_exp_f32 v79, v79
  v_cvt_pk_bf16_f32 v102, v76, v77
  v_cvt_pk_bf16_f32 v103, v78, v79
  s_waitcnt lgkmcnt(0)
  v_mfma_f32_32x32x16_bf16 v[112:127], v[56:59], v[96:99], v[112:127]
  v_exp_f32 v80, v80
  v_exp_f32 v81, v81
  v_exp_f32 v82, v82
  v_exp_f32 v83, v83
  v_mfma_f32_32x32x16_bf16 v[112:127], v[60:63], v[100:103], v[112:127]
  v_cvt_pk_bf16_f32 v104, v80, v81
  v_exp_f32 v84, v84
  v_exp_f32 v85, v85
  v_cvt_pk_bf16_f32 v105, v82, v83
  v_exp_f32 v86, v86
  v_exp_f32 v87, v87
  v_cvt_pk_bf16_f32 v106, v84, v85
  v_exp_f32 v88, v88
  v_exp_f32 v89, v89
  v_cvt_pk_bf16_f32 v107, v86, v87
  v_exp_f32 v90, v90
  v_exp_f32 v91, v91
  v_cvt_pk_bf16_f32 v108, v88, v89
  v_exp_f32 v92, v92
  v_exp_f32 v93, v93
  v_cvt_pk_bf16_f32 v109, v90, v91
  v_exp_f32 v94, v94
  v_exp_f32 v95, v95
  v_cvt_pk_bf16_f32 v110, v92, v93
  v_cvt_pk_bf16_f32 v111, v94, v95
  s_nop 1
  v_mfma_f32_32x32x16_bf16 v[128:143], v[56:59], v[104:107], v[128:143]
  v_mfma_f32_32x32x16_bf16 v[128:143], v[60:63], v[108:111], v[128:143]
  s_waitcnt vmcnt(0)
  s_barrier
  s_add_u32 s41, s41, 1
  s_min_u32 s29, s41, 3
  s_mul_i32 s53, s29, 32768
  s_lshl_b32 s31, s21, 13
  s_add_u32 s53, s53, s31
  ds_read_b128 v[32:35], v4 offset:0
  ds_read_b128 v[36:39], v4 offset:1024
  ds_read_b128 v[48:51], v4 offset:32768
  ds_read_b128 v[52:55], v4 offset:33792
  ds_read_b128 v[40:43], v4 offset:2048
  ds_read_b128 v[44:47], v4 offset:3072
  s_waitcnt lgkmcnt(4)
  v_mfma_f32_32x32x16_bf16 v[64:79], v[32:35], v[192:195], 0
  v_mfma_f32_32x32x16_bf16 v[64:79], v[36:39], v[196:199], v[64:79]
  s_nop 11
  v_exp_f32 v64, v64
  v_exp_f32 v65, v65
  v_exp_f32 v66, v66
  v_exp_f32 v67, v67
  v_cvt_pk_bf16_f32 v96, v64, v65
  v_exp_f32 v68, v68
  v_exp_f32 v69, v69
  v_cvt_pk_bf16_f32 v97, v66, v67
  v_exp_f32 v70, v70
  v_mfma_f32_32x32x16_bf16 v[80:95], v[32:35], v[200:203], 0
  v_exp_f32 v71, v71
  v_cvt_pk_bf16_f32 v98, v68, v69
  v_exp_f32 v72, v72
  v_exp_f32 v73, v73
  v_cvt_pk_bf16_f32 v99, v70, v71
  v_mfma_f32_32x32x16_bf16 v[80:95], v[36:39], v[204:207], v[80:95]
  v_exp_f32 v74, v74
  v_exp_f32 v75, v75
  ds_read_b128 v[56:59], v4 offset:34816
  v_cvt_pk_bf16_f32 v100, v72, v73
  v_exp_f32 v76, v76
  v_exp_f32 v77, v77
  ds_read_b128 v[60:63], v4 offset:35840
  v_cvt_pk_bf16_f32 v101, v74, v75
  v_exp_f32 v78, v78
  s_add_u32 m0, s31, 0
  s_add_u32 s29, s53, s27
  s_add_u32 s29, s29, 0
  buffer_load_dwordx4 v2, s[8:11], s29 offen sc1 lds
  v_exp_f32 v79, v79
  v_cvt_pk_bf16_f32 v102, v76, v77
  v_cvt_pk_bf16_f32 v103, v78, v79
  s_waitcnt lgkmcnt(4)
  v_mfma_f32_32x32x16_bf16 v[112:127], v[48:51], v[96:99], v[112:127]
  v_exp_f32 v80, v80
  v_exp_f32 v81, v81
  v_exp_f32 v82, v82
  v_exp_f32 v83, v83
  v_mfma_f32_32x32x16_bf16 v[112:127], v[52:55], v[100:103], v[112:127]
  v_cvt_pk_bf16_f32 v104, v80, v81
  v_exp_f32 v84, v84
  v_exp_f32 v85, v85
  v_cvt_pk_bf16_f32 v105, v82, v83
  v_exp_f32 v86, v86
  s_waitcnt lgkmcnt(2)
  v_mfma_f32_32x32x16_bf16 v[64:79], v[40:43], v[192:195], 0
  v_exp_f32 v87, v87
  v_cvt_pk_bf16_f32 v106, v84, v85
  v_exp_f32 v88, v88
  v_exp_f32 v89, v89
  v_cvt_pk_bf16_f32 v107, v86, v87
  v_mfma_f32_32x32x16_bf16 v[64:79], v[44:47], v[196:199], v[64:79]
  v_exp_f32 v90, v90
  v_exp_f32 v91, v91
  ds_read_b128 v[32:35], v4 offset:4096
  v_cvt_pk_bf16_f32 v108, v88, v89
  v_exp_f32 v92, v92
  v_exp_f32 v93, v93
  ds_read_b128 v[36:39], v4 offset:5120
  v_cvt_pk_bf16_f32 v109, v90, v91
  v_exp_f32 v94, v94
  v_exp_f32 v95, v95
  v_cvt_pk_bf16_f32 v110, v92, v93
  v_cvt_pk_bf16_f32 v111, v94, v95
  v_mfma_f32_32x32x16_bf16 v[128:143], v[48:51], v[104:107], v[128:143]
  v_exp_f32 v64, v64
  v_exp_f32 v65, v65
  v_exp_f32 v66, v66
  v_exp_f32 v67, v67
  v_mfma_f32_32x32x16_bf16 v[128:143], v[52:55], v[108:111], v[128:143]
  v_cvt_pk_bf16_f32 v96, v64, v65
  v_exp_f32 v68, v68
  v_exp_f32 v69, v69
  v_cvt_pk_bf16_f32 v97, v66, v67
  v_exp_f32 v70, v70
  v_mfma_f32_32x32x16_bf16 v[80:95], v[40:43], v[200:203], 0
  v_exp_f32 v71, v71
  v_cvt_pk_bf16_f32 v98, v68, v69
  v_exp_f32 v72, v72
  v_exp_f32 v73, v73
  v_cvt_pk_bf16_f32 v99, v70, v71
  v_mfma_f32_32x32x16_bf16 v[80:95], v[44:47], v[204:207], v[80:95]
  v_exp_f32 v74, v74
  v_exp_f32 v75, v75
  ds_read_b128 v[48:51], v4 offset:36864
  v_cvt_pk_bf16_f32 v100, v72, v73
  v_exp_f32 v76, v76
  v_exp_f32 v77, v77
  ds_read_b128 v[52:55], v4 offset:37888
  v_cvt_pk_bf16_f32 v101, v74, v75
  v_exp_f32 v78, v78
  s_add_u32 m0, s31, 1024
  s_add_u32 s29, s53, s27
  s_add_u32 s29, s29, 1024
  buffer_load_dwordx4 v2, s[8:11], s29 offen sc1 lds
  v_exp_f32 v79, v79
  v_cvt_pk_bf16_f32 v102, v76, v77
  v_cvt_pk_bf16_f32 v103, v78, v79
  s_waitcnt lgkmcnt(4)
  v_mfma_f32_32x32x16_bf16 v[112:127], v[56:59], v[96:99], v[112:127]
  v_exp_f32 v80, v80
  v_exp_f32 v81, v81
  v_exp_f32 v82, v82
  v_exp_f32 v83, v83
  v_mfma_f32_32x32x16_bf16 v[112:127], v[60:63], v[100:103], v[112:127]
  v_cvt_pk_bf16_f32 v104, v80, v81
  v_exp_f32 v84, v84
  v_exp_f32 v85, v85
  v_cvt_pk_bf16_f32 v105, v82, v83
  v_exp_f32 v86, v86
  s_waitcnt lgkmcnt(2)
  v_mfma_f32_32x32x16_bf16 v[64:79], v[32:35], v[192:195], 0
  v_exp_f32 v87, v87
  v_cvt_pk_bf16_f32 v106, v84, v85
  v_exp_f32 v88, v88
  v_exp_f32 v89, v89
  v_cvt_pk_bf16_f32 v107, v86, v87
  v_mfma_f32_32x32x16_bf16 v[64:79], v[36:39], v[196:199], v[64:79]
  v_exp_f32 v90, v90
  v_exp_f32 v91, v91
  ds_read_b128 v[40:43], v4 offset:6144
  v_cvt_pk_bf16_f32 v108, v88, v89
  v_exp_f32 v92, v92
  v_exp_f32 v93, v93
  ds_read_b128 v[44:47], v4 offset:7168
  v_cvt_pk_bf16_f32 v109, v90, v91
  v_exp_f32 v94, v94
  v_exp_f32 v95, v95
  v_cvt_pk_bf16_f32 v110, v92, v93
  v_cvt_pk_bf16_f32 v111, v94, v95
  v_mfma_f32_32x32x16_bf16 v[128:143], v[56:59], v[104:107], v[128:143]
  v_exp_f32 v64, v64
  v_exp_f32 v65, v65
  v_exp_f32 v66, v66
  v_exp_f32 v67, v67
  v_mfma_f32_32x32x16_bf16 v[128:143], v[60:63], v[108:111], v[128:143]
  v_cvt_pk_bf16_f32 v96, v64, v65
  v_exp_f32 v68, v68
  v_exp_f32 v69, v69
  v_cvt_pk_bf16_f32 v97, v66, v67
  v_exp_f32 v70, v70
  v_mfma_f32_32x32x16_bf16 v[80:95], v[32:35], v[200:203], 0
  v_exp_f32 v71, v71
  v_cvt_pk_bf16_f32 v98, v68, v69
  v_exp_f32 v72, v72
  v_exp_f32 v73, v73
  v_cvt_pk_bf16_f32 v99, v70, v71
  v_mfma_f32_32x32x16_bf16 v[80:95], v[36:39], v[204:207], v[80:95]
  v_exp_f32 v74, v74
  v_exp_f32 v75, v75
  ds_read_b128 v[56:59], v4 offset:38912
  v_cvt_pk_bf16_f32 v100, v72, v73
  v_exp_f32 v76, v76
  v_exp_f32 v77, v77
  ds_read_b128 v[60:63], v4 offset:39936
  v_cvt_pk_bf16_f32 v101, v74, v75
  v_exp_f32 v78, v78
  s_add_u32 m0, s31, 2048
  s_add_u32 s29, s53, s27
  s_add_u32 s29, s29, 2048
  buffer_load_dwordx4 v2, s[8:11], s29 offen sc1 lds
  v_exp_f32 v79, v79
  v_cvt_pk_bf16_f32 v102, v76, v77
  v_cvt_pk_bf16_f32 v103, v78, v79
  s_waitcnt lgkmcnt(4)
  v_mfma_f32_32x32x16_bf16 v[112:127], v[48:51], v[96:99], v[112:127]
  v_exp_f32 v80, v80
  v_exp_f32 v81, v81
  v_exp_f32 v82, v82
  v_exp_f32 v83, v83
  v_mfma_f32_32x32x16_bf16 v[112:127], v[52:55], v[100:103], v[112:127]
  v_cvt_pk_bf16_f32 v104, v80, v81
  v_exp_f32 v84, v84
  v_exp_f32 v85, v85
  v_cvt_pk_bf16_f32 v105, v82, v83
  v_exp_f32 v86, v86
  s_waitcnt lgkmcnt(2)
  v_mfma_f32_32x32x16_bf16 v[64:79], v[40:43], v[192:195], 0
  v_exp_f32 v87, v87
  v_cvt_pk_bf16_f32 v106, v84, v85
  v_exp_f32 v88, v88
  v_exp_f32 v89, v89
  v_cvt_pk_bf16_f32 v107, v86, v87
  v_mfma_f32_32x32x16_bf16 v[64:79], v[44:47], v[196:199], v[64:79]
  v_exp_f32 v90, v90
  v_exp_f32 v91, v91
  ds_read_b128 v[32:35], v4 offset:8192
  v_cvt_pk_bf16_f32 v108, v88, v89
  v_exp_f32 v92, v92
  v_exp_f32 v93, v93
  ds_read_b128 v[36:39], v4 offset:9216
  v_cvt_pk_bf16_f32 v109, v90, v91
  v_exp_f32 v94, v94
  v_exp_f32 v95, v95
  v_cvt_pk_bf16_f32 v110, v92, v93
  v_cvt_pk_bf16_f32 v111, v94, v95
  v_mfma_f32_32x32x16_bf16 v[128:143], v[48:51], v[104:107], v[128:143]
  v_exp_f32 v64, v64
  v_exp_f32 v65, v65
  v_exp_f32 v66, v66
  v_exp_f32 v67, v67
  v_mfma_f32_32x32x16_bf16 v[128:143], v[52:55], v[108:111], v[128:143]
  v_cvt_pk_bf16_f32 v96, v64, v65
  v_exp_f32 v68, v68
  v_exp_f32 v69, v69
  v_cvt_pk_bf16_f32 v97, v66, v67
  v_exp_f32 v70, v70
  v_mfma_f32_32x32x16_bf16 v[80:95], v[40:43], v[200:203], 0
  v_exp_f32 v71, v71
  v_cvt_pk_bf16_f32 v98, v68, v69
  v_exp_f32 v72, v72
  v_exp_f32 v73, v73
  v_cvt_pk_bf16_f32 v99, v70, v71
  v_mfma_f32_32x32x16_bf16 v[80:95], v[44:47], v[204:207], v[80:95]
  v_exp_f32 v74, v74
  v_exp_f32 v75, v75
  ds_read_b128 v[48:51], v4 offset:40960
  v_cvt_pk_bf16_f32 v100, v72, v73
  v_exp_f32 v76, v76
  v_exp_f32 v77, v77
  ds_read_b128 v[52:55], v4 offset:41984
  v_cvt_pk_bf16_f32 v101, v74, v75
  v_exp_f32 v78, v78
  s_add_u32 m0, s31, 3072
  s_add_u32 s29, s53, s27
  s_add_u32 s29, s29, 3072
  buffer_load_dwordx4 v2, s[8:11], s29 offen sc1 lds
  v_exp_f32 v79, v79
  v_cvt_pk_bf16_f32 v102, v76, v77
  v_cvt_pk_bf16_f32 v103, v78, v79
  s_waitcnt lgkmcnt(4)
  v_mfma_f32_32x32x16_bf16 v[112:127], v[56:59], v[96:99], v[112:127]
  v_exp_f32 v80, v80
  v_exp_f32 v81, v81
  v_exp_f32 v82, v82
  v_exp_f32 v83, v83
  v_mfma_f32_32x32x16_bf16 v[112:127], v[60:63], v[100:103], v[112:127]
  v_cvt_pk_bf16_f32 v104, v80, v81
  v_exp_f32 v84, v84
  v_exp_f32 v85, v85
  v_cvt_pk_bf16_f32 v105, v82, v83
  v_exp_f32 v86, v86
  s_waitcnt lgkmcnt(2)
  v_mfma_f32_32x32x16_bf16 v[64:79], v[32:35], v[192:195], 0
  v_exp_f32 v87, v87
  v_cvt_pk_bf16_f32 v106, v84, v85
  v_exp_f32 v88, v88
  v_exp_f32 v89, v89
  v_cvt_pk_bf16_f32 v107, v86, v87
  v_mfma_f32_32x32x16_bf16 v[64:79], v[36:39], v[196:199], v[64:79]
  v_exp_f32 v90, v90
  v_exp_f32 v91, v91
  ds_read_b128 v[40:43], v4 offset:10240
  v_cvt_pk_bf16_f32 v108, v88, v89
  v_exp_f32 v92, v92
  v_exp_f32 v93, v93
  ds_read_b128 v[44:47], v4 offset:11264
  v_cvt_pk_bf16_f32 v109, v90, v91
  v_exp_f32 v94, v94
  v_exp_f32 v95, v95
  v_cvt_pk_bf16_f32 v110, v92, v93
  v_cvt_pk_bf16_f32 v111, v94, v95
  v_mfma_f32_32x32x16_bf16 v[128:143], v[56:59], v[104:107], v[128:143]
  v_exp_f32 v64, v64
  v_exp_f32 v65, v65
  v_exp_f32 v66, v66
  v_exp_f32 v67, v67
  v_mfma_f32_32x32x16_bf16 v[128:143], v[60:63], v[108:111], v[128:143]
  v_cvt_pk_bf16_f32 v96, v64, v65
  v_exp_f32 v68, v68
  v_exp_f32 v69, v69
  v_cvt_pk_bf16_f32 v97, v66, v67
  v_exp_f32 v70, v70
  v_mfma_f32_32x32x16_bf16 v[80:95], v[32:35], v[200:203], 0
  v_exp_f32 v71, v71
  v_cvt_pk_bf16_f32 v98, v68, v69
  v_exp_f32 v72, v72
  v_exp_f32 v73, v73
  v_cvt_pk_bf16_f32 v99, v70, v71
  v_mfma_f32_32x32x16_bf16 v[80:95], v[36:39], v[204:207], v[80:95]
  v_exp_f32 v74, v74
  v_exp_f32 v75, v75
  ds_read_b128 v[56:59], v4 offset:43008
  v_cvt_pk_bf16_f32 v100, v72, v73
  v_exp_f32 v76, v76
  v_exp_f32 v77, v77
  ds_read_b128 v[60:63], v4 offset:44032
  v_cvt_pk_bf16_f32 v101, v74, v75
  v_exp_f32 v78, v78
  s_add_u32 m0, s31, 4096
  s_add_u32 s29, s53, s27
  s_add_u32 s29, s29, 4096
  buffer_load_dwordx4 v2, s[8:11], s29 offen sc1 lds
  v_exp_f32 v79, v79
  v_cvt_pk_bf16_f32 v102, v76, v77
  v_cvt_pk_bf16_f32 v103, v78, v79
  s_waitcnt lgkmcnt(4)
  v_mfma_f32_32x32x16_bf16 v[112:127], v[48:51], v[96:99], v[112:127]
  v_exp_f32 v80, v80
  v_exp_f32 v81, v81
  v_exp_f32 v82, v82
  v_exp_f32 v83, v83
  v_mfma_f32_32x32x16_bf16 v[112:127], v[52:55], v[100:103], v[112:127]
  v_cvt_pk_bf16_f32 v104, v80, v81
  v_exp_f32 v84, v84
  v_exp_f32 v85, v85
  v_cvt_pk_bf16_f32 v105, v82, v83
  v_exp_f32 v86, v86
  s_waitcnt lgkmcnt(2)
  v_mfma_f32_32x32x16_bf16 v[64:79], v[40:43], v[192:195], 0
  v_exp_f32 v87, v87
  v_cvt_pk_bf16_f32 v106, v84, v85
  v_exp_f32 v88, v88
  v_exp_f32 v89, v89
  v_cvt_pk_bf16_f32 v107, v86, v87
  v_mfma_f32_32x32x16_bf16 v[64:79], v[44:47], v[196:199], v[64:79]
  v_exp_f32 v90, v90
  v_exp_f32 v91, v91
  ds_read_b128 v[32:35], v4 offset:12288
  v_cvt_pk_bf16_f32 v108, v88, v89
  v_exp_f32 v92, v92
  v_exp_f32 v93, v93
  ds_read_b128 v[36:39], v4 offset:13312
  v_cvt_pk_bf16_f32 v109, v90, v91
  v_exp_f32 v94, v94
  v_exp_f32 v95, v95
  v_cvt_pk_bf16_f32 v110, v92, v93
  v_cvt_pk_bf16_f32 v111, v94, v95
  v_mfma_f32_32x32x16_bf16 v[128:143], v[48:51], v[104:107], v[128:143]
  v_exp_f32 v64, v64
  v_exp_f32 v65, v65
  v_exp_f32 v66, v66
  v_exp_f32 v67, v67
  v_mfma_f32_32x32x16_bf16 v[128:143], v[52:55], v[108:111], v[128:143]
  v_cvt_pk_bf16_f32 v96, v64, v65
  v_exp_f32 v68, v68
  v_exp_f32 v69, v69
  v_cvt_pk_bf16_f32 v97, v66, v67
  v_exp_f32 v70, v70
  v_mfma_f32_32x32x16_bf16 v[80:95], v[40:43], v[200:203], 0
  v_exp_f32 v71, v71
  v_cvt_pk_bf16_f32 v98, v68, v69
  v_exp_f32 v72, v72
  v_exp_f32 v73, v73
  v_cvt_pk_bf16_f32 v99, v70, v71
  v_mfma_f32_32x32x16_bf16 v[80:95], v[44:47], v[204:207], v[80:95]
  v_exp_f32 v74, v74
  v_exp_f32 v75, v75
  ds_read_b128 v[48:51], v4 offset:45056
  v_cvt_pk_bf16_f32 v100, v72, v73
  v_exp_f32 v76, v76
  v_exp_f32 v77, v77
  ds_read_b128 v[52:55], v4 offset:46080
  v_cvt_pk_bf16_f32 v101, v74, v75
  v_exp_f32 v78, v78
  s_add_u32 m0, s31, 5120
  s_add_u32 s29, s53, s27
  s_add_u32 s29, s29, 5120
  buffer_load_dwordx4 v2, s[8:11], s29 offen sc1 lds
  v_exp_f32 v79, v79
  v_cvt_pk_bf16_f32 v102, v76, v77
  v_cvt_pk_bf16_f32 v103, v78, v79
  s_waitcnt lgkmcnt(4)
  v_mfma_f32_32x32x16_bf16 v[112:127], v[56:59], v[96:99], v[112:127]
  v_exp_f32 v80, v80
  v_exp_f32 v81, v81
  v_exp_f32 v82, v82
  v_exp_f32 v83, v83
  v_mfma_f32_32x32x16_bf16 v[112:127], v[60:63], v[100:103], v[112:127]
  v_cvt_pk_bf16_f32 v104, v80, v81
  v_exp_f32 v84, v84
  v_exp_f32 v85, v85
  v_cvt_pk_bf16_f32 v105, v82, v83
  v_exp_f32 v86, v86
  s_waitcnt lgkmcnt(2)
  v_mfma_f32_32x32x16_bf16 v[64:79], v[32:35], v[192:195], 0
  v_exp_f32 v87, v87
  v_cvt_pk_bf16_f32 v106, v84, v85
  v_exp_f32 v88, v88
  v_exp_f32 v89, v89
  v_cvt_pk_bf16_f32 v107, v86, v87
  v_mfma_f32_32x32x16_bf16 v[64:79], v[36:39], v[196:199], v[64:79]
  v_exp_f32 v90, v90
  v_exp_f32 v91, v91
  ds_read_b128 v[40:43], v4 offset:14336
  v_cvt_pk_bf16_f32 v108, v88, v89
  v_exp_f32 v92, v92
  v_exp_f32 v93, v93
  ds_read_b128 v[44:47], v4 offset:15360
  v_cvt_pk_bf16_f32 v109, v90, v91
  v_exp_f32 v94, v94
  v_exp_f32 v95, v95
  v_cvt_pk_bf16_f32 v110, v92, v93
  v_cvt_pk_bf16_f32 v111, v94, v95
  v_mfma_f32_32x32x16_bf16 v[128:143], v[56:59], v[104:107], v[128:143]
  v_exp_f32 v64, v64
  v_exp_f32 v65, v65
  v_exp_f32 v66, v66
  v_exp_f32 v67, v67
  v_mfma_f32_32x32x16_bf16 v[128:143], v[60:63], v[108:111], v[128:143]
  v_cvt_pk_bf16_f32 v96, v64, v65
  v_exp_f32 v68, v68
  v_exp_f32 v69, v69
  v_cvt_pk_bf16_f32 v97, v66, v67
  v_exp_f32 v70, v70
  v_mfma_f32_32x32x16_bf16 v[80:95], v[32:35], v[200:203], 0
  v_exp_f32 v71, v71
  v_cvt_pk_bf16_f32 v98, v68, v69
  v_exp_f32 v72, v72
  v_exp_f32 v73, v73
  v_cvt_pk_bf16_f32 v99, v70, v71
  v_mfma_f32_32x32x16_bf16 v[80:95], v[36:39], v[204:207], v[80:95]
  v_exp_f32 v74, v74
  v_exp_f32 v75, v75
  ds_read_b128 v[56:59], v4 offset:47104
  v_cvt_pk_bf16_f32 v100, v72, v73
  v_exp_f32 v76, v76
  v_exp_f32 v77, v77
  ds_read_b128 v[60:63], v4 offset:48128
  v_cvt_pk_bf16_f32 v101, v74, v75
  v_exp_f32 v78, v78
  s_add_u32 m0, s31, 6144
  s_add_u32 s29, s53, s27
  s_add_u32 s29, s29, 6144
  buffer_load_dwordx4 v2, s[8:11], s29 offen sc1 lds
  v_exp_f32 v79, v79
  v_cvt_pk_bf16_f32 v102, v76, v77
  v_cvt_pk_bf16_f32 v103, v78, v79
  s_waitcnt lgkmcnt(4)
  v_mfma_f32_32x32x16_bf16 v[112:127], v[48:51], v[96:99], v[112:127]
  v_exp_f32 v80, v80
  v_exp_f32 v81, v81
  v_exp_f32 v82, v82
  v_exp_f32 v83, v83
  v_mfma_f32_32x32x16_bf16 v[112:127], v[52:55], v[100:103], v[112:127]
  v_cvt_pk_bf16_f32 v104, v80, v81
  v_exp_f32 v84, v84
  v_exp_f32 v85, v85
  v_cvt_pk_bf16_f32 v105, v82, v83
  v_exp_f32 v86, v86
  s_waitcnt lgkmcnt(2)
  v_mfma_f32_32x32x16_bf16 v[64:79], v[40:43], v[192:195], 0
  v_exp_f32 v87, v87
  v_cvt_pk_bf16_f32 v106, v84, v85
  v_exp_f32 v88, v88
  v_exp_f32 v89, v89
  v_cvt_pk_bf16_f32 v107, v86, v87
  v_mfma_f32_32x32x16_bf16 v[64:79], v[44:47], v[196:199], v[64:79]
  v_exp_f32 v90, v90
  v_exp_f32 v91, v91
  ds_read_b128 v[32:35], v4 offset:16384
  v_cvt_pk_bf16_f32 v108, v88, v89
  v_exp_f32 v92, v92
  v_exp_f32 v93, v93
  ds_read_b128 v[36:39], v4 offset:17408
  v_cvt_pk_bf16_f32 v109, v90, v91
  v_exp_f32 v94, v94
  v_exp_f32 v95, v95
  v_cvt_pk_bf16_f32 v110, v92, v93
  v_cvt_pk_bf16_f32 v111, v94, v95
  v_mfma_f32_32x32x16_bf16 v[128:143], v[48:51], v[104:107], v[128:143]
  v_exp_f32 v64, v64
  v_exp_f32 v65, v65
  v_exp_f32 v66, v66
  v_exp_f32 v67, v67
  v_mfma_f32_32x32x16_bf16 v[128:143], v[52:55], v[108:111], v[128:143]
  v_cvt_pk_bf16_f32 v96, v64, v65
  v_exp_f32 v68, v68
  v_exp_f32 v69, v69
  v_cvt_pk_bf16_f32 v97, v66, v67
  v_exp_f32 v70, v70
  v_mfma_f32_32x32x16_bf16 v[80:95], v[40:43], v[200:203], 0
  v_exp_f32 v71, v71
  v_cvt_pk_bf16_f32 v98, v68, v69
  v_exp_f32 v72, v72
  v_exp_f32 v73, v73
  v_cvt_pk_bf16_f32 v99, v70, v71
  v_mfma_f32_32x32x16_bf16 v[80:95], v[44:47], v[204:207], v[80:95]
  v_exp_f32 v74, v74
  v_exp_f32 v75, v75
  ds_read_b128 v[48:51], v4 offset:49152
  v_cvt_pk_bf16_f32 v100, v72, v73
  v_exp_f32 v76, v76
  v_exp_f32 v77, v77
  ds_read_b128 v[52:55], v4 offset:50176
  v_cvt_pk_bf16_f32 v101, v74, v75
  v_exp_f32 v78, v78
  s_add_u32 m0, s31, 7168
  s_add_u32 s29, s53, s27
  s_add_u32 s29, s29, 7168
  buffer_load_dwordx4 v2, s[8:11], s29 offen sc1 lds
  v_exp_f32 v79, v79
  v_cvt_pk_bf16_f32 v102, v76, v77
  v_cvt_pk_bf16_f32 v103, v78, v79
  s_waitcnt lgkmcnt(4)
  v_mfma_f32_32x32x16_bf16 v[112:127], v[56:59], v[96:99], v[112:127]
  v_exp_f32 v80, v80
  v_exp_f32 v81, v81
  v_exp_f32 v82, v82
  v_exp_f32 v83, v83
  v_mfma_f32_32x32x16_bf16 v[112:127], v[60:63], v[100:103], v[112:127]
  v_cvt_pk_bf16_f32 v104, v80, v81
  v_exp_f32 v84, v84
  v_exp_f32 v85, v85
  v_cvt_pk_bf16_f32 v105, v82, v83
  v_exp_f32 v86, v86
  s_waitcnt lgkmcnt(2)
  v_mfma_f32_32x32x16_bf16 v[64:79], v[32:35], v[192:195], 0
  v_exp_f32 v87, v87
  v_cvt_pk_bf16_f32 v106, v84, v85
  v_exp_f32 v88, v88
  v_exp_f32 v89, v89
  v_cvt_pk_bf16_f32 v107, v86, v87
  v_mfma_f32_32x32x16_bf16 v[64:79], v[36:39], v[196:199], v[64:79]
  v_exp_f32 v90, v90
  v_exp_f32 v91, v91
  ds_read_b128 v[40:43], v4 offset:18432
  v_cvt_pk_bf16_f32 v108, v88, v89
  v_exp_f32 v92, v92
  v_exp_f32 v93, v93
  ds_read_b128 v[44:47], v4 offset:19456
  v_cvt_pk_bf16_f32 v109, v90, v91
  v_exp_f32 v94, v94
  v_exp_f32 v95, v95
  v_cvt_pk_bf16_f32 v110, v92, v93
  v_cvt_pk_bf16_f32 v111, v94, v95
  v_mfma_f32_32x32x16_bf16 v[128:143], v[56:59], v[104:107], v[128:143]
  v_exp_f32 v64, v64
  v_exp_f32 v65, v65
  v_exp_f32 v66, v66
  v_exp_f32 v67, v67
  v_mfma_f32_32x32x16_bf16 v[128:143], v[60:63], v[108:111], v[128:143]
  v_cvt_pk_bf16_f32 v96, v64, v65
  v_exp_f32 v68, v68
  v_exp_f32 v69, v69
  v_cvt_pk_bf16_f32 v97, v66, v67
  v_exp_f32 v70, v70
  v_mfma_f32_32x32x16_bf16 v[80:95], v[32:35], v[200:203], 0
  v_exp_f32 v71, v71
  v_cvt_pk_bf16_f32 v98, v68, v69
  v_exp_f32 v72, v72
  v_exp_f32 v73, v73
  v_cvt_pk_bf16_f32 v99, v70, v71
  v_mfma_f32_32x32x16_bf16 v[80:95], v[36:39], v[204:207], v[80:95]
  v_exp_f32 v74, v74
  v_exp_f32 v75, v75
  ds_read_b128 v[56:59], v4 offset:51200
  v_cvt_pk_bf16_f32 v100, v72, v73
  v_exp_f32 v76, v76
  v_exp_f32 v77, v77
  ds_read_b128 v[60:63], v4 offset:52224
  v_cvt_pk_bf16_f32 v101, v74, v75
  v_exp_f32 v78, v78
  s_add_u32 m0, s31, 32768
  s_add_u32 s29, s53, s28
  s_add_u32 s29, s29, 0
  buffer_load_dwordx4 v2, s[8:11], s29 offen sc1 lds
  v_exp_f32 v79, v79
  v_cvt_pk_bf16_f32 v102, v76, v77
  v_cvt_pk_bf16_f32 v103, v78, v79
  s_waitcnt lgkmcnt(4)
  v_mfma_f32_32x32x16_bf16 v[112:127], v[48:51], v[96:99], v[112:127]
  v_exp_f32 v80, v80
  v_exp_f32 v81, v81
  v_exp_f32 v82, v82
  v_exp_f32 v83, v83
  v_mfma_f32_32x32x16_bf16 v[112:127], v[52:55], v[100:103], v[112:127]
  v_cvt_pk_bf16_f32 v104, v80, v81
  v_exp_f32 v84, v84
  v_exp_f32 v85, v85
  v_cvt_pk_bf16_f32 v105, v82, v83
  v_exp_f32 v86, v86
  s_waitcnt lgkmcnt(2)
  v_mfma_f32_32x32x16_bf16 v[64:79], v[40:43], v[192:195], 0
  v_exp_f32 v87, v87
  v_cvt_pk_bf16_f32 v106, v84, v85
  v_exp_f32 v88, v88
  v_exp_f32 v89, v89
  v_cvt_pk_bf16_f32 v107, v86, v87
  v_mfma_f32_32x32x16_bf16 v[64:79], v[44:47], v[196:199], v[64:79]
  v_exp_f32 v90, v90
  v_exp_f32 v91, v91
  ds_read_b128 v[32:35], v4 offset:20480
  v_cvt_pk_bf16_f32 v108, v88, v89
  v_exp_f32 v92, v92
  v_exp_f32 v93, v93
  ds_read_b128 v[36:39], v4 offset:21504
  v_cvt_pk_bf16_f32 v109, v90, v91
  v_exp_f32 v94, v94
  v_exp_f32 v95, v95
  v_cvt_pk_bf16_f32 v110, v92, v93
  v_cvt_pk_bf16_f32 v111, v94, v95
  v_mfma_f32_32x32x16_bf16 v[128:143], v[48:51], v[104:107], v[128:143]
  v_exp_f32 v64, v64
  v_exp_f32 v65, v65
  v_exp_f32 v66, v66
  v_exp_f32 v67, v67
  v_mfma_f32_32x32x16_bf16 v[128:143], v[52:55], v[108:111], v[128:143]
  v_cvt_pk_bf16_f32 v96, v64, v65
  v_exp_f32 v68, v68
  v_exp_f32 v69, v69
  v_cvt_pk_bf16_f32 v97, v66, v67
  v_exp_f32 v70, v70
  v_mfma_f32_32x32x16_bf16 v[80:95], v[40:43], v[200:203], 0
  v_exp_f32 v71, v71
  v_cvt_pk_bf16_f32 v98, v68, v69
  v_exp_f32 v72, v72
  v_exp_f32 v73, v73
  v_cvt_pk_bf16_f32 v99, v70, v71
  v_mfma_f32_32x32x16_bf16 v[80:95], v[44:47], v[204:207], v[80:95]
  v_exp_f32 v74, v74
  v_exp_f32 v75, v75
  ds_read_b128 v[48:51], v4 offset:53248
  v_cvt_pk_bf16_f32 v100, v72, v73
  v_exp_f32 v76, v76
  v_exp_f32 v77, v77
  ds_read_b128 v[52:55], v4 offset:54272
  v_cvt_pk_bf16_f32 v101, v74, v75
  v_exp_f32 v78, v78
  s_add_u32 m0, s31, 33792
  s_add_u32 s29, s53, s28
  s_add_u32 s29, s29, 1024
  buffer_load_dwordx4 v2, s[8:11], s29 offen sc1 lds
  v_exp_f32 v79, v79
  v_cvt_pk_bf16_f32 v102, v76, v77
  v_cvt_pk_bf16_f32 v103, v78, v79
  s_waitcnt lgkmcnt(4)
  v_mfma_f32_32x32x16_bf16 v[112:127], v[56:59], v[96:99], v[112:127]
  v_exp_f32 v80, v80
  v_exp_f32 v81, v81
  v_exp_f32 v82, v82
  v_exp_f32 v83, v83
  v_mfma_f32_32x32x16_bf16 v[112:127], v[60:63], v[100:103], v[112:127]
  v_cvt_pk_bf16_f32 v104, v80, v81
  v_exp_f32 v84, v84
  v_exp_f32 v85, v85
  v_cvt_pk_bf16_f32 v105, v82, v83
  v_exp_f32 v86, v86
  s_waitcnt lgkmcnt(2)
  v_mfma_f32_32x32x16_bf16 v[64:79], v[32:35], v[192:195], 0
  v_exp_f32 v87, v87
  v_cvt_pk_bf16_f32 v106, v84, v85
  v_exp_f32 v88, v88
  v_exp_f32 v89, v89
  v_cvt_pk_bf16_f32 v107, v86, v87
  v_mfma_f32_32x32x16_bf16 v[64:79], v[36:39], v[196:199], v[64:79]
  v_exp_f32 v90, v90
  v_exp_f32 v91, v91
  ds_read_b128 v[40:43], v4 offset:22528
  v_cvt_pk_bf16_f32 v108, v88, v89
  v_exp_f32 v92, v92
  v_exp_f32 v93, v93
  ds_read_b128 v[44:47], v4 offset:23552
  v_cvt_pk_bf16_f32 v109, v90, v91
  v_exp_f32 v94, v94
  v_exp_f32 v95, v95
  v_cvt_pk_bf16_f32 v110, v92, v93
  v_cvt_pk_bf16_f32 v111, v94, v95
  v_mfma_f32_32x32x16_bf16 v[128:143], v[56:59], v[104:107], v[128:143]
  v_exp_f32 v64, v64
  v_exp_f32 v65, v65
  v_exp_f32 v66, v66
  v_exp_f32 v67, v67
  v_mfma_f32_32x32x16_bf16 v[128:143], v[60:63], v[108:111], v[128:143]
  v_cvt_pk_bf16_f32 v96, v64, v65
  v_exp_f32 v68, v68
  v_exp_f32 v69, v69
  v_cvt_pk_bf16_f32 v97, v66, v67
  v_exp_f32 v70, v70
  v_mfma_f32_32x32x16_bf16 v[80:95], v[32:35], v[200:203], 0
  v_exp_f32 v71, v71
  v_cvt_pk_bf16_f32 v98, v68, v69
  v_exp_f32 v72, v72
  v_exp_f32 v73, v73
  v_cvt_pk_bf16_f32 v99, v70, v71
  v_mfma_f32_32x32x16_bf16 v[80:95], v[36:39], v[204:207], v[80:95]
  v_exp_f32 v74, v74
  v_exp_f32 v75, v75
  ds_read_b128 v[56:59], v4 offset:55296
  v_cvt_pk_bf16_f32 v100, v72, v73
  v_exp_f32 v76, v76
  v_exp_f32 v77, v77
  ds_read_b128 v[60:63], v4 offset:56320
  v_cvt_pk_bf16_f32 v101, v74, v75
  v_exp_f32 v78, v78
  s_add_u32 m0, s31, 34816
  s_add_u32 s29, s53, s28
  s_add_u32 s29, s29, 2048
  buffer_load_dwordx4 v2, s[8:11], s29 offen sc1 lds
  v_exp_f32 v79, v79
  v_cvt_pk_bf16_f32 v102, v76, v77
  v_cvt_pk_bf16_f32 v103, v78, v79
  s_waitcnt lgkmcnt(4)
  v_mfma_f32_32x32x16_bf16 v[112:127], v[48:51], v[96:99], v[112:127]
  v_exp_f32 v80, v80
  v_exp_f32 v81, v81
  v_exp_f32 v82, v82
  v_exp_f32 v83, v83
  v_mfma_f32_32x32x16_bf16 v[112:127], v[52:55], v[100:103], v[112:127]
  v_cvt_pk_bf16_f32 v104, v80, v81
  v_exp_f32 v84, v84
  v_exp_f32 v85, v85
  v_cvt_pk_bf16_f32 v105, v82, v83
  v_exp_f32 v86, v86
  s_waitcnt lgkmcnt(2)
  v_mfma_f32_32x32x16_bf16 v[64:79], v[40:43], v[192:195], 0
  v_exp_f32 v87, v87
  v_cvt_pk_bf16_f32 v106, v84, v85
  v_exp_f32 v88, v88
  v_exp_f32 v89, v89
  v_cvt_pk_bf16_f32 v107, v86, v87
  v_mfma_f32_32x32x16_bf16 v[64:79], v[44:47], v[196:199], v[64:79]
  v_exp_f32 v90, v90
  v_exp_f32 v91, v91
  ds_read_b128 v[32:35], v4 offset:24576
  v_cvt_pk_bf16_f32 v108, v88, v89
  v_exp_f32 v92, v92
  v_exp_f32 v93, v93
  ds_read_b128 v[36:39], v4 offset:25600
  v_cvt_pk_bf16_f32 v109, v90, v91
  v_exp_f32 v94, v94
  v_exp_f32 v95, v95
  v_cvt_pk_bf16_f32 v110, v92, v93
  v_cvt_pk_bf16_f32 v111, v94, v95
  v_mfma_f32_32x32x16_bf16 v[128:143], v[48:51], v[104:107], v[128:143]
  v_exp_f32 v64, v64
  v_exp_f32 v65, v65
  v_exp_f32 v66, v66
  v_exp_f32 v67, v67
  v_mfma_f32_32x32x16_bf16 v[128:143], v[52:55], v[108:111], v[128:143]
  v_cvt_pk_bf16_f32 v96, v64, v65
  v_exp_f32 v68, v68
  v_exp_f32 v69, v69
  v_cvt_pk_bf16_f32 v97, v66, v67
  v_exp_f32 v70, v70
  v_mfma_f32_32x32x16_bf16 v[80:95], v[40:43], v[200:203], 0
  v_exp_f32 v71, v71
  v_cvt_pk_bf16_f32 v98, v68, v69
  v_exp_f32 v72, v72
  v_exp_f32 v73, v73
  v_cvt_pk_bf16_f32 v99, v70, v71
  v_mfma_f32_32x32x16_bf16 v[80:95], v[44:47], v[204:207], v[80:95]
  v_exp_f32 v74, v74
  v_exp_f32 v75, v75
  ds_read_b128 v[48:51], v4 offset:57344
  v_cvt_pk_bf16_f32 v100, v72, v73
  v_exp_f32 v76, v76
  v_exp_f32 v77, v77
  ds_read_b128 v[52:55], v4 offset:58368
  v_cvt_pk_bf16_f32 v101, v74, v75
  v_exp_f32 v78, v78
  s_add_u32 m0, s31, 35840
  s_add_u32 s29, s53, s28
  s_add_u32 s29, s29, 3072
  buffer_load_dwordx4 v2, s[8:11], s29 offen sc1 lds
  v_exp_f32 v79, v79
  v_cvt_pk_bf16_f32 v102, v76, v77
  v_cvt_pk_bf16_f32 v103, v78, v79
  s_waitcnt lgkmcnt(4)
  v_mfma_f32_32x32x16_bf16 v[112:127], v[56:59], v[96:99], v[112:127]
  v_exp_f32 v80, v80
  v_exp_f32 v81, v81
  v_exp_f32 v82, v82
  v_exp_f32 v83, v83
  v_mfma_f32_32x32x16_bf16 v[112:127], v[60:63], v[100:103], v[112:127]
  v_cvt_pk_bf16_f32 v104, v80, v81
  v_exp_f32 v84, v84
  v_exp_f32 v85, v85
  v_cvt_pk_bf16_f32 v105, v82, v83
  v_exp_f32 v86, v86
  s_waitcnt lgkmcnt(2)
  v_mfma_f32_32x32x16_bf16 v[64:79], v[32:35], v[192:195], 0
  v_exp_f32 v87, v87
  v_cvt_pk_bf16_f32 v106, v84, v85
  v_exp_f32 v88, v88
  v_exp_f32 v89, v89
  v_cvt_pk_bf16_f32 v107, v86, v87
  v_mfma_f32_32x32x16_bf16 v[64:79], v[36:39], v[196:199], v[64:79]
  v_exp_f32 v90, v90
  v_exp_f32 v91, v91
  ds_read_b128 v[40:43], v4 offset:26624
  v_cvt_pk_bf16_f32 v108, v88, v89
  v_exp_f32 v92, v92
  v_exp_f32 v93, v93
  ds_read_b128 v[44:47], v4 offset:27648
  v_cvt_pk_bf16_f32 v109, v90, v91
  v_exp_f32 v94, v94
  v_exp_f32 v95, v95
  v_cvt_pk_bf16_f32 v110, v92, v93
  v_cvt_pk_bf16_f32 v111, v94, v95
  v_mfma_f32_32x32x16_bf16 v[128:143], v[56:59], v[104:107], v[128:143]
  v_exp_f32 v64, v64
  v_exp_f32 v65, v65
  v_exp_f32 v66, v66
  v_exp_f32 v67, v67
  v_mfma_f32_32x32x16_bf16 v[128:143], v[60:63], v[108:111], v[128:143]
  v_cvt_pk_bf16_f32 v96, v64, v65
  v_exp_f32 v68, v68
  v_exp_f32 v69, v69
  v_cvt_pk_bf16_f32 v97, v66, v67
  v_exp_f32 v70, v70
  v_mfma_f32_32x32x16_bf16 v[80:95], v[32:35], v[200:203], 0
  v_exp_f32 v71, v71
  v_cvt_pk_bf16_f32 v98, v68, v69
  v_exp_f32 v72, v72
  v_exp_f32 v73, v73
  v_cvt_pk_bf16_f32 v99, v70, v71
  v_mfma_f32_32x32x16_bf16 v[80:95], v[36:39], v[204:207], v[80:95]
  v_exp_f32 v74, v74
  v_exp_f32 v75, v75
  ds_read_b128 v[56:59], v4 offset:59392
  v_cvt_pk_bf16_f32 v100, v72, v73
  v_exp_f32 v76, v76
  v_exp_f32 v77, v77
  ds_read_b128 v[60:63], v4 offset:60416
  v_cvt_pk_bf16_f32 v101, v74, v75
  v_exp_f32 v78, v78
  s_add_u32 m0, s31, 36864
  s_add_u32 s29, s53, s28
  s_add_u32 s29, s29, 4096
  buffer_load_dwordx4 v2, s[8:11], s29 offen sc1 lds
  v_exp_f32 v79, v79
  v_cvt_pk_bf16_f32 v102, v76, v77
  v_cvt_pk_bf16_f32 v103, v78, v79
  s_waitcnt lgkmcnt(4)
  v_mfma_f32_32x32x16_bf16 v[112:127], v[48:51], v[96:99], v[112:127]
  v_exp_f32 v80, v80
  v_exp_f32 v81, v81
  v_exp_f32 v82, v82
  v_exp_f32 v83, v83
  v_mfma_f32_32x32x16_bf16 v[112:127], v[52:55], v[100:103], v[112:127]
  v_cvt_pk_bf16_f32 v104, v80, v81
  v_exp_f32 v84, v84
  v_exp_f32 v85, v85
  v_cvt_pk_bf16_f32 v105, v82, v83
  v_exp_f32 v86, v86
  s_waitcnt lgkmcnt(2)
  v_mfma_f32_32x32x16_bf16 v[64:79], v[40:43], v[192:195], 0
  v_exp_f32 v87, v87
  v_cvt_pk_bf16_f32 v106, v84, v85
  v_exp_f32 v88, v88
  v_exp_f32 v89, v89
  v_cvt_pk_bf16_f32 v107, v86, v87
  v_mfma_f32_32x32x16_bf16 v[64:79], v[44:47], v[196:199], v[64:79]
  v_exp_f32 v90, v90
  v_exp_f32 v91, v91
  ds_read_b128 v[32:35], v4 offset:28672
  v_cvt_pk_bf16_f32 v108, v88, v89
  v_exp_f32 v92, v92
  v_exp_f32 v93, v93
  ds_read_b128 v[36:39], v4 offset:29696
  v_cvt_pk_bf16_f32 v109, v90, v91
  v_exp_f32 v94, v94
  v_exp_f32 v95, v95
  v_cvt_pk_bf16_f32 v110, v92, v93
  v_cvt_pk_bf16_f32 v111, v94, v95
  v_mfma_f32_32x32x16_bf16 v[128:143], v[48:51], v[104:107], v[128:143]
  v_exp_f32 v64, v64
  v_exp_f32 v65, v65
  v_exp_f32 v66, v66
  v_exp_f32 v67, v67
  v_mfma_f32_32x32x16_bf16 v[128:143], v[52:55], v[108:111], v[128:143]
  v_cvt_pk_bf16_f32 v96, v64, v65
  v_exp_f32 v68, v68
  v_exp_f32 v69, v69
  v_cvt_pk_bf16_f32 v97, v66, v67
  v_exp_f32 v70, v70
  v_mfma_f32_32x32x16_bf16 v[80:95], v[40:43], v[200:203], 0
  v_exp_f32 v71, v71
  v_cvt_pk_bf16_f32 v98, v68, v69
  v_exp_f32 v72, v72
  v_exp_f32 v73, v73
  v_cvt_pk_bf16_f32 v99, v70, v71
  v_mfma_f32_32x32x16_bf16 v[80:95], v[44:47], v[204:207], v[80:95]
  v_exp_f32 v74, v74
  v_exp_f32 v75, v75
  ds_read_b128 v[48:51], v4 offset:61440
  v_cvt_pk_bf16_f32 v100, v72, v73
  v_exp_f32 v76, v76
  v_exp_f32 v77, v77
  ds_read_b128 v[52:55], v4 offset:62464
  v_cvt_pk_bf16_f32 v101, v74, v75
  v_exp_f32 v78, v78
  s_add_u32 m0, s31, 37888
  s_add_u32 s29, s53, s28
  s_add_u32 s29, s29, 5120
  buffer_load_dwordx4 v2, s[8:11], s29 offen sc1 lds
  v_exp_f32 v79, v79
  v_cvt_pk_bf16_f32 v102, v76, v77
  v_cvt_pk_bf16_f32 v103, v78, v79
  s_waitcnt lgkmcnt(4)
  v_mfma_f32_32x32x16_bf16 v[112:127], v[56:59], v[96:99], v[112:127]
  v_exp_f32 v80, v80
  v_exp_f32 v81, v81
  v_exp_f32 v82, v82
  v_exp_f32 v83, v83
  v_mfma_f32_32x32x16_bf16 v[112:127], v[60:63], v[100:103], v[112:127]
  v_cvt_pk_bf16_f32 v104, v80, v81
  v_exp_f32 v84, v84
  v_exp_f32 v85, v85
  v_cvt_pk_bf16_f32 v105, v82, v83
  v_exp_f32 v86, v86
  s_waitcnt lgkmcnt(2)
  v_mfma_f32_32x32x16_bf16 v[64:79], v[32:35], v[192:195], 0
  v_exp_f32 v87, v87
  v_cvt_pk_bf16_f32 v106, v84, v85
  v_exp_f32 v88, v88
  v_exp_f32 v89, v89
  v_cvt_pk_bf16_f32 v107, v86, v87
  v_mfma_f32_32x32x16_bf16 v[64:79], v[36:39], v[196:199], v[64:79]
  v_exp_f32 v90, v90
  v_exp_f32 v91, v91
  ds_read_b128 v[40:43], v4 offset:30720
  v_cvt_pk_bf16_f32 v108, v88, v89
  v_exp_f32 v92, v92
  v_exp_f32 v93, v93
  ds_read_b128 v[44:47], v4 offset:31744
  v_cvt_pk_bf16_f32 v109, v90, v91
  v_exp_f32 v94, v94
  v_exp_f32 v95, v95
  v_cvt_pk_bf16_f32 v110, v92, v93
  v_cvt_pk_bf16_f32 v111, v94, v95
  v_mfma_f32_32x32x16_bf16 v[128:143], v[56:59], v[104:107], v[128:143]
  v_exp_f32 v64, v64
  v_exp_f32 v65, v65
  v_exp_f32 v66, v66
  v_exp_f32 v67, v67
  v_mfma_f32_32x32x16_bf16 v[128:143], v[60:63], v[108:111], v[128:143]
  v_cvt_pk_bf16_f32 v96, v64, v65
  v_exp_f32 v68, v68
  v_exp_f32 v69, v69
  v_cvt_pk_bf16_f32 v97, v66, v67
  v_exp_f32 v70, v70
  v_mfma_f32_32x32x16_bf16 v[80:95], v[32:35], v[200:203], 0
  v_exp_f32 v71, v71
  v_cvt_pk_bf16_f32 v98, v68, v69
  v_exp_f32 v72, v72
  v_exp_f32 v73, v73
  v_cvt_pk_bf16_f32 v99, v70, v71
  v_mfma_f32_32x32x16_bf16 v[80:95], v[36:39], v[204:207], v[80:95]
  v_exp_f32 v74, v74
  v_exp_f32 v75, v75
  ds_read_b128 v[56:59], v4 offset:63488
  v_cvt_pk_bf16_f32 v100, v72, v73
  v_exp_f32 v76, v76
  v_exp_f32 v77, v77
  ds_read_b128 v[60:63], v4 offset:64512
  v_cvt_pk_bf16_f32 v101, v74, v75
  v_exp_f32 v78, v78
  s_add_u32 m0, s31, 38912
  s_add_u32 s29, s53, s28
  s_add_u32 s29, s29, 6144
  buffer_load_dwordx4 v2, s[8:11], s29 offen sc1 lds
  v_exp_f32 v79, v79
  v_cvt_pk_bf16_f32 v102, v76, v77
  v_cvt_pk_bf16_f32 v103, v78, v79
  s_waitcnt lgkmcnt(4)
  v_mfma_f32_32x32x16_bf16 v[112:127], v[48:51], v[96:99], v[112:127]
  v_exp_f32 v80, v80
  v_exp_f32 v81, v81
  v_exp_f32 v82, v82
  v_exp_f32 v83, v83
  v_mfma_f32_32x32x16_bf16 v[112:127], v[52:55], v[100:103], v[112:127]
  v_cvt_pk_bf16_f32 v104, v80, v81
  v_exp_f32 v84, v84
  v_exp_f32 v85, v85
  v_cvt_pk_bf16_f32 v105, v82, v83
  v_exp_f32 v86, v86
  s_waitcnt lgkmcnt(2)
  v_mfma_f32_32x32x16_bf16 v[64:79], v[40:43], v[192:195], 0
  v_exp_f32 v87, v87
  v_cvt_pk_bf16_f32 v106, v84, v85
  v_exp_f32 v88, v88
  v_exp_f32 v89, v89
  v_cvt_pk_bf16_f32 v107, v86, v87
  v_mfma_f32_32x32x16_bf16 v[64:79], v[44:47], v[196:199], v[64:79]
  v_exp_f32 v90, v90
  v_exp_f32 v91, v91
  v_cvt_pk_bf16_f32 v108, v88, v89
  v_exp_f32 v92, v92
  v_exp_f32 v93, v93
  v_cvt_pk_bf16_f32 v109, v90, v91
  v_exp_f32 v94, v94
  v_exp_f32 v95, v95
  v_cvt_pk_bf16_f32 v110, v92, v93
  v_cvt_pk_bf16_f32 v111, v94, v95
  v_mfma_f32_32x32x16_bf16 v[128:143], v[48:51], v[104:107], v[128:143]
  v_exp_f32 v64, v64
  v_exp_f32 v65, v65
  v_exp_f32 v66, v66
  v_exp_f32 v67, v67
  v_mfma_f32_32x32x16_bf16 v[128:143], v[52:55], v[108:111], v[128:143]
  v_cvt_pk_bf16_f32 v96, v64, v65
  v_exp_f32 v68, v68
  v_exp_f32 v69, v69
  v_cvt_pk_bf16_f32 v97, v66, v67
  v_exp_f32 v70, v70
  v_mfma_f32_32x32x16_bf16 v[80:95], v[40:43], v[200:203], 0
  v_exp_f32 v71, v71
  v_cvt_pk_bf16_f32 v98, v68, v69
  v_exp_f32 v72, v72
  v_exp_f32 v73, v73
  v_cvt_pk_bf16_f32 v99, v70, v71
  v_mfma_f32_32x32x16_bf16 v[80:95], v[44:47], v[204:207], v[80:95]
  v_exp_f32 v74, v74
  v_exp_f32 v75, v75
  v_cvt_pk_bf16_f32 v100, v72, v73
  v_exp_f32 v76, v76
  v_exp_f32 v77, v77
  v_cvt_pk_bf16_f32 v101, v74, v75
  v_exp_f32 v78, v78
  s_add_u32 m0, s31, 39936
  s_add_u32 s29, s53, s28
  s_add_u32 s29, s29, 7168
  buffer_load_dwordx4 v2, s[8:11], s29 offen sc1 lds
  v_exp_f32 v79, v79
  v_cvt_pk_bf16_f32 v102, v76, v77
  v_cvt_pk_bf16_f32 v103, v78, v79
  s_waitcnt lgkmcnt(0)
  v_mfma_f32_32x32x16_bf16 v[112:127], v[56:59], v[96:99], v[112:127]
  v_exp_f32 v80, v80
  v_exp_f32 v81, v81
  v_exp_f32 v82, v82
  v_exp_f32 v83, v83
  v_mfma_f32_32x32x16_bf16 v[112:127], v[60:63], v[100:103], v[112:127]
  v_cvt_pk_bf16_f32 v104, v80, v81
  v_exp_f32 v84, v84
  v_exp_f32 v85, v85
  v_cvt_pk_bf16_f32 v105, v82, v83
  v_exp_f32 v86, v86
  v_exp_f32 v87, v87
  v_cvt_pk_bf16_f32 v106, v84, v85
  v_exp_f32 v88, v88
  v_exp_f32 v89, v89
  v_cvt_pk_bf16_f32 v107, v86, v87
  v_exp_f32 v90, v90
  v_exp_f32 v91, v91
  v_cvt_pk_bf16_f32 v108, v88, v89
  v_exp_f32 v92, v92
  v_exp_f32 v93, v93
  v_cvt_pk_bf16_f32 v109, v90, v91
  v_exp_f32 v94, v94
  v_exp_f32 v95, v95
  v_cvt_pk_bf16_f32 v110, v92, v93
  v_cvt_pk_bf16_f32 v111, v94, v95
  s_nop 1
  v_mfma_f32_32x32x16_bf16 v[128:143], v[56:59], v[104:107], v[128:143]
  v_mfma_f32_32x32x16_bf16 v[128:143], v[60:63], v[108:111], v[128:143]
  s_cmp_lt_u32 s41, 4
  s_cbranch_scc1 kb1_chunk2
  s_nop 11
  v_mov_b32 v5, v120
  v_mov_b32 v6, v120
  s_nop 1
  v_permlane32_swap_b32 v5, v6
  v_mov_b32 v14, v6
  v_mov_b32 v5, v136
  v_mov_b32 v6, v136
  s_nop 1
  v_permlane32_swap_b32 v5, v6
  v_mov_b32 v15, v6
  s_cmp_eq_u32 s40, 0
  s_cbranch_scc0 kb1_fin
  v_min_f32 v5, v14, v15
  v_cmp_gt_f32 vcc, 0x12800000, v5
  v_cmp_u_f32 s[36:37], v5, v5
  s_nop 1
  s_or_b64 vcc, vcc, s[36:37]
  s_cmp_lg_u64 vcc, 0
  s_cselect_b32 s42, 1, 0
  v_mov_b32 v5, s42
  s_lshl_b32 s30, s21, 2
  s_add_u32 s30, s30, 131584
  v_mov_b32 v6, s30
  ds_write_b32 v6, v5
  s_waitcnt vmcnt(0) lgkmcnt(0)
  s_barrier
  v_mov_b32 v6, 131584
  ds_read_b128 v[8:11], v6
  s_waitcnt lgkmcnt(0)
  v_or_b32 v8, v8, v9
  v_or_b32 v10, v10, v11
  v_or_b32 v8, v8, v10
  s_nop 0
  v_readfirstlane_b32 s42, v8
  s_cmp_eq_u32 s42, 0
  s_cbranch_scc1 kb1_fin
  s_mov_b32 s40, 1
  v_and_b32 v5, 0xffff0000, v198
  v_cndmask_b32 v198, v198, v5, s[34:35]
  v_mov_b32 v12, 0xff7fffff
  v_and_b32 v5, 0xffff0000, v206
  v_cndmask_b32 v206, v206, v5, s[34:35]
  v_mov_b32 v13, 0xff7fffff
  s_mov_b32 s41, 0
kb1_mx:
  s_lshl_b32 s30, s41, 11
  s_add_u32 s30, s30, s27
  buffer_load_dwordx4 v[32:35], v2, s[8:11], s30 offen sc1
  buffer_load_dwordx4 v[36:39], v2, s[8:11], s30 offen offset:1024 sc1
  s_waitcnt vmcnt(0)
  v_mfma_f32_32x32x16_bf16 v[64:79], v[32:35], v[192:195], 0
  v_mfma_f32_32x32x16_bf16 v[64:79], v[36:39], v[196:199], v[64:79]
  v_mfma_f32_32x32x16_bf16 v[80:95], v[32:35], v[200:203], 0
  v_mfma_f32_32x32x16_bf16 v[80:95], v[36:39], v[204:207], v[80:95]
  s_nop 11
  v_max3_f32 v12, v12, v64, v65
  v_max3_f32 v12, v12, v66, v67
  v_max3_f32 v12, v12, v68, v69
  v_max3_f32 v12, v12, v70, v71
  v_max3_f32 v12, v12, v72, v73
  v_max3_f32 v12, v12, v74, v75
  v_max3_f32 v12, v12, v76, v77
  v_max3_f32 v12, v12, v78, v79
  v_max3_f32 v13, v13, v80, v81
  v_max3_f32 v13, v13, v82, v83
  v_max3_f32 v13, v13, v84, v85
  v_max3_f32 v13, v13, v86, v87
  v_max3_f32 v13, v13, v88, v89
  v_max3_f32 v13, v13, v90, v91
  v_max3_f32 v13, v13, v92, v93
  v_max3_f32 v13, v13, v94, v95
  s_add_u32 s41, s41, 1
  s_cmp_lt_u32 s41, 64
  s_cbranch_scc1 kb1_mx
  v_mov_b32 v5, v12
  s_nop 1
  v_permlane32_swap_b32 v12, v5
  v_max_f32 v12, v12, v5
  v_cvt_pk_bf16_f32 v5, v12, v12
  v_and_b32 v5, 0xffff, v5
  v_xor_b32 v5, 0x8000, v5
  v_and_b32 v6, 0xffff0000, v198
  v_or_b32 v5, v5, v6
  v_cndmask_b32 v198, v198, v5, s[34:35]
  v_mov_b32 v5, v13
  s_nop 1
  v_permlane32_swap_b32 v13, v5
  v_max_f32 v13, v13, v5
  v_cvt_pk_bf16_f32 v5, v13, v13
  v_and_b32 v5, 0xffff, v5
  v_xor_b32 v5, 0x8000, v5
  v_and_b32 v6, 0xffff0000, v206
  v_or_b32 v5, v5, v6
  v_cndmask_b32 v206, v206, v5, s[34:35]
  s_barrier
  s_mov_b32 s41, 0
  s_mul_i32 s53, s41, 32768
  s_lshl_b32 s31, s21, 13
  s_add_u32 s53, s53, s31
  s_add_u32 m0, s31, 0
  s_add_u32 s29, s53, s27
  s_add_u32 s29, s29, 0
  buffer_load_dwordx4 v2, s[8:11], s29 offen sc1 lds
  s_add_u32 m0, s31, 1024
  s_add_u32 s29, s53, s27
  s_add_u32 s29, s29, 1024
  buffer_load_dwordx4 v2, s[8:11], s29 offen sc1 lds
  s_add_u32 m0, s31, 2048
  s_add_u32 s29, s53, s27
  s_add_u32 s29, s29, 2048
  buffer_load_dwordx4 v2, s[8:11], s29 offen sc1 lds
  s_add_u32 m0, s31, 3072
  s_add_u32 s29, s53, s27
  s_add_u32 s29, s29, 3072
  buffer_load_dwordx4 v2, s[8:11], s29 offen sc1 lds
  s_add_u32 m0, s31, 4096
  s_add_u32 s29, s53, s27
  s_add_u32 s29, s29, 4096
  buffer_load_dwordx4 v2, s[8:11], s29 offen sc1 lds
  s_add_u32 m0, s31, 5120
  s_add_u32 s29, s53, s27
  s_add_u32 s29, s29, 5120
  buffer_load_dwordx4 v2, s[8:11], s29 offen sc1 lds
  s_add_u32 m0, s31, 6144
  s_add_u32 s29, s53, s27
  s_add_u32 s29, s29, 6144
  buffer_load_dwordx4 v2, s[8:11], s29 offen sc1 lds
  s_add_u32 m0, s31, 7168
  s_add_u32 s29, s53, s27
  s_add_u32 s29, s29, 7168
  buffer_load_dwordx4 v2, s[8:11], s29 offen sc1 lds
  s_add_u32 m0, s31, 32768
  s_add_u32 s29, s53, s28
  s_add_u32 s29, s29, 0
  buffer_load_dwordx4 v2, s[8:11], s29 offen sc1 lds
  s_add_u32 m0, s31, 33792
  s_add_u32 s29, s53, s28
  s_add_u32 s29, s29, 1024
  buffer_load_dwordx4 v2, s[8:11], s29 offen sc1 lds
  s_add_u32 m0, s31, 34816
  s_add_u32 s29, s53, s28
  s_add_u32 s29, s29, 2048
  buffer_load_dwordx4 v2, s[8:11], s29 offen sc1 lds
  s_add_u32 m0, s31, 35840
  s_add_u32 s29, s53, s28
  s_add_u32 s29, s29, 3072
  buffer_load_dwordx4 v2, s[8:11], s29 offen sc1 lds
  s_add_u32 m0, s31, 36864
  s_add_u32 s29, s53, s28
  s_add_u32 s29, s29, 4096
  buffer_load_dwordx4 v2, s[8:11], s29 offen sc1 lds
  s_add_u32 m0, s31, 37888
  s_add_u32 s29, s53, s28
  s_add_u32 s29, s29, 5120
  buffer_load_dwordx4 v2, s[8:11], s29 offen sc1 lds
  s_add_u32 m0, s31, 38912
  s_add_u32 s29, s53, s28
  s_add_u32 s29, s29, 6144
  buffer_load_dwordx4 v2, s[8:11], s29 offen sc1 lds
  s_add_u32 m0, s31, 39936
  s_add_u32 s29, s53, s28
  s_add_u32 s29, s29, 7168
  buffer_load_dwordx4 v2, s[8:11], s29 offen sc1 lds
  s_branch kb1_main2
kb1_fin:
  v_and_b32 v3, 15, v1
  v_bfe_u32 v11, v1, 4, 1
  v_mul_u32_u24 v11, 20480, v11
  v_lshrrev_b32 v4, 5, v1
  s_mul_i32 s30, s22, 20
  v_lshlrev_b32 v5, 2, v4
  v_add_u32 v5, 0, v5
  v_add_u32 v5, s30, v5
  v_lshrrev_b32 v6, 5, v5
  v_lshlrev_b32 v6, 10, v6
  v_bfe_u32 v7, v5, 3, 2
  v_lshlrev_b32 v7, 4, v7
  v_add_u32 v7, v7, v3
  v_lshlrev_b32 v7, 4, v7
  v_add_u32 v6, v6, v7
  v_bfe_u32 v7, v5, 2, 1
  v_lshlrev_b32 v7, 3, v7
  v_add_u32 v6, v6, v7
  v_add_u32 v32, v6, v11
  v_lshlrev_b32 v5, 2, v4
  v_add_u32 v5, 8, v5
  v_add_u32 v5, s30, v5
  v_lshrrev_b32 v6, 5, v5
  v_lshlrev_b32 v6, 10, v6
  v_bfe_u32 v7, v5, 3, 2
  v_lshlrev_b32 v7, 4, v7
  v_add_u32 v7, v7, v3
  v_lshlrev_b32 v7, 4, v7
  v_add_u32 v6, v6, v7
  v_bfe_u32 v7, v5, 2, 1
  v_lshlrev_b32 v7, 3, v7
  v_add_u32 v6, v6, v7
  v_add_u32 v33, v6, v11
  v_lshlrev_b32 v5, 2, v4
  v_add_u32 v5, 16, v5
  v_add_u32 v5, s30, v5
  v_lshrrev_b32 v6, 5, v5
  v_lshlrev_b32 v6, 10, v6
  v_bfe_u32 v7, v5, 3, 2
  v_lshlrev_b32 v7, 4, v7
  v_add_u32 v7, v7, v3
  v_lshlrev_b32 v7, 4, v7
  v_add_u32 v6, v6, v7
  v_bfe_u32 v7, v5, 2, 1
  v_lshlrev_b32 v7, 3, v7
  v_add_u32 v6, v6, v7
  v_add_u32 v34, v6, v11
  v_mov_b32 v5, 0x40000000
  v_cndmask_b32 v34, v5, v34, s[34:35]
  v_rcp_f32 v5, v14
  s_nop 0
  v_mul_f32 v112, v112, v5
  v_mul_f32 v113, v113, v5
  v_mul_f32 v114, v114, v5
  v_mul_f32 v115, v115, v5
  v_mul_f32 v116, v116, v5
  v_mul_f32 v117, v117, v5
  v_mul_f32 v118, v118, v5
  v_mul_f32 v119, v119, v5
  v_mul_f32 v120, v120, v5
  v_mul_f32 v121, v121, v5
  v_mul_f32 v122, v122, v5
  v_mul_f32 v123, v123, v5
  v_cvt_pk_bf16_f32 v40, v112, v113
  v_cvt_pk_bf16_f32 v41, v114, v115
  v_cvt_pk_bf16_f32 v42, v116, v117
  v_cvt_pk_bf16_f32 v43, v118, v119
  v_cvt_pk_bf16_f32 v44, v120, v121
  v_cvt_pk_bf16_f32 v45, v122, v123
  s_add_u32 s31, s52, 0
  s_mul_i32 s31, s31, 40960
  s_add_u32 s31, s31, 0xf200000
  buffer_store_dwordx2 v[40:41], v32, s[8:11], s31 offen sc1
  buffer_store_dwordx2 v[42:43], v33, s[8:11], s31 offen sc1
  buffer_store_dwordx2 v[44:45], v34, s[8:11], s31 offen sc1
  v_rcp_f32 v5, v15
  s_nop 0
  v_mul_f32 v128, v128, v5
  v_mul_f32 v129, v129, v5
  v_mul_f32 v130, v130, v5
  v_mul_f32 v131, v131, v5
  v_mul_f32 v132, v132, v5
  v_mul_f32 v133, v133, v5
  v_mul_f32 v134, v134, v5
  v_mul_f32 v135, v135, v5
  v_mul_f32 v136, v136, v5
  v_mul_f32 v137, v137, v5
  v_mul_f32 v138, v138, v5
  v_mul_f32 v139, v139, v5
  v_cvt_pk_bf16_f32 v48, v128, v129
  v_cvt_pk_bf16_f32 v49, v130, v131
  v_cvt_pk_bf16_f32 v50, v132, v133
  v_cvt_pk_bf16_f32 v51, v134, v135
  v_cvt_pk_bf16_f32 v52, v136, v137
  v_cvt_pk_bf16_f32 v53, v138, v139
  s_add_u32 s31, s52, 1
  s_mul_i32 s31, s31, 40960
  s_add_u32 s31, s31, 0xf200000
  buffer_store_dwordx2 v[48:49], v32, s[8:11], s31 offen sc1
  buffer_store_dwordx2 v[50:51], v33, s[8:11], s31 offen sc1
  buffer_store_dwordx2 v[52:53], v34, s[8:11], s31 offen sc1
  s_waitcnt vmcnt(0)
  s_barrier
  s_cmp_eq_u32 s21, 0
  s_cbranch_scc0 arr_45
  s_mov_b64 s[24:25], exec
  s_mov_b64 exec, 1
  v_mov_b32 v3, 0
  v_mov_b32 v4, 1
  buffer_atomic_add v4, v3, s[8:11], s48 offen
  s_mov_b64 exec, s[24:25]
arr_45:
  v_and_b32 v5, 15, v1
  v_lshrrev_b32 v6, 4, v1
  v_and_b32 v7, 1, v6
  v_lshlrev_b32 v7, 10, v7
  v_lshrrev_b32 v8, 1, v6
  v_lshlrev_b32 v8, 5, v8
  v_add_u32 v8, v8, v5
  v_lshlrev_b32 v8, 4, v8
  v_add_u32 v9, v7, v8
  s_lshr_b32 s26, s2, 2
  s_mul_i32 s27, s26, 81920
  s_lshl_b32 s28, s50, 11
  s_add_u32 s27, s27, s28
  s_add_u32 s27, s27, 0x1400000
  s_add_u32 s28, s27, 0
  buffer_load_dwordx4 v[16:19], v9, s[8:11], s28 offen sc1
  s_add_u32 s28, s27, 256
  buffer_load_dwordx4 v[20:23], v9, s[8:11], s28 offen sc1
  s_add_u32 s28, s27, 2048
  buffer_load_dwordx4 v[24:27], v9, s[8:11], s28 offen sc1
  s_add_u32 s28, s27, 2304
  buffer_load_dwordx4 v[28:31], v9, s[8:11], s28 offen sc1
  s_cmp_lt_u32 s21, 2
  s_cbranch_scc0 g3_46
  s_add_u32 s28, s27, 4096
  buffer_load_dwordx4 v[32:35], v9, s[8:11], s28 offen sc1
  s_add_u32 s28, s27, 4352
  buffer_load_dwordx4 v[36:39], v9, s[8:11], s28 offen sc1
g3_46:
  s_mov_b32 s45, 0
  v_mov_b32 v3, 0
aw_47:
  buffer_load_dword v4, v3, s[8:11], s48 offen sc1
  s_add_u32 s45, s45, 1
  s_waitcnt vmcnt(0)
  v_readfirstlane_b32 s29, v4
  s_cmp_ge_u32 s29, 32
  s_cbranch_scc1 aw_47_ok
  s_cmp_lt_u32 s45, 400000
  s_cbranch_scc1 aw_47
  s_branch kb1_abort
aw_47_ok:
  s_mul_i32 s28, s26, 40960
  s_mul_i32 s31, s21, 10240
  s_add_u32 s28, s28, s31
  s_add_u32 s28, s28, 0xf200000
  s_add_u32 m0, s31, 0
  s_add_u32 s29, s28, 0
  buffer_load_dwordx4 v2, s[8:11], s29 offen sc1 lds
  s_add_u32 m0, s31, 1024
  s_add_u32 s29, s28, 1024
  buffer_load_dwordx4 v2, s[8:11], s29 offen sc1 lds
  s_add_u32 m0, s31, 2048
  s_add_u32 s29, s28, 2048
  buffer_load_dwordx4 v2, s[8:11], s29 offen sc1 lds
  s_add_u32 m0, s31, 3072
  s_add_u32 s29, s28, 3072
  buffer_load_dwordx4 v2, s[8:11], s29 offen sc1 lds
  s_add_u32 m0, s31, 4096
  s_add_u32 s29, s28, 4096
  buffer_load_dwordx4 v2, s[8:11], s29 offen sc1 lds
  s_add_u32 m0, s31, 5120
  s_add_u32 s29, s28, 5120
  buffer_load_dwordx4 v2, s[8:11], s29 offen sc1 lds
  s_add_u32 m0, s31, 6144
  s_add_u32 s29, s28, 6144
  buffer_load_dwordx4 v2, s[8:11], s29 offen sc1 lds
  s_add_u32 m0, s31, 7168
  s_add_u32 s29, s28, 7168
  buffer_load_dwordx4 v2, s[8:11], s29 offen sc1 lds
  s_add_u32 m0, s31, 8192
  s_add_u32 s29, s28, 8192
  buffer_load_dwordx4 v2, s[8:11], s29 offen sc1 lds
  s_add_u32 m0, s31, 9216
  s_add_u32 s29, s28, 9216
  buffer_load_dwordx4 v2, s[8:11], s29 offen sc1 lds
  s_waitcnt vmcnt(0)
  s_barrier
  ds_read_b128 v[80:83], v2 offset:0
  ds_read_b128 v[84:87], v2 offset:20480
  ds_read_b128 v[88:91], v2 offset:1024
  ds_read_b128 v[92:95], v2 offset:21504
  ds_read_b128 v[96:99], v2 offset:2048
  ds_read_b128 v[100:103], v2 offset:22528
  s_waitcnt lgkmcnt(4)
  v_mfma_f32_16x16x32_bf16 v[48:51], a[0:3], v[80:83], 0
  v_mfma_f32_16x16x32_bf16 v[52:55], a[0:3], v[84:87], 0
  v_mfma_f32_16x16x32_bf16 v[56:59], a[80:83], v[80:83], 0
  v_mfma_f32_16x16x32_bf16 v[60:63], a[80:83], v[84:87], 0
  v_mfma_f32_16x16x32_bf16 v[64:67], a[160:163], v[80:83], 0
  v_mfma_f32_16x16x32_bf16 v[68:71], a[160:163], v[84:87], 0
  ds_read_b128 v[80:83], v2 offset:3072
  ds_read_b128 v[84:87], v2 offset:23552
  s_waitcnt lgkmcnt(4)
  v_mfma_f32_16x16x32_bf16 v[48:51], a[4:7], v[88:91], v[48:51]
  v_mfma_f32_16x16x32_bf16 v[52:55], a[4:7], v[92:95], v[52:55]
  v_mfma_f32_16x16x32_bf16 v[56:59], a[84:87], v[88:91], v[56:59]
  v_mfma_f32_16x16x32_bf16 v[60:63], a[84:87], v[92:95], v[60:63]
  v_mfma_f32_16x16x32_bf16 v[64:67], a[164:167], v[88:91], v[64:67]
  v_mfma_f32_16x16x32_bf16 v[68:71], a[164:167], v[92:95], v[68:71]
  ds_read_b128 v[88:91], v2 offset:4096
  ds_read_b128 v[92:95], v2 offset:24576
  s_waitcnt lgkmcnt(4)
  v_mfma_f32_16x16x32_bf16 v[48:51], a[8:11], v[96:99], v[48:51]
  v_mfma_f32_16x16x32_bf16 v[52:55], a[8:11], v[100:103], v[52:55]
  v_mfma_f32_16x16x32_bf16 v[56:59], a[88:91], v[96:99], v[56:59]
  v_mfma_f32_16x16x32_bf16 v[60:63], a[88:91], v[100:103], v[60:63]
  v_mfma_f32_16x16x32_bf16 v[64:67], a[168:171], v[96:99], v[64:67]
  v_mfma_f32_16x16x32_bf16 v[68:71], a[168:171], v[100:103], v[68:71]
  ds_read_b128 v[96:99], v2 offset:5120
  ds_read_b128 v[100:103], v2 offset:25600
  s_waitcnt lgkmcnt(4)
  v_mfma_f32_16x16x32_bf16 v[48:51], a[12:15], v[80:83], v[48:51]
  v_mfma_f32_16x16x32_bf16 v[52:55], a[12:15], v[84:87], v[52:55]
  v_mfma_f32_16x16x32_bf16 v[56:59], a[92:95], v[80:83], v[56:59]
  v_mfma_f32_16x16x32_bf16 v[60:63], a[92:95], v[84:87], v[60:63]
  v_mfma_f32_16x16x32_bf16 v[64:67], a[172:175], v[80:83], v[64:67]
  v_mfma_f32_16x16x32_bf16 v[68:71], a[172:175], v[84:87], v[68:71]
  ds_read_b128 v[80:83], v2 offset:6144
  ds_read_b128 v[84:87], v2 offset:26624
  s_waitcnt lgkmcnt(4)
  v_mfma_f32_16x16x32_bf16 v[48:51], a[16:19], v[88:91], v[48:51]
  v_mfma_f32_16x16x32_bf16 v[52:55], a[16:19], v[92:95], v[52:55]
  v_mfma_f32_16x16x32_bf16 v[56:59], a[96:99], v[88:91], v[56:59]
  v_mfma_f32_16x16x32_bf16 v[60:63], a[96:99], v[92:95], v[60:63]
  v_mfma_f32_16x16x32_bf16 v[64:67], a[176:179], v[88:91], v[64:67]
  v_mfma_f32_16x16x32_bf16 v[68:71], a[176:179], v[92:95], v[68:71]
  ds_read_b128 v[88:91], v2 offset:7168
  ds_read_b128 v[92:95], v2 offset:27648
  s_waitcnt lgkmcnt(4)
  v_mfma_f32_16x16x32_bf16 v[48:51], a[20:23], v[96:99], v[48:51]
  v_mfma_f32_16x16x32_bf16 v[52:55], a[20:23], v[100:103], v[52:55]
  v_mfma_f32_16x16x32_bf16 v[56:59], a[100:103], v[96:99], v[56:59]
  v_mfma_f32_16x16x32_bf16 v[60:63], a[100:103], v[100:103], v[60:63]
  v_mfma_f32_16x16x32_bf16 v[64:67], a[180:183], v[96:99], v[64:67]
  v_mfma_f32_16x16x32_bf16 v[68:71], a[180:183], v[100:103], v[68:71]
  ds_read_b128 v[96:99], v2 offset:8192
  ds_read_b128 v[100:103], v2 offset:28672
  s_waitcnt lgkmcnt(4)
  v_mfma_f32_16x16x32_bf16 v[48:51], a[24:27], v[80:83], v[48:51]
  v_mfma_f32_16x16x32_bf16 v[52:55], a[24:27], v[84:87], v[52:55]
  v_mfma_f32_16x16x32_bf16 v[56:59], a[104:107], v[80:83], v[56:59]
  v_mfma_f32_16x16x32_bf16 v[60:63], a[104:107], v[84:87], v[60:63]
  v_mfma_f32_16x16x32_bf16 v[64:67], a[184:187], v[80:83], v[64:67]
  v_mfma_f32_16x16x32_bf16 v[68:71], a[184:187], v[84:87], v[68:71]
  ds_read_b128 v[80:83], v2 offset:9216
  ds_read_b128 v[84:87], v2 offset:29696
  s_waitcnt lgkmcnt(4)
  v_mfma_f32_16x16x32_bf16 v[48:51], a[28:31], v[88:91], v[48:51]
  v_mfma_f32_16x16x32_bf16 v[52:55], a[28:31], v[92:95], v[52:55]
  v_mfma_f32_16x16x32_bf16 v[56:59], a[108:111], v[88:91], v[56:59]
  v_mfma_f32_16x16x32_bf16 v[60:63], a[108:111], v[92:95], v[60:63]
  v_mfma_f32_16x16x32_bf16 v[64:67], a[188:191], v[88:91], v[64:67]
  v_mfma_f32_16x16x32_bf16 v[68:71], a[188:191], v[92:95], v[68:71]
  ds_read_b128 v[88:91], v2 offset:10240
  ds_read_b128 v[92:95], v2 offset:30720
  s_waitcnt lgkmcnt(4)
  v_mfma_f32_16x16x32_bf16 v[48:51], a[32:35], v[96:99], v[48:51]
  v_mfma_f32_16x16x32_bf16 v[52:55], a[32:35], v[100:103], v[52:55]
  v_mfma_f32_16x16x32_bf16 v[56:59], a[112:115], v[96:99], v[56:59]
  v_mfma_f32_16x16x32_bf16 v[60:63], a[112:115], v[100:103], v[60:63]
  v_mfma_f32_16x16x32_bf16 v[64:67], a[192:195], v[96:99], v[64:67]
  v_mfma_f32_16x16x32_bf16 v[68:71], a[192:195], v[100:103], v[68:71]
  ds_read_b128 v[96:99], v2 offset:11264
  ds_read_b128 v[100:103], v2 offset:31744
  s_waitcnt lgkmcnt(4)
  v_mfma_f32_16x16x32_bf16 v[48:51], a[36:39], v[80:83], v[48:51]
  v_mfma_f32_16x16x32_bf16 v[52:55], a[36:39], v[84:87], v[52:55]
  v_mfma_f32_16x16x32_bf16 v[56:59], a[116:119], v[80:83], v[56:59]
  v_mfma_f32_16x16x32_bf16 v[60:63], a[116:119], v[84:87], v[60:63]
  v_mfma_f32_16x16x32_bf16 v[64:67], a[196:199], v[80:83], v[64:67]
  v_mfma_f32_16x16x32_bf16 v[68:71], a[196:199], v[84:87], v[68:71]
  ds_read_b128 v[80:83], v2 offset:12288
  ds_read_b128 v[84:87], v2 offset:32768
  s_waitcnt lgkmcnt(4)
  v_mfma_f32_16x16x32_bf16 v[48:51], a[40:43], v[88:91], v[48:51]
  v_mfma_f32_16x16x32_bf16 v[52:55], a[40:43], v[92:95], v[52:55]
  v_mfma_f32_16x16x32_bf16 v[56:59], a[120:123], v[88:91], v[56:59]
  v_mfma_f32_16x16x32_bf16 v[60:63], a[120:123], v[92:95], v[60:63]
  v_mfma_f32_16x16x32_bf16 v[64:67], a[200:203], v[88:91], v[64:67]
  v_mfma_f32_16x16x32_bf16 v[68:71], a[200:203], v[92:95], v[68:71]
  ds_read_b128 v[88:91], v2 offset:13312
  ds_read_b128 v[92:95], v2 offset:33792
  s_waitcnt lgkmcnt(4)
  v_mfma_f32_16x16x32_bf16 v[48:51], a[44:47], v[96:99], v[48:51]
  v_mfma_f32_16x16x32_bf16 v[52:55], a[44:47], v[100:103], v[52:55]
  v_mfma_f32_16x16x32_bf16 v[56:59], a[124:127], v[96:99], v[56:59]
  v_mfma_f32_16x16x32_bf16 v[60:63], a[124:127], v[100:103], v[60:63]
  v_mfma_f32_16x16x32_bf16 v[64:67], a[204:207], v[96:99], v[64:67]
  v_mfma_f32_16x16x32_bf16 v[68:71], a[204:207], v[100:103], v[68:71]
  ds_read_b128 v[96:99], v2 offset:14336
  ds_read_b128 v[100:103], v2 offset:34816
  s_waitcnt lgkmcnt(4)
  v_mfma_f32_16x16x32_bf16 v[48:51], a[48:51], v[80:83], v[48:51]
  v_mfma_f32_16x16x32_bf16 v[52:55], a[48:51], v[84:87], v[52:55]
  v_mfma_f32_16x16x32_bf16 v[56:59], a[128:131], v[80:83], v[56:59]
  v_mfma_f32_16x16x32_bf16 v[60:63], a[128:131], v[84:87], v[60:63]
  v_mfma_f32_16x16x32_bf16 v[64:67], a[208:211], v[80:83], v[64:67]
  v_mfma_f32_16x16x32_bf16 v[68:71], a[208:211], v[84:87], v[68:71]
  ds_read_b128 v[80:83], v2 offset:15360
  ds_read_b128 v[84:87], v2 offset:35840
  s_waitcnt lgkmcnt(4)
  v_mfma_f32_16x16x32_bf16 v[48:51], a[52:55], v[88:91], v[48:51]
  v_mfma_f32_16x16x32_bf16 v[52:55], a[52:55], v[92:95], v[52:55]
  v_mfma_f32_16x16x32_bf16 v[56:59], a[132:135], v[88:91], v[56:59]
  v_mfma_f32_16x16x32_bf16 v[60:63], a[132:135], v[92:95], v[60:63]
  v_mfma_f32_16x16x32_bf16 v[64:67], a[212:215], v[88:91], v[64:67]
  v_mfma_f32_16x16x32_bf16 v[68:71], a[212:215], v[92:95], v[68:71]
  ds_read_b128 v[88:91], v2 offset:16384
  ds_read_b128 v[92:95], v2 offset:36864
  s_waitcnt lgkmcnt(4)
  v_mfma_f32_16x16x32_bf16 v[48:51], a[56:59], v[96:99], v[48:51]
  v_mfma_f32_16x16x32_bf16 v[52:55], a[56:59], v[100:103], v[52:55]
  v_mfma_f32_16x16x32_bf16 v[56:59], a[136:139], v[96:99], v[56:59]
  v_mfma_f32_16x16x32_bf16 v[60:63], a[136:139], v[100:103], v[60:63]
  v_mfma_f32_16x16x32_bf16 v[64:67], a[216:219], v[96:99], v[64:67]
  v_mfma_f32_16x16x32_bf16 v[68:71], a[216:219], v[100:103], v[68:71]
  ds_read_b128 v[96:99], v2 offset:17408
  ds_read_b128 v[100:103], v2 offset:37888
  s_waitcnt lgkmcnt(4)
  v_mfma_f32_16x16x32_bf16 v[48:51], a[60:63], v[80:83], v[48:51]
  v_mfma_f32_16x16x32_bf16 v[52:55], a[60:63], v[84:87], v[52:55]
  v_mfma_f32_16x16x32_bf16 v[56:59], a[140:143], v[80:83], v[56:59]
  v_mfma_f32_16x16x32_bf16 v[60:63], a[140:143], v[84:87], v[60:63]
  v_mfma_f32_16x16x32_bf16 v[64:67], a[220:223], v[80:83], v[64:67]
  v_mfma_f32_16x16x32_bf16 v[68:71], a[220:223], v[84:87], v[68:71]
  ds_read_b128 v[80:83], v2 offset:18432
  ds_read_b128 v[84:87], v2 offset:38912
  s_waitcnt lgkmcnt(4)
  v_mfma_f32_16x16x32_bf16 v[48:51], a[64:67], v[88:91], v[48:51]
  v_mfma_f32_16x16x32_bf16 v[52:55], a[64:67], v[92:95], v[52:55]
  v_mfma_f32_16x16x32_bf16 v[56:59], a[144:147], v[88:91], v[56:59]
  v_mfma_f32_16x16x32_bf16 v[60:63], a[144:147], v[92:95], v[60:63]
  v_mfma_f32_16x16x32_bf16 v[64:67], a[224:227], v[88:91], v[64:67]
  v_mfma_f32_16x16x32_bf16 v[68:71], a[224:227], v[92:95], v[68:71]
  ds_read_b128 v[88:91], v2 offset:19456
  ds_read_b128 v[92:95], v2 offset:39936
  s_waitcnt lgkmcnt(4)
  v_mfma_f32_16x16x32_bf16 v[48:51], a[68:71], v[96:99], v[48:51]
  v_mfma_f32_16x16x32_bf16 v[52:55], a[68:71], v[100:103], v[52:55]
  v_mfma_f32_16x16x32_bf16 v[56:59], a[148:151], v[96:99], v[56:59]
  v_mfma_f32_16x16x32_bf16 v[60:63], a[148:151], v[100:103], v[60:63]
  v_mfma_f32_16x16x32_bf16 v[64:67], a[228:231], v[96:99], v[64:67]
  v_mfma_f32_16x16x32_bf16 v[68:71], a[228:231], v[100:103], v[68:71]
  s_waitcnt lgkmcnt(2)
  v_mfma_f32_16x16x32_bf16 v[48:51], a[72:75], v[80:83], v[48:51]
  v_mfma_f32_16x16x32_bf16 v[52:55], a[72:75], v[84:87], v[52:55]
  v_mfma_f32_16x16x32_bf16 v[56:59], a[152:155], v[80:83], v[56:59]
  v_mfma_f32_16x16x32_bf16 v[60:63], a[152:155], v[84:87], v[60:63]
  v_mfma_f32_16x16x32_bf16 v[64:67], a[232:235], v[80:83], v[64:67]
  v_mfma_f32_16x16x32_bf16 v[68:71], a[232:235], v[84:87], v[68:71]
  s_waitcnt lgkmcnt(0)
  v_mfma_f32_16x16x32_bf16 v[48:51], a[76:79], v[88:91], v[48:51]
  v_mfma_f32_16x16x32_bf16 v[52:55], a[76:79], v[92:95], v[52:55]
  v_mfma_f32_16x16x32_bf16 v[56:59], a[156:159], v[88:91], v[56:59]
  v_mfma_f32_16x16x32_bf16 v[60:63], a[156:159], v[92:95], v[60:63]
  v_mfma_f32_16x16x32_bf16 v[64:67], a[236:239], v[88:91], v[64:67]
  v_mfma_f32_16x16x32_bf16 v[68:71], a[236:239], v[92:95], v[68:71]
  s_nop 7
  v_add_f32 v48, v48, v16
  v_add_f32 v49, v49, v17
  v_add_f32 v50, v50, v18
  v_add_f32 v51, v51, v19
  s_add_u32 s28, s27, 0
  buffer_store_dwordx4 v[48:51], v9, s[8:11], s28 offen
  v_add_f32 v52, v52, v20
  v_add_f32 v53, v53, v21
  v_add_f32 v54, v54, v22
  v_add_f32 v55, v55, v23
  s_add_u32 s28, s27, 256
  buffer_store_dwordx4 v[52:55], v9, s[8:11], s28 offen
  v_add_f32 v56, v56, v24
  v_add_f32 v57, v57, v25
  v_add_f32 v58, v58, v26
  v_add_f32 v59, v59, v27
  s_add_u32 s28, s27, 2048
  buffer_store_dwordx4 v[56:59], v9, s[8:11], s28 offen
  v_add_f32 v60, v60, v28
  v_add_f32 v61, v61, v29
  v_add_f32 v62, v62, v30
  v_add_f32 v63, v63, v31
  s_add_u32 s28, s27, 2304
  buffer_store_dwordx4 v[60:63], v9, s[8:11], s28 offen
  s_cmp_lt_u32 s21, 2
  s_cbranch_scc0 g3_48
  v_add_f32 v64, v64, v32
  v_add_f32 v65, v65, v33
  v_add_f32 v66, v66, v34
  v_add_f32 v67, v67, v35
  s_add_u32 s28, s27, 4096
  buffer_store_dwordx4 v[64:67], v9, s[8:11], s28 offen
  v_add_f32 v68, v68, v36
  v_add_f32 v69, v69, v37
  v_add_f32 v70, v70, v38
  v_add_f32 v71, v71, v39
  s_add_u32 s28, s27, 4352
  buffer_store_dwordx4 v[68:71], v9, s[8:11], s28 offen
g3_48:
  s_endpgm
kb1_abort:
  s_load_dwordx2 s[6:7], s[0:1], 88
  v_mov_b32 v2, 80
  v_mov_b32 v3, 1
  s_waitcnt lgkmcnt(0)
  s_mov_b64 exec, 1
  global_atomic_add v2, v3, s[6:7]
  s_waitcnt vmcnt(0)
kb1_exit:
  s_endpgm

.section .rodata,"a"
.p2align 6
.amdhsa_kernel kb1_kernel
  .amdhsa_next_free_vgpr 512
  .amdhsa_next_free_sgpr 102
  .amdhsa_accum_offset 256
  .amdhsa_group_segment_fixed_size 0
  .amdhsa_kernarg_size 104
  .amdhsa_user_sgpr_count 2
  .amdhsa_user_sgpr_kernarg_segment_ptr 1
  .amdhsa_system_sgpr_workgroup_id_x 1
.end_amdhsa_kernel
.text
.globl ka2_kernel
.p2align 8
.type ka2_kernel,@function
ka2_kernel:
  s_mov_b32 s99, 1
ka_body:
  s_cmp_ge_u32 s2, 256
  s_cbranch_scc1 ka_exit

  s_load_dwordx2 s[4:5], s[0:1], 96
  s_load_dwordx2 s[6:7], s[0:1], 88
  s_load_dwordx4 s[36:39], s[0:1], 16
  s_load_dwordx4 s[40:43], s[0:1], 32
  s_getreg_b32 s26, hwreg(HW_REG_XCC_ID)
  s_and_b32 s26, s26, 15
  v_lshrrev_b32 v1, 6, v0
  s_nop 0
  v_readfirstlane_b32 s21, v1
  s_waitcnt lgkmcnt(0)
  s_mov_b32 s8, s4
  s_and_b32 s9, s5, 0xffff
  s_mov_b32 s10, 0x10000000
  s_mov_b32 s11, 0x20000
  s_cmp_eq_u32 s21, 3
  s_cbranch_scc0 lnu_49_x
  v_and_b32 v1, 63, v0
  v_and_b32 v5, 7, v1
  v_bfe_u32 v6, v1, 3, 1
  v_lshrrev_b32 v7, 4, v1
  v_lshlrev_b32 v8, 5, v6
  v_add_u32 v8, v8, v5
  v_lshlrev_b32 v8, 4, v8
  v_lshlrev_b32 v10, 10, v7
  v_add_u32 v10, v10, v8
  s_lshr_b32 s46, s2, 2
  s_and_b32 s47, s2, 3
  s_lshl_b32 s47, s47, 7
  s_cmp_eq_u32 s99, 1
  s_cbranch_scc0 lnu_49_b
  v_lshlrev_b32 v9, 11, v7
  v_add_u32 v9, v9, v8
  s_mul_i32 s48, s46, 81920
  s_add_u32 s48, s48, s47
  s_add_u32 s48, s48, 0x1400000
  s_add_u32 s49, s48, 0
  buffer_load_dwordx4 v[16:19], v9, s[8:11], s49 offen
  s_add_u32 s49, s48, 1024
  buffer_load_dwordx4 v[20:23], v9, s[8:11], s49 offen
  s_add_u32 s49, s48, 8192
  buffer_load_dwordx4 v[24:27], v9, s[8:11], s49 offen
  s_add_u32 s49, s48, 9216
  buffer_load_dwordx4 v[28:31], v9, s[8:11], s49 offen
  s_add_u32 s49, s48, 16384
  buffer_load_dwordx4 v[32:35], v9, s[8:11], s49 offen
  s_add_u32 s49, s48, 17408
  buffer_load_dwordx4 v[36:39], v9, s[8:11], s49 offen
  s_add_u32 s49, s48, 24576
  buffer_load_dwordx4 v[40:43], v9, s[8:11], s49 offen
  s_add_u32 s49, s48, 25600
  buffer_load_dwordx4 v[44:47], v9, s[8:11], s49 offen
  s_add_u32 s49, s48, 32768
  buffer_load_dwordx4 v[48:51], v9, s[8:11], s49 offen
  s_add_u32 s49, s48, 33792
  buffer_load_dwordx4 v[52:55], v9, s[8:11], s49 offen
  s_add_u32 s49, s48, 40960
  buffer_load_dwordx4 v[56:59], v9, s[8:11], s49 offen
  s_add_u32 s49, s48, 41984
  buffer_load_dwordx4 v[60:63], v9, s[8:11], s49 offen
  s_add_u32 s49, s48, 49152
  buffer_load_dwordx4 v[64:67], v9, s[8:11], s49 offen
  s_add_u32 s49, s48, 50176
  buffer_load_dwordx4 v[68:71], v9, s[8:11], s49 offen
  s_add_u32 s49, s48, 57344
  buffer_load_dwordx4 v[72:75], v9, s[8:11], s49 offen
  s_add_u32 s49, s48, 58368
  buffer_load_dwordx4 v[76:79], v9, s[8:11], s49 offen
  s_add_u32 s49, s48, 65536
  buffer_load_dwordx4 v[80:83], v9, s[8:11], s49 offen
  s_add_u32 s49, s48, 66560
  buffer_load_dwordx4 v[84:87], v9, s[8:11], s49 offen
  s_add_u32 s49, s48, 73728
  buffer_load_dwordx4 v[88:91], v9, s[8:11], s49 offen
  s_add_u32 s49, s48, 74752
  buffer_load_dwordx4 v[92:95], v9, s[8:11], s49 offen
  s_waitcnt vmcnt(0)
  s_branch lnu_49_f
lnu_49_b:
  s_load_dwordx2 s[48:49], s[0:1], 0
  v_mul_u32_u24 v11, 1280, v5
  v_lshlrev_b32 v12, 5, v7
  v_add_u32 v11, v11, v12
  v_lshlrev_b32 v12, 4, v6
  v_add_u32 v11, v11, v12
  s_waitcnt lgkmcnt(0)
  s_mov_b32 s12, s48
  s_and_b32 s13, s49, 0xffff
  s_mov_b32 s14, 0x280000
  s_mov_b32 s15, 0x20000
  s_mul_i32 s49, s2, 10240
  buffer_load_dwordx4 v[56:59], v11, s[12:15], s49 offen offset:0
  buffer_load_dwordx4 v[60:63], v11, s[12:15], s49 offen offset:128
  buffer_load_dwordx4 v[64:67], v11, s[12:15], s49 offen offset:256
  buffer_load_dwordx4 v[68:71], v11, s[12:15], s49 offen offset:384
  buffer_load_dwordx4 v[72:75], v11, s[12:15], s49 offen offset:512
  buffer_load_dwordx4 v[76:79], v11, s[12:15], s49 offen offset:640
  buffer_load_dwordx4 v[80:83], v11, s[12:15], s49 offen offset:768
  buffer_load_dwordx4 v[84:87], v11, s[12:15], s49 offen offset:896
  buffer_load_dwordx4 v[88:91], v11, s[12:15], s49 offen offset:1024
  buffer_load_dwordx4 v[92:95], v11, s[12:15], s49 offen offset:1152
  s_waitcnt vmcnt(0)
  v_mov_b32 v4, v56
  v_lshlrev_b32 v16, 16, v4
  v_and_b32 v17, 0xffff0000, v4
  v_mov_b32 v4, v57
  v_lshlrev_b32 v18, 16, v4
  v_and_b32 v19, 0xffff0000, v4
  v_mov_b32 v4, v58
  v_lshlrev_b32 v20, 16, v4
  v_and_b32 v21, 0xffff0000, v4
  v_mov_b32 v4, v59
  v_lshlrev_b32 v22, 16, v4
  v_and_b32 v23, 0xffff0000, v4
  v_mov_b32 v4, v60
  v_lshlrev_b32 v24, 16, v4
  v_and_b32 v25, 0xffff0000, v4
  v_mov_b32 v4, v61
  v_lshlrev_b32 v26, 16, v4
  v_and_b32 v27, 0xffff0000, v4
  v_mov_b32 v4, v62
  v_lshlrev_b32 v28, 16, v4
  v_and_b32 v29, 0xffff0000, v4
  v_mov_b32 v4, v63
  v_lshlrev_b32 v30, 16, v4
  v_and_b32 v31, 0xffff0000, v4
  v_mov_b32 v4, v64
  v_lshlrev_b32 v32, 16, v4
  v_and_b32 v33, 0xffff0000, v4
  v_mov_b32 v4, v65
  v_lshlrev_b32 v34, 16, v4
  v_and_b32 v35, 0xffff0000, v4
  v_mov_b32 v4, v66
  v_lshlrev_b32 v36, 16, v4
  v_and_b32 v37, 0xffff0000, v4
  v_mov_b32 v4, v67
  v_lshlrev_b32 v38, 16, v4
  v_and_b32 v39, 0xffff0000, v4
  v_mov_b32 v4, v68
  v_lshlrev_b32 v40, 16, v4
  v_and_b32 v41, 0xffff0000, v4
  v_mov_b32 v4, v69
  v_lshlrev_b32 v42, 16, v4
  v_and_b32 v43, 0xffff0000, v4
  v_mov_b32 v4, v70
  v_lshlrev_b32 v44, 16, v4
  v_and_b32 v45, 0xffff0000, v4
  v_mov_b32 v4, v71
  v_lshlrev_b32 v46, 16, v4
  v_and_b32 v47, 0xffff0000, v4
  v_mov_b32 v4, v72
  v_lshlrev_b32 v48, 16, v4
  v_and_b32 v49, 0xffff0000, v4
  v_mov_b32 v4, v73
  v_lshlrev_b32 v50, 16, v4
  v_and_b32 v51, 0xffff0000, v4
  v_mov_b32 v4, v74
  v_lshlrev_b32 v52, 16, v4
  v_and_b32 v53, 0xffff0000, v4
  v_mov_b32 v4, v75
  v_lshlrev_b32 v54, 16, v4
  v_and_b32 v55, 0xffff0000, v4
  v_mov_b32 v4, v76
  v_lshlrev_b32 v56, 16, v4
  v_and_b32 v57, 0xffff0000, v4
  v_mov_b32 v4, v77
  v_lshlrev_b32 v58, 16, v4
  v_and_b32 v59, 0xffff0000, v4
  v_mov_b32 v4, v78
  v_lshlrev_b32 v60, 16, v4
  v_and_b32 v61, 0xffff0000, v4
  v_mov_b32 v4, v79
  v_lshlrev_b32 v62, 16, v4
  v_and_b32 v63, 0xffff0000, v4
  v_mov_b32 v4, v80
  v_lshlrev_b32 v64, 16, v4
  v_and_b32 v65, 0xffff0000, v4
  v_mov_b32 v4, v81
  v_lshlrev_b32 v66, 16, v4
  v_and_b32 v67, 0xffff0000, v4
  v_mov_b32 v4, v82
  v_lshlrev_b32 v68, 16, v4
  v_and_b32 v69, 0xffff0000, v4
  v_mov_b32 v4, v83
  v_lshlrev_b32 v70, 16, v4
  v_and_b32 v71, 0xffff0000, v4
  v_mov_b32 v4, v84
  v_lshlrev_b32 v72, 16, v4
  v_and_b32 v73, 0xffff0000, v4
  v_mov_b32 v4, v85
  v_lshlrev_b32 v74, 16, v4
  v_and_b32 v75, 0xffff0000, v4
  v_mov_b32 v4, v86
  v_lshlrev_b32 v76, 16, v4
  v_and_b32 v77, 0xffff0000, v4
  v_mov_b32 v4, v87
  v_lshlrev_b32 v78, 16, v4
  v_and_b32 v79, 0xffff0000, v4
  v_mov_b32 v4, v88
  v_lshlrev_b32 v80, 16, v4
  v_and_b32 v81, 0xffff0000, v4
  v_mov_b32 v4, v89
  v_lshlrev_b32 v82, 16, v4
  v_and_b32 v83, 0xffff0000, v4
  v_mov_b32 v4, v90
  v_lshlrev_b32 v84, 16, v4
  v_and_b32 v85, 0xffff0000, v4
  v_mov_b32 v4, v91
  v_lshlrev_b32 v86, 16, v4
  v_and_b32 v87, 0xffff0000, v4
  v_mov_b32 v4, v92
  v_lshlrev_b32 v88, 16, v4
  v_and_b32 v89, 0xffff0000, v4
  v_mov_b32 v4, v93
  v_lshlrev_b32 v90, 16, v4
  v_and_b32 v91, 0xffff0000, v4
  v_mov_b32 v4, v94
  v_lshlrev_b32 v92, 16, v4
  v_and_b32 v93, 0xffff0000, v4
  v_mov_b32 v4, v95
  v_lshlrev_b32 v94, 16, v4
  v_and_b32 v95, 0xffff0000, v4
lnu_49_f:
  v_pk_add_f32 v[12:13], v[16:17], v[18:19]
  v_pk_add_f32 v[12:13], v[12:13], v[20:21]
  v_pk_add_f32 v[12:13], v[12:13], v[22:23]
  v_pk_add_f32 v[12:13], v[12:13], v[24:25]
  v_pk_add_f32 v[12:13], v[12:13], v[26:27]
  v_pk_add_f32 v[12:13], v[12:13], v[28:29]
  v_pk_add_f32 v[12:13], v[12:13], v[30:31]
  v_pk_add_f32 v[12:13], v[12:13], v[32:33]
  v_pk_add_f32 v[12:13], v[12:13], v[34:35]
  v_pk_add_f32 v[12:13], v[12:13], v[36:37]
  v_pk_add_f32 v[12:13], v[12:13], v[38:39]
  v_pk_add_f32 v[12:13], v[12:13], v[40:41]
  v_pk_add_f32 v[12:13], v[12:13], v[42:43]
  v_pk_add_f32 v[12:13], v[12:13], v[44:45]
  v_pk_add_f32 v[12:13], v[12:13], v[46:47]
  v_pk_add_f32 v[12:13], v[12:13], v[48:49]
  v_pk_add_f32 v[12:13], v[12:13], v[50:51]
  v_pk_add_f32 v[12:13], v[12:13], v[52:53]
  v_pk_add_f32 v[12:13], v[12:13], v[54:55]
  v_pk_add_f32 v[12:13], v[12:13], v[56:57]
  v_pk_add_f32 v[12:13], v[12:13], v[58:59]
  v_pk_add_f32 v[12:13], v[12:13], v[60:61]
  v_pk_add_f32 v[12:13], v[12:13], v[62:63]
  v_pk_add_f32 v[12:13], v[12:13], v[64:65]
  v_pk_add_f32 v[12:13], v[12:13], v[66:67]
  v_pk_add_f32 v[12:13], v[12:13], v[68:69]
  v_pk_add_f32 v[12:13], v[12:13], v[70:71]
  v_pk_add_f32 v[12:13], v[12:13], v[72:73]
  v_pk_add_f32 v[12:13], v[12:13], v[74:75]
  v_pk_add_f32 v[12:13], v[12:13], v[76:77]
  v_pk_add_f32 v[12:13], v[12:13], v[78:79]
  v_pk_add_f32 v[12:13], v[12:13], v[80:81]
  v_pk_add_f32 v[12:13], v[12:13], v[82:83]
  v_pk_add_f32 v[12:13], v[12:13], v[84:85]
  v_pk_add_f32 v[12:13], v[12:13], v[86:87]
  v_pk_add_f32 v[12:13], v[12:13], v[88:89]
  v_pk_add_f32 v[12:13], v[12:13], v[90:91]
  v_pk_add_f32 v[12:13], v[12:13], v[92:93]
  v_pk_add_f32 v[12:13], v[12:13], v[94:95]
  v_add_f32 v12, v12, v13
  s_nop 1
  v_add_f32_dpp v12, v12, v12 row_ror:8 row_mask:0xf bank_mask:0xf
  v_mov_b32 v13, v12
  s_nop 1
  v_permlane16_swap_b32 v12, v13
  v_add_f32 v12, v12, v13
  v_mov_b32 v13, v12
  s_nop 1
  v_permlane32_swap_b32 v12, v13
  v_add_f32 v12, v12, v13
  v_mul_f32 v12, 0xbacccccd, v12
  v_mov_b32 v13, v12
  v_pk_add_f32 v[16:17], v[16:17], v[12:13]
  v_pk_add_f32 v[18:19], v[18:19], v[12:13]
  v_pk_add_f32 v[20:21], v[20:21], v[12:13]
  v_pk_add_f32 v[22:23], v[22:23], v[12:13]
  v_pk_add_f32 v[24:25], v[24:25], v[12:13]
  v_pk_add_f32 v[26:27], v[26:27], v[12:13]
  v_pk_add_f32 v[28:29], v[28:29], v[12:13]
  v_pk_add_f32 v[30:31], v[30:31], v[12:13]
  v_pk_add_f32 v[32:33], v[32:33], v[12:13]
  v_pk_add_f32 v[34:35], v[34:35], v[12:13]
  v_pk_add_f32 v[36:37], v[36:37], v[12:13]
  v_pk_add_f32 v[38:39], v[38:39], v[12:13]
  v_pk_add_f32 v[40:41], v[40:41], v[12:13]
  v_pk_add_f32 v[42:43], v[42:43], v[12:13]
  v_pk_add_f32 v[44:45], v[44:45], v[12:13]
  v_pk_add_f32 v[46:47], v[46:47], v[12:13]
  v_pk_add_f32 v[48:49], v[48:49], v[12:13]
  v_pk_add_f32 v[50:51], v[50:51], v[12:13]
  v_pk_add_f32 v[52:53], v[52:53], v[12:13]
  v_pk_add_f32 v[54:55], v[54:55], v[12:13]
  v_pk_add_f32 v[56:57], v[56:57], v[12:13]
  v_pk_add_f32 v[58:59], v[58:59], v[12:13]
  v_pk_add_f32 v[60:61], v[60:61], v[12:13]
  v_pk_add_f32 v[62:63], v[62:63], v[12:13]
  v_pk_add_f32 v[64:65], v[64:65], v[12:13]
  v_pk_add_f32 v[66:67], v[66:67], v[12:13]
  v_pk_add_f32 v[68:69], v[68:69], v[12:13]
  v_pk_add_f32 v[70:71], v[70:71], v[12:13]
  v_pk_add_f32 v[72:73], v[72:73], v[12:13]
  v_pk_add_f32 v[74:75], v[74:75], v[12:13]
  v_pk_add_f32 v[76:77], v[76:77], v[12:13]
  v_pk_add_f32 v[78:79], v[78:79], v[12:13]
  v_pk_add_f32 v[80:81], v[80:81], v[12:13]
  v_pk_add_f32 v[82:83], v[82:83], v[12:13]
  v_pk_add_f32 v[84:85], v[84:85], v[12:13]
  v_pk_add_f32 v[86:87], v[86:87], v[12:13]
  v_pk_add_f32 v[88:89], v[88:89], v[12:13]
  v_pk_add_f32 v[90:91], v[90:91], v[12:13]
  v_pk_add_f32 v[92:93], v[92:93], v[12:13]
  v_pk_add_f32 v[94:95], v[94:95], v[12:13]
  v_pk_mul_f32 v[12:13], v[16:17], v[16:17]
  v_pk_fma_f32 v[12:13], v[18:19], v[18:19], v[12:13]
  v_pk_fma_f32 v[12:13], v[20:21], v[20:21], v[12:13]
  v_pk_fma_f32 v[12:13], v[22:23], v[22:23], v[12:13]
  v_pk_fma_f32 v[12:13], v[24:25], v[24:25], v[12:13]
  v_pk_fma_f32 v[12:13], v[26:27], v[26:27], v[12:13]
  v_pk_fma_f32 v[12:13], v[28:29], v[28:29], v[12:13]
  v_pk_fma_f32 v[12:13], v[30:31], v[30:31], v[12:13]
  v_pk_fma_f32 v[12:13], v[32:33], v[32:33], v[12:13]
  v_pk_fma_f32 v[12:13], v[34:35], v[34:35], v[12:13]
  v_pk_fma_f32 v[12:13], v[36:37], v[36:37], v[12:13]
  v_pk_fma_f32 v[12:13], v[38:39], v[38:39], v[12:13]
  v_pk_fma_f32 v[12:13], v[40:41], v[40:41], v[12:13]
  v_pk_fma_f32 v[12:13], v[42:43], v[42:43], v[12:13]
  v_pk_fma_f32 v[12:13], v[44:45], v[44:45], v[12:13]
  v_pk_fma_f32 v[12:13], v[46:47], v[46:47], v[12:13]
  v_pk_fma_f32 v[12:13], v[48:49], v[48:49], v[12:13]
  v_pk_fma_f32 v[12:13], v[50:51], v[50:51], v[12:13]
  v_pk_fma_f32 v[12:13], v[52:53], v[52:53], v[12:13]
  v_pk_fma_f32 v[12:13], v[54:55], v[54:55], v[12:13]
  v_pk_fma_f32 v[12:13], v[56:57], v[56:57], v[12:13]
  v_pk_fma_f32 v[12:13], v[58:59], v[58:59], v[12:13]
  v_pk_fma_f32 v[12:13], v[60:61], v[60:61], v[12:13]
  v_pk_fma_f32 v[12:13], v[62:63], v[62:63], v[12:13]
  v_pk_fma_f32 v[12:13], v[64:65], v[64:65], v[12:13]
  v_pk_fma_f32 v[12:13], v[66:67], v[66:67], v[12:13]
  v_pk_fma_f32 v[12:13], v[68:69], v[68:69], v[12:13]
  v_pk_fma_f32 v[12:13], v[70:71], v[70:71], v[12:13]
  v_pk_fma_f32 v[12:13], v[72:73], v[72:73], v[12:13]
  v_pk_fma_f32 v[12:13], v[74:75], v[74:75], v[12:13]
  v_pk_fma_f32 v[12:13], v[76:77], v[76:77], v[12:13]
  v_pk_fma_f32 v[12:13], v[78:79], v[78:79], v[12:13]
  v_pk_fma_f32 v[12:13], v[80:81], v[80:81], v[12:13]
  v_pk_fma_f32 v[12:13], v[82:83], v[82:83], v[12:13]
  v_pk_fma_f32 v[12:13], v[84:85], v[84:85], v[12:13]
  v_pk_fma_f32 v[12:13], v[86:87], v[86:87], v[12:13]
  v_pk_fma_f32 v[12:13], v[88:89], v[88:89], v[12:13]
  v_pk_fma_f32 v[12:13], v[90:91], v[90:91], v[12:13]
  v_pk_fma_f32 v[12:13], v[92:93], v[92:93], v[12:13]
  v_pk_fma_f32 v[12:13], v[94:95], v[94:95], v[12:13]
  v_add_f32 v12, v12, v13
  s_nop 1
  v_add_f32_dpp v12, v12, v12 row_ror:8 row_mask:0xf bank_mask:0xf
  v_mov_b32 v13, v12
  s_nop 1
  v_permlane16_swap_b32 v12, v13
  v_add_f32 v12, v12, v13
  v_mov_b32 v13, v12
  s_nop 1
  v_permlane32_swap_b32 v12, v13
  v_add_f32 v12, v12, v13
  v_mov_b32 v13, 0x3727c5ac
  v_fmac_f32 v13, 0x3acccccd, v12
  v_rsq_f32 v12, v13
  s_nop 0
  v_mov_b32 v13, v12
  v_pk_mul_f32 v[16:17], v[16:17], v[12:13]
  v_pk_mul_f32 v[18:19], v[18:19], v[12:13]
  v_pk_mul_f32 v[20:21], v[20:21], v[12:13]
  v_pk_mul_f32 v[22:23], v[22:23], v[12:13]
  v_pk_mul_f32 v[24:25], v[24:25], v[12:13]
  v_pk_mul_f32 v[26:27], v[26:27], v[12:13]
  v_pk_mul_f32 v[28:29], v[28:29], v[12:13]
  v_pk_mul_f32 v[30:31], v[30:31], v[12:13]
  v_pk_mul_f32 v[32:33], v[32:33], v[12:13]
  v_pk_mul_f32 v[34:35], v[34:35], v[12:13]
  v_pk_mul_f32 v[36:37], v[36:37], v[12:13]
  v_pk_mul_f32 v[38:39], v[38:39], v[12:13]
  v_pk_mul_f32 v[40:41], v[40:41], v[12:13]
  v_pk_mul_f32 v[42:43], v[42:43], v[12:13]
  v_pk_mul_f32 v[44:45], v[44:45], v[12:13]
  v_pk_mul_f32 v[46:47], v[46:47], v[12:13]
  v_pk_mul_f32 v[48:49], v[48:49], v[12:13]
  v_pk_mul_f32 v[50:51], v[50:51], v[12:13]
  v_pk_mul_f32 v[52:53], v[52:53], v[12:13]
  v_pk_mul_f32 v[54:55], v[54:55], v[12:13]
  v_pk_mul_f32 v[56:57], v[56:57], v[12:13]
  v_pk_mul_f32 v[58:59], v[58:59], v[12:13]
  v_pk_mul_f32 v[60:61], v[60:61], v[12:13]
  v_pk_mul_f32 v[62:63], v[62:63], v[12:13]
  v_pk_mul_f32 v[64:65], v[64:65], v[12:13]
  v_pk_mul_f32 v[66:67], v[66:67], v[12:13]
  v_pk_mul_f32 v[68:69], v[68:69], v[12:13]
  v_pk_mul_f32 v[70:71], v[70:71], v[12:13]
  v_pk_mul_f32 v[72:73], v[72:73], v[12:13]
  v_pk_mul_f32 v[74:75], v[74:75], v[12:13]
  v_pk_mul_f32 v[76:77], v[76:77], v[12:13]
  v_pk_mul_f32 v[78:79], v[78:79], v[12:13]
  v_pk_mul_f32 v[80:81], v[80:81], v[12:13]
  v_pk_mul_f32 v[82:83], v[82:83], v[12:13]
  v_pk_mul_f32 v[84:85], v[84:85], v[12:13]
  v_pk_mul_f32 v[86:87], v[86:87], v[12:13]
  v_pk_mul_f32 v[88:89], v[88:89], v[12:13]
  v_pk_mul_f32 v[90:91], v[90:91], v[12:13]
  v_pk_mul_f32 v[92:93], v[92:93], v[12:13]
  v_pk_mul_f32 v[94:95], v[94:95], v[12:13]
  v_cvt_pk_bf16_f32 v16, v16, v17
  v_cvt_pk_bf16_f32 v17, v18, v19
  v_cvt_pk_bf16_f32 v18, v20, v21
  v_cvt_pk_bf16_f32 v19, v22, v23
  v_cvt_pk_bf16_f32 v20, v24, v25
  v_cvt_pk_bf16_f32 v21, v26, v27
  v_cvt_pk_bf16_f32 v22, v28, v29
  v_cvt_pk_bf16_f32 v23, v30, v31
  v_cvt_pk_bf16_f32 v24, v32, v33
  v_cvt_pk_bf16_f32 v25, v34, v35
  v_cvt_pk_bf16_f32 v26, v36, v37
  v_cvt_pk_bf16_f32 v27, v38, v39
  v_cvt_pk_bf16_f32 v28, v40, v41
  v_cvt_pk_bf16_f32 v29, v42, v43
  v_cvt_pk_bf16_f32 v30, v44, v45
  v_cvt_pk_bf16_f32 v31, v46, v47
  v_cvt_pk_bf16_f32 v32, v48, v49
  v_cvt_pk_bf16_f32 v33, v50, v51
  v_cvt_pk_bf16_f32 v34, v52, v53
  v_cvt_pk_bf16_f32 v35, v54, v55
  v_cvt_pk_bf16_f32 v36, v56, v57
  v_cvt_pk_bf16_f32 v37, v58, v59
  v_cvt_pk_bf16_f32 v38, v60, v61
  v_cvt_pk_bf16_f32 v39, v62, v63
  v_cvt_pk_bf16_f32 v40, v64, v65
  v_cvt_pk_bf16_f32 v41, v66, v67
  v_cvt_pk_bf16_f32 v42, v68, v69
  v_cvt_pk_bf16_f32 v43, v70, v71
  v_cvt_pk_bf16_f32 v44, v72, v73
  v_cvt_pk_bf16_f32 v45, v74, v75
  v_cvt_pk_bf16_f32 v46, v76, v77
  v_cvt_pk_bf16_f32 v47, v78, v79
  v_cvt_pk_bf16_f32 v48, v80, v81
  v_cvt_pk_bf16_f32 v49, v82, v83
  v_cvt_pk_bf16_f32 v50, v84, v85
  v_cvt_pk_bf16_f32 v51, v86, v87
  v_cvt_pk_bf16_f32 v52, v88, v89
  v_cvt_pk_bf16_f32 v53, v90, v91
  v_cvt_pk_bf16_f32 v54, v92, v93
  v_cvt_pk_bf16_f32 v55, v94, v95
  s_mul_i32 s48, s46, 40960
  s_add_u32 s48, s48, s47
  s_add_u32 s48, s48, 0x100000
  s_add_u32 s49, s48, 0
  buffer_store_dwordx4 v[16:19], v10, s[8:11], s49 offen sc1
  s_add_u32 s49, s48, 4096
  buffer_store_dwordx4 v[20:23], v10, s[8:11], s49 offen sc1
  s_add_u32 s49, s48, 8192
  buffer_store_dwordx4 v[24:27], v10, s[8:11], s49 offen sc1
  s_add_u32 s49, s48, 12288
  buffer_store_dwordx4 v[28:31], v10, s[8:11], s49 offen sc1
  s_add_u32 s49, s48, 16384
  buffer_store_dwordx4 v[32:35], v10, s[8:11], s49 offen sc1
  s_add_u32 s49, s48, 20480
  buffer_store_dwordx4 v[36:39], v10, s[8:11], s49 offen sc1
  s_add_u32 s49, s48, 24576
  buffer_store_dwordx4 v[40:43], v10, s[8:11], s49 offen sc1
  s_add_u32 s49, s48, 28672
  buffer_store_dwordx4 v[44:47], v10, s[8:11], s49 offen sc1
  s_add_u32 s49, s48, 32768
  buffer_store_dwordx4 v[48:51], v10, s[8:11], s49 offen sc1
  s_add_u32 s49, s48, 36864
  buffer_store_dwordx4 v[52:55], v10, s[8:11], s49 offen sc1
lnu_49_x:
  s_cmp_eq_u32 s21, 0
  s_cbranch_scc0 ka_cen_done
  s_mov_b64 s[24:25], exec
  s_mov_b64 exec, 1
  v_mov_b32 v3, 1
  s_lshl_b32 s27, s26, 7
  s_add_u32 s27, s27, 0x2000
  v_mov_b32 v4, 0
  buffer_atomic_add v3, v4, s[8:11], s27 offen sc0
  s_mov_b64 exec, 0xffff
  v_lshlrev_b32 v4, 7, v0
  s_mov_b32 s27, 0x2000
  s_mov_b32 s45, 0
  s_waitcnt vmcnt(0)
  v_mov_b32 v5, v3
ka_cen_spin:
  buffer_load_dword v7, v4, s[8:11], s27 offen sc1
  s_add_u32 s45, s45, 1
  s_waitcnt vmcnt(0)
  v_add_u32_dpp v8, v7, v7 quad_perm:[1,0,3,2] row_mask:0xf bank_mask:0xf
  s_nop 1
  v_add_u32_dpp v9, v8, v8 quad_perm:[2,3,0,1] row_mask:0xf bank_mask:0xf
  s_nop 1
  v_add_u32_dpp v8, v9, v9 row_half_mirror row_mask:0xf bank_mask:0xf
  s_nop 1
  v_add_u32_dpp v9, v8, v8 row_mirror row_mask:0xf bank_mask:0xf
  s_nop 0
  v_readfirstlane_b32 s28, v9
  s_cmp_ge_u32 s28, 256
  s_cbranch_scc1 ka_cen_ok
  s_cmp_lt_u32 s45, 400000
  s_cbranch_scc1 ka_cen_spin
ka_cen_ok:
  v_cmp_gt_u32 vcc, s26, v0
  s_nop 1
  v_cndmask_b32 v8, 0, v7, vcc
  s_nop 1
  v_add_u32_dpp v9, v8, v8 quad_perm:[1,0,3,2] row_mask:0xf bank_mask:0xf
  s_nop 1
  v_add_u32_dpp v8, v9, v9 quad_perm:[2,3,0,1] row_mask:0xf bank_mask:0xf
  s_nop 1
  v_add_u32_dpp v9, v8, v8 row_half_mirror row_mask:0xf bank_mask:0xf
  s_nop 1
  v_add_u32_dpp v8, v9, v9 row_mirror row_mask:0xf bank_mask:0xf
  v_add_u32 v6, v8, v5
  s_mov_b64 exec, 0xff
  v_cmp_ne_u32 vcc, 32, v7
  s_nop 1
  s_cmp_eq_u64 vcc, 0
  s_cselect_b32 s27, 1, 0
  s_cmp_ge_u32 s27, 1
  s_cselect_b32 s27, 1, 0
  s_mov_b64 exec, 1
  v_mov_b32 v8, s27
  v_mov_b32 v4, 0
  v_mov_b32 v9, 0
  ds_write_b128 v4, v[6:9]
  ds_write_b32 v4, v5 offset:16
  s_waitcnt lgkmcnt(0)
  s_mov_b64 exec, s[24:25]
ka_cen_done:
  s_barrier
  v_mov_b32 v4, 0
  ds_read_b128 v[6:9], v4
  ds_read_b32 v5, v4 offset:16
  s_waitcnt lgkmcnt(0)
  v_readfirstlane_b32 s27, v6
  v_readfirstlane_b32 s44, v8
  v_readfirstlane_b32 s28, v5
  s_barrier
  s_cmp_eq_u32 s44, 1
  s_cbranch_scc1 ka_cen_fast
  s_lshr_b32 s20, s27, 5
  s_and_b32 s22, s27, 31
  s_branch ka_cen_end
ka_cen_fast:
  s_mov_b32 s20, s26
  s_mov_b32 s22, s28
ka_cen_end:
  s_and_b32 s20, s20, 7
  s_and_b32 s22, s22, 31
  s_cmp_lt_u32 s20, 4
  s_cbranch_scc0 ka_bulk
  s_cmp_lt_u32 s22, 8
  s_cbranch_scc0 ka_noty
  s_lshl_b32 s23, s20, 3
  s_add_u32 s23, s23, s22
  s_cmp_eq_u32 s44, 1
  s_cbranch_scc1 kaf_x
  s_branch kas_x
ka_noty:
  s_cmp_lt_u32 s22, 28
  s_cbranch_scc0 ka_spare
  s_sub_u32 s23, s22, 8
  s_cmp_eq_u32 s44, 1
  s_cbranch_scc1 kaf_y
  s_branch kas_y
ka_bulk:
  s_sub_u32 s28, s20, 4
  s_lshl_b32 s23, s22, 2
  s_add_u32 s23, s23, s28
  s_cmp_lt_u32 s23, 72
  s_cbranch_scc1 ka_qkv
  s_sub_u32 s23, s23, 72
  s_cmp_lt_u32 s23, 32
  s_cbranch_scc1 ka_u
  s_sub_u32 s23, s23, 32
  s_branch ka_ln
ka_ln:
  v_and_b32 v1, 63, v0
  s_lshl_b32 s46, s23, 2
  s_add_u32 s46, s46, s21
  v_and_b32 v5, 7, v1
  v_bfe_u32 v6, v1, 3, 1
  v_lshrrev_b32 v7, 4, v1
  v_lshlrev_b32 v8, 5, v6
  v_add_u32 v8, v8, v5
  v_lshlrev_b32 v8, 4, v8
  v_lshlrev_b32 v9, 11, v7
  v_add_u32 v9, v9, v8
  v_lshlrev_b32 v10, 10, v7
  v_add_u32 v10, v10, v8
  v_mul_u32_u24 v11, 1280, v5
  v_lshlrev_b32 v12, 5, v7
  v_add_u32 v11, v11, v12
  v_lshlrev_b32 v12, 4, v6
  v_add_u32 v11, v11, v12
  s_load_dwordx2 s[36:37], s[0:1], 0
  s_load_dwordx4 s[40:43], s[0:1], 64
  s_waitcnt lgkmcnt(0)
  s_mov_b32 s12, s36
  s_and_b32 s13, s37, 0xffff
  s_mov_b32 s14, 0x280000
  s_mov_b32 s15, 0x20000

  s_cmp_eq_u32 s21, 3
  s_cbranch_scc0 lna_50
  s_waitcnt vmcnt(0)
  s_mov_b64 s[24:25], exec
  s_mov_b64 exec, 1
  v_mov_b32 v2, 4992
  v_mov_b32 v3, 1
  buffer_atomic_add v3, v2, s[8:11], 0 offen
  s_mov_b64 exec, s[24:25]
lna_50:
  s_cmp_eq_u32 s99, 0
  s_cbranch_scc0 ka_lnx
  s_mov_b32 s12, s42
  s_and_b32 s13, s43, 0xffff
  s_mov_b32 s14, 0xc8000
  s_mov_b32 s15, 0x20000
  s_mov_b32 s16, s40
  s_and_b32 s17, s41, 0xffff
  s_mov_b32 s18, 0x258000
  s_mov_b32 s19, 0x20000
  v_lshlrev_b32 v2, 4, v1
  v_and_b32 v8, 31, v1
  v_lshrrev_b32 v9, 5, v1
  v_lshrrev_b32 v10, 4, v8
  v_lshlrev_b32 v10, 4, v10
  v_bfe_u32 v11, v8, 2, 1
  v_lshlrev_b32 v11, 3, v11
  v_add_u32 v10, v10, v11
  v_bfe_u32 v11, v8, 3, 1
  v_lshlrev_b32 v11, 2, v11
  v_add_u32 v10, v10, v11
  v_and_b32 v11, 3, v8
  v_add_u32 v10, v10, v11
  v_mul_u32_u24 v12, 30720, v9
  v_lshlrev_b32 v13, 1, v10
  v_add_u32 v13, v13, v12
  v_lshlrev_b32 v14, 1, v8
  v_add_u32 v14, v14, v12
  v_cmp_gt_u32 s[50:51], 20, v10
  v_cmp_gt_u32 s[52:53], 20, v8
  v_lshrrev_b32 v15, 4, v1
  v_mul_u32_u24 v15, 10240, v15
  v_and_b32 v16, 15, v1
  v_lshlrev_b32 v16, 1, v16
  v_add_u32 v15, v15, v16
  s_mov_b32 s46, s23
ka_gl:
  s_barrier
  s_cmp_lt_u32 s46, 40
  s_cbranch_scc0 ka_gwo
  s_mul_i32 s28, s46, 61440
  s_lshl_b32 s29, s21, 10
  s_add_u32 s29, s29, 0
  s_mov_b32 m0, s29
  s_add_u32 s30, s28, s29
  buffer_load_dwordx4 v2, s[16:19], s30 offen lds
  s_lshl_b32 s29, s21, 10
  s_add_u32 s29, s29, 4096
  s_mov_b32 m0, s29
  s_add_u32 s30, s28, s29
  buffer_load_dwordx4 v2, s[16:19], s30 offen lds
  s_lshl_b32 s29, s21, 10
  s_add_u32 s29, s29, 8192
  s_mov_b32 m0, s29
  s_add_u32 s30, s28, s29
  buffer_load_dwordx4 v2, s[16:19], s30 offen lds
  s_lshl_b32 s29, s21, 10
  s_add_u32 s29, s29, 12288
  s_mov_b32 m0, s29
  s_add_u32 s30, s28, s29
  buffer_load_dwordx4 v2, s[16:19], s30 offen lds
  s_lshl_b32 s29, s21, 10
  s_add_u32 s29, s29, 16384
  s_mov_b32 m0, s29
  s_add_u32 s30, s28, s29
  buffer_load_dwordx4 v2, s[16:19], s30 offen lds
  s_lshl_b32 s29, s21, 10
  s_add_u32 s29, s29, 20480
  s_mov_b32 m0, s29
  s_add_u32 s30, s28, s29
  buffer_load_dwordx4 v2, s[16:19], s30 offen lds
  s_lshl_b32 s29, s21, 10
  s_add_u32 s29, s29, 24576
  s_mov_b32 m0, s29
  s_add_u32 s30, s28, s29
  buffer_load_dwordx4 v2, s[16:19], s30 offen lds
  s_lshl_b32 s29, s21, 10
  s_add_u32 s29, s29, 28672
  s_mov_b32 m0, s29
  s_add_u32 s30, s28, s29
  buffer_load_dwordx4 v2, s[16:19], s30 offen lds
  s_lshl_b32 s29, s21, 10
  s_add_u32 s29, s29, 32768
  s_mov_b32 m0, s29
  s_add_u32 s30, s28, s29
  buffer_load_dwordx4 v2, s[16:19], s30 offen lds
  s_lshl_b32 s29, s21, 10
  s_add_u32 s29, s29, 36864
  s_mov_b32 m0, s29
  s_add_u32 s30, s28, s29
  buffer_load_dwordx4 v2, s[16:19], s30 offen lds
  s_lshl_b32 s29, s21, 10
  s_add_u32 s29, s29, 40960
  s_mov_b32 m0, s29
  s_add_u32 s30, s28, s29
  buffer_load_dwordx4 v2, s[16:19], s30 offen lds
  s_lshl_b32 s29, s21, 10
  s_add_u32 s29, s29, 45056
  s_mov_b32 m0, s29
  s_add_u32 s30, s28, s29
  buffer_load_dwordx4 v2, s[16:19], s30 offen lds
  s_lshl_b32 s29, s21, 10
  s_add_u32 s29, s29, 49152
  s_mov_b32 m0, s29
  s_add_u32 s30, s28, s29
  buffer_load_dwordx4 v2, s[16:19], s30 offen lds
  s_lshl_b32 s29, s21, 10
  s_add_u32 s29, s29, 53248
  s_mov_b32 m0, s29
  s_add_u32 s30, s28, s29
  buffer_load_dwordx4 v2, s[16:19], s30 offen lds
  s_lshl_b32 s29, s21, 10
  s_add_u32 s29, s29, 57344
  s_mov_b32 m0, s29
  s_add_u32 s30, s28, s29
  buffer_load_dwordx4 v2, s[16:19], s30 offen lds
  s_waitcnt vmcnt(0)
  s_barrier
  s_lshl_b32 s47, s21, 3
ka_gh:
  s_mul_i32 s28, s47, 40
  s_add_u32 s28, s28, 0
  v_add_u32 v17, s28, v13
  ds_read_u16 v20, v17 offset:0
  ds_read_u16 v21, v17 offset:3840
  ds_read_u16 v22, v17 offset:7680
  ds_read_u16 v23, v17 offset:11520
  ds_read_u16 v24, v17 offset:15360
  ds_read_u16 v25, v17 offset:19200
  ds_read_u16 v26, v17 offset:23040
  ds_read_u16 v27, v17 offset:26880
  s_waitcnt lgkmcnt(0)
  v_lshl_or_b32 v28, v21, 16, v20
  v_cndmask_b32 v28, 0, v28, s[50:51]
  v_lshl_or_b32 v29, v23, 16, v22
  v_cndmask_b32 v29, 0, v29, s[50:51]
  v_lshl_or_b32 v30, v25, 16, v24
  v_cndmask_b32 v30, 0, v30, s[50:51]
  v_lshl_or_b32 v31, v27, 16, v26
  v_cndmask_b32 v31, 0, v31, s[50:51]
  s_mul_i32 s28, s47, 3
  s_add_u32 s28, s28, 0
  s_mul_i32 s28, s28, 40
  s_add_u32 s28, s28, s46
  s_lshl_b32 s28, s28, 10
  s_add_u32 s28, s28, 0xe100000
  buffer_store_dwordx4 v[28:31], v2, s[8:11], s28 offen
  s_nop 1
  s_mul_i32 s28, s47, 40
  s_add_u32 s28, s28, 1280
  v_add_u32 v17, s28, v13
  ds_read_u16 v20, v17 offset:0
  ds_read_u16 v21, v17 offset:3840
  ds_read_u16 v22, v17 offset:7680
  ds_read_u16 v23, v17 offset:11520
  ds_read_u16 v24, v17 offset:15360
  ds_read_u16 v25, v17 offset:19200
  ds_read_u16 v26, v17 offset:23040
  ds_read_u16 v27, v17 offset:26880
  s_waitcnt lgkmcnt(0)
  v_lshl_or_b32 v28, v21, 16, v20
  v_cndmask_b32 v28, 0, v28, s[50:51]
  v_lshl_or_b32 v29, v23, 16, v22
  v_cndmask_b32 v29, 0, v29, s[50:51]
  v_lshl_or_b32 v30, v25, 16, v24
  v_cndmask_b32 v30, 0, v30, s[50:51]
  v_lshl_or_b32 v31, v27, 16, v26
  v_cndmask_b32 v31, 0, v31, s[50:51]
  s_mul_i32 s28, s47, 3
  s_add_u32 s28, s28, 1
  s_mul_i32 s28, s28, 40
  s_add_u32 s28, s28, s46
  s_lshl_b32 s28, s28, 10
  s_add_u32 s28, s28, 0xe100000
  buffer_store_dwordx4 v[28:31], v2, s[8:11], s28 offen
  s_nop 1
  s_mul_i32 s28, s47, 40
  s_add_u32 s28, s28, 2560
  v_add_u32 v17, s28, v14
  ds_read_u16 v20, v17 offset:0
  ds_read_u16 v21, v17 offset:3840
  ds_read_u16 v22, v17 offset:7680
  ds_read_u16 v23, v17 offset:11520
  ds_read_u16 v24, v17 offset:15360
  ds_read_u16 v25, v17 offset:19200
  ds_read_u16 v26, v17 offset:23040
  ds_read_u16 v27, v17 offset:26880
  s_waitcnt lgkmcnt(0)
  v_lshl_or_b32 v28, v21, 16, v20
  v_cndmask_b32 v28, 0, v28, s[52:53]
  v_lshl_or_b32 v29, v23, 16, v22
  v_cndmask_b32 v29, 0, v29, s[52:53]
  v_lshl_or_b32 v30, v25, 16, v24
  v_cndmask_b32 v30, 0, v30, s[52:53]
  v_lshl_or_b32 v31, v27, 16, v26
  v_cndmask_b32 v31, 0, v31, s[52:53]
  s_mul_i32 s28, s47, 3
  s_add_u32 s28, s28, 2
  s_mul_i32 s28, s28, 40
  s_add_u32 s28, s28, s46
  s_lshl_b32 s28, s28, 10
  s_add_u32 s28, s28, 0xe100000
  buffer_store_dwordx4 v[28:31], v2, s[8:11], s28 offen
  s_nop 1
  s_add_u32 s47, s47, 1
  s_and_b32 s28, s47, 7
  s_cmp_lg_u32 s28, 0
  s_cbranch_scc1 ka_gh
  s_branch ka_gn
ka_gwo:
  s_sub_u32 s48, s46, 40
  s_mul_i32 s28, s48, 40960
  s_lshl_b32 s29, s21, 10
  s_add_u32 s29, s29, 0
  s_mov_b32 m0, s29
  s_add_u32 s30, s28, s29
  buffer_load_dwordx4 v2, s[12:15], s30 offen lds
  s_lshl_b32 s29, s21, 10
  s_add_u32 s29, s29, 4096
  s_mov_b32 m0, s29
  s_add_u32 s30, s28, s29
  buffer_load_dwordx4 v2, s[12:15], s30 offen lds
  s_lshl_b32 s29, s21, 10
  s_add_u32 s29, s29, 8192
  s_mov_b32 m0, s29
  s_add_u32 s30, s28, s29
  buffer_load_dwordx4 v2, s[12:15], s30 offen lds
  s_lshl_b32 s29, s21, 10
  s_add_u32 s29, s29, 12288
  s_mov_b32 m0, s29
  s_add_u32 s30, s28, s29
  buffer_load_dwordx4 v2, s[12:15], s30 offen lds
  s_lshl_b32 s29, s21, 10
  s_add_u32 s29, s29, 16384
  s_mov_b32 m0, s29
  s_add_u32 s30, s28, s29
  buffer_load_dwordx4 v2, s[12:15], s30 offen lds
  s_lshl_b32 s29, s21, 10
  s_add_u32 s29, s29, 20480
  s_mov_b32 m0, s29
  s_add_u32 s30, s28, s29
  buffer_load_dwordx4 v2, s[12:15], s30 offen lds
  s_lshl_b32 s29, s21, 10
  s_add_u32 s29, s29, 24576
  s_mov_b32 m0, s29
  s_add_u32 s30, s28, s29
  buffer_load_dwordx4 v2, s[12:15], s30 offen lds
  s_lshl_b32 s29, s21, 10
  s_add_u32 s29, s29, 28672
  s_mov_b32 m0, s29
  s_add_u32 s30, s28, s29
  buffer_load_dwordx4 v2, s[12:15], s30 offen lds
  s_lshl_b32 s29, s21, 10
  s_add_u32 s29, s29, 32768
  s_mov_b32 m0, s29
  s_add_u32 s30, s28, s29
  buffer_load_dwordx4 v2, s[12:15], s30 offen lds
  s_lshl_b32 s29, s21, 10
  s_add_u32 s29, s29, 36864
  s_mov_b32 m0, s29
  s_add_u32 s30, s28, s29
  buffer_load_dwordx4 v2, s[12:15], s30 offen lds
  s_waitcnt vmcnt(0)
  s_barrier
  s_mul_i32 s47, s21, 10
  s_add_u32 s49, s47, 10
ka_gc:
  s_lshl_b32 s28, s47, 5
  v_add_u32 v17, s28, v15
  ds_read_u16 v20, v17 offset:0
  ds_read_u16 v21, v17 offset:1280
  ds_read_u16 v22, v17 offset:2560
  ds_read_u16 v23, v17 offset:3840
  ds_read_u16 v24, v17 offset:5120
  ds_read_u16 v25, v17 offset:6400
  ds_read_u16 v26, v17 offset:7680
  ds_read_u16 v27, v17 offset:8960
  s_waitcnt lgkmcnt(0)
  v_lshl_or_b32 v28, v21, 16, v20
  v_lshl_or_b32 v29, v23, 16, v22
  v_lshl_or_b32 v30, v25, 16, v24
  v_lshl_or_b32 v31, v27, 16, v26
  s_mul_i32 s28, s47, 20
  s_add_u32 s28, s28, s48
  s_lshl_b32 s28, s28, 10
  s_add_u32 s28, s28, 0xe000000
  buffer_store_dwordx4 v[28:31], v2, s[8:11], s28 offen
  s_add_u32 s47, s47, 1
  s_cmp_lt_u32 s47, s49
  s_cbranch_scc1 ka_gc
ka_gn:
  s_add_u32 s46, s46, 24
  s_cmp_lt_u32 s46, 60
  s_cbranch_scc1 ka_gl
ka_lnx:
  s_waitcnt vmcnt(0)
  s_branch ka_exit
ka_spare:
  s_cmp_eq_u32 s21, 3
  s_cbranch_scc0 lna_51
  s_waitcnt vmcnt(0)
  s_mov_b64 s[24:25], exec
  s_mov_b64 exec, 1
  v_mov_b32 v2, 4992
  v_mov_b32 v3, 1
  buffer_atomic_add v3, v2, s[8:11], 0 offen
  s_mov_b64 exec, s[24:25]
lna_51:
ka_pf:
  v_and_b32 v1, 63, v0
  v_lshlrev_b32 v4, 6, v1
  s_sub_u32 s46, s22, 28
  s_lshl_b32 s46, s46, 2
  s_add_u32 s46, s46, s21
  s_mul_i32 s28, s20, 24
  v_and_b32 v5, 15, v1
  v_min_u32 v5, 11, v5
  v_cmp_le_u32 vcc, 6, v5
  v_subrev_u32 v6, 6, v5
  v_mov_b32 v7, 0x400
  v_cndmask_b32 v5, v5, v6, vcc
  v_cndmask_b32 v7, 0, v7, vcc
  v_lshlrev_b32 v5, 2, v5
  v_add_u32 v5, v5, v7
  s_add_u32 s28, s28, 0
  v_add_u32 v5, s28, v5
  v_and_b32 v6, 7, v1
  v_lshlrev_b32 v6, 2, v6
  s_lshl_b32 s28, s20, 5
  s_add_u32 s28, s28, 3072
  v_add_u32 v6, s28, v6
  s_mul_i32 s47, s20, 327680
  s_mul_i32 s28, s46, 20480
  s_add_u32 s47, s47, s28
  s_add_u32 s47, s47, 0x9000000
  s_mul_i32 s28, s46, 3
  s_add_u32 s28, s28, 0
  s_cmp_ge_u32 s28, 24
  s_cselect_b32 s29, 0x1800000, 0
  s_cselect_b32 s30, 24, 0
  s_sub_u32 s28, s28, s30
  s_mul_i32 s30, s28, 43
  s_lshr_b32 s30, s30, 7
  s_mul_i32 s31, s30, 3
  s_sub_u32 s31, s28, s31
  s_lshl_b32 s28, s20, 3
  s_add_u32 s30, s30, s28
  s_mul_i32 s30, s30, 786432
  s_lshl_b32 s31, s31, 12
  s_add_u32 s30, s30, s31
  s_add_u32 s30, s30, 0x4800000
  s_add_u32 s48, s30, s29
  s_mul_i32 s28, s46, 3
  s_add_u32 s28, s28, 1
  s_cmp_ge_u32 s28, 24
  s_cselect_b32 s29, 0x1800000, 0
  s_cselect_b32 s30, 24, 0
  s_sub_u32 s28, s28, s30
  s_mul_i32 s30, s28, 43
  s_lshr_b32 s30, s30, 7
  s_mul_i32 s31, s30, 3
  s_sub_u32 s31, s28, s31
  s_lshl_b32 s28, s20, 3
  s_add_u32 s30, s30, s28
  s_mul_i32 s30, s30, 786432
  s_lshl_b32 s31, s31, 12
  s_add_u32 s30, s30, s31
  s_add_u32 s30, s30, 0x4800000
  s_add_u32 s49, s30, s29
  s_mul_i32 s28, s46, 3
  s_add_u32 s28, s28, 2
  s_cmp_ge_u32 s28, 24
  s_cselect_b32 s29, 0x1800000, 0
  s_cselect_b32 s30, 24, 0
  s_sub_u32 s28, s28, s30
  s_mul_i32 s30, s28, 43
  s_lshr_b32 s30, s30, 7
  s_mul_i32 s31, s30, 3
  s_sub_u32 s31, s28, s31
  s_lshl_b32 s28, s20, 3
  s_add_u32 s30, s30, s28
  s_mul_i32 s30, s30, 786432
  s_lshl_b32 s31, s31, 12
  s_add_u32 s30, s30, s31
  s_add_u32 s30, s30, 0x4800000
  s_add_u32 s50, s30, s29
  s_mul_i32 s28, s20, 327680
  s_add_u32 s28, s28, 0x700000
  s_lshl_b32 s29, s46, 12
  s_add_u32 s51, s28, s29
  s_mov_b32 s52, 5120
  s_cmp_ge_u32 s46, 3
  s_cbranch_scc0 ka_pf1
  s_mul_i32 s28, s20, 655360
  s_add_u32 s28, s28, 0x402800
  s_sub_u32 s29, s46, 3
  s_lshl_b32 s29, s29, 12
  s_add_u32 s51, s28, s29
  s_mov_b32 s52, 10240
  s_cmp_ge_u32 s46, 6
  s_cbranch_scc0 ka_pf1
  s_mul_i32 s28, s20, 1310720
  s_add_u32 s28, s28, 0xe00000
  s_sub_u32 s29, s46, 6
  s_lshl_b32 s29, s29, 12
  s_add_u32 s51, s28, s29
  s_mov_b32 s52, 20480
ka_pf1:
  s_mul_i32 s53, s20, 655360
  s_add_u32 s53, s53, 0x400000
  s_mov_b32 s54, 0
  s_mov_b32 s55, 0
  s_mov_b32 s56, 0
  v_mov_b32 v7, 0
ka_pfl:
  s_cmp_gt_u32 s54, 3
  s_cbranch_scc0 ka_pfgo
  s_sub_u32 s28, s54, 3
  s_mul_i32 s28, s28, 10240
  s_add_u32 s28, s28, s53
  s_mov_b32 s45, 0
ka_pfw:
  buffer_load_dword v8, v7, s[8:11], s28 offen sc1
  s_add_u32 s45, s45, 1
  s_waitcnt vmcnt(0)
  v_readfirstlane_b32 s29, v8
  s_cmp_lg_u32 s29, -1
  s_cbranch_scc1 ka_pfgo
  s_sleep 4
  s_cmp_lt_u32 s45, 400000
  s_cbranch_scc1 ka_pfw
  s_branch ka_exit
ka_pfgo:
  s_cmp_eq_u32 s54, 6
  s_cbranch_scc0 ka_pfnm
  s_cmp_eq_u32 s20, 0
  s_cbranch_scc0 ka_pfnm
  s_cmp_eq_u32 s46, 15
  s_cbranch_scc0 ka_pfnm
  v_and_b32 v8, 7, v1
  v_lshlrev_b32 v8, 8, v8
  v_bfe_u32 v9, v1, 3, 1
  v_lshlrev_b32 v9, 13, v9
  v_add_u32 v8, v8, v9
  s_mov_b32 s28, 0xaa0000
  buffer_store_dword v7, v8, s[8:11], s28 offen sc1
  s_waitcnt vmcnt(0)
  s_mov_b64 s[24:25], exec
  s_mov_b64 exec, 1
  s_mov_b32 s30, -1
  s_mov_b32 s31, -1
  s_mov_b32 s28, 0xaa0000
  s_memtime s[32:33]
  s_waitcnt lgkmcnt(0)
  buffer_load_dword v9, v7, s[8:11], s28 offen sc1
  s_waitcnt vmcnt(0)
  s_memtime s[34:35]
  s_waitcnt lgkmcnt(0)
  s_sub_u32 s34, s34, s32
  s_min_u32 s30, s30, s34
  s_mov_b32 s28, 0xaa2000
  s_memtime s[32:33]
  s_waitcnt lgkmcnt(0)
  buffer_load_dword v9, v7, s[8:11], s28 offen sc1
  s_waitcnt vmcnt(0)
  s_memtime s[34:35]
  s_waitcnt lgkmcnt(0)
  s_sub_u32 s34, s34, s32
  s_min_u32 s31, s31, s34
  s_mov_b32 s28, 0xaa0100
  s_memtime s[32:33]
  s_waitcnt lgkmcnt(0)
  buffer_load_dword v9, v7, s[8:11], s28 offen sc1
  s_waitcnt vmcnt(0)
  s_memtime s[34:35]
  s_waitcnt lgkmcnt(0)
  s_sub_u32 s34, s34, s32
  s_min_u32 s30, s30, s34
  s_mov_b32 s28, 0xaa2100
  s_memtime s[32:33]
  s_waitcnt lgkmcnt(0)
  buffer_load_dword v9, v7, s[8:11], s28 offen sc1
  s_waitcnt vmcnt(0)
  s_memtime s[34:35]
  s_waitcnt lgkmcnt(0)
  s_sub_u32 s34, s34, s32
  s_min_u32 s31, s31, s34
  s_mov_b32 s28, 0xaa0200
  s_memtime s[32:33]
  s_waitcnt lgkmcnt(0)
  buffer_load_dword v9, v7, s[8:11], s28 offen sc1
  s_waitcnt vmcnt(0)
  s_memtime s[34:35]
  s_waitcnt lgkmcnt(0)
  s_sub_u32 s34, s34, s32
  s_min_u32 s30, s30, s34
  s_mov_b32 s28, 0xaa2200
  s_memtime s[32:33]
  s_waitcnt lgkmcnt(0)
  buffer_load_dword v9, v7, s[8:11], s28 offen sc1
  s_waitcnt vmcnt(0)
  s_memtime s[34:35]
  s_waitcnt lgkmcnt(0)
  s_sub_u32 s34, s34, s32
  s_min_u32 s31, s31, s34
  s_mov_b32 s28, 0xaa0300
  s_memtime s[32:33]
  s_waitcnt lgkmcnt(0)
  buffer_load_dword v9, v7, s[8:11], s28 offen sc1
  s_waitcnt vmcnt(0)
  s_memtime s[34:35]
  s_waitcnt lgkmcnt(0)
  s_sub_u32 s34, s34, s32
  s_min_u32 s30, s30, s34
  s_mov_b32 s28, 0xaa2300
  s_memtime s[32:33]
  s_waitcnt lgkmcnt(0)
  buffer_load_dword v9, v7, s[8:11], s28 offen sc1
  s_waitcnt vmcnt(0)
  s_memtime s[34:35]
  s_waitcnt lgkmcnt(0)
  s_sub_u32 s34, s34, s32
  s_min_u32 s31, s31, s34
  s_mov_b32 s28, 0xaa0400
  s_memtime s[32:33]
  s_waitcnt lgkmcnt(0)
  buffer_load_dword v9, v7, s[8:11], s28 offen sc1
  s_waitcnt vmcnt(0)
  s_memtime s[34:35]
  s_waitcnt lgkmcnt(0)
  s_sub_u32 s34, s34, s32
  s_min_u32 s30, s30, s34
  s_mov_b32 s28, 0xaa2400
  s_memtime s[32:33]
  s_waitcnt lgkmcnt(0)
  buffer_load_dword v9, v7, s[8:11], s28 offen sc1
  s_waitcnt vmcnt(0)
  s_memtime s[34:35]
  s_waitcnt lgkmcnt(0)
  s_sub_u32 s34, s34, s32
  s_min_u32 s31, s31, s34
  s_mov_b32 s28, 0xaa0500
  s_memtime s[32:33]
  s_waitcnt lgkmcnt(0)
  buffer_load_dword v9, v7, s[8:11], s28 offen sc1
  s_waitcnt vmcnt(0)
  s_memtime s[34:35]
  s_waitcnt lgkmcnt(0)
  s_sub_u32 s34, s34, s32
  s_min_u32 s30, s30, s34
  s_mov_b32 s28, 0xaa2500
  s_memtime s[32:33]
  s_waitcnt lgkmcnt(0)
  buffer_load_dword v9, v7, s[8:11], s28 offen sc1
  s_waitcnt vmcnt(0)
  s_memtime s[34:35]
  s_waitcnt lgkmcnt(0)
  s_sub_u32 s34, s34, s32
  s_min_u32 s31, s31, s34
  s_cmp_le_u32 s30, s31
  s_cselect_b32 s28, 1, 2
  v_mov_b32 v9, s28
  v_mov_b32 v8, 5056
  buffer_store_dword v9, v8, s[8:11], 0 offen sc1
  v_mov_b32 v9, s30
  buffer_store_dword v9, v8, s[8:11], 0 offen offset:4 sc1
  v_mov_b32 v9, s31
  buffer_store_dword v9, v8, s[8:11], 0 offen offset:8 sc1
  s_mov_b64 exec, s[24:25]
ka_pfnm:
  s_cmp_lt_u32 s46, 11
  s_cbranch_scc0 ka_pf2
  buffer_load_dword v9, v4, s[8:11], s51 offen sc1
ka_pf2:
  s_cmp_gt_u32 s55, s54
  s_cbranch_scc1 ka_wp_52_ok
  s_mov_b32 s45, 0
ka_wp_52_spin:
  buffer_load_dword v2, v5, s[8:11], 0 offen sc1
  s_add_u32 s45, s45, 1
  s_waitcnt vmcnt(0)
  v_min_u32_dpp v3, v2, v2 quad_perm:[1,0,3,2] row_mask:0xf bank_mask:0xf
  s_nop 1
  v_min_u32_dpp v2, v3, v3 quad_perm:[2,3,0,1] row_mask:0xf bank_mask:0xf
  s_nop 1
  v_min_u32_dpp v3, v2, v2 row_half_mirror row_mask:0xf bank_mask:0xf
  s_nop 1
  v_min_u32_dpp v2, v3, v3 row_mirror row_mask:0xf bank_mask:0xf
  s_nop 0
  v_readfirstlane_b32 s55, v2
  s_cmp_gt_u32 s55, s54
  s_cbranch_scc1 ka_wp_52_ok
  s_cmp_lt_u32 s45, 400000
  s_cbranch_scc1 ka_wp_52_spin
  s_branch ka_abort
ka_wp_52_ok:
  buffer_load_dword v10, v4, s[8:11], s48 offen sc1
  buffer_load_dword v11, v4, s[8:11], s49 offen sc1
  buffer_load_dword v12, v4, s[8:11], s50 offen sc1
  s_cmp_gt_u32 s56, s54
  s_cbranch_scc1 ka_wp_53_ok
  s_mov_b32 s45, 0
ka_wp_53_spin:
  buffer_load_dword v2, v6, s[8:11], 0 offen sc1
  s_add_u32 s45, s45, 1
  s_waitcnt vmcnt(0)
  v_min_u32_dpp v3, v2, v2 quad_perm:[1,0,3,2] row_mask:0xf bank_mask:0xf
  s_nop 1
  v_min_u32_dpp v2, v3, v3 quad_perm:[2,3,0,1] row_mask:0xf bank_mask:0xf
  s_nop 1
  v_min_u32_dpp v3, v2, v2 row_half_mirror row_mask:0xf bank_mask:0xf
  s_nop 1
  v_min_u32_dpp v2, v3, v3 quad_perm:[0,1,2,3] row_mask:0xf bank_mask:0xf
  s_nop 0
  v_readfirstlane_b32 s56, v2
  s_cmp_gt_u32 s56, s54
  s_cbranch_scc1 ka_wp_53_ok
  s_cmp_lt_u32 s45, 400000
  s_cbranch_scc1 ka_wp_53_spin
  s_branch ka_abort
ka_wp_53_ok:
  s_add_u32 s28, s47, 0
  buffer_load_dword v13, v4, s[8:11], s28 offen sc1
  s_add_u32 s28, s47, 4096
  buffer_load_dword v14, v4, s[8:11], s28 offen sc1
  s_add_u32 s28, s47, 8192
  buffer_load_dword v15, v4, s[8:11], s28 offen sc1
  s_add_u32 s28, s47, 12288
  buffer_load_dword v16, v4, s[8:11], s28 offen sc1
  s_add_u32 s28, s47, 16384
  buffer_load_dword v17, v4, s[8:11], s28 offen sc1
  s_add_u32 s47, s47, 1310720
  s_add_u32 s48, s48, 12288
  s_add_u32 s49, s49, 12288
  s_add_u32 s50, s50, 12288
  s_add_u32 s51, s51, s52
  s_add_u32 s54, s54, 1
  s_waitcnt vmcnt(0)
  s_cmp_lt_u32 s54, 64
  s_cbranch_scc1 ka_pfl
  s_branch ka_exit
ka_qkv:
  s_mul_i32 s26, s23, 43
  s_lshr_b32 s26, s26, 10
  s_mul_i32 s27, s26, 24
  s_sub_u32 s27, s23, s27
  s_cmp_eq_u32 s26, 0
  s_cselect_b32 s28, s36, s38
  s_cselect_b32 s29, s37, s39
  s_cmp_eq_u32 s26, 2
  s_cselect_b32 s28, s40, s28
  s_cselect_b32 s29, s41, s29
  s_mov_b32 s12, s28
  s_and_b32 s13, s29, 0xffff
  s_mov_b32 s14, 0x780000
  s_mov_b32 s15, 0x20000
  s_mul_i32 s46, s26, 0x1800000
  s_add_u32 s46, s46, 0x4800000
  s_lshl_b32 s47, s26, 10
  s_lshl_b32 s28, s27, 2
  s_add_u32 s47, s47, s28
  s_add_u32 s47, s47, 0
  s_lshl_b32 s28, s27, 3
  s_lshl_b32 s29, s21, 1
  s_add_u32 s28, s28, s29
  s_add_u32 s29, s28, 0
  s_mul_i32 s30, s29, 171
  s_lshr_b32 s30, s30, 10
  s_mul_i32 s31, s30, 6
  s_sub_u32 s31, s29, s31
  s_mul_i32 s30, s30, 786432
  s_lshl_b32 s31, s31, 11
  s_add_u32 s30, s30, s31
  s_add_u32 s48, s30, s46
  s_add_u32 s29, s28, 1
  s_mul_i32 s30, s29, 171
  s_lshr_b32 s30, s30, 10
  s_mul_i32 s31, s30, 6
  s_sub_u32 s31, s29, s31
  s_mul_i32 s30, s30, 786432
  s_lshl_b32 s31, s31, 11
  s_add_u32 s30, s30, s31
  s_add_u32 s49, s30, s46
  v_and_b32 v1, 63, v0
  v_lshrrev_b32 v2, 4, v1
  v_bfe_u32 v3, v1, 2, 2
  v_and_b32 v4, 3, v1
  s_lshr_b32 s28, s21, 1
  s_lshl_b32 s28, s28, 2
  v_add_u32 v5, s28, v3
  v_mul_u32_u24 v5, 12288, v5
  s_and_b32 s28, s21, 1
  s_lshl_b32 s28, s28, 8
  s_lshl_b32 s29, s27, 9
  s_add_u32 s28, s28, s29
  v_add_u32 v5, s28, v5
  v_lshlrev_b32 v6, 6, v2
  v_add_u32 v5, v5, v6
  v_lshlrev_b32 v6, 4, v4
  v_add_u32 v5, v5, v6
  v_lshrrev_b32 v6, 1, v2
  v_lshlrev_b32 v7, 12, v6
  v_lshlrev_b32 v6, 6, v3
  v_add_u32 v7, v7, v6
  v_and_b32 v6, 1, v2
  v_lshlrev_b32 v6, 5, v6
  v_add_u32 v7, v7, v6
  v_lshrrev_b32 v6, 1, v4
  v_lshlrev_b32 v6, 4, v6
  v_add_u32 v7, v7, v6
  v_and_b32 v6, 1, v4
  v_lshlrev_b32 v6, 3, v6
  v_add_u32 v7, v7, v6
  s_lshl_b32 s28, s21, 9
  v_add_u32 v7, s28, v7
  v_lshlrev_b32 v14, 4, v1
  s_lshl_b32 s28, s21, 10
  v_add_u32 v6, s28, v14
  v_mov_b32 v15, 4992
  s_mov_b32 s51, 0x100000
  s_lshl_b32 s29, s21, 10
  s_add_u32 m0, s29, 0
  s_mov_b32 s28, 0
  buffer_load_dwordx4 v5, s[12:15], s28 offen lds
  s_lshl_b32 s29, s21, 10
  s_add_u32 m0, s29, 4096
  s_mov_b32 s28, 98304
  buffer_load_dwordx4 v5, s[12:15], s28 offen lds
  s_lshl_b32 s29, s21, 10
  s_add_u32 m0, s29, 8192
  s_mov_b32 s28, 196608
  buffer_load_dwordx4 v5, s[12:15], s28 offen lds
  s_lshl_b32 s29, s21, 10
  s_add_u32 m0, s29, 12288
  s_mov_b32 s28, 294912
  buffer_load_dwordx4 v5, s[12:15], s28 offen lds
  s_lshl_b32 s29, s21, 10
  s_add_u32 m0, s29, 16384
  s_mov_b32 s28, 393216
  buffer_load_dwordx4 v5, s[12:15], s28 offen lds
  s_lshl_b32 s29, s21, 10
  s_add_u32 m0, s29, 20480
  s_mov_b32 s28, 491520
  buffer_load_dwordx4 v5, s[12:15], s28 offen lds
  s_lshl_b32 s29, s21, 10
  s_add_u32 m0, s29, 24576
  s_mov_b32 s28, 589824
  buffer_load_dwordx4 v5, s[12:15], s28 offen lds
  s_lshl_b32 s29, s21, 10
  s_add_u32 m0, s29, 28672
  s_mov_b32 s28, 688128
  buffer_load_dwordx4 v5, s[12:15], s28 offen lds
  s_lshl_b32 s29, s21, 10
  s_add_u32 m0, s29, 32768
  s_mov_b32 s28, 786432
  buffer_load_dwordx4 v5, s[12:15], s28 offen lds
  s_lshl_b32 s29, s21, 10
  s_add_u32 m0, s29, 36864
  s_mov_b32 s28, 884736
  buffer_load_dwordx4 v5, s[12:15], s28 offen lds
  s_lshl_b32 s29, s21, 10
  s_add_u32 m0, s29, 40960
  s_mov_b32 s28, 983040
  buffer_load_dwordx4 v5, s[12:15], s28 offen lds
  s_lshl_b32 s29, s21, 10
  s_add_u32 m0, s29, 45056
  s_mov_b32 s28, 1081344
  buffer_load_dwordx4 v5, s[12:15], s28 offen lds
  s_lshl_b32 s29, s21, 10
  s_add_u32 m0, s29, 49152
  s_mov_b32 s28, 1179648
  buffer_load_dwordx4 v5, s[12:15], s28 offen lds
  s_lshl_b32 s29, s21, 10
  s_add_u32 m0, s29, 53248
  s_mov_b32 s28, 1277952
  buffer_load_dwordx4 v5, s[12:15], s28 offen lds
  s_lshl_b32 s29, s21, 10
  s_add_u32 m0, s29, 57344
  s_mov_b32 s28, 1376256
  buffer_load_dwordx4 v5, s[12:15], s28 offen lds
  s_lshl_b32 s29, s21, 10
  s_add_u32 m0, s29, 61440
  s_mov_b32 s28, 1474560
  buffer_load_dwordx4 v5, s[12:15], s28 offen lds
  s_lshl_b32 s29, s21, 10
  s_add_u32 m0, s29, 65536
  s_mov_b32 s28, 1572864
  buffer_load_dwordx4 v5, s[12:15], s28 offen lds
  s_lshl_b32 s29, s21, 10
  s_add_u32 m0, s29, 69632
  s_mov_b32 s28, 1671168
  buffer_load_dwordx4 v5, s[12:15], s28 offen lds
  s_lshl_b32 s29, s21, 10
  s_add_u32 m0, s29, 73728
  s_mov_b32 s28, 1769472
  buffer_load_dwordx4 v5, s[12:15], s28 offen lds
  s_lshl_b32 s29, s21, 10
  s_add_u32 m0, s29, 77824
  s_mov_b32 s28, 1867776
  buffer_load_dwordx4 v5, s[12:15], s28 offen lds
  s_lshl_b32 s29, s21, 10
  s_add_u32 m0, s29, 81920
  s_mov_b32 s28, 1966080
  buffer_load_dwordx4 v5, s[12:15], s28 offen lds
  s_lshl_b32 s29, s21, 10
  s_add_u32 m0, s29, 86016
  s_mov_b32 s28, 2064384
  buffer_load_dwordx4 v5, s[12:15], s28 offen lds
  s_lshl_b32 s29, s21, 10
  s_add_u32 m0, s29, 90112
  s_mov_b32 s28, 2162688
  buffer_load_dwordx4 v5, s[12:15], s28 offen lds
  s_lshl_b32 s29, s21, 10
  s_add_u32 m0, s29, 94208
  s_mov_b32 s28, 2260992
  buffer_load_dwordx4 v5, s[12:15], s28 offen lds
  s_waitcnt vmcnt(20)
  s_cmp_eq_u32 s21, 3
  s_cbranch_scc0 lna_54
  s_mov_b64 s[24:25], exec
  s_mov_b64 exec, 1
  v_mov_b32 v2, 4992
  v_mov_b32 v3, 1
  buffer_atomic_add v3, v2, s[8:11], 0 offen
  s_mov_b64 exec, s[24:25]
lna_54:
  s_barrier
  s_lshl_b32 s29, s21, 10
  s_add_u32 m0, s29, 98304
  s_mov_b32 s28, 2359296
  buffer_load_dwordx4 v5, s[12:15], s28 offen lds
  s_lshl_b32 s29, s21, 10
  s_add_u32 m0, s29, 102400
  s_mov_b32 s28, 2457600
  buffer_load_dwordx4 v5, s[12:15], s28 offen lds
  s_lshl_b32 s29, s21, 10
  s_add_u32 m0, s29, 106496
  s_mov_b32 s28, 2555904
  buffer_load_dwordx4 v5, s[12:15], s28 offen lds
  s_lshl_b32 s29, s21, 10
  s_add_u32 m0, s29, 110592
  s_mov_b32 s28, 2654208
  buffer_load_dwordx4 v5, s[12:15], s28 offen lds
  v_add_u32 v8, 0, v7
  ds_read_b64_tr_b16 a[0:1], v8 offset:0
  ds_read_b64_tr_b16 a[2:3], v8 offset:2048
  ds_read_b64_tr_b16 a[4:5], v8 offset:8192
  ds_read_b64_tr_b16 a[6:7], v8 offset:10240
  ds_read_b64_tr_b16 a[160:161], v8 offset:256
  ds_read_b64_tr_b16 a[162:163], v8 offset:2304
  ds_read_b64_tr_b16 a[164:165], v8 offset:8448
  ds_read_b64_tr_b16 a[166:167], v8 offset:10496
  s_waitcnt lgkmcnt(0)
  s_waitcnt vmcnt(20)
  s_barrier
  s_lshl_b32 s29, s21, 10
  s_add_u32 m0, s29, 0
  s_mov_b32 s28, 2752512
  buffer_load_dwordx4 v5, s[12:15], s28 offen lds
  s_lshl_b32 s29, s21, 10
  s_add_u32 m0, s29, 4096
  s_mov_b32 s28, 2850816
  buffer_load_dwordx4 v5, s[12:15], s28 offen lds
  s_lshl_b32 s29, s21, 10
  s_add_u32 m0, s29, 8192
  s_mov_b32 s28, 2949120
  buffer_load_dwordx4 v5, s[12:15], s28 offen lds
  s_lshl_b32 s29, s21, 10
  s_add_u32 m0, s29, 12288
  s_mov_b32 s28, 3047424
  buffer_load_dwordx4 v5, s[12:15], s28 offen lds
  v_add_u32 v8, 16384, v7
  ds_read_b64_tr_b16 a[8:9], v8 offset:0
  ds_read_b64_tr_b16 a[10:11], v8 offset:2048
  ds_read_b64_tr_b16 a[12:13], v8 offset:8192
  ds_read_b64_tr_b16 a[14:15], v8 offset:10240
  ds_read_b64_tr_b16 a[168:169], v8 offset:256
  ds_read_b64_tr_b16 a[170:171], v8 offset:2304
  ds_read_b64_tr_b16 a[172:173], v8 offset:8448
  ds_read_b64_tr_b16 a[174:175], v8 offset:10496
  s_waitcnt lgkmcnt(0)
  s_waitcnt vmcnt(20)
  s_barrier
  s_lshl_b32 s29, s21, 10
  s_add_u32 m0, s29, 16384
  s_mov_b32 s28, 3145728
  buffer_load_dwordx4 v5, s[12:15], s28 offen lds
  s_lshl_b32 s29, s21, 10
  s_add_u32 m0, s29, 20480
  s_mov_b32 s28, 3244032
  buffer_load_dwordx4 v5, s[12:15], s28 offen lds
  s_lshl_b32 s29, s21, 10
  s_add_u32 m0, s29, 24576
  s_mov_b32 s28, 3342336
  buffer_load_dwordx4 v5, s[12:15], s28 offen lds
  s_lshl_b32 s29, s21, 10
  s_add_u32 m0, s29, 28672
  s_mov_b32 s28, 3440640
  buffer_load_dwordx4 v5, s[12:15], s28 offen lds
  v_add_u32 v8, 32768, v7
  ds_read_b64_tr_b16 a[16:17], v8 offset:0
  ds_read_b64_tr_b16 a[18:19], v8 offset:2048
  ds_read_b64_tr_b16 a[20:21], v8 offset:8192
  ds_read_b64_tr_b16 a[22:23], v8 offset:10240
  ds_read_b64_tr_b16 a[176:177], v8 offset:256
  ds_read_b64_tr_b16 a[178:179], v8 offset:2304
  ds_read_b64_tr_b16 a[180:181], v8 offset:8448
  ds_read_b64_tr_b16 a[182:183], v8 offset:10496
  s_waitcnt lgkmcnt(0)
  s_waitcnt vmcnt(20)
  s_barrier
  s_lshl_b32 s29, s21, 10
  s_add_u32 m0, s29, 32768
  s_mov_b32 s28, 3538944
  buffer_load_dwordx4 v5, s[12:15], s28 offen lds
  s_lshl_b32 s29, s21, 10
  s_add_u32 m0, s29, 36864
  s_mov_b32 s28, 3637248
  buffer_load_dwordx4 v5, s[12:15], s28 offen lds
  s_lshl_b32 s29, s21, 10
  s_add_u32 m0, s29, 40960
  s_mov_b32 s28, 3735552
  buffer_load_dwordx4 v5, s[12:15], s28 offen lds
  s_lshl_b32 s29, s21, 10
  s_add_u32 m0, s29, 45056
  s_mov_b32 s28, 3833856
  buffer_load_dwordx4 v5, s[12:15], s28 offen lds
  v_add_u32 v8, 49152, v7
  ds_read_b64_tr_b16 a[24:25], v8 offset:0
  ds_read_b64_tr_b16 a[26:27], v8 offset:2048
  ds_read_b64_tr_b16 a[28:29], v8 offset:8192
  ds_read_b64_tr_b16 a[30:31], v8 offset:10240
  ds_read_b64_tr_b16 a[184:185], v8 offset:256
  ds_read_b64_tr_b16 a[186:187], v8 offset:2304
  ds_read_b64_tr_b16 a[188:189], v8 offset:8448
  ds_read_b64_tr_b16 a[190:191], v8 offset:10496
  s_waitcnt lgkmcnt(0)
  s_waitcnt vmcnt(20)
  s_barrier
  s_lshl_b32 s29, s21, 10
  s_add_u32 m0, s29, 49152
  s_mov_b32 s28, 3932160
  buffer_load_dwordx4 v5, s[12:15], s28 offen lds
  s_lshl_b32 s29, s21, 10
  s_add_u32 m0, s29, 53248
  s_mov_b32 s28, 4030464
  buffer_load_dwordx4 v5, s[12:15], s28 offen lds
  s_lshl_b32 s29, s21, 10
  s_add_u32 m0, s29, 57344
  s_mov_b32 s28, 4128768
  buffer_load_dwordx4 v5, s[12:15], s28 offen lds
  s_lshl_b32 s29, s21, 10
  s_add_u32 m0, s29, 61440
  s_mov_b32 s28, 4227072
  buffer_load_dwordx4 v5, s[12:15], s28 offen lds
  v_add_u32 v8, 65536, v7
  ds_read_b64_tr_b16 a[32:33], v8 offset:0
  ds_read_b64_tr_b16 a[34:35], v8 offset:2048
  ds_read_b64_tr_b16 a[36:37], v8 offset:8192
  ds_read_b64_tr_b16 a[38:39], v8 offset:10240
  ds_read_b64_tr_b16 a[192:193], v8 offset:256
  ds_read_b64_tr_b16 a[194:195], v8 offset:2304
  ds_read_b64_tr_b16 a[196:197], v8 offset:8448
  ds_read_b64_tr_b16 a[198:199], v8 offset:10496
  s_waitcnt lgkmcnt(0)
  s_waitcnt vmcnt(20)
  s_barrier
  s_lshl_b32 s29, s21, 10
  s_add_u32 m0, s29, 65536
  s_mov_b32 s28, 4325376
  buffer_load_dwordx4 v5, s[12:15], s28 offen lds
  s_lshl_b32 s29, s21, 10
  s_add_u32 m0, s29, 69632
  s_mov_b32 s28, 4423680
  buffer_load_dwordx4 v5, s[12:15], s28 offen lds
  s_lshl_b32 s29, s21, 10
  s_add_u32 m0, s29, 73728
  s_mov_b32 s28, 4521984
  buffer_load_dwordx4 v5, s[12:15], s28 offen lds
  s_lshl_b32 s29, s21, 10
  s_add_u32 m0, s29, 77824
  s_mov_b32 s28, 4620288
  buffer_load_dwordx4 v5, s[12:15], s28 offen lds
  v_add_u32 v8, 81920, v7
  ds_read_b64_tr_b16 a[40:41], v8 offset:0
  ds_read_b64_tr_b16 a[42:43], v8 offset:2048
  ds_read_b64_tr_b16 a[44:45], v8 offset:8192
  ds_read_b64_tr_b16 a[46:47], v8 offset:10240
  ds_read_b64_tr_b16 a[200:201], v8 offset:256
  ds_read_b64_tr_b16 a[202:203], v8 offset:2304
  ds_read_b64_tr_b16 a[204:205], v8 offset:8448
  ds_read_b64_tr_b16 a[206:207], v8 offset:10496
  s_waitcnt lgkmcnt(0)
  s_waitcnt vmcnt(20)
  s_barrier
  s_lshl_b32 s29, s21, 10
  s_add_u32 m0, s29, 81920
  s_mov_b32 s28, 4718592
  buffer_load_dwordx4 v5, s[12:15], s28 offen lds
  s_lshl_b32 s29, s21, 10
  s_add_u32 m0, s29, 86016
  s_mov_b32 s28, 4816896
  buffer_load_dwordx4 v5, s[12:15], s28 offen lds
  s_lshl_b32 s29, s21, 10
  s_add_u32 m0, s29, 90112
  s_mov_b32 s28, 4915200
  buffer_load_dwordx4 v5, s[12:15], s28 offen lds
  s_lshl_b32 s29, s21, 10
  s_add_u32 m0, s29, 94208
  s_mov_b32 s28, 5013504
  buffer_load_dwordx4 v5, s[12:15], s28 offen lds
  buffer_load_dword v13, v15, s[8:11], 0 offen sc1
  v_add_u32 v8, 98304, v7
  ds_read_b64_tr_b16 a[48:49], v8 offset:0
  ds_read_b64_tr_b16 a[50:51], v8 offset:2048
  ds_read_b64_tr_b16 a[52:53], v8 offset:8192
  ds_read_b64_tr_b16 a[54:55], v8 offset:10240
  ds_read_b64_tr_b16 a[208:209], v8 offset:256
  ds_read_b64_tr_b16 a[210:211], v8 offset:2304
  ds_read_b64_tr_b16 a[212:213], v8 offset:8448
  ds_read_b64_tr_b16 a[214:215], v8 offset:10496
  s_waitcnt lgkmcnt(0)
  s_waitcnt vmcnt(21)
  s_barrier
  s_lshl_b32 s29, s21, 10
  s_add_u32 m0, s29, 98304
  s_mov_b32 s28, 5111808
  buffer_load_dwordx4 v5, s[12:15], s28 offen lds
  s_lshl_b32 s29, s21, 10
  s_add_u32 m0, s29, 102400
  s_mov_b32 s28, 5210112
  buffer_load_dwordx4 v5, s[12:15], s28 offen lds
  s_lshl_b32 s29, s21, 10
  s_add_u32 m0, s29, 106496
  s_mov_b32 s28, 5308416
  buffer_load_dwordx4 v5, s[12:15], s28 offen lds
  s_lshl_b32 s29, s21, 10
  s_add_u32 m0, s29, 110592
  s_mov_b32 s28, 5406720
  buffer_load_dwordx4 v5, s[12:15], s28 offen lds
  v_add_u32 v8, 0, v7
  ds_read_b64_tr_b16 a[56:57], v8 offset:0
  ds_read_b64_tr_b16 a[58:59], v8 offset:2048
  ds_read_b64_tr_b16 a[60:61], v8 offset:8192
  ds_read_b64_tr_b16 a[62:63], v8 offset:10240
  ds_read_b64_tr_b16 a[216:217], v8 offset:256
  ds_read_b64_tr_b16 a[218:219], v8 offset:2304
  ds_read_b64_tr_b16 a[220:221], v8 offset:8448
  ds_read_b64_tr_b16 a[222:223], v8 offset:10496
  s_waitcnt lgkmcnt(0)
  s_waitcnt vmcnt(21)
  s_barrier
  s_lshl_b32 s29, s21, 10
  s_add_u32 m0, s29, 0
  s_mov_b32 s28, 5505024
  buffer_load_dwordx4 v5, s[12:15], s28 offen lds
  s_lshl_b32 s29, s21, 10
  s_add_u32 m0, s29, 4096
  s_mov_b32 s28, 5603328
  buffer_load_dwordx4 v5, s[12:15], s28 offen lds
  s_lshl_b32 s29, s21, 10
  s_add_u32 m0, s29, 8192
  s_mov_b32 s28, 5701632
  buffer_load_dwordx4 v5, s[12:15], s28 offen lds
  s_lshl_b32 s29, s21, 10
  s_add_u32 m0, s29, 12288
  s_mov_b32 s28, 5799936
  buffer_load_dwordx4 v5, s[12:15], s28 offen lds
  v_add_u32 v8, 16384, v7
  ds_read_b64_tr_b16 a[64:65], v8 offset:0
  ds_read_b64_tr_b16 a[66:67], v8 offset:2048
  ds_read_b64_tr_b16 a[68:69], v8 offset:8192
  ds_read_b64_tr_b16 a[70:71], v8 offset:10240
  ds_read_b64_tr_b16 a[224:225], v8 offset:256
  ds_read_b64_tr_b16 a[226:227], v8 offset:2304
  ds_read_b64_tr_b16 a[228:229], v8 offset:8448
  ds_read_b64_tr_b16 a[230:231], v8 offset:10496
  s_waitcnt lgkmcnt(0)
  s_waitcnt vmcnt(21)
  s_barrier
  s_lshl_b32 s29, s21, 10
  s_add_u32 m0, s29, 16384
  s_mov_b32 s28, 5898240
  buffer_load_dwordx4 v5, s[12:15], s28 offen lds
  s_lshl_b32 s29, s21, 10
  s_add_u32 m0, s29, 20480
  s_mov_b32 s28, 5996544
  buffer_load_dwordx4 v5, s[12:15], s28 offen lds
  s_lshl_b32 s29, s21, 10
  s_add_u32 m0, s29, 24576
  s_mov_b32 s28, 6094848
  buffer_load_dwordx4 v5, s[12:15], s28 offen lds
  s_lshl_b32 s29, s21, 10
  s_add_u32 m0, s29, 28672
  s_mov_b32 s28, 6193152
  buffer_load_dwordx4 v5, s[12:15], s28 offen lds
  v_add_u32 v8, 32768, v7
  ds_read_b64_tr_b16 a[72:73], v8 offset:0
  ds_read_b64_tr_b16 a[74:75], v8 offset:2048
  ds_read_b64_tr_b16 a[76:77], v8 offset:8192
  ds_read_b64_tr_b16 a[78:79], v8 offset:10240
  ds_read_b64_tr_b16 a[232:233], v8 offset:256
  ds_read_b64_tr_b16 a[234:235], v8 offset:2304
  ds_read_b64_tr_b16 a[236:237], v8 offset:8448
  ds_read_b64_tr_b16 a[238:239], v8 offset:10496
  s_waitcnt lgkmcnt(0)
  s_waitcnt vmcnt(21)
  s_barrier
  s_lshl_b32 s29, s21, 10
  s_add_u32 m0, s29, 32768
  s_mov_b32 s28, 6291456
  buffer_load_dwordx4 v5, s[12:15], s28 offen lds
  s_lshl_b32 s29, s21, 10
  s_add_u32 m0, s29, 36864
  s_mov_b32 s28, 6389760
  buffer_load_dwordx4 v5, s[12:15], s28 offen lds
  s_lshl_b32 s29, s21, 10
  s_add_u32 m0, s29, 40960
  s_mov_b32 s28, 6488064
  buffer_load_dwordx4 v5, s[12:15], s28 offen lds
  s_lshl_b32 s29, s21, 10
  s_add_u32 m0, s29, 45056
  s_mov_b32 s28, 6586368
  buffer_load_dwordx4 v5, s[12:15], s28 offen lds
  v_add_u32 v8, 49152, v7
  ds_read_b64_tr_b16 a[80:81], v8 offset:0
  ds_read_b64_tr_b16 a[82:83], v8 offset:2048
  ds_read_b64_tr_b16 a[84:85], v8 offset:8192
  ds_read_b64_tr_b16 a[86:87], v8 offset:10240
  ds_read_b64_tr_b16 a[240:241], v8 offset:256
  ds_read_b64_tr_b16 a[242:243], v8 offset:2304
  ds_read_b64_tr_b16 a[244:245], v8 offset:8448
  ds_read_b64_tr_b16 a[246:247], v8 offset:10496
  s_waitcnt lgkmcnt(0)
  s_waitcnt vmcnt(21)
  s_barrier
  s_lshl_b32 s29, s21, 10
  s_add_u32 m0, s29, 49152
  s_mov_b32 s28, 6684672
  buffer_load_dwordx4 v5, s[12:15], s28 offen lds
  s_lshl_b32 s29, s21, 10
  s_add_u32 m0, s29, 53248
  s_mov_b32 s28, 6782976
  buffer_load_dwordx4 v5, s[12:15], s28 offen lds
  s_lshl_b32 s29, s21, 10
  s_add_u32 m0, s29, 57344
  s_mov_b32 s28, 6881280
  buffer_load_dwordx4 v5, s[12:15], s28 offen lds
  s_lshl_b32 s29, s21, 10
  s_add_u32 m0, s29, 61440
  s_mov_b32 s28, 6979584
  buffer_load_dwordx4 v5, s[12:15], s28 offen lds
  v_add_u32 v8, 65536, v7
  ds_read_b64_tr_b16 a[88:89], v8 offset:0
  ds_read_b64_tr_b16 a[90:91], v8 offset:2048
  ds_read_b64_tr_b16 a[92:93], v8 offset:8192
  ds_read_b64_tr_b16 a[94:95], v8 offset:10240
  ds_read_b64_tr_b16 a[248:249], v8 offset:256
  ds_read_b64_tr_b16 a[250:251], v8 offset:2304
  ds_read_b64_tr_b16 a[252:253], v8 offset:8448
  ds_read_b64_tr_b16 a[254:255], v8 offset:10496
  s_waitcnt lgkmcnt(0)
  s_waitcnt vmcnt(21)
  s_barrier
  s_lshl_b32 s29, s21, 10
  s_add_u32 m0, s29, 65536
  s_mov_b32 s28, 7077888
  buffer_load_dwordx4 v5, s[12:15], s28 offen lds
  s_lshl_b32 s29, s21, 10
  s_add_u32 m0, s29, 69632
  s_mov_b32 s28, 7176192
  buffer_load_dwordx4 v5, s[12:15], s28 offen lds
  s_lshl_b32 s29, s21, 10
  s_add_u32 m0, s29, 73728
  s_mov_b32 s28, 7274496
  buffer_load_dwordx4 v5, s[12:15], s28 offen lds
  s_lshl_b32 s29, s21, 10
  s_add_u32 m0, s29, 77824
  s_mov_b32 s28, 7372800
  buffer_load_dwordx4 v5, s[12:15], s28 offen lds
  v_add_u32 v8, 81920, v7
  ds_read_b64_tr_b16 a[96:97], v8 offset:0
  ds_read_b64_tr_b16 a[98:99], v8 offset:2048
  ds_read_b64_tr_b16 a[100:101], v8 offset:8192
  ds_read_b64_tr_b16 a[102:103], v8 offset:10240
  ds_read_b64_tr_b16 v[192:193], v8 offset:256
  ds_read_b64_tr_b16 v[194:195], v8 offset:2304
  ds_read_b64_tr_b16 v[196:197], v8 offset:8448
  ds_read_b64_tr_b16 v[198:199], v8 offset:10496
  s_waitcnt lgkmcnt(0)
  s_waitcnt vmcnt(20)
  s_nop 0
  v_readfirstlane_b32 s28, v13
  s_cmp_ge_u32 s28, 256
  s_cbranch_scc1 xw_55_ok
  s_mov_b32 s45, 0
xw_55:
  buffer_load_dword v13, v15, s[8:11], 0 offen sc1
  s_add_u32 s45, s45, 1
  s_waitcnt vmcnt(0)
  v_readfirstlane_b32 s28, v13
  s_cmp_ge_u32 s28, 256
  s_cbranch_scc1 xw_55_ok
  s_cmp_lt_u32 s45, 400000
  s_cbranch_scc1 xw_55
  s_branch ka_abort
xw_55_ok:
  s_lshl_b32 s29, s21, 10
  s_add_u32 m0, s29, 122880
  s_add_u32 s28, s51, 0
  buffer_load_dwordx4 v6, s[8:11], s28 offen sc1 lds
  s_lshl_b32 s29, s21, 10
  s_add_u32 m0, s29, 126976
  s_add_u32 s28, s51, 4096
  buffer_load_dwordx4 v6, s[8:11], s28 offen sc1 lds
  s_lshl_b32 s29, s21, 10
  s_add_u32 m0, s29, 131072
  s_add_u32 s28, s51, 8192
  buffer_load_dwordx4 v6, s[8:11], s28 offen sc1 lds
  s_lshl_b32 s29, s21, 10
  s_add_u32 m0, s29, 135168
  s_add_u32 s28, s51, 12288
  buffer_load_dwordx4 v6, s[8:11], s28 offen sc1 lds
  s_lshl_b32 s29, s21, 10
  s_add_u32 m0, s29, 139264
  s_add_u32 s28, s51, 16384
  buffer_load_dwordx4 v6, s[8:11], s28 offen sc1 lds
  s_lshl_b32 s29, s21, 10
  s_add_u32 m0, s29, 143360
  s_add_u32 s28, s51, 20480
  buffer_load_dwordx4 v6, s[8:11], s28 offen sc1 lds
  s_lshl_b32 s29, s21, 10
  s_add_u32 m0, s29, 147456
  s_add_u32 s28, s51, 24576
  buffer_load_dwordx4 v6, s[8:11], s28 offen sc1 lds
  s_lshl_b32 s29, s21, 10
  s_add_u32 m0, s29, 151552
  s_add_u32 s28, s51, 28672
  buffer_load_dwordx4 v6, s[8:11], s28 offen sc1 lds
  s_lshl_b32 s29, s21, 10
  s_add_u32 m0, s29, 155648
  s_add_u32 s28, s51, 32768
  buffer_load_dwordx4 v6, s[8:11], s28 offen sc1 lds
  s_lshl_b32 s29, s21, 10
  s_add_u32 m0, s29, 159744
  s_add_u32 s28, s51, 36864
  buffer_load_dwordx4 v6, s[8:11], s28 offen sc1 lds
  s_add_u32 s51, s51, 40960
  s_barrier
  s_lshl_b32 s29, s21, 10
  s_add_u32 m0, s29, 81920
  s_mov_b32 s28, 7471104
  buffer_load_dwordx4 v5, s[12:15], s28 offen lds
  s_lshl_b32 s29, s21, 10
  s_add_u32 m0, s29, 86016
  s_mov_b32 s28, 7569408
  buffer_load_dwordx4 v5, s[12:15], s28 offen lds
  s_lshl_b32 s29, s21, 10
  s_add_u32 m0, s29, 90112
  s_mov_b32 s28, 7667712
  buffer_load_dwordx4 v5, s[12:15], s28 offen lds
  s_lshl_b32 s29, s21, 10
  s_add_u32 m0, s29, 94208
  s_mov_b32 s28, 7766016
  buffer_load_dwordx4 v5, s[12:15], s28 offen lds
  v_add_u32 v8, 98304, v7
  ds_read_b64_tr_b16 a[104:105], v8 offset:0
  ds_read_b64_tr_b16 a[106:107], v8 offset:2048
  ds_read_b64_tr_b16 a[108:109], v8 offset:8192
  ds_read_b64_tr_b16 a[110:111], v8 offset:10240
  ds_read_b64_tr_b16 v[200:201], v8 offset:256
  ds_read_b64_tr_b16 v[202:203], v8 offset:2304
  ds_read_b64_tr_b16 v[204:205], v8 offset:8448
  ds_read_b64_tr_b16 v[206:207], v8 offset:10496
  s_waitcnt lgkmcnt(0)
  s_waitcnt vmcnt(30)
  s_barrier
  v_add_u32 v8, 0, v7
  ds_read_b64_tr_b16 a[112:113], v8 offset:0
  ds_read_b64_tr_b16 a[114:115], v8 offset:2048
  ds_read_b64_tr_b16 a[116:117], v8 offset:8192
  ds_read_b64_tr_b16 a[118:119], v8 offset:10240
  ds_read_b64_tr_b16 v[208:209], v8 offset:256
  ds_read_b64_tr_b16 v[210:211], v8 offset:2304
  ds_read_b64_tr_b16 v[212:213], v8 offset:8448
  ds_read_b64_tr_b16 v[214:215], v8 offset:10496
  s_waitcnt lgkmcnt(0)
  s_waitcnt vmcnt(26)
  s_barrier
  v_add_u32 v8, 16384, v7
  ds_read_b64_tr_b16 a[120:121], v8 offset:0
  ds_read_b64_tr_b16 a[122:123], v8 offset:2048
  ds_read_b64_tr_b16 a[124:125], v8 offset:8192
  ds_read_b64_tr_b16 a[126:127], v8 offset:10240
  ds_read_b64_tr_b16 v[216:217], v8 offset:256
  ds_read_b64_tr_b16 v[218:219], v8 offset:2304
  ds_read_b64_tr_b16 v[220:221], v8 offset:8448
  ds_read_b64_tr_b16 v[222:223], v8 offset:10496
  s_waitcnt lgkmcnt(0)
  s_waitcnt vmcnt(22)
  s_barrier
  v_add_u32 v8, 32768, v7
  ds_read_b64_tr_b16 a[128:129], v8 offset:0
  ds_read_b64_tr_b16 a[130:131], v8 offset:2048
  ds_read_b64_tr_b16 a[132:133], v8 offset:8192
  ds_read_b64_tr_b16 a[134:135], v8 offset:10240
  ds_read_b64_tr_b16 v[224:225], v8 offset:256
  ds_read_b64_tr_b16 v[226:227], v8 offset:2304
  ds_read_b64_tr_b16 v[228:229], v8 offset:8448
  ds_read_b64_tr_b16 v[230:231], v8 offset:10496
  s_waitcnt lgkmcnt(0)
  s_waitcnt vmcnt(18)
  s_barrier
  v_add_u32 v8, 49152, v7
  ds_read_b64_tr_b16 a[136:137], v8 offset:0
  ds_read_b64_tr_b16 a[138:139], v8 offset:2048
  ds_read_b64_tr_b16 a[140:141], v8 offset:8192
  ds_read_b64_tr_b16 a[142:143], v8 offset:10240
  ds_read_b64_tr_b16 v[232:233], v8 offset:256
  ds_read_b64_tr_b16 v[234:235], v8 offset:2304
  ds_read_b64_tr_b16 v[236:237], v8 offset:8448
  ds_read_b64_tr_b16 v[238:239], v8 offset:10496
  s_waitcnt lgkmcnt(0)
  s_waitcnt vmcnt(14)
  s_barrier
  v_add_u32 v8, 65536, v7
  ds_read_b64_tr_b16 a[144:145], v8 offset:0
  ds_read_b64_tr_b16 a[146:147], v8 offset:2048
  ds_read_b64_tr_b16 a[148:149], v8 offset:8192
  ds_read_b64_tr_b16 a[150:151], v8 offset:10240
  ds_read_b64_tr_b16 v[240:241], v8 offset:256
  ds_read_b64_tr_b16 v[242:243], v8 offset:2304
  ds_read_b64_tr_b16 v[244:245], v8 offset:8448
  ds_read_b64_tr_b16 v[246:247], v8 offset:10496
  s_waitcnt lgkmcnt(0)
  s_waitcnt vmcnt(0)
  s_barrier
  v_add_u32 v8, 81920, v7
  ds_read_b64_tr_b16 a[152:153], v8 offset:0
  ds_read_b64_tr_b16 a[154:155], v8 offset:2048
  ds_read_b64_tr_b16 a[156:157], v8 offset:8192
  ds_read_b64_tr_b16 a[158:159], v8 offset:10240
  ds_read_b64_tr_b16 v[248:249], v8 offset:256
  ds_read_b64_tr_b16 v[250:251], v8 offset:2304
  ds_read_b64_tr_b16 v[252:253], v8 offset:8448
  ds_read_b64_tr_b16 v[254:255], v8 offset:10496
  s_waitcnt lgkmcnt(0)
  s_barrier
  v_lshlrev_b32 v5, 4, v1
  v_add_u32 v9, 122880, v5
  v_mov_b32 v10, v5
  v_bfe_u32 v2, v1, 4, 1
  v_lshlrev_b32 v11, 10, v2
  v_and_b32 v2, 15, v1
  v_lshlrev_b32 v2, 4, v2
  v_add_u32 v11, v11, v2
  v_lshrrev_b32 v2, 5, v1
  v_lshlrev_b32 v2, 9, v2
  v_add_u32 v11, v11, v2
  v_mov_b32 v12, s47
  s_mov_b32 s50, 0
ka_qkv_loop:
  s_cmp_eq_u32 s50, 0
  s_cbranch_scc0 q0_56
  s_waitcnt vmcnt(0)
q0_56:
  s_waitcnt vmcnt(4)
  s_barrier
  s_cmp_ge_u32 s50, 63
  s_cbranch_scc1 qn_57_n
  s_lshl_b32 s29, s21, 10
  s_add_u32 m0, s29, 0
  s_add_u32 s28, s51, 0
  buffer_load_dwordx4 v6, s[8:11], s28 offen sc1 lds
  s_lshl_b32 s29, s21, 10
  s_add_u32 m0, s29, 4096
  s_add_u32 s28, s51, 4096
  buffer_load_dwordx4 v6, s[8:11], s28 offen sc1 lds
  s_lshl_b32 s29, s21, 10
  s_add_u32 m0, s29, 8192
  s_add_u32 s28, s51, 8192
  buffer_load_dwordx4 v6, s[8:11], s28 offen sc1 lds
  s_lshl_b32 s29, s21, 10
  s_add_u32 m0, s29, 12288
  s_add_u32 s28, s51, 12288
  buffer_load_dwordx4 v6, s[8:11], s28 offen sc1 lds
  s_lshl_b32 s29, s21, 10
  s_add_u32 m0, s29, 16384
  s_add_u32 s28, s51, 16384
  buffer_load_dwordx4 v6, s[8:11], s28 offen sc1 lds
  s_lshl_b32 s29, s21, 10
  s_add_u32 m0, s29, 20480
  s_add_u32 s28, s51, 20480
  buffer_load_dwordx4 v6, s[8:11], s28 offen sc1 lds
  s_lshl_b32 s29, s21, 10
  s_add_u32 m0, s29, 24576
  s_add_u32 s28, s51, 24576
  buffer_load_dwordx4 v6, s[8:11], s28 offen sc1 lds
  s_lshl_b32 s29, s21, 10
  s_add_u32 m0, s29, 28672
  s_add_u32 s28, s51, 28672
  buffer_load_dwordx4 v6, s[8:11], s28 offen sc1 lds
  s_lshl_b32 s29, s21, 10
  s_add_u32 m0, s29, 32768
  s_add_u32 s28, s51, 32768
  buffer_load_dwordx4 v6, s[8:11], s28 offen sc1 lds
  s_lshl_b32 s29, s21, 10
  s_add_u32 m0, s29, 36864
  s_add_u32 s28, s51, 36864
  buffer_load_dwordx4 v6, s[8:11], s28 offen sc1 lds
  s_add_u32 s51, s51, 40960
  s_branch qn_57
qn_57_n:
  s_waitcnt vmcnt(0)
qn_57:
  ds_read_b128 v[128:131], v9 offset:0
  ds_read_b128 v[132:135], v9 offset:1024
  ds_read_b128 v[136:139], v9 offset:2048
  ds_read_b128 v[140:143], v9 offset:3072
  s_waitcnt lgkmcnt(3)
  v_mfma_f32_32x32x16_bf16 v[64:79], a[0:3], v[128:131], 0
  v_mfma_f32_32x32x16_bf16 v[80:95], a[160:163], v[128:131], 0
  ds_read_b128 v[128:131], v9 offset:4096
  s_waitcnt lgkmcnt(3)
  v_mfma_f32_32x32x16_bf16 v[64:79], a[4:7], v[132:135], v[64:79]
  v_mfma_f32_32x32x16_bf16 v[80:95], a[164:167], v[132:135], v[80:95]
  ds_read_b128 v[132:135], v9 offset:5120
  s_waitcnt lgkmcnt(3)
  v_mfma_f32_32x32x16_bf16 v[64:79], a[8:11], v[136:139], v[64:79]
  v_mfma_f32_32x32x16_bf16 v[80:95], a[168:171], v[136:139], v[80:95]
  ds_read_b128 v[136:139], v9 offset:6144
  s_waitcnt lgkmcnt(3)
  v_mfma_f32_32x32x16_bf16 v[64:79], a[12:15], v[140:143], v[64:79]
  v_mfma_f32_32x32x16_bf16 v[80:95], a[172:175], v[140:143], v[80:95]
  ds_read_b128 v[140:143], v9 offset:7168
  s_waitcnt lgkmcnt(3)
  v_mfma_f32_32x32x16_bf16 v[64:79], a[16:19], v[128:131], v[64:79]
  v_mfma_f32_32x32x16_bf16 v[80:95], a[176:179], v[128:131], v[80:95]
  ds_read_b128 v[128:131], v9 offset:8192
  s_waitcnt lgkmcnt(3)
  v_mfma_f32_32x32x16_bf16 v[64:79], a[20:23], v[132:135], v[64:79]
  v_mfma_f32_32x32x16_bf16 v[80:95], a[180:183], v[132:135], v[80:95]
  ds_read_b128 v[132:135], v9 offset:9216
  s_waitcnt lgkmcnt(3)
  v_mfma_f32_32x32x16_bf16 v[64:79], a[24:27], v[136:139], v[64:79]
  v_mfma_f32_32x32x16_bf16 v[80:95], a[184:187], v[136:139], v[80:95]
  ds_read_b128 v[136:139], v9 offset:10240
  s_waitcnt lgkmcnt(3)
  v_mfma_f32_32x32x16_bf16 v[64:79], a[28:31], v[140:143], v[64:79]
  v_mfma_f32_32x32x16_bf16 v[80:95], a[188:191], v[140:143], v[80:95]
  ds_read_b128 v[140:143], v9 offset:11264
  s_waitcnt lgkmcnt(3)
  v_mfma_f32_32x32x16_bf16 v[64:79], a[32:35], v[128:131], v[64:79]
  v_mfma_f32_32x32x16_bf16 v[80:95], a[192:195], v[128:131], v[80:95]
  ds_read_b128 v[128:131], v9 offset:12288
  s_waitcnt lgkmcnt(3)
  v_mfma_f32_32x32x16_bf16 v[64:79], a[36:39], v[132:135], v[64:79]
  v_mfma_f32_32x32x16_bf16 v[80:95], a[196:199], v[132:135], v[80:95]
  ds_read_b128 v[132:135], v9 offset:13312
  s_waitcnt lgkmcnt(3)
  v_mfma_f32_32x32x16_bf16 v[64:79], a[40:43], v[136:139], v[64:79]
  v_mfma_f32_32x32x16_bf16 v[80:95], a[200:203], v[136:139], v[80:95]
  ds_read_b128 v[136:139], v9 offset:14336
  s_waitcnt lgkmcnt(3)
  v_mfma_f32_32x32x16_bf16 v[64:79], a[44:47], v[140:143], v[64:79]
  v_mfma_f32_32x32x16_bf16 v[80:95], a[204:207], v[140:143], v[80:95]
  ds_read_b128 v[140:143], v9 offset:15360
  s_waitcnt lgkmcnt(3)
  v_mfma_f32_32x32x16_bf16 v[64:79], a[48:51], v[128:131], v[64:79]
  v_mfma_f32_32x32x16_bf16 v[80:95], a[208:211], v[128:131], v[80:95]
  ds_read_b128 v[128:131], v9 offset:16384
  s_waitcnt lgkmcnt(3)
  v_mfma_f32_32x32x16_bf16 v[64:79], a[52:55], v[132:135], v[64:79]
  v_mfma_f32_32x32x16_bf16 v[80:95], a[212:215], v[132:135], v[80:95]
  ds_read_b128 v[132:135], v9 offset:17408
  s_waitcnt lgkmcnt(3)
  v_mfma_f32_32x32x16_bf16 v[64:79], a[56:59], v[136:139], v[64:79]
  v_mfma_f32_32x32x16_bf16 v[80:95], a[216:219], v[136:139], v[80:95]
  ds_read_b128 v[136:139], v9 offset:18432
  s_waitcnt lgkmcnt(3)
  v_mfma_f32_32x32x16_bf16 v[64:79], a[60:63], v[140:143], v[64:79]
  v_mfma_f32_32x32x16_bf16 v[80:95], a[220:223], v[140:143], v[80:95]
  ds_read_b128 v[140:143], v9 offset:19456
  s_waitcnt lgkmcnt(3)
  v_mfma_f32_32x32x16_bf16 v[64:79], a[64:67], v[128:131], v[64:79]
  v_mfma_f32_32x32x16_bf16 v[80:95], a[224:227], v[128:131], v[80:95]
  ds_read_b128 v[128:131], v9 offset:20480
  s_waitcnt lgkmcnt(3)
  v_mfma_f32_32x32x16_bf16 v[64:79], a[68:71], v[132:135], v[64:79]
  v_mfma_f32_32x32x16_bf16 v[80:95], a[228:231], v[132:135], v[80:95]
  ds_read_b128 v[132:135], v9 offset:21504
  s_waitcnt lgkmcnt(3)
  v_mfma_f32_32x32x16_bf16 v[64:79], a[72:75], v[136:139], v[64:79]
  v_mfma_f32_32x32x16_bf16 v[80:95], a[232:235], v[136:139], v[80:95]
  ds_read_b128 v[136:139], v9 offset:22528
  s_waitcnt lgkmcnt(3)
  v_mfma_f32_32x32x16_bf16 v[64:79], a[76:79], v[140:143], v[64:79]
  v_mfma_f32_32x32x16_bf16 v[80:95], a[236:239], v[140:143], v[80:95]
  ds_read_b128 v[140:143], v9 offset:23552
  s_waitcnt lgkmcnt(3)
  v_mfma_f32_32x32x16_bf16 v[64:79], a[80:83], v[128:131], v[64:79]
  v_mfma_f32_32x32x16_bf16 v[80:95], a[240:243], v[128:131], v[80:95]
  ds_read_b128 v[128:131], v9 offset:24576
  s_waitcnt lgkmcnt(3)
  v_mfma_f32_32x32x16_bf16 v[64:79], a[84:87], v[132:135], v[64:79]
  v_mfma_f32_32x32x16_bf16 v[80:95], a[244:247], v[132:135], v[80:95]
  ds_read_b128 v[132:135], v9 offset:25600
  s_waitcnt lgkmcnt(3)
  v_mfma_f32_32x32x16_bf16 v[64:79], a[88:91], v[136:139], v[64:79]
  v_mfma_f32_32x32x16_bf16 v[80:95], a[248:251], v[136:139], v[80:95]
  ds_read_b128 v[136:139], v9 offset:26624
  s_waitcnt lgkmcnt(3)
  v_mfma_f32_32x32x16_bf16 v[64:79], a[92:95], v[140:143], v[64:79]
  v_mfma_f32_32x32x16_bf16 v[80:95], a[252:255], v[140:143], v[80:95]
  ds_read_b128 v[140:143], v9 offset:27648
  s_waitcnt vmcnt(10)
  s_barrier
  s_cmp_eq_u32 s21, 0
  s_cbranch_scc0 mp_58
  v_mov_b32 v13, s50
  s_mov_b64 s[24:25], exec
  s_mov_b64 exec, 1
  buffer_store_dword v13, v12, s[8:11], 0 offen sc1
  s_mov_b64 exec, s[24:25]
mp_58:
  s_waitcnt lgkmcnt(3)
  v_mfma_f32_32x32x16_bf16 v[64:79], a[96:99], v[128:131], v[64:79]
  v_mfma_f32_32x32x16_bf16 v[80:95], v[192:195], v[128:131], v[80:95]
  ds_read_b128 v[128:131], v9 offset:28672
  s_waitcnt lgkmcnt(3)
  v_mfma_f32_32x32x16_bf16 v[64:79], a[100:103], v[132:135], v[64:79]
  v_mfma_f32_32x32x16_bf16 v[80:95], v[196:199], v[132:135], v[80:95]
  ds_read_b128 v[132:135], v9 offset:29696
  s_waitcnt lgkmcnt(3)
  v_mfma_f32_32x32x16_bf16 v[64:79], a[104:107], v[136:139], v[64:79]
  v_mfma_f32_32x32x16_bf16 v[80:95], v[200:203], v[136:139], v[80:95]
  ds_read_b128 v[136:139], v9 offset:30720
  s_waitcnt lgkmcnt(3)
  v_mfma_f32_32x32x16_bf16 v[64:79], a[108:111], v[140:143], v[64:79]
  v_mfma_f32_32x32x16_bf16 v[80:95], v[204:207], v[140:143], v[80:95]
  ds_read_b128 v[140:143], v9 offset:31744
  s_waitcnt lgkmcnt(3)
  v_mfma_f32_32x32x16_bf16 v[64:79], a[112:115], v[128:131], v[64:79]
  v_mfma_f32_32x32x16_bf16 v[80:95], v[208:211], v[128:131], v[80:95]
  ds_read_b128 v[128:131], v9 offset:32768
  s_waitcnt lgkmcnt(3)
  v_mfma_f32_32x32x16_bf16 v[64:79], a[116:119], v[132:135], v[64:79]
  v_mfma_f32_32x32x16_bf16 v[80:95], v[212:215], v[132:135], v[80:95]
  ds_read_b128 v[132:135], v9 offset:33792
  s_waitcnt lgkmcnt(3)
  v_mfma_f32_32x32x16_bf16 v[64:79], a[120:123], v[136:139], v[64:79]
  v_mfma_f32_32x32x16_bf16 v[80:95], v[216:219], v[136:139], v[80:95]
  ds_read_b128 v[136:139], v9 offset:34816
  s_waitcnt lgkmcnt(3)
  v_mfma_f32_32x32x16_bf16 v[64:79], a[124:127], v[140:143], v[64:79]
  v_mfma_f32_32x32x16_bf16 v[80:95], v[220:223], v[140:143], v[80:95]
  ds_read_b128 v[140:143], v9 offset:35840
  s_waitcnt lgkmcnt(3)
  v_mfma_f32_32x32x16_bf16 v[64:79], a[128:131], v[128:131], v[64:79]
  v_mfma_f32_32x32x16_bf16 v[80:95], v[224:227], v[128:131], v[80:95]
  ds_read_b128 v[128:131], v9 offset:36864
  s_waitcnt lgkmcnt(3)
  v_mfma_f32_32x32x16_bf16 v[64:79], a[132:135], v[132:135], v[64:79]
  v_mfma_f32_32x32x16_bf16 v[80:95], v[228:231], v[132:135], v[80:95]
  ds_read_b128 v[132:135], v9 offset:37888
  s_waitcnt lgkmcnt(3)
  v_mfma_f32_32x32x16_bf16 v[64:79], a[136:139], v[136:139], v[64:79]
  v_mfma_f32_32x32x16_bf16 v[80:95], v[232:235], v[136:139], v[80:95]
  ds_read_b128 v[136:139], v9 offset:38912
  s_waitcnt lgkmcnt(3)
  v_mfma_f32_32x32x16_bf16 v[64:79], a[140:143], v[140:143], v[64:79]
  v_mfma_f32_32x32x16_bf16 v[80:95], v[236:239], v[140:143], v[80:95]
  ds_read_b128 v[140:143], v9 offset:39936
  s_waitcnt lgkmcnt(3)
  v_mfma_f32_32x32x16_bf16 v[64:79], a[144:147], v[128:131], v[64:79]
  v_mfma_f32_32x32x16_bf16 v[80:95], v[240:243], v[128:131], v[80:95]
  s_waitcnt lgkmcnt(2)
  v_mfma_f32_32x32x16_bf16 v[64:79], a[148:151], v[132:135], v[64:79]
  v_mfma_f32_32x32x16_bf16 v[80:95], v[244:247], v[132:135], v[80:95]
  s_waitcnt lgkmcnt(1)
  v_mfma_f32_32x32x16_bf16 v[64:79], a[152:155], v[136:139], v[64:79]
  v_mfma_f32_32x32x16_bf16 v[80:95], v[248:251], v[136:139], v[80:95]
  s_waitcnt lgkmcnt(0)
  v_mfma_f32_32x32x16_bf16 v[64:79], a[156:159], v[140:143], v[64:79]
  v_mfma_f32_32x32x16_bf16 v[80:95], v[252:255], v[140:143], v[80:95]
  s_nop 11
  v_cvt_pk_bf16_f32 v144, v64, v65
  v_cvt_pk_bf16_f32 v145, v66, v67
  v_cvt_pk_bf16_f32 v146, v68, v69
  v_cvt_pk_bf16_f32 v147, v70, v71
  v_cvt_pk_bf16_f32 v148, v72, v73
  v_cvt_pk_bf16_f32 v149, v74, v75
  v_cvt_pk_bf16_f32 v150, v76, v77
  v_cvt_pk_bf16_f32 v151, v78, v79
  v_cvt_pk_bf16_f32 v152, v80, v81
  v_cvt_pk_bf16_f32 v153, v82, v83
  v_cvt_pk_bf16_f32 v154, v84, v85
  v_cvt_pk_bf16_f32 v155, v86, v87
  v_cvt_pk_bf16_f32 v156, v88, v89
  v_cvt_pk_bf16_f32 v157, v90, v91
  v_cvt_pk_bf16_f32 v158, v92, v93
  v_cvt_pk_bf16_f32 v159, v94, v95
  s_mul_i32 s28, s50, 12288
  s_add_u32 s29, s28, s48
  buffer_store_dwordx4 v[144:147], v11, s[8:11], s29 offen offset:0 sc1
  buffer_store_dwordx4 v[148:151], v11, s[8:11], s29 offen offset:256 sc1
  s_add_u32 s29, s28, s49
  buffer_store_dwordx4 v[152:155], v11, s[8:11], s29 offen offset:0 sc1
  buffer_store_dwordx4 v[156:159], v11, s[8:11], s29 offen offset:256 sc1
  s_add_u32 s50, s50, 1
  s_waitcnt vmcnt(4)
  s_barrier
  s_cmp_ge_u32 s50, 63
  s_cbranch_scc1 qn_59_n
  s_lshl_b32 s29, s21, 10
  s_add_u32 m0, s29, 122880
  s_add_u32 s28, s51, 0
  buffer_load_dwordx4 v6, s[8:11], s28 offen sc1 lds
  s_lshl_b32 s29, s21, 10
  s_add_u32 m0, s29, 126976
  s_add_u32 s28, s51, 4096
  buffer_load_dwordx4 v6, s[8:11], s28 offen sc1 lds
  s_lshl_b32 s29, s21, 10
  s_add_u32 m0, s29, 131072
  s_add_u32 s28, s51, 8192
  buffer_load_dwordx4 v6, s[8:11], s28 offen sc1 lds
  s_lshl_b32 s29, s21, 10
  s_add_u32 m0, s29, 135168
  s_add_u32 s28, s51, 12288
  buffer_load_dwordx4 v6, s[8:11], s28 offen sc1 lds
  s_lshl_b32 s29, s21, 10
  s_add_u32 m0, s29, 139264
  s_add_u32 s28, s51, 16384
  buffer_load_dwordx4 v6, s[8:11], s28 offen sc1 lds
  s_lshl_b32 s29, s21, 10
  s_add_u32 m0, s29, 143360
  s_add_u32 s28, s51, 20480
  buffer_load_dwordx4 v6, s[8:11], s28 offen sc1 lds
  s_lshl_b32 s29, s21, 10
  s_add_u32 m0, s29, 147456
  s_add_u32 s28, s51, 24576
  buffer_load_dwordx4 v6, s[8:11], s28 offen sc1 lds
  s_lshl_b32 s29, s21, 10
  s_add_u32 m0, s29, 151552
  s_add_u32 s28, s51, 28672
  buffer_load_dwordx4 v6, s[8:11], s28 offen sc1 lds
  s_lshl_b32 s29, s21, 10
  s_add_u32 m0, s29, 155648
  s_add_u32 s28, s51, 32768
  buffer_load_dwordx4 v6, s[8:11], s28 offen sc1 lds
  s_lshl_b32 s29, s21, 10
  s_add_u32 m0, s29, 159744
  s_add_u32 s28, s51, 36864
  buffer_load_dwordx4 v6, s[8:11], s28 offen sc1 lds
  s_add_u32 s51, s51, 40960
  s_branch qn_59
qn_59_n:
  s_waitcnt vmcnt(0)
qn_59:
  ds_read_b128 v[128:131], v10 offset:0
  ds_read_b128 v[132:135], v10 offset:1024
  ds_read_b128 v[136:139], v10 offset:2048
  ds_read_b128 v[140:143], v10 offset:3072
  s_waitcnt lgkmcnt(3)
  v_mfma_f32_32x32x16_bf16 v[64:79], a[0:3], v[128:131], 0
  v_mfma_f32_32x32x16_bf16 v[80:95], a[160:163], v[128:131], 0
  ds_read_b128 v[128:131], v10 offset:4096
  s_waitcnt lgkmcnt(3)
  v_mfma_f32_32x32x16_bf16 v[64:79], a[4:7], v[132:135], v[64:79]
  v_mfma_f32_32x32x16_bf16 v[80:95], a[164:167], v[132:135], v[80:95]
  ds_read_b128 v[132:135], v10 offset:5120
  s_waitcnt lgkmcnt(3)
  v_mfma_f32_32x32x16_bf16 v[64:79], a[8:11], v[136:139], v[64:79]
  v_mfma_f32_32x32x16_bf16 v[80:95], a[168:171], v[136:139], v[80:95]
  ds_read_b128 v[136:139], v10 offset:6144
  s_waitcnt lgkmcnt(3)
  v_mfma_f32_32x32x16_bf16 v[64:79], a[12:15], v[140:143], v[64:79]
  v_mfma_f32_32x32x16_bf16 v[80:95], a[172:175], v[140:143], v[80:95]
  ds_read_b128 v[140:143], v10 offset:7168
  s_waitcnt lgkmcnt(3)
  v_mfma_f32_32x32x16_bf16 v[64:79], a[16:19], v[128:131], v[64:79]
  v_mfma_f32_32x32x16_bf16 v[80:95], a[176:179], v[128:131], v[80:95]
  ds_read_b128 v[128:131], v10 offset:8192
  s_waitcnt lgkmcnt(3)
  v_mfma_f32_32x32x16_bf16 v[64:79], a[20:23], v[132:135], v[64:79]
  v_mfma_f32_32x32x16_bf16 v[80:95], a[180:183], v[132:135], v[80:95]
  ds_read_b128 v[132:135], v10 offset:9216
  s_waitcnt lgkmcnt(3)
  v_mfma_f32_32x32x16_bf16 v[64:79], a[24:27], v[136:139], v[64:79]
  v_mfma_f32_32x32x16_bf16 v[80:95], a[184:187], v[136:139], v[80:95]
  ds_read_b128 v[136:139], v10 offset:10240
  s_waitcnt lgkmcnt(3)
  v_mfma_f32_32x32x16_bf16 v[64:79], a[28:31], v[140:143], v[64:79]
  v_mfma_f32_32x32x16_bf16 v[80:95], a[188:191], v[140:143], v[80:95]
  ds_read_b128 v[140:143], v10 offset:11264
  s_waitcnt lgkmcnt(3)
  v_mfma_f32_32x32x16_bf16 v[64:79], a[32:35], v[128:131], v[64:79]
  v_mfma_f32_32x32x16_bf16 v[80:95], a[192:195], v[128:131], v[80:95]
  ds_read_b128 v[128:131], v10 offset:12288
  s_waitcnt lgkmcnt(3)
  v_mfma_f32_32x32x16_bf16 v[64:79], a[36:39], v[132:135], v[64:79]
  v_mfma_f32_32x32x16_bf16 v[80:95], a[196:199], v[132:135], v[80:95]
  ds_read_b128 v[132:135], v10 offset:13312
  s_waitcnt lgkmcnt(3)
  v_mfma_f32_32x32x16_bf16 v[64:79], a[40:43], v[136:139], v[64:79]
  v_mfma_f32_32x32x16_bf16 v[80:95], a[200:203], v[136:139], v[80:95]
  ds_read_b128 v[136:139], v10 offset:14336
  s_waitcnt lgkmcnt(3)
  v_mfma_f32_32x32x16_bf16 v[64:79], a[44:47], v[140:143], v[64:79]
  v_mfma_f32_32x32x16_bf16 v[80:95], a[204:207], v[140:143], v[80:95]
  ds_read_b128 v[140:143], v10 offset:15360
  s_waitcnt lgkmcnt(3)
  v_mfma_f32_32x32x16_bf16 v[64:79], a[48:51], v[128:131], v[64:79]
  v_mfma_f32_32x32x16_bf16 v[80:95], a[208:211], v[128:131], v[80:95]
  ds_read_b128 v[128:131], v10 offset:16384
  s_waitcnt lgkmcnt(3)
  v_mfma_f32_32x32x16_bf16 v[64:79], a[52:55], v[132:135], v[64:79]
  v_mfma_f32_32x32x16_bf16 v[80:95], a[212:215], v[132:135], v[80:95]
  ds_read_b128 v[132:135], v10 offset:17408
  s_waitcnt lgkmcnt(3)
  v_mfma_f32_32x32x16_bf16 v[64:79], a[56:59], v[136:139], v[64:79]
  v_mfma_f32_32x32x16_bf16 v[80:95], a[216:219], v[136:139], v[80:95]
  ds_read_b128 v[136:139], v10 offset:18432
  s_waitcnt lgkmcnt(3)
  v_mfma_f32_32x32x16_bf16 v[64:79], a[60:63], v[140:143], v[64:79]
  v_mfma_f32_32x32x16_bf16 v[80:95], a[220:223], v[140:143], v[80:95]
  ds_read_b128 v[140:143], v10 offset:19456
  s_waitcnt lgkmcnt(3)
  v_mfma_f32_32x32x16_bf16 v[64:79], a[64:67], v[128:131], v[64:79]
  v_mfma_f32_32x32x16_bf16 v[80:95], a[224:227], v[128:131], v[80:95]
  ds_read_b128 v[128:131], v10 offset:20480
  s_waitcnt lgkmcnt(3)
  v_mfma_f32_32x32x16_bf16 v[64:79], a[68:71], v[132:135], v[64:79]
  v_mfma_f32_32x32x16_bf16 v[80:95], a[228:231], v[132:135], v[80:95]
  ds_read_b128 v[132:135], v10 offset:21504
  s_waitcnt lgkmcnt(3)
  v_mfma_f32_32x32x16_bf16 v[64:79], a[72:75], v[136:139], v[64:79]
  v_mfma_f32_32x32x16_bf16 v[80:95], a[232:235], v[136:139], v[80:95]
  ds_read_b128 v[136:139], v10 offset:22528
  s_waitcnt lgkmcnt(3)
  v_mfma_f32_32x32x16_bf16 v[64:79], a[76:79], v[140:143], v[64:79]
  v_mfma_f32_32x32x16_bf16 v[80:95], a[236:239], v[140:143], v[80:95]
  ds_read_b128 v[140:143], v10 offset:23552
  s_waitcnt lgkmcnt(3)
  v_mfma_f32_32x32x16_bf16 v[64:79], a[80:83], v[128:131], v[64:79]
  v_mfma_f32_32x32x16_bf16 v[80:95], a[240:243], v[128:131], v[80:95]
  ds_read_b128 v[128:131], v10 offset:24576
  s_waitcnt lgkmcnt(3)
  v_mfma_f32_32x32x16_bf16 v[64:79], a[84:87], v[132:135], v[64:79]
  v_mfma_f32_32x32x16_bf16 v[80:95], a[244:247], v[132:135], v[80:95]
  ds_read_b128 v[132:135], v10 offset:25600
  s_waitcnt lgkmcnt(3)
  v_mfma_f32_32x32x16_bf16 v[64:79], a[88:91], v[136:139], v[64:79]
  v_mfma_f32_32x32x16_bf16 v[80:95], a[248:251], v[136:139], v[80:95]
  ds_read_b128 v[136:139], v10 offset:26624
  s_waitcnt lgkmcnt(3)
  v_mfma_f32_32x32x16_bf16 v[64:79], a[92:95], v[140:143], v[64:79]
  v_mfma_f32_32x32x16_bf16 v[80:95], a[252:255], v[140:143], v[80:95]
  ds_read_b128 v[140:143], v10 offset:27648
  s_waitcnt vmcnt(10)
  s_barrier
  s_cmp_eq_u32 s21, 0
  s_cbranch_scc0 mp_60
  v_mov_b32 v13, s50
  s_mov_b64 s[24:25], exec
  s_mov_b64 exec, 1
  buffer_store_dword v13, v12, s[8:11], 0 offen sc1
  s_mov_b64 exec, s[24:25]
mp_60:
  s_waitcnt lgkmcnt(3)
  v_mfma_f32_32x32x16_bf16 v[64:79], a[96:99], v[128:131], v[64:79]
  v_mfma_f32_32x32x16_bf16 v[80:95], v[192:195], v[128:131], v[80:95]
  ds_read_b128 v[128:131], v10 offset:28672
  s_waitcnt lgkmcnt(3)
  v_mfma_f32_32x32x16_bf16 v[64:79], a[100:103], v[132:135], v[64:79]
  v_mfma_f32_32x32x16_bf16 v[80:95], v[196:199], v[132:135], v[80:95]
  ds_read_b128 v[132:135], v10 offset:29696
  s_waitcnt lgkmcnt(3)
  v_mfma_f32_32x32x16_bf16 v[64:79], a[104:107], v[136:139], v[64:79]
  v_mfma_f32_32x32x16_bf16 v[80:95], v[200:203], v[136:139], v[80:95]
  ds_read_b128 v[136:139], v10 offset:30720
  s_waitcnt lgkmcnt(3)
  v_mfma_f32_32x32x16_bf16 v[64:79], a[108:111], v[140:143], v[64:79]
  v_mfma_f32_32x32x16_bf16 v[80:95], v[204:207], v[140:143], v[80:95]
  ds_read_b128 v[140:143], v10 offset:31744
  s_waitcnt lgkmcnt(3)
  v_mfma_f32_32x32x16_bf16 v[64:79], a[112:115], v[128:131], v[64:79]
  v_mfma_f32_32x32x16_bf16 v[80:95], v[208:211], v[128:131], v[80:95]
  ds_read_b128 v[128:131], v10 offset:32768
  s_waitcnt lgkmcnt(3)
  v_mfma_f32_32x32x16_bf16 v[64:79], a[116:119], v[132:135], v[64:79]
  v_mfma_f32_32x32x16_bf16 v[80:95], v[212:215], v[132:135], v[80:95]
  ds_read_b128 v[132:135], v10 offset:33792
  s_waitcnt lgkmcnt(3)
  v_mfma_f32_32x32x16_bf16 v[64:79], a[120:123], v[136:139], v[64:79]
  v_mfma_f32_32x32x16_bf16 v[80:95], v[216:219], v[136:139], v[80:95]
  ds_read_b128 v[136:139], v10 offset:34816
  s_waitcnt lgkmcnt(3)
  v_mfma_f32_32x32x16_bf16 v[64:79], a[124:127], v[140:143], v[64:79]
  v_mfma_f32_32x32x16_bf16 v[80:95], v[220:223], v[140:143], v[80:95]
  ds_read_b128 v[140:143], v10 offset:35840
  s_waitcnt lgkmcnt(3)
  v_mfma_f32_32x32x16_bf16 v[64:79], a[128:131], v[128:131], v[64:79]
  v_mfma_f32_32x32x16_bf16 v[80:95], v[224:227], v[128:131], v[80:95]
  ds_read_b128 v[128:131], v10 offset:36864
  s_waitcnt lgkmcnt(3)
  v_mfma_f32_32x32x16_bf16 v[64:79], a[132:135], v[132:135], v[64:79]
  v_mfma_f32_32x32x16_bf16 v[80:95], v[228:231], v[132:135], v[80:95]
  ds_read_b128 v[132:135], v10 offset:37888
  s_waitcnt lgkmcnt(3)
  v_mfma_f32_32x32x16_bf16 v[64:79], a[136:139], v[136:139], v[64:79]
  v_mfma_f32_32x32x16_bf16 v[80:95], v[232:235], v[136:139], v[80:95]
  ds_read_b128 v[136:139], v10 offset:38912
  s_waitcnt lgkmcnt(3)
  v_mfma_f32_32x32x16_bf16 v[64:79], a[140:143], v[140:143], v[64:79]
  v_mfma_f32_32x32x16_bf16 v[80:95], v[236:239], v[140:143], v[80:95]
  ds_read_b128 v[140:143], v10 offset:39936
  s_waitcnt lgkmcnt(3)
  v_mfma_f32_32x32x16_bf16 v[64:79], a[144:147], v[128:131], v[64:79]
  v_mfma_f32_32x32x16_bf16 v[80:95], v[240:243], v[128:131], v[80:95]
  s_waitcnt lgkmcnt(2)
  v_mfma_f32_32x32x16_bf16 v[64:79], a[148:151], v[132:135], v[64:79]
  v_mfma_f32_32x32x16_bf16 v[80:95], v[244:247], v[132:135], v[80:95]
  s_waitcnt lgkmcnt(1)
  v_mfma_f32_32x32x16_bf16 v[64:79], a[152:155], v[136:139], v[64:79]
  v_mfma_f32_32x32x16_bf16 v[80:95], v[248:251], v[136:139], v[80:95]
  s_waitcnt lgkmcnt(0)
  v_mfma_f32_32x32x16_bf16 v[64:79], a[156:159], v[140:143], v[64:79]
  v_mfma_f32_32x32x16_bf16 v[80:95], v[252:255], v[140:143], v[80:95]
  s_nop 11
  v_cvt_pk_bf16_f32 v144, v64, v65
  v_cvt_pk_bf16_f32 v145, v66, v67
  v_cvt_pk_bf16_f32 v146, v68, v69
  v_cvt_pk_bf16_f32 v147, v70, v71
  v_cvt_pk_bf16_f32 v148, v72, v73
  v_cvt_pk_bf16_f32 v149, v74, v75
  v_cvt_pk_bf16_f32 v150, v76, v77
  v_cvt_pk_bf16_f32 v151, v78, v79
  v_cvt_pk_bf16_f32 v152, v80, v81
  v_cvt_pk_bf16_f32 v153, v82, v83
  v_cvt_pk_bf16_f32 v154, v84, v85
  v_cvt_pk_bf16_f32 v155, v86, v87
  v_cvt_pk_bf16_f32 v156, v88, v89
  v_cvt_pk_bf16_f32 v157, v90, v91
  v_cvt_pk_bf16_f32 v158, v92, v93
  v_cvt_pk_bf16_f32 v159, v94, v95
  s_mul_i32 s28, s50, 12288
  s_add_u32 s29, s28, s48
  buffer_store_dwordx4 v[144:147], v11, s[8:11], s29 offen offset:0 sc1
  buffer_store_dwordx4 v[148:151], v11, s[8:11], s29 offen offset:256 sc1
  s_add_u32 s29, s28, s49
  buffer_store_dwordx4 v[152:155], v11, s[8:11], s29 offen offset:0 sc1
  buffer_store_dwordx4 v[156:159], v11, s[8:11], s29 offen offset:256 sc1
  s_add_u32 s50, s50, 1
  s_cmp_lt_u32 s50, 64
  s_cbranch_scc1 ka_qkv_loop
  s_waitcnt vmcnt(0)
  s_barrier
  s_cmp_eq_u32 s21, 0
  s_cbranch_scc0 ka_exit
  v_mov_b32 v13, 64
  s_mov_b64 exec, 1
  buffer_store_dword v13, v12, s[8:11], 0 offen sc1
  s_waitcnt vmcnt(0)
  s_branch ka_exit
ka_u:
  s_mov_b32 s12, s42
  s_and_b32 s13, s43, 0xffff
  s_mov_b32 s14, 0x780000
  s_mov_b32 s15, 0x20000
  v_and_b32 v1, 63, v0
  v_lshrrev_b32 v2, 4, v1
  v_bfe_u32 v3, v1, 2, 2
  v_and_b32 v4, 3, v1
  s_lshl_b32 s28, s21, 3
  v_add_u32 v5, s28, v3
  v_mul_u32_u24 v5, 1280, v5
  v_lshlrev_b32 v6, 6, v2
  v_add_u32 v5, v5, v6
  v_lshlrev_b32 v6, 4, v4
  v_add_u32 v5, v5, v6
  v_lshrrev_b32 v6, 1, v2
  v_mul_u32_u24 v7, 20480, v6
  v_lshlrev_b32 v6, 6, v3
  v_add_u32 v7, v7, v6
  v_and_b32 v6, 1, v2
  v_lshlrev_b32 v6, 5, v6
  v_add_u32 v7, v7, v6
  v_lshrrev_b32 v6, 1, v4
  v_lshlrev_b32 v6, 4, v6
  v_add_u32 v7, v7, v6
  v_and_b32 v6, 1, v4
  v_lshlrev_b32 v6, 3, v6
  v_add_u32 v7, v7, v6
  s_mul_i32 s28, s21, 1280
  v_add_u32 v7, s28, v7
  s_mul_i32 s46, s23, 245760
  s_mul_i32 s29, s21, 10240
  s_add_u32 m0, s29, 0
  s_add_u32 s28, s46, 0
  buffer_load_dwordx4 v5, s[12:15], s28 offen lds
  s_mul_i32 s29, s21, 10240
  s_add_u32 m0, s29, 1024
  s_add_u32 s28, s46, 256
  buffer_load_dwordx4 v5, s[12:15], s28 offen lds
  s_mul_i32 s29, s21, 10240
  s_add_u32 m0, s29, 2048
  s_add_u32 s28, s46, 512
  buffer_load_dwordx4 v5, s[12:15], s28 offen lds
  s_mul_i32 s29, s21, 10240
  s_add_u32 m0, s29, 3072
  s_add_u32 s28, s46, 768
  buffer_load_dwordx4 v5, s[12:15], s28 offen lds
  s_mul_i32 s29, s21, 10240
  s_add_u32 m0, s29, 4096
  s_add_u32 s28, s46, 1024
  buffer_load_dwordx4 v5, s[12:15], s28 offen lds
  s_mul_i32 s29, s21, 10240
  s_add_u32 m0, s29, 5120
  s_add_u32 s28, s46, 5120
  buffer_load_dwordx4 v5, s[12:15], s28 offen lds
  s_mul_i32 s29, s21, 10240
  s_add_u32 m0, s29, 6144
  s_add_u32 s28, s46, 5376
  buffer_load_dwordx4 v5, s[12:15], s28 offen lds
  s_mul_i32 s29, s21, 10240
  s_add_u32 m0, s29, 7168
  s_add_u32 s28, s46, 5632
  buffer_load_dwordx4 v5, s[12:15], s28 offen lds
  s_mul_i32 s29, s21, 10240
  s_add_u32 m0, s29, 8192
  s_add_u32 s28, s46, 5888
  buffer_load_dwordx4 v5, s[12:15], s28 offen lds
  s_mul_i32 s29, s21, 10240
  s_add_u32 m0, s29, 9216
  s_add_u32 s28, s46, 6144
  buffer_load_dwordx4 v5, s[12:15], s28 offen lds
  s_mul_i32 s29, s21, 10240
  s_add_u32 m0, s29, 40960
  s_add_u32 s28, s46, 40960
  buffer_load_dwordx4 v5, s[12:15], s28 offen lds
  s_mul_i32 s29, s21, 10240
  s_add_u32 m0, s29, 41984
  s_add_u32 s28, s46, 41216
  buffer_load_dwordx4 v5, s[12:15], s28 offen lds
  s_mul_i32 s29, s21, 10240
  s_add_u32 m0, s29, 43008
  s_add_u32 s28, s46, 41472
  buffer_load_dwordx4 v5, s[12:15], s28 offen lds
  s_mul_i32 s29, s21, 10240
  s_add_u32 m0, s29, 44032
  s_add_u32 s28, s46, 41728
  buffer_load_dwordx4 v5, s[12:15], s28 offen lds
  s_mul_i32 s29, s21, 10240
  s_add_u32 m0, s29, 45056
  s_add_u32 s28, s46, 41984
  buffer_load_dwordx4 v5, s[12:15], s28 offen lds
  s_mul_i32 s29, s21, 10240
  s_add_u32 m0, s29, 46080
  s_add_u32 s28, s46, 46080
  buffer_load_dwordx4 v5, s[12:15], s28 offen lds
  s_mul_i32 s29, s21, 10240
  s_add_u32 m0, s29, 47104
  s_add_u32 s28, s46, 46336
  buffer_load_dwordx4 v5, s[12:15], s28 offen lds
  s_mul_i32 s29, s21, 10240
  s_add_u32 m0, s29, 48128
  s_add_u32 s28, s46, 46592
  buffer_load_dwordx4 v5, s[12:15], s28 offen lds
  s_mul_i32 s29, s21, 10240
  s_add_u32 m0, s29, 49152
  s_add_u32 s28, s46, 46848
  buffer_load_dwordx4 v5, s[12:15], s28 offen lds
  s_mul_i32 s29, s21, 10240
  s_add_u32 m0, s29, 50176
  s_add_u32 s28, s46, 47104
  buffer_load_dwordx4 v5, s[12:15], s28 offen lds
  s_waitcnt vmcnt(10)
  s_cmp_eq_u32 s21, 3
  s_cbranch_scc0 lna_61
  s_mov_b64 s[24:25], exec
  s_mov_b64 exec, 1
  v_mov_b32 v2, 4992
  v_mov_b32 v3, 1
  buffer_atomic_add v3, v2, s[8:11], 0 offen
  s_mov_b64 exec, s[24:25]
lna_61:
  s_barrier
  s_mul_i32 s29, s21, 10240
  s_add_u32 m0, s29, 81920
  s_add_u32 s28, s46, 81920
  buffer_load_dwordx4 v5, s[12:15], s28 offen lds
  s_mul_i32 s29, s21, 10240
  s_add_u32 m0, s29, 82944
  s_add_u32 s28, s46, 82176
  buffer_load_dwordx4 v5, s[12:15], s28 offen lds
  s_mul_i32 s29, s21, 10240
  s_add_u32 m0, s29, 83968
  s_add_u32 s28, s46, 82432
  buffer_load_dwordx4 v5, s[12:15], s28 offen lds
  s_mul_i32 s29, s21, 10240
  s_add_u32 m0, s29, 84992
  s_add_u32 s28, s46, 82688
  buffer_load_dwordx4 v5, s[12:15], s28 offen lds
  s_mul_i32 s29, s21, 10240
  s_add_u32 m0, s29, 86016
  s_add_u32 s28, s46, 82944
  buffer_load_dwordx4 v5, s[12:15], s28 offen lds
  s_mul_i32 s29, s21, 10240
  s_add_u32 m0, s29, 87040
  s_add_u32 s28, s46, 87040
  buffer_load_dwordx4 v5, s[12:15], s28 offen lds
  s_mul_i32 s29, s21, 10240
  s_add_u32 m0, s29, 88064
  s_add_u32 s28, s46, 87296
  buffer_load_dwordx4 v5, s[12:15], s28 offen lds
  s_mul_i32 s29, s21, 10240
  s_add_u32 m0, s29, 89088
  s_add_u32 s28, s46, 87552
  buffer_load_dwordx4 v5, s[12:15], s28 offen lds
  s_mul_i32 s29, s21, 10240
  s_add_u32 m0, s29, 90112
  s_add_u32 s28, s46, 87808
  buffer_load_dwordx4 v5, s[12:15], s28 offen lds
  s_mul_i32 s29, s21, 10240
  s_add_u32 m0, s29, 91136
  s_add_u32 s28, s46, 88064
  buffer_load_dwordx4 v5, s[12:15], s28 offen lds
  v_add_u32 v8, 0, v7
  ds_read_b64_tr_b16 a[0:1], v8 offset:0
  ds_read_b64_tr_b16 a[2:3], v8 offset:10240
  ds_read_b64_tr_b16 a[4:5], v8 offset:5120
  ds_read_b64_tr_b16 a[6:7], v8 offset:15360
  ds_read_b64_tr_b16 a[48:49], v8 offset:256
  ds_read_b64_tr_b16 a[50:51], v8 offset:10496
  ds_read_b64_tr_b16 a[52:53], v8 offset:5376
  ds_read_b64_tr_b16 a[54:55], v8 offset:15616
  ds_read_b64_tr_b16 a[96:97], v8 offset:512
  ds_read_b64_tr_b16 a[98:99], v8 offset:10752
  ds_read_b64_tr_b16 a[100:101], v8 offset:5632
  ds_read_b64_tr_b16 a[102:103], v8 offset:15872
  s_waitcnt lgkmcnt(0)
  ds_read_b64_tr_b16 a[144:145], v8 offset:768
  ds_read_b64_tr_b16 a[146:147], v8 offset:11008
  ds_read_b64_tr_b16 a[148:149], v8 offset:5888
  ds_read_b64_tr_b16 a[150:151], v8 offset:16128
  ds_read_b64_tr_b16 a[192:193], v8 offset:1024
  ds_read_b64_tr_b16 a[194:195], v8 offset:11264
  ds_read_b64_tr_b16 a[196:197], v8 offset:6144
  ds_read_b64_tr_b16 a[198:199], v8 offset:16384
  s_waitcnt lgkmcnt(0)
  s_waitcnt vmcnt(10)
  s_barrier
  s_mul_i32 s29, s21, 10240
  s_add_u32 m0, s29, 0
  s_add_u32 s28, s46, 122880
  buffer_load_dwordx4 v5, s[12:15], s28 offen lds
  s_mul_i32 s29, s21, 10240
  s_add_u32 m0, s29, 1024
  s_add_u32 s28, s46, 123136
  buffer_load_dwordx4 v5, s[12:15], s28 offen lds
  s_mul_i32 s29, s21, 10240
  s_add_u32 m0, s29, 2048
  s_add_u32 s28, s46, 123392
  buffer_load_dwordx4 v5, s[12:15], s28 offen lds
  s_mul_i32 s29, s21, 10240
  s_add_u32 m0, s29, 3072
  s_add_u32 s28, s46, 123648
  buffer_load_dwordx4 v5, s[12:15], s28 offen lds
  s_mul_i32 s29, s21, 10240
  s_add_u32 m0, s29, 4096
  s_add_u32 s28, s46, 123904
  buffer_load_dwordx4 v5, s[12:15], s28 offen lds
  s_mul_i32 s29, s21, 10240
  s_add_u32 m0, s29, 5120
  s_add_u32 s28, s46, 128000
  buffer_load_dwordx4 v5, s[12:15], s28 offen lds
  s_mul_i32 s29, s21, 10240
  s_add_u32 m0, s29, 6144
  s_add_u32 s28, s46, 128256
  buffer_load_dwordx4 v5, s[12:15], s28 offen lds
  s_mul_i32 s29, s21, 10240
  s_add_u32 m0, s29, 7168
  s_add_u32 s28, s46, 128512
  buffer_load_dwordx4 v5, s[12:15], s28 offen lds
  s_mul_i32 s29, s21, 10240
  s_add_u32 m0, s29, 8192
  s_add_u32 s28, s46, 128768
  buffer_load_dwordx4 v5, s[12:15], s28 offen lds
  s_mul_i32 s29, s21, 10240
  s_add_u32 m0, s29, 9216
  s_add_u32 s28, s46, 129024
  buffer_load_dwordx4 v5, s[12:15], s28 offen lds
  v_add_u32 v8, 40960, v7
  ds_read_b64_tr_b16 a[8:9], v8 offset:0
  ds_read_b64_tr_b16 a[10:11], v8 offset:10240
  ds_read_b64_tr_b16 a[12:13], v8 offset:5120
  ds_read_b64_tr_b16 a[14:15], v8 offset:15360
  ds_read_b64_tr_b16 a[56:57], v8 offset:256
  ds_read_b64_tr_b16 a[58:59], v8 offset:10496
  ds_read_b64_tr_b16 a[60:61], v8 offset:5376
  ds_read_b64_tr_b16 a[62:63], v8 offset:15616
  ds_read_b64_tr_b16 a[104:105], v8 offset:512
  ds_read_b64_tr_b16 a[106:107], v8 offset:10752
  ds_read_b64_tr_b16 a[108:109], v8 offset:5632
  ds_read_b64_tr_b16 a[110:111], v8 offset:15872
  s_waitcnt lgkmcnt(0)
  ds_read_b64_tr_b16 a[152:153], v8 offset:768
  ds_read_b64_tr_b16 a[154:155], v8 offset:11008
  ds_read_b64_tr_b16 a[156:157], v8 offset:5888
  ds_read_b64_tr_b16 a[158:159], v8 offset:16128
  ds_read_b64_tr_b16 a[200:201], v8 offset:1024
  ds_read_b64_tr_b16 a[202:203], v8 offset:11264
  ds_read_b64_tr_b16 a[204:205], v8 offset:6144
  ds_read_b64_tr_b16 a[206:207], v8 offset:16384
  s_waitcnt lgkmcnt(0)
  s_waitcnt vmcnt(10)
  s_barrier
  s_mul_i32 s29, s21, 10240
  s_add_u32 m0, s29, 40960
  s_add_u32 s28, s46, 163840
  buffer_load_dwordx4 v5, s[12:15], s28 offen lds
  s_mul_i32 s29, s21, 10240
  s_add_u32 m0, s29, 41984
  s_add_u32 s28, s46, 164096
  buffer_load_dwordx4 v5, s[12:15], s28 offen lds
  s_mul_i32 s29, s21, 10240
  s_add_u32 m0, s29, 43008
  s_add_u32 s28, s46, 164352
  buffer_load_dwordx4 v5, s[12:15], s28 offen lds
  s_mul_i32 s29, s21, 10240
  s_add_u32 m0, s29, 44032
  s_add_u32 s28, s46, 164608
  buffer_load_dwordx4 v5, s[12:15], s28 offen lds
  s_mul_i32 s29, s21, 10240
  s_add_u32 m0, s29, 45056
  s_add_u32 s28, s46, 164864
  buffer_load_dwordx4 v5, s[12:15], s28 offen lds
  s_mul_i32 s29, s21, 10240
  s_add_u32 m0, s29, 46080
  s_add_u32 s28, s46, 168960
  buffer_load_dwordx4 v5, s[12:15], s28 offen lds
  s_mul_i32 s29, s21, 10240
  s_add_u32 m0, s29, 47104
  s_add_u32 s28, s46, 169216
  buffer_load_dwordx4 v5, s[12:15], s28 offen lds
  s_mul_i32 s29, s21, 10240
  s_add_u32 m0, s29, 48128
  s_add_u32 s28, s46, 169472
  buffer_load_dwordx4 v5, s[12:15], s28 offen lds
  s_mul_i32 s29, s21, 10240
  s_add_u32 m0, s29, 49152
  s_add_u32 s28, s46, 169728
  buffer_load_dwordx4 v5, s[12:15], s28 offen lds
  s_mul_i32 s29, s21, 10240
  s_add_u32 m0, s29, 50176
  s_add_u32 s28, s46, 169984
  buffer_load_dwordx4 v5, s[12:15], s28 offen lds
  v_add_u32 v8, 81920, v7
  ds_read_b64_tr_b16 a[16:17], v8 offset:0
  ds_read_b64_tr_b16 a[18:19], v8 offset:10240
  ds_read_b64_tr_b16 a[20:21], v8 offset:5120
  ds_read_b64_tr_b16 a[22:23], v8 offset:15360
  ds_read_b64_tr_b16 a[64:65], v8 offset:256
  ds_read_b64_tr_b16 a[66:67], v8 offset:10496
  ds_read_b64_tr_b16 a[68:69], v8 offset:5376
  ds_read_b64_tr_b16 a[70:71], v8 offset:15616
  ds_read_b64_tr_b16 a[112:113], v8 offset:512
  ds_read_b64_tr_b16 a[114:115], v8 offset:10752
  ds_read_b64_tr_b16 a[116:117], v8 offset:5632
  ds_read_b64_tr_b16 a[118:119], v8 offset:15872
  s_waitcnt lgkmcnt(0)
  ds_read_b64_tr_b16 a[160:161], v8 offset:768
  ds_read_b64_tr_b16 a[162:163], v8 offset:11008
  ds_read_b64_tr_b16 a[164:165], v8 offset:5888
  ds_read_b64_tr_b16 a[166:167], v8 offset:16128
  ds_read_b64_tr_b16 a[208:209], v8 offset:1024
  ds_read_b64_tr_b16 a[210:211], v8 offset:11264
  ds_read_b64_tr_b16 a[212:213], v8 offset:6144
  ds_read_b64_tr_b16 a[214:215], v8 offset:16384
  s_waitcnt lgkmcnt(0)
  s_waitcnt vmcnt(10)
  s_barrier
  s_mul_i32 s29, s21, 10240
  s_add_u32 m0, s29, 81920
  s_add_u32 s28, s46, 204800
  buffer_load_dwordx4 v5, s[12:15], s28 offen lds
  s_mul_i32 s29, s21, 10240
  s_add_u32 m0, s29, 82944
  s_add_u32 s28, s46, 205056
  buffer_load_dwordx4 v5, s[12:15], s28 offen lds
  s_mul_i32 s29, s21, 10240
  s_add_u32 m0, s29, 83968
  s_add_u32 s28, s46, 205312
  buffer_load_dwordx4 v5, s[12:15], s28 offen lds
  s_mul_i32 s29, s21, 10240
  s_add_u32 m0, s29, 84992
  s_add_u32 s28, s46, 205568
  buffer_load_dwordx4 v5, s[12:15], s28 offen lds
  s_mul_i32 s29, s21, 10240
  s_add_u32 m0, s29, 86016
  s_add_u32 s28, s46, 205824
  buffer_load_dwordx4 v5, s[12:15], s28 offen lds
  s_mul_i32 s29, s21, 10240
  s_add_u32 m0, s29, 87040
  s_add_u32 s28, s46, 209920
  buffer_load_dwordx4 v5, s[12:15], s28 offen lds
  s_mul_i32 s29, s21, 10240
  s_add_u32 m0, s29, 88064
  s_add_u32 s28, s46, 210176
  buffer_load_dwordx4 v5, s[12:15], s28 offen lds
  s_mul_i32 s29, s21, 10240
  s_add_u32 m0, s29, 89088
  s_add_u32 s28, s46, 210432
  buffer_load_dwordx4 v5, s[12:15], s28 offen lds
  s_mul_i32 s29, s21, 10240
  s_add_u32 m0, s29, 90112
  s_add_u32 s28, s46, 210688
  buffer_load_dwordx4 v5, s[12:15], s28 offen lds
  s_mul_i32 s29, s21, 10240
  s_add_u32 m0, s29, 91136
  s_add_u32 s28, s46, 210944
  buffer_load_dwordx4 v5, s[12:15], s28 offen lds
  v_add_u32 v8, 0, v7
  ds_read_b64_tr_b16 a[24:25], v8 offset:0
  ds_read_b64_tr_b16 a[26:27], v8 offset:10240
  ds_read_b64_tr_b16 a[28:29], v8 offset:5120
  ds_read_b64_tr_b16 a[30:31], v8 offset:15360
  ds_read_b64_tr_b16 a[72:73], v8 offset:256
  ds_read_b64_tr_b16 a[74:75], v8 offset:10496
  ds_read_b64_tr_b16 a[76:77], v8 offset:5376
  ds_read_b64_tr_b16 a[78:79], v8 offset:15616
  ds_read_b64_tr_b16 a[120:121], v8 offset:512
  ds_read_b64_tr_b16 a[122:123], v8 offset:10752
  ds_read_b64_tr_b16 a[124:125], v8 offset:5632
  ds_read_b64_tr_b16 a[126:127], v8 offset:15872
  s_waitcnt lgkmcnt(0)
  ds_read_b64_tr_b16 a[168:169], v8 offset:768
  ds_read_b64_tr_b16 a[170:171], v8 offset:11008
  ds_read_b64_tr_b16 a[172:173], v8 offset:5888
  ds_read_b64_tr_b16 a[174:175], v8 offset:16128
  ds_read_b64_tr_b16 a[216:217], v8 offset:1024
  ds_read_b64_tr_b16 a[218:219], v8 offset:11264
  ds_read_b64_tr_b16 a[220:221], v8 offset:6144
  ds_read_b64_tr_b16 a[222:223], v8 offset:16384
  s_waitcnt lgkmcnt(0)
  s_waitcnt vmcnt(10)
  s_barrier
  v_add_u32 v8, 40960, v7
  ds_read_b64_tr_b16 a[32:33], v8 offset:0
  ds_read_b64_tr_b16 a[34:35], v8 offset:10240
  ds_read_b64_tr_b16 a[36:37], v8 offset:5120
  ds_read_b64_tr_b16 a[38:39], v8 offset:15360
  ds_read_b64_tr_b16 a[80:81], v8 offset:256
  ds_read_b64_tr_b16 a[82:83], v8 offset:10496
  ds_read_b64_tr_b16 a[84:85], v8 offset:5376
  ds_read_b64_tr_b16 a[86:87], v8 offset:15616
  ds_read_b64_tr_b16 a[128:129], v8 offset:512
  ds_read_b64_tr_b16 a[130:131], v8 offset:10752
  ds_read_b64_tr_b16 a[132:133], v8 offset:5632
  ds_read_b64_tr_b16 a[134:135], v8 offset:15872
  s_waitcnt lgkmcnt(0)
  ds_read_b64_tr_b16 a[176:177], v8 offset:768
  ds_read_b64_tr_b16 a[178:179], v8 offset:11008
  ds_read_b64_tr_b16 a[180:181], v8 offset:5888
  ds_read_b64_tr_b16 a[182:183], v8 offset:16128
  ds_read_b64_tr_b16 a[224:225], v8 offset:1024
  ds_read_b64_tr_b16 a[226:227], v8 offset:11264
  ds_read_b64_tr_b16 a[228:229], v8 offset:6144
  ds_read_b64_tr_b16 a[230:231], v8 offset:16384
  s_waitcnt lgkmcnt(0)
  s_waitcnt vmcnt(0)
  s_barrier
  v_add_u32 v8, 81920, v7
  ds_read_b64_tr_b16 a[40:41], v8 offset:0
  ds_read_b64_tr_b16 a[42:43], v8 offset:10240
  ds_read_b64_tr_b16 a[44:45], v8 offset:5120
  ds_read_b64_tr_b16 a[46:47], v8 offset:15360
  ds_read_b64_tr_b16 a[88:89], v8 offset:256
  ds_read_b64_tr_b16 a[90:91], v8 offset:10496
  ds_read_b64_tr_b16 a[92:93], v8 offset:5376
  ds_read_b64_tr_b16 a[94:95], v8 offset:15616
  ds_read_b64_tr_b16 a[136:137], v8 offset:512
  ds_read_b64_tr_b16 a[138:139], v8 offset:10752
  ds_read_b64_tr_b16 a[140:141], v8 offset:5632
  ds_read_b64_tr_b16 a[142:143], v8 offset:15872
  s_waitcnt lgkmcnt(0)
  ds_read_b64_tr_b16 a[184:185], v8 offset:768
  ds_read_b64_tr_b16 a[186:187], v8 offset:11008
  ds_read_b64_tr_b16 a[188:189], v8 offset:5888
  ds_read_b64_tr_b16 a[190:191], v8 offset:16128
  ds_read_b64_tr_b16 a[232:233], v8 offset:1024
  ds_read_b64_tr_b16 a[234:235], v8 offset:11264
  ds_read_b64_tr_b16 a[236:237], v8 offset:6144
  ds_read_b64_tr_b16 a[238:239], v8 offset:16384
  s_waitcnt lgkmcnt(0)
  s_barrier
  v_lshlrev_b32 v5, 4, v1
  s_lshl_b32 s28, s21, 10
  v_add_u32 v6, s28, v5
  v_bfe_u32 v2, v1, 4, 1
  v_lshlrev_b32 v9, 10, v2
  v_and_b32 v2, 15, v1
  v_lshlrev_b32 v2, 4, v2
  v_add_u32 v9, v9, v2
  v_lshrrev_b32 v3, 5, v1
  v_lshlrev_b32 v3, 8, v3
  v_add_u32 v9, v9, v3
  v_add_u32 v10, 12288, v9
  v_bfe_u32 v3, v1, 4, 1
  v_lshlrev_b32 v11, 10, v3
  v_add_u32 v11, v11, v2
  v_lshrrev_b32 v3, 5, v1
  v_lshlrev_b32 v3, 9, v3
  v_add_u32 v11, v11, v3
  s_mul_i32 s28, s23, 6
  s_lshr_b32 s29, s28, 3
  s_add_u32 s28, s28, 5
  s_lshr_b32 s28, s28, 3
  v_and_b32 v2, 1, v1
  v_mov_b32 v12, s29
  v_mov_b32 v13, s28
  v_cmp_eq_u32 vcc, 1, v2
  s_nop 1
  v_cndmask_b32 v12, v12, v13, vcc
  v_lshlrev_b32 v12, 2, v12
  v_add_u32 v12, 2048, v12
  s_lshl_b32 s28, s23, 2
  s_add_u32 s28, s28, 3072
  v_mov_b32 v14, s28
  s_mul_i32 s47, s23, 786432
  s_add_u32 s47, s47, 0x7800000
  s_mul_i32 s48, s23, 40960
  s_mul_i32 s28, s21, 10240
  s_add_u32 s48, s48, s28
  s_add_u32 s48, s48, 0x9000000
  s_mov_b32 s50, 0
  s_mov_b32 s52, 0
  s_mov_b32 s54, 0
  s_mov_b32 s53, 0
  s_cmp_gt_u32 s52, s53
  s_cbranch_scc1 ka_wp_62_ok
  s_mov_b32 s45, 0
ka_wp_62_spin:
  buffer_load_dword v2, v12, s[8:11], 0 offen sc1
  s_add_u32 s45, s45, 1
  s_waitcnt vmcnt(0)
  v_min_u32_dpp v3, v2, v2 quad_perm:[1,0,3,2] row_mask:0xf bank_mask:0xf
  s_nop 1
  v_min_u32_dpp v2, v3, v3 quad_perm:[2,3,0,1] row_mask:0xf bank_mask:0xf
  s_nop 1
  v_min_u32_dpp v3, v2, v2 row_half_mirror row_mask:0xf bank_mask:0xf
  s_nop 1
  v_min_u32_dpp v2, v3, v3 quad_perm:[0,1,2,3] row_mask:0xf bank_mask:0xf
  s_nop 0
  v_readfirstlane_b32 s52, v2
  s_cmp_gt_u32 s52, s53
  s_cbranch_scc1 ka_wp_62_ok
  s_cmp_lt_u32 s45, 400000
  s_cbranch_scc1 ka_wp_62_spin
  s_branch ka_abort
ka_wp_62_ok:
  s_lshl_b32 s29, s21, 10
  s_add_u32 m0, s29, 0
  s_add_u32 s28, s47, 0
  buffer_load_dwordx4 v6, s[8:11], s28 offen sc1 lds
  s_lshl_b32 s29, s21, 10
  s_add_u32 m0, s29, 4096
  s_add_u32 s28, s47, 4096
  buffer_load_dwordx4 v6, s[8:11], s28 offen sc1 lds
  s_lshl_b32 s29, s21, 10
  s_add_u32 m0, s29, 8192
  s_add_u32 s28, s47, 8192
  buffer_load_dwordx4 v6, s[8:11], s28 offen sc1 lds
  s_add_u32 s47, s47, 12288
ka_u_loop:
  s_cmp_eq_u32 s50, 0
  s_cbranch_scc0 u0_63
  s_waitcnt vmcnt(0)
u0_63:
  s_waitcnt vmcnt(10)
  s_cmp_eq_u32 s54, 0
  s_cbranch_scc1 ud_64
  s_waitcnt vmcnt(0)
ud_64:
  s_barrier
  ds_read_b128 v[16:19], v9 offset:0
  ds_read_b128 v[20:23], v9 offset:512
  ds_read_b128 v[24:27], v9 offset:2048
  ds_read_b128 v[28:31], v9 offset:2560
  ds_read_b128 v[32:35], v9 offset:4096
  ds_read_b128 v[36:39], v9 offset:4608
  ds_read_b128 v[40:43], v9 offset:6144
  ds_read_b128 v[44:47], v9 offset:6656
  ds_read_b128 v[48:51], v9 offset:8192
  ds_read_b128 v[52:55], v9 offset:8704
  ds_read_b128 v[56:59], v9 offset:10240
  ds_read_b128 v[60:63], v9 offset:10752
  s_mov_b32 s54, 0
  s_cmp_ge_u32 s50, 63
  s_cbranch_scc1 un_65_n
  s_add_u32 s53, s50, 1
  s_cmp_gt_u32 s52, s53
  s_cbranch_scc1 un_65_go
  buffer_load_dword v2, v12, s[8:11], 0 offen sc1
  s_waitcnt vmcnt(0)
  v_min_u32_dpp v3, v2, v2 quad_perm:[1,0,3,2] row_mask:0xf bank_mask:0xf
  s_nop 0
  v_readfirstlane_b32 s52, v3
  s_cmp_gt_u32 s52, s53
  s_cbranch_scc1 un_65_go2
  s_mov_b32 s54, 1
  s_branch un_65
un_65_go2:
un_65_go:
  s_lshl_b32 s29, s21, 10
  s_add_u32 m0, s29, 12288
  s_add_u32 s28, s47, 0
  buffer_load_dwordx4 v6, s[8:11], s28 offen sc1 lds
  s_lshl_b32 s29, s21, 10
  s_add_u32 m0, s29, 16384
  s_add_u32 s28, s47, 4096
  buffer_load_dwordx4 v6, s[8:11], s28 offen sc1 lds
  s_lshl_b32 s29, s21, 10
  s_add_u32 m0, s29, 20480
  s_add_u32 s28, s47, 8192
  buffer_load_dwordx4 v6, s[8:11], s28 offen sc1 lds
  s_add_u32 s47, s47, 12288
  s_branch un_65
un_65_n:
  s_waitcnt vmcnt(0)
un_65:
  s_mul_i32 s30, s50, 1310720
  s_add_u32 s30, s30, s48
  s_waitcnt lgkmcnt(11)
  v_mfma_f32_32x32x16_bf16 v[64:79], v[16:19], a[0:3], 0
  s_waitcnt lgkmcnt(10)
  v_mfma_f32_32x32x16_bf16 v[64:79], v[20:23], a[4:7], v[64:79]
  s_waitcnt lgkmcnt(9)
  v_mfma_f32_32x32x16_bf16 v[64:79], v[24:27], a[8:11], v[64:79]
  s_waitcnt lgkmcnt(8)
  v_mfma_f32_32x32x16_bf16 v[64:79], v[28:31], a[12:15], v[64:79]
  s_waitcnt lgkmcnt(7)
  v_mfma_f32_32x32x16_bf16 v[64:79], v[32:35], a[16:19], v[64:79]
  s_waitcnt lgkmcnt(6)
  v_mfma_f32_32x32x16_bf16 v[64:79], v[36:39], a[20:23], v[64:79]
  s_waitcnt lgkmcnt(5)
  v_mfma_f32_32x32x16_bf16 v[64:79], v[40:43], a[24:27], v[64:79]
  s_waitcnt lgkmcnt(4)
  v_mfma_f32_32x32x16_bf16 v[64:79], v[44:47], a[28:31], v[64:79]
  s_waitcnt lgkmcnt(3)
  v_mfma_f32_32x32x16_bf16 v[64:79], v[48:51], a[32:35], v[64:79]
  s_waitcnt lgkmcnt(2)
  v_mfma_f32_32x32x16_bf16 v[64:79], v[52:55], a[36:39], v[64:79]
  s_waitcnt lgkmcnt(1)
  v_mfma_f32_32x32x16_bf16 v[64:79], v[56:59], a[40:43], v[64:79]
  s_waitcnt lgkmcnt(0)
  v_mfma_f32_32x32x16_bf16 v[64:79], v[60:63], a[44:47], v[64:79]
  v_mfma_f32_32x32x16_bf16 v[80:95], v[16:19], a[48:51], 0
  v_mfma_f32_32x32x16_bf16 v[80:95], v[20:23], a[52:55], v[80:95]
  v_mfma_f32_32x32x16_bf16 v[80:95], v[24:27], a[56:59], v[80:95]
  v_cvt_pk_bf16_f32 v96, v64, v65
  v_cvt_pk_bf16_f32 v97, v66, v67
  v_mfma_f32_32x32x16_bf16 v[80:95], v[28:31], a[60:63], v[80:95]
  v_cvt_pk_bf16_f32 v98, v68, v69
  v_cvt_pk_bf16_f32 v99, v70, v71
  v_mfma_f32_32x32x16_bf16 v[80:95], v[32:35], a[64:67], v[80:95]
  v_cvt_pk_bf16_f32 v100, v72, v73
  v_cvt_pk_bf16_f32 v101, v74, v75
  v_mfma_f32_32x32x16_bf16 v[80:95], v[36:39], a[68:71], v[80:95]
  v_cvt_pk_bf16_f32 v102, v76, v77
  v_cvt_pk_bf16_f32 v103, v78, v79
  v_mfma_f32_32x32x16_bf16 v[80:95], v[40:43], a[72:75], v[80:95]
  s_add_u32 s29, s30, 0
  buffer_store_dwordx4 v[96:99], v11, s[8:11], s29 offen offset:0 sc1
  v_mfma_f32_32x32x16_bf16 v[80:95], v[44:47], a[76:79], v[80:95]
  buffer_store_dwordx4 v[100:103], v11, s[8:11], s29 offen offset:256 sc1
  v_mfma_f32_32x32x16_bf16 v[80:95], v[48:51], a[80:83], v[80:95]
  v_mfma_f32_32x32x16_bf16 v[80:95], v[52:55], a[84:87], v[80:95]
  v_mfma_f32_32x32x16_bf16 v[80:95], v[56:59], a[88:91], v[80:95]
  v_mfma_f32_32x32x16_bf16 v[80:95], v[60:63], a[92:95], v[80:95]
  v_mfma_f32_32x32x16_bf16 v[64:79], v[16:19], a[96:99], 0
  v_mfma_f32_32x32x16_bf16 v[64:79], v[20:23], a[100:103], v[64:79]
  v_mfma_f32_32x32x16_bf16 v[64:79], v[24:27], a[104:107], v[64:79]
  v_cvt_pk_bf16_f32 v96, v80, v81
  v_cvt_pk_bf16_f32 v97, v82, v83
  v_mfma_f32_32x32x16_bf16 v[64:79], v[28:31], a[108:111], v[64:79]
  v_cvt_pk_bf16_f32 v98, v84, v85
  v_cvt_pk_bf16_f32 v99, v86, v87
  v_mfma_f32_32x32x16_bf16 v[64:79], v[32:35], a[112:115], v[64:79]
  v_cvt_pk_bf16_f32 v100, v88, v89
  v_cvt_pk_bf16_f32 v101, v90, v91
  v_mfma_f32_32x32x16_bf16 v[64:79], v[36:39], a[116:119], v[64:79]
  v_cvt_pk_bf16_f32 v102, v92, v93
  v_cvt_pk_bf16_f32 v103, v94, v95
  v_mfma_f32_32x32x16_bf16 v[64:79], v[40:43], a[120:123], v[64:79]
  s_add_u32 s29, s30, 2048
  buffer_store_dwordx4 v[96:99], v11, s[8:11], s29 offen offset:0 sc1
  v_mfma_f32_32x32x16_bf16 v[64:79], v[44:47], a[124:127], v[64:79]
  buffer_store_dwordx4 v[100:103], v11, s[8:11], s29 offen offset:256 sc1
  v_mfma_f32_32x32x16_bf16 v[64:79], v[48:51], a[128:131], v[64:79]
  v_mfma_f32_32x32x16_bf16 v[64:79], v[52:55], a[132:135], v[64:79]
  v_mfma_f32_32x32x16_bf16 v[64:79], v[56:59], a[136:139], v[64:79]
  v_mfma_f32_32x32x16_bf16 v[64:79], v[60:63], a[140:143], v[64:79]
  s_waitcnt vmcnt(7)
  s_barrier
  s_cmp_eq_u32 s21, 0
  s_cbranch_scc0 mp_66
  v_mov_b32 v13, s50
  s_mov_b64 s[24:25], exec
  s_mov_b64 exec, 1
  buffer_store_dword v13, v14, s[8:11], 0 offen sc1
  s_mov_b64 exec, s[24:25]
mp_66:
  v_mfma_f32_32x32x16_bf16 v[80:95], v[16:19], a[144:147], 0
  v_mfma_f32_32x32x16_bf16 v[80:95], v[20:23], a[148:151], v[80:95]
  v_mfma_f32_32x32x16_bf16 v[80:95], v[24:27], a[152:155], v[80:95]
  v_cvt_pk_bf16_f32 v96, v64, v65
  v_cvt_pk_bf16_f32 v97, v66, v67
  v_mfma_f32_32x32x16_bf16 v[80:95], v[28:31], a[156:159], v[80:95]
  v_cvt_pk_bf16_f32 v98, v68, v69
  v_cvt_pk_bf16_f32 v99, v70, v71
  v_mfma_f32_32x32x16_bf16 v[80:95], v[32:35], a[160:163], v[80:95]
  v_cvt_pk_bf16_f32 v100, v72, v73
  v_cvt_pk_bf16_f32 v101, v74, v75
  v_mfma_f32_32x32x16_bf16 v[80:95], v[36:39], a[164:167], v[80:95]
  v_cvt_pk_bf16_f32 v102, v76, v77
  v_cvt_pk_bf16_f32 v103, v78, v79
  v_mfma_f32_32x32x16_bf16 v[80:95], v[40:43], a[168:171], v[80:95]
  s_add_u32 s29, s30, 4096
  buffer_store_dwordx4 v[96:99], v11, s[8:11], s29 offen offset:0 sc1
  v_mfma_f32_32x32x16_bf16 v[80:95], v[44:47], a[172:175], v[80:95]
  buffer_store_dwordx4 v[100:103], v11, s[8:11], s29 offen offset:256 sc1
  v_mfma_f32_32x32x16_bf16 v[80:95], v[48:51], a[176:179], v[80:95]
  v_mfma_f32_32x32x16_bf16 v[80:95], v[52:55], a[180:183], v[80:95]
  v_mfma_f32_32x32x16_bf16 v[80:95], v[56:59], a[184:187], v[80:95]
  v_mfma_f32_32x32x16_bf16 v[80:95], v[60:63], a[188:191], v[80:95]
  v_mfma_f32_32x32x16_bf16 v[64:79], v[16:19], a[192:195], 0
  v_mfma_f32_32x32x16_bf16 v[64:79], v[20:23], a[196:199], v[64:79]
  v_mfma_f32_32x32x16_bf16 v[64:79], v[24:27], a[200:203], v[64:79]
  v_cvt_pk_bf16_f32 v96, v80, v81
  v_cvt_pk_bf16_f32 v97, v82, v83
  v_mfma_f32_32x32x16_bf16 v[64:79], v[28:31], a[204:207], v[64:79]
  v_cvt_pk_bf16_f32 v98, v84, v85
  v_cvt_pk_bf16_f32 v99, v86, v87
  v_mfma_f32_32x32x16_bf16 v[64:79], v[32:35], a[208:211], v[64:79]
  v_cvt_pk_bf16_f32 v100, v88, v89
  v_cvt_pk_bf16_f32 v101, v90, v91
  v_mfma_f32_32x32x16_bf16 v[64:79], v[36:39], a[212:215], v[64:79]
  v_cvt_pk_bf16_f32 v102, v92, v93
  v_cvt_pk_bf16_f32 v103, v94, v95
  v_mfma_f32_32x32x16_bf16 v[64:79], v[40:43], a[216:219], v[64:79]
  s_add_u32 s29, s30, 6144
  buffer_store_dwordx4 v[96:99], v11, s[8:11], s29 offen offset:0 sc1
  v_mfma_f32_32x32x16_bf16 v[64:79], v[44:47], a[220:223], v[64:79]
  buffer_store_dwordx4 v[100:103], v11, s[8:11], s29 offen offset:256 sc1
  v_mfma_f32_32x32x16_bf16 v[64:79], v[48:51], a[224:227], v[64:79]
  v_mfma_f32_32x32x16_bf16 v[64:79], v[52:55], a[228:231], v[64:79]
  v_mfma_f32_32x32x16_bf16 v[64:79], v[56:59], a[232:235], v[64:79]
  v_mfma_f32_32x32x16_bf16 v[64:79], v[60:63], a[236:239], v[64:79]
  s_nop 11
  v_cvt_pk_bf16_f32 v96, v64, v65
  v_cvt_pk_bf16_f32 v97, v66, v67
  v_cvt_pk_bf16_f32 v98, v68, v69
  v_cvt_pk_bf16_f32 v99, v70, v71
  v_cvt_pk_bf16_f32 v100, v72, v73
  v_cvt_pk_bf16_f32 v101, v74, v75
  v_cvt_pk_bf16_f32 v102, v76, v77
  v_cvt_pk_bf16_f32 v103, v78, v79
  s_add_u32 s29, s30, 8192
  buffer_store_dwordx4 v[96:99], v11, s[8:11], s29 offen offset:0 sc1
  buffer_store_dwordx4 v[100:103], v11, s[8:11], s29 offen offset:256 sc1
  s_cmp_eq_u32 s54, 0
  s_cbranch_scc1 udf_67
  s_cmp_gt_u32 s52, s53
  s_cbranch_scc1 ka_wp_68_ok
  s_mov_b32 s45, 0
ka_wp_68_spin:
  buffer_load_dword v2, v12, s[8:11], 0 offen sc1
  s_add_u32 s45, s45, 1
  s_waitcnt vmcnt(0)
  v_min_u32_dpp v3, v2, v2 quad_perm:[1,0,3,2] row_mask:0xf bank_mask:0xf
  s_nop 1
  v_min_u32_dpp v2, v3, v3 quad_perm:[2,3,0,1] row_mask:0xf bank_mask:0xf
  s_nop 1
  v_min_u32_dpp v3, v2, v2 row_half_mirror row_mask:0xf bank_mask:0xf
  s_nop 1
  v_min_u32_dpp v2, v3, v3 quad_perm:[0,1,2,3] row_mask:0xf bank_mask:0xf
  s_nop 0
  v_readfirstlane_b32 s52, v2
  s_cmp_gt_u32 s52, s53
  s_cbranch_scc1 ka_wp_68_ok
  s_cmp_lt_u32 s45, 400000
  s_cbranch_scc1 ka_wp_68_spin
  s_branch ka_abort
ka_wp_68_ok:
  s_lshl_b32 s29, s21, 10
  s_add_u32 m0, s29, 12288
  s_add_u32 s28, s47, 0
  buffer_load_dwordx4 v6, s[8:11], s28 offen sc1 lds
  s_lshl_b32 s29, s21, 10
  s_add_u32 m0, s29, 16384
  s_add_u32 s28, s47, 4096
  buffer_load_dwordx4 v6, s[8:11], s28 offen sc1 lds
  s_lshl_b32 s29, s21, 10
  s_add_u32 m0, s29, 20480
  s_add_u32 s28, s47, 8192
  buffer_load_dwordx4 v6, s[8:11], s28 offen sc1 lds
  s_add_u32 s47, s47, 12288
udf_67:
  s_add_u32 s50, s50, 1
  s_waitcnt vmcnt(10)
  s_cmp_eq_u32 s54, 0
  s_cbranch_scc1 ud_69
  s_waitcnt vmcnt(0)
ud_69:
  s_barrier
  ds_read_b128 v[16:19], v10 offset:0
  ds_read_b128 v[20:23], v10 offset:512
  ds_read_b128 v[24:27], v10 offset:2048
  ds_read_b128 v[28:31], v10 offset:2560
  ds_read_b128 v[32:35], v10 offset:4096
  ds_read_b128 v[36:39], v10 offset:4608
  ds_read_b128 v[40:43], v10 offset:6144
  ds_read_b128 v[44:47], v10 offset:6656
  ds_read_b128 v[48:51], v10 offset:8192
  ds_read_b128 v[52:55], v10 offset:8704
  ds_read_b128 v[56:59], v10 offset:10240
  ds_read_b128 v[60:63], v10 offset:10752
  s_mov_b32 s54, 0
  s_cmp_ge_u32 s50, 63
  s_cbranch_scc1 un_70_n
  s_add_u32 s53, s50, 1
  s_cmp_gt_u32 s52, s53
  s_cbranch_scc1 un_70_go
  buffer_load_dword v2, v12, s[8:11], 0 offen sc1
  s_waitcnt vmcnt(0)
  v_min_u32_dpp v3, v2, v2 quad_perm:[1,0,3,2] row_mask:0xf bank_mask:0xf
  s_nop 0
  v_readfirstlane_b32 s52, v3
  s_cmp_gt_u32 s52, s53
  s_cbranch_scc1 un_70_go2
  s_mov_b32 s54, 1
  s_branch un_70
un_70_go2:
un_70_go:
  s_lshl_b32 s29, s21, 10
  s_add_u32 m0, s29, 0
  s_add_u32 s28, s47, 0
  buffer_load_dwordx4 v6, s[8:11], s28 offen sc1 lds
  s_lshl_b32 s29, s21, 10
  s_add_u32 m0, s29, 4096
  s_add_u32 s28, s47, 4096
  buffer_load_dwordx4 v6, s[8:11], s28 offen sc1 lds
  s_lshl_b32 s29, s21, 10
  s_add_u32 m0, s29, 8192
  s_add_u32 s28, s47, 8192
  buffer_load_dwordx4 v6, s[8:11], s28 offen sc1 lds
  s_add_u32 s47, s47, 12288
  s_branch un_70
un_70_n:
  s_waitcnt vmcnt(0)
un_70:
  s_mul_i32 s30, s50, 1310720
  s_add_u32 s30, s30, s48
  s_waitcnt lgkmcnt(11)
  v_mfma_f32_32x32x16_bf16 v[64:79], v[16:19], a[0:3], 0
  s_waitcnt lgkmcnt(10)
  v_mfma_f32_32x32x16_bf16 v[64:79], v[20:23], a[4:7], v[64:79]
  s_waitcnt lgkmcnt(9)
  v_mfma_f32_32x32x16_bf16 v[64:79], v[24:27], a[8:11], v[64:79]
  s_waitcnt lgkmcnt(8)
  v_mfma_f32_32x32x16_bf16 v[64:79], v[28:31], a[12:15], v[64:79]
  s_waitcnt lgkmcnt(7)
  v_mfma_f32_32x32x16_bf16 v[64:79], v[32:35], a[16:19], v[64:79]
  s_waitcnt lgkmcnt(6)
  v_mfma_f32_32x32x16_bf16 v[64:79], v[36:39], a[20:23], v[64:79]
  s_waitcnt lgkmcnt(5)
  v_mfma_f32_32x32x16_bf16 v[64:79], v[40:43], a[24:27], v[64:79]
  s_waitcnt lgkmcnt(4)
  v_mfma_f32_32x32x16_bf16 v[64:79], v[44:47], a[28:31], v[64:79]
  s_waitcnt lgkmcnt(3)
  v_mfma_f32_32x32x16_bf16 v[64:79], v[48:51], a[32:35], v[64:79]
  s_waitcnt lgkmcnt(2)
  v_mfma_f32_32x32x16_bf16 v[64:79], v[52:55], a[36:39], v[64:79]
  s_waitcnt lgkmcnt(1)
  v_mfma_f32_32x32x16_bf16 v[64:79], v[56:59], a[40:43], v[64:79]
  s_waitcnt lgkmcnt(0)
  v_mfma_f32_32x32x16_bf16 v[64:79], v[60:63], a[44:47], v[64:79]
  v_mfma_f32_32x32x16_bf16 v[80:95], v[16:19], a[48:51], 0
  v_mfma_f32_32x32x16_bf16 v[80:95], v[20:23], a[52:55], v[80:95]
  v_mfma_f32_32x32x16_bf16 v[80:95], v[24:27], a[56:59], v[80:95]
  v_cvt_pk_bf16_f32 v96, v64, v65
  v_cvt_pk_bf16_f32 v97, v66, v67
  v_mfma_f32_32x32x16_bf16 v[80:95], v[28:31], a[60:63], v[80:95]
  v_cvt_pk_bf16_f32 v98, v68, v69
  v_cvt_pk_bf16_f32 v99, v70, v71
  v_mfma_f32_32x32x16_bf16 v[80:95], v[32:35], a[64:67], v[80:95]
  v_cvt_pk_bf16_f32 v100, v72, v73
  v_cvt_pk_bf16_f32 v101, v74, v75
  v_mfma_f32_32x32x16_bf16 v[80:95], v[36:39], a[68:71], v[80:95]
  v_cvt_pk_bf16_f32 v102, v76, v77
  v_cvt_pk_bf16_f32 v103, v78, v79
  v_mfma_f32_32x32x16_bf16 v[80:95], v[40:43], a[72:75], v[80:95]
  s_add_u32 s29, s30, 0
  buffer_store_dwordx4 v[96:99], v11, s[8:11], s29 offen offset:0 sc1
  v_mfma_f32_32x32x16_bf16 v[80:95], v[44:47], a[76:79], v[80:95]
  buffer_store_dwordx4 v[100:103], v11, s[8:11], s29 offen offset:256 sc1
  v_mfma_f32_32x32x16_bf16 v[80:95], v[48:51], a[80:83], v[80:95]
  v_mfma_f32_32x32x16_bf16 v[80:95], v[52:55], a[84:87], v[80:95]
  v_mfma_f32_32x32x16_bf16 v[80:95], v[56:59], a[88:91], v[80:95]
  v_mfma_f32_32x32x16_bf16 v[80:95], v[60:63], a[92:95], v[80:95]
  v_mfma_f32_32x32x16_bf16 v[64:79], v[16:19], a[96:99], 0
  v_mfma_f32_32x32x16_bf16 v[64:79], v[20:23], a[100:103], v[64:79]
  v_mfma_f32_32x32x16_bf16 v[64:79], v[24:27], a[104:107], v[64:79]
  v_cvt_pk_bf16_f32 v96, v80, v81
  v_cvt_pk_bf16_f32 v97, v82, v83
  v_mfma_f32_32x32x16_bf16 v[64:79], v[28:31], a[108:111], v[64:79]
  v_cvt_pk_bf16_f32 v98, v84, v85
  v_cvt_pk_bf16_f32 v99, v86, v87
  v_mfma_f32_32x32x16_bf16 v[64:79], v[32:35], a[112:115], v[64:79]
  v_cvt_pk_bf16_f32 v100, v88, v89
  v_cvt_pk_bf16_f32 v101, v90, v91
  v_mfma_f32_32x32x16_bf16 v[64:79], v[36:39], a[116:119], v[64:79]
  v_cvt_pk_bf16_f32 v102, v92, v93
  v_cvt_pk_bf16_f32 v103, v94, v95
  v_mfma_f32_32x32x16_bf16 v[64:79], v[40:43], a[120:123], v[64:79]
  s_add_u32 s29, s30, 2048
  buffer_store_dwordx4 v[96:99], v11, s[8:11], s29 offen offset:0 sc1
  v_mfma_f32_32x32x16_bf16 v[64:79], v[44:47], a[124:127], v[64:79]
  buffer_store_dwordx4 v[100:103], v11, s[8:11], s29 offen offset:256 sc1
  v_mfma_f32_32x32x16_bf16 v[64:79], v[48:51], a[128:131], v[64:79]
  v_mfma_f32_32x32x16_bf16 v[64:79], v[52:55], a[132:135], v[64:79]
  v_mfma_f32_32x32x16_bf16 v[64:79], v[56:59], a[136:139], v[64:79]
  v_mfma_f32_32x32x16_bf16 v[64:79], v[60:63], a[140:143], v[64:79]
  s_waitcnt vmcnt(7)
  s_barrier
  s_cmp_eq_u32 s21, 0
  s_cbranch_scc0 mp_71
  v_mov_b32 v13, s50
  s_mov_b64 s[24:25], exec
  s_mov_b64 exec, 1
  buffer_store_dword v13, v14, s[8:11], 0 offen sc1
  s_mov_b64 exec, s[24:25]
mp_71:
  v_mfma_f32_32x32x16_bf16 v[80:95], v[16:19], a[144:147], 0
  v_mfma_f32_32x32x16_bf16 v[80:95], v[20:23], a[148:151], v[80:95]
  v_mfma_f32_32x32x16_bf16 v[80:95], v[24:27], a[152:155], v[80:95]
  v_cvt_pk_bf16_f32 v96, v64, v65
  v_cvt_pk_bf16_f32 v97, v66, v67
  v_mfma_f32_32x32x16_bf16 v[80:95], v[28:31], a[156:159], v[80:95]
  v_cvt_pk_bf16_f32 v98, v68, v69
  v_cvt_pk_bf16_f32 v99, v70, v71
  v_mfma_f32_32x32x16_bf16 v[80:95], v[32:35], a[160:163], v[80:95]
  v_cvt_pk_bf16_f32 v100, v72, v73
  v_cvt_pk_bf16_f32 v101, v74, v75
  v_mfma_f32_32x32x16_bf16 v[80:95], v[36:39], a[164:167], v[80:95]
  v_cvt_pk_bf16_f32 v102, v76, v77
  v_cvt_pk_bf16_f32 v103, v78, v79
  v_mfma_f32_32x32x16_bf16 v[80:95], v[40:43], a[168:171], v[80:95]
  s_add_u32 s29, s30, 4096
  buffer_store_dwordx4 v[96:99], v11, s[8:11], s29 offen offset:0 sc1
  v_mfma_f32_32x32x16_bf16 v[80:95], v[44:47], a[172:175], v[80:95]
  buffer_store_dwordx4 v[100:103], v11, s[8:11], s29 offen offset:256 sc1
  v_mfma_f32_32x32x16_bf16 v[80:95], v[48:51], a[176:179], v[80:95]
  v_mfma_f32_32x32x16_bf16 v[80:95], v[52:55], a[180:183], v[80:95]
  v_mfma_f32_32x32x16_bf16 v[80:95], v[56:59], a[184:187], v[80:95]
  v_mfma_f32_32x32x16_bf16 v[80:95], v[60:63], a[188:191], v[80:95]
  v_mfma_f32_32x32x16_bf16 v[64:79], v[16:19], a[192:195], 0
  v_mfma_f32_32x32x16_bf16 v[64:79], v[20:23], a[196:199], v[64:79]
  v_mfma_f32_32x32x16_bf16 v[64:79], v[24:27], a[200:203], v[64:79]
  v_cvt_pk_bf16_f32 v96, v80, v81
  v_cvt_pk_bf16_f32 v97, v82, v83
  v_mfma_f32_32x32x16_bf16 v[64:79], v[28:31], a[204:207], v[64:79]
  v_cvt_pk_bf16_f32 v98, v84, v85
  v_cvt_pk_bf16_f32 v99, v86, v87
  v_mfma_f32_32x32x16_bf16 v[64:79], v[32:35], a[208:211], v[64:79]
  v_cvt_pk_bf16_f32 v100, v88, v89
  v_cvt_pk_bf16_f32 v101, v90, v91
  v_mfma_f32_32x32x16_bf16 v[64:79], v[36:39], a[212:215], v[64:79]
  v_cvt_pk_bf16_f32 v102, v92, v93
  v_cvt_pk_bf16_f32 v103, v94, v95
  v_mfma_f32_32x32x16_bf16 v[64:79], v[40:43], a[216:219], v[64:79]
  s_add_u32 s29, s30, 6144
  buffer_store_dwordx4 v[96:99], v11, s[8:11], s29 offen offset:0 sc1
  v_mfma_f32_32x32x16_bf16 v[64:79], v[44:47], a[220:223], v[64:79]
  buffer_store_dwordx4 v[100:103], v11, s[8:11], s29 offen offset:256 sc1
  v_mfma_f32_32x32x16_bf16 v[64:79], v[48:51], a[224:227], v[64:79]
  v_mfma_f32_32x32x16_bf16 v[64:79], v[52:55], a[228:231], v[64:79]
  v_mfma_f32_32x32x16_bf16 v[64:79], v[56:59], a[232:235], v[64:79]
  v_mfma_f32_32x32x16_bf16 v[64:79], v[60:63], a[236:239], v[64:79]
  s_nop 11
  v_cvt_pk_bf16_f32 v96, v64, v65
  v_cvt_pk_bf16_f32 v97, v66, v67
  v_cvt_pk_bf16_f32 v98, v68, v69
  v_cvt_pk_bf16_f32 v99, v70, v71
  v_cvt_pk_bf16_f32 v100, v72, v73
  v_cvt_pk_bf16_f32 v101, v74, v75
  v_cvt_pk_bf16_f32 v102, v76, v77
  v_cvt_pk_bf16_f32 v103, v78, v79
  s_add_u32 s29, s30, 8192
  buffer_store_dwordx4 v[96:99], v11, s[8:11], s29 offen offset:0 sc1
  buffer_store_dwordx4 v[100:103], v11, s[8:11], s29 offen offset:256 sc1
  s_cmp_eq_u32 s54, 0
  s_cbranch_scc1 udf_72
  s_cmp_gt_u32 s52, s53
  s_cbranch_scc1 ka_wp_73_ok
  s_mov_b32 s45, 0
ka_wp_73_spin:
  buffer_load_dword v2, v12, s[8:11], 0 offen sc1
  s_add_u32 s45, s45, 1
  s_waitcnt vmcnt(0)
  v_min_u32_dpp v3, v2, v2 quad_perm:[1,0,3,2] row_mask:0xf bank_mask:0xf
  s_nop 1
  v_min_u32_dpp v2, v3, v3 quad_perm:[2,3,0,1] row_mask:0xf bank_mask:0xf
  s_nop 1
  v_min_u32_dpp v3, v2, v2 row_half_mirror row_mask:0xf bank_mask:0xf
  s_nop 1
  v_min_u32_dpp v2, v3, v3 quad_perm:[0,1,2,3] row_mask:0xf bank_mask:0xf
  s_nop 0
  v_readfirstlane_b32 s52, v2
  s_cmp_gt_u32 s52, s53
  s_cbranch_scc1 ka_wp_73_ok
  s_cmp_lt_u32 s45, 400000
  s_cbranch_scc1 ka_wp_73_spin
  s_branch ka_abort
ka_wp_73_ok:
  s_lshl_b32 s29, s21, 10
  s_add_u32 m0, s29, 0
  s_add_u32 s28, s47, 0
  buffer_load_dwordx4 v6, s[8:11], s28 offen sc1 lds
  s_lshl_b32 s29, s21, 10
  s_add_u32 m0, s29, 4096
  s_add_u32 s28, s47, 4096
  buffer_load_dwordx4 v6, s[8:11], s28 offen sc1 lds
  s_lshl_b32 s29, s21, 10
  s_add_u32 m0, s29, 8192
  s_add_u32 s28, s47, 8192
  buffer_load_dwordx4 v6, s[8:11], s28 offen sc1 lds
  s_add_u32 s47, s47, 12288
udf_72:
  s_add_u32 s50, s50, 1
  s_cmp_lt_u32 s50, 64
  s_cbranch_scc1 ka_u_loop
  s_waitcnt vmcnt(0)
  s_barrier
  s_cmp_eq_u32 s21, 0
  s_cbranch_scc0 ka_exit
  v_mov_b32 v13, 64
  s_mov_b64 exec, 1
  buffer_store_dword v13, v14, s[8:11], 0 offen sc1
  s_waitcnt vmcnt(0)
  s_branch ka_exit
.macro CHAINROLES sfx, pol
ka\sfx\()_x:
  s_mov_b32 s12, s36
  s_and_b32 s13, s37, 0xffff
  s_mov_b32 s14, 0x780000
  s_mov_b32 s15, 0x20000
  s_mov_b32 s16, s38
  s_and_b32 s17, s39, 0xffff
  s_mov_b32 s18, 0x780000
  s_mov_b32 s19, 0x20000
  v_and_b32 v1, 63, v0
  v_lshrrev_b32 v2, 4, v1
  v_bfe_u32 v3, v1, 3, 1
  v_bfe_u32 v4, v1, 1, 2
  v_and_b32 v5, 1, v1
  s_mul_i32 s46, s23, 384
  s_lshl_b32 s28, s21, 2
  s_add_u32 s28, s28, 0
  v_add_u32 v6, s28, v2
  v_mul_u32_u24 v7, 43, v6
  v_lshrrev_b32 v7, 9, v7
  v_mul_u32_u24 v8, 12, v7
  v_sub_u32 v8, v6, v8
  v_lshrrev_b32 v9, 1, v7
  v_lshlrev_b32 v9, 4, v9
  v_and_b32 v10, 1, v7
  v_lshlrev_b32 v10, 2, v10
  v_add_u32 v9, v9, v10
  v_lshlrev_b32 v10, 3, v3
  v_add_u32 v9, v9, v10
  v_add_u32 v9, v9, v4
  v_mul_u32_u24 v9, 12288, v9
  v_lshrrev_b32 v10, 1, v8
  v_lshlrev_b32 v10, 2, v10
  v_lshlrev_b32 v11, 1, v5
  v_add_u32 v10, v10, v11
  v_and_b32 v11, 1, v8
  v_add_u32 v10, v10, v11
  v_lshlrev_b32 v10, 4, v10
  v_add_u32 v9, v9, v10
  v_add_u32 v136, s46, v9
  s_lshl_b32 s28, s21, 2
  s_add_u32 s28, s28, 16
  v_add_u32 v6, s28, v2
  v_mul_u32_u24 v7, 43, v6
  v_lshrrev_b32 v7, 9, v7
  v_mul_u32_u24 v8, 12, v7
  v_sub_u32 v8, v6, v8
  v_lshrrev_b32 v9, 1, v7
  v_lshlrev_b32 v9, 4, v9
  v_and_b32 v10, 1, v7
  v_lshlrev_b32 v10, 2, v10
  v_add_u32 v9, v9, v10
  v_lshlrev_b32 v10, 3, v3
  v_add_u32 v9, v9, v10
  v_add_u32 v9, v9, v4
  v_mul_u32_u24 v9, 12288, v9
  v_lshrrev_b32 v10, 1, v8
  v_lshlrev_b32 v10, 2, v10
  v_lshlrev_b32 v11, 1, v5
  v_add_u32 v10, v10, v11
  v_and_b32 v11, 1, v8
  v_add_u32 v10, v10, v11
  v_lshlrev_b32 v10, 4, v10
  v_add_u32 v9, v9, v10
  v_add_u32 v137, s46, v9
  s_lshl_b32 s28, s21, 2
  s_add_u32 s28, s28, 32
  v_add_u32 v6, s28, v2
  v_mul_u32_u24 v7, 43, v6
  v_lshrrev_b32 v7, 9, v7
  v_mul_u32_u24 v8, 12, v7
  v_sub_u32 v8, v6, v8
  v_lshrrev_b32 v9, 1, v7
  v_lshlrev_b32 v9, 4, v9
  v_and_b32 v10, 1, v7
  v_lshlrev_b32 v10, 2, v10
  v_add_u32 v9, v9, v10
  v_lshlrev_b32 v10, 3, v3
  v_add_u32 v9, v9, v10
  v_add_u32 v9, v9, v4
  v_mul_u32_u24 v9, 12288, v9
  v_lshrrev_b32 v10, 1, v8
  v_lshlrev_b32 v10, 2, v10
  v_lshlrev_b32 v11, 1, v5
  v_add_u32 v10, v10, v11
  v_and_b32 v11, 1, v8
  v_add_u32 v10, v10, v11
  v_lshlrev_b32 v10, 4, v10
  v_add_u32 v9, v9, v10
  v_add_u32 v138, s46, v9
  s_lshl_b32 s28, s21, 2
  s_add_u32 s28, s28, 48
  v_add_u32 v6, s28, v2
  v_mul_u32_u24 v7, 43, v6
  v_lshrrev_b32 v7, 9, v7
  v_mul_u32_u24 v8, 12, v7
  v_sub_u32 v8, v6, v8
  v_lshrrev_b32 v9, 1, v7
  v_lshlrev_b32 v9, 4, v9
  v_and_b32 v10, 1, v7
  v_lshlrev_b32 v10, 2, v10
  v_add_u32 v9, v9, v10
  v_lshlrev_b32 v10, 3, v3
  v_add_u32 v9, v9, v10
  v_add_u32 v9, v9, v4
  v_mul_u32_u24 v9, 12288, v9
  v_lshrrev_b32 v10, 1, v8
  v_lshlrev_b32 v10, 2, v10
  v_lshlrev_b32 v11, 1, v5
  v_add_u32 v10, v10, v11
  v_and_b32 v11, 1, v8
  v_add_u32 v10, v10, v11
  v_lshlrev_b32 v10, 4, v10
  v_add_u32 v9, v9, v10
  v_add_u32 v139, s46, v9
  s_lshl_b32 s28, s21, 2
  s_add_u32 s28, s28, 64
  v_add_u32 v6, s28, v2
  v_mul_u32_u24 v7, 43, v6
  v_lshrrev_b32 v7, 9, v7
  v_mul_u32_u24 v8, 12, v7
  v_sub_u32 v8, v6, v8
  v_lshrrev_b32 v9, 1, v7
  v_lshlrev_b32 v9, 4, v9
  v_and_b32 v10, 1, v7
  v_lshlrev_b32 v10, 2, v10
  v_add_u32 v9, v9, v10
  v_lshlrev_b32 v10, 3, v3
  v_add_u32 v9, v9, v10
  v_add_u32 v9, v9, v4
  v_mul_u32_u24 v9, 12288, v9
  v_lshrrev_b32 v10, 1, v8
  v_lshlrev_b32 v10, 2, v10
  v_lshlrev_b32 v11, 1, v5
  v_add_u32 v10, v10, v11
  v_and_b32 v11, 1, v8
  v_add_u32 v10, v10, v11
  v_lshlrev_b32 v10, 4, v10
  v_add_u32 v9, v9, v10
  v_add_u32 v140, s46, v9
  s_lshl_b32 s28, s21, 2
  s_add_u32 s28, s28, 80
  v_add_u32 v6, s28, v2
  v_mul_u32_u24 v7, 43, v6
  v_lshrrev_b32 v7, 9, v7
  v_mul_u32_u24 v8, 12, v7
  v_sub_u32 v8, v6, v8
  v_lshrrev_b32 v9, 1, v7
  v_lshlrev_b32 v9, 4, v9
  v_and_b32 v10, 1, v7
  v_lshlrev_b32 v10, 2, v10
  v_add_u32 v9, v9, v10
  v_lshlrev_b32 v10, 3, v3
  v_add_u32 v9, v9, v10
  v_add_u32 v9, v9, v4
  v_mul_u32_u24 v9, 12288, v9
  v_lshrrev_b32 v10, 1, v8
  v_lshlrev_b32 v10, 2, v10
  v_lshlrev_b32 v11, 1, v5
  v_add_u32 v10, v10, v11
  v_and_b32 v11, 1, v8
  v_add_u32 v10, v10, v11
  v_lshlrev_b32 v10, 4, v10
  v_add_u32 v9, v9, v10
  v_add_u32 v141, s46, v9
  v_lshrrev_b32 v6, 1, v2
  v_mul_u32_u24 v142, 6144, v6
  v_and_b32 v6, 1, v2
  v_lshlrev_b32 v6, 7, v6
  v_add_u32 v142, v142, v6
  v_bfe_u32 v6, v1, 2, 2
  v_lshlrev_b32 v6, 5, v6
  v_add_u32 v142, v142, v6
  v_and_b32 v6, 1, v1
  v_lshlrev_b32 v6, 4, v6
  v_add_u32 v142, v142, v6
  v_bfe_u32 v6, v1, 1, 1
  v_lshlrev_b32 v6, 3, v6
  v_add_u32 v142, v142, v6
  s_mul_i32 s28, s21, 768
  v_add_u32 v142, s28, v142
  s_lshl_b32 s29, s21, 10
  s_add_u32 m0, s29, 0
  s_mov_b32 s28, 0
  buffer_load_dwordx4 v136, s[12:15], s28 offen lds
  s_lshl_b32 s29, s21, 10
  s_add_u32 m0, s29, 4096
  s_mov_b32 s28, 0
  buffer_load_dwordx4 v137, s[12:15], s28 offen lds
  s_lshl_b32 s29, s21, 10
  s_add_u32 m0, s29, 8192
  s_mov_b32 s28, 0
  buffer_load_dwordx4 v138, s[12:15], s28 offen lds
  s_lshl_b32 s29, s21, 10
  s_add_u32 m0, s29, 12288
  s_mov_b32 s28, 0
  buffer_load_dwordx4 v139, s[12:15], s28 offen lds
  s_lshl_b32 s29, s21, 10
  s_add_u32 m0, s29, 16384
  s_mov_b32 s28, 0
  buffer_load_dwordx4 v140, s[12:15], s28 offen lds
  s_lshl_b32 s29, s21, 10
  s_add_u32 m0, s29, 20480
  s_mov_b32 s28, 0
  buffer_load_dwordx4 v141, s[12:15], s28 offen lds
  s_lshl_b32 s29, s21, 10
  s_add_u32 m0, s29, 24576
  s_mov_b32 s28, 786432
  buffer_load_dwordx4 v136, s[12:15], s28 offen lds
  s_lshl_b32 s29, s21, 10
  s_add_u32 m0, s29, 28672
  s_mov_b32 s28, 786432
  buffer_load_dwordx4 v137, s[12:15], s28 offen lds
  s_lshl_b32 s29, s21, 10
  s_add_u32 m0, s29, 32768
  s_mov_b32 s28, 786432
  buffer_load_dwordx4 v138, s[12:15], s28 offen lds
  s_lshl_b32 s29, s21, 10
  s_add_u32 m0, s29, 36864
  s_mov_b32 s28, 786432
  buffer_load_dwordx4 v139, s[12:15], s28 offen lds
  s_lshl_b32 s29, s21, 10
  s_add_u32 m0, s29, 40960
  s_mov_b32 s28, 786432
  buffer_load_dwordx4 v140, s[12:15], s28 offen lds
  s_lshl_b32 s29, s21, 10
  s_add_u32 m0, s29, 45056
  s_mov_b32 s28, 786432
  buffer_load_dwordx4 v141, s[12:15], s28 offen lds
  s_lshl_b32 s29, s21, 10
  s_add_u32 m0, s29, 49152
  s_mov_b32 s28, 1572864
  buffer_load_dwordx4 v136, s[12:15], s28 offen lds
  s_lshl_b32 s29, s21, 10
  s_add_u32 m0, s29, 53248
  s_mov_b32 s28, 1572864
  buffer_load_dwordx4 v137, s[12:15], s28 offen lds
  s_lshl_b32 s29, s21, 10
  s_add_u32 m0, s29, 57344
  s_mov_b32 s28, 1572864
  buffer_load_dwordx4 v138, s[12:15], s28 offen lds
  s_lshl_b32 s29, s21, 10
  s_add_u32 m0, s29, 61440
  s_mov_b32 s28, 1572864
  buffer_load_dwordx4 v139, s[12:15], s28 offen lds
  s_lshl_b32 s29, s21, 10
  s_add_u32 m0, s29, 65536
  s_mov_b32 s28, 1572864
  buffer_load_dwordx4 v140, s[12:15], s28 offen lds
  s_lshl_b32 s29, s21, 10
  s_add_u32 m0, s29, 69632
  s_mov_b32 s28, 1572864
  buffer_load_dwordx4 v141, s[12:15], s28 offen lds
  s_lshl_b32 s29, s21, 10
  s_add_u32 m0, s29, 73728
  s_mov_b32 s28, 2359296
  buffer_load_dwordx4 v136, s[12:15], s28 offen lds
  s_lshl_b32 s29, s21, 10
  s_add_u32 m0, s29, 77824
  s_mov_b32 s28, 2359296
  buffer_load_dwordx4 v137, s[12:15], s28 offen lds
  s_lshl_b32 s29, s21, 10
  s_add_u32 m0, s29, 81920
  s_mov_b32 s28, 2359296
  buffer_load_dwordx4 v138, s[12:15], s28 offen lds
  s_lshl_b32 s29, s21, 10
  s_add_u32 m0, s29, 86016
  s_mov_b32 s28, 2359296
  buffer_load_dwordx4 v139, s[12:15], s28 offen lds
  s_lshl_b32 s29, s21, 10
  s_add_u32 m0, s29, 90112
  s_mov_b32 s28, 2359296
  buffer_load_dwordx4 v140, s[12:15], s28 offen lds
  s_lshl_b32 s29, s21, 10
  s_add_u32 m0, s29, 94208
  s_mov_b32 s28, 2359296
  buffer_load_dwordx4 v141, s[12:15], s28 offen lds
  s_lshl_b32 s29, s21, 10
  s_add_u32 m0, s29, 98304
  s_mov_b32 s28, 3145728
  buffer_load_dwordx4 v136, s[12:15], s28 offen lds
  s_lshl_b32 s29, s21, 10
  s_add_u32 m0, s29, 102400
  s_mov_b32 s28, 3145728
  buffer_load_dwordx4 v137, s[12:15], s28 offen lds
  s_lshl_b32 s29, s21, 10
  s_add_u32 m0, s29, 106496
  s_mov_b32 s28, 3145728
  buffer_load_dwordx4 v138, s[12:15], s28 offen lds
  s_lshl_b32 s29, s21, 10
  s_add_u32 m0, s29, 110592
  s_mov_b32 s28, 3145728
  buffer_load_dwordx4 v139, s[12:15], s28 offen lds
  s_lshl_b32 s29, s21, 10
  s_add_u32 m0, s29, 114688
  s_mov_b32 s28, 3145728
  buffer_load_dwordx4 v140, s[12:15], s28 offen lds
  s_lshl_b32 s29, s21, 10
  s_add_u32 m0, s29, 118784
  s_mov_b32 s28, 3145728
  buffer_load_dwordx4 v141, s[12:15], s28 offen lds
  s_waitcnt vmcnt(24)
  s_cmp_eq_u32 s21, 3
  s_cbranch_scc0 lna_74_\sfx\()
  s_mov_b64 s[24:25], exec
  s_mov_b64 exec, 1
  v_mov_b32 v2, 4992
  v_mov_b32 v3, 1
  buffer_atomic_add v3, v2, s[8:11], 0 offen
  s_mov_b64 exec, s[24:25]
lna_74_\sfx\():
  s_barrier
  s_lshl_b32 s29, s21, 10
  s_add_u32 m0, s29, 122880
  s_mov_b32 s28, 3932160
  buffer_load_dwordx4 v136, s[12:15], s28 offen lds
  s_lshl_b32 s29, s21, 10
  s_add_u32 m0, s29, 126976
  s_mov_b32 s28, 3932160
  buffer_load_dwordx4 v137, s[12:15], s28 offen lds
  s_lshl_b32 s29, s21, 10
  s_add_u32 m0, s29, 131072
  s_mov_b32 s28, 3932160
  buffer_load_dwordx4 v138, s[12:15], s28 offen lds
  s_lshl_b32 s29, s21, 10
  s_add_u32 m0, s29, 135168
  s_mov_b32 s28, 3932160
  buffer_load_dwordx4 v139, s[12:15], s28 offen lds
  s_lshl_b32 s29, s21, 10
  s_add_u32 m0, s29, 139264
  s_mov_b32 s28, 3932160
  buffer_load_dwordx4 v140, s[12:15], s28 offen lds
  s_lshl_b32 s29, s21, 10
  s_add_u32 m0, s29, 143360
  s_mov_b32 s28, 3932160
  buffer_load_dwordx4 v141, s[12:15], s28 offen lds
  v_add_u32 v143, 0, v142
  ds_read_b64_tr_b16 a[0:1], v143 offset:0
  ds_read_b64_tr_b16 a[2:3], v143 offset:3072
  ds_read_b64_tr_b16 a[4:5], v143 offset:12288
  ds_read_b64_tr_b16 a[6:7], v143 offset:15360
  ds_read_b64_tr_b16 a[80:81], v143 offset:256
  ds_read_b64_tr_b16 a[82:83], v143 offset:3328
  ds_read_b64_tr_b16 a[84:85], v143 offset:12544
  ds_read_b64_tr_b16 a[86:87], v143 offset:15616
  ds_read_b64_tr_b16 a[160:161], v143 offset:512
  ds_read_b64_tr_b16 a[162:163], v143 offset:3584
  ds_read_b64_tr_b16 a[164:165], v143 offset:12800
  ds_read_b64_tr_b16 a[166:167], v143 offset:15872
  s_waitcnt lgkmcnt(0)
  s_waitcnt vmcnt(24)
  s_barrier
  s_lshl_b32 s29, s21, 10
  s_add_u32 m0, s29, 0
  s_mov_b32 s28, 4718592
  buffer_load_dwordx4 v136, s[12:15], s28 offen lds
  s_lshl_b32 s29, s21, 10
  s_add_u32 m0, s29, 4096
  s_mov_b32 s28, 4718592
  buffer_load_dwordx4 v137, s[12:15], s28 offen lds
  s_lshl_b32 s29, s21, 10
  s_add_u32 m0, s29, 8192
  s_mov_b32 s28, 4718592
  buffer_load_dwordx4 v138, s[12:15], s28 offen lds
  s_lshl_b32 s29, s21, 10
  s_add_u32 m0, s29, 12288
  s_mov_b32 s28, 4718592
  buffer_load_dwordx4 v139, s[12:15], s28 offen lds
  s_lshl_b32 s29, s21, 10
  s_add_u32 m0, s29, 16384
  s_mov_b32 s28, 4718592
  buffer_load_dwordx4 v140, s[12:15], s28 offen lds
  s_lshl_b32 s29, s21, 10
  s_add_u32 m0, s29, 20480
  s_mov_b32 s28, 4718592
  buffer_load_dwordx4 v141, s[12:15], s28 offen lds
  v_add_u32 v143, 24576, v142
  ds_read_b64_tr_b16 a[8:9], v143 offset:0
  ds_read_b64_tr_b16 a[10:11], v143 offset:3072
  ds_read_b64_tr_b16 a[12:13], v143 offset:12288
  ds_read_b64_tr_b16 a[14:15], v143 offset:15360
  ds_read_b64_tr_b16 a[88:89], v143 offset:256
  ds_read_b64_tr_b16 a[90:91], v143 offset:3328
  ds_read_b64_tr_b16 a[92:93], v143 offset:12544
  ds_read_b64_tr_b16 a[94:95], v143 offset:15616
  ds_read_b64_tr_b16 a[168:169], v143 offset:512
  ds_read_b64_tr_b16 a[170:171], v143 offset:3584
  ds_read_b64_tr_b16 a[172:173], v143 offset:12800
  ds_read_b64_tr_b16 a[174:175], v143 offset:15872
  s_waitcnt lgkmcnt(0)
  s_waitcnt vmcnt(24)
  s_barrier
  s_lshl_b32 s29, s21, 10
  s_add_u32 m0, s29, 24576
  s_mov_b32 s28, 5505024
  buffer_load_dwordx4 v136, s[12:15], s28 offen lds
  s_lshl_b32 s29, s21, 10
  s_add_u32 m0, s29, 28672
  s_mov_b32 s28, 5505024
  buffer_load_dwordx4 v137, s[12:15], s28 offen lds
  s_lshl_b32 s29, s21, 10
  s_add_u32 m0, s29, 32768
  s_mov_b32 s28, 5505024
  buffer_load_dwordx4 v138, s[12:15], s28 offen lds
  s_lshl_b32 s29, s21, 10
  s_add_u32 m0, s29, 36864
  s_mov_b32 s28, 5505024
  buffer_load_dwordx4 v139, s[12:15], s28 offen lds
  s_lshl_b32 s29, s21, 10
  s_add_u32 m0, s29, 40960
  s_mov_b32 s28, 5505024
  buffer_load_dwordx4 v140, s[12:15], s28 offen lds
  s_lshl_b32 s29, s21, 10
  s_add_u32 m0, s29, 45056
  s_mov_b32 s28, 5505024
  buffer_load_dwordx4 v141, s[12:15], s28 offen lds
  v_add_u32 v143, 49152, v142
  ds_read_b64_tr_b16 a[16:17], v143 offset:0
  ds_read_b64_tr_b16 a[18:19], v143 offset:3072
  ds_read_b64_tr_b16 a[20:21], v143 offset:12288
  ds_read_b64_tr_b16 a[22:23], v143 offset:15360
  ds_read_b64_tr_b16 a[96:97], v143 offset:256
  ds_read_b64_tr_b16 a[98:99], v143 offset:3328
  ds_read_b64_tr_b16 a[100:101], v143 offset:12544
  ds_read_b64_tr_b16 a[102:103], v143 offset:15616
  ds_read_b64_tr_b16 a[176:177], v143 offset:512
  ds_read_b64_tr_b16 a[178:179], v143 offset:3584
  ds_read_b64_tr_b16 a[180:181], v143 offset:12800
  ds_read_b64_tr_b16 a[182:183], v143 offset:15872
  s_waitcnt lgkmcnt(0)
  s_waitcnt vmcnt(24)
  s_barrier
  s_lshl_b32 s29, s21, 10
  s_add_u32 m0, s29, 49152
  s_mov_b32 s28, 6291456
  buffer_load_dwordx4 v136, s[12:15], s28 offen lds
  s_lshl_b32 s29, s21, 10
  s_add_u32 m0, s29, 53248
  s_mov_b32 s28, 6291456
  buffer_load_dwordx4 v137, s[12:15], s28 offen lds
  s_lshl_b32 s29, s21, 10
  s_add_u32 m0, s29, 57344
  s_mov_b32 s28, 6291456
  buffer_load_dwordx4 v138, s[12:15], s28 offen lds
  s_lshl_b32 s29, s21, 10
  s_add_u32 m0, s29, 61440
  s_mov_b32 s28, 6291456
  buffer_load_dwordx4 v139, s[12:15], s28 offen lds
  s_lshl_b32 s29, s21, 10
  s_add_u32 m0, s29, 65536
  s_mov_b32 s28, 6291456
  buffer_load_dwordx4 v140, s[12:15], s28 offen lds
  s_lshl_b32 s29, s21, 10
  s_add_u32 m0, s29, 69632
  s_mov_b32 s28, 6291456
  buffer_load_dwordx4 v141, s[12:15], s28 offen lds
  v_add_u32 v143, 73728, v142
  ds_read_b64_tr_b16 a[24:25], v143 offset:0
  ds_read_b64_tr_b16 a[26:27], v143 offset:3072
  ds_read_b64_tr_b16 a[28:29], v143 offset:12288
  ds_read_b64_tr_b16 a[30:31], v143 offset:15360
  ds_read_b64_tr_b16 a[104:105], v143 offset:256
  ds_read_b64_tr_b16 a[106:107], v143 offset:3328
  ds_read_b64_tr_b16 a[108:109], v143 offset:12544
  ds_read_b64_tr_b16 a[110:111], v143 offset:15616
  ds_read_b64_tr_b16 a[184:185], v143 offset:512
  ds_read_b64_tr_b16 a[186:187], v143 offset:3584
  ds_read_b64_tr_b16 a[188:189], v143 offset:12800
  ds_read_b64_tr_b16 a[190:191], v143 offset:15872
  s_waitcnt lgkmcnt(0)
  s_waitcnt vmcnt(24)
  s_barrier
  s_lshl_b32 s29, s21, 10
  s_add_u32 m0, s29, 73728
  s_mov_b32 s28, 7077888
  buffer_load_dwordx4 v136, s[12:15], s28 offen lds
  s_lshl_b32 s29, s21, 10
  s_add_u32 m0, s29, 77824
  s_mov_b32 s28, 7077888
  buffer_load_dwordx4 v137, s[12:15], s28 offen lds
  s_lshl_b32 s29, s21, 10
  s_add_u32 m0, s29, 81920
  s_mov_b32 s28, 7077888
  buffer_load_dwordx4 v138, s[12:15], s28 offen lds
  s_lshl_b32 s29, s21, 10
  s_add_u32 m0, s29, 86016
  s_mov_b32 s28, 7077888
  buffer_load_dwordx4 v139, s[12:15], s28 offen lds
  s_lshl_b32 s29, s21, 10
  s_add_u32 m0, s29, 90112
  s_mov_b32 s28, 7077888
  buffer_load_dwordx4 v140, s[12:15], s28 offen lds
  s_lshl_b32 s29, s21, 10
  s_add_u32 m0, s29, 94208
  s_mov_b32 s28, 7077888
  buffer_load_dwordx4 v141, s[12:15], s28 offen lds
  v_add_u32 v143, 98304, v142
  ds_read_b64_tr_b16 a[32:33], v143 offset:0
  ds_read_b64_tr_b16 a[34:35], v143 offset:3072
  ds_read_b64_tr_b16 a[36:37], v143 offset:12288
  ds_read_b64_tr_b16 a[38:39], v143 offset:15360
  ds_read_b64_tr_b16 a[112:113], v143 offset:256
  ds_read_b64_tr_b16 a[114:115], v143 offset:3328
  ds_read_b64_tr_b16 a[116:117], v143 offset:12544
  ds_read_b64_tr_b16 a[118:119], v143 offset:15616
  ds_read_b64_tr_b16 a[192:193], v143 offset:512
  ds_read_b64_tr_b16 a[194:195], v143 offset:3584
  ds_read_b64_tr_b16 a[196:197], v143 offset:12800
  ds_read_b64_tr_b16 a[198:199], v143 offset:15872
  s_waitcnt lgkmcnt(0)
  s_waitcnt vmcnt(24)
  s_barrier
  s_lshl_b32 s29, s21, 10
  s_add_u32 m0, s29, 98304
  s_mov_b32 s28, 0
  buffer_load_dwordx4 v136, s[16:19], s28 offen lds
  s_lshl_b32 s29, s21, 10
  s_add_u32 m0, s29, 102400
  s_mov_b32 s28, 0
  buffer_load_dwordx4 v137, s[16:19], s28 offen lds
  s_lshl_b32 s29, s21, 10
  s_add_u32 m0, s29, 106496
  s_mov_b32 s28, 0
  buffer_load_dwordx4 v138, s[16:19], s28 offen lds
  s_lshl_b32 s29, s21, 10
  s_add_u32 m0, s29, 110592
  s_mov_b32 s28, 0
  buffer_load_dwordx4 v139, s[16:19], s28 offen lds
  s_lshl_b32 s29, s21, 10
  s_add_u32 m0, s29, 114688
  s_mov_b32 s28, 0
  buffer_load_dwordx4 v140, s[16:19], s28 offen lds
  s_lshl_b32 s29, s21, 10
  s_add_u32 m0, s29, 118784
  s_mov_b32 s28, 0
  buffer_load_dwordx4 v141, s[16:19], s28 offen lds
  v_add_u32 v143, 122880, v142
  ds_read_b64_tr_b16 a[40:41], v143 offset:0
  ds_read_b64_tr_b16 a[42:43], v143 offset:3072
  ds_read_b64_tr_b16 a[44:45], v143 offset:12288
  ds_read_b64_tr_b16 a[46:47], v143 offset:15360
  ds_read_b64_tr_b16 a[120:121], v143 offset:256
  ds_read_b64_tr_b16 a[122:123], v143 offset:3328
  ds_read_b64_tr_b16 a[124:125], v143 offset:12544
  ds_read_b64_tr_b16 a[126:127], v143 offset:15616
  ds_read_b64_tr_b16 a[200:201], v143 offset:512
  ds_read_b64_tr_b16 a[202:203], v143 offset:3584
  ds_read_b64_tr_b16 a[204:205], v143 offset:12800
  ds_read_b64_tr_b16 a[206:207], v143 offset:15872
  s_waitcnt lgkmcnt(0)
  s_waitcnt vmcnt(24)
  s_barrier
  s_lshl_b32 s29, s21, 10
  s_add_u32 m0, s29, 122880
  s_mov_b32 s28, 1572864
  buffer_load_dwordx4 v136, s[16:19], s28 offen lds
  s_lshl_b32 s29, s21, 10
  s_add_u32 m0, s29, 126976
  s_mov_b32 s28, 1572864
  buffer_load_dwordx4 v137, s[16:19], s28 offen lds
  s_lshl_b32 s29, s21, 10
  s_add_u32 m0, s29, 131072
  s_mov_b32 s28, 1572864
  buffer_load_dwordx4 v138, s[16:19], s28 offen lds
  s_lshl_b32 s29, s21, 10
  s_add_u32 m0, s29, 135168
  s_mov_b32 s28, 1572864
  buffer_load_dwordx4 v139, s[16:19], s28 offen lds
  s_lshl_b32 s29, s21, 10
  s_add_u32 m0, s29, 139264
  s_mov_b32 s28, 1572864
  buffer_load_dwordx4 v140, s[16:19], s28 offen lds
  s_lshl_b32 s29, s21, 10
  s_add_u32 m0, s29, 143360
  s_mov_b32 s28, 1572864
  buffer_load_dwordx4 v141, s[16:19], s28 offen lds
  v_add_u32 v143, 0, v142
  ds_read_b64_tr_b16 a[48:49], v143 offset:0
  ds_read_b64_tr_b16 a[50:51], v143 offset:3072
  ds_read_b64_tr_b16 a[52:53], v143 offset:12288
  ds_read_b64_tr_b16 a[54:55], v143 offset:15360
  ds_read_b64_tr_b16 a[128:129], v143 offset:256
  ds_read_b64_tr_b16 a[130:131], v143 offset:3328
  ds_read_b64_tr_b16 a[132:133], v143 offset:12544
  ds_read_b64_tr_b16 a[134:135], v143 offset:15616
  ds_read_b64_tr_b16 a[208:209], v143 offset:512
  ds_read_b64_tr_b16 a[210:211], v143 offset:3584
  ds_read_b64_tr_b16 a[212:213], v143 offset:12800
  ds_read_b64_tr_b16 a[214:215], v143 offset:15872
  s_waitcnt lgkmcnt(0)
  s_waitcnt vmcnt(24)
  s_barrier
  s_lshl_b32 s29, s21, 10
  s_add_u32 m0, s29, 0
  s_mov_b32 s28, 3145728
  buffer_load_dwordx4 v136, s[16:19], s28 offen lds
  s_lshl_b32 s29, s21, 10
  s_add_u32 m0, s29, 4096
  s_mov_b32 s28, 3145728
  buffer_load_dwordx4 v137, s[16:19], s28 offen lds
  s_lshl_b32 s29, s21, 10
  s_add_u32 m0, s29, 8192
  s_mov_b32 s28, 3145728
  buffer_load_dwordx4 v138, s[16:19], s28 offen lds
  s_lshl_b32 s29, s21, 10
  s_add_u32 m0, s29, 12288
  s_mov_b32 s28, 3145728
  buffer_load_dwordx4 v139, s[16:19], s28 offen lds
  s_lshl_b32 s29, s21, 10
  s_add_u32 m0, s29, 16384
  s_mov_b32 s28, 3145728
  buffer_load_dwordx4 v140, s[16:19], s28 offen lds
  s_lshl_b32 s29, s21, 10
  s_add_u32 m0, s29, 20480
  s_mov_b32 s28, 3145728
  buffer_load_dwordx4 v141, s[16:19], s28 offen lds
  v_add_u32 v143, 24576, v142
  ds_read_b64_tr_b16 a[56:57], v143 offset:0
  ds_read_b64_tr_b16 a[58:59], v143 offset:3072
  ds_read_b64_tr_b16 a[60:61], v143 offset:12288
  ds_read_b64_tr_b16 a[62:63], v143 offset:15360
  ds_read_b64_tr_b16 a[136:137], v143 offset:256
  ds_read_b64_tr_b16 a[138:139], v143 offset:3328
  ds_read_b64_tr_b16 a[140:141], v143 offset:12544
  ds_read_b64_tr_b16 a[142:143], v143 offset:15616
  ds_read_b64_tr_b16 a[216:217], v143 offset:512
  ds_read_b64_tr_b16 a[218:219], v143 offset:3584
  ds_read_b64_tr_b16 a[220:221], v143 offset:12800
  ds_read_b64_tr_b16 a[222:223], v143 offset:15872
  s_waitcnt lgkmcnt(0)
  s_waitcnt vmcnt(24)
  s_barrier
  s_lshl_b32 s29, s21, 10
  s_add_u32 m0, s29, 24576
  s_mov_b32 s28, 4718592
  buffer_load_dwordx4 v136, s[16:19], s28 offen lds
  s_lshl_b32 s29, s21, 10
  s_add_u32 m0, s29, 28672
  s_mov_b32 s28, 4718592
  buffer_load_dwordx4 v137, s[16:19], s28 offen lds
  s_lshl_b32 s29, s21, 10
  s_add_u32 m0, s29, 32768
  s_mov_b32 s28, 4718592
  buffer_load_dwordx4 v138, s[16:19], s28 offen lds
  s_lshl_b32 s29, s21, 10
  s_add_u32 m0, s29, 36864
  s_mov_b32 s28, 4718592
  buffer_load_dwordx4 v139, s[16:19], s28 offen lds
  s_lshl_b32 s29, s21, 10
  s_add_u32 m0, s29, 40960
  s_mov_b32 s28, 4718592
  buffer_load_dwordx4 v140, s[16:19], s28 offen lds
  s_lshl_b32 s29, s21, 10
  s_add_u32 m0, s29, 45056
  s_mov_b32 s28, 4718592
  buffer_load_dwordx4 v141, s[16:19], s28 offen lds
  v_add_u32 v143, 49152, v142
  ds_read_b64_tr_b16 a[64:65], v143 offset:0
  ds_read_b64_tr_b16 a[66:67], v143 offset:3072
  ds_read_b64_tr_b16 a[68:69], v143 offset:12288
  ds_read_b64_tr_b16 a[70:71], v143 offset:15360
  ds_read_b64_tr_b16 a[144:145], v143 offset:256
  ds_read_b64_tr_b16 a[146:147], v143 offset:3328
  ds_read_b64_tr_b16 a[148:149], v143 offset:12544
  ds_read_b64_tr_b16 a[150:151], v143 offset:15616
  ds_read_b64_tr_b16 a[224:225], v143 offset:512
  ds_read_b64_tr_b16 a[226:227], v143 offset:3584
  ds_read_b64_tr_b16 a[228:229], v143 offset:12800
  ds_read_b64_tr_b16 a[230:231], v143 offset:15872
  s_waitcnt lgkmcnt(0)
  s_waitcnt vmcnt(24)
  s_barrier
  s_lshl_b32 s29, s21, 10
  s_add_u32 m0, s29, 49152
  s_mov_b32 s28, 6291456
  buffer_load_dwordx4 v136, s[16:19], s28 offen lds
  s_lshl_b32 s29, s21, 10
  s_add_u32 m0, s29, 53248
  s_mov_b32 s28, 6291456
  buffer_load_dwordx4 v137, s[16:19], s28 offen lds
  s_lshl_b32 s29, s21, 10
  s_add_u32 m0, s29, 57344
  s_mov_b32 s28, 6291456
  buffer_load_dwordx4 v138, s[16:19], s28 offen lds
  s_lshl_b32 s29, s21, 10
  s_add_u32 m0, s29, 61440
  s_mov_b32 s28, 6291456
  buffer_load_dwordx4 v139, s[16:19], s28 offen lds
  s_lshl_b32 s29, s21, 10
  s_add_u32 m0, s29, 65536
  s_mov_b32 s28, 6291456
  buffer_load_dwordx4 v140, s[16:19], s28 offen lds
  s_lshl_b32 s29, s21, 10
  s_add_u32 m0, s29, 69632
  s_mov_b32 s28, 6291456
  buffer_load_dwordx4 v141, s[16:19], s28 offen lds
  v_add_u32 v143, 73728, v142
  ds_read_b64_tr_b16 a[72:73], v143 offset:0
  ds_read_b64_tr_b16 a[74:75], v143 offset:3072
  ds_read_b64_tr_b16 a[76:77], v143 offset:12288
  ds_read_b64_tr_b16 a[78:79], v143 offset:15360
  ds_read_b64_tr_b16 a[152:153], v143 offset:256
  ds_read_b64_tr_b16 a[154:155], v143 offset:3328
  ds_read_b64_tr_b16 a[156:157], v143 offset:12544
  ds_read_b64_tr_b16 a[158:159], v143 offset:15616
  ds_read_b64_tr_b16 a[232:233], v143 offset:512
  ds_read_b64_tr_b16 a[234:235], v143 offset:3584
  ds_read_b64_tr_b16 a[236:237], v143 offset:12800
  ds_read_b64_tr_b16 a[238:239], v143 offset:15872
  s_waitcnt lgkmcnt(0)
  s_waitcnt vmcnt(24)
  s_barrier
  s_lshl_b32 s29, s21, 10
  s_add_u32 m0, s29, 73728
  s_mov_b32 s28, 786432
  buffer_load_dwordx4 v136, s[16:19], s28 offen lds
  s_lshl_b32 s29, s21, 10
  s_add_u32 m0, s29, 77824
  s_mov_b32 s28, 786432
  buffer_load_dwordx4 v137, s[16:19], s28 offen lds
  s_lshl_b32 s29, s21, 10
  s_add_u32 m0, s29, 81920
  s_mov_b32 s28, 786432
  buffer_load_dwordx4 v138, s[16:19], s28 offen lds
  s_lshl_b32 s29, s21, 10
  s_add_u32 m0, s29, 86016
  s_mov_b32 s28, 786432
  buffer_load_dwordx4 v139, s[16:19], s28 offen lds
  s_lshl_b32 s29, s21, 10
  s_add_u32 m0, s29, 90112
  s_mov_b32 s28, 786432
  buffer_load_dwordx4 v140, s[16:19], s28 offen lds
  s_lshl_b32 s29, s21, 10
  s_add_u32 m0, s29, 94208
  s_mov_b32 s28, 786432
  buffer_load_dwordx4 v141, s[16:19], s28 offen lds
  v_add_u32 v143, 98304, v142
  ds_read_b64_tr_b16 a[240:241], v143 offset:0
  ds_read_b64_tr_b16 a[242:243], v143 offset:3072
  ds_read_b64_tr_b16 a[244:245], v143 offset:12288
  ds_read_b64_tr_b16 a[246:247], v143 offset:15360
  ds_read_b64_tr_b16 v[176:177], v143 offset:256
  ds_read_b64_tr_b16 v[178:179], v143 offset:3328
  ds_read_b64_tr_b16 v[180:181], v143 offset:12544
  ds_read_b64_tr_b16 v[182:183], v143 offset:15616
  ds_read_b64_tr_b16 v[216:217], v143 offset:512
  ds_read_b64_tr_b16 v[218:219], v143 offset:3584
  ds_read_b64_tr_b16 v[220:221], v143 offset:12800
  ds_read_b64_tr_b16 v[222:223], v143 offset:15872
  s_waitcnt lgkmcnt(0)
  s_waitcnt vmcnt(24)
  s_barrier
  s_lshl_b32 s29, s21, 10
  s_add_u32 m0, s29, 98304
  s_mov_b32 s28, 2359296
  buffer_load_dwordx4 v136, s[16:19], s28 offen lds
  s_lshl_b32 s29, s21, 10
  s_add_u32 m0, s29, 102400
  s_mov_b32 s28, 2359296
  buffer_load_dwordx4 v137, s[16:19], s28 offen lds
  s_lshl_b32 s29, s21, 10
  s_add_u32 m0, s29, 106496
  s_mov_b32 s28, 2359296
  buffer_load_dwordx4 v138, s[16:19], s28 offen lds
  s_lshl_b32 s29, s21, 10
  s_add_u32 m0, s29, 110592
  s_mov_b32 s28, 2359296
  buffer_load_dwordx4 v139, s[16:19], s28 offen lds
  s_lshl_b32 s29, s21, 10
  s_add_u32 m0, s29, 114688
  s_mov_b32 s28, 2359296
  buffer_load_dwordx4 v140, s[16:19], s28 offen lds
  s_lshl_b32 s29, s21, 10
  s_add_u32 m0, s29, 118784
  s_mov_b32 s28, 2359296
  buffer_load_dwordx4 v141, s[16:19], s28 offen lds
  v_add_u32 v143, 122880, v142
  ds_read_b64_tr_b16 a[248:249], v143 offset:0
  ds_read_b64_tr_b16 a[250:251], v143 offset:3072
  ds_read_b64_tr_b16 a[252:253], v143 offset:12288
  ds_read_b64_tr_b16 a[254:255], v143 offset:15360
  ds_read_b64_tr_b16 v[184:185], v143 offset:256
  ds_read_b64_tr_b16 v[186:187], v143 offset:3328
  ds_read_b64_tr_b16 v[188:189], v143 offset:12544
  ds_read_b64_tr_b16 v[190:191], v143 offset:15616
  ds_read_b64_tr_b16 v[224:225], v143 offset:512
  ds_read_b64_tr_b16 v[226:227], v143 offset:3584
  ds_read_b64_tr_b16 v[228:229], v143 offset:12800
  ds_read_b64_tr_b16 v[230:231], v143 offset:15872
  s_waitcnt lgkmcnt(0)
  s_waitcnt vmcnt(24)
  s_barrier
  s_lshl_b32 s29, s21, 10
  s_add_u32 m0, s29, 122880
  s_mov_b32 s28, 3932160
  buffer_load_dwordx4 v136, s[16:19], s28 offen lds
  s_lshl_b32 s29, s21, 10
  s_add_u32 m0, s29, 126976
  s_mov_b32 s28, 3932160
  buffer_load_dwordx4 v137, s[16:19], s28 offen lds
  s_lshl_b32 s29, s21, 10
  s_add_u32 m0, s29, 131072
  s_mov_b32 s28, 3932160
  buffer_load_dwordx4 v138, s[16:19], s28 offen lds
  s_lshl_b32 s29, s21, 10
  s_add_u32 m0, s29, 135168
  s_mov_b32 s28, 3932160
  buffer_load_dwordx4 v139, s[16:19], s28 offen lds
  s_lshl_b32 s29, s21, 10
  s_add_u32 m0, s29, 139264
  s_mov_b32 s28, 3932160
  buffer_load_dwordx4 v140, s[16:19], s28 offen lds
  s_lshl_b32 s29, s21, 10
  s_add_u32 m0, s29, 143360
  s_mov_b32 s28, 3932160
  buffer_load_dwordx4 v141, s[16:19], s28 offen lds
  v_add_u32 v143, 0, v142
  ds_read_b64_tr_b16 v[152:153], v143 offset:0
  ds_read_b64_tr_b16 v[154:155], v143 offset:3072
  ds_read_b64_tr_b16 v[156:157], v143 offset:12288
  ds_read_b64_tr_b16 v[158:159], v143 offset:15360
  ds_read_b64_tr_b16 v[192:193], v143 offset:256
  ds_read_b64_tr_b16 v[194:195], v143 offset:3328
  ds_read_b64_tr_b16 v[196:197], v143 offset:12544
  ds_read_b64_tr_b16 v[198:199], v143 offset:15616
  ds_read_b64_tr_b16 v[232:233], v143 offset:512
  ds_read_b64_tr_b16 v[234:235], v143 offset:3584
  ds_read_b64_tr_b16 v[236:237], v143 offset:12800
  ds_read_b64_tr_b16 v[238:239], v143 offset:15872
  s_waitcnt lgkmcnt(0)
  s_waitcnt vmcnt(24)
  s_barrier
  s_lshl_b32 s29, s21, 10
  s_add_u32 m0, s29, 0
  s_mov_b32 s28, 5505024
  buffer_load_dwordx4 v136, s[16:19], s28 offen lds
  s_lshl_b32 s29, s21, 10
  s_add_u32 m0, s29, 4096
  s_mov_b32 s28, 5505024
  buffer_load_dwordx4 v137, s[16:19], s28 offen lds
  s_lshl_b32 s29, s21, 10
  s_add_u32 m0, s29, 8192
  s_mov_b32 s28, 5505024
  buffer_load_dwordx4 v138, s[16:19], s28 offen lds
  s_lshl_b32 s29, s21, 10
  s_add_u32 m0, s29, 12288
  s_mov_b32 s28, 5505024
  buffer_load_dwordx4 v139, s[16:19], s28 offen lds
  s_lshl_b32 s29, s21, 10
  s_add_u32 m0, s29, 16384
  s_mov_b32 s28, 5505024
  buffer_load_dwordx4 v140, s[16:19], s28 offen lds
  s_lshl_b32 s29, s21, 10
  s_add_u32 m0, s29, 20480
  s_mov_b32 s28, 5505024
  buffer_load_dwordx4 v141, s[16:19], s28 offen lds
  v_add_u32 v143, 24576, v142
  ds_read_b64_tr_b16 v[160:161], v143 offset:0
  ds_read_b64_tr_b16 v[162:163], v143 offset:3072
  ds_read_b64_tr_b16 v[164:165], v143 offset:12288
  ds_read_b64_tr_b16 v[166:167], v143 offset:15360
  ds_read_b64_tr_b16 v[200:201], v143 offset:256
  ds_read_b64_tr_b16 v[202:203], v143 offset:3328
  ds_read_b64_tr_b16 v[204:205], v143 offset:12544
  ds_read_b64_tr_b16 v[206:207], v143 offset:15616
  ds_read_b64_tr_b16 v[240:241], v143 offset:512
  ds_read_b64_tr_b16 v[242:243], v143 offset:3584
  ds_read_b64_tr_b16 v[244:245], v143 offset:12800
  ds_read_b64_tr_b16 v[246:247], v143 offset:15872
  s_waitcnt lgkmcnt(0)
  s_waitcnt vmcnt(24)
  s_barrier
  s_lshl_b32 s29, s21, 10
  s_add_u32 m0, s29, 24576
  s_mov_b32 s28, 7077888
  buffer_load_dwordx4 v136, s[16:19], s28 offen lds
  s_lshl_b32 s29, s21, 10
  s_add_u32 m0, s29, 28672
  s_mov_b32 s28, 7077888
  buffer_load_dwordx4 v137, s[16:19], s28 offen lds
  s_lshl_b32 s29, s21, 10
  s_add_u32 m0, s29, 32768
  s_mov_b32 s28, 7077888
  buffer_load_dwordx4 v138, s[16:19], s28 offen lds
  s_lshl_b32 s29, s21, 10
  s_add_u32 m0, s29, 36864
  s_mov_b32 s28, 7077888
  buffer_load_dwordx4 v139, s[16:19], s28 offen lds
  s_lshl_b32 s29, s21, 10
  s_add_u32 m0, s29, 40960
  s_mov_b32 s28, 7077888
  buffer_load_dwordx4 v140, s[16:19], s28 offen lds
  s_lshl_b32 s29, s21, 10
  s_add_u32 m0, s29, 45056
  s_mov_b32 s28, 7077888
  buffer_load_dwordx4 v141, s[16:19], s28 offen lds
  v_add_u32 v143, 49152, v142
  ds_read_b64_tr_b16 v[168:169], v143 offset:0
  ds_read_b64_tr_b16 v[170:171], v143 offset:3072
  ds_read_b64_tr_b16 v[172:173], v143 offset:12288
  ds_read_b64_tr_b16 v[174:175], v143 offset:15360
  ds_read_b64_tr_b16 v[208:209], v143 offset:256
  ds_read_b64_tr_b16 v[210:211], v143 offset:3328
  ds_read_b64_tr_b16 v[212:213], v143 offset:12544
  ds_read_b64_tr_b16 v[214:215], v143 offset:15616
  ds_read_b64_tr_b16 v[248:249], v143 offset:512
  ds_read_b64_tr_b16 v[250:251], v143 offset:3584
  ds_read_b64_tr_b16 v[252:253], v143 offset:12800
  ds_read_b64_tr_b16 v[254:255], v143 offset:15872
  s_waitcnt lgkmcnt(0)
  s_waitcnt vmcnt(24)
  s_barrier
  v_add_u32 v143, 73728, v142
  ds_read_b64_tr_b16 v[16:17], v143 offset:0
  ds_read_b64_tr_b16 v[18:19], v143 offset:3072
  ds_read_b64_tr_b16 v[20:21], v143 offset:12288
  ds_read_b64_tr_b16 v[22:23], v143 offset:15360
  ds_read_b64_tr_b16 v[24:25], v143 offset:256
  ds_read_b64_tr_b16 v[26:27], v143 offset:3328
  ds_read_b64_tr_b16 v[28:29], v143 offset:12544
  ds_read_b64_tr_b16 v[30:31], v143 offset:15616
  ds_read_b64_tr_b16 v[32:33], v143 offset:512
  ds_read_b64_tr_b16 v[34:35], v143 offset:3584
  ds_read_b64_tr_b16 v[36:37], v143 offset:12800
  ds_read_b64_tr_b16 v[38:39], v143 offset:15872
  s_waitcnt lgkmcnt(0)
  s_waitcnt vmcnt(18)
  s_barrier
  v_add_u32 v143, 98304, v142
  ds_read_b64_tr_b16 v[40:41], v143 offset:0
  ds_read_b64_tr_b16 v[42:43], v143 offset:3072
  ds_read_b64_tr_b16 v[44:45], v143 offset:12288
  ds_read_b64_tr_b16 v[46:47], v143 offset:15360
  ds_read_b64_tr_b16 v[48:49], v143 offset:256
  ds_read_b64_tr_b16 v[50:51], v143 offset:3328
  ds_read_b64_tr_b16 v[52:53], v143 offset:12544
  ds_read_b64_tr_b16 v[54:55], v143 offset:15616
  ds_read_b64_tr_b16 v[56:57], v143 offset:512
  ds_read_b64_tr_b16 v[58:59], v143 offset:3584
  ds_read_b64_tr_b16 v[60:61], v143 offset:12800
  ds_read_b64_tr_b16 v[62:63], v143 offset:15872
  s_waitcnt lgkmcnt(0)
  s_waitcnt vmcnt(12)
  s_barrier
  v_add_u32 v143, 122880, v142
  ds_read_b64_tr_b16 v[64:65], v143 offset:0
  ds_read_b64_tr_b16 v[66:67], v143 offset:3072
  ds_read_b64_tr_b16 v[68:69], v143 offset:12288
  ds_read_b64_tr_b16 v[70:71], v143 offset:15360
  ds_read_b64_tr_b16 v[72:73], v143 offset:256
  ds_read_b64_tr_b16 v[74:75], v143 offset:3328
  ds_read_b64_tr_b16 v[76:77], v143 offset:12544
  ds_read_b64_tr_b16 v[78:79], v143 offset:15616
  ds_read_b64_tr_b16 v[80:81], v143 offset:512
  ds_read_b64_tr_b16 v[82:83], v143 offset:3584
  ds_read_b64_tr_b16 v[84:85], v143 offset:12800
  ds_read_b64_tr_b16 v[86:87], v143 offset:15872
  s_waitcnt lgkmcnt(0)
  s_waitcnt vmcnt(6)
  s_barrier
  v_add_u32 v143, 0, v142
  ds_read_b64_tr_b16 v[88:89], v143 offset:0
  ds_read_b64_tr_b16 v[90:91], v143 offset:3072
  ds_read_b64_tr_b16 v[92:93], v143 offset:12288
  ds_read_b64_tr_b16 v[94:95], v143 offset:15360
  ds_read_b64_tr_b16 v[96:97], v143 offset:256
  ds_read_b64_tr_b16 v[98:99], v143 offset:3328
  ds_read_b64_tr_b16 v[100:101], v143 offset:12544
  ds_read_b64_tr_b16 v[102:103], v143 offset:15616
  ds_read_b64_tr_b16 v[104:105], v143 offset:512
  ds_read_b64_tr_b16 v[106:107], v143 offset:3584
  ds_read_b64_tr_b16 v[108:109], v143 offset:12800
  ds_read_b64_tr_b16 v[110:111], v143 offset:15872
  s_waitcnt lgkmcnt(0)
  s_waitcnt vmcnt(0)
  s_barrier
  v_add_u32 v143, 24576, v142
  ds_read_b64_tr_b16 v[112:113], v143 offset:0
  ds_read_b64_tr_b16 v[114:115], v143 offset:3072
  ds_read_b64_tr_b16 v[116:117], v143 offset:12288
  ds_read_b64_tr_b16 v[118:119], v143 offset:15360
  ds_read_b64_tr_b16 v[120:121], v143 offset:256
  ds_read_b64_tr_b16 v[122:123], v143 offset:3328
  ds_read_b64_tr_b16 v[124:125], v143 offset:12544
  ds_read_b64_tr_b16 v[126:127], v143 offset:15616
  ds_read_b64_tr_b16 v[128:129], v143 offset:512
  ds_read_b64_tr_b16 v[130:131], v143 offset:3584
  ds_read_b64_tr_b16 v[132:133], v143 offset:12800
  ds_read_b64_tr_b16 v[134:135], v143 offset:15872
  s_waitcnt lgkmcnt(0)
  s_barrier
  v_lshlrev_b32 v2, 4, v1
  s_mul_i32 s28, s21, 30720
  v_add_u32 v143, s28, v2
  ds_write_b128 v143, v[16:19] offset:0
  ds_write_b128 v143, v[20:23] offset:1024
  ds_write_b128 v143, v[24:27] offset:10240
  ds_write_b128 v143, v[28:31] offset:11264
  ds_write_b128 v143, v[32:35] offset:20480
  ds_write_b128 v143, v[36:39] offset:21504
  ds_write_b128 v143, v[40:43] offset:2048
  ds_write_b128 v143, v[44:47] offset:3072
  ds_write_b128 v143, v[48:51] offset:12288
  ds_write_b128 v143, v[52:55] offset:13312
  ds_write_b128 v143, v[56:59] offset:22528
  ds_write_b128 v143, v[60:63] offset:23552
  ds_write_b128 v143, v[64:67] offset:4096
  ds_write_b128 v143, v[68:71] offset:5120
  ds_write_b128 v143, v[72:75] offset:14336
  ds_write_b128 v143, v[76:79] offset:15360
  ds_write_b128 v143, v[80:83] offset:24576
  ds_write_b128 v143, v[84:87] offset:25600
  ds_write_b128 v143, v[88:91] offset:6144
  ds_write_b128 v143, v[92:95] offset:7168
  ds_write_b128 v143, v[96:99] offset:16384
  ds_write_b128 v143, v[100:103] offset:17408
  ds_write_b128 v143, v[104:107] offset:26624
  ds_write_b128 v143, v[108:111] offset:27648
  ds_write_b128 v143, v[112:115] offset:8192
  ds_write_b128 v143, v[116:119] offset:9216
  ds_write_b128 v143, v[120:123] offset:18432
  ds_write_b128 v143, v[124:127] offset:19456
  ds_write_b128 v143, v[128:131] offset:28672
  ds_write_b128 v143, v[132:135] offset:29696
  s_waitcnt lgkmcnt(0)
  v_and_b32 v1, 63, v0
  v_lshlrev_b32 v132, 4, v1
  s_mul_i32 s28, s21, 30720
  v_add_u32 v129, s28, v132
  s_lshl_b32 s28, s21, 10
  v_add_u32 v124, s28, v132
  v_add_u32 v125, 4096, v124
  v_add_u32 v126, 8192, v124
  v_add_u32 v127, 122880, v124
  v_add_u32 v128, 122880, v132
  v_lshrrev_b32 v2, 3, v1
  s_cmp_lt_u32 s21, 2
  s_cselect_b32 s28, 2, 1
  v_min_u32 v2, s28, v2
  v_lshlrev_b32 v2, 12, v2
  v_and_b32 v3, 7, v1
  v_lshlrev_b32 v3, 7, v3
  v_add_u32 v2, v2, v3
  s_lshl_b32 s28, s21, 10
  v_add_u32 v141, s28, v2
  v_and_b32 v2, 15, v1
  v_lshrrev_b32 v3, 4, v1
  v_add_u32 v3, v3, v2
  v_and_b32 v3, 3, v3
  v_lshlrev_b32 v3, 4, v3
  v_lshlrev_b32 v2, 6, v2
  v_add_u32 v2, v2, v3
  s_mul_i32 s28, s21, 3072
  s_add_u32 s28, s28, 133120
  v_add_u32 v130, s28, v2
  s_mul_i32 s28, s21, 1536
  s_add_u32 s28, s28, 145408
  v_lshlrev_b32 v2, 3, v1
  v_add_u32 v131, s28, v2
  v_mov_b32 v110, 0x44444444
  v_mov_b32 v2, 0xeeeeeeee
  v_and_b32 v3, 8, v1
  v_cmp_ne_u32 vcc, 0, v3
  s_nop 1
  v_cndmask_b32 v110, v110, v2, vcc
  v_and_b32 v4, 15, v1
  v_lshrrev_b32 v5, 4, v1
  v_lshlrev_b32 v6, 2, v5
  v_sub_u32 v6, v4, v6
  v_mov_b32 v7, 0x3f80
  v_mov_b32 v8, 0x3f800000
  v_mov_b32 v108, 0
  v_mov_b32 v109, 0
  v_cmp_eq_u32 vcc, 0, v6
  s_nop 1
  v_cndmask_b32 v108, v108, v7, vcc
  v_cmp_eq_u32 vcc, 1, v6
  s_nop 1
  v_cndmask_b32 v108, v108, v8, vcc
  v_cmp_eq_u32 vcc, 2, v6
  s_nop 1
  v_cndmask_b32 v109, v109, v7, vcc
  v_cmp_eq_u32 vcc, 3, v6
  s_nop 1
  v_cndmask_b32 v109, v109, v8, vcc
  s_mul_i32 s28, s23, 6
  s_lshr_b32 s29, s28, 3
  s_add_u32 s28, s28, 5
  s_lshr_b32 s28, s28, 3
  v_mov_b32 v6, s29
  v_mov_b32 v7, s28
  v_and_b32 v8, 1, v1
  v_cmp_eq_u32 vcc, 1, v8
  s_nop 1
  v_cndmask_b32 v6, v6, v7, vcc
  v_lshlrev_b32 v6, 2, v6
  v_bfe_u32 v8, v1, 1, 1
  v_lshlrev_b32 v8, 10, v8
  v_add_u32 v6, v6, v8
  v_add_u32 v138, 0, v6
  s_mul_i32 s97, s20, 655360
  s_add_u32 s97, s97, 0x400000
  s_mov_b32 s48, 0x4000
  s_mul_i32 s49, s20, 327680
  s_add_u32 s49, s49, 0x700000
  s_add_u32 s98, s49, 5120
  s_mul_i32 s50, s23, 786432
  s_add_u32 s63, s50, 0x4800000
  s_add_u32 s50, s50, 0x6000000
  s_mov_b32 s51, 0
  s_mov_b32 s52, 0
  s_mul_i32 s28, s21, 3
  s_add_u32 s28, s28, 0
  s_lshr_b32 s29, s28, 1
  s_lshl_b32 s29, s29, 11
  s_and_b32 s28, s28, 1
  s_lshl_b32 s28, s28, 3
  s_add_u32 s53, s29, s28
  s_mul_i32 s28, s21, 3
  s_add_u32 s28, s28, 1
  s_lshr_b32 s29, s28, 1
  s_lshl_b32 s29, s29, 11
  s_and_b32 s28, s28, 1
  s_lshl_b32 s28, s28, 3
  s_add_u32 s54, s29, s28
  s_mul_i32 s28, s21, 3
  s_add_u32 s28, s28, 2
  s_lshr_b32 s29, s28, 1
  s_lshl_b32 s29, s29, 11
  s_and_b32 s28, s28, 1
  s_lshl_b32 s28, s28, 3
  s_add_u32 s55, s29, s28
  v_mov_b32 v60, 0
  v_mov_b32 v61, 0
  v_mov_b32 v62, 0
  v_mov_b32 v63, 0
  v_mov_b32 v64, 0
  v_mov_b32 v65, 0
  v_mov_b32 v66, 0
  v_mov_b32 v67, 0
  v_mov_b32 v68, 0
  v_mov_b32 v69, 0
  v_mov_b32 v70, 0
  v_mov_b32 v71, 0
  v_mov_b32 v72, 0
  v_mov_b32 v73, 0
  v_mov_b32 v74, 0
  v_mov_b32 v75, 0
  v_mov_b32 v36, 0
  v_mov_b32 v37, 0
  v_mov_b32 v38, 0
  v_mov_b32 v39, 0
  v_mov_b32 v40, 0
  v_mov_b32 v41, 0
  v_mov_b32 v42, 0
  v_mov_b32 v43, 0
  s_barrier
  s_cmp_gt_u32 s52, s51
  s_cbranch_scc1 ka\sfx\()_x_wp_75_ok
  s_mov_b32 s45, 0
ka\sfx\()_x_wp_75_spin:
  buffer_load_dword v2, v138, s[8:11], 0 offen sc1
  s_add_u32 s45, s45, 1
  s_waitcnt vmcnt(0)
  v_min_u32_dpp v3, v2, v2 quad_perm:[1,0,3,2] row_mask:0xf bank_mask:0xf
  s_nop 1
  v_min_u32_dpp v2, v3, v3 quad_perm:[2,3,0,1] row_mask:0xf bank_mask:0xf
  s_nop 1
  v_min_u32_dpp v3, v2, v2 row_half_mirror row_mask:0xf bank_mask:0xf
  s_nop 1
  v_min_u32_dpp v2, v3, v3 quad_perm:[0,1,2,3] row_mask:0xf bank_mask:0xf
  s_nop 0
  v_readfirstlane_b32 s52, v2
  s_cmp_gt_u32 s52, s51
  s_cbranch_scc1 ka\sfx\()_x_wp_75_ok
  s_cmp_lt_u32 s45, 400000
  s_cbranch_scc1 ka\sfx\()_x_wp_75_spin
  s_branch ka\sfx\()_abort
ka\sfx\()_x_wp_75_ok:
  s_add_u32 s28, s50, s53
  buffer_load_dwordx2 v[88:89], v132, s[8:11], s28 offen offset:0 sc1
  buffer_load_dwordx2 v[92:93], v132, s[8:11], s28 offen offset:1024 sc1
  s_add_u32 s28, s50, s54
  buffer_load_dwordx2 v[90:91], v132, s[8:11], s28 offen offset:0 sc1
  buffer_load_dwordx2 v[94:95], v132, s[8:11], s28 offen offset:1024 sc1
  s_add_u32 s28, s50, s55
  buffer_load_dwordx2 v[96:97], v132, s[8:11], s28 offen offset:0 sc1
  buffer_load_dwordx2 v[98:99], v132, s[8:11], s28 offen offset:1024 sc1
  s_cmp_eq_u32 s21, 0
  s_cbranch_scc1 ka\sfx\()_x_w0
  s_cmp_eq_u32 s21, 1
  s_cbranch_scc1 ka\sfx\()_x_w1
  s_branch ka\sfx\()_x_w23
ka\sfx\()_x_w0:
  v_lshrrev_b32 v4, 3, v1
  v_and_b32 v5, 7, v1
  v_lshrrev_b32 v6, 2, v5
  v_and_b32 v7, 3, v5
  v_lshlrev_b32 v8, 10, v6
  v_lshlrev_b32 v9, 6, v4
  v_add_u32 v8, v8, v9
  v_add_u32 v9, v7, v4
  v_and_b32 v9, 3, v9
  v_lshlrev_b32 v9, 4, v9
  v_add_u32 v8, v8, v9
  v_add_u32 v133, 134144, v8
  v_add_u32 v8, 2, v6
  v_add_u32 v8, v8, v4
  v_and_b32 v8, 3, v8
  v_lshlrev_b32 v8, 4, v8
  v_lshlrev_b32 v9, 6, v4
  v_add_u32 v8, v8, v9
  v_lshlrev_b32 v9, 2, v7
  v_add_u32 v8, v8, v9
  v_add_u32 v134, 133120, v8
  s_and_b32 s26, s23, 7
  v_and_b32 v8, 1, v7
  v_lshlrev_b32 v8, 1, v8
  v_add_u32 v8, v8, v6
  v_lshlrev_b32 v8, 4, v8
  v_add_u32 v8, v8, v4
  v_lshlrev_b32 v8, 4, v8
  v_lshrrev_b32 v9, 1, v7
  v_lshlrev_b32 v9, 3, v9
  v_add_u32 v8, v8, v9
  s_lshr_b32 s28, s26, 1
  s_lshl_b32 s28, s28, 10
  s_and_b32 s29, s26, 1
  s_lshl_b32 s29, s29, 7
  s_add_u32 s28, s28, s29
  v_add_u32 v135, s28, v8
  v_lshlrev_b32 v8, 4, v6
  v_add_u32 v8, v8, v4
  v_lshlrev_b32 v8, 4, v8
  v_lshlrev_b32 v9, 1, v7
  v_add_u32 v8, v8, v9
  s_lshr_b32 s28, s26, 2
  s_lshl_b32 s28, s28, 7
  s_and_b32 s29, s26, 1
  s_lshl_b32 s29, s29, 9
  s_add_u32 s28, s28, s29
  s_bfe_u32 s29, s26, 0x10001
  s_lshl_b32 s29, s29, 3
  s_add_u32 s28, s28, s29
  s_add_u32 s28, s28, 4096
  v_add_u32 v8, s28, v8
  v_mov_b32 v9, 0x40000000
  v_and_b32 v10, 1, v5
  v_cmp_eq_u32 vcc, 0, v10
  s_nop 1
  v_cndmask_b32 v136, v9, v8, vcc
  s_mov_b32 s64, 0x3dd53b95
  s_mov_b32 s65, 0x3dd53b95
  v_mov_b32 v137, 0x42800000
ka\sfx\()_x_w0l:
  ds_read_b128 v[44:47], v129 offset:0
  ds_read_b128 v[48:51], v129 offset:1024
  ds_read_b128 v[52:55], v129 offset:2048
  ds_read_b128 v[56:59], v129 offset:3072
  s_waitcnt lgkmcnt(0)
  s_mov_b32 s45, 0
ka\sfx\()_x_pf_76_pr:
  buffer_load_dword v139, v141, s[8:11], s48 offen sc1
  s_add_u32 s45, s45, 1
  s_waitcnt vmcnt(0)
  v_cmp_eq_u32 vcc, -1, v139
  s_cbranch_vccz ka\sfx\()_x_pf_76
  s_cmp_lt_u32 s45, 400000
  s_cbranch_scc1 ka\sfx\()_x_pf_76_pr
  s_branch ka\sfx\()_abort
ka\sfx\()_x_pf_76:
  buffer_load_dwordx4 v[112:115], v124, s[8:11], s48 offen sc1
  buffer_load_dwordx4 v[116:119], v125, s[8:11], s48 offen sc1
  buffer_load_dwordx4 v[120:123], v126, s[8:11], s48 offen sc1
  s_add_u32 s45, s45, 1
  s_waitcnt vmcnt(2)
  ds_write_b128 v127, v[112:115] offset:0
  v_max3_u32 v139, v112, v113, v114
  v_max_u32 v139, v139, v115
  s_waitcnt vmcnt(1)
  ds_write_b128 v127, v[116:119] offset:4096
  v_max3_u32 v139, v139, v116, v117
  v_max3_u32 v139, v139, v118, v119
  s_waitcnt vmcnt(0)
  ds_write_b128 v127, v[120:123] offset:8192
  v_max3_u32 v139, v139, v120, v121
  v_max3_u32 v139, v139, v122, v123
  v_cmp_eq_u32 vcc, -1, v139
  s_cbranch_vccz ka\sfx\()_x_pf_76_ok
  s_cmp_lt_u32 s45, 400000
  s_cbranch_scc1 ka\sfx\()_x_pf_76
  s_branch ka\sfx\()_abort
ka\sfx\()_x_pf_76_ok:
  v_smfmac_f32_16x16x64_bf16 v[60:63], v[112:115], a[0:7], v110
  v_smfmac_f32_16x16x64_bf16 v[64:67], v[112:115], a[240:247], v110
  v_smfmac_f32_16x16x64_bf16 v[68:71], v[112:115], a[80:87], v110
  v_smfmac_f32_16x16x64_bf16 v[72:75], v[112:115], v[176:183], v110
  s_waitcnt lgkmcnt(0)
  s_barrier
  v_smfmac_f32_16x16x64_bf16 v[36:39], v[112:115], a[160:167], v110
  ds_read_b128 v[4:7], v128 offset:1024
  v_smfmac_f32_16x16x64_bf16 v[40:43], v[112:115], v[216:223], v110
  ds_read_b128 v[8:11], v128 offset:2048
  v_smfmac_f32_16x16x64_bf16 v[60:63], v[116:119], a[32:39], v110
  ds_read_b128 v[12:15], v128 offset:3072
  v_smfmac_f32_16x16x64_bf16 v[64:67], v[116:119], v[152:159], v110
  ds_read_b128 v[16:19], v128 offset:5120
  v_smfmac_f32_16x16x64_bf16 v[68:71], v[116:119], a[112:119], v110
  ds_read_b128 v[20:23], v128 offset:6144
  v_smfmac_f32_16x16x64_bf16 v[72:75], v[116:119], v[192:199], v110
  ds_read_b128 v[24:27], v128 offset:7168
  v_smfmac_f32_16x16x64_bf16 v[36:39], v[116:119], a[192:199], v110
  ds_read_b128 v[28:31], v128 offset:9216
  v_smfmac_f32_16x16x64_bf16 v[40:43], v[116:119], v[232:239], v110
  v_smfmac_f32_16x16x64_bf16 v[60:63], v[120:123], a[64:71], v110
  v_smfmac_f32_16x16x64_bf16 v[64:67], v[120:123], v[168:175], v110
  v_smfmac_f32_16x16x64_bf16 v[68:71], v[120:123], a[144:151], v110
  v_smfmac_f32_16x16x64_bf16 v[72:75], v[120:123], v[208:215], v110
  v_smfmac_f32_16x16x64_bf16 v[36:39], v[120:123], a[224:231], v110
  v_smfmac_f32_16x16x64_bf16 v[40:43], v[120:123], v[248:255], v110
  s_waitcnt lgkmcnt(6)
  v_smfmac_f32_16x16x64_bf16 v[60:63], v[4:7], a[8:15], v110
  v_smfmac_f32_16x16x64_bf16 v[64:67], v[4:7], v[44:51], v110
  ds_read_b128 v[44:47], v129 offset:4096
  s_waitcnt lgkmcnt(6)
  v_smfmac_f32_16x16x64_bf16 v[60:63], v[8:11], a[16:23], v110
  ds_read_b128 v[48:51], v129 offset:5120
  v_smfmac_f32_16x16x64_bf16 v[64:67], v[8:11], a[248:255], v110
  s_waitcnt lgkmcnt(6)
  v_smfmac_f32_16x16x64_bf16 v[60:63], v[12:15], a[24:31], v110
  v_smfmac_f32_16x16x64_bf16 v[64:67], v[12:15], v[52:59], v110
  ds_read_b128 v[52:55], v129 offset:6144
  s_waitcnt lgkmcnt(6)
  v_smfmac_f32_16x16x64_bf16 v[60:63], v[16:19], a[40:47], v110
  ds_read_b128 v[56:59], v129 offset:7168
  s_waitcnt lgkmcnt(2)
  v_smfmac_f32_16x16x64_bf16 v[64:67], v[16:19], v[44:51], v110
  ds_read_b128 v[44:47], v129 offset:8192
  v_smfmac_f32_16x16x64_bf16 v[60:63], v[20:23], a[48:55], v110
  ds_read_b128 v[48:51], v129 offset:9216
  v_smfmac_f32_16x16x64_bf16 v[64:67], v[20:23], v[160:167], v110
  v_smfmac_f32_16x16x64_bf16 v[60:63], v[24:27], a[56:63], v110
  s_waitcnt lgkmcnt(2)
  v_smfmac_f32_16x16x64_bf16 v[64:67], v[24:27], v[52:59], v110
  ds_read_b128 v[52:55], v129 offset:10240
  v_smfmac_f32_16x16x64_bf16 v[60:63], v[28:31], a[72:79], v110
  ds_read_b128 v[56:59], v129 offset:11264
  s_waitcnt lgkmcnt(2)
  v_smfmac_f32_16x16x64_bf16 v[64:67], v[28:31], v[44:51], v110
  ds_read_b128 v[44:47], v129 offset:12288
  v_smfmac_f32_16x16x64_bf16 v[68:71], v[4:7], a[88:95], v110
  ds_read_b128 v[48:51], v129 offset:13312
  s_waitcnt lgkmcnt(2)
  v_smfmac_f32_16x16x64_bf16 v[72:75], v[4:7], v[52:59], v110
  ds_read_b128 v[52:55], v129 offset:14336
  v_permlane32_swap_b32 v60, v64
  v_smfmac_f32_16x16x64_bf16 v[68:71], v[8:11], a[96:103], v110
  ds_read_b128 v[56:59], v129 offset:15360
  v_smfmac_f32_16x16x64_bf16 v[72:75], v[8:11], v[184:191], v110
  v_permlane32_swap_b32 v61, v65
  v_smfmac_f32_16x16x64_bf16 v[68:71], v[12:15], a[104:111], v110
  s_waitcnt lgkmcnt(2)
  v_smfmac_f32_16x16x64_bf16 v[72:75], v[12:15], v[44:51], v110
  ds_read_b128 v[44:47], v129 offset:16384
  v_permlane32_swap_b32 v62, v66
  v_smfmac_f32_16x16x64_bf16 v[68:71], v[16:19], a[120:127], v110
  ds_read_b128 v[48:51], v129 offset:17408
  v_permlane32_swap_b32 v63, v67
  s_waitcnt lgkmcnt(2)
  v_smfmac_f32_16x16x64_bf16 v[72:75], v[16:19], v[52:59], v110
  ds_read_b128 v[52:55], v129 offset:18432
  v_add_f32 v60, v60, v64
  v_smfmac_f32_16x16x64_bf16 v[68:71], v[20:23], a[128:135], v110
  ds_read_b128 v[56:59], v129 offset:19456
  v_add_f32 v61, v61, v65
  v_smfmac_f32_16x16x64_bf16 v[72:75], v[20:23], v[200:207], v110
  v_add_f32 v62, v62, v66
  v_smfmac_f32_16x16x64_bf16 v[68:71], v[24:27], a[136:143], v110
  v_add_f32 v63, v63, v67
  s_waitcnt lgkmcnt(2)
  v_smfmac_f32_16x16x64_bf16 v[72:75], v[24:27], v[44:51], v110
  ds_read_b128 v[44:47], v129 offset:20480
  v_cvt_pk_bf16_f32 v100, v60, v61
  v_smfmac_f32_16x16x64_bf16 v[68:71], v[28:31], a[152:159], v110
  ds_read_b128 v[48:51], v129 offset:21504
  v_cvt_pk_bf16_f32 v101, v62, v63
  s_waitcnt lgkmcnt(2)
  v_smfmac_f32_16x16x64_bf16 v[72:75], v[28:31], v[52:59], v110
  ds_read_b128 v[52:55], v129 offset:22528
  v_smfmac_f32_16x16x64_bf16 v[36:39], v[4:7], a[168:175], v110
  ds_read_b128 v[56:59], v129 offset:23552
  s_waitcnt lgkmcnt(2)
  v_smfmac_f32_16x16x64_bf16 v[40:43], v[4:7], v[44:51], v110
  ds_read_b128 v[44:47], v129 offset:24576
  v_permlane32_swap_b32 v68, v72
  v_smfmac_f32_16x16x64_bf16 v[36:39], v[8:11], a[176:183], v110
  ds_read_b128 v[48:51], v129 offset:25600
  v_smfmac_f32_16x16x64_bf16 v[40:43], v[8:11], v[224:231], v110
  v_permlane32_swap_b32 v69, v73
  v_smfmac_f32_16x16x64_bf16 v[36:39], v[12:15], a[184:191], v110
  s_waitcnt lgkmcnt(2)
  v_smfmac_f32_16x16x64_bf16 v[40:43], v[12:15], v[52:59], v110
  ds_read_b128 v[52:55], v129 offset:26624
  v_permlane32_swap_b32 v70, v74
  v_smfmac_f32_16x16x64_bf16 v[36:39], v[16:19], a[200:207], v110
  ds_read_b128 v[56:59], v129 offset:27648
  v_permlane32_swap_b32 v71, v75
  s_waitcnt lgkmcnt(2)
  v_smfmac_f32_16x16x64_bf16 v[40:43], v[16:19], v[44:51], v110
  ds_read_b128 v[44:47], v129 offset:28672
  v_add_f32 v68, v68, v72
  v_smfmac_f32_16x16x64_bf16 v[36:39], v[20:23], a[208:215], v110
  ds_read_b128 v[48:51], v129 offset:29696
  v_add_f32 v69, v69, v73
  v_smfmac_f32_16x16x64_bf16 v[40:43], v[20:23], v[240:247], v110
  v_add_f32 v70, v70, v74
  v_smfmac_f32_16x16x64_bf16 v[36:39], v[24:27], a[216:223], v110
  v_add_f32 v71, v71, v75
  s_waitcnt lgkmcnt(2)
  v_smfmac_f32_16x16x64_bf16 v[40:43], v[24:27], v[52:59], v110
  v_cvt_pk_bf16_f32 v102, v68, v69
  v_smfmac_f32_16x16x64_bf16 v[36:39], v[28:31], a[232:239], v110
  v_cvt_pk_bf16_f32 v103, v70, v71
  s_waitcnt lgkmcnt(0)
  v_smfmac_f32_16x16x64_bf16 v[40:43], v[28:31], v[44:51], v110
  v_mfma_f32_16x16x16_bf16 v[142:145], v[100:101], v[108:109], 0
  v_mfma_f32_16x16x16_bf16 v[146:149], v[102:103], v[108:109], 0
  s_nop 1
  v_permlane32_swap_b32 v36, v40
  v_permlane32_swap_b32 v37, v41
  v_permlane32_swap_b32 v38, v42
  v_permlane32_swap_b32 v39, v43
  v_add_f32 v36, v36, v40
  v_add_f32 v37, v37, v41
  v_add_f32 v38, v38, v42
  v_add_f32 v39, v39, v43
  v_cvt_pk_bf16_f32 v104, v36, v37
  v_cvt_pk_bf16_f32 v105, v38, v39
  v_cvt_pk_bf16_f32 v44, v142, v143
  v_cvt_pk_bf16_f32 v45, v144, v145
  v_mfma_f32_16x16x16_bf16 v[142:145], v[104:105], v[108:109], 0
  v_cvt_pk_bf16_f32 v46, v146, v147
  v_cvt_pk_bf16_f32 v47, v148, v149
  s_nop 1
  v_mfma_f32_16x16x32_bf16 v[76:79], v[44:47], v[44:47], 0
  v_mfma_f32_16x16x32_bf16 v[80:83], v[88:91], v[44:47], 0
  v_cvt_pk_bf16_f32 v106, v142, v143
  v_cvt_pk_bf16_f32 v107, v144, v145
  v_mfma_f32_16x16x32_bf16 v[84:87], v[92:95], v[44:47], 0
  s_nop 0
  v_mfma_f32_16x16x16_bf16 v[76:79], v[106:107], v[106:107], v[76:79]
  v_mfma_f32_16x16x16_bf16 v[80:83], v[96:97], v[106:107], v[80:83]
  v_mfma_f32_16x16x16_bf16 v[84:87], v[98:99], v[106:107], v[84:87]
  s_mov_b32 exec_lo, 0
  s_mov_b32 exec_hi, 0x00ff00ff
  s_nop 3
  ds_write_b128 v130, v[76:79]
  s_mov_b32 exec_lo, 0x00ff00ff
  ds_write_b128 v130, v[80:83] offset:1024
  s_nop 0
  ds_write_b128 v130, v[84:87] offset:2048
  s_mov_b64 exec, -1
  s_waitcnt lgkmcnt(0)
  s_barrier
  s_cmp_ge_u32 s51, 63
  s_cbranch_scc0 x63_77_\sfx\()
  ds_write_b64 v131, v[44:45]
  ds_write_b64 v131, v[46:47] offset:512
  ds_write_b64 v131, v[106:107] offset:1024
  s_branch ka\sfx\()_x_done
x63_77_\sfx\():
  ds_read_b128 v[4:7], v133 offset:0
  ds_read_b32 v20, v134 offset:0
  ds_read_b128 v[8:11], v133 offset:3072
  ds_read_b32 v21, v134 offset:3072
  ds_read_b128 v[12:15], v133 offset:6144
  ds_read_b32 v22, v134 offset:6144
  ds_read_b128 v[16:19], v133 offset:9216
  ds_read_b32 v23, v134 offset:9216
  s_waitcnt lgkmcnt(4)
  v_pk_add_f32 v[4:5], v[4:5], v[8:9]
  v_pk_add_f32 v[6:7], v[6:7], v[10:11]
  v_add_f32 v20, v20, v21
  s_waitcnt lgkmcnt(0)
  v_pk_add_f32 v[12:13], v[12:13], v[16:17]
  v_pk_add_f32 v[14:15], v[14:15], v[18:19]
  v_add_f32 v22, v22, v23
  v_pk_add_f32 v[4:5], v[4:5], v[12:13]
  v_pk_add_f32 v[6:7], v[6:7], v[14:15]
  v_add_f32 v8, v20, v22
  v_pk_mul_f32 v[4:5], v[4:5], s[64:65]
  v_pk_mul_f32 v[6:7], v[6:7], s[64:65]
  v_mul_f32 v8, s64, v8
  v_max3_f32 v24, abs(v4), abs(v5), abs(v6)
  v_max3_f32 v24, v24, abs(v7), abs(v8)
  v_cmp_nlt_f32 vcc, v24, v137
  s_cbranch_vccz smx_78_go_\sfx\()
  v_max3_f32 v24, v4, v5, v6
  v_max3_f32 v24, v24, v7, v8
  s_nop 1
  v_max_f32_dpp v25, v24, v24 quad_perm:[1,0,3,2] row_mask:0xf bank_mask:0xf
  s_nop 1
  v_max_f32_dpp v24, v25, v25 quad_perm:[2,3,0,1] row_mask:0xf bank_mask:0xf
  s_nop 1
  v_max_f32_dpp v25, v24, v24 row_half_mirror row_mask:0xf bank_mask:0xf
  v_sub_f32 v4, v4, v25
  v_sub_f32 v5, v5, v25
  v_sub_f32 v6, v6, v25
  v_sub_f32 v7, v7, v25
  v_sub_f32 v8, v8, v25
smx_78_go_\sfx\():
  v_exp_f32 v4, v4
  v_exp_f32 v5, v5
  v_exp_f32 v6, v6
  v_exp_f32 v7, v7
  v_exp_f32 v8, v8
  v_add_f32 v24, v4, v5
  v_add_f32 v25, v6, v7
  v_add_f32 v24, v24, v8
  v_add_f32 v24, v24, v25
  s_nop 1
  v_add_f32_dpp v25, v24, v24 quad_perm:[1,0,3,2] row_mask:0xf bank_mask:0xf
  s_nop 1
  v_add_f32_dpp v24, v25, v25 quad_perm:[2,3,0,1] row_mask:0xf bank_mask:0xf
  s_nop 1
  v_add_f32_dpp v25, v24, v24 row_half_mirror row_mask:0xf bank_mask:0xf
  v_rcp_f32 v24, v25
  s_nop 0
  v_mul_f32 v8, v8, v24
  v_pk_mul_f32 v[4:5], v[4:5], v[24:25] op_sel_hi:[1,0]
  v_pk_mul_f32 v[6:7], v[6:7], v[24:25] op_sel_hi:[1,0]
  v_mov_b32_dpp v9, v8 quad_perm:[1,0,3,2] row_mask:0xf bank_mask:0xf
  v_cvt_pk_bf16_f32 v10, v4, v5
  v_cvt_pk_bf16_f32 v11, v6, v7
  buffer_store_dwordx2 v[10:11], v135, s[8:11], s49 offen \pol
  v_cvt_pk_bf16_f32 v12, v8, v9
  buffer_store_dword v12, v136, s[8:11], s49 offen \pol
  ds_write_b64 v131, v[44:45]
  ds_write_b64 v131, v[46:47] offset:512
  ds_write_b64 v131, v[106:107] offset:1024
  s_waitcnt lgkmcnt(0)
  s_barrier
  v_mov_b32 v60, 0
  v_mov_b32 v61, 0
  v_mov_b32 v62, 0
  v_mov_b32 v63, 0
  v_mov_b32 v64, 0
  v_mov_b32 v65, 0
  v_mov_b32 v66, 0
  v_mov_b32 v67, 0
  v_mov_b32 v68, 0
  v_mov_b32 v69, 0
  v_mov_b32 v70, 0
  v_mov_b32 v71, 0
  v_mov_b32 v72, 0
  v_mov_b32 v73, 0
  v_mov_b32 v74, 0
  v_mov_b32 v75, 0
  v_mov_b32 v36, 0
  v_mov_b32 v37, 0
  v_mov_b32 v38, 0
  v_mov_b32 v39, 0
  v_mov_b32 v40, 0
  v_mov_b32 v41, 0
  v_mov_b32 v42, 0
  v_mov_b32 v43, 0
  s_add_u32 s97, s97, 10240
  s_mov_b32 s48, s97
  s_add_u32 s49, s49, 5120
  s_add_u32 s98, s49, 5120
  s_add_u32 s50, s50, 12288
  s_add_u32 s63, s63, 12288
  s_add_u32 s51, s51, 1
  s_cmp_gt_u32 s52, s51
  s_cbranch_scc1 ka\sfx\()_x_wp_79_ok
  s_mov_b32 s45, 0
ka\sfx\()_x_wp_79_spin:
  buffer_load_dword v2, v138, s[8:11], 0 offen sc1
  s_add_u32 s45, s45, 1
  s_waitcnt vmcnt(0)
  v_min_u32_dpp v3, v2, v2 quad_perm:[1,0,3,2] row_mask:0xf bank_mask:0xf
  s_nop 1
  v_min_u32_dpp v2, v3, v3 quad_perm:[2,3,0,1] row_mask:0xf bank_mask:0xf
  s_nop 1
  v_min_u32_dpp v3, v2, v2 row_half_mirror row_mask:0xf bank_mask:0xf
  s_nop 1
  v_min_u32_dpp v2, v3, v3 quad_perm:[0,1,2,3] row_mask:0xf bank_mask:0xf
  s_nop 0
  v_readfirstlane_b32 s52, v2
  s_cmp_gt_u32 s52, s51
  s_cbranch_scc1 ka\sfx\()_x_wp_79_ok
  s_cmp_lt_u32 s45, 400000
  s_cbranch_scc1 ka\sfx\()_x_wp_79_spin
  s_branch ka\sfx\()_abort
ka\sfx\()_x_wp_79_ok:
  s_add_u32 s28, s50, s53
  buffer_load_dwordx2 v[88:89], v132, s[8:11], s28 offen offset:0 sc1
  buffer_load_dwordx2 v[92:93], v132, s[8:11], s28 offen offset:1024 sc1
  s_add_u32 s28, s50, s54
  buffer_load_dwordx2 v[90:91], v132, s[8:11], s28 offen offset:0 sc1
  buffer_load_dwordx2 v[94:95], v132, s[8:11], s28 offen offset:1024 sc1
  s_add_u32 s28, s50, s55
  buffer_load_dwordx2 v[96:97], v132, s[8:11], s28 offen offset:0 sc1
  buffer_load_dwordx2 v[98:99], v132, s[8:11], s28 offen offset:1024 sc1
  s_branch ka\sfx\()_x_w0l
ka\sfx\()_x_w1:
ka\sfx\()_x_w1l:
  ds_read_b128 v[44:47], v129 offset:0
  ds_read_b128 v[48:51], v129 offset:1024
  ds_read_b128 v[52:55], v129 offset:10240
  ds_read_b128 v[56:59], v129 offset:11264
  s_waitcnt lgkmcnt(0)
  s_mov_b32 s45, 0
ka\sfx\()_x_pf_80_pr:
  buffer_load_dword v139, v141, s[8:11], s48 offen sc1
  s_add_u32 s45, s45, 1
  s_waitcnt vmcnt(0)
  v_cmp_eq_u32 vcc, -1, v139
  s_cbranch_vccz ka\sfx\()_x_pf_80
  s_cmp_lt_u32 s45, 400000
  s_cbranch_scc1 ka\sfx\()_x_pf_80_pr
  s_branch ka\sfx\()_abort
ka\sfx\()_x_pf_80:
  buffer_load_dwordx4 v[112:115], v124, s[8:11], s48 offen sc1
  buffer_load_dwordx4 v[116:119], v125, s[8:11], s48 offen sc1
  buffer_load_dwordx4 v[120:123], v126, s[8:11], s48 offen sc1
  s_add_u32 s45, s45, 1
  s_waitcnt vmcnt(2)
  ds_write_b128 v127, v[112:115] offset:0
  v_max3_u32 v139, v112, v113, v114
  v_max_u32 v139, v139, v115
  s_waitcnt vmcnt(1)
  ds_write_b128 v127, v[116:119] offset:4096
  v_max3_u32 v139, v139, v116, v117
  v_max3_u32 v139, v139, v118, v119
  s_waitcnt vmcnt(0)
  ds_write_b128 v127, v[120:123] offset:8192
  v_max3_u32 v139, v139, v120, v121
  v_max3_u32 v139, v139, v122, v123
  v_cmp_eq_u32 vcc, -1, v139
  s_cbranch_vccz ka\sfx\()_x_pf_80_ok
  s_cmp_lt_u32 s45, 400000
  s_cbranch_scc1 ka\sfx\()_x_pf_80
  s_branch ka\sfx\()_abort
ka\sfx\()_x_pf_80_ok:
  v_smfmac_f32_16x16x64_bf16 v[60:63], v[112:115], a[8:15], v110
  v_smfmac_f32_16x16x64_bf16 v[64:67], v[112:115], v[44:51], v110
  ds_read_b128 v[44:47], v129 offset:20480
  v_smfmac_f32_16x16x64_bf16 v[68:71], v[112:115], a[88:95], v110
  ds_read_b128 v[48:51], v129 offset:21504
  v_smfmac_f32_16x16x64_bf16 v[72:75], v[112:115], v[52:59], v110
  ds_read_b128 v[52:55], v129 offset:4096
  s_waitcnt lgkmcnt(3)
  s_barrier
  v_smfmac_f32_16x16x64_bf16 v[36:39], v[112:115], a[168:175], v110
  ds_read_b128 v[56:59], v129 offset:5120
  ds_read_b128 v[4:7], v128 offset:0
  s_waitcnt lgkmcnt(3)
  v_smfmac_f32_16x16x64_bf16 v[40:43], v[112:115], v[44:51], v110
  ds_read_b128 v[44:47], v129 offset:14336
  ds_read_b128 v[8:11], v128 offset:2048
  v_smfmac_f32_16x16x64_bf16 v[60:63], v[116:119], a[40:47], v110
  ds_read_b128 v[48:51], v129 offset:15360
  ds_read_b128 v[12:15], v128 offset:3072
  s_waitcnt lgkmcnt(5)
  v_smfmac_f32_16x16x64_bf16 v[64:67], v[116:119], v[52:59], v110
  ds_read_b128 v[52:55], v129 offset:24576
  ds_read_b128 v[16:19], v128 offset:4096
  v_smfmac_f32_16x16x64_bf16 v[68:71], v[116:119], a[120:127], v110
  ds_read_b128 v[56:59], v129 offset:25600
  ds_read_b128 v[20:23], v128 offset:6144
  s_waitcnt lgkmcnt(5)
  v_smfmac_f32_16x16x64_bf16 v[72:75], v[116:119], v[44:51], v110
  ds_read_b128 v[44:47], v129 offset:8192
  ds_read_b128 v[24:27], v128 offset:7168
  v_smfmac_f32_16x16x64_bf16 v[36:39], v[116:119], a[200:207], v110
  ds_read_b128 v[48:51], v129 offset:9216
  ds_read_b128 v[28:31], v128 offset:8192
  s_waitcnt lgkmcnt(5)
  v_smfmac_f32_16x16x64_bf16 v[40:43], v[116:119], v[52:59], v110
  ds_read_b128 v[52:55], v129 offset:18432
  v_smfmac_f32_16x16x64_bf16 v[60:63], v[120:123], a[72:79], v110
  ds_read_b128 v[56:59], v129 offset:19456
  s_waitcnt lgkmcnt(3)
  v_smfmac_f32_16x16x64_bf16 v[64:67], v[120:123], v[44:51], v110
  ds_read_b128 v[44:47], v129 offset:28672
  v_smfmac_f32_16x16x64_bf16 v[68:71], v[120:123], a[152:159], v110
  ds_read_b128 v[48:51], v129 offset:29696
  s_waitcnt lgkmcnt(2)
  v_smfmac_f32_16x16x64_bf16 v[72:75], v[120:123], v[52:59], v110
  ds_read_b128 v[52:55], v129 offset:2048
  v_smfmac_f32_16x16x64_bf16 v[36:39], v[120:123], a[232:239], v110
  ds_read_b128 v[56:59], v129 offset:3072
  s_waitcnt lgkmcnt(2)
  v_smfmac_f32_16x16x64_bf16 v[40:43], v[120:123], v[44:51], v110
  ds_read_b128 v[44:47], v129 offset:6144
  v_smfmac_f32_16x16x64_bf16 v[60:63], v[4:7], a[0:7], v110
  ds_read_b128 v[48:51], v129 offset:7168
  v_smfmac_f32_16x16x64_bf16 v[64:67], v[4:7], a[240:247], v110
  v_smfmac_f32_16x16x64_bf16 v[60:63], v[8:11], a[16:23], v110
  v_smfmac_f32_16x16x64_bf16 v[64:67], v[8:11], a[248:255], v110
  v_smfmac_f32_16x16x64_bf16 v[60:63], v[12:15], a[24:31], v110
  s_waitcnt lgkmcnt(2)
  v_smfmac_f32_16x16x64_bf16 v[64:67], v[12:15], v[52:59], v110
  ds_read_b128 v[52:55], v129 offset:12288
  v_smfmac_f32_16x16x64_bf16 v[60:63], v[16:19], a[32:39], v110
  ds_read_b128 v[56:59], v129 offset:13312
  v_smfmac_f32_16x16x64_bf16 v[64:67], v[16:19], v[152:159], v110
  v_smfmac_f32_16x16x64_bf16 v[60:63], v[20:23], a[48:55], v110
  v_smfmac_f32_16x16x64_bf16 v[64:67], v[20:23], v[160:167], v110
  v_smfmac_f32_16x16x64_bf16 v[60:63], v[24:27], a[56:63], v110
  s_waitcnt lgkmcnt(2)
  v_smfmac_f32_16x16x64_bf16 v[64:67], v[24:27], v[44:51], v110
  ds_read_b128 v[44:47], v129 offset:16384
  v_smfmac_f32_16x16x64_bf16 v[60:63], v[28:31], a[64:71], v110
  ds_read_b128 v[48:51], v129 offset:17408
  v_smfmac_f32_16x16x64_bf16 v[64:67], v[28:31], v[168:175], v110
  v_smfmac_f32_16x16x64_bf16 v[68:71], v[4:7], a[80:87], v110
  v_smfmac_f32_16x16x64_bf16 v[72:75], v[4:7], v[176:183], v110
  v_permlane32_swap_b32 v60, v64
  v_smfmac_f32_16x16x64_bf16 v[68:71], v[8:11], a[96:103], v110
  v_smfmac_f32_16x16x64_bf16 v[72:75], v[8:11], v[184:191], v110
  v_permlane32_swap_b32 v61, v65
  v_smfmac_f32_16x16x64_bf16 v[68:71], v[12:15], a[104:111], v110
  s_waitcnt lgkmcnt(2)
  v_smfmac_f32_16x16x64_bf16 v[72:75], v[12:15], v[52:59], v110
  ds_read_b128 v[52:55], v129 offset:22528
  v_permlane32_swap_b32 v62, v66
  v_smfmac_f32_16x16x64_bf16 v[68:71], v[16:19], a[112:119], v110
  ds_read_b128 v[56:59], v129 offset:23552
  v_permlane32_swap_b32 v63, v67
  v_smfmac_f32_16x16x64_bf16 v[72:75], v[16:19], v[192:199], v110
  v_add_f32 v60, v60, v64
  v_smfmac_f32_16x16x64_bf16 v[68:71], v[20:23], a[128:135], v110
  v_add_f32 v61, v61, v65
  v_smfmac_f32_16x16x64_bf16 v[72:75], v[20:23], v[200:207], v110
  v_add_f32 v62, v62, v66
  v_smfmac_f32_16x16x64_bf16 v[68:71], v[24:27], a[136:143], v110
  v_add_f32 v63, v63, v67
  s_waitcnt lgkmcnt(2)
  v_smfmac_f32_16x16x64_bf16 v[72:75], v[24:27], v[44:51], v110
  ds_read_b128 v[44:47], v129 offset:26624
  v_cvt_pk_bf16_f32 v100, v60, v61
  v_smfmac_f32_16x16x64_bf16 v[68:71], v[28:31], a[144:151], v110
  ds_read_b128 v[48:51], v129 offset:27648
  v_cvt_pk_bf16_f32 v101, v62, v63
  v_smfmac_f32_16x16x64_bf16 v[72:75], v[28:31], v[208:215], v110
  v_smfmac_f32_16x16x64_bf16 v[36:39], v[4:7], a[160:167], v110
  v_smfmac_f32_16x16x64_bf16 v[40:43], v[4:7], v[216:223], v110
  v_permlane32_swap_b32 v68, v72
  v_smfmac_f32_16x16x64_bf16 v[36:39], v[8:11], a[176:183], v110
  v_smfmac_f32_16x16x64_bf16 v[40:43], v[8:11], v[224:231], v110
  v_permlane32_swap_b32 v69, v73
  v_smfmac_f32_16x16x64_bf16 v[36:39], v[12:15], a[184:191], v110
  s_waitcnt lgkmcnt(2)
  v_smfmac_f32_16x16x64_bf16 v[40:43], v[12:15], v[52:59], v110
  v_permlane32_swap_b32 v70, v74
  v_smfmac_f32_16x16x64_bf16 v[36:39], v[16:19], a[192:199], v110
  v_permlane32_swap_b32 v71, v75
  v_smfmac_f32_16x16x64_bf16 v[40:43], v[16:19], v[232:239], v110
  v_add_f32 v68, v68, v72
  v_smfmac_f32_16x16x64_bf16 v[36:39], v[20:23], a[208:215], v110
  v_add_f32 v69, v69, v73
  v_smfmac_f32_16x16x64_bf16 v[40:43], v[20:23], v[240:247], v110
  v_add_f32 v70, v70, v74
  v_smfmac_f32_16x16x64_bf16 v[36:39], v[24:27], a[216:223], v110
  v_add_f32 v71, v71, v75
  s_waitcnt lgkmcnt(0)
  v_smfmac_f32_16x16x64_bf16 v[40:43], v[24:27], v[44:51], v110
  v_cvt_pk_bf16_f32 v102, v68, v69
  v_smfmac_f32_16x16x64_bf16 v[36:39], v[28:31], a[224:231], v110
  v_cvt_pk_bf16_f32 v103, v70, v71
  v_smfmac_f32_16x16x64_bf16 v[40:43], v[28:31], v[248:255], v110
  v_mfma_f32_16x16x16_bf16 v[142:145], v[100:101], v[108:109], 0
  v_mfma_f32_16x16x16_bf16 v[146:149], v[102:103], v[108:109], 0
  s_nop 1
  v_permlane32_swap_b32 v36, v40
  v_permlane32_swap_b32 v37, v41
  v_permlane32_swap_b32 v38, v42
  v_permlane32_swap_b32 v39, v43
  v_add_f32 v36, v36, v40
  v_add_f32 v37, v37, v41
  v_add_f32 v38, v38, v42
  v_add_f32 v39, v39, v43
  v_cvt_pk_bf16_f32 v104, v36, v37
  v_cvt_pk_bf16_f32 v105, v38, v39
  v_cvt_pk_bf16_f32 v44, v142, v143
  v_cvt_pk_bf16_f32 v45, v144, v145
  v_mfma_f32_16x16x16_bf16 v[142:145], v[104:105], v[108:109], 0
  v_cvt_pk_bf16_f32 v46, v146, v147
  v_cvt_pk_bf16_f32 v47, v148, v149
  s_nop 1
  v_mfma_f32_16x16x32_bf16 v[76:79], v[44:47], v[44:47], 0
  v_mfma_f32_16x16x32_bf16 v[80:83], v[88:91], v[44:47], 0
  v_cvt_pk_bf16_f32 v106, v142, v143
  v_cvt_pk_bf16_f32 v107, v144, v145
  v_mfma_f32_16x16x32_bf16 v[84:87], v[92:95], v[44:47], 0
  s_nop 0
  v_mfma_f32_16x16x16_bf16 v[76:79], v[106:107], v[106:107], v[76:79]
  v_mfma_f32_16x16x16_bf16 v[80:83], v[96:97], v[106:107], v[80:83]
  v_mfma_f32_16x16x16_bf16 v[84:87], v[98:99], v[106:107], v[84:87]
  s_mov_b32 exec_lo, 0
  s_mov_b32 exec_hi, 0x00ff00ff
  s_nop 3
  ds_write_b128 v130, v[76:79]
  s_mov_b32 exec_lo, 0x00ff00ff
  ds_write_b128 v130, v[80:83] offset:1024
  s_nop 0
  ds_write_b128 v130, v[84:87] offset:2048
  s_mov_b64 exec, -1
  s_waitcnt lgkmcnt(0)
  s_barrier
  ds_write_b64 v131, v[44:45]
  ds_write_b64 v131, v[46:47] offset:512
  ds_write_b64 v131, v[106:107] offset:1024
  s_waitcnt lgkmcnt(0)
  s_cmp_ge_u32 s51, 63
  s_cbranch_scc1 ka\sfx\()_x_done
  s_barrier
  v_mov_b32 v60, 0
  v_mov_b32 v61, 0
  v_mov_b32 v62, 0
  v_mov_b32 v63, 0
  v_mov_b32 v64, 0
  v_mov_b32 v65, 0
  v_mov_b32 v66, 0
  v_mov_b32 v67, 0
  v_mov_b32 v68, 0
  v_mov_b32 v69, 0
  v_mov_b32 v70, 0
  v_mov_b32 v71, 0
  v_mov_b32 v72, 0
  v_mov_b32 v73, 0
  v_mov_b32 v74, 0
  v_mov_b32 v75, 0
  v_mov_b32 v36, 0
  v_mov_b32 v37, 0
  v_mov_b32 v38, 0
  v_mov_b32 v39, 0
  v_mov_b32 v40, 0
  v_mov_b32 v41, 0
  v_mov_b32 v42, 0
  v_mov_b32 v43, 0
  s_add_u32 s97, s97, 10240
  s_mov_b32 s48, s97
  s_add_u32 s49, s49, 5120
  s_add_u32 s98, s49, 5120
  s_add_u32 s50, s50, 12288
  s_add_u32 s63, s63, 12288
  s_add_u32 s51, s51, 1
  s_cmp_gt_u32 s52, s51
  s_cbranch_scc1 ka\sfx\()_x_wp_81_ok
  s_mov_b32 s45, 0
ka\sfx\()_x_wp_81_spin:
  buffer_load_dword v2, v138, s[8:11], 0 offen sc1
  s_add_u32 s45, s45, 1
  s_waitcnt vmcnt(0)
  v_min_u32_dpp v3, v2, v2 quad_perm:[1,0,3,2] row_mask:0xf bank_mask:0xf
  s_nop 1
  v_min_u32_dpp v2, v3, v3 quad_perm:[2,3,0,1] row_mask:0xf bank_mask:0xf
  s_nop 1
  v_min_u32_dpp v3, v2, v2 row_half_mirror row_mask:0xf bank_mask:0xf
  s_nop 1
  v_min_u32_dpp v2, v3, v3 quad_perm:[0,1,2,3] row_mask:0xf bank_mask:0xf
  s_nop 0
  v_readfirstlane_b32 s52, v2
  s_cmp_gt_u32 s52, s51
  s_cbranch_scc1 ka\sfx\()_x_wp_81_ok
  s_cmp_lt_u32 s45, 400000
  s_cbranch_scc1 ka\sfx\()_x_wp_81_spin
  s_branch ka\sfx\()_abort
ka\sfx\()_x_wp_81_ok:
  s_add_u32 s28, s50, s53
  buffer_load_dwordx2 v[88:89], v132, s[8:11], s28 offen offset:0 sc1
  buffer_load_dwordx2 v[92:93], v132, s[8:11], s28 offen offset:1024 sc1
  s_add_u32 s28, s50, s54
  buffer_load_dwordx2 v[90:91], v132, s[8:11], s28 offen offset:0 sc1
  buffer_load_dwordx2 v[94:95], v132, s[8:11], s28 offen offset:1024 sc1
  s_add_u32 s28, s50, s55
  buffer_load_dwordx2 v[96:97], v132, s[8:11], s28 offen offset:0 sc1
  buffer_load_dwordx2 v[98:99], v132, s[8:11], s28 offen offset:1024 sc1
  s_branch ka\sfx\()_x_w1l
ka\sfx\()_x_w23:
  s_sub_u32 s65, s21, 2
  s_and_b32 s26, s23, 7
  v_and_b32 v4, 15, v1
  v_lshrrev_b32 v5, 4, v1
  v_and_b32 v6, 1, v5
  v_lshlrev_b32 v6, 5, v6
  v_add_u32 v6, v6, v4
  v_lshlrev_b32 v6, 4, v6
  v_lshrrev_b32 v7, 1, v5
  v_lshlrev_b32 v7, 3, v7
  v_add_u32 v6, v6, v7
  s_lshl_b32 s28, s26, 1
  s_add_u32 s28, s28, s65
  s_lshl_b32 s28, s28, 10
  v_add_u32 v133, s28, v6
  s_lshr_b32 s28, s26, 2
  s_lshl_b32 s28, s28, 1
  s_add_u32 s28, s28, s65
  s_lshl_b32 s28, s28, 10
  s_and_b32 s29, s26, 1
  s_lshl_b32 s29, s29, 9
  s_add_u32 s28, s28, s29
  s_bfe_u32 s29, s26, 0x10001
  s_lshl_b32 s29, s29, 3
  s_add_u32 s28, s28, s29
  s_add_u32 s28, s28, 15872
  v_lshlrev_b32 v6, 4, v5
  v_add_u32 v6, v6, v4
  v_lshlrev_b32 v6, 4, v6
  v_add_u32 v6, s28, v6
  v_mov_b32 v7, 0x40000000
  v_cmp_le_u32 vcc, 2, v5
  s_nop 1
  v_cndmask_b32 v134, v7, v6, vcc
  v_mov_b32 v135, 0xf149f2ca
  v_lshlrev_b32 v6, 3, v1
  v_add_u32 v136, 145408, v6
  s_mul_i32 s94, s65, 6144
  s_add_u32 s94, s94, 151552
  v_add_u32 v137, s94, v132
  v_cmp_le_u32 s[66:67], 2, v5
  v_lshlrev_b32 v6, 2, v5
  v_sub_u32 v6, v4, v6
  v_cmp_le_i32 s[68:69], 0, v6
  v_cmp_le_i32 s[70:71], 1, v6
  v_cmp_le_i32 s[72:73], 2, v6
  v_cmp_le_i32 s[74:75], 3, v6
  s_nop 1
  s_cmp_eq_u32 s65, 0
  s_cselect_b64 s[76:77], s[68:69], -1
  s_cselect_b64 s[84:85], 0, s[68:69]
  s_cselect_b64 s[78:79], s[70:71], -1
  s_cselect_b64 s[86:87], 0, s[70:71]
  s_cselect_b64 s[80:81], s[72:73], -1
  s_cselect_b64 s[88:89], 0, s[72:73]
  s_cselect_b64 s[82:83], s[74:75], -1
  s_cselect_b64 s[90:91], 0, s[74:75]
  s_mul_i32 s92, s20, 1310720
  s_add_u32 s92, s92, 0xe00000
  s_lshl_b32 s93, s65, 10
  s_mov_b32 s64, 0x3dd53b95
  s_add_u32 s95, s63, s93
  s_add_u32 m0, s94, 0
  s_add_u32 s28, s95, 0
  buffer_load_dwordx4 v132, s[8:11], s28 offen sc1 lds
  s_add_u32 m0, s94, 1024
  s_add_u32 s28, s95, 2048
  buffer_load_dwordx4 v132, s[8:11], s28 offen sc1 lds
  s_add_u32 m0, s94, 2048
  s_add_u32 s28, s95, 4096
  buffer_load_dwordx4 v132, s[8:11], s28 offen sc1 lds
  s_add_u32 m0, s94, 3072
  s_add_u32 s28, s95, 6144
  buffer_load_dwordx4 v132, s[8:11], s28 offen sc1 lds
  s_add_u32 m0, s94, 4096
  s_add_u32 s28, s95, 8192
  buffer_load_dwordx4 v132, s[8:11], s28 offen sc1 lds
  s_add_u32 m0, s94, 5120
  s_add_u32 s28, s95, 10240
  buffer_load_dwordx4 v132, s[8:11], s28 offen sc1 lds
  s_cmp_eq_u32 s21, 3
  s_cbranch_scc1 ka\sfx\()_x_w3l
ka\sfx\()_x_w2l:
  ds_read_b128 v[44:47], v129 offset:0
  ds_read_b128 v[48:51], v129 offset:1024
  ds_read_b128 v[52:55], v129 offset:2048
  ds_read_b128 v[56:59], v129 offset:3072
  s_waitcnt lgkmcnt(0)
  s_mov_b32 s45, 0
ka\sfx\()_x_pf_82_pr:
  buffer_load_dword v139, v141, s[8:11], s48 offen sc1
  s_add_u32 s45, s45, 1
  s_waitcnt vmcnt(0)
  v_cmp_eq_u32 vcc, -1, v139
  s_cbranch_vccz ka\sfx\()_x_pf_82
  s_cmp_lt_u32 s45, 400000
  s_cbranch_scc1 ka\sfx\()_x_pf_82_pr
  s_branch ka\sfx\()_abort
ka\sfx\()_x_pf_82:
  buffer_load_dwordx4 v[112:115], v124, s[8:11], s48 offen sc1
  buffer_load_dwordx4 v[116:119], v125, s[8:11], s48 offen sc1
  s_add_u32 s45, s45, 1
  s_waitcnt vmcnt(1)
  ds_write_b128 v127, v[112:115] offset:0
  v_max3_u32 v139, v112, v113, v114
  v_max_u32 v139, v139, v115
  s_waitcnt vmcnt(0)
  ds_write_b128 v127, v[116:119] offset:4096
  v_max3_u32 v139, v139, v116, v117
  v_max3_u32 v139, v139, v118, v119
  v_cmp_eq_u32 vcc, -1, v139
  s_cbranch_vccz ka\sfx\()_x_pf_82_ok
  s_cmp_lt_u32 s45, 400000
  s_cbranch_scc1 ka\sfx\()_x_pf_82
  s_branch ka\sfx\()_abort
ka\sfx\()_x_pf_82_ok:
  v_smfmac_f32_16x16x64_bf16 v[60:63], v[112:115], a[16:23], v110
  v_smfmac_f32_16x16x64_bf16 v[64:67], v[112:115], a[248:255], v110
  v_smfmac_f32_16x16x64_bf16 v[68:71], v[112:115], a[96:103], v110
  v_smfmac_f32_16x16x64_bf16 v[72:75], v[112:115], v[184:191], v110
  s_waitcnt lgkmcnt(0)
  s_barrier
  v_smfmac_f32_16x16x64_bf16 v[36:39], v[112:115], a[176:183], v110
  ds_read_b128 v[4:7], v128 offset:0
  v_smfmac_f32_16x16x64_bf16 v[40:43], v[112:115], v[224:231], v110
  ds_read_b128 v[8:11], v128 offset:1024
  v_smfmac_f32_16x16x64_bf16 v[60:63], v[116:119], a[48:55], v110
  ds_read_b128 v[12:15], v128 offset:3072
  v_smfmac_f32_16x16x64_bf16 v[64:67], v[116:119], v[160:167], v110
  ds_read_b128 v[16:19], v128 offset:4096
  v_smfmac_f32_16x16x64_bf16 v[68:71], v[116:119], a[128:135], v110
  ds_read_b128 v[20:23], v128 offset:5120
  v_smfmac_f32_16x16x64_bf16 v[72:75], v[116:119], v[200:207], v110
  ds_read_b128 v[24:27], v128 offset:7168
  v_smfmac_f32_16x16x64_bf16 v[36:39], v[116:119], a[208:215], v110
  ds_read_b128 v[28:31], v128 offset:8192
  v_smfmac_f32_16x16x64_bf16 v[40:43], v[116:119], v[240:247], v110
  ds_read_b128 v[32:35], v128 offset:9216
  s_waitcnt lgkmcnt(7)
  v_smfmac_f32_16x16x64_bf16 v[60:63], v[4:7], a[0:7], v110
  v_smfmac_f32_16x16x64_bf16 v[64:67], v[4:7], a[240:247], v110
  s_waitcnt lgkmcnt(6)
  v_smfmac_f32_16x16x64_bf16 v[60:63], v[8:11], a[8:15], v110
  v_smfmac_f32_16x16x64_bf16 v[64:67], v[8:11], v[44:51], v110
  ds_read_b128 v[44:47], v129 offset:4096
  s_waitcnt lgkmcnt(6)
  v_smfmac_f32_16x16x64_bf16 v[60:63], v[12:15], a[24:31], v110
  ds_read_b128 v[48:51], v129 offset:5120
  v_smfmac_f32_16x16x64_bf16 v[64:67], v[12:15], v[52:59], v110
  ds_read_b128 v[52:55], v129 offset:6144
  s_waitcnt lgkmcnt(7)
  v_smfmac_f32_16x16x64_bf16 v[60:63], v[16:19], a[32:39], v110
  ds_read_b128 v[56:59], v129 offset:7168
  v_smfmac_f32_16x16x64_bf16 v[64:67], v[16:19], v[152:159], v110
  s_waitcnt lgkmcnt(7)
  v_smfmac_f32_16x16x64_bf16 v[60:63], v[20:23], a[40:47], v110
  s_waitcnt lgkmcnt(2)
  v_smfmac_f32_16x16x64_bf16 v[64:67], v[20:23], v[44:51], v110
  ds_read_b128 v[44:47], v129 offset:8192
  v_smfmac_f32_16x16x64_bf16 v[60:63], v[24:27], a[56:63], v110
  ds_read_b128 v[48:51], v129 offset:9216
  s_waitcnt lgkmcnt(2)
  v_smfmac_f32_16x16x64_bf16 v[64:67], v[24:27], v[52:59], v110
  ds_read_b128 v[52:55], v129 offset:10240
  v_smfmac_f32_16x16x64_bf16 v[60:63], v[28:31], a[64:71], v110
  ds_read_b128 v[56:59], v129 offset:11264
  v_smfmac_f32_16x16x64_bf16 v[64:67], v[28:31], v[168:175], v110
  v_smfmac_f32_16x16x64_bf16 v[60:63], v[32:35], a[72:79], v110
  s_waitcnt lgkmcnt(2)
  v_smfmac_f32_16x16x64_bf16 v[64:67], v[32:35], v[44:51], v110
  ds_read_b128 v[44:47], v129 offset:12288
  v_smfmac_f32_16x16x64_bf16 v[68:71], v[4:7], a[80:87], v110
  ds_read_b128 v[48:51], v129 offset:13312
  v_smfmac_f32_16x16x64_bf16 v[72:75], v[4:7], v[176:183], v110
  v_permlane32_swap_b32 v60, v64
  v_smfmac_f32_16x16x64_bf16 v[68:71], v[8:11], a[88:95], v110
  s_waitcnt lgkmcnt(2)
  v_smfmac_f32_16x16x64_bf16 v[72:75], v[8:11], v[52:59], v110
  ds_read_b128 v[52:55], v129 offset:14336
  v_permlane32_swap_b32 v61, v65
  v_smfmac_f32_16x16x64_bf16 v[68:71], v[12:15], a[104:111], v110
  ds_read_b128 v[56:59], v129 offset:15360
  s_waitcnt lgkmcnt(2)
  v_smfmac_f32_16x16x64_bf16 v[72:75], v[12:15], v[44:51], v110
  ds_read_b128 v[44:47], v129 offset:16384
  v_permlane32_swap_b32 v62, v66
  v_smfmac_f32_16x16x64_bf16 v[68:71], v[16:19], a[112:119], v110
  ds_read_b128 v[48:51], v129 offset:17408
  v_permlane32_swap_b32 v63, v67
  v_smfmac_f32_16x16x64_bf16 v[72:75], v[16:19], v[192:199], v110
  v_add_f32 v60, v60, v64
  v_smfmac_f32_16x16x64_bf16 v[68:71], v[20:23], a[120:127], v110
  v_add_f32 v61, v61, v65
  s_waitcnt lgkmcnt(2)
  v_smfmac_f32_16x16x64_bf16 v[72:75], v[20:23], v[52:59], v110
  ds_read_b128 v[52:55], v129 offset:18432
  v_add_f32 v62, v62, v66
  v_smfmac_f32_16x16x64_bf16 v[68:71], v[24:27], a[136:143], v110
  ds_read_b128 v[56:59], v129 offset:19456
  v_add_f32 v63, v63, v67
  s_waitcnt lgkmcnt(2)
  v_smfmac_f32_16x16x64_bf16 v[72:75], v[24:27], v[44:51], v110
  ds_read_b128 v[44:47], v129 offset:20480
  v_cvt_pk_bf16_f32 v100, v60, v61
  v_smfmac_f32_16x16x64_bf16 v[68:71], v[28:31], a[144:151], v110
  ds_read_b128 v[48:51], v129 offset:21504
  v_cvt_pk_bf16_f32 v101, v62, v63
  v_smfmac_f32_16x16x64_bf16 v[72:75], v[28:31], v[208:215], v110
  v_smfmac_f32_16x16x64_bf16 v[68:71], v[32:35], a[152:159], v110
  s_waitcnt lgkmcnt(2)
  v_smfmac_f32_16x16x64_bf16 v[72:75], v[32:35], v[52:59], v110
  ds_read_b128 v[52:55], v129 offset:22528
  v_smfmac_f32_16x16x64_bf16 v[36:39], v[4:7], a[160:167], v110
  ds_read_b128 v[56:59], v129 offset:23552
  v_smfmac_f32_16x16x64_bf16 v[40:43], v[4:7], v[216:223], v110
  v_permlane32_swap_b32 v68, v72
  v_smfmac_f32_16x16x64_bf16 v[36:39], v[8:11], a[168:175], v110
  s_waitcnt lgkmcnt(2)
  v_smfmac_f32_16x16x64_bf16 v[40:43], v[8:11], v[44:51], v110
  ds_read_b128 v[44:47], v129 offset:24576
  v_permlane32_swap_b32 v69, v73
  v_smfmac_f32_16x16x64_bf16 v[36:39], v[12:15], a[184:191], v110
  ds_read_b128 v[48:51], v129 offset:25600
  s_waitcnt lgkmcnt(2)
  v_smfmac_f32_16x16x64_bf16 v[40:43], v[12:15], v[52:59], v110
  ds_read_b128 v[52:55], v129 offset:26624
  v_permlane32_swap_b32 v70, v74
  v_smfmac_f32_16x16x64_bf16 v[36:39], v[16:19], a[192:199], v110
  ds_read_b128 v[56:59], v129 offset:27648
  v_permlane32_swap_b32 v71, v75
  v_smfmac_f32_16x16x64_bf16 v[40:43], v[16:19], v[232:239], v110
  v_add_f32 v68, v68, v72
  v_smfmac_f32_16x16x64_bf16 v[36:39], v[20:23], a[200:207], v110
  v_add_f32 v69, v69, v73
  s_waitcnt lgkmcnt(2)
  v_smfmac_f32_16x16x64_bf16 v[40:43], v[20:23], v[44:51], v110
  ds_read_b128 v[44:47], v129 offset:28672
  v_add_f32 v70, v70, v74
  v_smfmac_f32_16x16x64_bf16 v[36:39], v[24:27], a[216:223], v110
  ds_read_b128 v[48:51], v129 offset:29696
  v_add_f32 v71, v71, v75
  s_waitcnt lgkmcnt(2)
  v_smfmac_f32_16x16x64_bf16 v[40:43], v[24:27], v[52:59], v110
  v_cvt_pk_bf16_f32 v102, v68, v69
  v_smfmac_f32_16x16x64_bf16 v[36:39], v[28:31], a[224:231], v110
  v_cvt_pk_bf16_f32 v103, v70, v71
  v_smfmac_f32_16x16x64_bf16 v[40:43], v[28:31], v[248:255], v110
  v_smfmac_f32_16x16x64_bf16 v[36:39], v[32:35], a[232:239], v110
  s_waitcnt lgkmcnt(0)
  v_smfmac_f32_16x16x64_bf16 v[40:43], v[32:35], v[44:51], v110
  v_mfma_f32_16x16x16_bf16 v[142:145], v[100:101], v[108:109], 0
  v_mfma_f32_16x16x16_bf16 v[146:149], v[102:103], v[108:109], 0
  s_nop 1
  v_permlane32_swap_b32 v36, v40
  v_permlane32_swap_b32 v37, v41
  v_permlane32_swap_b32 v38, v42
  v_permlane32_swap_b32 v39, v43
  v_add_f32 v36, v36, v40
  v_add_f32 v37, v37, v41
  v_add_f32 v38, v38, v42
  v_add_f32 v39, v39, v43
  v_cvt_pk_bf16_f32 v104, v36, v37
  v_cvt_pk_bf16_f32 v105, v38, v39
  v_cvt_pk_bf16_f32 v44, v142, v143
  v_cvt_pk_bf16_f32 v45, v144, v145
  v_mfma_f32_16x16x16_bf16 v[142:145], v[104:105], v[108:109], 0
  v_cvt_pk_bf16_f32 v46, v146, v147
  v_cvt_pk_bf16_f32 v47, v148, v149
  s_nop 1
  v_mfma_f32_16x16x32_bf16 v[76:79], v[44:47], v[44:47], 0
  v_mfma_f32_16x16x32_bf16 v[80:83], v[88:91], v[44:47], 0
  v_cvt_pk_bf16_f32 v106, v142, v143
  v_cvt_pk_bf16_f32 v107, v144, v145
  v_mfma_f32_16x16x32_bf16 v[84:87], v[92:95], v[44:47], 0
  s_nop 0
  v_mfma_f32_16x16x16_bf16 v[76:79], v[106:107], v[106:107], v[76:79]
  v_mfma_f32_16x16x16_bf16 v[80:83], v[96:97], v[106:107], v[80:83]
  v_mfma_f32_16x16x16_bf16 v[84:87], v[98:99], v[106:107], v[84:87]
  s_mov_b32 exec_lo, 0
  s_mov_b32 exec_hi, 0x00ff00ff
  s_nop 3
  ds_write_b128 v130, v[76:79]
  s_mov_b32 exec_lo, 0x00ff00ff
  ds_write_b128 v130, v[80:83] offset:1024
  s_nop 0
  ds_write_b128 v130, v[84:87] offset:2048
  s_mov_b64 exec, -1
  s_waitcnt lgkmcnt(0)
  s_barrier
  ds_write_b64 v131, v[44:45]
  ds_write_b64 v131, v[46:47] offset:512
  ds_write_b64 v131, v[106:107] offset:1024
  ds_read_b128 v[44:47], v137 offset:0
  ds_read_b128 v[48:51], v137 offset:1024
  ds_read_b128 v[52:55], v137 offset:2048
  ds_read_b128 v[56:59], v137 offset:3072
  ds_read_b128 v[68:71], v137 offset:4096
  ds_read_b128 v[72:75], v137 offset:5120
  s_waitcnt lgkmcnt(0)
  s_barrier
  s_mov_b32 s28, s50
  buffer_load_dwordx4 v[4:7], v132, s[8:11], s28 offen sc1
  buffer_load_dwordx4 v[8:11], v132, s[8:11], s28 offen offset:1024 sc1
  s_add_u32 s28, s28, 2048
  buffer_load_dwordx4 v[12:15], v132, s[8:11], s28 offen sc1
  buffer_load_dwordx4 v[16:19], v132, s[8:11], s28 offen offset:1024 sc1
  s_add_u32 s28, s28, 2048
  buffer_load_dwordx4 v[20:23], v132, s[8:11], s28 offen sc1
  buffer_load_dwordx4 v[24:27], v132, s[8:11], s28 offen offset:1024 sc1
  s_add_u32 s28, s28, 2048
  buffer_load_dwordx4 v[28:31], v132, s[8:11], s28 offen sc1
  buffer_load_dwordx4 v[32:35], v132, s[8:11], s28 offen offset:1024 sc1
  s_add_u32 s28, s28, 2048
  buffer_load_dwordx4 v[36:39], v132, s[8:11], s28 offen sc1
  buffer_load_dwordx4 v[40:43], v132, s[8:11], s28 offen offset:1024 sc1
  s_add_u32 s28, s28, 2048
  buffer_load_dwordx4 v[60:63], v132, s[8:11], s28 offen sc1
  buffer_load_dwordx4 v[64:67], v132, s[8:11], s28 offen offset:1024 sc1
  s_add_u32 s28, s28, 2048
  ds_read_b64 v[76:77], v136 offset:0
  ds_read_b64 v[78:79], v136 offset:512
  ds_read_b64 v[80:81], v136 offset:1024
  ds_read_b64 v[82:83], v136 offset:1536
  ds_read_b64 v[84:85], v136 offset:2048
  ds_read_b64 v[86:87], v136 offset:2560
  ds_read_b64 v[88:89], v136 offset:3072
  ds_read_b64 v[90:91], v136 offset:3584
  ds_read_b64 v[92:93], v136 offset:4096
  ds_read_b64 v[94:95], v136 offset:4608
  ds_read_b64 v[96:97], v136 offset:5120
  ds_read_b64 v[98:99], v136 offset:5632
  s_waitcnt lgkmcnt(0)
  s_cmp_ge_u32 s51, 63
  s_cbranch_scc1 xq_83_\sfx\()
  s_add_u32 s96, s51, 1
  s_cmp_gt_u32 s52, s96
  s_cbranch_scc1 ka\sfx\()_x_wp_84_ok
  s_mov_b32 s45, 0
ka\sfx\()_x_wp_84_spin:
  buffer_load_dword v2, v138, s[8:11], 0 offen sc1
  s_add_u32 s45, s45, 1
  s_waitcnt vmcnt(0)
  v_min_u32_dpp v3, v2, v2 quad_perm:[1,0,3,2] row_mask:0xf bank_mask:0xf
  s_nop 1
  v_min_u32_dpp v2, v3, v3 quad_perm:[2,3,0,1] row_mask:0xf bank_mask:0xf
  s_nop 1
  v_min_u32_dpp v3, v2, v2 row_half_mirror row_mask:0xf bank_mask:0xf
  s_nop 1
  v_min_u32_dpp v2, v3, v3 quad_perm:[0,1,2,3] row_mask:0xf bank_mask:0xf
  s_nop 0
  v_readfirstlane_b32 s52, v2
  s_cmp_gt_u32 s52, s96
  s_cbranch_scc1 ka\sfx\()_x_wp_84_ok
  s_cmp_lt_u32 s45, 400000
  s_cbranch_scc1 ka\sfx\()_x_wp_84_spin
  s_branch ka\sfx\()_abort
ka\sfx\()_x_wp_84_ok:
  s_add_u32 s95, s63, s93
  s_add_u32 s95, s95, 12288
  s_add_u32 m0, s94, 0
  s_add_u32 s28, s95, 0
  buffer_load_dwordx4 v132, s[8:11], s28 offen sc1 lds
  s_add_u32 m0, s94, 1024
  s_add_u32 s28, s95, 2048
  buffer_load_dwordx4 v132, s[8:11], s28 offen sc1 lds
  s_add_u32 m0, s94, 2048
  s_add_u32 s28, s95, 4096
  buffer_load_dwordx4 v132, s[8:11], s28 offen sc1 lds
  s_add_u32 m0, s94, 3072
  s_add_u32 s28, s95, 6144
  buffer_load_dwordx4 v132, s[8:11], s28 offen sc1 lds
  s_add_u32 m0, s94, 4096
  s_add_u32 s28, s95, 8192
  buffer_load_dwordx4 v132, s[8:11], s28 offen sc1 lds
  s_add_u32 m0, s94, 5120
  s_add_u32 s28, s95, 10240
  buffer_load_dwordx4 v132, s[8:11], s28 offen sc1 lds
  s_branch xq_83_j_\sfx\()
xq_83_\sfx\():
  s_waitcnt vmcnt(0)
xq_83_j_\sfx\():
  s_waitcnt vmcnt(16)
  v_mfma_f32_16x16x32_bf16 v[112:115], v[76:79], v[44:47], 0
  v_mfma_f32_16x16x32_bf16 v[116:119], v[4:7], v[44:47], 0
  v_mfma_f32_16x16x32_bf16 v[120:123], v[8:11], v[44:47], 0
  s_waitcnt vmcnt(14)
  v_mfma_f32_16x16x32_bf16 v[112:115], v[80:83], v[48:51], v[112:115]
  v_mfma_f32_16x16x32_bf16 v[116:119], v[12:15], v[48:51], v[116:119]
  v_mfma_f32_16x16x32_bf16 v[120:123], v[16:19], v[48:51], v[120:123]
  s_waitcnt vmcnt(12)
  v_mfma_f32_16x16x32_bf16 v[112:115], v[84:87], v[52:55], v[112:115]
  v_mfma_f32_16x16x32_bf16 v[116:119], v[20:23], v[52:55], v[116:119]
  v_mfma_f32_16x16x32_bf16 v[120:123], v[24:27], v[52:55], v[120:123]
  s_waitcnt vmcnt(10)
  v_mfma_f32_16x16x32_bf16 v[112:115], v[88:91], v[56:59], v[112:115]
  v_mfma_f32_16x16x32_bf16 v[116:119], v[28:31], v[56:59], v[116:119]
  v_mfma_f32_16x16x32_bf16 v[120:123], v[32:35], v[56:59], v[120:123]
  s_waitcnt vmcnt(8)
  v_mfma_f32_16x16x32_bf16 v[112:115], v[92:95], v[68:71], v[112:115]
  v_mfma_f32_16x16x32_bf16 v[116:119], v[36:39], v[68:71], v[116:119]
  v_mfma_f32_16x16x32_bf16 v[120:123], v[40:43], v[68:71], v[120:123]
  s_waitcnt vmcnt(6)
  v_mfma_f32_16x16x32_bf16 v[112:115], v[96:99], v[72:75], v[112:115]
  v_mfma_f32_16x16x32_bf16 v[116:119], v[60:63], v[72:75], v[116:119]
  v_mfma_f32_16x16x32_bf16 v[120:123], v[64:67], v[72:75], v[120:123]
  s_nop 8
  v_cndmask_b32 v112, v135, v112, s[66:67]
  v_cndmask_b32 v113, v135, v113, s[66:67]
  v_cndmask_b32 v114, v135, v114, s[66:67]
  v_cndmask_b32 v115, v135, v115, s[66:67]
  v_cndmask_b32 v116, v135, v116, s[76:77]
  v_cndmask_b32 v120, v135, v120, s[84:85]
  v_cndmask_b32 v117, v135, v117, s[78:79]
  v_cndmask_b32 v121, v135, v121, s[86:87]
  v_cndmask_b32 v118, v135, v118, s[80:81]
  v_cndmask_b32 v122, v135, v122, s[88:89]
  v_cndmask_b32 v119, v135, v119, s[82:83]
  v_cndmask_b32 v123, v135, v123, s[90:91]
  v_max3_f32 v4, v112, v113, v114
  v_max3_f32 v5, v115, v116, v117
  v_max3_f32 v6, v118, v119, v120
  v_max3_f32 v7, v121, v122, v123
  v_max3_f32 v4, v4, v5, v6
  v_max_f32 v4, v4, v7
  v_mov_b32 v5, v4
  s_nop 1
  v_permlane16_swap_b32 v4, v5
  v_max_f32 v4, v4, v5
  v_mov_b32 v5, v4
  s_nop 1
  v_permlane32_swap_b32 v4, v5
  v_max_f32 v4, v4, v5
  v_mul_f32 v4, s64, v4
  v_fma_f32 v112, v112, s64, -v4
  v_fma_f32 v113, v113, s64, -v4
  v_fma_f32 v114, v114, s64, -v4
  v_fma_f32 v115, v115, s64, -v4
  v_fma_f32 v116, v116, s64, -v4
  v_fma_f32 v117, v117, s64, -v4
  v_fma_f32 v118, v118, s64, -v4
  v_fma_f32 v119, v119, s64, -v4
  v_fma_f32 v120, v120, s64, -v4
  v_fma_f32 v121, v121, s64, -v4
  v_fma_f32 v122, v122, s64, -v4
  v_fma_f32 v123, v123, s64, -v4
  v_exp_f32 v112, v112
  v_exp_f32 v113, v113
  v_exp_f32 v114, v114
  v_exp_f32 v115, v115
  v_exp_f32 v116, v116
  v_exp_f32 v117, v117
  v_exp_f32 v118, v118
  v_exp_f32 v119, v119
  v_exp_f32 v120, v120
  v_exp_f32 v121, v121
  v_exp_f32 v122, v122
  v_exp_f32 v123, v123
  v_add_f32 v5, v112, v113
  v_add_f32 v6, v114, v115
  v_add_f32 v7, v116, v117
  v_add_f32 v8, v118, v119
  v_add_f32 v9, v120, v121
  v_add_f32 v10, v122, v123
  v_add_f32 v5, v5, v6
  v_add_f32 v7, v7, v8
  v_add_f32 v9, v9, v10
  v_add_f32 v5, v5, v7
  v_add_f32 v5, v5, v9
  v_mov_b32 v6, v5
  s_nop 1
  v_permlane16_swap_b32 v5, v6
  v_add_f32 v5, v5, v6
  v_mov_b32 v6, v5
  s_nop 1
  v_permlane32_swap_b32 v5, v6
  v_add_f32 v5, v5, v6
  v_rcp_f32 v5, v5
  s_nop 0
  v_mul_f32 v112, v112, v5
  v_mul_f32 v113, v113, v5
  v_mul_f32 v114, v114, v5
  v_mul_f32 v115, v115, v5
  v_mul_f32 v116, v116, v5
  v_mul_f32 v117, v117, v5
  v_mul_f32 v118, v118, v5
  v_mul_f32 v119, v119, v5
  v_mul_f32 v120, v120, v5
  v_mul_f32 v121, v121, v5
  v_mul_f32 v122, v122, v5
  v_mul_f32 v123, v123, v5
  v_cvt_pk_bf16_f32 v8, v112, v113
  v_cvt_pk_bf16_f32 v9, v114, v115
  v_cvt_pk_bf16_f32 v10, v116, v117
  v_cvt_pk_bf16_f32 v11, v118, v119
  v_cvt_pk_bf16_f32 v12, v120, v121
  v_cvt_pk_bf16_f32 v13, v122, v123
  buffer_store_dwordx2 v[10:11], v133, s[8:11], s92 offen \pol
  buffer_store_dwordx2 v[12:13], v133, s[8:11], s92 offen offset:256 \pol
  buffer_store_dwordx2 v[8:9], v134, s[8:11], s92 offen \pol
  s_add_u32 s92, s92, 20480
  s_cmp_ge_u32 s51, 63
  s_cbranch_scc1 ka\sfx\()_x_done
  v_mov_b32 v60, 0
  v_mov_b32 v61, 0
  v_mov_b32 v62, 0
  v_mov_b32 v63, 0
  v_mov_b32 v64, 0
  v_mov_b32 v65, 0
  v_mov_b32 v66, 0
  v_mov_b32 v67, 0
  v_mov_b32 v68, 0
  v_mov_b32 v69, 0
  v_mov_b32 v70, 0
  v_mov_b32 v71, 0
  v_mov_b32 v72, 0
  v_mov_b32 v73, 0
  v_mov_b32 v74, 0
  v_mov_b32 v75, 0
  v_mov_b32 v36, 0
  v_mov_b32 v37, 0
  v_mov_b32 v38, 0
  v_mov_b32 v39, 0
  v_mov_b32 v40, 0
  v_mov_b32 v41, 0
  v_mov_b32 v42, 0
  v_mov_b32 v43, 0
  s_add_u32 s97, s97, 10240
  s_mov_b32 s48, s97
  s_add_u32 s49, s49, 5120
  s_add_u32 s98, s49, 5120
  s_add_u32 s50, s50, 12288
  s_add_u32 s63, s63, 12288
  s_add_u32 s51, s51, 1
  s_cmp_gt_u32 s52, s51
  s_cbranch_scc1 ka\sfx\()_x_wp_85_ok
  s_mov_b32 s45, 0
ka\sfx\()_x_wp_85_spin:
  buffer_load_dword v2, v138, s[8:11], 0 offen sc1
  s_add_u32 s45, s45, 1
  s_waitcnt vmcnt(0)
  v_min_u32_dpp v3, v2, v2 quad_perm:[1,0,3,2] row_mask:0xf bank_mask:0xf
  s_nop 1
  v_min_u32_dpp v2, v3, v3 quad_perm:[2,3,0,1] row_mask:0xf bank_mask:0xf
  s_nop 1
  v_min_u32_dpp v3, v2, v2 row_half_mirror row_mask:0xf bank_mask:0xf
  s_nop 1
  v_min_u32_dpp v2, v3, v3 quad_perm:[0,1,2,3] row_mask:0xf bank_mask:0xf
  s_nop 0
  v_readfirstlane_b32 s52, v2
  s_cmp_gt_u32 s52, s51
  s_cbranch_scc1 ka\sfx\()_x_wp_85_ok
  s_cmp_lt_u32 s45, 400000
  s_cbranch_scc1 ka\sfx\()_x_wp_85_spin
  s_branch ka\sfx\()_abort
ka\sfx\()_x_wp_85_ok:
  s_add_u32 s28, s50, s53
  buffer_load_dwordx2 v[88:89], v132, s[8:11], s28 offen offset:0 sc1
  buffer_load_dwordx2 v[92:93], v132, s[8:11], s28 offen offset:1024 sc1
  s_add_u32 s28, s50, s54
  buffer_load_dwordx2 v[90:91], v132, s[8:11], s28 offen offset:0 sc1
  buffer_load_dwordx2 v[94:95], v132, s[8:11], s28 offen offset:1024 sc1
  s_add_u32 s28, s50, s55
  buffer_load_dwordx2 v[96:97], v132, s[8:11], s28 offen offset:0 sc1
  buffer_load_dwordx2 v[98:99], v132, s[8:11], s28 offen offset:1024 sc1
  s_branch ka\sfx\()_x_w2l
ka\sfx\()_x_w3l:
  ds_read_b128 v[44:47], v129 offset:2048
  ds_read_b128 v[48:51], v129 offset:3072
  ds_read_b128 v[52:55], v129 offset:12288
  ds_read_b128 v[56:59], v129 offset:13312
  s_waitcnt lgkmcnt(0)
  s_mov_b32 s45, 0
ka\sfx\()_x_pf_86_pr:
  buffer_load_dword v139, v141, s[8:11], s48 offen sc1
  s_add_u32 s45, s45, 1
  s_waitcnt vmcnt(0)
  v_cmp_eq_u32 vcc, -1, v139
  s_cbranch_vccz ka\sfx\()_x_pf_86
  s_cmp_lt_u32 s45, 400000
  s_cbranch_scc1 ka\sfx\()_x_pf_86_pr
  s_branch ka\sfx\()_abort
ka\sfx\()_x_pf_86:
  buffer_load_dwordx4 v[112:115], v124, s[8:11], s48 offen sc1
  buffer_load_dwordx4 v[116:119], v125, s[8:11], s48 offen sc1
  s_add_u32 s45, s45, 1
  s_waitcnt vmcnt(1)
  ds_write_b128 v127, v[112:115] offset:0
  v_max3_u32 v139, v112, v113, v114
  v_max_u32 v139, v139, v115
  s_waitcnt vmcnt(0)
  ds_write_b128 v127, v[116:119] offset:4096
  v_max3_u32 v139, v139, v116, v117
  v_max3_u32 v139, v139, v118, v119
  v_cmp_eq_u32 vcc, -1, v139
  s_cbranch_vccz ka\sfx\()_x_pf_86_ok
  s_cmp_lt_u32 s45, 400000
  s_cbranch_scc1 ka\sfx\()_x_pf_86
  s_branch ka\sfx\()_abort
ka\sfx\()_x_pf_86_ok:
  v_smfmac_f32_16x16x64_bf16 v[60:63], v[112:115], a[24:31], v110
  v_smfmac_f32_16x16x64_bf16 v[64:67], v[112:115], v[44:51], v110
  ds_read_b128 v[44:47], v129 offset:22528
  v_smfmac_f32_16x16x64_bf16 v[68:71], v[112:115], a[104:111], v110
  ds_read_b128 v[48:51], v129 offset:23552
  v_smfmac_f32_16x16x64_bf16 v[72:75], v[112:115], v[52:59], v110
  ds_read_b128 v[52:55], v129 offset:6144
  s_waitcnt lgkmcnt(3)
  s_barrier
  v_smfmac_f32_16x16x64_bf16 v[36:39], v[112:115], a[184:191], v110
  ds_read_b128 v[56:59], v129 offset:7168
  ds_read_b128 v[4:7], v128 offset:0
  s_waitcnt lgkmcnt(3)
  v_smfmac_f32_16x16x64_bf16 v[40:43], v[112:115], v[44:51], v110
  ds_read_b128 v[44:47], v129 offset:16384
  ds_read_b128 v[8:11], v128 offset:1024
  v_smfmac_f32_16x16x64_bf16 v[60:63], v[116:119], a[56:63], v110
  ds_read_b128 v[48:51], v129 offset:17408
  ds_read_b128 v[12:15], v128 offset:2048
  s_waitcnt lgkmcnt(5)
  v_smfmac_f32_16x16x64_bf16 v[64:67], v[116:119], v[52:59], v110
  ds_read_b128 v[52:55], v129 offset:26624
  ds_read_b128 v[16:19], v128 offset:4096
  v_smfmac_f32_16x16x64_bf16 v[68:71], v[116:119], a[136:143], v110
  ds_read_b128 v[56:59], v129 offset:27648
  ds_read_b128 v[20:23], v128 offset:5120
  s_waitcnt lgkmcnt(5)
  v_smfmac_f32_16x16x64_bf16 v[72:75], v[116:119], v[44:51], v110
  ds_read_b128 v[44:47], v129 offset:0
  ds_read_b128 v[24:27], v128 offset:6144
  v_smfmac_f32_16x16x64_bf16 v[36:39], v[116:119], a[216:223], v110
  ds_read_b128 v[48:51], v129 offset:1024
  ds_read_b128 v[28:31], v128 offset:8192
  s_waitcnt lgkmcnt(5)
  v_smfmac_f32_16x16x64_bf16 v[40:43], v[116:119], v[52:59], v110
  ds_read_b128 v[52:55], v129 offset:4096
  ds_read_b128 v[32:35], v128 offset:9216
  v_smfmac_f32_16x16x64_bf16 v[60:63], v[4:7], a[0:7], v110
  ds_read_b128 v[56:59], v129 offset:5120
  v_smfmac_f32_16x16x64_bf16 v[64:67], v[4:7], a[240:247], v110
  v_smfmac_f32_16x16x64_bf16 v[60:63], v[8:11], a[8:15], v110
  s_waitcnt lgkmcnt(4)
  v_smfmac_f32_16x16x64_bf16 v[64:67], v[8:11], v[44:51], v110
  ds_read_b128 v[44:47], v129 offset:8192
  v_smfmac_f32_16x16x64_bf16 v[60:63], v[12:15], a[16:23], v110
  ds_read_b128 v[48:51], v129 offset:9216
  v_smfmac_f32_16x16x64_bf16 v[64:67], v[12:15], a[248:255], v110
  v_smfmac_f32_16x16x64_bf16 v[60:63], v[16:19], a[32:39], v110
  v_smfmac_f32_16x16x64_bf16 v[64:67], v[16:19], v[152:159], v110
  v_smfmac_f32_16x16x64_bf16 v[60:63], v[20:23], a[40:47], v110
  s_waitcnt lgkmcnt(2)
  v_smfmac_f32_16x16x64_bf16 v[64:67], v[20:23], v[52:59], v110
  ds_read_b128 v[52:55], v129 offset:10240
  v_smfmac_f32_16x16x64_bf16 v[60:63], v[24:27], a[48:55], v110
  ds_read_b128 v[56:59], v129 offset:11264
  v_smfmac_f32_16x16x64_bf16 v[64:67], v[24:27], v[160:167], v110
  v_smfmac_f32_16x16x64_bf16 v[60:63], v[28:31], a[64:71], v110
  v_smfmac_f32_16x16x64_bf16 v[64:67], v[28:31], v[168:175], v110
  v_smfmac_f32_16x16x64_bf16 v[60:63], v[32:35], a[72:79], v110
  s_waitcnt lgkmcnt(2)
  v_smfmac_f32_16x16x64_bf16 v[64:67], v[32:35], v[44:51], v110
  ds_read_b128 v[44:47], v129 offset:14336
  v_smfmac_f32_16x16x64_bf16 v[68:71], v[4:7], a[80:87], v110
  ds_read_b128 v[48:51], v129 offset:15360
  v_smfmac_f32_16x16x64_bf16 v[72:75], v[4:7], v[176:183], v110
  v_permlane32_swap_b32 v60, v64
  v_smfmac_f32_16x16x64_bf16 v[68:71], v[8:11], a[88:95], v110
  s_waitcnt lgkmcnt(2)
  v_smfmac_f32_16x16x64_bf16 v[72:75], v[8:11], v[52:59], v110
  ds_read_b128 v[52:55], v129 offset:18432
  v_permlane32_swap_b32 v61, v65
  v_smfmac_f32_16x16x64_bf16 v[68:71], v[12:15], a[96:103], v110
  ds_read_b128 v[56:59], v129 offset:19456
  v_smfmac_f32_16x16x64_bf16 v[72:75], v[12:15], v[184:191], v110
  v_permlane32_swap_b32 v62, v66
  v_smfmac_f32_16x16x64_bf16 v[68:71], v[16:19], a[112:119], v110
  v_permlane32_swap_b32 v63, v67
  v_smfmac_f32_16x16x64_bf16 v[72:75], v[16:19], v[192:199], v110
  v_add_f32 v60, v60, v64
  v_smfmac_f32_16x16x64_bf16 v[68:71], v[20:23], a[120:127], v110
  v_add_f32 v61, v61, v65
  s_waitcnt lgkmcnt(2)
  v_smfmac_f32_16x16x64_bf16 v[72:75], v[20:23], v[44:51], v110
  ds_read_b128 v[44:47], v129 offset:20480
  v_add_f32 v62, v62, v66
  v_smfmac_f32_16x16x64_bf16 v[68:71], v[24:27], a[128:135], v110
  ds_read_b128 v[48:51], v129 offset:21504
  v_add_f32 v63, v63, v67
  v_smfmac_f32_16x16x64_bf16 v[72:75], v[24:27], v[200:207], v110
  v_cvt_pk_bf16_f32 v100, v60, v61
  v_smfmac_f32_16x16x64_bf16 v[68:71], v[28:31], a[144:151], v110
  v_cvt_pk_bf16_f32 v101, v62, v63
  v_smfmac_f32_16x16x64_bf16 v[72:75], v[28:31], v[208:215], v110
  v_smfmac_f32_16x16x64_bf16 v[68:71], v[32:35], a[152:159], v110
  s_waitcnt lgkmcnt(2)
  v_smfmac_f32_16x16x64_bf16 v[72:75], v[32:35], v[52:59], v110
  ds_read_b128 v[52:55], v129 offset:24576
  v_smfmac_f32_16x16x64_bf16 v[36:39], v[4:7], a[160:167], v110
  ds_read_b128 v[56:59], v129 offset:25600
  v_smfmac_f32_16x16x64_bf16 v[40:43], v[4:7], v[216:223], v110
  v_permlane32_swap_b32 v68, v72
  v_smfmac_f32_16x16x64_bf16 v[36:39], v[8:11], a[168:175], v110
  s_waitcnt lgkmcnt(2)
  v_smfmac_f32_16x16x64_bf16 v[40:43], v[8:11], v[44:51], v110
  ds_read_b128 v[44:47], v129 offset:28672
  v_permlane32_swap_b32 v69, v73
  v_smfmac_f32_16x16x64_bf16 v[36:39], v[12:15], a[176:183], v110
  ds_read_b128 v[48:51], v129 offset:29696
  v_smfmac_f32_16x16x64_bf16 v[40:43], v[12:15], v[224:231], v110
  v_permlane32_swap_b32 v70, v74
  v_smfmac_f32_16x16x64_bf16 v[36:39], v[16:19], a[192:199], v110
  v_permlane32_swap_b32 v71, v75
  v_smfmac_f32_16x16x64_bf16 v[40:43], v[16:19], v[232:239], v110
  v_add_f32 v68, v68, v72
  v_smfmac_f32_16x16x64_bf16 v[36:39], v[20:23], a[200:207], v110
  v_add_f32 v69, v69, v73
  s_waitcnt lgkmcnt(2)
  v_smfmac_f32_16x16x64_bf16 v[40:43], v[20:23], v[52:59], v110
  v_add_f32 v70, v70, v74
  v_smfmac_f32_16x16x64_bf16 v[36:39], v[24:27], a[208:215], v110
  v_add_f32 v71, v71, v75
  v_smfmac_f32_16x16x64_bf16 v[40:43], v[24:27], v[240:247], v110
  v_cvt_pk_bf16_f32 v102, v68, v69
  v_smfmac_f32_16x16x64_bf16 v[36:39], v[28:31], a[224:231], v110
  v_cvt_pk_bf16_f32 v103, v70, v71
  v_smfmac_f32_16x16x64_bf16 v[40:43], v[28:31], v[248:255], v110
  v_smfmac_f32_16x16x64_bf16 v[36:39], v[32:35], a[232:239], v110
  s_waitcnt lgkmcnt(0)
  v_smfmac_f32_16x16x64_bf16 v[40:43], v[32:35], v[44:51], v110
  v_mfma_f32_16x16x16_bf16 v[142:145], v[100:101], v[108:109], 0
  v_mfma_f32_16x16x16_bf16 v[146:149], v[102:103], v[108:109], 0
  s_nop 1
  v_permlane32_swap_b32 v36, v40
  v_permlane32_swap_b32 v37, v41
  v_permlane32_swap_b32 v38, v42
  v_permlane32_swap_b32 v39, v43
  v_add_f32 v36, v36, v40
  v_add_f32 v37, v37, v41
  v_add_f32 v38, v38, v42
  v_add_f32 v39, v39, v43
  v_cvt_pk_bf16_f32 v104, v36, v37
  v_cvt_pk_bf16_f32 v105, v38, v39
  v_cvt_pk_bf16_f32 v44, v142, v143
  v_cvt_pk_bf16_f32 v45, v144, v145
  v_mfma_f32_16x16x16_bf16 v[142:145], v[104:105], v[108:109], 0
  v_cvt_pk_bf16_f32 v46, v146, v147
  v_cvt_pk_bf16_f32 v47, v148, v149
  s_nop 1
  v_mfma_f32_16x16x32_bf16 v[76:79], v[44:47], v[44:47], 0
  v_mfma_f32_16x16x32_bf16 v[80:83], v[88:91], v[44:47], 0
  v_cvt_pk_bf16_f32 v106, v142, v143
  v_cvt_pk_bf16_f32 v107, v144, v145
  v_mfma_f32_16x16x32_bf16 v[84:87], v[92:95], v[44:47], 0
  s_nop 0
  v_mfma_f32_16x16x16_bf16 v[76:79], v[106:107], v[106:107], v[76:79]
  v_mfma_f32_16x16x16_bf16 v[80:83], v[96:97], v[106:107], v[80:83]
  v_mfma_f32_16x16x16_bf16 v[84:87], v[98:99], v[106:107], v[84:87]
  s_mov_b32 exec_lo, 0
  s_mov_b32 exec_hi, 0x00ff00ff
  s_nop 3
  ds_write_b128 v130, v[76:79]
  s_mov_b32 exec_lo, 0x00ff00ff
  ds_write_b128 v130, v[80:83] offset:1024
  s_nop 0
  ds_write_b128 v130, v[84:87] offset:2048
  s_mov_b64 exec, -1
  s_waitcnt lgkmcnt(0)
  s_barrier
  ds_write_b64 v131, v[44:45]
  ds_write_b64 v131, v[46:47] offset:512
  ds_write_b64 v131, v[106:107] offset:1024
  ds_read_b128 v[44:47], v137 offset:0
  ds_read_b128 v[48:51], v137 offset:1024
  ds_read_b128 v[52:55], v137 offset:2048
  ds_read_b128 v[56:59], v137 offset:3072
  ds_read_b128 v[68:71], v137 offset:4096
  ds_read_b128 v[72:75], v137 offset:5120
  s_waitcnt lgkmcnt(0)
  s_barrier
  s_mov_b32 s28, s50
  buffer_load_dwordx4 v[4:7], v132, s[8:11], s28 offen sc1
  buffer_load_dwordx4 v[8:11], v132, s[8:11], s28 offen offset:1024 sc1
  s_add_u32 s28, s28, 2048
  buffer_load_dwordx4 v[12:15], v132, s[8:11], s28 offen sc1
  buffer_load_dwordx4 v[16:19], v132, s[8:11], s28 offen offset:1024 sc1
  s_add_u32 s28, s28, 2048
  buffer_load_dwordx4 v[20:23], v132, s[8:11], s28 offen sc1
  buffer_load_dwordx4 v[24:27], v132, s[8:11], s28 offen offset:1024 sc1
  s_add_u32 s28, s28, 2048
  buffer_load_dwordx4 v[28:31], v132, s[8:11], s28 offen sc1
  buffer_load_dwordx4 v[32:35], v132, s[8:11], s28 offen offset:1024 sc1
  s_add_u32 s28, s28, 2048
  buffer_load_dwordx4 v[36:39], v132, s[8:11], s28 offen sc1
  buffer_load_dwordx4 v[40:43], v132, s[8:11], s28 offen offset:1024 sc1
  s_add_u32 s28, s28, 2048
  buffer_load_dwordx4 v[60:63], v132, s[8:11], s28 offen sc1
  buffer_load_dwordx4 v[64:67], v132, s[8:11], s28 offen offset:1024 sc1
  s_add_u32 s28, s28, 2048
  ds_read_b64 v[76:77], v136 offset:0
  ds_read_b64 v[78:79], v136 offset:512
  ds_read_b64 v[80:81], v136 offset:1024
  ds_read_b64 v[82:83], v136 offset:1536
  ds_read_b64 v[84:85], v136 offset:2048
  ds_read_b64 v[86:87], v136 offset:2560
  ds_read_b64 v[88:89], v136 offset:3072
  ds_read_b64 v[90:91], v136 offset:3584
  ds_read_b64 v[92:93], v136 offset:4096
  ds_read_b64 v[94:95], v136 offset:4608
  ds_read_b64 v[96:97], v136 offset:5120
  ds_read_b64 v[98:99], v136 offset:5632
  s_waitcnt lgkmcnt(0)
  s_cmp_ge_u32 s51, 63
  s_cbranch_scc1 xq_87_\sfx\()
  s_add_u32 s96, s51, 1
  s_cmp_gt_u32 s52, s96
  s_cbranch_scc1 ka\sfx\()_x_wp_88_ok
  s_mov_b32 s45, 0
ka\sfx\()_x_wp_88_spin:
  buffer_load_dword v2, v138, s[8:11], 0 offen sc1
  s_add_u32 s45, s45, 1
  s_waitcnt vmcnt(0)
  v_min_u32_dpp v3, v2, v2 quad_perm:[1,0,3,2] row_mask:0xf bank_mask:0xf
  s_nop 1
  v_min_u32_dpp v2, v3, v3 quad_perm:[2,3,0,1] row_mask:0xf bank_mask:0xf
  s_nop 1
  v_min_u32_dpp v3, v2, v2 row_half_mirror row_mask:0xf bank_mask:0xf
  s_nop 1
  v_min_u32_dpp v2, v3, v3 quad_perm:[0,1,2,3] row_mask:0xf bank_mask:0xf
  s_nop 0
  v_readfirstlane_b32 s52, v2
  s_cmp_gt_u32 s52, s96
  s_cbranch_scc1 ka\sfx\()_x_wp_88_ok
  s_cmp_lt_u32 s45, 400000
  s_cbranch_scc1 ka\sfx\()_x_wp_88_spin
  s_branch ka\sfx\()_abort
ka\sfx\()_x_wp_88_ok:
  s_add_u32 s95, s63, s93
  s_add_u32 s95, s95, 12288
  s_add_u32 m0, s94, 0
  s_add_u32 s28, s95, 0
  buffer_load_dwordx4 v132, s[8:11], s28 offen sc1 lds
  s_add_u32 m0, s94, 1024
  s_add_u32 s28, s95, 2048
  buffer_load_dwordx4 v132, s[8:11], s28 offen sc1 lds
  s_add_u32 m0, s94, 2048
  s_add_u32 s28, s95, 4096
  buffer_load_dwordx4 v132, s[8:11], s28 offen sc1 lds
  s_add_u32 m0, s94, 3072
  s_add_u32 s28, s95, 6144
  buffer_load_dwordx4 v132, s[8:11], s28 offen sc1 lds
  s_add_u32 m0, s94, 4096
  s_add_u32 s28, s95, 8192
  buffer_load_dwordx4 v132, s[8:11], s28 offen sc1 lds
  s_add_u32 m0, s94, 5120
  s_add_u32 s28, s95, 10240
  buffer_load_dwordx4 v132, s[8:11], s28 offen sc1 lds
  s_branch xq_87_j_\sfx\()
xq_87_\sfx\():
  s_waitcnt vmcnt(0)
xq_87_j_\sfx\():
  s_waitcnt vmcnt(16)
  v_mfma_f32_16x16x32_bf16 v[112:115], v[76:79], v[44:47], 0
  v_mfma_f32_16x16x32_bf16 v[116:119], v[4:7], v[44:47], 0
  v_mfma_f32_16x16x32_bf16 v[120:123], v[8:11], v[44:47], 0
  s_waitcnt vmcnt(14)
  v_mfma_f32_16x16x32_bf16 v[112:115], v[80:83], v[48:51], v[112:115]
  v_mfma_f32_16x16x32_bf16 v[116:119], v[12:15], v[48:51], v[116:119]
  v_mfma_f32_16x16x32_bf16 v[120:123], v[16:19], v[48:51], v[120:123]
  s_waitcnt vmcnt(12)
  v_mfma_f32_16x16x32_bf16 v[112:115], v[84:87], v[52:55], v[112:115]
  v_mfma_f32_16x16x32_bf16 v[116:119], v[20:23], v[52:55], v[116:119]
  v_mfma_f32_16x16x32_bf16 v[120:123], v[24:27], v[52:55], v[120:123]
  s_waitcnt vmcnt(10)
  v_mfma_f32_16x16x32_bf16 v[112:115], v[88:91], v[56:59], v[112:115]
  v_mfma_f32_16x16x32_bf16 v[116:119], v[28:31], v[56:59], v[116:119]
  v_mfma_f32_16x16x32_bf16 v[120:123], v[32:35], v[56:59], v[120:123]
  s_waitcnt vmcnt(8)
  v_mfma_f32_16x16x32_bf16 v[112:115], v[92:95], v[68:71], v[112:115]
  v_mfma_f32_16x16x32_bf16 v[116:119], v[36:39], v[68:71], v[116:119]
  v_mfma_f32_16x16x32_bf16 v[120:123], v[40:43], v[68:71], v[120:123]
  s_waitcnt vmcnt(6)
  v_mfma_f32_16x16x32_bf16 v[112:115], v[96:99], v[72:75], v[112:115]
  v_mfma_f32_16x16x32_bf16 v[116:119], v[60:63], v[72:75], v[116:119]
  v_mfma_f32_16x16x32_bf16 v[120:123], v[64:67], v[72:75], v[120:123]
  s_nop 8
  v_cndmask_b32 v112, v135, v112, s[66:67]
  v_cndmask_b32 v113, v135, v113, s[66:67]
  v_cndmask_b32 v114, v135, v114, s[66:67]
  v_cndmask_b32 v115, v135, v115, s[66:67]
  v_cndmask_b32 v116, v135, v116, s[76:77]
  v_cndmask_b32 v120, v135, v120, s[84:85]
  v_cndmask_b32 v117, v135, v117, s[78:79]
  v_cndmask_b32 v121, v135, v121, s[86:87]
  v_cndmask_b32 v118, v135, v118, s[80:81]
  v_cndmask_b32 v122, v135, v122, s[88:89]
  v_cndmask_b32 v119, v135, v119, s[82:83]
  v_cndmask_b32 v123, v135, v123, s[90:91]
  v_max3_f32 v4, v112, v113, v114
  v_max3_f32 v5, v115, v116, v117
  v_max3_f32 v6, v118, v119, v120
  v_max3_f32 v7, v121, v122, v123
  v_max3_f32 v4, v4, v5, v6
  v_max_f32 v4, v4, v7
  v_mov_b32 v5, v4
  s_nop 1
  v_permlane16_swap_b32 v4, v5
  v_max_f32 v4, v4, v5
  v_mov_b32 v5, v4
  s_nop 1
  v_permlane32_swap_b32 v4, v5
  v_max_f32 v4, v4, v5
  v_mul_f32 v4, s64, v4
  v_fma_f32 v112, v112, s64, -v4
  v_fma_f32 v113, v113, s64, -v4
  v_fma_f32 v114, v114, s64, -v4
  v_fma_f32 v115, v115, s64, -v4
  v_fma_f32 v116, v116, s64, -v4
  v_fma_f32 v117, v117, s64, -v4
  v_fma_f32 v118, v118, s64, -v4
  v_fma_f32 v119, v119, s64, -v4
  v_fma_f32 v120, v120, s64, -v4
  v_fma_f32 v121, v121, s64, -v4
  v_fma_f32 v122, v122, s64, -v4
  v_fma_f32 v123, v123, s64, -v4
  v_exp_f32 v112, v112
  v_exp_f32 v113, v113
  v_exp_f32 v114, v114
  v_exp_f32 v115, v115
  v_exp_f32 v116, v116
  v_exp_f32 v117, v117
  v_exp_f32 v118, v118
  v_exp_f32 v119, v119
  v_exp_f32 v120, v120
  v_exp_f32 v121, v121
  v_exp_f32 v122, v122
  v_exp_f32 v123, v123
  v_add_f32 v5, v112, v113
  v_add_f32 v6, v114, v115
  v_add_f32 v7, v116, v117
  v_add_f32 v8, v118, v119
  v_add_f32 v9, v120, v121
  v_add_f32 v10, v122, v123
  v_add_f32 v5, v5, v6
  v_add_f32 v7, v7, v8
  v_add_f32 v9, v9, v10
  v_add_f32 v5, v5, v7
  v_add_f32 v5, v5, v9
  v_mov_b32 v6, v5
  s_nop 1
  v_permlane16_swap_b32 v5, v6
  v_add_f32 v5, v5, v6
  v_mov_b32 v6, v5
  s_nop 1
  v_permlane32_swap_b32 v5, v6
  v_add_f32 v5, v5, v6
  v_rcp_f32 v5, v5
  s_nop 0
  v_mul_f32 v112, v112, v5
  v_mul_f32 v113, v113, v5
  v_mul_f32 v114, v114, v5
  v_mul_f32 v115, v115, v5
  v_mul_f32 v116, v116, v5
  v_mul_f32 v117, v117, v5
  v_mul_f32 v118, v118, v5
  v_mul_f32 v119, v119, v5
  v_mul_f32 v120, v120, v5
  v_mul_f32 v121, v121, v5
  v_mul_f32 v122, v122, v5
  v_mul_f32 v123, v123, v5
  v_cvt_pk_bf16_f32 v8, v112, v113
  v_cvt_pk_bf16_f32 v9, v114, v115
  v_cvt_pk_bf16_f32 v10, v116, v117
  v_cvt_pk_bf16_f32 v11, v118, v119
  v_cvt_pk_bf16_f32 v12, v120, v121
  v_cvt_pk_bf16_f32 v13, v122, v123
  buffer_store_dwordx2 v[10:11], v133, s[8:11], s92 offen \pol
  buffer_store_dwordx2 v[12:13], v133, s[8:11], s92 offen offset:256 \pol
  buffer_store_dwordx2 v[8:9], v134, s[8:11], s92 offen \pol
  s_add_u32 s92, s92, 20480
  s_cmp_ge_u32 s51, 63
  s_cbranch_scc1 ka\sfx\()_x_done
  v_mov_b32 v60, 0
  v_mov_b32 v61, 0
  v_mov_b32 v62, 0
  v_mov_b32 v63, 0
  v_mov_b32 v64, 0
  v_mov_b32 v65, 0
  v_mov_b32 v66, 0
  v_mov_b32 v67, 0
  v_mov_b32 v68, 0
  v_mov_b32 v69, 0
  v_mov_b32 v70, 0
  v_mov_b32 v71, 0
  v_mov_b32 v72, 0
  v_mov_b32 v73, 0
  v_mov_b32 v74, 0
  v_mov_b32 v75, 0
  v_mov_b32 v36, 0
  v_mov_b32 v37, 0
  v_mov_b32 v38, 0
  v_mov_b32 v39, 0
  v_mov_b32 v40, 0
  v_mov_b32 v41, 0
  v_mov_b32 v42, 0
  v_mov_b32 v43, 0
  s_add_u32 s97, s97, 10240
  s_mov_b32 s48, s97
  s_add_u32 s49, s49, 5120
  s_add_u32 s98, s49, 5120
  s_add_u32 s50, s50, 12288
  s_add_u32 s63, s63, 12288
  s_add_u32 s51, s51, 1
  s_cmp_gt_u32 s52, s51
  s_cbranch_scc1 ka\sfx\()_x_wp_89_ok
  s_mov_b32 s45, 0
ka\sfx\()_x_wp_89_spin:
  buffer_load_dword v2, v138, s[8:11], 0 offen sc1
  s_add_u32 s45, s45, 1
  s_waitcnt vmcnt(0)
  v_min_u32_dpp v3, v2, v2 quad_perm:[1,0,3,2] row_mask:0xf bank_mask:0xf
  s_nop 1
  v_min_u32_dpp v2, v3, v3 quad_perm:[2,3,0,1] row_mask:0xf bank_mask:0xf
  s_nop 1
  v_min_u32_dpp v3, v2, v2 row_half_mirror row_mask:0xf bank_mask:0xf
  s_nop 1
  v_min_u32_dpp v2, v3, v3 quad_perm:[0,1,2,3] row_mask:0xf bank_mask:0xf
  s_nop 0
  v_readfirstlane_b32 s52, v2
  s_cmp_gt_u32 s52, s51
  s_cbranch_scc1 ka\sfx\()_x_wp_89_ok
  s_cmp_lt_u32 s45, 400000
  s_cbranch_scc1 ka\sfx\()_x_wp_89_spin
  s_branch ka\sfx\()_abort
ka\sfx\()_x_wp_89_ok:
  s_add_u32 s28, s50, s53
  buffer_load_dwordx2 v[88:89], v132, s[8:11], s28 offen offset:0 sc1
  buffer_load_dwordx2 v[92:93], v132, s[8:11], s28 offen offset:1024 sc1
  s_add_u32 s28, s50, s54
  buffer_load_dwordx2 v[90:91], v132, s[8:11], s28 offen offset:0 sc1
  buffer_load_dwordx2 v[94:95], v132, s[8:11], s28 offen offset:1024 sc1
  s_add_u32 s28, s50, s55
  buffer_load_dwordx2 v[96:97], v132, s[8:11], s28 offen offset:0 sc1
  buffer_load_dwordx2 v[98:99], v132, s[8:11], s28 offen offset:1024 sc1
  s_branch ka\sfx\()_x_w3l
ka\sfx\()_x_done:
  s_waitcnt vmcnt(0) lgkmcnt(0)
  s_branch ka\sfx\()_exit
ka\sfx\()_y:
  v_and_b32 v1, 63, v0
  v_lshlrev_b32 v178, 4, v1
  s_and_b32 s28, s21, 1
  s_lshl_b32 s46, s23, 1
  s_add_u32 s46, s46, s28
  s_lshr_b32 s28, s21, 1
  s_lshl_b32 s28, s28, 2
  s_lshl_b32 s47, s20, 3
  s_add_u32 s47, s47, s28
  s_mul_i32 s28, s47, 40
  s_add_u32 s28, s28, s46
  s_mul_i32 s28, s28, 20480
  s_add_u32 s28, s28, 0x2e00000
  s_add_u32 s29, s28, 0
  buffer_load_dwordx4 a[0:3], v178, s[8:11], s29 offen
  buffer_load_dwordx4 a[4:7], v178, s[8:11], s29 offen offset:1024
  s_add_u32 s29, s28, 2048
  buffer_load_dwordx4 a[8:11], v178, s[8:11], s29 offen
  buffer_load_dwordx4 a[12:15], v178, s[8:11], s29 offen offset:1024
  s_add_u32 s29, s28, 4096
  buffer_load_dwordx4 a[16:19], v178, s[8:11], s29 offen
  buffer_load_dwordx4 a[20:23], v178, s[8:11], s29 offen offset:1024
  s_add_u32 s29, s28, 6144
  buffer_load_dwordx4 a[24:27], v178, s[8:11], s29 offen
  buffer_load_dwordx4 a[28:31], v178, s[8:11], s29 offen offset:1024
  s_add_u32 s29, s28, 8192
  buffer_load_dwordx4 a[32:35], v178, s[8:11], s29 offen
  buffer_load_dwordx4 a[36:39], v178, s[8:11], s29 offen offset:1024
  s_add_u32 s29, s28, 10240
  buffer_load_dwordx4 a[40:43], v178, s[8:11], s29 offen
  buffer_load_dwordx4 a[44:47], v178, s[8:11], s29 offen offset:1024
  s_add_u32 s29, s28, 12288
  buffer_load_dwordx4 a[48:51], v178, s[8:11], s29 offen
  buffer_load_dwordx4 a[52:55], v178, s[8:11], s29 offen offset:1024
  s_add_u32 s29, s28, 14336
  buffer_load_dwordx4 a[56:59], v178, s[8:11], s29 offen
  buffer_load_dwordx4 a[60:63], v178, s[8:11], s29 offen offset:1024
  s_add_u32 s29, s28, 16384
  buffer_load_dwordx4 a[64:67], v178, s[8:11], s29 offen
  buffer_load_dwordx4 a[68:71], v178, s[8:11], s29 offen offset:1024
  s_add_u32 s29, s28, 18432
  buffer_load_dwordx4 a[72:75], v178, s[8:11], s29 offen
  buffer_load_dwordx4 a[76:79], v178, s[8:11], s29 offen offset:1024
  s_add_u32 s29, s28, 819200
  buffer_load_dwordx4 a[80:83], v178, s[8:11], s29 offen
  buffer_load_dwordx4 a[84:87], v178, s[8:11], s29 offen offset:1024
  s_add_u32 s29, s28, 821248
  buffer_load_dwordx4 a[88:91], v178, s[8:11], s29 offen
  buffer_load_dwordx4 a[92:95], v178, s[8:11], s29 offen offset:1024
  s_add_u32 s29, s28, 823296
  buffer_load_dwordx4 a[96:99], v178, s[8:11], s29 offen
  buffer_load_dwordx4 a[100:103], v178, s[8:11], s29 offen offset:1024
  s_add_u32 s29, s28, 825344
  buffer_load_dwordx4 a[104:107], v178, s[8:11], s29 offen
  buffer_load_dwordx4 a[108:111], v178, s[8:11], s29 offen offset:1024
  s_add_u32 s29, s28, 827392
  buffer_load_dwordx4 a[112:115], v178, s[8:11], s29 offen
  buffer_load_dwordx4 a[116:119], v178, s[8:11], s29 offen offset:1024
  s_add_u32 s29, s28, 829440
  buffer_load_dwordx4 a[120:123], v178, s[8:11], s29 offen
  buffer_load_dwordx4 a[124:127], v178, s[8:11], s29 offen offset:1024
  s_add_u32 s29, s28, 831488
  buffer_load_dwordx4 a[128:131], v178, s[8:11], s29 offen
  buffer_load_dwordx4 a[132:135], v178, s[8:11], s29 offen offset:1024
  s_add_u32 s29, s28, 833536
  buffer_load_dwordx4 a[136:139], v178, s[8:11], s29 offen
  buffer_load_dwordx4 a[140:143], v178, s[8:11], s29 offen offset:1024
  s_add_u32 s29, s28, 835584
  buffer_load_dwordx4 a[144:147], v178, s[8:11], s29 offen
  buffer_load_dwordx4 a[148:151], v178, s[8:11], s29 offen offset:1024
  s_add_u32 s29, s28, 837632
  buffer_load_dwordx4 a[152:155], v178, s[8:11], s29 offen
  buffer_load_dwordx4 a[156:159], v178, s[8:11], s29 offen offset:1024
  s_waitcnt vmcnt(30)
  s_cmp_eq_u32 s21, 3
  s_cbranch_scc0 lna_90_\sfx\()
  s_mov_b64 s[24:25], exec
  s_mov_b64 exec, 1
  v_mov_b32 v2, 4992
  v_mov_b32 v3, 1
  buffer_atomic_add v3, v2, s[8:11], 0 offen
  s_mov_b64 exec, s[24:25]
lna_90_\sfx\():
  s_add_u32 s29, s28, 1638400
  buffer_load_dwordx4 a[160:163], v178, s[8:11], s29 offen
  buffer_load_dwordx4 a[164:167], v178, s[8:11], s29 offen offset:1024
  s_add_u32 s29, s28, 1640448
  buffer_load_dwordx4 a[168:171], v178, s[8:11], s29 offen
  buffer_load_dwordx4 a[172:175], v178, s[8:11], s29 offen offset:1024
  s_add_u32 s29, s28, 1642496
  buffer_load_dwordx4 a[176:179], v178, s[8:11], s29 offen
  buffer_load_dwordx4 a[180:183], v178, s[8:11], s29 offen offset:1024
  s_add_u32 s29, s28, 1644544
  buffer_load_dwordx4 a[184:187], v178, s[8:11], s29 offen
  buffer_load_dwordx4 a[188:191], v178, s[8:11], s29 offen offset:1024
  s_add_u32 s29, s28, 1646592
  buffer_load_dwordx4 a[192:195], v178, s[8:11], s29 offen
  buffer_load_dwordx4 a[196:199], v178, s[8:11], s29 offen offset:1024
  s_add_u32 s29, s28, 1648640
  buffer_load_dwordx4 a[200:203], v178, s[8:11], s29 offen
  buffer_load_dwordx4 a[204:207], v178, s[8:11], s29 offen offset:1024
  s_add_u32 s29, s28, 1650688
  buffer_load_dwordx4 a[208:211], v178, s[8:11], s29 offen
  buffer_load_dwordx4 a[212:215], v178, s[8:11], s29 offen offset:1024
  s_add_u32 s29, s28, 1652736
  buffer_load_dwordx4 a[216:219], v178, s[8:11], s29 offen
  buffer_load_dwordx4 a[220:223], v178, s[8:11], s29 offen offset:1024
  s_add_u32 s29, s28, 1654784
  buffer_load_dwordx4 a[224:227], v178, s[8:11], s29 offen
  buffer_load_dwordx4 a[228:231], v178, s[8:11], s29 offen offset:1024
  s_add_u32 s29, s28, 1656832
  buffer_load_dwordx4 a[232:235], v178, s[8:11], s29 offen
  buffer_load_dwordx4 a[236:239], v178, s[8:11], s29 offen offset:1024
  s_waitcnt vmcnt(30)
  s_add_u32 s29, s28, 2457600
  buffer_load_dwordx4 a[240:243], v178, s[8:11], s29 offen
  buffer_load_dwordx4 a[244:247], v178, s[8:11], s29 offen offset:1024
  s_add_u32 s29, s28, 2459648
  buffer_load_dwordx4 a[248:251], v178, s[8:11], s29 offen
  buffer_load_dwordx4 a[252:255], v178, s[8:11], s29 offen offset:1024
  s_add_u32 s29, s28, 2461696
  buffer_load_dwordx4 v[192:195], v178, s[8:11], s29 offen
  buffer_load_dwordx4 v[196:199], v178, s[8:11], s29 offen offset:1024
  s_add_u32 s29, s28, 2463744
  buffer_load_dwordx4 v[200:203], v178, s[8:11], s29 offen
  buffer_load_dwordx4 v[204:207], v178, s[8:11], s29 offen offset:1024
  s_add_u32 s29, s28, 2465792
  buffer_load_dwordx4 v[208:211], v178, s[8:11], s29 offen
  buffer_load_dwordx4 v[212:215], v178, s[8:11], s29 offen offset:1024
  s_add_u32 s29, s28, 2467840
  buffer_load_dwordx4 v[216:219], v178, s[8:11], s29 offen
  buffer_load_dwordx4 v[220:223], v178, s[8:11], s29 offen offset:1024
  s_add_u32 s29, s28, 2469888
  buffer_load_dwordx4 v[224:227], v178, s[8:11], s29 offen
  buffer_load_dwordx4 v[228:231], v178, s[8:11], s29 offen offset:1024
  s_add_u32 s29, s28, 2471936
  buffer_load_dwordx4 v[232:235], v178, s[8:11], s29 offen
  buffer_load_dwordx4 v[236:239], v178, s[8:11], s29 offen offset:1024
  s_add_u32 s29, s28, 2473984
  buffer_load_dwordx4 v[240:243], v178, s[8:11], s29 offen
  buffer_load_dwordx4 v[244:247], v178, s[8:11], s29 offen offset:1024
  s_add_u32 s29, s28, 2476032
  buffer_load_dwordx4 v[248:251], v178, s[8:11], s29 offen
  buffer_load_dwordx4 v[252:255], v178, s[8:11], s29 offen offset:1024
  s_waitcnt vmcnt(30)
  v_mov_b32 v172, 0x44444444
  v_mov_b32 v2, 0xeeeeeeee
  v_and_b32 v3, 8, v1
  v_cmp_ne_u32 vcc, 0, v3
  s_nop 1
  v_cndmask_b32 v172, v172, v2, vcc
  s_lshl_b32 s28, s21, 10
  v_add_u32 v173, s28, v178
  v_add_u32 v174, 4096, v173
  v_add_u32 v175, 8192, v173
  v_add_u32 v176, 0, v173
  v_add_u32 v177, 0, v178
  v_add_u32 v179, 10240, v173
  s_xor_b32 s28, s21, 2
  s_lshl_b32 s28, s28, 10
  s_add_u32 s28, s28, 10240
  v_add_u32 v180, s28, v178
  v_and_b32 v4, 15, v1
  v_lshrrev_b32 v5, 4, v1
  v_and_b32 v6, 7, v1
  v_lshlrev_b32 v7, 3, v5
  v_add_u32 v7, v7, v6
  v_lshlrev_b32 v185, 4, v7
  v_add_u32 v182, 4096, v178
  v_mov_b32 v8, 0x40000000
  v_cmp_gt_u32 vcc, 8, v4
  s_nop 1
  v_cndmask_b32 v184, v8, v185, vcc
  v_lshlrev_b32 v7, 4, v4
  v_lshlrev_b32 v9, 2, v5
  v_add_u32 v7, v7, v9
  v_cndmask_b32 v186, v8, v7, vcc
  s_lshl_b32 s28, s20, 5
  s_add_u32 s28, s28, 3072
  v_lshlrev_b32 v7, 2, v6
  v_add_u32 v187, s28, v7
  v_and_b32 v7, 1, v5
  v_lshlrev_b32 v7, 3, v7
  v_lshrrev_b32 v9, 1, v5
  v_lshlrev_b32 v9, 5, v9
  v_add_u32 v9, v9, v4
  v_lshlrev_b32 v9, 4, v9
  v_add_u32 v189, v7, v9
  v_mov_b32 v44, 0
  v_mov_b32 v45, 0
  v_mov_b32 v46, 0
  v_mov_b32 v47, 0
  v_mov_b32 v48, 0
  v_mov_b32 v49, 0
  v_mov_b32 v50, 0
  v_mov_b32 v51, 0
  v_mov_b32 v52, 0
  v_mov_b32 v53, 0
  v_mov_b32 v54, 0
  v_mov_b32 v55, 0
  v_mov_b32 v56, 0
  v_mov_b32 v57, 0
  v_mov_b32 v58, 0
  v_mov_b32 v59, 0
  s_mul_i32 s97, s20, 655360
  s_add_u32 s97, s97, 0x400000
  s_mov_b32 s48, 0x4000
  s_mul_i32 s49, s20, 327680
  s_add_u32 s49, s49, 0x700000
  s_and_b32 s28, s21, 1
  s_mul_i32 s28, s28, 0
  s_add_u32 s49, s49, s28
  s_mul_i32 s50, s20, 327680
  s_lshl_b32 s28, s46, 10
  s_add_u32 s50, s50, s28
  s_add_u32 s50, s50, 0x9000000
  s_mov_b32 s51, 0
  s_mov_b32 s52, 0
  s_mov_b32 s53, 0
  s_mov_b32 s61, 0
  s_add_u32 s29, s20, 0
  s_and_b32 s29, s29, 3
  s_mul_i32 s29, s29, 20
  s_add_u32 s29, s29, s23
  s_lshr_b32 s28, s29, 3
  s_lshl_b32 s28, s28, 14
  s_and_b32 s29, s29, 7
  s_lshl_b32 s29, s29, 10
  s_add_u32 s28, s28, s29
  s_and_b32 s29, s21, 1
  s_lshl_b32 s29, s29, 9
  s_add_u32 s28, s28, s29
  s_add_u32 s28, s28, s61
  s_add_u32 s56, s28, 0xa00000
  s_mov_b32 s66, s56
  s_add_u32 s29, s20, 1
  s_and_b32 s29, s29, 3
  s_mul_i32 s29, s29, 20
  s_add_u32 s29, s29, s23
  s_lshr_b32 s28, s29, 3
  s_lshl_b32 s28, s28, 14
  s_and_b32 s29, s29, 7
  s_lshl_b32 s29, s29, 10
  s_add_u32 s28, s28, s29
  s_and_b32 s29, s21, 1
  s_lshl_b32 s29, s29, 9
  s_add_u32 s28, s28, s29
  s_add_u32 s28, s28, s61
  s_add_u32 s57, s28, 0xa00000
  s_mov_b32 s67, s57
  s_add_u32 s29, s20, 2
  s_and_b32 s29, s29, 3
  s_mul_i32 s29, s29, 20
  s_add_u32 s29, s29, s23
  s_lshr_b32 s28, s29, 3
  s_lshl_b32 s28, s28, 14
  s_and_b32 s29, s29, 7
  s_lshl_b32 s29, s29, 10
  s_add_u32 s28, s28, s29
  s_and_b32 s29, s21, 1
  s_lshl_b32 s29, s29, 9
  s_add_u32 s28, s28, s29
  s_add_u32 s28, s28, s61
  s_add_u32 s58, s28, 0xa00000
  s_mov_b32 s68, s58
  s_add_u32 s29, s20, 3
  s_and_b32 s29, s29, 3
  s_mul_i32 s29, s29, 20
  s_add_u32 s29, s29, s23
  s_lshr_b32 s28, s29, 3
  s_lshl_b32 s28, s28, 14
  s_and_b32 s29, s29, 7
  s_lshl_b32 s29, s29, 10
  s_add_u32 s28, s28, s29
  s_and_b32 s29, s21, 1
  s_lshl_b32 s29, s29, 9
  s_add_u32 s28, s28, s29
  s_add_u32 s28, s28, s61
  s_add_u32 s59, s28, 0xa00000
  s_mov_b32 s69, s59
  v_mov_b32 v124, -1
  v_mov_b32 v125, -1
  v_mov_b32 v126, -1
  v_mov_b32 v127, -1
  s_lshr_b32 s28, s46, 2
  s_lshl_b32 s28, s28, 10
  s_and_b32 s29, s46, 3
  s_lshl_b32 s29, s29, 8
  s_add_u32 s28, s28, s29
  s_add_u32 s60, s28, s97
  s_add_u32 s60, s60, 10240
  s_and_b32 s28, s21, 1
  s_lshl_b32 s28, s28, 10
  s_add_u32 s28, s28, 32768
  v_add_u32 v181, s28, v178
  v_add_u32 v183, 65536, v178
  s_waitcnt vmcnt(0)
  s_cmp_ge_u32 s21, 2
  s_cbranch_scc1 ka\sfx\()_y_tok
ka\sfx\()_y_crit:
  s_add_u32 s98, s48, 4096
  s_add_u32 s100, s48, 8192
  s_mov_b32 s45, 0
ka\sfx\()_y_pf_91:
  buffer_load_dwordx4 v[160:163], v173, s[8:11], s48 offen sc1
  buffer_load_dwordx4 v[164:167], v173, s[8:11], s48 offen offset:2048 sc1
  buffer_load_dwordx4 v[168:171], v173, s[8:11], s98 offen sc1
  buffer_load_dwordx4 v[68:71], v173, s[8:11], s98 offen offset:2048 sc1
  buffer_load_dwordx4 v[72:75], v173, s[8:11], s100 offen sc1
  s_add_u32 s45, s45, 1
  s_waitcnt vmcnt(4)
  ds_write_b128 v176, v[160:163] offset:0
  v_max3_u32 v190, v160, v161, v162
  v_max_u32 v190, v190, v163
  s_waitcnt vmcnt(3)
  ds_write_b128 v176, v[164:167] offset:2048
  v_max3_u32 v190, v190, v164, v165
  v_max3_u32 v190, v190, v166, v167
  s_waitcnt vmcnt(2)
  ds_write_b128 v176, v[168:171] offset:4096
  v_max3_u32 v190, v190, v168, v169
  v_max3_u32 v190, v190, v170, v171
  s_waitcnt vmcnt(1)
  ds_write_b128 v176, v[68:71] offset:6144
  v_max3_u32 v190, v190, v68, v69
  v_max3_u32 v190, v190, v70, v71
  s_waitcnt vmcnt(0)
  ds_write_b128 v176, v[72:75] offset:8192
  v_max3_u32 v190, v190, v72, v73
  v_max3_u32 v190, v190, v74, v75
  v_cmp_eq_u32 vcc, -1, v190
  s_cbranch_vccz ka\sfx\()_y_pf_91_ok
  s_cmp_lt_u32 s45, 400000
  s_cbranch_scc1 ka\sfx\()_y_pf_91
  s_branch ka\sfx\()_abort
ka\sfx\()_y_pf_91_ok:
  s_waitcnt lgkmcnt(0)
  s_barrier
  ds_read_b128 v[4:7], v177 offset:0
  ds_read_b128 v[8:11], v177 offset:1024
  ds_read_b128 v[12:15], v177 offset:2048
  ds_read_b128 v[16:19], v177 offset:3072
  ds_read_b128 v[20:23], v177 offset:4096
  ds_read_b128 v[24:27], v177 offset:5120
  ds_read_b128 v[28:31], v177 offset:6144
  ds_read_b128 v[32:35], v177 offset:7168
  ds_read_b128 v[36:39], v177 offset:8192
  ds_read_b128 v[40:43], v177 offset:9216
  s_cmp_eq_u32 s51, 7
  s_cbranch_scc0 ka\sfx\()_y_nosel
  v_mov_b32 v2, 5056
  s_mov_b32 s45, 0
ka\sfx\()_y_sel:
  buffer_load_dword v3, v2, s[8:11], 0 offen sc1
  s_add_u32 s45, s45, 1
  s_waitcnt vmcnt(0)
  v_readfirstlane_b32 s61, v3
  s_cmp_lg_u32 s61, 0
  s_cbranch_scc1 ka\sfx\()_y_selok
  s_cmp_lt_u32 s45, 400000
  s_cbranch_scc1 ka\sfx\()_y_sel
  s_branch ka\sfx\()_abort
ka\sfx\()_y_selok:
  s_and_b32 s61, s61, 2
  s_lshl_b32 s61, s61, 12
ka\sfx\()_y_nosel:
  s_cmp_lt_u32 s51, 2
  s_cbranch_scc1 ka\sfx\()_y_norst
  s_sub_u32 s28, s51, 2
  s_and_b32 s28, s28, 3
  s_mul_i32 s28, s28, 163840
  s_add_u32 s28, s28, s56
  v_mov_b32 v160, -1
  v_mov_b32 v161, -1
  v_mov_b32 v162, -1
  v_mov_b32 v163, -1
  buffer_store_dwordx4 v[160:163], v184, s[8:11], s28 offen sc1
ka\sfx\()_y_norst:
  s_waitcnt lgkmcnt(9)
  v_smfmac_f32_16x16x64_bf16 v[44:47], v[4:7], a[0:7], v172
  v_smfmac_f32_16x16x64_bf16 v[48:51], v[4:7], a[80:87], v172
  v_smfmac_f32_16x16x64_bf16 v[52:55], v[4:7], a[160:167], v172
  v_smfmac_f32_16x16x64_bf16 v[56:59], v[4:7], a[240:247], v172
  s_waitcnt lgkmcnt(8)
  v_smfmac_f32_16x16x64_bf16 v[44:47], v[8:11], a[8:15], v172
  v_smfmac_f32_16x16x64_bf16 v[48:51], v[8:11], a[88:95], v172
  v_smfmac_f32_16x16x64_bf16 v[52:55], v[8:11], a[168:175], v172
  v_smfmac_f32_16x16x64_bf16 v[56:59], v[8:11], a[248:255], v172
  s_waitcnt lgkmcnt(7)
  v_smfmac_f32_16x16x64_bf16 v[44:47], v[12:15], a[16:23], v172
  v_smfmac_f32_16x16x64_bf16 v[48:51], v[12:15], a[96:103], v172
  v_smfmac_f32_16x16x64_bf16 v[52:55], v[12:15], a[176:183], v172
  v_smfmac_f32_16x16x64_bf16 v[56:59], v[12:15], v[192:199], v172
  s_waitcnt lgkmcnt(6)
  v_smfmac_f32_16x16x64_bf16 v[44:47], v[16:19], a[24:31], v172
  v_smfmac_f32_16x16x64_bf16 v[48:51], v[16:19], a[104:111], v172
  v_smfmac_f32_16x16x64_bf16 v[52:55], v[16:19], a[184:191], v172
  v_smfmac_f32_16x16x64_bf16 v[56:59], v[16:19], v[200:207], v172
  s_waitcnt lgkmcnt(5)
  v_smfmac_f32_16x16x64_bf16 v[44:47], v[20:23], a[32:39], v172
  v_smfmac_f32_16x16x64_bf16 v[48:51], v[20:23], a[112:119], v172
  v_smfmac_f32_16x16x64_bf16 v[52:55], v[20:23], a[192:199], v172
  v_smfmac_f32_16x16x64_bf16 v[56:59], v[20:23], v[208:215], v172
  s_waitcnt lgkmcnt(4)
  v_smfmac_f32_16x16x64_bf16 v[44:47], v[24:27], a[40:47], v172
  v_smfmac_f32_16x16x64_bf16 v[48:51], v[24:27], a[120:127], v172
  v_smfmac_f32_16x16x64_bf16 v[52:55], v[24:27], a[200:207], v172
  v_smfmac_f32_16x16x64_bf16 v[56:59], v[24:27], v[216:223], v172
  s_waitcnt lgkmcnt(3)
  v_smfmac_f32_16x16x64_bf16 v[44:47], v[28:31], a[48:55], v172
  v_smfmac_f32_16x16x64_bf16 v[48:51], v[28:31], a[128:135], v172
  v_smfmac_f32_16x16x64_bf16 v[52:55], v[28:31], a[208:215], v172
  v_smfmac_f32_16x16x64_bf16 v[56:59], v[28:31], v[224:231], v172
  s_waitcnt lgkmcnt(2)
  v_smfmac_f32_16x16x64_bf16 v[44:47], v[32:35], a[56:63], v172
  v_smfmac_f32_16x16x64_bf16 v[48:51], v[32:35], a[136:143], v172
  v_smfmac_f32_16x16x64_bf16 v[52:55], v[32:35], a[216:223], v172
  v_smfmac_f32_16x16x64_bf16 v[56:59], v[32:35], v[232:239], v172
  s_waitcnt lgkmcnt(1)
  v_smfmac_f32_16x16x64_bf16 v[44:47], v[36:39], a[64:71], v172
  v_smfmac_f32_16x16x64_bf16 v[48:51], v[36:39], a[144:151], v172
  v_smfmac_f32_16x16x64_bf16 v[52:55], v[36:39], a[224:231], v172
  v_smfmac_f32_16x16x64_bf16 v[56:59], v[36:39], v[240:247], v172
  s_waitcnt lgkmcnt(0)
  v_smfmac_f32_16x16x64_bf16 v[44:47], v[40:43], a[72:79], v172
  v_smfmac_f32_16x16x64_bf16 v[48:51], v[40:43], a[152:159], v172
  v_smfmac_f32_16x16x64_bf16 v[52:55], v[40:43], a[232:239], v172
  v_smfmac_f32_16x16x64_bf16 v[56:59], v[40:43], v[248:255], v172
  s_nop 9
  v_permlane32_swap_b32 v44, v48
  v_permlane32_swap_b32 v45, v49
  v_permlane32_swap_b32 v46, v50
  v_permlane32_swap_b32 v47, v51
  v_permlane32_swap_b32 v52, v56
  v_permlane32_swap_b32 v53, v57
  v_permlane32_swap_b32 v54, v58
  v_permlane32_swap_b32 v55, v59
  v_add_f32 v44, v44, v48
  v_add_f32 v45, v45, v49
  v_add_f32 v46, v46, v50
  v_add_f32 v47, v47, v51
  v_add_f32 v52, v52, v56
  v_add_f32 v53, v53, v57
  v_add_f32 v54, v54, v58
  v_add_f32 v55, v55, v59
  v_cvt_pk_bf16_f32 v60, v44, v45
  v_cvt_pk_bf16_f32 v61, v46, v47
  v_cvt_pk_bf16_f32 v62, v52, v53
  v_cvt_pk_bf16_f32 v63, v54, v55
  ds_write_b128 v179, v[60:63]
  v_mov_b32 v44, 0
  v_mov_b32 v45, 0
  v_mov_b32 v46, 0
  v_mov_b32 v47, 0
  v_mov_b32 v48, 0
  v_mov_b32 v49, 0
  v_mov_b32 v50, 0
  v_mov_b32 v51, 0
  v_mov_b32 v52, 0
  v_mov_b32 v53, 0
  v_mov_b32 v54, 0
  v_mov_b32 v55, 0
  v_mov_b32 v56, 0
  v_mov_b32 v57, 0
  v_mov_b32 v58, 0
  v_mov_b32 v59, 0
  s_waitcnt lgkmcnt(0)
  s_barrier
  s_cmp_ge_u32 s51, 63
  s_cbranch_scc1 ka\sfx\()_y_crit_end
  ds_read_b128 v[64:67], v180
  ds_read_b128 v[68:71], v181 offset:0
  ds_read_b128 v[72:75], v181 offset:2048
  ds_read_b128 v[76:79], v181 offset:4096
  ds_read_b128 v[80:83], v181 offset:6144
  ds_read_b128 v[84:87], v181 offset:8192
  ds_read_b128 v[88:91], v181 offset:10240
  ds_read_b128 v[92:95], v181 offset:12288
  ds_read_b128 v[96:99], v181 offset:14336
  v_xor_b32 v181, 0x4000, v181
  s_mov_b32 s45, 0
  buffer_load_dwordx4 v[100:103], v178, s[8:11], s49 offen offset:0 sc1
  buffer_load_dwordx4 v[104:107], v178, s[8:11], s49 offen offset:1024 sc1
  buffer_load_dwordx4 v[108:111], v178, s[8:11], s49 offen offset:2048 sc1
  buffer_load_dwordx4 v[112:115], v178, s[8:11], s49 offen offset:3072 sc1
  buffer_load_dwordx4 v[116:119], v182, s[8:11], s49 offen sc1
yp_92_\sfx\():
  buffer_load_dwordx4 v[120:123], v178, s[8:11], s49 offen offset:0 sc1
  buffer_load_dwordx4 v[124:127], v178, s[8:11], s49 offen offset:1024 sc1
  buffer_load_dwordx4 v[128:131], v178, s[8:11], s49 offen offset:2048 sc1
  buffer_load_dwordx4 v[132:135], v178, s[8:11], s49 offen offset:3072 sc1
  buffer_load_dwordx4 v[136:139], v182, s[8:11], s49 offen sc1
  s_waitcnt vmcnt(9) lgkmcnt(0)
  v_mfma_f32_16x16x32_bf16 v[140:143], v[68:71], v[100:103], 0
  v_max_u32 v190, v100, v102
  v_mfma_f32_16x16x32_bf16 v[144:147], v[72:75], v[100:103], 0
  s_waitcnt vmcnt(8)
  v_mfma_f32_16x16x32_bf16 v[140:143], v[76:79], v[104:107], v[140:143]
  v_max3_u32 v190, v190, v104, v106
  v_mfma_f32_16x16x32_bf16 v[144:147], v[80:83], v[104:107], v[144:147]
  s_waitcnt vmcnt(7)
  v_mfma_f32_16x16x32_bf16 v[140:143], v[84:87], v[108:111], v[140:143]
  v_max3_u32 v190, v190, v108, v110
  v_mfma_f32_16x16x32_bf16 v[144:147], v[88:91], v[108:111], v[144:147]
  s_waitcnt vmcnt(6)
  v_mfma_f32_16x16x32_bf16 v[140:143], v[92:95], v[112:115], v[140:143]
  v_max3_u32 v190, v190, v112, v114
  v_mfma_f32_16x16x32_bf16 v[144:147], v[96:99], v[112:115], v[144:147]
  s_waitcnt vmcnt(5)
  v_mfma_f32_16x16x32_bf16 v[140:143], v[60:63], v[116:119], v[140:143]
  v_max3_u32 v190, v190, v116, v117
  v_mfma_f32_16x16x32_bf16 v[144:147], v[64:67], v[116:119], v[144:147]
  v_max3_u32 v190, v190, v118, v119
  v_cmp_eq_u32 vcc, -1, v190
  s_cbranch_vccz yp_92_okA_\sfx\()
  buffer_load_dwordx4 v[100:103], v178, s[8:11], s49 offen offset:0 sc1
  buffer_load_dwordx4 v[104:107], v178, s[8:11], s49 offen offset:1024 sc1
  buffer_load_dwordx4 v[108:111], v178, s[8:11], s49 offen offset:2048 sc1
  buffer_load_dwordx4 v[112:115], v178, s[8:11], s49 offen offset:3072 sc1
  buffer_load_dwordx4 v[116:119], v182, s[8:11], s49 offen sc1
  s_waitcnt vmcnt(9) lgkmcnt(0)
  v_mfma_f32_16x16x32_bf16 v[148:151], v[68:71], v[120:123], 0
  v_max_u32 v190, v120, v122
  v_mfma_f32_16x16x32_bf16 v[152:155], v[72:75], v[120:123], 0
  s_waitcnt vmcnt(8)
  v_mfma_f32_16x16x32_bf16 v[148:151], v[76:79], v[124:127], v[148:151]
  v_max3_u32 v190, v190, v124, v126
  v_mfma_f32_16x16x32_bf16 v[152:155], v[80:83], v[124:127], v[152:155]
  s_waitcnt vmcnt(7)
  v_mfma_f32_16x16x32_bf16 v[148:151], v[84:87], v[128:131], v[148:151]
  v_max3_u32 v190, v190, v128, v130
  v_mfma_f32_16x16x32_bf16 v[152:155], v[88:91], v[128:131], v[152:155]
  s_waitcnt vmcnt(6)
  v_mfma_f32_16x16x32_bf16 v[148:151], v[92:95], v[132:135], v[148:151]
  v_max3_u32 v190, v190, v132, v134
  v_mfma_f32_16x16x32_bf16 v[152:155], v[96:99], v[132:135], v[152:155]
  s_waitcnt vmcnt(5)
  v_mfma_f32_16x16x32_bf16 v[148:151], v[60:63], v[136:139], v[148:151]
  v_max3_u32 v190, v190, v136, v137
  v_mfma_f32_16x16x32_bf16 v[152:155], v[64:67], v[136:139], v[152:155]
  v_max3_u32 v190, v190, v138, v139
  v_cmp_eq_u32 vcc, -1, v190
  s_cbranch_vccz yp_92_okB_\sfx\()
  s_add_u32 s45, s45, 1
  s_cmp_lt_u32 s45, 400000
  s_cbranch_scc1 yp_92_c_\sfx\()
  s_branch ka\sfx\()_abort
yp_92_c_\sfx\():
  s_branch yp_92_\sfx\()
yp_92_okB_\sfx\():
  s_nop 4
  v_add_f32_dpp v140, v152, v148 row_ror:8 row_mask:0xf bank_mask:0xf
  v_add_f32_dpp v141, v153, v149 row_ror:8 row_mask:0xf bank_mask:0xf
  v_add_f32_dpp v142, v154, v150 row_ror:8 row_mask:0xf bank_mask:0xf
  v_add_f32_dpp v143, v155, v151 row_ror:8 row_mask:0xf bank_mask:0xf
  s_branch yp_92_j_\sfx\()
yp_92_okA_\sfx\():
  s_nop 4
  v_add_f32_dpp v140, v144, v140 row_ror:8 row_mask:0xf bank_mask:0xf
  v_add_f32_dpp v141, v145, v141 row_ror:8 row_mask:0xf bank_mask:0xf
  v_add_f32_dpp v142, v146, v142 row_ror:8 row_mask:0xf bank_mask:0xf
  v_add_f32_dpp v143, v147, v143 row_ror:8 row_mask:0xf bank_mask:0xf
yp_92_j_\sfx\():
  buffer_load_dwordx4 v[4:7], v185, s[8:11], s67 offen sc1
  buffer_load_dwordx4 v[8:11], v185, s[8:11], s68 offen sc1
  buffer_load_dwordx4 v[12:15], v185, s[8:11], s69 offen sc1
  buffer_store_dwordx4 v[140:143], v184, s[8:11], s66 offen sc1
  s_mov_b32 s45, 0
  buffer_load_dwordx4 v[148:151], v185, s[8:11], s67 offen sc1
  buffer_load_dwordx4 v[152:155], v185, s[8:11], s68 offen sc1
  buffer_load_dwordx4 v[156:159], v185, s[8:11], s69 offen sc1
  s_waitcnt vmcnt(4)
  v_max3_u32 v190, v4, v7, v8
  v_max3_u32 v190, v190, v11, v12
  v_max_u32 v190, v190, v15
  v_add_f32 v160, v140, v4
  v_add_f32 v161, v141, v5
  v_add_f32 v162, v142, v6
  v_add_f32 v163, v143, v7
  v_cmp_eq_u32 vcc, -1, v190
  v_add_f32 v164, v8, v12
  v_add_f32 v165, v9, v13
  v_add_f32 v166, v10, v14
  v_add_f32 v167, v11, v15
  s_cbranch_vccz yc_93_ok_\sfx\()
yc_93_\sfx\():
  buffer_load_dwordx4 v[4:7], v185, s[8:11], s67 offen sc1
  buffer_load_dwordx4 v[8:11], v185, s[8:11], s68 offen sc1
  buffer_load_dwordx4 v[12:15], v185, s[8:11], s69 offen sc1
  s_waitcnt vmcnt(3)
  v_max3_u32 v190, v148, v151, v152
  v_max3_u32 v190, v190, v155, v156
  v_max_u32 v190, v190, v159
  v_add_f32 v160, v140, v148
  v_add_f32 v161, v141, v149
  v_add_f32 v162, v142, v150
  v_add_f32 v163, v143, v151
  v_cmp_eq_u32 vcc, -1, v190
  v_add_f32 v164, v152, v156
  v_add_f32 v165, v153, v157
  v_add_f32 v166, v154, v158
  v_add_f32 v167, v155, v159
  s_cbranch_vccz yc_93_ok_\sfx\()
  buffer_load_dwordx4 v[148:151], v185, s[8:11], s67 offen sc1
  buffer_load_dwordx4 v[152:155], v185, s[8:11], s68 offen sc1
  buffer_load_dwordx4 v[156:159], v185, s[8:11], s69 offen sc1
  s_waitcnt vmcnt(3)
  v_max3_u32 v190, v4, v7, v8
  v_max3_u32 v190, v190, v11, v12
  v_max_u32 v190, v190, v15
  v_add_f32 v160, v140, v4
  v_add_f32 v161, v141, v5
  v_add_f32 v162, v142, v6
  v_add_f32 v163, v143, v7
  v_cmp_eq_u32 vcc, -1, v190
  v_add_f32 v164, v8, v12
  v_add_f32 v165, v9, v13
  v_add_f32 v166, v10, v14
  v_add_f32 v167, v11, v15
  s_cbranch_vccz yc_93_ok_\sfx\()
  s_add_u32 s45, s45, 1
  s_cmp_lt_u32 s45, 400000
  s_cbranch_scc1 yc_93_\sfx\()
  s_branch ka\sfx\()_abort
yc_93_ok_\sfx\():
  v_add_f32 v160, v160, v164
  v_add_f32 v161, v161, v165
  v_add_f32 v162, v162, v166
  v_add_f32 v163, v163, v167
  v_cvt_pk_bf16_f32 v168, v160, v161
  v_cvt_pk_bf16_f32 v169, v162, v163
  buffer_store_dword v168, v186, s[8:11], s60 offen \pol
  buffer_store_dword v169, v186, s[8:11], s60 offen offset:128 \pol
  s_add_u32 s97, s97, 10240
  s_mov_b32 s48, s97
  s_add_u32 s60, s60, 10240
  s_add_u32 s49, s49, 5120
  s_add_u32 s56, s56, s61
  s_add_u32 s57, s57, s61
  s_add_u32 s58, s58, s61
  s_add_u32 s59, s59, s61
  s_mov_b32 s61, 0
  s_add_u32 s28, s51, 1
  s_and_b32 s28, s28, 3
  s_mul_i32 s28, s28, 163840
  s_add_u32 s66, s56, s28
  s_add_u32 s67, s57, s28
  s_add_u32 s68, s58, s28
  s_add_u32 s69, s59, s28
  s_add_u32 s51, s51, 1
  s_branch ka\sfx\()_y_crit
ka\sfx\()_y_crit_end:
  s_waitcnt vmcnt(0) lgkmcnt(0)
  s_branch ka\sfx\()_exit
ka\sfx\()_y_tok:
  s_mul_i32 s61, s20, 1310720
  s_add_u32 s61, s61, 0xe00000
  s_mul_i32 s62, s20, 2621440
  s_lshl_b32 s28, s46, 10
  s_add_u32 s62, s62, s28
  s_add_u32 s62, s62, 0x1a00000
  s_mov_b32 s54, 0
  s_and_b32 s63, s21, 1
  s_lshl_b32 s63, s63, 10
  s_add_u32 s63, s63, 32768
  s_and_b32 s64, s21, 1
  s_mul_i32 s64, s64, 10240
ka\sfx\()_y_tokl:
  s_barrier
  ds_read_b128 v[4:7], v177 offset:0
  ds_read_b128 v[8:11], v177 offset:1024
  ds_read_b128 v[12:15], v177 offset:2048
  ds_read_b128 v[16:19], v177 offset:3072
  ds_read_b128 v[20:23], v177 offset:4096
  ds_read_b128 v[24:27], v177 offset:5120
  ds_read_b128 v[28:31], v177 offset:6144
  ds_read_b128 v[32:35], v177 offset:7168
  ds_read_b128 v[36:39], v177 offset:8192
  ds_read_b128 v[40:43], v177 offset:9216
  s_cmp_gt_u32 s52, s51
  s_cbranch_scc1 ka\sfx\()_y_wp_94_ok
  s_mov_b32 s45, 0
ka\sfx\()_y_wp_94_spin:
  buffer_load_dword v2, v187, s[8:11], 0 offen sc1
  s_add_u32 s45, s45, 1
  s_waitcnt vmcnt(0)
  v_min_u32_dpp v3, v2, v2 quad_perm:[1,0,3,2] row_mask:0xf bank_mask:0xf
  s_nop 1
  v_min_u32_dpp v2, v3, v3 quad_perm:[2,3,0,1] row_mask:0xf bank_mask:0xf
  s_nop 1
  v_min_u32_dpp v3, v2, v2 row_half_mirror row_mask:0xf bank_mask:0xf
  s_nop 1
  v_min_u32_dpp v2, v3, v3 quad_perm:[0,1,2,3] row_mask:0xf bank_mask:0xf
  s_nop 0
  v_readfirstlane_b32 s52, v2
  s_cmp_gt_u32 s52, s51
  s_cbranch_scc1 ka\sfx\()_y_wp_94_ok
  s_cmp_lt_u32 s45, 400000
  s_cbranch_scc1 ka\sfx\()_y_wp_94_spin
  s_branch ka\sfx\()_abort
ka\sfx\()_y_wp_94_ok:
  s_add_u32 s65, s61, s64
  s_waitcnt lgkmcnt(9)
  v_smfmac_f32_16x16x64_bf16 v[44:47], v[4:7], a[0:7], v172
  s_add_u32 m0, s63, 0
  s_add_u32 s28, s50, 0
  buffer_load_dwordx4 v178, s[8:11], s28 offen sc1 lds
  v_smfmac_f32_16x16x64_bf16 v[48:51], v[4:7], a[80:87], v172
  v_smfmac_f32_16x16x64_bf16 v[52:55], v[4:7], a[160:167], v172
  s_add_u32 m0, s63, 2048
  s_add_u32 s28, s50, 40960
  buffer_load_dwordx4 v178, s[8:11], s28 offen sc1 lds
  v_smfmac_f32_16x16x64_bf16 v[56:59], v[4:7], a[240:247], v172
  s_waitcnt lgkmcnt(8)
  v_smfmac_f32_16x16x64_bf16 v[44:47], v[8:11], a[8:15], v172
  s_add_u32 m0, s63, 4096
  s_add_u32 s28, s50, 81920
  buffer_load_dwordx4 v178, s[8:11], s28 offen sc1 lds
  v_smfmac_f32_16x16x64_bf16 v[48:51], v[8:11], a[88:95], v172
  v_smfmac_f32_16x16x64_bf16 v[52:55], v[8:11], a[168:175], v172
  s_add_u32 m0, s63, 6144
  s_add_u32 s28, s50, 122880
  buffer_load_dwordx4 v178, s[8:11], s28 offen sc1 lds
  v_smfmac_f32_16x16x64_bf16 v[56:59], v[8:11], a[248:255], v172
  s_waitcnt lgkmcnt(7)
  v_smfmac_f32_16x16x64_bf16 v[44:47], v[12:15], a[16:23], v172
  s_add_u32 m0, s63, 8192
  s_add_u32 s28, s50, 163840
  buffer_load_dwordx4 v178, s[8:11], s28 offen sc1 lds
  v_smfmac_f32_16x16x64_bf16 v[48:51], v[12:15], a[96:103], v172
  v_smfmac_f32_16x16x64_bf16 v[52:55], v[12:15], a[176:183], v172
  s_add_u32 m0, s63, 10240
  s_add_u32 s28, s50, 204800
  buffer_load_dwordx4 v178, s[8:11], s28 offen sc1 lds
  v_smfmac_f32_16x16x64_bf16 v[56:59], v[12:15], v[192:199], v172
  s_waitcnt lgkmcnt(6)
  v_smfmac_f32_16x16x64_bf16 v[44:47], v[16:19], a[24:31], v172
  s_add_u32 m0, s63, 12288
  s_add_u32 s28, s50, 245760
  buffer_load_dwordx4 v178, s[8:11], s28 offen sc1 lds
  v_smfmac_f32_16x16x64_bf16 v[48:51], v[16:19], a[104:111], v172
  v_smfmac_f32_16x16x64_bf16 v[52:55], v[16:19], a[184:191], v172
  s_add_u32 m0, s63, 14336
  s_add_u32 s28, s50, 286720
  buffer_load_dwordx4 v178, s[8:11], s28 offen sc1 lds
  v_smfmac_f32_16x16x64_bf16 v[56:59], v[16:19], v[200:207], v172
  s_waitcnt lgkmcnt(5)
  v_smfmac_f32_16x16x64_bf16 v[44:47], v[20:23], a[32:39], v172
  s_add_u32 m0, s64, 65536
  s_add_u32 s28, s65, 0
  buffer_load_dwordx4 v178, s[8:11], s28 offen sc1 lds
  v_smfmac_f32_16x16x64_bf16 v[48:51], v[20:23], a[112:119], v172
  v_smfmac_f32_16x16x64_bf16 v[52:55], v[20:23], a[192:199], v172
  s_add_u32 m0, s64, 66560
  s_add_u32 s28, s65, 1024
  buffer_load_dwordx4 v178, s[8:11], s28 offen sc1 lds
  v_smfmac_f32_16x16x64_bf16 v[56:59], v[20:23], v[208:215], v172
  s_waitcnt lgkmcnt(4)
  v_smfmac_f32_16x16x64_bf16 v[44:47], v[24:27], a[40:47], v172
  s_add_u32 m0, s64, 67584
  s_add_u32 s28, s65, 2048
  buffer_load_dwordx4 v178, s[8:11], s28 offen sc1 lds
  v_smfmac_f32_16x16x64_bf16 v[48:51], v[24:27], a[120:127], v172
  v_smfmac_f32_16x16x64_bf16 v[52:55], v[24:27], a[200:207], v172
  s_add_u32 m0, s64, 68608
  s_add_u32 s28, s65, 3072
  buffer_load_dwordx4 v178, s[8:11], s28 offen sc1 lds
  v_smfmac_f32_16x16x64_bf16 v[56:59], v[24:27], v[216:223], v172
  s_waitcnt lgkmcnt(3)
  v_smfmac_f32_16x16x64_bf16 v[44:47], v[28:31], a[48:55], v172
  s_add_u32 m0, s64, 69632
  s_add_u32 s28, s65, 4096
  buffer_load_dwordx4 v178, s[8:11], s28 offen sc1 lds
  v_smfmac_f32_16x16x64_bf16 v[48:51], v[28:31], a[128:135], v172
  v_smfmac_f32_16x16x64_bf16 v[52:55], v[28:31], a[208:215], v172
  s_add_u32 m0, s64, 70656
  s_add_u32 s28, s65, 5120
  buffer_load_dwordx4 v178, s[8:11], s28 offen sc1 lds
  v_smfmac_f32_16x16x64_bf16 v[56:59], v[28:31], v[224:231], v172
  s_waitcnt lgkmcnt(2)
  v_smfmac_f32_16x16x64_bf16 v[44:47], v[32:35], a[56:63], v172
  s_add_u32 m0, s64, 71680
  s_add_u32 s28, s65, 6144
  buffer_load_dwordx4 v178, s[8:11], s28 offen sc1 lds
  v_smfmac_f32_16x16x64_bf16 v[48:51], v[32:35], a[136:143], v172
  v_smfmac_f32_16x16x64_bf16 v[52:55], v[32:35], a[216:223], v172
  s_add_u32 m0, s64, 72704
  s_add_u32 s28, s65, 7168
  buffer_load_dwordx4 v178, s[8:11], s28 offen sc1 lds
  v_smfmac_f32_16x16x64_bf16 v[56:59], v[32:35], v[232:239], v172
  s_waitcnt lgkmcnt(1)
  v_smfmac_f32_16x16x64_bf16 v[44:47], v[36:39], a[64:71], v172
  s_add_u32 m0, s64, 73728
  s_add_u32 s28, s65, 8192
  buffer_load_dwordx4 v178, s[8:11], s28 offen sc1 lds
  v_smfmac_f32_16x16x64_bf16 v[48:51], v[36:39], a[144:151], v172
  v_smfmac_f32_16x16x64_bf16 v[52:55], v[36:39], a[224:231], v172
  s_add_u32 m0, s64, 74752
  s_add_u32 s28, s65, 9216
  buffer_load_dwordx4 v178, s[8:11], s28 offen sc1 lds
  v_smfmac_f32_16x16x64_bf16 v[56:59], v[36:39], v[240:247], v172
  s_waitcnt lgkmcnt(0)
  v_smfmac_f32_16x16x64_bf16 v[44:47], v[40:43], a[72:79], v172
  v_smfmac_f32_16x16x64_bf16 v[48:51], v[40:43], a[152:159], v172
  v_smfmac_f32_16x16x64_bf16 v[52:55], v[40:43], a[232:239], v172
  v_smfmac_f32_16x16x64_bf16 v[56:59], v[40:43], v[248:255], v172
  s_xor_b32 s63, s63, 0x4000
  s_add_u32 s50, s50, 1310720
  s_nop 9
  v_permlane32_swap_b32 v44, v48
  v_permlane32_swap_b32 v45, v49
  v_permlane32_swap_b32 v46, v50
  v_permlane32_swap_b32 v47, v51
  v_permlane32_swap_b32 v52, v56
  v_permlane32_swap_b32 v53, v57
  v_permlane32_swap_b32 v54, v58
  v_permlane32_swap_b32 v55, v59
  v_add_f32 v44, v44, v48
  v_add_f32 v45, v45, v49
  v_add_f32 v46, v46, v50
  v_add_f32 v47, v47, v51
  v_add_f32 v52, v52, v56
  v_add_f32 v53, v53, v57
  v_add_f32 v54, v54, v58
  v_add_f32 v55, v55, v59
  v_cvt_pk_bf16_f32 v64, v44, v45
  v_cvt_pk_bf16_f32 v65, v46, v47
  v_cvt_pk_bf16_f32 v66, v52, v53
  v_cvt_pk_bf16_f32 v67, v54, v55
  ds_write_b128 v179, v[64:67]
  v_mov_b32 v44, 0
  v_mov_b32 v45, 0
  v_mov_b32 v46, 0
  v_mov_b32 v47, 0
  v_mov_b32 v48, 0
  v_mov_b32 v49, 0
  v_mov_b32 v50, 0
  v_mov_b32 v51, 0
  v_mov_b32 v52, 0
  v_mov_b32 v53, 0
  v_mov_b32 v54, 0
  v_mov_b32 v55, 0
  v_mov_b32 v56, 0
  v_mov_b32 v57, 0
  v_mov_b32 v58, 0
  v_mov_b32 v59, 0
  s_waitcnt vmcnt(0) lgkmcnt(0)
  s_barrier
  ds_read_b128 v[60:63], v180
  s_cmp_eq_u32 s51, 0
  s_cbranch_scc1 yt_95_\sfx\()
  ds_read_b128 v[68:71], v181 offset:0
  ds_read_b128 v[72:75], v181 offset:2048
  ds_read_b128 v[76:79], v181 offset:4096
  ds_read_b128 v[80:83], v181 offset:6144
  ds_read_b128 v[84:87], v181 offset:8192
  ds_read_b128 v[88:91], v181 offset:10240
  ds_read_b128 v[92:95], v181 offset:12288
  ds_read_b128 v[96:99], v181 offset:14336
  s_mov_b32 s45, 0
ytp_96_\sfx\():
  s_waitcnt lgkmcnt(0)
  ds_read_b128 v[100:103], v183 offset:0
  ds_read_b128 v[104:107], v183 offset:2048
  ds_read_b128 v[108:111], v183 offset:4096
  ds_read_b128 v[112:115], v183 offset:6144
  ds_read_b128 v[116:119], v183 offset:8192
  ds_read_b128 v[120:123], v183 offset:10240
  ds_read_b128 v[124:127], v183 offset:12288
  ds_read_b128 v[128:131], v183 offset:14336
  ds_read_b128 v[132:135], v183 offset:16384
  ds_read_b128 v[136:139], v183 offset:18432
  s_waitcnt lgkmcnt(0)
  v_max_u32 v190, v100, v102
  v_max3_u32 v190, v190, v104, v106
  v_max3_u32 v190, v190, v108, v110
  v_max3_u32 v190, v190, v112, v114
  v_max3_u32 v190, v190, v116, v118
  v_max3_u32 v190, v190, v120, v122
  v_max3_u32 v190, v190, v124, v126
  v_max3_u32 v190, v190, v128, v130
  v_max3_u32 v190, v190, v132, v134
  v_max3_u32 v190, v190, v136, v138
  v_cmp_eq_u32 vcc, -1, v190
  s_cbranch_vccz ytp_96_ok_\sfx\()
  s_add_u32 s45, s45, 1
  s_cmp_lt_u32 s45, 400000
  s_cbranch_scc0 ka\sfx\()_abort
ytp_96_dma_\sfx\():
  s_mov_b32 m0, 65536
  s_add_u32 s28, s61, 0
  buffer_load_dwordx4 v178, s[8:11], s28 offen sc1 lds
  s_mov_b32 m0, 66560
  s_add_u32 s28, s61, 1024
  buffer_load_dwordx4 v178, s[8:11], s28 offen sc1 lds
  s_mov_b32 m0, 67584
  s_add_u32 s28, s61, 2048
  buffer_load_dwordx4 v178, s[8:11], s28 offen sc1 lds
  s_mov_b32 m0, 68608
  s_add_u32 s28, s61, 3072
  buffer_load_dwordx4 v178, s[8:11], s28 offen sc1 lds
  s_mov_b32 m0, 69632
  s_add_u32 s28, s61, 4096
  buffer_load_dwordx4 v178, s[8:11], s28 offen sc1 lds
  s_mov_b32 m0, 70656
  s_add_u32 s28, s61, 5120
  buffer_load_dwordx4 v178, s[8:11], s28 offen sc1 lds
  s_mov_b32 m0, 71680
  s_add_u32 s28, s61, 6144
  buffer_load_dwordx4 v178, s[8:11], s28 offen sc1 lds
  s_mov_b32 m0, 72704
  s_add_u32 s28, s61, 7168
  buffer_load_dwordx4 v178, s[8:11], s28 offen sc1 lds
  s_mov_b32 m0, 73728
  s_add_u32 s28, s61, 8192
  buffer_load_dwordx4 v178, s[8:11], s28 offen sc1 lds
  s_mov_b32 m0, 74752
  s_add_u32 s28, s61, 9216
  buffer_load_dwordx4 v178, s[8:11], s28 offen sc1 lds
  s_mov_b32 m0, 75776
  s_add_u32 s28, s61, 10240
  buffer_load_dwordx4 v178, s[8:11], s28 offen sc1 lds
  s_mov_b32 m0, 76800
  s_add_u32 s28, s61, 11264
  buffer_load_dwordx4 v178, s[8:11], s28 offen sc1 lds
  s_mov_b32 m0, 77824
  s_add_u32 s28, s61, 12288
  buffer_load_dwordx4 v178, s[8:11], s28 offen sc1 lds
  s_mov_b32 m0, 78848
  s_add_u32 s28, s61, 13312
  buffer_load_dwordx4 v178, s[8:11], s28 offen sc1 lds
  s_mov_b32 m0, 79872
  s_add_u32 s28, s61, 14336
  buffer_load_dwordx4 v178, s[8:11], s28 offen sc1 lds
  s_mov_b32 m0, 80896
  s_add_u32 s28, s61, 15360
  buffer_load_dwordx4 v178, s[8:11], s28 offen sc1 lds
  s_mov_b32 m0, 81920
  s_add_u32 s28, s61, 16384
  buffer_load_dwordx4 v178, s[8:11], s28 offen sc1 lds
  s_mov_b32 m0, 82944
  s_add_u32 s28, s61, 17408
  buffer_load_dwordx4 v178, s[8:11], s28 offen sc1 lds
  s_mov_b32 m0, 83968
  s_add_u32 s28, s61, 18432
  buffer_load_dwordx4 v178, s[8:11], s28 offen sc1 lds
  s_mov_b32 m0, 84992
  s_add_u32 s28, s61, 19456
  buffer_load_dwordx4 v178, s[8:11], s28 offen sc1 lds
  s_waitcnt vmcnt(0)
  s_branch ytp_96_\sfx\()
ytp_96_ok_\sfx\():
  v_mfma_f32_16x16x32_bf16 v[140:143], v[68:71], v[100:103], 0
  v_mfma_f32_16x16x32_bf16 v[140:143], v[72:75], v[104:107], v[140:143]
  v_mfma_f32_16x16x32_bf16 v[140:143], v[76:79], v[108:111], v[140:143]
  v_mfma_f32_16x16x32_bf16 v[140:143], v[80:83], v[112:115], v[140:143]
  v_mfma_f32_16x16x32_bf16 v[140:143], v[84:87], v[116:119], v[140:143]
  v_mfma_f32_16x16x32_bf16 v[140:143], v[88:91], v[120:123], v[140:143]
  v_mfma_f32_16x16x32_bf16 v[140:143], v[92:95], v[124:127], v[140:143]
  v_mfma_f32_16x16x32_bf16 v[140:143], v[96:99], v[128:131], v[140:143]
  v_mfma_f32_16x16x32_bf16 v[140:143], v[148:151], v[132:135], v[140:143]
  v_mfma_f32_16x16x32_bf16 v[140:143], v[152:155], v[136:139], v[140:143]
  s_nop 8
  v_cvt_pk_bf16_f32 v144, v140, v141
  v_cvt_pk_bf16_f32 v145, v142, v143
  s_add_u32 s28, s62, 0
  buffer_store_dwordx2 v[144:145], v189, s[8:11], s28 offen
  s_nop 1
  s_mov_b32 s45, 0
ytp_97_\sfx\():
  s_waitcnt lgkmcnt(0)
  ds_read_b128 v[100:103], v183 offset:1024
  ds_read_b128 v[104:107], v183 offset:3072
  ds_read_b128 v[108:111], v183 offset:5120
  ds_read_b128 v[112:115], v183 offset:7168
  ds_read_b128 v[116:119], v183 offset:9216
  ds_read_b128 v[120:123], v183 offset:11264
  ds_read_b128 v[124:127], v183 offset:13312
  ds_read_b128 v[128:131], v183 offset:15360
  ds_read_b128 v[132:135], v183 offset:17408
  ds_read_b128 v[136:139], v183 offset:19456
  s_waitcnt lgkmcnt(0)
  v_max_u32 v190, v100, v102
  v_max3_u32 v190, v190, v104, v106
  v_max3_u32 v190, v190, v108, v110
  v_max3_u32 v190, v190, v112, v114
  v_max3_u32 v190, v190, v116, v118
  v_max3_u32 v190, v190, v120, v122
  v_max3_u32 v190, v190, v124, v126
  v_max3_u32 v190, v190, v128, v130
  v_max3_u32 v190, v190, v132, v134
  v_max3_u32 v190, v190, v136, v138
  v_cmp_eq_u32 vcc, -1, v190
  s_cbranch_vccz ytp_97_ok_\sfx\()
  s_add_u32 s45, s45, 1
  s_cmp_lt_u32 s45, 400000
  s_cbranch_scc0 ka\sfx\()_abort
ytp_97_dma_\sfx\():
  s_mov_b32 m0, 65536
  s_add_u32 s28, s61, 0
  buffer_load_dwordx4 v178, s[8:11], s28 offen sc1 lds
  s_mov_b32 m0, 66560
  s_add_u32 s28, s61, 1024
  buffer_load_dwordx4 v178, s[8:11], s28 offen sc1 lds
  s_mov_b32 m0, 67584
  s_add_u32 s28, s61, 2048
  buffer_load_dwordx4 v178, s[8:11], s28 offen sc1 lds
  s_mov_b32 m0, 68608
  s_add_u32 s28, s61, 3072
  buffer_load_dwordx4 v178, s[8:11], s28 offen sc1 lds
  s_mov_b32 m0, 69632
  s_add_u32 s28, s61, 4096
  buffer_load_dwordx4 v178, s[8:11], s28 offen sc1 lds
  s_mov_b32 m0, 70656
  s_add_u32 s28, s61, 5120
  buffer_load_dwordx4 v178, s[8:11], s28 offen sc1 lds
  s_mov_b32 m0, 71680
  s_add_u32 s28, s61, 6144
  buffer_load_dwordx4 v178, s[8:11], s28 offen sc1 lds
  s_mov_b32 m0, 72704
  s_add_u32 s28, s61, 7168
  buffer_load_dwordx4 v178, s[8:11], s28 offen sc1 lds
  s_mov_b32 m0, 73728
  s_add_u32 s28, s61, 8192
  buffer_load_dwordx4 v178, s[8:11], s28 offen sc1 lds
  s_mov_b32 m0, 74752
  s_add_u32 s28, s61, 9216
  buffer_load_dwordx4 v178, s[8:11], s28 offen sc1 lds
  s_mov_b32 m0, 75776
  s_add_u32 s28, s61, 10240
  buffer_load_dwordx4 v178, s[8:11], s28 offen sc1 lds
  s_mov_b32 m0, 76800
  s_add_u32 s28, s61, 11264
  buffer_load_dwordx4 v178, s[8:11], s28 offen sc1 lds
  s_mov_b32 m0, 77824
  s_add_u32 s28, s61, 12288
  buffer_load_dwordx4 v178, s[8:11], s28 offen sc1 lds
  s_mov_b32 m0, 78848
  s_add_u32 s28, s61, 13312
  buffer_load_dwordx4 v178, s[8:11], s28 offen sc1 lds
  s_mov_b32 m0, 79872
  s_add_u32 s28, s61, 14336
  buffer_load_dwordx4 v178, s[8:11], s28 offen sc1 lds
  s_mov_b32 m0, 80896
  s_add_u32 s28, s61, 15360
  buffer_load_dwordx4 v178, s[8:11], s28 offen sc1 lds
  s_mov_b32 m0, 81920
  s_add_u32 s28, s61, 16384
  buffer_load_dwordx4 v178, s[8:11], s28 offen sc1 lds
  s_mov_b32 m0, 82944
  s_add_u32 s28, s61, 17408
  buffer_load_dwordx4 v178, s[8:11], s28 offen sc1 lds
  s_mov_b32 m0, 83968
  s_add_u32 s28, s61, 18432
  buffer_load_dwordx4 v178, s[8:11], s28 offen sc1 lds
  s_mov_b32 m0, 84992
  s_add_u32 s28, s61, 19456
  buffer_load_dwordx4 v178, s[8:11], s28 offen sc1 lds
  s_waitcnt vmcnt(0)
  s_branch ytp_97_\sfx\()
ytp_97_ok_\sfx\():
  v_mfma_f32_16x16x32_bf16 v[140:143], v[68:71], v[100:103], 0
  v_mfma_f32_16x16x32_bf16 v[140:143], v[72:75], v[104:107], v[140:143]
  v_mfma_f32_16x16x32_bf16 v[140:143], v[76:79], v[108:111], v[140:143]
  v_mfma_f32_16x16x32_bf16 v[140:143], v[80:83], v[112:115], v[140:143]
  v_mfma_f32_16x16x32_bf16 v[140:143], v[84:87], v[116:119], v[140:143]
  v_mfma_f32_16x16x32_bf16 v[140:143], v[88:91], v[120:123], v[140:143]
  v_mfma_f32_16x16x32_bf16 v[140:143], v[92:95], v[124:127], v[140:143]
  v_mfma_f32_16x16x32_bf16 v[140:143], v[96:99], v[128:131], v[140:143]
  v_mfma_f32_16x16x32_bf16 v[140:143], v[148:151], v[132:135], v[140:143]
  v_mfma_f32_16x16x32_bf16 v[140:143], v[152:155], v[136:139], v[140:143]
  s_nop 8
  v_cvt_pk_bf16_f32 v144, v140, v141
  v_cvt_pk_bf16_f32 v145, v142, v143
  s_add_u32 s28, s62, 256
  buffer_store_dwordx2 v[144:145], v189, s[8:11], s28 offen
  s_nop 1
  s_add_u32 s61, s61, 20480
  s_add_u32 s62, s62, 40960
  s_add_u32 s54, s54, 1
  v_xor_b32 v181, 0x4000, v181
yt_95_\sfx\():
  s_waitcnt lgkmcnt(0)
  v_mov_b32 v148, v60
  v_mov_b32 v149, v61
  v_mov_b32 v150, v62
  v_mov_b32 v151, v63
  v_mov_b32 v152, v64
  v_mov_b32 v153, v65
  v_mov_b32 v154, v66
  v_mov_b32 v155, v67
  s_add_u32 s97, s97, 10240
  s_mov_b32 s48, s97
  s_add_u32 s51, s51, 1
  s_cmp_lt_u32 s51, 64
  s_cbranch_scc1 ka\sfx\()_y_tokl
  s_barrier
  ds_read_b128 v[68:71], v181 offset:0
  ds_read_b128 v[72:75], v181 offset:2048
  ds_read_b128 v[76:79], v181 offset:4096
  ds_read_b128 v[80:83], v181 offset:6144
  ds_read_b128 v[84:87], v181 offset:8192
  ds_read_b128 v[88:91], v181 offset:10240
  ds_read_b128 v[92:95], v181 offset:12288
  ds_read_b128 v[96:99], v181 offset:14336
  s_mov_b32 s45, 0
  s_branch ytp_98_dma_\sfx\()
ytp_98_\sfx\():
  s_waitcnt lgkmcnt(0)
  ds_read_b128 v[100:103], v183 offset:0
  ds_read_b128 v[104:107], v183 offset:2048
  ds_read_b128 v[108:111], v183 offset:4096
  ds_read_b128 v[112:115], v183 offset:6144
  ds_read_b128 v[116:119], v183 offset:8192
  ds_read_b128 v[120:123], v183 offset:10240
  ds_read_b128 v[124:127], v183 offset:12288
  ds_read_b128 v[128:131], v183 offset:14336
  ds_read_b128 v[132:135], v183 offset:16384
  ds_read_b128 v[136:139], v183 offset:18432
  s_waitcnt lgkmcnt(0)
  v_max_u32 v190, v100, v102
  v_max3_u32 v190, v190, v104, v106
  v_max3_u32 v190, v190, v108, v110
  v_max3_u32 v190, v190, v112, v114
  v_max3_u32 v190, v190, v116, v118
  v_max3_u32 v190, v190, v120, v122
  v_max3_u32 v190, v190, v124, v126
  v_max3_u32 v190, v190, v128, v130
  v_max3_u32 v190, v190, v132, v134
  v_max3_u32 v190, v190, v136, v138
  v_cmp_eq_u32 vcc, -1, v190
  s_cbranch_vccz ytp_98_ok_\sfx\()
  s_add_u32 s45, s45, 1
  s_cmp_lt_u32 s45, 400000
  s_cbranch_scc0 ka\sfx\()_abort
ytp_98_dma_\sfx\():
  s_mov_b32 m0, 65536
  s_add_u32 s28, s61, 0
  buffer_load_dwordx4 v178, s[8:11], s28 offen sc1 lds
  s_mov_b32 m0, 66560
  s_add_u32 s28, s61, 1024
  buffer_load_dwordx4 v178, s[8:11], s28 offen sc1 lds
  s_mov_b32 m0, 67584
  s_add_u32 s28, s61, 2048
  buffer_load_dwordx4 v178, s[8:11], s28 offen sc1 lds
  s_mov_b32 m0, 68608
  s_add_u32 s28, s61, 3072
  buffer_load_dwordx4 v178, s[8:11], s28 offen sc1 lds
  s_mov_b32 m0, 69632
  s_add_u32 s28, s61, 4096
  buffer_load_dwordx4 v178, s[8:11], s28 offen sc1 lds
  s_mov_b32 m0, 70656
  s_add_u32 s28, s61, 5120
  buffer_load_dwordx4 v178, s[8:11], s28 offen sc1 lds
  s_mov_b32 m0, 71680
  s_add_u32 s28, s61, 6144
  buffer_load_dwordx4 v178, s[8:11], s28 offen sc1 lds
  s_mov_b32 m0, 72704
  s_add_u32 s28, s61, 7168
  buffer_load_dwordx4 v178, s[8:11], s28 offen sc1 lds
  s_mov_b32 m0, 73728
  s_add_u32 s28, s61, 8192
  buffer_load_dwordx4 v178, s[8:11], s28 offen sc1 lds
  s_mov_b32 m0, 74752
  s_add_u32 s28, s61, 9216
  buffer_load_dwordx4 v178, s[8:11], s28 offen sc1 lds
  s_mov_b32 m0, 75776
  s_add_u32 s28, s61, 10240
  buffer_load_dwordx4 v178, s[8:11], s28 offen sc1 lds
  s_mov_b32 m0, 76800
  s_add_u32 s28, s61, 11264
  buffer_load_dwordx4 v178, s[8:11], s28 offen sc1 lds
  s_mov_b32 m0, 77824
  s_add_u32 s28, s61, 12288
  buffer_load_dwordx4 v178, s[8:11], s28 offen sc1 lds
  s_mov_b32 m0, 78848
  s_add_u32 s28, s61, 13312
  buffer_load_dwordx4 v178, s[8:11], s28 offen sc1 lds
  s_mov_b32 m0, 79872
  s_add_u32 s28, s61, 14336
  buffer_load_dwordx4 v178, s[8:11], s28 offen sc1 lds
  s_mov_b32 m0, 80896
  s_add_u32 s28, s61, 15360
  buffer_load_dwordx4 v178, s[8:11], s28 offen sc1 lds
  s_mov_b32 m0, 81920
  s_add_u32 s28, s61, 16384
  buffer_load_dwordx4 v178, s[8:11], s28 offen sc1 lds
  s_mov_b32 m0, 82944
  s_add_u32 s28, s61, 17408
  buffer_load_dwordx4 v178, s[8:11], s28 offen sc1 lds
  s_mov_b32 m0, 83968
  s_add_u32 s28, s61, 18432
  buffer_load_dwordx4 v178, s[8:11], s28 offen sc1 lds
  s_mov_b32 m0, 84992
  s_add_u32 s28, s61, 19456
  buffer_load_dwordx4 v178, s[8:11], s28 offen sc1 lds
  s_waitcnt vmcnt(0)
  s_branch ytp_98_\sfx\()
ytp_98_ok_\sfx\():
  v_mfma_f32_16x16x32_bf16 v[140:143], v[68:71], v[100:103], 0
  v_mfma_f32_16x16x32_bf16 v[140:143], v[72:75], v[104:107], v[140:143]
  v_mfma_f32_16x16x32_bf16 v[140:143], v[76:79], v[108:111], v[140:143]
  v_mfma_f32_16x16x32_bf16 v[140:143], v[80:83], v[112:115], v[140:143]
  v_mfma_f32_16x16x32_bf16 v[140:143], v[84:87], v[116:119], v[140:143]
  v_mfma_f32_16x16x32_bf16 v[140:143], v[88:91], v[120:123], v[140:143]
  v_mfma_f32_16x16x32_bf16 v[140:143], v[92:95], v[124:127], v[140:143]
  v_mfma_f32_16x16x32_bf16 v[140:143], v[96:99], v[128:131], v[140:143]
  v_mfma_f32_16x16x32_bf16 v[140:143], v[148:151], v[132:135], v[140:143]
  v_mfma_f32_16x16x32_bf16 v[140:143], v[152:155], v[136:139], v[140:143]
  s_nop 8
  v_cvt_pk_bf16_f32 v144, v140, v141
  v_cvt_pk_bf16_f32 v145, v142, v143
  s_add_u32 s28, s62, 0
  buffer_store_dwordx2 v[144:145], v189, s[8:11], s28 offen
  s_nop 1
  s_mov_b32 s45, 0
ytp_99_\sfx\():
  s_waitcnt lgkmcnt(0)
  ds_read_b128 v[100:103], v183 offset:1024
  ds_read_b128 v[104:107], v183 offset:3072
  ds_read_b128 v[108:111], v183 offset:5120
  ds_read_b128 v[112:115], v183 offset:7168
  ds_read_b128 v[116:119], v183 offset:9216
  ds_read_b128 v[120:123], v183 offset:11264
  ds_read_b128 v[124:127], v183 offset:13312
  ds_read_b128 v[128:131], v183 offset:15360
  ds_read_b128 v[132:135], v183 offset:17408
  ds_read_b128 v[136:139], v183 offset:19456
  s_waitcnt lgkmcnt(0)
  v_max_u32 v190, v100, v102
  v_max3_u32 v190, v190, v104, v106
  v_max3_u32 v190, v190, v108, v110
  v_max3_u32 v190, v190, v112, v114
  v_max3_u32 v190, v190, v116, v118
  v_max3_u32 v190, v190, v120, v122
  v_max3_u32 v190, v190, v124, v126
  v_max3_u32 v190, v190, v128, v130
  v_max3_u32 v190, v190, v132, v134
  v_max3_u32 v190, v190, v136, v138
  v_cmp_eq_u32 vcc, -1, v190
  s_cbranch_vccz ytp_99_ok_\sfx\()
  s_add_u32 s45, s45, 1
  s_cmp_lt_u32 s45, 400000
  s_cbranch_scc0 ka\sfx\()_abort
ytp_99_dma_\sfx\():
  s_mov_b32 m0, 65536
  s_add_u32 s28, s61, 0
  buffer_load_dwordx4 v178, s[8:11], s28 offen sc1 lds
  s_mov_b32 m0, 66560
  s_add_u32 s28, s61, 1024
  buffer_load_dwordx4 v178, s[8:11], s28 offen sc1 lds
  s_mov_b32 m0, 67584
  s_add_u32 s28, s61, 2048
  buffer_load_dwordx4 v178, s[8:11], s28 offen sc1 lds
  s_mov_b32 m0, 68608
  s_add_u32 s28, s61, 3072
  buffer_load_dwordx4 v178, s[8:11], s28 offen sc1 lds
  s_mov_b32 m0, 69632
  s_add_u32 s28, s61, 4096
  buffer_load_dwordx4 v178, s[8:11], s28 offen sc1 lds
  s_mov_b32 m0, 70656
  s_add_u32 s28, s61, 5120
  buffer_load_dwordx4 v178, s[8:11], s28 offen sc1 lds
  s_mov_b32 m0, 71680
  s_add_u32 s28, s61, 6144
  buffer_load_dwordx4 v178, s[8:11], s28 offen sc1 lds
  s_mov_b32 m0, 72704
  s_add_u32 s28, s61, 7168
  buffer_load_dwordx4 v178, s[8:11], s28 offen sc1 lds
  s_mov_b32 m0, 73728
  s_add_u32 s28, s61, 8192
  buffer_load_dwordx4 v178, s[8:11], s28 offen sc1 lds
  s_mov_b32 m0, 74752
  s_add_u32 s28, s61, 9216
  buffer_load_dwordx4 v178, s[8:11], s28 offen sc1 lds
  s_mov_b32 m0, 75776
  s_add_u32 s28, s61, 10240
  buffer_load_dwordx4 v178, s[8:11], s28 offen sc1 lds
  s_mov_b32 m0, 76800
  s_add_u32 s28, s61, 11264
  buffer_load_dwordx4 v178, s[8:11], s28 offen sc1 lds
  s_mov_b32 m0, 77824
  s_add_u32 s28, s61, 12288
  buffer_load_dwordx4 v178, s[8:11], s28 offen sc1 lds
  s_mov_b32 m0, 78848
  s_add_u32 s28, s61, 13312
  buffer_load_dwordx4 v178, s[8:11], s28 offen sc1 lds
  s_mov_b32 m0, 79872
  s_add_u32 s28, s61, 14336
  buffer_load_dwordx4 v178, s[8:11], s28 offen sc1 lds
  s_mov_b32 m0, 80896
  s_add_u32 s28, s61, 15360
  buffer_load_dwordx4 v178, s[8:11], s28 offen sc1 lds
  s_mov_b32 m0, 81920
  s_add_u32 s28, s61, 16384
  buffer_load_dwordx4 v178, s[8:11], s28 offen sc1 lds
  s_mov_b32 m0, 82944
  s_add_u32 s28, s61, 17408
  buffer_load_dwordx4 v178, s[8:11], s28 offen sc1 lds
  s_mov_b32 m0, 83968
  s_add_u32 s28, s61, 18432
  buffer_load_dwordx4 v178, s[8:11], s28 offen sc1 lds
  s_mov_b32 m0, 84992
  s_add_u32 s28, s61, 19456
  buffer_load_dwordx4 v178, s[8:11], s28 offen sc1 lds
  s_waitcnt vmcnt(0)
  s_branch ytp_99_\sfx\()
ytp_99_ok_\sfx\():
  v_mfma_f32_16x16x32_bf16 v[140:143], v[68:71], v[100:103], 0
  v_mfma_f32_16x16x32_bf16 v[140:143], v[72:75], v[104:107], v[140:143]
  v_mfma_f32_16x16x32_bf16 v[140:143], v[76:79], v[108:111], v[140:143]
  v_mfma_f32_16x16x32_bf16 v[140:143], v[80:83], v[112:115], v[140:143]
  v_mfma_f32_16x16x32_bf16 v[140:143], v[84:87], v[116:119], v[140:143]
  v_mfma_f32_16x16x32_bf16 v[140:143], v[88:91], v[120:123], v[140:143]
  v_mfma_f32_16x16x32_bf16 v[140:143], v[92:95], v[124:127], v[140:143]
  v_mfma_f32_16x16x32_bf16 v[140:143], v[96:99], v[128:131], v[140:143]
  v_mfma_f32_16x16x32_bf16 v[140:143], v[148:151], v[132:135], v[140:143]
  v_mfma_f32_16x16x32_bf16 v[140:143], v[152:155], v[136:139], v[140:143]
  s_nop 8
  v_cvt_pk_bf16_f32 v144, v140, v141
  v_cvt_pk_bf16_f32 v145, v142, v143
  s_add_u32 s28, s62, 256
  buffer_store_dwordx2 v[144:145], v189, s[8:11], s28 offen
  s_nop 1
  s_add_u32 s61, s61, 20480
  s_add_u32 s62, s62, 40960
  s_add_u32 s54, s54, 1
  v_xor_b32 v181, 0x4000, v181
  s_waitcnt vmcnt(0)
  s_branch ka\sfx\()_exit
ka\sfx\()_abort:
  s_branch ka_abort
ka\sfx\()_exit:
  s_branch ka_exit
.endm
CHAINROLES f,
CHAINROLES s, sc1
ka_abort:
  s_load_dwordx2 s[6:7], s[0:1], 88
  v_mov_b32 v2, 80
  v_mov_b32 v3, 1
  s_waitcnt lgkmcnt(0)
  s_mov_b64 exec, 1
  global_atomic_add v2, v3, s[6:7]
  s_waitcnt vmcnt(0)
ka_exit:
  s_endpgm

.section .rodata,"a"
.p2align 6
.amdhsa_kernel ka2_kernel
  .amdhsa_next_free_vgpr 512
  .amdhsa_next_free_sgpr 102
  .amdhsa_accum_offset 256
  .amdhsa_group_segment_fixed_size 0
  .amdhsa_kernarg_size 104
  .amdhsa_user_sgpr_count 2
  .amdhsa_user_sgpr_kernarg_segment_ptr 1
  .amdhsa_system_sgpr_workgroup_id_x 1
.end_amdhsa_kernel
.text
.globl kb2_kernel
.p2align 8
.type kb2_kernel,@function
kb2_kernel:
  s_cmp_ge_u32 s2, 256
  s_cbranch_scc1 kb2_exit
  s_load_dwordx2 s[36:37], s[0:1], 0
  s_load_dwordx2 s[38:39], s[0:1], 80
  s_load_dwordx2 s[4:5], s[0:1], 96
  v_lshrrev_b32 v1, 6, v0
  s_nop 0
  v_readfirstlane_b32 s21, v1
  v_and_b32 v1, 63, v0
  v_lshlrev_b32 v2, 4, v1
  s_waitcnt lgkmcnt(0)
  s_mov_b32 s8, s4
  s_and_b32 s9, s5, 0xffff
  s_mov_b32 s10, 0x10000000
  s_mov_b32 s11, 0x20000
  s_mov_b32 s12, s36
  s_and_b32 s13, s37, 0xffff
  s_mov_b32 s14, 0x280000
  s_mov_b32 s15, 0x20000
  s_mov_b32 s16, s38
  s_and_b32 s17, s39, 0xffff
  s_mov_b32 s18, 0x280000
  s_mov_b32 s19, 0x20000
  s_and_b32 s22, s2, 7
  s_lshl_b32 s22, s22, 2
  s_bfe_u32 s23, s2, 0x20003
  s_add_u32 s22, s22, s23
  s_lshr_b32 s23, s2, 5
  s_lshl_b32 s46, s23, 7
  s_add_u32 s46, s46, 0xa000
  s_add_u32 s48, s46, 0x1400
  s_lshl_b32 s47, s22, 7
  s_add_u32 s47, s47, 0xa400
  s_lshr_b32 s26, s2, 2
  s_and_b32 s27, s2, 3
  s_lshl_b32 s27, s27, 3
  v_and_b32 v5, 7, v1
  v_bfe_u32 v6, v1, 3, 1
  v_lshrrev_b32 v7, 4, v1
  v_lshlrev_b32 v8, 5, v6
  v_add_u32 v8, v8, v5
  v_add_u32 v8, s27, v8
  v_lshlrev_b32 v8, 4, v8
  v_lshlrev_b32 v9, 11, v7
  v_add_u32 v9, v9, v8
  v_lshlrev_b32 v10, 10, v7
  v_add_u32 v10, v10, v8
  s_mul_i32 s28, s26, 81920
  s_lshl_b32 s29, s21, 13
  s_add_u32 s28, s28, s29
  s_cmp_lt_u32 s21, 2
  s_cselect_b32 s49, 3, 2
  v_mov_b32 v32, 0
  v_mov_b32 v33, 0
  v_mov_b32 v34, 0
  v_mov_b32 v35, 0
  v_mov_b32 v36, 0
  v_mov_b32 v37, 0
  v_mov_b32 v38, 0
  v_mov_b32 v39, 0
  v_mov_b32 v56, 0
  v_mov_b32 v57, 0
  v_mov_b32 v58, 0
  v_mov_b32 v59, 0
  v_mov_b32 v68, 0
  v_mov_b32 v69, 0
  v_mov_b32 v70, 0
  v_mov_b32 v71, 0
  v_mov_b32 v80, 0
  v_mov_b32 v81, 0
  v_mov_b32 v82, 0
  v_mov_b32 v83, 0
  v_mov_b32 v92, 0
  v_mov_b32 v93, 0
  v_mov_b32 v94, 0
  v_mov_b32 v95, 0
  s_mul_i32 s33, s26, 40960
  s_lshl_b32 s30, s21, 12
  s_add_u32 s33, s33, s30
  s_add_u32 s30, s33, 27262976
  buffer_load_dwordx4 v[48:51], v10, s[8:11], s30 offen
  s_add_u32 s30, s33, 29884416
  buffer_load_dwordx4 v[60:63], v10, s[8:11], s30 offen
  s_add_u32 s30, s33, 32505856
  buffer_load_dwordx4 v[72:75], v10, s[8:11], s30 offen
  s_add_u32 s30, s33, 35127296
  buffer_load_dwordx4 v[84:87], v10, s[8:11], s30 offen
  s_add_u32 s30, s28, 20971520
  buffer_load_dwordx4 v[16:19], v9, s[8:11], s30 offen
  s_add_u32 s30, s28, 20972544
  buffer_load_dwordx4 v[20:23], v9, s[8:11], s30 offen
  s_add_u32 s30, s33, 27279360
  buffer_load_dwordx4 v[52:55], v10, s[8:11], s30 offen
  s_add_u32 s30, s33, 29900800
  buffer_load_dwordx4 v[64:67], v10, s[8:11], s30 offen
  s_add_u32 s30, s33, 32522240
  buffer_load_dwordx4 v[76:79], v10, s[8:11], s30 offen
  s_add_u32 s30, s33, 35143680
  buffer_load_dwordx4 v[88:91], v10, s[8:11], s30 offen
  s_add_u32 s30, s28, 21004288
  buffer_load_dwordx4 v[24:27], v9, s[8:11], s30 offen
  s_add_u32 s30, s28, 21005312
  buffer_load_dwordx4 v[28:31], v9, s[8:11], s30 offen
  s_cmp_lt_u32 s21, 2
  s_cbranch_scc0 g3_100
  s_add_u32 s30, s33, 27295744
  buffer_load_dwordx4 v[56:59], v10, s[8:11], s30 offen
  s_add_u32 s30, s33, 29917184
  buffer_load_dwordx4 v[68:71], v10, s[8:11], s30 offen
  s_add_u32 s30, s33, 32538624
  buffer_load_dwordx4 v[80:83], v10, s[8:11], s30 offen
  s_add_u32 s30, s33, 35160064
  buffer_load_dwordx4 v[92:95], v10, s[8:11], s30 offen
  s_add_u32 s30, s28, 21037056
  buffer_load_dwordx4 v[32:35], v9, s[8:11], s30 offen
  s_add_u32 s30, s28, 21038080
  buffer_load_dwordx4 v[36:39], v9, s[8:11], s30 offen
g3_100:
  s_mul_i32 s30, s22, 122880
  s_mul_i32 s31, s21, 30720
  s_add_u32 s30, s30, s31
  s_add_u32 s30, s30, 0xe100000
  s_add_u32 m0, s31, 0
  s_add_u32 s29, s30, 0
  buffer_load_dwordx4 v2, s[8:11], s29 offen lds
  s_add_u32 m0, s31, 1024
  s_add_u32 s29, s30, 1024
  buffer_load_dwordx4 v2, s[8:11], s29 offen lds
  s_add_u32 m0, s31, 2048
  s_add_u32 s29, s30, 2048
  buffer_load_dwordx4 v2, s[8:11], s29 offen lds
  s_add_u32 m0, s31, 3072
  s_add_u32 s29, s30, 3072
  buffer_load_dwordx4 v2, s[8:11], s29 offen lds
  s_add_u32 m0, s31, 4096
  s_add_u32 s29, s30, 4096
  buffer_load_dwordx4 v2, s[8:11], s29 offen lds
  s_add_u32 m0, s31, 5120
  s_add_u32 s29, s30, 5120
  buffer_load_dwordx4 v2, s[8:11], s29 offen lds
  s_add_u32 m0, s31, 6144
  s_add_u32 s29, s30, 6144
  buffer_load_dwordx4 v2, s[8:11], s29 offen lds
  s_add_u32 m0, s31, 7168
  s_add_u32 s29, s30, 7168
  buffer_load_dwordx4 v2, s[8:11], s29 offen lds
  s_add_u32 m0, s31, 8192
  s_add_u32 s29, s30, 8192
  buffer_load_dwordx4 v2, s[8:11], s29 offen lds
  s_add_u32 m0, s31, 9216
  s_add_u32 s29, s30, 9216
  buffer_load_dwordx4 v2, s[8:11], s29 offen lds
  s_add_u32 m0, s31, 10240
  s_add_u32 s29, s30, 10240
  buffer_load_dwordx4 v2, s[8:11], s29 offen lds
  s_add_u32 m0, s31, 11264
  s_add_u32 s29, s30, 11264
  buffer_load_dwordx4 v2, s[8:11], s29 offen lds
  s_add_u32 m0, s31, 12288
  s_add_u32 s29, s30, 12288
  buffer_load_dwordx4 v2, s[8:11], s29 offen lds
  s_add_u32 m0, s31, 13312
  s_add_u32 s29, s30, 13312
  buffer_load_dwordx4 v2, s[8:11], s29 offen lds
  s_add_u32 m0, s31, 14336
  s_add_u32 s29, s30, 14336
  buffer_load_dwordx4 v2, s[8:11], s29 offen lds
  s_add_u32 m0, s31, 15360
  s_add_u32 s29, s30, 15360
  buffer_load_dwordx4 v2, s[8:11], s29 offen lds
  s_add_u32 m0, s31, 16384
  s_add_u32 s29, s30, 16384
  buffer_load_dwordx4 v2, s[8:11], s29 offen lds
  s_add_u32 m0, s31, 17408
  s_add_u32 s29, s30, 17408
  buffer_load_dwordx4 v2, s[8:11], s29 offen lds
  s_add_u32 m0, s31, 18432
  s_add_u32 s29, s30, 18432
  buffer_load_dwordx4 v2, s[8:11], s29 offen lds
  s_add_u32 m0, s31, 19456
  s_add_u32 s29, s30, 19456
  buffer_load_dwordx4 v2, s[8:11], s29 offen lds
  s_add_u32 m0, s31, 20480
  s_add_u32 s29, s30, 20480
  buffer_load_dwordx4 v2, s[8:11], s29 offen lds
  s_add_u32 m0, s31, 21504
  s_add_u32 s29, s30, 21504
  buffer_load_dwordx4 v2, s[8:11], s29 offen lds
  s_add_u32 m0, s31, 22528
  s_add_u32 s29, s30, 22528
  buffer_load_dwordx4 v2, s[8:11], s29 offen lds
  s_add_u32 m0, s31, 23552
  s_add_u32 s29, s30, 23552
  buffer_load_dwordx4 v2, s[8:11], s29 offen lds
  s_add_u32 m0, s31, 24576
  s_add_u32 s29, s30, 24576
  buffer_load_dwordx4 v2, s[8:11], s29 offen lds
  s_add_u32 m0, s31, 25600
  s_add_u32 s29, s30, 25600
  buffer_load_dwordx4 v2, s[8:11], s29 offen lds
  s_add_u32 m0, s31, 26624
  s_add_u32 s29, s30, 26624
  buffer_load_dwordx4 v2, s[8:11], s29 offen lds
  s_add_u32 m0, s31, 27648
  s_add_u32 s29, s30, 27648
  buffer_load_dwordx4 v2, s[8:11], s29 offen lds
  s_add_u32 m0, s31, 28672
  s_add_u32 s29, s30, 28672
  buffer_load_dwordx4 v2, s[8:11], s29 offen lds
  s_add_u32 m0, s31, 29696
  s_add_u32 s29, s30, 29696
  buffer_load_dwordx4 v2, s[8:11], s29 offen lds
  s_waitcnt vmcnt(30)
  v_lshlrev_b32 v12, 16, v48
  v_and_b32 v13, 0xffff0000, v48
  v_pk_add_f32 v[16:17], v[16:17], v[12:13]
  v_lshlrev_b32 v12, 16, v49
  v_and_b32 v13, 0xffff0000, v49
  v_pk_add_f32 v[18:19], v[18:19], v[12:13]
  v_lshlrev_b32 v12, 16, v50
  v_and_b32 v13, 0xffff0000, v50
  v_pk_add_f32 v[20:21], v[20:21], v[12:13]
  v_lshlrev_b32 v12, 16, v51
  v_and_b32 v13, 0xffff0000, v51
  v_pk_add_f32 v[22:23], v[22:23], v[12:13]
  v_lshlrev_b32 v12, 16, v52
  v_and_b32 v13, 0xffff0000, v52
  v_pk_add_f32 v[24:25], v[24:25], v[12:13]
  v_lshlrev_b32 v12, 16, v53
  v_and_b32 v13, 0xffff0000, v53
  v_pk_add_f32 v[26:27], v[26:27], v[12:13]
  v_lshlrev_b32 v12, 16, v54
  v_and_b32 v13, 0xffff0000, v54
  v_pk_add_f32 v[28:29], v[28:29], v[12:13]
  v_lshlrev_b32 v12, 16, v55
  v_and_b32 v13, 0xffff0000, v55
  v_pk_add_f32 v[30:31], v[30:31], v[12:13]
  v_lshlrev_b32 v12, 16, v56
  v_and_b32 v13, 0xffff0000, v56
  v_pk_add_f32 v[32:33], v[32:33], v[12:13]
  v_lshlrev_b32 v12, 16, v57
  v_and_b32 v13, 0xffff0000, v57
  v_pk_add_f32 v[34:35], v[34:35], v[12:13]
  v_lshlrev_b32 v12, 16, v58
  v_and_b32 v13, 0xffff0000, v58
  v_pk_add_f32 v[36:37], v[36:37], v[12:13]
  v_lshlrev_b32 v12, 16, v59
  v_and_b32 v13, 0xffff0000, v59
  v_pk_add_f32 v[38:39], v[38:39], v[12:13]
  v_lshlrev_b32 v12, 16, v60
  v_and_b32 v13, 0xffff0000, v60
  v_pk_add_f32 v[16:17], v[16:17], v[12:13]
  v_lshlrev_b32 v12, 16, v61
  v_and_b32 v13, 0xffff0000, v61
  v_pk_add_f32 v[18:19], v[18:19], v[12:13]
  v_lshlrev_b32 v12, 16, v62
  v_and_b32 v13, 0xffff0000, v62
  v_pk_add_f32 v[20:21], v[20:21], v[12:13]
  v_lshlrev_b32 v12, 16, v63
  v_and_b32 v13, 0xffff0000, v63
  v_pk_add_f32 v[22:23], v[22:23], v[12:13]
  v_lshlrev_b32 v12, 16, v64
  v_and_b32 v13, 0xffff0000, v64
  v_pk_add_f32 v[24:25], v[24:25], v[12:13]
  v_lshlrev_b32 v12, 16, v65
  v_and_b32 v13, 0xffff0000, v65
  v_pk_add_f32 v[26:27], v[26:27], v[12:13]
  v_lshlrev_b32 v12, 16, v66
  v_and_b32 v13, 0xffff0000, v66
  v_pk_add_f32 v[28:29], v[28:29], v[12:13]
  v_lshlrev_b32 v12, 16, v67
  v_and_b32 v13, 0xffff0000, v67
  v_pk_add_f32 v[30:31], v[30:31], v[12:13]
  v_lshlrev_b32 v12, 16, v68
  v_and_b32 v13, 0xffff0000, v68
  v_pk_add_f32 v[32:33], v[32:33], v[12:13]
  v_lshlrev_b32 v12, 16, v69
  v_and_b32 v13, 0xffff0000, v69
  v_pk_add_f32 v[34:35], v[34:35], v[12:13]
  v_lshlrev_b32 v12, 16, v70
  v_and_b32 v13, 0xffff0000, v70
  v_pk_add_f32 v[36:37], v[36:37], v[12:13]
  v_lshlrev_b32 v12, 16, v71
  v_and_b32 v13, 0xffff0000, v71
  v_pk_add_f32 v[38:39], v[38:39], v[12:13]
  v_lshlrev_b32 v12, 16, v72
  v_and_b32 v13, 0xffff0000, v72
  v_pk_add_f32 v[16:17], v[16:17], v[12:13]
  v_lshlrev_b32 v12, 16, v73
  v_and_b32 v13, 0xffff0000, v73
  v_pk_add_f32 v[18:19], v[18:19], v[12:13]
  v_lshlrev_b32 v12, 16, v74
  v_and_b32 v13, 0xffff0000, v74
  v_pk_add_f32 v[20:21], v[20:21], v[12:13]
  v_lshlrev_b32 v12, 16, v75
  v_and_b32 v13, 0xffff0000, v75
  v_pk_add_f32 v[22:23], v[22:23], v[12:13]
  v_lshlrev_b32 v12, 16, v76
  v_and_b32 v13, 0xffff0000, v76
  v_pk_add_f32 v[24:25], v[24:25], v[12:13]
  v_lshlrev_b32 v12, 16, v77
  v_and_b32 v13, 0xffff0000, v77
  v_pk_add_f32 v[26:27], v[26:27], v[12:13]
  v_lshlrev_b32 v12, 16, v78
  v_and_b32 v13, 0xffff0000, v78
  v_pk_add_f32 v[28:29], v[28:29], v[12:13]
  v_lshlrev_b32 v12, 16, v79
  v_and_b32 v13, 0xffff0000, v79
  v_pk_add_f32 v[30:31], v[30:31], v[12:13]
  v_lshlrev_b32 v12, 16, v80
  v_and_b32 v13, 0xffff0000, v80
  v_pk_add_f32 v[32:33], v[32:33], v[12:13]
  v_lshlrev_b32 v12, 16, v81
  v_and_b32 v13, 0xffff0000, v81
  v_pk_add_f32 v[34:35], v[34:35], v[12:13]
  v_lshlrev_b32 v12, 16, v82
  v_and_b32 v13, 0xffff0000, v82
  v_pk_add_f32 v[36:37], v[36:37], v[12:13]
  v_lshlrev_b32 v12, 16, v83
  v_and_b32 v13, 0xffff0000, v83
  v_pk_add_f32 v[38:39], v[38:39], v[12:13]
  v_lshlrev_b32 v12, 16, v84
  v_and_b32 v13, 0xffff0000, v84
  v_pk_add_f32 v[16:17], v[16:17], v[12:13]
  v_lshlrev_b32 v12, 16, v85
  v_and_b32 v13, 0xffff0000, v85
  v_pk_add_f32 v[18:19], v[18:19], v[12:13]
  v_lshlrev_b32 v12, 16, v86
  v_and_b32 v13, 0xffff0000, v86
  v_pk_add_f32 v[20:21], v[20:21], v[12:13]
  v_lshlrev_b32 v12, 16, v87
  v_and_b32 v13, 0xffff0000, v87
  v_pk_add_f32 v[22:23], v[22:23], v[12:13]
  v_lshlrev_b32 v12, 16, v88
  v_and_b32 v13, 0xffff0000, v88
  v_pk_add_f32 v[24:25], v[24:25], v[12:13]
  v_lshlrev_b32 v12, 16, v89
  v_and_b32 v13, 0xffff0000, v89
  v_pk_add_f32 v[26:27], v[26:27], v[12:13]
  v_lshlrev_b32 v12, 16, v90
  v_and_b32 v13, 0xffff0000, v90
  v_pk_add_f32 v[28:29], v[28:29], v[12:13]
  v_lshlrev_b32 v12, 16, v91
  v_and_b32 v13, 0xffff0000, v91
  v_pk_add_f32 v[30:31], v[30:31], v[12:13]
  v_lshlrev_b32 v12, 16, v92
  v_and_b32 v13, 0xffff0000, v92
  v_pk_add_f32 v[32:33], v[32:33], v[12:13]
  v_lshlrev_b32 v12, 16, v93
  v_and_b32 v13, 0xffff0000, v93
  v_pk_add_f32 v[34:35], v[34:35], v[12:13]
  v_lshlrev_b32 v12, 16, v94
  v_and_b32 v13, 0xffff0000, v94
  v_pk_add_f32 v[36:37], v[36:37], v[12:13]
  v_lshlrev_b32 v12, 16, v95
  v_and_b32 v13, 0xffff0000, v95
  v_pk_add_f32 v[38:39], v[38:39], v[12:13]
  s_add_u32 s30, s28, 20971520
  buffer_store_dwordx4 v[16:19], v9, s[8:11], s30 offen sc1
  s_add_u32 s30, s28, 20972544
  buffer_store_dwordx4 v[20:23], v9, s[8:11], s30 offen sc1
  s_add_u32 s30, s28, 21004288
  buffer_store_dwordx4 v[24:27], v9, s[8:11], s30 offen sc1
  s_add_u32 s30, s28, 21005312
  buffer_store_dwordx4 v[28:31], v9, s[8:11], s30 offen sc1
  s_cmp_lt_u32 s21, 2
  s_cbranch_scc0 g3_101
  s_add_u32 s30, s28, 21037056
  buffer_store_dwordx4 v[32:35], v9, s[8:11], s30 offen sc1
  s_add_u32 s30, s28, 21038080
  buffer_store_dwordx4 v[36:39], v9, s[8:11], s30 offen sc1
g3_101:
  v_add_f32 v12, v16, v17
  v_add_f32 v12, v12, v18
  v_add_f32 v12, v12, v19
  v_add_f32 v12, v12, v20
  v_add_f32 v12, v12, v21
  v_add_f32 v12, v12, v22
  v_add_f32 v12, v12, v23
  v_add_f32 v12, v12, v24
  v_add_f32 v12, v12, v25
  v_add_f32 v12, v12, v26
  v_add_f32 v12, v12, v27
  v_add_f32 v12, v12, v28
  v_add_f32 v12, v12, v29
  v_add_f32 v12, v12, v30
  v_add_f32 v12, v12, v31
  v_add_f32 v12, v12, v32
  v_add_f32 v12, v12, v33
  v_add_f32 v12, v12, v34
  v_add_f32 v12, v12, v35
  v_add_f32 v12, v12, v36
  v_add_f32 v12, v12, v37
  v_add_f32 v12, v12, v38
  v_add_f32 v12, v12, v39
  s_nop 1
  v_add_f32_dpp v12, v12, v12 row_ror:8 row_mask:0xf bank_mask:0xf
  v_mov_b32 v13, v12
  s_nop 1
  v_permlane16_swap_b32 v12, v13
  v_add_f32 v12, v12, v13
  v_mov_b32 v13, v12
  s_nop 1
  v_permlane32_swap_b32 v12, v13
  v_add_f32 v12, v12, v13
  v_lshlrev_b32 v14, 2, v5
  v_add_u32 v14, 131072, v14
  s_lshl_b32 s30, s21, 5
  v_add_u32 v15, s30, v14
  ds_write_b32 v15, v12
  s_waitcnt lgkmcnt(0)
  s_barrier
  ds_read_b32 v48, v14
  ds_read_b32 v49, v14 offset:32
  ds_read_b32 v50, v14 offset:64
  ds_read_b32 v51, v14 offset:96
  s_waitcnt lgkmcnt(0)
  v_add_f32 v48, v48, v49
  v_add_f32 v50, v50, v51
  v_add_f32 v48, v48, v50
  v_mul_f32 v48, 0x3acccccd, v48
  v_sub_f32 v56, v16, v48
  v_sub_f32 v57, v17, v48
  v_sub_f32 v58, v18, v48
  v_sub_f32 v59, v19, v48
  v_sub_f32 v60, v20, v48
  v_sub_f32 v61, v21, v48
  v_sub_f32 v62, v22, v48
  v_sub_f32 v63, v23, v48
  v_sub_f32 v64, v24, v48
  v_sub_f32 v65, v25, v48
  v_sub_f32 v66, v26, v48
  v_sub_f32 v67, v27, v48
  v_sub_f32 v68, v28, v48
  v_sub_f32 v69, v29, v48
  v_sub_f32 v70, v30, v48
  v_sub_f32 v71, v31, v48
  v_sub_f32 v72, v32, v48
  v_sub_f32 v73, v33, v48
  v_sub_f32 v74, v34, v48
  v_sub_f32 v75, v35, v48
  v_sub_f32 v76, v36, v48
  v_sub_f32 v77, v37, v48
  v_sub_f32 v78, v38, v48
  v_sub_f32 v79, v39, v48
  s_cmp_lt_u32 s21, 2
  s_cbranch_scc1 g3z_102
  v_mov_b32 v72, 0
  v_mov_b32 v73, 0
  v_mov_b32 v74, 0
  v_mov_b32 v75, 0
  v_mov_b32 v76, 0
  v_mov_b32 v77, 0
  v_mov_b32 v78, 0
  v_mov_b32 v79, 0
g3z_102:
  v_mul_f32 v12, v56, v56
  v_fmac_f32 v12, v57, v57
  v_fmac_f32 v12, v58, v58
  v_fmac_f32 v12, v59, v59
  v_fmac_f32 v12, v60, v60
  v_fmac_f32 v12, v61, v61
  v_fmac_f32 v12, v62, v62
  v_fmac_f32 v12, v63, v63
  v_fmac_f32 v12, v64, v64
  v_fmac_f32 v12, v65, v65
  v_fmac_f32 v12, v66, v66
  v_fmac_f32 v12, v67, v67
  v_fmac_f32 v12, v68, v68
  v_fmac_f32 v12, v69, v69
  v_fmac_f32 v12, v70, v70
  v_fmac_f32 v12, v71, v71
  v_fmac_f32 v12, v72, v72
  v_fmac_f32 v12, v73, v73
  v_fmac_f32 v12, v74, v74
  v_fmac_f32 v12, v75, v75
  v_fmac_f32 v12, v76, v76
  v_fmac_f32 v12, v77, v77
  v_fmac_f32 v12, v78, v78
  v_fmac_f32 v12, v79, v79
  s_nop 1
  v_add_f32_dpp v12, v12, v12 row_ror:8 row_mask:0xf bank_mask:0xf
  v_mov_b32 v13, v12
  s_nop 1
  v_permlane16_swap_b32 v12, v13
  v_add_f32 v12, v12, v13
  v_mov_b32 v13, v12
  s_nop 1
  v_permlane32_swap_b32 v12, v13
  v_add_f32 v12, v12, v13
  v_lshlrev_b32 v14, 2, v5
  v_add_u32 v14, 131328, v14
  s_lshl_b32 s30, s21, 5
  v_add_u32 v15, s30, v14
  ds_write_b32 v15, v12
  s_waitcnt lgkmcnt(0)
  s_barrier
  ds_read_b32 v48, v14
  ds_read_b32 v49, v14 offset:32
  ds_read_b32 v50, v14 offset:64
  ds_read_b32 v51, v14 offset:96
  s_waitcnt lgkmcnt(0)
  v_add_f32 v48, v48, v49
  v_add_f32 v50, v50, v51
  v_add_f32 v48, v48, v50
  v_mov_b32 v49, 0x3727c5ac
  v_fmac_f32 v49, 0x3acccccd, v48
  v_rsq_f32 v49, v49
  s_nop 0
  v_mul_f32 v56, v56, v49
  v_mul_f32 v57, v57, v49
  v_mul_f32 v58, v58, v49
  v_mul_f32 v59, v59, v49
  v_mul_f32 v60, v60, v49
  v_mul_f32 v61, v61, v49
  v_mul_f32 v62, v62, v49
  v_mul_f32 v63, v63, v49
  v_mul_f32 v64, v64, v49
  v_mul_f32 v65, v65, v49
  v_mul_f32 v66, v66, v49
  v_mul_f32 v67, v67, v49
  v_mul_f32 v68, v68, v49
  v_mul_f32 v69, v69, v49
  v_mul_f32 v70, v70, v49
  v_mul_f32 v71, v71, v49
  v_mul_f32 v72, v72, v49
  v_mul_f32 v73, v73, v49
  v_mul_f32 v74, v74, v49
  v_mul_f32 v75, v75, v49
  v_mul_f32 v76, v76, v49
  v_mul_f32 v77, v77, v49
  v_mul_f32 v78, v78, v49
  v_mul_f32 v79, v79, v49
  v_cvt_pk_bf16_f32 v80, v56, v57
  v_cvt_pk_bf16_f32 v81, v58, v59
  v_cvt_pk_bf16_f32 v82, v60, v61
  v_cvt_pk_bf16_f32 v83, v62, v63
  v_cvt_pk_bf16_f32 v84, v64, v65
  v_cvt_pk_bf16_f32 v85, v66, v67
  v_cvt_pk_bf16_f32 v86, v68, v69
  v_cvt_pk_bf16_f32 v87, v70, v71
  v_cvt_pk_bf16_f32 v88, v72, v73
  v_cvt_pk_bf16_f32 v89, v74, v75
  v_cvt_pk_bf16_f32 v90, v76, v77
  v_cvt_pk_bf16_f32 v91, v78, v79
  s_mul_i32 s30, s26, 40960
  s_lshl_b32 s31, s21, 12
  s_add_u32 s30, s30, s31
  s_add_u32 s30, s30, 0x100000
  s_add_u32 s31, s30, 0
  buffer_store_dwordx4 v[80:83], v10, s[8:11], s31 offen sc1
  s_add_u32 s31, s30, 16384
  buffer_store_dwordx4 v[84:87], v10, s[8:11], s31 offen sc1
  s_cmp_lt_u32 s21, 2
  s_cbranch_scc0 g3_103
  s_add_u32 s31, s30, 32768
  buffer_store_dwordx4 v[88:91], v10, s[8:11], s31 offen sc1
g3_103:
  s_waitcnt vmcnt(0)
  s_barrier
  s_cmp_eq_u32 s21, 0
  s_cbranch_scc0 arr_104
  s_mov_b64 s[24:25], exec
  s_mov_b64 exec, 1
  v_mov_b32 v3, 0
  v_mov_b32 v4, 1
  buffer_atomic_add v4, v3, s[8:11], s46 offen
  s_mov_b64 exec, s[24:25]
arr_104:
  s_mov_b32 s45, 0
  v_mov_b32 v3, 0
aw_105:
  buffer_load_dword v4, v3, s[8:11], s46 offen sc1
  s_add_u32 s45, s45, 1
  s_waitcnt vmcnt(0)
  v_readfirstlane_b32 s29, v4
  s_cmp_ge_u32 s29, 32
  s_cbranch_scc1 aw_105_ok
  s_cmp_lt_u32 s45, 400000
  s_cbranch_scc1 aw_105
  s_branch kb2_abort
aw_105_ok:
  s_barrier
  s_lshl_b32 s26, s23, 3
  s_lshl_b32 s27, s21, 1
  s_add_u32 s24, s26, s27
  s_mul_i32 s27, s24, 40960
  s_add_u32 s27, s27, 0x100000
  s_add_u32 s28, s27, 40960
  v_mov_b32 v3, v2
  v_add_u32 v4, 65536, v2
  v_lshlrev_b32 v5, 7, v1
  s_add_u32 s29, s27, 0
  buffer_load_dword v10, v5, s[8:11], s29 offen sc1
  s_add_u32 s29, s27, 8192
  buffer_load_dword v10, v5, s[8:11], s29 offen sc1
  s_add_u32 s29, s27, 16384
  buffer_load_dword v10, v5, s[8:11], s29 offen sc1
  s_add_u32 s29, s27, 24576
  buffer_load_dword v10, v5, s[8:11], s29 offen sc1
  s_add_u32 s29, s27, 32768
  buffer_load_dword v10, v5, s[8:11], s29 offen sc1
  s_add_u32 s29, s27, 40960
  buffer_load_dword v10, v5, s[8:11], s29 offen sc1
  s_add_u32 s29, s27, 49152
  buffer_load_dword v10, v5, s[8:11], s29 offen sc1
  s_add_u32 s29, s27, 57344
  buffer_load_dword v10, v5, s[8:11], s29 offen sc1
  s_add_u32 s29, s27, 65536
  buffer_load_dword v10, v5, s[8:11], s29 offen sc1
  s_add_u32 s29, s27, 73728
  buffer_load_dword v10, v5, s[8:11], s29 offen sc1
  s_mov_b32 s30, 0x3ea52b5c
  v_mov_b32 v5, 0
  v_cmp_gt_u32 s[34:35], 32, v1
  v_mov_b32 v6, 1.0
  v_and_b32 v7, 31, v1
  v_cndmask_b32 v6, v5, v6, s[34:35]
  v_cmp_eq_u32 s[32:33], 20, v7
  v_mov_b32 v8, 1.0
  s_lshl_b32 s31, s22, 6
  s_add_u32 s31, s31, s24
  s_lshl_b32 s31, s31, 11
  v_mov_b32 v9, 0
  s_add_u32 s29, s27, 0
  buffer_load_dwordx4 v[16:19], v2, s[8:11], s29 offen sc1
  s_add_u32 s29, s27, 1024
  buffer_load_dwordx4 v[20:23], v2, s[8:11], s29 offen sc1
  s_add_u32 s29, s27, 2048
  buffer_load_dwordx4 v[24:27], v2, s[8:11], s29 offen sc1
  s_add_u32 s29, s27, 3072
  buffer_load_dwordx4 v[28:31], v2, s[8:11], s29 offen sc1
  s_add_u32 s29, s27, 4096
  buffer_load_dwordx4 v[32:35], v2, s[8:11], s29 offen sc1
  s_add_u32 s29, s27, 5120
  buffer_load_dwordx4 v[36:39], v2, s[8:11], s29 offen sc1
  s_add_u32 s29, s27, 6144
  buffer_load_dwordx4 v[40:43], v2, s[8:11], s29 offen sc1
  s_add_u32 s29, s27, 7168
  buffer_load_dwordx4 v[44:47], v2, s[8:11], s29 offen sc1
  s_add_u32 s29, s27, 8192
  buffer_load_dwordx4 v[48:51], v2, s[8:11], s29 offen sc1
  s_add_u32 s29, s27, 9216
  buffer_load_dwordx4 v[52:55], v2, s[8:11], s29 offen sc1
  s_add_u32 s29, s27, 10240
  buffer_load_dwordx4 v[56:59], v2, s[8:11], s29 offen sc1
  s_add_u32 s29, s27, 11264
  buffer_load_dwordx4 v[60:63], v2, s[8:11], s29 offen sc1
  s_add_u32 s29, s27, 12288
  buffer_load_dwordx4 v[64:67], v2, s[8:11], s29 offen sc1
  s_add_u32 s29, s27, 13312
  buffer_load_dwordx4 v[68:71], v2, s[8:11], s29 offen sc1
  s_add_u32 s29, s27, 14336
  buffer_load_dwordx4 v[72:75], v2, s[8:11], s29 offen sc1
  ds_read_b128 v[208:211], v3 offset:0
  ds_read_b128 v[212:215], v3 offset:40960
  ds_read_b128 v[216:219], v4 offset:16384
  s_add_u32 s29, s27, 15360
  buffer_load_dwordx4 v[76:79], v2, s[8:11], s29 offen sc1
  ds_read_b128 v[220:223], v3 offset:1024
  ds_read_b128 v[224:227], v3 offset:41984
  ds_read_b128 v[228:231], v4 offset:17408
  s_waitcnt lgkmcnt(3)
  s_waitcnt vmcnt(15)
  v_mfma_f32_32x32x16_bf16 v[80:95], v[208:211], v[16:19], 0
  v_mfma_f32_32x32x16_bf16 v[96:111], v[212:215], v[16:19], 0
  v_mfma_f32_32x32x16_bf16 v[112:127], v[16:19], v[216:219], 0
  s_add_u32 s29, s27, 16384
  buffer_load_dwordx4 v[16:19], v2, s[8:11], s29 offen sc1
  ds_read_b128 v[208:211], v3 offset:2048
  ds_read_b128 v[212:215], v3 offset:43008
  ds_read_b128 v[216:219], v4 offset:18432
  s_waitcnt lgkmcnt(3)
  s_waitcnt vmcnt(15)
  v_mfma_f32_32x32x16_bf16 v[80:95], v[220:223], v[20:23], v[80:95]
  v_mfma_f32_32x32x16_bf16 v[96:111], v[224:227], v[20:23], v[96:111]
  v_mfma_f32_32x32x16_bf16 v[112:127], v[20:23], v[228:231], v[112:127]
  s_add_u32 s29, s27, 17408
  buffer_load_dwordx4 v[20:23], v2, s[8:11], s29 offen sc1
  ds_read_b128 v[220:223], v3 offset:3072
  ds_read_b128 v[224:227], v3 offset:44032
  ds_read_b128 v[228:231], v4 offset:19456
  s_waitcnt lgkmcnt(3)
  s_waitcnt vmcnt(15)
  v_mfma_f32_32x32x16_bf16 v[80:95], v[208:211], v[24:27], v[80:95]
  v_mfma_f32_32x32x16_bf16 v[96:111], v[212:215], v[24:27], v[96:111]
  v_mfma_f32_32x32x16_bf16 v[112:127], v[24:27], v[216:219], v[112:127]
  s_add_u32 s29, s27, 18432
  buffer_load_dwordx4 v[24:27], v2, s[8:11], s29 offen sc1
  ds_read_b128 v[208:211], v3 offset:4096
  ds_read_b128 v[212:215], v3 offset:45056
  ds_read_b128 v[216:219], v4 offset:20480
  s_waitcnt lgkmcnt(3)
  s_waitcnt vmcnt(15)
  v_mfma_f32_32x32x16_bf16 v[80:95], v[220:223], v[28:31], v[80:95]
  v_mfma_f32_32x32x16_bf16 v[96:111], v[224:227], v[28:31], v[96:111]
  v_mfma_f32_32x32x16_bf16 v[112:127], v[28:31], v[228:231], v[112:127]
  s_add_u32 s29, s27, 19456
  buffer_load_dwordx4 v[28:31], v2, s[8:11], s29 offen sc1
  ds_read_b128 v[220:223], v3 offset:5120
  ds_read_b128 v[224:227], v3 offset:46080
  ds_read_b128 v[228:231], v4 offset:21504
  s_waitcnt lgkmcnt(3)
  s_waitcnt vmcnt(15)
  v_mfma_f32_32x32x16_bf16 v[80:95], v[208:211], v[32:35], v[80:95]
  v_mfma_f32_32x32x16_bf16 v[96:111], v[212:215], v[32:35], v[96:111]
  v_mfma_f32_32x32x16_bf16 v[112:127], v[32:35], v[216:219], v[112:127]
  s_add_u32 s29, s27, 20480
  buffer_load_dwordx4 v[32:35], v2, s[8:11], s29 offen sc1
  ds_read_b128 v[208:211], v3 offset:6144
  ds_read_b128 v[212:215], v3 offset:47104
  ds_read_b128 v[216:219], v4 offset:22528
  s_waitcnt lgkmcnt(3)
  s_waitcnt vmcnt(15)
  v_mfma_f32_32x32x16_bf16 v[80:95], v[220:223], v[36:39], v[80:95]
  v_mfma_f32_32x32x16_bf16 v[96:111], v[224:227], v[36:39], v[96:111]
  v_mfma_f32_32x32x16_bf16 v[112:127], v[36:39], v[228:231], v[112:127]
  s_add_u32 s29, s27, 21504
  buffer_load_dwordx4 v[36:39], v2, s[8:11], s29 offen sc1
  ds_read_b128 v[220:223], v3 offset:7168
  ds_read_b128 v[224:227], v3 offset:48128
  ds_read_b128 v[228:231], v4 offset:23552
  s_waitcnt lgkmcnt(3)
  s_waitcnt vmcnt(15)
  v_mfma_f32_32x32x16_bf16 v[80:95], v[208:211], v[40:43], v[80:95]
  v_mfma_f32_32x32x16_bf16 v[96:111], v[212:215], v[40:43], v[96:111]
  v_mfma_f32_32x32x16_bf16 v[112:127], v[40:43], v[216:219], v[112:127]
  s_add_u32 s29, s27, 22528
  buffer_load_dwordx4 v[40:43], v2, s[8:11], s29 offen sc1
  ds_read_b128 v[208:211], v3 offset:8192
  ds_read_b128 v[212:215], v3 offset:49152
  ds_read_b128 v[216:219], v4 offset:24576
  s_waitcnt lgkmcnt(3)
  s_waitcnt vmcnt(15)
  v_mfma_f32_32x32x16_bf16 v[80:95], v[220:223], v[44:47], v[80:95]
  v_mfma_f32_32x32x16_bf16 v[96:111], v[224:227], v[44:47], v[96:111]
  v_mfma_f32_32x32x16_bf16 v[112:127], v[44:47], v[228:231], v[112:127]
  s_add_u32 s29, s27, 23552
  buffer_load_dwordx4 v[44:47], v2, s[8:11], s29 offen sc1
  ds_read_b128 v[220:223], v3 offset:9216
  ds_read_b128 v[224:227], v3 offset:50176
  ds_read_b128 v[228:231], v4 offset:25600
  s_waitcnt lgkmcnt(3)
  s_waitcnt vmcnt(15)
  v_mfma_f32_32x32x16_bf16 v[80:95], v[208:211], v[48:51], v[80:95]
  v_mfma_f32_32x32x16_bf16 v[96:111], v[212:215], v[48:51], v[96:111]
  v_mfma_f32_32x32x16_bf16 v[112:127], v[48:51], v[216:219], v[112:127]
  s_add_u32 s29, s27, 24576
  buffer_load_dwordx4 v[48:51], v2, s[8:11], s29 offen sc1
  ds_read_b128 v[208:211], v3 offset:10240
  ds_read_b128 v[212:215], v3 offset:51200
  ds_read_b128 v[216:219], v4 offset:26624
  s_waitcnt lgkmcnt(3)
  s_waitcnt vmcnt(15)
  v_mfma_f32_32x32x16_bf16 v[80:95], v[220:223], v[52:55], v[80:95]
  v_mfma_f32_32x32x16_bf16 v[96:111], v[224:227], v[52:55], v[96:111]
  v_mfma_f32_32x32x16_bf16 v[112:127], v[52:55], v[228:231], v[112:127]
  s_add_u32 s29, s27, 25600
  buffer_load_dwordx4 v[52:55], v2, s[8:11], s29 offen sc1
  ds_read_b128 v[220:223], v3 offset:11264
  ds_read_b128 v[224:227], v3 offset:52224
  ds_read_b128 v[228:231], v4 offset:27648
  s_waitcnt lgkmcnt(3)
  s_waitcnt vmcnt(15)
  v_mfma_f32_32x32x16_bf16 v[80:95], v[208:211], v[56:59], v[80:95]
  v_mfma_f32_32x32x16_bf16 v[96:111], v[212:215], v[56:59], v[96:111]
  v_mfma_f32_32x32x16_bf16 v[112:127], v[56:59], v[216:219], v[112:127]
  s_add_u32 s29, s27, 26624
  buffer_load_dwordx4 v[56:59], v2, s[8:11], s29 offen sc1
  ds_read_b128 v[208:211], v3 offset:12288
  ds_read_b128 v[212:215], v3 offset:53248
  ds_read_b128 v[216:219], v4 offset:28672
  s_waitcnt lgkmcnt(3)
  s_waitcnt vmcnt(15)
  v_mfma_f32_32x32x16_bf16 v[80:95], v[220:223], v[60:63], v[80:95]
  v_mfma_f32_32x32x16_bf16 v[96:111], v[224:227], v[60:63], v[96:111]
  v_mfma_f32_32x32x16_bf16 v[112:127], v[60:63], v[228:231], v[112:127]
  s_add_u32 s29, s27, 27648
  buffer_load_dwordx4 v[60:63], v2, s[8:11], s29 offen sc1
  ds_read_b128 v[220:223], v3 offset:13312
  ds_read_b128 v[224:227], v3 offset:54272
  ds_read_b128 v[228:231], v4 offset:29696
  s_waitcnt lgkmcnt(3)
  s_waitcnt vmcnt(15)
  v_mfma_f32_32x32x16_bf16 v[80:95], v[208:211], v[64:67], v[80:95]
  v_mfma_f32_32x32x16_bf16 v[96:111], v[212:215], v[64:67], v[96:111]
  v_mfma_f32_32x32x16_bf16 v[112:127], v[64:67], v[216:219], v[112:127]
  s_add_u32 s29, s27, 28672
  buffer_load_dwordx4 v[64:67], v2, s[8:11], s29 offen sc1
  ds_read_b128 v[208:211], v3 offset:14336
  ds_read_b128 v[212:215], v3 offset:55296
  ds_read_b128 v[216:219], v4 offset:30720
  s_waitcnt lgkmcnt(3)
  s_waitcnt vmcnt(15)
  v_mfma_f32_32x32x16_bf16 v[80:95], v[220:223], v[68:71], v[80:95]
  v_mfma_f32_32x32x16_bf16 v[96:111], v[224:227], v[68:71], v[96:111]
  v_mfma_f32_32x32x16_bf16 v[112:127], v[68:71], v[228:231], v[112:127]
  s_add_u32 s29, s27, 29696
  buffer_load_dwordx4 v[68:71], v2, s[8:11], s29 offen sc1
  ds_read_b128 v[220:223], v3 offset:15360
  ds_read_b128 v[224:227], v3 offset:56320
  ds_read_b128 v[228:231], v4 offset:31744
  s_waitcnt lgkmcnt(3)
  s_waitcnt vmcnt(15)
  v_mfma_f32_32x32x16_bf16 v[80:95], v[208:211], v[72:75], v[80:95]
  v_mfma_f32_32x32x16_bf16 v[96:111], v[212:215], v[72:75], v[96:111]
  v_mfma_f32_32x32x16_bf16 v[112:127], v[72:75], v[216:219], v[112:127]
  s_add_u32 s29, s27, 30720
  buffer_load_dwordx4 v[72:75], v2, s[8:11], s29 offen sc1
  ds_read_b128 v[208:211], v3 offset:16384
  ds_read_b128 v[212:215], v3 offset:57344
  ds_read_b128 v[216:219], v4 offset:32768
  s_waitcnt lgkmcnt(3)
  s_waitcnt vmcnt(15)
  v_mfma_f32_32x32x16_bf16 v[80:95], v[220:223], v[76:79], v[80:95]
  v_mfma_f32_32x32x16_bf16 v[96:111], v[224:227], v[76:79], v[96:111]
  v_mfma_f32_32x32x16_bf16 v[112:127], v[76:79], v[228:231], v[112:127]
  s_add_u32 s29, s27, 31744
  buffer_load_dwordx4 v[76:79], v2, s[8:11], s29 offen sc1
  ds_read_b128 v[220:223], v3 offset:17408
  ds_read_b128 v[224:227], v3 offset:58368
  ds_read_b128 v[228:231], v4 offset:33792
  s_waitcnt lgkmcnt(3)
  s_waitcnt vmcnt(15)
  v_mfma_f32_32x32x16_bf16 v[80:95], v[208:211], v[16:19], v[80:95]
  v_mfma_f32_32x32x16_bf16 v[96:111], v[212:215], v[16:19], v[96:111]
  v_mfma_f32_32x32x16_bf16 v[112:127], v[16:19], v[216:219], v[112:127]
  s_add_u32 s29, s27, 32768
  buffer_load_dwordx4 v[16:19], v2, s[8:11], s29 offen sc1
  ds_read_b128 v[208:211], v3 offset:18432
  ds_read_b128 v[212:215], v3 offset:59392
  ds_read_b128 v[216:219], v4 offset:34816
  s_waitcnt lgkmcnt(3)
  s_waitcnt vmcnt(15)
  v_mfma_f32_32x32x16_bf16 v[80:95], v[220:223], v[20:23], v[80:95]
  v_mfma_f32_32x32x16_bf16 v[96:111], v[224:227], v[20:23], v[96:111]
  v_mfma_f32_32x32x16_bf16 v[112:127], v[20:23], v[228:231], v[112:127]
  s_add_u32 s29, s27, 33792
  buffer_load_dwordx4 v[20:23], v2, s[8:11], s29 offen sc1
  ds_read_b128 v[220:223], v3 offset:19456
  ds_read_b128 v[224:227], v3 offset:60416
  ds_read_b128 v[228:231], v4 offset:35840
  s_waitcnt lgkmcnt(3)
  s_waitcnt vmcnt(15)
  v_mfma_f32_32x32x16_bf16 v[80:95], v[208:211], v[24:27], v[80:95]
  v_mfma_f32_32x32x16_bf16 v[96:111], v[212:215], v[24:27], v[96:111]
  v_mfma_f32_32x32x16_bf16 v[112:127], v[24:27], v[216:219], v[112:127]
  s_add_u32 s29, s27, 34816
  buffer_load_dwordx4 v[24:27], v2, s[8:11], s29 offen sc1
  ds_read_b128 v[208:211], v3 offset:20480
  ds_read_b128 v[212:215], v3 offset:61440
  ds_read_b128 v[216:219], v4 offset:36864
  s_waitcnt lgkmcnt(3)
  s_waitcnt vmcnt(15)
  v_mfma_f32_32x32x16_bf16 v[80:95], v[220:223], v[28:31], v[80:95]
  v_mfma_f32_32x32x16_bf16 v[96:111], v[224:227], v[28:31], v[96:111]
  v_mfma_f32_32x32x16_bf16 v[112:127], v[28:31], v[228:231], v[112:127]
  s_add_u32 s29, s27, 35840
  buffer_load_dwordx4 v[28:31], v2, s[8:11], s29 offen sc1
  ds_read_b128 v[220:223], v3 offset:21504
  ds_read_b128 v[224:227], v3 offset:62464
  ds_read_b128 v[228:231], v4 offset:37888
  s_waitcnt lgkmcnt(3)
  s_waitcnt vmcnt(15)
  v_mfma_f32_32x32x16_bf16 v[80:95], v[208:211], v[32:35], v[80:95]
  v_mfma_f32_32x32x16_bf16 v[96:111], v[212:215], v[32:35], v[96:111]
  v_mfma_f32_32x32x16_bf16 v[112:127], v[32:35], v[216:219], v[112:127]
  s_add_u32 s29, s27, 36864
  buffer_load_dwordx4 v[32:35], v2, s[8:11], s29 offen sc1
  ds_read_b128 v[208:211], v3 offset:22528
  ds_read_b128 v[212:215], v3 offset:63488
  ds_read_b128 v[216:219], v4 offset:38912
  s_waitcnt lgkmcnt(3)
  s_waitcnt vmcnt(15)
  v_mfma_f32_32x32x16_bf16 v[80:95], v[220:223], v[36:39], v[80:95]
  v_mfma_f32_32x32x16_bf16 v[96:111], v[224:227], v[36:39], v[96:111]
  v_mfma_f32_32x32x16_bf16 v[112:127], v[36:39], v[228:231], v[112:127]
  s_add_u32 s29, s27, 37888
  buffer_load_dwordx4 v[36:39], v2, s[8:11], s29 offen sc1
  ds_read_b128 v[220:223], v3 offset:23552
  ds_read_b128 v[224:227], v3 offset:64512
  ds_read_b128 v[228:231], v4 offset:39936
  s_waitcnt lgkmcnt(3)
  s_waitcnt vmcnt(15)
  v_mfma_f32_32x32x16_bf16 v[80:95], v[208:211], v[40:43], v[80:95]
  v_mfma_f32_32x32x16_bf16 v[96:111], v[212:215], v[40:43], v[96:111]
  v_mfma_f32_32x32x16_bf16 v[112:127], v[40:43], v[216:219], v[112:127]
  s_add_u32 s29, s27, 38912
  buffer_load_dwordx4 v[40:43], v2, s[8:11], s29 offen sc1
  ds_read_b128 v[208:211], v3 offset:24576
  ds_read_b128 v[212:215], v4 offset:0
  ds_read_b128 v[216:219], v4 offset:40960
  s_waitcnt lgkmcnt(3)
  s_waitcnt vmcnt(15)
  v_mfma_f32_32x32x16_bf16 v[80:95], v[220:223], v[44:47], v[80:95]
  v_mfma_f32_32x32x16_bf16 v[96:111], v[224:227], v[44:47], v[96:111]
  v_mfma_f32_32x32x16_bf16 v[112:127], v[44:47], v[228:231], v[112:127]
  s_add_u32 s29, s27, 39936
  buffer_load_dwordx4 v[44:47], v2, s[8:11], s29 offen sc1
  ds_read_b128 v[220:223], v3 offset:25600
  ds_read_b128 v[224:227], v4 offset:1024
  ds_read_b128 v[228:231], v4 offset:41984
  s_waitcnt lgkmcnt(3)
  s_waitcnt vmcnt(15)
  v_mfma_f32_32x32x16_bf16 v[80:95], v[208:211], v[48:51], v[80:95]
  v_mfma_f32_32x32x16_bf16 v[96:111], v[212:215], v[48:51], v[96:111]
  v_mfma_f32_32x32x16_bf16 v[112:127], v[48:51], v[216:219], v[112:127]
  s_add_u32 s29, s28, 0
  buffer_load_dwordx4 v[48:51], v2, s[8:11], s29 offen sc1
  ds_read_b128 v[208:211], v3 offset:26624
  ds_read_b128 v[212:215], v4 offset:2048
  ds_read_b128 v[216:219], v4 offset:43008
  s_waitcnt lgkmcnt(3)
  s_waitcnt vmcnt(15)
  v_mfma_f32_32x32x16_bf16 v[80:95], v[220:223], v[52:55], v[80:95]
  v_mfma_f32_32x32x16_bf16 v[96:111], v[224:227], v[52:55], v[96:111]
  v_mfma_f32_32x32x16_bf16 v[112:127], v[52:55], v[228:231], v[112:127]
  s_add_u32 s29, s28, 1024
  buffer_load_dwordx4 v[52:55], v2, s[8:11], s29 offen sc1
  ds_read_b128 v[220:223], v3 offset:27648
  ds_read_b128 v[224:227], v4 offset:3072
  ds_read_b128 v[228:231], v4 offset:44032
  s_waitcnt lgkmcnt(3)
  s_waitcnt vmcnt(15)
  v_mfma_f32_32x32x16_bf16 v[80:95], v[208:211], v[56:59], v[80:95]
  v_mfma_f32_32x32x16_bf16 v[96:111], v[212:215], v[56:59], v[96:111]
  v_mfma_f32_32x32x16_bf16 v[112:127], v[56:59], v[216:219], v[112:127]
  s_add_u32 s29, s28, 2048
  buffer_load_dwordx4 v[56:59], v2, s[8:11], s29 offen sc1
  ds_read_b128 v[208:211], v3 offset:28672
  ds_read_b128 v[212:215], v4 offset:4096
  ds_read_b128 v[216:219], v4 offset:45056
  s_waitcnt lgkmcnt(3)
  s_waitcnt vmcnt(15)
  v_mfma_f32_32x32x16_bf16 v[80:95], v[220:223], v[60:63], v[80:95]
  v_mfma_f32_32x32x16_bf16 v[96:111], v[224:227], v[60:63], v[96:111]
  v_mfma_f32_32x32x16_bf16 v[112:127], v[60:63], v[228:231], v[112:127]
  s_add_u32 s29, s28, 3072
  buffer_load_dwordx4 v[60:63], v2, s[8:11], s29 offen sc1
  ds_read_b128 v[220:223], v3 offset:29696
  ds_read_b128 v[224:227], v4 offset:5120
  ds_read_b128 v[228:231], v4 offset:46080
  s_waitcnt lgkmcnt(3)
  s_waitcnt vmcnt(15)
  v_mfma_f32_32x32x16_bf16 v[80:95], v[208:211], v[64:67], v[80:95]
  v_mfma_f32_32x32x16_bf16 v[96:111], v[212:215], v[64:67], v[96:111]
  v_mfma_f32_32x32x16_bf16 v[112:127], v[64:67], v[216:219], v[112:127]
  s_add_u32 s29, s28, 4096
  buffer_load_dwordx4 v[64:67], v2, s[8:11], s29 offen sc1
  ds_read_b128 v[208:211], v3 offset:30720
  ds_read_b128 v[212:215], v4 offset:6144
  ds_read_b128 v[216:219], v4 offset:47104
  s_waitcnt lgkmcnt(3)
  s_waitcnt vmcnt(15)
  v_mfma_f32_32x32x16_bf16 v[80:95], v[220:223], v[68:71], v[80:95]
  v_mfma_f32_32x32x16_bf16 v[96:111], v[224:227], v[68:71], v[96:111]
  v_mfma_f32_32x32x16_bf16 v[112:127], v[68:71], v[228:231], v[112:127]
  s_add_u32 s29, s28, 5120
  buffer_load_dwordx4 v[68:71], v2, s[8:11], s29 offen sc1
  ds_read_b128 v[220:223], v3 offset:31744
  ds_read_b128 v[224:227], v4 offset:7168
  ds_read_b128 v[228:231], v4 offset:48128
  s_waitcnt lgkmcnt(3)
  s_waitcnt vmcnt(15)
  v_mfma_f32_32x32x16_bf16 v[80:95], v[208:211], v[72:75], v[80:95]
  v_mfma_f32_32x32x16_bf16 v[96:111], v[212:215], v[72:75], v[96:111]
  v_mfma_f32_32x32x16_bf16 v[112:127], v[72:75], v[216:219], v[112:127]
  s_add_u32 s29, s28, 6144
  buffer_load_dwordx4 v[72:75], v2, s[8:11], s29 offen sc1
  ds_read_b128 v[208:211], v3 offset:32768
  ds_read_b128 v[212:215], v4 offset:8192
  ds_read_b128 v[216:219], v4 offset:49152
  s_waitcnt lgkmcnt(3)
  s_waitcnt vmcnt(15)
  v_mfma_f32_32x32x16_bf16 v[80:95], v[220:223], v[76:79], v[80:95]
  v_mfma_f32_32x32x16_bf16 v[96:111], v[224:227], v[76:79], v[96:111]
  v_mfma_f32_32x32x16_bf16 v[112:127], v[76:79], v[228:231], v[112:127]
  s_add_u32 s29, s28, 7168
  buffer_load_dwordx4 v[76:79], v2, s[8:11], s29 offen sc1
  ds_read_b128 v[220:223], v3 offset:33792
  ds_read_b128 v[224:227], v4 offset:9216
  ds_read_b128 v[228:231], v4 offset:50176
  s_waitcnt lgkmcnt(3)
  s_waitcnt vmcnt(15)
  v_mfma_f32_32x32x16_bf16 v[80:95], v[208:211], v[16:19], v[80:95]
  v_mfma_f32_32x32x16_bf16 v[96:111], v[212:215], v[16:19], v[96:111]
  v_mfma_f32_32x32x16_bf16 v[112:127], v[16:19], v[216:219], v[112:127]
  s_add_u32 s29, s28, 8192
  buffer_load_dwordx4 v[16:19], v2, s[8:11], s29 offen sc1
  ds_read_b128 v[208:211], v3 offset:34816
  ds_read_b128 v[212:215], v4 offset:10240
  ds_read_b128 v[216:219], v4 offset:51200
  s_waitcnt lgkmcnt(3)
  s_waitcnt vmcnt(15)
  v_mfma_f32_32x32x16_bf16 v[80:95], v[220:223], v[20:23], v[80:95]
  v_mfma_f32_32x32x16_bf16 v[96:111], v[224:227], v[20:23], v[96:111]
  v_mfma_f32_32x32x16_bf16 v[112:127], v[20:23], v[228:231], v[112:127]
  s_add_u32 s29, s28, 9216
  buffer_load_dwordx4 v[20:23], v2, s[8:11], s29 offen sc1
  ds_read_b128 v[220:223], v3 offset:35840
  ds_read_b128 v[224:227], v4 offset:11264
  ds_read_b128 v[228:231], v4 offset:52224
  s_waitcnt lgkmcnt(3)
  s_waitcnt vmcnt(15)
  v_mfma_f32_32x32x16_bf16 v[80:95], v[208:211], v[24:27], v[80:95]
  v_mfma_f32_32x32x16_bf16 v[96:111], v[212:215], v[24:27], v[96:111]
  v_mfma_f32_32x32x16_bf16 v[112:127], v[24:27], v[216:219], v[112:127]
  s_add_u32 s29, s28, 10240
  buffer_load_dwordx4 v[24:27], v2, s[8:11], s29 offen sc1
  ds_read_b128 v[208:211], v3 offset:36864
  ds_read_b128 v[212:215], v4 offset:12288
  ds_read_b128 v[216:219], v4 offset:53248
  s_waitcnt lgkmcnt(3)
  s_waitcnt vmcnt(15)
  v_mfma_f32_32x32x16_bf16 v[80:95], v[220:223], v[28:31], v[80:95]
  v_mfma_f32_32x32x16_bf16 v[96:111], v[224:227], v[28:31], v[96:111]
  v_mfma_f32_32x32x16_bf16 v[112:127], v[28:31], v[228:231], v[112:127]
  s_add_u32 s29, s28, 11264
  buffer_load_dwordx4 v[28:31], v2, s[8:11], s29 offen sc1
  ds_read_b128 v[220:223], v3 offset:37888
  ds_read_b128 v[224:227], v4 offset:13312
  ds_read_b128 v[228:231], v4 offset:54272
  s_waitcnt lgkmcnt(3)
  s_waitcnt vmcnt(15)
  v_mfma_f32_32x32x16_bf16 v[80:95], v[208:211], v[32:35], v[80:95]
  v_mfma_f32_32x32x16_bf16 v[96:111], v[212:215], v[32:35], v[96:111]
  v_mfma_f32_32x32x16_bf16 v[112:127], v[32:35], v[216:219], v[112:127]
  s_add_u32 s29, s28, 12288
  buffer_load_dwordx4 v[32:35], v2, s[8:11], s29 offen sc1
  ds_read_b128 v[208:211], v3 offset:38912
  ds_read_b128 v[212:215], v4 offset:14336
  ds_read_b128 v[216:219], v4 offset:55296
  s_waitcnt lgkmcnt(3)
  s_waitcnt vmcnt(15)
  v_mfma_f32_32x32x16_bf16 v[80:95], v[220:223], v[36:39], v[80:95]
  v_mfma_f32_32x32x16_bf16 v[96:111], v[224:227], v[36:39], v[96:111]
  v_mfma_f32_32x32x16_bf16 v[112:127], v[36:39], v[228:231], v[112:127]
  s_add_u32 s29, s28, 13312
  buffer_load_dwordx4 v[36:39], v2, s[8:11], s29 offen sc1
  ds_read_b128 v[220:223], v3 offset:39936
  ds_read_b128 v[224:227], v4 offset:15360
  ds_read_b128 v[228:231], v4 offset:56320
  s_waitcnt lgkmcnt(3)
  s_waitcnt vmcnt(15)
  v_mfma_f32_32x32x16_bf16 v[80:95], v[208:211], v[40:43], v[80:95]
  v_mfma_f32_32x32x16_bf16 v[96:111], v[212:215], v[40:43], v[96:111]
  v_mfma_f32_32x32x16_bf16 v[112:127], v[40:43], v[216:219], v[112:127]
  s_add_u32 s29, s28, 14336
  buffer_load_dwordx4 v[40:43], v2, s[8:11], s29 offen sc1
  ds_read_b128 v[208:211], v3 offset:0
  ds_read_b128 v[212:215], v3 offset:40960
  ds_read_b128 v[216:219], v4 offset:16384
  s_waitcnt lgkmcnt(3)
  s_waitcnt vmcnt(15)
  v_mfma_f32_32x32x16_bf16 v[80:95], v[220:223], v[44:47], v[80:95]
  v_mfma_f32_32x32x16_bf16 v[96:111], v[224:227], v[44:47], v[96:111]
  v_mfma_f32_32x32x16_bf16 v[112:127], v[44:47], v[228:231], v[112:127]
  s_add_u32 s29, s28, 15360
  buffer_load_dwordx4 v[44:47], v2, s[8:11], s29 offen sc1
  ds_read_b128 v[220:223], v3 offset:1024
  ds_read_b128 v[224:227], v3 offset:41984
  ds_read_b128 v[228:231], v4 offset:17408
  s_waitcnt lgkmcnt(3)
  s_waitcnt vmcnt(15)
  v_mfma_f32_32x32x16_bf16 v[128:143], v[208:211], v[48:51], 0
  v_mfma_f32_32x32x16_bf16 v[144:159], v[212:215], v[48:51], 0
  v_mfma_f32_32x32x16_bf16 v[160:175], v[48:51], v[216:219], 0
  s_add_u32 s29, s28, 16384
  buffer_load_dwordx4 v[48:51], v2, s[8:11], s29 offen sc1
  ds_read_b128 v[208:211], v3 offset:2048
  ds_read_b128 v[212:215], v3 offset:43008
  ds_read_b128 v[216:219], v4 offset:18432
  s_waitcnt lgkmcnt(3)
  s_waitcnt vmcnt(15)
  v_mfma_f32_32x32x16_bf16 v[128:143], v[220:223], v[52:55], v[128:143]
  v_mfma_f32_32x32x16_bf16 v[144:159], v[224:227], v[52:55], v[144:159]
  v_mfma_f32_32x32x16_bf16 v[160:175], v[52:55], v[228:231], v[160:175]
  s_add_u32 s29, s28, 17408
  buffer_load_dwordx4 v[52:55], v2, s[8:11], s29 offen sc1
  ds_read_b128 v[220:223], v3 offset:3072
  ds_read_b128 v[224:227], v3 offset:44032
  ds_read_b128 v[228:231], v4 offset:19456
  s_waitcnt lgkmcnt(3)
  s_waitcnt vmcnt(15)
  v_mfma_f32_32x32x16_bf16 v[128:143], v[208:211], v[56:59], v[128:143]
  v_max3_f32 v9, v9, abs(v96), abs(v97)
  v_max3_f32 v9, v9, abs(v98), abs(v99)
  v_mfma_f32_32x32x16_bf16 v[144:159], v[212:215], v[56:59], v[144:159]
  v_max3_f32 v9, v9, abs(v100), abs(v101)
  v_max3_f32 v9, v9, abs(v102), abs(v103)
  v_mfma_f32_32x32x16_bf16 v[160:175], v[56:59], v[216:219], v[160:175]
  v_max3_f32 v9, v9, abs(v104), abs(v105)
  v_max3_f32 v9, v9, abs(v106), abs(v107)
  s_add_u32 s29, s28, 18432
  buffer_load_dwordx4 v[56:59], v2, s[8:11], s29 offen sc1
  ds_read_b128 v[208:211], v3 offset:4096
  ds_read_b128 v[212:215], v3 offset:45056
  ds_read_b128 v[216:219], v4 offset:20480
  s_waitcnt lgkmcnt(3)
  s_waitcnt vmcnt(15)
  v_mfma_f32_32x32x16_bf16 v[128:143], v[220:223], v[60:63], v[128:143]
  v_max3_f32 v9, v9, abs(v108), abs(v109)
  v_max3_f32 v9, v9, abs(v110), abs(v111)
  v_mfma_f32_32x32x16_bf16 v[144:159], v[224:227], v[60:63], v[144:159]
  v_add_f32 v108, v108, v6
  v_cvt_pk_bf16_f32 v232, v96, v97
  v_mfma_f32_32x32x16_bf16 v[160:175], v[60:63], v[228:231], v[160:175]
  v_cvt_pk_bf16_f32 v233, v98, v99
  v_cvt_pk_bf16_f32 v234, v100, v101
  s_add_u32 s29, s28, 19456
  buffer_load_dwordx4 v[60:63], v2, s[8:11], s29 offen sc1
  ds_read_b128 v[220:223], v3 offset:5120
  ds_read_b128 v[224:227], v3 offset:46080
  ds_read_b128 v[228:231], v4 offset:21504
  s_waitcnt lgkmcnt(3)
  s_waitcnt vmcnt(15)
  v_mfma_f32_32x32x16_bf16 v[128:143], v[208:211], v[64:67], v[128:143]
  v_cvt_pk_bf16_f32 v235, v102, v103
  v_cvt_pk_bf16_f32 v236, v104, v105
  v_mfma_f32_32x32x16_bf16 v[144:159], v[212:215], v[64:67], v[144:159]
  v_cvt_pk_bf16_f32 v237, v106, v107
  v_cvt_pk_bf16_f32 v238, v108, v109
  v_mfma_f32_32x32x16_bf16 v[160:175], v[64:67], v[216:219], v[160:175]
  v_cvt_pk_bf16_f32 v239, v110, v111
  s_add_u32 s26, s31, 245366784
  s_add_u32 s29, s28, 20480
  buffer_load_dwordx4 v[64:67], v2, s[8:11], s29 offen sc1
  ds_read_b128 v[208:211], v3 offset:6144
  ds_read_b128 v[212:215], v3 offset:47104
  ds_read_b128 v[216:219], v4 offset:22528
  s_waitcnt lgkmcnt(3)
  s_waitcnt vmcnt(15)
  v_mfma_f32_32x32x16_bf16 v[128:143], v[220:223], v[68:71], v[128:143]
  buffer_store_dwordx4 v[232:235], v2, s[8:11], s26 offen sc1
  buffer_store_dwordx4 v[236:239], v2, s[8:11], s26 offen offset:1024 sc1
  v_mfma_f32_32x32x16_bf16 v[144:159], v[224:227], v[68:71], v[144:159]
  v_cndmask_b32 v112, v112, v8, s[32:33]
  v_cndmask_b32 v113, v113, v8, s[32:33]
  v_mfma_f32_32x32x16_bf16 v[160:175], v[68:71], v[228:231], v[160:175]
  v_cndmask_b32 v114, v114, v8, s[32:33]
  v_cndmask_b32 v115, v115, v8, s[32:33]
  s_add_u32 s29, s28, 21504
  buffer_load_dwordx4 v[68:71], v2, s[8:11], s29 offen sc1
  ds_read_b128 v[220:223], v3 offset:7168
  ds_read_b128 v[224:227], v3 offset:48128
  ds_read_b128 v[228:231], v4 offset:23552
  s_waitcnt lgkmcnt(3)
  s_waitcnt vmcnt(17)
  v_mfma_f32_32x32x16_bf16 v[128:143], v[208:211], v[72:75], v[128:143]
  v_cndmask_b32 v116, v116, v8, s[32:33]
  v_cndmask_b32 v117, v117, v8, s[32:33]
  v_mfma_f32_32x32x16_bf16 v[144:159], v[212:215], v[72:75], v[144:159]
  v_cndmask_b32 v118, v118, v8, s[32:33]
  v_cndmask_b32 v119, v119, v8, s[32:33]
  v_mfma_f32_32x32x16_bf16 v[160:175], v[72:75], v[216:219], v[160:175]
  v_cndmask_b32 v120, v120, v8, s[32:33]
  v_cndmask_b32 v121, v121, v8, s[32:33]
  s_add_u32 s29, s28, 22528
  buffer_load_dwordx4 v[72:75], v2, s[8:11], s29 offen sc1
  ds_read_b128 v[208:211], v3 offset:8192
  ds_read_b128 v[212:215], v3 offset:49152
  ds_read_b128 v[216:219], v4 offset:24576
  s_waitcnt lgkmcnt(3)
  s_waitcnt vmcnt(17)
  v_mfma_f32_32x32x16_bf16 v[128:143], v[220:223], v[76:79], v[128:143]
  v_cndmask_b32 v122, v122, v8, s[32:33]
  v_cndmask_b32 v123, v123, v8, s[32:33]
  v_mfma_f32_32x32x16_bf16 v[144:159], v[224:227], v[76:79], v[144:159]
  v_cndmask_b32 v124, v124, v8, s[32:33]
  v_cndmask_b32 v125, v125, v8, s[32:33]
  v_mfma_f32_32x32x16_bf16 v[160:175], v[76:79], v[228:231], v[160:175]
  v_cndmask_b32 v126, v126, v8, s[32:33]
  v_cndmask_b32 v127, v127, v8, s[32:33]
  s_add_u32 s29, s28, 23552
  buffer_load_dwordx4 v[76:79], v2, s[8:11], s29 offen sc1
  ds_read_b128 v[220:223], v3 offset:9216
  ds_read_b128 v[224:227], v3 offset:50176
  ds_read_b128 v[228:231], v4 offset:25600
  s_waitcnt lgkmcnt(3)
  s_waitcnt vmcnt(17)
  v_mfma_f32_32x32x16_bf16 v[128:143], v[208:211], v[16:19], v[128:143]
  v_cvt_pk_bf16_f32 v240, v112, v113
  v_cvt_pk_bf16_f32 v241, v114, v115
  v_mfma_f32_32x32x16_bf16 v[144:159], v[212:215], v[16:19], v[144:159]
  v_cvt_pk_bf16_f32 v242, v116, v117
  v_cvt_pk_bf16_f32 v243, v118, v119
  v_mfma_f32_32x32x16_bf16 v[160:175], v[16:19], v[216:219], v[160:175]
  v_cvt_pk_bf16_f32 v244, v120, v121
  v_cvt_pk_bf16_f32 v245, v122, v123
  s_add_u32 s29, s28, 24576
  buffer_load_dwordx4 v[16:19], v2, s[8:11], s29 offen sc1
  ds_read_b128 v[208:211], v3 offset:10240
  ds_read_b128 v[212:215], v3 offset:51200
  ds_read_b128 v[216:219], v4 offset:26624
  s_waitcnt lgkmcnt(3)
  s_waitcnt vmcnt(17)
  v_mfma_f32_32x32x16_bf16 v[128:143], v[220:223], v[20:23], v[128:143]
  v_cvt_pk_bf16_f32 v246, v124, v125
  v_cvt_pk_bf16_f32 v247, v126, v127
  v_mfma_f32_32x32x16_bf16 v[144:159], v[224:227], v[20:23], v[144:159]
  s_add_u32 s26, s31, 249561088
  buffer_store_dwordx4 v[240:243], v2, s[8:11], s26 offen sc1
  v_mfma_f32_32x32x16_bf16 v[160:175], v[20:23], v[228:231], v[160:175]
  buffer_store_dwordx4 v[244:247], v2, s[8:11], s26 offen offset:1024 sc1
  v_mul_f32 v80, s30, v80
  s_add_u32 s29, s28, 25600
  buffer_load_dwordx4 v[20:23], v2, s[8:11], s29 offen sc1
  ds_read_b128 v[220:223], v3 offset:11264
  ds_read_b128 v[224:227], v3 offset:52224
  ds_read_b128 v[228:231], v4 offset:27648
  s_waitcnt lgkmcnt(3)
  s_waitcnt vmcnt(19)
  v_mfma_f32_32x32x16_bf16 v[128:143], v[208:211], v[24:27], v[128:143]
  v_mul_f32 v81, s30, v81
  v_mul_f32 v82, s30, v82
  v_mfma_f32_32x32x16_bf16 v[144:159], v[212:215], v[24:27], v[144:159]
  v_mul_f32 v83, s30, v83
  v_mul_f32 v84, s30, v84
  v_mfma_f32_32x32x16_bf16 v[160:175], v[24:27], v[216:219], v[160:175]
  v_mul_f32 v85, s30, v85
  v_mul_f32 v86, s30, v86
  s_add_u32 s29, s28, 26624
  buffer_load_dwordx4 v[24:27], v2, s[8:11], s29 offen sc1
  ds_read_b128 v[208:211], v3 offset:12288
  ds_read_b128 v[212:215], v3 offset:53248
  ds_read_b128 v[216:219], v4 offset:28672
  s_waitcnt lgkmcnt(3)
  s_waitcnt vmcnt(19)
  v_mfma_f32_32x32x16_bf16 v[128:143], v[220:223], v[28:31], v[128:143]
  v_mul_f32 v87, s30, v87
  v_mul_f32 v88, s30, v88
  v_mfma_f32_32x32x16_bf16 v[144:159], v[224:227], v[28:31], v[144:159]
  v_mul_f32 v89, s30, v89
  v_mul_f32 v90, s30, v90
  v_mfma_f32_32x32x16_bf16 v[160:175], v[28:31], v[228:231], v[160:175]
  v_mul_f32 v91, s30, v91
  v_mul_f32 v92, s30, v92
  s_add_u32 s29, s28, 27648
  buffer_load_dwordx4 v[28:31], v2, s[8:11], s29 offen sc1
  ds_read_b128 v[220:223], v3 offset:13312
  ds_read_b128 v[224:227], v3 offset:54272
  ds_read_b128 v[228:231], v4 offset:29696
  s_waitcnt lgkmcnt(3)
  s_waitcnt vmcnt(19)
  v_mfma_f32_32x32x16_bf16 v[128:143], v[208:211], v[32:35], v[128:143]
  v_mul_f32 v93, s30, v93
  v_mul_f32 v94, s30, v94
  v_mfma_f32_32x32x16_bf16 v[144:159], v[212:215], v[32:35], v[144:159]
  v_mul_f32 v95, s30, v95
  v_cvt_pk_bf16_f32 v192, v80, v81
  v_mfma_f32_32x32x16_bf16 v[160:175], v[32:35], v[216:219], v[160:175]
  v_cvt_pk_bf16_f32 v193, v82, v83
  v_cvt_pk_bf16_f32 v194, v84, v85
  s_add_u32 s29, s28, 28672
  buffer_load_dwordx4 v[32:35], v2, s[8:11], s29 offen sc1
  ds_read_b128 v[208:211], v3 offset:14336
  ds_read_b128 v[212:215], v3 offset:55296
  ds_read_b128 v[216:219], v4 offset:30720
  s_waitcnt lgkmcnt(3)
  s_waitcnt vmcnt(19)
  v_mfma_f32_32x32x16_bf16 v[128:143], v[220:223], v[36:39], v[128:143]
  v_cvt_pk_bf16_f32 v195, v86, v87
  v_cvt_pk_bf16_f32 v196, v88, v89
  v_mfma_f32_32x32x16_bf16 v[144:159], v[224:227], v[36:39], v[144:159]
  v_cvt_pk_bf16_f32 v197, v90, v91
  v_cvt_pk_bf16_f32 v198, v92, v93
  v_mfma_f32_32x32x16_bf16 v[160:175], v[36:39], v[228:231], v[160:175]
  v_cvt_pk_bf16_f32 v199, v94, v95
  s_add_u32 s29, s28, 29696
  buffer_load_dwordx4 v[36:39], v2, s[8:11], s29 offen sc1
  ds_read_b128 v[220:223], v3 offset:15360
  ds_read_b128 v[224:227], v3 offset:56320
  ds_read_b128 v[228:231], v4 offset:31744
  s_waitcnt lgkmcnt(3)
  s_waitcnt vmcnt(19)
  v_mfma_f32_32x32x16_bf16 v[128:143], v[208:211], v[40:43], v[128:143]
  v_mfma_f32_32x32x16_bf16 v[144:159], v[212:215], v[40:43], v[144:159]
  v_mfma_f32_32x32x16_bf16 v[160:175], v[40:43], v[216:219], v[160:175]
  s_add_u32 s29, s28, 30720
  buffer_load_dwordx4 v[40:43], v2, s[8:11], s29 offen sc1
  ds_read_b128 v[208:211], v3 offset:16384
  ds_read_b128 v[212:215], v3 offset:57344
  ds_read_b128 v[216:219], v4 offset:32768
  s_waitcnt lgkmcnt(3)
  s_waitcnt vmcnt(19)
  v_mfma_f32_32x32x16_bf16 v[128:143], v[220:223], v[44:47], v[128:143]
  v_mfma_f32_32x32x16_bf16 v[144:159], v[224:227], v[44:47], v[144:159]
  v_mfma_f32_32x32x16_bf16 v[160:175], v[44:47], v[228:231], v[160:175]
  s_add_u32 s29, s28, 31744
  buffer_load_dwordx4 v[44:47], v2, s[8:11], s29 offen sc1
  ds_read_b128 v[220:223], v3 offset:17408
  ds_read_b128 v[224:227], v3 offset:58368
  ds_read_b128 v[228:231], v4 offset:33792
  s_waitcnt lgkmcnt(3)
  s_waitcnt vmcnt(19)
  v_mfma_f32_32x32x16_bf16 v[128:143], v[208:211], v[48:51], v[128:143]
  v_mfma_f32_32x32x16_bf16 v[144:159], v[212:215], v[48:51], v[144:159]
  v_mfma_f32_32x32x16_bf16 v[160:175], v[48:51], v[216:219], v[160:175]
  s_add_u32 s29, s28, 32768
  buffer_load_dwordx4 v[48:51], v2, s[8:11], s29 offen sc1
  ds_read_b128 v[208:211], v3 offset:18432
  ds_read_b128 v[212:215], v3 offset:59392
  ds_read_b128 v[216:219], v4 offset:34816
  s_waitcnt lgkmcnt(3)
  s_waitcnt vmcnt(19)
  v_mfma_f32_32x32x16_bf16 v[128:143], v[220:223], v[52:55], v[128:143]
  v_mfma_f32_32x32x16_bf16 v[144:159], v[224:227], v[52:55], v[144:159]
  v_mfma_f32_32x32x16_bf16 v[160:175], v[52:55], v[228:231], v[160:175]
  s_add_u32 s29, s28, 33792
  buffer_load_dwordx4 v[52:55], v2, s[8:11], s29 offen sc1
  ds_read_b128 v[220:223], v3 offset:19456
  ds_read_b128 v[224:227], v3 offset:60416
  ds_read_b128 v[228:231], v4 offset:35840
  s_waitcnt lgkmcnt(3)
  s_waitcnt vmcnt(19)
  v_mfma_f32_32x32x16_bf16 v[128:143], v[208:211], v[56:59], v[128:143]
  v_mfma_f32_32x32x16_bf16 v[144:159], v[212:215], v[56:59], v[144:159]
  v_mfma_f32_32x32x16_bf16 v[160:175], v[56:59], v[216:219], v[160:175]
  s_add_u32 s29, s28, 34816
  buffer_load_dwordx4 v[56:59], v2, s[8:11], s29 offen sc1
  ds_read_b128 v[208:211], v3 offset:20480
  ds_read_b128 v[212:215], v3 offset:61440
  ds_read_b128 v[216:219], v4 offset:36864
  s_waitcnt lgkmcnt(3)
  s_waitcnt vmcnt(19)
  v_mfma_f32_32x32x16_bf16 v[128:143], v[220:223], v[60:63], v[128:143]
  v_mfma_f32_32x32x16_bf16 v[144:159], v[224:227], v[60:63], v[144:159]
  v_mfma_f32_32x32x16_bf16 v[160:175], v[60:63], v[228:231], v[160:175]
  s_add_u32 s29, s28, 35840
  buffer_load_dwordx4 v[60:63], v2, s[8:11], s29 offen sc1
  ds_read_b128 v[220:223], v3 offset:21504
  ds_read_b128 v[224:227], v3 offset:62464
  ds_read_b128 v[228:231], v4 offset:37888
  s_waitcnt lgkmcnt(3)
  s_waitcnt vmcnt(19)
  v_mfma_f32_32x32x16_bf16 v[128:143], v[208:211], v[64:67], v[128:143]
  v_mfma_f32_32x32x16_bf16 v[144:159], v[212:215], v[64:67], v[144:159]
  v_mfma_f32_32x32x16_bf16 v[160:175], v[64:67], v[216:219], v[160:175]
  s_add_u32 s29, s28, 36864
  buffer_load_dwordx4 v[64:67], v2, s[8:11], s29 offen sc1
  ds_read_b128 v[208:211], v3 offset:22528
  ds_read_b128 v[212:215], v3 offset:63488
  ds_read_b128 v[216:219], v4 offset:38912
  s_waitcnt lgkmcnt(3)
  s_waitcnt vmcnt(17)
  v_mfma_f32_32x32x16_bf16 v[128:143], v[220:223], v[68:71], v[128:143]
  v_mfma_f32_32x32x16_bf16 v[144:159], v[224:227], v[68:71], v[144:159]
  v_mfma_f32_32x32x16_bf16 v[160:175], v[68:71], v[228:231], v[160:175]
  s_add_u32 s29, s28, 37888
  buffer_load_dwordx4 v[68:71], v2, s[8:11], s29 offen sc1
  ds_read_b128 v[220:223], v3 offset:23552
  ds_read_b128 v[224:227], v3 offset:64512
  ds_read_b128 v[228:231], v4 offset:39936
  s_waitcnt lgkmcnt(3)
  s_waitcnt vmcnt(17)
  v_mfma_f32_32x32x16_bf16 v[128:143], v[208:211], v[72:75], v[128:143]
  v_mfma_f32_32x32x16_bf16 v[144:159], v[212:215], v[72:75], v[144:159]
  v_mfma_f32_32x32x16_bf16 v[160:175], v[72:75], v[216:219], v[160:175]
  s_add_u32 s29, s28, 38912
  buffer_load_dwordx4 v[72:75], v2, s[8:11], s29 offen sc1
  ds_read_b128 v[208:211], v3 offset:24576
  ds_read_b128 v[212:215], v4 offset:0
  ds_read_b128 v[216:219], v4 offset:40960
  s_waitcnt lgkmcnt(3)
  s_waitcnt vmcnt(17)
  v_mfma_f32_32x32x16_bf16 v[128:143], v[220:223], v[76:79], v[128:143]
  v_mfma_f32_32x32x16_bf16 v[144:159], v[224:227], v[76:79], v[144:159]
  v_mfma_f32_32x32x16_bf16 v[160:175], v[76:79], v[228:231], v[160:175]
  s_add_u32 s29, s28, 39936
  buffer_load_dwordx4 v[76:79], v2, s[8:11], s29 offen sc1
  ds_read_b128 v[220:223], v3 offset:25600
  ds_read_b128 v[224:227], v4 offset:1024
  ds_read_b128 v[228:231], v4 offset:41984
  s_waitcnt lgkmcnt(3)
  s_waitcnt vmcnt(17)
  v_mfma_f32_32x32x16_bf16 v[128:143], v[208:211], v[16:19], v[128:143]
  v_mfma_f32_32x32x16_bf16 v[144:159], v[212:215], v[16:19], v[144:159]
  v_mfma_f32_32x32x16_bf16 v[160:175], v[16:19], v[216:219], v[160:175]
  ds_read_b128 v[208:211], v3 offset:26624
  ds_read_b128 v[212:215], v4 offset:2048
  ds_read_b128 v[216:219], v4 offset:43008
  s_waitcnt lgkmcnt(3)
  s_waitcnt vmcnt(14)
  v_mfma_f32_32x32x16_bf16 v[128:143], v[220:223], v[20:23], v[128:143]
  v_mfma_f32_32x32x16_bf16 v[144:159], v[224:227], v[20:23], v[144:159]
  v_mfma_f32_32x32x16_bf16 v[160:175], v[20:23], v[228:231], v[160:175]
  ds_read_b128 v[220:223], v3 offset:27648
  ds_read_b128 v[224:227], v4 offset:3072
  ds_read_b128 v[228:231], v4 offset:44032
  s_waitcnt lgkmcnt(3)
  s_waitcnt vmcnt(13)
  v_mfma_f32_32x32x16_bf16 v[128:143], v[208:211], v[24:27], v[128:143]
  v_mfma_f32_32x32x16_bf16 v[144:159], v[212:215], v[24:27], v[144:159]
  v_mfma_f32_32x32x16_bf16 v[160:175], v[24:27], v[216:219], v[160:175]
  ds_read_b128 v[208:211], v3 offset:28672
  ds_read_b128 v[212:215], v4 offset:4096
  ds_read_b128 v[216:219], v4 offset:45056
  s_waitcnt lgkmcnt(3)
  s_waitcnt vmcnt(12)
  v_mfma_f32_32x32x16_bf16 v[128:143], v[220:223], v[28:31], v[128:143]
  v_mfma_f32_32x32x16_bf16 v[144:159], v[224:227], v[28:31], v[144:159]
  v_mfma_f32_32x32x16_bf16 v[160:175], v[28:31], v[228:231], v[160:175]
  ds_read_b128 v[220:223], v3 offset:29696
  ds_read_b128 v[224:227], v4 offset:5120
  ds_read_b128 v[228:231], v4 offset:46080
  s_waitcnt lgkmcnt(3)
  s_waitcnt vmcnt(11)
  v_mfma_f32_32x32x16_bf16 v[128:143], v[208:211], v[32:35], v[128:143]
  v_mfma_f32_32x32x16_bf16 v[144:159], v[212:215], v[32:35], v[144:159]
  v_mfma_f32_32x32x16_bf16 v[160:175], v[32:35], v[216:219], v[160:175]
  ds_read_b128 v[208:211], v3 offset:30720
  ds_read_b128 v[212:215], v4 offset:6144
  ds_read_b128 v[216:219], v4 offset:47104
  s_waitcnt lgkmcnt(3)
  s_waitcnt vmcnt(10)
  v_mfma_f32_32x32x16_bf16 v[128:143], v[220:223], v[36:39], v[128:143]
  v_mfma_f32_32x32x16_bf16 v[144:159], v[224:227], v[36:39], v[144:159]
  v_mfma_f32_32x32x16_bf16 v[160:175], v[36:39], v[228:231], v[160:175]
  ds_read_b128 v[220:223], v3 offset:31744
  ds_read_b128 v[224:227], v4 offset:7168
  ds_read_b128 v[228:231], v4 offset:48128
  s_waitcnt lgkmcnt(3)
  s_waitcnt vmcnt(9)
  v_mfma_f32_32x32x16_bf16 v[128:143], v[208:211], v[40:43], v[128:143]
  v_mfma_f32_32x32x16_bf16 v[144:159], v[212:215], v[40:43], v[144:159]
  v_mfma_f32_32x32x16_bf16 v[160:175], v[40:43], v[216:219], v[160:175]
  ds_read_b128 v[208:211], v3 offset:32768
  ds_read_b128 v[212:215], v4 offset:8192
  ds_read_b128 v[216:219], v4 offset:49152
  s_waitcnt lgkmcnt(3)
  s_waitcnt vmcnt(8)
  v_mfma_f32_32x32x16_bf16 v[128:143], v[220:223], v[44:47], v[128:143]
  v_mfma_f32_32x32x16_bf16 v[144:159], v[224:227], v[44:47], v[144:159]
  v_mfma_f32_32x32x16_bf16 v[160:175], v[44:47], v[228:231], v[160:175]
  ds_read_b128 v[220:223], v3 offset:33792
  ds_read_b128 v[224:227], v4 offset:9216
  ds_read_b128 v[228:231], v4 offset:50176
  s_waitcnt lgkmcnt(3)
  s_waitcnt vmcnt(7)
  v_mfma_f32_32x32x16_bf16 v[128:143], v[208:211], v[48:51], v[128:143]
  v_mfma_f32_32x32x16_bf16 v[144:159], v[212:215], v[48:51], v[144:159]
  v_mfma_f32_32x32x16_bf16 v[160:175], v[48:51], v[216:219], v[160:175]
  ds_read_b128 v[208:211], v3 offset:34816
  ds_read_b128 v[212:215], v4 offset:10240
  ds_read_b128 v[216:219], v4 offset:51200
  s_waitcnt lgkmcnt(3)
  s_waitcnt vmcnt(6)
  v_mfma_f32_32x32x16_bf16 v[128:143], v[220:223], v[52:55], v[128:143]
  v_mfma_f32_32x32x16_bf16 v[144:159], v[224:227], v[52:55], v[144:159]
  v_mfma_f32_32x32x16_bf16 v[160:175], v[52:55], v[228:231], v[160:175]
  ds_read_b128 v[220:223], v3 offset:35840
  ds_read_b128 v[224:227], v4 offset:11264
  ds_read_b128 v[228:231], v4 offset:52224
  s_waitcnt lgkmcnt(3)
  s_waitcnt vmcnt(5)
  v_mfma_f32_32x32x16_bf16 v[128:143], v[208:211], v[56:59], v[128:143]
  v_mfma_f32_32x32x16_bf16 v[144:159], v[212:215], v[56:59], v[144:159]
  v_mfma_f32_32x32x16_bf16 v[160:175], v[56:59], v[216:219], v[160:175]
  ds_read_b128 v[208:211], v3 offset:36864
  ds_read_b128 v[212:215], v4 offset:12288
  ds_read_b128 v[216:219], v4 offset:53248
  s_waitcnt lgkmcnt(3)
  s_waitcnt vmcnt(4)
  v_mfma_f32_32x32x16_bf16 v[128:143], v[220:223], v[60:63], v[128:143]
  v_mfma_f32_32x32x16_bf16 v[144:159], v[224:227], v[60:63], v[144:159]
  v_mfma_f32_32x32x16_bf16 v[160:175], v[60:63], v[228:231], v[160:175]
  ds_read_b128 v[220:223], v3 offset:37888
  ds_read_b128 v[224:227], v4 offset:13312
  ds_read_b128 v[228:231], v4 offset:54272
  s_waitcnt lgkmcnt(3)
  s_waitcnt vmcnt(3)
  v_mfma_f32_32x32x16_bf16 v[128:143], v[208:211], v[64:67], v[128:143]
  v_mfma_f32_32x32x16_bf16 v[144:159], v[212:215], v[64:67], v[144:159]
  v_mfma_f32_32x32x16_bf16 v[160:175], v[64:67], v[216:219], v[160:175]
  ds_read_b128 v[208:211], v3 offset:38912
  ds_read_b128 v[212:215], v4 offset:14336
  ds_read_b128 v[216:219], v4 offset:55296
  s_waitcnt lgkmcnt(3)
  s_waitcnt vmcnt(2)
  v_mfma_f32_32x32x16_bf16 v[128:143], v[220:223], v[68:71], v[128:143]
  v_mfma_f32_32x32x16_bf16 v[144:159], v[224:227], v[68:71], v[144:159]
  v_mfma_f32_32x32x16_bf16 v[160:175], v[68:71], v[228:231], v[160:175]
  ds_read_b128 v[220:223], v3 offset:39936
  ds_read_b128 v[224:227], v4 offset:15360
  ds_read_b128 v[228:231], v4 offset:56320
  s_waitcnt lgkmcnt(3)
  s_waitcnt vmcnt(1)
  v_mfma_f32_32x32x16_bf16 v[128:143], v[208:211], v[72:75], v[128:143]
  v_mfma_f32_32x32x16_bf16 v[144:159], v[212:215], v[72:75], v[144:159]
  v_mfma_f32_32x32x16_bf16 v[160:175], v[72:75], v[216:219], v[160:175]
  s_waitcnt lgkmcnt(0)
  s_waitcnt vmcnt(0)
  v_mfma_f32_32x32x16_bf16 v[128:143], v[220:223], v[76:79], v[128:143]
  v_mfma_f32_32x32x16_bf16 v[144:159], v[224:227], v[76:79], v[144:159]
  v_mfma_f32_32x32x16_bf16 v[160:175], v[76:79], v[228:231], v[160:175]
  s_nop 11
  v_max3_f32 v9, v9, abs(v144), abs(v145)
  v_max3_f32 v9, v9, abs(v146), abs(v147)
  v_max3_f32 v9, v9, abs(v148), abs(v149)
  v_max3_f32 v9, v9, abs(v150), abs(v151)
  v_max3_f32 v9, v9, abs(v152), abs(v153)
  v_max3_f32 v9, v9, abs(v154), abs(v155)
  v_max3_f32 v9, v9, abs(v156), abs(v157)
  v_max3_f32 v9, v9, abs(v158), abs(v159)
  v_add_f32 v156, v156, v6
  v_cvt_pk_bf16_f32 v232, v144, v145
  v_cvt_pk_bf16_f32 v233, v146, v147
  v_cvt_pk_bf16_f32 v234, v148, v149
  v_cvt_pk_bf16_f32 v235, v150, v151
  v_cvt_pk_bf16_f32 v236, v152, v153
  v_cvt_pk_bf16_f32 v237, v154, v155
  v_cvt_pk_bf16_f32 v238, v156, v157
  v_cvt_pk_bf16_f32 v239, v158, v159
  s_add_u32 s26, s31, 245368832
  buffer_store_dwordx4 v[232:235], v2, s[8:11], s26 offen sc1
  buffer_store_dwordx4 v[236:239], v2, s[8:11], s26 offen offset:1024 sc1
  v_cndmask_b32 v160, v160, v8, s[32:33]
  v_cndmask_b32 v161, v161, v8, s[32:33]
  v_cndmask_b32 v162, v162, v8, s[32:33]
  v_cndmask_b32 v163, v163, v8, s[32:33]
  v_cndmask_b32 v164, v164, v8, s[32:33]
  v_cndmask_b32 v165, v165, v8, s[32:33]
  v_cndmask_b32 v166, v166, v8, s[32:33]
  v_cndmask_b32 v167, v167, v8, s[32:33]
  v_cndmask_b32 v168, v168, v8, s[32:33]
  v_cndmask_b32 v169, v169, v8, s[32:33]
  v_cndmask_b32 v170, v170, v8, s[32:33]
  v_cndmask_b32 v171, v171, v8, s[32:33]
  v_cndmask_b32 v172, v172, v8, s[32:33]
  v_cndmask_b32 v173, v173, v8, s[32:33]
  v_cndmask_b32 v174, v174, v8, s[32:33]
  v_cndmask_b32 v175, v175, v8, s[32:33]
  v_cvt_pk_bf16_f32 v240, v160, v161
  v_cvt_pk_bf16_f32 v241, v162, v163
  v_cvt_pk_bf16_f32 v242, v164, v165
  v_cvt_pk_bf16_f32 v243, v166, v167
  v_cvt_pk_bf16_f32 v244, v168, v169
  v_cvt_pk_bf16_f32 v245, v170, v171
  v_cvt_pk_bf16_f32 v246, v172, v173
  v_cvt_pk_bf16_f32 v247, v174, v175
  s_add_u32 s26, s31, 249563136
  buffer_store_dwordx4 v[240:243], v2, s[8:11], s26 offen sc1
  buffer_store_dwordx4 v[244:247], v2, s[8:11], s26 offen offset:1024 sc1
  v_mul_f32 v128, s30, v128
  v_mul_f32 v129, s30, v129
  v_mul_f32 v130, s30, v130
  v_mul_f32 v131, s30, v131
  v_mul_f32 v132, s30, v132
  v_mul_f32 v133, s30, v133
  v_mul_f32 v134, s30, v134
  v_mul_f32 v135, s30, v135
  v_mul_f32 v136, s30, v136
  v_mul_f32 v137, s30, v137
  v_mul_f32 v138, s30, v138
  v_mul_f32 v139, s30, v139
  v_mul_f32 v140, s30, v140
  v_mul_f32 v141, s30, v141
  v_mul_f32 v142, s30, v142
  v_mul_f32 v143, s30, v143
  v_cvt_pk_bf16_f32 v200, v128, v129
  v_cvt_pk_bf16_f32 v201, v130, v131
  v_cvt_pk_bf16_f32 v202, v132, v133
  v_cvt_pk_bf16_f32 v203, v134, v135
  v_cvt_pk_bf16_f32 v204, v136, v137
  v_cvt_pk_bf16_f32 v205, v138, v139
  v_cvt_pk_bf16_f32 v206, v140, v141
  v_cvt_pk_bf16_f32 v207, v142, v143
  s_nop 1
  v_max_f32_dpp v10, v9, v9 quad_perm:[1,0,3,2] row_mask:0xf bank_mask:0xf
  s_nop 1
  v_max_f32_dpp v9, v10, v10 quad_perm:[2,3,0,1] row_mask:0xf bank_mask:0xf
  s_nop 1
  v_max_f32_dpp v10, v9, v9 row_half_mirror row_mask:0xf bank_mask:0xf
  s_nop 1
  v_max_f32_dpp v9, v10, v10 row_mirror row_mask:0xf bank_mask:0xf
  v_mov_b32 v10, v9
  s_nop 1
  v_permlane16_swap_b32 v9, v10
  v_max_f32 v9, v9, v10
  v_mov_b32 v10, v9
  s_nop 1
  v_permlane32_swap_b32 v9, v10
  v_max_f32 v9, v9, v10
  s_lshl_b32 s51, s22, 7
  s_add_u32 s51, s51, 0xf600000
  s_lshl_b32 s26, s23, 4
  s_lshl_b32 s29, s21, 2
  s_add_u32 s26, s26, s29
  v_mov_b32 v11, s26
  s_mov_b64 s[40:41], exec
  s_mov_b64 exec, 1
  buffer_store_dword v9, v11, s[8:11], s51 offen sc1
  s_mov_b64 exec, s[40:41]
  s_mov_b32 s52, s24
  s_waitcnt vmcnt(0)
  s_barrier
  s_cmp_eq_u32 s21, 0
  s_cbranch_scc0 arr_106
  s_mov_b64 s[24:25], exec
  s_mov_b64 exec, 1
  v_mov_b32 v3, 0
  v_mov_b32 v4, 1
  buffer_atomic_add v4, v3, s[8:11], s47 offen
  s_mov_b64 exec, s[24:25]
arr_106:
  s_and_b32 s26, s2, 3
  s_mul_i32 s26, s26, 10
  s_mul_i32 s27, s21, 3
  s_cmp_eq_u32 s21, 3
  s_cselect_b32 s27, 8, s27
  s_add_u32 s50, s26, s27
  s_mul_i32 s26, s50, 20480
  s_add_u32 s26, s26, 0xe000000
  s_add_u32 s27, s26, 0
  buffer_load_dwordx4 a[0:3], v2, s[8:11], s27 offen
  s_add_u32 s27, s26, 1024
  buffer_load_dwordx4 a[4:7], v2, s[8:11], s27 offen
  s_add_u32 s27, s26, 2048
  buffer_load_dwordx4 a[8:11], v2, s[8:11], s27 offen
  s_add_u32 s27, s26, 3072
  buffer_load_dwordx4 a[12:15], v2, s[8:11], s27 offen
  s_add_u32 s27, s26, 4096
  buffer_load_dwordx4 a[16:19], v2, s[8:11], s27 offen
  s_add_u32 s27, s26, 5120
  buffer_load_dwordx4 a[20:23], v2, s[8:11], s27 offen
  s_add_u32 s27, s26, 6144
  buffer_load_dwordx4 a[24:27], v2, s[8:11], s27 offen
  s_add_u32 s27, s26, 7168
  buffer_load_dwordx4 a[28:31], v2, s[8:11], s27 offen
  s_add_u32 s27, s26, 8192
  buffer_load_dwordx4 a[32:35], v2, s[8:11], s27 offen
  s_add_u32 s27, s26, 9216
  buffer_load_dwordx4 a[36:39], v2, s[8:11], s27 offen
  s_add_u32 s27, s26, 10240
  buffer_load_dwordx4 a[40:43], v2, s[8:11], s27 offen
  s_add_u32 s27, s26, 11264
  buffer_load_dwordx4 a[44:47], v2, s[8:11], s27 offen
  s_add_u32 s27, s26, 12288
  buffer_load_dwordx4 a[48:51], v2, s[8:11], s27 offen
  s_add_u32 s27, s26, 13312
  buffer_load_dwordx4 a[52:55], v2, s[8:11], s27 offen
  s_add_u32 s27, s26, 14336
  buffer_load_dwordx4 a[56:59], v2, s[8:11], s27 offen
  s_add_u32 s27, s26, 15360
  buffer_load_dwordx4 a[60:63], v2, s[8:11], s27 offen
  s_add_u32 s27, s26, 16384
  buffer_load_dwordx4 a[64:67], v2, s[8:11], s27 offen
  s_add_u32 s27, s26, 17408
  buffer_load_dwordx4 a[68:71], v2, s[8:11], s27 offen
  s_add_u32 s27, s26, 18432
  buffer_load_dwordx4 a[72:75], v2, s[8:11], s27 offen
  s_add_u32 s27, s26, 19456
  buffer_load_dwordx4 a[76:79], v2, s[8:11], s27 offen
  s_add_u32 s27, s26, 20480
  buffer_load_dwordx4 a[80:83], v2, s[8:11], s27 offen
  s_add_u32 s27, s26, 21504
  buffer_load_dwordx4 a[84:87], v2, s[8:11], s27 offen
  s_add_u32 s27, s26, 22528
  buffer_load_dwordx4 a[88:91], v2, s[8:11], s27 offen
  s_add_u32 s27, s26, 23552
  buffer_load_dwordx4 a[92:95], v2, s[8:11], s27 offen
  s_add_u32 s27, s26, 24576
  buffer_load_dwordx4 a[96:99], v2, s[8:11], s27 offen
  s_add_u32 s27, s26, 25600
  buffer_load_dwordx4 a[100:103], v2, s[8:11], s27 offen
  s_add_u32 s27, s26, 26624
  buffer_load_dwordx4 a[104:107], v2, s[8:11], s27 offen
  s_add_u32 s27, s26, 27648
  buffer_load_dwordx4 a[108:111], v2, s[8:11], s27 offen
  s_add_u32 s27, s26, 28672
  buffer_load_dwordx4 a[112:115], v2, s[8:11], s27 offen
  s_add_u32 s27, s26, 29696
  buffer_load_dwordx4 a[116:119], v2, s[8:11], s27 offen
  s_add_u32 s27, s26, 30720
  buffer_load_dwordx4 a[120:123], v2, s[8:11], s27 offen
  s_add_u32 s27, s26, 31744
  buffer_load_dwordx4 a[124:127], v2, s[8:11], s27 offen
  s_add_u32 s27, s26, 32768
  buffer_load_dwordx4 a[128:131], v2, s[8:11], s27 offen
  s_add_u32 s27, s26, 33792
  buffer_load_dwordx4 a[132:135], v2, s[8:11], s27 offen
  s_add_u32 s27, s26, 34816
  buffer_load_dwordx4 a[136:139], v2, s[8:11], s27 offen
  s_add_u32 s27, s26, 35840
  buffer_load_dwordx4 a[140:143], v2, s[8:11], s27 offen
  s_add_u32 s27, s26, 36864
  buffer_load_dwordx4 a[144:147], v2, s[8:11], s27 offen
  s_add_u32 s27, s26, 37888
  buffer_load_dwordx4 a[148:151], v2, s[8:11], s27 offen
  s_add_u32 s27, s26, 38912
  buffer_load_dwordx4 a[152:155], v2, s[8:11], s27 offen
  s_add_u32 s27, s26, 39936
  buffer_load_dwordx4 a[156:159], v2, s[8:11], s27 offen
  s_cmp_lt_u32 s21, 2
  s_cbranch_scc0 g3_107
  s_add_u32 s27, s26, 40960
  buffer_load_dwordx4 a[160:163], v2, s[8:11], s27 offen
  s_add_u32 s27, s26, 41984
  buffer_load_dwordx4 a[164:167], v2, s[8:11], s27 offen
  s_add_u32 s27, s26, 43008
  buffer_load_dwordx4 a[168:171], v2, s[8:11], s27 offen
  s_add_u32 s27, s26, 44032
  buffer_load_dwordx4 a[172:175], v2, s[8:11], s27 offen
  s_add_u32 s27, s26, 45056
  buffer_load_dwordx4 a[176:179], v2, s[8:11], s27 offen
  s_add_u32 s27, s26, 46080
  buffer_load_dwordx4 a[180:183], v2, s[8:11], s27 offen
  s_add_u32 s27, s26, 47104
  buffer_load_dwordx4 a[184:187], v2, s[8:11], s27 offen
  s_add_u32 s27, s26, 48128
  buffer_load_dwordx4 a[188:191], v2, s[8:11], s27 offen
  s_add_u32 s27, s26, 49152
  buffer_load_dwordx4 a[192:195], v2, s[8:11], s27 offen
  s_add_u32 s27, s26, 50176
  buffer_load_dwordx4 a[196:199], v2, s[8:11], s27 offen
  s_add_u32 s27, s26, 51200
  buffer_load_dwordx4 a[200:203], v2, s[8:11], s27 offen
  s_add_u32 s27, s26, 52224
  buffer_load_dwordx4 a[204:207], v2, s[8:11], s27 offen
  s_add_u32 s27, s26, 53248
  buffer_load_dwordx4 a[208:211], v2, s[8:11], s27 offen
  s_add_u32 s27, s26, 54272
  buffer_load_dwordx4 a[212:215], v2, s[8:11], s27 offen
  s_add_u32 s27, s26, 55296
  buffer_load_dwordx4 a[216:219], v2, s[8:11], s27 offen
  s_add_u32 s27, s26, 56320
  buffer_load_dwordx4 a[220:223], v2, s[8:11], s27 offen
  s_add_u32 s27, s26, 57344
  buffer_load_dwordx4 a[224:227], v2, s[8:11], s27 offen
  s_add_u32 s27, s26, 58368
  buffer_load_dwordx4 a[228:231], v2, s[8:11], s27 offen
  s_add_u32 s27, s26, 59392
  buffer_load_dwordx4 a[232:235], v2, s[8:11], s27 offen
  s_add_u32 s27, s26, 60416
  buffer_load_dwordx4 a[236:239], v2, s[8:11], s27 offen
g3_107:
  v_mov_b32 v12, 0
  v_lshlrev_b32 v6, 16, v192
  v_and_b32 v7, 0xffff0000, v192
  v_add_f32_e64 v12, v12, abs(v6)
  v_add_f32_e64 v12, v12, abs(v7)
  v_lshlrev_b32 v6, 16, v193
  v_and_b32 v7, 0xffff0000, v193
  v_add_f32_e64 v12, v12, abs(v6)
  v_add_f32_e64 v12, v12, abs(v7)
  v_lshlrev_b32 v6, 16, v194
  v_and_b32 v7, 0xffff0000, v194
  v_add_f32_e64 v12, v12, abs(v6)
  v_add_f32_e64 v12, v12, abs(v7)
  v_lshlrev_b32 v6, 16, v195
  v_and_b32 v7, 0xffff0000, v195
  v_add_f32_e64 v12, v12, abs(v6)
  v_add_f32_e64 v12, v12, abs(v7)
  v_lshlrev_b32 v6, 16, v196
  v_and_b32 v7, 0xffff0000, v196
  v_add_f32_e64 v12, v12, abs(v6)
  v_add_f32_e64 v12, v12, abs(v7)
  v_lshlrev_b32 v6, 16, v197
  v_and_b32 v7, 0xffff0000, v197
  v_add_f32_e64 v12, v12, abs(v6)
  v_add_f32_e64 v12, v12, abs(v7)
  v_lshlrev_b32 v6, 16, v198
  v_and_b32 v7, 0xffff0000, v198
  v_add_f32_e64 v12, v12, abs(v6)
  v_add_f32_e64 v12, v12, abs(v7)
  v_lshlrev_b32 v6, 16, v199
  v_and_b32 v7, 0xffff0000, v199
  v_add_f32_e64 v12, v12, abs(v6)
  v_add_f32_e64 v12, v12, abs(v7)
  v_mov_b32 v6, v12
  s_nop 1
  v_permlane32_swap_b32 v12, v6
  v_add_f32 v12, v12, v6
  v_mov_b32 v13, 0
  v_lshlrev_b32 v6, 16, v200
  v_and_b32 v7, 0xffff0000, v200
  v_add_f32_e64 v13, v13, abs(v6)
  v_add_f32_e64 v13, v13, abs(v7)
  v_lshlrev_b32 v6, 16, v201
  v_and_b32 v7, 0xffff0000, v201
  v_add_f32_e64 v13, v13, abs(v6)
  v_add_f32_e64 v13, v13, abs(v7)
  v_lshlrev_b32 v6, 16, v202
  v_and_b32 v7, 0xffff0000, v202
  v_add_f32_e64 v13, v13, abs(v6)
  v_add_f32_e64 v13, v13, abs(v7)
  v_lshlrev_b32 v6, 16, v203
  v_and_b32 v7, 0xffff0000, v203
  v_add_f32_e64 v13, v13, abs(v6)
  v_add_f32_e64 v13, v13, abs(v7)
  v_lshlrev_b32 v6, 16, v204
  v_and_b32 v7, 0xffff0000, v204
  v_add_f32_e64 v13, v13, abs(v6)
  v_add_f32_e64 v13, v13, abs(v7)
  v_lshlrev_b32 v6, 16, v205
  v_and_b32 v7, 0xffff0000, v205
  v_add_f32_e64 v13, v13, abs(v6)
  v_add_f32_e64 v13, v13, abs(v7)
  v_lshlrev_b32 v6, 16, v206
  v_and_b32 v7, 0xffff0000, v206
  v_add_f32_e64 v13, v13, abs(v6)
  v_add_f32_e64 v13, v13, abs(v7)
  v_lshlrev_b32 v6, 16, v207
  v_and_b32 v7, 0xffff0000, v207
  v_add_f32_e64 v13, v13, abs(v6)
  v_add_f32_e64 v13, v13, abs(v7)
  v_mov_b32 v6, v13
  s_nop 1
  v_permlane32_swap_b32 v13, v6
  v_add_f32 v13, v13, v6
  s_mov_b32 s45, 0
  v_mov_b32 v3, 0
aw_108:
  buffer_load_dword v4, v3, s[8:11], s47 offen sc1
  s_add_u32 s45, s45, 1
  s_waitcnt vmcnt(0)
  v_readfirstlane_b32 s29, v4
  s_cmp_ge_u32 s29, 8
  s_cbranch_scc1 aw_108_ok
  s_cmp_lt_u32 s45, 400000
  s_cbranch_scc1 aw_108
  s_branch kb2_abort
aw_108_ok:
  v_and_b32 v3, 31, v1
  v_lshlrev_b32 v3, 2, v3
  buffer_load_dword v4, v3, s[8:11], s51 offen sc1
  s_lshl_b32 s25, s22, 6
  s_lshl_b32 s27, s25, 11
  s_add_u32 s28, s27, 0xee00000
  s_add_u32 s27, s27, 0xea00000
  s_mov_b32 s41, 0
  s_mul_i32 s53, s41, 32768
  s_lshl_b32 s31, s21, 13
  s_add_u32 s53, s53, s31
  s_add_u32 m0, s31, 0
  s_add_u32 s29, s53, s27
  s_add_u32 s29, s29, 0
  buffer_load_dwordx4 v2, s[8:11], s29 offen sc1 lds
  s_add_u32 m0, s31, 1024
  s_add_u32 s29, s53, s27
  s_add_u32 s29, s29, 1024
  buffer_load_dwordx4 v2, s[8:11], s29 offen sc1 lds
  s_add_u32 m0, s31, 2048
  s_add_u32 s29, s53, s27
  s_add_u32 s29, s29, 2048
  buffer_load_dwordx4 v2, s[8:11], s29 offen sc1 lds
  s_add_u32 m0, s31, 3072
  s_add_u32 s29, s53, s27
  s_add_u32 s29, s29, 3072
  buffer_load_dwordx4 v2, s[8:11], s29 offen sc1 lds
  s_add_u32 m0, s31, 4096
  s_add_u32 s29, s53, s27
  s_add_u32 s29, s29, 4096
  buffer_load_dwordx4 v2, s[8:11], s29 offen sc1 lds
  s_add_u32 m0, s31, 5120
  s_add_u32 s29, s53, s27
  s_add_u32 s29, s29, 5120
  buffer_load_dwordx4 v2, s[8:11], s29 offen sc1 lds
  s_add_u32 m0, s31, 6144
  s_add_u32 s29, s53, s27
  s_add_u32 s29, s29, 6144
  buffer_load_dwordx4 v2, s[8:11], s29 offen sc1 lds
  s_add_u32 m0, s31, 7168
  s_add_u32 s29, s53, s27
  s_add_u32 s29, s29, 7168
  buffer_load_dwordx4 v2, s[8:11], s29 offen sc1 lds
  s_add_u32 m0, s31, 32768
  s_add_u32 s29, s53, s28
  s_add_u32 s29, s29, 0
  buffer_load_dwordx4 v2, s[8:11], s29 offen sc1 lds
  s_add_u32 m0, s31, 33792
  s_add_u32 s29, s53, s28
  s_add_u32 s29, s29, 1024
  buffer_load_dwordx4 v2, s[8:11], s29 offen sc1 lds
  s_add_u32 m0, s31, 34816
  s_add_u32 s29, s53, s28
  s_add_u32 s29, s29, 2048
  buffer_load_dwordx4 v2, s[8:11], s29 offen sc1 lds
  s_add_u32 m0, s31, 35840
  s_add_u32 s29, s53, s28
  s_add_u32 s29, s29, 3072
  buffer_load_dwordx4 v2, s[8:11], s29 offen sc1 lds
  s_add_u32 m0, s31, 36864
  s_add_u32 s29, s53, s28
  s_add_u32 s29, s29, 4096
  buffer_load_dwordx4 v2, s[8:11], s29 offen sc1 lds
  s_add_u32 m0, s31, 37888
  s_add_u32 s29, s53, s28
  s_add_u32 s29, s29, 5120
  buffer_load_dwordx4 v2, s[8:11], s29 offen sc1 lds
  s_add_u32 m0, s31, 38912
  s_add_u32 s29, s53, s28
  s_add_u32 s29, s29, 6144
  buffer_load_dwordx4 v2, s[8:11], s29 offen sc1 lds
  s_add_u32 m0, s31, 39936
  s_add_u32 s29, s53, s28
  s_add_u32 s29, s29, 7168
  buffer_load_dwordx4 v2, s[8:11], s29 offen sc1 lds
  s_waitcnt vmcnt(16)
  v_max_f32_dpp v5, v4, v4 quad_perm:[1,0,3,2] row_mask:0xf bank_mask:0xf
  s_nop 1
  v_max_f32_dpp v4, v5, v5 quad_perm:[2,3,0,1] row_mask:0xf bank_mask:0xf
  s_nop 1
  v_max_f32_dpp v5, v4, v4 row_half_mirror row_mask:0xf bank_mask:0xf
  s_nop 1
  v_max_f32_dpp v4, v5, v5 row_mirror row_mask:0xf bank_mask:0xf
  v_mov_b32 v5, v4
  s_nop 1
  v_permlane16_swap_b32 v4, v5
  v_max_f32 v4, v4, v5
  v_mul_f32 v12, v12, v4
  v_mul_f32 v12, 0x3f820000, v12
  v_mul_f32 v13, v13, v4
  v_mul_f32 v13, 0x3f820000, v13
  s_mov_b32 s40, 0
kb2_main:
  v_lshrrev_b32 v5, 16, v12
  v_or_b32 v5, 0x8000, v5
  v_and_b32 v6, 0xffff0000, v198
  v_or_b32 v5, v5, v6
  v_cndmask_b32 v198, v198, v5, s[34:35]
  v_lshrrev_b32 v5, 16, v13
  v_or_b32 v5, 0x8000, v5
  v_and_b32 v6, 0xffff0000, v206
  v_or_b32 v5, v5, v6
  v_cndmask_b32 v206, v206, v5, s[34:35]
kb2_main2:
  v_mov_b32 v112, 0
  v_mov_b32 v113, 0
  v_mov_b32 v114, 0
  v_mov_b32 v115, 0
  v_mov_b32 v116, 0
  v_mov_b32 v117, 0
  v_mov_b32 v118, 0
  v_mov_b32 v119, 0
  v_mov_b32 v120, 0
  v_mov_b32 v121, 0
  v_mov_b32 v122, 0
  v_mov_b32 v123, 0
  v_mov_b32 v124, 0
  v_mov_b32 v125, 0
  v_mov_b32 v126, 0
  v_mov_b32 v127, 0
  v_mov_b32 v128, 0
  v_mov_b32 v129, 0
  v_mov_b32 v130, 0
  v_mov_b32 v131, 0
  v_mov_b32 v132, 0
  v_mov_b32 v133, 0
  v_mov_b32 v134, 0
  v_mov_b32 v135, 0
  v_mov_b32 v136, 0
  v_mov_b32 v137, 0
  v_mov_b32 v138, 0
  v_mov_b32 v139, 0
  v_mov_b32 v140, 0
  v_mov_b32 v141, 0
  v_mov_b32 v142, 0
  v_mov_b32 v143, 0
  v_mov_b32 v3, v2
  v_add_u32 v4, 65536, v2
kb2_chunk2:
  s_waitcnt vmcnt(0)
  s_barrier
  s_add_u32 s41, s41, 1
  s_min_u32 s29, s41, 3
  s_mul_i32 s53, s29, 32768
  s_lshl_b32 s31, s21, 13
  s_add_u32 s53, s53, s31
  ds_read_b128 v[32:35], v3 offset:0
  ds_read_b128 v[36:39], v3 offset:1024
  ds_read_b128 v[48:51], v3 offset:32768
  ds_read_b128 v[52:55], v3 offset:33792
  ds_read_b128 v[40:43], v3 offset:2048
  ds_read_b128 v[44:47], v3 offset:3072
  s_waitcnt lgkmcnt(4)
  v_mfma_f32_32x32x16_bf16 v[64:79], v[32:35], v[192:195], 0
  v_mfma_f32_32x32x16_bf16 v[64:79], v[36:39], v[196:199], v[64:79]
  s_nop 11
  v_exp_f32 v64, v64
  v_exp_f32 v65, v65
  v_exp_f32 v66, v66
  v_exp_f32 v67, v67
  v_cvt_pk_bf16_f32 v96, v64, v65
  v_exp_f32 v68, v68
  v_exp_f32 v69, v69
  v_cvt_pk_bf16_f32 v97, v66, v67
  v_exp_f32 v70, v70
  v_mfma_f32_32x32x16_bf16 v[80:95], v[32:35], v[200:203], 0
  v_exp_f32 v71, v71
  v_cvt_pk_bf16_f32 v98, v68, v69
  v_exp_f32 v72, v72
  v_exp_f32 v73, v73
  v_cvt_pk_bf16_f32 v99, v70, v71
  v_mfma_f32_32x32x16_bf16 v[80:95], v[36:39], v[204:207], v[80:95]
  v_exp_f32 v74, v74
  v_exp_f32 v75, v75
  ds_read_b128 v[56:59], v3 offset:34816
  v_cvt_pk_bf16_f32 v100, v72, v73
  v_exp_f32 v76, v76
  v_exp_f32 v77, v77
  ds_read_b128 v[60:63], v3 offset:35840
  v_cvt_pk_bf16_f32 v101, v74, v75
  v_exp_f32 v78, v78
  s_add_u32 m0, s31, 65536
  s_add_u32 s29, s53, s27
  s_add_u32 s29, s29, 0
  buffer_load_dwordx4 v2, s[8:11], s29 offen sc1 lds
  v_exp_f32 v79, v79
  v_cvt_pk_bf16_f32 v102, v76, v77
  v_cvt_pk_bf16_f32 v103, v78, v79
  s_waitcnt lgkmcnt(4)
  v_mfma_f32_32x32x16_bf16 v[112:127], v[48:51], v[96:99], v[112:127]
  v_exp_f32 v80, v80
  v_exp_f32 v81, v81
  v_exp_f32 v82, v82
  v_exp_f32 v83, v83
  v_mfma_f32_32x32x16_bf16 v[112:127], v[52:55], v[100:103], v[112:127]
  v_cvt_pk_bf16_f32 v104, v80, v81
  v_exp_f32 v84, v84
  v_exp_f32 v85, v85
  v_cvt_pk_bf16_f32 v105, v82, v83
  v_exp_f32 v86, v86
  s_waitcnt lgkmcnt(2)
  v_mfma_f32_32x32x16_bf16 v[64:79], v[40:43], v[192:195], 0
  v_exp_f32 v87, v87
  v_cvt_pk_bf16_f32 v106, v84, v85
  v_exp_f32 v88, v88
  v_exp_f32 v89, v89
  v_cvt_pk_bf16_f32 v107, v86, v87
  v_mfma_f32_32x32x16_bf16 v[64:79], v[44:47], v[196:199], v[64:79]
  v_exp_f32 v90, v90
  v_exp_f32 v91, v91
  ds_read_b128 v[32:35], v3 offset:4096
  v_cvt_pk_bf16_f32 v108, v88, v89
  v_exp_f32 v92, v92
  v_exp_f32 v93, v93
  ds_read_b128 v[36:39], v3 offset:5120
  v_cvt_pk_bf16_f32 v109, v90, v91
  v_exp_f32 v94, v94
  v_exp_f32 v95, v95
  v_cvt_pk_bf16_f32 v110, v92, v93
  v_cvt_pk_bf16_f32 v111, v94, v95
  v_mfma_f32_32x32x16_bf16 v[128:143], v[48:51], v[104:107], v[128:143]
  v_exp_f32 v64, v64
  v_exp_f32 v65, v65
  v_exp_f32 v66, v66
  v_exp_f32 v67, v67
  v_mfma_f32_32x32x16_bf16 v[128:143], v[52:55], v[108:111], v[128:143]
  v_cvt_pk_bf16_f32 v96, v64, v65
  v_exp_f32 v68, v68
  v_exp_f32 v69, v69
  v_cvt_pk_bf16_f32 v97, v66, v67
  v_exp_f32 v70, v70
  v_mfma_f32_32x32x16_bf16 v[80:95], v[40:43], v[200:203], 0
  v_exp_f32 v71, v71
  v_cvt_pk_bf16_f32 v98, v68, v69
  v_exp_f32 v72, v72
  v_exp_f32 v73, v73
  v_cvt_pk_bf16_f32 v99, v70, v71
  v_mfma_f32_32x32x16_bf16 v[80:95], v[44:47], v[204:207], v[80:95]
  v_exp_f32 v74, v74
  v_exp_f32 v75, v75
  ds_read_b128 v[48:51], v3 offset:36864
  v_cvt_pk_bf16_f32 v100, v72, v73
  v_exp_f32 v76, v76
  v_exp_f32 v77, v77
  ds_read_b128 v[52:55], v3 offset:37888
  v_cvt_pk_bf16_f32 v101, v74, v75
  v_exp_f32 v78, v78
  s_add_u32 m0, s31, 66560
  s_add_u32 s29, s53, s27
  s_add_u32 s29, s29, 1024
  buffer_load_dwordx4 v2, s[8:11], s29 offen sc1 lds
  v_exp_f32 v79, v79
  v_cvt_pk_bf16_f32 v102, v76, v77
  v_cvt_pk_bf16_f32 v103, v78, v79
  s_waitcnt lgkmcnt(4)
  v_mfma_f32_32x32x16_bf16 v[112:127], v[56:59], v[96:99], v[112:127]
  v_exp_f32 v80, v80
  v_exp_f32 v81, v81
  v_exp_f32 v82, v82
  v_exp_f32 v83, v83
  v_mfma_f32_32x32x16_bf16 v[112:127], v[60:63], v[100:103], v[112:127]
  v_cvt_pk_bf16_f32 v104, v80, v81
  v_exp_f32 v84, v84
  v_exp_f32 v85, v85
  v_cvt_pk_bf16_f32 v105, v82, v83
  v_exp_f32 v86, v86
  s_waitcnt lgkmcnt(2)
  v_mfma_f32_32x32x16_bf16 v[64:79], v[32:35], v[192:195], 0
  v_exp_f32 v87, v87
  v_cvt_pk_bf16_f32 v106, v84, v85
  v_exp_f32 v88, v88
  v_exp_f32 v89, v89
  v_cvt_pk_bf16_f32 v107, v86, v87
  v_mfma_f32_32x32x16_bf16 v[64:79], v[36:39], v[196:199], v[64:79]
  v_exp_f32 v90, v90
  v_exp_f32 v91, v91
  ds_read_b128 v[40:43], v3 offset:6144
  v_cvt_pk_bf16_f32 v108, v88, v89
  v_exp_f32 v92, v92
  v_exp_f32 v93, v93
  ds_read_b128 v[44:47], v3 offset:7168
  v_cvt_pk_bf16_f32 v109, v90, v91
  v_exp_f32 v94, v94
  v_exp_f32 v95, v95
  v_cvt_pk_bf16_f32 v110, v92, v93
  v_cvt_pk_bf16_f32 v111, v94, v95
  v_mfma_f32_32x32x16_bf16 v[128:143], v[56:59], v[104:107], v[128:143]
  v_exp_f32 v64, v64
  v_exp_f32 v65, v65
  v_exp_f32 v66, v66
  v_exp_f32 v67, v67
  v_mfma_f32_32x32x16_bf16 v[128:143], v[60:63], v[108:111], v[128:143]
  v_cvt_pk_bf16_f32 v96, v64, v65
  v_exp_f32 v68, v68
  v_exp_f32 v69, v69
  v_cvt_pk_bf16_f32 v97, v66, v67
  v_exp_f32 v70, v70
  v_mfma_f32_32x32x16_bf16 v[80:95], v[32:35], v[200:203], 0
  v_exp_f32 v71, v71
  v_cvt_pk_bf16_f32 v98, v68, v69
  v_exp_f32 v72, v72
  v_exp_f32 v73, v73
  v_cvt_pk_bf16_f32 v99, v70, v71
  v_mfma_f32_32x32x16_bf16 v[80:95], v[36:39], v[204:207], v[80:95]
  v_exp_f32 v74, v74
  v_exp_f32 v75, v75
  ds_read_b128 v[56:59], v3 offset:38912
  v_cvt_pk_bf16_f32 v100, v72, v73
  v_exp_f32 v76, v76
  v_exp_f32 v77, v77
  ds_read_b128 v[60:63], v3 offset:39936
  v_cvt_pk_bf16_f32 v101, v74, v75
  v_exp_f32 v78, v78
  s_add_u32 m0, s31, 67584
  s_add_u32 s29, s53, s27
  s_add_u32 s29, s29, 2048
  buffer_load_dwordx4 v2, s[8:11], s29 offen sc1 lds
  v_exp_f32 v79, v79
  v_cvt_pk_bf16_f32 v102, v76, v77
  v_cvt_pk_bf16_f32 v103, v78, v79
  s_waitcnt lgkmcnt(4)
  v_mfma_f32_32x32x16_bf16 v[112:127], v[48:51], v[96:99], v[112:127]
  v_exp_f32 v80, v80
  v_exp_f32 v81, v81
  v_exp_f32 v82, v82
  v_exp_f32 v83, v83
  v_mfma_f32_32x32x16_bf16 v[112:127], v[52:55], v[100:103], v[112:127]
  v_cvt_pk_bf16_f32 v104, v80, v81
  v_exp_f32 v84, v84
  v_exp_f32 v85, v85
  v_cvt_pk_bf16_f32 v105, v82, v83
  v_exp_f32 v86, v86
  s_waitcnt lgkmcnt(2)
  v_mfma_f32_32x32x16_bf16 v[64:79], v[40:43], v[192:195], 0
  v_exp_f32 v87, v87
  v_cvt_pk_bf16_f32 v106, v84, v85
  v_exp_f32 v88, v88
  v_exp_f32 v89, v89
  v_cvt_pk_bf16_f32 v107, v86, v87
  v_mfma_f32_32x32x16_bf16 v[64:79], v[44:47], v[196:199], v[64:79]
  v_exp_f32 v90, v90
  v_exp_f32 v91, v91
  ds_read_b128 v[32:35], v3 offset:8192
  v_cvt_pk_bf16_f32 v108, v88, v89
  v_exp_f32 v92, v92
  v_exp_f32 v93, v93
  ds_read_b128 v[36:39], v3 offset:9216
  v_cvt_pk_bf16_f32 v109, v90, v91
  v_exp_f32 v94, v94
  v_exp_f32 v95, v95
  v_cvt_pk_bf16_f32 v110, v92, v93
  v_cvt_pk_bf16_f32 v111, v94, v95
  v_mfma_f32_32x32x16_bf16 v[128:143], v[48:51], v[104:107], v[128:143]
  v_exp_f32 v64, v64
  v_exp_f32 v65, v65
  v_exp_f32 v66, v66
  v_exp_f32 v67, v67
  v_mfma_f32_32x32x16_bf16 v[128:143], v[52:55], v[108:111], v[128:143]
  v_cvt_pk_bf16_f32 v96, v64, v65
  v_exp_f32 v68, v68
  v_exp_f32 v69, v69
  v_cvt_pk_bf16_f32 v97, v66, v67
  v_exp_f32 v70, v70
  v_mfma_f32_32x32x16_bf16 v[80:95], v[40:43], v[200:203], 0
  v_exp_f32 v71, v71
  v_cvt_pk_bf16_f32 v98, v68, v69
  v_exp_f32 v72, v72
  v_exp_f32 v73, v73
  v_cvt_pk_bf16_f32 v99, v70, v71
  v_mfma_f32_32x32x16_bf16 v[80:95], v[44:47], v[204:207], v[80:95]
  v_exp_f32 v74, v74
  v_exp_f32 v75, v75
  ds_read_b128 v[48:51], v3 offset:40960
  v_cvt_pk_bf16_f32 v100, v72, v73
  v_exp_f32 v76, v76
  v_exp_f32 v77, v77
  ds_read_b128 v[52:55], v3 offset:41984
  v_cvt_pk_bf16_f32 v101, v74, v75
  v_exp_f32 v78, v78
  s_add_u32 m0, s31, 68608
  s_add_u32 s29, s53, s27
  s_add_u32 s29, s29, 3072
  buffer_load_dwordx4 v2, s[8:11], s29 offen sc1 lds
  v_exp_f32 v79, v79
  v_cvt_pk_bf16_f32 v102, v76, v77
  v_cvt_pk_bf16_f32 v103, v78, v79
  s_waitcnt lgkmcnt(4)
  v_mfma_f32_32x32x16_bf16 v[112:127], v[56:59], v[96:99], v[112:127]
  v_exp_f32 v80, v80
  v_exp_f32 v81, v81
  v_exp_f32 v82, v82
  v_exp_f32 v83, v83
  v_mfma_f32_32x32x16_bf16 v[112:127], v[60:63], v[100:103], v[112:127]
  v_cvt_pk_bf16_f32 v104, v80, v81
  v_exp_f32 v84, v84
  v_exp_f32 v85, v85
  v_cvt_pk_bf16_f32 v105, v82, v83
  v_exp_f32 v86, v86
  s_waitcnt lgkmcnt(2)
  v_mfma_f32_32x32x16_bf16 v[64:79], v[32:35], v[192:195], 0
  v_exp_f32 v87, v87
  v_cvt_pk_bf16_f32 v106, v84, v85
  v_exp_f32 v88, v88
  v_exp_f32 v89, v89
  v_cvt_pk_bf16_f32 v107, v86, v87
  v_mfma_f32_32x32x16_bf16 v[64:79], v[36:39], v[196:199], v[64:79]
  v_exp_f32 v90, v90
  v_exp_f32 v91, v91
  ds_read_b128 v[40:43], v3 offset:10240
  v_cvt_pk_bf16_f32 v108, v88, v89
  v_exp_f32 v92, v92
  v_exp_f32 v93, v93
  ds_read_b128 v[44:47], v3 offset:11264
  v_cvt_pk_bf16_f32 v109, v90, v91
  v_exp_f32 v94, v94
  v_exp_f32 v95, v95
  v_cvt_pk_bf16_f32 v110, v92, v93
  v_cvt_pk_bf16_f32 v111, v94, v95
  v_mfma_f32_32x32x16_bf16 v[128:143], v[56:59], v[104:107], v[128:143]
  v_exp_f32 v64, v64
  v_exp_f32 v65, v65
  v_exp_f32 v66, v66
  v_exp_f32 v67, v67
  v_mfma_f32_32x32x16_bf16 v[128:143], v[60:63], v[108:111], v[128:143]
  v_cvt_pk_bf16_f32 v96, v64, v65
  v_exp_f32 v68, v68
  v_exp_f32 v69, v69
  v_cvt_pk_bf16_f32 v97, v66, v67
  v_exp_f32 v70, v70
  v_mfma_f32_32x32x16_bf16 v[80:95], v[32:35], v[200:203], 0
  v_exp_f32 v71, v71
  v_cvt_pk_bf16_f32 v98, v68, v69
  v_exp_f32 v72, v72
  v_exp_f32 v73, v73
  v_cvt_pk_bf16_f32 v99, v70, v71
  v_mfma_f32_32x32x16_bf16 v[80:95], v[36:39], v[204:207], v[80:95]
  v_exp_f32 v74, v74
  v_exp_f32 v75, v75
  ds_read_b128 v[56:59], v3 offset:43008
  v_cvt_pk_bf16_f32 v100, v72, v73
  v_exp_f32 v76, v76
  v_exp_f32 v77, v77
  ds_read_b128 v[60:63], v3 offset:44032
  v_cvt_pk_bf16_f32 v101, v74, v75
  v_exp_f32 v78, v78
  s_add_u32 m0, s31, 69632
  s_add_u32 s29, s53, s27
  s_add_u32 s29, s29, 4096
  buffer_load_dwordx4 v2, s[8:11], s29 offen sc1 lds
  v_exp_f32 v79, v79
  v_cvt_pk_bf16_f32 v102, v76, v77
  v_cvt_pk_bf16_f32 v103, v78, v79
  s_waitcnt lgkmcnt(4)
  v_mfma_f32_32x32x16_bf16 v[112:127], v[48:51], v[96:99], v[112:127]
  v_exp_f32 v80, v80
  v_exp_f32 v81, v81
  v_exp_f32 v82, v82
  v_exp_f32 v83, v83
  v_mfma_f32_32x32x16_bf16 v[112:127], v[52:55], v[100:103], v[112:127]
  v_cvt_pk_bf16_f32 v104, v80, v81
  v_exp_f32 v84, v84
  v_exp_f32 v85, v85
  v_cvt_pk_bf16_f32 v105, v82, v83
  v_exp_f32 v86, v86
  s_waitcnt lgkmcnt(2)
  v_mfma_f32_32x32x16_bf16 v[64:79], v[40:43], v[192:195], 0
  v_exp_f32 v87, v87
  v_cvt_pk_bf16_f32 v106, v84, v85
  v_exp_f32 v88, v88
  v_exp_f32 v89, v89
  v_cvt_pk_bf16_f32 v107, v86, v87
  v_mfma_f32_32x32x16_bf16 v[64:79], v[44:47], v[196:199], v[64:79]
  v_exp_f32 v90, v90
  v_exp_f32 v91, v91
  ds_read_b128 v[32:35], v3 offset:12288
  v_cvt_pk_bf16_f32 v108, v88, v89
  v_exp_f32 v92, v92
  v_exp_f32 v93, v93
  ds_read_b128 v[36:39], v3 offset:13312
  v_cvt_pk_bf16_f32 v109, v90, v91
  v_exp_f32 v94, v94
  v_exp_f32 v95, v95
  v_cvt_pk_bf16_f32 v110, v92, v93
  v_cvt_pk_bf16_f32 v111, v94, v95
  v_mfma_f32_32x32x16_bf16 v[128:143], v[48:51], v[104:107], v[128:143]
  v_exp_f32 v64, v64
  v_exp_f32 v65, v65
  v_exp_f32 v66, v66
  v_exp_f32 v67, v67
  v_mfma_f32_32x32x16_bf16 v[128:143], v[52:55], v[108:111], v[128:143]
  v_cvt_pk_bf16_f32 v96, v64, v65
  v_exp_f32 v68, v68
  v_exp_f32 v69, v69
  v_cvt_pk_bf16_f32 v97, v66, v67
  v_exp_f32 v70, v70
  v_mfma_f32_32x32x16_bf16 v[80:95], v[40:43], v[200:203], 0
  v_exp_f32 v71, v71
  v_cvt_pk_bf16_f32 v98, v68, v69
  v_exp_f32 v72, v72
  v_exp_f32 v73, v73
  v_cvt_pk_bf16_f32 v99, v70, v71
  v_mfma_f32_32x32x16_bf16 v[80:95], v[44:47], v[204:207], v[80:95]
  v_exp_f32 v74, v74
  v_exp_f32 v75, v75
  ds_read_b128 v[48:51], v3 offset:45056
  v_cvt_pk_bf16_f32 v100, v72, v73
  v_exp_f32 v76, v76
  v_exp_f32 v77, v77
  ds_read_b128 v[52:55], v3 offset:46080
  v_cvt_pk_bf16_f32 v101, v74, v75
  v_exp_f32 v78, v78
  s_add_u32 m0, s31, 70656
  s_add_u32 s29, s53, s27
  s_add_u32 s29, s29, 5120
  buffer_load_dwordx4 v2, s[8:11], s29 offen sc1 lds
  v_exp_f32 v79, v79
  v_cvt_pk_bf16_f32 v102, v76, v77
  v_cvt_pk_bf16_f32 v103, v78, v79
  s_waitcnt lgkmcnt(4)
  v_mfma_f32_32x32x16_bf16 v[112:127], v[56:59], v[96:99], v[112:127]
  v_exp_f32 v80, v80
  v_exp_f32 v81, v81
  v_exp_f32 v82, v82
  v_exp_f32 v83, v83
  v_mfma_f32_32x32x16_bf16 v[112:127], v[60:63], v[100:103], v[112:127]
  v_cvt_pk_bf16_f32 v104, v80, v81
  v_exp_f32 v84, v84
  v_exp_f32 v85, v85
  v_cvt_pk_bf16_f32 v105, v82, v83
  v_exp_f32 v86, v86
  s_waitcnt lgkmcnt(2)
  v_mfma_f32_32x32x16_bf16 v[64:79], v[32:35], v[192:195], 0
  v_exp_f32 v87, v87
  v_cvt_pk_bf16_f32 v106, v84, v85
  v_exp_f32 v88, v88
  v_exp_f32 v89, v89
  v_cvt_pk_bf16_f32 v107, v86, v87
  v_mfma_f32_32x32x16_bf16 v[64:79], v[36:39], v[196:199], v[64:79]
  v_exp_f32 v90, v90
  v_exp_f32 v91, v91
  ds_read_b128 v[40:43], v3 offset:14336
  v_cvt_pk_bf16_f32 v108, v88, v89
  v_exp_f32 v92, v92
  v_exp_f32 v93, v93
  ds_read_b128 v[44:47], v3 offset:15360
  v_cvt_pk_bf16_f32 v109, v90, v91
  v_exp_f32 v94, v94
  v_exp_f32 v95, v95
  v_cvt_pk_bf16_f32 v110, v92, v93
  v_cvt_pk_bf16_f32 v111, v94, v95
  v_mfma_f32_32x32x16_bf16 v[128:143], v[56:59], v[104:107], v[128:143]
  v_exp_f32 v64, v64
  v_exp_f32 v65, v65
  v_exp_f32 v66, v66
  v_exp_f32 v67, v67
  v_mfma_f32_32x32x16_bf16 v[128:143], v[60:63], v[108:111], v[128:143]
  v_cvt_pk_bf16_f32 v96, v64, v65
  v_exp_f32 v68, v68
  v_exp_f32 v69, v69
  v_cvt_pk_bf16_f32 v97, v66, v67
  v_exp_f32 v70, v70
  v_mfma_f32_32x32x16_bf16 v[80:95], v[32:35], v[200:203], 0
  v_exp_f32 v71, v71
  v_cvt_pk_bf16_f32 v98, v68, v69
  v_exp_f32 v72, v72
  v_exp_f32 v73, v73
  v_cvt_pk_bf16_f32 v99, v70, v71
  v_mfma_f32_32x32x16_bf16 v[80:95], v[36:39], v[204:207], v[80:95]
  v_exp_f32 v74, v74
  v_exp_f32 v75, v75
  ds_read_b128 v[56:59], v3 offset:47104
  v_cvt_pk_bf16_f32 v100, v72, v73
  v_exp_f32 v76, v76
  v_exp_f32 v77, v77
  ds_read_b128 v[60:63], v3 offset:48128
  v_cvt_pk_bf16_f32 v101, v74, v75
  v_exp_f32 v78, v78
  s_add_u32 m0, s31, 71680
  s_add_u32 s29, s53, s27
  s_add_u32 s29, s29, 6144
  buffer_load_dwordx4 v2, s[8:11], s29 offen sc1 lds
  v_exp_f32 v79, v79
  v_cvt_pk_bf16_f32 v102, v76, v77
  v_cvt_pk_bf16_f32 v103, v78, v79
  s_waitcnt lgkmcnt(4)
  v_mfma_f32_32x32x16_bf16 v[112:127], v[48:51], v[96:99], v[112:127]
  v_exp_f32 v80, v80
  v_exp_f32 v81, v81
  v_exp_f32 v82, v82
  v_exp_f32 v83, v83
  v_mfma_f32_32x32x16_bf16 v[112:127], v[52:55], v[100:103], v[112:127]
  v_cvt_pk_bf16_f32 v104, v80, v81
  v_exp_f32 v84, v84
  v_exp_f32 v85, v85
  v_cvt_pk_bf16_f32 v105, v82, v83
  v_exp_f32 v86, v86
  s_waitcnt lgkmcnt(2)
  v_mfma_f32_32x32x16_bf16 v[64:79], v[40:43], v[192:195], 0
  v_exp_f32 v87, v87
  v_cvt_pk_bf16_f32 v106, v84, v85
  v_exp_f32 v88, v88
  v_exp_f32 v89, v89
  v_cvt_pk_bf16_f32 v107, v86, v87
  v_mfma_f32_32x32x16_bf16 v[64:79], v[44:47], v[196:199], v[64:79]
  v_exp_f32 v90, v90
  v_exp_f32 v91, v91
  ds_read_b128 v[32:35], v3 offset:16384
  v_cvt_pk_bf16_f32 v108, v88, v89
  v_exp_f32 v92, v92
  v_exp_f32 v93, v93
  ds_read_b128 v[36:39], v3 offset:17408
  v_cvt_pk_bf16_f32 v109, v90, v91
  v_exp_f32 v94, v94
  v_exp_f32 v95, v95
  v_cvt_pk_bf16_f32 v110, v92, v93
  v_cvt_pk_bf16_f32 v111, v94, v95
  v_mfma_f32_32x32x16_bf16 v[128:143], v[48:51], v[104:107], v[128:143]
  v_exp_f32 v64, v64
  v_exp_f32 v65, v65
  v_exp_f32 v66, v66
  v_exp_f32 v67, v67
  v_mfma_f32_32x32x16_bf16 v[128:143], v[52:55], v[108:111], v[128:143]
  v_cvt_pk_bf16_f32 v96, v64, v65
  v_exp_f32 v68, v68
  v_exp_f32 v69, v69
  v_cvt_pk_bf16_f32 v97, v66, v67
  v_exp_f32 v70, v70
  v_mfma_f32_32x32x16_bf16 v[80:95], v[40:43], v[200:203], 0
  v_exp_f32 v71, v71
  v_cvt_pk_bf16_f32 v98, v68, v69
  v_exp_f32 v72, v72
  v_exp_f32 v73, v73
  v_cvt_pk_bf16_f32 v99, v70, v71
  v_mfma_f32_32x32x16_bf16 v[80:95], v[44:47], v[204:207], v[80:95]
  v_exp_f32 v74, v74
  v_exp_f32 v75, v75
  ds_read_b128 v[48:51], v3 offset:49152
  v_cvt_pk_bf16_f32 v100, v72, v73
  v_exp_f32 v76, v76
  v_exp_f32 v77, v77
  ds_read_b128 v[52:55], v3 offset:50176
  v_cvt_pk_bf16_f32 v101, v74, v75
  v_exp_f32 v78, v78
  s_add_u32 m0, s31, 72704
  s_add_u32 s29, s53, s27
  s_add_u32 s29, s29, 7168
  buffer_load_dwordx4 v2, s[8:11], s29 offen sc1 lds
  v_exp_f32 v79, v79
  v_cvt_pk_bf16_f32 v102, v76, v77
  v_cvt_pk_bf16_f32 v103, v78, v79
  s_waitcnt lgkmcnt(4)
  v_mfma_f32_32x32x16_bf16 v[112:127], v[56:59], v[96:99], v[112:127]
  v_exp_f32 v80, v80
  v_exp_f32 v81, v81
  v_exp_f32 v82, v82
  v_exp_f32 v83, v83
  v_mfma_f32_32x32x16_bf16 v[112:127], v[60:63], v[100:103], v[112:127]
  v_cvt_pk_bf16_f32 v104, v80, v81
  v_exp_f32 v84, v84
  v_exp_f32 v85, v85
  v_cvt_pk_bf16_f32 v105, v82, v83
  v_exp_f32 v86, v86
  s_waitcnt lgkmcnt(2)
  v_mfma_f32_32x32x16_bf16 v[64:79], v[32:35], v[192:195], 0
  v_exp_f32 v87, v87
  v_cvt_pk_bf16_f32 v106, v84, v85
  v_exp_f32 v88, v88
  v_exp_f32 v89, v89
  v_cvt_pk_bf16_f32 v107, v86, v87
  v_mfma_f32_32x32x16_bf16 v[64:79], v[36:39], v[196:199], v[64:79]
  v_exp_f32 v90, v90
  v_exp_f32 v91, v91
  ds_read_b128 v[40:43], v3 offset:18432
  v_cvt_pk_bf16_f32 v108, v88, v89
  v_exp_f32 v92, v92
  v_exp_f32 v93, v93
  ds_read_b128 v[44:47], v3 offset:19456
  v_cvt_pk_bf16_f32 v109, v90, v91
  v_exp_f32 v94, v94
  v_exp_f32 v95, v95
  v_cvt_pk_bf16_f32 v110, v92, v93
  v_cvt_pk_bf16_f32 v111, v94, v95
  v_mfma_f32_32x32x16_bf16 v[128:143], v[56:59], v[104:107], v[128:143]
  v_exp_f32 v64, v64
  v_exp_f32 v65, v65
  v_exp_f32 v66, v66
  v_exp_f32 v67, v67
  v_mfma_f32_32x32x16_bf16 v[128:143], v[60:63], v[108:111], v[128:143]
  v_cvt_pk_bf16_f32 v96, v64, v65
  v_exp_f32 v68, v68
  v_exp_f32 v69, v69
  v_cvt_pk_bf16_f32 v97, v66, v67
  v_exp_f32 v70, v70
  v_mfma_f32_32x32x16_bf16 v[80:95], v[32:35], v[200:203], 0
  v_exp_f32 v71, v71
  v_cvt_pk_bf16_f32 v98, v68, v69
  v_exp_f32 v72, v72
  v_exp_f32 v73, v73
  v_cvt_pk_bf16_f32 v99, v70, v71
  v_mfma_f32_32x32x16_bf16 v[80:95], v[36:39], v[204:207], v[80:95]
  v_exp_f32 v74, v74
  v_exp_f32 v75, v75
  ds_read_b128 v[56:59], v3 offset:51200
  v_cvt_pk_bf16_f32 v100, v72, v73
  v_exp_f32 v76, v76
  v_exp_f32 v77, v77
  ds_read_b128 v[60:63], v3 offset:52224
  v_cvt_pk_bf16_f32 v101, v74, v75
  v_exp_f32 v78, v78
  s_add_u32 m0, s31, 98304
  s_add_u32 s29, s53, s28
  s_add_u32 s29, s29, 0
  buffer_load_dwordx4 v2, s[8:11], s29 offen sc1 lds
  v_exp_f32 v79, v79
  v_cvt_pk_bf16_f32 v102, v76, v77
  v_cvt_pk_bf16_f32 v103, v78, v79
  s_waitcnt lgkmcnt(4)
  v_mfma_f32_32x32x16_bf16 v[112:127], v[48:51], v[96:99], v[112:127]
  v_exp_f32 v80, v80
  v_exp_f32 v81, v81
  v_exp_f32 v82, v82
  v_exp_f32 v83, v83
  v_mfma_f32_32x32x16_bf16 v[112:127], v[52:55], v[100:103], v[112:127]
  v_cvt_pk_bf16_f32 v104, v80, v81
  v_exp_f32 v84, v84
  v_exp_f32 v85, v85
  v_cvt_pk_bf16_f32 v105, v82, v83
  v_exp_f32 v86, v86
  s_waitcnt lgkmcnt(2)
  v_mfma_f32_32x32x16_bf16 v[64:79], v[40:43], v[192:195], 0
  v_exp_f32 v87, v87
  v_cvt_pk_bf16_f32 v106, v84, v85
  v_exp_f32 v88, v88
  v_exp_f32 v89, v89
  v_cvt_pk_bf16_f32 v107, v86, v87
  v_mfma_f32_32x32x16_bf16 v[64:79], v[44:47], v[196:199], v[64:79]
  v_exp_f32 v90, v90
  v_exp_f32 v91, v91
  ds_read_b128 v[32:35], v3 offset:20480
  v_cvt_pk_bf16_f32 v108, v88, v89
  v_exp_f32 v92, v92
  v_exp_f32 v93, v93
  ds_read_b128 v[36:39], v3 offset:21504
  v_cvt_pk_bf16_f32 v109, v90, v91
  v_exp_f32 v94, v94
  v_exp_f32 v95, v95
  v_cvt_pk_bf16_f32 v110, v92, v93
  v_cvt_pk_bf16_f32 v111, v94, v95
  v_mfma_f32_32x32x16_bf16 v[128:143], v[48:51], v[104:107], v[128:143]
  v_exp_f32 v64, v64
  v_exp_f32 v65, v65
  v_exp_f32 v66, v66
  v_exp_f32 v67, v67
  v_mfma_f32_32x32x16_bf16 v[128:143], v[52:55], v[108:111], v[128:143]
  v_cvt_pk_bf16_f32 v96, v64, v65
  v_exp_f32 v68, v68
  v_exp_f32 v69, v69
  v_cvt_pk_bf16_f32 v97, v66, v67
  v_exp_f32 v70, v70
  v_mfma_f32_32x32x16_bf16 v[80:95], v[40:43], v[200:203], 0
  v_exp_f32 v71, v71
  v_cvt_pk_bf16_f32 v98, v68, v69
  v_exp_f32 v72, v72
  v_exp_f32 v73, v73
  v_cvt_pk_bf16_f32 v99, v70, v71
  v_mfma_f32_32x32x16_bf16 v[80:95], v[44:47], v[204:207], v[80:95]
  v_exp_f32 v74, v74
  v_exp_f32 v75, v75
  ds_read_b128 v[48:51], v3 offset:53248
  v_cvt_pk_bf16_f32 v100, v72, v73
  v_exp_f32 v76, v76
  v_exp_f32 v77, v77
  ds_read_b128 v[52:55], v3 offset:54272
  v_cvt_pk_bf16_f32 v101, v74, v75
  v_exp_f32 v78, v78
  s_add_u32 m0, s31, 99328
  s_add_u32 s29, s53, s28
  s_add_u32 s29, s29, 1024
  buffer_load_dwordx4 v2, s[8:11], s29 offen sc1 lds
  v_exp_f32 v79, v79
  v_cvt_pk_bf16_f32 v102, v76, v77
  v_cvt_pk_bf16_f32 v103, v78, v79
  s_waitcnt lgkmcnt(4)
  v_mfma_f32_32x32x16_bf16 v[112:127], v[56:59], v[96:99], v[112:127]
  v_exp_f32 v80, v80
  v_exp_f32 v81, v81
  v_exp_f32 v82, v82
  v_exp_f32 v83, v83
  v_mfma_f32_32x32x16_bf16 v[112:127], v[60:63], v[100:103], v[112:127]
  v_cvt_pk_bf16_f32 v104, v80, v81
  v_exp_f32 v84, v84
  v_exp_f32 v85, v85
  v_cvt_pk_bf16_f32 v105, v82, v83
  v_exp_f32 v86, v86
  s_waitcnt lgkmcnt(2)
  v_mfma_f32_32x32x16_bf16 v[64:79], v[32:35], v[192:195], 0
  v_exp_f32 v87, v87
  v_cvt_pk_bf16_f32 v106, v84, v85
  v_exp_f32 v88, v88
  v_exp_f32 v89, v89
  v_cvt_pk_bf16_f32 v107, v86, v87
  v_mfma_f32_32x32x16_bf16 v[64:79], v[36:39], v[196:199], v[64:79]
  v_exp_f32 v90, v90
  v_exp_f32 v91, v91
  ds_read_b128 v[40:43], v3 offset:22528
  v_cvt_pk_bf16_f32 v108, v88, v89
  v_exp_f32 v92, v92
  v_exp_f32 v93, v93
  ds_read_b128 v[44:47], v3 offset:23552
  v_cvt_pk_bf16_f32 v109, v90, v91
  v_exp_f32 v94, v94
  v_exp_f32 v95, v95
  v_cvt_pk_bf16_f32 v110, v92, v93
  v_cvt_pk_bf16_f32 v111, v94, v95
  v_mfma_f32_32x32x16_bf16 v[128:143], v[56:59], v[104:107], v[128:143]
  v_exp_f32 v64, v64
  v_exp_f32 v65, v65
  v_exp_f32 v66, v66
  v_exp_f32 v67, v67
  v_mfma_f32_32x32x16_bf16 v[128:143], v[60:63], v[108:111], v[128:143]
  v_cvt_pk_bf16_f32 v96, v64, v65
  v_exp_f32 v68, v68
  v_exp_f32 v69, v69
  v_cvt_pk_bf16_f32 v97, v66, v67
  v_exp_f32 v70, v70
  v_mfma_f32_32x32x16_bf16 v[80:95], v[32:35], v[200:203], 0
  v_exp_f32 v71, v71
  v_cvt_pk_bf16_f32 v98, v68, v69
  v_exp_f32 v72, v72
  v_exp_f32 v73, v73
  v_cvt_pk_bf16_f32 v99, v70, v71
  v_mfma_f32_32x32x16_bf16 v[80:95], v[36:39], v[204:207], v[80:95]
  v_exp_f32 v74, v74
  v_exp_f32 v75, v75
  ds_read_b128 v[56:59], v3 offset:55296
  v_cvt_pk_bf16_f32 v100, v72, v73
  v_exp_f32 v76, v76
  v_exp_f32 v77, v77
  ds_read_b128 v[60:63], v3 offset:56320
  v_cvt_pk_bf16_f32 v101, v74, v75
  v_exp_f32 v78, v78
  s_add_u32 m0, s31, 100352
  s_add_u32 s29, s53, s28
  s_add_u32 s29, s29, 2048
  buffer_load_dwordx4 v2, s[8:11], s29 offen sc1 lds
  v_exp_f32 v79, v79
  v_cvt_pk_bf16_f32 v102, v76, v77
  v_cvt_pk_bf16_f32 v103, v78, v79
  s_waitcnt lgkmcnt(4)
  v_mfma_f32_32x32x16_bf16 v[112:127], v[48:51], v[96:99], v[112:127]
  v_exp_f32 v80, v80
  v_exp_f32 v81, v81
  v_exp_f32 v82, v82
  v_exp_f32 v83, v83
  v_mfma_f32_32x32x16_bf16 v[112:127], v[52:55], v[100:103], v[112:127]
  v_cvt_pk_bf16_f32 v104, v80, v81
  v_exp_f32 v84, v84
  v_exp_f32 v85, v85
  v_cvt_pk_bf16_f32 v105, v82, v83
  v_exp_f32 v86, v86
  s_waitcnt lgkmcnt(2)
  v_mfma_f32_32x32x16_bf16 v[64:79], v[40:43], v[192:195], 0
  v_exp_f32 v87, v87
  v_cvt_pk_bf16_f32 v106, v84, v85
  v_exp_f32 v88, v88
  v_exp_f32 v89, v89
  v_cvt_pk_bf16_f32 v107, v86, v87
  v_mfma_f32_32x32x16_bf16 v[64:79], v[44:47], v[196:199], v[64:79]
  v_exp_f32 v90, v90
  v_exp_f32 v91, v91
  ds_read_b128 v[32:35], v3 offset:24576
  v_cvt_pk_bf16_f32 v108, v88, v89
  v_exp_f32 v92, v92
  v_exp_f32 v93, v93
  ds_read_b128 v[36:39], v3 offset:25600
  v_cvt_pk_bf16_f32 v109, v90, v91
  v_exp_f32 v94, v94
  v_exp_f32 v95, v95
  v_cvt_pk_bf16_f32 v110, v92, v93
  v_cvt_pk_bf16_f32 v111, v94, v95
  v_mfma_f32_32x32x16_bf16 v[128:143], v[48:51], v[104:107], v[128:143]
  v_exp_f32 v64, v64
  v_exp_f32 v65, v65
  v_exp_f32 v66, v66
  v_exp_f32 v67, v67
  v_mfma_f32_32x32x16_bf16 v[128:143], v[52:55], v[108:111], v[128:143]
  v_cvt_pk_bf16_f32 v96, v64, v65
  v_exp_f32 v68, v68
  v_exp_f32 v69, v69
  v_cvt_pk_bf16_f32 v97, v66, v67
  v_exp_f32 v70, v70
  v_mfma_f32_32x32x16_bf16 v[80:95], v[40:43], v[200:203], 0
  v_exp_f32 v71, v71
  v_cvt_pk_bf16_f32 v98, v68, v69
  v_exp_f32 v72, v72
  v_exp_f32 v73, v73
  v_cvt_pk_bf16_f32 v99, v70, v71
  v_mfma_f32_32x32x16_bf16 v[80:95], v[44:47], v[204:207], v[80:95]
  v_exp_f32 v74, v74
  v_exp_f32 v75, v75
  ds_read_b128 v[48:51], v3 offset:57344
  v_cvt_pk_bf16_f32 v100, v72, v73
  v_exp_f32 v76, v76
  v_exp_f32 v77, v77
  ds_read_b128 v[52:55], v3 offset:58368
  v_cvt_pk_bf16_f32 v101, v74, v75
  v_exp_f32 v78, v78
  s_add_u32 m0, s31, 101376
  s_add_u32 s29, s53, s28
  s_add_u32 s29, s29, 3072
  buffer_load_dwordx4 v2, s[8:11], s29 offen sc1 lds
  v_exp_f32 v79, v79
  v_cvt_pk_bf16_f32 v102, v76, v77
  v_cvt_pk_bf16_f32 v103, v78, v79
  s_waitcnt lgkmcnt(4)
  v_mfma_f32_32x32x16_bf16 v[112:127], v[56:59], v[96:99], v[112:127]
  v_exp_f32 v80, v80
  v_exp_f32 v81, v81
  v_exp_f32 v82, v82
  v_exp_f32 v83, v83
  v_mfma_f32_32x32x16_bf16 v[112:127], v[60:63], v[100:103], v[112:127]
  v_cvt_pk_bf16_f32 v104, v80, v81
  v_exp_f32 v84, v84
  v_exp_f32 v85, v85
  v_cvt_pk_bf16_f32 v105, v82, v83
  v_exp_f32 v86, v86
  s_waitcnt lgkmcnt(2)
  v_mfma_f32_32x32x16_bf16 v[64:79], v[32:35], v[192:195], 0
  v_exp_f32 v87, v87
  v_cvt_pk_bf16_f32 v106, v84, v85
  v_exp_f32 v88, v88
  v_exp_f32 v89, v89
  v_cvt_pk_bf16_f32 v107, v86, v87
  v_mfma_f32_32x32x16_bf16 v[64:79], v[36:39], v[196:199], v[64:79]
  v_exp_f32 v90, v90
  v_exp_f32 v91, v91
  ds_read_b128 v[40:43], v3 offset:26624
  v_cvt_pk_bf16_f32 v108, v88, v89
  v_exp_f32 v92, v92
  v_exp_f32 v93, v93
  ds_read_b128 v[44:47], v3 offset:27648
  v_cvt_pk_bf16_f32 v109, v90, v91
  v_exp_f32 v94, v94
  v_exp_f32 v95, v95
  v_cvt_pk_bf16_f32 v110, v92, v93
  v_cvt_pk_bf16_f32 v111, v94, v95
  v_mfma_f32_32x32x16_bf16 v[128:143], v[56:59], v[104:107], v[128:143]
  v_exp_f32 v64, v64
  v_exp_f32 v65, v65
  v_exp_f32 v66, v66
  v_exp_f32 v67, v67
  v_mfma_f32_32x32x16_bf16 v[128:143], v[60:63], v[108:111], v[128:143]
  v_cvt_pk_bf16_f32 v96, v64, v65
  v_exp_f32 v68, v68
  v_exp_f32 v69, v69
  v_cvt_pk_bf16_f32 v97, v66, v67
  v_exp_f32 v70, v70
  v_mfma_f32_32x32x16_bf16 v[80:95], v[32:35], v[200:203], 0
  v_exp_f32 v71, v71
  v_cvt_pk_bf16_f32 v98, v68, v69
  v_exp_f32 v72, v72
  v_exp_f32 v73, v73
  v_cvt_pk_bf16_f32 v99, v70, v71
  v_mfma_f32_32x32x16_bf16 v[80:95], v[36:39], v[204:207], v[80:95]
  v_exp_f32 v74, v74
  v_exp_f32 v75, v75
  ds_read_b128 v[56:59], v3 offset:59392
  v_cvt_pk_bf16_f32 v100, v72, v73
  v_exp_f32 v76, v76
  v_exp_f32 v77, v77
  ds_read_b128 v[60:63], v3 offset:60416
  v_cvt_pk_bf16_f32 v101, v74, v75
  v_exp_f32 v78, v78
  s_add_u32 m0, s31, 102400
  s_add_u32 s29, s53, s28
  s_add_u32 s29, s29, 4096
  buffer_load_dwordx4 v2, s[8:11], s29 offen sc1 lds
  v_exp_f32 v79, v79
  v_cvt_pk_bf16_f32 v102, v76, v77
  v_cvt_pk_bf16_f32 v103, v78, v79
  s_waitcnt lgkmcnt(4)
  v_mfma_f32_32x32x16_bf16 v[112:127], v[48:51], v[96:99], v[112:127]
  v_exp_f32 v80, v80
  v_exp_f32 v81, v81
  v_exp_f32 v82, v82
  v_exp_f32 v83, v83
  v_mfma_f32_32x32x16_bf16 v[112:127], v[52:55], v[100:103], v[112:127]
  v_cvt_pk_bf16_f32 v104, v80, v81
  v_exp_f32 v84, v84
  v_exp_f32 v85, v85
  v_cvt_pk_bf16_f32 v105, v82, v83
  v_exp_f32 v86, v86
  s_waitcnt lgkmcnt(2)
  v_mfma_f32_32x32x16_bf16 v[64:79], v[40:43], v[192:195], 0
  v_exp_f32 v87, v87
  v_cvt_pk_bf16_f32 v106, v84, v85
  v_exp_f32 v88, v88
  v_exp_f32 v89, v89
  v_cvt_pk_bf16_f32 v107, v86, v87
  v_mfma_f32_32x32x16_bf16 v[64:79], v[44:47], v[196:199], v[64:79]
  v_exp_f32 v90, v90
  v_exp_f32 v91, v91
  ds_read_b128 v[32:35], v3 offset:28672
  v_cvt_pk_bf16_f32 v108, v88, v89
  v_exp_f32 v92, v92
  v_exp_f32 v93, v93
  ds_read_b128 v[36:39], v3 offset:29696
  v_cvt_pk_bf16_f32 v109, v90, v91
  v_exp_f32 v94, v94
  v_exp_f32 v95, v95
  v_cvt_pk_bf16_f32 v110, v92, v93
  v_cvt_pk_bf16_f32 v111, v94, v95
  v_mfma_f32_32x32x16_bf16 v[128:143], v[48:51], v[104:107], v[128:143]
  v_exp_f32 v64, v64
  v_exp_f32 v65, v65
  v_exp_f32 v66, v66
  v_exp_f32 v67, v67
  v_mfma_f32_32x32x16_bf16 v[128:143], v[52:55], v[108:111], v[128:143]
  v_cvt_pk_bf16_f32 v96, v64, v65
  v_exp_f32 v68, v68
  v_exp_f32 v69, v69
  v_cvt_pk_bf16_f32 v97, v66, v67
  v_exp_f32 v70, v70
  v_mfma_f32_32x32x16_bf16 v[80:95], v[40:43], v[200:203], 0
  v_exp_f32 v71, v71
  v_cvt_pk_bf16_f32 v98, v68, v69
  v_exp_f32 v72, v72
  v_exp_f32 v73, v73
  v_cvt_pk_bf16_f32 v99, v70, v71
  v_mfma_f32_32x32x16_bf16 v[80:95], v[44:47], v[204:207], v[80:95]
  v_exp_f32 v74, v74
  v_exp_f32 v75, v75
  ds_read_b128 v[48:51], v3 offset:61440
  v_cvt_pk_bf16_f32 v100, v72, v73
  v_exp_f32 v76, v76
  v_exp_f32 v77, v77
  ds_read_b128 v[52:55], v3 offset:62464
  v_cvt_pk_bf16_f32 v101, v74, v75
  v_exp_f32 v78, v78
  s_add_u32 m0, s31, 103424
  s_add_u32 s29, s53, s28
  s_add_u32 s29, s29, 5120
  buffer_load_dwordx4 v2, s[8:11], s29 offen sc1 lds
  v_exp_f32 v79, v79
  v_cvt_pk_bf16_f32 v102, v76, v77
  v_cvt_pk_bf16_f32 v103, v78, v79
  s_waitcnt lgkmcnt(4)
  v_mfma_f32_32x32x16_bf16 v[112:127], v[56:59], v[96:99], v[112:127]
  v_exp_f32 v80, v80
  v_exp_f32 v81, v81
  v_exp_f32 v82, v82
  v_exp_f32 v83, v83
  v_mfma_f32_32x32x16_bf16 v[112:127], v[60:63], v[100:103], v[112:127]
  v_cvt_pk_bf16_f32 v104, v80, v81
  v_exp_f32 v84, v84
  v_exp_f32 v85, v85
  v_cvt_pk_bf16_f32 v105, v82, v83
  v_exp_f32 v86, v86
  s_waitcnt lgkmcnt(2)
  v_mfma_f32_32x32x16_bf16 v[64:79], v[32:35], v[192:195], 0
  v_exp_f32 v87, v87
  v_cvt_pk_bf16_f32 v106, v84, v85
  v_exp_f32 v88, v88
  v_exp_f32 v89, v89
  v_cvt_pk_bf16_f32 v107, v86, v87
  v_mfma_f32_32x32x16_bf16 v[64:79], v[36:39], v[196:199], v[64:79]
  v_exp_f32 v90, v90
  v_exp_f32 v91, v91
  ds_read_b128 v[40:43], v3 offset:30720
  v_cvt_pk_bf16_f32 v108, v88, v89
  v_exp_f32 v92, v92
  v_exp_f32 v93, v93
  ds_read_b128 v[44:47], v3 offset:31744
  v_cvt_pk_bf16_f32 v109, v90, v91
  v_exp_f32 v94, v94
  v_exp_f32 v95, v95
  v_cvt_pk_bf16_f32 v110, v92, v93
  v_cvt_pk_bf16_f32 v111, v94, v95
  v_mfma_f32_32x32x16_bf16 v[128:143], v[56:59], v[104:107], v[128:143]
  v_exp_f32 v64, v64
  v_exp_f32 v65, v65
  v_exp_f32 v66, v66
  v_exp_f32 v67, v67
  v_mfma_f32_32x32x16_bf16 v[128:143], v[60:63], v[108:111], v[128:143]
  v_cvt_pk_bf16_f32 v96, v64, v65
  v_exp_f32 v68, v68
  v_exp_f32 v69, v69
  v_cvt_pk_bf16_f32 v97, v66, v67
  v_exp_f32 v70, v70
  v_mfma_f32_32x32x16_bf16 v[80:95], v[32:35], v[200:203], 0
  v_exp_f32 v71, v71
  v_cvt_pk_bf16_f32 v98, v68, v69
  v_exp_f32 v72, v72
  v_exp_f32 v73, v73
  v_cvt_pk_bf16_f32 v99, v70, v71
  v_mfma_f32_32x32x16_bf16 v[80:95], v[36:39], v[204:207], v[80:95]
  v_exp_f32 v74, v74
  v_exp_f32 v75, v75
  ds_read_b128 v[56:59], v3 offset:63488
  v_cvt_pk_bf16_f32 v100, v72, v73
  v_exp_f32 v76, v76
  v_exp_f32 v77, v77
  ds_read_b128 v[60:63], v3 offset:64512
  v_cvt_pk_bf16_f32 v101, v74, v75
  v_exp_f32 v78, v78
  s_add_u32 m0, s31, 104448
  s_add_u32 s29, s53, s28
  s_add_u32 s29, s29, 6144
  buffer_load_dwordx4 v2, s[8:11], s29 offen sc1 lds
  v_exp_f32 v79, v79
  v_cvt_pk_bf16_f32 v102, v76, v77
  v_cvt_pk_bf16_f32 v103, v78, v79
  s_waitcnt lgkmcnt(4)
  v_mfma_f32_32x32x16_bf16 v[112:127], v[48:51], v[96:99], v[112:127]
  v_exp_f32 v80, v80
  v_exp_f32 v81, v81
  v_exp_f32 v82, v82
  v_exp_f32 v83, v83
  v_mfma_f32_32x32x16_bf16 v[112:127], v[52:55], v[100:103], v[112:127]
  v_cvt_pk_bf16_f32 v104, v80, v81
  v_exp_f32 v84, v84
  v_exp_f32 v85, v85
  v_cvt_pk_bf16_f32 v105, v82, v83
  v_exp_f32 v86, v86
  s_waitcnt lgkmcnt(2)
  v_mfma_f32_32x32x16_bf16 v[64:79], v[40:43], v[192:195], 0
  v_exp_f32 v87, v87
  v_cvt_pk_bf16_f32 v106, v84, v85
  v_exp_f32 v88, v88
  v_exp_f32 v89, v89
  v_cvt_pk_bf16_f32 v107, v86, v87
  v_mfma_f32_32x32x16_bf16 v[64:79], v[44:47], v[196:199], v[64:79]
  v_exp_f32 v90, v90
  v_exp_f32 v91, v91
  v_cvt_pk_bf16_f32 v108, v88, v89
  v_exp_f32 v92, v92
  v_exp_f32 v93, v93
  v_cvt_pk_bf16_f32 v109, v90, v91
  v_exp_f32 v94, v94
  v_exp_f32 v95, v95
  v_cvt_pk_bf16_f32 v110, v92, v93
  v_cvt_pk_bf16_f32 v111, v94, v95
  v_mfma_f32_32x32x16_bf16 v[128:143], v[48:51], v[104:107], v[128:143]
  v_exp_f32 v64, v64
  v_exp_f32 v65, v65
  v_exp_f32 v66, v66
  v_exp_f32 v67, v67
  v_mfma_f32_32x32x16_bf16 v[128:143], v[52:55], v[108:111], v[128:143]
  v_cvt_pk_bf16_f32 v96, v64, v65
  v_exp_f32 v68, v68
  v_exp_f32 v69, v69
  v_cvt_pk_bf16_f32 v97, v66, v67
  v_exp_f32 v70, v70
  v_mfma_f32_32x32x16_bf16 v[80:95], v[40:43], v[200:203], 0
  v_exp_f32 v71, v71
  v_cvt_pk_bf16_f32 v98, v68, v69
  v_exp_f32 v72, v72
  v_exp_f32 v73, v73
  v_cvt_pk_bf16_f32 v99, v70, v71
  v_mfma_f32_32x32x16_bf16 v[80:95], v[44:47], v[204:207], v[80:95]
  v_exp_f32 v74, v74
  v_exp_f32 v75, v75
  v_cvt_pk_bf16_f32 v100, v72, v73
  v_exp_f32 v76, v76
  v_exp_f32 v77, v77
  v_cvt_pk_bf16_f32 v101, v74, v75
  v_exp_f32 v78, v78
  s_add_u32 m0, s31, 105472
  s_add_u32 s29, s53, s28
  s_add_u32 s29, s29, 7168
  buffer_load_dwordx4 v2, s[8:11], s29 offen sc1 lds
  v_exp_f32 v79, v79
  v_cvt_pk_bf16_f32 v102, v76, v77
  v_cvt_pk_bf16_f32 v103, v78, v79
  s_waitcnt lgkmcnt(0)
  v_mfma_f32_32x32x16_bf16 v[112:127], v[56:59], v[96:99], v[112:127]
  v_exp_f32 v80, v80
  v_exp_f32 v81, v81
  v_exp_f32 v82, v82
  v_exp_f32 v83, v83
  v_mfma_f32_32x32x16_bf16 v[112:127], v[60:63], v[100:103], v[112:127]
  v_cvt_pk_bf16_f32 v104, v80, v81
  v_exp_f32 v84, v84
  v_exp_f32 v85, v85
  v_cvt_pk_bf16_f32 v105, v82, v83
  v_exp_f32 v86, v86
  v_exp_f32 v87, v87
  v_cvt_pk_bf16_f32 v106, v84, v85
  v_exp_f32 v88, v88
  v_exp_f32 v89, v89
  v_cvt_pk_bf16_f32 v107, v86, v87
  v_exp_f32 v90, v90
  v_exp_f32 v91, v91
  v_cvt_pk_bf16_f32 v108, v88, v89
  v_exp_f32 v92, v92
  v_exp_f32 v93, v93
  v_cvt_pk_bf16_f32 v109, v90, v91
  v_exp_f32 v94, v94
  v_exp_f32 v95, v95
  v_cvt_pk_bf16_f32 v110, v92, v93
  v_cvt_pk_bf16_f32 v111, v94, v95
  s_nop 1
  v_mfma_f32_32x32x16_bf16 v[128:143], v[56:59], v[104:107], v[128:143]
  v_mfma_f32_32x32x16_bf16 v[128:143], v[60:63], v[108:111], v[128:143]
  s_waitcnt vmcnt(0)
  s_barrier
  s_add_u32 s41, s41, 1
  s_min_u32 s29, s41, 3
  s_mul_i32 s53, s29, 32768
  s_lshl_b32 s31, s21, 13
  s_add_u32 s53, s53, s31
  ds_read_b128 v[32:35], v4 offset:0
  ds_read_b128 v[36:39], v4 offset:1024
  ds_read_b128 v[48:51], v4 offset:32768
  ds_read_b128 v[52:55], v4 offset:33792
  ds_read_b128 v[40:43], v4 offset:2048
  ds_read_b128 v[44:47], v4 offset:3072
  s_waitcnt lgkmcnt(4)
  v_mfma_f32_32x32x16_bf16 v[64:79], v[32:35], v[192:195], 0
  v_mfma_f32_32x32x16_bf16 v[64:79], v[36:39], v[196:199], v[64:79]
  s_nop 11
  v_exp_f32 v64, v64
  v_exp_f32 v65, v65
  v_exp_f32 v66, v66
  v_exp_f32 v67, v67
  v_cvt_pk_bf16_f32 v96, v64, v65
  v_exp_f32 v68, v68
  v_exp_f32 v69, v69
  v_cvt_pk_bf16_f32 v97, v66, v67
  v_exp_f32 v70, v70
  v_mfma_f32_32x32x16_bf16 v[80:95], v[32:35], v[200:203], 0
  v_exp_f32 v71, v71
  v_cvt_pk_bf16_f32 v98, v68, v69
  v_exp_f32 v72, v72
  v_exp_f32 v73, v73
  v_cvt_pk_bf16_f32 v99, v70, v71
  v_mfma_f32_32x32x16_bf16 v[80:95], v[36:39], v[204:207], v[80:95]
  v_exp_f32 v74, v74
  v_exp_f32 v75, v75
  ds_read_b128 v[56:59], v4 offset:34816
  v_cvt_pk_bf16_f32 v100, v72, v73
  v_exp_f32 v76, v76
  v_exp_f32 v77, v77
  ds_read_b128 v[60:63], v4 offset:35840
  v_cvt_pk_bf16_f32 v101, v74, v75
  v_exp_f32 v78, v78
  s_add_u32 m0, s31, 0
  s_add_u32 s29, s53, s27
  s_add_u32 s29, s29, 0
  buffer_load_dwordx4 v2, s[8:11], s29 offen sc1 lds
  v_exp_f32 v79, v79
  v_cvt_pk_bf16_f32 v102, v76, v77
  v_cvt_pk_bf16_f32 v103, v78, v79
  s_waitcnt lgkmcnt(4)
  v_mfma_f32_32x32x16_bf16 v[112:127], v[48:51], v[96:99], v[112:127]
  v_exp_f32 v80, v80
  v_exp_f32 v81, v81
  v_exp_f32 v82, v82
  v_exp_f32 v83, v83
  v_mfma_f32_32x32x16_bf16 v[112:127], v[52:55], v[100:103], v[112:127]
  v_cvt_pk_bf16_f32 v104, v80, v81
  v_exp_f32 v84, v84
  v_exp_f32 v85, v85
  v_cvt_pk_bf16_f32 v105, v82, v83
  v_exp_f32 v86, v86
  s_waitcnt lgkmcnt(2)
  v_mfma_f32_32x32x16_bf16 v[64:79], v[40:43], v[192:195], 0
  v_exp_f32 v87, v87
  v_cvt_pk_bf16_f32 v106, v84, v85
  v_exp_f32 v88, v88
  v_exp_f32 v89, v89
  v_cvt_pk_bf16_f32 v107, v86, v87
  v_mfma_f32_32x32x16_bf16 v[64:79], v[44:47], v[196:199], v[64:79]
  v_exp_f32 v90, v90
  v_exp_f32 v91, v91
  ds_read_b128 v[32:35], v4 offset:4096
  v_cvt_pk_bf16_f32 v108, v88, v89
  v_exp_f32 v92, v92
  v_exp_f32 v93, v93
  ds_read_b128 v[36:39], v4 offset:5120
  v_cvt_pk_bf16_f32 v109, v90, v91
  v_exp_f32 v94, v94
  v_exp_f32 v95, v95
  v_cvt_pk_bf16_f32 v110, v92, v93
  v_cvt_pk_bf16_f32 v111, v94, v95
  v_mfma_f32_32x32x16_bf16 v[128:143], v[48:51], v[104:107], v[128:143]
  v_exp_f32 v64, v64
  v_exp_f32 v65, v65
  v_exp_f32 v66, v66
  v_exp_f32 v67, v67
  v_mfma_f32_32x32x16_bf16 v[128:143], v[52:55], v[108:111], v[128:143]
  v_cvt_pk_bf16_f32 v96, v64, v65
  v_exp_f32 v68, v68
  v_exp_f32 v69, v69
  v_cvt_pk_bf16_f32 v97, v66, v67
  v_exp_f32 v70, v70
  v_mfma_f32_32x32x16_bf16 v[80:95], v[40:43], v[200:203], 0
  v_exp_f32 v71, v71
  v_cvt_pk_bf16_f32 v98, v68, v69
  v_exp_f32 v72, v72
  v_exp_f32 v73, v73
  v_cvt_pk_bf16_f32 v99, v70, v71
  v_mfma_f32_32x32x16_bf16 v[80:95], v[44:47], v[204:207], v[80:95]
  v_exp_f32 v74, v74
  v_exp_f32 v75, v75
  ds_read_b128 v[48:51], v4 offset:36864
  v_cvt_pk_bf16_f32 v100, v72, v73
  v_exp_f32 v76, v76
  v_exp_f32 v77, v77
  ds_read_b128 v[52:55], v4 offset:37888
  v_cvt_pk_bf16_f32 v101, v74, v75
  v_exp_f32 v78, v78
  s_add_u32 m0, s31, 1024
  s_add_u32 s29, s53, s27
  s_add_u32 s29, s29, 1024
  buffer_load_dwordx4 v2, s[8:11], s29 offen sc1 lds
  v_exp_f32 v79, v79
  v_cvt_pk_bf16_f32 v102, v76, v77
  v_cvt_pk_bf16_f32 v103, v78, v79
  s_waitcnt lgkmcnt(4)
  v_mfma_f32_32x32x16_bf16 v[112:127], v[56:59], v[96:99], v[112:127]
  v_exp_f32 v80, v80
  v_exp_f32 v81, v81
  v_exp_f32 v82, v82
  v_exp_f32 v83, v83
  v_mfma_f32_32x32x16_bf16 v[112:127], v[60:63], v[100:103], v[112:127]
  v_cvt_pk_bf16_f32 v104, v80, v81
  v_exp_f32 v84, v84
  v_exp_f32 v85, v85
  v_cvt_pk_bf16_f32 v105, v82, v83
  v_exp_f32 v86, v86
  s_waitcnt lgkmcnt(2)
  v_mfma_f32_32x32x16_bf16 v[64:79], v[32:35], v[192:195], 0
  v_exp_f32 v87, v87
  v_cvt_pk_bf16_f32 v106, v84, v85
  v_exp_f32 v88, v88
  v_exp_f32 v89, v89
  v_cvt_pk_bf16_f32 v107, v86, v87
  v_mfma_f32_32x32x16_bf16 v[64:79], v[36:39], v[196:199], v[64:79]
  v_exp_f32 v90, v90
  v_exp_f32 v91, v91
  ds_read_b128 v[40:43], v4 offset:6144
  v_cvt_pk_bf16_f32 v108, v88, v89
  v_exp_f32 v92, v92
  v_exp_f32 v93, v93
  ds_read_b128 v[44:47], v4 offset:7168
  v_cvt_pk_bf16_f32 v109, v90, v91
  v_exp_f32 v94, v94
  v_exp_f32 v95, v95
  v_cvt_pk_bf16_f32 v110, v92, v93
  v_cvt_pk_bf16_f32 v111, v94, v95
  v_mfma_f32_32x32x16_bf16 v[128:143], v[56:59], v[104:107], v[128:143]
  v_exp_f32 v64, v64
  v_exp_f32 v65, v65
  v_exp_f32 v66, v66
  v_exp_f32 v67, v67
  v_mfma_f32_32x32x16_bf16 v[128:143], v[60:63], v[108:111], v[128:143]
  v_cvt_pk_bf16_f32 v96, v64, v65
  v_exp_f32 v68, v68
  v_exp_f32 v69, v69
  v_cvt_pk_bf16_f32 v97, v66, v67
  v_exp_f32 v70, v70
  v_mfma_f32_32x32x16_bf16 v[80:95], v[32:35], v[200:203], 0
  v_exp_f32 v71, v71
  v_cvt_pk_bf16_f32 v98, v68, v69
  v_exp_f32 v72, v72
  v_exp_f32 v73, v73
  v_cvt_pk_bf16_f32 v99, v70, v71
  v_mfma_f32_32x32x16_bf16 v[80:95], v[36:39], v[204:207], v[80:95]
  v_exp_f32 v74, v74
  v_exp_f32 v75, v75
  ds_read_b128 v[56:59], v4 offset:38912
  v_cvt_pk_bf16_f32 v100, v72, v73
  v_exp_f32 v76, v76
  v_exp_f32 v77, v77
  ds_read_b128 v[60:63], v4 offset:39936
  v_cvt_pk_bf16_f32 v101, v74, v75
  v_exp_f32 v78, v78
  s_add_u32 m0, s31, 2048
  s_add_u32 s29, s53, s27
  s_add_u32 s29, s29, 2048
  buffer_load_dwordx4 v2, s[8:11], s29 offen sc1 lds
  v_exp_f32 v79, v79
  v_cvt_pk_bf16_f32 v102, v76, v77
  v_cvt_pk_bf16_f32 v103, v78, v79
  s_waitcnt lgkmcnt(4)
  v_mfma_f32_32x32x16_bf16 v[112:127], v[48:51], v[96:99], v[112:127]
  v_exp_f32 v80, v80
  v_exp_f32 v81, v81
  v_exp_f32 v82, v82
  v_exp_f32 v83, v83
  v_mfma_f32_32x32x16_bf16 v[112:127], v[52:55], v[100:103], v[112:127]
  v_cvt_pk_bf16_f32 v104, v80, v81
  v_exp_f32 v84, v84
  v_exp_f32 v85, v85
  v_cvt_pk_bf16_f32 v105, v82, v83
  v_exp_f32 v86, v86
  s_waitcnt lgkmcnt(2)
  v_mfma_f32_32x32x16_bf16 v[64:79], v[40:43], v[192:195], 0
  v_exp_f32 v87, v87
  v_cvt_pk_bf16_f32 v106, v84, v85
  v_exp_f32 v88, v88
  v_exp_f32 v89, v89
  v_cvt_pk_bf16_f32 v107, v86, v87
  v_mfma_f32_32x32x16_bf16 v[64:79], v[44:47], v[196:199], v[64:79]
  v_exp_f32 v90, v90
  v_exp_f32 v91, v91
  ds_read_b128 v[32:35], v4 offset:8192
  v_cvt_pk_bf16_f32 v108, v88, v89
  v_exp_f32 v92, v92
  v_exp_f32 v93, v93
  ds_read_b128 v[36:39], v4 offset:9216
  v_cvt_pk_bf16_f32 v109, v90, v91
  v_exp_f32 v94, v94
  v_exp_f32 v95, v95
  v_cvt_pk_bf16_f32 v110, v92, v93
  v_cvt_pk_bf16_f32 v111, v94, v95
  v_mfma_f32_32x32x16_bf16 v[128:143], v[48:51], v[104:107], v[128:143]
  v_exp_f32 v64, v64
  v_exp_f32 v65, v65
  v_exp_f32 v66, v66
  v_exp_f32 v67, v67
  v_mfma_f32_32x32x16_bf16 v[128:143], v[52:55], v[108:111], v[128:143]
  v_cvt_pk_bf16_f32 v96, v64, v65
  v_exp_f32 v68, v68
  v_exp_f32 v69, v69
  v_cvt_pk_bf16_f32 v97, v66, v67
  v_exp_f32 v70, v70
  v_mfma_f32_32x32x16_bf16 v[80:95], v[40:43], v[200:203], 0
  v_exp_f32 v71, v71
  v_cvt_pk_bf16_f32 v98, v68, v69
  v_exp_f32 v72, v72
  v_exp_f32 v73, v73
  v_cvt_pk_bf16_f32 v99, v70, v71
  v_mfma_f32_32x32x16_bf16 v[80:95], v[44:47], v[204:207], v[80:95]
  v_exp_f32 v74, v74
  v_exp_f32 v75, v75
  ds_read_b128 v[48:51], v4 offset:40960
  v_cvt_pk_bf16_f32 v100, v72, v73
  v_exp_f32 v76, v76
  v_exp_f32 v77, v77
  ds_read_b128 v[52:55], v4 offset:41984
  v_cvt_pk_bf16_f32 v101, v74, v75
  v_exp_f32 v78, v78
  s_add_u32 m0, s31, 3072
  s_add_u32 s29, s53, s27
  s_add_u32 s29, s29, 3072
  buffer_load_dwordx4 v2, s[8:11], s29 offen sc1 lds
  v_exp_f32 v79, v79
  v_cvt_pk_bf16_f32 v102, v76, v77
  v_cvt_pk_bf16_f32 v103, v78, v79
  s_waitcnt lgkmcnt(4)
  v_mfma_f32_32x32x16_bf16 v[112:127], v[56:59], v[96:99], v[112:127]
  v_exp_f32 v80, v80
  v_exp_f32 v81, v81
  v_exp_f32 v82, v82
  v_exp_f32 v83, v83
  v_mfma_f32_32x32x16_bf16 v[112:127], v[60:63], v[100:103], v[112:127]
  v_cvt_pk_bf16_f32 v104, v80, v81
  v_exp_f32 v84, v84
  v_exp_f32 v85, v85
  v_cvt_pk_bf16_f32 v105, v82, v83
  v_exp_f32 v86, v86
  s_waitcnt lgkmcnt(2)
  v_mfma_f32_32x32x16_bf16 v[64:79], v[32:35], v[192:195], 0
  v_exp_f32 v87, v87
  v_cvt_pk_bf16_f32 v106, v84, v85
  v_exp_f32 v88, v88
  v_exp_f32 v89, v89
  v_cvt_pk_bf16_f32 v107, v86, v87
  v_mfma_f32_32x32x16_bf16 v[64:79], v[36:39], v[196:199], v[64:79]
  v_exp_f32 v90, v90
  v_exp_f32 v91, v91
  ds_read_b128 v[40:43], v4 offset:10240
  v_cvt_pk_bf16_f32 v108, v88, v89
  v_exp_f32 v92, v92
  v_exp_f32 v93, v93
  ds_read_b128 v[44:47], v4 offset:11264
  v_cvt_pk_bf16_f32 v109, v90, v91
  v_exp_f32 v94, v94
  v_exp_f32 v95, v95
  v_cvt_pk_bf16_f32 v110, v92, v93
  v_cvt_pk_bf16_f32 v111, v94, v95
  v_mfma_f32_32x32x16_bf16 v[128:143], v[56:59], v[104:107], v[128:143]
  v_exp_f32 v64, v64
  v_exp_f32 v65, v65
  v_exp_f32 v66, v66
  v_exp_f32 v67, v67
  v_mfma_f32_32x32x16_bf16 v[128:143], v[60:63], v[108:111], v[128:143]
  v_cvt_pk_bf16_f32 v96, v64, v65
  v_exp_f32 v68, v68
  v_exp_f32 v69, v69
  v_cvt_pk_bf16_f32 v97, v66, v67
  v_exp_f32 v70, v70
  v_mfma_f32_32x32x16_bf16 v[80:95], v[32:35], v[200:203], 0
  v_exp_f32 v71, v71
  v_cvt_pk_bf16_f32 v98, v68, v69
  v_exp_f32 v72, v72
  v_exp_f32 v73, v73
  v_cvt_pk_bf16_f32 v99, v70, v71
  v_mfma_f32_32x32x16_bf16 v[80:95], v[36:39], v[204:207], v[80:95]
  v_exp_f32 v74, v74
  v_exp_f32 v75, v75
  ds_read_b128 v[56:59], v4 offset:43008
  v_cvt_pk_bf16_f32 v100, v72, v73
  v_exp_f32 v76, v76
  v_exp_f32 v77, v77
  ds_read_b128 v[60:63], v4 offset:44032
  v_cvt_pk_bf16_f32 v101, v74, v75
  v_exp_f32 v78, v78
  s_add_u32 m0, s31, 4096
  s_add_u32 s29, s53, s27
  s_add_u32 s29, s29, 4096
  buffer_load_dwordx4 v2, s[8:11], s29 offen sc1 lds
  v_exp_f32 v79, v79
  v_cvt_pk_bf16_f32 v102, v76, v77
  v_cvt_pk_bf16_f32 v103, v78, v79
  s_waitcnt lgkmcnt(4)
  v_mfma_f32_32x32x16_bf16 v[112:127], v[48:51], v[96:99], v[112:127]
  v_exp_f32 v80, v80
  v_exp_f32 v81, v81
  v_exp_f32 v82, v82
  v_exp_f32 v83, v83
  v_mfma_f32_32x32x16_bf16 v[112:127], v[52:55], v[100:103], v[112:127]
  v_cvt_pk_bf16_f32 v104, v80, v81
  v_exp_f32 v84, v84
  v_exp_f32 v85, v85
  v_cvt_pk_bf16_f32 v105, v82, v83
  v_exp_f32 v86, v86
  s_waitcnt lgkmcnt(2)
  v_mfma_f32_32x32x16_bf16 v[64:79], v[40:43], v[192:195], 0
  v_exp_f32 v87, v87
  v_cvt_pk_bf16_f32 v106, v84, v85
  v_exp_f32 v88, v88
  v_exp_f32 v89, v89
  v_cvt_pk_bf16_f32 v107, v86, v87
  v_mfma_f32_32x32x16_bf16 v[64:79], v[44:47], v[196:199], v[64:79]
  v_exp_f32 v90, v90
  v_exp_f32 v91, v91
  ds_read_b128 v[32:35], v4 offset:12288
  v_cvt_pk_bf16_f32 v108, v88, v89
  v_exp_f32 v92, v92
  v_exp_f32 v93, v93
  ds_read_b128 v[36:39], v4 offset:13312
  v_cvt_pk_bf16_f32 v109, v90, v91
  v_exp_f32 v94, v94
  v_exp_f32 v95, v95
  v_cvt_pk_bf16_f32 v110, v92, v93
  v_cvt_pk_bf16_f32 v111, v94, v95
  v_mfma_f32_32x32x16_bf16 v[128:143], v[48:51], v[104:107], v[128:143]
  v_exp_f32 v64, v64
  v_exp_f32 v65, v65
  v_exp_f32 v66, v66
  v_exp_f32 v67, v67
  v_mfma_f32_32x32x16_bf16 v[128:143], v[52:55], v[108:111], v[128:143]
  v_cvt_pk_bf16_f32 v96, v64, v65
  v_exp_f32 v68, v68
  v_exp_f32 v69, v69
  v_cvt_pk_bf16_f32 v97, v66, v67
  v_exp_f32 v70, v70
  v_mfma_f32_32x32x16_bf16 v[80:95], v[40:43], v[200:203], 0
  v_exp_f32 v71, v71
  v_cvt_pk_bf16_f32 v98, v68, v69
  v_exp_f32 v72, v72
  v_exp_f32 v73, v73
  v_cvt_pk_bf16_f32 v99, v70, v71
  v_mfma_f32_32x32x16_bf16 v[80:95], v[44:47], v[204:207], v[80:95]
  v_exp_f32 v74, v74
  v_exp_f32 v75, v75
  ds_read_b128 v[48:51], v4 offset:45056
  v_cvt_pk_bf16_f32 v100, v72, v73
  v_exp_f32 v76, v76
  v_exp_f32 v77, v77
  ds_read_b128 v[52:55], v4 offset:46080
  v_cvt_pk_bf16_f32 v101, v74, v75
  v_exp_f32 v78, v78
  s_add_u32 m0, s31, 5120
  s_add_u32 s29, s53, s27
  s_add_u32 s29, s29, 5120
  buffer_load_dwordx4 v2, s[8:11], s29 offen sc1 lds
  v_exp_f32 v79, v79
  v_cvt_pk_bf16_f32 v102, v76, v77
  v_cvt_pk_bf16_f32 v103, v78, v79
  s_waitcnt lgkmcnt(4)
  v_mfma_f32_32x32x16_bf16 v[112:127], v[56:59], v[96:99], v[112:127]
  v_exp_f32 v80, v80
  v_exp_f32 v81, v81
  v_exp_f32 v82, v82
  v_exp_f32 v83, v83
  v_mfma_f32_32x32x16_bf16 v[112:127], v[60:63], v[100:103], v[112:127]
  v_cvt_pk_bf16_f32 v104, v80, v81
  v_exp_f32 v84, v84
  v_exp_f32 v85, v85
  v_cvt_pk_bf16_f32 v105, v82, v83
  v_exp_f32 v86, v86
  s_waitcnt lgkmcnt(2)
  v_mfma_f32_32x32x16_bf16 v[64:79], v[32:35], v[192:195], 0
  v_exp_f32 v87, v87
  v_cvt_pk_bf16_f32 v106, v84, v85
  v_exp_f32 v88, v88
  v_exp_f32 v89, v89
  v_cvt_pk_bf16_f32 v107, v86, v87
  v_mfma_f32_32x32x16_bf16 v[64:79], v[36:39], v[196:199], v[64:79]
  v_exp_f32 v90, v90
  v_exp_f32 v91, v91
  ds_read_b128 v[40:43], v4 offset:14336
  v_cvt_pk_bf16_f32 v108, v88, v89
  v_exp_f32 v92, v92
  v_exp_f32 v93, v93
  ds_read_b128 v[44:47], v4 offset:15360
  v_cvt_pk_bf16_f32 v109, v90, v91
  v_exp_f32 v94, v94
  v_exp_f32 v95, v95
  v_cvt_pk_bf16_f32 v110, v92, v93
  v_cvt_pk_bf16_f32 v111, v94, v95
  v_mfma_f32_32x32x16_bf16 v[128:143], v[56:59], v[104:107], v[128:143]
  v_exp_f32 v64, v64
  v_exp_f32 v65, v65
  v_exp_f32 v66, v66
  v_exp_f32 v67, v67
  v_mfma_f32_32x32x16_bf16 v[128:143], v[60:63], v[108:111], v[128:143]
  v_cvt_pk_bf16_f32 v96, v64, v65
  v_exp_f32 v68, v68
  v_exp_f32 v69, v69
  v_cvt_pk_bf16_f32 v97, v66, v67
  v_exp_f32 v70, v70
  v_mfma_f32_32x32x16_bf16 v[80:95], v[32:35], v[200:203], 0
  v_exp_f32 v71, v71
  v_cvt_pk_bf16_f32 v98, v68, v69
  v_exp_f32 v72, v72
  v_exp_f32 v73, v73
  v_cvt_pk_bf16_f32 v99, v70, v71
  v_mfma_f32_32x32x16_bf16 v[80:95], v[36:39], v[204:207], v[80:95]
  v_exp_f32 v74, v74
  v_exp_f32 v75, v75
  ds_read_b128 v[56:59], v4 offset:47104
  v_cvt_pk_bf16_f32 v100, v72, v73
  v_exp_f32 v76, v76
  v_exp_f32 v77, v77
  ds_read_b128 v[60:63], v4 offset:48128
  v_cvt_pk_bf16_f32 v101, v74, v75
  v_exp_f32 v78, v78
  s_add_u32 m0, s31, 6144
  s_add_u32 s29, s53, s27
  s_add_u32 s29, s29, 6144
  buffer_load_dwordx4 v2, s[8:11], s29 offen sc1 lds
  v_exp_f32 v79, v79
  v_cvt_pk_bf16_f32 v102, v76, v77
  v_cvt_pk_bf16_f32 v103, v78, v79
  s_waitcnt lgkmcnt(4)
  v_mfma_f32_32x32x16_bf16 v[112:127], v[48:51], v[96:99], v[112:127]
  v_exp_f32 v80, v80
  v_exp_f32 v81, v81
  v_exp_f32 v82, v82
  v_exp_f32 v83, v83
  v_mfma_f32_32x32x16_bf16 v[112:127], v[52:55], v[100:103], v[112:127]
  v_cvt_pk_bf16_f32 v104, v80, v81
  v_exp_f32 v84, v84
  v_exp_f32 v85, v85
  v_cvt_pk_bf16_f32 v105, v82, v83
  v_exp_f32 v86, v86
  s_waitcnt lgkmcnt(2)
  v_mfma_f32_32x32x16_bf16 v[64:79], v[40:43], v[192:195], 0
  v_exp_f32 v87, v87
  v_cvt_pk_bf16_f32 v106, v84, v85
  v_exp_f32 v88, v88
  v_exp_f32 v89, v89
  v_cvt_pk_bf16_f32 v107, v86, v87
  v_mfma_f32_32x32x16_bf16 v[64:79], v[44:47], v[196:199], v[64:79]
  v_exp_f32 v90, v90
  v_exp_f32 v91, v91
  ds_read_b128 v[32:35], v4 offset:16384
  v_cvt_pk_bf16_f32 v108, v88, v89
  v_exp_f32 v92, v92
  v_exp_f32 v93, v93
  ds_read_b128 v[36:39], v4 offset:17408
  v_cvt_pk_bf16_f32 v109, v90, v91
  v_exp_f32 v94, v94
  v_exp_f32 v95, v95
  v_cvt_pk_bf16_f32 v110, v92, v93
  v_cvt_pk_bf16_f32 v111, v94, v95
  v_mfma_f32_32x32x16_bf16 v[128:143], v[48:51], v[104:107], v[128:143]
  v_exp_f32 v64, v64
  v_exp_f32 v65, v65
  v_exp_f32 v66, v66
  v_exp_f32 v67, v67
  v_mfma_f32_32x32x16_bf16 v[128:143], v[52:55], v[108:111], v[128:143]
  v_cvt_pk_bf16_f32 v96, v64, v65
  v_exp_f32 v68, v68
  v_exp_f32 v69, v69
  v_cvt_pk_bf16_f32 v97, v66, v67
  v_exp_f32 v70, v70
  v_mfma_f32_32x32x16_bf16 v[80:95], v[40:43], v[200:203], 0
  v_exp_f32 v71, v71
  v_cvt_pk_bf16_f32 v98, v68, v69
  v_exp_f32 v72, v72
  v_exp_f32 v73, v73
  v_cvt_pk_bf16_f32 v99, v70, v71
  v_mfma_f32_32x32x16_bf16 v[80:95], v[44:47], v[204:207], v[80:95]
  v_exp_f32 v74, v74
  v_exp_f32 v75, v75
  ds_read_b128 v[48:51], v4 offset:49152
  v_cvt_pk_bf16_f32 v100, v72, v73
  v_exp_f32 v76, v76
  v_exp_f32 v77, v77
  ds_read_b128 v[52:55], v4 offset:50176
  v_cvt_pk_bf16_f32 v101, v74, v75
  v_exp_f32 v78, v78
  s_add_u32 m0, s31, 7168
  s_add_u32 s29, s53, s27
  s_add_u32 s29, s29, 7168
  buffer_load_dwordx4 v2, s[8:11], s29 offen sc1 lds
  v_exp_f32 v79, v79
  v_cvt_pk_bf16_f32 v102, v76, v77
  v_cvt_pk_bf16_f32 v103, v78, v79
  s_waitcnt lgkmcnt(4)
  v_mfma_f32_32x32x16_bf16 v[112:127], v[56:59], v[96:99], v[112:127]
  v_exp_f32 v80, v80
  v_exp_f32 v81, v81
  v_exp_f32 v82, v82
  v_exp_f32 v83, v83
  v_mfma_f32_32x32x16_bf16 v[112:127], v[60:63], v[100:103], v[112:127]
  v_cvt_pk_bf16_f32 v104, v80, v81
  v_exp_f32 v84, v84
  v_exp_f32 v85, v85
  v_cvt_pk_bf16_f32 v105, v82, v83
  v_exp_f32 v86, v86
  s_waitcnt lgkmcnt(2)
  v_mfma_f32_32x32x16_bf16 v[64:79], v[32:35], v[192:195], 0
  v_exp_f32 v87, v87
  v_cvt_pk_bf16_f32 v106, v84, v85
  v_exp_f32 v88, v88
  v_exp_f32 v89, v89
  v_cvt_pk_bf16_f32 v107, v86, v87
  v_mfma_f32_32x32x16_bf16 v[64:79], v[36:39], v[196:199], v[64:79]
  v_exp_f32 v90, v90
  v_exp_f32 v91, v91
  ds_read_b128 v[40:43], v4 offset:18432
  v_cvt_pk_bf16_f32 v108, v88, v89
  v_exp_f32 v92, v92
  v_exp_f32 v93, v93
  ds_read_b128 v[44:47], v4 offset:19456
  v_cvt_pk_bf16_f32 v109, v90, v91
  v_exp_f32 v94, v94
  v_exp_f32 v95, v95
  v_cvt_pk_bf16_f32 v110, v92, v93
  v_cvt_pk_bf16_f32 v111, v94, v95
  v_mfma_f32_32x32x16_bf16 v[128:143], v[56:59], v[104:107], v[128:143]
  v_exp_f32 v64, v64
  v_exp_f32 v65, v65
  v_exp_f32 v66, v66
  v_exp_f32 v67, v67
  v_mfma_f32_32x32x16_bf16 v[128:143], v[60:63], v[108:111], v[128:143]
  v_cvt_pk_bf16_f32 v96, v64, v65
  v_exp_f32 v68, v68
  v_exp_f32 v69, v69
  v_cvt_pk_bf16_f32 v97, v66, v67
  v_exp_f32 v70, v70
  v_mfma_f32_32x32x16_bf16 v[80:95], v[32:35], v[200:203], 0
  v_exp_f32 v71, v71
  v_cvt_pk_bf16_f32 v98, v68, v69
  v_exp_f32 v72, v72
  v_exp_f32 v73, v73
  v_cvt_pk_bf16_f32 v99, v70, v71
  v_mfma_f32_32x32x16_bf16 v[80:95], v[36:39], v[204:207], v[80:95]
  v_exp_f32 v74, v74
  v_exp_f32 v75, v75
  ds_read_b128 v[56:59], v4 offset:51200
  v_cvt_pk_bf16_f32 v100, v72, v73
  v_exp_f32 v76, v76
  v_exp_f32 v77, v77
  ds_read_b128 v[60:63], v4 offset:52224
  v_cvt_pk_bf16_f32 v101, v74, v75
  v_exp_f32 v78, v78
  s_add_u32 m0, s31, 32768
  s_add_u32 s29, s53, s28
  s_add_u32 s29, s29, 0
  buffer_load_dwordx4 v2, s[8:11], s29 offen sc1 lds
  v_exp_f32 v79, v79
  v_cvt_pk_bf16_f32 v102, v76, v77
  v_cvt_pk_bf16_f32 v103, v78, v79
  s_waitcnt lgkmcnt(4)
  v_mfma_f32_32x32x16_bf16 v[112:127], v[48:51], v[96:99], v[112:127]
  v_exp_f32 v80, v80
  v_exp_f32 v81, v81
  v_exp_f32 v82, v82
  v_exp_f32 v83, v83
  v_mfma_f32_32x32x16_bf16 v[112:127], v[52:55], v[100:103], v[112:127]
  v_cvt_pk_bf16_f32 v104, v80, v81
  v_exp_f32 v84, v84
  v_exp_f32 v85, v85
  v_cvt_pk_bf16_f32 v105, v82, v83
  v_exp_f32 v86, v86
  s_waitcnt lgkmcnt(2)
  v_mfma_f32_32x32x16_bf16 v[64:79], v[40:43], v[192:195], 0
  v_exp_f32 v87, v87
  v_cvt_pk_bf16_f32 v106, v84, v85
  v_exp_f32 v88, v88
  v_exp_f32 v89, v89
  v_cvt_pk_bf16_f32 v107, v86, v87
  v_mfma_f32_32x32x16_bf16 v[64:79], v[44:47], v[196:199], v[64:79]
  v_exp_f32 v90, v90
  v_exp_f32 v91, v91
  ds_read_b128 v[32:35], v4 offset:20480
  v_cvt_pk_bf16_f32 v108, v88, v89
  v_exp_f32 v92, v92
  v_exp_f32 v93, v93
  ds_read_b128 v[36:39], v4 offset:21504
  v_cvt_pk_bf16_f32 v109, v90, v91
  v_exp_f32 v94, v94
  v_exp_f32 v95, v95
  v_cvt_pk_bf16_f32 v110, v92, v93
  v_cvt_pk_bf16_f32 v111, v94, v95
  v_mfma_f32_32x32x16_bf16 v[128:143], v[48:51], v[104:107], v[128:143]
  v_exp_f32 v64, v64
  v_exp_f32 v65, v65
  v_exp_f32 v66, v66
  v_exp_f32 v67, v67
  v_mfma_f32_32x32x16_bf16 v[128:143], v[52:55], v[108:111], v[128:143]
  v_cvt_pk_bf16_f32 v96, v64, v65
  v_exp_f32 v68, v68
  v_exp_f32 v69, v69
  v_cvt_pk_bf16_f32 v97, v66, v67
  v_exp_f32 v70, v70
  v_mfma_f32_32x32x16_bf16 v[80:95], v[40:43], v[200:203], 0
  v_exp_f32 v71, v71
  v_cvt_pk_bf16_f32 v98, v68, v69
  v_exp_f32 v72, v72
  v_exp_f32 v73, v73
  v_cvt_pk_bf16_f32 v99, v70, v71
  v_mfma_f32_32x32x16_bf16 v[80:95], v[44:47], v[204:207], v[80:95]
  v_exp_f32 v74, v74
  v_exp_f32 v75, v75
  ds_read_b128 v[48:51], v4 offset:53248
  v_cvt_pk_bf16_f32 v100, v72, v73
  v_exp_f32 v76, v76
  v_exp_f32 v77, v77
  ds_read_b128 v[52:55], v4 offset:54272
  v_cvt_pk_bf16_f32 v101, v74, v75
  v_exp_f32 v78, v78
  s_add_u32 m0, s31, 33792
  s_add_u32 s29, s53, s28
  s_add_u32 s29, s29, 1024
  buffer_load_dwordx4 v2, s[8:11], s29 offen sc1 lds
  v_exp_f32 v79, v79
  v_cvt_pk_bf16_f32 v102, v76, v77
  v_cvt_pk_bf16_f32 v103, v78, v79
  s_waitcnt lgkmcnt(4)
  v_mfma_f32_32x32x16_bf16 v[112:127], v[56:59], v[96:99], v[112:127]
  v_exp_f32 v80, v80
  v_exp_f32 v81, v81
  v_exp_f32 v82, v82
  v_exp_f32 v83, v83
  v_mfma_f32_32x32x16_bf16 v[112:127], v[60:63], v[100:103], v[112:127]
  v_cvt_pk_bf16_f32 v104, v80, v81
  v_exp_f32 v84, v84
  v_exp_f32 v85, v85
  v_cvt_pk_bf16_f32 v105, v82, v83
  v_exp_f32 v86, v86
  s_waitcnt lgkmcnt(2)
  v_mfma_f32_32x32x16_bf16 v[64:79], v[32:35], v[192:195], 0
  v_exp_f32 v87, v87
  v_cvt_pk_bf16_f32 v106, v84, v85
  v_exp_f32 v88, v88
  v_exp_f32 v89, v89
  v_cvt_pk_bf16_f32 v107, v86, v87
  v_mfma_f32_32x32x16_bf16 v[64:79], v[36:39], v[196:199], v[64:79]
  v_exp_f32 v90, v90
  v_exp_f32 v91, v91
  ds_read_b128 v[40:43], v4 offset:22528
  v_cvt_pk_bf16_f32 v108, v88, v89
  v_exp_f32 v92, v92
  v_exp_f32 v93, v93
  ds_read_b128 v[44:47], v4 offset:23552
  v_cvt_pk_bf16_f32 v109, v90, v91
  v_exp_f32 v94, v94
  v_exp_f32 v95, v95
  v_cvt_pk_bf16_f32 v110, v92, v93
  v_cvt_pk_bf16_f32 v111, v94, v95
  v_mfma_f32_32x32x16_bf16 v[128:143], v[56:59], v[104:107], v[128:143]
  v_exp_f32 v64, v64
  v_exp_f32 v65, v65
  v_exp_f32 v66, v66
  v_exp_f32 v67, v67
  v_mfma_f32_32x32x16_bf16 v[128:143], v[60:63], v[108:111], v[128:143]
  v_cvt_pk_bf16_f32 v96, v64, v65
  v_exp_f32 v68, v68
  v_exp_f32 v69, v69
  v_cvt_pk_bf16_f32 v97, v66, v67
  v_exp_f32 v70, v70
  v_mfma_f32_32x32x16_bf16 v[80:95], v[32:35], v[200:203], 0
  v_exp_f32 v71, v71
  v_cvt_pk_bf16_f32 v98, v68, v69
  v_exp_f32 v72, v72
  v_exp_f32 v73, v73
  v_cvt_pk_bf16_f32 v99, v70, v71
  v_mfma_f32_32x32x16_bf16 v[80:95], v[36:39], v[204:207], v[80:95]
  v_exp_f32 v74, v74
  v_exp_f32 v75, v75
  ds_read_b128 v[56:59], v4 offset:55296
  v_cvt_pk_bf16_f32 v100, v72, v73
  v_exp_f32 v76, v76
  v_exp_f32 v77, v77
  ds_read_b128 v[60:63], v4 offset:56320
  v_cvt_pk_bf16_f32 v101, v74, v75
  v_exp_f32 v78, v78
  s_add_u32 m0, s31, 34816
  s_add_u32 s29, s53, s28
  s_add_u32 s29, s29, 2048
  buffer_load_dwordx4 v2, s[8:11], s29 offen sc1 lds
  v_exp_f32 v79, v79
  v_cvt_pk_bf16_f32 v102, v76, v77
  v_cvt_pk_bf16_f32 v103, v78, v79
  s_waitcnt lgkmcnt(4)
  v_mfma_f32_32x32x16_bf16 v[112:127], v[48:51], v[96:99], v[112:127]
  v_exp_f32 v80, v80
  v_exp_f32 v81, v81
  v_exp_f32 v82, v82
  v_exp_f32 v83, v83
  v_mfma_f32_32x32x16_bf16 v[112:127], v[52:55], v[100:103], v[112:127]
  v_cvt_pk_bf16_f32 v104, v80, v81
  v_exp_f32 v84, v84
  v_exp_f32 v85, v85
  v_cvt_pk_bf16_f32 v105, v82, v83
  v_exp_f32 v86, v86
  s_waitcnt lgkmcnt(2)
  v_mfma_f32_32x32x16_bf16 v[64:79], v[40:43], v[192:195], 0
  v_exp_f32 v87, v87
  v_cvt_pk_bf16_f32 v106, v84, v85
  v_exp_f32 v88, v88
  v_exp_f32 v89, v89
  v_cvt_pk_bf16_f32 v107, v86, v87
  v_mfma_f32_32x32x16_bf16 v[64:79], v[44:47], v[196:199], v[64:79]
  v_exp_f32 v90, v90
  v_exp_f32 v91, v91
  ds_read_b128 v[32:35], v4 offset:24576
  v_cvt_pk_bf16_f32 v108, v88, v89
  v_exp_f32 v92, v92
  v_exp_f32 v93, v93
  ds_read_b128 v[36:39], v4 offset:25600
  v_cvt_pk_bf16_f32 v109, v90, v91
  v_exp_f32 v94, v94
  v_exp_f32 v95, v95
  v_cvt_pk_bf16_f32 v110, v92, v93
  v_cvt_pk_bf16_f32 v111, v94, v95
  v_mfma_f32_32x32x16_bf16 v[128:143], v[48:51], v[104:107], v[128:143]
  v_exp_f32 v64, v64
  v_exp_f32 v65, v65
  v_exp_f32 v66, v66
  v_exp_f32 v67, v67
  v_mfma_f32_32x32x16_bf16 v[128:143], v[52:55], v[108:111], v[128:143]
  v_cvt_pk_bf16_f32 v96, v64, v65
  v_exp_f32 v68, v68
  v_exp_f32 v69, v69
  v_cvt_pk_bf16_f32 v97, v66, v67
  v_exp_f32 v70, v70
  v_mfma_f32_32x32x16_bf16 v[80:95], v[40:43], v[200:203], 0
  v_exp_f32 v71, v71
  v_cvt_pk_bf16_f32 v98, v68, v69
  v_exp_f32 v72, v72
  v_exp_f32 v73, v73
  v_cvt_pk_bf16_f32 v99, v70, v71
  v_mfma_f32_32x32x16_bf16 v[80:95], v[44:47], v[204:207], v[80:95]
  v_exp_f32 v74, v74
  v_exp_f32 v75, v75
  ds_read_b128 v[48:51], v4 offset:57344
  v_cvt_pk_bf16_f32 v100, v72, v73
  v_exp_f32 v76, v76
  v_exp_f32 v77, v77
  ds_read_b128 v[52:55], v4 offset:58368
  v_cvt_pk_bf16_f32 v101, v74, v75
  v_exp_f32 v78, v78
  s_add_u32 m0, s31, 35840
  s_add_u32 s29, s53, s28
  s_add_u32 s29, s29, 3072
  buffer_load_dwordx4 v2, s[8:11], s29 offen sc1 lds
  v_exp_f32 v79, v79
  v_cvt_pk_bf16_f32 v102, v76, v77
  v_cvt_pk_bf16_f32 v103, v78, v79
  s_waitcnt lgkmcnt(4)
  v_mfma_f32_32x32x16_bf16 v[112:127], v[56:59], v[96:99], v[112:127]
  v_exp_f32 v80, v80
  v_exp_f32 v81, v81
  v_exp_f32 v82, v82
  v_exp_f32 v83, v83
  v_mfma_f32_32x32x16_bf16 v[112:127], v[60:63], v[100:103], v[112:127]
  v_cvt_pk_bf16_f32 v104, v80, v81
  v_exp_f32 v84, v84
  v_exp_f32 v85, v85
  v_cvt_pk_bf16_f32 v105, v82, v83
  v_exp_f32 v86, v86
  s_waitcnt lgkmcnt(2)
  v_mfma_f32_32x32x16_bf16 v[64:79], v[32:35], v[192:195], 0
  v_exp_f32 v87, v87
  v_cvt_pk_bf16_f32 v106, v84, v85
  v_exp_f32 v88, v88
  v_exp_f32 v89, v89
  v_cvt_pk_bf16_f32 v107, v86, v87
  v_mfma_f32_32x32x16_bf16 v[64:79], v[36:39], v[196:199], v[64:79]
  v_exp_f32 v90, v90
  v_exp_f32 v91, v91
  ds_read_b128 v[40:43], v4 offset:26624
  v_cvt_pk_bf16_f32 v108, v88, v89
  v_exp_f32 v92, v92
  v_exp_f32 v93, v93
  ds_read_b128 v[44:47], v4 offset:27648
  v_cvt_pk_bf16_f32 v109, v90, v91
  v_exp_f32 v94, v94
  v_exp_f32 v95, v95
  v_cvt_pk_bf16_f32 v110, v92, v93
  v_cvt_pk_bf16_f32 v111, v94, v95
  v_mfma_f32_32x32x16_bf16 v[128:143], v[56:59], v[104:107], v[128:143]
  v_exp_f32 v64, v64
  v_exp_f32 v65, v65
  v_exp_f32 v66, v66
  v_exp_f32 v67, v67
  v_mfma_f32_32x32x16_bf16 v[128:143], v[60:63], v[108:111], v[128:143]
  v_cvt_pk_bf16_f32 v96, v64, v65
  v_exp_f32 v68, v68
  v_exp_f32 v69, v69
  v_cvt_pk_bf16_f32 v97, v66, v67
  v_exp_f32 v70, v70
  v_mfma_f32_32x32x16_bf16 v[80:95], v[32:35], v[200:203], 0
  v_exp_f32 v71, v71
  v_cvt_pk_bf16_f32 v98, v68, v69
  v_exp_f32 v72, v72
  v_exp_f32 v73, v73
  v_cvt_pk_bf16_f32 v99, v70, v71
  v_mfma_f32_32x32x16_bf16 v[80:95], v[36:39], v[204:207], v[80:95]
  v_exp_f32 v74, v74
  v_exp_f32 v75, v75
  ds_read_b128 v[56:59], v4 offset:59392
  v_cvt_pk_bf16_f32 v100, v72, v73
  v_exp_f32 v76, v76
  v_exp_f32 v77, v77
  ds_read_b128 v[60:63], v4 offset:60416
  v_cvt_pk_bf16_f32 v101, v74, v75
  v_exp_f32 v78, v78
  s_add_u32 m0, s31, 36864
  s_add_u32 s29, s53, s28
  s_add_u32 s29, s29, 4096
  buffer_load_dwordx4 v2, s[8:11], s29 offen sc1 lds
  v_exp_f32 v79, v79
  v_cvt_pk_bf16_f32 v102, v76, v77
  v_cvt_pk_bf16_f32 v103, v78, v79
  s_waitcnt lgkmcnt(4)
  v_mfma_f32_32x32x16_bf16 v[112:127], v[48:51], v[96:99], v[112:127]
  v_exp_f32 v80, v80
  v_exp_f32 v81, v81
  v_exp_f32 v82, v82
  v_exp_f32 v83, v83
  v_mfma_f32_32x32x16_bf16 v[112:127], v[52:55], v[100:103], v[112:127]
  v_cvt_pk_bf16_f32 v104, v80, v81
  v_exp_f32 v84, v84
  v_exp_f32 v85, v85
  v_cvt_pk_bf16_f32 v105, v82, v83
  v_exp_f32 v86, v86
  s_waitcnt lgkmcnt(2)
  v_mfma_f32_32x32x16_bf16 v[64:79], v[40:43], v[192:195], 0
  v_exp_f32 v87, v87
  v_cvt_pk_bf16_f32 v106, v84, v85
  v_exp_f32 v88, v88
  v_exp_f32 v89, v89
  v_cvt_pk_bf16_f32 v107, v86, v87
  v_mfma_f32_32x32x16_bf16 v[64:79], v[44:47], v[196:199], v[64:79]
  v_exp_f32 v90, v90
  v_exp_f32 v91, v91
  ds_read_b128 v[32:35], v4 offset:28672
  v_cvt_pk_bf16_f32 v108, v88, v89
  v_exp_f32 v92, v92
  v_exp_f32 v93, v93
  ds_read_b128 v[36:39], v4 offset:29696
  v_cvt_pk_bf16_f32 v109, v90, v91
  v_exp_f32 v94, v94
  v_exp_f32 v95, v95
  v_cvt_pk_bf16_f32 v110, v92, v93
  v_cvt_pk_bf16_f32 v111, v94, v95
  v_mfma_f32_32x32x16_bf16 v[128:143], v[48:51], v[104:107], v[128:143]
  v_exp_f32 v64, v64
  v_exp_f32 v65, v65
  v_exp_f32 v66, v66
  v_exp_f32 v67, v67
  v_mfma_f32_32x32x16_bf16 v[128:143], v[52:55], v[108:111], v[128:143]
  v_cvt_pk_bf16_f32 v96, v64, v65
  v_exp_f32 v68, v68
  v_exp_f32 v69, v69
  v_cvt_pk_bf16_f32 v97, v66, v67
  v_exp_f32 v70, v70
  v_mfma_f32_32x32x16_bf16 v[80:95], v[40:43], v[200:203], 0
  v_exp_f32 v71, v71
  v_cvt_pk_bf16_f32 v98, v68, v69
  v_exp_f32 v72, v72
  v_exp_f32 v73, v73
  v_cvt_pk_bf16_f32 v99, v70, v71
  v_mfma_f32_32x32x16_bf16 v[80:95], v[44:47], v[204:207], v[80:95]
  v_exp_f32 v74, v74
  v_exp_f32 v75, v75
  ds_read_b128 v[48:51], v4 offset:61440
  v_cvt_pk_bf16_f32 v100, v72, v73
  v_exp_f32 v76, v76
  v_exp_f32 v77, v77
  ds_read_b128 v[52:55], v4 offset:62464
  v_cvt_pk_bf16_f32 v101, v74, v75
  v_exp_f32 v78, v78
  s_add_u32 m0, s31, 37888
  s_add_u32 s29, s53, s28
  s_add_u32 s29, s29, 5120
  buffer_load_dwordx4 v2, s[8:11], s29 offen sc1 lds
  v_exp_f32 v79, v79
  v_cvt_pk_bf16_f32 v102, v76, v77
  v_cvt_pk_bf16_f32 v103, v78, v79
  s_waitcnt lgkmcnt(4)
  v_mfma_f32_32x32x16_bf16 v[112:127], v[56:59], v[96:99], v[112:127]
  v_exp_f32 v80, v80
  v_exp_f32 v81, v81
  v_exp_f32 v82, v82
  v_exp_f32 v83, v83
  v_mfma_f32_32x32x16_bf16 v[112:127], v[60:63], v[100:103], v[112:127]
  v_cvt_pk_bf16_f32 v104, v80, v81
  v_exp_f32 v84, v84
  v_exp_f32 v85, v85
  v_cvt_pk_bf16_f32 v105, v82, v83
  v_exp_f32 v86, v86
  s_waitcnt lgkmcnt(2)
  v_mfma_f32_32x32x16_bf16 v[64:79], v[32:35], v[192:195], 0
  v_exp_f32 v87, v87
  v_cvt_pk_bf16_f32 v106, v84, v85
  v_exp_f32 v88, v88
  v_exp_f32 v89, v89
  v_cvt_pk_bf16_f32 v107, v86, v87
  v_mfma_f32_32x32x16_bf16 v[64:79], v[36:39], v[196:199], v[64:79]
  v_exp_f32 v90, v90
  v_exp_f32 v91, v91
  ds_read_b128 v[40:43], v4 offset:30720
  v_cvt_pk_bf16_f32 v108, v88, v89
  v_exp_f32 v92, v92
  v_exp_f32 v93, v93
  ds_read_b128 v[44:47], v4 offset:31744
  v_cvt_pk_bf16_f32 v109, v90, v91
  v_exp_f32 v94, v94
  v_exp_f32 v95, v95
  v_cvt_pk_bf16_f32 v110, v92, v93
  v_cvt_pk_bf16_f32 v111, v94, v95
  v_mfma_f32_32x32x16_bf16 v[128:143], v[56:59], v[104:107], v[128:143]
  v_exp_f32 v64, v64
  v_exp_f32 v65, v65
  v_exp_f32 v66, v66
  v_exp_f32 v67, v67
  v_mfma_f32_32x32x16_bf16 v[128:143], v[60:63], v[108:111], v[128:143]
  v_cvt_pk_bf16_f32 v96, v64, v65
  v_exp_f32 v68, v68
  v_exp_f32 v69, v69
  v_cvt_pk_bf16_f32 v97, v66, v67
  v_exp_f32 v70, v70
  v_mfma_f32_32x32x16_bf16 v[80:95], v[32:35], v[200:203], 0
  v_exp_f32 v71, v71
  v_cvt_pk_bf16_f32 v98, v68, v69
  v_exp_f32 v72, v72
  v_exp_f32 v73, v73
  v_cvt_pk_bf16_f32 v99, v70, v71
  v_mfma_f32_32x32x16_bf16 v[80:95], v[36:39], v[204:207], v[80:95]
  v_exp_f32 v74, v74
  v_exp_f32 v75, v75
  ds_read_b128 v[56:59], v4 offset:63488
  v_cvt_pk_bf16_f32 v100, v72, v73
  v_exp_f32 v76, v76
  v_exp_f32 v77, v77
  ds_read_b128 v[60:63], v4 offset:64512
  v_cvt_pk_bf16_f32 v101, v74, v75
  v_exp_f32 v78, v78
  s_add_u32 m0, s31, 38912
  s_add_u32 s29, s53, s28
  s_add_u32 s29, s29, 6144
  buffer_load_dwordx4 v2, s[8:11], s29 offen sc1 lds
  v_exp_f32 v79, v79
  v_cvt_pk_bf16_f32 v102, v76, v77
  v_cvt_pk_bf16_f32 v103, v78, v79
  s_waitcnt lgkmcnt(4)
  v_mfma_f32_32x32x16_bf16 v[112:127], v[48:51], v[96:99], v[112:127]
  v_exp_f32 v80, v80
  v_exp_f32 v81, v81
  v_exp_f32 v82, v82
  v_exp_f32 v83, v83
  v_mfma_f32_32x32x16_bf16 v[112:127], v[52:55], v[100:103], v[112:127]
  v_cvt_pk_bf16_f32 v104, v80, v81
  v_exp_f32 v84, v84
  v_exp_f32 v85, v85
  v_cvt_pk_bf16_f32 v105, v82, v83
  v_exp_f32 v86, v86
  s_waitcnt lgkmcnt(2)
  v_mfma_f32_32x32x16_bf16 v[64:79], v[40:43], v[192:195], 0
  v_exp_f32 v87, v87
  v_cvt_pk_bf16_f32 v106, v84, v85
  v_exp_f32 v88, v88
  v_exp_f32 v89, v89
  v_cvt_pk_bf16_f32 v107, v86, v87
  v_mfma_f32_32x32x16_bf16 v[64:79], v[44:47], v[196:199], v[64:79]
  v_exp_f32 v90, v90
  v_exp_f32 v91, v91
  v_cvt_pk_bf16_f32 v108, v88, v89
  v_exp_f32 v92, v92
  v_exp_f32 v93, v93
  v_cvt_pk_bf16_f32 v109, v90, v91
  v_exp_f32 v94, v94
  v_exp_f32 v95, v95
  v_cvt_pk_bf16_f32 v110, v92, v93
  v_cvt_pk_bf16_f32 v111, v94, v95
  v_mfma_f32_32x32x16_bf16 v[128:143], v[48:51], v[104:107], v[128:143]
  v_exp_f32 v64, v64
  v_exp_f32 v65, v65
  v_exp_f32 v66, v66
  v_exp_f32 v67, v67
  v_mfma_f32_32x32x16_bf16 v[128:143], v[52:55], v[108:111], v[128:143]
  v_cvt_pk_bf16_f32 v96, v64, v65
  v_exp_f32 v68, v68
  v_exp_f32 v69, v69
  v_cvt_pk_bf16_f32 v97, v66, v67
  v_exp_f32 v70, v70
  v_mfma_f32_32x32x16_bf16 v[80:95], v[40:43], v[200:203], 0
  v_exp_f32 v71, v71
  v_cvt_pk_bf16_f32 v98, v68, v69
  v_exp_f32 v72, v72
  v_exp_f32 v73, v73
  v_cvt_pk_bf16_f32 v99, v70, v71
  v_mfma_f32_32x32x16_bf16 v[80:95], v[44:47], v[204:207], v[80:95]
  v_exp_f32 v74, v74
  v_exp_f32 v75, v75
  v_cvt_pk_bf16_f32 v100, v72, v73
  v_exp_f32 v76, v76
  v_exp_f32 v77, v77
  v_cvt_pk_bf16_f32 v101, v74, v75
  v_exp_f32 v78, v78
  s_add_u32 m0, s31, 39936
  s_add_u32 s29, s53, s28
  s_add_u32 s29, s29, 7168
  buffer_load_dwordx4 v2, s[8:11], s29 offen sc1 lds
  v_exp_f32 v79, v79
  v_cvt_pk_bf16_f32 v102, v76, v77
  v_cvt_pk_bf16_f32 v103, v78, v79
  s_waitcnt lgkmcnt(0)
  v_mfma_f32_32x32x16_bf16 v[112:127], v[56:59], v[96:99], v[112:127]
  v_exp_f32 v80, v80
  v_exp_f32 v81, v81
  v_exp_f32 v82, v82
  v_exp_f32 v83, v83
  v_mfma_f32_32x32x16_bf16 v[112:127], v[60:63], v[100:103], v[112:127]
  v_cvt_pk_bf16_f32 v104, v80, v81
  v_exp_f32 v84, v84
  v_exp_f32 v85, v85
  v_cvt_pk_bf16_f32 v105, v82, v83
  v_exp_f32 v86, v86
  v_exp_f32 v87, v87
  v_cvt_pk_bf16_f32 v106, v84, v85
  v_exp_f32 v88, v88
  v_exp_f32 v89, v89
  v_cvt_pk_bf16_f32 v107, v86, v87
  v_exp_f32 v90, v90
  v_exp_f32 v91, v91
  v_cvt_pk_bf16_f32 v108, v88, v89
  v_exp_f32 v92, v92
  v_exp_f32 v93, v93
  v_cvt_pk_bf16_f32 v109, v90, v91
  v_exp_f32 v94, v94
  v_exp_f32 v95, v95
  v_cvt_pk_bf16_f32 v110, v92, v93
  v_cvt_pk_bf16_f32 v111, v94, v95
  s_nop 1
  v_mfma_f32_32x32x16_bf16 v[128:143], v[56:59], v[104:107], v[128:143]
  v_mfma_f32_32x32x16_bf16 v[128:143], v[60:63], v[108:111], v[128:143]
  s_cmp_lt_u32 s41, 4
  s_cbranch_scc1 kb2_chunk2
  s_nop 11
  v_mov_b32 v5, v120
  v_mov_b32 v6, v120
  s_nop 1
  v_permlane32_swap_b32 v5, v6
  v_mov_b32 v14, v6
  v_mov_b32 v5, v136
  v_mov_b32 v6, v136
  s_nop 1
  v_permlane32_swap_b32 v5, v6
  v_mov_b32 v15, v6
  s_cmp_eq_u32 s40, 0
  s_cbranch_scc0 kb2_fin
  v_min_f32 v5, v14, v15
  v_cmp_gt_f32 vcc, 0x12800000, v5
  v_cmp_u_f32 s[36:37], v5, v5
  s_nop 1
  s_or_b64 vcc, vcc, s[36:37]
  s_cmp_lg_u64 vcc, 0
  s_cselect_b32 s42, 1, 0
  v_mov_b32 v5, s42
  s_lshl_b32 s30, s21, 2
  s_add_u32 s30, s30, 131584
  v_mov_b32 v6, s30
  ds_write_b32 v6, v5
  s_waitcnt vmcnt(0) lgkmcnt(0)
  s_barrier
  v_mov_b32 v6, 131584
  ds_read_b128 v[8:11], v6
  s_waitcnt lgkmcnt(0)
  v_or_b32 v8, v8, v9
  v_or_b32 v10, v10, v11
  v_or_b32 v8, v8, v10
  s_nop 0
  v_readfirstlane_b32 s42, v8
  s_cmp_eq_u32 s42, 0
  s_cbranch_scc1 kb2_fin
  s_mov_b32 s40, 1
  v_and_b32 v5, 0xffff0000, v198
  v_cndmask_b32 v198, v198, v5, s[34:35]
  v_mov_b32 v12, 0xff7fffff
  v_and_b32 v5, 0xffff0000, v206
  v_cndmask_b32 v206, v206, v5, s[34:35]
  v_mov_b32 v13, 0xff7fffff
  s_mov_b32 s41, 0
kb2_mx:
  s_lshl_b32 s30, s41, 11
  s_add_u32 s30, s30, s27
  buffer_load_dwordx4 v[32:35], v2, s[8:11], s30 offen sc1
  buffer_load_dwordx4 v[36:39], v2, s[8:11], s30 offen offset:1024 sc1
  s_waitcnt vmcnt(0)
  v_mfma_f32_32x32x16_bf16 v[64:79], v[32:35], v[192:195], 0
  v_mfma_f32_32x32x16_bf16 v[64:79], v[36:39], v[196:199], v[64:79]
  v_mfma_f32_32x32x16_bf16 v[80:95], v[32:35], v[200:203], 0
  v_mfma_f32_32x32x16_bf16 v[80:95], v[36:39], v[204:207], v[80:95]
  s_nop 11
  v_max3_f32 v12, v12, v64, v65
  v_max3_f32 v12, v12, v66, v67
  v_max3_f32 v12, v12, v68, v69
  v_max3_f32 v12, v12, v70, v71
  v_max3_f32 v12, v12, v72, v73
  v_max3_f32 v12, v12, v74, v75
  v_max3_f32 v12, v12, v76, v77
  v_max3_f32 v12, v12, v78, v79
  v_max3_f32 v13, v13, v80, v81
  v_max3_f32 v13, v13, v82, v83
  v_max3_f32 v13, v13, v84, v85
  v_max3_f32 v13, v13, v86, v87
  v_max3_f32 v13, v13, v88, v89
  v_max3_f32 v13, v13, v90, v91
  v_max3_f32 v13, v13, v92, v93
  v_max3_f32 v13, v13, v94, v95
  s_add_u32 s41, s41, 1
  s_cmp_lt_u32 s41, 64
  s_cbranch_scc1 kb2_mx
  v_mov_b32 v5, v12
  s_nop 1
  v_permlane32_swap_b32 v12, v5
  v_max_f32 v12, v12, v5
  v_cvt_pk_bf16_f32 v5, v12, v12
  v_and_b32 v5, 0xffff, v5
  v_xor_b32 v5, 0x8000, v5
  v_and_b32 v6, 0xffff0000, v198
  v_or_b32 v5, v5, v6
  v_cndmask_b32 v198, v198, v5, s[34:35]
  v_mov_b32 v5, v13
  s_nop 1
  v_permlane32_swap_b32 v13, v5
  v_max_f32 v13, v13, v5
  v_cvt_pk_bf16_f32 v5, v13, v13
  v_and_b32 v5, 0xffff, v5
  v_xor_b32 v5, 0x8000, v5
  v_and_b32 v6, 0xffff0000, v206
  v_or_b32 v5, v5, v6
  v_cndmask_b32 v206, v206, v5, s[34:35]
  s_barrier
  s_mov_b32 s41, 0
  s_mul_i32 s53, s41, 32768
  s_lshl_b32 s31, s21, 13
  s_add_u32 s53, s53, s31
  s_add_u32 m0, s31, 0
  s_add_u32 s29, s53, s27
  s_add_u32 s29, s29, 0
  buffer_load_dwordx4 v2, s[8:11], s29 offen sc1 lds
  s_add_u32 m0, s31, 1024
  s_add_u32 s29, s53, s27
  s_add_u32 s29, s29, 1024
  buffer_load_dwordx4 v2, s[8:11], s29 offen sc1 lds
  s_add_u32 m0, s31, 2048
  s_add_u32 s29, s53, s27
  s_add_u32 s29, s29, 2048
  buffer_load_dwordx4 v2, s[8:11], s29 offen sc1 lds
  s_add_u32 m0, s31, 3072
  s_add_u32 s29, s53, s27
  s_add_u32 s29, s29, 3072
  buffer_load_dwordx4 v2, s[8:11], s29 offen sc1 lds
  s_add_u32 m0, s31, 4096
  s_add_u32 s29, s53, s27
  s_add_u32 s29, s29, 4096
  buffer_load_dwordx4 v2, s[8:11], s29 offen sc1 lds
  s_add_u32 m0, s31, 5120
  s_add_u32 s29, s53, s27
  s_add_u32 s29, s29, 5120
  buffer_load_dwordx4 v2, s[8:11], s29 offen sc1 lds
  s_add_u32 m0, s31, 6144
  s_add_u32 s29, s53, s27
  s_add_u32 s29, s29, 6144
  buffer_load_dwordx4 v2, s[8:11], s29 offen sc1 lds
  s_add_u32 m0, s31, 7168
  s_add_u32 s29, s53, s27
  s_add_u32 s29, s29, 7168
  buffer_load_dwordx4 v2, s[8:11], s29 offen sc1 lds
  s_add_u32 m0, s31, 32768
  s_add_u32 s29, s53, s28
  s_add_u32 s29, s29, 0
  buffer_load_dwordx4 v2, s[8:11], s29 offen sc1 lds
  s_add_u32 m0, s31, 33792
  s_add_u32 s29, s53, s28
  s_add_u32 s29, s29, 1024
  buffer_load_dwordx4 v2, s[8:11], s29 offen sc1 lds
  s_add_u32 m0, s31, 34816
  s_add_u32 s29, s53, s28
  s_add_u32 s29, s29, 2048
  buffer_load_dwordx4 v2, s[8:11], s29 offen sc1 lds
  s_add_u32 m0, s31, 35840
  s_add_u32 s29, s53, s28
  s_add_u32 s29, s29, 3072
  buffer_load_dwordx4 v2, s[8:11], s29 offen sc1 lds
  s_add_u32 m0, s31, 36864
  s_add_u32 s29, s53, s28
  s_add_u32 s29, s29, 4096
  buffer_load_dwordx4 v2, s[8:11], s29 offen sc1 lds
  s_add_u32 m0, s31, 37888
  s_add_u32 s29, s53, s28
  s_add_u32 s29, s29, 5120
  buffer_load_dwordx4 v2, s[8:11], s29 offen sc1 lds
  s_add_u32 m0, s31, 38912
  s_add_u32 s29, s53, s28
  s_add_u32 s29, s29, 6144
  buffer_load_dwordx4 v2, s[8:11], s29 offen sc1 lds
  s_add_u32 m0, s31, 39936
  s_add_u32 s29, s53, s28
  s_add_u32 s29, s29, 7168
  buffer_load_dwordx4 v2, s[8:11], s29 offen sc1 lds
  s_branch kb2_main2
kb2_fin:
  v_and_b32 v3, 15, v1
  v_bfe_u32 v11, v1, 4, 1
  v_mul_u32_u24 v11, 20480, v11
  v_lshrrev_b32 v4, 5, v1
  s_mul_i32 s30, s22, 20
  v_lshlrev_b32 v5, 2, v4
  v_add_u32 v5, 0, v5
  v_add_u32 v5, s30, v5
  v_lshrrev_b32 v6, 5, v5
  v_lshlrev_b32 v6, 10, v6
  v_bfe_u32 v7, v5, 3, 2
  v_lshlrev_b32 v7, 4, v7
  v_add_u32 v7, v7, v3
  v_lshlrev_b32 v7, 4, v7
  v_add_u32 v6, v6, v7
  v_bfe_u32 v7, v5, 2, 1
  v_lshlrev_b32 v7, 3, v7
  v_add_u32 v6, v6, v7
  v_add_u32 v32, v6, v11
  v_lshlrev_b32 v5, 2, v4
  v_add_u32 v5, 8, v5
  v_add_u32 v5, s30, v5
  v_lshrrev_b32 v6, 5, v5
  v_lshlrev_b32 v6, 10, v6
  v_bfe_u32 v7, v5, 3, 2
  v_lshlrev_b32 v7, 4, v7
  v_add_u32 v7, v7, v3
  v_lshlrev_b32 v7, 4, v7
  v_add_u32 v6, v6, v7
  v_bfe_u32 v7, v5, 2, 1
  v_lshlrev_b32 v7, 3, v7
  v_add_u32 v6, v6, v7
  v_add_u32 v33, v6, v11
  v_lshlrev_b32 v5, 2, v4
  v_add_u32 v5, 16, v5
  v_add_u32 v5, s30, v5
  v_lshrrev_b32 v6, 5, v5
  v_lshlrev_b32 v6, 10, v6
  v_bfe_u32 v7, v5, 3, 2
  v_lshlrev_b32 v7, 4, v7
  v_add_u32 v7, v7, v3
  v_lshlrev_b32 v7, 4, v7
  v_add_u32 v6, v6, v7
  v_bfe_u32 v7, v5, 2, 1
  v_lshlrev_b32 v7, 3, v7
  v_add_u32 v6, v6, v7
  v_add_u32 v34, v6, v11
  v_mov_b32 v5, 0x40000000
  v_cndmask_b32 v34, v5, v34, s[34:35]
  v_rcp_f32 v5, v14
  s_nop 0
  v_mul_f32 v112, v112, v5
  v_mul_f32 v113, v113, v5
  v_mul_f32 v114, v114, v5
  v_mul_f32 v115, v115, v5
  v_mul_f32 v116, v116, v5
  v_mul_f32 v117, v117, v5
  v_mul_f32 v118, v118, v5
  v_mul_f32 v119, v119, v5
  v_mul_f32 v120, v120, v5
  v_mul_f32 v121, v121, v5
  v_mul_f32 v122, v122, v5
  v_mul_f32 v123, v123, v5
  v_cvt_pk_bf16_f32 v40, v112, v113
  v_cvt_pk_bf16_f32 v41, v114, v115
  v_cvt_pk_bf16_f32 v42, v116, v117
  v_cvt_pk_bf16_f32 v43, v118, v119
  v_cvt_pk_bf16_f32 v44, v120, v121
  v_cvt_pk_bf16_f32 v45, v122, v123
  s_add_u32 s31, s52, 0
  s_mul_i32 s31, s31, 40960
  s_add_u32 s31, s31, 0xf200000
  buffer_store_dwordx2 v[40:41], v32, s[8:11], s31 offen sc1
  buffer_store_dwordx2 v[42:43], v33, s[8:11], s31 offen sc1
  buffer_store_dwordx2 v[44:45], v34, s[8:11], s31 offen sc1
  v_rcp_f32 v5, v15
  s_nop 0
  v_mul_f32 v128, v128, v5
  v_mul_f32 v129, v129, v5
  v_mul_f32 v130, v130, v5
  v_mul_f32 v131, v131, v5
  v_mul_f32 v132, v132, v5
  v_mul_f32 v133, v133, v5
  v_mul_f32 v134, v134, v5
  v_mul_f32 v135, v135, v5
  v_mul_f32 v136, v136, v5
  v_mul_f32 v137, v137, v5
  v_mul_f32 v138, v138, v5
  v_mul_f32 v139, v139, v5
  v_cvt_pk_bf16_f32 v48, v128, v129
  v_cvt_pk_bf16_f32 v49, v130, v131
  v_cvt_pk_bf16_f32 v50, v132, v133
  v_cvt_pk_bf16_f32 v51, v134, v135
  v_cvt_pk_bf16_f32 v52, v136, v137
  v_cvt_pk_bf16_f32 v53, v138, v139
  s_add_u32 s31, s52, 1
  s_mul_i32 s31, s31, 40960
  s_add_u32 s31, s31, 0xf200000
  buffer_store_dwordx2 v[48:49], v32, s[8:11], s31 offen sc1
  buffer_store_dwordx2 v[50:51], v33, s[8:11], s31 offen sc1
  buffer_store_dwordx2 v[52:53], v34, s[8:11], s31 offen sc1
  s_waitcnt vmcnt(0)
  s_barrier
  s_cmp_eq_u32 s21, 0
  s_cbranch_scc0 arr_109
  s_mov_b64 s[24:25], exec
  s_mov_b64 exec, 1
  v_mov_b32 v3, 0
  v_mov_b32 v4, 1
  buffer_atomic_add v4, v3, s[8:11], s48 offen
  s_mov_b64 exec, s[24:25]
arr_109:
  v_and_b32 v5, 15, v1
  v_lshrrev_b32 v6, 4, v1
  v_and_b32 v7, 1, v6
  v_lshlrev_b32 v7, 10, v7
  v_lshrrev_b32 v8, 1, v6
  v_lshlrev_b32 v8, 5, v8
  v_add_u32 v8, v8, v5
  v_lshlrev_b32 v8, 4, v8
  v_add_u32 v9, v7, v8
  s_lshr_b32 s26, s2, 2
  s_mul_i32 s27, s26, 81920
  s_lshl_b32 s28, s50, 11
  s_add_u32 s27, s27, s28
  s_add_u32 s27, s27, 0x1400000
  s_add_u32 s28, s27, 0
  buffer_load_dwordx4 v[16:19], v9, s[8:11], s28 offen sc1
  s_add_u32 s28, s27, 256
  buffer_load_dwordx4 v[20:23], v9, s[8:11], s28 offen sc1
  s_add_u32 s28, s27, 2048
  buffer_load_dwordx4 v[24:27], v9, s[8:11], s28 offen sc1
  s_add_u32 s28, s27, 2304
  buffer_load_dwordx4 v[28:31], v9, s[8:11], s28 offen sc1
  s_cmp_lt_u32 s21, 2
  s_cbranch_scc0 g3_110
  s_add_u32 s28, s27, 4096
  buffer_load_dwordx4 v[32:35], v9, s[8:11], s28 offen sc1
  s_add_u32 s28, s27, 4352
  buffer_load_dwordx4 v[36:39], v9, s[8:11], s28 offen sc1
g3_110:
  s_mov_b32 s45, 0
  v_mov_b32 v3, 0
aw_111:
  buffer_load_dword v4, v3, s[8:11], s48 offen sc1
  s_add_u32 s45, s45, 1
  s_waitcnt vmcnt(0)
  v_readfirstlane_b32 s29, v4
  s_cmp_ge_u32 s29, 32
  s_cbranch_scc1 aw_111_ok
  s_cmp_lt_u32 s45, 400000
  s_cbranch_scc1 aw_111
  s_branch kb2_abort
aw_111_ok:
  s_mul_i32 s28, s26, 40960
  s_mul_i32 s31, s21, 10240
  s_add_u32 s28, s28, s31
  s_add_u32 s28, s28, 0xf200000
  s_add_u32 m0, s31, 0
  s_add_u32 s29, s28, 0
  buffer_load_dwordx4 v2, s[8:11], s29 offen sc1 lds
  s_add_u32 m0, s31, 1024
  s_add_u32 s29, s28, 1024
  buffer_load_dwordx4 v2, s[8:11], s29 offen sc1 lds
  s_add_u32 m0, s31, 2048
  s_add_u32 s29, s28, 2048
  buffer_load_dwordx4 v2, s[8:11], s29 offen sc1 lds
  s_add_u32 m0, s31, 3072
  s_add_u32 s29, s28, 3072
  buffer_load_dwordx4 v2, s[8:11], s29 offen sc1 lds
  s_add_u32 m0, s31, 4096
  s_add_u32 s29, s28, 4096
  buffer_load_dwordx4 v2, s[8:11], s29 offen sc1 lds
  s_add_u32 m0, s31, 5120
  s_add_u32 s29, s28, 5120
  buffer_load_dwordx4 v2, s[8:11], s29 offen sc1 lds
  s_add_u32 m0, s31, 6144
  s_add_u32 s29, s28, 6144
  buffer_load_dwordx4 v2, s[8:11], s29 offen sc1 lds
  s_add_u32 m0, s31, 7168
  s_add_u32 s29, s28, 7168
  buffer_load_dwordx4 v2, s[8:11], s29 offen sc1 lds
  s_add_u32 m0, s31, 8192
  s_add_u32 s29, s28, 8192
  buffer_load_dwordx4 v2, s[8:11], s29 offen sc1 lds
  s_add_u32 m0, s31, 9216
  s_add_u32 s29, s28, 9216
  buffer_load_dwordx4 v2, s[8:11], s29 offen sc1 lds
  s_waitcnt vmcnt(0)
  s_barrier
  ds_read_b128 v[80:83], v2 offset:0
  ds_read_b128 v[84:87], v2 offset:20480
  ds_read_b128 v[88:91], v2 offset:1024
  ds_read_b128 v[92:95], v2 offset:21504
  ds_read_b128 v[96:99], v2 offset:2048
  ds_read_b128 v[100:103], v2 offset:22528
  s_waitcnt lgkmcnt(4)
  v_mfma_f32_16x16x32_bf16 v[48:51], a[0:3], v[80:83], 0
  v_mfma_f32_16x16x32_bf16 v[52:55], a[0:3], v[84:87], 0
  v_mfma_f32_16x16x32_bf16 v[56:59], a[80:83], v[80:83], 0
  v_mfma_f32_16x16x32_bf16 v[60:63], a[80:83], v[84:87], 0
  v_mfma_f32_16x16x32_bf16 v[64:67], a[160:163], v[80:83], 0
  v_mfma_f32_16x16x32_bf16 v[68:71], a[160:163], v[84:87], 0
  ds_read_b128 v[80:83], v2 offset:3072
  ds_read_b128 v[84:87], v2 offset:23552
  s_waitcnt lgkmcnt(4)
  v_mfma_f32_16x16x32_bf16 v[48:51], a[4:7], v[88:91], v[48:51]
  v_mfma_f32_16x16x32_bf16 v[52:55], a[4:7], v[92:95], v[52:55]
  v_mfma_f32_16x16x32_bf16 v[56:59], a[84:87], v[88:91], v[56:59]
  v_mfma_f32_16x16x32_bf16 v[60:63], a[84:87], v[92:95], v[60:63]
  v_mfma_f32_16x16x32_bf16 v[64:67], a[164:167], v[88:91], v[64:67]
  v_mfma_f32_16x16x32_bf16 v[68:71], a[164:167], v[92:95], v[68:71]
  ds_read_b128 v[88:91], v2 offset:4096
  ds_read_b128 v[92:95], v2 offset:24576
  s_waitcnt lgkmcnt(4)
  v_mfma_f32_16x16x32_bf16 v[48:51], a[8:11], v[96:99], v[48:51]
  v_mfma_f32_16x16x32_bf16 v[52:55], a[8:11], v[100:103], v[52:55]
  v_mfma_f32_16x16x32_bf16 v[56:59], a[88:91], v[96:99], v[56:59]
  v_mfma_f32_16x16x32_bf16 v[60:63], a[88:91], v[100:103], v[60:63]
  v_mfma_f32_16x16x32_bf16 v[64:67], a[168:171], v[96:99], v[64:67]
  v_mfma_f32_16x16x32_bf16 v[68:71], a[168:171], v[100:103], v[68:71]
  ds_read_b128 v[96:99], v2 offset:5120
  ds_read_b128 v[100:103], v2 offset:25600
  s_waitcnt lgkmcnt(4)
  v_mfma_f32_16x16x32_bf16 v[48:51], a[12:15], v[80:83], v[48:51]
  v_mfma_f32_16x16x32_bf16 v[52:55], a[12:15], v[84:87], v[52:55]
  v_mfma_f32_16x16x32_bf16 v[56:59], a[92:95], v[80:83], v[56:59]
  v_mfma_f32_16x16x32_bf16 v[60:63], a[92:95], v[84:87], v[60:63]
  v_mfma_f32_16x16x32_bf16 v[64:67], a[172:175], v[80:83], v[64:67]
  v_mfma_f32_16x16x32_bf16 v[68:71], a[172:175], v[84:87], v[68:71]
  ds_read_b128 v[80:83], v2 offset:6144
  ds_read_b128 v[84:87], v2 offset:26624
  s_waitcnt lgkmcnt(4)
  v_mfma_f32_16x16x32_bf16 v[48:51], a[16:19], v[88:91], v[48:51]
  v_mfma_f32_16x16x32_bf16 v[52:55], a[16:19], v[92:95], v[52:55]
  v_mfma_f32_16x16x32_bf16 v[56:59], a[96:99], v[88:91], v[56:59]
  v_mfma_f32_16x16x32_bf16 v[60:63], a[96:99], v[92:95], v[60:63]
  v_mfma_f32_16x16x32_bf16 v[64:67], a[176:179], v[88:91], v[64:67]
  v_mfma_f32_16x16x32_bf16 v[68:71], a[176:179], v[92:95], v[68:71]
  ds_read_b128 v[88:91], v2 offset:7168
  ds_read_b128 v[92:95], v2 offset:27648
  s_waitcnt lgkmcnt(4)
  v_mfma_f32_16x16x32_bf16 v[48:51], a[20:23], v[96:99], v[48:51]
  v_mfma_f32_16x16x32_bf16 v[52:55], a[20:23], v[100:103], v[52:55]
  v_mfma_f32_16x16x32_bf16 v[56:59], a[100:103], v[96:99], v[56:59]
  v_mfma_f32_16x16x32_bf16 v[60:63], a[100:103], v[100:103], v[60:63]
  v_mfma_f32_16x16x32_bf16 v[64:67], a[180:183], v[96:99], v[64:67]
  v_mfma_f32_16x16x32_bf16 v[68:71], a[180:183], v[100:103], v[68:71]
  ds_read_b128 v[96:99], v2 offset:8192
  ds_read_b128 v[100:103], v2 offset:28672
  s_waitcnt lgkmcnt(4)
  v_mfma_f32_16x16x32_bf16 v[48:51], a[24:27], v[80:83], v[48:51]
  v_mfma_f32_16x16x32_bf16 v[52:55], a[24:27], v[84:87], v[52:55]
  v_mfma_f32_16x16x32_bf16 v[56:59], a[104:107], v[80:83], v[56:59]
  v_mfma_f32_16x16x32_bf16 v[60:63], a[104:107], v[84:87], v[60:63]
  v_mfma_f32_16x16x32_bf16 v[64:67], a[184:187], v[80:83], v[64:67]
  v_mfma_f32_16x16x32_bf16 v[68:71], a[184:187], v[84:87], v[68:71]
  ds_read_b128 v[80:83], v2 offset:9216
  ds_read_b128 v[84:87], v2 offset:29696
  s_waitcnt lgkmcnt(4)
  v_mfma_f32_16x16x32_bf16 v[48:51], a[28:31], v[88:91], v[48:51]
  v_mfma_f32_16x16x32_bf16 v[52:55], a[28:31], v[92:95], v[52:55]
  v_mfma_f32_16x16x32_bf16 v[56:59], a[108:111], v[88:91], v[56:59]
  v_mfma_f32_16x16x32_bf16 v[60:63], a[108:111], v[92:95], v[60:63]
  v_mfma_f32_16x16x32_bf16 v[64:67], a[188:191], v[88:91], v[64:67]
  v_mfma_f32_16x16x32_bf16 v[68:71], a[188:191], v[92:95], v[68:71]
  ds_read_b128 v[88:91], v2 offset:10240
  ds_read_b128 v[92:95], v2 offset:30720
  s_waitcnt lgkmcnt(4)
  v_mfma_f32_16x16x32_bf16 v[48:51], a[32:35], v[96:99], v[48:51]
  v_mfma_f32_16x16x32_bf16 v[52:55], a[32:35], v[100:103], v[52:55]
  v_mfma_f32_16x16x32_bf16 v[56:59], a[112:115], v[96:99], v[56:59]
  v_mfma_f32_16x16x32_bf16 v[60:63], a[112:115], v[100:103], v[60:63]
  v_mfma_f32_16x16x32_bf16 v[64:67], a[192:195], v[96:99], v[64:67]
  v_mfma_f32_16x16x32_bf16 v[68:71], a[192:195], v[100:103], v[68:71]
  ds_read_b128 v[96:99], v2 offset:11264
  ds_read_b128 v[100:103], v2 offset:31744
  s_waitcnt lgkmcnt(4)
  v_mfma_f32_16x16x32_bf16 v[48:51], a[36:39], v[80:83], v[48:51]
  v_mfma_f32_16x16x32_bf16 v[52:55], a[36:39], v[84:87], v[52:55]
  v_mfma_f32_16x16x32_bf16 v[56:59], a[116:119], v[80:83], v[56:59]
  v_mfma_f32_16x16x32_bf16 v[60:63], a[116:119], v[84:87], v[60:63]
  v_mfma_f32_16x16x32_bf16 v[64:67], a[196:199], v[80:83], v[64:67]
  v_mfma_f32_16x16x32_bf16 v[68:71], a[196:199], v[84:87], v[68:71]
  ds_read_b128 v[80:83], v2 offset:12288
  ds_read_b128 v[84:87], v2 offset:32768
  s_waitcnt lgkmcnt(4)
  v_mfma_f32_16x16x32_bf16 v[48:51], a[40:43], v[88:91], v[48:51]
  v_mfma_f32_16x16x32_bf16 v[52:55], a[40:43], v[92:95], v[52:55]
  v_mfma_f32_16x16x32_bf16 v[56:59], a[120:123], v[88:91], v[56:59]
  v_mfma_f32_16x16x32_bf16 v[60:63], a[120:123], v[92:95], v[60:63]
  v_mfma_f32_16x16x32_bf16 v[64:67], a[200:203], v[88:91], v[64:67]
  v_mfma_f32_16x16x32_bf16 v[68:71], a[200:203], v[92:95], v[68:71]
  ds_read_b128 v[88:91], v2 offset:13312
  ds_read_b128 v[92:95], v2 offset:33792
  s_waitcnt lgkmcnt(4)
  v_mfma_f32_16x16x32_bf16 v[48:51], a[44:47], v[96:99], v[48:51]
  v_mfma_f32_16x16x32_bf16 v[52:55], a[44:47], v[100:103], v[52:55]
  v_mfma_f32_16x16x32_bf16 v[56:59], a[124:127], v[96:99], v[56:59]
  v_mfma_f32_16x16x32_bf16 v[60:63], a[124:127], v[100:103], v[60:63]
  v_mfma_f32_16x16x32_bf16 v[64:67], a[204:207], v[96:99], v[64:67]
  v_mfma_f32_16x16x32_bf16 v[68:71], a[204:207], v[100:103], v[68:71]
  ds_read_b128 v[96:99], v2 offset:14336
  ds_read_b128 v[100:103], v2 offset:34816
  s_waitcnt lgkmcnt(4)
  v_mfma_f32_16x16x32_bf16 v[48:51], a[48:51], v[80:83], v[48:51]
  v_mfma_f32_16x16x32_bf16 v[52:55], a[48:51], v[84:87], v[52:55]
  v_mfma_f32_16x16x32_bf16 v[56:59], a[128:131], v[80:83], v[56:59]
  v_mfma_f32_16x16x32_bf16 v[60:63], a[128:131], v[84:87], v[60:63]
  v_mfma_f32_16x16x32_bf16 v[64:67], a[208:211], v[80:83], v[64:67]
  v_mfma_f32_16x16x32_bf16 v[68:71], a[208:211], v[84:87], v[68:71]
  ds_read_b128 v[80:83], v2 offset:15360
  ds_read_b128 v[84:87], v2 offset:35840
  s_waitcnt lgkmcnt(4)
  v_mfma_f32_16x16x32_bf16 v[48:51], a[52:55], v[88:91], v[48:51]
  v_mfma_f32_16x16x32_bf16 v[52:55], a[52:55], v[92:95], v[52:55]
  v_mfma_f32_16x16x32_bf16 v[56:59], a[132:135], v[88:91], v[56:59]
  v_mfma_f32_16x16x32_bf16 v[60:63], a[132:135], v[92:95], v[60:63]
  v_mfma_f32_16x16x32_bf16 v[64:67], a[212:215], v[88:91], v[64:67]
  v_mfma_f32_16x16x32_bf16 v[68:71], a[212:215], v[92:95], v[68:71]
  ds_read_b128 v[88:91], v2 offset:16384
  ds_read_b128 v[92:95], v2 offset:36864
  s_waitcnt lgkmcnt(4)
  v_mfma_f32_16x16x32_bf16 v[48:51], a[56:59], v[96:99], v[48:51]
  v_mfma_f32_16x16x32_bf16 v[52:55], a[56:59], v[100:103], v[52:55]
  v_mfma_f32_16x16x32_bf16 v[56:59], a[136:139], v[96:99], v[56:59]
  v_mfma_f32_16x16x32_bf16 v[60:63], a[136:139], v[100:103], v[60:63]
  v_mfma_f32_16x16x32_bf16 v[64:67], a[216:219], v[96:99], v[64:67]
  v_mfma_f32_16x16x32_bf16 v[68:71], a[216:219], v[100:103], v[68:71]
  ds_read_b128 v[96:99], v2 offset:17408
  ds_read_b128 v[100:103], v2 offset:37888
  s_waitcnt lgkmcnt(4)
  v_mfma_f32_16x16x32_bf16 v[48:51], a[60:63], v[80:83], v[48:51]
  v_mfma_f32_16x16x32_bf16 v[52:55], a[60:63], v[84:87], v[52:55]
  v_mfma_f32_16x16x32_bf16 v[56:59], a[140:143], v[80:83], v[56:59]
  v_mfma_f32_16x16x32_bf16 v[60:63], a[140:143], v[84:87], v[60:63]
  v_mfma_f32_16x16x32_bf16 v[64:67], a[220:223], v[80:83], v[64:67]
  v_mfma_f32_16x16x32_bf16 v[68:71], a[220:223], v[84:87], v[68:71]
  ds_read_b128 v[80:83], v2 offset:18432
  ds_read_b128 v[84:87], v2 offset:38912
  s_waitcnt lgkmcnt(4)
  v_mfma_f32_16x16x32_bf16 v[48:51], a[64:67], v[88:91], v[48:51]
  v_mfma_f32_16x16x32_bf16 v[52:55], a[64:67], v[92:95], v[52:55]
  v_mfma_f32_16x16x32_bf16 v[56:59], a[144:147], v[88:91], v[56:59]
  v_mfma_f32_16x16x32_bf16 v[60:63], a[144:147], v[92:95], v[60:63]
  v_mfma_f32_16x16x32_bf16 v[64:67], a[224:227], v[88:91], v[64:67]
  v_mfma_f32_16x16x32_bf16 v[68:71], a[224:227], v[92:95], v[68:71]
  ds_read_b128 v[88:91], v2 offset:19456
  ds_read_b128 v[92:95], v2 offset:39936
  s_waitcnt lgkmcnt(4)
  v_mfma_f32_16x16x32_bf16 v[48:51], a[68:71], v[96:99], v[48:51]
  v_mfma_f32_16x16x32_bf16 v[52:55], a[68:71], v[100:103], v[52:55]
  v_mfma_f32_16x16x32_bf16 v[56:59], a[148:151], v[96:99], v[56:59]
  v_mfma_f32_16x16x32_bf16 v[60:63], a[148:151], v[100:103], v[60:63]
  v_mfma_f32_16x16x32_bf16 v[64:67], a[228:231], v[96:99], v[64:67]
  v_mfma_f32_16x16x32_bf16 v[68:71], a[228:231], v[100:103], v[68:71]
  s_waitcnt lgkmcnt(2)
  v_mfma_f32_16x16x32_bf16 v[48:51], a[72:75], v[80:83], v[48:51]
  v_mfma_f32_16x16x32_bf16 v[52:55], a[72:75], v[84:87], v[52:55]
  v_mfma_f32_16x16x32_bf16 v[56:59], a[152:155], v[80:83], v[56:59]
  v_mfma_f32_16x16x32_bf16 v[60:63], a[152:155], v[84:87], v[60:63]
  v_mfma_f32_16x16x32_bf16 v[64:67], a[232:235], v[80:83], v[64:67]
  v_mfma_f32_16x16x32_bf16 v[68:71], a[232:235], v[84:87], v[68:71]
  s_waitcnt lgkmcnt(0)
  v_mfma_f32_16x16x32_bf16 v[48:51], a[76:79], v[88:91], v[48:51]
  v_mfma_f32_16x16x32_bf16 v[52:55], a[76:79], v[92:95], v[52:55]
  v_mfma_f32_16x16x32_bf16 v[56:59], a[156:159], v[88:91], v[56:59]
  v_mfma_f32_16x16x32_bf16 v[60:63], a[156:159], v[92:95], v[60:63]
  v_mfma_f32_16x16x32_bf16 v[64:67], a[236:239], v[88:91], v[64:67]
  v_mfma_f32_16x16x32_bf16 v[68:71], a[236:239], v[92:95], v[68:71]
  s_nop 7
  v_mul_u32_u24 v10, 1280, v5
  v_lshlrev_b32 v11, 3, v6
  v_add_u32 v10, v10, v11
  s_mul_i32 s30, s26, 40960
  s_lshl_b32 s31, s50, 5
  s_add_u32 s30, s30, s31
  v_add_f32 v48, v48, v16
  v_add_f32 v49, v49, v17
  v_add_f32 v50, v50, v18
  v_add_f32 v51, v51, v19
  v_cvt_pk_bf16_f32 v48, v48, v49
  v_cvt_pk_bf16_f32 v49, v50, v51
  s_add_u32 s28, s30, 0
  buffer_store_dwordx2 v[48:49], v10, s[16:19], s28 offen
  v_add_f32 v52, v52, v20
  v_add_f32 v53, v53, v21
  v_add_f32 v54, v54, v22
  v_add_f32 v55, v55, v23
  v_cvt_pk_bf16_f32 v52, v52, v53
  v_cvt_pk_bf16_f32 v53, v54, v55
  s_add_u32 s28, s30, 20480
  buffer_store_dwordx2 v[52:53], v10, s[16:19], s28 offen
  v_add_f32 v56, v56, v24
  v_add_f32 v57, v57, v25
  v_add_f32 v58, v58, v26
  v_add_f32 v59, v59, v27
  v_cvt_pk_bf16_f32 v56, v56, v57
  v_cvt_pk_bf16_f32 v57, v58, v59
  s_add_u32 s28, s30, 32
  buffer_store_dwordx2 v[56:57], v10, s[16:19], s28 offen
  v_add_f32 v60, v60, v28
  v_add_f32 v61, v61, v29
  v_add_f32 v62, v62, v30
  v_add_f32 v63, v63, v31
  v_cvt_pk_bf16_f32 v60, v60, v61
  v_cvt_pk_bf16_f32 v61, v62, v63
  s_add_u32 s28, s30, 20512
  buffer_store_dwordx2 v[60:61], v10, s[16:19], s28 offen
  s_cmp_lt_u32 s21, 2
  s_cbranch_scc0 g3_112
  v_add_f32 v64, v64, v32
  v_add_f32 v65, v65, v33
  v_add_f32 v66, v66, v34
  v_add_f32 v67, v67, v35
  v_cvt_pk_bf16_f32 v64, v64, v65
  v_cvt_pk_bf16_f32 v65, v66, v67
  s_add_u32 s28, s30, 64
  buffer_store_dwordx2 v[64:65], v10, s[16:19], s28 offen
  v_add_f32 v68, v68, v36
  v_add_f32 v69, v69, v37
  v_add_f32 v70, v70, v38
  v_add_f32 v71, v71, v39
  v_cvt_pk_bf16_f32 v68, v68, v69
  v_cvt_pk_bf16_f32 v69, v70, v71
  s_add_u32 s28, s30, 20544
  buffer_store_dwordx2 v[68:69], v10, s[16:19], s28 offen
g3_112:
  s_endpgm
kb2_abort:
  s_load_dwordx2 s[6:7], s[0:1], 88
  v_mov_b32 v2, 80
  v_mov_b32 v3, 1
  s_waitcnt lgkmcnt(0)
  s_mov_b64 exec, 1
  global_atomic_add v2, v3, s[6:7]
  s_waitcnt vmcnt(0)
kb2_exit:
  s_endpgm

.section .rodata,"a"
.p2align 6
.amdhsa_kernel kb2_kernel
  .amdhsa_next_free_vgpr 512
  .amdhsa_next_free_sgpr 102
  .amdhsa_accum_offset 256
  .amdhsa_group_segment_fixed_size 0
  .amdhsa_kernarg_size 104
  .amdhsa_user_sgpr_count 2
  .amdhsa_user_sgpr_kernarg_segment_ptr 1
  .amdhsa_system_sgpr_workgroup_id_x 1
.end_amdhsa_kernel
```

```asm
; @launch kernel=prep_kernel grid=(256,1,1) block=(256,1,1) lds=32768
; @launch kernel=ka1_kernel grid=(256,1,1) block=(256,1,1) lds=163840
; @launch kernel=kb1_kernel grid=(256,1,1) block=(256,1,1) lds=135168
; @launch kernel=ka2_kernel grid=(256,1,1) block=(256,1,1) lds=163840
; @launch kernel=kb2_kernel grid=(256,1,1) block=(256,1,1) lds=135168
.amdgcn_target "amdgcn-amd-amdhsa--gfx950"
.text
.globl prep_kernel
.p2align 8
.type prep_kernel,@function
prep_kernel:
  s_cmp_ge_u32 s2, 256
  s_cbranch_scc1 k0_exit
  s_load_dwordx2 s[38:39], s[0:1], 8
  s_load_dwordx4 s[40:43], s[0:1], 32
  s_load_dwordx4 s[44:47], s[0:1], 16
  s_load_dwordx2 s[4:5], s[0:1], 96
  v_lshrrev_b32 v1, 6, v0
  s_nop 0
  v_readfirstlane_b32 s21, v1
  v_and_b32 v1, 63, v0
  v_lshlrev_b32 v2, 4, v1
  s_waitcnt lgkmcnt(0)
  s_mov_b32 s8, s4
  s_and_b32 s9, s5, 0xffff
  s_mov_b32 s10, 0x10000000
  s_mov_b32 s11, 0x20000
  s_mov_b32 s12, s40
  s_and_b32 s13, s41, 0xffff
  s_mov_b32 s14, 0x780000
  s_mov_b32 s15, 0x20000
  s_mov_b32 s16, s42
  s_and_b32 s17, s43, 0xffff
  s_mov_b32 s18, 0x780000
  s_mov_b32 s19, 0x20000
  v_mov_b32 v208, -1
  v_mov_b32 v209, -1
  v_mov_b32 v210, -1
  v_mov_b32 v211, -1
  s_lshl_b32 s28, s2, 2
  s_add_u32 s28, s28, s21
  s_add_u32 s29, s28, 0
  s_cmp_lt_u32 s29, 2560
  s_cbranch_scc0 f_1
  s_lshl_b32 s29, s29, 10
  s_add_u32 s29, s29, 0x400000
  buffer_store_dwordx4 v[208:211], v2, s[8:11], s29 offen
f_1:
  s_add_u32 s29, s28, 1024
  s_cmp_lt_u32 s29, 2560
  s_cbranch_scc0 f_2
  s_lshl_b32 s29, s29, 10
  s_add_u32 s29, s29, 0x400000
  buffer_store_dwordx4 v[208:211], v2, s[8:11], s29 offen
f_2:
  s_add_u32 s29, s28, 2048
  s_cmp_lt_u32 s29, 2560
  s_cbranch_scc0 f_3
  s_lshl_b32 s29, s29, 10
  s_add_u32 s29, s29, 0x400000
  buffer_store_dwordx4 v[208:211], v2, s[8:11], s29 offen
f_3:
  s_add_u32 s29, s28, 0
  s_cmp_lt_u32 s29, 1280
  s_cbranch_scc0 f_4
  s_lshl_b32 s29, s29, 10
  s_add_u32 s29, s29, 0x700000
  buffer_store_dwordx4 v[208:211], v2, s[8:11], s29 offen
f_4:
  s_add_u32 s29, s28, 1024
  s_cmp_lt_u32 s29, 1280
  s_cbranch_scc0 f_5
  s_lshl_b32 s29, s29, 10
  s_add_u32 s29, s29, 0x700000
  buffer_store_dwordx4 v[208:211], v2, s[8:11], s29 offen
f_5:
  s_add_u32 s29, s28, 0
  s_cmp_lt_u32 s29, 640
  s_cbranch_scc0 f_6
  s_lshl_b32 s29, s29, 10
  s_add_u32 s29, s29, 0xa00000
  buffer_store_dwordx4 v[208:211], v2, s[8:11], s29 offen
f_6:
  s_add_u32 s29, s28, 0
  s_cmp_lt_u32 s29, 5120
  s_cbranch_scc0 f_7
  s_lshl_b32 s29, s29, 10
  s_add_u32 s29, s29, 0xe00000
  buffer_store_dwordx4 v[208:211], v2, s[8:11], s29 offen
f_7:
  s_add_u32 s29, s28, 1024
  s_cmp_lt_u32 s29, 5120
  s_cbranch_scc0 f_8
  s_lshl_b32 s29, s29, 10
  s_add_u32 s29, s29, 0xe00000
  buffer_store_dwordx4 v[208:211], v2, s[8:11], s29 offen
f_8:
  s_add_u32 s29, s28, 2048
  s_cmp_lt_u32 s29, 5120
  s_cbranch_scc0 f_9
  s_lshl_b32 s29, s29, 10
  s_add_u32 s29, s29, 0xe00000
  buffer_store_dwordx4 v[208:211], v2, s[8:11], s29 offen
f_9:
  s_add_u32 s29, s28, 3072
  s_cmp_lt_u32 s29, 5120
  s_cbranch_scc0 f_10
  s_lshl_b32 s29, s29, 10
  s_add_u32 s29, s29, 0xe00000
  buffer_store_dwordx4 v[208:211], v2, s[8:11], s29 offen
f_10:
  s_add_u32 s29, s28, 4096
  s_cmp_lt_u32 s29, 5120
  s_cbranch_scc0 f_11
  s_lshl_b32 s29, s29, 10
  s_add_u32 s29, s29, 0xe00000
  buffer_store_dwordx4 v[208:211], v2, s[8:11], s29 offen
f_11:
  s_and_b32 s22, s2, 7
  s_lshl_b32 s22, s22, 2
  s_lshr_b32 s23, s2, 6
  s_add_u32 s22, s22, s23
  s_bfe_u32 s23, s2, 0x30003
  v_lshrrev_b32 v8, 3, v1
  v_bfe_u32 v9, v1, 1, 2
  v_and_b32 v10, 1, v1
  s_mul_i32 s24, s22, 245760
  s_mul_i32 s25, s23, 160
  s_add_u32 s24, s24, s25
  s_add_u32 s26, s21, 0
  s_cmp_lt_u32 s26, 30
  s_cbranch_scc0 wd_12
  s_lshl_b32 s27, s26, 3
  v_add_u32 v11, s27, v8
  v_mul_u32_u24 v12, 52429, v11
  v_lshrrev_b32 v12, 18, v12
  v_mul_u32_u24 v13, 5, v12
  v_sub_u32 v13, v11, v13
  v_lshlrev_b32 v12, 2, v12
  v_add_u32 v12, v12, v9
  v_mul_u32_u24 v12, 1280, v12
  v_lshlrev_b32 v13, 5, v13
  v_add_u32 v12, v12, v13
  v_lshlrev_b32 v13, 4, v10
  v_add_u32 v12, v12, v13
  s_lshl_b32 m0, s26, 10
  s_nop 0
  buffer_load_dwordx4 v12, s[16:19], s24 offen lds
wd_12:
  s_add_u32 s26, s21, 4
  s_cmp_lt_u32 s26, 30
  s_cbranch_scc0 wd_13
  s_lshl_b32 s27, s26, 3
  v_add_u32 v11, s27, v8
  v_mul_u32_u24 v12, 52429, v11
  v_lshrrev_b32 v12, 18, v12
  v_mul_u32_u24 v13, 5, v12
  v_sub_u32 v13, v11, v13
  v_lshlrev_b32 v12, 2, v12
  v_add_u32 v12, v12, v9
  v_mul_u32_u24 v12, 1280, v12
  v_lshlrev_b32 v13, 5, v13
  v_add_u32 v12, v12, v13
  v_lshlrev_b32 v13, 4, v10
  v_add_u32 v12, v12, v13
  s_lshl_b32 m0, s26, 10
  s_nop 0
  buffer_load_dwordx4 v12, s[16:19], s24 offen lds
wd_13:
  s_add_u32 s26, s21, 8
  s_cmp_lt_u32 s26, 30
  s_cbranch_scc0 wd_14
  s_lshl_b32 s27, s26, 3
  v_add_u32 v11, s27, v8
  v_mul_u32_u24 v12, 52429, v11
  v_lshrrev_b32 v12, 18, v12
  v_mul_u32_u24 v13, 5, v12
  v_sub_u32 v13, v11, v13
  v_lshlrev_b32 v12, 2, v12
  v_add_u32 v12, v12, v9
  v_mul_u32_u24 v12, 1280, v12
  v_lshlrev_b32 v13, 5, v13
  v_add_u32 v12, v12, v13
  v_lshlrev_b32 v13, 4, v10
  v_add_u32 v12, v12, v13
  s_lshl_b32 m0, s26, 10
  s_nop 0
  buffer_load_dwordx4 v12, s[16:19], s24 offen lds
wd_14:
  s_add_u32 s26, s21, 12
  s_cmp_lt_u32 s26, 30
  s_cbranch_scc0 wd_15
  s_lshl_b32 s27, s26, 3
  v_add_u32 v11, s27, v8
  v_mul_u32_u24 v12, 52429, v11
  v_lshrrev_b32 v12, 18, v12
  v_mul_u32_u24 v13, 5, v12
  v_sub_u32 v13, v11, v13
  v_lshlrev_b32 v12, 2, v12
  v_add_u32 v12, v12, v9
  v_mul_u32_u24 v12, 1280, v12
  v_lshlrev_b32 v13, 5, v13
  v_add_u32 v12, v12, v13
  v_lshlrev_b32 v13, 4, v10
  v_add_u32 v12, v12, v13
  s_lshl_b32 m0, s26, 10
  s_nop 0
  buffer_load_dwordx4 v12, s[16:19], s24 offen lds
wd_15:
  s_add_u32 s26, s21, 16
  s_cmp_lt_u32 s26, 30
  s_cbranch_scc0 wd_16
  s_lshl_b32 s27, s26, 3
  v_add_u32 v11, s27, v8
  v_mul_u32_u24 v12, 52429, v11
  v_lshrrev_b32 v12, 18, v12
  v_mul_u32_u24 v13, 5, v12
  v_sub_u32 v13, v11, v13
  v_lshlrev_b32 v12, 2, v12
  v_add_u32 v12, v12, v9
  v_mul_u32_u24 v12, 1280, v12
  v_lshlrev_b32 v13, 5, v13
  v_add_u32 v12, v12, v13
  v_lshlrev_b32 v13, 4, v10
  v_add_u32 v12, v12, v13
  s_lshl_b32 m0, s26, 10
  s_nop 0
  buffer_load_dwordx4 v12, s[16:19], s24 offen lds
wd_16:
  s_add_u32 s26, s21, 20
  s_cmp_lt_u32 s26, 30
  s_cbranch_scc0 wd_17
  s_lshl_b32 s27, s26, 3
  v_add_u32 v11, s27, v8
  v_mul_u32_u24 v12, 52429, v11
  v_lshrrev_b32 v12, 18, v12
  v_mul_u32_u24 v13, 5, v12
  v_sub_u32 v13, v11, v13
  v_lshlrev_b32 v12, 2, v12
  v_add_u32 v12, v12, v9
  v_mul_u32_u24 v12, 1280, v12
  v_lshlrev_b32 v13, 5, v13
  v_add_u32 v12, v12, v13
  v_lshlrev_b32 v13, 4, v10
  v_add_u32 v12, v12, v13
  s_lshl_b32 m0, s26, 10
  s_nop 0
  buffer_load_dwordx4 v12, s[16:19], s24 offen lds
wd_17:
  s_add_u32 s26, s21, 24
  s_cmp_lt_u32 s26, 30
  s_cbranch_scc0 wd_18
  s_lshl_b32 s27, s26, 3
  v_add_u32 v11, s27, v8
  v_mul_u32_u24 v12, 52429, v11
  v_lshrrev_b32 v12, 18, v12
  v_mul_u32_u24 v13, 5, v12
  v_sub_u32 v13, v11, v13
  v_lshlrev_b32 v12, 2, v12
  v_add_u32 v12, v12, v9
  v_mul_u32_u24 v12, 1280, v12
  v_lshlrev_b32 v13, 5, v13
  v_add_u32 v12, v12, v13
  v_lshlrev_b32 v13, 4, v10
  v_add_u32 v12, v12, v13
  s_lshl_b32 m0, s26, 10
  s_nop 0
  buffer_load_dwordx4 v12, s[16:19], s24 offen lds
wd_18:
  s_add_u32 s26, s21, 28
  s_cmp_lt_u32 s26, 30
  s_cbranch_scc0 wd_19
  s_lshl_b32 s27, s26, 3
  v_add_u32 v11, s27, v8
  v_mul_u32_u24 v12, 52429, v11
  v_lshrrev_b32 v12, 18, v12
  v_mul_u32_u24 v13, 5, v12
  v_sub_u32 v13, v11, v13
  v_lshlrev_b32 v12, 2, v12
  v_add_u32 v12, v12, v9
  v_mul_u32_u24 v12, 1280, v12
  v_lshlrev_b32 v13, 5, v13
  v_add_u32 v12, v12, v13
  v_lshlrev_b32 v13, 4, v10
  v_add_u32 v12, v12, v13
  s_lshl_b32 m0, s26, 10
  s_nop 0
  buffer_load_dwordx4 v12, s[16:19], s24 offen lds
wd_19:
  v_and_b32 v8, 15, v1
  v_lshrrev_b32 v9, 2, v8
  v_lshlrev_b32 v9, 3, v9
  v_and_b32 v10, 3, v8
  v_add_u32 v9, v9, v10
  v_mul_u32_u24 v9, 12288, v9
  v_lshrrev_b32 v10, 4, v1
  v_lshlrev_b32 v10, 4, v10
  v_add_u32 v9, v9, v10
  v_add_u32 v10, 49152, v9
  s_mul_i32 s24, s22, 384
  s_mul_i32 s25, s21, 1966080
  s_add_u32 s24, s24, s25
  s_add_u32 s27, s24, 0
  buffer_load_dwordx4 a[120:123], v9, s[12:15], s27 offen offset:0
  buffer_load_dwordx4 a[124:127], v9, s[12:15], s27 offen offset:64
  buffer_load_dwordx4 a[128:131], v9, s[12:15], s27 offen offset:128
  buffer_load_dwordx4 a[132:135], v9, s[12:15], s27 offen offset:192
  buffer_load_dwordx4 a[136:139], v9, s[12:15], s27 offen offset:256
  buffer_load_dwordx4 a[140:143], v9, s[12:15], s27 offen offset:320
  buffer_load_dwordx4 a[144:147], v10, s[12:15], s27 offen offset:0
  buffer_load_dwordx4 a[148:151], v10, s[12:15], s27 offen offset:64
  buffer_load_dwordx4 a[152:155], v10, s[12:15], s27 offen offset:128
  buffer_load_dwordx4 a[156:159], v10, s[12:15], s27 offen offset:192
  buffer_load_dwordx4 a[160:163], v10, s[12:15], s27 offen offset:256
  buffer_load_dwordx4 a[164:167], v10, s[12:15], s27 offen offset:320
  s_add_u32 s27, s24, 393216
  buffer_load_dwordx4 a[168:171], v9, s[12:15], s27 offen offset:0
  buffer_load_dwordx4 a[172:175], v9, s[12:15], s27 offen offset:64
  buffer_load_dwordx4 a[176:179], v9, s[12:15], s27 offen offset:128
  buffer_load_dwordx4 a[180:183], v9, s[12:15], s27 offen offset:192
  buffer_load_dwordx4 a[184:187], v9, s[12:15], s27 offen offset:256
  buffer_load_dwordx4 a[188:191], v9, s[12:15], s27 offen offset:320
  buffer_load_dwordx4 a[192:195], v10, s[12:15], s27 offen offset:0
  buffer_load_dwordx4 a[196:199], v10, s[12:15], s27 offen offset:64
  buffer_load_dwordx4 a[200:203], v10, s[12:15], s27 offen offset:128
  buffer_load_dwordx4 a[204:207], v10, s[12:15], s27 offen offset:192
  buffer_load_dwordx4 a[208:211], v10, s[12:15], s27 offen offset:256
  buffer_load_dwordx4 a[212:215], v10, s[12:15], s27 offen offset:320
  s_add_u32 s27, s24, 786432
  buffer_load_dwordx4 v[64:67], v9, s[12:15], s27 offen offset:0
  buffer_load_dwordx4 v[68:71], v9, s[12:15], s27 offen offset:64
  buffer_load_dwordx4 v[72:75], v9, s[12:15], s27 offen offset:128
  buffer_load_dwordx4 v[76:79], v9, s[12:15], s27 offen offset:192
  buffer_load_dwordx4 v[80:83], v9, s[12:15], s27 offen offset:256
  buffer_load_dwordx4 v[84:87], v9, s[12:15], s27 offen offset:320
  buffer_load_dwordx4 v[88:91], v10, s[12:15], s27 offen offset:0
  buffer_load_dwordx4 v[92:95], v10, s[12:15], s27 offen offset:64
  buffer_load_dwordx4 v[96:99], v10, s[12:15], s27 offen offset:128
  buffer_load_dwordx4 v[100:103], v10, s[12:15], s27 offen offset:192
  buffer_load_dwordx4 v[104:107], v10, s[12:15], s27 offen offset:256
  buffer_load_dwordx4 v[108:111], v10, s[12:15], s27 offen offset:320
  s_mul_i32 s26, s22, 40
  s_mul_i32 s27, s23, 5
  s_add_u32 s26, s26, s27
  s_mul_i32 s26, s26, 20
  s_mul_i32 s27, s21, 5
  s_add_u32 s26, s26, s27
  s_lshl_b32 s26, s26, 10
  s_add_u32 s26, s26, 0x2e00000
  v_lshrrev_b32 v8, 4, v1
  v_mul_u32_u24 v8, 1280, v8
  v_bfe_u32 v11, v1, 2, 2
  v_lshlrev_b32 v11, 5, v11
  v_add_u32 v8, v8, v11
  v_bfe_u32 v11, v1, 1, 1
  v_lshlrev_b32 v11, 4, v11
  v_add_u32 v8, v8, v11
  v_and_b32 v11, 1, v1
  v_lshlrev_b32 v11, 3, v11
  v_add_u32 v8, v8, v11
  s_waitcnt vmcnt(36)
  s_barrier
  ds_read_b64_tr_b16 a[0:1], v8 offset:0
  ds_read_b64_tr_b16 a[2:3], v8 offset:640
  ds_read_b64_tr_b16 a[4:5], v8 offset:128
  ds_read_b64_tr_b16 a[6:7], v8 offset:768
  ds_read_b64_tr_b16 a[8:9], v8 offset:256
  ds_read_b64_tr_b16 a[10:11], v8 offset:896
  ds_read_b64_tr_b16 a[12:13], v8 offset:384
  ds_read_b64_tr_b16 a[14:15], v8 offset:1024
  ds_read_b64_tr_b16 a[16:17], v8 offset:512
  ds_read_b64_tr_b16 a[18:19], v8 offset:1152
  ds_read_b64_tr_b16 a[20:21], v8 offset:5120
  ds_read_b64_tr_b16 a[22:23], v8 offset:5760
  s_waitcnt lgkmcnt(0)
  ds_read_b64_tr_b16 a[24:25], v8 offset:5248
  ds_read_b64_tr_b16 a[26:27], v8 offset:5888
  ds_read_b64_tr_b16 a[28:29], v8 offset:5376
  ds_read_b64_tr_b16 a[30:31], v8 offset:6016
  ds_read_b64_tr_b16 a[32:33], v8 offset:5504
  ds_read_b64_tr_b16 a[34:35], v8 offset:6144
  ds_read_b64_tr_b16 a[36:37], v8 offset:5632
  ds_read_b64_tr_b16 a[38:39], v8 offset:6272
  ds_read_b64_tr_b16 a[40:41], v8 offset:10240
  ds_read_b64_tr_b16 a[42:43], v8 offset:10880
  ds_read_b64_tr_b16 a[44:45], v8 offset:10368
  ds_read_b64_tr_b16 a[46:47], v8 offset:11008
  s_waitcnt lgkmcnt(0)
  ds_read_b64_tr_b16 a[48:49], v8 offset:10496
  ds_read_b64_tr_b16 a[50:51], v8 offset:11136
  ds_read_b64_tr_b16 a[52:53], v8 offset:10624
  ds_read_b64_tr_b16 a[54:55], v8 offset:11264
  ds_read_b64_tr_b16 a[56:57], v8 offset:10752
  ds_read_b64_tr_b16 a[58:59], v8 offset:11392
  ds_read_b64_tr_b16 a[60:61], v8 offset:15360
  ds_read_b64_tr_b16 a[62:63], v8 offset:16000
  ds_read_b64_tr_b16 a[64:65], v8 offset:15488
  ds_read_b64_tr_b16 a[66:67], v8 offset:16128
  ds_read_b64_tr_b16 a[68:69], v8 offset:15616
  ds_read_b64_tr_b16 a[70:71], v8 offset:16256
  s_waitcnt lgkmcnt(0)
  ds_read_b64_tr_b16 a[72:73], v8 offset:15744
  ds_read_b64_tr_b16 a[74:75], v8 offset:16384
  ds_read_b64_tr_b16 a[76:77], v8 offset:15872
  ds_read_b64_tr_b16 a[78:79], v8 offset:16512
  ds_read_b64_tr_b16 a[80:81], v8 offset:20480
  ds_read_b64_tr_b16 a[82:83], v8 offset:21120
  ds_read_b64_tr_b16 a[84:85], v8 offset:20608
  ds_read_b64_tr_b16 a[86:87], v8 offset:21248
  ds_read_b64_tr_b16 a[88:89], v8 offset:20736
  ds_read_b64_tr_b16 a[90:91], v8 offset:21376
  ds_read_b64_tr_b16 a[92:93], v8 offset:20864
  ds_read_b64_tr_b16 a[94:95], v8 offset:21504
  s_waitcnt lgkmcnt(0)
  ds_read_b64_tr_b16 a[96:97], v8 offset:20992
  ds_read_b64_tr_b16 a[98:99], v8 offset:21632
  ds_read_b64_tr_b16 a[100:101], v8 offset:25600
  ds_read_b64_tr_b16 a[102:103], v8 offset:26240
  ds_read_b64_tr_b16 a[104:105], v8 offset:25728
  ds_read_b64_tr_b16 a[106:107], v8 offset:26368
  ds_read_b64_tr_b16 a[108:109], v8 offset:25856
  ds_read_b64_tr_b16 a[110:111], v8 offset:26496
  ds_read_b64_tr_b16 a[112:113], v8 offset:25984
  ds_read_b64_tr_b16 a[114:115], v8 offset:26624
  ds_read_b64_tr_b16 a[116:117], v8 offset:26112
  ds_read_b64_tr_b16 a[118:119], v8 offset:26752
  s_waitcnt lgkmcnt(0)
  s_waitcnt lgkmcnt(0)
  s_add_u32 s27, s24, 1179648
  buffer_load_dwordx4 v[112:115], v9, s[12:15], s27 offen offset:0
  buffer_load_dwordx4 v[116:119], v9, s[12:15], s27 offen offset:64
  buffer_load_dwordx4 v[120:123], v9, s[12:15], s27 offen offset:128
  buffer_load_dwordx4 v[124:127], v9, s[12:15], s27 offen offset:192
  buffer_load_dwordx4 v[128:131], v9, s[12:15], s27 offen offset:256
  buffer_load_dwordx4 v[132:135], v9, s[12:15], s27 offen offset:320
  buffer_load_dwordx4 v[136:139], v10, s[12:15], s27 offen offset:0
  buffer_load_dwordx4 v[140:143], v10, s[12:15], s27 offen offset:64
  buffer_load_dwordx4 v[144:147], v10, s[12:15], s27 offen offset:128
  buffer_load_dwordx4 v[148:151], v10, s[12:15], s27 offen offset:192
  buffer_load_dwordx4 v[152:155], v10, s[12:15], s27 offen offset:256
  buffer_load_dwordx4 v[156:159], v10, s[12:15], s27 offen offset:320
  s_add_u32 s27, s24, 1572864
  buffer_load_dwordx4 v[160:163], v9, s[12:15], s27 offen offset:0
  buffer_load_dwordx4 v[164:167], v9, s[12:15], s27 offen offset:64
  buffer_load_dwordx4 v[168:171], v9, s[12:15], s27 offen offset:128
  buffer_load_dwordx4 v[172:175], v9, s[12:15], s27 offen offset:192
  buffer_load_dwordx4 v[176:179], v9, s[12:15], s27 offen offset:256
  buffer_load_dwordx4 v[180:183], v9, s[12:15], s27 offen offset:320
  buffer_load_dwordx4 v[184:187], v10, s[12:15], s27 offen offset:0
  buffer_load_dwordx4 v[188:191], v10, s[12:15], s27 offen offset:64
  buffer_load_dwordx4 v[192:195], v10, s[12:15], s27 offen offset:128
  buffer_load_dwordx4 v[196:199], v10, s[12:15], s27 offen offset:192
  buffer_load_dwordx4 v[200:203], v10, s[12:15], s27 offen offset:256
  buffer_load_dwordx4 v[204:207], v10, s[12:15], s27 offen offset:320
  s_waitcnt vmcnt(48)
  v_mfma_f32_16x16x32_bf16 v[16:19], a[120:123], a[0:3], 0
  v_mfma_f32_16x16x32_bf16 v[20:23], a[120:123], a[4:7], 0
  v_mfma_f32_16x16x32_bf16 v[24:27], a[120:123], a[8:11], 0
  v_mfma_f32_16x16x32_bf16 v[28:31], a[120:123], a[12:15], 0
  v_mfma_f32_16x16x32_bf16 v[32:35], a[120:123], a[16:19], 0
  v_mfma_f32_16x16x32_bf16 v[36:39], a[144:147], a[0:3], 0
  v_mfma_f32_16x16x32_bf16 v[40:43], a[144:147], a[4:7], 0
  v_mfma_f32_16x16x32_bf16 v[44:47], a[144:147], a[8:11], 0
  v_mfma_f32_16x16x32_bf16 v[48:51], a[144:147], a[12:15], 0
  v_mfma_f32_16x16x32_bf16 v[52:55], a[144:147], a[16:19], 0
  v_mfma_f32_16x16x32_bf16 v[16:19], a[124:127], a[20:23], v[16:19]
  v_mfma_f32_16x16x32_bf16 v[20:23], a[124:127], a[24:27], v[20:23]
  v_mfma_f32_16x16x32_bf16 v[24:27], a[124:127], a[28:31], v[24:27]
  v_mfma_f32_16x16x32_bf16 v[28:31], a[124:127], a[32:35], v[28:31]
  v_mfma_f32_16x16x32_bf16 v[32:35], a[124:127], a[36:39], v[32:35]
  v_mfma_f32_16x16x32_bf16 v[36:39], a[148:151], a[20:23], v[36:39]
  v_mfma_f32_16x16x32_bf16 v[40:43], a[148:151], a[24:27], v[40:43]
  v_mfma_f32_16x16x32_bf16 v[44:47], a[148:151], a[28:31], v[44:47]
  v_mfma_f32_16x16x32_bf16 v[48:51], a[148:151], a[32:35], v[48:51]
  v_mfma_f32_16x16x32_bf16 v[52:55], a[148:151], a[36:39], v[52:55]
  v_mfma_f32_16x16x32_bf16 v[16:19], a[128:131], a[40:43], v[16:19]
  v_mfma_f32_16x16x32_bf16 v[20:23], a[128:131], a[44:47], v[20:23]
  v_mfma_f32_16x16x32_bf16 v[24:27], a[128:131], a[48:51], v[24:27]
  v_mfma_f32_16x16x32_bf16 v[28:31], a[128:131], a[52:55], v[28:31]
  v_mfma_f32_16x16x32_bf16 v[32:35], a[128:131], a[56:59], v[32:35]
  v_mfma_f32_16x16x32_bf16 v[36:39], a[152:155], a[40:43], v[36:39]
  v_mfma_f32_16x16x32_bf16 v[40:43], a[152:155], a[44:47], v[40:43]
  v_mfma_f32_16x16x32_bf16 v[44:47], a[152:155], a[48:51], v[44:47]
  v_mfma_f32_16x16x32_bf16 v[48:51], a[152:155], a[52:55], v[48:51]
  v_mfma_f32_16x16x32_bf16 v[52:55], a[152:155], a[56:59], v[52:55]
  v_mfma_f32_16x16x32_bf16 v[16:19], a[132:135], a[60:63], v[16:19]
  v_mfma_f32_16x16x32_bf16 v[20:23], a[132:135], a[64:67], v[20:23]
  v_mfma_f32_16x16x32_bf16 v[24:27], a[132:135], a[68:71], v[24:27]
  v_mfma_f32_16x16x32_bf16 v[28:31], a[132:135], a[72:75], v[28:31]
  v_mfma_f32_16x16x32_bf16 v[32:35], a[132:135], a[76:79], v[32:35]
  v_mfma_f32_16x16x32_bf16 v[36:39], a[156:159], a[60:63], v[36:39]
  v_mfma_f32_16x16x32_bf16 v[40:43], a[156:159], a[64:67], v[40:43]
  v_mfma_f32_16x16x32_bf16 v[44:47], a[156:159], a[68:71], v[44:47]
  v_mfma_f32_16x16x32_bf16 v[48:51], a[156:159], a[72:75], v[48:51]
  v_mfma_f32_16x16x32_bf16 v[52:55], a[156:159], a[76:79], v[52:55]
  v_mfma_f32_16x16x32_bf16 v[16:19], a[136:139], a[80:83], v[16:19]
  v_mfma_f32_16x16x32_bf16 v[20:23], a[136:139], a[84:87], v[20:23]
  v_mfma_f32_16x16x32_bf16 v[24:27], a[136:139], a[88:91], v[24:27]
  v_mfma_f32_16x16x32_bf16 v[28:31], a[136:139], a[92:95], v[28:31]
  v_mfma_f32_16x16x32_bf16 v[32:35], a[136:139], a[96:99], v[32:35]
  v_mfma_f32_16x16x32_bf16 v[36:39], a[160:163], a[80:83], v[36:39]
  v_mfma_f32_16x16x32_bf16 v[40:43], a[160:163], a[84:87], v[40:43]
  v_mfma_f32_16x16x32_bf16 v[44:47], a[160:163], a[88:91], v[44:47]
  v_mfma_f32_16x16x32_bf16 v[48:51], a[160:163], a[92:95], v[48:51]
  v_mfma_f32_16x16x32_bf16 v[52:55], a[160:163], a[96:99], v[52:55]
  v_mfma_f32_16x16x32_bf16 v[16:19], a[140:143], a[100:103], v[16:19]
  v_mfma_f32_16x16x32_bf16 v[20:23], a[140:143], a[104:107], v[20:23]
  v_mfma_f32_16x16x32_bf16 v[24:27], a[140:143], a[108:111], v[24:27]
  v_mfma_f32_16x16x32_bf16 v[28:31], a[140:143], a[112:115], v[28:31]
  v_mfma_f32_16x16x32_bf16 v[32:35], a[140:143], a[116:119], v[32:35]
  v_mfma_f32_16x16x32_bf16 v[36:39], a[164:167], a[100:103], v[36:39]
  v_mfma_f32_16x16x32_bf16 v[40:43], a[164:167], a[104:107], v[40:43]
  v_mfma_f32_16x16x32_bf16 v[44:47], a[164:167], a[108:111], v[44:47]
  v_mfma_f32_16x16x32_bf16 v[48:51], a[164:167], a[112:115], v[48:51]
  v_mfma_f32_16x16x32_bf16 v[52:55], a[164:167], a[116:119], v[52:55]
  s_nop 7
  v_cvt_pk_bf16_f32 v212, v16, v17
  v_cvt_pk_bf16_f32 v213, v18, v19
  v_cvt_pk_bf16_f32 v214, v36, v37
  v_cvt_pk_bf16_f32 v215, v38, v39
  s_add_u32 s27, s26, 0
  buffer_store_dwordx4 v[212:215], v2, s[8:11], s27 offen
  v_cvt_pk_bf16_f32 v216, v20, v21
  v_cvt_pk_bf16_f32 v217, v22, v23
  v_cvt_pk_bf16_f32 v218, v40, v41
  v_cvt_pk_bf16_f32 v219, v42, v43
  s_add_u32 s27, s26, 20480
  buffer_store_dwordx4 v[216:219], v2, s[8:11], s27 offen
  v_cvt_pk_bf16_f32 v220, v24, v25
  v_cvt_pk_bf16_f32 v221, v26, v27
  v_cvt_pk_bf16_f32 v222, v44, v45
  v_cvt_pk_bf16_f32 v223, v46, v47
  s_add_u32 s27, s26, 40960
  buffer_store_dwordx4 v[220:223], v2, s[8:11], s27 offen
  v_cvt_pk_bf16_f32 v224, v28, v29
  v_cvt_pk_bf16_f32 v225, v30, v31
  v_cvt_pk_bf16_f32 v226, v48, v49
  v_cvt_pk_bf16_f32 v227, v50, v51
  s_add_u32 s27, s26, 61440
  buffer_store_dwordx4 v[224:227], v2, s[8:11], s27 offen
  v_cvt_pk_bf16_f32 v212, v32, v33
  v_cvt_pk_bf16_f32 v213, v34, v35
  v_cvt_pk_bf16_f32 v214, v52, v53
  v_cvt_pk_bf16_f32 v215, v54, v55
  s_add_u32 s27, s26, 81920
  buffer_store_dwordx4 v[212:215], v2, s[8:11], s27 offen
  s_waitcnt vmcnt(41)
  v_mfma_f32_16x16x32_bf16 v[16:19], a[168:171], a[0:3], 0
  v_mfma_f32_16x16x32_bf16 v[20:23], a[168:171], a[4:7], 0
  v_mfma_f32_16x16x32_bf16 v[24:27], a[168:171], a[8:11], 0
  v_mfma_f32_16x16x32_bf16 v[28:31], a[168:171], a[12:15], 0
  v_mfma_f32_16x16x32_bf16 v[32:35], a[168:171], a[16:19], 0
  v_mfma_f32_16x16x32_bf16 v[36:39], a[192:195], a[0:3], 0
  v_mfma_f32_16x16x32_bf16 v[40:43], a[192:195], a[4:7], 0
  v_mfma_f32_16x16x32_bf16 v[44:47], a[192:195], a[8:11], 0
  v_mfma_f32_16x16x32_bf16 v[48:51], a[192:195], a[12:15], 0
  v_mfma_f32_16x16x32_bf16 v[52:55], a[192:195], a[16:19], 0
  v_mfma_f32_16x16x32_bf16 v[16:19], a[172:175], a[20:23], v[16:19]
  v_mfma_f32_16x16x32_bf16 v[20:23], a[172:175], a[24:27], v[20:23]
  v_mfma_f32_16x16x32_bf16 v[24:27], a[172:175], a[28:31], v[24:27]
  v_mfma_f32_16x16x32_bf16 v[28:31], a[172:175], a[32:35], v[28:31]
  v_mfma_f32_16x16x32_bf16 v[32:35], a[172:175], a[36:39], v[32:35]
  v_mfma_f32_16x16x32_bf16 v[36:39], a[196:199], a[20:23], v[36:39]
  v_mfma_f32_16x16x32_bf16 v[40:43], a[196:199], a[24:27], v[40:43]
  v_mfma_f32_16x16x32_bf16 v[44:47], a[196:199], a[28:31], v[44:47]
  v_mfma_f32_16x16x32_bf16 v[48:51], a[196:199], a[32:35], v[48:51]
  v_mfma_f32_16x16x32_bf16 v[52:55], a[196:199], a[36:39], v[52:55]
  v_mfma_f32_16x16x32_bf16 v[16:19], a[176:179], a[40:43], v[16:19]
  v_mfma_f32_16x16x32_bf16 v[20:23], a[176:179], a[44:47], v[20:23]
  v_mfma_f32_16x16x32_bf16 v[24:27], a[176:179], a[48:51], v[24:27]
  v_mfma_f32_16x16x32_bf16 v[28:31], a[176:179], a[52:55], v[28:31]
  v_mfma_f32_16x16x32_bf16 v[32:35], a[176:179], a[56:59], v[32:35]
  v_mfma_f32_16x16x32_bf16 v[36:39], a[200:203], a[40:43], v[36:39]
  v_mfma_f32_16x16x32_bf16 v[40:43], a[200:203], a[44:47], v[40:43]
  v_mfma_f32_16x16x32_bf16 v[44:47], a[200:203], a[48:51], v[44:47]
  v_mfma_f32_16x16x32_bf16 v[48:51], a[200:203], a[52:55], v[48:51]
  v_mfma_f32_16x16x32_bf16 v[52:55], a[200:203], a[56:59], v[52:55]
  v_mfma_f32_16x16x32_bf16 v[16:19], a[180:183], a[60:63], v[16:19]
  v_mfma_f32_16x16x32_bf16 v[20:23], a[180:183], a[64:67], v[20:23]
  v_mfma_f32_16x16x32_bf16 v[24:27], a[180:183], a[68:71], v[24:27]
  v_mfma_f32_16x16x32_bf16 v[28:31], a[180:183], a[72:75], v[28:31]
  v_mfma_f32_16x16x32_bf16 v[32:35], a[180:183], a[76:79], v[32:35]
  v_mfma_f32_16x16x32_bf16 v[36:39], a[204:207], a[60:63], v[36:39]
  v_mfma_f32_16x16x32_bf16 v[40:43], a[204:207], a[64:67], v[40:43]
  v_mfma_f32_16x16x32_bf16 v[44:47], a[204:207], a[68:71], v[44:47]
  v_mfma_f32_16x16x32_bf16 v[48:51], a[204:207], a[72:75], v[48:51]
  v_mfma_f32_16x16x32_bf16 v[52:55], a[204:207], a[76:79], v[52:55]
  v_mfma_f32_16x16x32_bf16 v[16:19], a[184:187], a[80:83], v[16:19]
  v_mfma_f32_16x16x32_bf16 v[20:23], a[184:187], a[84:87], v[20:23]
  v_mfma_f32_16x16x32_bf16 v[24:27], a[184:187], a[88:91], v[24:27]
  v_mfma_f32_16x16x32_bf16 v[28:31], a[184:187], a[92:95], v[28:31]
  v_mfma_f32_16x16x32_bf16 v[32:35], a[184:187], a[96:99], v[32:35]
  v_mfma_f32_16x16x32_bf16 v[36:39], a[208:211], a[80:83], v[36:39]
  v_mfma_f32_16x16x32_bf16 v[40:43], a[208:211], a[84:87], v[40:43]
  v_mfma_f32_16x16x32_bf16 v[44:47], a[208:211], a[88:91], v[44:47]
  v_mfma_f32_16x16x32_bf16 v[48:51], a[208:211], a[92:95], v[48:51]
  v_mfma_f32_16x16x32_bf16 v[52:55], a[208:211], a[96:99], v[52:55]
  v_mfma_f32_16x16x32_bf16 v[16:19], a[188:191], a[100:103], v[16:19]
  v_mfma_f32_16x16x32_bf16 v[20:23], a[188:191], a[104:107], v[20:23]
  v_mfma_f32_16x16x32_bf16 v[24:27], a[188:191], a[108:111], v[24:27]
  v_mfma_f32_16x16x32_bf16 v[28:31], a[188:191], a[112:115], v[28:31]
  v_mfma_f32_16x16x32_bf16 v[32:35], a[188:191], a[116:119], v[32:35]
  v_mfma_f32_16x16x32_bf16 v[36:39], a[212:215], a[100:103], v[36:39]
  v_mfma_f32_16x16x32_bf16 v[40:43], a[212:215], a[104:107], v[40:43]
  v_mfma_f32_16x16x32_bf16 v[44:47], a[212:215], a[108:111], v[44:47]
  v_mfma_f32_16x16x32_bf16 v[48:51], a[212:215], a[112:115], v[48:51]
  v_mfma_f32_16x16x32_bf16 v[52:55], a[212:215], a[116:119], v[52:55]
  s_nop 7
  v_cvt_pk_bf16_f32 v212, v16, v17
  v_cvt_pk_bf16_f32 v213, v18, v19
  v_cvt_pk_bf16_f32 v214, v36, v37
  v_cvt_pk_bf16_f32 v215, v38, v39
  s_add_u32 s27, s26, 1024
  buffer_store_dwordx4 v[212:215], v2, s[8:11], s27 offen
  v_cvt_pk_bf16_f32 v216, v20, v21
  v_cvt_pk_bf16_f32 v217, v22, v23
  v_cvt_pk_bf16_f32 v218, v40, v41
  v_cvt_pk_bf16_f32 v219, v42, v43
  s_add_u32 s27, s26, 21504
  buffer_store_dwordx4 v[216:219], v2, s[8:11], s27 offen
  v_cvt_pk_bf16_f32 v220, v24, v25
  v_cvt_pk_bf16_f32 v221, v26, v27
  v_cvt_pk_bf16_f32 v222, v44, v45
  v_cvt_pk_bf16_f32 v223, v46, v47
  s_add_u32 s27, s26, 41984
  buffer_store_dwordx4 v[220:223], v2, s[8:11], s27 offen
  v_cvt_pk_bf16_f32 v224, v28, v29
  v_cvt_pk_bf16_f32 v225, v30, v31
  v_cvt_pk_bf16_f32 v226, v48, v49
  v_cvt_pk_bf16_f32 v227, v50, v51
  s_add_u32 s27, s26, 62464
  buffer_store_dwordx4 v[224:227], v2, s[8:11], s27 offen
  v_cvt_pk_bf16_f32 v212, v32, v33
  v_cvt_pk_bf16_f32 v213, v34, v35
  v_cvt_pk_bf16_f32 v214, v52, v53
  v_cvt_pk_bf16_f32 v215, v54, v55
  s_add_u32 s27, s26, 82944
  buffer_store_dwordx4 v[212:215], v2, s[8:11], s27 offen
  s_waitcnt vmcnt(34)
  v_mfma_f32_16x16x32_bf16 v[16:19], v[64:67], a[0:3], 0
  v_mfma_f32_16x16x32_bf16 v[20:23], v[64:67], a[4:7], 0
  v_mfma_f32_16x16x32_bf16 v[24:27], v[64:67], a[8:11], 0
  v_mfma_f32_16x16x32_bf16 v[28:31], v[64:67], a[12:15], 0
  v_mfma_f32_16x16x32_bf16 v[32:35], v[64:67], a[16:19], 0
  v_mfma_f32_16x16x32_bf16 v[36:39], v[88:91], a[0:3], 0
  v_mfma_f32_16x16x32_bf16 v[40:43], v[88:91], a[4:7], 0
  v_mfma_f32_16x16x32_bf16 v[44:47], v[88:91], a[8:11], 0
  v_mfma_f32_16x16x32_bf16 v[48:51], v[88:91], a[12:15], 0
  v_mfma_f32_16x16x32_bf16 v[52:55], v[88:91], a[16:19], 0
  v_mfma_f32_16x16x32_bf16 v[16:19], v[68:71], a[20:23], v[16:19]
  v_mfma_f32_16x16x32_bf16 v[20:23], v[68:71], a[24:27], v[20:23]
  v_mfma_f32_16x16x32_bf16 v[24:27], v[68:71], a[28:31], v[24:27]
  v_mfma_f32_16x16x32_bf16 v[28:31], v[68:71], a[32:35], v[28:31]
  v_mfma_f32_16x16x32_bf16 v[32:35], v[68:71], a[36:39], v[32:35]
  v_mfma_f32_16x16x32_bf16 v[36:39], v[92:95], a[20:23], v[36:39]
  v_mfma_f32_16x16x32_bf16 v[40:43], v[92:95], a[24:27], v[40:43]
  v_mfma_f32_16x16x32_bf16 v[44:47], v[92:95], a[28:31], v[44:47]
  v_mfma_f32_16x16x32_bf16 v[48:51], v[92:95], a[32:35], v[48:51]
  v_mfma_f32_16x16x32_bf16 v[52:55], v[92:95], a[36:39], v[52:55]
  v_mfma_f32_16x16x32_bf16 v[16:19], v[72:75], a[40:43], v[16:19]
  v_mfma_f32_16x16x32_bf16 v[20:23], v[72:75], a[44:47], v[20:23]
  v_mfma_f32_16x16x32_bf16 v[24:27], v[72:75], a[48:51], v[24:27]
  v_mfma_f32_16x16x32_bf16 v[28:31], v[72:75], a[52:55], v[28:31]
  v_mfma_f32_16x16x32_bf16 v[32:35], v[72:75], a[56:59], v[32:35]
  v_mfma_f32_16x16x32_bf16 v[36:39], v[96:99], a[40:43], v[36:39]
  v_mfma_f32_16x16x32_bf16 v[40:43], v[96:99], a[44:47], v[40:43]
  v_mfma_f32_16x16x32_bf16 v[44:47], v[96:99], a[48:51], v[44:47]
  v_mfma_f32_16x16x32_bf16 v[48:51], v[96:99], a[52:55], v[48:51]
  v_mfma_f32_16x16x32_bf16 v[52:55], v[96:99], a[56:59], v[52:55]
  v_mfma_f32_16x16x32_bf16 v[16:19], v[76:79], a[60:63], v[16:19]
  v_mfma_f32_16x16x32_bf16 v[20:23], v[76:79], a[64:67], v[20:23]
  v_mfma_f32_16x16x32_bf16 v[24:27], v[76:79], a[68:71], v[24:27]
  v_mfma_f32_16x16x32_bf16 v[28:31], v[76:79], a[72:75], v[28:31]
  v_mfma_f32_16x16x32_bf16 v[32:35], v[76:79], a[76:79], v[32:35]
  v_mfma_f32_16x16x32_bf16 v[36:39], v[100:103], a[60:63], v[36:39]
  v_mfma_f32_16x16x32_bf16 v[40:43], v[100:103], a[64:67], v[40:43]
  v_mfma_f32_16x16x32_bf16 v[44:47], v[100:103], a[68:71], v[44:47]
  v_mfma_f32_16x16x32_bf16 v[48:51], v[100:103], a[72:75], v[48:51]
  v_mfma_f32_16x16x32_bf16 v[52:55], v[100:103], a[76:79], v[52:55]
  v_mfma_f32_16x16x32_bf16 v[16:19], v[80:83], a[80:83], v[16:19]
  v_mfma_f32_16x16x32_bf16 v[20:23], v[80:83], a[84:87], v[20:23]
  v_mfma_f32_16x16x32_bf16 v[24:27], v[80:83], a[88:91], v[24:27]
  v_mfma_f32_16x16x32_bf16 v[28:31], v[80:83], a[92:95], v[28:31]
  v_mfma_f32_16x16x32_bf16 v[32:35], v[80:83], a[96:99], v[32:35]
  v_mfma_f32_16x16x32_bf16 v[36:39], v[104:107], a[80:83], v[36:39]
  v_mfma_f32_16x16x32_bf16 v[40:43], v[104:107], a[84:87], v[40:43]
  v_mfma_f32_16x16x32_bf16 v[44:47], v[104:107], a[88:91], v[44:47]
  v_mfma_f32_16x16x32_bf16 v[48:51], v[104:107], a[92:95], v[48:51]
  v_mfma_f32_16x16x32_bf16 v[52:55], v[104:107], a[96:99], v[52:55]
  v_mfma_f32_16x16x32_bf16 v[16:19], v[84:87], a[100:103], v[16:19]
  v_mfma_f32_16x16x32_bf16 v[20:23], v[84:87], a[104:107], v[20:23]
  v_mfma_f32_16x16x32_bf16 v[24:27], v[84:87], a[108:111], v[24:27]
  v_mfma_f32_16x16x32_bf16 v[28:31], v[84:87], a[112:115], v[28:31]
  v_mfma_f32_16x16x32_bf16 v[32:35], v[84:87], a[116:119], v[32:35]
  v_mfma_f32_16x16x32_bf16 v[36:39], v[108:111], a[100:103], v[36:39]
  v_mfma_f32_16x16x32_bf16 v[40:43], v[108:111], a[104:107], v[40:43]
  v_mfma_f32_16x16x32_bf16 v[44:47], v[108:111], a[108:111], v[44:47]
  v_mfma_f32_16x16x32_bf16 v[48:51], v[108:111], a[112:115], v[48:51]
  v_mfma_f32_16x16x32_bf16 v[52:55], v[108:111], a[116:119], v[52:55]
  s_nop 7
  v_cvt_pk_bf16_f32 v212, v16, v17
  v_cvt_pk_bf16_f32 v213, v18, v19
  v_cvt_pk_bf16_f32 v214, v36, v37
  v_cvt_pk_bf16_f32 v215, v38, v39
  s_add_u32 s27, s26, 2048
  buffer_store_dwordx4 v[212:215], v2, s[8:11], s27 offen
  v_cvt_pk_bf16_f32 v216, v20, v21
  v_cvt_pk_bf16_f32 v217, v22, v23
  v_cvt_pk_bf16_f32 v218, v40, v41
  v_cvt_pk_bf16_f32 v219, v42, v43
  s_add_u32 s27, s26, 22528
  buffer_store_dwordx4 v[216:219], v2, s[8:11], s27 offen
  v_cvt_pk_bf16_f32 v220, v24, v25
  v_cvt_pk_bf16_f32 v221, v26, v27
  v_cvt_pk_bf16_f32 v222, v44, v45
  v_cvt_pk_bf16_f32 v223, v46, v47
  s_add_u32 s27, s26, 43008
  buffer_store_dwordx4 v[220:223], v2, s[8:11], s27 offen
  v_cvt_pk_bf16_f32 v224, v28, v29
  v_cvt_pk_bf16_f32 v225, v30, v31
  v_cvt_pk_bf16_f32 v226, v48, v49
  v_cvt_pk_bf16_f32 v227, v50, v51
  s_add_u32 s27, s26, 63488
  buffer_store_dwordx4 v[224:227], v2, s[8:11], s27 offen
  v_cvt_pk_bf16_f32 v212, v32, v33
  v_cvt_pk_bf16_f32 v213, v34, v35
  v_cvt_pk_bf16_f32 v214, v52, v53
  v_cvt_pk_bf16_f32 v215, v54, v55
  s_add_u32 s27, s26, 83968
  buffer_store_dwordx4 v[212:215], v2, s[8:11], s27 offen
  s_waitcnt vmcnt(27)
  v_mfma_f32_16x16x32_bf16 v[16:19], v[112:115], a[0:3], 0
  v_mfma_f32_16x16x32_bf16 v[20:23], v[112:115], a[4:7], 0
  v_mfma_f32_16x16x32_bf16 v[24:27], v[112:115], a[8:11], 0
  v_mfma_f32_16x16x32_bf16 v[28:31], v[112:115], a[12:15], 0
  v_mfma_f32_16x16x32_bf16 v[32:35], v[112:115], a[16:19], 0
  v_mfma_f32_16x16x32_bf16 v[36:39], v[136:139], a[0:3], 0
  v_mfma_f32_16x16x32_bf16 v[40:43], v[136:139], a[4:7], 0
  v_mfma_f32_16x16x32_bf16 v[44:47], v[136:139], a[8:11], 0
  v_mfma_f32_16x16x32_bf16 v[48:51], v[136:139], a[12:15], 0
  v_mfma_f32_16x16x32_bf16 v[52:55], v[136:139], a[16:19], 0
  v_mfma_f32_16x16x32_bf16 v[16:19], v[116:119], a[20:23], v[16:19]
  v_mfma_f32_16x16x32_bf16 v[20:23], v[116:119], a[24:27], v[20:23]
  v_mfma_f32_16x16x32_bf16 v[24:27], v[116:119], a[28:31], v[24:27]
  v_mfma_f32_16x16x32_bf16 v[28:31], v[116:119], a[32:35], v[28:31]
  v_mfma_f32_16x16x32_bf16 v[32:35], v[116:119], a[36:39], v[32:35]
  v_mfma_f32_16x16x32_bf16 v[36:39], v[140:143], a[20:23], v[36:39]
  v_mfma_f32_16x16x32_bf16 v[40:43], v[140:143], a[24:27], v[40:43]
  v_mfma_f32_16x16x32_bf16 v[44:47], v[140:143], a[28:31], v[44:47]
  v_mfma_f32_16x16x32_bf16 v[48:51], v[140:143], a[32:35], v[48:51]
  v_mfma_f32_16x16x32_bf16 v[52:55], v[140:143], a[36:39], v[52:55]
  v_mfma_f32_16x16x32_bf16 v[16:19], v[120:123], a[40:43], v[16:19]
  v_mfma_f32_16x16x32_bf16 v[20:23], v[120:123], a[44:47], v[20:23]
  v_mfma_f32_16x16x32_bf16 v[24:27], v[120:123], a[48:51], v[24:27]
  v_mfma_f32_16x16x32_bf16 v[28:31], v[120:123], a[52:55], v[28:31]
  v_mfma_f32_16x16x32_bf16 v[32:35], v[120:123], a[56:59], v[32:35]
  v_mfma_f32_16x16x32_bf16 v[36:39], v[144:147], a[40:43], v[36:39]
  v_mfma_f32_16x16x32_bf16 v[40:43], v[144:147], a[44:47], v[40:43]
  v_mfma_f32_16x16x32_bf16 v[44:47], v[144:147], a[48:51], v[44:47]
  v_mfma_f32_16x16x32_bf16 v[48:51], v[144:147], a[52:55], v[48:51]
  v_mfma_f32_16x16x32_bf16 v[52:55], v[144:147], a[56:59], v[52:55]
  v_mfma_f32_16x16x32_bf16 v[16:19], v[124:127], a[60:63], v[16:19]
  v_mfma_f32_16x16x32_bf16 v[20:23], v[124:127], a[64:67], v[20:23]
  v_mfma_f32_16x16x32_bf16 v[24:27], v[124:127], a[68:71], v[24:27]
  v_mfma_f32_16x16x32_bf16 v[28:31], v[124:127], a[72:75], v[28:31]
  v_mfma_f32_16x16x32_bf16 v[32:35], v[124:127], a[76:79], v[32:35]
  v_mfma_f32_16x16x32_bf16 v[36:39], v[148:151], a[60:63], v[36:39]
  v_mfma_f32_16x16x32_bf16 v[40:43], v[148:151], a[64:67], v[40:43]
  v_mfma_f32_16x16x32_bf16 v[44:47], v[148:151], a[68:71], v[44:47]
  v_mfma_f32_16x16x32_bf16 v[48:51], v[148:151], a[72:75], v[48:51]
  v_mfma_f32_16x16x32_bf16 v[52:55], v[148:151], a[76:79], v[52:55]
  v_mfma_f32_16x16x32_bf16 v[16:19], v[128:131], a[80:83], v[16:19]
  v_mfma_f32_16x16x32_bf16 v[20:23], v[128:131], a[84:87], v[20:23]
  v_mfma_f32_16x16x32_bf16 v[24:27], v[128:131], a[88:91], v[24:27]
  v_mfma_f32_16x16x32_bf16 v[28:31], v[128:131], a[92:95], v[28:31]
  v_mfma_f32_16x16x32_bf16 v[32:35], v[128:131], a[96:99], v[32:35]
  v_mfma_f32_16x16x32_bf16 v[36:39], v[152:155], a[80:83], v[36:39]
  v_mfma_f32_16x16x32_bf16 v[40:43], v[152:155], a[84:87], v[40:43]
  v_mfma_f32_16x16x32_bf16 v[44:47], v[152:155], a[88:91], v[44:47]
  v_mfma_f32_16x16x32_bf16 v[48:51], v[152:155], a[92:95], v[48:51]
  v_mfma_f32_16x16x32_bf16 v[52:55], v[152:155], a[96:99], v[52:55]
  v_mfma_f32_16x16x32_bf16 v[16:19], v[132:135], a[100:103], v[16:19]
  v_mfma_f32_16x16x32_bf16 v[20:23], v[132:135], a[104:107], v[20:23]
  v_mfma_f32_16x16x32_bf16 v[24:27], v[132:135], a[108:111], v[24:27]
  v_mfma_f32_16x16x32_bf16 v[28:31], v[132:135], a[112:115], v[28:31]
  v_mfma_f32_16x16x32_bf16 v[32:35], v[132:135], a[116:119], v[32:35]
  v_mfma_f32_16x16x32_bf16 v[36:39], v[156:159], a[100:103], v[36:39]
  v_mfma_f32_16x16x32_bf16 v[40:43], v[156:159], a[104:107], v[40:43]
  v_mfma_f32_16x16x32_bf16 v[44:47], v[156:159], a[108:111], v[44:47]
  v_mfma_f32_16x16x32_bf16 v[48:51], v[156:159], a[112:115], v[48:51]
  v_mfma_f32_16x16x32_bf16 v[52:55], v[156:159], a[116:119], v[52:55]
  s_nop 7
  v_cvt_pk_bf16_f32 v212, v16, v17
  v_cvt_pk_bf16_f32 v213, v18, v19
  v_cvt_pk_bf16_f32 v214, v36, v37
  v_cvt_pk_bf16_f32 v215, v38, v39
  s_add_u32 s27, s26, 3072
  buffer_store_dwordx4 v[212:215], v2, s[8:11], s27 offen
  v_cvt_pk_bf16_f32 v216, v20, v21
  v_cvt_pk_bf16_f32 v217, v22, v23
  v_cvt_pk_bf16_f32 v218, v40, v41
  v_cvt_pk_bf16_f32 v219, v42, v43
  s_add_u32 s27, s26, 23552
  buffer_store_dwordx4 v[216:219], v2, s[8:11], s27 offen
  v_cvt_pk_bf16_f32 v220, v24, v25
  v_cvt_pk_bf16_f32 v221, v26, v27
  v_cvt_pk_bf16_f32 v222, v44, v45
  v_cvt_pk_bf16_f32 v223, v46, v47
  s_add_u32 s27, s26, 44032
  buffer_store_dwordx4 v[220:223], v2, s[8:11], s27 offen
  v_cvt_pk_bf16_f32 v224, v28, v29
  v_cvt_pk_bf16_f32 v225, v30, v31
  v_cvt_pk_bf16_f32 v226, v48, v49
  v_cvt_pk_bf16_f32 v227, v50, v51
  s_add_u32 s27, s26, 64512
  buffer_store_dwordx4 v[224:227], v2, s[8:11], s27 offen
  v_cvt_pk_bf16_f32 v212, v32, v33
  v_cvt_pk_bf16_f32 v213, v34, v35
  v_cvt_pk_bf16_f32 v214, v52, v53
  v_cvt_pk_bf16_f32 v215, v54, v55
  s_add_u32 s27, s26, 84992
  buffer_store_dwordx4 v[212:215], v2, s[8:11], s27 offen
  s_waitcnt vmcnt(20)
  v_mfma_f32_16x16x32_bf16 v[16:19], v[160:163], a[0:3], 0
  v_mfma_f32_16x16x32_bf16 v[20:23], v[160:163], a[4:7], 0
  v_mfma_f32_16x16x32_bf16 v[24:27], v[160:163], a[8:11], 0
  v_mfma_f32_16x16x32_bf16 v[28:31], v[160:163], a[12:15], 0
  v_mfma_f32_16x16x32_bf16 v[32:35], v[160:163], a[16:19], 0
  v_mfma_f32_16x16x32_bf16 v[36:39], v[184:187], a[0:3], 0
  v_mfma_f32_16x16x32_bf16 v[40:43], v[184:187], a[4:7], 0
  v_mfma_f32_16x16x32_bf16 v[44:47], v[184:187], a[8:11], 0
  v_mfma_f32_16x16x32_bf16 v[48:51], v[184:187], a[12:15], 0
  v_mfma_f32_16x16x32_bf16 v[52:55], v[184:187], a[16:19], 0
  v_mfma_f32_16x16x32_bf16 v[16:19], v[164:167], a[20:23], v[16:19]
  v_mfma_f32_16x16x32_bf16 v[20:23], v[164:167], a[24:27], v[20:23]
  v_mfma_f32_16x16x32_bf16 v[24:27], v[164:167], a[28:31], v[24:27]
  v_mfma_f32_16x16x32_bf16 v[28:31], v[164:167], a[32:35], v[28:31]
  v_mfma_f32_16x16x32_bf16 v[32:35], v[164:167], a[36:39], v[32:35]
  v_mfma_f32_16x16x32_bf16 v[36:39], v[188:191], a[20:23], v[36:39]
  v_mfma_f32_16x16x32_bf16 v[40:43], v[188:191], a[24:27], v[40:43]
  v_mfma_f32_16x16x32_bf16 v[44:47], v[188:191], a[28:31], v[44:47]
  v_mfma_f32_16x16x32_bf16 v[48:51], v[188:191], a[32:35], v[48:51]
  v_mfma_f32_16x16x32_bf16 v[52:55], v[188:191], a[36:39], v[52:55]
  v_mfma_f32_16x16x32_bf16 v[16:19], v[168:171], a[40:43], v[16:19]
  v_mfma_f32_16x16x32_bf16 v[20:23], v[168:171], a[44:47], v[20:23]
  v_mfma_f32_16x16x32_bf16 v[24:27], v[168:171], a[48:51], v[24:27]
  v_mfma_f32_16x16x32_bf16 v[28:31], v[168:171], a[52:55], v[28:31]
  v_mfma_f32_16x16x32_bf16 v[32:35], v[168:171], a[56:59], v[32:35]
  v_mfma_f32_16x16x32_bf16 v[36:39], v[192:195], a[40:43], v[36:39]
  v_mfma_f32_16x16x32_bf16 v[40:43], v[192:195], a[44:47], v[40:43]
  v_mfma_f32_16x16x32_bf16 v[44:47], v[192:195], a[48:51], v[44:47]
  v_mfma_f32_16x16x32_bf16 v[48:51], v[192:195], a[52:55], v[48:51]
  v_mfma_f32_16x16x32_bf16 v[52:55], v[192:195], a[56:59], v[52:55]
  v_mfma_f32_16x16x32_bf16 v[16:19], v[172:175], a[60:63], v[16:19]
  v_mfma_f32_16x16x32_bf16 v[20:23], v[172:175], a[64:67], v[20:23]
  v_mfma_f32_16x16x32_bf16 v[24:27], v[172:175], a[68:71], v[24:27]
  v_mfma_f32_16x16x32_bf16 v[28:31], v[172:175], a[72:75], v[28:31]
  v_mfma_f32_16x16x32_bf16 v[32:35], v[172:175], a[76:79], v[32:35]
  v_mfma_f32_16x16x32_bf16 v[36:39], v[196:199], a[60:63], v[36:39]
  v_mfma_f32_16x16x32_bf16 v[40:43], v[196:199], a[64:67], v[40:43]
  v_mfma_f32_16x16x32_bf16 v[44:47], v[196:199], a[68:71], v[44:47]
  v_mfma_f32_16x16x32_bf16 v[48:51], v[196:199], a[72:75], v[48:51]
  v_mfma_f32_16x16x32_bf16 v[52:55], v[196:199], a[76:79], v[52:55]
  v_mfma_f32_16x16x32_bf16 v[16:19], v[176:179], a[80:83], v[16:19]
  v_mfma_f32_16x16x32_bf16 v[20:23], v[176:179], a[84:87], v[20:23]
  v_mfma_f32_16x16x32_bf16 v[24:27], v[176:179], a[88:91], v[24:27]
  v_mfma_f32_16x16x32_bf16 v[28:31], v[176:179], a[92:95], v[28:31]
  v_mfma_f32_16x16x32_bf16 v[32:35], v[176:179], a[96:99], v[32:35]
  v_mfma_f32_16x16x32_bf16 v[36:39], v[200:203], a[80:83], v[36:39]
  v_mfma_f32_16x16x32_bf16 v[40:43], v[200:203], a[84:87], v[40:43]
  v_mfma_f32_16x16x32_bf16 v[44:47], v[200:203], a[88:91], v[44:47]
  v_mfma_f32_16x16x32_bf16 v[48:51], v[200:203], a[92:95], v[48:51]
  v_mfma_f32_16x16x32_bf16 v[52:55], v[200:203], a[96:99], v[52:55]
  v_mfma_f32_16x16x32_bf16 v[16:19], v[180:183], a[100:103], v[16:19]
  v_mfma_f32_16x16x32_bf16 v[20:23], v[180:183], a[104:107], v[20:23]
  v_mfma_f32_16x16x32_bf16 v[24:27], v[180:183], a[108:111], v[24:27]
  v_mfma_f32_16x16x32_bf16 v[28:31], v[180:183], a[112:115], v[28:31]
  v_mfma_f32_16x16x32_bf16 v[32:35], v[180:183], a[116:119], v[32:35]
  v_mfma_f32_16x16x32_bf16 v[36:39], v[204:207], a[100:103], v[36:39]
  v_mfma_f32_16x16x32_bf16 v[40:43], v[204:207], a[104:107], v[40:43]
  v_mfma_f32_16x16x32_bf16 v[44:47], v[204:207], a[108:111], v[44:47]
  v_mfma_f32_16x16x32_bf16 v[48:51], v[204:207], a[112:115], v[48:51]
  v_mfma_f32_16x16x32_bf16 v[52:55], v[204:207], a[116:119], v[52:55]
  s_nop 7
  v_cvt_pk_bf16_f32 v212, v16, v17
  v_cvt_pk_bf16_f32 v213, v18, v19
  v_cvt_pk_bf16_f32 v214, v36, v37
  v_cvt_pk_bf16_f32 v215, v38, v39
  s_add_u32 s27, s26, 4096
  buffer_store_dwordx4 v[212:215], v2, s[8:11], s27 offen
  v_cvt_pk_bf16_f32 v216, v20, v21
  v_cvt_pk_bf16_f32 v217, v22, v23
  v_cvt_pk_bf16_f32 v218, v40, v41
  v_cvt_pk_bf16_f32 v219, v42, v43
  s_add_u32 s27, s26, 24576
  buffer_store_dwordx4 v[216:219], v2, s[8:11], s27 offen
  v_cvt_pk_bf16_f32 v220, v24, v25
  v_cvt_pk_bf16_f32 v221, v26, v27
  v_cvt_pk_bf16_f32 v222, v44, v45
  v_cvt_pk_bf16_f32 v223, v46, v47
  s_add_u32 s27, s26, 45056
  buffer_store_dwordx4 v[220:223], v2, s[8:11], s27 offen
  v_cvt_pk_bf16_f32 v224, v28, v29
  v_cvt_pk_bf16_f32 v225, v30, v31
  v_cvt_pk_bf16_f32 v226, v48, v49
  v_cvt_pk_bf16_f32 v227, v50, v51
  s_add_u32 s27, s26, 65536
  buffer_store_dwordx4 v[224:227], v2, s[8:11], s27 offen
  v_cvt_pk_bf16_f32 v212, v32, v33
  v_cvt_pk_bf16_f32 v213, v34, v35
  v_cvt_pk_bf16_f32 v214, v52, v53
  v_cvt_pk_bf16_f32 v215, v54, v55
  s_add_u32 s27, s26, 86016
  buffer_store_dwordx4 v[212:215], v2, s[8:11], s27 offen
  s_cmp_eq_u32 s2, 0
  s_cbranch_scc0 z_20
  s_cmp_eq_u32 s21, 0
  s_cbranch_scc0 z_20
  v_mov_b32 v8, 0
  v_mov_b32 v9, 0
  v_mov_b32 v10, 0
  v_mov_b32 v11, 0
  s_mov_b32 s26, 0x0
  buffer_store_dwordx4 v[8:11], v2, s[8:11], s26 offen
  s_add_u32 s26, s26, 1024
  buffer_store_dwordx4 v[8:11], v2, s[8:11], s26 offen
  s_add_u32 s26, s26, 1024
  buffer_store_dwordx4 v[8:11], v2, s[8:11], s26 offen
  s_add_u32 s26, s26, 1024
  buffer_store_dwordx4 v[8:11], v2, s[8:11], s26 offen
  s_add_u32 s26, s26, 1024
  buffer_store_dwordx4 v[8:11], v2, s[8:11], s26 offen
  s_add_u32 s26, s26, 1024
  buffer_store_dwordx4 v[8:11], v2, s[8:11], s26 offen
  s_add_u32 s26, s26, 1024
  s_mov_b32 s26, 0x2000
  buffer_store_dwordx4 v[8:11], v2, s[8:11], s26 offen
  s_add_u32 s26, s26, 1024
  buffer_store_dwordx4 v[8:11], v2, s[8:11], s26 offen
  s_add_u32 s26, s26, 1024
  buffer_store_dwordx4 v[8:11], v2, s[8:11], s26 offen
  s_add_u32 s26, s26, 1024
  s_mov_b32 s26, 0x8000
  buffer_store_dwordx4 v[8:11], v2, s[8:11], s26 offen
  s_add_u32 s26, s26, 1024
  buffer_store_dwordx4 v[8:11], v2, s[8:11], s26 offen
  s_add_u32 s26, s26, 1024
  buffer_store_dwordx4 v[8:11], v2, s[8:11], s26 offen
  s_add_u32 s26, s26, 1024
  buffer_store_dwordx4 v[8:11], v2, s[8:11], s26 offen
  s_add_u32 s26, s26, 1024
  buffer_store_dwordx4 v[8:11], v2, s[8:11], s26 offen
  s_add_u32 s26, s26, 1024
  buffer_store_dwordx4 v[8:11], v2, s[8:11], s26 offen
  s_add_u32 s26, s26, 1024
  buffer_store_dwordx4 v[8:11], v2, s[8:11], s26 offen
  s_add_u32 s26, s26, 1024
  buffer_store_dwordx4 v[8:11], v2, s[8:11], s26 offen
  s_add_u32 s26, s26, 1024
  buffer_store_dwordx4 v[8:11], v2, s[8:11], s26 offen
  s_add_u32 s26, s26, 1024
  buffer_store_dwordx4 v[8:11], v2, s[8:11], s26 offen
  s_add_u32 s26, s26, 1024
  buffer_store_dwordx4 v[8:11], v2, s[8:11], s26 offen
  s_add_u32 s26, s26, 1024
  buffer_store_dwordx4 v[8:11], v2, s[8:11], s26 offen
  s_add_u32 s26, s26, 1024
  buffer_store_dwordx4 v[8:11], v2, s[8:11], s26 offen
  s_add_u32 s26, s26, 1024
  buffer_store_dwordx4 v[8:11], v2, s[8:11], s26 offen
  s_add_u32 s26, s26, 1024
  buffer_store_dwordx4 v[8:11], v2, s[8:11], s26 offen
  s_add_u32 s26, s26, 1024
  buffer_store_dwordx4 v[8:11], v2, s[8:11], s26 offen
  s_add_u32 s26, s26, 1024
z_20:
  s_cmp_eq_u32 s2, 1
  s_cbranch_scc0 m0_21
  s_cmp_eq_u32 s21, 0
  s_cbranch_scc0 m0_21
  s_mov_b32 s12, s38
  s_and_b32 s13, s39, 0xffff
  s_mov_b32 s14, 0x2800
  s_mov_b32 s15, 0x20000
  v_and_b32 v8, 7, v1
  v_mul_u32_u24 v8, 1280, v8
  v_lshrrev_b32 v9, 4, v1
  v_lshlrev_b32 v9, 5, v9
  v_add_u32 v8, v8, v9
  v_bfe_u32 v9, v1, 3, 1
  v_lshlrev_b32 v9, 2, v9
  v_add_u32 v8, v8, v9
  s_mov_b32 s26, 0x4000
  buffer_load_dword v16, v8, s[12:15], 0 offen offset:0
  buffer_load_dword v17, v8, s[12:15], 0 offen offset:8
  buffer_load_dword v18, v8, s[12:15], 0 offen offset:16
  buffer_load_dword v19, v8, s[12:15], 0 offen offset:24
  buffer_load_dword v20, v8, s[12:15], 0 offen offset:128
  buffer_load_dword v21, v8, s[12:15], 0 offen offset:136
  buffer_load_dword v22, v8, s[12:15], 0 offen offset:144
  buffer_load_dword v23, v8, s[12:15], 0 offen offset:152
  buffer_load_dword v24, v8, s[12:15], 0 offen offset:256
  buffer_load_dword v25, v8, s[12:15], 0 offen offset:264
  buffer_load_dword v26, v8, s[12:15], 0 offen offset:272
  buffer_load_dword v27, v8, s[12:15], 0 offen offset:280
  buffer_load_dword v28, v8, s[12:15], 0 offen offset:384
  buffer_load_dword v29, v8, s[12:15], 0 offen offset:392
  buffer_load_dword v30, v8, s[12:15], 0 offen offset:400
  buffer_load_dword v31, v8, s[12:15], 0 offen offset:408
  buffer_load_dword v32, v8, s[12:15], 0 offen offset:512
  buffer_load_dword v33, v8, s[12:15], 0 offen offset:520
  buffer_load_dword v34, v8, s[12:15], 0 offen offset:528
  buffer_load_dword v35, v8, s[12:15], 0 offen offset:536
  buffer_load_dword v36, v8, s[12:15], 0 offen offset:640
  buffer_load_dword v37, v8, s[12:15], 0 offen offset:648
  buffer_load_dword v38, v8, s[12:15], 0 offen offset:656
  buffer_load_dword v39, v8, s[12:15], 0 offen offset:664
  buffer_load_dword v40, v8, s[12:15], 0 offen offset:768
  buffer_load_dword v41, v8, s[12:15], 0 offen offset:776
  buffer_load_dword v42, v8, s[12:15], 0 offen offset:784
  buffer_load_dword v43, v8, s[12:15], 0 offen offset:792
  buffer_load_dword v44, v8, s[12:15], 0 offen offset:896
  buffer_load_dword v45, v8, s[12:15], 0 offen offset:904
  buffer_load_dword v46, v8, s[12:15], 0 offen offset:912
  buffer_load_dword v47, v8, s[12:15], 0 offen offset:920
  buffer_load_dword v48, v8, s[12:15], 0 offen offset:1024
  buffer_load_dword v49, v8, s[12:15], 0 offen offset:1032
  buffer_load_dword v50, v8, s[12:15], 0 offen offset:1040
  buffer_load_dword v51, v8, s[12:15], 0 offen offset:1048
  buffer_load_dword v52, v8, s[12:15], 0 offen offset:1152
  buffer_load_dword v53, v8, s[12:15], 0 offen offset:1160
  buffer_load_dword v54, v8, s[12:15], 0 offen offset:1168
  buffer_load_dword v55, v8, s[12:15], 0 offen offset:1176
  s_waitcnt vmcnt(0)
  buffer_store_dwordx4 v[16:19], v2, s[8:11], s26 offen
  s_add_u32 s26, s26, 1024
  buffer_store_dwordx4 v[20:23], v2, s[8:11], s26 offen
  s_add_u32 s26, s26, 1024
  buffer_store_dwordx4 v[24:27], v2, s[8:11], s26 offen
  s_add_u32 s26, s26, 1024
  buffer_store_dwordx4 v[28:31], v2, s[8:11], s26 offen
  s_add_u32 s26, s26, 1024
  buffer_store_dwordx4 v[32:35], v2, s[8:11], s26 offen
  s_add_u32 s26, s26, 1024
  buffer_store_dwordx4 v[36:39], v2, s[8:11], s26 offen
  s_add_u32 s26, s26, 1024
  buffer_store_dwordx4 v[40:43], v2, s[8:11], s26 offen
  s_add_u32 s26, s26, 1024
  buffer_store_dwordx4 v[44:47], v2, s[8:11], s26 offen
  s_add_u32 s26, s26, 1024
  buffer_store_dwordx4 v[48:51], v2, s[8:11], s26 offen
  s_add_u32 s26, s26, 1024
  buffer_store_dwordx4 v[52:55], v2, s[8:11], s26 offen
  s_add_u32 s26, s26, 1024
m0_21:
k0_exit:
  s_endpgm

.section .rodata,"a"
.p2align 6
.amdhsa_kernel prep_kernel
  .amdhsa_next_free_vgpr 512
  .amdhsa_next_free_sgpr 102
  .amdhsa_accum_offset 256
  .amdhsa_group_segment_fixed_size 0
  .amdhsa_kernarg_size 104
  .amdhsa_user_sgpr_count 2
  .amdhsa_user_sgpr_kernarg_segment_ptr 1
  .amdhsa_system_sgpr_workgroup_id_x 1
.end_amdhsa_kernel
.text
.globl ka1_kernel
.p2align 8
.type ka1_kernel,@function
ka1_kernel:
  s_mov_b32 s99, 0
  s_branch ka_body

.section .rodata,"a"
.p2align 6
.amdhsa_kernel ka1_kernel
  .amdhsa_next_free_vgpr 512
  .amdhsa_next_free_sgpr 102
  .amdhsa_accum_offset 256
  .amdhsa_group_segment_fixed_size 0
  .amdhsa_kernarg_size 104
  .amdhsa_user_sgpr_count 2
  .amdhsa_user_sgpr_kernarg_segment_ptr 1
  .amdhsa_system_sgpr_workgroup_id_x 1
.end_amdhsa_kernel
.text
.globl kb1_kernel
.p2align 8
.type kb1_kernel,@function
kb1_kernel:
  s_cmp_ge_u32 s2, 256
  s_cbranch_scc1 kb1_exit
  s_load_dwordx2 s[36:37], s[0:1], 0
  s_load_dwordx2 s[38:39], s[0:1], 80
  s_load_dwordx2 s[4:5], s[0:1], 96
  v_lshrrev_b32 v1, 6, v0
  s_nop 0
  v_readfirstlane_b32 s21, v1
  v_and_b32 v1, 63, v0
  v_lshlrev_b32 v2, 4, v1
  s_waitcnt lgkmcnt(0)
  s_mov_b32 s8, s4
  s_and_b32 s9, s5, 0xffff
  s_mov_b32 s10, 0x10000000
  s_mov_b32 s11, 0x20000
  s_mov_b32 s12, s36
  s_and_b32 s13, s37, 0xffff
  s_mov_b32 s14, 0x280000
  s_mov_b32 s15, 0x20000
  s_mov_b32 s16, s38
  s_and_b32 s17, s39, 0xffff
  s_mov_b32 s18, 0x280000
  s_mov_b32 s19, 0x20000
  s_and_b32 s22, s2, 7
  s_lshl_b32 s22, s22, 2
  s_bfe_u32 s23, s2, 0x20003
  s_add_u32 s22, s22, s23
  s_lshr_b32 s23, s2, 5
  s_lshl_b32 s46, s23, 7
  s_add_u32 s46, s46, 0x8000
  s_add_u32 s48, s46, 0x1400
  s_lshl_b32 s47, s22, 7
  s_add_u32 s47, s47, 0x8400
  s_lshr_b32 s26, s2, 2
  s_and_b32 s27, s2, 3
  s_lshl_b32 s27, s27, 3
  v_and_b32 v5, 7, v1
  v_bfe_u32 v6, v1, 3, 1
  v_lshrrev_b32 v7, 4, v1
  v_lshlrev_b32 v8, 5, v6
  v_add_u32 v8, v8, v5
  v_add_u32 v8, s27, v8
  v_lshlrev_b32 v8, 4, v8
  v_lshlrev_b32 v9, 11, v7
  v_add_u32 v9, v9, v8
  v_lshlrev_b32 v10, 10, v7
  v_add_u32 v10, v10, v8
  s_mul_i32 s28, s26, 81920
  s_lshl_b32 s29, s21, 13
  s_add_u32 s28, s28, s29
  s_cmp_lt_u32 s21, 2
  s_cselect_b32 s49, 3, 2
  v_mov_b32 v32, 0
  v_mov_b32 v33, 0
  v_mov_b32 v34, 0
  v_mov_b32 v35, 0
  v_mov_b32 v36, 0
  v_mov_b32 v37, 0
  v_mov_b32 v38, 0
  v_mov_b32 v39, 0
  v_mov_b32 v56, 0
  v_mov_b32 v57, 0
  v_mov_b32 v58, 0
  v_mov_b32 v59, 0
  v_mov_b32 v68, 0
  v_mov_b32 v69, 0
  v_mov_b32 v70, 0
  v_mov_b32 v71, 0
  v_mov_b32 v80, 0
  v_mov_b32 v81, 0
  v_mov_b32 v82, 0
  v_mov_b32 v83, 0
  v_mov_b32 v92, 0
  v_mov_b32 v93, 0
  v_mov_b32 v94, 0
  v_mov_b32 v95, 0
  s_mul_i32 s33, s26, 40960
  s_lshl_b32 s30, s21, 12
  s_add_u32 s33, s33, s30
  s_add_u32 s30, s33, 27262976
  buffer_load_dwordx4 v[48:51], v10, s[8:11], s30 offen
  s_add_u32 s30, s33, 29884416
  buffer_load_dwordx4 v[60:63], v10, s[8:11], s30 offen
  s_add_u32 s30, s33, 32505856
  buffer_load_dwordx4 v[72:75], v10, s[8:11], s30 offen
  s_add_u32 s30, s33, 35127296
  buffer_load_dwordx4 v[84:87], v10, s[8:11], s30 offen
  s_add_u32 s30, s33, 27279360
  buffer_load_dwordx4 v[52:55], v10, s[8:11], s30 offen
  s_add_u32 s30, s33, 29900800
  buffer_load_dwordx4 v[64:67], v10, s[8:11], s30 offen
  s_add_u32 s30, s33, 32522240
  buffer_load_dwordx4 v[76:79], v10, s[8:11], s30 offen
  s_add_u32 s30, s33, 35143680
  buffer_load_dwordx4 v[88:91], v10, s[8:11], s30 offen
  s_cmp_lt_u32 s21, 2
  s_cbranch_scc0 g3_22
  s_add_u32 s30, s33, 27295744
  buffer_load_dwordx4 v[56:59], v10, s[8:11], s30 offen
  s_add_u32 s30, s33, 29917184
  buffer_load_dwordx4 v[68:71], v10, s[8:11], s30 offen
  s_add_u32 s30, s33, 32538624
  buffer_load_dwordx4 v[80:83], v10, s[8:11], s30 offen
  s_add_u32 s30, s33, 35160064
  buffer_load_dwordx4 v[92:95], v10, s[8:11], s30 offen
g3_22:
  s_lshl_b32 s30, s26, 5
  s_add_u32 s30, s30, s27
  v_add_u32 v11, s30, v5
  v_mul_u32_u24 v11, 1280, v11
  v_lshlrev_b32 v12, 5, v7
  v_add_u32 v11, v11, v12
  v_lshlrev_b32 v12, 4, v6
  v_add_u32 v11, v11, v12
  s_lshl_b32 s30, s21, 7
  buffer_load_dwordx4 v[144:147], v11, s[12:15], s30 offen offset:0
  buffer_load_dwordx4 v[148:151], v11, s[12:15], s30 offen offset:512
  s_cmp_lt_u32 s21, 2
  s_cbranch_scc0 g3_23
  buffer_load_dwordx4 v[152:155], v11, s[12:15], s30 offen offset:1024
g3_23:
  s_mul_i32 s30, s22, 122880
  s_mul_i32 s31, s21, 30720
  s_add_u32 s30, s30, s31
  s_add_u32 s30, s30, 0xe100000
  s_add_u32 m0, s31, 0
  s_add_u32 s29, s30, 0
  buffer_load_dwordx4 v2, s[8:11], s29 offen lds
  s_add_u32 m0, s31, 1024
  s_add_u32 s29, s30, 1024
  buffer_load_dwordx4 v2, s[8:11], s29 offen lds
  s_add_u32 m0, s31, 2048
  s_add_u32 s29, s30, 2048
  buffer_load_dwordx4 v2, s[8:11], s29 offen lds
  s_add_u32 m0, s31, 3072
  s_add_u32 s29, s30, 3072
  buffer_load_dwordx4 v2, s[8:11], s29 offen lds
  s_add_u32 m0, s31, 4096
  s_add_u32 s29, s30, 4096
  buffer_load_dwordx4 v2, s[8:11], s29 offen lds
  s_add_u32 m0, s31, 5120
  s_add_u32 s29, s30, 5120
  buffer_load_dwordx4 v2, s[8:11], s29 offen lds
  s_add_u32 m0, s31, 6144
  s_add_u32 s29, s30, 6144
  buffer_load_dwordx4 v2, s[8:11], s29 offen lds
  s_add_u32 m0, s31, 7168
  s_add_u32 s29, s30, 7168
  buffer_load_dwordx4 v2, s[8:11], s29 offen lds
  s_add_u32 m0, s31, 8192
  s_add_u32 s29, s30, 8192
  buffer_load_dwordx4 v2, s[8:11], s29 offen lds
  s_add_u32 m0, s31, 9216
  s_add_u32 s29, s30, 9216
  buffer_load_dwordx4 v2, s[8:11], s29 offen lds
  s_add_u32 m0, s31, 10240
  s_add_u32 s29, s30, 10240
  buffer_load_dwordx4 v2, s[8:11], s29 offen lds
  s_add_u32 m0, s31, 11264
  s_add_u32 s29, s30, 11264
  buffer_load_dwordx4 v2, s[8:11], s29 offen lds
  s_add_u32 m0, s31, 12288
  s_add_u32 s29, s30, 12288
  buffer_load_dwordx4 v2, s[8:11], s29 offen lds
  s_add_u32 m0, s31, 13312
  s_add_u32 s29, s30, 13312
  buffer_load_dwordx4 v2, s[8:11], s29 offen lds
  s_add_u32 m0, s31, 14336
  s_add_u32 s29, s30, 14336
  buffer_load_dwordx4 v2, s[8:11], s29 offen lds
  s_add_u32 m0, s31, 15360
  s_add_u32 s29, s30, 15360
  buffer_load_dwordx4 v2, s[8:11], s29 offen lds
  s_add_u32 m0, s31, 16384
  s_add_u32 s29, s30, 16384
  buffer_load_dwordx4 v2, s[8:11], s29 offen lds
  s_add_u32 m0, s31, 17408
  s_add_u32 s29, s30, 17408
  buffer_load_dwordx4 v2, s[8:11], s29 offen lds
  s_add_u32 m0, s31, 18432
  s_add_u32 s29, s30, 18432
  buffer_load_dwordx4 v2, s[8:11], s29 offen lds
  s_add_u32 m0, s31, 19456
  s_add_u32 s29, s30, 19456
  buffer_load_dwordx4 v2, s[8:11], s29 offen lds
  s_add_u32 m0, s31, 20480
  s_add_u32 s29, s30, 20480
  buffer_load_dwordx4 v2, s[8:11], s29 offen lds
  s_add_u32 m0, s31, 21504
  s_add_u32 s29, s30, 21504
  buffer_load_dwordx4 v2, s[8:11], s29 offen lds
  s_add_u32 m0, s31, 22528
  s_add_u32 s29, s30, 22528
  buffer_load_dwordx4 v2, s[8:11], s29 offen lds
  s_add_u32 m0, s31, 23552
  s_add_u32 s29, s30, 23552
  buffer_load_dwordx4 v2, s[8:11], s29 offen lds
  s_add_u32 m0, s31, 24576
  s_add_u32 s29, s30, 24576
  buffer_load_dwordx4 v2, s[8:11], s29 offen lds
  s_add_u32 m0, s31, 25600
  s_add_u32 s29, s30, 25600
  buffer_load_dwordx4 v2, s[8:11], s29 offen lds
  s_add_u32 m0, s31, 26624
  s_add_u32 s29, s30, 26624
  buffer_load_dwordx4 v2, s[8:11], s29 offen lds
  s_add_u32 m0, s31, 27648
  s_add_u32 s29, s30, 27648
  buffer_load_dwordx4 v2, s[8:11], s29 offen lds
  s_add_u32 m0, s31, 28672
  s_add_u32 s29, s30, 28672
  buffer_load_dwordx4 v2, s[8:11], s29 offen lds
  s_add_u32 m0, s31, 29696
  s_add_u32 s29, s30, 29696
  buffer_load_dwordx4 v2, s[8:11], s29 offen lds
  s_waitcnt vmcnt(30)
  v_lshlrev_b32 v16, 16, v144
  v_and_b32 v17, 0xffff0000, v144
  v_lshlrev_b32 v18, 16, v145
  v_and_b32 v19, 0xffff0000, v145
  v_lshlrev_b32 v20, 16, v146
  v_and_b32 v21, 0xffff0000, v146
  v_lshlrev_b32 v22, 16, v147
  v_and_b32 v23, 0xffff0000, v147
  v_lshlrev_b32 v24, 16, v148
  v_and_b32 v25, 0xffff0000, v148
  v_lshlrev_b32 v26, 16, v149
  v_and_b32 v27, 0xffff0000, v149
  v_lshlrev_b32 v28, 16, v150
  v_and_b32 v29, 0xffff0000, v150
  v_lshlrev_b32 v30, 16, v151
  v_and_b32 v31, 0xffff0000, v151
  s_cmp_lt_u32 s21, 2
  s_cbranch_scc0 g3_24
  v_lshlrev_b32 v32, 16, v152
  v_and_b32 v33, 0xffff0000, v152
  v_lshlrev_b32 v34, 16, v153
  v_and_b32 v35, 0xffff0000, v153
  v_lshlrev_b32 v36, 16, v154
  v_and_b32 v37, 0xffff0000, v154
  v_lshlrev_b32 v38, 16, v155
  v_and_b32 v39, 0xffff0000, v155
g3_24:
  v_lshlrev_b32 v12, 16, v48
  v_and_b32 v13, 0xffff0000, v48
  v_pk_add_f32 v[16:17], v[16:17], v[12:13]
  v_lshlrev_b32 v12, 16, v49
  v_and_b32 v13, 0xffff0000, v49
  v_pk_add_f32 v[18:19], v[18:19], v[12:13]
  v_lshlrev_b32 v12, 16, v50
  v_and_b32 v13, 0xffff0000, v50
  v_pk_add_f32 v[20:21], v[20:21], v[12:13]
  v_lshlrev_b32 v12, 16, v51
  v_and_b32 v13, 0xffff0000, v51
  v_pk_add_f32 v[22:23], v[22:23], v[12:13]
  v_lshlrev_b32 v12, 16, v52
  v_and_b32 v13, 0xffff0000, v52
  v_pk_add_f32 v[24:25], v[24:25], v[12:13]
  v_lshlrev_b32 v12, 16, v53
  v_and_b32 v13, 0xffff0000, v53
  v_pk_add_f32 v[26:27], v[26:27], v[12:13]
  v_lshlrev_b32 v12, 16, v54
  v_and_b32 v13, 0xffff0000, v54
  v_pk_add_f32 v[28:29], v[28:29], v[12:13]
  v_lshlrev_b32 v12, 16, v55
  v_and_b32 v13, 0xffff0000, v55
  v_pk_add_f32 v[30:31], v[30:31], v[12:13]
  v_lshlrev_b32 v12, 16, v56
  v_and_b32 v13, 0xffff0000, v56
  v_pk_add_f32 v[32:33], v[32:33], v[12:13]
  v_lshlrev_b32 v12, 16, v57
  v_and_b32 v13, 0xffff0000, v57
  v_pk_add_f32 v[34:35], v[34:35], v[12:13]
  v_lshlrev_b32 v12, 16, v58
  v_and_b32 v13, 0xffff0000, v58
  v_pk_add_f32 v[36:37], v[36:37], v[12:13]
  v_lshlrev_b32 v12, 16, v59
  v_and_b32 v13, 0xffff0000, v59
  v_pk_add_f32 v[38:39], v[38:39], v[12:13]
  v_lshlrev_b32 v12, 16, v60
  v_and_b32 v13, 0xffff0000, v60
  v_pk_add_f32 v[16:17], v[16:17], v[12:13]
  v_lshlrev_b32 v12, 16, v61
  v_and_b32 v13, 0xffff0000, v61
  v_pk_add_f32 v[18:19], v[18:19], v[12:13]
  v_lshlrev_b32 v12, 16, v62
  v_and_b32 v13, 0xffff0000, v62
  v_pk_add_f32 v[20:21], v[20:21], v[12:13]
  v_lshlrev_b32 v12, 16, v63
  v_and_b32 v13, 0xffff0000, v63
  v_pk_add_f32 v[22:23], v[22:23], v[12:13]
  v_lshlrev_b32 v12, 16, v64
  v_and_b32 v13, 0xffff0000, v64
  v_pk_add_f32 v[24:25], v[24:25], v[12:13]
  v_lshlrev_b32 v12, 16, v65
  v_and_b32 v13, 0xffff0000, v65
  v_pk_add_f32 v[26:27], v[26:27], v[12:13]
  v_lshlrev_b32 v12, 16, v66
  v_and_b32 v13, 0xffff0000, v66
  v_pk_add_f32 v[28:29], v[28:29], v[12:13]
  v_lshlrev_b32 v12, 16, v67
  v_and_b32 v13, 0xffff0000, v67
  v_pk_add_f32 v[30:31], v[30:31], v[12:13]
  v_lshlrev_b32 v12, 16, v68
  v_and_b32 v13, 0xffff0000, v68
  v_pk_add_f32 v[32:33], v[32:33], v[12:13]
  v_lshlrev_b32 v12, 16, v69
  v_and_b32 v13, 0xffff0000, v69
  v_pk_add_f32 v[34:35], v[34:35], v[12:13]
  v_lshlrev_b32 v12, 16, v70
  v_and_b32 v13, 0xffff0000, v70
  v_pk_add_f32 v[36:37], v[36:37], v[12:13]
  v_lshlrev_b32 v12, 16, v71
  v_and_b32 v13, 0xffff0000, v71
  v_pk_add_f32 v[38:39], v[38:39], v[12:13]
  v_lshlrev_b32 v12, 16, v72
  v_and_b32 v13, 0xffff0000, v72
  v_pk_add_f32 v[16:17], v[16:17], v[12:13]
  v_lshlrev_b32 v12, 16, v73
  v_and_b32 v13, 0xffff0000, v73
  v_pk_add_f32 v[18:19], v[18:19], v[12:13]
  v_lshlrev_b32 v12, 16, v74
  v_and_b32 v13, 0xffff0000, v74
  v_pk_add_f32 v[20:21], v[20:21], v[12:13]
  v_lshlrev_b32 v12, 16, v75
  v_and_b32 v13, 0xffff0000, v75
  v_pk_add_f32 v[22:23], v[22:23], v[12:13]
  v_lshlrev_b32 v12, 16, v76
  v_and_b32 v13, 0xffff0000, v76
  v_pk_add_f32 v[24:25], v[24:25], v[12:13]
  v_lshlrev_b32 v12, 16, v77
  v_and_b32 v13, 0xffff0000, v77
  v_pk_add_f32 v[26:27], v[26:27], v[12:13]
  v_lshlrev_b32 v12, 16, v78
  v_and_b32 v13, 0xffff0000, v78
  v_pk_add_f32 v[28:29], v[28:29], v[12:13]
  v_lshlrev_b32 v12, 16, v79
  v_and_b32 v13, 0xffff0000, v79
  v_pk_add_f32 v[30:31], v[30:31], v[12:13]
  v_lshlrev_b32 v12, 16, v80
  v_and_b32 v13, 0xffff0000, v80
  v_pk_add_f32 v[32:33], v[32:33], v[12:13]
  v_lshlrev_b32 v12, 16, v81
  v_and_b32 v13, 0xffff0000, v81
  v_pk_add_f32 v[34:35], v[34:35], v[12:13]
  v_lshlrev_b32 v12, 16, v82
  v_and_b32 v13, 0xffff0000, v82
  v_pk_add_f32 v[36:37], v[36:37], v[12:13]
  v_lshlrev_b32 v12, 16, v83
  v_and_b32 v13, 0xffff0000, v83
  v_pk_add_f32 v[38:39], v[38:39], v[12:13]
  v_lshlrev_b32 v12, 16, v84
  v_and_b32 v13, 0xffff0000, v84
  v_pk_add_f32 v[16:17], v[16:17], v[12:13]
  v_lshlrev_b32 v12, 16, v85
  v_and_b32 v13, 0xffff0000, v85
  v_pk_add_f32 v[18:19], v[18:19], v[12:13]
  v_lshlrev_b32 v12, 16, v86
  v_and_b32 v13, 0xffff0000, v86
  v_pk_add_f32 v[20:21], v[20:21], v[12:13]
  v_lshlrev_b32 v12, 16, v87
  v_and_b32 v13, 0xffff0000, v87
  v_pk_add_f32 v[22:23], v[22:23], v[12:13]
  v_lshlrev_b32 v12, 16, v88
  v_and_b32 v13, 0xffff0000, v88
  v_pk_add_f32 v[24:25], v[24:25], v[12:13]
  v_lshlrev_b32 v12, 16, v89
  v_and_b32 v13, 0xffff0000, v89
  v_pk_add_f32 v[26:27], v[26:27], v[12:13]
  v_lshlrev_b32 v12, 16, v90
  v_and_b32 v13, 0xffff0000, v90
  v_pk_add_f32 v[28:29], v[28:29], v[12:13]
  v_lshlrev_b32 v12, 16, v91
  v_and_b32 v13, 0xffff0000, v91
  v_pk_add_f32 v[30:31], v[30:31], v[12:13]
  v_lshlrev_b32 v12, 16, v92
  v_and_b32 v13, 0xffff0000, v92
  v_pk_add_f32 v[32:33], v[32:33], v[12:13]
  v_lshlrev_b32 v12, 16, v93
  v_and_b32 v13, 0xffff0000, v93
  v_pk_add_f32 v[34:35], v[34:35], v[12:13]
  v_lshlrev_b32 v12, 16, v94
  v_and_b32 v13, 0xffff0000, v94
  v_pk_add_f32 v[36:37], v[36:37], v[12:13]
  v_lshlrev_b32 v12, 16, v95
  v_and_b32 v13, 0xffff0000, v95
  v_pk_add_f32 v[38:39], v[38:39], v[12:13]
  s_add_u32 s30, s28, 20971520
  buffer_store_dwordx4 v[16:19], v9, s[8:11], s30 offen sc1
  s_add_u32 s30, s28, 20972544
  buffer_store_dwordx4 v[20:23], v9, s[8:11], s30 offen sc1
  s_add_u32 s30, s28, 21004288
  buffer_store_dwordx4 v[24:27], v9, s[8:11], s30 offen sc1
  s_add_u32 s30, s28, 21005312
  buffer_store_dwordx4 v[28:31], v9, s[8:11], s30 offen sc1
  s_cmp_lt_u32 s21, 2
  s_cbranch_scc0 g3_25
  s_add_u32 s30, s28, 21037056
  buffer_store_dwordx4 v[32:35], v9, s[8:11], s30 offen sc1
  s_add_u32 s30, s28, 21038080
  buffer_store_dwordx4 v[36:39], v9, s[8:11], s30 offen sc1
g3_25:
  v_add_f32 v12, v16, v17
  v_add_f32 v12, v12, v18
  v_add_f32 v12, v12, v19
  v_add_f32 v12, v12, v20
  v_add_f32 v12, v12, v21
  v_add_f32 v12, v12, v22
  v_add_f32 v12, v12, v23
  v_add_f32 v12, v12, v24
  v_add_f32 v12, v12, v25
  v_add_f32 v12, v12, v26
  v_add_f32 v12, v12, v27
  v_add_f32 v12, v12, v28
  v_add_f32 v12, v12, v29
  v_add_f32 v12, v12, v30
  v_add_f32 v12, v12, v31
  v_add_f32 v12, v12, v32
  v_add_f32 v12, v12, v33
  v_add_f32 v12, v12, v34
  v_add_f32 v12, v12, v35
  v_add_f32 v12, v12, v36
  v_add_f32 v12, v12, v37
  v_add_f32 v12, v12, v38
  v_add_f32 v12, v12, v39
  s_nop 1
  v_add_f32_dpp v12, v12, v12 row_ror:8 row_mask:0xf bank_mask:0xf
  v_mov_b32 v13, v12
  s_nop 1
  v_permlane16_swap_b32 v12, v13
  v_add_f32 v12, v12, v13
  v_mov_b32 v13, v12
  s_nop 1
  v_permlane32_swap_b32 v12, v13
  v_add_f32 v12, v12, v13
  v_lshlrev_b32 v14, 2, v5
  v_add_u32 v14, 131072, v14
  s_lshl_b32 s30, s21, 5
  v_add_u32 v15, s30, v14
  ds_write_b32 v15, v12
  s_waitcnt lgkmcnt(0)
  s_barrier
  ds_read_b32 v48, v14
  ds_read_b32 v49, v14 offset:32
  ds_read_b32 v50, v14 offset:64
  ds_read_b32 v51, v14 offset:96
  s_waitcnt lgkmcnt(0)
  v_add_f32 v48, v48, v49
  v_add_f32 v50, v50, v51
  v_add_f32 v48, v48, v50
  v_mul_f32 v48, 0x3acccccd, v48
  v_sub_f32 v56, v16, v48
  v_sub_f32 v57, v17, v48
  v_sub_f32 v58, v18, v48
  v_sub_f32 v59, v19, v48
  v_sub_f32 v60, v20, v48
  v_sub_f32 v61, v21, v48
  v_sub_f32 v62, v22, v48
  v_sub_f32 v63, v23, v48
  v_sub_f32 v64, v24, v48
  v_sub_f32 v65, v25, v48
  v_sub_f32 v66, v26, v48
  v_sub_f32 v67, v27, v48
  v_sub_f32 v68, v28, v48
  v_sub_f32 v69, v29, v48
  v_sub_f32 v70, v30, v48
  v_sub_f32 v71, v31, v48
  v_sub_f32 v72, v32, v48
  v_sub_f32 v73, v33, v48
  v_sub_f32 v74, v34, v48
  v_sub_f32 v75, v35, v48
  v_sub_f32 v76, v36, v48
  v_sub_f32 v77, v37, v48
  v_sub_f32 v78, v38, v48
  v_sub_f32 v79, v39, v48
  s_cmp_lt_u32 s21, 2
  s_cbranch_scc1 g3z_26
  v_mov_b32 v72, 0
  v_mov_b32 v73, 0
  v_mov_b32 v74, 0
  v_mov_b32 v75, 0
  v_mov_b32 v76, 0
  v_mov_b32 v77, 0
  v_mov_b32 v78, 0
  v_mov_b32 v79, 0
g3z_26:
  v_mul_f32 v12, v56, v56
  v_fmac_f32 v12, v57, v57
  v_fmac_f32 v12, v58, v58
  v_fmac_f32 v12, v59, v59
  v_fmac_f32 v12, v60, v60
  v_fmac_f32 v12, v61, v61
  v_fmac_f32 v12, v62, v62
  v_fmac_f32 v12, v63, v63
  v_fmac_f32 v12, v64, v64
  v_fmac_f32 v12, v65, v65
  v_fmac_f32 v12, v66, v66
  v_fmac_f32 v12, v67, v67
  v_fmac_f32 v12, v68, v68
  v_fmac_f32 v12, v69, v69
  v_fmac_f32 v12, v70, v70
  v_fmac_f32 v12, v71, v71
  v_fmac_f32 v12, v72, v72
  v_fmac_f32 v12, v73, v73
  v_fmac_f32 v12, v74, v74
  v_fmac_f32 v12, v75, v75
  v_fmac_f32 v12, v76, v76
  v_fmac_f32 v12, v77, v77
  v_fmac_f32 v12, v78, v78
  v_fmac_f32 v12, v79, v79
  s_nop 1
  v_add_f32_dpp v12, v12, v12 row_ror:8 row_mask:0xf bank_mask:0xf
  v_mov_b32 v13, v12
  s_nop 1
  v_permlane16_swap_b32 v12, v13
  v_add_f32 v12, v12, v13
  v_mov_b32 v13, v12
  s_nop 1
  v_permlane32_swap_b32 v12, v13
  v_add_f32 v12, v12, v13
  v_lshlrev_b32 v14, 2, v5
  v_add_u32 v14, 131328, v14
  s_lshl_b32 s30, s21, 5
  v_add_u32 v15, s30, v14
  ds_write_b32 v15, v12
  s_waitcnt lgkmcnt(0)
  s_barrier
  ds_read_b32 v48, v14
  ds_read_b32 v49, v14 offset:32
  ds_read_b32 v50, v14 offset:64
  ds_read_b32 v51, v14 offset:96
  s_waitcnt lgkmcnt(0)
  v_add_f32 v48, v48, v49
  v_add_f32 v50, v50, v51
  v_add_f32 v48, v48, v50
  v_mov_b32 v49, 0x3727c5ac
  v_fmac_f32 v49, 0x3acccccd, v48
  v_rsq_f32 v49, v49
  s_nop 0
  v_mul_f32 v56, v56, v49
  v_mul_f32 v57, v57, v49
  v_mul_f32 v58, v58, v49
  v_mul_f32 v59, v59, v49
  v_mul_f32 v60, v60, v49
  v_mul_f32 v61, v61, v49
  v_mul_f32 v62, v62, v49
  v_mul_f32 v63, v63, v49
  v_mul_f32 v64, v64, v49
  v_mul_f32 v65, v65, v49
  v_mul_f32 v66, v66, v49
  v_mul_f32 v67, v67, v49
  v_mul_f32 v68, v68, v49
  v_mul_f32 v69, v69, v49
  v_mul_f32 v70, v70, v49
  v_mul_f32 v71, v71, v49
  v_mul_f32 v72, v72, v49
  v_mul_f32 v73, v73, v49
  v_mul_f32 v74, v74, v49
  v_mul_f32 v75, v75, v49
  v_mul_f32 v76, v76, v49
  v_mul_f32 v77, v77, v49
  v_mul_f32 v78, v78, v49
  v_mul_f32 v79, v79, v49
  v_cvt_pk_bf16_f32 v80, v56, v57
  v_cvt_pk_bf16_f32 v81, v58, v59
  v_cvt_pk_bf16_f32 v82, v60, v61
  v_cvt_pk_bf16_f32 v83, v62, v63
  v_cvt_pk_bf16_f32 v84, v64, v65
  v_cvt_pk_bf16_f32 v85, v66, v67
  v_cvt_pk_bf16_f32 v86, v68, v69
  v_cvt_pk_bf16_f32 v87, v70, v71
  v_cvt_pk_bf16_f32 v88, v72, v73
  v_cvt_pk_bf16_f32 v89, v74, v75
  v_cvt_pk_bf16_f32 v90, v76, v77
  v_cvt_pk_bf16_f32 v91, v78, v79
  s_mul_i32 s30, s26, 40960
  s_lshl_b32 s31, s21, 12
  s_add_u32 s30, s30, s31
  s_add_u32 s30, s30, 0x100000
  s_add_u32 s31, s30, 0
  buffer_store_dwordx4 v[80:83], v10, s[8:11], s31 offen sc1
  s_add_u32 s31, s30, 16384
  buffer_store_dwordx4 v[84:87], v10, s[8:11], s31 offen sc1
  s_cmp_lt_u32 s21, 2
  s_cbranch_scc0 g3_27
  s_add_u32 s31, s30, 32768
  buffer_store_dwordx4 v[88:91], v10, s[8:11], s31 offen sc1
g3_27:
  s_waitcnt vmcnt(0)
  s_barrier
  s_cmp_eq_u32 s21, 0
  s_cbranch_scc0 arr_28
  s_mov_b64 s[24:25], exec
  s_mov_b64 exec, 1
  v_mov_b32 v3, 0
  v_mov_b32 v4, 1
  buffer_atomic_add v4, v3, s[8:11], s46 offen
  s_mov_b64 exec, s[24:25]
arr_28:
  s_mov_b32 s45, 0
  v_mov_b32 v3, 0
aw_29:
  buffer_load_dword v4, v3, s[8:11], s46 offen sc1
  s_add_u32 s45, s45, 1
  s_waitcnt vmcnt(0)
  v_readfirstlane_b32 s29, v4
  s_cmp_ge_u32 s29, 32
  s_cbranch_scc1 aw_29_ok
  s_cmp_lt_u32 s45, 400000
  s_cbranch_scc1 aw_29
  s_branch kb1_abort
aw_29_ok:
  s_barrier
  s_lshl_b32 s26, s23, 3
  s_lshl_b32 s27, s21, 1
  s_add_u32 s24, s26, s27
  s_mul_i32 s27, s24, 40960
  s_add_u32 s27, s27, 0x100000
  s_add_u32 s28, s27, 40960
  v_mov_b32 v3, v2
  v_add_u32 v4, 65536, v2
  v_lshlrev_b32 v5, 7, v1
  s_add_u32 s29, s27, 0
  buffer_load_dword v10, v5, s[8:11], s29 offen sc1
  s_add_u32 s29, s27, 8192
  buffer_load_dword v10, v5, s[8:11], s29 offen sc1
  s_add_u32 s29, s27, 16384
  buffer_load_dword v10, v5, s[8:11], s29 offen sc1
  s_add_u32 s29, s27, 24576
  buffer_load_dword v10, v5, s[8:11], s29 offen sc1
  s_add_u32 s29, s27, 32768
  buffer_load_dword v10, v5, s[8:11], s29 offen sc1
  s_add_u32 s29, s27, 40960
  buffer_load_dword v10, v5, s[8:11], s29 offen sc1
  s_add_u32 s29, s27, 49152
  buffer_load_dword v10, v5, s[8:11], s29 offen sc1
  s_add_u32 s29, s27, 57344
  buffer_load_dword v10, v5, s[8:11], s29 offen sc1
  s_add_u32 s29, s27, 65536
  buffer_load_dword v10, v5, s[8:11], s29 offen sc1
  s_add_u32 s29, s27, 73728
  buffer_load_dword v10, v5, s[8:11], s29 offen sc1
  s_mov_b32 s30, 0x3ea52b5c
  v_mov_b32 v5, 0
  v_cmp_gt_u32 s[34:35], 32, v1
  v_mov_b32 v6, 1.0
  v_and_b32 v7, 31, v1
  v_cndmask_b32 v6, v5, v6, s[34:35]
  v_cmp_eq_u32 s[32:33], 20, v7
  v_mov_b32 v8, 1.0
  s_lshl_b32 s31, s22, 6
  s_add_u32 s31, s31, s24
  s_lshl_b32 s31, s31, 11
  v_mov_b32 v9, 0
  s_add_u32 s29, s27, 0
  buffer_load_dwordx4 v[16:19], v2, s[8:11], s29 offen sc1
  s_add_u32 s29, s27, 1024
  buffer_load_dwordx4 v[20:23], v2, s[8:11], s29 offen sc1
  s_add_u32 s29, s27, 2048
  buffer_load_dwordx4 v[24:27], v2, s[8:11], s29 offen sc1
  s_add_u32 s29, s27, 3072
  buffer_load_dwordx4 v[28:31], v2, s[8:11], s29 offen sc1
  s_add_u32 s29, s27, 4096
  buffer_load_dwordx4 v[32:35], v2, s[8:11], s29 offen sc1
  s_add_u32 s29, s27, 5120
  buffer_load_dwordx4 v[36:39], v2, s[8:11], s29 offen sc1
  s_add_u32 s29, s27, 6144
  buffer_load_dwordx4 v[40:43], v2, s[8:11], s29 offen sc1
  s_add_u32 s29, s27, 7168
  buffer_load_dwordx4 v[44:47], v2, s[8:11], s29 offen sc1
  s_add_u32 s29, s27, 8192
  buffer_load_dwordx4 v[48:51], v2, s[8:11], s29 offen sc1
  s_add_u32 s29, s27, 9216
  buffer_load_dwordx4 v[52:55], v2, s[8:11], s29 offen sc1
  s_add_u32 s29, s27, 10240
  buffer_load_dwordx4 v[56:59], v2, s[8:11], s29 offen sc1
  s_add_u32 s29, s27, 11264
  buffer_load_dwordx4 v[60:63], v2, s[8:11], s29 offen sc1
  s_add_u32 s29, s27, 12288
  buffer_load_dwordx4 v[64:67], v2, s[8:11], s29 offen sc1
  s_add_u32 s29, s27, 13312
  buffer_load_dwordx4 v[68:71], v2, s[8:11], s29 offen sc1
  s_add_u32 s29, s27, 14336
  buffer_load_dwordx4 v[72:75], v2, s[8:11], s29 offen sc1
  ds_read_b128 v[208:211], v3 offset:0
  ds_read_b128 v[212:215], v3 offset:40960
  ds_read_b128 v[216:219], v4 offset:16384
  s_add_u32 s29, s27, 15360
  buffer_load_dwordx4 v[76:79], v2, s[8:11], s29 offen sc1
  ds_read_b128 v[220:223], v3 offset:1024
  ds_read_b128 v[224:227], v3 offset:41984
  ds_read_b128 v[228:231], v4 offset:17408
  s_waitcnt lgkmcnt(3)
  s_waitcnt vmcnt(15)
  v_mfma_f32_32x32x16_bf16 v[80:95], v[208:211], v[16:19], 0
  v_mfma_f32_32x32x16_bf16 v[96:111], v[212:215], v[16:19], 0
  v_mfma_f32_32x32x16_bf16 v[112:127], v[16:19], v[216:219], 0
  s_add_u32 s29, s27, 16384
  buffer_load_dwordx4 v[16:19], v2, s[8:11], s29 offen sc1
  ds_read_b128 v[208:211], v3 offset:2048
  ds_read_b128 v[212:215], v3 offset:43008
  ds_read_b128 v[216:219], v4 offset:18432
  s_waitcnt lgkmcnt(3)
  s_waitcnt vmcnt(15)
  v_mfma_f32_32x32x16_bf16 v[80:95], v[220:223], v[20:23], v[80:95]
  v_mfma_f32_32x32x16_bf16 v[96:111], v[224:227], v[20:23], v[96:111]
  v_mfma_f32_32x32x16_bf16 v[112:127], v[20:23], v[228:231], v[112:127]
  s_add_u32 s29, s27, 17408
  buffer_load_dwordx4 v[20:23], v2, s[8:11], s29 offen sc1
  ds_read_b128 v[220:223], v3 offset:3072
  ds_read_b128 v[224:227], v3 offset:44032
  ds_read_b128 v[228:231], v4 offset:19456
  s_waitcnt lgkmcnt(3)
  s_waitcnt vmcnt(15)
  v_mfma_f32_32x32x16_bf16 v[80:95], v[208:211], v[24:27], v[80:95]
  v_mfma_f32_32x32x16_bf16 v[96:111], v[212:215], v[24:27], v[96:111]
  v_mfma_f32_32x32x16_bf16 v[112:127], v[24:27], v[216:219], v[112:127]
  s_add_u32 s29, s27, 18432
  buffer_load_dwordx4 v[24:27], v2, s[8:11], s29 offen sc1
  ds_read_b128 v[208:211], v3 offset:4096
  ds_read_b128 v[212:215], v3 offset:45056
  ds_read_b128 v[216:219], v4 offset:20480
  s_waitcnt lgkmcnt(3)
  s_waitcnt vmcnt(15)
  v_mfma_f32_32x32x16_bf16 v[80:95], v[220:223], v[28:31], v[80:95]
  v_mfma_f32_32x32x16_bf16 v[96:111], v[224:227], v[28:31], v[96:111]
  v_mfma_f32_32x32x16_bf16 v[112:127], v[28:31], v[228:231], v[112:127]
  s_add_u32 s29, s27, 19456
  buffer_load_dwordx4 v[28:31], v2, s[8:11], s29 offen sc1
  ds_read_b128 v[220:223], v3 offset:5120
  ds_read_b128 v[224:227], v3 offset:46080
  ds_read_b128 v[228:231], v4 offset:21504
  s_waitcnt lgkmcnt(3)
  s_waitcnt vmcnt(15)
  v_mfma_f32_32x32x16_bf16 v[80:95], v[208:211], v[32:35], v[80:95]
  v_mfma_f32_32x32x16_bf16 v[96:111], v[212:215], v[32:35], v[96:111]
  v_mfma_f32_32x32x16_bf16 v[112:127], v[32:35], v[216:219], v[112:127]
  s_add_u32 s29, s27, 20480
  buffer_load_dwordx4 v[32:35], v2, s[8:11], s29 offen sc1
  ds_read_b128 v[208:211], v3 offset:6144
  ds_read_b128 v[212:215], v3 offset:47104
  ds_read_b128 v[216:219], v4 offset:22528
  s_waitcnt lgkmcnt(3)
  s_waitcnt vmcnt(15)
  v_mfma_f32_32x32x16_bf16 v[80:95], v[220:223], v[36:39], v[80:95]
  v_mfma_f32_32x32x16_bf16 v[96:111], v[224:227], v[36:39], v[96:111]
  v_mfma_f32_32x32x16_bf16 v[112:127], v[36:39], v[228:231], v[112:127]
  s_add_u32 s29, s27, 21504
  buffer_load_dwordx4 v[36:39], v2, s[8:11], s29 offen sc1
  ds_read_b128 v[220:223], v3 offset:7168
  ds_read_b128 v[224:227], v3 offset:48128
  ds_read_b128 v[228:231], v4 offset:23552
  s_waitcnt lgkmcnt(3)
  s_waitcnt vmcnt(15)
  v_mfma_f32_32x32x16_bf16 v[80:95], v[208:211], v[40:43], v[80:95]
  v_mfma_f32_32x32x16_bf16 v[96:111], v[212:215], v[40:43], v[96:111]
  v_mfma_f32_32x32x16_bf16 v[112:127], v[40:43], v[216:219], v[112:127]
  s_add_u32 s29, s27, 22528
  buffer_load_dwordx4 v[40:43], v2, s[8:11], s29 offen sc1
  ds_read_b128 v[208:211], v3 offset:8192
  ds_read_b128 v[212:215], v3 offset:49152
  ds_read_b128 v[216:219], v4 offset:24576
  s_waitcnt lgkmcnt(3)
  s_waitcnt vmcnt(15)
  v_mfma_f32_32x32x16_bf16 v[80:95], v[220:223], v[44:47], v[80:95]
  v_mfma_f32_32x32x16_bf16 v[96:111], v[224:227], v[44:47], v[96:111]
  v_mfma_f32_32x32x16_bf16 v[112:127], v[44:47], v[228:231], v[112:127]
  s_add_u32 s29, s27, 23552
  buffer_load_dwordx4 v[44:47], v2, s[8:11], s29 offen sc1
  ds_read_b128 v[220:223], v3 offset:9216
  ds_read_b128 v[224:227], v3 offset:50176
  ds_read_b128 v[228:231], v4 offset:25600
  s_waitcnt lgkmcnt(3)
  s_waitcnt vmcnt(15)
  v_mfma_f32_32x32x16_bf16 v[80:95], v[208:211], v[48:51], v[80:95]
  v_mfma_f32_32x32x16_bf16 v[96:111], v[212:215], v[48:51], v[96:111]
  v_mfma_f32_32x32x16_bf16 v[112:127], v[48:51], v[216:219], v[112:127]
  s_add_u32 s29, s27, 24576
  buffer_load_dwordx4 v[48:51], v2, s[8:11], s29 offen sc1
  ds_read_b128 v[208:211], v3 offset:10240
  ds_read_b128 v[212:215], v3 offset:51200
  ds_read_b128 v[216:219], v4 offset:26624
  s_waitcnt lgkmcnt(3)
  s_waitcnt vmcnt(15)
  v_mfma_f32_32x32x16_bf16 v[80:95], v[220:223], v[52:55], v[80:95]
  v_mfma_f32_32x32x16_bf16 v[96:111], v[224:227], v[52:55], v[96:111]
  v_mfma_f32_32x32x16_bf16 v[112:127], v[52:55], v[228:231], v[112:127]
  s_add_u32 s29, s27, 25600
  buffer_load_dwordx4 v[52:55], v2, s[8:11], s29 offen sc1
  ds_read_b128 v[220:223], v3 offset:11264
  ds_read_b128 v[224:227], v3 offset:52224
  ds_read_b128 v[228:231], v4 offset:27648
  s_waitcnt lgkmcnt(3)
  s_waitcnt vmcnt(15)
  v_mfma_f32_32x32x16_bf16 v[80:95], v[208:211], v[56:59], v[80:95]
  v_mfma_f32_32x32x16_bf16 v[96:111], v[212:215], v[56:59], v[96:111]
  v_mfma_f32_32x32x16_bf16 v[112:127], v[56:59], v[216:219], v[112:127]
  s_add_u32 s29, s27, 26624
  buffer_load_dwordx4 v[56:59], v2, s[8:11], s29 offen sc1
  ds_read_b128 v[208:211], v3 offset:12288
  ds_read_b128 v[212:215], v3 offset:53248
  ds_read_b128 v[216:219], v4 offset:28672
  s_waitcnt lgkmcnt(3)
  s_waitcnt vmcnt(15)
  v_mfma_f32_32x32x16_bf16 v[80:95], v[220:223], v[60:63], v[80:95]
  v_mfma_f32_32x32x16_bf16 v[96:111], v[224:227], v[60:63], v[96:111]
  v_mfma_f32_32x32x16_bf16 v[112:127], v[60:63], v[228:231], v[112:127]
  s_add_u32 s29, s27, 27648
  buffer_load_dwordx4 v[60:63], v2, s[8:11], s29 offen sc1
  ds_read_b128 v[220:223], v3 offset:13312
  ds_read_b128 v[224:227], v3 offset:54272
  ds_read_b128 v[228:231], v4 offset:29696
  s_waitcnt lgkmcnt(3)
  s_waitcnt vmcnt(15)
  v_mfma_f32_32x32x16_bf16 v[80:95], v[208:211], v[64:67], v[80:95]
  v_mfma_f32_32x32x16_bf16 v[96:111], v[212:215], v[64:67], v[96:111]
  v_mfma_f32_32x32x16_bf16 v[112:127], v[64:67], v[216:219], v[112:127]
  s_add_u32 s29, s27, 28672
  buffer_load_dwordx4 v[64:67], v2, s[8:11], s29 offen sc1
  ds_read_b128 v[208:211], v3 offset:14336
  ds_read_b128 v[212:215], v3 offset:55296
  ds_read_b128 v[216:219], v4 offset:30720
  s_waitcnt lgkmcnt(3)
  s_waitcnt vmcnt(15)
  v_mfma_f32_32x32x16_bf16 v[80:95], v[220:223], v[68:71], v[80:95]
  v_mfma_f32_32x32x16_bf16 v[96:111], v[224:227], v[68:71], v[96:111]
  v_mfma_f32_32x32x16_bf16 v[112:127], v[68:71], v[228:231], v[112:127]
  s_add_u32 s29, s27, 29696
  buffer_load_dwordx4 v[68:71], v2, s[8:11], s29 offen sc1
  ds_read_b128 v[220:223], v3 offset:15360
  ds_read_b128 v[224:227], v3 offset:56320
  ds_read_b128 v[228:231], v4 offset:31744
  s_waitcnt lgkmcnt(3)
  s_waitcnt vmcnt(15)
  v_mfma_f32_32x32x16_bf16 v[80:95], v[208:211], v[72:75], v[80:95]
  v_mfma_f32_32x32x16_bf16 v[96:111], v[212:215], v[72:75], v[96:111]
  v_mfma_f32_32x32x16_bf16 v[112:127], v[72:75], v[216:219], v[112:127]
  s_add_u32 s29, s27, 30720
  buffer_load_dwordx4 v[72:75], v2, s[8:11], s29 offen sc1
  ds_read_b128 v[208:211], v3 offset:16384
  ds_read_b128 v[212:215], v3 offset:57344
  ds_read_b128 v[216:219], v4 offset:32768
  s_waitcnt lgkmcnt(3)
  s_waitcnt vmcnt(15)
  v_mfma_f32_32x32x16_bf16 v[80:95], v[220:223], v[76:79], v[80:95]
  v_mfma_f32_32x32x16_bf16 v[96:111], v[224:227], v[76:79], v[96:111]
  v_mfma_f32_32x32x16_bf16 v[112:127], v[76:79], v[228:231], v[112:127]
  s_add_u32 s29, s27, 31744
  buffer_load_dwordx4 v[76:79], v2, s[8:11], s29 offen sc1
  ds_read_b128 v[220:223], v3 offset:17408
  ds_read_b128 v[224:227], v3 offset:58368
  ds_read_b128 v[228:231], v4 offset:33792
  s_waitcnt lgkmcnt(3)
  s_waitcnt vmcnt(15)
  v_mfma_f32_32x32x16_bf16 v[80:95], v[208:211], v[16:19], v[80:95]
  v_mfma_f32_32x32x16_bf16 v[96:111], v[212:215], v[16:19], v[96:111]
  v_mfma_f32_32x32x16_bf16 v[112:127], v[16:19], v[216:219], v[112:127]
  s_add_u32 s29, s27, 32768
  buffer_load_dwordx4 v[16:19], v2, s[8:11], s29 offen sc1
  ds_read_b128 v[208:211], v3 offset:18432
  ds_read_b128 v[212:215], v3 offset:59392
  ds_read_b128 v[216:219], v4 offset:34816
  s_waitcnt lgkmcnt(3)
  s_waitcnt vmcnt(15)
  v_mfma_f32_32x32x16_bf16 v[80:95], v[220:223], v[20:23], v[80:95]
  v_mfma_f32_32x32x16_bf16 v[96:111], v[224:227], v[20:23], v[96:111]
  v_mfma_f32_32x32x16_bf16 v[112:127], v[20:23], v[228:231], v[112:127]
  s_add_u32 s29, s27, 33792
  buffer_load_dwordx4 v[20:23], v2, s[8:11], s29 offen sc1
  ds_read_b128 v[220:223], v3 offset:19456
  ds_read_b128 v[224:227], v3 offset:60416
  ds_read_b128 v[228:231], v4 offset:35840
  s_waitcnt lgkmcnt(3)
  s_waitcnt vmcnt(15)
  v_mfma_f32_32x32x16_bf16 v[80:95], v[208:211], v[24:27], v[80:95]
  v_mfma_f32_32x32x16_bf16 v[96:111], v[212:215], v[24:27], v[96:111]
  v_mfma_f32_32x32x16_bf16 v[112:127], v[24:27], v[216:219], v[112:127]
  s_add_u32 s29, s27, 34816
  buffer_load_dwordx4 v[24:27], v2, s[8:11], s29 offen sc1
  ds_read_b128 v[208:211], v3 offset:20480
  ds_read_b128 v[212:215], v3 offset:61440
  ds_read_b128 v[216:219], v4 offset:36864
  s_waitcnt lgkmcnt(3)
  s_waitcnt vmcnt(15)
  v_mfma_f32_32x32x16_bf16 v[80:95], v[220:223], v[28:31], v[80:95]
  v_mfma_f32_32x32x16_bf16 v[96:111], v[224:227], v[28:31], v[96:111]
  v_mfma_f32_32x32x16_bf16 v[112:127], v[28:31], v[228:231], v[112:127]
  s_add_u32 s29, s27, 35840
  buffer_load_dwordx4 v[28:31], v2, s[8:11], s29 offen sc1
  ds_read_b128 v[220:223], v3 offset:21504
  ds_read_b128 v[224:227], v3 offset:62464
  ds_read_b128 v[228:231], v4 offset:37888
  s_waitcnt lgkmcnt(3)
  s_waitcnt vmcnt(15)
  v_mfma_f32_32x32x16_bf16 v[80:95], v[208:211], v[32:35], v[80:95]
  v_mfma_f32_32x32x16_bf16 v[96:111], v[212:215], v[32:35], v[96:111]
  v_mfma_f32_32x32x16_bf16 v[112:127], v[32:35], v[216:219], v[112:127]
  s_add_u32 s29, s27, 36864
  buffer_load_dwordx4 v[32:35], v2, s[8:11], s29 offen sc1
  ds_read_b128 v[208:211], v3 offset:22528
  ds_read_b128 v[212:215], v3 offset:63488
  ds_read_b128 v[216:219], v4 offset:38912
  s_waitcnt lgkmcnt(3)
  s_waitcnt vmcnt(15)
  v_mfma_f32_32x32x16_bf16 v[80:95], v[220:223], v[36:39], v[80:95]
  v_mfma_f32_32x32x16_bf16 v[96:111], v[224:227], v[36:39], v[96:111]
  v_mfma_f32_32x32x16_bf16 v[112:127], v[36:39], v[228:231], v[112:127]
  s_add_u32 s29, s27, 37888
  buffer_load_dwordx4 v[36:39], v2, s[8:11], s29 offen sc1
  ds_read_b128 v[220:223], v3 offset:23552
  ds_read_b128 v[224:227], v3 offset:64512
  ds_read_b128 v[228:231], v4 offset:39936
  s_waitcnt lgkmcnt(3)
  s_waitcnt vmcnt(15)
  v_mfma_f32_32x32x16_bf16 v[80:95], v[208:211], v[40:43], v[80:95]
  v_mfma_f32_32x32x16_bf16 v[96:111], v[212:215], v[40:43], v[96:111]
  v_mfma_f32_32x32x16_bf16 v[112:127], v[40:43], v[216:219], v[112:127]
  s_add_u32 s29, s27, 38912
  buffer_load_dwordx4 v[40:43], v2, s[8:11], s29 offen sc1
  ds_read_b128 v[208:211], v3 offset:24576
  ds_read_b128 v[212:215], v4 offset:0
  ds_read_b128 v[216:219], v4 offset:40960
  s_waitcnt lgkmcnt(3)
  s_waitcnt vmcnt(15)
  v_mfma_f32_32x32x16_bf16 v[80:95], v[220:223], v[44:47], v[80:95]
  v_mfma_f32_32x32x16_bf16 v[96:111], v[224:227], v[44:47], v[96:111]
  v_mfma_f32_32x32x16_bf16 v[112:127], v[44:47], v[228:231], v[112:127]
  s_add_u32 s29, s27, 39936
  buffer_load_dwordx4 v[44:47], v2, s[8:11], s29 offen sc1
  ds_read_b128 v[220:223], v3 offset:25600
  ds_read_b128 v[224:227], v4 offset:1024
  ds_read_b128 v[228:231], v4 offset:41984
  s_waitcnt lgkmcnt(3)
  s_waitcnt vmcnt(15)
  v_mfma_f32_32x32x16_bf16 v[80:95], v[208:211], v[48:51], v[80:95]
  v_mfma_f32_32x32x16_bf16 v[96:111], v[212:215], v[48:51], v[96:111]
  v_mfma_f32_32x32x16_bf16 v[112:127], v[48:51], v[216:219], v[112:127]
  s_add_u32 s29, s28, 0
  buffer_load_dwordx4 v[48:51], v2, s[8:11], s29 offen sc1
  ds_read_b128 v[208:211], v3 offset:26624
  ds_read_b128 v[212:215], v4 offset:2048
  ds_read_b128 v[216:219], v4 offset:43008
  s_waitcnt lgkmcnt(3)
  s_waitcnt vmcnt(15)
  v_mfma_f32_32x32x16_bf16 v[80:95], v[220:223], v[52:55], v[80:95]
  v_mfma_f32_32x32x16_bf16 v[96:111], v[224:227], v[52:55], v[96:111]
  v_mfma_f32_32x32x16_bf16 v[112:127], v[52:55], v[228:231], v[112:127]
  s_add_u32 s29, s28, 1024
  buffer_load_dwordx4 v[52:55], v2, s[8:11], s29 offen sc1
  ds_read_b128 v[220:223], v3 offset:27648
  ds_read_b128 v[224:227], v4 offset:3072
  ds_read_b128 v[228:231], v4 offset:44032
  s_waitcnt lgkmcnt(3)
  s_waitcnt vmcnt(15)
  v_mfma_f32_32x32x16_bf16 v[80:95], v[208:211], v[56:59], v[80:95]
  v_mfma_f32_32x32x16_bf16 v[96:111], v[212:215], v[56:59], v[96:111]
  v_mfma_f32_32x32x16_bf16 v[112:127], v[56:59], v[216:219], v[112:127]
  s_add_u32 s29, s28, 2048
  buffer_load_dwordx4 v[56:59], v2, s[8:11], s29 offen sc1
  ds_read_b128 v[208:211], v3 offset:28672
  ds_read_b128 v[212:215], v4 offset:4096
  ds_read_b128 v[216:219], v4 offset:45056
  s_waitcnt lgkmcnt(3)
  s_waitcnt vmcnt(15)
  v_mfma_f32_32x32x16_bf16 v[80:95], v[220:223], v[60:63], v[80:95]
  v_mfma_f32_32x32x16_bf16 v[96:111], v[224:227], v[60:63], v[96:111]
  v_mfma_f32_32x32x16_bf16 v[112:127], v[60:63], v[228:231], v[112:127]
  s_add_u32 s29, s28, 3072
  buffer_load_dwordx4 v[60:63], v2, s[8:11], s29 offen sc1
  ds_read_b128 v[220:223], v3 offset:29696
  ds_read_b128 v[224:227], v4 offset:5120
  ds_read_b128 v[228:231], v4 offset:46080
  s_waitcnt lgkmcnt(3)
  s_waitcnt vmcnt(15)
  v_mfma_f32_32x32x16_bf16 v[80:95], v[208:211], v[64:67], v[80:95]
  v_mfma_f32_32x32x16_bf16 v[96:111], v[212:215], v[64:67], v[96:111]
  v_mfma_f32_32x32x16_bf16 v[112:127], v[64:67], v[216:219], v[112:127]
  s_add_u32 s29, s28, 4096
  buffer_load_dwordx4 v[64:67], v2, s[8:11], s29 offen sc1
  ds_read_b128 v[208:211], v3 offset:30720
  ds_read_b128 v[212:215], v4 offset:6144
  ds_read_b128 v[216:219], v4 offset:47104
  s_waitcnt lgkmcnt(3)
  s_waitcnt vmcnt(15)
  v_mfma_f32_32x32x16_bf16 v[80:95], v[220:223], v[68:71], v[80:95]
  v_mfma_f32_32x32x16_bf16 v[96:111], v[224:227], v[68:71], v[96:111]
  v_mfma_f32_32x32x16_bf16 v[112:127], v[68:71], v[228:231], v[112:127]
  s_add_u32 s29, s28, 5120
  buffer_load_dwordx4 v[68:71], v2, s[8:11], s29 offen sc1
  ds_read_b128 v[220:223], v3 offset:31744
  ds_read_b128 v[224:227], v4 offset:7168
  ds_read_b128 v[228:231], v4 offset:48128
  s_waitcnt lgkmcnt(3)
  s_waitcnt vmcnt(15)
  v_mfma_f32_32x32x16_bf16 v[80:95], v[208:211], v[72:75], v[80:95]
  v_mfma_f32_32x32x16_bf16 v[96:111], v[212:215], v[72:75], v[96:111]
  v_mfma_f32_32x32x16_bf16 v[112:127], v[72:75], v[216:219], v[112:127]
  s_add_u32 s29, s28, 6144
  buffer_load_dwordx4 v[72:75], v2, s[8:11], s29 offen sc1
  ds_read_b128 v[208:211], v3 offset:32768
  ds_read_b128 v[212:215], v4 offset:8192
  ds_read_b128 v[216:219], v4 offset:49152
  s_waitcnt lgkmcnt(3)
  s_waitcnt vmcnt(15)
  v_mfma_f32_32x32x16_bf16 v[80:95], v[220:223], v[76:79], v[80:95]
  v_mfma_f32_32x32x16_bf16 v[96:111], v[224:227], v[76:79], v[96:111]
  v_mfma_f32_32x32x16_bf16 v[112:127], v[76:79], v[228:231], v[112:127]
  s_add_u32 s29, s28, 7168
  buffer_load_dwordx4 v[76:79], v2, s[8:11], s29 offen sc1
  ds_read_b128 v[220:223], v3 offset:33792
  ds_read_b128 v[224:227], v4 offset:9216
  ds_read_b128 v[228:231], v4 offset:50176
  s_waitcnt lgkmcnt(3)
  s_waitcnt vmcnt(15)
  v_mfma_f32_32x32x16_bf16 v[80:95], v[208:211], v[16:19], v[80:95]
  v_mfma_f32_32x32x16_bf16 v[96:111], v[212:215], v[16:19], v[96:111]
  v_mfma_f32_32x32x16_bf16 v[112:127], v[16:19], v[216:219], v[112:127]
  s_add_u32 s29, s28, 8192
  buffer_load_dwordx4 v[16:19], v2, s[8:11], s29 offen sc1
  ds_read_b128 v[208:211], v3 offset:34816
  ds_read_b128 v[212:215], v4 offset:10240
  ds_read_b128 v[216:219], v4 offset:51200
  s_waitcnt lgkmcnt(3)
  s_waitcnt vmcnt(15)
  v_mfma_f32_32x32x16_bf16 v[80:95], v[220:223], v[20:23], v[80:95]
  v_mfma_f32_32x32x16_bf16 v[96:111], v[224:227], v[20:23], v[96:111]
  v_mfma_f32_32x32x16_bf16 v[112:127], v[20:23], v[228:231], v[112:127]
  s_add_u32 s29, s28, 9216
  buffer_load_dwordx4 v[20:23], v2, s[8:11], s29 offen sc1
  ds_read_b128 v[220:223], v3 offset:35840
  ds_read_b128 v[224:227], v4 offset:11264
  ds_read_b128 v[228:231], v4 offset:52224
  s_waitcnt lgkmcnt(3)
  s_waitcnt vmcnt(15)
  v_mfma_f32_32x32x16_bf16 v[80:95], v[208:211], v[24:27], v[80:95]
  v_mfma_f32_32x32x16_bf16 v[96:111], v[212:215], v[24:27], v[96:111]
  v_mfma_f32_32x32x16_bf16 v[112:127], v[24:27], v[216:219], v[112:127]
  s_add_u32 s29, s28, 10240
  buffer_load_dwordx4 v[24:27], v2, s[8:11], s29 offen sc1
  ds_read_b128 v[208:211], v3 offset:36864
  ds_read_b128 v[212:215], v4 offset:12288
  ds_read_b128 v[216:219], v4 offset:53248
  s_waitcnt lgkmcnt(3)
  s_waitcnt vmcnt(15)
  v_mfma_f32_32x32x16_bf16 v[80:95], v[220:223], v[28:31], v[80:95]
  v_mfma_f32_32x32x16_bf16 v[96:111], v[224:227], v[28:31], v[96:111]
  v_mfma_f32_32x32x16_bf16 v[112:127], v[28:31], v[228:231], v[112:127]
  s_add_u32 s29, s28, 11264
  buffer_load_dwordx4 v[28:31], v2, s[8:11], s29 offen sc1
  ds_read_b128 v[220:223], v3 offset:37888
  ds_read_b128 v[224:227], v4 offset:13312
  ds_read_b128 v[228:231], v4 offset:54272
  s_waitcnt lgkmcnt(3)
  s_waitcnt vmcnt(15)
  v_mfma_f32_32x32x16_bf16 v[80:95], v[208:211], v[32:35], v[80:95]
  v_mfma_f32_32x32x16_bf16 v[96:111], v[212:215], v[32:35], v[96:111]
  v_mfma_f32_32x32x16_bf16 v[112:127], v[32:35], v[216:219], v[112:127]
  s_add_u32 s29, s28, 12288
  buffer_load_dwordx4 v[32:35], v2, s[8:11], s29 offen sc1
  ds_read_b128 v[208:211], v3 offset:38912
  ds_read_b128 v[212:215], v4 offset:14336
  ds_read_b128 v[216:219], v4 offset:55296
  s_waitcnt lgkmcnt(3)
  s_waitcnt vmcnt(15)
  v_mfma_f32_32x32x16_bf16 v[80:95], v[220:223], v[36:39], v[80:95]
  v_mfma_f32_32x32x16_bf16 v[96:111], v[224:227], v[36:39], v[96:111]
  v_mfma_f32_32x32x16_bf16 v[112:127], v[36:39], v[228:231], v[112:127]
  s_add_u32 s29, s28, 13312
  buffer_load_dwordx4 v[36:39], v2, s[8:11], s29 offen sc1
  ds_read_b128 v[220:223], v3 offset:39936
  ds_read_b128 v[224:227], v4 offset:15360
  ds_read_b128 v[228:231], v4 offset:56320
  s_waitcnt lgkmcnt(3)
  s_waitcnt vmcnt(15)
  v_mfma_f32_32x32x16_bf16 v[80:95], v[208:211], v[40:43], v[80:95]
  v_mfma_f32_32x32x16_bf16 v[96:111], v[212:215], v[40:43], v[96:111]
  v_mfma_f32_32x32x16_bf16 v[112:127], v[40:43], v[216:219], v[112:127]
  s_add_u32 s29, s28, 14336
  buffer_load_dwordx4 v[40:43], v2, s[8:11], s29 offen sc1
  ds_read_b128 v[208:211], v3 offset:0
  ds_read_b128 v[212:215], v3 offset:40960
  ds_read_b128 v[216:219], v4 offset:16384
  s_waitcnt lgkmcnt(3)
  s_waitcnt vmcnt(15)
  v_mfma_f32_32x32x16_bf16 v[80:95], v[220:223], v[44:47], v[80:95]
  v_mfma_f32_32x32x16_bf16 v[96:111], v[224:227], v[44:47], v[96:111]
  v_mfma_f32_32x32x16_bf16 v[112:127], v[44:47], v[228:231], v[112:127]
  s_add_u32 s29, s28, 15360
  buffer_load_dwordx4 v[44:47], v2, s[8:11], s29 offen sc1
  ds_read_b128 v[220:223], v3 offset:1024
  ds_read_b128 v[224:227], v3 offset:41984
  ds_read_b128 v[228:231], v4 offset:17408
  s_waitcnt lgkmcnt(3)
  s_waitcnt vmcnt(15)
  v_mfma_f32_32x32x16_bf16 v[128:143], v[208:211], v[48:51], 0
  v_mfma_f32_32x32x16_bf16 v[144:159], v[212:215], v[48:51], 0
  v_mfma_f32_32x32x16_bf16 v[160:175], v[48:51], v[216:219], 0
  s_add_u32 s29, s28, 16384
  buffer_load_dwordx4 v[48:51], v2, s[8:11], s29 offen sc1
  ds_read_b128 v[208:211], v3 offset:2048
  ds_read_b128 v[212:215], v3 offset:43008
  ds_read_b128 v[216:219], v4 offset:18432
  s_waitcnt lgkmcnt(3)
  s_waitcnt vmcnt(15)
  v_mfma_f32_32x32x16_bf16 v[128:143], v[220:223], v[52:55], v[128:143]
  v_mfma_f32_32x32x16_bf16 v[144:159], v[224:227], v[52:55], v[144:159]
  v_mfma_f32_32x32x16_bf16 v[160:175], v[52:55], v[228:231], v[160:175]
  s_add_u32 s29, s28, 17408
  buffer_load_dwordx4 v[52:55], v2, s[8:11], s29 offen sc1
  ds_read_b128 v[220:223], v3 offset:3072
  ds_read_b128 v[224:227], v3 offset:44032
  ds_read_b128 v[228:231], v4 offset:19456
  s_waitcnt lgkmcnt(3)
  s_waitcnt vmcnt(15)
  v_mfma_f32_32x32x16_bf16 v[128:143], v[208:211], v[56:59], v[128:143]
  v_max3_f32 v9, v9, abs(v96), abs(v97)
  v_max3_f32 v9, v9, abs(v98), abs(v99)
  v_mfma_f32_32x32x16_bf16 v[144:159], v[212:215], v[56:59], v[144:159]
  v_max3_f32 v9, v9, abs(v100), abs(v101)
  v_max3_f32 v9, v9, abs(v102), abs(v103)
  v_mfma_f32_32x32x16_bf16 v[160:175], v[56:59], v[216:219], v[160:175]
  v_max3_f32 v9, v9, abs(v104), abs(v105)
  v_max3_f32 v9, v9, abs(v106), abs(v107)
  s_add_u32 s29, s28, 18432
  buffer_load_dwordx4 v[56:59], v2, s[8:11], s29 offen sc1
  ds_read_b128 v[208:211], v3 offset:4096
  ds_read_b128 v[212:215], v3 offset:45056
  ds_read_b128 v[216:219], v4 offset:20480
  s_waitcnt lgkmcnt(3)
  s_waitcnt vmcnt(15)
  v_mfma_f32_32x32x16_bf16 v[128:143], v[220:223], v[60:63], v[128:143]
  v_max3_f32 v9, v9, abs(v108), abs(v109)
  v_max3_f32 v9, v9, abs(v110), abs(v111)
  v_mfma_f32_32x32x16_bf16 v[144:159], v[224:227], v[60:63], v[144:159]
  v_add_f32 v108, v108, v6
  v_cvt_pk_bf16_f32 v232, v96, v97
  v_mfma_f32_32x32x16_bf16 v[160:175], v[60:63], v[228:231], v[160:175]
  v_cvt_pk_bf16_f32 v233, v98, v99
  v_cvt_pk_bf16_f32 v234, v100, v101
  s_add_u32 s29, s28, 19456
  buffer_load_dwordx4 v[60:63], v2, s[8:11], s29 offen sc1
  ds_read_b128 v[220:223], v3 offset:5120
  ds_read_b128 v[224:227], v3 offset:46080
  ds_read_b128 v[228:231], v4 offset:21504
  s_waitcnt lgkmcnt(3)
  s_waitcnt vmcnt(15)
  v_mfma_f32_32x32x16_bf16 v[128:143], v[208:211], v[64:67], v[128:143]
  v_cvt_pk_bf16_f32 v235, v102, v103
  v_cvt_pk_bf16_f32 v236, v104, v105
  v_mfma_f32_32x32x16_bf16 v[144:159], v[212:215], v[64:67], v[144:159]
  v_cvt_pk_bf16_f32 v237, v106, v107
  v_cvt_pk_bf16_f32 v238, v108, v109
  v_mfma_f32_32x32x16_bf16 v[160:175], v[64:67], v[216:219], v[160:175]
  v_cvt_pk_bf16_f32 v239, v110, v111
  s_add_u32 s26, s31, 245366784
  s_add_u32 s29, s28, 20480
  buffer_load_dwordx4 v[64:67], v2, s[8:11], s29 offen sc1
  ds_read_b128 v[208:211], v3 offset:6144
  ds_read_b128 v[212:215], v3 offset:47104
  ds_read_b128 v[216:219], v4 offset:22528
  s_waitcnt lgkmcnt(3)
  s_waitcnt vmcnt(15)
  v_mfma_f32_32x32x16_bf16 v[128:143], v[220:223], v[68:71], v[128:143]
  buffer_store_dwordx4 v[232:235], v2, s[8:11], s26 offen sc1
  buffer_store_dwordx4 v[236:239], v2, s[8:11], s26 offen offset:1024 sc1
  v_mfma_f32_32x32x16_bf16 v[144:159], v[224:227], v[68:71], v[144:159]
  v_cndmask_b32 v112, v112, v8, s[32:33]
  v_cndmask_b32 v113, v113, v8, s[32:33]
  v_mfma_f32_32x32x16_bf16 v[160:175], v[68:71], v[228:231], v[160:175]
  v_cndmask_b32 v114, v114, v8, s[32:33]
  v_cndmask_b32 v115, v115, v8, s[32:33]
  s_add_u32 s29, s28, 21504
  buffer_load_dwordx4 v[68:71], v2, s[8:11], s29 offen sc1
  ds_read_b128 v[220:223], v3 offset:7168
  ds_read_b128 v[224:227], v3 offset:48128
  ds_read_b128 v[228:231], v4 offset:23552
  s_waitcnt lgkmcnt(3)
  s_waitcnt vmcnt(17)
  v_mfma_f32_32x32x16_bf16 v[128:143], v[208:211], v[72:75], v[128:143]
  v_cndmask_b32 v116, v116, v8, s[32:33]
  v_cndmask_b32 v117, v117, v8, s[32:33]
  v_mfma_f32_32x32x16_bf16 v[144:159], v[212:215], v[72:75], v[144:159]
  v_cndmask_b32 v118, v118, v8, s[32:33]
  v_cndmask_b32 v119, v119, v8, s[32:33]
  v_mfma_f32_32x32x16_bf16 v[160:175], v[72:75], v[216:219], v[160:175]
  v_cndmask_b32 v120, v120, v8, s[32:33]
  v_cndmask_b32 v121, v121, v8, s[32:33]
  s_add_u32 s29, s28, 22528
  buffer_load_dwordx4 v[72:75], v2, s[8:11], s29 offen sc1
  ds_read_b128 v[208:211], v3 offset:8192
  ds_read_b128 v[212:215], v3 offset:49152
  ds_read_b128 v[216:219], v4 offset:24576
  s_waitcnt lgkmcnt(3)
  s_waitcnt vmcnt(17)
  v_mfma_f32_32x32x16_bf16 v[128:143], v[220:223], v[76:79], v[128:143]
  v_cndmask_b32 v122, v122, v8, s[32:33]
  v_cndmask_b32 v123, v123, v8, s[32:33]
  v_mfma_f32_32x32x16_bf16 v[144:159], v[224:227], v[76:79], v[144:159]
  v_cndmask_b32 v124, v124, v8, s[32:33]
  v_cndmask_b32 v125, v125, v8, s[32:33]
  v_mfma_f32_32x32x16_bf16 v[160:175], v[76:79], v[228:231], v[160:175]
  v_cndmask_b32 v126, v126, v8, s[32:33]
  v_cndmask_b32 v127, v127, v8, s[32:33]
  s_add_u32 s29, s28, 23552
  buffer_load_dwordx4 v[76:79], v2, s[8:11], s29 offen sc1
  ds_read_b128 v[220:223], v3 offset:9216
  ds_read_b128 v[224:227], v3 offset:50176
  ds_read_b128 v[228:231], v4 offset:25600
  s_waitcnt lgkmcnt(3)
  s_waitcnt vmcnt(17)
  v_mfma_f32_32x32x16_bf16 v[128:143], v[208:211], v[16:19], v[128:143]
  v_cvt_pk_bf16_f32 v240, v112, v113
  v_cvt_pk_bf16_f32 v241, v114, v115
  v_mfma_f32_32x32x16_bf16 v[144:159], v[212:215], v[16:19], v[144:159]
  v_cvt_pk_bf16_f32 v242, v116, v117
  v_cvt_pk_bf16_f32 v243, v118, v119
  v_mfma_f32_32x32x16_bf16 v[160:175], v[16:19], v[216:219], v[160:175]
  v_cvt_pk_bf16_f32 v244, v120, v121
  v_cvt_pk_bf16_f32 v245, v122, v123
  s_add_u32 s29, s28, 24576
  buffer_load_dwordx4 v[16:19], v2, s[8:11], s29 offen sc1
  ds_read_b128 v[208:211], v3 offset:10240
  ds_read_b128 v[212:215], v3 offset:51200
  ds_read_b128 v[216:219], v4 offset:26624
  s_waitcnt lgkmcnt(3)
  s_waitcnt vmcnt(17)
  v_mfma_f32_32x32x16_bf16 v[128:143], v[220:223], v[20:23], v[128:143]
  v_cvt_pk_bf16_f32 v246, v124, v125
  v_cvt_pk_bf16_f32 v247, v126, v127
  v_mfma_f32_32x32x16_bf16 v[144:159], v[224:227], v[20:23], v[144:159]
  s_add_u32 s26, s31, 249561088
  buffer_store_dwordx4 v[240:243], v2, s[8:11], s26 offen sc1
  v_mfma_f32_32x32x16_bf16 v[160:175], v[20:23], v[228:231], v[160:175]
  buffer_store_dwordx4 v[244:247], v2, s[8:11], s26 offen offset:1024 sc1
  v_mul_f32 v80, s30, v80
  s_add_u32 s29, s28, 25600
  buffer_load_dwordx4 v[20:23], v2, s[8:11], s29 offen sc1
  ds_read_b128 v[220:223], v3 offset:11264
  ds_read_b128 v[224:227], v3 offset:52224
  ds_read_b128 v[228:231], v4 offset:27648
  s_waitcnt lgkmcnt(3)
  s_waitcnt vmcnt(19)
  v_mfma_f32_32x32x16_bf16 v[128:143], v[208:211], v[24:27], v[128:143]
  v_mul_f32 v81, s30, v81
  v_mul_f32 v82, s30, v82
  v_mfma_f32_32x32x16_bf16 v[144:159], v[212:215], v[24:27], v[144:159]
  v_mul_f32 v83, s30, v83
  v_mul_f32 v84, s30, v84
  v_mfma_f32_32x32x16_bf16 v[160:175], v[24:27], v[216:219], v[160:175]
  v_mul_f32 v85, s30, v85
  v_mul_f32 v86, s30, v86
  s_add_u32 s29, s28, 26624
  buffer_load_dwordx4 v[24:27], v2, s[8:11], s29 offen sc1
  ds_read_b128 v[208:211], v3 offset:12288
  ds_read_b128 v[212:215], v3 offset:53248
  ds_read_b128 v[216:219], v4 offset:28672
  s_waitcnt lgkmcnt(3)
  s_waitcnt vmcnt(19)
  v_mfma_f32_32x32x16_bf16 v[128:143], v[220:223], v[28:31], v[128:143]
  v_mul_f32 v87, s30, v87
  v_mul_f32 v88, s30, v88
  v_mfma_f32_32x32x16_bf16 v[144:159], v[224:227], v[28:31], v[144:159]
  v_mul_f32 v89, s30, v89
  v_mul_f32 v90, s30, v90
  v_mfma_f32_32x32x16_bf16 v[160:175], v[28:31], v[228:231], v[160:175]
  v_mul_f32 v91, s30, v91
  v_mul_f32 v92, s30, v92
  s_add_u32 s29, s28, 27648
  buffer_load_dwordx4 v[28:31], v2, s[8:11], s29 offen sc1
  ds_read_b128 v[220:223], v3 offset:13312
  ds_read_b128 v[224:227], v3 offset:54272
  ds_read_b128 v[228:231], v4 offset:29696
  s_waitcnt lgkmcnt(3)
  s_waitcnt vmcnt(19)
  v_mfma_f32_32x32x16_bf16 v[128:143], v[208:211], v[32:35], v[128:143]
  v_mul_f32 v93, s30, v93
  v_mul_f32 v94, s30, v94
  v_mfma_f32_32x32x16_bf16 v[144:159], v[212:215], v[32:35], v[144:159]
  v_mul_f32 v95, s30, v95
  v_cvt_pk_bf16_f32 v192, v80, v81
  v_mfma_f32_32x32x16_bf16 v[160:175], v[32:35], v[216:219], v[160:175]
  v_cvt_pk_bf16_f32 v193, v82, v83
  v_cvt_pk_bf16_f32 v194, v84, v85
  s_add_u32 s29, s28, 28672
  buffer_load_dwordx4 v[32:35], v2, s[8:11], s29 offen sc1
  ds_read_b128 v[208:211], v3 offset:14336
  ds_read_b128 v[212:215], v3 offset:55296
  ds_read_b128 v[216:219], v4 offset:30720
  s_waitcnt lgkmcnt(3)
  s_waitcnt vmcnt(19)
  v_mfma_f32_32x32x16_bf16 v[128:143], v[220:223], v[36:39], v[128:143]
  v_cvt_pk_bf16_f32 v195, v86, v87
  v_cvt_pk_bf16_f32 v196, v88, v89
  v_mfma_f32_32x32x16_bf16 v[144:159], v[224:227], v[36:39], v[144:159]
  v_cvt_pk_bf16_f32 v197, v90, v91
  v_cvt_pk_bf16_f32 v198, v92, v93
  v_mfma_f32_32x32x16_bf16 v[160:175], v[36:39], v[228:231], v[160:175]
  v_cvt_pk_bf16_f32 v199, v94, v95
  s_add_u32 s29, s28, 29696
  buffer_load_dwordx4 v[36:39], v2, s[8:11], s29 offen sc1
  ds_read_b128 v[220:223], v3 offset:15360
  ds_read_b128 v[224:227], v3 offset:56320
  ds_read_b128 v[228:231], v4 offset:31744
  s_waitcnt lgkmcnt(3)
  s_waitcnt vmcnt(19)
  v_mfma_f32_32x32x16_bf16 v[128:143], v[208:211], v[40:43], v[128:143]
  v_mfma_f32_32x32x16_bf16 v[144:159], v[212:215], v[40:43], v[144:159]
  v_mfma_f32_32x32x16_bf16 v[160:175], v[40:43], v[216:219], v[160:175]
  s_add_u32 s29, s28, 30720
  buffer_load_dwordx4 v[40:43], v2, s[8:11], s29 offen sc1
  ds_read_b128 v[208:211], v3 offset:16384
  ds_read_b128 v[212:215], v3 offset:57344
  ds_read_b128 v[216:219], v4 offset:32768
  s_waitcnt lgkmcnt(3)
  s_waitcnt vmcnt(19)
  v_mfma_f32_32x32x16_bf16 v[128:143], v[220:223], v[44:47], v[128:143]
  v_mfma_f32_32x32x16_bf16 v[144:159], v[224:227], v[44:47], v[144:159]
  v_mfma_f32_32x32x16_bf16 v[160:175], v[44:47], v[228:231], v[160:175]
  s_add_u32 s29, s28, 31744
  buffer_load_dwordx4 v[44:47], v2, s[8:11], s29 offen sc1
  ds_read_b128 v[220:223], v3 offset:17408
  ds_read_b128 v[224:227], v3 offset:58368
  ds_read_b128 v[228:231], v4 offset:33792
  s_waitcnt lgkmcnt(3)
  s_waitcnt vmcnt(19)
  v_mfma_f32_32x32x16_bf16 v[128:143], v[208:211], v[48:51], v[128:143]
  v_mfma_f32_32x32x16_bf16 v[144:159], v[212:215], v[48:51], v[144:159]
  v_mfma_f32_32x32x16_bf16 v[160:175], v[48:51], v[216:219], v[160:175]
  s_add_u32 s29, s28, 32768
  buffer_load_dwordx4 v[48:51], v2, s[8:11], s29 offen sc1
  ds_read_b128 v[208:211], v3 offset:18432
  ds_read_b128 v[212:215], v3 offset:59392
  ds_read_b128 v[216:219], v4 offset:34816
  s_waitcnt lgkmcnt(3)
  s_waitcnt vmcnt(19)
  v_mfma_f32_32x32x16_bf16 v[128:143], v[220:223], v[52:55], v[128:143]
  v_mfma_f32_32x32x16_bf16 v[144:159], v[224:227], v[52:55], v[144:159]
  v_mfma_f32_32x32x16_bf16 v[160:175], v[52:55], v[228:231], v[160:175]
  s_add_u32 s29, s28, 33792
  buffer_load_dwordx4 v[52:55], v2, s[8:11], s29 offen sc1
  ds_read_b128 v[220:223], v3 offset:19456
  ds_read_b128 v[224:227], v3 offset:60416
  ds_read_b128 v[228:231], v4 offset:35840
  s_waitcnt lgkmcnt(3)
  s_waitcnt vmcnt(19)
  v_mfma_f32_32x32x16_bf16 v[128:143], v[208:211], v[56:59], v[128:143]
  v_mfma_f32_32x32x16_bf16 v[144:159], v[212:215], v[56:59], v[144:159]
  v_mfma_f32_32x32x16_bf16 v[160:175], v[56:59], v[216:219], v[160:175]
  s_add_u32 s29, s28, 34816
  buffer_load_dwordx4 v[56:59], v2, s[8:11], s29 offen sc1
  ds_read_b128 v[208:211], v3 offset:20480
  ds_read_b128 v[212:215], v3 offset:61440
  ds_read_b128 v[216:219], v4 offset:36864
  s_waitcnt lgkmcnt(3)
  s_waitcnt vmcnt(19)
  v_mfma_f32_32x32x16_bf16 v[128:143], v[220:223], v[60:63], v[128:143]
  v_mfma_f32_32x32x16_bf16 v[144:159], v[224:227], v[60:63], v[144:159]
  v_mfma_f32_32x32x16_bf16 v[160:175], v[60:63], v[228:231], v[160:175]
  s_add_u32 s29, s28, 35840
  buffer_load_dwordx4 v[60:63], v2, s[8:11], s29 offen sc1
  ds_read_b128 v[220:223], v3 offset:21504
  ds_read_b128 v[224:227], v3 offset:62464
  ds_read_b128 v[228:231], v4 offset:37888
  s_waitcnt lgkmcnt(3)
  s_waitcnt vmcnt(19)
  v_mfma_f32_32x32x16_bf16 v[128:143], v[208:211], v[64:67], v[128:143]
  v_mfma_f32_32x32x16_bf16 v[144:159], v[212:215], v[64:67], v[144:159]
  v_mfma_f32_32x32x16_bf16 v[160:175], v[64:67], v[216:219], v[160:175]
  s_add_u32 s29, s28, 36864
  buffer_load_dwordx4 v[64:67], v2, s[8:11], s29 offen sc1
  ds_read_b128 v[208:211], v3 offset:22528
  ds_read_b128 v[212:215], v3 offset:63488
  ds_read_b128 v[216:219], v4 offset:38912
  s_waitcnt lgkmcnt(3)
  s_waitcnt vmcnt(17)
  v_mfma_f32_32x32x16_bf16 v[128:143], v[220:223], v[68:71], v[128:143]
  v_mfma_f32_32x32x16_bf16 v[144:159], v[224:227], v[68:71], v[144:159]
  v_mfma_f32_32x32x16_bf16 v[160:175], v[68:71], v[228:231], v[160:175]
  s_add_u32 s29, s28, 37888
  buffer_load_dwordx4 v[68:71], v2, s[8:11], s29 offen sc1
  ds_read_b128 v[220:223], v3 offset:23552
  ds_read_b128 v[224:227], v3 offset:64512
  ds_read_b128 v[228:231], v4 offset:39936
  s_waitcnt lgkmcnt(3)
  s_waitcnt vmcnt(17)
  v_mfma_f32_32x32x16_bf16 v[128:143], v[208:211], v[72:75], v[128:143]
  v_mfma_f32_32x32x16_bf16 v[144:159], v[212:215], v[72:75], v[144:159]
  v_mfma_f32_32x32x16_bf16 v[160:175], v[72:75], v[216:219], v[160:175]
  s_add_u32 s29, s28, 38912
  buffer_load_dwordx4 v[72:75], v2, s[8:11], s29 offen sc1
  ds_read_b128 v[208:211], v3 offset:24576
  ds_read_b128 v[212:215], v4 offset:0
  ds_read_b128 v[216:219], v4 offset:40960
  s_waitcnt lgkmcnt(3)
  s_waitcnt vmcnt(17)
  v_mfma_f32_32x32x16_bf16 v[128:143], v[220:223], v[76:79], v[128:143]
  v_mfma_f32_32x32x16_bf16 v[144:159], v[224:227], v[76:79], v[144:159]
  v_mfma_f32_32x32x16_bf16 v[160:175], v[76:79], v[228:231], v[160:175]
  s_add_u32 s29, s28, 39936
  buffer_load_dwordx4 v[76:79], v2, s[8:11], s29 offen sc1
  ds_read_b128 v[220:223], v3 offset:25600
  ds_read_b128 v[224:227], v4 offset:1024
  ds_read_b128 v[228:231], v4 offset:41984
  s_waitcnt lgkmcnt(3)
  s_waitcnt vmcnt(17)
  v_mfma_f32_32x32x16_bf16 v[128:143], v[208:211], v[16:19], v[128:143]
  v_mfma_f32_32x32x16_bf16 v[144:159], v[212:215], v[16:19], v[144:159]
  v_mfma_f32_32x32x16_bf16 v[160:175], v[16:19], v[216:219], v[160:175]
  ds_read_b128 v[208:211], v3 offset:26624
  ds_read_b128 v[212:215], v4 offset:2048
  ds_read_b128 v[216:219], v4 offset:43008
  s_waitcnt lgkmcnt(3)
  s_waitcnt vmcnt(14)
  v_mfma_f32_32x32x16_bf16 v[128:143], v[220:223], v[20:23], v[128:143]
  v_mfma_f32_32x32x16_bf16 v[144:159], v[224:227], v[20:23], v[144:159]
  v_mfma_f32_32x32x16_bf16 v[160:175], v[20:23], v[228:231], v[160:175]
  ds_read_b128 v[220:223], v3 offset:27648
  ds_read_b128 v[224:227], v4 offset:3072
  ds_read_b128 v[228:231], v4 offset:44032
  s_waitcnt lgkmcnt(3)
  s_waitcnt vmcnt(13)
  v_mfma_f32_32x32x16_bf16 v[128:143], v[208:211], v[24:27], v[128:143]
  v_mfma_f32_32x32x16_bf16 v[144:159], v[212:215], v[24:27], v[144:159]
  v_mfma_f32_32x32x16_bf16 v[160:175], v[24:27], v[216:219], v[160:175]
  ds_read_b128 v[208:211], v3 offset:28672
  ds_read_b128 v[212:215], v4 offset:4096
  ds_read_b128 v[216:219], v4 offset:45056
  s_waitcnt lgkmcnt(3)
  s_waitcnt vmcnt(12)
  v_mfma_f32_32x32x16_bf16 v[128:143], v[220:223], v[28:31], v[128:143]
  v_mfma_f32_32x32x16_bf16 v[144:159], v[224:227], v[28:31], v[144:159]
  v_mfma_f32_32x32x16_bf16 v[160:175], v[28:31], v[228:231], v[160:175]
  ds_read_b128 v[220:223], v3 offset:29696
  ds_read_b128 v[224:227], v4 offset:5120
  ds_read_b128 v[228:231], v4 offset:46080
  s_waitcnt lgkmcnt(3)
  s_waitcnt vmcnt(11)
  v_mfma_f32_32x32x16_bf16 v[128:143], v[208:211], v[32:35], v[128:143]
  v_mfma_f32_32x32x16_bf16 v[144:159], v[212:215], v[32:35], v[144:159]
  v_mfma_f32_32x32x16_bf16 v[160:175], v[32:35], v[216:219], v[160:175]
  ds_read_b128 v[208:211], v3 offset:30720
  ds_read_b128 v[212:215], v4 offset:6144
  ds_read_b128 v[216:219], v4 offset:47104
  s_waitcnt lgkmcnt(3)
  s_waitcnt vmcnt(10)
  v_mfma_f32_32x32x16_bf16 v[128:143], v[220:223], v[36:39], v[128:143]
  v_mfma_f32_32x32x16_bf16 v[144:159], v[224:227], v[36:39], v[144:159]
  v_mfma_f32_32x32x16_bf16 v[160:175], v[36:39], v[228:231], v[160:175]
  ds_read_b128 v[220:223], v3 offset:31744
  ds_read_b128 v[224:227], v4 offset:7168
  ds_read_b128 v[228:231], v4 offset:48128
  s_waitcnt lgkmcnt(3)
  s_waitcnt vmcnt(9)
  v_mfma_f32_32x32x16_bf16 v[128:143], v[208:211], v[40:43], v[128:143]
  v_mfma_f32_32x32x16_bf16 v[144:159], v[212:215], v[40:43], v[144:159]
  v_mfma_f32_32x32x16_bf16 v[160:175], v[40:43], v[216:219], v[160:175]
  ds_read_b128 v[208:211], v3 offset:32768
  ds_read_b128 v[212:215], v4 offset:8192
  ds_read_b128 v[216:219], v4 offset:49152
  s_waitcnt lgkmcnt(3)
  s_waitcnt vmcnt(8)
  v_mfma_f32_32x32x16_bf16 v[128:143], v[220:223], v[44:47], v[128:143]
  v_mfma_f32_32x32x16_bf16 v[144:159], v[224:227], v[44:47], v[144:159]
  v_mfma_f32_32x32x16_bf16 v[160:175], v[44:47], v[228:231], v[160:175]
  ds_read_b128 v[220:223], v3 offset:33792
  ds_read_b128 v[224:227], v4 offset:9216
  ds_read_b128 v[228:231], v4 offset:50176
  s_waitcnt lgkmcnt(3)
  s_waitcnt vmcnt(7)
  v_mfma_f32_32x32x16_bf16 v[128:143], v[208:211], v[48:51], v[128:143]
  v_mfma_f32_32x32x16_bf16 v[144:159], v[212:215], v[48:51], v[144:159]
  v_mfma_f32_32x32x16_bf16 v[160:175], v[48:51], v[216:219], v[160:175]
  ds_read_b128 v[208:211], v3 offset:34816
  ds_read_b128 v[212:215], v4 offset:10240
  ds_read_b128 v[216:219], v4 offset:51200
  s_waitcnt lgkmcnt(3)
  s_waitcnt vmcnt(6)
  v_mfma_f32_32x32x16_bf16 v[128:143], v[220:223], v[52:55], v[128:143]
  v_mfma_f32_32x32x16_bf16 v[144:159], v[224:227], v[52:55], v[144:159]
  v_mfma_f32_32x32x16_bf16 v[160:175], v[52:55], v[228:231], v[160:175]
  ds_read_b128 v[220:223], v3 offset:35840
  ds_read_b128 v[224:227], v4 offset:11264
  ds_read_b128 v[228:231], v4 offset:52224
  s_waitcnt lgkmcnt(3)
  s_waitcnt vmcnt(5)
  v_mfma_f32_32x32x16_bf16 v[128:143], v[208:211], v[56:59], v[128:143]
  v_mfma_f32_32x32x16_bf16 v[144:159], v[212:215], v[56:59], v[144:159]
  v_mfma_f32_32x32x16_bf16 v[160:175], v[56:59], v[216:219], v[160:175]
  ds_read_b128 v[208:211], v3 offset:36864
  ds_read_b128 v[212:215], v4 offset:12288
  ds_read_b128 v[216:219], v4 offset:53248
  s_waitcnt lgkmcnt(3)
  s_waitcnt vmcnt(4)
  v_mfma_f32_32x32x16_bf16 v[128:143], v[220:223], v[60:63], v[128:143]
  v_mfma_f32_32x32x16_bf16 v[144:159], v[224:227], v[60:63], v[144:159]
  v_mfma_f32_32x32x16_bf16 v[160:175], v[60:63], v[228:231], v[160:175]
  ds_read_b128 v[220:223], v3 offset:37888
  ds_read_b128 v[224:227], v4 offset:13312
  ds_read_b128 v[228:231], v4 offset:54272
  s_waitcnt lgkmcnt(3)
  s_waitcnt vmcnt(3)
  v_mfma_f32_32x32x16_bf16 v[128:143], v[208:211], v[64:67], v[128:143]
  v_mfma_f32_32x32x16_bf16 v[144:159], v[212:215], v[64:67], v[144:159]
  v_mfma_f32_32x32x16_bf16 v[160:175], v[64:67], v[216:219], v[160:175]
  ds_read_b128 v[208:211], v3 offset:38912
  ds_read_b128 v[212:215], v4 offset:14336
  ds_read_b128 v[216:219], v4 offset:55296
  s_waitcnt lgkmcnt(3)
  s_waitcnt vmcnt(2)
  v_mfma_f32_32x32x16_bf16 v[128:143], v[220:223], v[68:71], v[128:143]
  v_mfma_f32_32x32x16_bf16 v[144:159], v[224:227], v[68:71], v[144:159]
  v_mfma_f32_32x32x16_bf16 v[160:175], v[68:71], v[228:231], v[160:175]
  ds_read_b128 v[220:223], v3 offset:39936
  ds_read_b128 v[224:227], v4 offset:15360
  ds_read_b128 v[228:231], v4 offset:56320
  s_waitcnt lgkmcnt(3)
  s_waitcnt vmcnt(1)
  v_mfma_f32_32x32x16_bf16 v[128:143], v[208:211], v[72:75], v[128:143]
  v_mfma_f32_32x32x16_bf16 v[144:159], v[212:215], v[72:75], v[144:159]
  v_mfma_f32_32x32x16_bf16 v[160:175], v[72:75], v[216:219], v[160:175]
  s_waitcnt lgkmcnt(0)
  s_waitcnt vmcnt(0)
  v_mfma_f32_32x32x16_bf16 v[128:143], v[220:223], v[76:79], v[128:143]
  v_mfma_f32_32x32x16_bf16 v[144:159], v[224:227], v[76:79], v[144:159]
  v_mfma_f32_32x32x16_bf16 v[160:175], v[76:79], v[228:231], v[160:175]
  s_nop 11
  v_max3_f32 v9, v9, abs(v144), abs(v145)
  v_max3_f32 v9, v9, abs(v146), abs(v147)
  v_max3_f32 v9, v9, abs(v148), abs(v149)
  v_max3_f32 v9, v9, abs(v150), abs(v151)
  v_max3_f32 v9, v9, abs(v152), abs(v153)
  v_max3_f32 v9, v9, abs(v154), abs(v155)
  v_max3_f32 v9, v9, abs(v156), abs(v157)
  v_max3_f32 v9, v9, abs(v158), abs(v159)
  v_add_f32 v156, v156, v6
  v_cvt_pk_bf16_f32 v232, v144, v145
  v_cvt_pk_bf16_f32 v233, v146, v147
  v_cvt_pk_bf16_f32 v234, v148, v149
  v_cvt_pk_bf16_f32 v235, v150, v151
  v_cvt_pk_bf16_f32 v236, v152, v153
  v_cvt_pk_bf16_f32 v237, v154, v155
  v_cvt_pk_bf16_f32 v238, v156, v157
  v_cvt_pk_bf16_f32 v239, v158, v159
  s_add_u32 s26, s31, 245368832
  buffer_store_dwordx4 v[232:235], v2, s[8:11], s26 offen sc1
  buffer_store_dwordx4 v[236:239], v2, s[8:11], s26 offen offset:1024 sc1
  v_cndmask_b32 v160, v160, v8, s[32:33]
  v_cndmask_b32 v161, v161, v8, s[32:33]
  v_cndmask_b32 v162, v162, v8, s[32:33]
  v_cndmask_b32 v163, v163, v8, s[32:33]
  v_cndmask_b32 v164, v164, v8, s[32:33]
  v_cndmask_b32 v165, v165, v8, s[32:33]
  v_cndmask_b32 v166, v166, v8, s[32:33]
  v_cndmask_b32 v167, v167, v8, s[32:33]
  v_cndmask_b32 v168, v168, v8, s[32:33]
  v_cndmask_b32 v169, v169, v8, s[32:33]
  v_cndmask_b32 v170, v170, v8, s[32:33]
  v_cndmask_b32 v171, v171, v8, s[32:33]
  v_cndmask_b32 v172, v172, v8, s[32:33]
  v_cndmask_b32 v173, v173, v8, s[32:33]
  v_cndmask_b32 v174, v174, v8, s[32:33]
  v_cndmask_b32 v175, v175, v8, s[32:33]
  v_cvt_pk_bf16_f32 v240, v160, v161
  v_cvt_pk_bf16_f32 v241, v162, v163
  v_cvt_pk_bf16_f32 v242, v164, v165
  v_cvt_pk_bf16_f32 v243, v166, v167
  v_cvt_pk_bf16_f32 v244, v168, v169
  v_cvt_pk_bf16_f32 v245, v170, v171
  v_cvt_pk_bf16_f32 v246, v172, v173
  v_cvt_pk_bf16_f32 v247, v174, v175
  s_add_u32 s26, s31, 249563136
  buffer_store_dwordx4 v[240:243], v2, s[8:11], s26 offen sc1
  buffer_store_dwordx4 v[244:247], v2, s[8:11], s26 offen offset:1024 sc1
  v_mul_f32 v128, s30, v128
  v_mul_f32 v129, s30, v129
  v_mul_f32 v130, s30, v130
  v_mul_f32 v131, s30, v131
  v_mul_f32 v132, s30, v132
  v_mul_f32 v133, s30, v133
  v_mul_f32 v134, s30, v134
  v_mul_f32 v135, s30, v135
  v_mul_f32 v136, s30, v136
  v_mul_f32 v137, s30, v137
  v_mul_f32 v138, s30, v138
  v_mul_f32 v139, s30, v139
  v_mul_f32 v140, s30, v140
  v_mul_f32 v141, s30, v141
  v_mul_f32 v142, s30, v142
  v_mul_f32 v143, s30, v143
  v_cvt_pk_bf16_f32 v200, v128, v129
  v_cvt_pk_bf16_f32 v201, v130, v131
  v_cvt_pk_bf16_f32 v202, v132, v133
  v_cvt_pk_bf16_f32 v203, v134, v135
  v_cvt_pk_bf16_f32 v204, v136, v137
  v_cvt_pk_bf16_f32 v205, v138, v139
  v_cvt_pk_bf16_f32 v206, v140, v141
  v_cvt_pk_bf16_f32 v207, v142, v143
  s_nop 1
  v_max_f32_dpp v10, v9, v9 quad_perm:[1,0,3,2] row_mask:0xf bank_mask:0xf
  s_nop 1
  v_max_f32_dpp v9, v10, v10 quad_perm:[2,3,0,1] row_mask:0xf bank_mask:0xf
  s_nop 1
  v_max_f32_dpp v10, v9, v9 row_half_mirror row_mask:0xf bank_mask:0xf
  s_nop 1
  v_max_f32_dpp v9, v10, v10 row_mirror row_mask:0xf bank_mask:0xf
  v_mov_b32 v10, v9
  s_nop 1
  v_permlane16_swap_b32 v9, v10
  v_max_f32 v9, v9, v10
  v_mov_b32 v10, v9
  s_nop 1
  v_permlane32_swap_b32 v9, v10
  v_max_f32 v9, v9, v10
  s_lshl_b32 s51, s22, 7
  s_add_u32 s51, s51, 0xf600000
  s_lshl_b32 s26, s23, 4
  s_lshl_b32 s29, s21, 2
  s_add_u32 s26, s26, s29
  v_mov_b32 v11, s26
  s_mov_b64 s[40:41], exec
  s_mov_b64 exec, 1
  buffer_store_dword v9, v11, s[8:11], s51 offen sc1
  s_mov_b64 exec, s[40:41]
  s_mov_b32 s52, s24
  s_waitcnt vmcnt(0)
  s_barrier
  s_cmp_eq_u32 s21, 0
  s_cbranch_scc0 arr_30
  s_mov_b64 s[24:25], exec
  s_mov_b64 exec, 1
  v_mov_b32 v3, 0
  v_mov_b32 v4, 1
  buffer_atomic_add v4, v3, s[8:11], s47 offen
  s_mov_b64 exec, s[24:25]
arr_30:
  s_and_b32 s26, s2, 3
  s_mul_i32 s26, s26, 10
  s_mul_i32 s27, s21, 3
  s_cmp_eq_u32 s21, 3
  s_cselect_b32 s27, 8, s27
  s_add_u32 s50, s26, s27
  s_mul_i32 s26, s50, 20480
  s_add_u32 s26, s26, 0xe000000
  s_add_u32 s27, s26, 0
  buffer_load_dwordx4 a[0:3], v2, s[8:11], s27 offen
  s_add_u32 s27, s26, 1024
  buffer_load_dwordx4 a[4:7], v2, s[8:11], s27 offen
  s_add_u32 s27, s26, 2048
  buffer_load_dwordx4 a[8:11], v2, s[8:11], s27 offen
  s_add_u32 s27, s26, 3072
  buffer_load_dwordx4 a[12:15], v2, s[8:11], s27 offen
  s_add_u32 s27, s26, 4096
  buffer_load_dwordx4 a[16:19], v2, s[8:11], s27 offen
  s_add_u32 s27, s26, 5120
  buffer_load_dwordx4 a[20:23], v2, s[8:11], s27 offen
  s_add_u32 s27, s26, 6144
  buffer_load_dwordx4 a[24:27], v2, s[8:11], s27 offen
  s_add_u32 s27, s26, 7168
  buffer_load_dwordx4 a[28:31], v2, s[8:11], s27 offen
  s_add_u32 s27, s26, 8192
  buffer_load_dwordx4 a[32:35], v2, s[8:11], s27 offen
  s_add_u32 s27, s26, 9216
  buffer_load_dwordx4 a[36:39], v2, s[8:11], s27 offen
  s_add_u32 s27, s26, 10240
  buffer_load_dwordx4 a[40:43], v2, s[8:11], s27 offen
  s_add_u32 s27, s26, 11264
  buffer_load_dwordx4 a[44:47], v2, s[8:11], s27 offen
  s_add_u32 s27, s26, 12288
  buffer_load_dwordx4 a[48:51], v2, s[8:11], s27 offen
  s_add_u32 s27, s26, 13312
  buffer_load_dwordx4 a[52:55], v2, s[8:11], s27 offen
  s_add_u32 s27, s26, 14336
  buffer_load_dwordx4 a[56:59], v2, s[8:11], s27 offen
  s_add_u32 s27, s26, 15360
  buffer_load_dwordx4 a[60:63], v2, s[8:11], s27 offen
  s_add_u32 s27, s26, 16384
  buffer_load_dwordx4 a[64:67], v2, s[8:11], s27 offen
  s_add_u32 s27, s26, 17408
  buffer_load_dwordx4 a[68:71], v2, s[8:11], s27 offen
  s_add_u32 s27, s26, 18432
  buffer_load_dwordx4 a[72:75], v2, s[8:11], s27 offen
  s_add_u32 s27, s26, 19456
  buffer_load_dwordx4 a[76:79], v2, s[8:11], s27 offen
  s_add_u32 s27, s26, 20480
  buffer_load_dwordx4 a[80:83], v2, s[8:11], s27 offen
  s_add_u32 s27, s26, 21504
  buffer_load_dwordx4 a[84:87], v2, s[8:11], s27 offen
  s_add_u32 s27, s26, 22528
  buffer_load_dwordx4 a[88:91], v2, s[8:11], s27 offen
  s_add_u32 s27, s26, 23552
  buffer_load_dwordx4 a[92:95], v2, s[8:11], s27 offen
  s_add_u32 s27, s26, 24576
  buffer_load_dwordx4 a[96:99], v2, s[8:11], s27 offen
  s_add_u32 s27, s26, 25600
  buffer_load_dwordx4 a[100:103], v2, s[8:11], s27 offen
  s_add_u32 s27, s26, 26624
  buffer_load_dwordx4 a[104:107], v2, s[8:11], s27 offen
  s_add_u32 s27, s26, 27648
  buffer_load_dwordx4 a[108:111], v2, s[8:11], s27 offen
  s_add_u32 s27, s26, 28672
  buffer_load_dwordx4 a[112:115], v2, s[8:11], s27 offen
  s_add_u32 s27, s26, 29696
  buffer_load_dwordx4 a[116:119], v2, s[8:11], s27 offen
  s_add_u32 s27, s26, 30720
  buffer_load_dwordx4 a[120:123], v2, s[8:11], s27 offen
  s_add_u32 s27, s26, 31744
  buffer_load_dwordx4 a[124:127], v2, s[8:11], s27 offen
  s_add_u32 s27, s26, 32768
  buffer_load_dwordx4 a[128:131], v2, s[8:11], s27 offen
  s_add_u32 s27, s26, 33792
  buffer_load_dwordx4 a[132:135], v2, s[8:11], s27 offen
  s_add_u32 s27, s26, 34816
  buffer_load_dwordx4 a[136:139], v2, s[8:11], s27 offen
  s_add_u32 s27, s26, 35840
  buffer_load_dwordx4 a[140:143], v2, s[8:11], s27 offen
  s_add_u32 s27, s26, 36864
  buffer_load_dwordx4 a[144:147], v2, s[8:11], s27 offen
  s_add_u32 s27, s26, 37888
  buffer_load_dwordx4 a[148:151], v2, s[8:11], s27 offen
  s_add_u32 s27, s26, 38912
  buffer_load_dwordx4 a[152:155], v2, s[8:11], s27 offen
  s_add_u32 s27, s26, 39936
  buffer_load_dwordx4 a[156:159], v2, s[8:11], s27 offen
  s_cmp_lt_u32 s21, 2
  s_cbranch_scc0 g3_31
  s_add_u32 s27, s26, 40960
  buffer_load_dwordx4 a[160:163], v2, s[8:11], s27 offen
  s_add_u32 s27, s26, 41984
  buffer_load_dwordx4 a[164:167], v2, s[8:11], s27 offen
  s_add_u32 s27, s26, 43008
  buffer_load_dwordx4 a[168:171], v2, s[8:11], s27 offen
  s_add_u32 s27, s26, 44032
  buffer_load_dwordx4 a[172:175], v2, s[8:11], s27 offen
  s_add_u32 s27, s26, 45056
  buffer_load_dwordx4 a[176:179], v2, s[8:11], s27 offen
  s_add_u32 s27, s26, 46080
  buffer_load_dwordx4 a[180:183], v2, s[8:11], s27 offen
  s_add_u32 s27, s26, 47104
  buffer_load_dwordx4 a[184:187], v2, s[8:11], s27 offen
  s_add_u32 s27, s26, 48128
  buffer_load_dwordx4 a[188:191], v2, s[8:11], s27 offen
  s_add_u32 s27, s26, 49152
  buffer_load_dwordx4 a[192:195], v2, s[8:11], s27 offen
  s_add_u32 s27, s26, 50176
  buffer_load_dwordx4 a[196:199], v2, s[8:11], s27 offen
  s_add_u32 s27, s26, 51200
  buffer_load_dwordx4 a[200:203], v2, s[8:11], s27 offen
  s_add_u32 s27, s26, 52224
  buffer_load_dwordx4 a[204:207], v2, s[8:11], s27 offen
  s_add_u32 s27, s26, 53248
  buffer_load_dwordx4 a[208:211], v2, s[8:11], s27 offen
  s_add_u32 s27, s26, 54272
  buffer_load_dwordx4 a[212:215], v2, s[8:11], s27 offen
  s_add_u32 s27, s26, 55296
  buffer_load_dwordx4 a[216:219], v2, s[8:11], s27 offen
  s_add_u32 s27, s26, 56320
  buffer_load_dwordx4 a[220:223], v2, s[8:11], s27 offen
  s_add_u32 s27, s26, 57344
  buffer_load_dwordx4 a[224:227], v2, s[8:11], s27 offen
  s_add_u32 s27, s26, 58368
  buffer_load_dwordx4 a[228:231], v2, s[8:11], s27 offen
  s_add_u32 s27, s26, 59392
  buffer_load_dwordx4 a[232:235], v2, s[8:11], s27 offen
  s_add_u32 s27, s26, 60416
  buffer_load_dwordx4 a[236:239], v2, s[8:11], s27 offen
g3_31:
  v_mov_b32 v12, 0
  v_lshlrev_b32 v6, 16, v192
  v_and_b32 v7, 0xffff0000, v192
  v_add_f32_e64 v12, v12, abs(v6)
  v_add_f32_e64 v12, v12, abs(v7)
  v_lshlrev_b32 v6, 16, v193
  v_and_b32 v7, 0xffff0000, v193
  v_add_f32_e64 v12, v12, abs(v6)
  v_add_f32_e64 v12, v12, abs(v7)
  v_lshlrev_b32 v6, 16, v194
  v_and_b32 v7, 0xffff0000, v194
  v_add_f32_e64 v12, v12, abs(v6)
  v_add_f32_e64 v12, v12, abs(v7)
  v_lshlrev_b32 v6, 16, v195
  v_and_b32 v7, 0xffff0000, v195
  v_add_f32_e64 v12, v12, abs(v6)
  v_add_f32_e64 v12, v12, abs(v7)
  v_lshlrev_b32 v6, 16, v196
  v_and_b32 v7, 0xffff0000, v196
  v_add_f32_e64 v12, v12, abs(v6)
  v_add_f32_e64 v12, v12, abs(v7)
  v_lshlrev_b32 v6, 16, v197
  v_and_b32 v7, 0xffff0000, v197
  v_add_f32_e64 v12, v12, abs(v6)
  v_add_f32_e64 v12, v12, abs(v7)
  v_lshlrev_b32 v6, 16, v198
  v_and_b32 v7, 0xffff0000, v198
  v_add_f32_e64 v12, v12, abs(v6)
  v_add_f32_e64 v12, v12, abs(v7)
  v_lshlrev_b32 v6, 16, v199
  v_and_b32 v7, 0xffff0000, v199
  v_add_f32_e64 v12, v12, abs(v6)
  v_add_f32_e64 v12, v12, abs(v7)
  v_mov_b32 v6, v12
  s_nop 1
  v_permlane32_swap_b32 v12, v6
  v_add_f32 v12, v12, v6
  v_mov_b32 v13, 0
  v_lshlrev_b32 v6, 16, v200
  v_and_b32 v7, 0xffff0000, v200
  v_add_f32_e64 v13, v13, abs(v6)
  v_add_f32_e64 v13, v13, abs(v7)
  v_lshlrev_b32 v6, 16, v201
  v_and_b32 v7, 0xffff0000, v201
  v_add_f32_e64 v13, v13, abs(v6)
  v_add_f32_e64 v13, v13, abs(v7)
  v_lshlrev_b32 v6, 16, v202
  v_and_b32 v7, 0xffff0000, v202
  v_add_f32_e64 v13, v13, abs(v6)
  v_add_f32_e64 v13, v13, abs(v7)
  v_lshlrev_b32 v6, 16, v203
  v_and_b32 v7, 0xffff0000, v203
  v_add_f32_e64 v13, v13, abs(v6)
  v_add_f32_e64 v13, v13, abs(v7)
  v_lshlrev_b32 v6, 16, v204
  v_and_b32 v7, 0xffff0000, v204
  v_add_f32_e64 v13, v13, abs(v6)
  v_add_f32_e64 v13, v13, abs(v7)
  v_lshlrev_b32 v6, 16, v205
  v_and_b32 v7, 0xffff0000, v205
  v_add_f32_e64 v13, v13, abs(v6)
  v_add_f32_e64 v13, v13, abs(v7)
  v_lshlrev_b32 v6, 16, v206
  v_and_b32 v7, 0xffff0000, v206
  v_add_f32_e64 v13, v13, abs(v6)
  v_add_f32_e64 v13, v13, abs(v7)
  v_lshlrev_b32 v6, 16, v207
  v_and_b32 v7, 0xffff0000, v207
  v_add_f32_e64 v13, v13, abs(v6)
  v_add_f32_e64 v13, v13, abs(v7)
  v_mov_b32 v6, v13
  s_nop 1
  v_permlane32_swap_b32 v13, v6
  v_add_f32 v13, v13, v6
  v_mov_b32 v8, -1
  v_mov_b32 v9, -1
  v_mov_b32 v10, -1
  v_mov_b32 v11, -1
  s_lshl_b32 s30, s2, 2
  s_add_u32 s30, s30, s21
  s_add_u32 s31, s30, 0
  s_cmp_lt_u32 s31, 2560
  s_cbranch_scc0 f_32
  s_lshl_b32 s31, s31, 10
  s_add_u32 s31, s31, 0x400000
  buffer_store_dwordx4 v[8:11], v2, s[8:11], s31 offen
f_32:
  s_add_u32 s31, s30, 1024
  s_cmp_lt_u32 s31, 2560
  s_cbranch_scc0 f_33
  s_lshl_b32 s31, s31, 10
  s_add_u32 s31, s31, 0x400000
  buffer_store_dwordx4 v[8:11], v2, s[8:11], s31 offen
f_33:
  s_add_u32 s31, s30, 2048
  s_cmp_lt_u32 s31, 2560
  s_cbranch_scc0 f_34
  s_lshl_b32 s31, s31, 10
  s_add_u32 s31, s31, 0x400000
  buffer_store_dwordx4 v[8:11], v2, s[8:11], s31 offen
f_34:
  s_add_u32 s31, s30, 0
  s_cmp_lt_u32 s31, 1280
  s_cbranch_scc0 f_35
  s_lshl_b32 s31, s31, 10
  s_add_u32 s31, s31, 0x700000
  buffer_store_dwordx4 v[8:11], v2, s[8:11], s31 offen
f_35:
  s_add_u32 s31, s30, 1024
  s_cmp_lt_u32 s31, 1280
  s_cbranch_scc0 f_36
  s_lshl_b32 s31, s31, 10
  s_add_u32 s31, s31, 0x700000
  buffer_store_dwordx4 v[8:11], v2, s[8:11], s31 offen
f_36:
  s_add_u32 s31, s30, 0
  s_cmp_lt_u32 s31, 640
  s_cbranch_scc0 f_37
  s_lshl_b32 s31, s31, 10
  s_add_u32 s31, s31, 0xa00000
  buffer_store_dwordx4 v[8:11], v2, s[8:11], s31 offen
f_37:
  s_add_u32 s31, s30, 0
  s_cmp_lt_u32 s31, 5120
  s_cbranch_scc0 f_38
  s_lshl_b32 s31, s31, 10
  s_add_u32 s31, s31, 0xe00000
  buffer_store_dwordx4 v[8:11], v2, s[8:11], s31 offen
f_38:
  s_add_u32 s31, s30, 1024
  s_cmp_lt_u32 s31, 5120
  s_cbranch_scc0 f_39
  s_lshl_b32 s31, s31, 10
  s_add_u32 s31, s31, 0xe00000
  buffer_store_dwordx4 v[8:11], v2, s[8:11], s31 offen
f_39:
  s_add_u32 s31, s30, 2048
  s_cmp_lt_u32 s31, 5120
  s_cbranch_scc0 f_40
  s_lshl_b32 s31, s31, 10
  s_add_u32 s31, s31, 0xe00000
  buffer_store_dwordx4 v[8:11], v2, s[8:11], s31 offen
f_40:
  s_add_u32 s31, s30, 3072
  s_cmp_lt_u32 s31, 5120
  s_cbranch_scc0 f_41
  s_lshl_b32 s31, s31, 10
  s_add_u32 s31, s31, 0xe00000
  buffer_store_dwordx4 v[8:11], v2, s[8:11], s31 offen
f_41:
  s_add_u32 s31, s30, 4096
  s_cmp_lt_u32 s31, 5120
  s_cbranch_scc0 f_42
  s_lshl_b32 s31, s31, 10
  s_add_u32 s31, s31, 0xe00000
  buffer_store_dwordx4 v[8:11], v2, s[8:11], s31 offen
f_42:
  s_cmp_eq_u32 s2, 0
  s_cbranch_scc0 z_43
  s_cmp_eq_u32 s21, 0
  s_cbranch_scc0 z_43
  v_mov_b32 v8, 0
  v_mov_b32 v9, 0
  v_mov_b32 v10, 0
  v_mov_b32 v11, 0
  s_mov_b32 s30, 0x0
  buffer_store_dwordx4 v[8:11], v2, s[8:11], s30 offen
  s_add_u32 s30, s30, 1024
  buffer_store_dwordx4 v[8:11], v2, s[8:11], s30 offen
  s_add_u32 s30, s30, 1024
  buffer_store_dwordx4 v[8:11], v2, s[8:11], s30 offen
  s_add_u32 s30, s30, 1024
  buffer_store_dwordx4 v[8:11], v2, s[8:11], s30 offen
  s_add_u32 s30, s30, 1024
  buffer_store_dwordx4 v[8:11], v2, s[8:11], s30 offen
  s_add_u32 s30, s30, 1024
  s_mov_b32 s30, 0x2000
  buffer_store_dwordx4 v[8:11], v2, s[8:11], s30 offen
  s_add_u32 s30, s30, 1024
  buffer_store_dwordx4 v[8:11], v2, s[8:11], s30 offen
  s_add_u32 s30, s30, 1024
  buffer_store_dwordx4 v[8:11], v2, s[8:11], s30 offen
  s_add_u32 s30, s30, 1024
z_43:
  s_mov_b32 s45, 0
  v_mov_b32 v3, 0
aw_44:
  buffer_load_dword v4, v3, s[8:11], s47 offen sc1
  s_add_u32 s45, s45, 1
  s_waitcnt vmcnt(0)
  v_readfirstlane_b32 s29, v4
  s_cmp_ge_u32 s29, 8
  s_cbranch_scc1 aw_44_ok
  s_cmp_lt_u32 s45, 400000
  s_cbranch_scc1 aw_44
  s_branch kb1_abort
aw_44_ok:
  v_and_b32 v3, 31, v1
  v_lshlrev_b32 v3, 2, v3
  buffer_load_dword v4, v3, s[8:11], s51 offen sc1
  s_lshl_b32 s25, s22, 6
  s_lshl_b32 s27, s25, 11
  s_add_u32 s28, s27, 0xee00000
  s_add_u32 s27, s27, 0xea00000
  s_mov_b32 s41, 0
  s_mul_i32 s53, s41, 32768
  s_lshl_b32 s31, s21, 13
  s_add_u32 s53, s53, s31
  s_add_u32 m0, s31, 0
  s_add_u32 s29, s53, s27
  s_add_u32 s29, s29, 0
  buffer_load_dwordx4 v2, s[8:11], s29 offen sc1 lds
  s_add_u32 m0, s31, 1024
  s_add_u32 s29, s53, s27
  s_add_u32 s29, s29, 1024
  buffer_load_dwordx4 v2, s[8:11], s29 offen sc1 lds
  s_add_u32 m0, s31, 2048
  s_add_u32 s29, s53, s27
  s_add_u32 s29, s29, 2048
  buffer_load_dwordx4 v2, s[8:11], s29 offen sc1 lds
  s_add_u32 m0, s31, 3072
  s_add_u32 s29, s53, s27
  s_add_u32 s29, s29, 3072
  buffer_load_dwordx4 v2, s[8:11], s29 offen sc1 lds
  s_add_u32 m0, s31, 4096
  s_add_u32 s29, s53, s27
  s_add_u32 s29, s29, 4096
  buffer_load_dwordx4 v2, s[8:11], s29 offen sc1 lds
  s_add_u32 m0, s31, 5120
  s_add_u32 s29, s53, s27
  s_add_u32 s29, s29, 5120
  buffer_load_dwordx4 v2, s[8:11], s29 offen sc1 lds
  s_add_u32 m0, s31, 6144
  s_add_u32 s29, s53, s27
  s_add_u32 s29, s29, 6144
  buffer_load_dwordx4 v2, s[8:11], s29 offen sc1 lds
  s_add_u32 m0, s31, 7168
  s_add_u32 s29, s53, s27
  s_add_u32 s29, s29, 7168
  buffer_load_dwordx4 v2, s[8:11], s29 offen sc1 lds
  s_add_u32 m0, s31, 32768
  s_add_u32 s29, s53, s28
  s_add_u32 s29, s29, 0
  buffer_load_dwordx4 v2, s[8:11], s29 offen sc1 lds
  s_add_u32 m0, s31, 33792
  s_add_u32 s29, s53, s28
  s_add_u32 s29, s29, 1024
  buffer_load_dwordx4 v2, s[8:11], s29 offen sc1 lds
  s_add_u32 m0, s31, 34816
  s_add_u32 s29, s53, s28
  s_add_u32 s29, s29, 2048
  buffer_load_dwordx4 v2, s[8:11], s29 offen sc1 lds
  s_add_u32 m0, s31, 35840
  s_add_u32 s29, s53, s28
  s_add_u32 s29, s29, 3072
  buffer_load_dwordx4 v2, s[8:11], s29 offen sc1 lds
  s_add_u32 m0, s31, 36864
  s_add_u32 s29, s53, s28
  s_add_u32 s29, s29, 4096
  buffer_load_dwordx4 v2, s[8:11], s29 offen sc1 lds
  s_add_u32 m0, s31, 37888
  s_add_u32 s29, s53, s28
  s_add_u32 s29, s29, 5120
  buffer_load_dwordx4 v2, s[8:11], s29 offen sc1 lds
  s_add_u32 m0, s31, 38912
  s_add_u32 s29, s53, s28
  s_add_u32 s29, s29, 6144
  buffer_load_dwordx4 v2, s[8:11], s29 offen sc1 lds
  s_add_u32 m0, s31, 39936
  s_add_u32 s29, s53, s28
  s_add_u32 s29, s29, 7168
  buffer_load_dwordx4 v2, s[8:11], s29 offen sc1 lds
  s_waitcnt vmcnt(16)
  v_max_f32_dpp v5, v4, v4 quad_perm:[1,0,3,2] row_mask:0xf bank_mask:0xf
  s_nop 1
  v_max_f32_dpp v4, v5, v5 quad_perm:[2,3,0,1] row_mask:0xf bank_mask:0xf
  s_nop 1
  v_max_f32_dpp v5, v4, v4 row_half_mirror row_mask:0xf bank_mask:0xf
  s_nop 1
  v_max_f32_dpp v4, v5, v5 row_mirror row_mask:0xf bank_mask:0xf
  v_mov_b32 v5, v4
  s_nop 1
  v_permlane16_swap_b32 v4, v5
  v_max_f32 v4, v4, v5
  v_mul_f32 v12, v12, v4
  v_mul_f32 v12, 0x3f820000, v12
  v_mul_f32 v13, v13, v4
  v_mul_f32 v13, 0x3f820000, v13
  s_mov_b32 s40, 0
kb1_main:
  v_lshrrev_b32 v5, 16, v12
  v_or_b32 v5, 0x8000, v5
  v_and_b32 v6, 0xffff0000, v198
  v_or_b32 v5, v5, v6
  v_cndmask_b32 v198, v198, v5, s[34:35]
  v_lshrrev_b32 v5, 16, v13
  v_or_b32 v5, 0x8000, v5
  v_and_b32 v6, 0xffff0000, v206
  v_or_b32 v5, v5, v6
  v_cndmask_b32 v206, v206, v5, s[34:35]
kb1_main2:
  v_mov_b32 v112, 0
  v_mov_b32 v113, 0
  v_mov_b32 v114, 0
  v_mov_b32 v115, 0
  v_mov_b32 v116, 0
  v_mov_b32 v117, 0
  v_mov_b32 v118, 0
  v_mov_b32 v119, 0
  v_mov_b32 v120, 0
  v_mov_b32 v121, 0
  v_mov_b32 v122, 0
  v_mov_b32 v123, 0
  v_mov_b32 v124, 0
  v_mov_b32 v125, 0
  v_mov_b32 v126, 0
  v_mov_b32 v127, 0
  v_mov_b32 v128, 0
  v_mov_b32 v129, 0
  v_mov_b32 v130, 0
  v_mov_b32 v131, 0
  v_mov_b32 v132, 0
  v_mov_b32 v133, 0
  v_mov_b32 v134, 0
  v_mov_b32 v135, 0
  v_mov_b32 v136, 0
  v_mov_b32 v137, 0
  v_mov_b32 v138, 0
  v_mov_b32 v139, 0
  v_mov_b32 v140, 0
  v_mov_b32 v141, 0
  v_mov_b32 v142, 0
  v_mov_b32 v143, 0
  v_mov_b32 v3, v2
  v_add_u32 v4, 65536, v2
kb1_chunk2:
  s_waitcnt vmcnt(0)
  s_barrier
  s_add_u32 s41, s41, 1
  s_min_u32 s29, s41, 3
  s_mul_i32 s53, s29, 32768
  s_lshl_b32 s31, s21, 13
  s_add_u32 s53, s53, s31
  ds_read_b128 v[32:35], v3 offset:0
  ds_read_b128 v[36:39], v3 offset:1024
  ds_read_b128 v[48:51], v3 offset:32768
  ds_read_b128 v[52:55], v3 offset:33792
  ds_read_b128 v[40:43], v3 offset:2048
  ds_read_b128 v[44:47], v3 offset:3072
  s_waitcnt lgkmcnt(4)
  v_mfma_f32_32x32x16_bf16 v[64:79], v[32:35], v[192:195], 0
  v_mfma_f32_32x32x16_bf16 v[64:79], v[36:39], v[196:199], v[64:79]
  s_nop 11
  v_exp_f32 v64, v64
  v_exp_f32 v65, v65
  v_exp_f32 v66, v66
  v_exp_f32 v67, v67
  v_cvt_pk_bf16_f32 v96, v64, v65
  v_exp_f32 v68, v68
  v_exp_f32 v69, v69
  v_cvt_pk_bf16_f32 v97, v66, v67
  v_exp_f32 v70, v70
  v_mfma_f32_32x32x16_bf16 v[80:95], v[32:35], v[200:203], 0
  v_exp_f32 v71, v71
  v_cvt_pk_bf16_f32 v98, v68, v69
  v_exp_f32 v72, v72
  v_exp_f32 v73, v73
  v_cvt_pk_bf16_f32 v99, v70, v71
  v_mfma_f32_32x32x16_bf16 v[80:95], v[36:39], v[204:207], v[80:95]
  v_exp_f32 v74, v74
  v_exp_f32 v75, v75
  ds_read_b128 v[56:59], v3 offset:34816
  v_cvt_pk_bf16_f32 v100, v72, v73
  v_exp_f32 v76, v76
  v_exp_f32 v77, v77
  ds_read_b128 v[60:63], v3 offset:35840
  v_cvt_pk_bf16_f32 v101, v74, v75
  v_exp_f32 v78, v78
  s_add_u32 m0, s31, 65536
  s_add_u32 s29, s53, s27
  s_add_u32 s29, s29, 0
  buffer_load_dwordx4 v2, s[8:11], s29 offen sc1 lds
  v_exp_f32 v79, v79
  v_cvt_pk_bf16_f32 v102, v76, v77
  v_cvt_pk_bf16_f32 v103, v78, v79
  s_waitcnt lgkmcnt(4)
  v_mfma_f32_32x32x16_bf16 v[112:127], v[48:51], v[96:99], v[112:127]
  v_exp_f32 v80, v80
  v_exp_f32 v81, v81
  v_exp_f32 v82, v82
  v_exp_f32 v83, v83
  v_mfma_f32_32x32x16_bf16 v[112:127], v[52:55], v[100:103], v[112:127]
  v_cvt_pk_bf16_f32 v104, v80, v81
  v_exp_f32 v84, v84
  v_exp_f32 v85, v85
  v_cvt_pk_bf16_f32 v105, v82, v83
  v_exp_f32 v86, v86
  s_waitcnt lgkmcnt(2)
  v_mfma_f32_32x32x16_bf16 v[64:79], v[40:43], v[192:195], 0
  v_exp_f32 v87, v87
  v_cvt_pk_bf16_f32 v106, v84, v85
  v_exp_f32 v88, v88
  v_exp_f32 v89, v89
  v_cvt_pk_bf16_f32 v107, v86, v87
  v_mfma_f32_32x32x16_bf16 v[64:79], v[44:47], v[196:199], v[64:79]
  v_exp_f32 v90, v90
  v_exp_f32 v91, v91
  ds_read_b128 v[32:35], v3 offset:4096
  v_cvt_pk_bf16_f32 v108, v88, v89
  v_exp_f32 v92, v92
  v_exp_f32 v93, v93
  ds_read_b128 v[36:39], v3 offset:5120
  v_cvt_pk_bf16_f32 v109, v90, v91
  v_exp_f32 v94, v94
  v_exp_f32 v95, v95
  v_cvt_pk_bf16_f32 v110, v92, v93
  v_cvt_pk_bf16_f32 v111, v94, v95
  v_mfma_f32_32x32x16_bf16 v[128:143], v[48:51], v[104:107], v[128:143]
  v_exp_f32 v64, v64
  v_exp_f32 v65, v65
  v_exp_f32 v66, v66
  v_exp_f32 v67, v67
  v_mfma_f32_32x32x16_bf16 v[128:143], v[52:55], v[108:111], v[128:143]
  v_cvt_pk_bf16_f32 v96, v64, v65
  v_exp_f32 v68, v68
  v_exp_f32 v69, v69
  v_cvt_pk_bf16_f32 v97, v66, v67
  v_exp_f32 v70, v70
  v_mfma_f32_32x32x16_bf16 v[80:95], v[40:43], v[200:203], 0
  v_exp_f32 v71, v71
  v_cvt_pk_bf16_f32 v98, v68, v69
  v_exp_f32 v72, v72
  v_exp_f32 v73, v73
  v_cvt_pk_bf16_f32 v99, v70, v71
  v_mfma_f32_32x32x16_bf16 v[80:95], v[44:47], v[204:207], v[80:95]
  v_exp_f32 v74, v74
  v_exp_f32 v75, v75
  ds_read_b128 v[48:51], v3 offset:36864
  v_cvt_pk_bf16_f32 v100, v72, v73
  v_exp_f32 v76, v76
  v_exp_f32 v77, v77
  ds_read_b128 v[52:55], v3 offset:37888
  v_cvt_pk_bf16_f32 v101, v74, v75
  v_exp_f32 v78, v78
  s_add_u32 m0, s31, 66560
  s_add_u32 s29, s53, s27
  s_add_u32 s29, s29, 1024
  buffer_load_dwordx4 v2, s[8:11], s29 offen sc1 lds
  v_exp_f32 v79, v79
  v_cvt_pk_bf16_f32 v102, v76, v77
  v_cvt_pk_bf16_f32 v103, v78, v79
  s_waitcnt lgkmcnt(4)
  v_mfma_f32_32x32x16_bf16 v[112:127], v[56:59], v[96:99], v[112:127]
  v_exp_f32 v80, v80
  v_exp_f32 v81, v81
  v_exp_f32 v82, v82
  v_exp_f32 v83, v83
  v_mfma_f32_32x32x16_bf16 v[112:127], v[60:63], v[100:103], v[112:127]
  v_cvt_pk_bf16_f32 v104, v80, v81
  v_exp_f32 v84, v84
  v_exp_f32 v85, v85
  v_cvt_pk_bf16_f32 v105, v82, v83
  v_exp_f32 v86, v86
  s_waitcnt lgkmcnt(2)
  v_mfma_f32_32x32x16_bf16 v[64:79], v[32:35], v[192:195], 0
  v_exp_f32 v87, v87
  v_cvt_pk_bf16_f32 v106, v84, v85
  v_exp_f32 v88, v88
  v_exp_f32 v89, v89
  v_cvt_pk_bf16_f32 v107, v86, v87
  v_mfma_f32_32x32x16_bf16 v[64:79], v[36:39], v[196:199], v[64:79]
  v_exp_f32 v90, v90
  v_exp_f32 v91, v91
  ds_read_b128 v[40:43], v3 offset:6144
  v_cvt_pk_bf16_f32 v108, v88, v89
  v_exp_f32 v92, v92
  v_exp_f32 v93, v93
  ds_read_b128 v[44:47], v3 offset:7168
  v_cvt_pk_bf16_f32 v109, v90, v91
  v_exp_f32 v94, v94
  v_exp_f32 v95, v95
  v_cvt_pk_bf16_f32 v110, v92, v93
  v_cvt_pk_bf16_f32 v111, v94, v95
  v_mfma_f32_32x32x16_bf16 v[128:143], v[56:59], v[104:107], v[128:143]
  v_exp_f32 v64, v64
  v_exp_f32 v65, v65
  v_exp_f32 v66, v66
  v_exp_f32 v67, v67
  v_mfma_f32_32x32x16_bf16 v[128:143], v[60:63], v[108:111], v[128:143]
  v_cvt_pk_bf16_f32 v96, v64, v65
  v_exp_f32 v68, v68
  v_exp_f32 v69, v69
  v_cvt_pk_bf16_f32 v97, v66, v67
  v_exp_f32 v70, v70
  v_mfma_f32_32x32x16_bf16 v[80:95], v[32:35], v[200:203], 0
  v_exp_f32 v71, v71
  v_cvt_pk_bf16_f32 v98, v68, v69
  v_exp_f32 v72, v72
  v_exp_f32 v73, v73
  v_cvt_pk_bf16_f32 v99, v70, v71
  v_mfma_f32_32x32x16_bf16 v[80:95], v[36:39], v[204:207], v[80:95]
  v_exp_f32 v74, v74
  v_exp_f32 v75, v75
  ds_read_b128 v[56:59], v3 offset:38912
  v_cvt_pk_bf16_f32 v100, v72, v73
  v_exp_f32 v76, v76
  v_exp_f32 v77, v77
  ds_read_b128 v[60:63], v3 offset:39936
  v_cvt_pk_bf16_f32 v101, v74, v75
  v_exp_f32 v78, v78
  s_add_u32 m0, s31, 67584
  s_add_u32 s29, s53, s27
  s_add_u32 s29, s29, 2048
  buffer_load_dwordx4 v2, s[8:11], s29 offen sc1 lds
  v_exp_f32 v79, v79
  v_cvt_pk_bf16_f32 v102, v76, v77
  v_cvt_pk_bf16_f32 v103, v78, v79
  s_waitcnt lgkmcnt(4)
  v_mfma_f32_32x32x16_bf16 v[112:127], v[48:51], v[96:99], v[112:127]
  v_exp_f32 v80, v80
  v_exp_f32 v81, v81
  v_exp_f32 v82, v82
  v_exp_f32 v83, v83
  v_mfma_f32_32x32x16_bf16 v[112:127], v[52:55], v[100:103], v[112:127]
  v_cvt_pk_bf16_f32 v104, v80, v81
  v_exp_f32 v84, v84
  v_exp_f32 v85, v85
  v_cvt_pk_bf16_f32 v105, v82, v83
  v_exp_f32 v86, v86
  s_waitcnt lgkmcnt(2)
  v_mfma_f32_32x32x16_bf16 v[64:79], v[40:43], v[192:195], 0
  v_exp_f32 v87, v87
  v_cvt_pk_bf16_f32 v106, v84, v85
  v_exp_f32 v88, v88
  v_exp_f32 v89, v89
  v_cvt_pk_bf16_f32 v107, v86, v87
  v_mfma_f32_32x32x16_bf16 v[64:79], v[44:47], v[196:199], v[64:79]
  v_exp_f32 v90, v90
  v_exp_f32 v91, v91
  ds_read_b128 v[32:35], v3 offset:8192
  v_cvt_pk_bf16_f32 v108, v88, v89
  v_exp_f32 v92, v92
  v_exp_f32 v93, v93
  ds_read_b128 v[36:39], v3 offset:9216
  v_cvt_pk_bf16_f32 v109, v90, v91
  v_exp_f32 v94, v94
  v_exp_f32 v95, v95
  v_cvt_pk_bf16_f32 v110, v92, v93
  v_cvt_pk_bf16_f32 v111, v94, v95
  v_mfma_f32_32x32x16_bf16 v[128:143], v[48:51], v[104:107], v[128:143]
  v_exp_f32 v64, v64
  v_exp_f32 v65, v65
  v_exp_f32 v66, v66
  v_exp_f32 v67, v67
  v_mfma_f32_32x32x16_bf16 v[128:143], v[52:55], v[108:111], v[128:143]
  v_cvt_pk_bf16_f32 v96, v64, v65
  v_exp_f32 v68, v68
  v_exp_f32 v69, v69
  v_cvt_pk_bf16_f32 v97, v66, v67
  v_exp_f32 v70, v70
  v_mfma_f32_32x32x16_bf16 v[80:95], v[40:43], v[200:203], 0
  v_exp_f32 v71, v71
  v_cvt_pk_bf16_f32 v98, v68, v69
  v_exp_f32 v72, v72
  v_exp_f32 v73, v73
  v_cvt_pk_bf16_f32 v99, v70, v71
  v_mfma_f32_32x32x16_bf16 v[80:95], v[44:47], v[204:207], v[80:95]
  v_exp_f32 v74, v74
  v_exp_f32 v75, v75
  ds_read_b128 v[48:51], v3 offset:40960
  v_cvt_pk_bf16_f32 v100, v72, v73
  v_exp_f32 v76, v76
  v_exp_f32 v77, v77
  ds_read_b128 v[52:55], v3 offset:41984
  v_cvt_pk_bf16_f32 v101, v74, v75
  v_exp_f32 v78, v78
  s_add_u32 m0, s31, 68608
  s_add_u32 s29, s53, s27
  s_add_u32 s29, s29, 3072
  buffer_load_dwordx4 v2, s[8:11], s29 offen sc1 lds
  v_exp_f32 v79, v79
  v_cvt_pk_bf16_f32 v102, v76, v77
  v_cvt_pk_bf16_f32 v103, v78, v79
  s_waitcnt lgkmcnt(4)
  v_mfma_f32_32x32x16_bf16 v[112:127], v[56:59], v[96:99], v[112:127]
  v_exp_f32 v80, v80
  v_exp_f32 v81, v81
  v_exp_f32 v82, v82
  v_exp_f32 v83, v83
  v_mfma_f32_32x32x16_bf16 v[112:127], v[60:63], v[100:103], v[112:127]
  v_cvt_pk_bf16_f32 v104, v80, v81
  v_exp_f32 v84, v84
  v_exp_f32 v85, v85
  v_cvt_pk_bf16_f32 v105, v82, v83
  v_exp_f32 v86, v86
  s_waitcnt lgkmcnt(2)
  v_mfma_f32_32x32x16_bf16 v[64:79], v[32:35], v[192:195], 0
  v_exp_f32 v87, v87
  v_cvt_pk_bf16_f32 v106, v84, v85
  v_exp_f32 v88, v88
  v_exp_f32 v89, v89
  v_cvt_pk_bf16_f32 v107, v86, v87
  v_mfma_f32_32x32x16_bf16 v[64:79], v[36:39], v[196:199], v[64:79]
  v_exp_f32 v90, v90
  v_exp_f32 v91, v91
  ds_read_b128 v[40:43], v3 offset:10240
  v_cvt_pk_bf16_f32 v108, v88, v89
  v_exp_f32 v92, v92
  v_exp_f32 v93, v93
  ds_read_b128 v[44:47], v3 offset:11264
  v_cvt_pk_bf16_f32 v109, v90, v91
  v_exp_f32 v94, v94
  v_exp_f32 v95, v95
  v_cvt_pk_bf16_f32 v110, v92, v93
  v_cvt_pk_bf16_f32 v111, v94, v95
  v_mfma_f32_32x32x16_bf16 v[128:143], v[56:59], v[104:107], v[128:143]
  v_exp_f32 v64, v64
  v_exp_f32 v65, v65
  v_exp_f32 v66, v66
  v_exp_f32 v67, v67
  v_mfma_f32_32x32x16_bf16 v[128:143], v[60:63], v[108:111], v[128:143]
  v_cvt_pk_bf16_f32 v96, v64, v65
  v_exp_f32 v68, v68
  v_exp_f32 v69, v69
  v_cvt_pk_bf16_f32 v97, v66, v67
  v_exp_f32 v70, v70
  v_mfma_f32_32x32x16_bf16 v[80:95], v[32:35], v[200:203], 0
  v_exp_f32 v71, v71
  v_cvt_pk_bf16_f32 v98, v68, v69
  v_exp_f32 v72, v72
  v_exp_f32 v73, v73
  v_cvt_pk_bf16_f32 v99, v70, v71
  v_mfma_f32_32x32x16_bf16 v[80:95], v[36:39], v[204:207], v[80:95]
  v_exp_f32 v74, v74
  v_exp_f32 v75, v75
  ds_read_b128 v[56:59], v3 offset:43008
  v_cvt_pk_bf16_f32 v100, v72, v73
  v_exp_f32 v76, v76
  v_exp_f32 v77, v77
  ds_read_b128 v[60:63], v3 offset:44032
  v_cvt_pk_bf16_f32 v101, v74, v75
  v_exp_f32 v78, v78
  s_add_u32 m0, s31, 69632
  s_add_u32 s29, s53, s27
  s_add_u32 s29, s29, 4096
  buffer_load_dwordx4 v2, s[8:11], s29 offen sc1 lds
  v_exp_f32 v79, v79
  v_cvt_pk_bf16_f32 v102, v76, v77
  v_cvt_pk_bf16_f32 v103, v78, v79
  s_waitcnt lgkmcnt(4)
  v_mfma_f32_32x32x16_bf16 v[112:127], v[48:51], v[96:99], v[112:127]
  v_exp_f32 v80, v80
  v_exp_f32 v81, v81
  v_exp_f32 v82, v82
  v_exp_f32 v83, v83
  v_mfma_f32_32x32x16_bf16 v[112:127], v[52:55], v[100:103], v[112:127]
  v_cvt_pk_bf16_f32 v104, v80, v81
  v_exp_f32 v84, v84
  v_exp_f32 v85, v85
  v_cvt_pk_bf16_f32 v105, v82, v83
  v_exp_f32 v86, v86
  s_waitcnt lgkmcnt(2)
  v_mfma_f32_32x32x16_bf16 v[64:79], v[40:43], v[192:195], 0
  v_exp_f32 v87, v87
  v_cvt_pk_bf16_f32 v106, v84, v85
  v_exp_f32 v88, v88
  v_exp_f32 v89, v89
  v_cvt_pk_bf16_f32 v107, v86, v87
  v_mfma_f32_32x32x16_bf16 v[64:79], v[44:47], v[196:199], v[64:79]
  v_exp_f32 v90, v90
  v_exp_f32 v91, v91
  ds_read_b128 v[32:35], v3 offset:12288
  v_cvt_pk_bf16_f32 v108, v88, v89
  v_exp_f32 v92, v92
  v_exp_f32 v93, v93
  ds_read_b128 v[36:39], v3 offset:13312
  v_cvt_pk_bf16_f32 v109, v90, v91
  v_exp_f32 v94, v94
  v_exp_f32 v95, v95
  v_cvt_pk_bf16_f32 v110, v92, v93
  v_cvt_pk_bf16_f32 v111, v94, v95
  v_mfma_f32_32x32x16_bf16 v[128:143], v[48:51], v[104:107], v[128:143]
  v_exp_f32 v64, v64
  v_exp_f32 v65, v65
  v_exp_f32 v66, v66
  v_exp_f32 v67, v67
  v_mfma_f32_32x32x16_bf16 v[128:143], v[52:55], v[108:111], v[128:143]
  v_cvt_pk_bf16_f32 v96, v64, v65
  v_exp_f32 v68, v68
  v_exp_f32 v69, v69
  v_cvt_pk_bf16_f32 v97, v66, v67
  v_exp_f32 v70, v70
  v_mfma_f32_32x32x16_bf16 v[80:95], v[40:43], v[200:203], 0
  v_exp_f32 v71, v71
  v_cvt_pk_bf16_f32 v98, v68, v69
  v_exp_f32 v72, v72
  v_exp_f32 v73, v73
  v_cvt_pk_bf16_f32 v99, v70, v71
  v_mfma_f32_32x32x16_bf16 v[80:95], v[44:47], v[204:207], v[80:95]
  v_exp_f32 v74, v74
  v_exp_f32 v75, v75
  ds_read_b128 v[48:51], v3 offset:45056
  v_cvt_pk_bf16_f32 v100, v72, v73
  v_exp_f32 v76, v76
  v_exp_f32 v77, v77
  ds_read_b128 v[52:55], v3 offset:46080
  v_cvt_pk_bf16_f32 v101, v74, v75
  v_exp_f32 v78, v78
  s_add_u32 m0, s31, 70656
  s_add_u32 s29, s53, s27
  s_add_u32 s29, s29, 5120
  buffer_load_dwordx4 v2, s[8:11], s29 offen sc1 lds
  v_exp_f32 v79, v79
  v_cvt_pk_bf16_f32 v102, v76, v77
  v_cvt_pk_bf16_f32 v103, v78, v79
  s_waitcnt lgkmcnt(4)
  v_mfma_f32_32x32x16_bf16 v[112:127], v[56:59], v[96:99], v[112:127]
  v_exp_f32 v80, v80
  v_exp_f32 v81, v81
  v_exp_f32 v82, v82
  v_exp_f32 v83, v83
  v_mfma_f32_32x32x16_bf16 v[112:127], v[60:63], v[100:103], v[112:127]
  v_cvt_pk_bf16_f32 v104, v80, v81
  v_exp_f32 v84, v84
  v_exp_f32 v85, v85
  v_cvt_pk_bf16_f32 v105, v82, v83
  v_exp_f32 v86, v86
  s_waitcnt lgkmcnt(2)
  v_mfma_f32_32x32x16_bf16 v[64:79], v[32:35], v[192:195], 0
  v_exp_f32 v87, v87
  v_cvt_pk_bf16_f32 v106, v84, v85
  v_exp_f32 v88, v88
  v_exp_f32 v89, v89
  v_cvt_pk_bf16_f32 v107, v86, v87
  v_mfma_f32_32x32x16_bf16 v[64:79], v[36:39], v[196:199], v[64:79]
  v_exp_f32 v90, v90
  v_exp_f32 v91, v91
  ds_read_b128 v[40:43], v3 offset:14336
  v_cvt_pk_bf16_f32 v108, v88, v89
  v_exp_f32 v92, v92
  v_exp_f32 v93, v93
  ds_read_b128 v[44:47], v3 offset:15360
  v_cvt_pk_bf16_f32 v109, v90, v91
  v_exp_f32 v94, v94
  v_exp_f32 v95, v95
  v_cvt_pk_bf16_f32 v110, v92, v93
  v_cvt_pk_bf16_f32 v111, v94, v95
  v_mfma_f32_32x32x16_bf16 v[128:143], v[56:59], v[104:107], v[128:143]
  v_exp_f32 v64, v64
  v_exp_f32 v65, v65
  v_exp_f32 v66, v66
  v_exp_f32 v67, v67
  v_mfma_f32_32x32x16_bf16 v[128:143], v[60:63], v[108:111], v[128:143]
  v_cvt_pk_bf16_f32 v96, v64, v65
  v_exp_f32 v68, v68
  v_exp_f32 v69, v69
  v_cvt_pk_bf16_f32 v97, v66, v67
  v_exp_f32 v70, v70
  v_mfma_f32_32x32x16_bf16 v[80:95], v[32:35], v[200:203], 0
  v_exp_f32 v71, v71
  v_cvt_pk_bf16_f32 v98, v68, v69
  v_exp_f32 v72, v72
  v_exp_f32 v73, v73
  v_cvt_pk_bf16_f32 v99, v70, v71
  v_mfma_f32_32x32x16_bf16 v[80:95], v[36:39], v[204:207], v[80:95]
  v_exp_f32 v74, v74
  v_exp_f32 v75, v75
  ds_read_b128 v[56:59], v3 offset:47104
  v_cvt_pk_bf16_f32 v100, v72, v73
  v_exp_f32 v76, v76
  v_exp_f32 v77, v77
  ds_read_b128 v[60:63], v3 offset:48128
  v_cvt_pk_bf16_f32 v101, v74, v75
  v_exp_f32 v78, v78
  s_add_u32 m0, s31, 71680
  s_add_u32 s29, s53, s27
  s_add_u32 s29, s29, 6144
  buffer_load_dwordx4 v2, s[8:11], s29 offen sc1 lds
  v_exp_f32 v79, v79
  v_cvt_pk_bf16_f32 v102, v76, v77
  v_cvt_pk_bf16_f32 v103, v78, v79
  s_waitcnt lgkmcnt(4)
  v_mfma_f32_32x32x16_bf16 v[112:127], v[48:51], v[96:99], v[112:127]
  v_exp_f32 v80, v80
  v_exp_f32 v81, v81
  v_exp_f32 v82, v82
  v_exp_f32 v83, v83
  v_mfma_f32_32x32x16_bf16 v[112:127], v[52:55], v[100:103], v[112:127]
  v_cvt_pk_bf16_f32 v104, v80, v81
  v_exp_f32 v84, v84
  v_exp_f32 v85, v85
  v_cvt_pk_bf16_f32 v105, v82, v83
  v_exp_f32 v86, v86
  s_waitcnt lgkmcnt(2)
  v_mfma_f32_32x32x16_bf16 v[64:79], v[40:43], v[192:195], 0
  v_exp_f32 v87, v87
  v_cvt_pk_bf16_f32 v106, v84, v85
  v_exp_f32 v88, v88
  v_exp_f32 v89, v89
  v_cvt_pk_bf16_f32 v107, v86, v87
  v_mfma_f32_32x32x16_bf16 v[64:79], v[44:47], v[196:199], v[64:79]
  v_exp_f32 v90, v90
  v_exp_f32 v91, v91
  ds_read_b128 v[32:35], v3 offset:16384
  v_cvt_pk_bf16_f32 v108, v88, v89
  v_exp_f32 v92, v92
  v_exp_f32 v93, v93
  ds_read_b128 v[36:39], v3 offset:17408
  v_cvt_pk_bf16_f32 v109, v90, v91
  v_exp_f32 v94, v94
  v_exp_f32 v95, v95
  v_cvt_pk_bf16_f32 v110, v92, v93
  v_cvt_pk_bf16_f32 v111, v94, v95
  v_mfma_f32_32x32x16_bf16 v[128:143], v[48:51], v[104:107], v[128:143]
  v_exp_f32 v64, v64
  v_exp_f32 v65, v65
  v_exp_f32 v66, v66
  v_exp_f32 v67, v67
  v_mfma_f32_32x32x16_bf16 v[128:143], v[52:55], v[108:111], v[128:143]
  v_cvt_pk_bf16_f32 v96, v64, v65
  v_exp_f32 v68, v68
  v_exp_f32 v69, v69
  v_cvt_pk_bf16_f32 v97, v66, v67
  v_exp_f32 v70, v70
  v_mfma_f32_32x32x16_bf16 v[80:95], v[40:43], v[200:203], 0
  v_exp_f32 v71, v71
  v_cvt_pk_bf16_f32 v98, v68, v69
  v_exp_f32 v72, v72
  v_exp_f32 v73, v73
  v_cvt_pk_bf16_f32 v99, v70, v71
  v_mfma_f32_32x32x16_bf16 v[80:95], v[44:47], v[204:207], v[80:95]
  v_exp_f32 v74, v74
  v_exp_f32 v75, v75
  ds_read_b128 v[48:51], v3 offset:49152
  v_cvt_pk_bf16_f32 v100, v72, v73
  v_exp_f32 v76, v76
  v_exp_f32 v77, v77
  ds_read_b128 v[52:55], v3 offset:50176
  v_cvt_pk_bf16_f32 v101, v74, v75
  v_exp_f32 v78, v78
  s_add_u32 m0, s31, 72704
  s_add_u32 s29, s53, s27
  s_add_u32 s29, s29, 7168
  buffer_load_dwordx4 v2, s[8:11], s29 offen sc1 lds
  v_exp_f32 v79, v79
  v_cvt_pk_bf16_f32 v102, v76, v77
  v_cvt_pk_bf16_f32 v103, v78, v79
  s_waitcnt lgkmcnt(4)
  v_mfma_f32_32x32x16_bf16 v[112:127], v[56:59], v[96:99], v[112:127]
  v_exp_f32 v80, v80
  v_exp_f32 v81, v81
  v_exp_f32 v82, v82
  v_exp_f32 v83, v83
  v_mfma_f32_32x32x16_bf16 v[112:127], v[60:63], v[100:103], v[112:127]
  v_cvt_pk_bf16_f32 v104, v80, v81
  v_exp_f32 v84, v84
  v_exp_f32 v85, v85
  v_cvt_pk_bf16_f32 v105, v82, v83
  v_exp_f32 v86, v86
  s_waitcnt lgkmcnt(2)
  v_mfma_f32_32x32x16_bf16 v[64:79], v[32:35], v[192:195], 0
  v_exp_f32 v87, v87
  v_cvt_pk_bf16_f32 v106, v84, v85
  v_exp_f32 v88, v88
  v_exp_f32 v89, v89
  v_cvt_pk_bf16_f32 v107, v86, v87
  v_mfma_f32_32x32x16_bf16 v[64:79], v[36:39], v[196:199], v[64:79]
  v_exp_f32 v90, v90
  v_exp_f32 v91, v91
  ds_read_b128 v[40:43], v3 offset:18432
  v_cvt_pk_bf16_f32 v108, v88, v89
  v_exp_f32 v92, v92
  v_exp_f32 v93, v93
  ds_read_b128 v[44:47], v3 offset:19456
  v_cvt_pk_bf16_f32 v109, v90, v91
  v_exp_f32 v94, v94
  v_exp_f32 v95, v95
  v_cvt_pk_bf16_f32 v110, v92, v93
  v_cvt_pk_bf16_f32 v111, v94, v95
  v_mfma_f32_32x32x16_bf16 v[128:143], v[56:59], v[104:107], v[128:143]
  v_exp_f32 v64, v64
  v_exp_f32 v65, v65
  v_exp_f32 v66, v66
  v_exp_f32 v67, v67
  v_mfma_f32_32x32x16_bf16 v[128:143], v[60:63], v[108:111], v[128:143]
  v_cvt_pk_bf16_f32 v96, v64, v65
  v_exp_f32 v68, v68
  v_exp_f32 v69, v69
  v_cvt_pk_bf16_f32 v97, v66, v67
  v_exp_f32 v70, v70
  v_mfma_f32_32x32x16_bf16 v[80:95], v[32:35], v[200:203], 0
  v_exp_f32 v71, v71
  v_cvt_pk_bf16_f32 v98, v68, v69
  v_exp_f32 v72, v72
  v_exp_f32 v73, v73
  v_cvt_pk_bf16_f32 v99, v70, v71
  v_mfma_f32_32x32x16_bf16 v[80:95], v[36:39], v[204:207], v[80:95]
  v_exp_f32 v74, v74
  v_exp_f32 v75, v75
  ds_read_b128 v[56:59], v3 offset:51200
  v_cvt_pk_bf16_f32 v100, v72, v73
  v_exp_f32 v76, v76
  v_exp_f32 v77, v77
  ds_read_b128 v[60:63], v3 offset:52224
  v_cvt_pk_bf16_f32 v101, v74, v75
  v_exp_f32 v78, v78
  s_add_u32 m0, s31, 98304
  s_add_u32 s29, s53, s28
  s_add_u32 s29, s29, 0
  buffer_load_dwordx4 v2, s[8:11], s29 offen sc1 lds
  v_exp_f32 v79, v79
  v_cvt_pk_bf16_f32 v102, v76, v77
  v_cvt_pk_bf16_f32 v103, v78, v79
  s_waitcnt lgkmcnt(4)
  v_mfma_f32_32x32x16_bf16 v[112:127], v[48:51], v[96:99], v[112:127]
  v_exp_f32 v80, v80
  v_exp_f32 v81, v81
  v_exp_f32 v82, v82
  v_exp_f32 v83, v83
  v_mfma_f32_32x32x16_bf16 v[112:127], v[52:55], v[100:103], v[112:127]
  v_cvt_pk_bf16_f32 v104, v80, v81
  v_exp_f32 v84, v84
  v_exp_f32 v85, v85
  v_cvt_pk_bf16_f32 v105, v82, v83
  v_exp_f32 v86, v86
  s_waitcnt lgkmcnt(2)
  v_mfma_f32_32x32x16_bf16 v[64:79], v[40:43], v[192:195], 0
  v_exp_f32 v87, v87
  v_cvt_pk_bf16_f32 v106, v84, v85
  v_exp_f32 v88, v88
  v_exp_f32 v89, v89
  v_cvt_pk_bf16_f32 v107, v86, v87
  v_mfma_f32_32x32x16_bf16 v[64:79], v[44:47], v[196:199], v[64:79]
  v_exp_f32 v90, v90
  v_exp_f32 v91, v91
  ds_read_b128 v[32:35], v3 offset:20480
  v_cvt_pk_bf16_f32 v108, v88, v89
  v_exp_f32 v92, v92
  v_exp_f32 v93, v93
  ds_read_b128 v[36:39], v3 offset:21504
  v_cvt_pk_bf16_f32 v109, v90, v91
  v_exp_f32 v94, v94
  v_exp_f32 v95, v95
  v_cvt_pk_bf16_f32 v110, v92, v93
  v_cvt_pk_bf16_f32 v111, v94, v95
  v_mfma_f32_32x32x16_bf16 v[128:143], v[48:51], v[104:107], v[128:143]
  v_exp_f32 v64, v64
  v_exp_f32 v65, v65
  v_exp_f32 v66, v66
  v_exp_f32 v67, v67
  v_mfma_f32_32x32x16_bf16 v[128:143], v[52:55], v[108:111], v[128:143]
  v_cvt_pk_bf16_f32 v96, v64, v65
  v_exp_f32 v68, v68
  v_exp_f32 v69, v69
  v_cvt_pk_bf16_f32 v97, v66, v67
  v_exp_f32 v70, v70
  v_mfma_f32_32x32x16_bf16 v[80:95], v[40:43], v[200:203], 0
  v_exp_f32 v71, v71
  v_cvt_pk_bf16_f32 v98, v68, v69
  v_exp_f32 v72, v72
  v_exp_f32 v73, v73
  v_cvt_pk_bf16_f32 v99, v70, v71
  v_mfma_f32_32x32x16_bf16 v[80:95], v[44:47], v[204:207], v[80:95]
  v_exp_f32 v74, v74
  v_exp_f32 v75, v75
  ds_read_b128 v[48:51], v3 offset:53248
  v_cvt_pk_bf16_f32 v100, v72, v73
  v_exp_f32 v76, v76
  v_exp_f32 v77, v77
  ds_read_b128 v[52:55], v3 offset:54272
  v_cvt_pk_bf16_f32 v101, v74, v75
  v_exp_f32 v78, v78
  s_add_u32 m0, s31, 99328
  s_add_u32 s29, s53, s28
  s_add_u32 s29, s29, 1024
  buffer_load_dwordx4 v2, s[8:11], s29 offen sc1 lds
  v_exp_f32 v79, v79
  v_cvt_pk_bf16_f32 v102, v76, v77
  v_cvt_pk_bf16_f32 v103, v78, v79
  s_waitcnt lgkmcnt(4)
  v_mfma_f32_32x32x16_bf16 v[112:127], v[56:59], v[96:99], v[112:127]
  v_exp_f32 v80, v80
  v_exp_f32 v81, v81
  v_exp_f32 v82, v82
  v_exp_f32 v83, v83
  v_mfma_f32_32x32x16_bf16 v[112:127], v[60:63], v[100:103], v[112:127]
  v_cvt_pk_bf16_f32 v104, v80, v81
  v_exp_f32 v84, v84
  v_exp_f32 v85, v85
  v_cvt_pk_bf16_f32 v105, v82, v83
  v_exp_f32 v86, v86
  s_waitcnt lgkmcnt(2)
  v_mfma_f32_32x32x16_bf16 v[64:79], v[32:35], v[192:195], 0
  v_exp_f32 v87, v87
  v_cvt_pk_bf16_f32 v106, v84, v85
  v_exp_f32 v88, v88
  v_exp_f32 v89, v89
  v_cvt_pk_bf16_f32 v107, v86, v87
  v_mfma_f32_32x32x16_bf16 v[64:79], v[36:39], v[196:199], v[64:79]
  v_exp_f32 v90, v90
  v_exp_f32 v91, v91
  ds_read_b128 v[40:43], v3 offset:22528
  v_cvt_pk_bf16_f32 v108, v88, v89
  v_exp_f32 v92, v92
  v_exp_f32 v93, v93
  ds_read_b128 v[44:47], v3 offset:23552
  v_cvt_pk_bf16_f32 v109, v90, v91
  v_exp_f32 v94, v94
  v_exp_f32 v95, v95
  v_cvt_pk_bf16_f32 v110, v92, v93
  v_cvt_pk_bf16_f32 v111, v94, v95
  v_mfma_f32_32x32x16_bf16 v[128:143], v[56:59], v[104:107], v[128:143]
  v_exp_f32 v64, v64
  v_exp_f32 v65, v65
  v_exp_f32 v66, v66
  v_exp_f32 v67, v67
  v_mfma_f32_32x32x16_bf16 v[128:143], v[60:63], v[108:111], v[128:143]
  v_cvt_pk_bf16_f32 v96, v64, v65
  v_exp_f32 v68, v68
  v_exp_f32 v69, v69
  v_cvt_pk_bf16_f32 v97, v66, v67
  v_exp_f32 v70, v70
  v_mfma_f32_32x32x16_bf16 v[80:95], v[32:35], v[200:203], 0
  v_exp_f32 v71, v71
  v_cvt_pk_bf16_f32 v98, v68, v69
  v_exp_f32 v72, v72
  v_exp_f32 v73, v73
  v_cvt_pk_bf16_f32 v99, v70, v71
  v_mfma_f32_32x32x16_bf16 v[80:95], v[36:39], v[204:207], v[80:95]
  v_exp_f32 v74, v74
  v_exp_f32 v75, v75
  ds_read_b128 v[56:59], v3 offset:55296
  v_cvt_pk_bf16_f32 v100, v72, v73
  v_exp_f32 v76, v76
  v_exp_f32 v77, v77
  ds_read_b128 v[60:63], v3 offset:56320
  v_cvt_pk_bf16_f32 v101, v74, v75
  v_exp_f32 v78, v78
  s_add_u32 m0, s31, 100352
  s_add_u32 s29, s53, s28
  s_add_u32 s29, s29, 2048
  buffer_load_dwordx4 v2, s[8:11], s29 offen sc1 lds
  v_exp_f32 v79, v79
  v_cvt_pk_bf16_f32 v102, v76, v77
  v_cvt_pk_bf16_f32 v103, v78, v79
  s_waitcnt lgkmcnt(4)
  v_mfma_f32_32x32x16_bf16 v[112:127], v[48:51], v[96:99], v[112:127]
  v_exp_f32 v80, v80
  v_exp_f32 v81, v81
  v_exp_f32 v82, v82
  v_exp_f32 v83, v83
  v_mfma_f32_32x32x16_bf16 v[112:127], v[52:55], v[100:103], v[112:127]
  v_cvt_pk_bf16_f32 v104, v80, v81
  v_exp_f32 v84, v84
  v_exp_f32 v85, v85
  v_cvt_pk_bf16_f32 v105, v82, v83
  v_exp_f32 v86, v86
  s_waitcnt lgkmcnt(2)
  v_mfma_f32_32x32x16_bf16 v[64:79], v[40:43], v[192:195], 0
  v_exp_f32 v87, v87
  v_cvt_pk_bf16_f32 v106, v84, v85
  v_exp_f32 v88, v88
  v_exp_f32 v89, v89
  v_cvt_pk_bf16_f32 v107, v86, v87
  v_mfma_f32_32x32x16_bf16 v[64:79], v[44:47], v[196:199], v[64:79]
  v_exp_f32 v90, v90
  v_exp_f32 v91, v91
  ds_read_b128 v[32:35], v3 offset:24576
  v_cvt_pk_bf16_f32 v108, v88, v89
  v_exp_f32 v92, v92
  v_exp_f32 v93, v93
  ds_read_b128 v[36:39], v3 offset:25600
  v_cvt_pk_bf16_f32 v109, v90, v91
  v_exp_f32 v94, v94
  v_exp_f32 v95, v95
  v_cvt_pk_bf16_f32 v110, v92, v93
  v_cvt_pk_bf16_f32 v111, v94, v95
  v_mfma_f32_32x32x16_bf16 v[128:143], v[48:51], v[104:107], v[128:143]
  v_exp_f32 v64, v64
  v_exp_f32 v65, v65
  v_exp_f32 v66, v66
  v_exp_f32 v67, v67
  v_mfma_f32_32x32x16_bf16 v[128:143], v[52:55], v[108:111], v[128:143]
  v_cvt_pk_bf16_f32 v96, v64, v65
  v_exp_f32 v68, v68
  v_exp_f32 v69, v69
  v_cvt_pk_bf16_f32 v97, v66, v67
  v_exp_f32 v70, v70
  v_mfma_f32_32x32x16_bf16 v[80:95], v[40:43], v[200:203], 0
  v_exp_f32 v71, v71
  v_cvt_pk_bf16_f32 v98, v68, v69
  v_exp_f32 v72, v72
  v_exp_f32 v73, v73
  v_cvt_pk_bf16_f32 v99, v70, v71
  v_mfma_f32_32x32x16_bf16 v[80:95], v[44:47], v[204:207], v[80:95]
  v_exp_f32 v74, v74
  v_exp_f32 v75, v75
  ds_read_b128 v[48:51], v3 offset:57344
  v_cvt_pk_bf16_f32 v100, v72, v73
  v_exp_f32 v76, v76
  v_exp_f32 v77, v77
  ds_read_b128 v[52:55], v3 offset:58368
  v_cvt_pk_bf16_f32 v101, v74, v75
  v_exp_f32 v78, v78
  s_add_u32 m0, s31, 101376
  s_add_u32 s29, s53, s28
  s_add_u32 s29, s29, 3072
  buffer_load_dwordx4 v2, s[8:11], s29 offen sc1 lds
  v_exp_f32 v79, v79
  v_cvt_pk_bf16_f32 v102, v76, v77
  v_cvt_pk_bf16_f32 v103, v78, v79
  s_waitcnt lgkmcnt(4)
  v_mfma_f32_32x32x16_bf16 v[112:127], v[56:59], v[96:99], v[112:127]
  v_exp_f32 v80, v80
  v_exp_f32 v81, v81
  v_exp_f32 v82, v82
  v_exp_f32 v83, v83
  v_mfma_f32_32x32x16_bf16 v[112:127], v[60:63], v[100:103], v[112:127]
  v_cvt_pk_bf16_f32 v104, v80, v81
  v_exp_f32 v84, v84
  v_exp_f32 v85, v85
  v_cvt_pk_bf16_f32 v105, v82, v83
  v_exp_f32 v86, v86
  s_waitcnt lgkmcnt(2)
  v_mfma_f32_32x32x16_bf16 v[64:79], v[32:35], v[192:195], 0
  v_exp_f32 v87, v87
  v_cvt_pk_bf16_f32 v106, v84, v85
  v_exp_f32 v88, v88
  v_exp_f32 v89, v89
  v_cvt_pk_bf16_f32 v107, v86, v87
  v_mfma_f32_32x32x16_bf16 v[64:79], v[36:39], v[196:199], v[64:79]
  v_exp_f32 v90, v90
  v_exp_f32 v91, v91
  ds_read_b128 v[40:43], v3 offset:26624
  v_cvt_pk_bf16_f32 v108, v88, v89
  v_exp_f32 v92, v92
  v_exp_f32 v93, v93
  ds_read_b128 v[44:47], v3 offset:27648
  v_cvt_pk_bf16_f32 v109, v90, v91
  v_exp_f32 v94, v94
  v_exp_f32 v95, v95
  v_cvt_pk_bf16_f32 v110, v92, v93
  v_cvt_pk_bf16_f32 v111, v94, v95
  v_mfma_f32_32x32x16_bf16 v[128:143], v[56:59], v[104:107], v[128:143]
  v_exp_f32 v64, v64
  v_exp_f32 v65, v65
  v_exp_f32 v66, v66
  v_exp_f32 v67, v67
  v_mfma_f32_32x32x16_bf16 v[128:143], v[60:63], v[108:111], v[128:143]
  v_cvt_pk_bf16_f32 v96, v64, v65
  v_exp_f32 v68, v68
  v_exp_f32 v69, v69
  v_cvt_pk_bf16_f32 v97, v66, v67
  v_exp_f32 v70, v70
  v_mfma_f32_32x32x16_bf16 v[80:95], v[32:35], v[200:203], 0
  v_exp_f32 v71, v71
  v_cvt_pk_bf16_f32 v98, v68, v69
  v_exp_f32 v72, v72
  v_exp_f32 v73, v73
  v_cvt_pk_bf16_f32 v99, v70, v71
  v_mfma_f32_32x32x16_bf16 v[80:95], v[36:39], v[204:207], v[80:95]
  v_exp_f32 v74, v74
  v_exp_f32 v75, v75
  ds_read_b128 v[56:59], v3 offset:59392
  v_cvt_pk_bf16_f32 v100, v72, v73
  v_exp_f32 v76, v76
  v_exp_f32 v77, v77
  ds_read_b128 v[60:63], v3 offset:60416
  v_cvt_pk_bf16_f32 v101, v74, v75
  v_exp_f32 v78, v78
  s_add_u32 m0, s31, 102400
  s_add_u32 s29, s53, s28
  s_add_u32 s29, s29, 4096
  buffer_load_dwordx4 v2, s[8:11], s29 offen sc1 lds
  v_exp_f32 v79, v79
  v_cvt_pk_bf16_f32 v102, v76, v77
  v_cvt_pk_bf16_f32 v103, v78, v79
  s_waitcnt lgkmcnt(4)
  v_mfma_f32_32x32x16_bf16 v[112:127], v[48:51], v[96:99], v[112:127]
  v_exp_f32 v80, v80
  v_exp_f32 v81, v81
  v_exp_f32 v82, v82
  v_exp_f32 v83, v83
  v_mfma_f32_32x32x16_bf16 v[112:127], v[52:55], v[100:103], v[112:127]
  v_cvt_pk_bf16_f32 v104, v80, v81
  v_exp_f32 v84, v84
  v_exp_f32 v85, v85
  v_cvt_pk_bf16_f32 v105, v82, v83
  v_exp_f32 v86, v86
  s_waitcnt lgkmcnt(2)
  v_mfma_f32_32x32x16_bf16 v[64:79], v[40:43], v[192:195], 0
  v_exp_f32 v87, v87
  v_cvt_pk_bf16_f32 v106, v84, v85
  v_exp_f32 v88, v88
  v_exp_f32 v89, v89
  v_cvt_pk_bf16_f32 v107, v86, v87
  v_mfma_f32_32x32x16_bf16 v[64:79], v[44:47], v[196:199], v[64:79]
  v_exp_f32 v90, v90
  v_exp_f32 v91, v91
  ds_read_b128 v[32:35], v3 offset:28672
  v_cvt_pk_bf16_f32 v108, v88, v89
  v_exp_f32 v92, v92
  v_exp_f32 v93, v93
  ds_read_b128 v[36:39], v3 offset:29696
  v_cvt_pk_bf16_f32 v109, v90, v91
  v_exp_f32 v94, v94
  v_exp_f32 v95, v95
  v_cvt_pk_bf16_f32 v110, v92, v93
  v_cvt_pk_bf16_f32 v111, v94, v95
  v_mfma_f32_32x32x16_bf16 v[128:143], v[48:51], v[104:107], v[128:143]
  v_exp_f32 v64, v64
  v_exp_f32 v65, v65
  v_exp_f32 v66, v66
  v_exp_f32 v67, v67
  v_mfma_f32_32x32x16_bf16 v[128:143], v[52:55], v[108:111], v[128:143]
  v_cvt_pk_bf16_f32 v96, v64, v65
  v_exp_f32 v68, v68
  v_exp_f32 v69, v69
  v_cvt_pk_bf16_f32 v97, v66, v67
  v_exp_f32 v70, v70
  v_mfma_f32_32x32x16_bf16 v[80:95], v[40:43], v[200:203], 0
  v_exp_f32 v71, v71
  v_cvt_pk_bf16_f32 v98, v68, v69
  v_exp_f32 v72, v72
  v_exp_f32 v73, v73
  v_cvt_pk_bf16_f32 v99, v70, v71
  v_mfma_f32_32x32x16_bf16 v[80:95], v[44:47], v[204:207], v[80:95]
  v_exp_f32 v74, v74
  v_exp_f32 v75, v75
  ds_read_b128 v[48:51], v3 offset:61440
  v_cvt_pk_bf16_f32 v100, v72, v73
  v_exp_f32 v76, v76
  v_exp_f32 v77, v77
  ds_read_b128 v[52:55], v3 offset:62464
  v_cvt_pk_bf16_f32 v101, v74, v75
  v_exp_f32 v78, v78
  s_add_u32 m0, s31, 103424
  s_add_u32 s29, s53, s28
  s_add_u32 s29, s29, 5120
  buffer_load_dwordx4 v2, s[8:11], s29 offen sc1 lds
  v_exp_f32 v79, v79
  v_cvt_pk_bf16_f32 v102, v76, v77
  v_cvt_pk_bf16_f32 v103, v78, v79
  s_waitcnt lgkmcnt(4)
  v_mfma_f32_32x32x16_bf16 v[112:127], v[56:59], v[96:99], v[112:127]
  v_exp_f32 v80, v80
  v_exp_f32 v81, v81
  v_exp_f32 v82, v82
  v_exp_f32 v83, v83
  v_mfma_f32_32x32x16_bf16 v[112:127], v[60:63], v[100:103], v[112:127]
  v_cvt_pk_bf16_f32 v104, v80, v81
  v_exp_f32 v84, v84
  v_exp_f32 v85, v85
  v_cvt_pk_bf16_f32 v105, v82, v83
  v_exp_f32 v86, v86
  s_waitcnt lgkmcnt(2)
  v_mfma_f32_32x32x16_bf16 v[64:79], v[32:35], v[192:195], 0
  v_exp_f32 v87, v87
  v_cvt_pk_bf16_f32 v106, v84, v85
  v_exp_f32 v88, v88
  v_exp_f32 v89, v89
  v_cvt_pk_bf16_f32 v107, v86, v87
  v_mfma_f32_32x32x16_bf16 v[64:79], v[36:39], v[196:199], v[64:79]
  v_exp_f32 v90, v90
  v_exp_f32 v91, v91
  ds_read_b128 v[40:43], v3 offset:30720
  v_cvt_pk_bf16_f32 v108, v88, v89
  v_exp_f32 v92, v92
  v_exp_f32 v93, v93
  ds_read_b128 v[44:47], v3 offset:31744
  v_cvt_pk_bf16_f32 v109, v90, v91
  v_exp_f32 v94, v94
  v_exp_f32 v95, v95
  v_cvt_pk_bf16_f32 v110, v92, v93
  v_cvt_pk_bf16_f32 v111, v94, v95
  v_mfma_f32_32x32x16_bf16 v[128:143], v[56:59], v[104:107], v[128:143]
  v_exp_f32 v64, v64
  v_exp_f32 v65, v65
  v_exp_f32 v66, v66
  v_exp_f32 v67, v67
  v_mfma_f32_32x32x16_bf16 v[128:143], v[60:63], v[108:111], v[128:143]
  v_cvt_pk_bf16_f32 v96, v64, v65
  v_exp_f32 v68, v68
  v_exp_f32 v69, v69
  v_cvt_pk_bf16_f32 v97, v66, v67
  v_exp_f32 v70, v70
  v_mfma_f32_32x32x16_bf16 v[80:95], v[32:35], v[200:203], 0
  v_exp_f32 v71, v71
  v_cvt_pk_bf16_f32 v98, v68, v69
  v_exp_f32 v72, v72
  v_exp_f32 v73, v73
  v_cvt_pk_bf16_f32 v99, v70, v71
  v_mfma_f32_32x32x16_bf16 v[80:95], v[36:39], v[204:207], v[80:95]
  v_exp_f32 v74, v74
  v_exp_f32 v75, v75
  ds_read_b128 v[56:59], v3 offset:63488
  v_cvt_pk_bf16_f32 v100, v72, v73
  v_exp_f32 v76, v76
  v_exp_f32 v77, v77
  ds_read_b128 v[60:63], v3 offset:64512
  v_cvt_pk_bf16_f32 v101, v74, v75
  v_exp_f32 v78, v78
  s_add_u32 m0, s31, 104448
  s_add_u32 s29, s53, s28
  s_add_u32 s29, s29, 6144
  buffer_load_dwordx4 v2, s[8:11], s29 offen sc1 lds
  v_exp_f32 v79, v79
  v_cvt_pk_bf16_f32 v102, v76, v77
  v_cvt_pk_bf16_f32 v103, v78, v79
  s_waitcnt lgkmcnt(4)
  v_mfma_f32_32x32x16_bf16 v[112:127], v[48:51], v[96:99], v[112:127]
  v_exp_f32 v80, v80
  v_exp_f32 v81, v81
  v_exp_f32 v82, v82
  v_exp_f32 v83, v83
  v_mfma_f32_32x32x16_bf16 v[112:127], v[52:55], v[100:103], v[112:127]
  v_cvt_pk_bf16_f32 v104, v80, v81
  v_exp_f32 v84, v84
  v_exp_f32 v85, v85
  v_cvt_pk_bf16_f32 v105, v82, v83
  v_exp_f32 v86, v86
  s_waitcnt lgkmcnt(2)
  v_mfma_f32_32x32x16_bf16 v[64:79], v[40:43], v[192:195], 0
  v_exp_f32 v87, v87
  v_cvt_pk_bf16_f32 v106, v84, v85
  v_exp_f32 v88, v88
  v_exp_f32 v89, v89
  v_cvt_pk_bf16_f32 v107, v86, v87
  v_mfma_f32_32x32x16_bf16 v[64:79], v[44:47], v[196:199], v[64:79]
  v_exp_f32 v90, v90
  v_exp_f32 v91, v91
  v_cvt_pk_bf16_f32 v108, v88, v89
  v_exp_f32 v92, v92
  v_exp_f32 v93, v93
  v_cvt_pk_bf16_f32 v109, v90, v91
  v_exp_f32 v94, v94
  v_exp_f32 v95, v95
  v_cvt_pk_bf16_f32 v110, v92, v93
  v_cvt_pk_bf16_f32 v111, v94, v95
  v_mfma_f32_32x32x16_bf16 v[128:143], v[48:51], v[104:107], v[128:143]
  v_exp_f32 v64, v64
  v_exp_f32 v65, v65
  v_exp_f32 v66, v66
  v_exp_f32 v67, v67
  v_mfma_f32_32x32x16_bf16 v[128:143], v[52:55], v[108:111], v[128:143]
  v_cvt_pk_bf16_f32 v96, v64, v65
  v_exp_f32 v68, v68
  v_exp_f32 v69, v69
  v_cvt_pk_bf16_f32 v97, v66, v67
  v_exp_f32 v70, v70
  v_mfma_f32_32x32x16_bf16 v[80:95], v[40:43], v[200:203], 0
  v_exp_f32 v71, v71
  v_cvt_pk_bf16_f32 v98, v68, v69
  v_exp_f32 v72, v72
  v_exp_f32 v73, v73
  v_cvt_pk_bf16_f32 v99, v70, v71
  v_mfma_f32_32x32x16_bf16 v[80:95], v[44:47], v[204:207], v[80:95]
  v_exp_f32 v74, v74
  v_exp_f32 v75, v75
  v_cvt_pk_bf16_f32 v100, v72, v73
  v_exp_f32 v76, v76
  v_exp_f32 v77, v77
  v_cvt_pk_bf16_f32 v101, v74, v75
  v_exp_f32 v78, v78
  s_add_u32 m0, s31, 105472
  s_add_u32 s29, s53, s28
  s_add_u32 s29, s29, 7168
  buffer_load_dwordx4 v2, s[8:11], s29 offen sc1 lds
  v_exp_f32 v79, v79
  v_cvt_pk_bf16_f32 v102, v76, v77
  v_cvt_pk_bf16_f32 v103, v78, v79
  s_waitcnt lgkmcnt(0)
  v_mfma_f32_32x32x16_bf16 v[112:127], v[56:59], v[96:99], v[112:127]
  v_exp_f32 v80, v80
  v_exp_f32 v81, v81
  v_exp_f32 v82, v82
  v_exp_f32 v83, v83
  v_mfma_f32_32x32x16_bf16 v[112:127], v[60:63], v[100:103], v[112:127]
  v_cvt_pk_bf16_f32 v104, v80, v81
  v_exp_f32 v84, v84
  v_exp_f32 v85, v85
  v_cvt_pk_bf16_f32 v105, v82, v83
  v_exp_f32 v86, v86
  v_exp_f32 v87, v87
  v_cvt_pk_bf16_f32 v106, v84, v85
  v_exp_f32 v88, v88
  v_exp_f32 v89, v89
  v_cvt_pk_bf16_f32 v107, v86, v87
  v_exp_f32 v90, v90
  v_exp_f32 v91, v91
  v_cvt_pk_bf16_f32 v108, v88, v89
  v_exp_f32 v92, v92
  v_exp_f32 v93, v93
  v_cvt_pk_bf16_f32 v109, v90, v91
  v_exp_f32 v94, v94
  v_exp_f32 v95, v95
  v_cvt_pk_bf16_f32 v110, v92, v93
  v_cvt_pk_bf16_f32 v111, v94, v95
  s_nop 1
  v_mfma_f32_32x32x16_bf16 v[128:143], v[56:59], v[104:107], v[128:143]
  v_mfma_f32_32x32x16_bf16 v[128:143], v[60:63], v[108:111], v[128:143]
  s_waitcnt vmcnt(0)
  s_barrier
  s_add_u32 s41, s41, 1
  s_min_u32 s29, s41, 3
  s_mul_i32 s53, s29, 32768
  s_lshl_b32 s31, s21, 13
  s_add_u32 s53, s53, s31
  ds_read_b128 v[32:35], v4 offset:0
  ds_read_b128 v[36:39], v4 offset:1024
  ds_read_b128 v[48:51], v4 offset:32768
  ds_read_b128 v[52:55], v4 offset:33792
  ds_read_b128 v[40:43], v4 offset:2048
  ds_read_b128 v[44:47], v4 offset:3072
  s_waitcnt lgkmcnt(4)
  v_mfma_f32_32x32x16_bf16 v[64:79], v[32:35], v[192:195], 0
  v_mfma_f32_32x32x16_bf16 v[64:79], v[36:39], v[196:199], v[64:79]
  s_nop 11
  v_exp_f32 v64, v64
  v_exp_f32 v65, v65
  v_exp_f32 v66, v66
  v_exp_f32 v67, v67
  v_cvt_pk_bf16_f32 v96, v64, v65
  v_exp_f32 v68, v68
  v_exp_f32 v69, v69
  v_cvt_pk_bf16_f32 v97, v66, v67
  v_exp_f32 v70, v70
  v_mfma_f32_32x32x16_bf16 v[80:95], v[32:35], v[200:203], 0
  v_exp_f32 v71, v71
  v_cvt_pk_bf16_f32 v98, v68, v69
  v_exp_f32 v72, v72
  v_exp_f32 v73, v73
  v_cvt_pk_bf16_f32 v99, v70, v71
  v_mfma_f32_32x32x16_bf16 v[80:95], v[36:39], v[204:207], v[80:95]
  v_exp_f32 v74, v74
  v_exp_f32 v75, v75
  ds_read_b128 v[56:59], v4 offset:34816
  v_cvt_pk_bf16_f32 v100, v72, v73
  v_exp_f32 v76, v76
  v_exp_f32 v77, v77
  ds_read_b128 v[60:63], v4 offset:35840
  v_cvt_pk_bf16_f32 v101, v74, v75
  v_exp_f32 v78, v78
  s_add_u32 m0, s31, 0
  s_add_u32 s29, s53, s27
  s_add_u32 s29, s29, 0
  buffer_load_dwordx4 v2, s[8:11], s29 offen sc1 lds
  v_exp_f32 v79, v79
  v_cvt_pk_bf16_f32 v102, v76, v77
  v_cvt_pk_bf16_f32 v103, v78, v79
  s_waitcnt lgkmcnt(4)
  v_mfma_f32_32x32x16_bf16 v[112:127], v[48:51], v[96:99], v[112:127]
  v_exp_f32 v80, v80
  v_exp_f32 v81, v81
  v_exp_f32 v82, v82
  v_exp_f32 v83, v83
  v_mfma_f32_32x32x16_bf16 v[112:127], v[52:55], v[100:103], v[112:127]
  v_cvt_pk_bf16_f32 v104, v80, v81
  v_exp_f32 v84, v84
  v_exp_f32 v85, v85
  v_cvt_pk_bf16_f32 v105, v82, v83
  v_exp_f32 v86, v86
  s_waitcnt lgkmcnt(2)
  v_mfma_f32_32x32x16_bf16 v[64:79], v[40:43], v[192:195], 0
  v_exp_f32 v87, v87
  v_cvt_pk_bf16_f32 v106, v84, v85
  v_exp_f32 v88, v88
  v_exp_f32 v89, v89
  v_cvt_pk_bf16_f32 v107, v86, v87
  v_mfma_f32_32x32x16_bf16 v[64:79], v[44:47], v[196:199], v[64:79]
  v_exp_f32 v90, v90
  v_exp_f32 v91, v91
  ds_read_b128 v[32:35], v4 offset:4096
  v_cvt_pk_bf16_f32 v108, v88, v89
  v_exp_f32 v92, v92
  v_exp_f32 v93, v93
  ds_read_b128 v[36:39], v4 offset:5120
  v_cvt_pk_bf16_f32 v109, v90, v91
  v_exp_f32 v94, v94
  v_exp_f32 v95, v95
  v_cvt_pk_bf16_f32 v110, v92, v93
  v_cvt_pk_bf16_f32 v111, v94, v95
  v_mfma_f32_32x32x16_bf16 v[128:143], v[48:51], v[104:107], v[128:143]
  v_exp_f32 v64, v64
  v_exp_f32 v65, v65
  v_exp_f32 v66, v66
  v_exp_f32 v67, v67
  v_mfma_f32_32x32x16_bf16 v[128:143], v[52:55], v[108:111], v[128:143]
  v_cvt_pk_bf16_f32 v96, v64, v65
  v_exp_f32 v68, v68
  v_exp_f32 v69, v69
  v_cvt_pk_bf16_f32 v97, v66, v67
  v_exp_f32 v70, v70
  v_mfma_f32_32x32x16_bf16 v[80:95], v[40:43], v[200:203], 0
  v_exp_f32 v71, v71
  v_cvt_pk_bf16_f32 v98, v68, v69
  v_exp_f32 v72, v72
  v_exp_f32 v73, v73
  v_cvt_pk_bf16_f32 v99, v70, v71
  v_mfma_f32_32x32x16_bf16 v[80:95], v[44:47], v[204:207], v[80:95]
  v_exp_f32 v74, v74
  v_exp_f32 v75, v75
  ds_read_b128 v[48:51], v4 offset:36864
  v_cvt_pk_bf16_f32 v100, v72, v73
  v_exp_f32 v76, v76
  v_exp_f32 v77, v77
  ds_read_b128 v[52:55], v4 offset:37888
  v_cvt_pk_bf16_f32 v101, v74, v75
  v_exp_f32 v78, v78
  s_add_u32 m0, s31, 1024
  s_add_u32 s29, s53, s27
  s_add_u32 s29, s29, 1024
  buffer_load_dwordx4 v2, s[8:11], s29 offen sc1 lds
  v_exp_f32 v79, v79
  v_cvt_pk_bf16_f32 v102, v76, v77
  v_cvt_pk_bf16_f32 v103, v78, v79
  s_waitcnt lgkmcnt(4)
  v_mfma_f32_32x32x16_bf16 v[112:127], v[56:59], v[96:99], v[112:127]
  v_exp_f32 v80, v80
  v_exp_f32 v81, v81
  v_exp_f32 v82, v82
  v_exp_f32 v83, v83
  v_mfma_f32_32x32x16_bf16 v[112:127], v[60:63], v[100:103], v[112:127]
  v_cvt_pk_bf16_f32 v104, v80, v81
  v_exp_f32 v84, v84
  v_exp_f32 v85, v85
  v_cvt_pk_bf16_f32 v105, v82, v83
  v_exp_f32 v86, v86
  s_waitcnt lgkmcnt(2)
  v_mfma_f32_32x32x16_bf16 v[64:79], v[32:35], v[192:195], 0
  v_exp_f32 v87, v87
  v_cvt_pk_bf16_f32 v106, v84, v85
  v_exp_f32 v88, v88
  v_exp_f32 v89, v89
  v_cvt_pk_bf16_f32 v107, v86, v87
  v_mfma_f32_32x32x16_bf16 v[64:79], v[36:39], v[196:199], v[64:79]
  v_exp_f32 v90, v90
  v_exp_f32 v91, v91
  ds_read_b128 v[40:43], v4 offset:6144
  v_cvt_pk_bf16_f32 v108, v88, v89
  v_exp_f32 v92, v92
  v_exp_f32 v93, v93
  ds_read_b128 v[44:47], v4 offset:7168
  v_cvt_pk_bf16_f32 v109, v90, v91
  v_exp_f32 v94, v94
  v_exp_f32 v95, v95
  v_cvt_pk_bf16_f32 v110, v92, v93
  v_cvt_pk_bf16_f32 v111, v94, v95
  v_mfma_f32_32x32x16_bf16 v[128:143], v[56:59], v[104:107], v[128:143]
  v_exp_f32 v64, v64
  v_exp_f32 v65, v65
  v_exp_f32 v66, v66
  v_exp_f32 v67, v67
  v_mfma_f32_32x32x16_bf16 v[128:143], v[60:63], v[108:111], v[128:143]
  v_cvt_pk_bf16_f32 v96, v64, v65
  v_exp_f32 v68, v68
  v_exp_f32 v69, v69
  v_cvt_pk_bf16_f32 v97, v66, v67
  v_exp_f32 v70, v70
  v_mfma_f32_32x32x16_bf16 v[80:95], v[32:35], v[200:203], 0
  v_exp_f32 v71, v71
  v_cvt_pk_bf16_f32 v98, v68, v69
  v_exp_f32 v72, v72
  v_exp_f32 v73, v73
  v_cvt_pk_bf16_f32 v99, v70, v71
  v_mfma_f32_32x32x16_bf16 v[80:95], v[36:39], v[204:207], v[80:95]
  v_exp_f32 v74, v74
  v_exp_f32 v75, v75
  ds_read_b128 v[56:59], v4 offset:38912
  v_cvt_pk_bf16_f32 v100, v72, v73
  v_exp_f32 v76, v76
  v_exp_f32 v77, v77
  ds_read_b128 v[60:63], v4 offset:39936
  v_cvt_pk_bf16_f32 v101, v74, v75
  v_exp_f32 v78, v78
  s_add_u32 m0, s31, 2048
  s_add_u32 s29, s53, s27
  s_add_u32 s29, s29, 2048
  buffer_load_dwordx4 v2, s[8:11], s29 offen sc1 lds
  v_exp_f32 v79, v79
  v_cvt_pk_bf16_f32 v102, v76, v77
  v_cvt_pk_bf16_f32 v103, v78, v79
  s_waitcnt lgkmcnt(4)
  v_mfma_f32_32x32x16_bf16 v[112:127], v[48:51], v[96:99], v[112:127]
  v_exp_f32 v80, v80
  v_exp_f32 v81, v81
  v_exp_f32 v82, v82
  v_exp_f32 v83, v83
  v_mfma_f32_32x32x16_bf16 v[112:127], v[52:55], v[100:103], v[112:127]
  v_cvt_pk_bf16_f32 v104, v80, v81
  v_exp_f32 v84, v84
  v_exp_f32 v85, v85
  v_cvt_pk_bf16_f32 v105, v82, v83
  v_exp_f32 v86, v86
  s_waitcnt lgkmcnt(2)
  v_mfma_f32_32x32x16_bf16 v[64:79], v[40:43], v[192:195], 0
  v_exp_f32 v87, v87
  v_cvt_pk_bf16_f32 v106, v84, v85
  v_exp_f32 v88, v88
  v_exp_f32 v89, v89
  v_cvt_pk_bf16_f32 v107, v86, v87
  v_mfma_f32_32x32x16_bf16 v[64:79], v[44:47], v[196:199], v[64:79]
  v_exp_f32 v90, v90
  v_exp_f32 v91, v91
  ds_read_b128 v[32:35], v4 offset:8192
  v_cvt_pk_bf16_f32 v108, v88, v89
  v_exp_f32 v92, v92
  v_exp_f32 v93, v93
  ds_read_b128 v[36:39], v4 offset:9216
  v_cvt_pk_bf16_f32 v109, v90, v91
  v_exp_f32 v94, v94
  v_exp_f32 v95, v95
  v_cvt_pk_bf16_f32 v110, v92, v93
  v_cvt_pk_bf16_f32 v111, v94, v95
  v_mfma_f32_32x32x16_bf16 v[128:143], v[48:51], v[104:107], v[128:143]
  v_exp_f32 v64, v64
  v_exp_f32 v65, v65
  v_exp_f32 v66, v66
  v_exp_f32 v67, v67
  v_mfma_f32_32x32x16_bf16 v[128:143], v[52:55], v[108:111], v[128:143]
  v_cvt_pk_bf16_f32 v96, v64, v65
  v_exp_f32 v68, v68
  v_exp_f32 v69, v69
  v_cvt_pk_bf16_f32 v97, v66, v67
  v_exp_f32 v70, v70
  v_mfma_f32_32x32x16_bf16 v[80:95], v[40:43], v[200:203], 0
  v_exp_f32 v71, v71
  v_cvt_pk_bf16_f32 v98, v68, v69
  v_exp_f32 v72, v72
  v_exp_f32 v73, v73
  v_cvt_pk_bf16_f32 v99, v70, v71
  v_mfma_f32_32x32x16_bf16 v[80:95], v[44:47], v[204:207], v[80:95]
  v_exp_f32 v74, v74
  v_exp_f32 v75, v75
  ds_read_b128 v[48:51], v4 offset:40960
  v_cvt_pk_bf16_f32 v100, v72, v73
  v_exp_f32 v76, v76
  v_exp_f32 v77, v77
  ds_read_b128 v[52:55], v4 offset:41984
  v_cvt_pk_bf16_f32 v101, v74, v75
  v_exp_f32 v78, v78
  s_add_u32 m0, s31, 3072
  s_add_u32 s29, s53, s27
  s_add_u32 s29, s29, 3072
  buffer_load_dwordx4 v2, s[8:11], s29 offen sc1 lds
  v_exp_f32 v79, v79
  v_cvt_pk_bf16_f32 v102, v76, v77
  v_cvt_pk_bf16_f32 v103, v78, v79
  s_waitcnt lgkmcnt(4)
  v_mfma_f32_32x32x16_bf16 v[112:127], v[56:59], v[96:99], v[112:127]
  v_exp_f32 v80, v80
  v_exp_f32 v81, v81
  v_exp_f32 v82, v82
  v_exp_f32 v83, v83
  v_mfma_f32_32x32x16_bf16 v[112:127], v[60:63], v[100:103], v[112:127]
  v_cvt_pk_bf16_f32 v104, v80, v81
  v_exp_f32 v84, v84
  v_exp_f32 v85, v85
  v_cvt_pk_bf16_f32 v105, v82, v83
  v_exp_f32 v86, v86
  s_waitcnt lgkmcnt(2)
  v_mfma_f32_32x32x16_bf16 v[64:79], v[32:35], v[192:195], 0
  v_exp_f32 v87, v87
  v_cvt_pk_bf16_f32 v106, v84, v85
  v_exp_f32 v88, v88
  v_exp_f32 v89, v89
  v_cvt_pk_bf16_f32 v107, v86, v87
  v_mfma_f32_32x32x16_bf16 v[64:79], v[36:39], v[196:199], v[64:79]
  v_exp_f32 v90, v90
  v_exp_f32 v91, v91
  ds_read_b128 v[40:43], v4 offset:10240
  v_cvt_pk_bf16_f32 v108, v88, v89
  v_exp_f32 v92, v92
  v_exp_f32 v93, v93
  ds_read_b128 v[44:47], v4 offset:11264
  v_cvt_pk_bf16_f32 v109, v90, v91
  v_exp_f32 v94, v94
  v_exp_f32 v95, v95
  v_cvt_pk_bf16_f32 v110, v92, v93
  v_cvt_pk_bf16_f32 v111, v94, v95
  v_mfma_f32_32x32x16_bf16 v[128:143], v[56:59], v[104:107], v[128:143]
  v_exp_f32 v64, v64
  v_exp_f32 v65, v65
  v_exp_f32 v66, v66
  v_exp_f32 v67, v67
  v_mfma_f32_32x32x16_bf16 v[128:143], v[60:63], v[108:111], v[128:143]
  v_cvt_pk_bf16_f32 v96, v64, v65
  v_exp_f32 v68, v68
  v_exp_f32 v69, v69
  v_cvt_pk_bf16_f32 v97, v66, v67
  v_exp_f32 v70, v70
  v_mfma_f32_32x32x16_bf16 v[80:95], v[32:35], v[200:203], 0
  v_exp_f32 v71, v71
  v_cvt_pk_bf16_f32 v98, v68, v69
  v_exp_f32 v72, v72
  v_exp_f32 v73, v73
  v_cvt_pk_bf16_f32 v99, v70, v71
  v_mfma_f32_32x32x16_bf16 v[80:95], v[36:39], v[204:207], v[80:95]
  v_exp_f32 v74, v74
  v_exp_f32 v75, v75
  ds_read_b128 v[56:59], v4 offset:43008
  v_cvt_pk_bf16_f32 v100, v72, v73
  v_exp_f32 v76, v76
  v_exp_f32 v77, v77
  ds_read_b128 v[60:63], v4 offset:44032
  v_cvt_pk_bf16_f32 v101, v74, v75
  v_exp_f32 v78, v78
  s_add_u32 m0, s31, 4096
  s_add_u32 s29, s53, s27
  s_add_u32 s29, s29, 4096
  buffer_load_dwordx4 v2, s[8:11], s29 offen sc1 lds
  v_exp_f32 v79, v79
  v_cvt_pk_bf16_f32 v102, v76, v77
  v_cvt_pk_bf16_f32 v103, v78, v79
  s_waitcnt lgkmcnt(4)
  v_mfma_f32_32x32x16_bf16 v[112:127], v[48:51], v[96:99], v[112:127]
  v_exp_f32 v80, v80
  v_exp_f32 v81, v81
  v_exp_f32 v82, v82
  v_exp_f32 v83, v83
  v_mfma_f32_32x32x16_bf16 v[112:127], v[52:55], v[100:103], v[112:127]
  v_cvt_pk_bf16_f32 v104, v80, v81
  v_exp_f32 v84, v84
  v_exp_f32 v85, v85
  v_cvt_pk_bf16_f32 v105, v82, v83
  v_exp_f32 v86, v86
  s_waitcnt lgkmcnt(2)
  v_mfma_f32_32x32x16_bf16 v[64:79], v[40:43], v[192:195], 0
  v_exp_f32 v87, v87
  v_cvt_pk_bf16_f32 v106, v84, v85
  v_exp_f32 v88, v88
  v_exp_f32 v89, v89
  v_cvt_pk_bf16_f32 v107, v86, v87
  v_mfma_f32_32x32x16_bf16 v[64:79], v[44:47], v[196:199], v[64:79]
  v_exp_f32 v90, v90
  v_exp_f32 v91, v91
  ds_read_b128 v[32:35], v4 offset:12288
  v_cvt_pk_bf16_f32 v108, v88, v89
  v_exp_f32 v92, v92
  v_exp_f32 v93, v93
  ds_read_b128 v[36:39], v4 offset:13312
  v_cvt_pk_bf16_f32 v109, v90, v91
  v_exp_f32 v94, v94
  v_exp_f32 v95, v95
  v_cvt_pk_bf16_f32 v110, v92, v93
  v_cvt_pk_bf16_f32 v111, v94, v95
  v_mfma_f32_32x32x16_bf16 v[128:143], v[48:51], v[104:107], v[128:143]
  v_exp_f32 v64, v64
  v_exp_f32 v65, v65
  v_exp_f32 v66, v66
  v_exp_f32 v67, v67
  v_mfma_f32_32x32x16_bf16 v[128:143], v[52:55], v[108:111], v[128:143]
  v_cvt_pk_bf16_f32 v96, v64, v65
  v_exp_f32 v68, v68
  v_exp_f32 v69, v69
  v_cvt_pk_bf16_f32 v97, v66, v67
  v_exp_f32 v70, v70
  v_mfma_f32_32x32x16_bf16 v[80:95], v[40:43], v[200:203], 0
  v_exp_f32 v71, v71
  v_cvt_pk_bf16_f32 v98, v68, v69
  v_exp_f32 v72, v72
  v_exp_f32 v73, v73
  v_cvt_pk_bf16_f32 v99, v70, v71
  v_mfma_f32_32x32x16_bf16 v[80:95], v[44:47], v[204:207], v[80:95]
  v_exp_f32 v74, v74
  v_exp_f32 v75, v75
  ds_read_b128 v[48:51], v4 offset:45056
  v_cvt_pk_bf16_f32 v100, v72, v73
  v_exp_f32 v76, v76
  v_exp_f32 v77, v77
  ds_read_b128 v[52:55], v4 offset:46080
  v_cvt_pk_bf16_f32 v101, v74, v75
  v_exp_f32 v78, v78
  s_add_u32 m0, s31, 5120
  s_add_u32 s29, s53, s27
  s_add_u32 s29, s29, 5120
  buffer_load_dwordx4 v2, s[8:11], s29 offen sc1 lds
  v_exp_f32 v79, v79
  v_cvt_pk_bf16_f32 v102, v76, v77
  v_cvt_pk_bf16_f32 v103, v78, v79
  s_waitcnt lgkmcnt(4)
  v_mfma_f32_32x32x16_bf16 v[112:127], v[56:59], v[96:99], v[112:127]
  v_exp_f32 v80, v80
  v_exp_f32 v81, v81
  v_exp_f32 v82, v82
  v_exp_f32 v83, v83
  v_mfma_f32_32x32x16_bf16 v[112:127], v[60:63], v[100:103], v[112:127]
  v_cvt_pk_bf16_f32 v104, v80, v81
  v_exp_f32 v84, v84
  v_exp_f32 v85, v85
  v_cvt_pk_bf16_f32 v105, v82, v83
  v_exp_f32 v86, v86
  s_waitcnt lgkmcnt(2)
  v_mfma_f32_32x32x16_bf16 v[64:79], v[32:35], v[192:195], 0
  v_exp_f32 v87, v87
  v_cvt_pk_bf16_f32 v106, v84, v85
  v_exp_f32 v88, v88
  v_exp_f32 v89, v89
  v_cvt_pk_bf16_f32 v107, v86, v87
  v_mfma_f32_32x32x16_bf16 v[64:79], v[36:39], v[196:199], v[64:79]
  v_exp_f32 v90, v90
  v_exp_f32 v91, v91
  ds_read_b128 v[40:43], v4 offset:14336
  v_cvt_pk_bf16_f32 v108, v88, v89
  v_exp_f32 v92, v92
  v_exp_f32 v93, v93
  ds_read_b128 v[44:47], v4 offset:15360
  v_cvt_pk_bf16_f32 v109, v90, v91
  v_exp_f32 v94, v94
  v_exp_f32 v95, v95
  v_cvt_pk_bf16_f32 v110, v92, v93
  v_cvt_pk_bf16_f32 v111, v94, v95
  v_mfma_f32_32x32x16_bf16 v[128:143], v[56:59], v[104:107], v[128:143]
  v_exp_f32 v64, v64
  v_exp_f32 v65, v65
  v_exp_f32 v66, v66
  v_exp_f32 v67, v67
  v_mfma_f32_32x32x16_bf16 v[128:143], v[60:63], v[108:111], v[128:143]
  v_cvt_pk_bf16_f32 v96, v64, v65
  v_exp_f32 v68, v68
  v_exp_f32 v69, v69
  v_cvt_pk_bf16_f32 v97, v66, v67
  v_exp_f32 v70, v70
  v_mfma_f32_32x32x16_bf16 v[80:95], v[32:35], v[200:203], 0
  v_exp_f32 v71, v71
  v_cvt_pk_bf16_f32 v98, v68, v69
  v_exp_f32 v72, v72
  v_exp_f32 v73, v73
  v_cvt_pk_bf16_f32 v99, v70, v71
  v_mfma_f32_32x32x16_bf16 v[80:95], v[36:39], v[204:207], v[80:95]
  v_exp_f32 v74, v74
  v_exp_f32 v75, v75
  ds_read_b128 v[56:59], v4 offset:47104
  v_cvt_pk_bf16_f32 v100, v72, v73
  v_exp_f32 v76, v76
  v_exp_f32 v77, v77
  ds_read_b128 v[60:63], v4 offset:48128
  v_cvt_pk_bf16_f32 v101, v74, v75
  v_exp_f32 v78, v78
  s_add_u32 m0, s31, 6144
  s_add_u32 s29, s53, s27
  s_add_u32 s29, s29, 6144
  buffer_load_dwordx4 v2, s[8:11], s29 offen sc1 lds
  v_exp_f32 v79, v79
  v_cvt_pk_bf16_f32 v102, v76, v77
  v_cvt_pk_bf16_f32 v103, v78, v79
  s_waitcnt lgkmcnt(4)
  v_mfma_f32_32x32x16_bf16 v[112:127], v[48:51], v[96:99], v[112:127]
  v_exp_f32 v80, v80
  v_exp_f32 v81, v81
  v_exp_f32 v82, v82
  v_exp_f32 v83, v83
  v_mfma_f32_32x32x16_bf16 v[112:127], v[52:55], v[100:103], v[112:127]
  v_cvt_pk_bf16_f32 v104, v80, v81
  v_exp_f32 v84, v84
  v_exp_f32 v85, v85
  v_cvt_pk_bf16_f32 v105, v82, v83
  v_exp_f32 v86, v86
  s_waitcnt lgkmcnt(2)
  v_mfma_f32_32x32x16_bf16 v[64:79], v[40:43], v[192:195], 0
  v_exp_f32 v87, v87
  v_cvt_pk_bf16_f32 v106, v84, v85
  v_exp_f32 v88, v88
  v_exp_f32 v89, v89
  v_cvt_pk_bf16_f32 v107, v86, v87
  v_mfma_f32_32x32x16_bf16 v[64:79], v[44:47], v[196:199], v[64:79]
  v_exp_f32 v90, v90
  v_exp_f32 v91, v91
  ds_read_b128 v[32:35], v4 offset:16384
  v_cvt_pk_bf16_f32 v108, v88, v89
  v_exp_f32 v92, v92
  v_exp_f32 v93, v93
  ds_read_b128 v[36:39], v4 offset:17408
  v_cvt_pk_bf16_f32 v109, v90, v91
  v_exp_f32 v94, v94
  v_exp_f32 v95, v95
  v_cvt_pk_bf16_f32 v110, v92, v93
  v_cvt_pk_bf16_f32 v111, v94, v95
  v_mfma_f32_32x32x16_bf16 v[128:143], v[48:51], v[104:107], v[128:143]
  v_exp_f32 v64, v64
  v_exp_f32 v65, v65
  v_exp_f32 v66, v66
  v_exp_f32 v67, v67
  v_mfma_f32_32x32x16_bf16 v[128:143], v[52:55], v[108:111], v[128:143]
  v_cvt_pk_bf16_f32 v96, v64, v65
  v_exp_f32 v68, v68
  v_exp_f32 v69, v69
  v_cvt_pk_bf16_f32 v97, v66, v67
  v_exp_f32 v70, v70
  v_mfma_f32_32x32x16_bf16 v[80:95], v[40:43], v[200:203], 0
  v_exp_f32 v71, v71
  v_cvt_pk_bf16_f32 v98, v68, v69
  v_exp_f32 v72, v72
  v_exp_f32 v73, v73
  v_cvt_pk_bf16_f32 v99, v70, v71
  v_mfma_f32_32x32x16_bf16 v[80:95], v[44:47], v[204:207], v[80:95]
  v_exp_f32 v74, v74
  v_exp_f32 v75, v75
  ds_read_b128 v[48:51], v4 offset:49152
  v_cvt_pk_bf16_f32 v100, v72, v73
  v_exp_f32 v76, v76
  v_exp_f32 v77, v77
  ds_read_b128 v[52:55], v4 offset:50176
  v_cvt_pk_bf16_f32 v101, v74, v75
  v_exp_f32 v78, v78
  s_add_u32 m0, s31, 7168
  s_add_u32 s29, s53, s27
  s_add_u32 s29, s29, 7168
  buffer_load_dwordx4 v2, s[8:11], s29 offen sc1 lds
  v_exp_f32 v79, v79
  v_cvt_pk_bf16_f32 v102, v76, v77
  v_cvt_pk_bf16_f32 v103, v78, v79
  s_waitcnt lgkmcnt(4)
  v_mfma_f32_32x32x16_bf16 v[112:127], v[56:59], v[96:99], v[112:127]
  v_exp_f32 v80, v80
  v_exp_f32 v81, v81
  v_exp_f32 v82, v82
  v_exp_f32 v83, v83
  v_mfma_f32_32x32x16_bf16 v[112:127], v[60:63], v[100:103], v[112:127]
  v_cvt_pk_bf16_f32 v104, v80, v81
  v_exp_f32 v84, v84
  v_exp_f32 v85, v85
  v_cvt_pk_bf16_f32 v105, v82, v83
  v_exp_f32 v86, v86
  s_waitcnt lgkmcnt(2)
  v_mfma_f32_32x32x16_bf16 v[64:79], v[32:35], v[192:195], 0
  v_exp_f32 v87, v87
  v_cvt_pk_bf16_f32 v106, v84, v85
  v_exp_f32 v88, v88
  v_exp_f32 v89, v89
  v_cvt_pk_bf16_f32 v107, v86, v87
  v_mfma_f32_32x32x16_bf16 v[64:79], v[36:39], v[196:199], v[64:79]
  v_exp_f32 v90, v90
  v_exp_f32 v91, v91
  ds_read_b128 v[40:43], v4 offset:18432
  v_cvt_pk_bf16_f32 v108, v88, v89
  v_exp_f32 v92, v92
  v_exp_f32 v93, v93
  ds_read_b128 v[44:47], v4 offset:19456
  v_cvt_pk_bf16_f32 v109, v90, v91
  v_exp_f32 v94, v94
  v_exp_f32 v95, v95
  v_cvt_pk_bf16_f32 v110, v92, v93
  v_cvt_pk_bf16_f32 v111, v94, v95
  v_mfma_f32_32x32x16_bf16 v[128:143], v[56:59], v[104:107], v[128:143]
  v_exp_f32 v64, v64
  v_exp_f32 v65, v65
  v_exp_f32 v66, v66
  v_exp_f32 v67, v67
  v_mfma_f32_32x32x16_bf16 v[128:143], v[60:63], v[108:111], v[128:143]
  v_cvt_pk_bf16_f32 v96, v64, v65
  v_exp_f32 v68, v68
  v_exp_f32 v69, v69
  v_cvt_pk_bf16_f32 v97, v66, v67
  v_exp_f32 v70, v70
  v_mfma_f32_32x32x16_bf16 v[80:95], v[32:35], v[200:203], 0
  v_exp_f32 v71, v71
  v_cvt_pk_bf16_f32 v98, v68, v69
  v_exp_f32 v72, v72
  v_exp_f32 v73, v73
  v_cvt_pk_bf16_f32 v99, v70, v71
  v_mfma_f32_32x32x16_bf16 v[80:95], v[36:39], v[204:207], v[80:95]
  v_exp_f32 v74, v74
  v_exp_f32 v75, v75
  ds_read_b128 v[56:59], v4 offset:51200
  v_cvt_pk_bf16_f32 v100, v72, v73
  v_exp_f32 v76, v76
  v_exp_f32 v77, v77
  ds_read_b128 v[60:63], v4 offset:52224
  v_cvt_pk_bf16_f32 v101, v74, v75
  v_exp_f32 v78, v78
  s_add_u32 m0, s31, 32768
  s_add_u32 s29, s53, s28
  s_add_u32 s29, s29, 0
  buffer_load_dwordx4 v2, s[8:11], s29 offen sc1 lds
  v_exp_f32 v79, v79
  v_cvt_pk_bf16_f32 v102, v76, v77
  v_cvt_pk_bf16_f32 v103, v78, v79
  s_waitcnt lgkmcnt(4)
  v_mfma_f32_32x32x16_bf16 v[112:127], v[48:51], v[96:99], v[112:127]
  v_exp_f32 v80, v80
  v_exp_f32 v81, v81
  v_exp_f32 v82, v82
  v_exp_f32 v83, v83
  v_mfma_f32_32x32x16_bf16 v[112:127], v[52:55], v[100:103], v[112:127]
  v_cvt_pk_bf16_f32 v104, v80, v81
  v_exp_f32 v84, v84
  v_exp_f32 v85, v85
  v_cvt_pk_bf16_f32 v105, v82, v83
  v_exp_f32 v86, v86
  s_waitcnt lgkmcnt(2)
  v_mfma_f32_32x32x16_bf16 v[64:79], v[40:43], v[192:195], 0
  v_exp_f32 v87, v87
  v_cvt_pk_bf16_f32 v106, v84, v85
  v_exp_f32 v88, v88
  v_exp_f32 v89, v89
  v_cvt_pk_bf16_f32 v107, v86, v87
  v_mfma_f32_32x32x16_bf16 v[64:79], v[44:47], v[196:199], v[64:79]
  v_exp_f32 v90, v90
  v_exp_f32 v91, v91
  ds_read_b128 v[32:35], v4 offset:20480
  v_cvt_pk_bf16_f32 v108, v88, v89
  v_exp_f32 v92, v92
  v_exp_f32 v93, v93
  ds_read_b128 v[36:39], v4 offset:21504
  v_cvt_pk_bf16_f32 v109, v90, v91
  v_exp_f32 v94, v94
  v_exp_f32 v95, v95
  v_cvt_pk_bf16_f32 v110, v92, v93
  v_cvt_pk_bf16_f32 v111, v94, v95
  v_mfma_f32_32x32x16_bf16 v[128:143], v[48:51], v[104:107], v[128:143]
  v_exp_f32 v64, v64
  v_exp_f32 v65, v65
  v_exp_f32 v66, v66
  v_exp_f32 v67, v67
  v_mfma_f32_32x32x16_bf16 v[128:143], v[52:55], v[108:111], v[128:143]
  v_cvt_pk_bf16_f32 v96, v64, v65
  v_exp_f32 v68, v68
  v_exp_f32 v69, v69
  v_cvt_pk_bf16_f32 v97, v66, v67
  v_exp_f32 v70, v70
  v_mfma_f32_32x32x16_bf16 v[80:95], v[40:43], v[200:203], 0
  v_exp_f32 v71, v71
  v_cvt_pk_bf16_f32 v98, v68, v69
  v_exp_f32 v72, v72
  v_exp_f32 v73, v73
  v_cvt_pk_bf16_f32 v99, v70, v71
  v_mfma_f32_32x32x16_bf16 v[80:95], v[44:47], v[204:207], v[80:95]
  v_exp_f32 v74, v74
  v_exp_f32 v75, v75
  ds_read_b128 v[48:51], v4 offset:53248
  v_cvt_pk_bf16_f32 v100, v72, v73
  v_exp_f32 v76, v76
  v_exp_f32 v77, v77
  ds_read_b128 v[52:55], v4 offset:54272
  v_cvt_pk_bf16_f32 v101, v74, v75
  v_exp_f32 v78, v78
  s_add_u32 m0, s31, 33792
  s_add_u32 s29, s53, s28
  s_add_u32 s29, s29, 1024
  buffer_load_dwordx4 v2, s[8:11], s29 offen sc1 lds
  v_exp_f32 v79, v79
  v_cvt_pk_bf16_f32 v102, v76, v77
  v_cvt_pk_bf16_f32 v103, v78, v79
  s_waitcnt lgkmcnt(4)
  v_mfma_f32_32x32x16_bf16 v[112:127], v[56:59], v[96:99], v[112:127]
  v_exp_f32 v80, v80
  v_exp_f32 v81, v81
  v_exp_f32 v82, v82
  v_exp_f32 v83, v83
  v_mfma_f32_32x32x16_bf16 v[112:127], v[60:63], v[100:103], v[112:127]
  v_cvt_pk_bf16_f32 v104, v80, v81
  v_exp_f32 v84, v84
  v_exp_f32 v85, v85
  v_cvt_pk_bf16_f32 v105, v82, v83
  v_exp_f32 v86, v86
  s_waitcnt lgkmcnt(2)
  v_mfma_f32_32x32x16_bf16 v[64:79], v[32:35], v[192:195], 0
  v_exp_f32 v87, v87
  v_cvt_pk_bf16_f32 v106, v84, v85
  v_exp_f32 v88, v88
  v_exp_f32 v89, v89
  v_cvt_pk_bf16_f32 v107, v86, v87
  v_mfma_f32_32x32x16_bf16 v[64:79], v[36:39], v[196:199], v[64:79]
  v_exp_f32 v90, v90
  v_exp_f32 v91, v91
  ds_read_b128 v[40:43], v4 offset:22528
  v_cvt_pk_bf16_f32 v108, v88, v89
  v_exp_f32 v92, v92
  v_exp_f32 v93, v93
  ds_read_b128 v[44:47], v4 offset:23552
  v_cvt_pk_bf16_f32 v109, v90, v91
  v_exp_f32 v94, v94
  v_exp_f32 v95, v95
  v_cvt_pk_bf16_f32 v110, v92, v93
  v_cvt_pk_bf16_f32 v111, v94, v95
  v_mfma_f32_32x32x16_bf16 v[128:143], v[56:59], v[104:107], v[128:143]
  v_exp_f32 v64, v64
  v_exp_f32 v65, v65
  v_exp_f32 v66, v66
  v_exp_f32 v67, v67
  v_mfma_f32_32x32x16_bf16 v[128:143], v[60:63], v[108:111], v[128:143]
  v_cvt_pk_bf16_f32 v96, v64, v65
  v_exp_f32 v68, v68
  v_exp_f32 v69, v69
  v_cvt_pk_bf16_f32 v97, v66, v67
  v_exp_f32 v70, v70
  v_mfma_f32_32x32x16_bf16 v[80:95], v[32:35], v[200:203], 0
  v_exp_f32 v71, v71
  v_cvt_pk_bf16_f32 v98, v68, v69
  v_exp_f32 v72, v72
  v_exp_f32 v73, v73
  v_cvt_pk_bf16_f32 v99, v70, v71
  v_mfma_f32_32x32x16_bf16 v[80:95], v[36:39], v[204:207], v[80:95]
  v_exp_f32 v74, v74
  v_exp_f32 v75, v75
  ds_read_b128 v[56:59], v4 offset:55296
  v_cvt_pk_bf16_f32 v100, v72, v73
  v_exp_f32 v76, v76
  v_exp_f32 v77, v77
  ds_read_b128 v[60:63], v4 offset:56320
  v_cvt_pk_bf16_f32 v101, v74, v75
  v_exp_f32 v78, v78
  s_add_u32 m0, s31, 34816
  s_add_u32 s29, s53, s28
  s_add_u32 s29, s29, 2048
  buffer_load_dwordx4 v2, s[8:11], s29 offen sc1 lds
  v_exp_f32 v79, v79
  v_cvt_pk_bf16_f32 v102, v76, v77
  v_cvt_pk_bf16_f32 v103, v78, v79
  s_waitcnt lgkmcnt(4)
  v_mfma_f32_32x32x16_bf16 v[112:127], v[48:51], v[96:99], v[112:127]
  v_exp_f32 v80, v80
  v_exp_f32 v81, v81
  v_exp_f32 v82, v82
  v_exp_f32 v83, v83
  v_mfma_f32_32x32x16_bf16 v[112:127], v[52:55], v[100:103], v[112:127]
  v_cvt_pk_bf16_f32 v104, v80, v81
  v_exp_f32 v84, v84
  v_exp_f32 v85, v85
  v_cvt_pk_bf16_f32 v105, v82, v83
  v_exp_f32 v86, v86
  s_waitcnt lgkmcnt(2)
  v_mfma_f32_32x32x16_bf16 v[64:79], v[40:43], v[192:195], 0
  v_exp_f32 v87, v87
  v_cvt_pk_bf16_f32 v106, v84, v85
  v_exp_f32 v88, v88
  v_exp_f32 v89, v89
  v_cvt_pk_bf16_f32 v107, v86, v87
  v_mfma_f32_32x32x16_bf16 v[64:79], v[44:47], v[196:199], v[64:79]
  v_exp_f32 v90, v90
  v_exp_f32 v91, v91
  ds_read_b128 v[32:35], v4 offset:24576
  v_cvt_pk_bf16_f32 v108, v88, v89
  v_exp_f32 v92, v92
  v_exp_f32 v93, v93
  ds_read_b128 v[36:39], v4 offset:25600
  v_cvt_pk_bf16_f32 v109, v90, v91
  v_exp_f32 v94, v94
  v_exp_f32 v95, v95
  v_cvt_pk_bf16_f32 v110, v92, v93
  v_cvt_pk_bf16_f32 v111, v94, v95
  v_mfma_f32_32x32x16_bf16 v[128:143], v[48:51], v[104:107], v[128:143]
  v_exp_f32 v64, v64
  v_exp_f32 v65, v65
  v_exp_f32 v66, v66
  v_exp_f32 v67, v67
  v_mfma_f32_32x32x16_bf16 v[128:143], v[52:55], v[108:111], v[128:143]
  v_cvt_pk_bf16_f32 v96, v64, v65
  v_exp_f32 v68, v68
  v_exp_f32 v69, v69
  v_cvt_pk_bf16_f32 v97, v66, v67
  v_exp_f32 v70, v70
  v_mfma_f32_32x32x16_bf16 v[80:95], v[40:43], v[200:203], 0
  v_exp_f32 v71, v71
  v_cvt_pk_bf16_f32 v98, v68, v69
  v_exp_f32 v72, v72
  v_exp_f32 v73, v73
  v_cvt_pk_bf16_f32 v99, v70, v71
  v_mfma_f32_32x32x16_bf16 v[80:95], v[44:47], v[204:207], v[80:95]
  v_exp_f32 v74, v74
  v_exp_f32 v75, v75
  ds_read_b128 v[48:51], v4 offset:57344
  v_cvt_pk_bf16_f32 v100, v72, v73
  v_exp_f32 v76, v76
  v_exp_f32 v77, v77
  ds_read_b128 v[52:55], v4 offset:58368
  v_cvt_pk_bf16_f32 v101, v74, v75
  v_exp_f32 v78, v78
  s_add_u32 m0, s31, 35840
  s_add_u32 s29, s53, s28
  s_add_u32 s29, s29, 3072
  buffer_load_dwordx4 v2, s[8:11], s29 offen sc1 lds
  v_exp_f32 v79, v79
  v_cvt_pk_bf16_f32 v102, v76, v77
  v_cvt_pk_bf16_f32 v103, v78, v79
  s_waitcnt lgkmcnt(4)
  v_mfma_f32_32x32x16_bf16 v[112:127], v[56:59], v[96:99], v[112:127]
  v_exp_f32 v80, v80
  v_exp_f32 v81, v81
  v_exp_f32 v82, v82
  v_exp_f32 v83, v83
  v_mfma_f32_32x32x16_bf16 v[112:127], v[60:63], v[100:103], v[112:127]
  v_cvt_pk_bf16_f32 v104, v80, v81
  v_exp_f32 v84, v84
  v_exp_f32 v85, v85
  v_cvt_pk_bf16_f32 v105, v82, v83
  v_exp_f32 v86, v86
  s_waitcnt lgkmcnt(2)
  v_mfma_f32_32x32x16_bf16 v[64:79], v[32:35], v[192:195], 0
  v_exp_f32 v87, v87
  v_cvt_pk_bf16_f32 v106, v84, v85
  v_exp_f32 v88, v88
  v_exp_f32 v89, v89
  v_cvt_pk_bf16_f32 v107, v86, v87
  v_mfma_f32_32x32x16_bf16 v[64:79], v[36:39], v[196:199], v[64:79]
  v_exp_f32 v90, v90
  v_exp_f32 v91, v91
  ds_read_b128 v[40:43], v4 offset:26624
  v_cvt_pk_bf16_f32 v108, v88, v89
  v_exp_f32 v92, v92
  v_exp_f32 v93, v93
  ds_read_b128 v[44:47], v4 offset:27648
  v_cvt_pk_bf16_f32 v109, v90, v91
  v_exp_f32 v94, v94
  v_exp_f32 v95, v95
  v_cvt_pk_bf16_f32 v110, v92, v93
  v_cvt_pk_bf16_f32 v111, v94, v95
  v_mfma_f32_32x32x16_bf16 v[128:143], v[56:59], v[104:107], v[128:143]
  v_exp_f32 v64, v64
  v_exp_f32 v65, v65
  v_exp_f32 v66, v66
  v_exp_f32 v67, v67
  v_mfma_f32_32x32x16_bf16 v[128:143], v[60:63], v[108:111], v[128:143]
  v_cvt_pk_bf16_f32 v96, v64, v65
  v_exp_f32 v68, v68
  v_exp_f32 v69, v69
  v_cvt_pk_bf16_f32 v97, v66, v67
  v_exp_f32 v70, v70
  v_mfma_f32_32x32x16_bf16 v[80:95], v[32:35], v[200:203], 0
  v_exp_f32 v71, v71
  v_cvt_pk_bf16_f32 v98, v68, v69
  v_exp_f32 v72, v72
  v_exp_f32 v73, v73
  v_cvt_pk_bf16_f32 v99, v70, v71
  v_mfma_f32_32x32x16_bf16 v[80:95], v[36:39], v[204:207], v[80:95]
  v_exp_f32 v74, v74
  v_exp_f32 v75, v75
  ds_read_b128 v[56:59], v4 offset:59392
  v_cvt_pk_bf16_f32 v100, v72, v73
  v_exp_f32 v76, v76
  v_exp_f32 v77, v77
  ds_read_b128 v[60:63], v4 offset:60416
  v_cvt_pk_bf16_f32 v101, v74, v75
  v_exp_f32 v78, v78
  s_add_u32 m0, s31, 36864
  s_add_u32 s29, s53, s28
  s_add_u32 s29, s29, 4096
  buffer_load_dwordx4 v2, s[8:11], s29 offen sc1 lds
  v_exp_f32 v79, v79
  v_cvt_pk_bf16_f32 v102, v76, v77
  v_cvt_pk_bf16_f32 v103, v78, v79
  s_waitcnt lgkmcnt(4)
  v_mfma_f32_32x32x16_bf16 v[112:127], v[48:51], v[96:99], v[112:127]
  v_exp_f32 v80, v80
  v_exp_f32 v81, v81
  v_exp_f32 v82, v82
  v_exp_f32 v83, v83
  v_mfma_f32_32x32x16_bf16 v[112:127], v[52:55], v[100:103], v[112:127]
  v_cvt_pk_bf16_f32 v104, v80, v81
  v_exp_f32 v84, v84
  v_exp_f32 v85, v85
  v_cvt_pk_bf16_f32 v105, v82, v83
  v_exp_f32 v86, v86
  s_waitcnt lgkmcnt(2)
  v_mfma_f32_32x32x16_bf16 v[64:79], v[40:43], v[192:195], 0
  v_exp_f32 v87, v87
  v_cvt_pk_bf16_f32 v106, v84, v85
  v_exp_f32 v88, v88
  v_exp_f32 v89, v89
  v_cvt_pk_bf16_f32 v107, v86, v87
  v_mfma_f32_32x32x16_bf16 v[64:79], v[44:47], v[196:199], v[64:79]
  v_exp_f32 v90, v90
  v_exp_f32 v91, v91
  ds_read_b128 v[32:35], v4 offset:28672
  v_cvt_pk_bf16_f32 v108, v88, v89
  v_exp_f32 v92, v92
  v_exp_f32 v93, v93
  ds_read_b128 v[36:39], v4 offset:29696
  v_cvt_pk_bf16_f32 v109, v90, v91
  v_exp_f32 v94, v94
  v_exp_f32 v95, v95
  v_cvt_pk_bf16_f32 v110, v92, v93
  v_cvt_pk_bf16_f32 v111, v94, v95
  v_mfma_f32_32x32x16_bf16 v[128:143], v[48:51], v[104:107], v[128:143]
  v_exp_f32 v64, v64
  v_exp_f32 v65, v65
  v_exp_f32 v66, v66
  v_exp_f32 v67, v67
  v_mfma_f32_32x32x16_bf16 v[128:143], v[52:55], v[108:111], v[128:143]
  v_cvt_pk_bf16_f32 v96, v64, v65
  v_exp_f32 v68, v68
  v_exp_f32 v69, v69
  v_cvt_pk_bf16_f32 v97, v66, v67
  v_exp_f32 v70, v70
  v_mfma_f32_32x32x16_bf16 v[80:95], v[40:43], v[200:203], 0
  v_exp_f32 v71, v71
  v_cvt_pk_bf16_f32 v98, v68, v69
  v_exp_f32 v72, v72
  v_exp_f32 v73, v73
  v_cvt_pk_bf16_f32 v99, v70, v71
  v_mfma_f32_32x32x16_bf16 v[80:95], v[44:47], v[204:207], v[80:95]
  v_exp_f32 v74, v74
  v_exp_f32 v75, v75
  ds_read_b128 v[48:51], v4 offset:61440
  v_cvt_pk_bf16_f32 v100, v72, v73
  v_exp_f32 v76, v76
  v_exp_f32 v77, v77
  ds_read_b128 v[52:55], v4 offset:62464
  v_cvt_pk_bf16_f32 v101, v74, v75
  v_exp_f32 v78, v78
  s_add_u32 m0, s31, 37888
  s_add_u32 s29, s53, s28
  s_add_u32 s29, s29, 5120
  buffer_load_dwordx4 v2, s[8:11], s29 offen sc1 lds
  v_exp_f32 v79, v79
  v_cvt_pk_bf16_f32 v102, v76, v77
  v_cvt_pk_bf16_f32 v103, v78, v79
  s_waitcnt lgkmcnt(4)
  v_mfma_f32_32x32x16_bf16 v[112:127], v[56:59], v[96:99], v[112:127]
  v_exp_f32 v80, v80
  v_exp_f32 v81, v81
  v_exp_f32 v82, v82
  v_exp_f32 v83, v83
  v_mfma_f32_32x32x16_bf16 v[112:127], v[60:63], v[100:103], v[112:127]
  v_cvt_pk_bf16_f32 v104, v80, v81
  v_exp_f32 v84, v84
  v_exp_f32 v85, v85
  v_cvt_pk_bf16_f32 v105, v82, v83
  v_exp_f32 v86, v86
  s_waitcnt lgkmcnt(2)
  v_mfma_f32_32x32x16_bf16 v[64:79], v[32:35], v[192:195], 0
  v_exp_f32 v87, v87
  v_cvt_pk_bf16_f32 v106, v84, v85
  v_exp_f32 v88, v88
  v_exp_f32 v89, v89
  v_cvt_pk_bf16_f32 v107, v86, v87
  v_mfma_f32_32x32x16_bf16 v[64:79], v[36:39], v[196:199], v[64:79]
  v_exp_f32 v90, v90
  v_exp_f32 v91, v91
  ds_read_b128 v[40:43], v4 offset:30720
  v_cvt_pk_bf16_f32 v108, v88, v89
  v_exp_f32 v92, v92
  v_exp_f32 v93, v93
  ds_read_b128 v[44:47], v4 offset:31744
  v_cvt_pk_bf16_f32 v109, v90, v91
  v_exp_f32 v94, v94
  v_exp_f32 v95, v95
  v_cvt_pk_bf16_f32 v110, v92, v93
  v_cvt_pk_bf16_f32 v111, v94, v95
  v_mfma_f32_32x32x16_bf16 v[128:143], v[56:59], v[104:107], v[128:143]
  v_exp_f32 v64, v64
  v_exp_f32 v65, v65
  v_exp_f32 v66, v66
  v_exp_f32 v67, v67
  v_mfma_f32_32x32x16_bf16 v[128:143], v[60:63], v[108:111], v[128:143]
  v_cvt_pk_bf16_f32 v96, v64, v65
  v_exp_f32 v68, v68
  v_exp_f32 v69, v69
  v_cvt_pk_bf16_f32 v97, v66, v67
  v_exp_f32 v70, v70
  v_mfma_f32_32x32x16_bf16 v[80:95], v[32:35], v[200:203], 0
  v_exp_f32 v71, v71
  v_cvt_pk_bf16_f32 v98, v68, v69
  v_exp_f32 v72, v72
  v_exp_f32 v73, v73
  v_cvt_pk_bf16_f32 v99, v70, v71
  v_mfma_f32_32x32x16_bf16 v[80:95], v[36:39], v[204:207], v[80:95]
  v_exp_f32 v74, v74
  v_exp_f32 v75, v75
  ds_read_b128 v[56:59], v4 offset:63488
  v_cvt_pk_bf16_f32 v100, v72, v73
  v_exp_f32 v76, v76
  v_exp_f32 v77, v77
  ds_read_b128 v[60:63], v4 offset:64512
  v_cvt_pk_bf16_f32 v101, v74, v75
  v_exp_f32 v78, v78
  s_add_u32 m0, s31, 38912
  s_add_u32 s29, s53, s28
  s_add_u32 s29, s29, 6144
  buffer_load_dwordx4 v2, s[8:11], s29 offen sc1 lds
  v_exp_f32 v79, v79
  v_cvt_pk_bf16_f32 v102, v76, v77
  v_cvt_pk_bf16_f32 v103, v78, v79
  s_waitcnt lgkmcnt(4)
  v_mfma_f32_32x32x16_bf16 v[112:127], v[48:51], v[96:99], v[112:127]
  v_exp_f32 v80, v80
  v_exp_f32 v81, v81
  v_exp_f32 v82, v82
  v_exp_f32 v83, v83
  v_mfma_f32_32x32x16_bf16 v[112:127], v[52:55], v[100:103], v[112:127]
  v_cvt_pk_bf16_f32 v104, v80, v81
  v_exp_f32 v84, v84
  v_exp_f32 v85, v85
  v_cvt_pk_bf16_f32 v105, v82, v83
  v_exp_f32 v86, v86
  s_waitcnt lgkmcnt(2)
  v_mfma_f32_32x32x16_bf16 v[64:79], v[40:43], v[192:195], 0
  v_exp_f32 v87, v87
  v_cvt_pk_bf16_f32 v106, v84, v85
  v_exp_f32 v88, v88
  v_exp_f32 v89, v89
  v_cvt_pk_bf16_f32 v107, v86, v87
  v_mfma_f32_32x32x16_bf16 v[64:79], v[44:47], v[196:199], v[64:79]
  v_exp_f32 v90, v90
  v_exp_f32 v91, v91
  v_cvt_pk_bf16_f32 v108, v88, v89
  v_exp_f32 v92, v92
  v_exp_f32 v93, v93
  v_cvt_pk_bf16_f32 v109, v90, v91
  v_exp_f32 v94, v94
  v_exp_f32 v95, v95
  v_cvt_pk_bf16_f32 v110, v92, v93
  v_cvt_pk_bf16_f32 v111, v94, v95
  v_mfma_f32_32x32x16_bf16 v[128:143], v[48:51], v[104:107], v[128:143]
  v_exp_f32 v64, v64
  v_exp_f32 v65, v65
  v_exp_f32 v66, v66
  v_exp_f32 v67, v67
  v_mfma_f32_32x32x16_bf16 v[128:143], v[52:55], v[108:111], v[128:143]
  v_cvt_pk_bf16_f32 v96, v64, v65
  v_exp_f32 v68, v68
  v_exp_f32 v69, v69
  v_cvt_pk_bf16_f32 v97, v66, v67
  v_exp_f32 v70, v70
  v_mfma_f32_32x32x16_bf16 v[80:95], v[40:43], v[200:203], 0
  v_exp_f32 v71, v71
  v_cvt_pk_bf16_f32 v98, v68, v69
  v_exp_f32 v72, v72
  v_exp_f32 v73, v73
  v_cvt_pk_bf16_f32 v99, v70, v71
  v_mfma_f32_32x32x16_bf16 v[80:95], v[44:47], v[204:207], v[80:95]
  v_exp_f32 v74, v74
  v_exp_f32 v75, v75
  v_cvt_pk_bf16_f32 v100, v72, v73
  v_exp_f32 v76, v76
  v_exp_f32 v77, v77
  v_cvt_pk_bf16_f32 v101, v74, v75
  v_exp_f32 v78, v78
  s_add_u32 m0, s31, 39936
  s_add_u32 s29, s53, s28
  s_add_u32 s29, s29, 7168
  buffer_load_dwordx4 v2, s[8:11], s29 offen sc1 lds
  v_exp_f32 v79, v79
  v_cvt_pk_bf16_f32 v102, v76, v77
  v_cvt_pk_bf16_f32 v103, v78, v79
  s_waitcnt lgkmcnt(0)
  v_mfma_f32_32x32x16_bf16 v[112:127], v[56:59], v[96:99], v[112:127]
  v_exp_f32 v80, v80
  v_exp_f32 v81, v81
  v_exp_f32 v82, v82
  v_exp_f32 v83, v83
  v_mfma_f32_32x32x16_bf16 v[112:127], v[60:63], v[100:103], v[112:127]
  v_cvt_pk_bf16_f32 v104, v80, v81
  v_exp_f32 v84, v84
  v_exp_f32 v85, v85
  v_cvt_pk_bf16_f32 v105, v82, v83
  v_exp_f32 v86, v86
  v_exp_f32 v87, v87
  v_cvt_pk_bf16_f32 v106, v84, v85
  v_exp_f32 v88, v88
  v_exp_f32 v89, v89
  v_cvt_pk_bf16_f32 v107, v86, v87
  v_exp_f32 v90, v90
  v_exp_f32 v91, v91
  v_cvt_pk_bf16_f32 v108, v88, v89
  v_exp_f32 v92, v92
  v_exp_f32 v93, v93
  v_cvt_pk_bf16_f32 v109, v90, v91
  v_exp_f32 v94, v94
  v_exp_f32 v95, v95
  v_cvt_pk_bf16_f32 v110, v92, v93
  v_cvt_pk_bf16_f32 v111, v94, v95
  s_nop 1
  v_mfma_f32_32x32x16_bf16 v[128:143], v[56:59], v[104:107], v[128:143]
  v_mfma_f32_32x32x16_bf16 v[128:143], v[60:63], v[108:111], v[128:143]
  s_cmp_lt_u32 s41, 4
  s_cbranch_scc1 kb1_chunk2
  s_nop 11
  v_mov_b32 v5, v120
  v_mov_b32 v6, v120
  s_nop 1
  v_permlane32_swap_b32 v5, v6
  v_mov_b32 v14, v6
  v_mov_b32 v5, v136
  v_mov_b32 v6, v136
  s_nop 1
  v_permlane32_swap_b32 v5, v6
  v_mov_b32 v15, v6
  s_cmp_eq_u32 s40, 0
  s_cbranch_scc0 kb1_fin
  v_min_f32 v5, v14, v15
  v_cmp_gt_f32 vcc, 0x12800000, v5
  v_cmp_u_f32 s[36:37], v5, v5
  s_nop 1
  s_or_b64 vcc, vcc, s[36:37]
  s_cmp_lg_u64 vcc, 0
  s_cselect_b32 s42, 1, 0
  v_mov_b32 v5, s42
  s_lshl_b32 s30, s21, 2
  s_add_u32 s30, s30, 131584
  v_mov_b32 v6, s30
  ds_write_b32 v6, v5
  s_waitcnt vmcnt(0) lgkmcnt(0)
  s_barrier
  v_mov_b32 v6, 131584
  ds_read_b128 v[8:11], v6
  s_waitcnt lgkmcnt(0)
  v_or_b32 v8, v8, v9
  v_or_b32 v10, v10, v11
  v_or_b32 v8, v8, v10
  s_nop 0
  v_readfirstlane_b32 s42, v8
  s_cmp_eq_u32 s42, 0
  s_cbranch_scc1 kb1_fin
  s_mov_b32 s40, 1
  v_and_b32 v5, 0xffff0000, v198
  v_cndmask_b32 v198, v198, v5, s[34:35]
  v_mov_b32 v12, 0xff7fffff
  v_and_b32 v5, 0xffff0000, v206
  v_cndmask_b32 v206, v206, v5, s[34:35]
  v_mov_b32 v13, 0xff7fffff
  s_mov_b32 s41, 0
kb1_mx:
  s_lshl_b32 s30, s41, 11
  s_add_u32 s30, s30, s27
  buffer_load_dwordx4 v[32:35], v2, s[8:11], s30 offen sc1
  buffer_load_dwordx4 v[36:39], v2, s[8:11], s30 offen offset:1024 sc1
  s_waitcnt vmcnt(0)
  v_mfma_f32_32x32x16_bf16 v[64:79], v[32:35], v[192:195], 0
  v_mfma_f32_32x32x16_bf16 v[64:79], v[36:39], v[196:199], v[64:79]
  v_mfma_f32_32x32x16_bf16 v[80:95], v[32:35], v[200:203], 0
  v_mfma_f32_32x32x16_bf16 v[80:95], v[36:39], v[204:207], v[80:95]
  s_nop 11
  v_max3_f32 v12, v12, v64, v65
  v_max3_f32 v12, v12, v66, v67
  v_max3_f32 v12, v12, v68, v69
  v_max3_f32 v12, v12, v70, v71
  v_max3_f32 v12, v12, v72, v73
  v_max3_f32 v12, v12, v74, v75
  v_max3_f32 v12, v12, v76, v77
  v_max3_f32 v12, v12, v78, v79
  v_max3_f32 v13, v13, v80, v81
  v_max3_f32 v13, v13, v82, v83
  v_max3_f32 v13, v13, v84, v85
  v_max3_f32 v13, v13, v86, v87
  v_max3_f32 v13, v13, v88, v89
  v_max3_f32 v13, v13, v90, v91
  v_max3_f32 v13, v13, v92, v93
  v_max3_f32 v13, v13, v94, v95
  s_add_u32 s41, s41, 1
  s_cmp_lt_u32 s41, 64
  s_cbranch_scc1 kb1_mx
  v_mov_b32 v5, v12
  s_nop 1
  v_permlane32_swap_b32 v12, v5
  v_max_f32 v12, v12, v5
  v_cvt_pk_bf16_f32 v5, v12, v12
  v_and_b32 v5, 0xffff, v5
  v_xor_b32 v5, 0x8000, v5
  v_and_b32 v6, 0xffff0000, v198
  v_or_b32 v5, v5, v6
  v_cndmask_b32 v198, v198, v5, s[34:35]
  v_mov_b32 v5, v13
  s_nop 1
  v_permlane32_swap_b32 v13, v5
  v_max_f32 v13, v13, v5
  v_cvt_pk_bf16_f32 v5, v13, v13
  v_and_b32 v5, 0xffff, v5
  v_xor_b32 v5, 0x8000, v5
  v_and_b32 v6, 0xffff0000, v206
  v_or_b32 v5, v5, v6
  v_cndmask_b32 v206, v206, v5, s[34:35]
  s_barrier
  s_mov_b32 s41, 0
  s_mul_i32 s53, s41, 32768
  s_lshl_b32 s31, s21, 13
  s_add_u32 s53, s53, s31
  s_add_u32 m0, s31, 0
  s_add_u32 s29, s53, s27
  s_add_u32 s29, s29, 0
  buffer_load_dwordx4 v2, s[8:11], s29 offen sc1 lds
  s_add_u32 m0, s31, 1024
  s_add_u32 s29, s53, s27
  s_add_u32 s29, s29, 1024
  buffer_load_dwordx4 v2, s[8:11], s29 offen sc1 lds
  s_add_u32 m0, s31, 2048
  s_add_u32 s29, s53, s27
  s_add_u32 s29, s29, 2048
  buffer_load_dwordx4 v2, s[8:11], s29 offen sc1 lds
  s_add_u32 m0, s31, 3072
  s_add_u32 s29, s53, s27
  s_add_u32 s29, s29, 3072
  buffer_load_dwordx4 v2, s[8:11], s29 offen sc1 lds
  s_add_u32 m0, s31, 4096
  s_add_u32 s29, s53, s27
  s_add_u32 s29, s29, 4096
  buffer_load_dwordx4 v2, s[8:11], s29 offen sc1 lds
  s_add_u32 m0, s31, 5120
  s_add_u32 s29, s53, s27
  s_add_u32 s29, s29, 5120
  buffer_load_dwordx4 v2, s[8:11], s29 offen sc1 lds
  s_add_u32 m0, s31, 6144
  s_add_u32 s29, s53, s27
  s_add_u32 s29, s29, 6144
  buffer_load_dwordx4 v2, s[8:11], s29 offen sc1 lds
  s_add_u32 m0, s31, 7168
  s_add_u32 s29, s53, s27
  s_add_u32 s29, s29, 7168
  buffer_load_dwordx4 v2, s[8:11], s29 offen sc1 lds
  s_add_u32 m0, s31, 32768
  s_add_u32 s29, s53, s28
  s_add_u32 s29, s29, 0
  buffer_load_dwordx4 v2, s[8:11], s29 offen sc1 lds
  s_add_u32 m0, s31, 33792
  s_add_u32 s29, s53, s28
  s_add_u32 s29, s29, 1024
  buffer_load_dwordx4 v2, s[8:11], s29 offen sc1 lds
  s_add_u32 m0, s31, 34816
  s_add_u32 s29, s53, s28
  s_add_u32 s29, s29, 2048
  buffer_load_dwordx4 v2, s[8:11], s29 offen sc1 lds
  s_add_u32 m0, s31, 35840
  s_add_u32 s29, s53, s28
  s_add_u32 s29, s29, 3072
  buffer_load_dwordx4 v2, s[8:11], s29 offen sc1 lds
  s_add_u32 m0, s31, 36864
  s_add_u32 s29, s53, s28
  s_add_u32 s29, s29, 4096
  buffer_load_dwordx4 v2, s[8:11], s29 offen sc1 lds
  s_add_u32 m0, s31, 37888
  s_add_u32 s29, s53, s28
  s_add_u32 s29, s29, 5120
  buffer_load_dwordx4 v2, s[8:11], s29 offen sc1 lds
  s_add_u32 m0, s31, 38912
  s_add_u32 s29, s53, s28
  s_add_u32 s29, s29, 6144
  buffer_load_dwordx4 v2, s[8:11], s29 offen sc1 lds
  s_add_u32 m0, s31, 39936
  s_add_u32 s29, s53, s28
  s_add_u32 s29, s29, 7168
  buffer_load_dwordx4 v2, s[8:11], s29 offen sc1 lds
  s_branch kb1_main2
kb1_fin:
  v_and_b32 v3, 15, v1
  v_bfe_u32 v11, v1, 4, 1
  v_mul_u32_u24 v11, 20480, v11
  v_lshrrev_b32 v4, 5, v1
  s_mul_i32 s30, s22, 20
  v_lshlrev_b32 v5, 2, v4
  v_add_u32 v5, 0, v5
  v_add_u32 v5, s30, v5
  v_lshrrev_b32 v6, 5, v5
  v_lshlrev_b32 v6, 10, v6
  v_bfe_u32 v7, v5, 3, 2
  v_lshlrev_b32 v7, 4, v7
  v_add_u32 v7, v7, v3
  v_lshlrev_b32 v7, 4, v7
  v_add_u32 v6, v6, v7
  v_bfe_u32 v7, v5, 2, 1
  v_lshlrev_b32 v7, 3, v7
  v_add_u32 v6, v6, v7
  v_add_u32 v32, v6, v11
  v_lshlrev_b32 v5, 2, v4
  v_add_u32 v5, 8, v5
  v_add_u32 v5, s30, v5
  v_lshrrev_b32 v6, 5, v5
  v_lshlrev_b32 v6, 10, v6
  v_bfe_u32 v7, v5, 3, 2
  v_lshlrev_b32 v7, 4, v7
  v_add_u32 v7, v7, v3
  v_lshlrev_b32 v7, 4, v7
  v_add_u32 v6, v6, v7
  v_bfe_u32 v7, v5, 2, 1
  v_lshlrev_b32 v7, 3, v7
  v_add_u32 v6, v6, v7
  v_add_u32 v33, v6, v11
  v_lshlrev_b32 v5, 2, v4
  v_add_u32 v5, 16, v5
  v_add_u32 v5, s30, v5
  v_lshrrev_b32 v6, 5, v5
  v_lshlrev_b32 v6, 10, v6
  v_bfe_u32 v7, v5, 3, 2
  v_lshlrev_b32 v7, 4, v7
  v_add_u32 v7, v7, v3
  v_lshlrev_b32 v7, 4, v7
  v_add_u32 v6, v6, v7
  v_bfe_u32 v7, v5, 2, 1
  v_lshlrev_b32 v7, 3, v7
  v_add_u32 v6, v6, v7
  v_add_u32 v34, v6, v11
  v_mov_b32 v5, 0x40000000
  v_cndmask_b32 v34, v5, v34, s[34:35]
  v_rcp_f32 v5, v14
  s_nop 0
  v_mul_f32 v112, v112, v5
  v_mul_f32 v113, v113, v5
  v_mul_f32 v114, v114, v5
  v_mul_f32 v115, v115, v5
  v_mul_f32 v116, v116, v5
  v_mul_f32 v117, v117, v5
  v_mul_f32 v118, v118, v5
  v_mul_f32 v119, v119, v5
  v_mul_f32 v120, v120, v5
  v_mul_f32 v121, v121, v5
  v_mul_f32 v122, v122, v5
  v_mul_f32 v123, v123, v5
  v_cvt_pk_bf16_f32 v40, v112, v113
  v_cvt_pk_bf16_f32 v41, v114, v115
  v_cvt_pk_bf16_f32 v42, v116, v117
  v_cvt_pk_bf16_f32 v43, v118, v119
  v_cvt_pk_bf16_f32 v44, v120, v121
  v_cvt_pk_bf16_f32 v45, v122, v123
  s_add_u32 s31, s52, 0
  s_mul_i32 s31, s31, 40960
  s_add_u32 s31, s31, 0xf200000
  buffer_store_dwordx2 v[40:41], v32, s[8:11], s31 offen sc1
  buffer_store_dwordx2 v[42:43], v33, s[8:11], s31 offen sc1
  buffer_store_dwordx2 v[44:45], v34, s[8:11], s31 offen sc1
  v_rcp_f32 v5, v15
  s_nop 0
  v_mul_f32 v128, v128, v5
  v_mul_f32 v129, v129, v5
  v_mul_f32 v130, v130, v5
  v_mul_f32 v131, v131, v5
  v_mul_f32 v132, v132, v5
  v_mul_f32 v133, v133, v5
  v_mul_f32 v134, v134, v5
  v_mul_f32 v135, v135, v5
  v_mul_f32 v136, v136, v5
  v_mul_f32 v137, v137, v5
  v_mul_f32 v138, v138, v5
  v_mul_f32 v139, v139, v5
  v_cvt_pk_bf16_f32 v48, v128, v129
  v_cvt_pk_bf16_f32 v49, v130, v131
  v_cvt_pk_bf16_f32 v50, v132, v133
  v_cvt_pk_bf16_f32 v51, v134, v135
  v_cvt_pk_bf16_f32 v52, v136, v137
  v_cvt_pk_bf16_f32 v53, v138, v139
  s_add_u32 s31, s52, 1
  s_mul_i32 s31, s31, 40960
  s_add_u32 s31, s31, 0xf200000
  buffer_store_dwordx2 v[48:49], v32, s[8:11], s31 offen sc1
  buffer_store_dwordx2 v[50:51], v33, s[8:11], s31 offen sc1
  buffer_store_dwordx2 v[52:53], v34, s[8:11], s31 offen sc1
  s_waitcnt vmcnt(0)
  s_barrier
  s_cmp_eq_u32 s21, 0
  s_cbranch_scc0 arr_45
  s_mov_b64 s[24:25], exec
  s_mov_b64 exec, 1
  v_mov_b32 v3, 0
  v_mov_b32 v4, 1
  buffer_atomic_add v4, v3, s[8:11], s48 offen
  s_mov_b64 exec, s[24:25]
arr_45:
  v_and_b32 v5, 15, v1
  v_lshrrev_b32 v6, 4, v1
  v_and_b32 v7, 1, v6
  v_lshlrev_b32 v7, 10, v7
  v_lshrrev_b32 v8, 1, v6
  v_lshlrev_b32 v8, 5, v8
  v_add_u32 v8, v8, v5
  v_lshlrev_b32 v8, 4, v8
  v_add_u32 v9, v7, v8
  s_lshr_b32 s26, s2, 2
  s_mul_i32 s27, s26, 81920
  s_lshl_b32 s28, s50, 11
  s_add_u32 s27, s27, s28
  s_add_u32 s27, s27, 0x1400000
  s_add_u32 s28, s27, 0
  buffer_load_dwordx4 v[16:19], v9, s[8:11], s28 offen sc1
  s_add_u32 s28, s27, 256
  buffer_load_dwordx4 v[20:23], v9, s[8:11], s28 offen sc1
  s_add_u32 s28, s27, 2048
  buffer_load_dwordx4 v[24:27], v9, s[8:11], s28 offen sc1
  s_add_u32 s28, s27, 2304
  buffer_load_dwordx4 v[28:31], v9, s[8:11], s28 offen sc1
  s_cmp_lt_u32 s21, 2
  s_cbranch_scc0 g3_46
  s_add_u32 s28, s27, 4096
  buffer_load_dwordx4 v[32:35], v9, s[8:11], s28 offen sc1
  s_add_u32 s28, s27, 4352
  buffer_load_dwordx4 v[36:39], v9, s[8:11], s28 offen sc1
g3_46:
  s_mov_b32 s45, 0
  v_mov_b32 v3, 0
aw_47:
  buffer_load_dword v4, v3, s[8:11], s48 offen sc1
  s_add_u32 s45, s45, 1
  s_waitcnt vmcnt(0)
  v_readfirstlane_b32 s29, v4
  s_cmp_ge_u32 s29, 32
  s_cbranch_scc1 aw_47_ok
  s_cmp_lt_u32 s45, 400000
  s_cbranch_scc1 aw_47
  s_branch kb1_abort
aw_47_ok:
  s_mul_i32 s28, s26, 40960
  s_mul_i32 s31, s21, 10240
  s_add_u32 s28, s28, s31
  s_add_u32 s28, s28, 0xf200000
  s_add_u32 m0, s31, 0
  s_add_u32 s29, s28, 0
  buffer_load_dwordx4 v2, s[8:11], s29 offen sc1 lds
  s_add_u32 m0, s31, 1024
  s_add_u32 s29, s28, 1024
  buffer_load_dwordx4 v2, s[8:11], s29 offen sc1 lds
  s_add_u32 m0, s31, 2048
  s_add_u32 s29, s28, 2048
  buffer_load_dwordx4 v2, s[8:11], s29 offen sc1 lds
  s_add_u32 m0, s31, 3072
  s_add_u32 s29, s28, 3072
  buffer_load_dwordx4 v2, s[8:11], s29 offen sc1 lds
  s_add_u32 m0, s31, 4096
  s_add_u32 s29, s28, 4096
  buffer_load_dwordx4 v2, s[8:11], s29 offen sc1 lds
  s_add_u32 m0, s31, 5120
  s_add_u32 s29, s28, 5120
  buffer_load_dwordx4 v2, s[8:11], s29 offen sc1 lds
  s_add_u32 m0, s31, 6144
  s_add_u32 s29, s28, 6144
  buffer_load_dwordx4 v2, s[8:11], s29 offen sc1 lds
  s_add_u32 m0, s31, 7168
  s_add_u32 s29, s28, 7168
  buffer_load_dwordx4 v2, s[8:11], s29 offen sc1 lds
  s_add_u32 m0, s31, 8192
  s_add_u32 s29, s28, 8192
  buffer_load_dwordx4 v2, s[8:11], s29 offen sc1 lds
  s_add_u32 m0, s31, 9216
  s_add_u32 s29, s28, 9216
  buffer_load_dwordx4 v2, s[8:11], s29 offen sc1 lds
  s_waitcnt vmcnt(0)
  s_barrier
  ds_read_b128 v[80:83], v2 offset:0
  ds_read_b128 v[84:87], v2 offset:20480
  ds_read_b128 v[88:91], v2 offset:1024
  ds_read_b128 v[92:95], v2 offset:21504
  ds_read_b128 v[96:99], v2 offset:2048
  ds_read_b128 v[100:103], v2 offset:22528
  s_waitcnt lgkmcnt(4)
  v_mfma_f32_16x16x32_bf16 v[48:51], a[0:3], v[80:83], 0
  v_mfma_f32_16x16x32_bf16 v[52:55], a[0:3], v[84:87], 0
  v_mfma_f32_16x16x32_bf16 v[56:59], a[80:83], v[80:83], 0
  v_mfma_f32_16x16x32_bf16 v[60:63], a[80:83], v[84:87], 0
  v_mfma_f32_16x16x32_bf16 v[64:67], a[160:163], v[80:83], 0
  v_mfma_f32_16x16x32_bf16 v[68:71], a[160:163], v[84:87], 0
  ds_read_b128 v[80:83], v2 offset:3072
  ds_read_b128 v[84:87], v2 offset:23552
  s_waitcnt lgkmcnt(4)
  v_mfma_f32_16x16x32_bf16 v[48:51], a[4:7], v[88:91], v[48:51]
  v_mfma_f32_16x16x32_bf16 v[52:55], a[4:7], v[92:95], v[52:55]
  v_mfma_f32_16x16x32_bf16 v[56:59], a[84:87], v[88:91], v[56:59]
  v_mfma_f32_16x16x32_bf16 v[60:63], a[84:87], v[92:95], v[60:63]
  v_mfma_f32_16x16x32_bf16 v[64:67], a[164:167], v[88:91], v[64:67]
  v_mfma_f32_16x16x32_bf16 v[68:71], a[164:167], v[92:95], v[68:71]
  ds_read_b128 v[88:91], v2 offset:4096
  ds_read_b128 v[92:95], v2 offset:24576
  s_waitcnt lgkmcnt(4)
  v_mfma_f32_16x16x32_bf16 v[48:51], a[8:11], v[96:99], v[48:51]
  v_mfma_f32_16x16x32_bf16 v[52:55], a[8:11], v[100:103], v[52:55]
  v_mfma_f32_16x16x32_bf16 v[56:59], a[88:91], v[96:99], v[56:59]
  v_mfma_f32_16x16x32_bf16 v[60:63], a[88:91], v[100:103], v[60:63]
  v_mfma_f32_16x16x32_bf16 v[64:67], a[168:171], v[96:99], v[64:67]
  v_mfma_f32_16x16x32_bf16 v[68:71], a[168:171], v[100:103], v[68:71]
  ds_read_b128 v[96:99], v2 offset:5120
  ds_read_b128 v[100:103], v2 offset:25600
  s_waitcnt lgkmcnt(4)
  v_mfma_f32_16x16x32_bf16 v[48:51], a[12:15], v[80:83], v[48:51]
  v_mfma_f32_16x16x32_bf16 v[52:55], a[12:15], v[84:87], v[52:55]
  v_mfma_f32_16x16x32_bf16 v[56:59], a[92:95], v[80:83], v[56:59]
  v_mfma_f32_16x16x32_bf16 v[60:63], a[92:95], v[84:87], v[60:63]
  v_mfma_f32_16x16x32_bf16 v[64:67], a[172:175], v[80:83], v[64:67]
  v_mfma_f32_16x16x32_bf16 v[68:71], a[172:175], v[84:87], v[68:71]
  ds_read_b128 v[80:83], v2 offset:6144
  ds_read_b128 v[84:87], v2 offset:26624
  s_waitcnt lgkmcnt(4)
  v_mfma_f32_16x16x32_bf16 v[48:51], a[16:19], v[88:91], v[48:51]
  v_mfma_f32_16x16x32_bf16 v[52:55], a[16:19], v[92:95], v[52:55]
  v_mfma_f32_16x16x32_bf16 v[56:59], a[96:99], v[88:91], v[56:59]
  v_mfma_f32_16x16x32_bf16 v[60:63], a[96:99], v[92:95], v[60:63]
  v_mfma_f32_16x16x32_bf16 v[64:67], a[176:179], v[88:91], v[64:67]
  v_mfma_f32_16x16x32_bf16 v[68:71], a[176:179], v[92:95], v[68:71]
  ds_read_b128 v[88:91], v2 offset:7168
  ds_read_b128 v[92:95], v2 offset:27648
  s_waitcnt lgkmcnt(4)
  v_mfma_f32_16x16x32_bf16 v[48:51], a[20:23], v[96:99], v[48:51]
  v_mfma_f32_16x16x32_bf16 v[52:55], a[20:23], v[100:103], v[52:55]
  v_mfma_f32_16x16x32_bf16 v[56:59], a[100:103], v[96:99], v[56:59]
  v_mfma_f32_16x16x32_bf16 v[60:63], a[100:103], v[100:103], v[60:63]
  v_mfma_f32_16x16x32_bf16 v[64:67], a[180:183], v[96:99], v[64:67]
  v_mfma_f32_16x16x32_bf16 v[68:71], a[180:183], v[100:103], v[68:71]
  ds_read_b128 v[96:99], v2 offset:8192
  ds_read_b128 v[100:103], v2 offset:28672
  s_waitcnt lgkmcnt(4)
  v_mfma_f32_16x16x32_bf16 v[48:51], a[24:27], v[80:83], v[48:51]
  v_mfma_f32_16x16x32_bf16 v[52:55], a[24:27], v[84:87], v[52:55]
  v_mfma_f32_16x16x32_bf16 v[56:59], a[104:107], v[80:83], v[56:59]
  v_mfma_f32_16x16x32_bf16 v[60:63], a[104:107], v[84:87], v[60:63]
  v_mfma_f32_16x16x32_bf16 v[64:67], a[184:187], v[80:83], v[64:67]
  v_mfma_f32_16x16x32_bf16 v[68:71], a[184:187], v[84:87], v[68:71]
  ds_read_b128 v[80:83], v2 offset:9216
  ds_read_b128 v[84:87], v2 offset:29696
  s_waitcnt lgkmcnt(4)
  v_mfma_f32_16x16x32_bf16 v[48:51], a[28:31], v[88:91], v[48:51]
  v_mfma_f32_16x16x32_bf16 v[52:55], a[28:31], v[92:95], v[52:55]
  v_mfma_f32_16x16x32_bf16 v[56:59], a[108:111], v[88:91], v[56:59]
  v_mfma_f32_16x16x32_bf16 v[60:63], a[108:111], v[92:95], v[60:63]
  v_mfma_f32_16x16x32_bf16 v[64:67], a[188:191], v[88:91], v[64:67]
  v_mfma_f32_16x16x32_bf16 v[68:71], a[188:191], v[92:95], v[68:71]
  ds_read_b128 v[88:91], v2 offset:10240
  ds_read_b128 v[92:95], v2 offset:30720
  s_waitcnt lgkmcnt(4)
  v_mfma_f32_16x16x32_bf16 v[48:51], a[32:35], v[96:99], v[48:51]
  v_mfma_f32_16x16x32_bf16 v[52:55], a[32:35], v[100:103], v[52:55]
  v_mfma_f32_16x16x32_bf16 v[56:59], a[112:115], v[96:99], v[56:59]
  v_mfma_f32_16x16x32_bf16 v[60:63], a[112:115], v[100:103], v[60:63]
  v_mfma_f32_16x16x32_bf16 v[64:67], a[192:195], v[96:99], v[64:67]
  v_mfma_f32_16x16x32_bf16 v[68:71], a[192:195], v[100:103], v[68:71]
  ds_read_b128 v[96:99], v2 offset:11264
  ds_read_b128 v[100:103], v2 offset:31744
  s_waitcnt lgkmcnt(4)
  v_mfma_f32_16x16x32_bf16 v[48:51], a[36:39], v[80:83], v[48:51]
  v_mfma_f32_16x16x32_bf16 v[52:55], a[36:39], v[84:87], v[52:55]
  v_mfma_f32_16x16x32_bf16 v[56:59], a[116:119], v[80:83], v[56:59]
  v_mfma_f32_16x16x32_bf16 v[60:63], a[116:119], v[84:87], v[60:63]
  v_mfma_f32_16x16x32_bf16 v[64:67], a[196:199], v[80:83], v[64:67]
  v_mfma_f32_16x16x32_bf16 v[68:71], a[196:199], v[84:87], v[68:71]
  ds_read_b128 v[80:83], v2 offset:12288
  ds_read_b128 v[84:87], v2 offset:32768
  s_waitcnt lgkmcnt(4)
  v_mfma_f32_16x16x32_bf16 v[48:51], a[40:43], v[88:91], v[48:51]
  v_mfma_f32_16x16x32_bf16 v[52:55], a[40:43], v[92:95], v[52:55]
  v_mfma_f32_16x16x32_bf16 v[56:59], a[120:123], v[88:91], v[56:59]
  v_mfma_f32_16x16x32_bf16 v[60:63], a[120:123], v[92:95], v[60:63]
  v_mfma_f32_16x16x32_bf16 v[64:67], a[200:203], v[88:91], v[64:67]
  v_mfma_f32_16x16x32_bf16 v[68:71], a[200:203], v[92:95], v[68:71]
  ds_read_b128 v[88:91], v2 offset:13312
  ds_read_b128 v[92:95], v2 offset:33792
  s_waitcnt lgkmcnt(4)
  v_mfma_f32_16x16x32_bf16 v[48:51], a[44:47], v[96:99], v[48:51]
  v_mfma_f32_16x16x32_bf16 v[52:55], a[44:47], v[100:103], v[52:55]
  v_mfma_f32_16x16x32_bf16 v[56:59], a[124:127], v[96:99], v[56:59]
  v_mfma_f32_16x16x32_bf16 v[60:63], a[124:127], v[100:103], v[60:63]
  v_mfma_f32_16x16x32_bf16 v[64:67], a[204:207], v[96:99], v[64:67]
  v_mfma_f32_16x16x32_bf16 v[68:71], a[204:207], v[100:103], v[68:71]
  ds_read_b128 v[96:99], v2 offset:14336
  ds_read_b128 v[100:103], v2 offset:34816
  s_waitcnt lgkmcnt(4)
  v_mfma_f32_16x16x32_bf16 v[48:51], a[48:51], v[80:83], v[48:51]
  v_mfma_f32_16x16x32_bf16 v[52:55], a[48:51], v[84:87], v[52:55]
  v_mfma_f32_16x16x32_bf16 v[56:59], a[128:131], v[80:83], v[56:59]
  v_mfma_f32_16x16x32_bf16 v[60:63], a[128:131], v[84:87], v[60:63]
  v_mfma_f32_16x16x32_bf16 v[64:67], a[208:211], v[80:83], v[64:67]
  v_mfma_f32_16x16x32_bf16 v[68:71], a[208:211], v[84:87], v[68:71]
  ds_read_b128 v[80:83], v2 offset:15360
  ds_read_b128 v[84:87], v2 offset:35840
  s_waitcnt lgkmcnt(4)
  v_mfma_f32_16x16x32_bf16 v[48:51], a[52:55], v[88:91], v[48:51]
  v_mfma_f32_16x16x32_bf16 v[52:55], a[52:55], v[92:95], v[52:55]
  v_mfma_f32_16x16x32_bf16 v[56:59], a[132:135], v[88:91], v[56:59]
  v_mfma_f32_16x16x32_bf16 v[60:63], a[132:135], v[92:95], v[60:63]
  v_mfma_f32_16x16x32_bf16 v[64:67], a[212:215], v[88:91], v[64:67]
  v_mfma_f32_16x16x32_bf16 v[68:71], a[212:215], v[92:95], v[68:71]
  ds_read_b128 v[88:91], v2 offset:16384
  ds_read_b128 v[92:95], v2 offset:36864
  s_waitcnt lgkmcnt(4)
  v_mfma_f32_16x16x32_bf16 v[48:51], a[56:59], v[96:99], v[48:51]
  v_mfma_f32_16x16x32_bf16 v[52:55], a[56:59], v[100:103], v[52:55]
  v_mfma_f32_16x16x32_bf16 v[56:59], a[136:139], v[96:99], v[56:59]
  v_mfma_f32_16x16x32_bf16 v[60:63], a[136:139], v[100:103], v[60:63]
  v_mfma_f32_16x16x32_bf16 v[64:67], a[216:219], v[96:99], v[64:67]
  v_mfma_f32_16x16x32_bf16 v[68:71], a[216:219], v[100:103], v[68:71]
  ds_read_b128 v[96:99], v2 offset:17408
  ds_read_b128 v[100:103], v2 offset:37888
  s_waitcnt lgkmcnt(4)
  v_mfma_f32_16x16x32_bf16 v[48:51], a[60:63], v[80:83], v[48:51]
  v_mfma_f32_16x16x32_bf16 v[52:55], a[60:63], v[84:87], v[52:55]
  v_mfma_f32_16x16x32_bf16 v[56:59], a[140:143], v[80:83], v[56:59]
  v_mfma_f32_16x16x32_bf16 v[60:63], a[140:143], v[84:87], v[60:63]
  v_mfma_f32_16x16x32_bf16 v[64:67], a[220:223], v[80:83], v[64:67]
  v_mfma_f32_16x16x32_bf16 v[68:71], a[220:223], v[84:87], v[68:71]
  ds_read_b128 v[80:83], v2 offset:18432
  ds_read_b128 v[84:87], v2 offset:38912
  s_waitcnt lgkmcnt(4)
  v_mfma_f32_16x16x32_bf16 v[48:51], a[64:67], v[88:91], v[48:51]
  v_mfma_f32_16x16x32_bf16 v[52:55], a[64:67], v[92:95], v[52:55]
  v_mfma_f32_16x16x32_bf16 v[56:59], a[144:147], v[88:91], v[56:59]
  v_mfma_f32_16x16x32_bf16 v[60:63], a[144:147], v[92:95], v[60:63]
  v_mfma_f32_16x16x32_bf16 v[64:67], a[224:227], v[88:91], v[64:67]
  v_mfma_f32_16x16x32_bf16 v[68:71], a[224:227], v[92:95], v[68:71]
  ds_read_b128 v[88:91], v2 offset:19456
  ds_read_b128 v[92:95], v2 offset:39936
  s_waitcnt lgkmcnt(4)
  v_mfma_f32_16x16x32_bf16 v[48:51], a[68:71], v[96:99], v[48:51]
  v_mfma_f32_16x16x32_bf16 v[52:55], a[68:71], v[100:103], v[52:55]
  v_mfma_f32_16x16x32_bf16 v[56:59], a[148:151], v[96:99], v[56:59]
  v_mfma_f32_16x16x32_bf16 v[60:63], a[148:151], v[100:103], v[60:63]
  v_mfma_f32_16x16x32_bf16 v[64:67], a[228:231], v[96:99], v[64:67]
  v_mfma_f32_16x16x32_bf16 v[68:71], a[228:231], v[100:103], v[68:71]
  s_waitcnt lgkmcnt(2)
  v_mfma_f32_16x16x32_bf16 v[48:51], a[72:75], v[80:83], v[48:51]
  v_mfma_f32_16x16x32_bf16 v[52:55], a[72:75], v[84:87], v[52:55]
  v_mfma_f32_16x16x32_bf16 v[56:59], a[152:155], v[80:83], v[56:59]
  v_mfma_f32_16x16x32_bf16 v[60:63], a[152:155], v[84:87], v[60:63]
  v_mfma_f32_16x16x32_bf16 v[64:67], a[232:235], v[80:83], v[64:67]
  v_mfma_f32_16x16x32_bf16 v[68:71], a[232:235], v[84:87], v[68:71]
  s_waitcnt lgkmcnt(0)
  v_mfma_f32_16x16x32_bf16 v[48:51], a[76:79], v[88:91], v[48:51]
  v_mfma_f32_16x16x32_bf16 v[52:55], a[76:79], v[92:95], v[52:55]
  v_mfma_f32_16x16x32_bf16 v[56:59], a[156:159], v[88:91], v[56:59]
  v_mfma_f32_16x16x32_bf16 v[60:63], a[156:159], v[92:95], v[60:63]
  v_mfma_f32_16x16x32_bf16 v[64:67], a[236:239], v[88:91], v[64:67]
  v_mfma_f32_16x16x32_bf16 v[68:71], a[236:239], v[92:95], v[68:71]
  s_nop 7
  v_add_f32 v48, v48, v16
  v_add_f32 v49, v49, v17
  v_add_f32 v50, v50, v18
  v_add_f32 v51, v51, v19
  s_add_u32 s28, s27, 0
  buffer_store_dwordx4 v[48:51], v9, s[8:11], s28 offen
  v_add_f32 v52, v52, v20
  v_add_f32 v53, v53, v21
  v_add_f32 v54, v54, v22
  v_add_f32 v55, v55, v23
  s_add_u32 s28, s27, 256
  buffer_store_dwordx4 v[52:55], v9, s[8:11], s28 offen
  v_add_f32 v56, v56, v24
  v_add_f32 v57, v57, v25
  v_add_f32 v58, v58, v26
  v_add_f32 v59, v59, v27
  s_add_u32 s28, s27, 2048
  buffer_store_dwordx4 v[56:59], v9, s[8:11], s28 offen
  v_add_f32 v60, v60, v28
  v_add_f32 v61, v61, v29
  v_add_f32 v62, v62, v30
  v_add_f32 v63, v63, v31
  s_add_u32 s28, s27, 2304
  buffer_store_dwordx4 v[60:63], v9, s[8:11], s28 offen
  s_cmp_lt_u32 s21, 2
  s_cbranch_scc0 g3_48
  v_add_f32 v64, v64, v32
  v_add_f32 v65, v65, v33
  v_add_f32 v66, v66, v34
  v_add_f32 v67, v67, v35
  s_add_u32 s28, s27, 4096
  buffer_store_dwordx4 v[64:67], v9, s[8:11], s28 offen
  v_add_f32 v68, v68, v36
  v_add_f32 v69, v69, v37
  v_add_f32 v70, v70, v38
  v_add_f32 v71, v71, v39
  s_add_u32 s28, s27, 4352
  buffer_store_dwordx4 v[68:71], v9, s[8:11], s28 offen
g3_48:
  s_endpgm
kb1_abort:
  s_load_dwordx2 s[6:7], s[0:1], 88
  v_mov_b32 v2, 80
  v_mov_b32 v3, 1
  s_waitcnt lgkmcnt(0)
  s_mov_b64 exec, 1
  global_atomic_add v2, v3, s[6:7]
  s_waitcnt vmcnt(0)
kb1_exit:
  s_endpgm

.section .rodata,"a"
.p2align 6
.amdhsa_kernel kb1_kernel
  .amdhsa_next_free_vgpr 512
  .amdhsa_next_free_sgpr 102
  .amdhsa_accum_offset 256
  .amdhsa_group_segment_fixed_size 0
  .amdhsa_kernarg_size 104
  .amdhsa_user_sgpr_count 2
  .amdhsa_user_sgpr_kernarg_segment_ptr 1
  .amdhsa_system_sgpr_workgroup_id_x 1
.end_amdhsa_kernel
.text
.globl ka2_kernel
.p2align 8
.type ka2_kernel,@function
ka2_kernel:
  s_mov_b32 s99, 1
ka_body:
  s_cmp_ge_u32 s2, 256
  s_cbranch_scc1 ka_exit

  s_load_dwordx2 s[4:5], s[0:1], 96
  s_load_dwordx2 s[6:7], s[0:1], 88
  s_load_dwordx4 s[36:39], s[0:1], 16
  s_load_dwordx4 s[40:43], s[0:1], 32
  s_getreg_b32 s26, hwreg(HW_REG_XCC_ID)
  s_and_b32 s26, s26, 15
  v_lshrrev_b32 v1, 6, v0
  s_nop 0
  v_readfirstlane_b32 s21, v1
  s_waitcnt lgkmcnt(0)
  s_mov_b32 s8, s4
  s_and_b32 s9, s5, 0xffff
  s_mov_b32 s10, 0x10000000
  s_mov_b32 s11, 0x20000
  s_cmp_eq_u32 s21, 3
  s_cbranch_scc0 lnu_49_x
  v_and_b32 v1, 63, v0
  v_and_b32 v5, 7, v1
  v_bfe_u32 v6, v1, 3, 1
  v_lshrrev_b32 v7, 4, v1
  v_lshlrev_b32 v8, 5, v6
  v_add_u32 v8, v8, v5
  v_lshlrev_b32 v8, 4, v8
  v_lshlrev_b32 v10, 10, v7
  v_add_u32 v10, v10, v8
  s_lshr_b32 s46, s2, 2
  s_and_b32 s47, s2, 3
  s_lshl_b32 s47, s47, 7
  s_cmp_eq_u32 s99, 1
  s_cbranch_scc0 lnu_49_b
  v_lshlrev_b32 v9, 11, v7
  v_add_u32 v9, v9, v8
  s_mul_i32 s48, s46, 81920
  s_add_u32 s48, s48, s47
  s_add_u32 s48, s48, 0x1400000
  s_add_u32 s49, s48, 0
  buffer_load_dwordx4 v[16:19], v9, s[8:11], s49 offen
  s_add_u32 s49, s48, 1024
  buffer_load_dwordx4 v[20:23], v9, s[8:11], s49 offen
  s_add_u32 s49, s48, 8192
  buffer_load_dwordx4 v[24:27], v9, s[8:11], s49 offen
  s_add_u32 s49, s48, 9216
  buffer_load_dwordx4 v[28:31], v9, s[8:11], s49 offen
  s_add_u32 s49, s48, 16384
  buffer_load_dwordx4 v[32:35], v9, s[8:11], s49 offen
  s_add_u32 s49, s48, 17408
  buffer_load_dwordx4 v[36:39], v9, s[8:11], s49 offen
  s_add_u32 s49, s48, 24576
  buffer_load_dwordx4 v[40:43], v9, s[8:11], s49 offen
  s_add_u32 s49, s48, 25600
  buffer_load_dwordx4 v[44:47], v9, s[8:11], s49 offen
  s_add_u32 s49, s48, 32768
  buffer_load_dwordx4 v[48:51], v9, s[8:11], s49 offen
  s_add_u32 s49, s48, 33792
  buffer_load_dwordx4 v[52:55], v9, s[8:11], s49 offen
  s_add_u32 s49, s48, 40960
  buffer_load_dwordx4 v[56:59], v9, s[8:11], s49 offen
  s_add_u32 s49, s48, 41984
  buffer_load_dwordx4 v[60:63], v9, s[8:11], s49 offen
  s_add_u32 s49, s48, 49152
  buffer_load_dwordx4 v[64:67], v9, s[8:11], s49 offen
  s_add_u32 s49, s48, 50176
  buffer_load_dwordx4 v[68:71], v9, s[8:11], s49 offen
  s_add_u32 s49, s48, 57344
  buffer_load_dwordx4 v[72:75], v9, s[8:11], s49 offen
  s_add_u32 s49, s48, 58368
  buffer_load_dwordx4 v[76:79], v9, s[8:11], s49 offen
  s_add_u32 s49, s48, 65536
  buffer_load_dwordx4 v[80:83], v9, s[8:11], s49 offen
  s_add_u32 s49, s48, 66560
  buffer_load_dwordx4 v[84:87], v9, s[8:11], s49 offen
  s_add_u32 s49, s48, 73728
  buffer_load_dwordx4 v[88:91], v9, s[8:11], s49 offen
  s_add_u32 s49, s48, 74752
  buffer_load_dwordx4 v[92:95], v9, s[8:11], s49 offen
  s_waitcnt vmcnt(0)
  s_branch lnu_49_f
lnu_49_b:
  s_load_dwordx2 s[48:49], s[0:1], 0
  v_mul_u32_u24 v11, 1280, v5
  v_lshlrev_b32 v12, 5, v7
  v_add_u32 v11, v11, v12
  v_lshlrev_b32 v12, 4, v6
  v_add_u32 v11, v11, v12
  s_waitcnt lgkmcnt(0)
  s_mov_b32 s12, s48
  s_and_b32 s13, s49, 0xffff
  s_mov_b32 s14, 0x280000
  s_mov_b32 s15, 0x20000
  s_mul_i32 s49, s2, 10240
  buffer_load_dwordx4 v[56:59], v11, s[12:15], s49 offen offset:0
  buffer_load_dwordx4 v[60:63], v11, s[12:15], s49 offen offset:128
  buffer_load_dwordx4 v[64:67], v11, s[12:15], s49 offen offset:256
  buffer_load_dwordx4 v[68:71], v11, s[12:15], s49 offen offset:384
  buffer_load_dwordx4 v[72:75], v11, s[12:15], s49 offen offset:512
  buffer_load_dwordx4 v[76:79], v11, s[12:15], s49 offen offset:640
  buffer_load_dwordx4 v[80:83], v11, s[12:15], s49 offen offset:768
  buffer_load_dwordx4 v[84:87], v11, s[12:15], s49 offen offset:896
  buffer_load_dwordx4 v[88:91], v11, s[12:15], s49 offen offset:1024
  buffer_load_dwordx4 v[92:95], v11, s[12:15], s49 offen offset:1152
  s_waitcnt vmcnt(0)
  v_mov_b32 v4, v56
  v_lshlrev_b32 v16, 16, v4
  v_and_b32 v17, 0xffff0000, v4
  v_mov_b32 v4, v57
  v_lshlrev_b32 v18, 16, v4
  v_and_b32 v19, 0xffff0000, v4
  v_mov_b32 v4, v58
  v_lshlrev_b32 v20, 16, v4
  v_and_b32 v21, 0xffff0000, v4
  v_mov_b32 v4, v59
  v_lshlrev_b32 v22, 16, v4
  v_and_b32 v23, 0xffff0000, v4
  v_mov_b32 v4, v60
  v_lshlrev_b32 v24, 16, v4
  v_and_b32 v25, 0xffff0000, v4
  v_mov_b32 v4, v61
  v_lshlrev_b32 v26, 16, v4
  v_and_b32 v27, 0xffff0000, v4
  v_mov_b32 v4, v62
  v_lshlrev_b32 v28, 16, v4
  v_and_b32 v29, 0xffff0000, v4
  v_mov_b32 v4, v63
  v_lshlrev_b32 v30, 16, v4
  v_and_b32 v31, 0xffff0000, v4
  v_mov_b32 v4, v64
  v_lshlrev_b32 v32, 16, v4
  v_and_b32 v33, 0xffff0000, v4
  v_mov_b32 v4, v65
  v_lshlrev_b32 v34, 16, v4
  v_and_b32 v35, 0xffff0000, v4
  v_mov_b32 v4, v66
  v_lshlrev_b32 v36, 16, v4
  v_and_b32 v37, 0xffff0000, v4
  v_mov_b32 v4, v67
  v_lshlrev_b32 v38, 16, v4
  v_and_b32 v39, 0xffff0000, v4
  v_mov_b32 v4, v68
  v_lshlrev_b32 v40, 16, v4
  v_and_b32 v41, 0xffff0000, v4
  v_mov_b32 v4, v69
  v_lshlrev_b32 v42, 16, v4
  v_and_b32 v43, 0xffff0000, v4
  v_mov_b32 v4, v70
  v_lshlrev_b32 v44, 16, v4
  v_and_b32 v45, 0xffff0000, v4
  v_mov_b32 v4, v71
  v_lshlrev_b32 v46, 16, v4
  v_and_b32 v47, 0xffff0000, v4
  v_mov_b32 v4, v72
  v_lshlrev_b32 v48, 16, v4
  v_and_b32 v49, 0xffff0000, v4
  v_mov_b32 v4, v73
  v_lshlrev_b32 v50, 16, v4
  v_and_b32 v51, 0xffff0000, v4
  v_mov_b32 v4, v74
  v_lshlrev_b32 v52, 16, v4
  v_and_b32 v53, 0xffff0000, v4
  v_mov_b32 v4, v75
  v_lshlrev_b32 v54, 16, v4
  v_and_b32 v55, 0xffff0000, v4
  v_mov_b32 v4, v76
  v_lshlrev_b32 v56, 16, v4
  v_and_b32 v57, 0xffff0000, v4
  v_mov_b32 v4, v77
  v_lshlrev_b32 v58, 16, v4
  v_and_b32 v59, 0xffff0000, v4
  v_mov_b32 v4, v78
  v_lshlrev_b32 v60, 16, v4
  v_and_b32 v61, 0xffff0000, v4
  v_mov_b32 v4, v79
  v_lshlrev_b32 v62, 16, v4
  v_and_b32 v63, 0xffff0000, v4
  v_mov_b32 v4, v80
  v_lshlrev_b32 v64, 16, v4
  v_and_b32 v65, 0xffff0000, v4
  v_mov_b32 v4, v81
  v_lshlrev_b32 v66, 16, v4
  v_and_b32 v67, 0xffff0000, v4
  v_mov_b32 v4, v82
  v_lshlrev_b32 v68, 16, v4
  v_and_b32 v69, 0xffff0000, v4
  v_mov_b32 v4, v83
  v_lshlrev_b32 v70, 16, v4
  v_and_b32 v71, 0xffff0000, v4
  v_mov_b32 v4, v84
  v_lshlrev_b32 v72, 16, v4
  v_and_b32 v73, 0xffff0000, v4
  v_mov_b32 v4, v85
  v_lshlrev_b32 v74, 16, v4
  v_and_b32 v75, 0xffff0000, v4
  v_mov_b32 v4, v86
  v_lshlrev_b32 v76, 16, v4
  v_and_b32 v77, 0xffff0000, v4
  v_mov_b32 v4, v87
  v_lshlrev_b32 v78, 16, v4
  v_and_b32 v79, 0xffff0000, v4
  v_mov_b32 v4, v88
  v_lshlrev_b32 v80, 16, v4
  v_and_b32 v81, 0xffff0000, v4
  v_mov_b32 v4, v89
  v_lshlrev_b32 v82, 16, v4
  v_and_b32 v83, 0xffff0000, v4
  v_mov_b32 v4, v90
  v_lshlrev_b32 v84, 16, v4
  v_and_b32 v85, 0xffff0000, v4
  v_mov_b32 v4, v91
  v_lshlrev_b32 v86, 16, v4
  v_and_b32 v87, 0xffff0000, v4
  v_mov_b32 v4, v92
  v_lshlrev_b32 v88, 16, v4
  v_and_b32 v89, 0xffff0000, v4
  v_mov_b32 v4, v93
  v_lshlrev_b32 v90, 16, v4
  v_and_b32 v91, 0xffff0000, v4
  v_mov_b32 v4, v94
  v_lshlrev_b32 v92, 16, v4
  v_and_b32 v93, 0xffff0000, v4
  v_mov_b32 v4, v95
  v_lshlrev_b32 v94, 16, v4
  v_and_b32 v95, 0xffff0000, v4
lnu_49_f:
  v_pk_add_f32 v[12:13], v[16:17], v[18:19]
  v_pk_add_f32 v[12:13], v[12:13], v[20:21]
  v_pk_add_f32 v[12:13], v[12:13], v[22:23]
  v_pk_add_f32 v[12:13], v[12:13], v[24:25]
  v_pk_add_f32 v[12:13], v[12:13], v[26:27]
  v_pk_add_f32 v[12:13], v[12:13], v[28:29]
  v_pk_add_f32 v[12:13], v[12:13], v[30:31]
  v_pk_add_f32 v[12:13], v[12:13], v[32:33]
  v_pk_add_f32 v[12:13], v[12:13], v[34:35]
  v_pk_add_f32 v[12:13], v[12:13], v[36:37]
  v_pk_add_f32 v[12:13], v[12:13], v[38:39]
  v_pk_add_f32 v[12:13], v[12:13], v[40:41]
  v_pk_add_f32 v[12:13], v[12:13], v[42:43]
  v_pk_add_f32 v[12:13], v[12:13], v[44:45]
  v_pk_add_f32 v[12:13], v[12:13], v[46:47]
  v_pk_add_f32 v[12:13], v[12:13], v[48:49]
  v_pk_add_f32 v[12:13], v[12:13], v[50:51]
  v_pk_add_f32 v[12:13], v[12:13], v[52:53]
  v_pk_add_f32 v[12:13], v[12:13], v[54:55]
  v_pk_add_f32 v[12:13], v[12:13], v[56:57]
  v_pk_add_f32 v[12:13], v[12:13], v[58:59]
  v_pk_add_f32 v[12:13], v[12:13], v[60:61]
  v_pk_add_f32 v[12:13], v[12:13], v[62:63]
  v_pk_add_f32 v[12:13], v[12:13], v[64:65]
  v_pk_add_f32 v[12:13], v[12:13], v[66:67]
  v_pk_add_f32 v[12:13], v[12:13], v[68:69]
  v_pk_add_f32 v[12:13], v[12:13], v[70:71]
  v_pk_add_f32 v[12:13], v[12:13], v[72:73]
  v_pk_add_f32 v[12:13], v[12:13], v[74:75]
  v_pk_add_f32 v[12:13], v[12:13], v[76:77]
  v_pk_add_f32 v[12:13], v[12:13], v[78:79]
  v_pk_add_f32 v[12:13], v[12:13], v[80:81]
  v_pk_add_f32 v[12:13], v[12:13], v[82:83]
  v_pk_add_f32 v[12:13], v[12:13], v[84:85]
  v_pk_add_f32 v[12:13], v[12:13], v[86:87]
  v_pk_add_f32 v[12:13], v[12:13], v[88:89]
  v_pk_add_f32 v[12:13], v[12:13], v[90:91]
  v_pk_add_f32 v[12:13], v[12:13], v[92:93]
  v_pk_add_f32 v[12:13], v[12:13], v[94:95]
  v_add_f32 v12, v12, v13
  s_nop 1
  v_add_f32_dpp v12, v12, v12 row_ror:8 row_mask:0xf bank_mask:0xf
  v_mov_b32 v13, v12
  s_nop 1
  v_permlane16_swap_b32 v12, v13
  v_add_f32 v12, v12, v13
  v_mov_b32 v13, v12
  s_nop 1
  v_permlane32_swap_b32 v12, v13
  v_add_f32 v12, v12, v13
  v_mul_f32 v12, 0xbacccccd, v12
  v_mov_b32 v13, v12
  v_pk_add_f32 v[16:17], v[16:17], v[12:13]
  v_pk_add_f32 v[18:19], v[18:19], v[12:13]
  v_pk_add_f32 v[20:21], v[20:21], v[12:13]
  v_pk_add_f32 v[22:23], v[22:23], v[12:13]
  v_pk_add_f32 v[24:25], v[24:25], v[12:13]
  v_pk_add_f32 v[26:27], v[26:27], v[12:13]
  v_pk_add_f32 v[28:29], v[28:29], v[12:13]
  v_pk_add_f32 v[30:31], v[30:31], v[12:13]
  v_pk_add_f32 v[32:33], v[32:33], v[12:13]
  v_pk_add_f32 v[34:35], v[34:35], v[12:13]
  v_pk_add_f32 v[36:37], v[36:37], v[12:13]
  v_pk_add_f32 v[38:39], v[38:39], v[12:13]
  v_pk_add_f32 v[40:41], v[40:41], v[12:13]
  v_pk_add_f32 v[42:43], v[42:43], v[12:13]
  v_pk_add_f32 v[44:45], v[44:45], v[12:13]
  v_pk_add_f32 v[46:47], v[46:47], v[12:13]
  v_pk_add_f32 v[48:49], v[48:49], v[12:13]
  v_pk_add_f32 v[50:51], v[50:51], v[12:13]
  v_pk_add_f32 v[52:53], v[52:53], v[12:13]
  v_pk_add_f32 v[54:55], v[54:55], v[12:13]
  v_pk_add_f32 v[56:57], v[56:57], v[12:13]
  v_pk_add_f32 v[58:59], v[58:59], v[12:13]
  v_pk_add_f32 v[60:61], v[60:61], v[12:13]
  v_pk_add_f32 v[62:63], v[62:63], v[12:13]
  v_pk_add_f32 v[64:65], v[64:65], v[12:13]
  v_pk_add_f32 v[66:67], v[66:67], v[12:13]
  v_pk_add_f32 v[68:69], v[68:69], v[12:13]
  v_pk_add_f32 v[70:71], v[70:71], v[12:13]
  v_pk_add_f32 v[72:73], v[72:73], v[12:13]
  v_pk_add_f32 v[74:75], v[74:75], v[12:13]
  v_pk_add_f32 v[76:77], v[76:77], v[12:13]
  v_pk_add_f32 v[78:79], v[78:79], v[12:13]
  v_pk_add_f32 v[80:81], v[80:81], v[12:13]
  v_pk_add_f32 v[82:83], v[82:83], v[12:13]
  v_pk_add_f32 v[84:85], v[84:85], v[12:13]
  v_pk_add_f32 v[86:87], v[86:87], v[12:13]
  v_pk_add_f32 v[88:89], v[88:89], v[12:13]
  v_pk_add_f32 v[90:91], v[90:91], v[12:13]
  v_pk_add_f32 v[92:93], v[92:93], v[12:13]
  v_pk_add_f32 v[94:95], v[94:95], v[12:13]
  v_pk_mul_f32 v[12:13], v[16:17], v[16:17]
  v_pk_fma_f32 v[12:13], v[18:19], v[18:19], v[12:13]
  v_pk_fma_f32 v[12:13], v[20:21], v[20:21], v[12:13]
  v_pk_fma_f32 v[12:13], v[22:23], v[22:23], v[12:13]
  v_pk_fma_f32 v[12:13], v[24:25], v[24:25], v[12:13]
  v_pk_fma_f32 v[12:13], v[26:27], v[26:27], v[12:13]
  v_pk_fma_f32 v[12:13], v[28:29], v[28:29], v[12:13]
  v_pk_fma_f32 v[12:13], v[30:31], v[30:31], v[12:13]
  v_pk_fma_f32 v[12:13], v[32:33], v[32:33], v[12:13]
  v_pk_fma_f32 v[12:13], v[34:35], v[34:35], v[12:13]
  v_pk_fma_f32 v[12:13], v[36:37], v[36:37], v[12:13]
  v_pk_fma_f32 v[12:13], v[38:39], v[38:39], v[12:13]
  v_pk_fma_f32 v[12:13], v[40:41], v[40:41], v[12:13]
  v_pk_fma_f32 v[12:13], v[42:43], v[42:43], v[12:13]
  v_pk_fma_f32 v[12:13], v[44:45], v[44:45], v[12:13]
  v_pk_fma_f32 v[12:13], v[46:47], v[46:47], v[12:13]
  v_pk_fma_f32 v[12:13], v[48:49], v[48:49], v[12:13]
  v_pk_fma_f32 v[12:13], v[50:51], v[50:51], v[12:13]
  v_pk_fma_f32 v[12:13], v[52:53], v[52:53], v[12:13]
  v_pk_fma_f32 v[12:13], v[54:55], v[54:55], v[12:13]
  v_pk_fma_f32 v[12:13], v[56:57], v[56:57], v[12:13]
  v_pk_fma_f32 v[12:13], v[58:59], v[58:59], v[12:13]
  v_pk_fma_f32 v[12:13], v[60:61], v[60:61], v[12:13]
  v_pk_fma_f32 v[12:13], v[62:63], v[62:63], v[12:13]
  v_pk_fma_f32 v[12:13], v[64:65], v[64:65], v[12:13]
  v_pk_fma_f32 v[12:13], v[66:67], v[66:67], v[12:13]
  v_pk_fma_f32 v[12:13], v[68:69], v[68:69], v[12:13]
  v_pk_fma_f32 v[12:13], v[70:71], v[70:71], v[12:13]
  v_pk_fma_f32 v[12:13], v[72:73], v[72:73], v[12:13]
  v_pk_fma_f32 v[12:13], v[74:75], v[74:75], v[12:13]
  v_pk_fma_f32 v[12:13], v[76:77], v[76:77], v[12:13]
  v_pk_fma_f32 v[12:13], v[78:79], v[78:79], v[12:13]
  v_pk_fma_f32 v[12:13], v[80:81], v[80:81], v[12:13]
  v_pk_fma_f32 v[12:13], v[82:83], v[82:83], v[12:13]
  v_pk_fma_f32 v[12:13], v[84:85], v[84:85], v[12:13]
  v_pk_fma_f32 v[12:13], v[86:87], v[86:87], v[12:13]
  v_pk_fma_f32 v[12:13], v[88:89], v[88:89], v[12:13]
  v_pk_fma_f32 v[12:13], v[90:91], v[90:91], v[12:13]
  v_pk_fma_f32 v[12:13], v[92:93], v[92:93], v[12:13]
  v_pk_fma_f32 v[12:13], v[94:95], v[94:95], v[12:13]
  v_add_f32 v12, v12, v13
  s_nop 1
  v_add_f32_dpp v12, v12, v12 row_ror:8 row_mask:0xf bank_mask:0xf
  v_mov_b32 v13, v12
  s_nop 1
  v_permlane16_swap_b32 v12, v13
  v_add_f32 v12, v12, v13
  v_mov_b32 v13, v12
  s_nop 1
  v_permlane32_swap_b32 v12, v13
  v_add_f32 v12, v12, v13
  v_mov_b32 v13, 0x3727c5ac
  v_fmac_f32 v13, 0x3acccccd, v12
  v_rsq_f32 v12, v13
  s_nop 0
  v_mov_b32 v13, v12
  v_pk_mul_f32 v[16:17], v[16:17], v[12:13]
  v_pk_mul_f32 v[18:19], v[18:19], v[12:13]
  v_pk_mul_f32 v[20:21], v[20:21], v[12:13]
  v_pk_mul_f32 v[22:23], v[22:23], v[12:13]
  v_pk_mul_f32 v[24:25], v[24:25], v[12:13]
  v_pk_mul_f32 v[26:27], v[26:27], v[12:13]
  v_pk_mul_f32 v[28:29], v[28:29], v[12:13]
  v_pk_mul_f32 v[30:31], v[30:31], v[12:13]
  v_pk_mul_f32 v[32:33], v[32:33], v[12:13]
  v_pk_mul_f32 v[34:35], v[34:35], v[12:13]
  v_pk_mul_f32 v[36:37], v[36:37], v[12:13]
  v_pk_mul_f32 v[38:39], v[38:39], v[12:13]
  v_pk_mul_f32 v[40:41], v[40:41], v[12:13]
  v_pk_mul_f32 v[42:43], v[42:43], v[12:13]
  v_pk_mul_f32 v[44:45], v[44:45], v[12:13]
  v_pk_mul_f32 v[46:47], v[46:47], v[12:13]
  v_pk_mul_f32 v[48:49], v[48:49], v[12:13]
  v_pk_mul_f32 v[50:51], v[50:51], v[12:13]
  v_pk_mul_f32 v[52:53], v[52:53], v[12:13]
  v_pk_mul_f32 v[54:55], v[54:55], v[12:13]
  v_pk_mul_f32 v[56:57], v[56:57], v[12:13]
  v_pk_mul_f32 v[58:59], v[58:59], v[12:13]
  v_pk_mul_f32 v[60:61], v[60:61], v[12:13]
  v_pk_mul_f32 v[62:63], v[62:63], v[12:13]
  v_pk_mul_f32 v[64:65], v[64:65], v[12:13]
  v_pk_mul_f32 v[66:67], v[66:67], v[12:13]
  v_pk_mul_f32 v[68:69], v[68:69], v[12:13]
  v_pk_mul_f32 v[70:71], v[70:71], v[12:13]
  v_pk_mul_f32 v[72:73], v[72:73], v[12:13]
  v_pk_mul_f32 v[74:75], v[74:75], v[12:13]
  v_pk_mul_f32 v[76:77], v[76:77], v[12:13]
  v_pk_mul_f32 v[78:79], v[78:79], v[12:13]
  v_pk_mul_f32 v[80:81], v[80:81], v[12:13]
  v_pk_mul_f32 v[82:83], v[82:83], v[12:13]
  v_pk_mul_f32 v[84:85], v[84:85], v[12:13]
  v_pk_mul_f32 v[86:87], v[86:87], v[12:13]
  v_pk_mul_f32 v[88:89], v[88:89], v[12:13]
  v_pk_mul_f32 v[90:91], v[90:91], v[12:13]
  v_pk_mul_f32 v[92:93], v[92:93], v[12:13]
  v_pk_mul_f32 v[94:95], v[94:95], v[12:13]
  v_cvt_pk_bf16_f32 v16, v16, v17
  v_cvt_pk_bf16_f32 v17, v18, v19
  v_cvt_pk_bf16_f32 v18, v20, v21
  v_cvt_pk_bf16_f32 v19, v22, v23
  v_cvt_pk_bf16_f32 v20, v24, v25
  v_cvt_pk_bf16_f32 v21, v26, v27
  v_cvt_pk_bf16_f32 v22, v28, v29
  v_cvt_pk_bf16_f32 v23, v30, v31
  v_cvt_pk_bf16_f32 v24, v32, v33
  v_cvt_pk_bf16_f32 v25, v34, v35
  v_cvt_pk_bf16_f32 v26, v36, v37
  v_cvt_pk_bf16_f32 v27, v38, v39
  v_cvt_pk_bf16_f32 v28, v40, v41
  v_cvt_pk_bf16_f32 v29, v42, v43
  v_cvt_pk_bf16_f32 v30, v44, v45
  v_cvt_pk_bf16_f32 v31, v46, v47
  v_cvt_pk_bf16_f32 v32, v48, v49
  v_cvt_pk_bf16_f32 v33, v50, v51
  v_cvt_pk_bf16_f32 v34, v52, v53
  v_cvt_pk_bf16_f32 v35, v54, v55
  v_cvt_pk_bf16_f32 v36, v56, v57
  v_cvt_pk_bf16_f32 v37, v58, v59
  v_cvt_pk_bf16_f32 v38, v60, v61
  v_cvt_pk_bf16_f32 v39, v62, v63
  v_cvt_pk_bf16_f32 v40, v64, v65
  v_cvt_pk_bf16_f32 v41, v66, v67
  v_cvt_pk_bf16_f32 v42, v68, v69
  v_cvt_pk_bf16_f32 v43, v70, v71
  v_cvt_pk_bf16_f32 v44, v72, v73
  v_cvt_pk_bf16_f32 v45, v74, v75
  v_cvt_pk_bf16_f32 v46, v76, v77
  v_cvt_pk_bf16_f32 v47, v78, v79
  v_cvt_pk_bf16_f32 v48, v80, v81
  v_cvt_pk_bf16_f32 v49, v82, v83
  v_cvt_pk_bf16_f32 v50, v84, v85
  v_cvt_pk_bf16_f32 v51, v86, v87
  v_cvt_pk_bf16_f32 v52, v88, v89
  v_cvt_pk_bf16_f32 v53, v90, v91
  v_cvt_pk_bf16_f32 v54, v92, v93
  v_cvt_pk_bf16_f32 v55, v94, v95
  s_mul_i32 s48, s46, 40960
  s_add_u32 s48, s48, s47
  s_add_u32 s48, s48, 0x100000
  s_add_u32 s49, s48, 0
  buffer_store_dwordx4 v[16:19], v10, s[8:11], s49 offen sc1
  s_add_u32 s49, s48, 4096
  buffer_store_dwordx4 v[20:23], v10, s[8:11], s49 offen sc1
  s_add_u32 s49, s48, 8192
  buffer_store_dwordx4 v[24:27], v10, s[8:11], s49 offen sc1
  s_add_u32 s49, s48, 12288
  buffer_store_dwordx4 v[28:31], v10, s[8:11], s49 offen sc1
  s_add_u32 s49, s48, 16384
  buffer_store_dwordx4 v[32:35], v10, s[8:11], s49 offen sc1
  s_add_u32 s49, s48, 20480
  buffer_store_dwordx4 v[36:39], v10, s[8:11], s49 offen sc1
  s_add_u32 s49, s48, 24576
  buffer_store_dwordx4 v[40:43], v10, s[8:11], s49 offen sc1
  s_add_u32 s49, s48, 28672
  buffer_store_dwordx4 v[44:47], v10, s[8:11], s49 offen sc1
  s_add_u32 s49, s48, 32768
  buffer_store_dwordx4 v[48:51], v10, s[8:11], s49 offen sc1
  s_add_u32 s49, s48, 36864
  buffer_store_dwordx4 v[52:55], v10, s[8:11], s49 offen sc1
lnu_49_x:
  s_cmp_eq_u32 s21, 0
  s_cbranch_scc0 ka_cen_done
  s_mov_b64 s[24:25], exec
  s_mov_b64 exec, 1
  v_mov_b32 v3, 1
  s_lshl_b32 s27, s26, 7
  s_add_u32 s27, s27, 0x2000
  v_mov_b32 v4, 0
  buffer_atomic_add v3, v4, s[8:11], s27 offen sc0
  s_mov_b64 exec, 0xffff
  v_lshlrev_b32 v4, 7, v0
  s_mov_b32 s27, 0x2000
  s_mov_b32 s45, 0
  s_waitcnt vmcnt(0)
  v_mov_b32 v5, v3
ka_cen_spin:
  buffer_load_dword v7, v4, s[8:11], s27 offen sc1
  s_add_u32 s45, s45, 1
  s_waitcnt vmcnt(0)
  v_add_u32_dpp v8, v7, v7 quad_perm:[1,0,3,2] row_mask:0xf bank_mask:0xf
  s_nop 1
  v_add_u32_dpp v9, v8, v8 quad_perm:[2,3,0,1] row_mask:0xf bank_mask:0xf
  s_nop 1
  v_add_u32_dpp v8, v9, v9 row_half_mirror row_mask:0xf bank_mask:0xf
  s_nop 1
  v_add_u32_dpp v9, v8, v8 row_mirror row_mask:0xf bank_mask:0xf
  s_nop 0
  v_readfirstlane_b32 s28, v9
  s_cmp_ge_u32 s28, 256
  s_cbranch_scc1 ka_cen_ok
  s_cmp_lt_u32 s45, 400000
  s_cbranch_scc1 ka_cen_spin
ka_cen_ok:
  v_cmp_gt_u32 vcc, s26, v0
  s_nop 1
  v_cndmask_b32 v8, 0, v7, vcc
  s_nop 1
  v_add_u32_dpp v9, v8, v8 quad_perm:[1,0,3,2] row_mask:0xf bank_mask:0xf
  s_nop 1
  v_add_u32_dpp v8, v9, v9 quad_perm:[2,3,0,1] row_mask:0xf bank_mask:0xf
  s_nop 1
  v_add_u32_dpp v9, v8, v8 row_half_mirror row_mask:0xf bank_mask:0xf
  s_nop 1
  v_add_u32_dpp v8, v9, v9 row_mirror row_mask:0xf bank_mask:0xf
  v_add_u32 v6, v8, v5
  s_mov_b64 exec, 0xff
  v_cmp_ne_u32 vcc, 32, v7
  s_nop 1
  s_cmp_eq_u64 vcc, 0
  s_cselect_b32 s27, 1, 0
  s_cmp_ge_u32 s27, 1
  s_cselect_b32 s27, 1, 0
  s_mov_b64 exec, 1
  v_mov_b32 v8, s27
  v_mov_b32 v4, 0
  v_mov_b32 v9, 0
  ds_write_b128 v4, v[6:9]
  ds_write_b32 v4, v5 offset:16
  s_waitcnt lgkmcnt(0)
  s_mov_b64 exec, s[24:25]
ka_cen_done:
  s_barrier
  v_mov_b32 v4, 0
  ds_read_b128 v[6:9], v4
  ds_read_b32 v5, v4 offset:16
  s_waitcnt lgkmcnt(0)
  v_readfirstlane_b32 s27, v6
  v_readfirstlane_b32 s44, v8
  v_readfirstlane_b32 s28, v5
  s_barrier
  s_cmp_eq_u32 s44, 1
  s_cbranch_scc1 ka_cen_fast
  s_lshr_b32 s20, s27, 5
  s_and_b32 s22, s27, 31
  s_branch ka_cen_end
ka_cen_fast:
  s_mov_b32 s20, s26
  s_mov_b32 s22, s28
ka_cen_end:
  s_and_b32 s20, s20, 7
  s_and_b32 s22, s22, 31
  s_cmp_lt_u32 s20, 4
  s_cbranch_scc0 ka_bulk
  s_cmp_lt_u32 s22, 8
  s_cbranch_scc0 ka_noty
  s_lshl_b32 s23, s20, 3
  s_add_u32 s23, s23, s22
  s_cmp_eq_u32 s44, 1
  s_cbranch_scc1 kaf_x
  s_branch kas_x
ka_noty:
  s_cmp_lt_u32 s22, 28
  s_cbranch_scc0 ka_spare
  s_sub_u32 s23, s22, 8
  s_cmp_eq_u32 s44, 1
  s_cbranch_scc1 kaf_y
  s_branch kas_y
ka_bulk:
  s_sub_u32 s28, s20, 4
  s_lshl_b32 s23, s22, 2
  s_add_u32 s23, s23, s28
  s_cmp_lt_u32 s23, 72
  s_cbranch_scc1 ka_qkv
  s_sub_u32 s23, s23, 72
  s_cmp_lt_u32 s23, 32
  s_cbranch_scc1 ka_u
  s_sub_u32 s23, s23, 32
  s_branch ka_ln
ka_ln:
  v_and_b32 v1, 63, v0
  s_lshl_b32 s46, s23, 2
  s_add_u32 s46, s46, s21
  v_and_b32 v5, 7, v1
  v_bfe_u32 v6, v1, 3, 1
  v_lshrrev_b32 v7, 4, v1
  v_lshlrev_b32 v8, 5, v6
  v_add_u32 v8, v8, v5
  v_lshlrev_b32 v8, 4, v8
  v_lshlrev_b32 v9, 11, v7
  v_add_u32 v9, v9, v8
  v_lshlrev_b32 v10, 10, v7
  v_add_u32 v10, v10, v8
  v_mul_u32_u24 v11, 1280, v5
  v_lshlrev_b32 v12, 5, v7
  v_add_u32 v11, v11, v12
  v_lshlrev_b32 v12, 4, v6
  v_add_u32 v11, v11, v12
  s_load_dwordx2 s[36:37], s[0:1], 0
  s_load_dwordx4 s[40:43], s[0:1], 64
  s_waitcnt lgkmcnt(0)
  s_mov_b32 s12, s36
  s_and_b32 s13, s37, 0xffff
  s_mov_b32 s14, 0x280000
  s_mov_b32 s15, 0x20000

  s_cmp_eq_u32 s21, 3
  s_cbranch_scc0 lna_50
  s_waitcnt vmcnt(0)
  s_mov_b64 s[24:25], exec
  s_mov_b64 exec, 1
  s_and_b32 s45, s2, 7
  s_lshl_b32 s45, s45, 7
  s_add_u32 s45, s45, 10240
  v_mov_b32 v2, s45
  v_mov_b32 v3, 1
  buffer_atomic_add v3, v2, s[8:11], 0 offen
  s_mov_b64 exec, s[24:25]
lna_50:
  s_cmp_eq_u32 s99, 0
  s_cbranch_scc0 ka_lnx
  s_mov_b32 s12, s42
  s_and_b32 s13, s43, 0xffff
  s_mov_b32 s14, 0xc8000
  s_mov_b32 s15, 0x20000
  s_mov_b32 s16, s40
  s_and_b32 s17, s41, 0xffff
  s_mov_b32 s18, 0x258000
  s_mov_b32 s19, 0x20000
  v_lshlrev_b32 v2, 4, v1
  v_and_b32 v8, 31, v1
  v_lshrrev_b32 v9, 5, v1
  v_lshrrev_b32 v10, 4, v8
  v_lshlrev_b32 v10, 4, v10
  v_bfe_u32 v11, v8, 2, 1
  v_lshlrev_b32 v11, 3, v11
  v_add_u32 v10, v10, v11
  v_bfe_u32 v11, v8, 3, 1
  v_lshlrev_b32 v11, 2, v11
  v_add_u32 v10, v10, v11
  v_and_b32 v11, 3, v8
  v_add_u32 v10, v10, v11
  v_mul_u32_u24 v12, 30720, v9
  v_lshlrev_b32 v13, 1, v10
  v_add_u32 v13, v13, v12
  v_lshlrev_b32 v14, 1, v8
  v_add_u32 v14, v14, v12
  v_cmp_gt_u32 s[50:51], 20, v10
  v_cmp_gt_u32 s[52:53], 20, v8
  v_lshrrev_b32 v15, 4, v1
  v_mul_u32_u24 v15, 10240, v15
  v_and_b32 v16, 15, v1
  v_lshlrev_b32 v16, 1, v16
  v_add_u32 v15, v15, v16
  s_mov_b32 s46, s23
ka_gl:
  s_barrier
  s_cmp_lt_u32 s46, 40
  s_cbranch_scc0 ka_gwo
  s_mul_i32 s28, s46, 61440
  s_lshl_b32 s29, s21, 10
  s_add_u32 s29, s29, 0
  s_mov_b32 m0, s29
  s_add_u32 s30, s28, s29
  buffer_load_dwordx4 v2, s[16:19], s30 offen lds
  s_lshl_b32 s29, s21, 10
  s_add_u32 s29, s29, 4096
  s_mov_b32 m0, s29
  s_add_u32 s30, s28, s29
  buffer_load_dwordx4 v2, s[16:19], s30 offen lds
  s_lshl_b32 s29, s21, 10
  s_add_u32 s29, s29, 8192
  s_mov_b32 m0, s29
  s_add_u32 s30, s28, s29
  buffer_load_dwordx4 v2, s[16:19], s30 offen lds
  s_lshl_b32 s29, s21, 10
  s_add_u32 s29, s29, 12288
  s_mov_b32 m0, s29
  s_add_u32 s30, s28, s29
  buffer_load_dwordx4 v2, s[16:19], s30 offen lds
  s_lshl_b32 s29, s21, 10
  s_add_u32 s29, s29, 16384
  s_mov_b32 m0, s29
  s_add_u32 s30, s28, s29
  buffer_load_dwordx4 v2, s[16:19], s30 offen lds
  s_lshl_b32 s29, s21, 10
  s_add_u32 s29, s29, 20480
  s_mov_b32 m0, s29
  s_add_u32 s30, s28, s29
  buffer_load_dwordx4 v2, s[16:19], s30 offen lds
  s_lshl_b32 s29, s21, 10
  s_add_u32 s29, s29, 24576
  s_mov_b32 m0, s29
  s_add_u32 s30, s28, s29
  buffer_load_dwordx4 v2, s[16:19], s30 offen lds
  s_lshl_b32 s29, s21, 10
  s_add_u32 s29, s29, 28672
  s_mov_b32 m0, s29
  s_add_u32 s30, s28, s29
  buffer_load_dwordx4 v2, s[16:19], s30 offen lds
  s_lshl_b32 s29, s21, 10
  s_add_u32 s29, s29, 32768
  s_mov_b32 m0, s29
  s_add_u32 s30, s28, s29
  buffer_load_dwordx4 v2, s[16:19], s30 offen lds
  s_lshl_b32 s29, s21, 10
  s_add_u32 s29, s29, 36864
  s_mov_b32 m0, s29
  s_add_u32 s30, s28, s29
  buffer_load_dwordx4 v2, s[16:19], s30 offen lds
  s_lshl_b32 s29, s21, 10
  s_add_u32 s29, s29, 40960
  s_mov_b32 m0, s29
  s_add_u32 s30, s28, s29
  buffer_load_dwordx4 v2, s[16:19], s30 offen lds
  s_lshl_b32 s29, s21, 10
  s_add_u32 s29, s29, 45056
  s_mov_b32 m0, s29
  s_add_u32 s30, s28, s29
  buffer_load_dwordx4 v2, s[16:19], s30 offen lds
  s_lshl_b32 s29, s21, 10
  s_add_u32 s29, s29, 49152
  s_mov_b32 m0, s29
  s_add_u32 s30, s28, s29
  buffer_load_dwordx4 v2, s[16:19], s30 offen lds
  s_lshl_b32 s29, s21, 10
  s_add_u32 s29, s29, 53248
  s_mov_b32 m0, s29
  s_add_u32 s30, s28, s29
  buffer_load_dwordx4 v2, s[16:19], s30 offen lds
  s_lshl_b32 s29, s21, 10
  s_add_u32 s29, s29, 57344
  s_mov_b32 m0, s29
  s_add_u32 s30, s28, s29
  buffer_load_dwordx4 v2, s[16:19], s30 offen lds
  s_waitcnt vmcnt(0)
  s_barrier
  s_lshl_b32 s47, s21, 3
ka_gh:
  s_mul_i32 s28, s47, 40
  s_add_u32 s28, s28, 0
  v_add_u32 v17, s28, v13
  ds_read_u16 v20, v17 offset:0
  ds_read_u16 v21, v17 offset:3840
  ds_read_u16 v22, v17 offset:7680
  ds_read_u16 v23, v17 offset:11520
  ds_read_u16 v24, v17 offset:15360
  ds_read_u16 v25, v17 offset:19200
  ds_read_u16 v26, v17 offset:23040
  ds_read_u16 v27, v17 offset:26880
  s_waitcnt lgkmcnt(0)
  v_lshl_or_b32 v28, v21, 16, v20
  v_cndmask_b32 v28, 0, v28, s[50:51]
  v_lshl_or_b32 v29, v23, 16, v22
  v_cndmask_b32 v29, 0, v29, s[50:51]
  v_lshl_or_b32 v30, v25, 16, v24
  v_cndmask_b32 v30, 0, v30, s[50:51]
  v_lshl_or_b32 v31, v27, 16, v26
  v_cndmask_b32 v31, 0, v31, s[50:51]
  s_mul_i32 s28, s47, 3
  s_add_u32 s28, s28, 0
  s_mul_i32 s28, s28, 40
  s_add_u32 s28, s28, s46
  s_lshl_b32 s28, s28, 10
  s_add_u32 s28, s28, 0xe100000
  buffer_store_dwordx4 v[28:31], v2, s[8:11], s28 offen
  s_nop 1
  s_mul_i32 s28, s47, 40
  s_add_u32 s28, s28, 1280
  v_add_u32 v17, s28, v13
  ds_read_u16 v20, v17 offset:0
  ds_read_u16 v21, v17 offset:3840
  ds_read_u16 v22, v17 offset:7680
  ds_read_u16 v23, v17 offset:11520
  ds_read_u16 v24, v17 offset:15360
  ds_read_u16 v25, v17 offset:19200
  ds_read_u16 v26, v17 offset:23040
  ds_read_u16 v27, v17 offset:26880
  s_waitcnt lgkmcnt(0)
  v_lshl_or_b32 v28, v21, 16, v20
  v_cndmask_b32 v28, 0, v28, s[50:51]
  v_lshl_or_b32 v29, v23, 16, v22
  v_cndmask_b32 v29, 0, v29, s[50:51]
  v_lshl_or_b32 v30, v25, 16, v24
  v_cndmask_b32 v30, 0, v30, s[50:51]
  v_lshl_or_b32 v31, v27, 16, v26
  v_cndmask_b32 v31, 0, v31, s[50:51]
  s_mul_i32 s28, s47, 3
  s_add_u32 s28, s28, 1
  s_mul_i32 s28, s28, 40
  s_add_u32 s28, s28, s46
  s_lshl_b32 s28, s28, 10
  s_add_u32 s28, s28, 0xe100000
  buffer_store_dwordx4 v[28:31], v2, s[8:11], s28 offen
  s_nop 1
  s_mul_i32 s28, s47, 40
  s_add_u32 s28, s28, 2560
  v_add_u32 v17, s28, v14
  ds_read_u16 v20, v17 offset:0
  ds_read_u16 v21, v17 offset:3840
  ds_read_u16 v22, v17 offset:7680
  ds_read_u16 v23, v17 offset:11520
  ds_read_u16 v24, v17 offset:15360
  ds_read_u16 v25, v17 offset:19200
  ds_read_u16 v26, v17 offset:23040
  ds_read_u16 v27, v17 offset:26880
  s_waitcnt lgkmcnt(0)
  v_lshl_or_b32 v28, v21, 16, v20
  v_cndmask_b32 v28, 0, v28, s[52:53]
  v_lshl_or_b32 v29, v23, 16, v22
  v_cndmask_b32 v29, 0, v29, s[52:53]
  v_lshl_or_b32 v30, v25, 16, v24
  v_cndmask_b32 v30, 0, v30, s[52:53]
  v_lshl_or_b32 v31, v27, 16, v26
  v_cndmask_b32 v31, 0, v31, s[52:53]
  s_mul_i32 s28, s47, 3
  s_add_u32 s28, s28, 2
  s_mul_i32 s28, s28, 40
  s_add_u32 s28, s28, s46
  s_lshl_b32 s28, s28, 10
  s_add_u32 s28, s28, 0xe100000
  buffer_store_dwordx4 v[28:31], v2, s[8:11], s28 offen
  s_nop 1
  s_add_u32 s47, s47, 1
  s_and_b32 s28, s47, 7
  s_cmp_lg_u32 s28, 0
  s_cbranch_scc1 ka_gh
  s_branch ka_gn
ka_gwo:
  s_sub_u32 s48, s46, 40
  s_mul_i32 s28, s48, 40960
  s_lshl_b32 s29, s21, 10
  s_add_u32 s29, s29, 0
  s_mov_b32 m0, s29
  s_add_u32 s30, s28, s29
  buffer_load_dwordx4 v2, s[12:15], s30 offen lds
  s_lshl_b32 s29, s21, 10
  s_add_u32 s29, s29, 4096
  s_mov_b32 m0, s29
  s_add_u32 s30, s28, s29
  buffer_load_dwordx4 v2, s[12:15], s30 offen lds
  s_lshl_b32 s29, s21, 10
  s_add_u32 s29, s29, 8192
  s_mov_b32 m0, s29
  s_add_u32 s30, s28, s29
  buffer_load_dwordx4 v2, s[12:15], s30 offen lds
  s_lshl_b32 s29, s21, 10
  s_add_u32 s29, s29, 12288
  s_mov_b32 m0, s29
  s_add_u32 s30, s28, s29
  buffer_load_dwordx4 v2, s[12:15], s30 offen lds
  s_lshl_b32 s29, s21, 10
  s_add_u32 s29, s29, 16384
  s_mov_b32 m0, s29
  s_add_u32 s30, s28, s29
  buffer_load_dwordx4 v2, s[12:15], s30 offen lds
  s_lshl_b32 s29, s21, 10
  s_add_u32 s29, s29, 20480
  s_mov_b32 m0, s29
  s_add_u32 s30, s28, s29
  buffer_load_dwordx4 v2, s[12:15], s30 offen lds
  s_lshl_b32 s29, s21, 10
  s_add_u32 s29, s29, 24576
  s_mov_b32 m0, s29
  s_add_u32 s30, s28, s29
  buffer_load_dwordx4 v2, s[12:15], s30 offen lds
  s_lshl_b32 s29, s21, 10
  s_add_u32 s29, s29, 28672
  s_mov_b32 m0, s29
  s_add_u32 s30, s28, s29
  buffer_load_dwordx4 v2, s[12:15], s30 offen lds
  s_lshl_b32 s29, s21, 10
  s_add_u32 s29, s29, 32768
  s_mov_b32 m0, s29
  s_add_u32 s30, s28, s29
  buffer_load_dwordx4 v2, s[12:15], s30 offen lds
  s_lshl_b32 s29, s21, 10
  s_add_u32 s29, s29, 36864
  s_mov_b32 m0, s29
  s_add_u32 s30, s28, s29
  buffer_load_dwordx4 v2, s[12:15], s30 offen lds
  s_waitcnt vmcnt(0)
  s_barrier
  s_mul_i32 s47, s21, 10
  s_add_u32 s49, s47, 10
ka_gc:
  s_lshl_b32 s28, s47, 5
  v_add_u32 v17, s28, v15
  ds_read_u16 v20, v17 offset:0
  ds_read_u16 v21, v17 offset:1280
  ds_read_u16 v22, v17 offset:2560
  ds_read_u16 v23, v17 offset:3840
  ds_read_u16 v24, v17 offset:5120
  ds_read_u16 v25, v17 offset:6400
  ds_read_u16 v26, v17 offset:7680
  ds_read_u16 v27, v17 offset:8960
  s_waitcnt lgkmcnt(0)
  v_lshl_or_b32 v28, v21, 16, v20
  v_lshl_or_b32 v29, v23, 16, v22
  v_lshl_or_b32 v30, v25, 16, v24
  v_lshl_or_b32 v31, v27, 16, v26
  s_mul_i32 s28, s47, 20
  s_add_u32 s28, s28, s48
  s_lshl_b32 s28, s28, 10
  s_add_u32 s28, s28, 0xe000000
  buffer_store_dwordx4 v[28:31], v2, s[8:11], s28 offen
  s_add_u32 s47, s47, 1
  s_cmp_lt_u32 s47, s49
  s_cbranch_scc1 ka_gc
ka_gn:
  s_add_u32 s46, s46, 24
  s_cmp_lt_u32 s46, 60
  s_cbranch_scc1 ka_gl
ka_lnx:
  s_waitcnt vmcnt(0)
  s_branch ka_exit
ka_spare:
  s_cmp_eq_u32 s21, 3
  s_cbranch_scc0 lna_51
  s_waitcnt vmcnt(0)
  s_mov_b64 s[24:25], exec
  s_mov_b64 exec, 1
  s_and_b32 s45, s2, 7
  s_lshl_b32 s45, s45, 7
  s_add_u32 s45, s45, 10240
  v_mov_b32 v2, s45
  v_mov_b32 v3, 1
  buffer_atomic_add v3, v2, s[8:11], 0 offen
  s_mov_b64 exec, s[24:25]
lna_51:
ka_pf:
  v_and_b32 v1, 63, v0
  v_lshlrev_b32 v4, 6, v1
  s_sub_u32 s46, s22, 28
  s_lshl_b32 s46, s46, 2
  s_add_u32 s46, s46, s21
  s_mul_i32 s28, s20, 24
  v_and_b32 v5, 15, v1
  v_min_u32 v5, 11, v5
  v_cmp_le_u32 vcc, 6, v5
  v_subrev_u32 v6, 6, v5
  v_mov_b32 v7, 0x400
  v_cndmask_b32 v5, v5, v6, vcc
  v_cndmask_b32 v7, 0, v7, vcc
  v_lshlrev_b32 v5, 2, v5
  v_add_u32 v5, v5, v7
  s_add_u32 s28, s28, 0
  v_add_u32 v5, s28, v5
  v_and_b32 v6, 7, v1
  v_lshlrev_b32 v6, 2, v6
  s_lshl_b32 s28, s20, 5
  s_add_u32 s28, s28, 3072
  v_add_u32 v6, s28, v6
  s_mul_i32 s47, s20, 327680
  s_mul_i32 s28, s46, 20480
  s_add_u32 s47, s47, s28
  s_add_u32 s47, s47, 0x9000000
  s_mul_i32 s28, s46, 3
  s_add_u32 s28, s28, 0
  s_cmp_ge_u32 s28, 24
  s_cselect_b32 s29, 0x1800000, 0
  s_cselect_b32 s30, 24, 0
  s_sub_u32 s28, s28, s30
  s_mul_i32 s30, s28, 43
  s_lshr_b32 s30, s30, 7
  s_mul_i32 s31, s30, 3
  s_sub_u32 s31, s28, s31
  s_lshl_b32 s28, s20, 3
  s_add_u32 s30, s30, s28
  s_mul_i32 s30, s30, 786432
  s_lshl_b32 s31, s31, 12
  s_add_u32 s30, s30, s31
  s_add_u32 s30, s30, 0x4800000
  s_add_u32 s48, s30, s29
  s_mul_i32 s28, s46, 3
  s_add_u32 s28, s28, 1
  s_cmp_ge_u32 s28, 24
  s_cselect_b32 s29, 0x1800000, 0
  s_cselect_b32 s30, 24, 0
  s_sub_u32 s28, s28, s30
  s_mul_i32 s30, s28, 43
  s_lshr_b32 s30, s30, 7
  s_mul_i32 s31, s30, 3
  s_sub_u32 s31, s28, s31
  s_lshl_b32 s28, s20, 3
  s_add_u32 s30, s30, s28
  s_mul_i32 s30, s30, 786432
  s_lshl_b32 s31, s31, 12
  s_add_u32 s30, s30, s31
  s_add_u32 s30, s30, 0x4800000
  s_add_u32 s49, s30, s29
  s_mul_i32 s28, s46, 3
  s_add_u32 s28, s28, 2
  s_cmp_ge_u32 s28, 24
  s_cselect_b32 s29, 0x1800000, 0
  s_cselect_b32 s30, 24, 0
  s_sub_u32 s28, s28, s30
  s_mul_i32 s30, s28, 43
  s_lshr_b32 s30, s30, 7
  s_mul_i32 s31, s30, 3
  s_sub_u32 s31, s28, s31
  s_lshl_b32 s28, s20, 3
  s_add_u32 s30, s30, s28
  s_mul_i32 s30, s30, 786432
  s_lshl_b32 s31, s31, 12
  s_add_u32 s30, s30, s31
  s_add_u32 s30, s30, 0x4800000
  s_add_u32 s50, s30, s29
  s_mul_i32 s28, s20, 327680
  s_add_u32 s28, s28, 0x700000
  s_lshl_b32 s29, s46, 12
  s_add_u32 s51, s28, s29
  s_mov_b32 s52, 5120
  s_cmp_ge_u32 s46, 3
  s_cbranch_scc0 ka_pf1
  s_mul_i32 s28, s20, 655360
  s_add_u32 s28, s28, 0x402800
  s_sub_u32 s29, s46, 3
  s_lshl_b32 s29, s29, 12
  s_add_u32 s51, s28, s29
  s_mov_b32 s52, 10240
  s_cmp_ge_u32 s46, 6
  s_cbranch_scc0 ka_pf1
  s_mul_i32 s28, s20, 1310720
  s_add_u32 s28, s28, 0xe00000
  s_sub_u32 s29, s46, 6
  s_lshl_b32 s29, s29, 12
  s_add_u32 s51, s28, s29
  s_mov_b32 s52, 20480
ka_pf1:
  s_mul_i32 s53, s20, 655360
  s_add_u32 s53, s53, 0x400000
  s_mov_b32 s54, 0
  s_mov_b32 s55, 0
  s_mov_b32 s56, 0
  v_mov_b32 v7, 0
ka_pfl:
  s_cmp_gt_u32 s54, 3
  s_cbranch_scc0 ka_pfgo
  s_sub_u32 s28, s54, 3
  s_mul_i32 s28, s28, 10240
  s_add_u32 s28, s28, s53
  s_mov_b32 s45, 0
ka_pfw:
  buffer_load_dword v8, v7, s[8:11], s28 offen sc1
  s_add_u32 s45, s45, 1
  s_waitcnt vmcnt(0)
  v_readfirstlane_b32 s29, v8
  s_cmp_lg_u32 s29, -1
  s_cbranch_scc1 ka_pfgo
  s_sleep 4
  s_cmp_lt_u32 s45, 400000
  s_cbranch_scc1 ka_pfw
  s_branch ka_exit
ka_pfgo:
  s_cmp_eq_u32 s54, 6
  s_cbranch_scc0 ka_pfnm
  s_cmp_eq_u32 s20, 0
  s_cbranch_scc0 ka_pfnm
  s_cmp_eq_u32 s46, 15
  s_cbranch_scc0 ka_pfnm
  v_and_b32 v8, 7, v1
  v_lshlrev_b32 v8, 8, v8
  v_bfe_u32 v9, v1, 3, 1
  v_lshlrev_b32 v9, 13, v9
  v_add_u32 v8, v8, v9
  s_mov_b32 s28, 0xaa0000
  buffer_store_dword v7, v8, s[8:11], s28 offen sc1
  s_waitcnt vmcnt(0)
  s_mov_b64 s[24:25], exec
  s_mov_b64 exec, 1
  s_mov_b32 s30, -1
  s_mov_b32 s31, -1
  s_mov_b32 s28, 0xaa0000
  s_memtime s[32:33]
  s_waitcnt lgkmcnt(0)
  buffer_load_dword v9, v7, s[8:11], s28 offen sc1
  s_waitcnt vmcnt(0)
  s_memtime s[34:35]
  s_waitcnt lgkmcnt(0)
  s_sub_u32 s34, s34, s32
  s_min_u32 s30, s30, s34
  s_mov_b32 s28, 0xaa2000
  s_memtime s[32:33]
  s_waitcnt lgkmcnt(0)
  buffer_load_dword v9, v7, s[8:11], s28 offen sc1
  s_waitcnt vmcnt(0)
  s_memtime s[34:35]
  s_waitcnt lgkmcnt(0)
  s_sub_u32 s34, s34, s32
  s_min_u32 s31, s31, s34
  s_mov_b32 s28, 0xaa0100
  s_memtime s[32:33]
  s_waitcnt lgkmcnt(0)
  buffer_load_dword v9, v7, s[8:11], s28 offen sc1
  s_waitcnt vmcnt(0)
  s_memtime s[34:35]
  s_waitcnt lgkmcnt(0)
  s_sub_u32 s34, s34, s32
  s_min_u32 s30, s30, s34
  s_mov_b32 s28, 0xaa2100
  s_memtime s[32:33]
  s_waitcnt lgkmcnt(0)
  buffer_load_dword v9, v7, s[8:11], s28 offen sc1
  s_waitcnt vmcnt(0)
  s_memtime s[34:35]
  s_waitcnt lgkmcnt(0)
  s_sub_u32 s34, s34, s32
  s_min_u32 s31, s31, s34
  s_mov_b32 s28, 0xaa0200
  s_memtime s[32:33]
  s_waitcnt lgkmcnt(0)
  buffer_load_dword v9, v7, s[8:11], s28 offen sc1
  s_waitcnt vmcnt(0)
  s_memtime s[34:35]
  s_waitcnt lgkmcnt(0)
  s_sub_u32 s34, s34, s32
  s_min_u32 s30, s30, s34
  s_mov_b32 s28, 0xaa2200
  s_memtime s[32:33]
  s_waitcnt lgkmcnt(0)
  buffer_load_dword v9, v7, s[8:11], s28 offen sc1
  s_waitcnt vmcnt(0)
  s_memtime s[34:35]
  s_waitcnt lgkmcnt(0)
  s_sub_u32 s34, s34, s32
  s_min_u32 s31, s31, s34
  s_mov_b32 s28, 0xaa0300
  s_memtime s[32:33]
  s_waitcnt lgkmcnt(0)
  buffer_load_dword v9, v7, s[8:11], s28 offen sc1
  s_waitcnt vmcnt(0)
  s_memtime s[34:35]
  s_waitcnt lgkmcnt(0)
  s_sub_u32 s34, s34, s32
  s_min_u32 s30, s30, s34
  s_mov_b32 s28, 0xaa2300
  s_memtime s[32:33]
  s_waitcnt lgkmcnt(0)
  buffer_load_dword v9, v7, s[8:11], s28 offen sc1
  s_waitcnt vmcnt(0)
  s_memtime s[34:35]
  s_waitcnt lgkmcnt(0)
  s_sub_u32 s34, s34, s32
  s_min_u32 s31, s31, s34
  s_mov_b32 s28, 0xaa0400
  s_memtime s[32:33]
  s_waitcnt lgkmcnt(0)
  buffer_load_dword v9, v7, s[8:11], s28 offen sc1
  s_waitcnt vmcnt(0)
  s_memtime s[34:35]
  s_waitcnt lgkmcnt(0)
  s_sub_u32 s34, s34, s32
  s_min_u32 s30, s30, s34
  s_mov_b32 s28, 0xaa2400
  s_memtime s[32:33]
  s_waitcnt lgkmcnt(0)
  buffer_load_dword v9, v7, s[8:11], s28 offen sc1
  s_waitcnt vmcnt(0)
  s_memtime s[34:35]
  s_waitcnt lgkmcnt(0)
  s_sub_u32 s34, s34, s32
  s_min_u32 s31, s31, s34
  s_mov_b32 s28, 0xaa0500
  s_memtime s[32:33]
  s_waitcnt lgkmcnt(0)
  buffer_load_dword v9, v7, s[8:11], s28 offen sc1
  s_waitcnt vmcnt(0)
  s_memtime s[34:35]
  s_waitcnt lgkmcnt(0)
  s_sub_u32 s34, s34, s32
  s_min_u32 s30, s30, s34
  s_mov_b32 s28, 0xaa2500
  s_memtime s[32:33]
  s_waitcnt lgkmcnt(0)
  buffer_load_dword v9, v7, s[8:11], s28 offen sc1
  s_waitcnt vmcnt(0)
  s_memtime s[34:35]
  s_waitcnt lgkmcnt(0)
  s_sub_u32 s34, s34, s32
  s_min_u32 s31, s31, s34
  s_cmp_le_u32 s30, s31
  s_cselect_b32 s28, 1, 2
  v_mov_b32 v9, s28
  v_mov_b32 v8, 5056
  buffer_store_dword v9, v8, s[8:11], 0 offen sc1
  v_mov_b32 v9, s30
  buffer_store_dword v9, v8, s[8:11], 0 offen offset:4 sc1
  v_mov_b32 v9, s31
  buffer_store_dword v9, v8, s[8:11], 0 offen offset:8 sc1
  s_mov_b64 exec, s[24:25]
ka_pfnm:
  s_cmp_lt_u32 s46, 11
  s_cbranch_scc0 ka_pf2
  buffer_load_dword v9, v4, s[8:11], s51 offen sc1
ka_pf2:
  s_cmp_gt_u32 s55, s54
  s_cbranch_scc1 ka_wp_52_ok
  s_mov_b32 s45, 0
ka_wp_52_spin:
  buffer_load_dword v2, v5, s[8:11], 0 offen sc1
  s_add_u32 s45, s45, 1
  s_waitcnt vmcnt(0)
  v_min_u32_dpp v3, v2, v2 quad_perm:[1,0,3,2] row_mask:0xf bank_mask:0xf
  s_nop 1
  v_min_u32_dpp v2, v3, v3 quad_perm:[2,3,0,1] row_mask:0xf bank_mask:0xf
  s_nop 1
  v_min_u32_dpp v3, v2, v2 row_half_mirror row_mask:0xf bank_mask:0xf
  s_nop 1
  v_min_u32_dpp v2, v3, v3 row_mirror row_mask:0xf bank_mask:0xf
  s_nop 0
  v_readfirstlane_b32 s55, v2
  s_cmp_gt_u32 s55, s54
  s_cbranch_scc1 ka_wp_52_ok
  s_cmp_lt_u32 s45, 400000
  s_cbranch_scc1 ka_wp_52_spin
  s_branch ka_abort
ka_wp_52_ok:
  buffer_load_dword v10, v4, s[8:11], s48 offen sc1
  buffer_load_dword v11, v4, s[8:11], s49 offen sc1
  buffer_load_dword v12, v4, s[8:11], s50 offen sc1
  s_cmp_gt_u32 s56, s54
  s_cbranch_scc1 ka_wp_53_ok
  s_mov_b32 s45, 0
ka_wp_53_spin:
  buffer_load_dword v2, v6, s[8:11], 0 offen sc1
  s_add_u32 s45, s45, 1
  s_waitcnt vmcnt(0)
  v_min_u32_dpp v3, v2, v2 quad_perm:[1,0,3,2] row_mask:0xf bank_mask:0xf
  s_nop 1
  v_min_u32_dpp v2, v3, v3 quad_perm:[2,3,0,1] row_mask:0xf bank_mask:0xf
  s_nop 1
  v_min_u32_dpp v3, v2, v2 row_half_mirror row_mask:0xf bank_mask:0xf
  s_nop 1
  v_min_u32_dpp v2, v3, v3 quad_perm:[0,1,2,3] row_mask:0xf bank_mask:0xf
  s_nop 0
  v_readfirstlane_b32 s56, v2
  s_cmp_gt_u32 s56, s54
  s_cbranch_scc1 ka_wp_53_ok
  s_cmp_lt_u32 s45, 400000
  s_cbranch_scc1 ka_wp_53_spin
  s_branch ka_abort
ka_wp_53_ok:
  s_add_u32 s28, s47, 0
  buffer_load_dword v13, v4, s[8:11], s28 offen sc1
  s_add_u32 s28, s47, 4096
  buffer_load_dword v14, v4, s[8:11], s28 offen sc1
  s_add_u32 s28, s47, 8192
  buffer_load_dword v15, v4, s[8:11], s28 offen sc1
  s_add_u32 s28, s47, 12288
  buffer_load_dword v16, v4, s[8:11], s28 offen sc1
  s_add_u32 s28, s47, 16384
  buffer_load_dword v17, v4, s[8:11], s28 offen sc1
  s_add_u32 s47, s47, 1310720
  s_add_u32 s48, s48, 12288
  s_add_u32 s49, s49, 12288
  s_add_u32 s50, s50, 12288
  s_add_u32 s51, s51, s52
  s_add_u32 s54, s54, 1
  s_waitcnt vmcnt(0)
  s_cmp_lt_u32 s54, 64
  s_cbranch_scc1 ka_pfl
  s_branch ka_exit
ka_qkv:
  s_mul_i32 s26, s23, 43
  s_lshr_b32 s26, s26, 10
  s_mul_i32 s27, s26, 24
  s_sub_u32 s27, s23, s27
  s_cmp_eq_u32 s26, 0
  s_cselect_b32 s28, s36, s38
  s_cselect_b32 s29, s37, s39
  s_cmp_eq_u32 s26, 2
  s_cselect_b32 s28, s40, s28
  s_cselect_b32 s29, s41, s29
  s_mov_b32 s12, s28
  s_and_b32 s13, s29, 0xffff
  s_mov_b32 s14, 0x780000
  s_mov_b32 s15, 0x20000
  s_mul_i32 s46, s26, 0x1800000
  s_add_u32 s46, s46, 0x4800000
  s_lshl_b32 s47, s26, 10
  s_lshl_b32 s28, s27, 2
  s_add_u32 s47, s47, s28
  s_add_u32 s47, s47, 0
  s_lshl_b32 s28, s27, 3
  s_lshl_b32 s29, s21, 1
  s_add_u32 s28, s28, s29
  s_add_u32 s29, s28, 0
  s_mul_i32 s30, s29, 171
  s_lshr_b32 s30, s30, 10
  s_mul_i32 s31, s30, 6
  s_sub_u32 s31, s29, s31
  s_mul_i32 s30, s30, 786432
  s_lshl_b32 s31, s31, 11
  s_add_u32 s30, s30, s31
  s_add_u32 s48, s30, s46
  s_add_u32 s29, s28, 1
  s_mul_i32 s30, s29, 171
  s_lshr_b32 s30, s30, 10
  s_mul_i32 s31, s30, 6
  s_sub_u32 s31, s29, s31
  s_mul_i32 s30, s30, 786432
  s_lshl_b32 s31, s31, 11
  s_add_u32 s30, s30, s31
  s_add_u32 s49, s30, s46
  v_and_b32 v1, 63, v0
  v_lshrrev_b32 v2, 4, v1
  v_bfe_u32 v3, v1, 2, 2
  v_and_b32 v4, 3, v1
  s_lshr_b32 s28, s21, 1
  s_lshl_b32 s28, s28, 2
  v_add_u32 v5, s28, v3
  v_mul_u32_u24 v5, 12288, v5
  s_and_b32 s28, s21, 1
  s_lshl_b32 s28, s28, 8
  s_lshl_b32 s29, s27, 9
  s_add_u32 s28, s28, s29
  v_add_u32 v5, s28, v5
  v_lshlrev_b32 v6, 6, v2
  v_add_u32 v5, v5, v6
  v_lshlrev_b32 v6, 4, v4
  v_add_u32 v5, v5, v6
  v_lshrrev_b32 v6, 1, v2
  v_lshlrev_b32 v7, 12, v6
  v_lshlrev_b32 v6, 6, v3
  v_add_u32 v7, v7, v6
  v_and_b32 v6, 1, v2
  v_lshlrev_b32 v6, 5, v6
  v_add_u32 v7, v7, v6
  v_lshrrev_b32 v6, 1, v4
  v_lshlrev_b32 v6, 4, v6
  v_add_u32 v7, v7, v6
  v_and_b32 v6, 1, v4
  v_lshlrev_b32 v6, 3, v6
  v_add_u32 v7, v7, v6
  s_lshl_b32 s28, s21, 9
  v_add_u32 v7, s28, v7
  v_lshlrev_b32 v14, 4, v1
  s_lshl_b32 s28, s21, 10
  v_add_u32 v6, s28, v14
  v_and_b32 v15, 7, v1
  v_lshlrev_b32 v15, 7, v15
  v_add_u32 v15, 10240, v15
  s_mov_b32 s51, 0x100000
  s_lshl_b32 s29, s21, 10
  s_add_u32 m0, s29, 0
  s_mov_b32 s28, 0
  buffer_load_dwordx4 v5, s[12:15], s28 offen lds
  s_lshl_b32 s29, s21, 10
  s_add_u32 m0, s29, 4096
  s_mov_b32 s28, 98304
  buffer_load_dwordx4 v5, s[12:15], s28 offen lds
  s_lshl_b32 s29, s21, 10
  s_add_u32 m0, s29, 8192
  s_mov_b32 s28, 196608
  buffer_load_dwordx4 v5, s[12:15], s28 offen lds
  s_lshl_b32 s29, s21, 10
  s_add_u32 m0, s29, 12288
  s_mov_b32 s28, 294912
  buffer_load_dwordx4 v5, s[12:15], s28 offen lds
  s_lshl_b32 s29, s21, 10
  s_add_u32 m0, s29, 16384
  s_mov_b32 s28, 393216
  buffer_load_dwordx4 v5, s[12:15], s28 offen lds
  s_lshl_b32 s29, s21, 10
  s_add_u32 m0, s29, 20480
  s_mov_b32 s28, 491520
  buffer_load_dwordx4 v5, s[12:15], s28 offen lds
  s_lshl_b32 s29, s21, 10
  s_add_u32 m0, s29, 24576
  s_mov_b32 s28, 589824
  buffer_load_dwordx4 v5, s[12:15], s28 offen lds
  s_lshl_b32 s29, s21, 10
  s_add_u32 m0, s29, 28672
  s_mov_b32 s28, 688128
  buffer_load_dwordx4 v5, s[12:15], s28 offen lds
  s_lshl_b32 s29, s21, 10
  s_add_u32 m0, s29, 32768
  s_mov_b32 s28, 786432
  buffer_load_dwordx4 v5, s[12:15], s28 offen lds
  s_lshl_b32 s29, s21, 10
  s_add_u32 m0, s29, 36864
  s_mov_b32 s28, 884736
  buffer_load_dwordx4 v5, s[12:15], s28 offen lds
  s_lshl_b32 s29, s21, 10
  s_add_u32 m0, s29, 40960
  s_mov_b32 s28, 983040
  buffer_load_dwordx4 v5, s[12:15], s28 offen lds
  s_lshl_b32 s29, s21, 10
  s_add_u32 m0, s29, 45056
  s_mov_b32 s28, 1081344
  buffer_load_dwordx4 v5, s[12:15], s28 offen lds
  s_lshl_b32 s29, s21, 10
  s_add_u32 m0, s29, 49152
  s_mov_b32 s28, 1179648
  buffer_load_dwordx4 v5, s[12:15], s28 offen lds
  s_lshl_b32 s29, s21, 10
  s_add_u32 m0, s29, 53248
  s_mov_b32 s28, 1277952
  buffer_load_dwordx4 v5, s[12:15], s28 offen lds
  s_lshl_b32 s29, s21, 10
  s_add_u32 m0, s29, 57344
  s_mov_b32 s28, 1376256
  buffer_load_dwordx4 v5, s[12:15], s28 offen lds
  s_lshl_b32 s29, s21, 10
  s_add_u32 m0, s29, 61440
  s_mov_b32 s28, 1474560
  buffer_load_dwordx4 v5, s[12:15], s28 offen lds
  s_lshl_b32 s29, s21, 10
  s_add_u32 m0, s29, 65536
  s_mov_b32 s28, 1572864
  buffer_load_dwordx4 v5, s[12:15], s28 offen lds
  s_lshl_b32 s29, s21, 10
  s_add_u32 m0, s29, 69632
  s_mov_b32 s28, 1671168
  buffer_load_dwordx4 v5, s[12:15], s28 offen lds
  s_lshl_b32 s29, s21, 10
  s_add_u32 m0, s29, 73728
  s_mov_b32 s28, 1769472
  buffer_load_dwordx4 v5, s[12:15], s28 offen lds
  s_lshl_b32 s29, s21, 10
  s_add_u32 m0, s29, 77824
  s_mov_b32 s28, 1867776
  buffer_load_dwordx4 v5, s[12:15], s28 offen lds
  s_lshl_b32 s29, s21, 10
  s_add_u32 m0, s29, 81920
  s_mov_b32 s28, 1966080
  buffer_load_dwordx4 v5, s[12:15], s28 offen lds
  s_lshl_b32 s29, s21, 10
  s_add_u32 m0, s29, 86016
  s_mov_b32 s28, 2064384
  buffer_load_dwordx4 v5, s[12:15], s28 offen lds
  s_lshl_b32 s29, s21, 10
  s_add_u32 m0, s29, 90112
  s_mov_b32 s28, 2162688
  buffer_load_dwordx4 v5, s[12:15], s28 offen lds
  s_lshl_b32 s29, s21, 10
  s_add_u32 m0, s29, 94208
  s_mov_b32 s28, 2260992
  buffer_load_dwordx4 v5, s[12:15], s28 offen lds
  s_waitcnt vmcnt(20)
  s_cmp_eq_u32 s21, 3
  s_cbranch_scc0 lna_54
  s_mov_b64 s[24:25], exec
  s_mov_b64 exec, 1
  s_and_b32 s45, s2, 7
  s_lshl_b32 s45, s45, 7
  s_add_u32 s45, s45, 10240
  v_mov_b32 v2, s45
  v_mov_b32 v3, 1
  buffer_atomic_add v3, v2, s[8:11], 0 offen
  s_mov_b64 exec, s[24:25]
lna_54:
  s_barrier
  s_lshl_b32 s29, s21, 10
  s_add_u32 m0, s29, 98304
  s_mov_b32 s28, 2359296
  buffer_load_dwordx4 v5, s[12:15], s28 offen lds
  s_lshl_b32 s29, s21, 10
  s_add_u32 m0, s29, 102400
  s_mov_b32 s28, 2457600
  buffer_load_dwordx4 v5, s[12:15], s28 offen lds
  s_lshl_b32 s29, s21, 10
  s_add_u32 m0, s29, 106496
  s_mov_b32 s28, 2555904
  buffer_load_dwordx4 v5, s[12:15], s28 offen lds
  s_lshl_b32 s29, s21, 10
  s_add_u32 m0, s29, 110592
  s_mov_b32 s28, 2654208
  buffer_load_dwordx4 v5, s[12:15], s28 offen lds
  v_add_u32 v8, 0, v7
  ds_read_b64_tr_b16 a[0:1], v8 offset:0
  ds_read_b64_tr_b16 a[2:3], v8 offset:2048
  ds_read_b64_tr_b16 a[4:5], v8 offset:8192
  ds_read_b64_tr_b16 a[6:7], v8 offset:10240
  ds_read_b64_tr_b16 a[160:161], v8 offset:256
  ds_read_b64_tr_b16 a[162:163], v8 offset:2304
  ds_read_b64_tr_b16 a[164:165], v8 offset:8448
  ds_read_b64_tr_b16 a[166:167], v8 offset:10496
  s_waitcnt lgkmcnt(0)
  s_waitcnt vmcnt(20)
  s_barrier
  s_lshl_b32 s29, s21, 10
  s_add_u32 m0, s29, 0
  s_mov_b32 s28, 2752512
  buffer_load_dwordx4 v5, s[12:15], s28 offen lds
  s_lshl_b32 s29, s21, 10
  s_add_u32 m0, s29, 4096
  s_mov_b32 s28, 2850816
  buffer_load_dwordx4 v5, s[12:15], s28 offen lds
  s_lshl_b32 s29, s21, 10
  s_add_u32 m0, s29, 8192
  s_mov_b32 s28, 2949120
  buffer_load_dwordx4 v5, s[12:15], s28 offen lds
  s_lshl_b32 s29, s21, 10
  s_add_u32 m0, s29, 12288
  s_mov_b32 s28, 3047424
  buffer_load_dwordx4 v5, s[12:15], s28 offen lds
  v_add_u32 v8, 16384, v7
  ds_read_b64_tr_b16 a[8:9], v8 offset:0
  ds_read_b64_tr_b16 a[10:11], v8 offset:2048
  ds_read_b64_tr_b16 a[12:13], v8 offset:8192
  ds_read_b64_tr_b16 a[14:15], v8 offset:10240
  ds_read_b64_tr_b16 a[168:169], v8 offset:256
  ds_read_b64_tr_b16 a[170:171], v8 offset:2304
  ds_read_b64_tr_b16 a[172:173], v8 offset:8448
  ds_read_b64_tr_b16 a[174:175], v8 offset:10496
  s_waitcnt lgkmcnt(0)
  s_waitcnt vmcnt(20)
  s_barrier
  s_lshl_b32 s29, s21, 10
  s_add_u32 m0, s29, 16384
  s_mov_b32 s28, 3145728
  buffer_load_dwordx4 v5, s[12:15], s28 offen lds
  s_lshl_b32 s29, s21, 10
  s_add_u32 m0, s29, 20480
  s_mov_b32 s28, 3244032
  buffer_load_dwordx4 v5, s[12:15], s28 offen lds
  s_lshl_b32 s29, s21, 10
  s_add_u32 m0, s29, 24576
  s_mov_b32 s28, 3342336
  buffer_load_dwordx4 v5, s[12:15], s28 offen lds
  s_lshl_b32 s29, s21, 10
  s_add_u32 m0, s29, 28672
  s_mov_b32 s28, 3440640
  buffer_load_dwordx4 v5, s[12:15], s28 offen lds
  v_add_u32 v8, 32768, v7
  ds_read_b64_tr_b16 a[16:17], v8 offset:0
  ds_read_b64_tr_b16 a[18:19], v8 offset:2048
  ds_read_b64_tr_b16 a[20:21], v8 offset:8192
  ds_read_b64_tr_b16 a[22:23], v8 offset:10240
  ds_read_b64_tr_b16 a[176:177], v8 offset:256
  ds_read_b64_tr_b16 a[178:179], v8 offset:2304
  ds_read_b64_tr_b16 a[180:181], v8 offset:8448
  ds_read_b64_tr_b16 a[182:183], v8 offset:10496
  s_waitcnt lgkmcnt(0)
  s_waitcnt vmcnt(20)
  s_barrier
  s_lshl_b32 s29, s21, 10
  s_add_u32 m0, s29, 32768
  s_mov_b32 s28, 3538944
  buffer_load_dwordx4 v5, s[12:15], s28 offen lds
  s_lshl_b32 s29, s21, 10
  s_add_u32 m0, s29, 36864
  s_mov_b32 s28, 3637248
  buffer_load_dwordx4 v5, s[12:15], s28 offen lds
  s_lshl_b32 s29, s21, 10
  s_add_u32 m0, s29, 40960
  s_mov_b32 s28, 3735552
  buffer_load_dwordx4 v5, s[12:15], s28 offen lds
  s_lshl_b32 s29, s21, 10
  s_add_u32 m0, s29, 45056
  s_mov_b32 s28, 3833856
  buffer_load_dwordx4 v5, s[12:15], s28 offen lds
  v_add_u32 v8, 49152, v7
  ds_read_b64_tr_b16 a[24:25], v8 offset:0
  ds_read_b64_tr_b16 a[26:27], v8 offset:2048
  ds_read_b64_tr_b16 a[28:29], v8 offset:8192
  ds_read_b64_tr_b16 a[30:31], v8 offset:10240
  ds_read_b64_tr_b16 a[184:185], v8 offset:256
  ds_read_b64_tr_b16 a[186:187], v8 offset:2304
  ds_read_b64_tr_b16 a[188:189], v8 offset:8448
  ds_read_b64_tr_b16 a[190:191], v8 offset:10496
  s_waitcnt lgkmcnt(0)
  s_waitcnt vmcnt(20)
  s_barrier
  s_lshl_b32 s29, s21, 10
  s_add_u32 m0, s29, 49152
  s_mov_b32 s28, 3932160
  buffer_load_dwordx4 v5, s[12:15], s28 offen lds
  s_lshl_b32 s29, s21, 10
  s_add_u32 m0, s29, 53248
  s_mov_b32 s28, 4030464
  buffer_load_dwordx4 v5, s[12:15], s28 offen lds
  s_lshl_b32 s29, s21, 10
  s_add_u32 m0, s29, 57344
  s_mov_b32 s28, 4128768
  buffer_load_dwordx4 v5, s[12:15], s28 offen lds
  s_lshl_b32 s29, s21, 10
  s_add_u32 m0, s29, 61440
  s_mov_b32 s28, 4227072
  buffer_load_dwordx4 v5, s[12:15], s28 offen lds
  v_add_u32 v8, 65536, v7
  ds_read_b64_tr_b16 a[32:33], v8 offset:0
  ds_read_b64_tr_b16 a[34:35], v8 offset:2048
  ds_read_b64_tr_b16 a[36:37], v8 offset:8192
  ds_read_b64_tr_b16 a[38:39], v8 offset:10240
  ds_read_b64_tr_b16 a[192:193], v8 offset:256
  ds_read_b64_tr_b16 a[194:195], v8 offset:2304
  ds_read_b64_tr_b16 a[196:197], v8 offset:8448
  ds_read_b64_tr_b16 a[198:199], v8 offset:10496
  s_waitcnt lgkmcnt(0)
  s_waitcnt vmcnt(20)
  s_barrier
  s_lshl_b32 s29, s21, 10
  s_add_u32 m0, s29, 65536
  s_mov_b32 s28, 4325376
  buffer_load_dwordx4 v5, s[12:15], s28 offen lds
  s_lshl_b32 s29, s21, 10
  s_add_u32 m0, s29, 69632
  s_mov_b32 s28, 4423680
  buffer_load_dwordx4 v5, s[12:15], s28 offen lds
  s_lshl_b32 s29, s21, 10
  s_add_u32 m0, s29, 73728
  s_mov_b32 s28, 4521984
  buffer_load_dwordx4 v5, s[12:15], s28 offen lds
  s_lshl_b32 s29, s21, 10
  s_add_u32 m0, s29, 77824
  s_mov_b32 s28, 4620288
  buffer_load_dwordx4 v5, s[12:15], s28 offen lds
  v_add_u32 v8, 81920, v7
  ds_read_b64_tr_b16 a[40:41], v8 offset:0
  ds_read_b64_tr_b16 a[42:43], v8 offset:2048
  ds_read_b64_tr_b16 a[44:45], v8 offset:8192
  ds_read_b64_tr_b16 a[46:47], v8 offset:10240
  ds_read_b64_tr_b16 a[200:201], v8 offset:256
  ds_read_b64_tr_b16 a[202:203], v8 offset:2304
  ds_read_b64_tr_b16 a[204:205], v8 offset:8448
  ds_read_b64_tr_b16 a[206:207], v8 offset:10496
  s_waitcnt lgkmcnt(0)
  s_waitcnt vmcnt(20)
  s_barrier
  s_lshl_b32 s29, s21, 10
  s_add_u32 m0, s29, 81920
  s_mov_b32 s28, 4718592
  buffer_load_dwordx4 v5, s[12:15], s28 offen lds
  s_lshl_b32 s29, s21, 10
  s_add_u32 m0, s29, 86016
  s_mov_b32 s28, 4816896
  buffer_load_dwordx4 v5, s[12:15], s28 offen lds
  s_lshl_b32 s29, s21, 10
  s_add_u32 m0, s29, 90112
  s_mov_b32 s28, 4915200
  buffer_load_dwordx4 v5, s[12:15], s28 offen lds
  s_lshl_b32 s29, s21, 10
  s_add_u32 m0, s29, 94208
  s_mov_b32 s28, 5013504
  buffer_load_dwordx4 v5, s[12:15], s28 offen lds
  buffer_load_dword v13, v15, s[8:11], 0 offen sc1
  v_add_u32 v8, 98304, v7
  ds_read_b64_tr_b16 a[48:49], v8 offset:0
  ds_read_b64_tr_b16 a[50:51], v8 offset:2048
  ds_read_b64_tr_b16 a[52:53], v8 offset:8192
  ds_read_b64_tr_b16 a[54:55], v8 offset:10240
  ds_read_b64_tr_b16 a[208:209], v8 offset:256
  ds_read_b64_tr_b16 a[210:211], v8 offset:2304
  ds_read_b64_tr_b16 a[212:213], v8 offset:8448
  ds_read_b64_tr_b16 a[214:215], v8 offset:10496
  s_waitcnt lgkmcnt(0)
  s_waitcnt vmcnt(21)
  s_barrier
  s_lshl_b32 s29, s21, 10
  s_add_u32 m0, s29, 98304
  s_mov_b32 s28, 5111808
  buffer_load_dwordx4 v5, s[12:15], s28 offen lds
  s_lshl_b32 s29, s21, 10
  s_add_u32 m0, s29, 102400
  s_mov_b32 s28, 5210112
  buffer_load_dwordx4 v5, s[12:15], s28 offen lds
  s_lshl_b32 s29, s21, 10
  s_add_u32 m0, s29, 106496
  s_mov_b32 s28, 5308416
  buffer_load_dwordx4 v5, s[12:15], s28 offen lds
  s_lshl_b32 s29, s21, 10
  s_add_u32 m0, s29, 110592
  s_mov_b32 s28, 5406720
  buffer_load_dwordx4 v5, s[12:15], s28 offen lds
  v_add_u32 v8, 0, v7
  ds_read_b64_tr_b16 a[56:57], v8 offset:0
  ds_read_b64_tr_b16 a[58:59], v8 offset:2048
  ds_read_b64_tr_b16 a[60:61], v8 offset:8192
  ds_read_b64_tr_b16 a[62:63], v8 offset:10240
  ds_read_b64_tr_b16 a[216:217], v8 offset:256
  ds_read_b64_tr_b16 a[218:219], v8 offset:2304
  ds_read_b64_tr_b16 a[220:221], v8 offset:8448
  ds_read_b64_tr_b16 a[222:223], v8 offset:10496
  s_waitcnt lgkmcnt(0)
  s_waitcnt vmcnt(21)
  s_barrier
  s_lshl_b32 s29, s21, 10
  s_add_u32 m0, s29, 0
  s_mov_b32 s28, 5505024
  buffer_load_dwordx4 v5, s[12:15], s28 offen lds
  s_lshl_b32 s29, s21, 10
  s_add_u32 m0, s29, 4096
  s_mov_b32 s28, 5603328
  buffer_load_dwordx4 v5, s[12:15], s28 offen lds
  s_lshl_b32 s29, s21, 10
  s_add_u32 m0, s29, 8192
  s_mov_b32 s28, 5701632
  buffer_load_dwordx4 v5, s[12:15], s28 offen lds
  s_lshl_b32 s29, s21, 10
  s_add_u32 m0, s29, 12288
  s_mov_b32 s28, 5799936
  buffer_load_dwordx4 v5, s[12:15], s28 offen lds
  v_add_u32 v8, 16384, v7
  ds_read_b64_tr_b16 a[64:65], v8 offset:0
  ds_read_b64_tr_b16 a[66:67], v8 offset:2048
  ds_read_b64_tr_b16 a[68:69], v8 offset:8192
  ds_read_b64_tr_b16 a[70:71], v8 offset:10240
  ds_read_b64_tr_b16 a[224:225], v8 offset:256
  ds_read_b64_tr_b16 a[226:227], v8 offset:2304
  ds_read_b64_tr_b16 a[228:229], v8 offset:8448
  ds_read_b64_tr_b16 a[230:231], v8 offset:10496
  s_waitcnt lgkmcnt(0)
  s_waitcnt vmcnt(21)
  s_barrier
  s_lshl_b32 s29, s21, 10
  s_add_u32 m0, s29, 16384
  s_mov_b32 s28, 5898240
  buffer_load_dwordx4 v5, s[12:15], s28 offen lds
  s_lshl_b32 s29, s21, 10
  s_add_u32 m0, s29, 20480
  s_mov_b32 s28, 5996544
  buffer_load_dwordx4 v5, s[12:15], s28 offen lds
  s_lshl_b32 s29, s21, 10
  s_add_u32 m0, s29, 24576
  s_mov_b32 s28, 6094848
  buffer_load_dwordx4 v5, s[12:15], s28 offen lds
  s_lshl_b32 s29, s21, 10
  s_add_u32 m0, s29, 28672
  s_mov_b32 s28, 6193152
  buffer_load_dwordx4 v5, s[12:15], s28 offen lds
  v_add_u32 v8, 32768, v7
  ds_read_b64_tr_b16 a[72:73], v8 offset:0
  ds_read_b64_tr_b16 a[74:75], v8 offset:2048
  ds_read_b64_tr_b16 a[76:77], v8 offset:8192
  ds_read_b64_tr_b16 a[78:79], v8 offset:10240
  ds_read_b64_tr_b16 a[232:233], v8 offset:256
  ds_read_b64_tr_b16 a[234:235], v8 offset:2304
  ds_read_b64_tr_b16 a[236:237], v8 offset:8448
  ds_read_b64_tr_b16 a[238:239], v8 offset:10496
  s_waitcnt lgkmcnt(0)
  s_waitcnt vmcnt(21)
  s_barrier
  s_lshl_b32 s29, s21, 10
  s_add_u32 m0, s29, 32768
  s_mov_b32 s28, 6291456
  buffer_load_dwordx4 v5, s[12:15], s28 offen lds
  s_lshl_b32 s29, s21, 10
  s_add_u32 m0, s29, 36864
  s_mov_b32 s28, 6389760
  buffer_load_dwordx4 v5, s[12:15], s28 offen lds
  s_lshl_b32 s29, s21, 10
  s_add_u32 m0, s29, 40960
  s_mov_b32 s28, 6488064
  buffer_load_dwordx4 v5, s[12:15], s28 offen lds
  s_lshl_b32 s29, s21, 10
  s_add_u32 m0, s29, 45056
  s_mov_b32 s28, 6586368
  buffer_load_dwordx4 v5, s[12:15], s28 offen lds
  v_add_u32 v8, 49152, v7
  ds_read_b64_tr_b16 a[80:81], v8 offset:0
  ds_read_b64_tr_b16 a[82:83], v8 offset:2048
  ds_read_b64_tr_b16 a[84:85], v8 offset:8192
  ds_read_b64_tr_b16 a[86:87], v8 offset:10240
  ds_read_b64_tr_b16 a[240:241], v8 offset:256
  ds_read_b64_tr_b16 a[242:243], v8 offset:2304
  ds_read_b64_tr_b16 a[244:245], v8 offset:8448
  ds_read_b64_tr_b16 a[246:247], v8 offset:10496
  s_waitcnt lgkmcnt(0)
  s_waitcnt vmcnt(21)
  s_barrier
  s_lshl_b32 s29, s21, 10
  s_add_u32 m0, s29, 49152
  s_mov_b32 s28, 6684672
  buffer_load_dwordx4 v5, s[12:15], s28 offen lds
  s_lshl_b32 s29, s21, 10
  s_add_u32 m0, s29, 53248
  s_mov_b32 s28, 6782976
  buffer_load_dwordx4 v5, s[12:15], s28 offen lds
  s_lshl_b32 s29, s21, 10
  s_add_u32 m0, s29, 57344
  s_mov_b32 s28, 6881280
  buffer_load_dwordx4 v5, s[12:15], s28 offen lds
  s_lshl_b32 s29, s21, 10
  s_add_u32 m0, s29, 61440
  s_mov_b32 s28, 6979584
  buffer_load_dwordx4 v5, s[12:15], s28 offen lds
  v_add_u32 v8, 65536, v7
  ds_read_b64_tr_b16 a[88:89], v8 offset:0
  ds_read_b64_tr_b16 a[90:91], v8 offset:2048
  ds_read_b64_tr_b16 a[92:93], v8 offset:8192
  ds_read_b64_tr_b16 a[94:95], v8 offset:10240
  ds_read_b64_tr_b16 a[248:249], v8 offset:256
  ds_read_b64_tr_b16 a[250:251], v8 offset:2304
  ds_read_b64_tr_b16 a[252:253], v8 offset:8448
  ds_read_b64_tr_b16 a[254:255], v8 offset:10496
  s_waitcnt lgkmcnt(0)
  s_waitcnt vmcnt(21)
  s_barrier
  s_lshl_b32 s29, s21, 10
  s_add_u32 m0, s29, 65536
  s_mov_b32 s28, 7077888
  buffer_load_dwordx4 v5, s[12:15], s28 offen lds
  s_lshl_b32 s29, s21, 10
  s_add_u32 m0, s29, 69632
  s_mov_b32 s28, 7176192
  buffer_load_dwordx4 v5, s[12:15], s28 offen lds
  s_lshl_b32 s29, s21, 10
  s_add_u32 m0, s29, 73728
  s_mov_b32 s28, 7274496
  buffer_load_dwordx4 v5, s[12:15], s28 offen lds
  s_lshl_b32 s29, s21, 10
  s_add_u32 m0, s29, 77824
  s_mov_b32 s28, 7372800
  buffer_load_dwordx4 v5, s[12:15], s28 offen lds
  v_add_u32 v8, 81920, v7
  ds_read_b64_tr_b16 a[96:97], v8 offset:0
  ds_read_b64_tr_b16 a[98:99], v8 offset:2048
  ds_read_b64_tr_b16 a[100:101], v8 offset:8192
  ds_read_b64_tr_b16 a[102:103], v8 offset:10240
  ds_read_b64_tr_b16 v[192:193], v8 offset:256
  ds_read_b64_tr_b16 v[194:195], v8 offset:2304
  ds_read_b64_tr_b16 v[196:197], v8 offset:8448
  ds_read_b64_tr_b16 v[198:199], v8 offset:10496
  s_waitcnt lgkmcnt(0)
  s_waitcnt vmcnt(20)
  v_min_u32_dpp v2, v13, v13 quad_perm:[1,0,3,2] row_mask:0xf bank_mask:0xf
  s_nop 1
  v_min_u32_dpp v3, v2, v2 quad_perm:[2,3,0,1] row_mask:0xf bank_mask:0xf
  s_nop 1
  v_min_u32_dpp v2, v3, v3 row_half_mirror row_mask:0xf bank_mask:0xf
  s_nop 0
  v_readfirstlane_b32 s28, v2
  s_cmp_ge_u32 s28, 32
  s_cbranch_scc1 xw_55_ok
  s_mov_b32 s45, 0
xw_55:
  buffer_load_dword v13, v15, s[8:11], 0 offen sc1
  s_add_u32 s45, s45, 1
  s_waitcnt vmcnt(0)
  v_min_u32_dpp v2, v13, v13 quad_perm:[1,0,3,2] row_mask:0xf bank_mask:0xf
  s_nop 1
  v_min_u32_dpp v3, v2, v2 quad_perm:[2,3,0,1] row_mask:0xf bank_mask:0xf
  s_nop 1
  v_min_u32_dpp v2, v3, v3 row_half_mirror row_mask:0xf bank_mask:0xf
  s_nop 0
  v_readfirstlane_b32 s28, v2
  s_cmp_ge_u32 s28, 32
  s_cbranch_scc1 xw_55_ok
  s_cmp_lt_u32 s45, 400000
  s_cbranch_scc1 xw_55
  s_branch ka_abort
xw_55_ok:
  s_lshl_b32 s29, s21, 10
  s_add_u32 m0, s29, 122880
  s_add_u32 s28, s51, 0
  buffer_load_dwordx4 v6, s[8:11], s28 offen sc1 lds
  s_lshl_b32 s29, s21, 10
  s_add_u32 m0, s29, 126976
  s_add_u32 s28, s51, 4096
  buffer_load_dwordx4 v6, s[8:11], s28 offen sc1 lds
  s_lshl_b32 s29, s21, 10
  s_add_u32 m0, s29, 131072
  s_add_u32 s28, s51, 8192
  buffer_load_dwordx4 v6, s[8:11], s28 offen sc1 lds
  s_lshl_b32 s29, s21, 10
  s_add_u32 m0, s29, 135168
  s_add_u32 s28, s51, 12288
  buffer_load_dwordx4 v6, s[8:11], s28 offen sc1 lds
  s_lshl_b32 s29, s21, 10
  s_add_u32 m0, s29, 139264
  s_add_u32 s28, s51, 16384
  buffer_load_dwordx4 v6, s[8:11], s28 offen sc1 lds
  s_lshl_b32 s29, s21, 10
  s_add_u32 m0, s29, 143360
  s_add_u32 s28, s51, 20480
  buffer_load_dwordx4 v6, s[8:11], s28 offen sc1 lds
  s_lshl_b32 s29, s21, 10
  s_add_u32 m0, s29, 147456
  s_add_u32 s28, s51, 24576
  buffer_load_dwordx4 v6, s[8:11], s28 offen sc1 lds
  s_lshl_b32 s29, s21, 10
  s_add_u32 m0, s29, 151552
  s_add_u32 s28, s51, 28672
  buffer_load_dwordx4 v6, s[8:11], s28 offen sc1 lds
  s_lshl_b32 s29, s21, 10
  s_add_u32 m0, s29, 155648
  s_add_u32 s28, s51, 32768
  buffer_load_dwordx4 v6, s[8:11], s28 offen sc1 lds
  s_lshl_b32 s29, s21, 10
  s_add_u32 m0, s29, 159744
  s_add_u32 s28, s51, 36864
  buffer_load_dwordx4 v6, s[8:11], s28 offen sc1 lds
  s_add_u32 s51, s51, 40960
  s_barrier
  s_lshl_b32 s29, s21, 10
  s_add_u32 m0, s29, 81920
  s_mov_b32 s28, 7471104
  buffer_load_dwordx4 v5, s[12:15], s28 offen lds
  s_lshl_b32 s29, s21, 10
  s_add_u32 m0, s29, 86016
  s_mov_b32 s28, 7569408
  buffer_load_dwordx4 v5, s[12:15], s28 offen lds
  s_lshl_b32 s29, s21, 10
  s_add_u32 m0, s29, 90112
  s_mov_b32 s28, 7667712
  buffer_load_dwordx4 v5, s[12:15], s28 offen lds
  s_lshl_b32 s29, s21, 10
  s_add_u32 m0, s29, 94208
  s_mov_b32 s28, 7766016
  buffer_load_dwordx4 v5, s[12:15], s28 offen lds
  v_add_u32 v8, 98304, v7
  ds_read_b64_tr_b16 a[104:105], v8 offset:0
  ds_read_b64_tr_b16 a[106:107], v8 offset:2048
  ds_read_b64_tr_b16 a[108:109], v8 offset:8192
  ds_read_b64_tr_b16 a[110:111], v8 offset:10240
  ds_read_b64_tr_b16 v[200:201], v8 offset:256
  ds_read_b64_tr_b16 v[202:203], v8 offset:2304
  ds_read_b64_tr_b16 v[204:205], v8 offset:8448
  ds_read_b64_tr_b16 v[206:207], v8 offset:10496
  s_waitcnt lgkmcnt(0)
  s_waitcnt vmcnt(30)
  s_barrier
  v_add_u32 v8, 0, v7
  ds_read_b64_tr_b16 a[112:113], v8 offset:0
  ds_read_b64_tr_b16 a[114:115], v8 offset:2048
  ds_read_b64_tr_b16 a[116:117], v8 offset:8192
  ds_read_b64_tr_b16 a[118:119], v8 offset:10240
  ds_read_b64_tr_b16 v[208:209], v8 offset:256
  ds_read_b64_tr_b16 v[210:211], v8 offset:2304
  ds_read_b64_tr_b16 v[212:213], v8 offset:8448
  ds_read_b64_tr_b16 v[214:215], v8 offset:10496
  s_waitcnt lgkmcnt(0)
  s_waitcnt vmcnt(26)
  s_barrier
  v_add_u32 v8, 16384, v7
  ds_read_b64_tr_b16 a[120:121], v8 offset:0
  ds_read_b64_tr_b16 a[122:123], v8 offset:2048
  ds_read_b64_tr_b16 a[124:125], v8 offset:8192
  ds_read_b64_tr_b16 a[126:127], v8 offset:10240
  ds_read_b64_tr_b16 v[216:217], v8 offset:256
  ds_read_b64_tr_b16 v[218:219], v8 offset:2304
  ds_read_b64_tr_b16 v[220:221], v8 offset:8448
  ds_read_b64_tr_b16 v[222:223], v8 offset:10496
  s_waitcnt lgkmcnt(0)
  s_waitcnt vmcnt(22)
  s_barrier
  v_add_u32 v8, 32768, v7
  ds_read_b64_tr_b16 a[128:129], v8 offset:0
  ds_read_b64_tr_b16 a[130:131], v8 offset:2048
  ds_read_b64_tr_b16 a[132:133], v8 offset:8192
  ds_read_b64_tr_b16 a[134:135], v8 offset:10240
  ds_read_b64_tr_b16 v[224:225], v8 offset:256
  ds_read_b64_tr_b16 v[226:227], v8 offset:2304
  ds_read_b64_tr_b16 v[228:229], v8 offset:8448
  ds_read_b64_tr_b16 v[230:231], v8 offset:10496
  s_waitcnt lgkmcnt(0)
  s_waitcnt vmcnt(18)
  s_barrier
  v_add_u32 v8, 49152, v7
  ds_read_b64_tr_b16 a[136:137], v8 offset:0
  ds_read_b64_tr_b16 a[138:139], v8 offset:2048
  ds_read_b64_tr_b16 a[140:141], v8 offset:8192
  ds_read_b64_tr_b16 a[142:143], v8 offset:10240
  ds_read_b64_tr_b16 v[232:233], v8 offset:256
  ds_read_b64_tr_b16 v[234:235], v8 offset:2304
  ds_read_b64_tr_b16 v[236:237], v8 offset:8448
  ds_read_b64_tr_b16 v[238:239], v8 offset:10496
  s_waitcnt lgkmcnt(0)
  s_waitcnt vmcnt(14)
  s_barrier
  v_add_u32 v8, 65536, v7
  ds_read_b64_tr_b16 a[144:145], v8 offset:0
  ds_read_b64_tr_b16 a[146:147], v8 offset:2048
  ds_read_b64_tr_b16 a[148:149], v8 offset:8192
  ds_read_b64_tr_b16 a[150:151], v8 offset:10240
  ds_read_b64_tr_b16 v[240:241], v8 offset:256
  ds_read_b64_tr_b16 v[242:243], v8 offset:2304
  ds_read_b64_tr_b16 v[244:245], v8 offset:8448
  ds_read_b64_tr_b16 v[246:247], v8 offset:10496
  s_waitcnt lgkmcnt(0)
  s_waitcnt vmcnt(0)
  s_barrier
  v_add_u32 v8, 81920, v7
  ds_read_b64_tr_b16 a[152:153], v8 offset:0
  ds_read_b64_tr_b16 a[154:155], v8 offset:2048
  ds_read_b64_tr_b16 a[156:157], v8 offset:8192
  ds_read_b64_tr_b16 a[158:159], v8 offset:10240
  ds_read_b64_tr_b16 v[248:249], v8 offset:256
  ds_read_b64_tr_b16 v[250:251], v8 offset:2304
  ds_read_b64_tr_b16 v[252:253], v8 offset:8448
  ds_read_b64_tr_b16 v[254:255], v8 offset:10496
  s_waitcnt lgkmcnt(0)
  s_barrier
  v_lshlrev_b32 v5, 4, v1
  v_add_u32 v9, 122880, v5
  v_mov_b32 v10, v5
  v_bfe_u32 v2, v1, 4, 1
  v_lshlrev_b32 v11, 10, v2
  v_and_b32 v2, 15, v1
  v_lshlrev_b32 v2, 4, v2
  v_add_u32 v11, v11, v2
  v_lshrrev_b32 v2, 5, v1
  v_lshlrev_b32 v2, 9, v2
  v_add_u32 v11, v11, v2
  v_mov_b32 v12, s47
  s_mov_b32 s50, 0
ka_qkv_loop:
  s_cmp_eq_u32 s50, 0
  s_cbranch_scc0 q0_56
  s_waitcnt vmcnt(0)
q0_56:
  s_waitcnt vmcnt(4)
  s_barrier
  s_cmp_ge_u32 s50, 63
  s_cbranch_scc1 qn_57_n
  s_lshl_b32 s29, s21, 10
  s_add_u32 m0, s29, 0
  s_add_u32 s28, s51, 0
  buffer_load_dwordx4 v6, s[8:11], s28 offen sc1 lds
  s_lshl_b32 s29, s21, 10
  s_add_u32 m0, s29, 4096
  s_add_u32 s28, s51, 4096
  buffer_load_dwordx4 v6, s[8:11], s28 offen sc1 lds
  s_lshl_b32 s29, s21, 10
  s_add_u32 m0, s29, 8192
  s_add_u32 s28, s51, 8192
  buffer_load_dwordx4 v6, s[8:11], s28 offen sc1 lds
  s_lshl_b32 s29, s21, 10
  s_add_u32 m0, s29, 12288
  s_add_u32 s28, s51, 12288
  buffer_load_dwordx4 v6, s[8:11], s28 offen sc1 lds
  s_lshl_b32 s29, s21, 10
  s_add_u32 m0, s29, 16384
  s_add_u32 s28, s51, 16384
  buffer_load_dwordx4 v6, s[8:11], s28 offen sc1 lds
  s_lshl_b32 s29, s21, 10
  s_add_u32 m0, s29, 20480
  s_add_u32 s28, s51, 20480
  buffer_load_dwordx4 v6, s[8:11], s28 offen sc1 lds
  s_lshl_b32 s29, s21, 10
  s_add_u32 m0, s29, 24576
  s_add_u32 s28, s51, 24576
  buffer_load_dwordx4 v6, s[8:11], s28 offen sc1 lds
  s_lshl_b32 s29, s21, 10
  s_add_u32 m0, s29, 28672
  s_add_u32 s28, s51, 28672
  buffer_load_dwordx4 v6, s[8:11], s28 offen sc1 lds
  s_lshl_b32 s29, s21, 10
  s_add_u32 m0, s29, 32768
  s_add_u32 s28, s51, 32768
  buffer_load_dwordx4 v6, s[8:11], s28 offen sc1 lds
  s_lshl_b32 s29, s21, 10
  s_add_u32 m0, s29, 36864
  s_add_u32 s28, s51, 36864
  buffer_load_dwordx4 v6, s[8:11], s28 offen sc1 lds
  s_add_u32 s51, s51, 40960
  s_branch qn_57
qn_57_n:
  s_waitcnt vmcnt(0)
qn_57:
  ds_read_b128 v[128:131], v9 offset:0
  ds_read_b128 v[132:135], v9 offset:1024
  ds_read_b128 v[136:139], v9 offset:2048
  ds_read_b128 v[140:143], v9 offset:3072
  s_waitcnt lgkmcnt(3)
  v_mfma_f32_32x32x16_bf16 v[64:79], a[0:3], v[128:131], 0
  v_mfma_f32_32x32x16_bf16 v[80:95], a[160:163], v[128:131], 0
  ds_read_b128 v[128:131], v9 offset:4096
  s_waitcnt lgkmcnt(3)
  v_mfma_f32_32x32x16_bf16 v[64:79], a[4:7], v[132:135], v[64:79]
  v_mfma_f32_32x32x16_bf16 v[80:95], a[164:167], v[132:135], v[80:95]
  ds_read_b128 v[132:135], v9 offset:5120
  s_waitcnt lgkmcnt(3)
  v_mfma_f32_32x32x16_bf16 v[64:79], a[8:11], v[136:139], v[64:79]
  v_mfma_f32_32x32x16_bf16 v[80:95], a[168:171], v[136:139], v[80:95]
  ds_read_b128 v[136:139], v9 offset:6144
  s_waitcnt lgkmcnt(3)
  v_mfma_f32_32x32x16_bf16 v[64:79], a[12:15], v[140:143], v[64:79]
  v_mfma_f32_32x32x16_bf16 v[80:95], a[172:175], v[140:143], v[80:95]
  ds_read_b128 v[140:143], v9 offset:7168
  s_waitcnt lgkmcnt(3)
  v_mfma_f32_32x32x16_bf16 v[64:79], a[16:19], v[128:131], v[64:79]
  v_mfma_f32_32x32x16_bf16 v[80:95], a[176:179], v[128:131], v[80:95]
  ds_read_b128 v[128:131], v9 offset:8192
  s_waitcnt lgkmcnt(3)
  v_mfma_f32_32x32x16_bf16 v[64:79], a[20:23], v[132:135], v[64:79]
  v_mfma_f32_32x32x16_bf16 v[80:95], a[180:183], v[132:135], v[80:95]
  ds_read_b128 v[132:135], v9 offset:9216
  s_waitcnt lgkmcnt(3)
  v_mfma_f32_32x32x16_bf16 v[64:79], a[24:27], v[136:139], v[64:79]
  v_mfma_f32_32x32x16_bf16 v[80:95], a[184:187], v[136:139], v[80:95]
  ds_read_b128 v[136:139], v9 offset:10240
  s_waitcnt lgkmcnt(3)
  v_mfma_f32_32x32x16_bf16 v[64:79], a[28:31], v[140:143], v[64:79]
  v_mfma_f32_32x32x16_bf16 v[80:95], a[188:191], v[140:143], v[80:95]
  ds_read_b128 v[140:143], v9 offset:11264
  s_waitcnt lgkmcnt(3)
  v_mfma_f32_32x32x16_bf16 v[64:79], a[32:35], v[128:131], v[64:79]
  v_mfma_f32_32x32x16_bf16 v[80:95], a[192:195], v[128:131], v[80:95]
  ds_read_b128 v[128:131], v9 offset:12288
  s_waitcnt lgkmcnt(3)
  v_mfma_f32_32x32x16_bf16 v[64:79], a[36:39], v[132:135], v[64:79]
  v_mfma_f32_32x32x16_bf16 v[80:95], a[196:199], v[132:135], v[80:95]
  ds_read_b128 v[132:135], v9 offset:13312
  s_waitcnt lgkmcnt(3)
  v_mfma_f32_32x32x16_bf16 v[64:79], a[40:43], v[136:139], v[64:79]
  v_mfma_f32_32x32x16_bf16 v[80:95], a[200:203], v[136:139], v[80:95]
  ds_read_b128 v[136:139], v9 offset:14336
  s_waitcnt lgkmcnt(3)
  v_mfma_f32_32x32x16_bf16 v[64:79], a[44:47], v[140:143], v[64:79]
  v_mfma_f32_32x32x16_bf16 v[80:95], a[204:207], v[140:143], v[80:95]
  ds_read_b128 v[140:143], v9 offset:15360
  s_waitcnt lgkmcnt(3)
  v_mfma_f32_32x32x16_bf16 v[64:79], a[48:51], v[128:131], v[64:79]
  v_mfma_f32_32x32x16_bf16 v[80:95], a[208:211], v[128:131], v[80:95]
  ds_read_b128 v[128:131], v9 offset:16384
  s_waitcnt lgkmcnt(3)
  v_mfma_f32_32x32x16_bf16 v[64:79], a[52:55], v[132:135], v[64:79]
  v_mfma_f32_32x32x16_bf16 v[80:95], a[212:215], v[132:135], v[80:95]
  ds_read_b128 v[132:135], v9 offset:17408
  s_waitcnt lgkmcnt(3)
  v_mfma_f32_32x32x16_bf16 v[64:79], a[56:59], v[136:139], v[64:79]
  v_mfma_f32_32x32x16_bf16 v[80:95], a[216:219], v[136:139], v[80:95]
  ds_read_b128 v[136:139], v9 offset:18432
  s_waitcnt lgkmcnt(3)
  v_mfma_f32_32x32x16_bf16 v[64:79], a[60:63], v[140:143], v[64:79]
  v_mfma_f32_32x32x16_bf16 v[80:95], a[220:223], v[140:143], v[80:95]
  ds_read_b128 v[140:143], v9 offset:19456
  s_waitcnt lgkmcnt(3)
  v_mfma_f32_32x32x16_bf16 v[64:79], a[64:67], v[128:131], v[64:79]
  v_mfma_f32_32x32x16_bf16 v[80:95], a[224:227], v[128:131], v[80:95]
  ds_read_b128 v[128:131], v9 offset:20480
  s_waitcnt lgkmcnt(3)
  v_mfma_f32_32x32x16_bf16 v[64:79], a[68:71], v[132:135], v[64:79]
  v_mfma_f32_32x32x16_bf16 v[80:95], a[228:231], v[132:135], v[80:95]
  ds_read_b128 v[132:135], v9 offset:21504
  s_waitcnt lgkmcnt(3)
  v_mfma_f32_32x32x16_bf16 v[64:79], a[72:75], v[136:139], v[64:79]
  v_mfma_f32_32x32x16_bf16 v[80:95], a[232:235], v[136:139], v[80:95]
  ds_read_b128 v[136:139], v9 offset:22528
  s_waitcnt lgkmcnt(3)
  v_mfma_f32_32x32x16_bf16 v[64:79], a[76:79], v[140:143], v[64:79]
  v_mfma_f32_32x32x16_bf16 v[80:95], a[236:239], v[140:143], v[80:95]
  ds_read_b128 v[140:143], v9 offset:23552
  s_waitcnt lgkmcnt(3)
  v_mfma_f32_32x32x16_bf16 v[64:79], a[80:83], v[128:131], v[64:79]
  v_mfma_f32_32x32x16_bf16 v[80:95], a[240:243], v[128:131], v[80:95]
  ds_read_b128 v[128:131], v9 offset:24576
  s_waitcnt lgkmcnt(3)
  v_mfma_f32_32x32x16_bf16 v[64:79], a[84:87], v[132:135], v[64:79]
  v_mfma_f32_32x32x16_bf16 v[80:95], a[244:247], v[132:135], v[80:95]
  ds_read_b128 v[132:135], v9 offset:25600
  s_waitcnt lgkmcnt(3)
  v_mfma_f32_32x32x16_bf16 v[64:79], a[88:91], v[136:139], v[64:79]
  v_mfma_f32_32x32x16_bf16 v[80:95], a[248:251], v[136:139], v[80:95]
  ds_read_b128 v[136:139], v9 offset:26624
  s_waitcnt lgkmcnt(3)
  v_mfma_f32_32x32x16_bf16 v[64:79], a[92:95], v[140:143], v[64:79]
  v_mfma_f32_32x32x16_bf16 v[80:95], a[252:255], v[140:143], v[80:95]
  ds_read_b128 v[140:143], v9 offset:27648
  s_waitcnt vmcnt(10)
  s_barrier
  s_cmp_eq_u32 s21, 0
  s_cbranch_scc0 mp_58
  v_mov_b32 v13, s50
  s_mov_b64 s[24:25], exec
  s_mov_b64 exec, 1
  buffer_store_dword v13, v12, s[8:11], 0 offen sc1
  s_mov_b64 exec, s[24:25]
mp_58:
  s_waitcnt lgkmcnt(3)
  v_mfma_f32_32x32x16_bf16 v[64:79], a[96:99], v[128:131], v[64:79]
  v_mfma_f32_32x32x16_bf16 v[80:95], v[192:195], v[128:131], v[80:95]
  ds_read_b128 v[128:131], v9 offset:28672
  s_waitcnt lgkmcnt(3)
  v_mfma_f32_32x32x16_bf16 v[64:79], a[100:103], v[132:135], v[64:79]
  v_mfma_f32_32x32x16_bf16 v[80:95], v[196:199], v[132:135], v[80:95]
  ds_read_b128 v[132:135], v9 offset:29696
  s_waitcnt lgkmcnt(3)
  v_mfma_f32_32x32x16_bf16 v[64:79], a[104:107], v[136:139], v[64:79]
  v_mfma_f32_32x32x16_bf16 v[80:95], v[200:203], v[136:139], v[80:95]
  ds_read_b128 v[136:139], v9 offset:30720
  s_waitcnt lgkmcnt(3)
  v_mfma_f32_32x32x16_bf16 v[64:79], a[108:111], v[140:143], v[64:79]
  v_mfma_f32_32x32x16_bf16 v[80:95], v[204:207], v[140:143], v[80:95]
  ds_read_b128 v[140:143], v9 offset:31744
  s_waitcnt lgkmcnt(3)
  v_mfma_f32_32x32x16_bf16 v[64:79], a[112:115], v[128:131], v[64:79]
  v_mfma_f32_32x32x16_bf16 v[80:95], v[208:211], v[128:131], v[80:95]
  ds_read_b128 v[128:131], v9 offset:32768
  s_waitcnt lgkmcnt(3)
  v_mfma_f32_32x32x16_bf16 v[64:79], a[116:119], v[132:135], v[64:79]
  v_mfma_f32_32x32x16_bf16 v[80:95], v[212:215], v[132:135], v[80:95]
  ds_read_b128 v[132:135], v9 offset:33792
  s_waitcnt lgkmcnt(3)
  v_mfma_f32_32x32x16_bf16 v[64:79], a[120:123], v[136:139], v[64:79]
  v_mfma_f32_32x32x16_bf16 v[80:95], v[216:219], v[136:139], v[80:95]
  ds_read_b128 v[136:139], v9 offset:34816
  s_waitcnt lgkmcnt(3)
  v_mfma_f32_32x32x16_bf16 v[64:79], a[124:127], v[140:143], v[64:79]
  v_mfma_f32_32x32x16_bf16 v[80:95], v[220:223], v[140:143], v[80:95]
  ds_read_b128 v[140:143], v9 offset:35840
  s_waitcnt lgkmcnt(3)
  v_mfma_f32_32x32x16_bf16 v[64:79], a[128:131], v[128:131], v[64:79]
  v_mfma_f32_32x32x16_bf16 v[80:95], v[224:227], v[128:131], v[80:95]
  ds_read_b128 v[128:131], v9 offset:36864
  s_waitcnt lgkmcnt(3)
  v_mfma_f32_32x32x16_bf16 v[64:79], a[132:135], v[132:135], v[64:79]
  v_mfma_f32_32x32x16_bf16 v[80:95], v[228:231], v[132:135], v[80:95]
  ds_read_b128 v[132:135], v9 offset:37888
  s_waitcnt lgkmcnt(3)
  v_mfma_f32_32x32x16_bf16 v[64:79], a[136:139], v[136:139], v[64:79]
  v_mfma_f32_32x32x16_bf16 v[80:95], v[232:235], v[136:139], v[80:95]
  ds_read_b128 v[136:139], v9 offset:38912
  s_waitcnt lgkmcnt(3)
  v_mfma_f32_32x32x16_bf16 v[64:79], a[140:143], v[140:143], v[64:79]
  v_mfma_f32_32x32x16_bf16 v[80:95], v[236:239], v[140:143], v[80:95]
  ds_read_b128 v[140:143], v9 offset:39936
  s_waitcnt lgkmcnt(3)
  v_mfma_f32_32x32x16_bf16 v[64:79], a[144:147], v[128:131], v[64:79]
  v_mfma_f32_32x32x16_bf16 v[80:95], v[240:243], v[128:131], v[80:95]
  s_waitcnt lgkmcnt(2)
  v_mfma_f32_32x32x16_bf16 v[64:79], a[148:151], v[132:135], v[64:79]
  v_mfma_f32_32x32x16_bf16 v[80:95], v[244:247], v[132:135], v[80:95]
  s_waitcnt lgkmcnt(1)
  v_mfma_f32_32x32x16_bf16 v[64:79], a[152:155], v[136:139], v[64:79]
  v_mfma_f32_32x32x16_bf16 v[80:95], v[248:251], v[136:139], v[80:95]
  s_waitcnt lgkmcnt(0)
  v_mfma_f32_32x32x16_bf16 v[64:79], a[156:159], v[140:143], v[64:79]
  v_mfma_f32_32x32x16_bf16 v[80:95], v[252:255], v[140:143], v[80:95]
  s_nop 11
  v_cvt_pk_bf16_f32 v144, v64, v65
  v_cvt_pk_bf16_f32 v145, v66, v67
  v_cvt_pk_bf16_f32 v146, v68, v69
  v_cvt_pk_bf16_f32 v147, v70, v71
  v_cvt_pk_bf16_f32 v148, v72, v73
  v_cvt_pk_bf16_f32 v149, v74, v75
  v_cvt_pk_bf16_f32 v150, v76, v77
  v_cvt_pk_bf16_f32 v151, v78, v79
  v_cvt_pk_bf16_f32 v152, v80, v81
  v_cvt_pk_bf16_f32 v153, v82, v83
  v_cvt_pk_bf16_f32 v154, v84, v85
  v_cvt_pk_bf16_f32 v155, v86, v87
  v_cvt_pk_bf16_f32 v156, v88, v89
  v_cvt_pk_bf16_f32 v157, v90, v91
  v_cvt_pk_bf16_f32 v158, v92, v93
  v_cvt_pk_bf16_f32 v159, v94, v95
  s_mul_i32 s28, s50, 12288
  s_add_u32 s29, s28, s48
  buffer_store_dwordx4 v[144:147], v11, s[8:11], s29 offen offset:0 sc1
  buffer_store_dwordx4 v[148:151], v11, s[8:11], s29 offen offset:256 sc1
  s_add_u32 s29, s28, s49
  buffer_store_dwordx4 v[152:155], v11, s[8:11], s29 offen offset:0 sc1
  buffer_store_dwordx4 v[156:159], v11, s[8:11], s29 offen offset:256 sc1
  s_add_u32 s50, s50, 1
  s_waitcnt vmcnt(4)
  s_barrier
  s_cmp_ge_u32 s50, 63
  s_cbranch_scc1 qn_59_n
  s_lshl_b32 s29, s21, 10
  s_add_u32 m0, s29, 122880
  s_add_u32 s28, s51, 0
  buffer_load_dwordx4 v6, s[8:11], s28 offen sc1 lds
  s_lshl_b32 s29, s21, 10
  s_add_u32 m0, s29, 126976
  s_add_u32 s28, s51, 4096
  buffer_load_dwordx4 v6, s[8:11], s28 offen sc1 lds
  s_lshl_b32 s29, s21, 10
  s_add_u32 m0, s29, 131072
  s_add_u32 s28, s51, 8192
  buffer_load_dwordx4 v6, s[8:11], s28 offen sc1 lds
  s_lshl_b32 s29, s21, 10
  s_add_u32 m0, s29, 135168
  s_add_u32 s28, s51, 12288
  buffer_load_dwordx4 v6, s[8:11], s28 offen sc1 lds
  s_lshl_b32 s29, s21, 10
  s_add_u32 m0, s29, 139264
  s_add_u32 s28, s51, 16384
  buffer_load_dwordx4 v6, s[8:11], s28 offen sc1 lds
  s_lshl_b32 s29, s21, 10
  s_add_u32 m0, s29, 143360
  s_add_u32 s28, s51, 20480
  buffer_load_dwordx4 v6, s[8:11], s28 offen sc1 lds
  s_lshl_b32 s29, s21, 10
  s_add_u32 m0, s29, 147456
  s_add_u32 s28, s51, 24576
  buffer_load_dwordx4 v6, s[8:11], s28 offen sc1 lds
  s_lshl_b32 s29, s21, 10
  s_add_u32 m0, s29, 151552
  s_add_u32 s28, s51, 28672
  buffer_load_dwordx4 v6, s[8:11], s28 offen sc1 lds
  s_lshl_b32 s29, s21, 10
  s_add_u32 m0, s29, 155648
  s_add_u32 s28, s51, 32768
  buffer_load_dwordx4 v6, s[8:11], s28 offen sc1 lds
  s_lshl_b32 s29, s21, 10
  s_add_u32 m0, s29, 159744
  s_add_u32 s28, s51, 36864
  buffer_load_dwordx4 v6, s[8:11], s28 offen sc1 lds
  s_add_u32 s51, s51, 40960
  s_branch qn_59
qn_59_n:
  s_waitcnt vmcnt(0)
qn_59:
  ds_read_b128 v[128:131], v10 offset:0
  ds_read_b128 v[132:135], v10 offset:1024
  ds_read_b128 v[136:139], v10 offset:2048
  ds_read_b128 v[140:143], v10 offset:3072
  s_waitcnt lgkmcnt(3)
  v_mfma_f32_32x32x16_bf16 v[64:79], a[0:3], v[128:131], 0
  v_mfma_f32_32x32x16_bf16 v[80:95], a[160:163], v[128:131], 0
  ds_read_b128 v[128:131], v10 offset:4096
  s_waitcnt lgkmcnt(3)
  v_mfma_f32_32x32x16_bf16 v[64:79], a[4:7], v[132:135], v[64:79]
  v_mfma_f32_32x32x16_bf16 v[80:95], a[164:167], v[132:135], v[80:95]
  ds_read_b128 v[132:135], v10 offset:5120
  s_waitcnt lgkmcnt(3)
  v_mfma_f32_32x32x16_bf16 v[64:79], a[8:11], v[136:139], v[64:79]
  v_mfma_f32_32x32x16_bf16 v[80:95], a[168:171], v[136:139], v[80:95]
  ds_read_b128 v[136:139], v10 offset:6144
  s_waitcnt lgkmcnt(3)
  v_mfma_f32_32x32x16_bf16 v[64:79], a[12:15], v[140:143], v[64:79]
  v_mfma_f32_32x32x16_bf16 v[80:95], a[172:175], v[140:143], v[80:95]
  ds_read_b128 v[140:143], v10 offset:7168
  s_waitcnt lgkmcnt(3)
  v_mfma_f32_32x32x16_bf16 v[64:79], a[16:19], v[128:131], v[64:79]
  v_mfma_f32_32x32x16_bf16 v[80:95], a[176:179], v[128:131], v[80:95]
  ds_read_b128 v[128:131], v10 offset:8192
  s_waitcnt lgkmcnt(3)
  v_mfma_f32_32x32x16_bf16 v[64:79], a[20:23], v[132:135], v[64:79]
  v_mfma_f32_32x32x16_bf16 v[80:95], a[180:183], v[132:135], v[80:95]
  ds_read_b128 v[132:135], v10 offset:9216
  s_waitcnt lgkmcnt(3)
  v_mfma_f32_32x32x16_bf16 v[64:79], a[24:27], v[136:139], v[64:79]
  v_mfma_f32_32x32x16_bf16 v[80:95], a[184:187], v[136:139], v[80:95]
  ds_read_b128 v[136:139], v10 offset:10240
  s_waitcnt lgkmcnt(3)
  v_mfma_f32_32x32x16_bf16 v[64:79], a[28:31], v[140:143], v[64:79]
  v_mfma_f32_32x32x16_bf16 v[80:95], a[188:191], v[140:143], v[80:95]
  ds_read_b128 v[140:143], v10 offset:11264
  s_waitcnt lgkmcnt(3)
  v_mfma_f32_32x32x16_bf16 v[64:79], a[32:35], v[128:131], v[64:79]
  v_mfma_f32_32x32x16_bf16 v[80:95], a[192:195], v[128:131], v[80:95]
  ds_read_b128 v[128:131], v10 offset:12288
  s_waitcnt lgkmcnt(3)
  v_mfma_f32_32x32x16_bf16 v[64:79], a[36:39], v[132:135], v[64:79]
  v_mfma_f32_32x32x16_bf16 v[80:95], a[196:199], v[132:135], v[80:95]
  ds_read_b128 v[132:135], v10 offset:13312
  s_waitcnt lgkmcnt(3)
  v_mfma_f32_32x32x16_bf16 v[64:79], a[40:43], v[136:139], v[64:79]
  v_mfma_f32_32x32x16_bf16 v[80:95], a[200:203], v[136:139], v[80:95]
  ds_read_b128 v[136:139], v10 offset:14336
  s_waitcnt lgkmcnt(3)
  v_mfma_f32_32x32x16_bf16 v[64:79], a[44:47], v[140:143], v[64:79]
  v_mfma_f32_32x32x16_bf16 v[80:95], a[204:207], v[140:143], v[80:95]
  ds_read_b128 v[140:143], v10 offset:15360
  s_waitcnt lgkmcnt(3)
  v_mfma_f32_32x32x16_bf16 v[64:79], a[48:51], v[128:131], v[64:79]
  v_mfma_f32_32x32x16_bf16 v[80:95], a[208:211], v[128:131], v[80:95]
  ds_read_b128 v[128:131], v10 offset:16384
  s_waitcnt lgkmcnt(3)
  v_mfma_f32_32x32x16_bf16 v[64:79], a[52:55], v[132:135], v[64:79]
  v_mfma_f32_32x32x16_bf16 v[80:95], a[212:215], v[132:135], v[80:95]
  ds_read_b128 v[132:135], v10 offset:17408
  s_waitcnt lgkmcnt(3)
  v_mfma_f32_32x32x16_bf16 v[64:79], a[56:59], v[136:139], v[64:79]
  v_mfma_f32_32x32x16_bf16 v[80:95], a[216:219], v[136:139], v[80:95]
  ds_read_b128 v[136:139], v10 offset:18432
  s_waitcnt lgkmcnt(3)
  v_mfma_f32_32x32x16_bf16 v[64:79], a[60:63], v[140:143], v[64:79]
  v_mfma_f32_32x32x16_bf16 v[80:95], a[220:223], v[140:143], v[80:95]
  ds_read_b128 v[140:143], v10 offset:19456
  s_waitcnt lgkmcnt(3)
  v_mfma_f32_32x32x16_bf16 v[64:79], a[64:67], v[128:131], v[64:79]
  v_mfma_f32_32x32x16_bf16 v[80:95], a[224:227], v[128:131], v[80:95]
  ds_read_b128 v[128:131], v10 offset:20480
  s_waitcnt lgkmcnt(3)
  v_mfma_f32_32x32x16_bf16 v[64:79], a[68:71], v[132:135], v[64:79]
  v_mfma_f32_32x32x16_bf16 v[80:95], a[228:231], v[132:135], v[80:95]
  ds_read_b128 v[132:135], v10 offset:21504
  s_waitcnt lgkmcnt(3)
  v_mfma_f32_32x32x16_bf16 v[64:79], a[72:75], v[136:139], v[64:79]
  v_mfma_f32_32x32x16_bf16 v[80:95], a[232:235], v[136:139], v[80:95]
  ds_read_b128 v[136:139], v10 offset:22528
  s_waitcnt lgkmcnt(3)
  v_mfma_f32_32x32x16_bf16 v[64:79], a[76:79], v[140:143], v[64:79]
  v_mfma_f32_32x32x16_bf16 v[80:95], a[236:239], v[140:143], v[80:95]
  ds_read_b128 v[140:143], v10 offset:23552
  s_waitcnt lgkmcnt(3)
  v_mfma_f32_32x32x16_bf16 v[64:79], a[80:83], v[128:131], v[64:79]
  v_mfma_f32_32x32x16_bf16 v[80:95], a[240:243], v[128:131], v[80:95]
  ds_read_b128 v[128:131], v10 offset:24576
  s_waitcnt lgkmcnt(3)
  v_mfma_f32_32x32x16_bf16 v[64:79], a[84:87], v[132:135], v[64:79]
  v_mfma_f32_32x32x16_bf16 v[80:95], a[244:247], v[132:135], v[80:95]
  ds_read_b128 v[132:135], v10 offset:25600
  s_waitcnt lgkmcnt(3)
  v_mfma_f32_32x32x16_bf16 v[64:79], a[88:91], v[136:139], v[64:79]
  v_mfma_f32_32x32x16_bf16 v[80:95], a[248:251], v[136:139], v[80:95]
  ds_read_b128 v[136:139], v10 offset:26624
  s_waitcnt lgkmcnt(3)
  v_mfma_f32_32x32x16_bf16 v[64:79], a[92:95], v[140:143], v[64:79]
  v_mfma_f32_32x32x16_bf16 v[80:95], a[252:255], v[140:143], v[80:95]
  ds_read_b128 v[140:143], v10 offset:27648
  s_waitcnt vmcnt(10)
  s_barrier
  s_cmp_eq_u32 s21, 0
  s_cbranch_scc0 mp_60
  v_mov_b32 v13, s50
  s_mov_b64 s[24:25], exec
  s_mov_b64 exec, 1
  buffer_store_dword v13, v12, s[8:11], 0 offen sc1
  s_mov_b64 exec, s[24:25]
mp_60:
  s_waitcnt lgkmcnt(3)
  v_mfma_f32_32x32x16_bf16 v[64:79], a[96:99], v[128:131], v[64:79]
  v_mfma_f32_32x32x16_bf16 v[80:95], v[192:195], v[128:131], v[80:95]
  ds_read_b128 v[128:131], v10 offset:28672
  s_waitcnt lgkmcnt(3)
  v_mfma_f32_32x32x16_bf16 v[64:79], a[100:103], v[132:135], v[64:79]
  v_mfma_f32_32x32x16_bf16 v[80:95], v[196:199], v[132:135], v[80:95]
  ds_read_b128 v[132:135], v10 offset:29696
  s_waitcnt lgkmcnt(3)
  v_mfma_f32_32x32x16_bf16 v[64:79], a[104:107], v[136:139], v[64:79]
  v_mfma_f32_32x32x16_bf16 v[80:95], v[200:203], v[136:139], v[80:95]
  ds_read_b128 v[136:139], v10 offset:30720
  s_waitcnt lgkmcnt(3)
  v_mfma_f32_32x32x16_bf16 v[64:79], a[108:111], v[140:143], v[64:79]
  v_mfma_f32_32x32x16_bf16 v[80:95], v[204:207], v[140:143], v[80:95]
  ds_read_b128 v[140:143], v10 offset:31744
  s_waitcnt lgkmcnt(3)
  v_mfma_f32_32x32x16_bf16 v[64:79], a[112:115], v[128:131], v[64:79]
  v_mfma_f32_32x32x16_bf16 v[80:95], v[208:211], v[128:131], v[80:95]
  ds_read_b128 v[128:131], v10 offset:32768
  s_waitcnt lgkmcnt(3)
  v_mfma_f32_32x32x16_bf16 v[64:79], a[116:119], v[132:135], v[64:79]
  v_mfma_f32_32x32x16_bf16 v[80:95], v[212:215], v[132:135], v[80:95]
  ds_read_b128 v[132:135], v10 offset:33792
  s_waitcnt lgkmcnt(3)
  v_mfma_f32_32x32x16_bf16 v[64:79], a[120:123], v[136:139], v[64:79]
  v_mfma_f32_32x32x16_bf16 v[80:95], v[216:219], v[136:139], v[80:95]
  ds_read_b128 v[136:139], v10 offset:34816
  s_waitcnt lgkmcnt(3)
  v_mfma_f32_32x32x16_bf16 v[64:79], a[124:127], v[140:143], v[64:79]
  v_mfma_f32_32x32x16_bf16 v[80:95], v[220:223], v[140:143], v[80:95]
  ds_read_b128 v[140:143], v10 offset:35840
  s_waitcnt lgkmcnt(3)
  v_mfma_f32_32x32x16_bf16 v[64:79], a[128:131], v[128:131], v[64:79]
  v_mfma_f32_32x32x16_bf16 v[80:95], v[224:227], v[128:131], v[80:95]
  ds_read_b128 v[128:131], v10 offset:36864
  s_waitcnt lgkmcnt(3)
  v_mfma_f32_32x32x16_bf16 v[64:79], a[132:135], v[132:135], v[64:79]
  v_mfma_f32_32x32x16_bf16 v[80:95], v[228:231], v[132:135], v[80:95]
  ds_read_b128 v[132:135], v10 offset:37888
  s_waitcnt lgkmcnt(3)
  v_mfma_f32_32x32x16_bf16 v[64:79], a[136:139], v[136:139], v[64:79]
  v_mfma_f32_32x32x16_bf16 v[80:95], v[232:235], v[136:139], v[80:95]
  ds_read_b128 v[136:139], v10 offset:38912
  s_waitcnt lgkmcnt(3)
  v_mfma_f32_32x32x16_bf16 v[64:79], a[140:143], v[140:143], v[64:79]
  v_mfma_f32_32x32x16_bf16 v[80:95], v[236:239], v[140:143], v[80:95]
  ds_read_b128 v[140:143], v10 offset:39936
  s_waitcnt lgkmcnt(3)
  v_mfma_f32_32x32x16_bf16 v[64:79], a[144:147], v[128:131], v[64:79]
  v_mfma_f32_32x32x16_bf16 v[80:95], v[240:243], v[128:131], v[80:95]
  s_waitcnt lgkmcnt(2)
  v_mfma_f32_32x32x16_bf16 v[64:79], a[148:151], v[132:135], v[64:79]
  v_mfma_f32_32x32x16_bf16 v[80:95], v[244:247], v[132:135], v[80:95]
  s_waitcnt lgkmcnt(1)
  v_mfma_f32_32x32x16_bf16 v[64:79], a[152:155], v[136:139], v[64:79]
  v_mfma_f32_32x32x16_bf16 v[80:95], v[248:251], v[136:139], v[80:95]
  s_waitcnt lgkmcnt(0)
  v_mfma_f32_32x32x16_bf16 v[64:79], a[156:159], v[140:143], v[64:79]
  v_mfma_f32_32x32x16_bf16 v[80:95], v[252:255], v[140:143], v[80:95]
  s_nop 11
  v_cvt_pk_bf16_f32 v144, v64, v65
  v_cvt_pk_bf16_f32 v145, v66, v67
  v_cvt_pk_bf16_f32 v146, v68, v69
  v_cvt_pk_bf16_f32 v147, v70, v71
  v_cvt_pk_bf16_f32 v148, v72, v73
  v_cvt_pk_bf16_f32 v149, v74, v75
  v_cvt_pk_bf16_f32 v150, v76, v77
  v_cvt_pk_bf16_f32 v151, v78, v79
  v_cvt_pk_bf16_f32 v152, v80, v81
  v_cvt_pk_bf16_f32 v153, v82, v83
  v_cvt_pk_bf16_f32 v154, v84, v85
  v_cvt_pk_bf16_f32 v155, v86, v87
  v_cvt_pk_bf16_f32 v156, v88, v89
  v_cvt_pk_bf16_f32 v157, v90, v91
  v_cvt_pk_bf16_f32 v158, v92, v93
  v_cvt_pk_bf16_f32 v159, v94, v95
  s_mul_i32 s28, s50, 12288
  s_add_u32 s29, s28, s48
  buffer_store_dwordx4 v[144:147], v11, s[8:11], s29 offen offset:0 sc1
  buffer_store_dwordx4 v[148:151], v11, s[8:11], s29 offen offset:256 sc1
  s_add_u32 s29, s28, s49
  buffer_store_dwordx4 v[152:155], v11, s[8:11], s29 offen offset:0 sc1
  buffer_store_dwordx4 v[156:159], v11, s[8:11], s29 offen offset:256 sc1
  s_add_u32 s50, s50, 1
  s_cmp_lt_u32 s50, 64
  s_cbranch_scc1 ka_qkv_loop
  s_waitcnt vmcnt(0)
  s_barrier
  s_cmp_eq_u32 s21, 0
  s_cbranch_scc0 ka_exit
  v_mov_b32 v13, 64
  s_mov_b64 exec, 1
  buffer_store_dword v13, v12, s[8:11], 0 offen sc1
  s_waitcnt vmcnt(0)
  s_branch ka_exit
ka_u:
  s_mov_b32 s12, s42
  s_and_b32 s13, s43, 0xffff
  s_mov_b32 s14, 0x780000
  s_mov_b32 s15, 0x20000
  v_and_b32 v1, 63, v0
  v_lshrrev_b32 v2, 4, v1
  v_bfe_u32 v3, v1, 2, 2
  v_and_b32 v4, 3, v1
  s_lshl_b32 s28, s21, 3
  v_add_u32 v5, s28, v3
  v_mul_u32_u24 v5, 1280, v5
  v_lshlrev_b32 v6, 6, v2
  v_add_u32 v5, v5, v6
  v_lshlrev_b32 v6, 4, v4
  v_add_u32 v5, v5, v6
  v_lshrrev_b32 v6, 1, v2
  v_mul_u32_u24 v7, 20480, v6
  v_lshlrev_b32 v6, 6, v3
  v_add_u32 v7, v7, v6
  v_and_b32 v6, 1, v2
  v_lshlrev_b32 v6, 5, v6
  v_add_u32 v7, v7, v6
  v_lshrrev_b32 v6, 1, v4
  v_lshlrev_b32 v6, 4, v6
  v_add_u32 v7, v7, v6
  v_and_b32 v6, 1, v4
  v_lshlrev_b32 v6, 3, v6
  v_add_u32 v7, v7, v6
  s_mul_i32 s28, s21, 1280
  v_add_u32 v7, s28, v7
  s_mul_i32 s46, s23, 245760
  s_mul_i32 s29, s21, 10240
  s_add_u32 m0, s29, 0
  s_add_u32 s28, s46, 0
  buffer_load_dwordx4 v5, s[12:15], s28 offen lds
  s_mul_i32 s29, s21, 10240
  s_add_u32 m0, s29, 1024
  s_add_u32 s28, s46, 256
  buffer_load_dwordx4 v5, s[12:15], s28 offen lds
  s_mul_i32 s29, s21, 10240
  s_add_u32 m0, s29, 2048
  s_add_u32 s28, s46, 512
  buffer_load_dwordx4 v5, s[12:15], s28 offen lds
  s_mul_i32 s29, s21, 10240
  s_add_u32 m0, s29, 3072
  s_add_u32 s28, s46, 768
  buffer_load_dwordx4 v5, s[12:15], s28 offen lds
  s_mul_i32 s29, s21, 10240
  s_add_u32 m0, s29, 4096
  s_add_u32 s28, s46, 1024
  buffer_load_dwordx4 v5, s[12:15], s28 offen lds
  s_mul_i32 s29, s21, 10240
  s_add_u32 m0, s29, 5120
  s_add_u32 s28, s46, 5120
  buffer_load_dwordx4 v5, s[12:15], s28 offen lds
  s_mul_i32 s29, s21, 10240
  s_add_u32 m0, s29, 6144
  s_add_u32 s28, s46, 5376
  buffer_load_dwordx4 v5, s[12:15], s28 offen lds
  s_mul_i32 s29, s21, 10240
  s_add_u32 m0, s29, 7168
  s_add_u32 s28, s46, 5632
  buffer_load_dwordx4 v5, s[12:15], s28 offen lds
  s_mul_i32 s29, s21, 10240
  s_add_u32 m0, s29, 8192
  s_add_u32 s28, s46, 5888
  buffer_load_dwordx4 v5, s[12:15], s28 offen lds
  s_mul_i32 s29, s21, 10240
  s_add_u32 m0, s29, 9216
  s_add_u32 s28, s46, 6144
  buffer_load_dwordx4 v5, s[12:15], s28 offen lds
  s_mul_i32 s29, s21, 10240
  s_add_u32 m0, s29, 40960
  s_add_u32 s28, s46, 40960
  buffer_load_dwordx4 v5, s[12:15], s28 offen lds
  s_mul_i32 s29, s21, 10240
  s_add_u32 m0, s29, 41984
  s_add_u32 s28, s46, 41216
  buffer_load_dwordx4 v5, s[12:15], s28 offen lds
  s_mul_i32 s29, s21, 10240
  s_add_u32 m0, s29, 43008
  s_add_u32 s28, s46, 41472
  buffer_load_dwordx4 v5, s[12:15], s28 offen lds
  s_mul_i32 s29, s21, 10240
  s_add_u32 m0, s29, 44032
  s_add_u32 s28, s46, 41728
  buffer_load_dwordx4 v5, s[12:15], s28 offen lds
  s_mul_i32 s29, s21, 10240
  s_add_u32 m0, s29, 45056
  s_add_u32 s28, s46, 41984
  buffer_load_dwordx4 v5, s[12:15], s28 offen lds
  s_mul_i32 s29, s21, 10240
  s_add_u32 m0, s29, 46080
  s_add_u32 s28, s46, 46080
  buffer_load_dwordx4 v5, s[12:15], s28 offen lds
  s_mul_i32 s29, s21, 10240
  s_add_u32 m0, s29, 47104
  s_add_u32 s28, s46, 46336
  buffer_load_dwordx4 v5, s[12:15], s28 offen lds
  s_mul_i32 s29, s21, 10240
  s_add_u32 m0, s29, 48128
  s_add_u32 s28, s46, 46592
  buffer_load_dwordx4 v5, s[12:15], s28 offen lds
  s_mul_i32 s29, s21, 10240
  s_add_u32 m0, s29, 49152
  s_add_u32 s28, s46, 46848
  buffer_load_dwordx4 v5, s[12:15], s28 offen lds
  s_mul_i32 s29, s21, 10240
  s_add_u32 m0, s29, 50176
  s_add_u32 s28, s46, 47104
  buffer_load_dwordx4 v5, s[12:15], s28 offen lds
  s_waitcnt vmcnt(10)
  s_cmp_eq_u32 s21, 3
  s_cbranch_scc0 lna_61
  s_mov_b64 s[24:25], exec
  s_mov_b64 exec, 1
  s_and_b32 s45, s2, 7
  s_lshl_b32 s45, s45, 7
  s_add_u32 s45, s45, 10240
  v_mov_b32 v2, s45
  v_mov_b32 v3, 1
  buffer_atomic_add v3, v2, s[8:11], 0 offen
  s_mov_b64 exec, s[24:25]
lna_61:
  s_barrier
  s_mul_i32 s29, s21, 10240
  s_add_u32 m0, s29, 81920
  s_add_u32 s28, s46, 81920
  buffer_load_dwordx4 v5, s[12:15], s28 offen lds
  s_mul_i32 s29, s21, 10240
  s_add_u32 m0, s29, 82944
  s_add_u32 s28, s46, 82176
  buffer_load_dwordx4 v5, s[12:15], s28 offen lds
  s_mul_i32 s29, s21, 10240
  s_add_u32 m0, s29, 83968
  s_add_u32 s28, s46, 82432
  buffer_load_dwordx4 v5, s[12:15], s28 offen lds
  s_mul_i32 s29, s21, 10240
  s_add_u32 m0, s29, 84992
  s_add_u32 s28, s46, 82688
  buffer_load_dwordx4 v5, s[12:15], s28 offen lds
  s_mul_i32 s29, s21, 10240
  s_add_u32 m0, s29, 86016
  s_add_u32 s28, s46, 82944
  buffer_load_dwordx4 v5, s[12:15], s28 offen lds
  s_mul_i32 s29, s21, 10240
  s_add_u32 m0, s29, 87040
  s_add_u32 s28, s46, 87040
  buffer_load_dwordx4 v5, s[12:15], s28 offen lds
  s_mul_i32 s29, s21, 10240
  s_add_u32 m0, s29, 88064
  s_add_u32 s28, s46, 87296
  buffer_load_dwordx4 v5, s[12:15], s28 offen lds
  s_mul_i32 s29, s21, 10240
  s_add_u32 m0, s29, 89088
  s_add_u32 s28, s46, 87552
  buffer_load_dwordx4 v5, s[12:15], s28 offen lds
  s_mul_i32 s29, s21, 10240
  s_add_u32 m0, s29, 90112
  s_add_u32 s28, s46, 87808
  buffer_load_dwordx4 v5, s[12:15], s28 offen lds
  s_mul_i32 s29, s21, 10240
  s_add_u32 m0, s29, 91136
  s_add_u32 s28, s46, 88064
  buffer_load_dwordx4 v5, s[12:15], s28 offen lds
  v_add_u32 v8, 0, v7
  ds_read_b64_tr_b16 a[0:1], v8 offset:0
  ds_read_b64_tr_b16 a[2:3], v8 offset:10240
  ds_read_b64_tr_b16 a[4:5], v8 offset:5120
  ds_read_b64_tr_b16 a[6:7], v8 offset:15360
  ds_read_b64_tr_b16 a[48:49], v8 offset:256
  ds_read_b64_tr_b16 a[50:51], v8 offset:10496
  ds_read_b64_tr_b16 a[52:53], v8 offset:5376
  ds_read_b64_tr_b16 a[54:55], v8 offset:15616
  ds_read_b64_tr_b16 a[96:97], v8 offset:512
  ds_read_b64_tr_b16 a[98:99], v8 offset:10752
  ds_read_b64_tr_b16 a[100:101], v8 offset:5632
  ds_read_b64_tr_b16 a[102:103], v8 offset:15872
  s_waitcnt lgkmcnt(0)
  ds_read_b64_tr_b16 a[144:145], v8 offset:768
  ds_read_b64_tr_b16 a[146:147], v8 offset:11008
  ds_read_b64_tr_b16 a[148:149], v8 offset:5888
  ds_read_b64_tr_b16 a[150:151], v8 offset:16128
  ds_read_b64_tr_b16 a[192:193], v8 offset:1024
  ds_read_b64_tr_b16 a[194:195], v8 offset:11264
  ds_read_b64_tr_b16 a[196:197], v8 offset:6144
  ds_read_b64_tr_b16 a[198:199], v8 offset:16384
  s_waitcnt lgkmcnt(0)
  s_waitcnt vmcnt(10)
  s_barrier
  s_mul_i32 s29, s21, 10240
  s_add_u32 m0, s29, 0
  s_add_u32 s28, s46, 122880
  buffer_load_dwordx4 v5, s[12:15], s28 offen lds
  s_mul_i32 s29, s21, 10240
  s_add_u32 m0, s29, 1024
  s_add_u32 s28, s46, 123136
  buffer_load_dwordx4 v5, s[12:15], s28 offen lds
  s_mul_i32 s29, s21, 10240
  s_add_u32 m0, s29, 2048
  s_add_u32 s28, s46, 123392
  buffer_load_dwordx4 v5, s[12:15], s28 offen lds
  s_mul_i32 s29, s21, 10240
  s_add_u32 m0, s29, 3072
  s_add_u32 s28, s46, 123648
  buffer_load_dwordx4 v5, s[12:15], s28 offen lds
  s_mul_i32 s29, s21, 10240
  s_add_u32 m0, s29, 4096
  s_add_u32 s28, s46, 123904
  buffer_load_dwordx4 v5, s[12:15], s28 offen lds
  s_mul_i32 s29, s21, 10240
  s_add_u32 m0, s29, 5120
  s_add_u32 s28, s46, 128000
  buffer_load_dwordx4 v5, s[12:15], s28 offen lds
  s_mul_i32 s29, s21, 10240
  s_add_u32 m0, s29, 6144
  s_add_u32 s28, s46, 128256
  buffer_load_dwordx4 v5, s[12:15], s28 offen lds
  s_mul_i32 s29, s21, 10240
  s_add_u32 m0, s29, 7168
  s_add_u32 s28, s46, 128512
  buffer_load_dwordx4 v5, s[12:15], s28 offen lds
  s_mul_i32 s29, s21, 10240
  s_add_u32 m0, s29, 8192
  s_add_u32 s28, s46, 128768
  buffer_load_dwordx4 v5, s[12:15], s28 offen lds
  s_mul_i32 s29, s21, 10240
  s_add_u32 m0, s29, 9216
  s_add_u32 s28, s46, 129024
  buffer_load_dwordx4 v5, s[12:15], s28 offen lds
  v_add_u32 v8, 40960, v7
  ds_read_b64_tr_b16 a[8:9], v8 offset:0
  ds_read_b64_tr_b16 a[10:11], v8 offset:10240
  ds_read_b64_tr_b16 a[12:13], v8 offset:5120
  ds_read_b64_tr_b16 a[14:15], v8 offset:15360
  ds_read_b64_tr_b16 a[56:57], v8 offset:256
  ds_read_b64_tr_b16 a[58:59], v8 offset:10496
  ds_read_b64_tr_b16 a[60:61], v8 offset:5376
  ds_read_b64_tr_b16 a[62:63], v8 offset:15616
  ds_read_b64_tr_b16 a[104:105], v8 offset:512
  ds_read_b64_tr_b16 a[106:107], v8 offset:10752
  ds_read_b64_tr_b16 a[108:109], v8 offset:5632
  ds_read_b64_tr_b16 a[110:111], v8 offset:15872
  s_waitcnt lgkmcnt(0)
  ds_read_b64_tr_b16 a[152:153], v8 offset:768
  ds_read_b64_tr_b16 a[154:155], v8 offset:11008
  ds_read_b64_tr_b16 a[156:157], v8 offset:5888
  ds_read_b64_tr_b16 a[158:159], v8 offset:16128
  ds_read_b64_tr_b16 a[200:201], v8 offset:1024
  ds_read_b64_tr_b16 a[202:203], v8 offset:11264
  ds_read_b64_tr_b16 a[204:205], v8 offset:6144
  ds_read_b64_tr_b16 a[206:207], v8 offset:16384
  s_waitcnt lgkmcnt(0)
  s_waitcnt vmcnt(10)
  s_barrier
  s_mul_i32 s29, s21, 10240
  s_add_u32 m0, s29, 40960
  s_add_u32 s28, s46, 163840
  buffer_load_dwordx4 v5, s[12:15], s28 offen lds
  s_mul_i32 s29, s21, 10240
  s_add_u32 m0, s29, 41984
  s_add_u32 s28, s46, 164096
  buffer_load_dwordx4 v5, s[12:15], s28 offen lds
  s_mul_i32 s29, s21, 10240
  s_add_u32 m0, s29, 43008
  s_add_u32 s28, s46, 164352
  buffer_load_dwordx4 v5, s[12:15], s28 offen lds
  s_mul_i32 s29, s21, 10240
  s_add_u32 m0, s29, 44032
  s_add_u32 s28, s46, 164608
  buffer_load_dwordx4 v5, s[12:15], s28 offen lds
  s_mul_i32 s29, s21, 10240
  s_add_u32 m0, s29, 45056
  s_add_u32 s28, s46, 164864
  buffer_load_dwordx4 v5, s[12:15], s28 offen lds
  s_mul_i32 s29, s21, 10240
  s_add_u32 m0, s29, 46080
  s_add_u32 s28, s46, 168960
  buffer_load_dwordx4 v5, s[12:15], s28 offen lds
  s_mul_i32 s29, s21, 10240
  s_add_u32 m0, s29, 47104
  s_add_u32 s28, s46, 169216
  buffer_load_dwordx4 v5, s[12:15], s28 offen lds
  s_mul_i32 s29, s21, 10240
  s_add_u32 m0, s29, 48128
  s_add_u32 s28, s46, 169472
  buffer_load_dwordx4 v5, s[12:15], s28 offen lds
  s_mul_i32 s29, s21, 10240
  s_add_u32 m0, s29, 49152
  s_add_u32 s28, s46, 169728
  buffer_load_dwordx4 v5, s[12:15], s28 offen lds
  s_mul_i32 s29, s21, 10240
  s_add_u32 m0, s29, 50176
  s_add_u32 s28, s46, 169984
  buffer_load_dwordx4 v5, s[12:15], s28 offen lds
  v_add_u32 v8, 81920, v7
  ds_read_b64_tr_b16 a[16:17], v8 offset:0
  ds_read_b64_tr_b16 a[18:19], v8 offset:10240
  ds_read_b64_tr_b16 a[20:21], v8 offset:5120
  ds_read_b64_tr_b16 a[22:23], v8 offset:15360
  ds_read_b64_tr_b16 a[64:65], v8 offset:256
  ds_read_b64_tr_b16 a[66:67], v8 offset:10496
  ds_read_b64_tr_b16 a[68:69], v8 offset:5376
  ds_read_b64_tr_b16 a[70:71], v8 offset:15616
  ds_read_b64_tr_b16 a[112:113], v8 offset:512
  ds_read_b64_tr_b16 a[114:115], v8 offset:10752
  ds_read_b64_tr_b16 a[116:117], v8 offset:5632
  ds_read_b64_tr_b16 a[118:119], v8 offset:15872
  s_waitcnt lgkmcnt(0)
  ds_read_b64_tr_b16 a[160:161], v8 offset:768
  ds_read_b64_tr_b16 a[162:163], v8 offset:11008
  ds_read_b64_tr_b16 a[164:165], v8 offset:5888
  ds_read_b64_tr_b16 a[166:167], v8 offset:16128
  ds_read_b64_tr_b16 a[208:209], v8 offset:1024
  ds_read_b64_tr_b16 a[210:211], v8 offset:11264
  ds_read_b64_tr_b16 a[212:213], v8 offset:6144
  ds_read_b64_tr_b16 a[214:215], v8 offset:16384
  s_waitcnt lgkmcnt(0)
  s_waitcnt vmcnt(10)
  s_barrier
  s_mul_i32 s29, s21, 10240
  s_add_u32 m0, s29, 81920
  s_add_u32 s28, s46, 204800
  buffer_load_dwordx4 v5, s[12:15], s28 offen lds
  s_mul_i32 s29, s21, 10240
  s_add_u32 m0, s29, 82944
  s_add_u32 s28, s46, 205056
  buffer_load_dwordx4 v5, s[12:15], s28 offen lds
  s_mul_i32 s29, s21, 10240
  s_add_u32 m0, s29, 83968
  s_add_u32 s28, s46, 205312
  buffer_load_dwordx4 v5, s[12:15], s28 offen lds
  s_mul_i32 s29, s21, 10240
  s_add_u32 m0, s29, 84992
  s_add_u32 s28, s46, 205568
  buffer_load_dwordx4 v5, s[12:15], s28 offen lds
  s_mul_i32 s29, s21, 10240
  s_add_u32 m0, s29, 86016
  s_add_u32 s28, s46, 205824
  buffer_load_dwordx4 v5, s[12:15], s28 offen lds
  s_mul_i32 s29, s21, 10240
  s_add_u32 m0, s29, 87040
  s_add_u32 s28, s46, 209920
  buffer_load_dwordx4 v5, s[12:15], s28 offen lds
  s_mul_i32 s29, s21, 10240
  s_add_u32 m0, s29, 88064
  s_add_u32 s28, s46, 210176
  buffer_load_dwordx4 v5, s[12:15], s28 offen lds
  s_mul_i32 s29, s21, 10240
  s_add_u32 m0, s29, 89088
  s_add_u32 s28, s46, 210432
  buffer_load_dwordx4 v5, s[12:15], s28 offen lds
  s_mul_i32 s29, s21, 10240
  s_add_u32 m0, s29, 90112
  s_add_u32 s28, s46, 210688
  buffer_load_dwordx4 v5, s[12:15], s28 offen lds
  s_mul_i32 s29, s21, 10240
  s_add_u32 m0, s29, 91136
  s_add_u32 s28, s46, 210944
  buffer_load_dwordx4 v5, s[12:15], s28 offen lds
  v_add_u32 v8, 0, v7
  ds_read_b64_tr_b16 a[24:25], v8 offset:0
  ds_read_b64_tr_b16 a[26:27], v8 offset:10240
  ds_read_b64_tr_b16 a[28:29], v8 offset:5120
  ds_read_b64_tr_b16 a[30:31], v8 offset:15360
  ds_read_b64_tr_b16 a[72:73], v8 offset:256
  ds_read_b64_tr_b16 a[74:75], v8 offset:10496
  ds_read_b64_tr_b16 a[76:77], v8 offset:5376
  ds_read_b64_tr_b16 a[78:79], v8 offset:15616
  ds_read_b64_tr_b16 a[120:121], v8 offset:512
  ds_read_b64_tr_b16 a[122:123], v8 offset:10752
  ds_read_b64_tr_b16 a[124:125], v8 offset:5632
  ds_read_b64_tr_b16 a[126:127], v8 offset:15872
  s_waitcnt lgkmcnt(0)
  ds_read_b64_tr_b16 a[168:169], v8 offset:768
  ds_read_b64_tr_b16 a[170:171], v8 offset:11008
  ds_read_b64_tr_b16 a[172:173], v8 offset:5888
  ds_read_b64_tr_b16 a[174:175], v8 offset:16128
  ds_read_b64_tr_b16 a[216:217], v8 offset:1024
  ds_read_b64_tr_b16 a[218:219], v8 offset:11264
  ds_read_b64_tr_b16 a[220:221], v8 offset:6144
  ds_read_b64_tr_b16 a[222:223], v8 offset:16384
  s_waitcnt lgkmcnt(0)
  s_waitcnt vmcnt(10)
  s_barrier
  v_add_u32 v8, 40960, v7
  ds_read_b64_tr_b16 a[32:33], v8 offset:0
  ds_read_b64_tr_b16 a[34:35], v8 offset:10240
  ds_read_b64_tr_b16 a[36:37], v8 offset:5120
  ds_read_b64_tr_b16 a[38:39], v8 offset:15360
  ds_read_b64_tr_b16 a[80:81], v8 offset:256
  ds_read_b64_tr_b16 a[82:83], v8 offset:10496
  ds_read_b64_tr_b16 a[84:85], v8 offset:5376
  ds_read_b64_tr_b16 a[86:87], v8 offset:15616
  ds_read_b64_tr_b16 a[128:129], v8 offset:512
  ds_read_b64_tr_b16 a[130:131], v8 offset:10752
  ds_read_b64_tr_b16 a[132:133], v8 offset:5632
  ds_read_b64_tr_b16 a[134:135], v8 offset:15872
  s_waitcnt lgkmcnt(0)
  ds_read_b64_tr_b16 a[176:177], v8 offset:768
  ds_read_b64_tr_b16 a[178:179], v8 offset:11008
  ds_read_b64_tr_b16 a[180:181], v8 offset:5888
  ds_read_b64_tr_b16 a[182:183], v8 offset:16128
  ds_read_b64_tr_b16 a[224:225], v8 offset:1024
  ds_read_b64_tr_b16 a[226:227], v8 offset:11264
  ds_read_b64_tr_b16 a[228:229], v8 offset:6144
  ds_read_b64_tr_b16 a[230:231], v8 offset:16384
  s_waitcnt lgkmcnt(0)
  s_waitcnt vmcnt(0)
  s_barrier
  v_add_u32 v8, 81920, v7
  ds_read_b64_tr_b16 a[40:41], v8 offset:0
  ds_read_b64_tr_b16 a[42:43], v8 offset:10240
  ds_read_b64_tr_b16 a[44:45], v8 offset:5120
  ds_read_b64_tr_b16 a[46:47], v8 offset:15360
  ds_read_b64_tr_b16 a[88:89], v8 offset:256
  ds_read_b64_tr_b16 a[90:91], v8 offset:10496
  ds_read_b64_tr_b16 a[92:93], v8 offset:5376
  ds_read_b64_tr_b16 a[94:95], v8 offset:15616
  ds_read_b64_tr_b16 a[136:137], v8 offset:512
  ds_read_b64_tr_b16 a[138:139], v8 offset:10752
  ds_read_b64_tr_b16 a[140:141], v8 offset:5632
  ds_read_b64_tr_b16 a[142:143], v8 offset:15872
  s_waitcnt lgkmcnt(0)
  ds_read_b64_tr_b16 a[184:185], v8 offset:768
  ds_read_b64_tr_b16 a[186:187], v8 offset:11008
  ds_read_b64_tr_b16 a[188:189], v8 offset:5888
  ds_read_b64_tr_b16 a[190:191], v8 offset:16128
  ds_read_b64_tr_b16 a[232:233], v8 offset:1024
  ds_read_b64_tr_b16 a[234:235], v8 offset:11264
  ds_read_b64_tr_b16 a[236:237], v8 offset:6144
  ds_read_b64_tr_b16 a[238:239], v8 offset:16384
  s_waitcnt lgkmcnt(0)
  s_barrier
  v_lshlrev_b32 v5, 4, v1
  s_lshl_b32 s28, s21, 10
  v_add_u32 v6, s28, v5
  v_bfe_u32 v2, v1, 4, 1
  v_lshlrev_b32 v9, 10, v2
  v_and_b32 v2, 15, v1
  v_lshlrev_b32 v2, 4, v2
  v_add_u32 v9, v9, v2
  v_lshrrev_b32 v3, 5, v1
  v_lshlrev_b32 v3, 8, v3
  v_add_u32 v9, v9, v3
  v_add_u32 v10, 12288, v9
  v_bfe_u32 v3, v1, 4, 1
  v_lshlrev_b32 v11, 10, v3
  v_add_u32 v11, v11, v2
  v_lshrrev_b32 v3, 5, v1
  v_lshlrev_b32 v3, 9, v3
  v_add_u32 v11, v11, v3
  s_mul_i32 s28, s23, 6
  s_lshr_b32 s29, s28, 3
  s_add_u32 s28, s28, 5
  s_lshr_b32 s28, s28, 3
  v_and_b32 v2, 1, v1
  v_mov_b32 v12, s29
  v_mov_b32 v13, s28
  v_cmp_eq_u32 vcc, 1, v2
  s_nop 1
  v_cndmask_b32 v12, v12, v13, vcc
  v_lshlrev_b32 v12, 2, v12
  v_add_u32 v12, 2048, v12
  s_lshl_b32 s28, s23, 2
  s_add_u32 s28, s28, 3072
  v_mov_b32 v14, s28
  s_mul_i32 s47, s23, 786432
  s_add_u32 s47, s47, 0x7800000
  s_mul_i32 s48, s23, 40960
  s_mul_i32 s28, s21, 10240
  s_add_u32 s48, s48, s28
  s_add_u32 s48, s48, 0x9000000
  s_mov_b32 s50, 0
  s_mov_b32 s52, 0
  s_mov_b32 s54, 0
  s_mov_b32 s53, 0
  s_cmp_gt_u32 s52, s53
  s_cbranch_scc1 ka_wp_62_ok
  s_mov_b32 s45, 0
ka_wp_62_spin:
  buffer_load_dword v2, v12, s[8:11], 0 offen sc1
  s_add_u32 s45, s45, 1
  s_waitcnt vmcnt(0)
  v_min_u32_dpp v3, v2, v2 quad_perm:[1,0,3,2] row_mask:0xf bank_mask:0xf
  s_nop 1
  v_min_u32_dpp v2, v3, v3 quad_perm:[2,3,0,1] row_mask:0xf bank_mask:0xf
  s_nop 1
  v_min_u32_dpp v3, v2, v2 row_half_mirror row_mask:0xf bank_mask:0xf
  s_nop 1
  v_min_u32_dpp v2, v3, v3 quad_perm:[0,1,2,3] row_mask:0xf bank_mask:0xf
  s_nop 0
  v_readfirstlane_b32 s52, v2
  s_cmp_gt_u32 s52, s53
  s_cbranch_scc1 ka_wp_62_ok
  s_cmp_lt_u32 s45, 400000
  s_cbranch_scc1 ka_wp_62_spin
  s_branch ka_abort
ka_wp_62_ok:
  s_lshl_b32 s29, s21, 10
  s_add_u32 m0, s29, 0
  s_add_u32 s28, s47, 0
  buffer_load_dwordx4 v6, s[8:11], s28 offen sc1 lds
  s_lshl_b32 s29, s21, 10
  s_add_u32 m0, s29, 4096
  s_add_u32 s28, s47, 4096
  buffer_load_dwordx4 v6, s[8:11], s28 offen sc1 lds
  s_lshl_b32 s29, s21, 10
  s_add_u32 m0, s29, 8192
  s_add_u32 s28, s47, 8192
  buffer_load_dwordx4 v6, s[8:11], s28 offen sc1 lds
  s_add_u32 s47, s47, 12288
ka_u_loop:
  s_cmp_eq_u32 s50, 0
  s_cbranch_scc0 u0_63
  s_waitcnt vmcnt(0)
u0_63:
  s_waitcnt vmcnt(10)
  s_cmp_eq_u32 s54, 0
  s_cbranch_scc1 ud_64
  s_waitcnt vmcnt(0)
ud_64:
  s_barrier
  ds_read_b128 v[16:19], v9 offset:0
  ds_read_b128 v[20:23], v9 offset:512
  ds_read_b128 v[24:27], v9 offset:2048
  ds_read_b128 v[28:31], v9 offset:2560
  ds_read_b128 v[32:35], v9 offset:4096
  ds_read_b128 v[36:39], v9 offset:4608
  ds_read_b128 v[40:43], v9 offset:6144
  ds_read_b128 v[44:47], v9 offset:6656
  ds_read_b128 v[48:51], v9 offset:8192
  ds_read_b128 v[52:55], v9 offset:8704
  ds_read_b128 v[56:59], v9 offset:10240
  ds_read_b128 v[60:63], v9 offset:10752
  s_mov_b32 s54, 0
  s_cmp_ge_u32 s50, 63
  s_cbranch_scc1 un_65_n
  s_add_u32 s53, s50, 1
  s_cmp_gt_u32 s52, s53
  s_cbranch_scc1 un_65_go
  buffer_load_dword v2, v12, s[8:11], 0 offen sc1
  s_waitcnt vmcnt(0)
  v_min_u32_dpp v3, v2, v2 quad_perm:[1,0,3,2] row_mask:0xf bank_mask:0xf
  s_nop 0
  v_readfirstlane_b32 s52, v3
  s_cmp_gt_u32 s52, s53
  s_cbranch_scc1 un_65_go2
  s_mov_b32 s54, 1
  s_branch un_65
un_65_go2:
un_65_go:
  s_lshl_b32 s29, s21, 10
  s_add_u32 m0, s29, 12288
  s_add_u32 s28, s47, 0
  buffer_load_dwordx4 v6, s[8:11], s28 offen sc1 lds
  s_lshl_b32 s29, s21, 10
  s_add_u32 m0, s29, 16384
  s_add_u32 s28, s47, 4096
  buffer_load_dwordx4 v6, s[8:11], s28 offen sc1 lds
  s_lshl_b32 s29, s21, 10
  s_add_u32 m0, s29, 20480
  s_add_u32 s28, s47, 8192
  buffer_load_dwordx4 v6, s[8:11], s28 offen sc1 lds
  s_add_u32 s47, s47, 12288
  s_branch un_65
un_65_n:
  s_waitcnt vmcnt(0)
un_65:
  s_mul_i32 s30, s50, 1310720
  s_add_u32 s30, s30, s48
  s_waitcnt lgkmcnt(11)
  v_mfma_f32_32x32x16_bf16 v[64:79], v[16:19], a[0:3], 0
  s_waitcnt lgkmcnt(10)
  v_mfma_f32_32x32x16_bf16 v[64:79], v[20:23], a[4:7], v[64:79]
  s_waitcnt lgkmcnt(9)
  v_mfma_f32_32x32x16_bf16 v[64:79], v[24:27], a[8:11], v[64:79]
  s_waitcnt lgkmcnt(8)
  v_mfma_f32_32x32x16_bf16 v[64:79], v[28:31], a[12:15], v[64:79]
  s_waitcnt lgkmcnt(7)
  v_mfma_f32_32x32x16_bf16 v[64:79], v[32:35], a[16:19], v[64:79]
  s_waitcnt lgkmcnt(6)
  v_mfma_f32_32x32x16_bf16 v[64:79], v[36:39], a[20:23], v[64:79]
  s_waitcnt lgkmcnt(5)
  v_mfma_f32_32x32x16_bf16 v[64:79], v[40:43], a[24:27], v[64:79]
  s_waitcnt lgkmcnt(4)
  v_mfma_f32_32x32x16_bf16 v[64:79], v[44:47], a[28:31], v[64:79]
  s_waitcnt lgkmcnt(3)
  v_mfma_f32_32x32x16_bf16 v[64:79], v[48:51], a[32:35], v[64:79]
  s_waitcnt lgkmcnt(2)
  v_mfma_f32_32x32x16_bf16 v[64:79], v[52:55], a[36:39], v[64:79]
  s_waitcnt lgkmcnt(1)
  v_mfma_f32_32x32x16_bf16 v[64:79], v[56:59], a[40:43], v[64:79]
  s_waitcnt lgkmcnt(0)
  v_mfma_f32_32x32x16_bf16 v[64:79], v[60:63], a[44:47], v[64:79]
  v_mfma_f32_32x32x16_bf16 v[80:95], v[16:19], a[48:51], 0
  v_mfma_f32_32x32x16_bf16 v[80:95], v[20:23], a[52:55], v[80:95]
  v_mfma_f32_32x32x16_bf16 v[80:95], v[24:27], a[56:59], v[80:95]
  v_cvt_pk_bf16_f32 v96, v64, v65
  v_cvt_pk_bf16_f32 v97, v66, v67
  v_mfma_f32_32x32x16_bf16 v[80:95], v[28:31], a[60:63], v[80:95]
  v_cvt_pk_bf16_f32 v98, v68, v69
  v_cvt_pk_bf16_f32 v99, v70, v71
  v_mfma_f32_32x32x16_bf16 v[80:95], v[32:35], a[64:67], v[80:95]
  v_cvt_pk_bf16_f32 v100, v72, v73
  v_cvt_pk_bf16_f32 v101, v74, v75
  v_mfma_f32_32x32x16_bf16 v[80:95], v[36:39], a[68:71], v[80:95]
  v_cvt_pk_bf16_f32 v102, v76, v77
  v_cvt_pk_bf16_f32 v103, v78, v79
  v_mfma_f32_32x32x16_bf16 v[80:95], v[40:43], a[72:75], v[80:95]
  s_add_u32 s29, s30, 0
  buffer_store_dwordx4 v[96:99], v11, s[8:11], s29 offen offset:0 sc1
  v_mfma_f32_32x32x16_bf16 v[80:95], v[44:47], a[76:79], v[80:95]
  buffer_store_dwordx4 v[100:103], v11, s[8:11], s29 offen offset:256 sc1
  v_mfma_f32_32x32x16_bf16 v[80:95], v[48:51], a[80:83], v[80:95]
  v_mfma_f32_32x32x16_bf16 v[80:95], v[52:55], a[84:87], v[80:95]
  v_mfma_f32_32x32x16_bf16 v[80:95], v[56:59], a[88:91], v[80:95]
  v_mfma_f32_32x32x16_bf16 v[80:95], v[60:63], a[92:95], v[80:95]
  v_mfma_f32_32x32x16_bf16 v[64:79], v[16:19], a[96:99], 0
  v_mfma_f32_32x32x16_bf16 v[64:79], v[20:23], a[100:103], v[64:79]
  v_mfma_f32_32x32x16_bf16 v[64:79], v[24:27], a[104:107], v[64:79]
  v_cvt_pk_bf16_f32 v96, v80, v81
  v_cvt_pk_bf16_f32 v97, v82, v83
  v_mfma_f32_32x32x16_bf16 v[64:79], v[28:31], a[108:111], v[64:79]
  v_cvt_pk_bf16_f32 v98, v84, v85
  v_cvt_pk_bf16_f32 v99, v86, v87
  v_mfma_f32_32x32x16_bf16 v[64:79], v[32:35], a[112:115], v[64:79]
  v_cvt_pk_bf16_f32 v100, v88, v89
  v_cvt_pk_bf16_f32 v101, v90, v91
  v_mfma_f32_32x32x16_bf16 v[64:79], v[36:39], a[116:119], v[64:79]
  v_cvt_pk_bf16_f32 v102, v92, v93
  v_cvt_pk_bf16_f32 v103, v94, v95
  v_mfma_f32_32x32x16_bf16 v[64:79], v[40:43], a[120:123], v[64:79]
  s_add_u32 s29, s30, 2048
  buffer_store_dwordx4 v[96:99], v11, s[8:11], s29 offen offset:0 sc1
  v_mfma_f32_32x32x16_bf16 v[64:79], v[44:47], a[124:127], v[64:79]
  buffer_store_dwordx4 v[100:103], v11, s[8:11], s29 offen offset:256 sc1
  v_mfma_f32_32x32x16_bf16 v[64:79], v[48:51], a[128:131], v[64:79]
  v_mfma_f32_32x32x16_bf16 v[64:79], v[52:55], a[132:135], v[64:79]
  v_mfma_f32_32x32x16_bf16 v[64:79], v[56:59], a[136:139], v[64:79]
  v_mfma_f32_32x32x16_bf16 v[64:79], v[60:63], a[140:143], v[64:79]
  s_waitcnt vmcnt(7)
  s_barrier
  s_cmp_eq_u32 s21, 0
  s_cbranch_scc0 mp_66
  v_mov_b32 v13, s50
  s_mov_b64 s[24:25], exec
  s_mov_b64 exec, 1
  buffer_store_dword v13, v14, s[8:11], 0 offen sc1
  s_mov_b64 exec, s[24:25]
mp_66:
  v_mfma_f32_32x32x16_bf16 v[80:95], v[16:19], a[144:147], 0
  v_mfma_f32_32x32x16_bf16 v[80:95], v[20:23], a[148:151], v[80:95]
  v_mfma_f32_32x32x16_bf16 v[80:95], v[24:27], a[152:155], v[80:95]
  v_cvt_pk_bf16_f32 v96, v64, v65
  v_cvt_pk_bf16_f32 v97, v66, v67
  v_mfma_f32_32x32x16_bf16 v[80:95], v[28:31], a[156:159], v[80:95]
  v_cvt_pk_bf16_f32 v98, v68, v69
  v_cvt_pk_bf16_f32 v99, v70, v71
  v_mfma_f32_32x32x16_bf16 v[80:95], v[32:35], a[160:163], v[80:95]
  v_cvt_pk_bf16_f32 v100, v72, v73
  v_cvt_pk_bf16_f32 v101, v74, v75
  v_mfma_f32_32x32x16_bf16 v[80:95], v[36:39], a[164:167], v[80:95]
  v_cvt_pk_bf16_f32 v102, v76, v77
  v_cvt_pk_bf16_f32 v103, v78, v79
  v_mfma_f32_32x32x16_bf16 v[80:95], v[40:43], a[168:171], v[80:95]
  s_add_u32 s29, s30, 4096
  buffer_store_dwordx4 v[96:99], v11, s[8:11], s29 offen offset:0 sc1
  v_mfma_f32_32x32x16_bf16 v[80:95], v[44:47], a[172:175], v[80:95]
  buffer_store_dwordx4 v[100:103], v11, s[8:11], s29 offen offset:256 sc1
  v_mfma_f32_32x32x16_bf16 v[80:95], v[48:51], a[176:179], v[80:95]
  v_mfma_f32_32x32x16_bf16 v[80:95], v[52:55], a[180:183], v[80:95]
  v_mfma_f32_32x32x16_bf16 v[80:95], v[56:59], a[184:187], v[80:95]
  v_mfma_f32_32x32x16_bf16 v[80:95], v[60:63], a[188:191], v[80:95]
  v_mfma_f32_32x32x16_bf16 v[64:79], v[16:19], a[192:195], 0
  v_mfma_f32_32x32x16_bf16 v[64:79], v[20:23], a[196:199], v[64:79]
  v_mfma_f32_32x32x16_bf16 v[64:79], v[24:27], a[200:203], v[64:79]
  v_cvt_pk_bf16_f32 v96, v80, v81
  v_cvt_pk_bf16_f32 v97, v82, v83
  v_mfma_f32_32x32x16_bf16 v[64:79], v[28:31], a[204:207], v[64:79]
  v_cvt_pk_bf16_f32 v98, v84, v85
  v_cvt_pk_bf16_f32 v99, v86, v87
  v_mfma_f32_32x32x16_bf16 v[64:79], v[32:35], a[208:211], v[64:79]
  v_cvt_pk_bf16_f32 v100, v88, v89
  v_cvt_pk_bf16_f32 v101, v90, v91
  v_mfma_f32_32x32x16_bf16 v[64:79], v[36:39], a[212:215], v[64:79]
  v_cvt_pk_bf16_f32 v102, v92, v93
  v_cvt_pk_bf16_f32 v103, v94, v95
  v_mfma_f32_32x32x16_bf16 v[64:79], v[40:43], a[216:219], v[64:79]
  s_add_u32 s29, s30, 6144
  buffer_store_dwordx4 v[96:99], v11, s[8:11], s29 offen offset:0 sc1
  v_mfma_f32_32x32x16_bf16 v[64:79], v[44:47], a[220:223], v[64:79]
  buffer_store_dwordx4 v[100:103], v11, s[8:11], s29 offen offset:256 sc1
  v_mfma_f32_32x32x16_bf16 v[64:79], v[48:51], a[224:227], v[64:79]
  v_mfma_f32_32x32x16_bf16 v[64:79], v[52:55], a[228:231], v[64:79]
  v_mfma_f32_32x32x16_bf16 v[64:79], v[56:59], a[232:235], v[64:79]
  v_mfma_f32_32x32x16_bf16 v[64:79], v[60:63], a[236:239], v[64:79]
  s_nop 11
  v_cvt_pk_bf16_f32 v96, v64, v65
  v_cvt_pk_bf16_f32 v97, v66, v67
  v_cvt_pk_bf16_f32 v98, v68, v69
  v_cvt_pk_bf16_f32 v99, v70, v71
  v_cvt_pk_bf16_f32 v100, v72, v73
  v_cvt_pk_bf16_f32 v101, v74, v75
  v_cvt_pk_bf16_f32 v102, v76, v77
  v_cvt_pk_bf16_f32 v103, v78, v79
  s_add_u32 s29, s30, 8192
  buffer_store_dwordx4 v[96:99], v11, s[8:11], s29 offen offset:0 sc1
  buffer_store_dwordx4 v[100:103], v11, s[8:11], s29 offen offset:256 sc1
  s_cmp_eq_u32 s54, 0
  s_cbranch_scc1 udf_67
  s_cmp_gt_u32 s52, s53
  s_cbranch_scc1 ka_wp_68_ok
  s_mov_b32 s45, 0
ka_wp_68_spin:
  buffer_load_dword v2, v12, s[8:11], 0 offen sc1
  s_add_u32 s45, s45, 1
  s_waitcnt vmcnt(0)
  v_min_u32_dpp v3, v2, v2 quad_perm:[1,0,3,2] row_mask:0xf bank_mask:0xf
  s_nop 1
  v_min_u32_dpp v2, v3, v3 quad_perm:[2,3,0,1] row_mask:0xf bank_mask:0xf
  s_nop 1
  v_min_u32_dpp v3, v2, v2 row_half_mirror row_mask:0xf bank_mask:0xf
  s_nop 1
  v_min_u32_dpp v2, v3, v3 quad_perm:[0,1,2,3] row_mask:0xf bank_mask:0xf
  s_nop 0
  v_readfirstlane_b32 s52, v2
  s_cmp_gt_u32 s52, s53
  s_cbranch_scc1 ka_wp_68_ok
  s_cmp_lt_u32 s45, 400000
  s_cbranch_scc1 ka_wp_68_spin
  s_branch ka_abort
ka_wp_68_ok:
  s_lshl_b32 s29, s21, 10
  s_add_u32 m0, s29, 12288
  s_add_u32 s28, s47, 0
  buffer_load_dwordx4 v6, s[8:11], s28 offen sc1 lds
  s_lshl_b32 s29, s21, 10
  s_add_u32 m0, s29, 16384
  s_add_u32 s28, s47, 4096
  buffer_load_dwordx4 v6, s[8:11], s28 offen sc1 lds
  s_lshl_b32 s29, s21, 10
  s_add_u32 m0, s29, 20480
  s_add_u32 s28, s47, 8192
  buffer_load_dwordx4 v6, s[8:11], s28 offen sc1 lds
  s_add_u32 s47, s47, 12288
udf_67:
  s_add_u32 s50, s50, 1
  s_waitcnt vmcnt(10)
  s_cmp_eq_u32 s54, 0
  s_cbranch_scc1 ud_69
  s_waitcnt vmcnt(0)
ud_69:
  s_barrier
  ds_read_b128 v[16:19], v10 offset:0
  ds_read_b128 v[20:23], v10 offset:512
  ds_read_b128 v[24:27], v10 offset:2048
  ds_read_b128 v[28:31], v10 offset:2560
  ds_read_b128 v[32:35], v10 offset:4096
  ds_read_b128 v[36:39], v10 offset:4608
  ds_read_b128 v[40:43], v10 offset:6144
  ds_read_b128 v[44:47], v10 offset:6656
  ds_read_b128 v[48:51], v10 offset:8192
  ds_read_b128 v[52:55], v10 offset:8704
  ds_read_b128 v[56:59], v10 offset:10240
  ds_read_b128 v[60:63], v10 offset:10752
  s_mov_b32 s54, 0
  s_cmp_ge_u32 s50, 63
  s_cbranch_scc1 un_70_n
  s_add_u32 s53, s50, 1
  s_cmp_gt_u32 s52, s53
  s_cbranch_scc1 un_70_go
  buffer_load_dword v2, v12, s[8:11], 0 offen sc1
  s_waitcnt vmcnt(0)
  v_min_u32_dpp v3, v2, v2 quad_perm:[1,0,3,2] row_mask:0xf bank_mask:0xf
  s_nop 0
  v_readfirstlane_b32 s52, v3
  s_cmp_gt_u32 s52, s53
  s_cbranch_scc1 un_70_go2
  s_mov_b32 s54, 1
  s_branch un_70
un_70_go2:
un_70_go:
  s_lshl_b32 s29, s21, 10
  s_add_u32 m0, s29, 0
  s_add_u32 s28, s47, 0
  buffer_load_dwordx4 v6, s[8:11], s28 offen sc1 lds
  s_lshl_b32 s29, s21, 10
  s_add_u32 m0, s29, 4096
  s_add_u32 s28, s47, 4096
  buffer_load_dwordx4 v6, s[8:11], s28 offen sc1 lds
  s_lshl_b32 s29, s21, 10
  s_add_u32 m0, s29, 8192
  s_add_u32 s28, s47, 8192
  buffer_load_dwordx4 v6, s[8:11], s28 offen sc1 lds
  s_add_u32 s47, s47, 12288
  s_branch un_70
un_70_n:
  s_waitcnt vmcnt(0)
un_70:
  s_mul_i32 s30, s50, 1310720
  s_add_u32 s30, s30, s48
  s_waitcnt lgkmcnt(11)
  v_mfma_f32_32x32x16_bf16 v[64:79], v[16:19], a[0:3], 0
  s_waitcnt lgkmcnt(10)
  v_mfma_f32_32x32x16_bf16 v[64:79], v[20:23], a[4:7], v[64:79]
  s_waitcnt lgkmcnt(9)
  v_mfma_f32_32x32x16_bf16 v[64:79], v[24:27], a[8:11], v[64:79]
  s_waitcnt lgkmcnt(8)
  v_mfma_f32_32x32x16_bf16 v[64:79], v[28:31], a[12:15], v[64:79]
  s_waitcnt lgkmcnt(7)
  v_mfma_f32_32x32x16_bf16 v[64:79], v[32:35], a[16:19], v[64:79]
  s_waitcnt lgkmcnt(6)
  v_mfma_f32_32x32x16_bf16 v[64:79], v[36:39], a[20:23], v[64:79]
  s_waitcnt lgkmcnt(5)
  v_mfma_f32_32x32x16_bf16 v[64:79], v[40:43], a[24:27], v[64:79]
  s_waitcnt lgkmcnt(4)
  v_mfma_f32_32x32x16_bf16 v[64:79], v[44:47], a[28:31], v[64:79]
  s_waitcnt lgkmcnt(3)
  v_mfma_f32_32x32x16_bf16 v[64:79], v[48:51], a[32:35], v[64:79]
  s_waitcnt lgkmcnt(2)
  v_mfma_f32_32x32x16_bf16 v[64:79], v[52:55], a[36:39], v[64:79]
  s_waitcnt lgkmcnt(1)
  v_mfma_f32_32x32x16_bf16 v[64:79], v[56:59], a[40:43], v[64:79]
  s_waitcnt lgkmcnt(0)
  v_mfma_f32_32x32x16_bf16 v[64:79], v[60:63], a[44:47], v[64:79]
  v_mfma_f32_32x32x16_bf16 v[80:95], v[16:19], a[48:51], 0
  v_mfma_f32_32x32x16_bf16 v[80:95], v[20:23], a[52:55], v[80:95]
  v_mfma_f32_32x32x16_bf16 v[80:95], v[24:27], a[56:59], v[80:95]
  v_cvt_pk_bf16_f32 v96, v64, v65
  v_cvt_pk_bf16_f32 v97, v66, v67
  v_mfma_f32_32x32x16_bf16 v[80:95], v[28:31], a[60:63], v[80:95]
  v_cvt_pk_bf16_f32 v98, v68, v69
  v_cvt_pk_bf16_f32 v99, v70, v71
  v_mfma_f32_32x32x16_bf16 v[80:95], v[32:35], a[64:67], v[80:95]
  v_cvt_pk_bf16_f32 v100, v72, v73
  v_cvt_pk_bf16_f32 v101, v74, v75
  v_mfma_f32_32x32x16_bf16 v[80:95], v[36:39], a[68:71], v[80:95]
  v_cvt_pk_bf16_f32 v102, v76, v77
  v_cvt_pk_bf16_f32 v103, v78, v79
  v_mfma_f32_32x32x16_bf16 v[80:95], v[40:43], a[72:75], v[80:95]
  s_add_u32 s29, s30, 0
  buffer_store_dwordx4 v[96:99], v11, s[8:11], s29 offen offset:0 sc1
  v_mfma_f32_32x32x16_bf16 v[80:95], v[44:47], a[76:79], v[80:95]
  buffer_store_dwordx4 v[100:103], v11, s[8:11], s29 offen offset:256 sc1
  v_mfma_f32_32x32x16_bf16 v[80:95], v[48:51], a[80:83], v[80:95]
  v_mfma_f32_32x32x16_bf16 v[80:95], v[52:55], a[84:87], v[80:95]
  v_mfma_f32_32x32x16_bf16 v[80:95], v[56:59], a[88:91], v[80:95]
  v_mfma_f32_32x32x16_bf16 v[80:95], v[60:63], a[92:95], v[80:95]
  v_mfma_f32_32x32x16_bf16 v[64:79], v[16:19], a[96:99], 0
  v_mfma_f32_32x32x16_bf16 v[64:79], v[20:23], a[100:103], v[64:79]
  v_mfma_f32_32x32x16_bf16 v[64:79], v[24:27], a[104:107], v[64:79]
  v_cvt_pk_bf16_f32 v96, v80, v81
  v_cvt_pk_bf16_f32 v97, v82, v83
  v_mfma_f32_32x32x16_bf16 v[64:79], v[28:31], a[108:111], v[64:79]
  v_cvt_pk_bf16_f32 v98, v84, v85
  v_cvt_pk_bf16_f32 v99, v86, v87
  v_mfma_f32_32x32x16_bf16 v[64:79], v[32:35], a[112:115], v[64:79]
  v_cvt_pk_bf16_f32 v100, v88, v89
  v_cvt_pk_bf16_f32 v101, v90, v91
  v_mfma_f32_32x32x16_bf16 v[64:79], v[36:39], a[116:119], v[64:79]
  v_cvt_pk_bf16_f32 v102, v92, v93
  v_cvt_pk_bf16_f32 v103, v94, v95
  v_mfma_f32_32x32x16_bf16 v[64:79], v[40:43], a[120:123], v[64:79]
  s_add_u32 s29, s30, 2048
  buffer_store_dwordx4 v[96:99], v11, s[8:11], s29 offen offset:0 sc1
  v_mfma_f32_32x32x16_bf16 v[64:79], v[44:47], a[124:127], v[64:79]
  buffer_store_dwordx4 v[100:103], v11, s[8:11], s29 offen offset:256 sc1
  v_mfma_f32_32x32x16_bf16 v[64:79], v[48:51], a[128:131], v[64:79]
  v_mfma_f32_32x32x16_bf16 v[64:79], v[52:55], a[132:135], v[64:79]
  v_mfma_f32_32x32x16_bf16 v[64:79], v[56:59], a[136:139], v[64:79]
  v_mfma_f32_32x32x16_bf16 v[64:79], v[60:63], a[140:143], v[64:79]
  s_waitcnt vmcnt(7)
  s_barrier
  s_cmp_eq_u32 s21, 0
  s_cbranch_scc0 mp_71
  v_mov_b32 v13, s50
  s_mov_b64 s[24:25], exec
  s_mov_b64 exec, 1
  buffer_store_dword v13, v14, s[8:11], 0 offen sc1
  s_mov_b64 exec, s[24:25]
mp_71:
  v_mfma_f32_32x32x16_bf16 v[80:95], v[16:19], a[144:147], 0
  v_mfma_f32_32x32x16_bf16 v[80:95], v[20:23], a[148:151], v[80:95]
  v_mfma_f32_32x32x16_bf16 v[80:95], v[24:27], a[152:155], v[80:95]
  v_cvt_pk_bf16_f32 v96, v64, v65
  v_cvt_pk_bf16_f32 v97, v66, v67
  v_mfma_f32_32x32x16_bf16 v[80:95], v[28:31], a[156:159], v[80:95]
  v_cvt_pk_bf16_f32 v98, v68, v69
  v_cvt_pk_bf16_f32 v99, v70, v71
  v_mfma_f32_32x32x16_bf16 v[80:95], v[32:35], a[160:163], v[80:95]
  v_cvt_pk_bf16_f32 v100, v72, v73
  v_cvt_pk_bf16_f32 v101, v74, v75
  v_mfma_f32_32x32x16_bf16 v[80:95], v[36:39], a[164:167], v[80:95]
  v_cvt_pk_bf16_f32 v102, v76, v77
  v_cvt_pk_bf16_f32 v103, v78, v79
  v_mfma_f32_32x32x16_bf16 v[80:95], v[40:43], a[168:171], v[80:95]
  s_add_u32 s29, s30, 4096
  buffer_store_dwordx4 v[96:99], v11, s[8:11], s29 offen offset:0 sc1
  v_mfma_f32_32x32x16_bf16 v[80:95], v[44:47], a[172:175], v[80:95]
  buffer_store_dwordx4 v[100:103], v11, s[8:11], s29 offen offset:256 sc1
  v_mfma_f32_32x32x16_bf16 v[80:95], v[48:51], a[176:179], v[80:95]
  v_mfma_f32_32x32x16_bf16 v[80:95], v[52:55], a[180:183], v[80:95]
  v_mfma_f32_32x32x16_bf16 v[80:95], v[56:59], a[184:187], v[80:95]
  v_mfma_f32_32x32x16_bf16 v[80:95], v[60:63], a[188:191], v[80:95]
  v_mfma_f32_32x32x16_bf16 v[64:79], v[16:19], a[192:195], 0
  v_mfma_f32_32x32x16_bf16 v[64:79], v[20:23], a[196:199], v[64:79]
  v_mfma_f32_32x32x16_bf16 v[64:79], v[24:27], a[200:203], v[64:79]
  v_cvt_pk_bf16_f32 v96, v80, v81
  v_cvt_pk_bf16_f32 v97, v82, v83
  v_mfma_f32_32x32x16_bf16 v[64:79], v[28:31], a[204:207], v[64:79]
  v_cvt_pk_bf16_f32 v98, v84, v85
  v_cvt_pk_bf16_f32 v99, v86, v87
  v_mfma_f32_32x32x16_bf16 v[64:79], v[32:35], a[208:211], v[64:79]
  v_cvt_pk_bf16_f32 v100, v88, v89
  v_cvt_pk_bf16_f32 v101, v90, v91
  v_mfma_f32_32x32x16_bf16 v[64:79], v[36:39], a[212:215], v[64:79]
  v_cvt_pk_bf16_f32 v102, v92, v93
  v_cvt_pk_bf16_f32 v103, v94, v95
  v_mfma_f32_32x32x16_bf16 v[64:79], v[40:43], a[216:219], v[64:79]
  s_add_u32 s29, s30, 6144
  buffer_store_dwordx4 v[96:99], v11, s[8:11], s29 offen offset:0 sc1
  v_mfma_f32_32x32x16_bf16 v[64:79], v[44:47], a[220:223], v[64:79]
  buffer_store_dwordx4 v[100:103], v11, s[8:11], s29 offen offset:256 sc1
  v_mfma_f32_32x32x16_bf16 v[64:79], v[48:51], a[224:227], v[64:79]
  v_mfma_f32_32x32x16_bf16 v[64:79], v[52:55], a[228:231], v[64:79]
  v_mfma_f32_32x32x16_bf16 v[64:79], v[56:59], a[232:235], v[64:79]
  v_mfma_f32_32x32x16_bf16 v[64:79], v[60:63], a[236:239], v[64:79]
  s_nop 11
  v_cvt_pk_bf16_f32 v96, v64, v65
  v_cvt_pk_bf16_f32 v97, v66, v67
  v_cvt_pk_bf16_f32 v98, v68, v69
  v_cvt_pk_bf16_f32 v99, v70, v71
  v_cvt_pk_bf16_f32 v100, v72, v73
  v_cvt_pk_bf16_f32 v101, v74, v75
  v_cvt_pk_bf16_f32 v102, v76, v77
  v_cvt_pk_bf16_f32 v103, v78, v79
  s_add_u32 s29, s30, 8192
  buffer_store_dwordx4 v[96:99], v11, s[8:11], s29 offen offset:0 sc1
  buffer_store_dwordx4 v[100:103], v11, s[8:11], s29 offen offset:256 sc1
  s_cmp_eq_u32 s54, 0
  s_cbranch_scc1 udf_72
  s_cmp_gt_u32 s52, s53
  s_cbranch_scc1 ka_wp_73_ok
  s_mov_b32 s45, 0
ka_wp_73_spin:
  buffer_load_dword v2, v12, s[8:11], 0 offen sc1
  s_add_u32 s45, s45, 1
  s_waitcnt vmcnt(0)
  v_min_u32_dpp v3, v2, v2 quad_perm:[1,0,3,2] row_mask:0xf bank_mask:0xf
  s_nop 1
  v_min_u32_dpp v2, v3, v3 quad_perm:[2,3,0,1] row_mask:0xf bank_mask:0xf
  s_nop 1
  v_min_u32_dpp v3, v2, v2 row_half_mirror row_mask:0xf bank_mask:0xf
  s_nop 1
  v_min_u32_dpp v2, v3, v3 quad_perm:[0,1,2,3] row_mask:0xf bank_mask:0xf
  s_nop 0
  v_readfirstlane_b32 s52, v2
  s_cmp_gt_u32 s52, s53
  s_cbranch_scc1 ka_wp_73_ok
  s_cmp_lt_u32 s45, 400000
  s_cbranch_scc1 ka_wp_73_spin
  s_branch ka_abort
ka_wp_73_ok:
  s_lshl_b32 s29, s21, 10
  s_add_u32 m0, s29, 0
  s_add_u32 s28, s47, 0
  buffer_load_dwordx4 v6, s[8:11], s28 offen sc1 lds
  s_lshl_b32 s29, s21, 10
  s_add_u32 m0, s29, 4096
  s_add_u32 s28, s47, 4096
  buffer_load_dwordx4 v6, s[8:11], s28 offen sc1 lds
  s_lshl_b32 s29, s21, 10
  s_add_u32 m0, s29, 8192
  s_add_u32 s28, s47, 8192
  buffer_load_dwordx4 v6, s[8:11], s28 offen sc1 lds
  s_add_u32 s47, s47, 12288
udf_72:
  s_add_u32 s50, s50, 1
  s_cmp_lt_u32 s50, 64
  s_cbranch_scc1 ka_u_loop
  s_waitcnt vmcnt(0)
  s_barrier
  s_cmp_eq_u32 s21, 0
  s_cbranch_scc0 ka_exit
  v_mov_b32 v13, 64
  s_mov_b64 exec, 1
  buffer_store_dword v13, v14, s[8:11], 0 offen sc1
  s_waitcnt vmcnt(0)
  s_branch ka_exit
.macro CHAINROLES sfx, pol
ka\sfx\()_x:
  s_mov_b32 s12, s36
  s_and_b32 s13, s37, 0xffff
  s_mov_b32 s14, 0x780000
  s_mov_b32 s15, 0x20000
  s_mov_b32 s16, s38
  s_and_b32 s17, s39, 0xffff
  s_mov_b32 s18, 0x780000
  s_mov_b32 s19, 0x20000
  v_and_b32 v1, 63, v0
  v_lshrrev_b32 v2, 4, v1
  v_bfe_u32 v3, v1, 3, 1
  v_bfe_u32 v4, v1, 1, 2
  v_and_b32 v5, 1, v1
  s_mul_i32 s46, s23, 384
  s_lshl_b32 s28, s21, 2
  s_add_u32 s28, s28, 0
  v_add_u32 v6, s28, v2
  v_mul_u32_u24 v7, 43, v6
  v_lshrrev_b32 v7, 9, v7
  v_mul_u32_u24 v8, 12, v7
  v_sub_u32 v8, v6, v8
  v_lshrrev_b32 v9, 1, v7
  v_lshlrev_b32 v9, 4, v9
  v_and_b32 v10, 1, v7
  v_lshlrev_b32 v10, 2, v10
  v_add_u32 v9, v9, v10
  v_lshlrev_b32 v10, 3, v3
  v_add_u32 v9, v9, v10
  v_add_u32 v9, v9, v4
  v_mul_u32_u24 v9, 12288, v9
  v_lshrrev_b32 v10, 1, v8
  v_lshlrev_b32 v10, 2, v10
  v_lshlrev_b32 v11, 1, v5
  v_add_u32 v10, v10, v11
  v_and_b32 v11, 1, v8
  v_add_u32 v10, v10, v11
  v_lshlrev_b32 v10, 4, v10
  v_add_u32 v9, v9, v10
  v_add_u32 v136, s46, v9
  s_lshl_b32 s28, s21, 2
  s_add_u32 s28, s28, 16
  v_add_u32 v6, s28, v2
  v_mul_u32_u24 v7, 43, v6
  v_lshrrev_b32 v7, 9, v7
  v_mul_u32_u24 v8, 12, v7
  v_sub_u32 v8, v6, v8
  v_lshrrev_b32 v9, 1, v7
  v_lshlrev_b32 v9, 4, v9
  v_and_b32 v10, 1, v7
  v_lshlrev_b32 v10, 2, v10
  v_add_u32 v9, v9, v10
  v_lshlrev_b32 v10, 3, v3
  v_add_u32 v9, v9, v10
  v_add_u32 v9, v9, v4
  v_mul_u32_u24 v9, 12288, v9
  v_lshrrev_b32 v10, 1, v8
  v_lshlrev_b32 v10, 2, v10
  v_lshlrev_b32 v11, 1, v5
  v_add_u32 v10, v10, v11
  v_and_b32 v11, 1, v8
  v_add_u32 v10, v10, v11
  v_lshlrev_b32 v10, 4, v10
  v_add_u32 v9, v9, v10
  v_add_u32 v137, s46, v9
  s_lshl_b32 s28, s21, 2
  s_add_u32 s28, s28, 32
  v_add_u32 v6, s28, v2
  v_mul_u32_u24 v7, 43, v6
  v_lshrrev_b32 v7, 9, v7
  v_mul_u32_u24 v8, 12, v7
  v_sub_u32 v8, v6, v8
  v_lshrrev_b32 v9, 1, v7
  v_lshlrev_b32 v9, 4, v9
  v_and_b32 v10, 1, v7
  v_lshlrev_b32 v10, 2, v10
  v_add_u32 v9, v9, v10
  v_lshlrev_b32 v10, 3, v3
  v_add_u32 v9, v9, v10
  v_add_u32 v9, v9, v4
  v_mul_u32_u24 v9, 12288, v9
  v_lshrrev_b32 v10, 1, v8
  v_lshlrev_b32 v10, 2, v10
  v_lshlrev_b32 v11, 1, v5
  v_add_u32 v10, v10, v11
  v_and_b32 v11, 1, v8
  v_add_u32 v10, v10, v11
  v_lshlrev_b32 v10, 4, v10
  v_add_u32 v9, v9, v10
  v_add_u32 v138, s46, v9
  s_lshl_b32 s28, s21, 2
  s_add_u32 s28, s28, 48
  v_add_u32 v6, s28, v2
  v_mul_u32_u24 v7, 43, v6
  v_lshrrev_b32 v7, 9, v7
  v_mul_u32_u24 v8, 12, v7
  v_sub_u32 v8, v6, v8
  v_lshrrev_b32 v9, 1, v7
  v_lshlrev_b32 v9, 4, v9
  v_and_b32 v10, 1, v7
  v_lshlrev_b32 v10, 2, v10
  v_add_u32 v9, v9, v10
  v_lshlrev_b32 v10, 3, v3
  v_add_u32 v9, v9, v10
  v_add_u32 v9, v9, v4
  v_mul_u32_u24 v9, 12288, v9
  v_lshrrev_b32 v10, 1, v8
  v_lshlrev_b32 v10, 2, v10
  v_lshlrev_b32 v11, 1, v5
  v_add_u32 v10, v10, v11
  v_and_b32 v11, 1, v8
  v_add_u32 v10, v10, v11
  v_lshlrev_b32 v10, 4, v10
  v_add_u32 v9, v9, v10
  v_add_u32 v139, s46, v9
  s_lshl_b32 s28, s21, 2
  s_add_u32 s28, s28, 64
  v_add_u32 v6, s28, v2
  v_mul_u32_u24 v7, 43, v6
  v_lshrrev_b32 v7, 9, v7
  v_mul_u32_u24 v8, 12, v7
  v_sub_u32 v8, v6, v8
  v_lshrrev_b32 v9, 1, v7
  v_lshlrev_b32 v9, 4, v9
  v_and_b32 v10, 1, v7
  v_lshlrev_b32 v10, 2, v10
  v_add_u32 v9, v9, v10
  v_lshlrev_b32 v10, 3, v3
  v_add_u32 v9, v9, v10
  v_add_u32 v9, v9, v4
  v_mul_u32_u24 v9, 12288, v9
  v_lshrrev_b32 v10, 1, v8
  v_lshlrev_b32 v10, 2, v10
  v_lshlrev_b32 v11, 1, v5
  v_add_u32 v10, v10, v11
  v_and_b32 v11, 1, v8
  v_add_u32 v10, v10, v11
  v_lshlrev_b32 v10, 4, v10
  v_add_u32 v9, v9, v10
  v_add_u32 v140, s46, v9
  s_lshl_b32 s28, s21, 2
  s_add_u32 s28, s28, 80
  v_add_u32 v6, s28, v2
  v_mul_u32_u24 v7, 43, v6
  v_lshrrev_b32 v7, 9, v7
  v_mul_u32_u24 v8, 12, v7
  v_sub_u32 v8, v6, v8
  v_lshrrev_b32 v9, 1, v7
  v_lshlrev_b32 v9, 4, v9
  v_and_b32 v10, 1, v7
  v_lshlrev_b32 v10, 2, v10
  v_add_u32 v9, v9, v10
  v_lshlrev_b32 v10, 3, v3
  v_add_u32 v9, v9, v10
  v_add_u32 v9, v9, v4
  v_mul_u32_u24 v9, 12288, v9
  v_lshrrev_b32 v10, 1, v8
  v_lshlrev_b32 v10, 2, v10
  v_lshlrev_b32 v11, 1, v5
  v_add_u32 v10, v10, v11
  v_and_b32 v11, 1, v8
  v_add_u32 v10, v10, v11
  v_lshlrev_b32 v10, 4, v10
  v_add_u32 v9, v9, v10
  v_add_u32 v141, s46, v9
  v_lshrrev_b32 v6, 1, v2
  v_mul_u32_u24 v142, 6144, v6
  v_and_b32 v6, 1, v2
  v_lshlrev_b32 v6, 7, v6
  v_add_u32 v142, v142, v6
  v_bfe_u32 v6, v1, 2, 2
  v_lshlrev_b32 v6, 5, v6
  v_add_u32 v142, v142, v6
  v_and_b32 v6, 1, v1
  v_lshlrev_b32 v6, 4, v6
  v_add_u32 v142, v142, v6
  v_bfe_u32 v6, v1, 1, 1
  v_lshlrev_b32 v6, 3, v6
  v_add_u32 v142, v142, v6
  s_mul_i32 s28, s21, 768
  v_add_u32 v142, s28, v142
  s_lshl_b32 s29, s21, 10
  s_add_u32 m0, s29, 0
  s_mov_b32 s28, 0
  buffer_load_dwordx4 v136, s[12:15], s28 offen lds
  s_lshl_b32 s29, s21, 10
  s_add_u32 m0, s29, 4096
  s_mov_b32 s28, 0
  buffer_load_dwordx4 v137, s[12:15], s28 offen lds
  s_lshl_b32 s29, s21, 10
  s_add_u32 m0, s29, 8192
  s_mov_b32 s28, 0
  buffer_load_dwordx4 v138, s[12:15], s28 offen lds
  s_lshl_b32 s29, s21, 10
  s_add_u32 m0, s29, 12288
  s_mov_b32 s28, 0
  buffer_load_dwordx4 v139, s[12:15], s28 offen lds
  s_lshl_b32 s29, s21, 10
  s_add_u32 m0, s29, 16384
  s_mov_b32 s28, 0
  buffer_load_dwordx4 v140, s[12:15], s28 offen lds
  s_lshl_b32 s29, s21, 10
  s_add_u32 m0, s29, 20480
  s_mov_b32 s28, 0
  buffer_load_dwordx4 v141, s[12:15], s28 offen lds
  s_lshl_b32 s29, s21, 10
  s_add_u32 m0, s29, 24576
  s_mov_b32 s28, 786432
  buffer_load_dwordx4 v136, s[12:15], s28 offen lds
  s_lshl_b32 s29, s21, 10
  s_add_u32 m0, s29, 28672
  s_mov_b32 s28, 786432
  buffer_load_dwordx4 v137, s[12:15], s28 offen lds
  s_lshl_b32 s29, s21, 10
  s_add_u32 m0, s29, 32768
  s_mov_b32 s28, 786432
  buffer_load_dwordx4 v138, s[12:15], s28 offen lds
  s_lshl_b32 s29, s21, 10
  s_add_u32 m0, s29, 36864
  s_mov_b32 s28, 786432
  buffer_load_dwordx4 v139, s[12:15], s28 offen lds
  s_lshl_b32 s29, s21, 10
  s_add_u32 m0, s29, 40960
  s_mov_b32 s28, 786432
  buffer_load_dwordx4 v140, s[12:15], s28 offen lds
  s_lshl_b32 s29, s21, 10
  s_add_u32 m0, s29, 45056
  s_mov_b32 s28, 786432
  buffer_load_dwordx4 v141, s[12:15], s28 offen lds
  s_lshl_b32 s29, s21, 10
  s_add_u32 m0, s29, 49152
  s_mov_b32 s28, 1572864
  buffer_load_dwordx4 v136, s[12:15], s28 offen lds
  s_lshl_b32 s29, s21, 10
  s_add_u32 m0, s29, 53248
  s_mov_b32 s28, 1572864
  buffer_load_dwordx4 v137, s[12:15], s28 offen lds
  s_lshl_b32 s29, s21, 10
  s_add_u32 m0, s29, 57344
  s_mov_b32 s28, 1572864
  buffer_load_dwordx4 v138, s[12:15], s28 offen lds
  s_lshl_b32 s29, s21, 10
  s_add_u32 m0, s29, 61440
  s_mov_b32 s28, 1572864
  buffer_load_dwordx4 v139, s[12:15], s28 offen lds
  s_lshl_b32 s29, s21, 10
  s_add_u32 m0, s29, 65536
  s_mov_b32 s28, 1572864
  buffer_load_dwordx4 v140, s[12:15], s28 offen lds
  s_lshl_b32 s29, s21, 10
  s_add_u32 m0, s29, 69632
  s_mov_b32 s28, 1572864
  buffer_load_dwordx4 v141, s[12:15], s28 offen lds
  s_lshl_b32 s29, s21, 10
  s_add_u32 m0, s29, 73728
  s_mov_b32 s28, 2359296
  buffer_load_dwordx4 v136, s[12:15], s28 offen lds
  s_lshl_b32 s29, s21, 10
  s_add_u32 m0, s29, 77824
  s_mov_b32 s28, 2359296
  buffer_load_dwordx4 v137, s[12:15], s28 offen lds
  s_lshl_b32 s29, s21, 10
  s_add_u32 m0, s29, 81920
  s_mov_b32 s28, 2359296
  buffer_load_dwordx4 v138, s[12:15], s28 offen lds
  s_lshl_b32 s29, s21, 10
  s_add_u32 m0, s29, 86016
  s_mov_b32 s28, 2359296
  buffer_load_dwordx4 v139, s[12:15], s28 offen lds
  s_lshl_b32 s29, s21, 10
  s_add_u32 m0, s29, 90112
  s_mov_b32 s28, 2359296
  buffer_load_dwordx4 v140, s[12:15], s28 offen lds
  s_lshl_b32 s29, s21, 10
  s_add_u32 m0, s29, 94208
  s_mov_b32 s28, 2359296
  buffer_load_dwordx4 v141, s[12:15], s28 offen lds
  s_lshl_b32 s29, s21, 10
  s_add_u32 m0, s29, 98304
  s_mov_b32 s28, 3145728
  buffer_load_dwordx4 v136, s[12:15], s28 offen lds
  s_lshl_b32 s29, s21, 10
  s_add_u32 m0, s29, 102400
  s_mov_b32 s28, 3145728
  buffer_load_dwordx4 v137, s[12:15], s28 offen lds
  s_lshl_b32 s29, s21, 10
  s_add_u32 m0, s29, 106496
  s_mov_b32 s28, 3145728
  buffer_load_dwordx4 v138, s[12:15], s28 offen lds
  s_lshl_b32 s29, s21, 10
  s_add_u32 m0, s29, 110592
  s_mov_b32 s28, 3145728
  buffer_load_dwordx4 v139, s[12:15], s28 offen lds
  s_lshl_b32 s29, s21, 10
  s_add_u32 m0, s29, 114688
  s_mov_b32 s28, 3145728
  buffer_load_dwordx4 v140, s[12:15], s28 offen lds
  s_lshl_b32 s29, s21, 10
  s_add_u32 m0, s29, 118784
  s_mov_b32 s28, 3145728
  buffer_load_dwordx4 v141, s[12:15], s28 offen lds
  s_waitcnt vmcnt(24)
  s_cmp_eq_u32 s21, 3
  s_cbranch_scc0 lna_74_\sfx\()
  s_mov_b64 s[24:25], exec
  s_mov_b64 exec, 1
  s_and_b32 s45, s2, 7
  s_lshl_b32 s45, s45, 7
  s_add_u32 s45, s45, 10240
  v_mov_b32 v2, s45
  v_mov_b32 v3, 1
  buffer_atomic_add v3, v2, s[8:11], 0 offen
  s_mov_b64 exec, s[24:25]
lna_74_\sfx\():
  s_barrier
  s_lshl_b32 s29, s21, 10
  s_add_u32 m0, s29, 122880
  s_mov_b32 s28, 3932160
  buffer_load_dwordx4 v136, s[12:15], s28 offen lds
  s_lshl_b32 s29, s21, 10
  s_add_u32 m0, s29, 126976
  s_mov_b32 s28, 3932160
  buffer_load_dwordx4 v137, s[12:15], s28 offen lds
  s_lshl_b32 s29, s21, 10
  s_add_u32 m0, s29, 131072
  s_mov_b32 s28, 3932160
  buffer_load_dwordx4 v138, s[12:15], s28 offen lds
  s_lshl_b32 s29, s21, 10
  s_add_u32 m0, s29, 135168
  s_mov_b32 s28, 3932160
  buffer_load_dwordx4 v139, s[12:15], s28 offen lds
  s_lshl_b32 s29, s21, 10
  s_add_u32 m0, s29, 139264
  s_mov_b32 s28, 3932160
  buffer_load_dwordx4 v140, s[12:15], s28 offen lds
  s_lshl_b32 s29, s21, 10
  s_add_u32 m0, s29, 143360
  s_mov_b32 s28, 3932160
  buffer_load_dwordx4 v141, s[12:15], s28 offen lds
  v_add_u32 v143, 0, v142
  ds_read_b64_tr_b16 a[0:1], v143 offset:0
  ds_read_b64_tr_b16 a[2:3], v143 offset:3072
  ds_read_b64_tr_b16 a[4:5], v143 offset:12288
  ds_read_b64_tr_b16 a[6:7], v143 offset:15360
  ds_read_b64_tr_b16 a[80:81], v143 offset:256
  ds_read_b64_tr_b16 a[82:83], v143 offset:3328
  ds_read_b64_tr_b16 a[84:85], v143 offset:12544
  ds_read_b64_tr_b16 a[86:87], v143 offset:15616
  ds_read_b64_tr_b16 a[160:161], v143 offset:512
  ds_read_b64_tr_b16 a[162:163], v143 offset:3584
  ds_read_b64_tr_b16 a[164:165], v143 offset:12800
  ds_read_b64_tr_b16 a[166:167], v143 offset:15872
  s_waitcnt lgkmcnt(0)
  s_waitcnt vmcnt(24)
  s_barrier
  s_lshl_b32 s29, s21, 10
  s_add_u32 m0, s29, 0
  s_mov_b32 s28, 4718592
  buffer_load_dwordx4 v136, s[12:15], s28 offen lds
  s_lshl_b32 s29, s21, 10
  s_add_u32 m0, s29, 4096
  s_mov_b32 s28, 4718592
  buffer_load_dwordx4 v137, s[12:15], s28 offen lds
  s_lshl_b32 s29, s21, 10
  s_add_u32 m0, s29, 8192
  s_mov_b32 s28, 4718592
  buffer_load_dwordx4 v138, s[12:15], s28 offen lds
  s_lshl_b32 s29, s21, 10
  s_add_u32 m0, s29, 12288
  s_mov_b32 s28, 4718592
  buffer_load_dwordx4 v139, s[12:15], s28 offen lds
  s_lshl_b32 s29, s21, 10
  s_add_u32 m0, s29, 16384
  s_mov_b32 s28, 4718592
  buffer_load_dwordx4 v140, s[12:15], s28 offen lds
  s_lshl_b32 s29, s21, 10
  s_add_u32 m0, s29, 20480
  s_mov_b32 s28, 4718592
  buffer_load_dwordx4 v141, s[12:15], s28 offen lds
  v_add_u32 v143, 24576, v142
  ds_read_b64_tr_b16 a[8:9], v143 offset:0
  ds_read_b64_tr_b16 a[10:11], v143 offset:3072
  ds_read_b64_tr_b16 a[12:13], v143 offset:12288
  ds_read_b64_tr_b16 a[14:15], v143 offset:15360
  ds_read_b64_tr_b16 a[88:89], v143 offset:256
  ds_read_b64_tr_b16 a[90:91], v143 offset:3328
  ds_read_b64_tr_b16 a[92:93], v143 offset:12544
  ds_read_b64_tr_b16 a[94:95], v143 offset:15616
  ds_read_b64_tr_b16 a[168:169], v143 offset:512
  ds_read_b64_tr_b16 a[170:171], v143 offset:3584
  ds_read_b64_tr_b16 a[172:173], v143 offset:12800
  ds_read_b64_tr_b16 a[174:175], v143 offset:15872
  s_waitcnt lgkmcnt(0)
  s_waitcnt vmcnt(24)
  s_barrier
  s_lshl_b32 s29, s21, 10
  s_add_u32 m0, s29, 24576
  s_mov_b32 s28, 5505024
  buffer_load_dwordx4 v136, s[12:15], s28 offen lds
  s_lshl_b32 s29, s21, 10
  s_add_u32 m0, s29, 28672
  s_mov_b32 s28, 5505024
  buffer_load_dwordx4 v137, s[12:15], s28 offen lds
  s_lshl_b32 s29, s21, 10
  s_add_u32 m0, s29, 32768
  s_mov_b32 s28, 5505024
  buffer_load_dwordx4 v138, s[12:15], s28 offen lds
  s_lshl_b32 s29, s21, 10
  s_add_u32 m0, s29, 36864
  s_mov_b32 s28, 5505024
  buffer_load_dwordx4 v139, s[12:15], s28 offen lds
  s_lshl_b32 s29, s21, 10
  s_add_u32 m0, s29, 40960
  s_mov_b32 s28, 5505024
  buffer_load_dwordx4 v140, s[12:15], s28 offen lds
  s_lshl_b32 s29, s21, 10
  s_add_u32 m0, s29, 45056
  s_mov_b32 s28, 5505024
  buffer_load_dwordx4 v141, s[12:15], s28 offen lds
  v_add_u32 v143, 49152, v142
  ds_read_b64_tr_b16 a[16:17], v143 offset:0
  ds_read_b64_tr_b16 a[18:19], v143 offset:3072
  ds_read_b64_tr_b16 a[20:21], v143 offset:12288
  ds_read_b64_tr_b16 a[22:23], v143 offset:15360
  ds_read_b64_tr_b16 a[96:97], v143 offset:256
  ds_read_b64_tr_b16 a[98:99], v143 offset:3328
  ds_read_b64_tr_b16 a[100:101], v143 offset:12544
  ds_read_b64_tr_b16 a[102:103], v143 offset:15616
  ds_read_b64_tr_b16 a[176:177], v143 offset:512
  ds_read_b64_tr_b16 a[178:179], v143 offset:3584
  ds_read_b64_tr_b16 a[180:181], v143 offset:12800
  ds_read_b64_tr_b16 a[182:183], v143 offset:15872
  s_waitcnt lgkmcnt(0)
  s_waitcnt vmcnt(24)
  s_barrier
  s_lshl_b32 s29, s21, 10
  s_add_u32 m0, s29, 49152
  s_mov_b32 s28, 6291456
  buffer_load_dwordx4 v136, s[12:15], s28 offen lds
  s_lshl_b32 s29, s21, 10
  s_add_u32 m0, s29, 53248
  s_mov_b32 s28, 6291456
  buffer_load_dwordx4 v137, s[12:15], s28 offen lds
  s_lshl_b32 s29, s21, 10
  s_add_u32 m0, s29, 57344
  s_mov_b32 s28, 6291456
  buffer_load_dwordx4 v138, s[12:15], s28 offen lds
  s_lshl_b32 s29, s21, 10
  s_add_u32 m0, s29, 61440
  s_mov_b32 s28, 6291456
  buffer_load_dwordx4 v139, s[12:15], s28 offen lds
  s_lshl_b32 s29, s21, 10
  s_add_u32 m0, s29, 65536
  s_mov_b32 s28, 6291456
  buffer_load_dwordx4 v140, s[12:15], s28 offen lds
  s_lshl_b32 s29, s21, 10
  s_add_u32 m0, s29, 69632
  s_mov_b32 s28, 6291456
  buffer_load_dwordx4 v141, s[12:15], s28 offen lds
  v_add_u32 v143, 73728, v142
  ds_read_b64_tr_b16 a[24:25], v143 offset:0
  ds_read_b64_tr_b16 a[26:27], v143 offset:3072
  ds_read_b64_tr_b16 a[28:29], v143 offset:12288
  ds_read_b64_tr_b16 a[30:31], v143 offset:15360
  ds_read_b64_tr_b16 a[104:105], v143 offset:256
  ds_read_b64_tr_b16 a[106:107], v143 offset:3328
  ds_read_b64_tr_b16 a[108:109], v143 offset:12544
  ds_read_b64_tr_b16 a[110:111], v143 offset:15616
  ds_read_b64_tr_b16 a[184:185], v143 offset:512
  ds_read_b64_tr_b16 a[186:187], v143 offset:3584
  ds_read_b64_tr_b16 a[188:189], v143 offset:12800
  ds_read_b64_tr_b16 a[190:191], v143 offset:15872
  s_waitcnt lgkmcnt(0)
  s_waitcnt vmcnt(24)
  s_barrier
  s_lshl_b32 s29, s21, 10
  s_add_u32 m0, s29, 73728
  s_mov_b32 s28, 7077888
  buffer_load_dwordx4 v136, s[12:15], s28 offen lds
  s_lshl_b32 s29, s21, 10
  s_add_u32 m0, s29, 77824
  s_mov_b32 s28, 7077888
  buffer_load_dwordx4 v137, s[12:15], s28 offen lds
  s_lshl_b32 s29, s21, 10
  s_add_u32 m0, s29, 81920
  s_mov_b32 s28, 7077888
  buffer_load_dwordx4 v138, s[12:15], s28 offen lds
  s_lshl_b32 s29, s21, 10
  s_add_u32 m0, s29, 86016
  s_mov_b32 s28, 7077888
  buffer_load_dwordx4 v139, s[12:15], s28 offen lds
  s_lshl_b32 s29, s21, 10
  s_add_u32 m0, s29, 90112
  s_mov_b32 s28, 7077888
  buffer_load_dwordx4 v140, s[12:15], s28 offen lds
  s_lshl_b32 s29, s21, 10
  s_add_u32 m0, s29, 94208
  s_mov_b32 s28, 7077888
  buffer_load_dwordx4 v141, s[12:15], s28 offen lds
  v_add_u32 v143, 98304, v142
  ds_read_b64_tr_b16 a[32:33], v143 offset:0
  ds_read_b64_tr_b16 a[34:35], v143 offset:3072
  ds_read_b64_tr_b16 a[36:37], v143 offset:12288
  ds_read_b64_tr_b16 a[38:39], v143 offset:15360
  ds_read_b64_tr_b16 a[112:113], v143 offset:256
  ds_read_b64_tr_b16 a[114:115], v143 offset:3328
  ds_read_b64_tr_b16 a[116:117], v143 offset:12544
  ds_read_b64_tr_b16 a[118:119], v143 offset:15616
  ds_read_b64_tr_b16 a[192:193], v143 offset:512
  ds_read_b64_tr_b16 a[194:195], v143 offset:3584
  ds_read_b64_tr_b16 a[196:197], v143 offset:12800
  ds_read_b64_tr_b16 a[198:199], v143 offset:15872
  s_waitcnt lgkmcnt(0)
  s_waitcnt vmcnt(24)
  s_barrier
  s_lshl_b32 s29, s21, 10
  s_add_u32 m0, s29, 98304
  s_mov_b32 s28, 0
  buffer_load_dwordx4 v136, s[16:19], s28 offen lds
  s_lshl_b32 s29, s21, 10
  s_add_u32 m0, s29, 102400
  s_mov_b32 s28, 0
  buffer_load_dwordx4 v137, s[16:19], s28 offen lds
  s_lshl_b32 s29, s21, 10
  s_add_u32 m0, s29, 106496
  s_mov_b32 s28, 0
  buffer_load_dwordx4 v138, s[16:19], s28 offen lds
  s_lshl_b32 s29, s21, 10
  s_add_u32 m0, s29, 110592
  s_mov_b32 s28, 0
  buffer_load_dwordx4 v139, s[16:19], s28 offen lds
  s_lshl_b32 s29, s21, 10
  s_add_u32 m0, s29, 114688
  s_mov_b32 s28, 0
  buffer_load_dwordx4 v140, s[16:19], s28 offen lds
  s_lshl_b32 s29, s21, 10
  s_add_u32 m0, s29, 118784
  s_mov_b32 s28, 0
  buffer_load_dwordx4 v141, s[16:19], s28 offen lds
  v_add_u32 v143, 122880, v142
  ds_read_b64_tr_b16 a[40:41], v143 offset:0
  ds_read_b64_tr_b16 a[42:43], v143 offset:3072
  ds_read_b64_tr_b16 a[44:45], v143 offset:12288
  ds_read_b64_tr_b16 a[46:47], v143 offset:15360
  ds_read_b64_tr_b16 a[120:121], v143 offset:256
  ds_read_b64_tr_b16 a[122:123], v143 offset:3328
  ds_read_b64_tr_b16 a[124:125], v143 offset:12544
  ds_read_b64_tr_b16 a[126:127], v143 offset:15616
  ds_read_b64_tr_b16 a[200:201], v143 offset:512
  ds_read_b64_tr_b16 a[202:203], v143 offset:3584
  ds_read_b64_tr_b16 a[204:205], v143 offset:12800
  ds_read_b64_tr_b16 a[206:207], v143 offset:15872
  s_waitcnt lgkmcnt(0)
  s_waitcnt vmcnt(24)
  s_barrier
  s_lshl_b32 s29, s21, 10
  s_add_u32 m0, s29, 122880
  s_mov_b32 s28, 1572864
  buffer_load_dwordx4 v136, s[16:19], s28 offen lds
  s_lshl_b32 s29, s21, 10
  s_add_u32 m0, s29, 126976
  s_mov_b32 s28, 1572864
  buffer_load_dwordx4 v137, s[16:19], s28 offen lds
  s_lshl_b32 s29, s21, 10
  s_add_u32 m0, s29, 131072
  s_mov_b32 s28, 1572864
  buffer_load_dwordx4 v138, s[16:19], s28 offen lds
  s_lshl_b32 s29, s21, 10
  s_add_u32 m0, s29, 135168
  s_mov_b32 s28, 1572864
  buffer_load_dwordx4 v139, s[16:19], s28 offen lds
  s_lshl_b32 s29, s21, 10
  s_add_u32 m0, s29, 139264
  s_mov_b32 s28, 1572864
  buffer_load_dwordx4 v140, s[16:19], s28 offen lds
  s_lshl_b32 s29, s21, 10
  s_add_u32 m0, s29, 143360
  s_mov_b32 s28, 1572864
  buffer_load_dwordx4 v141, s[16:19], s28 offen lds
  v_add_u32 v143, 0, v142
  ds_read_b64_tr_b16 a[48:49], v143 offset:0
  ds_read_b64_tr_b16 a[50:51], v143 offset:3072
  ds_read_b64_tr_b16 a[52:53], v143 offset:12288
  ds_read_b64_tr_b16 a[54:55], v143 offset:15360
  ds_read_b64_tr_b16 a[128:129], v143 offset:256
  ds_read_b64_tr_b16 a[130:131], v143 offset:3328
  ds_read_b64_tr_b16 a[132:133], v143 offset:12544
  ds_read_b64_tr_b16 a[134:135], v143 offset:15616
  ds_read_b64_tr_b16 a[208:209], v143 offset:512
  ds_read_b64_tr_b16 a[210:211], v143 offset:3584
  ds_read_b64_tr_b16 a[212:213], v143 offset:12800
  ds_read_b64_tr_b16 a[214:215], v143 offset:15872
  s_waitcnt lgkmcnt(0)
  s_waitcnt vmcnt(24)
  s_barrier
  s_lshl_b32 s29, s21, 10
  s_add_u32 m0, s29, 0
  s_mov_b32 s28, 3145728
  buffer_load_dwordx4 v136, s[16:19], s28 offen lds
  s_lshl_b32 s29, s21, 10
  s_add_u32 m0, s29, 4096
  s_mov_b32 s28, 3145728
  buffer_load_dwordx4 v137, s[16:19], s28 offen lds
  s_lshl_b32 s29, s21, 10
  s_add_u32 m0, s29, 8192
  s_mov_b32 s28, 3145728
  buffer_load_dwordx4 v138, s[16:19], s28 offen lds
  s_lshl_b32 s29, s21, 10
  s_add_u32 m0, s29, 12288
  s_mov_b32 s28, 3145728
  buffer_load_dwordx4 v139, s[16:19], s28 offen lds
  s_lshl_b32 s29, s21, 10
  s_add_u32 m0, s29, 16384
  s_mov_b32 s28, 3145728
  buffer_load_dwordx4 v140, s[16:19], s28 offen lds
  s_lshl_b32 s29, s21, 10
  s_add_u32 m0, s29, 20480
  s_mov_b32 s28, 3145728
  buffer_load_dwordx4 v141, s[16:19], s28 offen lds
  v_add_u32 v143, 24576, v142
  ds_read_b64_tr_b16 a[56:57], v143 offset:0
  ds_read_b64_tr_b16 a[58:59], v143 offset:3072
  ds_read_b64_tr_b16 a[60:61], v143 offset:12288
  ds_read_b64_tr_b16 a[62:63], v143 offset:15360
  ds_read_b64_tr_b16 a[136:137], v143 offset:256
  ds_read_b64_tr_b16 a[138:139], v143 offset:3328
  ds_read_b64_tr_b16 a[140:141], v143 offset:12544
  ds_read_b64_tr_b16 a[142:143], v143 offset:15616
  ds_read_b64_tr_b16 a[216:217], v143 offset:512
  ds_read_b64_tr_b16 a[218:219], v143 offset:3584
  ds_read_b64_tr_b16 a[220:221], v143 offset:12800
  ds_read_b64_tr_b16 a[222:223], v143 offset:15872
  s_waitcnt lgkmcnt(0)
  s_waitcnt vmcnt(24)
  s_barrier
  s_lshl_b32 s29, s21, 10
  s_add_u32 m0, s29, 24576
  s_mov_b32 s28, 4718592
  buffer_load_dwordx4 v136, s[16:19], s28 offen lds
  s_lshl_b32 s29, s21, 10
  s_add_u32 m0, s29, 28672
  s_mov_b32 s28, 4718592
  buffer_load_dwordx4 v137, s[16:19], s28 offen lds
  s_lshl_b32 s29, s21, 10
  s_add_u32 m0, s29, 32768
  s_mov_b32 s28, 4718592
  buffer_load_dwordx4 v138, s[16:19], s28 offen lds
  s_lshl_b32 s29, s21, 10
  s_add_u32 m0, s29, 36864
  s_mov_b32 s28, 4718592
  buffer_load_dwordx4 v139, s[16:19], s28 offen lds
  s_lshl_b32 s29, s21, 10
  s_add_u32 m0, s29, 40960
  s_mov_b32 s28, 4718592
  buffer_load_dwordx4 v140, s[16:19], s28 offen lds
  s_lshl_b32 s29, s21, 10
  s_add_u32 m0, s29, 45056
  s_mov_b32 s28, 4718592
  buffer_load_dwordx4 v141, s[16:19], s28 offen lds
  v_add_u32 v143, 49152, v142
  ds_read_b64_tr_b16 a[64:65], v143 offset:0
  ds_read_b64_tr_b16 a[66:67], v143 offset:3072
  ds_read_b64_tr_b16 a[68:69], v143 offset:12288
  ds_read_b64_tr_b16 a[70:71], v143 offset:15360
  ds_read_b64_tr_b16 a[144:145], v143 offset:256
  ds_read_b64_tr_b16 a[146:147], v143 offset:3328
  ds_read_b64_tr_b16 a[148:149], v143 offset:12544
  ds_read_b64_tr_b16 a[150:151], v143 offset:15616
  ds_read_b64_tr_b16 a[224:225], v143 offset:512
  ds_read_b64_tr_b16 a[226:227], v143 offset:3584
  ds_read_b64_tr_b16 a[228:229], v143 offset:12800
  ds_read_b64_tr_b16 a[230:231], v143 offset:15872
  s_waitcnt lgkmcnt(0)
  s_waitcnt vmcnt(24)
  s_barrier
  s_lshl_b32 s29, s21, 10
  s_add_u32 m0, s29, 49152
  s_mov_b32 s28, 6291456
  buffer_load_dwordx4 v136, s[16:19], s28 offen lds
  s_lshl_b32 s29, s21, 10
  s_add_u32 m0, s29, 53248
  s_mov_b32 s28, 6291456
  buffer_load_dwordx4 v137, s[16:19], s28 offen lds
  s_lshl_b32 s29, s21, 10
  s_add_u32 m0, s29, 57344
  s_mov_b32 s28, 6291456
  buffer_load_dwordx4 v138, s[16:19], s28 offen lds
  s_lshl_b32 s29, s21, 10
  s_add_u32 m0, s29, 61440
  s_mov_b32 s28, 6291456
  buffer_load_dwordx4 v139, s[16:19], s28 offen lds
  s_lshl_b32 s29, s21, 10
  s_add_u32 m0, s29, 65536
  s_mov_b32 s28, 6291456
  buffer_load_dwordx4 v140, s[16:19], s28 offen lds
  s_lshl_b32 s29, s21, 10
  s_add_u32 m0, s29, 69632
  s_mov_b32 s28, 6291456
  buffer_load_dwordx4 v141, s[16:19], s28 offen lds
  v_add_u32 v143, 73728, v142
  ds_read_b64_tr_b16 a[72:73], v143 offset:0
  ds_read_b64_tr_b16 a[74:75], v143 offset:3072
  ds_read_b64_tr_b16 a[76:77], v143 offset:12288
  ds_read_b64_tr_b16 a[78:79], v143 offset:15360
  ds_read_b64_tr_b16 a[152:153], v143 offset:256
  ds_read_b64_tr_b16 a[154:155], v143 offset:3328
  ds_read_b64_tr_b16 a[156:157], v143 offset:12544
  ds_read_b64_tr_b16 a[158:159], v143 offset:15616
  ds_read_b64_tr_b16 a[232:233], v143 offset:512
  ds_read_b64_tr_b16 a[234:235], v143 offset:3584
  ds_read_b64_tr_b16 a[236:237], v143 offset:12800
  ds_read_b64_tr_b16 a[238:239], v143 offset:15872
  s_waitcnt lgkmcnt(0)
  s_waitcnt vmcnt(24)
  s_barrier
  s_lshl_b32 s29, s21, 10
  s_add_u32 m0, s29, 73728
  s_mov_b32 s28, 786432
  buffer_load_dwordx4 v136, s[16:19], s28 offen lds
  s_lshl_b32 s29, s21, 10
  s_add_u32 m0, s29, 77824
  s_mov_b32 s28, 786432
  buffer_load_dwordx4 v137, s[16:19], s28 offen lds
  s_lshl_b32 s29, s21, 10
  s_add_u32 m0, s29, 81920
  s_mov_b32 s28, 786432
  buffer_load_dwordx4 v138, s[16:19], s28 offen lds
  s_lshl_b32 s29, s21, 10
  s_add_u32 m0, s29, 86016
  s_mov_b32 s28, 786432
  buffer_load_dwordx4 v139, s[16:19], s28 offen lds
  s_lshl_b32 s29, s21, 10
  s_add_u32 m0, s29, 90112
  s_mov_b32 s28, 786432
  buffer_load_dwordx4 v140, s[16:19], s28 offen lds
  s_lshl_b32 s29, s21, 10
  s_add_u32 m0, s29, 94208
  s_mov_b32 s28, 786432
  buffer_load_dwordx4 v141, s[16:19], s28 offen lds
  v_add_u32 v143, 98304, v142
  ds_read_b64_tr_b16 a[240:241], v143 offset:0
  ds_read_b64_tr_b16 a[242:243], v143 offset:3072
  ds_read_b64_tr_b16 a[244:245], v143 offset:12288
  ds_read_b64_tr_b16 a[246:247], v143 offset:15360
  ds_read_b64_tr_b16 v[176:177], v143 offset:256
  ds_read_b64_tr_b16 v[178:179], v143 offset:3328
  ds_read_b64_tr_b16 v[180:181], v143 offset:12544
  ds_read_b64_tr_b16 v[182:183], v143 offset:15616
  ds_read_b64_tr_b16 v[216:217], v143 offset:512
  ds_read_b64_tr_b16 v[218:219], v143 offset:3584
  ds_read_b64_tr_b16 v[220:221], v143 offset:12800
  ds_read_b64_tr_b16 v[222:223], v143 offset:15872
  s_waitcnt lgkmcnt(0)
  s_waitcnt vmcnt(24)
  s_barrier
  s_lshl_b32 s29, s21, 10
  s_add_u32 m0, s29, 98304
  s_mov_b32 s28, 2359296
  buffer_load_dwordx4 v136, s[16:19], s28 offen lds
  s_lshl_b32 s29, s21, 10
  s_add_u32 m0, s29, 102400
  s_mov_b32 s28, 2359296
  buffer_load_dwordx4 v137, s[16:19], s28 offen lds
  s_lshl_b32 s29, s21, 10
  s_add_u32 m0, s29, 106496
  s_mov_b32 s28, 2359296
  buffer_load_dwordx4 v138, s[16:19], s28 offen lds
  s_lshl_b32 s29, s21, 10
  s_add_u32 m0, s29, 110592
  s_mov_b32 s28, 2359296
  buffer_load_dwordx4 v139, s[16:19], s28 offen lds
  s_lshl_b32 s29, s21, 10
  s_add_u32 m0, s29, 114688
  s_mov_b32 s28, 2359296
  buffer_load_dwordx4 v140, s[16:19], s28 offen lds
  s_lshl_b32 s29, s21, 10
  s_add_u32 m0, s29, 118784
  s_mov_b32 s28, 2359296
  buffer_load_dwordx4 v141, s[16:19], s28 offen lds
  v_add_u32 v143, 122880, v142
  ds_read_b64_tr_b16 a[248:249], v143 offset:0
  ds_read_b64_tr_b16 a[250:251], v143 offset:3072
  ds_read_b64_tr_b16 a[252:253], v143 offset:12288
  ds_read_b64_tr_b16 a[254:255], v143 offset:15360
  ds_read_b64_tr_b16 v[184:185], v143 offset:256
  ds_read_b64_tr_b16 v[186:187], v143 offset:3328
  ds_read_b64_tr_b16 v[188:189], v143 offset:12544
  ds_read_b64_tr_b16 v[190:191], v143 offset:15616
  ds_read_b64_tr_b16 v[224:225], v143 offset:512
  ds_read_b64_tr_b16 v[226:227], v143 offset:3584
  ds_read_b64_tr_b16 v[228:229], v143 offset:12800
  ds_read_b64_tr_b16 v[230:231], v143 offset:15872
  s_waitcnt lgkmcnt(0)
  s_waitcnt vmcnt(24)
  s_barrier
  s_lshl_b32 s29, s21, 10
  s_add_u32 m0, s29, 122880
  s_mov_b32 s28, 3932160
  buffer_load_dwordx4 v136, s[16:19], s28 offen lds
  s_lshl_b32 s29, s21, 10
  s_add_u32 m0, s29, 126976
  s_mov_b32 s28, 3932160
  buffer_load_dwordx4 v137, s[16:19], s28 offen lds
  s_lshl_b32 s29, s21, 10
  s_add_u32 m0, s29, 131072
  s_mov_b32 s28, 3932160
  buffer_load_dwordx4 v138, s[16:19], s28 offen lds
  s_lshl_b32 s29, s21, 10
  s_add_u32 m0, s29, 135168
  s_mov_b32 s28, 3932160
  buffer_load_dwordx4 v139, s[16:19], s28 offen lds
  s_lshl_b32 s29, s21, 10
  s_add_u32 m0, s29, 139264
  s_mov_b32 s28, 3932160
  buffer_load_dwordx4 v140, s[16:19], s28 offen lds
  s_lshl_b32 s29, s21, 10
  s_add_u32 m0, s29, 143360
  s_mov_b32 s28, 3932160
  buffer_load_dwordx4 v141, s[16:19], s28 offen lds
  v_add_u32 v143, 0, v142
  ds_read_b64_tr_b16 v[152:153], v143 offset:0
  ds_read_b64_tr_b16 v[154:155], v143 offset:3072
  ds_read_b64_tr_b16 v[156:157], v143 offset:12288
  ds_read_b64_tr_b16 v[158:159], v143 offset:15360
  ds_read_b64_tr_b16 v[192:193], v143 offset:256
  ds_read_b64_tr_b16 v[194:195], v143 offset:3328
  ds_read_b64_tr_b16 v[196:197], v143 offset:12544
  ds_read_b64_tr_b16 v[198:199], v143 offset:15616
  ds_read_b64_tr_b16 v[232:233], v143 offset:512
  ds_read_b64_tr_b16 v[234:235], v143 offset:3584
  ds_read_b64_tr_b16 v[236:237], v143 offset:12800
  ds_read_b64_tr_b16 v[238:239], v143 offset:15872
  s_waitcnt lgkmcnt(0)
  s_waitcnt vmcnt(24)
  s_barrier
  s_lshl_b32 s29, s21, 10
  s_add_u32 m0, s29, 0
  s_mov_b32 s28, 5505024
  buffer_load_dwordx4 v136, s[16:19], s28 offen lds
  s_lshl_b32 s29, s21, 10
  s_add_u32 m0, s29, 4096
  s_mov_b32 s28, 5505024
  buffer_load_dwordx4 v137, s[16:19], s28 offen lds
  s_lshl_b32 s29, s21, 10
  s_add_u32 m0, s29, 8192
  s_mov_b32 s28, 5505024
  buffer_load_dwordx4 v138, s[16:19], s28 offen lds
  s_lshl_b32 s29, s21, 10
  s_add_u32 m0, s29, 12288
  s_mov_b32 s28, 5505024
  buffer_load_dwordx4 v139, s[16:19], s28 offen lds
  s_lshl_b32 s29, s21, 10
  s_add_u32 m0, s29, 16384
  s_mov_b32 s28, 5505024
  buffer_load_dwordx4 v140, s[16:19], s28 offen lds
  s_lshl_b32 s29, s21, 10
  s_add_u32 m0, s29, 20480
  s_mov_b32 s28, 5505024
  buffer_load_dwordx4 v141, s[16:19], s28 offen lds
  v_add_u32 v143, 24576, v142
  ds_read_b64_tr_b16 v[160:161], v143 offset:0
  ds_read_b64_tr_b16 v[162:163], v143 offset:3072
  ds_read_b64_tr_b16 v[164:165], v143 offset:12288
  ds_read_b64_tr_b16 v[166:167], v143 offset:15360
  ds_read_b64_tr_b16 v[200:201], v143 offset:256
  ds_read_b64_tr_b16 v[202:203], v143 offset:3328
  ds_read_b64_tr_b16 v[204:205], v143 offset:12544
  ds_read_b64_tr_b16 v[206:207], v143 offset:15616
  ds_read_b64_tr_b16 v[240:241], v143 offset:512
  ds_read_b64_tr_b16 v[242:243], v143 offset:3584
  ds_read_b64_tr_b16 v[244:245], v143 offset:12800
  ds_read_b64_tr_b16 v[246:247], v143 offset:15872
  s_waitcnt lgkmcnt(0)
  s_waitcnt vmcnt(24)
  s_barrier
  s_lshl_b32 s29, s21, 10
  s_add_u32 m0, s29, 24576
  s_mov_b32 s28, 7077888
  buffer_load_dwordx4 v136, s[16:19], s28 offen lds
  s_lshl_b32 s29, s21, 10
  s_add_u32 m0, s29, 28672
  s_mov_b32 s28, 7077888
  buffer_load_dwordx4 v137, s[16:19], s28 offen lds
  s_lshl_b32 s29, s21, 10
  s_add_u32 m0, s29, 32768
  s_mov_b32 s28, 7077888
  buffer_load_dwordx4 v138, s[16:19], s28 offen lds
  s_lshl_b32 s29, s21, 10
  s_add_u32 m0, s29, 36864
  s_mov_b32 s28, 7077888
  buffer_load_dwordx4 v139, s[16:19], s28 offen lds
  s_lshl_b32 s29, s21, 10
  s_add_u32 m0, s29, 40960
  s_mov_b32 s28, 7077888
  buffer_load_dwordx4 v140, s[16:19], s28 offen lds
  s_lshl_b32 s29, s21, 10
  s_add_u32 m0, s29, 45056
  s_mov_b32 s28, 7077888
  buffer_load_dwordx4 v141, s[16:19], s28 offen lds
  v_add_u32 v143, 49152, v142
  ds_read_b64_tr_b16 v[168:169], v143 offset:0
  ds_read_b64_tr_b16 v[170:171], v143 offset:3072
  ds_read_b64_tr_b16 v[172:173], v143 offset:12288
  ds_read_b64_tr_b16 v[174:175], v143 offset:15360
  ds_read_b64_tr_b16 v[208:209], v143 offset:256
  ds_read_b64_tr_b16 v[210:211], v143 offset:3328
  ds_read_b64_tr_b16 v[212:213], v143 offset:12544
  ds_read_b64_tr_b16 v[214:215], v143 offset:15616
  ds_read_b64_tr_b16 v[248:249], v143 offset:512
  ds_read_b64_tr_b16 v[250:251], v143 offset:3584
  ds_read_b64_tr_b16 v[252:253], v143 offset:12800
  ds_read_b64_tr_b16 v[254:255], v143 offset:15872
  s_waitcnt lgkmcnt(0)
  s_waitcnt vmcnt(24)
  s_barrier
  v_add_u32 v143, 73728, v142
  ds_read_b64_tr_b16 v[16:17], v143 offset:0
  ds_read_b64_tr_b16 v[18:19], v143 offset:3072
  ds_read_b64_tr_b16 v[20:21], v143 offset:12288
  ds_read_b64_tr_b16 v[22:23], v143 offset:15360
  ds_read_b64_tr_b16 v[24:25], v143 offset:256
  ds_read_b64_tr_b16 v[26:27], v143 offset:3328
  ds_read_b64_tr_b16 v[28:29], v143 offset:12544
  ds_read_b64_tr_b16 v[30:31], v143 offset:15616
  ds_read_b64_tr_b16 v[32:33], v143 offset:512
  ds_read_b64_tr_b16 v[34:35], v143 offset:3584
  ds_read_b64_tr_b16 v[36:37], v143 offset:12800
  ds_read_b64_tr_b16 v[38:39], v143 offset:15872
  s_waitcnt lgkmcnt(0)
  s_waitcnt vmcnt(18)
  s_barrier
  v_add_u32 v143, 98304, v142
  ds_read_b64_tr_b16 v[40:41], v143 offset:0
  ds_read_b64_tr_b16 v[42:43], v143 offset:3072
  ds_read_b64_tr_b16 v[44:45], v143 offset:12288
  ds_read_b64_tr_b16 v[46:47], v143 offset:15360
  ds_read_b64_tr_b16 v[48:49], v143 offset:256
  ds_read_b64_tr_b16 v[50:51], v143 offset:3328
  ds_read_b64_tr_b16 v[52:53], v143 offset:12544
  ds_read_b64_tr_b16 v[54:55], v143 offset:15616
  ds_read_b64_tr_b16 v[56:57], v143 offset:512
  ds_read_b64_tr_b16 v[58:59], v143 offset:3584
  ds_read_b64_tr_b16 v[60:61], v143 offset:12800
  ds_read_b64_tr_b16 v[62:63], v143 offset:15872
  s_waitcnt lgkmcnt(0)
  s_waitcnt vmcnt(12)
  s_barrier
  v_add_u32 v143, 122880, v142
  ds_read_b64_tr_b16 v[64:65], v143 offset:0
  ds_read_b64_tr_b16 v[66:67], v143 offset:3072
  ds_read_b64_tr_b16 v[68:69], v143 offset:12288
  ds_read_b64_tr_b16 v[70:71], v143 offset:15360
  ds_read_b64_tr_b16 v[72:73], v143 offset:256
  ds_read_b64_tr_b16 v[74:75], v143 offset:3328
  ds_read_b64_tr_b16 v[76:77], v143 offset:12544
  ds_read_b64_tr_b16 v[78:79], v143 offset:15616
  ds_read_b64_tr_b16 v[80:81], v143 offset:512
  ds_read_b64_tr_b16 v[82:83], v143 offset:3584
  ds_read_b64_tr_b16 v[84:85], v143 offset:12800
  ds_read_b64_tr_b16 v[86:87], v143 offset:15872
  s_waitcnt lgkmcnt(0)
  s_waitcnt vmcnt(6)
  s_barrier
  v_add_u32 v143, 0, v142
  ds_read_b64_tr_b16 v[88:89], v143 offset:0
  ds_read_b64_tr_b16 v[90:91], v143 offset:3072
  ds_read_b64_tr_b16 v[92:93], v143 offset:12288
  ds_read_b64_tr_b16 v[94:95], v143 offset:15360
  ds_read_b64_tr_b16 v[96:97], v143 offset:256
  ds_read_b64_tr_b16 v[98:99], v143 offset:3328
  ds_read_b64_tr_b16 v[100:101], v143 offset:12544
  ds_read_b64_tr_b16 v[102:103], v143 offset:15616
  ds_read_b64_tr_b16 v[104:105], v143 offset:512
  ds_read_b64_tr_b16 v[106:107], v143 offset:3584
  ds_read_b64_tr_b16 v[108:109], v143 offset:12800
  ds_read_b64_tr_b16 v[110:111], v143 offset:15872
  s_waitcnt lgkmcnt(0)
  s_waitcnt vmcnt(0)
  s_barrier
  v_add_u32 v143, 24576, v142
  ds_read_b64_tr_b16 v[112:113], v143 offset:0
  ds_read_b64_tr_b16 v[114:115], v143 offset:3072
  ds_read_b64_tr_b16 v[116:117], v143 offset:12288
  ds_read_b64_tr_b16 v[118:119], v143 offset:15360
  ds_read_b64_tr_b16 v[120:121], v143 offset:256
  ds_read_b64_tr_b16 v[122:123], v143 offset:3328
  ds_read_b64_tr_b16 v[124:125], v143 offset:12544
  ds_read_b64_tr_b16 v[126:127], v143 offset:15616
  ds_read_b64_tr_b16 v[128:129], v143 offset:512
  ds_read_b64_tr_b16 v[130:131], v143 offset:3584
  ds_read_b64_tr_b16 v[132:133], v143 offset:12800
  ds_read_b64_tr_b16 v[134:135], v143 offset:15872
  s_waitcnt lgkmcnt(0)
  s_barrier
  v_lshlrev_b32 v2, 4, v1
  s_mul_i32 s28, s21, 30720
  v_add_u32 v143, s28, v2
  ds_write_b128 v143, v[16:19] offset:0
  ds_write_b128 v143, v[20:23] offset:1024
  ds_write_b128 v143, v[24:27] offset:10240
  ds_write_b128 v143, v[28:31] offset:11264
  ds_write_b128 v143, v[32:35] offset:20480
  ds_write_b128 v143, v[36:39] offset:21504
  ds_write_b128 v143, v[40:43] offset:2048
  ds_write_b128 v143, v[44:47] offset:3072
  ds_write_b128 v143, v[48:51] offset:12288
  ds_write_b128 v143, v[52:55] offset:13312
  ds_write_b128 v143, v[56:59] offset:22528
  ds_write_b128 v143, v[60:63] offset:23552
  ds_write_b128 v143, v[64:67] offset:4096
  ds_write_b128 v143, v[68:71] offset:5120
  ds_write_b128 v143, v[72:75] offset:14336
  ds_write_b128 v143, v[76:79] offset:15360
  ds_write_b128 v143, v[80:83] offset:24576
  ds_write_b128 v143, v[84:87] offset:25600
  ds_write_b128 v143, v[88:91] offset:6144
  ds_write_b128 v143, v[92:95] offset:7168
  ds_write_b128 v143, v[96:99] offset:16384
  ds_write_b128 v143, v[100:103] offset:17408
  ds_write_b128 v143, v[104:107] offset:26624
  ds_write_b128 v143, v[108:111] offset:27648
  ds_write_b128 v143, v[112:115] offset:8192
  ds_write_b128 v143, v[116:119] offset:9216
  ds_write_b128 v143, v[120:123] offset:18432
  ds_write_b128 v143, v[124:127] offset:19456
  ds_write_b128 v143, v[128:131] offset:28672
  ds_write_b128 v143, v[132:135] offset:29696
  s_waitcnt lgkmcnt(0)
  v_and_b32 v1, 63, v0
  v_lshlrev_b32 v132, 4, v1
  s_mul_i32 s28, s21, 30720
  v_add_u32 v129, s28, v132
  s_lshl_b32 s28, s21, 10
  v_add_u32 v124, s28, v132
  v_add_u32 v125, 4096, v124
  v_add_u32 v126, 8192, v124
  v_add_u32 v127, 122880, v124
  v_add_u32 v128, 122880, v132
  v_lshrrev_b32 v2, 3, v1
  s_cmp_lt_u32 s21, 2
  s_cselect_b32 s28, 2, 1
  v_min_u32 v2, s28, v2
  v_lshlrev_b32 v2, 12, v2
  v_and_b32 v3, 7, v1
  v_lshlrev_b32 v3, 7, v3
  v_add_u32 v2, v2, v3
  s_lshl_b32 s28, s21, 10
  v_add_u32 v141, s28, v2
  v_and_b32 v2, 15, v1
  v_lshrrev_b32 v3, 4, v1
  v_add_u32 v3, v3, v2
  v_and_b32 v3, 3, v3
  v_lshlrev_b32 v3, 4, v3
  v_lshlrev_b32 v2, 6, v2
  v_add_u32 v2, v2, v3
  s_mul_i32 s28, s21, 3072
  s_add_u32 s28, s28, 133120
  v_add_u32 v130, s28, v2
  s_mul_i32 s28, s21, 1536
  s_add_u32 s28, s28, 145408
  v_lshlrev_b32 v2, 3, v1
  v_add_u32 v131, s28, v2
  v_mov_b32 v110, 0x44444444
  v_mov_b32 v2, 0xeeeeeeee
  v_and_b32 v3, 8, v1
  v_cmp_ne_u32 vcc, 0, v3
  s_nop 1
  v_cndmask_b32 v110, v110, v2, vcc
  v_and_b32 v4, 15, v1
  v_lshrrev_b32 v5, 4, v1
  v_lshlrev_b32 v6, 2, v5
  v_sub_u32 v6, v4, v6
  v_mov_b32 v7, 0x3f80
  v_mov_b32 v8, 0x3f800000
  v_mov_b32 v108, 0
  v_mov_b32 v109, 0
  v_cmp_eq_u32 vcc, 0, v6
  s_nop 1
  v_cndmask_b32 v108, v108, v7, vcc
  v_cmp_eq_u32 vcc, 1, v6
  s_nop 1
  v_cndmask_b32 v108, v108, v8, vcc
  v_cmp_eq_u32 vcc, 2, v6
  s_nop 1
  v_cndmask_b32 v109, v109, v7, vcc
  v_cmp_eq_u32 vcc, 3, v6
  s_nop 1
  v_cndmask_b32 v109, v109, v8, vcc
  s_mul_i32 s28, s23, 6
  s_lshr_b32 s29, s28, 3
  s_add_u32 s28, s28, 5
  s_lshr_b32 s28, s28, 3
  v_mov_b32 v6, s29
  v_mov_b32 v7, s28
  v_and_b32 v8, 1, v1
  v_cmp_eq_u32 vcc, 1, v8
  s_nop 1
  v_cndmask_b32 v6, v6, v7, vcc
  v_lshlrev_b32 v6, 2, v6
  v_bfe_u32 v8, v1, 1, 1
  v_lshlrev_b32 v8, 10, v8
  v_add_u32 v6, v6, v8
  v_add_u32 v138, 0, v6
  s_mul_i32 s97, s20, 655360
  s_add_u32 s97, s97, 0x400000
  s_mov_b32 s48, 0x4000
  s_mul_i32 s49, s20, 327680
  s_add_u32 s49, s49, 0x700000
  s_add_u32 s98, s49, 5120
  s_mul_i32 s50, s23, 786432
  s_add_u32 s63, s50, 0x4800000
  s_add_u32 s50, s50, 0x6000000
  s_mov_b32 s51, 0
  s_mov_b32 s52, 0
  s_mul_i32 s28, s21, 3
  s_add_u32 s28, s28, 0
  s_lshr_b32 s29, s28, 1
  s_lshl_b32 s29, s29, 11
  s_and_b32 s28, s28, 1
  s_lshl_b32 s28, s28, 3
  s_add_u32 s53, s29, s28
  s_mul_i32 s28, s21, 3
  s_add_u32 s28, s28, 1
  s_lshr_b32 s29, s28, 1
  s_lshl_b32 s29, s29, 11
  s_and_b32 s28, s28, 1
  s_lshl_b32 s28, s28, 3
  s_add_u32 s54, s29, s28
  s_mul_i32 s28, s21, 3
  s_add_u32 s28, s28, 2
  s_lshr_b32 s29, s28, 1
  s_lshl_b32 s29, s29, 11
  s_and_b32 s28, s28, 1
  s_lshl_b32 s28, s28, 3
  s_add_u32 s55, s29, s28
  v_mov_b32 v60, 0
  v_mov_b32 v61, 0
  v_mov_b32 v62, 0
  v_mov_b32 v63, 0
  v_mov_b32 v64, 0
  v_mov_b32 v65, 0
  v_mov_b32 v66, 0
  v_mov_b32 v67, 0
  v_mov_b32 v68, 0
  v_mov_b32 v69, 0
  v_mov_b32 v70, 0
  v_mov_b32 v71, 0
  v_mov_b32 v72, 0
  v_mov_b32 v73, 0
  v_mov_b32 v74, 0
  v_mov_b32 v75, 0
  v_mov_b32 v36, 0
  v_mov_b32 v37, 0
  v_mov_b32 v38, 0
  v_mov_b32 v39, 0
  v_mov_b32 v40, 0
  v_mov_b32 v41, 0
  v_mov_b32 v42, 0
  v_mov_b32 v43, 0
  s_barrier
  s_cmp_gt_u32 s52, s51
  s_cbranch_scc1 ka\sfx\()_x_wp_75_ok
  s_mov_b32 s45, 0
ka\sfx\()_x_wp_75_spin:
  buffer_load_dword v2, v138, s[8:11], 0 offen sc1
  s_add_u32 s45, s45, 1
  s_waitcnt vmcnt(0)
  v_min_u32_dpp v3, v2, v2 quad_perm:[1,0,3,2] row_mask:0xf bank_mask:0xf
  s_nop 1
  v_min_u32_dpp v2, v3, v3 quad_perm:[2,3,0,1] row_mask:0xf bank_mask:0xf
  s_nop 1
  v_min_u32_dpp v3, v2, v2 row_half_mirror row_mask:0xf bank_mask:0xf
  s_nop 1
  v_min_u32_dpp v2, v3, v3 quad_perm:[0,1,2,3] row_mask:0xf bank_mask:0xf
  s_nop 0
  v_readfirstlane_b32 s52, v2
  s_cmp_gt_u32 s52, s51
  s_cbranch_scc1 ka\sfx\()_x_wp_75_ok
  s_cmp_lt_u32 s45, 400000
  s_cbranch_scc1 ka\sfx\()_x_wp_75_spin
  s_branch ka\sfx\()_abort
ka\sfx\()_x_wp_75_ok:
  s_add_u32 s28, s50, s53
  buffer_load_dwordx2 v[88:89], v132, s[8:11], s28 offen offset:0 sc1
  buffer_load_dwordx2 v[92:93], v132, s[8:11], s28 offen offset:1024 sc1
  s_add_u32 s28, s50, s54
  buffer_load_dwordx2 v[90:91], v132, s[8:11], s28 offen offset:0 sc1
  buffer_load_dwordx2 v[94:95], v132, s[8:11], s28 offen offset:1024 sc1
  s_add_u32 s28, s50, s55
  buffer_load_dwordx2 v[96:97], v132, s[8:11], s28 offen offset:0 sc1
  buffer_load_dwordx2 v[98:99], v132, s[8:11], s28 offen offset:1024 sc1
  s_cmp_eq_u32 s21, 0
  s_cbranch_scc1 ka\sfx\()_x_w0
  s_cmp_eq_u32 s21, 1
  s_cbranch_scc1 ka\sfx\()_x_w1
  s_branch ka\sfx\()_x_w23
ka\sfx\()_x_w0:
  v_lshrrev_b32 v4, 3, v1
  v_and_b32 v5, 7, v1
  v_lshrrev_b32 v6, 2, v5
  v_and_b32 v7, 3, v5
  v_lshlrev_b32 v8, 10, v6
  v_lshlrev_b32 v9, 6, v4
  v_add_u32 v8, v8, v9
  v_add_u32 v9, v7, v4
  v_and_b32 v9, 3, v9
  v_lshlrev_b32 v9, 4, v9
  v_add_u32 v8, v8, v9
  v_add_u32 v133, 134144, v8
  v_add_u32 v8, 2, v6
  v_add_u32 v8, v8, v4
  v_and_b32 v8, 3, v8
  v_lshlrev_b32 v8, 4, v8
  v_lshlrev_b32 v9, 6, v4
  v_add_u32 v8, v8, v9
  v_lshlrev_b32 v9, 2, v7
  v_add_u32 v8, v8, v9
  v_add_u32 v134, 133120, v8
  s_and_b32 s26, s23, 7
  v_and_b32 v8, 1, v7
  v_lshlrev_b32 v8, 1, v8
  v_add_u32 v8, v8, v6
  v_lshlrev_b32 v8, 4, v8
  v_add_u32 v8, v8, v4
  v_lshlrev_b32 v8, 4, v8
  v_lshrrev_b32 v9, 1, v7
  v_lshlrev_b32 v9, 3, v9
  v_add_u32 v8, v8, v9
  s_lshr_b32 s28, s26, 1
  s_lshl_b32 s28, s28, 10
  s_and_b32 s29, s26, 1
  s_lshl_b32 s29, s29, 7
  s_add_u32 s28, s28, s29
  v_add_u32 v135, s28, v8
  v_lshlrev_b32 v8, 4, v6
  v_add_u32 v8, v8, v4
  v_lshlrev_b32 v8, 4, v8
  v_lshlrev_b32 v9, 1, v7
  v_add_u32 v8, v8, v9
  s_lshr_b32 s28, s26, 2
  s_lshl_b32 s28, s28, 7
  s_and_b32 s29, s26, 1
  s_lshl_b32 s29, s29, 9
  s_add_u32 s28, s28, s29
  s_bfe_u32 s29, s26, 0x10001
  s_lshl_b32 s29, s29, 3
  s_add_u32 s28, s28, s29
  s_add_u32 s28, s28, 4096
  v_add_u32 v8, s28, v8
  v_mov_b32 v9, 0x40000000
  v_and_b32 v10, 1, v5
  v_cmp_eq_u32 vcc, 0, v10
  s_nop 1
  v_cndmask_b32 v136, v9, v8, vcc
  s_mov_b32 s64, 0x3dd53b95
  s_mov_b32 s65, 0x3dd53b95
  v_mov_b32 v137, 0x42800000
ka\sfx\()_x_w0l:
  ds_read_b128 v[44:47], v129 offset:0
  ds_read_b128 v[48:51], v129 offset:1024
  ds_read_b128 v[52:55], v129 offset:2048
  ds_read_b128 v[56:59], v129 offset:3072
  s_waitcnt lgkmcnt(0)
  s_mov_b32 s45, 0
ka\sfx\()_x_pf_76_pr:
  buffer_load_dword v139, v141, s[8:11], s48 offen sc1
  s_add_u32 s45, s45, 1
  s_waitcnt vmcnt(0)
  v_cmp_eq_u32 vcc, -1, v139
  s_cbranch_vccz ka\sfx\()_x_pf_76
  s_cmp_lt_u32 s45, 400000
  s_cbranch_scc1 ka\sfx\()_x_pf_76_pr
  s_branch ka\sfx\()_abort
ka\sfx\()_x_pf_76:
  buffer_load_dwordx4 v[112:115], v124, s[8:11], s48 offen sc1
  buffer_load_dwordx4 v[116:119], v125, s[8:11], s48 offen sc1
  buffer_load_dwordx4 v[120:123], v126, s[8:11], s48 offen sc1
  s_add_u32 s45, s45, 1
  s_waitcnt vmcnt(2)
  ds_write_b128 v127, v[112:115] offset:0
  v_max3_u32 v139, v112, v113, v114
  v_max_u32 v139, v139, v115
  s_waitcnt vmcnt(1)
  ds_write_b128 v127, v[116:119] offset:4096
  v_max3_u32 v139, v139, v116, v117
  v_max3_u32 v139, v139, v118, v119
  s_waitcnt vmcnt(0)
  ds_write_b128 v127, v[120:123] offset:8192
  v_max3_u32 v139, v139, v120, v121
  v_max3_u32 v139, v139, v122, v123
  v_cmp_eq_u32 vcc, -1, v139
  s_cbranch_vccz ka\sfx\()_x_pf_76_ok
  s_cmp_lt_u32 s45, 400000
  s_cbranch_scc1 ka\sfx\()_x_pf_76
  s_branch ka\sfx\()_abort
ka\sfx\()_x_pf_76_ok:
  v_smfmac_f32_16x16x64_bf16 v[60:63], v[112:115], a[0:7], v110
  v_smfmac_f32_16x16x64_bf16 v[64:67], v[112:115], a[240:247], v110
  v_smfmac_f32_16x16x64_bf16 v[68:71], v[112:115], a[80:87], v110
  v_smfmac_f32_16x16x64_bf16 v[72:75], v[112:115], v[176:183], v110
  s_waitcnt lgkmcnt(0)
  s_barrier
  v_smfmac_f32_16x16x64_bf16 v[36:39], v[112:115], a[160:167], v110
  ds_read_b128 v[4:7], v128 offset:1024
  v_smfmac_f32_16x16x64_bf16 v[40:43], v[112:115], v[216:223], v110
  ds_read_b128 v[8:11], v128 offset:2048
  v_smfmac_f32_16x16x64_bf16 v[60:63], v[116:119], a[32:39], v110
  ds_read_b128 v[12:15], v128 offset:3072
  v_smfmac_f32_16x16x64_bf16 v[64:67], v[116:119], v[152:159], v110
  ds_read_b128 v[16:19], v128 offset:5120
  v_smfmac_f32_16x16x64_bf16 v[68:71], v[116:119], a[112:119], v110
  ds_read_b128 v[20:23], v128 offset:6144
  v_smfmac_f32_16x16x64_bf16 v[72:75], v[116:119], v[192:199], v110
  ds_read_b128 v[24:27], v128 offset:7168
  v_smfmac_f32_16x16x64_bf16 v[36:39], v[116:119], a[192:199], v110
  ds_read_b128 v[28:31], v128 offset:9216
  v_smfmac_f32_16x16x64_bf16 v[40:43], v[116:119], v[232:239], v110
  v_smfmac_f32_16x16x64_bf16 v[60:63], v[120:123], a[64:71], v110
  v_smfmac_f32_16x16x64_bf16 v[64:67], v[120:123], v[168:175], v110
  v_smfmac_f32_16x16x64_bf16 v[68:71], v[120:123], a[144:151], v110
  v_smfmac_f32_16x16x64_bf16 v[72:75], v[120:123], v[208:215], v110
  v_smfmac_f32_16x16x64_bf16 v[36:39], v[120:123], a[224:231], v110
  v_smfmac_f32_16x16x64_bf16 v[40:43], v[120:123], v[248:255], v110
  s_waitcnt lgkmcnt(6)
  v_smfmac_f32_16x16x64_bf16 v[60:63], v[4:7], a[8:15], v110
  v_smfmac_f32_16x16x64_bf16 v[64:67], v[4:7], v[44:51], v110
  ds_read_b128 v[44:47], v129 offset:4096
  s_waitcnt lgkmcnt(6)
  v_smfmac_f32_16x16x64_bf16 v[60:63], v[8:11], a[16:23], v110
  ds_read_b128 v[48:51], v129 offset:5120
  v_smfmac_f32_16x16x64_bf16 v[64:67], v[8:11], a[248:255], v110
  s_waitcnt lgkmcnt(6)
  v_smfmac_f32_16x16x64_bf16 v[60:63], v[12:15], a[24:31], v110
  v_smfmac_f32_16x16x64_bf16 v[64:67], v[12:15], v[52:59], v110
  ds_read_b128 v[52:55], v129 offset:6144
  s_waitcnt lgkmcnt(6)
  v_smfmac_f32_16x16x64_bf16 v[60:63], v[16:19], a[40:47], v110
  ds_read_b128 v[56:59], v129 offset:7168
  s_waitcnt lgkmcnt(2)
  v_smfmac_f32_16x16x64_bf16 v[64:67], v[16:19], v[44:51], v110
  ds_read_b128 v[44:47], v129 offset:8192
  v_smfmac_f32_16x16x64_bf16 v[60:63], v[20:23], a[48:55], v110
  ds_read_b128 v[48:51], v129 offset:9216
  v_smfmac_f32_16x16x64_bf16 v[64:67], v[20:23], v[160:167], v110
  v_smfmac_f32_16x16x64_bf16 v[60:63], v[24:27], a[56:63], v110
  s_waitcnt lgkmcnt(2)
  v_smfmac_f32_16x16x64_bf16 v[64:67], v[24:27], v[52:59], v110
  ds_read_b128 v[52:55], v129 offset:10240
  v_smfmac_f32_16x16x64_bf16 v[60:63], v[28:31], a[72:79], v110
  ds_read_b128 v[56:59], v129 offset:11264
  s_waitcnt lgkmcnt(2)
  v_smfmac_f32_16x16x64_bf16 v[64:67], v[28:31], v[44:51], v110
  ds_read_b128 v[44:47], v129 offset:12288
  v_smfmac_f32_16x16x64_bf16 v[68:71], v[4:7], a[88:95], v110
  ds_read_b128 v[48:51], v129 offset:13312
  s_waitcnt lgkmcnt(2)
  v_smfmac_f32_16x16x64_bf16 v[72:75], v[4:7], v[52:59], v110
  ds_read_b128 v[52:55], v129 offset:14336
  v_permlane32_swap_b32 v60, v64
  v_smfmac_f32_16x16x64_bf16 v[68:71], v[8:11], a[96:103], v110
  ds_read_b128 v[56:59], v129 offset:15360
  v_smfmac_f32_16x16x64_bf16 v[72:75], v[8:11], v[184:191], v110
  v_permlane32_swap_b32 v61, v65
  v_smfmac_f32_16x16x64_bf16 v[68:71], v[12:15], a[104:111], v110
  s_waitcnt lgkmcnt(2)
  v_smfmac_f32_16x16x64_bf16 v[72:75], v[12:15], v[44:51], v110
  ds_read_b128 v[44:47], v129 offset:16384
  v_permlane32_swap_b32 v62, v66
  v_smfmac_f32_16x16x64_bf16 v[68:71], v[16:19], a[120:127], v110
  ds_read_b128 v[48:51], v129 offset:17408
  v_permlane32_swap_b32 v63, v67
  s_waitcnt lgkmcnt(2)
  v_smfmac_f32_16x16x64_bf16 v[72:75], v[16:19], v[52:59], v110
  ds_read_b128 v[52:55], v129 offset:18432
  v_add_f32 v60, v60, v64
  v_smfmac_f32_16x16x64_bf16 v[68:71], v[20:23], a[128:135], v110
  ds_read_b128 v[56:59], v129 offset:19456
  v_add_f32 v61, v61, v65
  v_smfmac_f32_16x16x64_bf16 v[72:75], v[20:23], v[200:207], v110
  v_add_f32 v62, v62, v66
  v_smfmac_f32_16x16x64_bf16 v[68:71], v[24:27], a[136:143], v110
  v_add_f32 v63, v63, v67
  s_waitcnt lgkmcnt(2)
  v_smfmac_f32_16x16x64_bf16 v[72:75], v[24:27], v[44:51], v110
  ds_read_b128 v[44:47], v129 offset:20480
  v_cvt_pk_bf16_f32 v100, v60, v61
  v_smfmac_f32_16x16x64_bf16 v[68:71], v[28:31], a[152:159], v110
  ds_read_b128 v[48:51], v129 offset:21504
  v_cvt_pk_bf16_f32 v101, v62, v63
  s_waitcnt lgkmcnt(2)
  v_smfmac_f32_16x16x64_bf16 v[72:75], v[28:31], v[52:59], v110
  ds_read_b128 v[52:55], v129 offset:22528
  v_smfmac_f32_16x16x64_bf16 v[36:39], v[4:7], a[168:175], v110
  ds_read_b128 v[56:59], v129 offset:23552
  s_waitcnt lgkmcnt(2)
  v_smfmac_f32_16x16x64_bf16 v[40:43], v[4:7], v[44:51], v110
  ds_read_b128 v[44:47], v129 offset:24576
  v_permlane32_swap_b32 v68, v72
  v_smfmac_f32_16x16x64_bf16 v[36:39], v[8:11], a[176:183], v110
  ds_read_b128 v[48:51], v129 offset:25600
  v_smfmac_f32_16x16x64_bf16 v[40:43], v[8:11], v[224:231], v110
  v_permlane32_swap_b32 v69, v73
  v_smfmac_f32_16x16x64_bf16 v[36:39], v[12:15], a[184:191], v110
  s_waitcnt lgkmcnt(2)
  v_smfmac_f32_16x16x64_bf16 v[40:43], v[12:15], v[52:59], v110
  ds_read_b128 v[52:55], v129 offset:26624
  v_permlane32_swap_b32 v70, v74
  v_smfmac_f32_16x16x64_bf16 v[36:39], v[16:19], a[200:207], v110
  ds_read_b128 v[56:59], v129 offset:27648
  v_permlane32_swap_b32 v71, v75
  s_waitcnt lgkmcnt(2)
  v_smfmac_f32_16x16x64_bf16 v[40:43], v[16:19], v[44:51], v110
  ds_read_b128 v[44:47], v129 offset:28672
  v_add_f32 v68, v68, v72
  v_smfmac_f32_16x16x64_bf16 v[36:39], v[20:23], a[208:215], v110
  ds_read_b128 v[48:51], v129 offset:29696
  v_add_f32 v69, v69, v73
  v_smfmac_f32_16x16x64_bf16 v[40:43], v[20:23], v[240:247], v110
  v_add_f32 v70, v70, v74
  v_smfmac_f32_16x16x64_bf16 v[36:39], v[24:27], a[216:223], v110
  v_add_f32 v71, v71, v75
  s_waitcnt lgkmcnt(2)
  v_smfmac_f32_16x16x64_bf16 v[40:43], v[24:27], v[52:59], v110
  v_cvt_pk_bf16_f32 v102, v68, v69
  v_smfmac_f32_16x16x64_bf16 v[36:39], v[28:31], a[232:239], v110
  v_cvt_pk_bf16_f32 v103, v70, v71
  s_waitcnt lgkmcnt(0)
  v_smfmac_f32_16x16x64_bf16 v[40:43], v[28:31], v[44:51], v110
  v_mfma_f32_16x16x16_bf16 v[142:145], v[100:101], v[108:109], 0
  v_mfma_f32_16x16x16_bf16 v[146:149], v[102:103], v[108:109], 0
  s_nop 1
  v_permlane32_swap_b32 v36, v40
  v_permlane32_swap_b32 v37, v41
  v_permlane32_swap_b32 v38, v42
  v_permlane32_swap_b32 v39, v43
  v_add_f32 v36, v36, v40
  v_add_f32 v37, v37, v41
  v_add_f32 v38, v38, v42
  v_add_f32 v39, v39, v43
  v_cvt_pk_bf16_f32 v104, v36, v37
  v_cvt_pk_bf16_f32 v105, v38, v39
  v_cvt_pk_bf16_f32 v44, v142, v143
  v_cvt_pk_bf16_f32 v45, v144, v145
  v_mfma_f32_16x16x16_bf16 v[142:145], v[104:105], v[108:109], 0
  v_cvt_pk_bf16_f32 v46, v146, v147
  v_cvt_pk_bf16_f32 v47, v148, v149
  s_nop 1
  v_mfma_f32_16x16x32_bf16 v[76:79], v[44:47], v[44:47], 0
  v_mfma_f32_16x16x32_bf16 v[80:83], v[88:91], v[44:47], 0
  v_cvt_pk_bf16_f32 v106, v142, v143
  v_cvt_pk_bf16_f32 v107, v144, v145
  v_mfma_f32_16x16x32_bf16 v[84:87], v[92:95], v[44:47], 0
  s_nop 0
  v_mfma_f32_16x16x16_bf16 v[76:79], v[106:107], v[106:107], v[76:79]
  v_mfma_f32_16x16x16_bf16 v[80:83], v[96:97], v[106:107], v[80:83]
  v_mfma_f32_16x16x16_bf16 v[84:87], v[98:99], v[106:107], v[84:87]
  s_mov_b32 exec_lo, 0
  s_mov_b32 exec_hi, 0x00ff00ff
  s_nop 3
  ds_write_b128 v130, v[76:79]
  s_mov_b32 exec_lo, 0x00ff00ff
  ds_write_b128 v130, v[80:83] offset:1024
  s_nop 0
  ds_write_b128 v130, v[84:87] offset:2048
  s_mov_b64 exec, -1
  s_waitcnt lgkmcnt(0)
  s_barrier
  s_cmp_ge_u32 s51, 63
  s_cbranch_scc0 x63_77_\sfx\()
  ds_write_b64 v131, v[44:45]
  ds_write_b64 v131, v[46:47] offset:512
  ds_write_b64 v131, v[106:107] offset:1024
  s_branch ka\sfx\()_x_done
x63_77_\sfx\():
  ds_read_b128 v[4:7], v133 offset:0
  ds_read_b32 v20, v134 offset:0
  ds_read_b128 v[8:11], v133 offset:3072
  ds_read_b32 v21, v134 offset:3072
  ds_read_b128 v[12:15], v133 offset:6144
  ds_read_b32 v22, v134 offset:6144
  ds_read_b128 v[16:19], v133 offset:9216
  ds_read_b32 v23, v134 offset:9216
  s_waitcnt lgkmcnt(4)
  v_pk_add_f32 v[4:5], v[4:5], v[8:9]
  v_pk_add_f32 v[6:7], v[6:7], v[10:11]
  v_add_f32 v20, v20, v21
  s_waitcnt lgkmcnt(0)
  v_pk_add_f32 v[12:13], v[12:13], v[16:17]
  v_pk_add_f32 v[14:15], v[14:15], v[18:19]
  v_add_f32 v22, v22, v23
  v_pk_add_f32 v[4:5], v[4:5], v[12:13]
  v_pk_add_f32 v[6:7], v[6:7], v[14:15]
  v_add_f32 v8, v20, v22
  v_pk_mul_f32 v[4:5], v[4:5], s[64:65]
  v_pk_mul_f32 v[6:7], v[6:7], s[64:65]
  v_mul_f32 v8, s64, v8
  v_max3_f32 v24, abs(v4), abs(v5), abs(v6)
  v_max3_f32 v24, v24, abs(v7), abs(v8)
  v_cmp_nlt_f32 vcc, v24, v137
  s_cbranch_vccz smx_78_go_\sfx\()
  v_max3_f32 v24, v4, v5, v6
  v_max3_f32 v24, v24, v7, v8
  s_nop 1
  v_max_f32_dpp v25, v24, v24 quad_perm:[1,0,3,2] row_mask:0xf bank_mask:0xf
  s_nop 1
  v_max_f32_dpp v24, v25, v25 quad_perm:[2,3,0,1] row_mask:0xf bank_mask:0xf
  s_nop 1
  v_max_f32_dpp v25, v24, v24 row_half_mirror row_mask:0xf bank_mask:0xf
  v_sub_f32 v4, v4, v25
  v_sub_f32 v5, v5, v25
  v_sub_f32 v6, v6, v25
  v_sub_f32 v7, v7, v25
  v_sub_f32 v8, v8, v25
smx_78_go_\sfx\():
  v_exp_f32 v4, v4
  v_exp_f32 v5, v5
  v_exp_f32 v6, v6
  v_exp_f32 v7, v7
  v_exp_f32 v8, v8
  v_add_f32 v24, v4, v5
  v_add_f32 v25, v6, v7
  v_add_f32 v24, v24, v8
  v_add_f32 v24, v24, v25
  s_nop 1
  v_add_f32_dpp v25, v24, v24 quad_perm:[1,0,3,2] row_mask:0xf bank_mask:0xf
  s_nop 1
  v_add_f32_dpp v24, v25, v25 quad_perm:[2,3,0,1] row_mask:0xf bank_mask:0xf
  s_nop 1
  v_add_f32_dpp v25, v24, v24 row_half_mirror row_mask:0xf bank_mask:0xf
  v_rcp_f32 v24, v25
  s_nop 0
  v_mul_f32 v8, v8, v24
  v_pk_mul_f32 v[4:5], v[4:5], v[24:25] op_sel_hi:[1,0]
  v_pk_mul_f32 v[6:7], v[6:7], v[24:25] op_sel_hi:[1,0]
  v_mov_b32_dpp v9, v8 quad_perm:[1,0,3,2] row_mask:0xf bank_mask:0xf
  v_cvt_pk_bf16_f32 v10, v4, v5
  v_cvt_pk_bf16_f32 v11, v6, v7
  buffer_store_dwordx2 v[10:11], v135, s[8:11], s49 offen \pol
  v_cvt_pk_bf16_f32 v12, v8, v9
  buffer_store_dword v12, v136, s[8:11], s49 offen \pol
  ds_write_b64 v131, v[44:45]
  ds_write_b64 v131, v[46:47] offset:512
  ds_write_b64 v131, v[106:107] offset:1024
  s_waitcnt lgkmcnt(0)
  s_barrier
  v_mov_b32 v60, 0
  v_mov_b32 v61, 0
  v_mov_b32 v62, 0
  v_mov_b32 v63, 0
  v_mov_b32 v64, 0
  v_mov_b32 v65, 0
  v_mov_b32 v66, 0
  v_mov_b32 v67, 0
  v_mov_b32 v68, 0
  v_mov_b32 v69, 0
  v_mov_b32 v70, 0
  v_mov_b32 v71, 0
  v_mov_b32 v72, 0
  v_mov_b32 v73, 0
  v_mov_b32 v74, 0
  v_mov_b32 v75, 0
  v_mov_b32 v36, 0
  v_mov_b32 v37, 0
  v_mov_b32 v38, 0
  v_mov_b32 v39, 0
  v_mov_b32 v40, 0
  v_mov_b32 v41, 0
  v_mov_b32 v42, 0
  v_mov_b32 v43, 0
  s_add_u32 s97, s97, 10240
  s_mov_b32 s48, s97
  s_add_u32 s49, s49, 5120
  s_add_u32 s98, s49, 5120
  s_add_u32 s50, s50, 12288
  s_add_u32 s63, s63, 12288
  s_add_u32 s51, s51, 1
  s_cmp_gt_u32 s52, s51
  s_cbranch_scc1 ka\sfx\()_x_wp_79_ok
  s_mov_b32 s45, 0
ka\sfx\()_x_wp_79_spin:
  buffer_load_dword v2, v138, s[8:11], 0 offen sc1
  s_add_u32 s45, s45, 1
  s_waitcnt vmcnt(0)
  v_min_u32_dpp v3, v2, v2 quad_perm:[1,0,3,2] row_mask:0xf bank_mask:0xf
  s_nop 1
  v_min_u32_dpp v2, v3, v3 quad_perm:[2,3,0,1] row_mask:0xf bank_mask:0xf
  s_nop 1
  v_min_u32_dpp v3, v2, v2 row_half_mirror row_mask:0xf bank_mask:0xf
  s_nop 1
  v_min_u32_dpp v2, v3, v3 quad_perm:[0,1,2,3] row_mask:0xf bank_mask:0xf
  s_nop 0
  v_readfirstlane_b32 s52, v2
  s_cmp_gt_u32 s52, s51
  s_cbranch_scc1 ka\sfx\()_x_wp_79_ok
  s_cmp_lt_u32 s45, 400000
  s_cbranch_scc1 ka\sfx\()_x_wp_79_spin
  s_branch ka\sfx\()_abort
ka\sfx\()_x_wp_79_ok:
  s_add_u32 s28, s50, s53
  buffer_load_dwordx2 v[88:89], v132, s[8:11], s28 offen offset:0 sc1
  buffer_load_dwordx2 v[92:93], v132, s[8:11], s28 offen offset:1024 sc1
  s_add_u32 s28, s50, s54
  buffer_load_dwordx2 v[90:91], v132, s[8:11], s28 offen offset:0 sc1
  buffer_load_dwordx2 v[94:95], v132, s[8:11], s28 offen offset:1024 sc1
  s_add_u32 s28, s50, s55
  buffer_load_dwordx2 v[96:97], v132, s[8:11], s28 offen offset:0 sc1
  buffer_load_dwordx2 v[98:99], v132, s[8:11], s28 offen offset:1024 sc1
  s_branch ka\sfx\()_x_w0l
ka\sfx\()_x_w1:
ka\sfx\()_x_w1l:
  ds_read_b128 v[44:47], v129 offset:0
  ds_read_b128 v[48:51], v129 offset:1024
  ds_read_b128 v[52:55], v129 offset:10240
  ds_read_b128 v[56:59], v129 offset:11264
  s_waitcnt lgkmcnt(0)
  s_mov_b32 s45, 0
ka\sfx\()_x_pf_80_pr:
  buffer_load_dword v139, v141, s[8:11], s48 offen sc1
  s_add_u32 s45, s45, 1
  s_waitcnt vmcnt(0)
  v_cmp_eq_u32 vcc, -1, v139
  s_cbranch_vccz ka\sfx\()_x_pf_80
  s_cmp_lt_u32 s45, 400000
  s_cbranch_scc1 ka\sfx\()_x_pf_80_pr
  s_branch ka\sfx\()_abort
ka\sfx\()_x_pf_80:
  buffer_load_dwordx4 v[112:115], v124, s[8:11], s48 offen sc1
  buffer_load_dwordx4 v[116:119], v125, s[8:11], s48 offen sc1
  buffer_load_dwordx4 v[120:123], v126, s[8:11], s48 offen sc1
  s_add_u32 s45, s45, 1
  s_waitcnt vmcnt(2)
  ds_write_b128 v127, v[112:115] offset:0
  v_max3_u32 v139, v112, v113, v114
  v_max_u32 v139, v139, v115
  s_waitcnt vmcnt(1)
  ds_write_b128 v127, v[116:119] offset:4096
  v_max3_u32 v139, v139, v116, v117
  v_max3_u32 v139, v139, v118, v119
  s_waitcnt vmcnt(0)
  ds_write_b128 v127, v[120:123] offset:8192
  v_max3_u32 v139, v139, v120, v121
  v_max3_u32 v139, v139, v122, v123
  v_cmp_eq_u32 vcc, -1, v139
  s_cbranch_vccz ka\sfx\()_x_pf_80_ok
  s_cmp_lt_u32 s45, 400000
  s_cbranch_scc1 ka\sfx\()_x_pf_80
  s_branch ka\sfx\()_abort
ka\sfx\()_x_pf_80_ok:
  v_smfmac_f32_16x16x64_bf16 v[60:63], v[112:115], a[8:15], v110
  v_smfmac_f32_16x16x64_bf16 v[64:67], v[112:115], v[44:51], v110
  ds_read_b128 v[44:47], v129 offset:20480
  v_smfmac_f32_16x16x64_bf16 v[68:71], v[112:115], a[88:95], v110
  ds_read_b128 v[48:51], v129 offset:21504
  v_smfmac_f32_16x16x64_bf16 v[72:75], v[112:115], v[52:59], v110
  ds_read_b128 v[52:55], v129 offset:4096
  s_waitcnt lgkmcnt(3)
  s_barrier
  v_smfmac_f32_16x16x64_bf16 v[36:39], v[112:115], a[168:175], v110
  ds_read_b128 v[56:59], v129 offset:5120
  ds_read_b128 v[4:7], v128 offset:0
  s_waitcnt lgkmcnt(3)
  v_smfmac_f32_16x16x64_bf16 v[40:43], v[112:115], v[44:51], v110
  ds_read_b128 v[44:47], v129 offset:14336
  ds_read_b128 v[8:11], v128 offset:2048
  v_smfmac_f32_16x16x64_bf16 v[60:63], v[116:119], a[40:47], v110
  ds_read_b128 v[48:51], v129 offset:15360
  ds_read_b128 v[12:15], v128 offset:3072
  s_waitcnt lgkmcnt(5)
  v_smfmac_f32_16x16x64_bf16 v[64:67], v[116:119], v[52:59], v110
  ds_read_b128 v[52:55], v129 offset:24576
  ds_read_b128 v[16:19], v128 offset:4096
  v_smfmac_f32_16x16x64_bf16 v[68:71], v[116:119], a[120:127], v110
  ds_read_b128 v[56:59], v129 offset:25600
  ds_read_b128 v[20:23], v128 offset:6144
  s_waitcnt lgkmcnt(5)
  v_smfmac_f32_16x16x64_bf16 v[72:75], v[116:119], v[44:51], v110
  ds_read_b128 v[44:47], v129 offset:8192
  ds_read_b128 v[24:27], v128 offset:7168
  v_smfmac_f32_16x16x64_bf16 v[36:39], v[116:119], a[200:207], v110
  ds_read_b128 v[48:51], v129 offset:9216
  ds_read_b128 v[28:31], v128 offset:8192
  s_waitcnt lgkmcnt(5)
  v_smfmac_f32_16x16x64_bf16 v[40:43], v[116:119], v[52:59], v110
  ds_read_b128 v[52:55], v129 offset:18432
  v_smfmac_f32_16x16x64_bf16 v[60:63], v[120:123], a[72:79], v110
  ds_read_b128 v[56:59], v129 offset:19456
  s_waitcnt lgkmcnt(3)
  v_smfmac_f32_16x16x64_bf16 v[64:67], v[120:123], v[44:51], v110
  ds_read_b128 v[44:47], v129 offset:28672
  v_smfmac_f32_16x16x64_bf16 v[68:71], v[120:123], a[152:159], v110
  ds_read_b128 v[48:51], v129 offset:29696
  s_waitcnt lgkmcnt(2)
  v_smfmac_f32_16x16x64_bf16 v[72:75], v[120:123], v[52:59], v110
  ds_read_b128 v[52:55], v129 offset:2048
  v_smfmac_f32_16x16x64_bf16 v[36:39], v[120:123], a[232:239], v110
  ds_read_b128 v[56:59], v129 offset:3072
  s_waitcnt lgkmcnt(2)
  v_smfmac_f32_16x16x64_bf16 v[40:43], v[120:123], v[44:51], v110
  ds_read_b128 v[44:47], v129 offset:6144
  v_smfmac_f32_16x16x64_bf16 v[60:63], v[4:7], a[0:7], v110
  ds_read_b128 v[48:51], v129 offset:7168
  v_smfmac_f32_16x16x64_bf16 v[64:67], v[4:7], a[240:247], v110
  v_smfmac_f32_16x16x64_bf16 v[60:63], v[8:11], a[16:23], v110
  v_smfmac_f32_16x16x64_bf16 v[64:67], v[8:11], a[248:255], v110
  v_smfmac_f32_16x16x64_bf16 v[60:63], v[12:15], a[24:31], v110
  s_waitcnt lgkmcnt(2)
  v_smfmac_f32_16x16x64_bf16 v[64:67], v[12:15], v[52:59], v110
  ds_read_b128 v[52:55], v129 offset:12288
  v_smfmac_f32_16x16x64_bf16 v[60:63], v[16:19], a[32:39], v110
  ds_read_b128 v[56:59], v129 offset:13312
  v_smfmac_f32_16x16x64_bf16 v[64:67], v[16:19], v[152:159], v110
  v_smfmac_f32_16x16x64_bf16 v[60:63], v[20:23], a[48:55], v110
  v_smfmac_f32_16x16x64_bf16 v[64:67], v[20:23], v[160:167], v110
  v_smfmac_f32_16x16x64_bf16 v[60:63], v[24:27], a[56:63], v110
  s_waitcnt lgkmcnt(2)
  v_smfmac_f32_16x16x64_bf16 v[64:67], v[24:27], v[44:51], v110
  ds_read_b128 v[44:47], v129 offset:16384
  v_smfmac_f32_16x16x64_bf16 v[60:63], v[28:31], a[64:71], v110
  ds_read_b128 v[48:51], v129 offset:17408
  v_smfmac_f32_16x16x64_bf16 v[64:67], v[28:31], v[168:175], v110
  v_smfmac_f32_16x16x64_bf16 v[68:71], v[4:7], a[80:87], v110
  v_smfmac_f32_16x16x64_bf16 v[72:75], v[4:7], v[176:183], v110
  v_permlane32_swap_b32 v60, v64
  v_smfmac_f32_16x16x64_bf16 v[68:71], v[8:11], a[96:103], v110
  v_smfmac_f32_16x16x64_bf16 v[72:75], v[8:11], v[184:191], v110
  v_permlane32_swap_b32 v61, v65
  v_smfmac_f32_16x16x64_bf16 v[68:71], v[12:15], a[104:111], v110
  s_waitcnt lgkmcnt(2)
  v_smfmac_f32_16x16x64_bf16 v[72:75], v[12:15], v[52:59], v110
  ds_read_b128 v[52:55], v129 offset:22528
  v_permlane32_swap_b32 v62, v66
  v_smfmac_f32_16x16x64_bf16 v[68:71], v[16:19], a[112:119], v110
  ds_read_b128 v[56:59], v129 offset:23552
  v_permlane32_swap_b32 v63, v67
  v_smfmac_f32_16x16x64_bf16 v[72:75], v[16:19], v[192:199], v110
  v_add_f32 v60, v60, v64
  v_smfmac_f32_16x16x64_bf16 v[68:71], v[20:23], a[128:135], v110
  v_add_f32 v61, v61, v65
  v_smfmac_f32_16x16x64_bf16 v[72:75], v[20:23], v[200:207], v110
  v_add_f32 v62, v62, v66
  v_smfmac_f32_16x16x64_bf16 v[68:71], v[24:27], a[136:143], v110
  v_add_f32 v63, v63, v67
  s_waitcnt lgkmcnt(2)
  v_smfmac_f32_16x16x64_bf16 v[72:75], v[24:27], v[44:51], v110
  ds_read_b128 v[44:47], v129 offset:26624
  v_cvt_pk_bf16_f32 v100, v60, v61
  v_smfmac_f32_16x16x64_bf16 v[68:71], v[28:31], a[144:151], v110
  ds_read_b128 v[48:51], v129 offset:27648
  v_cvt_pk_bf16_f32 v101, v62, v63
  v_smfmac_f32_16x16x64_bf16 v[72:75], v[28:31], v[208:215], v110
  v_smfmac_f32_16x16x64_bf16 v[36:39], v[4:7], a[160:167], v110
  v_smfmac_f32_16x16x64_bf16 v[40:43], v[4:7], v[216:223], v110
  v_permlane32_swap_b32 v68, v72
  v_smfmac_f32_16x16x64_bf16 v[36:39], v[8:11], a[176:183], v110
  v_smfmac_f32_16x16x64_bf16 v[40:43], v[8:11], v[224:231], v110
  v_permlane32_swap_b32 v69, v73
  v_smfmac_f32_16x16x64_bf16 v[36:39], v[12:15], a[184:191], v110
  s_waitcnt lgkmcnt(2)
  v_smfmac_f32_16x16x64_bf16 v[40:43], v[12:15], v[52:59], v110
  v_permlane32_swap_b32 v70, v74
  v_smfmac_f32_16x16x64_bf16 v[36:39], v[16:19], a[192:199], v110
  v_permlane32_swap_b32 v71, v75
  v_smfmac_f32_16x16x64_bf16 v[40:43], v[16:19], v[232:239], v110
  v_add_f32 v68, v68, v72
  v_smfmac_f32_16x16x64_bf16 v[36:39], v[20:23], a[208:215], v110
  v_add_f32 v69, v69, v73
  v_smfmac_f32_16x16x64_bf16 v[40:43], v[20:23], v[240:247], v110
  v_add_f32 v70, v70, v74
  v_smfmac_f32_16x16x64_bf16 v[36:39], v[24:27], a[216:223], v110
  v_add_f32 v71, v71, v75
  s_waitcnt lgkmcnt(0)
  v_smfmac_f32_16x16x64_bf16 v[40:43], v[24:27], v[44:51], v110
  v_cvt_pk_bf16_f32 v102, v68, v69
  v_smfmac_f32_16x16x64_bf16 v[36:39], v[28:31], a[224:231], v110
  v_cvt_pk_bf16_f32 v103, v70, v71
  v_smfmac_f32_16x16x64_bf16 v[40:43], v[28:31], v[248:255], v110
  v_mfma_f32_16x16x16_bf16 v[142:145], v[100:101], v[108:109], 0
  v_mfma_f32_16x16x16_bf16 v[146:149], v[102:103], v[108:109], 0
  s_nop 1
  v_permlane32_swap_b32 v36, v40
  v_permlane32_swap_b32 v37, v41
  v_permlane32_swap_b32 v38, v42
  v_permlane32_swap_b32 v39, v43
  v_add_f32 v36, v36, v40
  v_add_f32 v37, v37, v41
  v_add_f32 v38, v38, v42
  v_add_f32 v39, v39, v43
  v_cvt_pk_bf16_f32 v104, v36, v37
  v_cvt_pk_bf16_f32 v105, v38, v39
  v_cvt_pk_bf16_f32 v44, v142, v143
  v_cvt_pk_bf16_f32 v45, v144, v145
  v_mfma_f32_16x16x16_bf16 v[142:145], v[104:105], v[108:109], 0
  v_cvt_pk_bf16_f32 v46, v146, v147
  v_cvt_pk_bf16_f32 v47, v148, v149
  s_nop 1
  v_mfma_f32_16x16x32_bf16 v[76:79], v[44:47], v[44:47], 0
  v_mfma_f32_16x16x32_bf16 v[80:83], v[88:91], v[44:47], 0
  v_cvt_pk_bf16_f32 v106, v142, v143
  v_cvt_pk_bf16_f32 v107, v144, v145
  v_mfma_f32_16x16x32_bf16 v[84:87], v[92:95], v[44:47], 0
  s_nop 0
  v_mfma_f32_16x16x16_bf16 v[76:79], v[106:107], v[106:107], v[76:79]
  v_mfma_f32_16x16x16_bf16 v[80:83], v[96:97], v[106:107], v[80:83]
  v_mfma_f32_16x16x16_bf16 v[84:87], v[98:99], v[106:107], v[84:87]
  s_mov_b32 exec_lo, 0
  s_mov_b32 exec_hi, 0x00ff00ff
  s_nop 3
  ds_write_b128 v130, v[76:79]
  s_mov_b32 exec_lo, 0x00ff00ff
  ds_write_b128 v130, v[80:83] offset:1024
  s_nop 0
  ds_write_b128 v130, v[84:87] offset:2048
  s_mov_b64 exec, -1
  s_waitcnt lgkmcnt(0)
  s_barrier
  ds_write_b64 v131, v[44:45]
  ds_write_b64 v131, v[46:47] offset:512
  ds_write_b64 v131, v[106:107] offset:1024
  s_waitcnt lgkmcnt(0)
  s_cmp_ge_u32 s51, 63
  s_cbranch_scc1 ka\sfx\()_x_done
  s_barrier
  v_mov_b32 v60, 0
  v_mov_b32 v61, 0
  v_mov_b32 v62, 0
  v_mov_b32 v63, 0
  v_mov_b32 v64, 0
  v_mov_b32 v65, 0
  v_mov_b32 v66, 0
  v_mov_b32 v67, 0
  v_mov_b32 v68, 0
  v_mov_b32 v69, 0
  v_mov_b32 v70, 0
  v_mov_b32 v71, 0
  v_mov_b32 v72, 0
  v_mov_b32 v73, 0
  v_mov_b32 v74, 0
  v_mov_b32 v75, 0
  v_mov_b32 v36, 0
  v_mov_b32 v37, 0
  v_mov_b32 v38, 0
  v_mov_b32 v39, 0
  v_mov_b32 v40, 0
  v_mov_b32 v41, 0
  v_mov_b32 v42, 0
  v_mov_b32 v43, 0
  s_add_u32 s97, s97, 10240
  s_mov_b32 s48, s97
  s_add_u32 s49, s49, 5120
  s_add_u32 s98, s49, 5120
  s_add_u32 s50, s50, 12288
  s_add_u32 s63, s63, 12288
  s_add_u32 s51, s51, 1
  s_cmp_gt_u32 s52, s51
  s_cbranch_scc1 ka\sfx\()_x_wp_81_ok
  s_mov_b32 s45, 0
ka\sfx\()_x_wp_81_spin:
  buffer_load_dword v2, v138, s[8:11], 0 offen sc1
  s_add_u32 s45, s45, 1
  s_waitcnt vmcnt(0)
  v_min_u32_dpp v3, v2, v2 quad_perm:[1,0,3,2] row_mask:0xf bank_mask:0xf
  s_nop 1
  v_min_u32_dpp v2, v3, v3 quad_perm:[2,3,0,1] row_mask:0xf bank_mask:0xf
  s_nop 1
  v_min_u32_dpp v3, v2, v2 row_half_mirror row_mask:0xf bank_mask:0xf
  s_nop 1
  v_min_u32_dpp v2, v3, v3 quad_perm:[0,1,2,3] row_mask:0xf bank_mask:0xf
  s_nop 0
  v_readfirstlane_b32 s52, v2
  s_cmp_gt_u32 s52, s51
  s_cbranch_scc1 ka\sfx\()_x_wp_81_ok
  s_cmp_lt_u32 s45, 400000
  s_cbranch_scc1 ka\sfx\()_x_wp_81_spin
  s_branch ka\sfx\()_abort
ka\sfx\()_x_wp_81_ok:
  s_add_u32 s28, s50, s53
  buffer_load_dwordx2 v[88:89], v132, s[8:11], s28 offen offset:0 sc1
  buffer_load_dwordx2 v[92:93], v132, s[8:11], s28 offen offset:1024 sc1
  s_add_u32 s28, s50, s54
  buffer_load_dwordx2 v[90:91], v132, s[8:11], s28 offen offset:0 sc1
  buffer_load_dwordx2 v[94:95], v132, s[8:11], s28 offen offset:1024 sc1
  s_add_u32 s28, s50, s55
  buffer_load_dwordx2 v[96:97], v132, s[8:11], s28 offen offset:0 sc1
  buffer_load_dwordx2 v[98:99], v132, s[8:11], s28 offen offset:1024 sc1
  s_branch ka\sfx\()_x_w1l
ka\sfx\()_x_w23:
  s_sub_u32 s65, s21, 2
  s_and_b32 s26, s23, 7
  v_and_b32 v4, 15, v1
  v_lshrrev_b32 v5, 4, v1
  v_and_b32 v6, 1, v5
  v_lshlrev_b32 v6, 5, v6
  v_add_u32 v6, v6, v4
  v_lshlrev_b32 v6, 4, v6
  v_lshrrev_b32 v7, 1, v5
  v_lshlrev_b32 v7, 3, v7
  v_add_u32 v6, v6, v7
  s_lshl_b32 s28, s26, 1
  s_add_u32 s28, s28, s65
  s_lshl_b32 s28, s28, 10
  v_add_u32 v133, s28, v6
  s_lshr_b32 s28, s26, 2
  s_lshl_b32 s28, s28, 1
  s_add_u32 s28, s28, s65
  s_lshl_b32 s28, s28, 10
  s_and_b32 s29, s26, 1
  s_lshl_b32 s29, s29, 9
  s_add_u32 s28, s28, s29
  s_bfe_u32 s29, s26, 0x10001
  s_lshl_b32 s29, s29, 3
  s_add_u32 s28, s28, s29
  s_add_u32 s28, s28, 15872
  v_lshlrev_b32 v6, 4, v5
  v_add_u32 v6, v6, v4
  v_lshlrev_b32 v6, 4, v6
  v_add_u32 v6, s28, v6
  v_mov_b32 v7, 0x40000000
  v_cmp_le_u32 vcc, 2, v5
  s_nop 1
  v_cndmask_b32 v134, v7, v6, vcc
  v_mov_b32 v135, 0xf149f2ca
  v_lshlrev_b32 v6, 3, v1
  v_add_u32 v136, 145408, v6
  s_mul_i32 s94, s65, 6144
  s_add_u32 s94, s94, 151552
  v_add_u32 v137, s94, v132
  v_cmp_le_u32 s[66:67], 2, v5
  v_lshlrev_b32 v6, 2, v5
  v_sub_u32 v6, v4, v6
  v_cmp_le_i32 s[68:69], 0, v6
  v_cmp_le_i32 s[70:71], 1, v6
  v_cmp_le_i32 s[72:73], 2, v6
  v_cmp_le_i32 s[74:75], 3, v6
  s_nop 1
  s_cmp_eq_u32 s65, 0
  s_cselect_b64 s[76:77], s[68:69], -1
  s_cselect_b64 s[84:85], 0, s[68:69]
  s_cselect_b64 s[78:79], s[70:71], -1
  s_cselect_b64 s[86:87], 0, s[70:71]
  s_cselect_b64 s[80:81], s[72:73], -1
  s_cselect_b64 s[88:89], 0, s[72:73]
  s_cselect_b64 s[82:83], s[74:75], -1
  s_cselect_b64 s[90:91], 0, s[74:75]
  s_mul_i32 s92, s20, 1310720
  s_add_u32 s92, s92, 0xe00000
  s_lshl_b32 s93, s65, 10
  s_mov_b32 s64, 0x3dd53b95
  s_add_u32 s95, s63, s93
  s_add_u32 m0, s94, 0
  s_add_u32 s28, s95, 0
  buffer_load_dwordx4 v132, s[8:11], s28 offen sc1 lds
  s_add_u32 m0, s94, 1024
  s_add_u32 s28, s95, 2048
  buffer_load_dwordx4 v132, s[8:11], s28 offen sc1 lds
  s_add_u32 m0, s94, 2048
  s_add_u32 s28, s95, 4096
  buffer_load_dwordx4 v132, s[8:11], s28 offen sc1 lds
  s_add_u32 m0, s94, 3072
  s_add_u32 s28, s95, 6144
  buffer_load_dwordx4 v132, s[8:11], s28 offen sc1 lds
  s_add_u32 m0, s94, 4096
  s_add_u32 s28, s95, 8192
  buffer_load_dwordx4 v132, s[8:11], s28 offen sc1 lds
  s_add_u32 m0, s94, 5120
  s_add_u32 s28, s95, 10240
  buffer_load_dwordx4 v132, s[8:11], s28 offen sc1 lds
  s_cmp_eq_u32 s21, 3
  s_cbranch_scc1 ka\sfx\()_x_w3l
ka\sfx\()_x_w2l:
  ds_read_b128 v[44:47], v129 offset:0
  ds_read_b128 v[48:51], v129 offset:1024
  ds_read_b128 v[52:55], v129 offset:2048
  ds_read_b128 v[56:59], v129 offset:3072
  s_waitcnt lgkmcnt(0)
  s_mov_b32 s45, 0
ka\sfx\()_x_pf_82_pr:
  buffer_load_dword v139, v141, s[8:11], s48 offen sc1
  s_add_u32 s45, s45, 1
  s_waitcnt vmcnt(0)
  v_cmp_eq_u32 vcc, -1, v139
  s_cbranch_vccz ka\sfx\()_x_pf_82
  s_cmp_lt_u32 s45, 400000
  s_cbranch_scc1 ka\sfx\()_x_pf_82_pr
  s_branch ka\sfx\()_abort
ka\sfx\()_x_pf_82:
  buffer_load_dwordx4 v[112:115], v124, s[8:11], s48 offen sc1
  buffer_load_dwordx4 v[116:119], v125, s[8:11], s48 offen sc1
  s_add_u32 s45, s45, 1
  s_waitcnt vmcnt(1)
  ds_write_b128 v127, v[112:115] offset:0
  v_max3_u32 v139, v112, v113, v114
  v_max_u32 v139, v139, v115
  s_waitcnt vmcnt(0)
  ds_write_b128 v127, v[116:119] offset:4096
  v_max3_u32 v139, v139, v116, v117
  v_max3_u32 v139, v139, v118, v119
  v_cmp_eq_u32 vcc, -1, v139
  s_cbranch_vccz ka\sfx\()_x_pf_82_ok
  s_cmp_lt_u32 s45, 400000
  s_cbranch_scc1 ka\sfx\()_x_pf_82
  s_branch ka\sfx\()_abort
ka\sfx\()_x_pf_82_ok:
  v_smfmac_f32_16x16x64_bf16 v[60:63], v[112:115], a[16:23], v110
  v_smfmac_f32_16x16x64_bf16 v[64:67], v[112:115], a[248:255], v110
  v_smfmac_f32_16x16x64_bf16 v[68:71], v[112:115], a[96:103], v110
  v_smfmac_f32_16x16x64_bf16 v[72:75], v[112:115], v[184:191], v110
  s_waitcnt lgkmcnt(0)
  s_barrier
  v_smfmac_f32_16x16x64_bf16 v[36:39], v[112:115], a[176:183], v110
  ds_read_b128 v[4:7], v128 offset:0
  v_smfmac_f32_16x16x64_bf16 v[40:43], v[112:115], v[224:231], v110
  ds_read_b128 v[8:11], v128 offset:1024
  v_smfmac_f32_16x16x64_bf16 v[60:63], v[116:119], a[48:55], v110
  ds_read_b128 v[12:15], v128 offset:3072
  v_smfmac_f32_16x16x64_bf16 v[64:67], v[116:119], v[160:167], v110
  ds_read_b128 v[16:19], v128 offset:4096
  v_smfmac_f32_16x16x64_bf16 v[68:71], v[116:119], a[128:135], v110
  ds_read_b128 v[20:23], v128 offset:5120
  v_smfmac_f32_16x16x64_bf16 v[72:75], v[116:119], v[200:207], v110
  ds_read_b128 v[24:27], v128 offset:7168
  v_smfmac_f32_16x16x64_bf16 v[36:39], v[116:119], a[208:215], v110
  ds_read_b128 v[28:31], v128 offset:8192
  v_smfmac_f32_16x16x64_bf16 v[40:43], v[116:119], v[240:247], v110
  ds_read_b128 v[32:35], v128 offset:9216
  s_waitcnt lgkmcnt(7)
  v_smfmac_f32_16x16x64_bf16 v[60:63], v[4:7], a[0:7], v110
  v_smfmac_f32_16x16x64_bf16 v[64:67], v[4:7], a[240:247], v110
  s_waitcnt lgkmcnt(6)
  v_smfmac_f32_16x16x64_bf16 v[60:63], v[8:11], a[8:15], v110
  v_smfmac_f32_16x16x64_bf16 v[64:67], v[8:11], v[44:51], v110
  ds_read_b128 v[44:47], v129 offset:4096
  s_waitcnt lgkmcnt(6)
  v_smfmac_f32_16x16x64_bf16 v[60:63], v[12:15], a[24:31], v110
  ds_read_b128 v[48:51], v129 offset:5120
  v_smfmac_f32_16x16x64_bf16 v[64:67], v[12:15], v[52:59], v110
  ds_read_b128 v[52:55], v129 offset:6144
  s_waitcnt lgkmcnt(7)
  v_smfmac_f32_16x16x64_bf16 v[60:63], v[16:19], a[32:39], v110
  ds_read_b128 v[56:59], v129 offset:7168
  v_smfmac_f32_16x16x64_bf16 v[64:67], v[16:19], v[152:159], v110
  s_waitcnt lgkmcnt(7)
  v_smfmac_f32_16x16x64_bf16 v[60:63], v[20:23], a[40:47], v110
  s_waitcnt lgkmcnt(2)
  v_smfmac_f32_16x16x64_bf16 v[64:67], v[20:23], v[44:51], v110
  ds_read_b128 v[44:47], v129 offset:8192
  v_smfmac_f32_16x16x64_bf16 v[60:63], v[24:27], a[56:63], v110
  ds_read_b128 v[48:51], v129 offset:9216
  s_waitcnt lgkmcnt(2)
  v_smfmac_f32_16x16x64_bf16 v[64:67], v[24:27], v[52:59], v110
  ds_read_b128 v[52:55], v129 offset:10240
  v_smfmac_f32_16x16x64_bf16 v[60:63], v[28:31], a[64:71], v110
  ds_read_b128 v[56:59], v129 offset:11264
  v_smfmac_f32_16x16x64_bf16 v[64:67], v[28:31], v[168:175], v110
  v_smfmac_f32_16x16x64_bf16 v[60:63], v[32:35], a[72:79], v110
  s_waitcnt lgkmcnt(2)
  v_smfmac_f32_16x16x64_bf16 v[64:67], v[32:35], v[44:51], v110
  ds_read_b128 v[44:47], v129 offset:12288
  v_smfmac_f32_16x16x64_bf16 v[68:71], v[4:7], a[80:87], v110
  ds_read_b128 v[48:51], v129 offset:13312
  v_smfmac_f32_16x16x64_bf16 v[72:75], v[4:7], v[176:183], v110
  v_permlane32_swap_b32 v60, v64
  v_smfmac_f32_16x16x64_bf16 v[68:71], v[8:11], a[88:95], v110
  s_waitcnt lgkmcnt(2)
  v_smfmac_f32_16x16x64_bf16 v[72:75], v[8:11], v[52:59], v110
  ds_read_b128 v[52:55], v129 offset:14336
  v_permlane32_swap_b32 v61, v65
  v_smfmac_f32_16x16x64_bf16 v[68:71], v[12:15], a[104:111], v110
  ds_read_b128 v[56:59], v129 offset:15360
  s_waitcnt lgkmcnt(2)
  v_smfmac_f32_16x16x64_bf16 v[72:75], v[12:15], v[44:51], v110
  ds_read_b128 v[44:47], v129 offset:16384
  v_permlane32_swap_b32 v62, v66
  v_smfmac_f32_16x16x64_bf16 v[68:71], v[16:19], a[112:119], v110
  ds_read_b128 v[48:51], v129 offset:17408
  v_permlane32_swap_b32 v63, v67
  v_smfmac_f32_16x16x64_bf16 v[72:75], v[16:19], v[192:199], v110
  v_add_f32 v60, v60, v64
  v_smfmac_f32_16x16x64_bf16 v[68:71], v[20:23], a[120:127], v110
  v_add_f32 v61, v61, v65
  s_waitcnt lgkmcnt(2)
  v_smfmac_f32_16x16x64_bf16 v[72:75], v[20:23], v[52:59], v110
  ds_read_b128 v[52:55], v129 offset:18432
  v_add_f32 v62, v62, v66
  v_smfmac_f32_16x16x64_bf16 v[68:71], v[24:27], a[136:143], v110
  ds_read_b128 v[56:59], v129 offset:19456
  v_add_f32 v63, v63, v67
  s_waitcnt lgkmcnt(2)
  v_smfmac_f32_16x16x64_bf16 v[72:75], v[24:27], v[44:51], v110
  ds_read_b128 v[44:47], v129 offset:20480
  v_cvt_pk_bf16_f32 v100, v60, v61
  v_smfmac_f32_16x16x64_bf16 v[68:71], v[28:31], a[144:151], v110
  ds_read_b128 v[48:51], v129 offset:21504
  v_cvt_pk_bf16_f32 v101, v62, v63
  v_smfmac_f32_16x16x64_bf16 v[72:75], v[28:31], v[208:215], v110
  v_smfmac_f32_16x16x64_bf16 v[68:71], v[32:35], a[152:159], v110
  s_waitcnt lgkmcnt(2)
  v_smfmac_f32_16x16x64_bf16 v[72:75], v[32:35], v[52:59], v110
  ds_read_b128 v[52:55], v129 offset:22528
  v_smfmac_f32_16x16x64_bf16 v[36:39], v[4:7], a[160:167], v110
  ds_read_b128 v[56:59], v129 offset:23552
  v_smfmac_f32_16x16x64_bf16 v[40:43], v[4:7], v[216:223], v110
  v_permlane32_swap_b32 v68, v72
  v_smfmac_f32_16x16x64_bf16 v[36:39], v[8:11], a[168:175], v110
  s_waitcnt lgkmcnt(2)
  v_smfmac_f32_16x16x64_bf16 v[40:43], v[8:11], v[44:51], v110
  ds_read_b128 v[44:47], v129 offset:24576
  v_permlane32_swap_b32 v69, v73
  v_smfmac_f32_16x16x64_bf16 v[36:39], v[12:15], a[184:191], v110
  ds_read_b128 v[48:51], v129 offset:25600
  s_waitcnt lgkmcnt(2)
  v_smfmac_f32_16x16x64_bf16 v[40:43], v[12:15], v[52:59], v110
  ds_read_b128 v[52:55], v129 offset:26624
  v_permlane32_swap_b32 v70, v74
  v_smfmac_f32_16x16x64_bf16 v[36:39], v[16:19], a[192:199], v110
  ds_read_b128 v[56:59], v129 offset:27648
  v_permlane32_swap_b32 v71, v75
  v_smfmac_f32_16x16x64_bf16 v[40:43], v[16:19], v[232:239], v110
  v_add_f32 v68, v68, v72
  v_smfmac_f32_16x16x64_bf16 v[36:39], v[20:23], a[200:207], v110
  v_add_f32 v69, v69, v73
  s_waitcnt lgkmcnt(2)
  v_smfmac_f32_16x16x64_bf16 v[40:43], v[20:23], v[44:51], v110
  ds_read_b128 v[44:47], v129 offset:28672
  v_add_f32 v70, v70, v74
  v_smfmac_f32_16x16x64_bf16 v[36:39], v[24:27], a[216:223], v110
  ds_read_b128 v[48:51], v129 offset:29696
  v_add_f32 v71, v71, v75
  s_waitcnt lgkmcnt(2)
  v_smfmac_f32_16x16x64_bf16 v[40:43], v[24:27], v[52:59], v110
  v_cvt_pk_bf16_f32 v102, v68, v69
  v_smfmac_f32_16x16x64_bf16 v[36:39], v[28:31], a[224:231], v110
  v_cvt_pk_bf16_f32 v103, v70, v71
  v_smfmac_f32_16x16x64_bf16 v[40:43], v[28:31], v[248:255], v110
  v_smfmac_f32_16x16x64_bf16 v[36:39], v[32:35], a[232:239], v110
  s_waitcnt lgkmcnt(0)
  v_smfmac_f32_16x16x64_bf16 v[40:43], v[32:35], v[44:51], v110
  v_mfma_f32_16x16x16_bf16 v[142:145], v[100:101], v[108:109], 0
  v_mfma_f32_16x16x16_bf16 v[146:149], v[102:103], v[108:109], 0
  s_nop 1
  v_permlane32_swap_b32 v36, v40
  v_permlane32_swap_b32 v37, v41
  v_permlane32_swap_b32 v38, v42
  v_permlane32_swap_b32 v39, v43
  v_add_f32 v36, v36, v40
  v_add_f32 v37, v37, v41
  v_add_f32 v38, v38, v42
  v_add_f32 v39, v39, v43
  v_cvt_pk_bf16_f32 v104, v36, v37
  v_cvt_pk_bf16_f32 v105, v38, v39
  v_cvt_pk_bf16_f32 v44, v142, v143
  v_cvt_pk_bf16_f32 v45, v144, v145
  v_mfma_f32_16x16x16_bf16 v[142:145], v[104:105], v[108:109], 0
  v_cvt_pk_bf16_f32 v46, v146, v147
  v_cvt_pk_bf16_f32 v47, v148, v149
  s_nop 1
  v_mfma_f32_16x16x32_bf16 v[76:79], v[44:47], v[44:47], 0
  v_mfma_f32_16x16x32_bf16 v[80:83], v[88:91], v[44:47], 0
  v_cvt_pk_bf16_f32 v106, v142, v143
  v_cvt_pk_bf16_f32 v107, v144, v145
  v_mfma_f32_16x16x32_bf16 v[84:87], v[92:95], v[44:47], 0
  s_nop 0
  v_mfma_f32_16x16x16_bf16 v[76:79], v[106:107], v[106:107], v[76:79]
  v_mfma_f32_16x16x16_bf16 v[80:83], v[96:97], v[106:107], v[80:83]
  v_mfma_f32_16x16x16_bf16 v[84:87], v[98:99], v[106:107], v[84:87]
  s_mov_b32 exec_lo, 0
  s_mov_b32 exec_hi, 0x00ff00ff
  s_nop 3
  ds_write_b128 v130, v[76:79]
  s_mov_b32 exec_lo, 0x00ff00ff
  ds_write_b128 v130, v[80:83] offset:1024
  s_nop 0
  ds_write_b128 v130, v[84:87] offset:2048
  s_mov_b64 exec, -1
  s_waitcnt lgkmcnt(0)
  s_barrier
  ds_write_b64 v131, v[44:45]
  ds_write_b64 v131, v[46:47] offset:512
  ds_write_b64 v131, v[106:107] offset:1024
  ds_read_b128 v[44:47], v137 offset:0
  ds_read_b128 v[48:51], v137 offset:1024
  ds_read_b128 v[52:55], v137 offset:2048
  ds_read_b128 v[56:59], v137 offset:3072
  ds_read_b128 v[68:71], v137 offset:4096
  ds_read_b128 v[72:75], v137 offset:5120
  s_waitcnt lgkmcnt(0)
  s_barrier
  s_mov_b32 s28, s50
  buffer_load_dwordx4 v[4:7], v132, s[8:11], s28 offen sc1
  buffer_load_dwordx4 v[8:11], v132, s[8:11], s28 offen offset:1024 sc1
  s_add_u32 s28, s28, 2048
  buffer_load_dwordx4 v[12:15], v132, s[8:11], s28 offen sc1
  buffer_load_dwordx4 v[16:19], v132, s[8:11], s28 offen offset:1024 sc1
  s_add_u32 s28, s28, 2048
  buffer_load_dwordx4 v[20:23], v132, s[8:11], s28 offen sc1
  buffer_load_dwordx4 v[24:27], v132, s[8:11], s28 offen offset:1024 sc1
  s_add_u32 s28, s28, 2048
  buffer_load_dwordx4 v[28:31], v132, s[8:11], s28 offen sc1
  buffer_load_dwordx4 v[32:35], v132, s[8:11], s28 offen offset:1024 sc1
  s_add_u32 s28, s28, 2048
  buffer_load_dwordx4 v[36:39], v132, s[8:11], s28 offen sc1
  buffer_load_dwordx4 v[40:43], v132, s[8:11], s28 offen offset:1024 sc1
  s_add_u32 s28, s28, 2048
  buffer_load_dwordx4 v[60:63], v132, s[8:11], s28 offen sc1
  buffer_load_dwordx4 v[64:67], v132, s[8:11], s28 offen offset:1024 sc1
  s_add_u32 s28, s28, 2048
  ds_read_b64 v[76:77], v136 offset:0
  ds_read_b64 v[78:79], v136 offset:512
  ds_read_b64 v[80:81], v136 offset:1024
  ds_read_b64 v[82:83], v136 offset:1536
  ds_read_b64 v[84:85], v136 offset:2048
  ds_read_b64 v[86:87], v136 offset:2560
  ds_read_b64 v[88:89], v136 offset:3072
  ds_read_b64 v[90:91], v136 offset:3584
  ds_read_b64 v[92:93], v136 offset:4096
  ds_read_b64 v[94:95], v136 offset:4608
  ds_read_b64 v[96:97], v136 offset:5120
  ds_read_b64 v[98:99], v136 offset:5632
  s_waitcnt lgkmcnt(0)
  s_cmp_ge_u32 s51, 63
  s_cbranch_scc1 xq_83_\sfx\()
  s_add_u32 s96, s51, 1
  s_cmp_gt_u32 s52, s96
  s_cbranch_scc1 ka\sfx\()_x_wp_84_ok
  s_mov_b32 s45, 0
ka\sfx\()_x_wp_84_spin:
  buffer_load_dword v2, v138, s[8:11], 0 offen sc1
  s_add_u32 s45, s45, 1
  s_waitcnt vmcnt(0)
  v_min_u32_dpp v3, v2, v2 quad_perm:[1,0,3,2] row_mask:0xf bank_mask:0xf
  s_nop 1
  v_min_u32_dpp v2, v3, v3 quad_perm:[2,3,0,1] row_mask:0xf bank_mask:0xf
  s_nop 1
  v_min_u32_dpp v3, v2, v2 row_half_mirror row_mask:0xf bank_mask:0xf
  s_nop 1
  v_min_u32_dpp v2, v3, v3 quad_perm:[0,1,2,3] row_mask:0xf bank_mask:0xf
  s_nop 0
  v_readfirstlane_b32 s52, v2
  s_cmp_gt_u32 s52, s96
  s_cbranch_scc1 ka\sfx\()_x_wp_84_ok
  s_cmp_lt_u32 s45, 400000
  s_cbranch_scc1 ka\sfx\()_x_wp_84_spin
  s_branch ka\sfx\()_abort
ka\sfx\()_x_wp_84_ok:
  s_add_u32 s95, s63, s93
  s_add_u32 s95, s95, 12288
  s_add_u32 m0, s94, 0
  s_add_u32 s28, s95, 0
  buffer_load_dwordx4 v132, s[8:11], s28 offen sc1 lds
  s_add_u32 m0, s94, 1024
  s_add_u32 s28, s95, 2048
  buffer_load_dwordx4 v132, s[8:11], s28 offen sc1 lds
  s_add_u32 m0, s94, 2048
  s_add_u32 s28, s95, 4096
  buffer_load_dwordx4 v132, s[8:11], s28 offen sc1 lds
  s_add_u32 m0, s94, 3072
  s_add_u32 s28, s95, 6144
  buffer_load_dwordx4 v132, s[8:11], s28 offen sc1 lds
  s_add_u32 m0, s94, 4096
  s_add_u32 s28, s95, 8192
  buffer_load_dwordx4 v132, s[8:11], s28 offen sc1 lds
  s_add_u32 m0, s94, 5120
  s_add_u32 s28, s95, 10240
  buffer_load_dwordx4 v132, s[8:11], s28 offen sc1 lds
  s_branch xq_83_j_\sfx\()
xq_83_\sfx\():
  s_waitcnt vmcnt(0)
xq_83_j_\sfx\():
  s_waitcnt vmcnt(16)
  v_mfma_f32_16x16x32_bf16 v[112:115], v[76:79], v[44:47], 0
  v_mfma_f32_16x16x32_bf16 v[116:119], v[4:7], v[44:47], 0
  v_mfma_f32_16x16x32_bf16 v[120:123], v[8:11], v[44:47], 0
  s_waitcnt vmcnt(14)
  v_mfma_f32_16x16x32_bf16 v[112:115], v[80:83], v[48:51], v[112:115]
  v_mfma_f32_16x16x32_bf16 v[116:119], v[12:15], v[48:51], v[116:119]
  v_mfma_f32_16x16x32_bf16 v[120:123], v[16:19], v[48:51], v[120:123]
  s_waitcnt vmcnt(12)
  v_mfma_f32_16x16x32_bf16 v[112:115], v[84:87], v[52:55], v[112:115]
  v_mfma_f32_16x16x32_bf16 v[116:119], v[20:23], v[52:55], v[116:119]
  v_mfma_f32_16x16x32_bf16 v[120:123], v[24:27], v[52:55], v[120:123]
  s_waitcnt vmcnt(10)
  v_mfma_f32_16x16x32_bf16 v[112:115], v[88:91], v[56:59], v[112:115]
  v_mfma_f32_16x16x32_bf16 v[116:119], v[28:31], v[56:59], v[116:119]
  v_mfma_f32_16x16x32_bf16 v[120:123], v[32:35], v[56:59], v[120:123]
  s_waitcnt vmcnt(8)
  v_mfma_f32_16x16x32_bf16 v[112:115], v[92:95], v[68:71], v[112:115]
  v_mfma_f32_16x16x32_bf16 v[116:119], v[36:39], v[68:71], v[116:119]
  v_mfma_f32_16x16x32_bf16 v[120:123], v[40:43], v[68:71], v[120:123]
  s_waitcnt vmcnt(6)
  v_mfma_f32_16x16x32_bf16 v[112:115], v[96:99], v[72:75], v[112:115]
  v_mfma_f32_16x16x32_bf16 v[116:119], v[60:63], v[72:75], v[116:119]
  v_mfma_f32_16x16x32_bf16 v[120:123], v[64:67], v[72:75], v[120:123]
  s_nop 8
  v_cndmask_b32 v112, v135, v112, s[66:67]
  v_cndmask_b32 v113, v135, v113, s[66:67]
  v_cndmask_b32 v114, v135, v114, s[66:67]
  v_cndmask_b32 v115, v135, v115, s[66:67]
  v_cndmask_b32 v116, v135, v116, s[76:77]
  v_cndmask_b32 v120, v135, v120, s[84:85]
  v_cndmask_b32 v117, v135, v117, s[78:79]
  v_cndmask_b32 v121, v135, v121, s[86:87]
  v_cndmask_b32 v118, v135, v118, s[80:81]
  v_cndmask_b32 v122, v135, v122, s[88:89]
  v_cndmask_b32 v119, v135, v119, s[82:83]
  v_cndmask_b32 v123, v135, v123, s[90:91]
  v_max3_f32 v4, v112, v113, v114
  v_max3_f32 v5, v115, v116, v117
  v_max3_f32 v6, v118, v119, v120
  v_max3_f32 v7, v121, v122, v123
  v_max3_f32 v4, v4, v5, v6
  v_max_f32 v4, v4, v7
  v_mov_b32 v5, v4
  s_nop 1
  v_permlane16_swap_b32 v4, v5
  v_max_f32 v4, v4, v5
  v_mov_b32 v5, v4
  s_nop 1
  v_permlane32_swap_b32 v4, v5
  v_max_f32 v4, v4, v5
  v_mul_f32 v4, s64, v4
  v_fma_f32 v112, v112, s64, -v4
  v_fma_f32 v113, v113, s64, -v4
  v_fma_f32 v114, v114, s64, -v4
  v_fma_f32 v115, v115, s64, -v4
  v_fma_f32 v116, v116, s64, -v4
  v_fma_f32 v117, v117, s64, -v4
  v_fma_f32 v118, v118, s64, -v4
  v_fma_f32 v119, v119, s64, -v4
  v_fma_f32 v120, v120, s64, -v4
  v_fma_f32 v121, v121, s64, -v4
  v_fma_f32 v122, v122, s64, -v4
  v_fma_f32 v123, v123, s64, -v4
  v_exp_f32 v112, v112
  v_exp_f32 v113, v113
  v_exp_f32 v114, v114
  v_exp_f32 v115, v115
  v_exp_f32 v116, v116
  v_exp_f32 v117, v117
  v_exp_f32 v118, v118
  v_exp_f32 v119, v119
  v_exp_f32 v120, v120
  v_exp_f32 v121, v121
  v_exp_f32 v122, v122
  v_exp_f32 v123, v123
  v_add_f32 v5, v112, v113
  v_add_f32 v6, v114, v115
  v_add_f32 v7, v116, v117
  v_add_f32 v8, v118, v119
  v_add_f32 v9, v120, v121
  v_add_f32 v10, v122, v123
  v_add_f32 v5, v5, v6
  v_add_f32 v7, v7, v8
  v_add_f32 v9, v9, v10
  v_add_f32 v5, v5, v7
  v_add_f32 v5, v5, v9
  v_mov_b32 v6, v5
  s_nop 1
  v_permlane16_swap_b32 v5, v6
  v_add_f32 v5, v5, v6
  v_mov_b32 v6, v5
  s_nop 1
  v_permlane32_swap_b32 v5, v6
  v_add_f32 v5, v5, v6
  v_rcp_f32 v5, v5
  s_nop 0
  v_mul_f32 v112, v112, v5
  v_mul_f32 v113, v113, v5
  v_mul_f32 v114, v114, v5
  v_mul_f32 v115, v115, v5
  v_mul_f32 v116, v116, v5
  v_mul_f32 v117, v117, v5
  v_mul_f32 v118, v118, v5
  v_mul_f32 v119, v119, v5
  v_mul_f32 v120, v120, v5
  v_mul_f32 v121, v121, v5
  v_mul_f32 v122, v122, v5
  v_mul_f32 v123, v123, v5
  v_cvt_pk_bf16_f32 v8, v112, v113
  v_cvt_pk_bf16_f32 v9, v114, v115
  v_cvt_pk_bf16_f32 v10, v116, v117
  v_cvt_pk_bf16_f32 v11, v118, v119
  v_cvt_pk_bf16_f32 v12, v120, v121
  v_cvt_pk_bf16_f32 v13, v122, v123
  buffer_store_dwordx2 v[10:11], v133, s[8:11], s92 offen \pol
  buffer_store_dwordx2 v[12:13], v133, s[8:11], s92 offen offset:256 \pol
  buffer_store_dwordx2 v[8:9], v134, s[8:11], s92 offen \pol
  s_add_u32 s92, s92, 20480
  s_cmp_ge_u32 s51, 63
  s_cbranch_scc1 ka\sfx\()_x_done
  v_mov_b32 v60, 0
  v_mov_b32 v61, 0
  v_mov_b32 v62, 0
  v_mov_b32 v63, 0
  v_mov_b32 v64, 0
  v_mov_b32 v65, 0
  v_mov_b32 v66, 0
  v_mov_b32 v67, 0
  v_mov_b32 v68, 0
  v_mov_b32 v69, 0
  v_mov_b32 v70, 0
  v_mov_b32 v71, 0
  v_mov_b32 v72, 0
  v_mov_b32 v73, 0
  v_mov_b32 v74, 0
  v_mov_b32 v75, 0
  v_mov_b32 v36, 0
  v_mov_b32 v37, 0
  v_mov_b32 v38, 0
  v_mov_b32 v39, 0
  v_mov_b32 v40, 0
  v_mov_b32 v41, 0
  v_mov_b32 v42, 0
  v_mov_b32 v43, 0
  s_add_u32 s97, s97, 10240
  s_mov_b32 s48, s97
  s_add_u32 s49, s49, 5120
  s_add_u32 s98, s49, 5120
  s_add_u32 s50, s50, 12288
  s_add_u32 s63, s63, 12288
  s_add_u32 s51, s51, 1
  s_cmp_gt_u32 s52, s51
  s_cbranch_scc1 ka\sfx\()_x_wp_85_ok
  s_mov_b32 s45, 0
ka\sfx\()_x_wp_85_spin:
  buffer_load_dword v2, v138, s[8:11], 0 offen sc1
  s_add_u32 s45, s45, 1
  s_waitcnt vmcnt(0)
  v_min_u32_dpp v3, v2, v2 quad_perm:[1,0,3,2] row_mask:0xf bank_mask:0xf
  s_nop 1
  v_min_u32_dpp v2, v3, v3 quad_perm:[2,3,0,1] row_mask:0xf bank_mask:0xf
  s_nop 1
  v_min_u32_dpp v3, v2, v2 row_half_mirror row_mask:0xf bank_mask:0xf
  s_nop 1
  v_min_u32_dpp v2, v3, v3 quad_perm:[0,1,2,3] row_mask:0xf bank_mask:0xf
  s_nop 0
  v_readfirstlane_b32 s52, v2
  s_cmp_gt_u32 s52, s51
  s_cbranch_scc1 ka\sfx\()_x_wp_85_ok
  s_cmp_lt_u32 s45, 400000
  s_cbranch_scc1 ka\sfx\()_x_wp_85_spin
  s_branch ka\sfx\()_abort
ka\sfx\()_x_wp_85_ok:
  s_add_u32 s28, s50, s53
  buffer_load_dwordx2 v[88:89], v132, s[8:11], s28 offen offset:0 sc1
  buffer_load_dwordx2 v[92:93], v132, s[8:11], s28 offen offset:1024 sc1
  s_add_u32 s28, s50, s54
  buffer_load_dwordx2 v[90:91], v132, s[8:11], s28 offen offset:0 sc1
  buffer_load_dwordx2 v[94:95], v132, s[8:11], s28 offen offset:1024 sc1
  s_add_u32 s28, s50, s55
  buffer_load_dwordx2 v[96:97], v132, s[8:11], s28 offen offset:0 sc1
  buffer_load_dwordx2 v[98:99], v132, s[8:11], s28 offen offset:1024 sc1
  s_branch ka\sfx\()_x_w2l
ka\sfx\()_x_w3l:
  ds_read_b128 v[44:47], v129 offset:2048
  ds_read_b128 v[48:51], v129 offset:3072
  ds_read_b128 v[52:55], v129 offset:12288
  ds_read_b128 v[56:59], v129 offset:13312
  s_waitcnt lgkmcnt(0)
  s_mov_b32 s45, 0
ka\sfx\()_x_pf_86_pr:
  buffer_load_dword v139, v141, s[8:11], s48 offen sc1
  s_add_u32 s45, s45, 1
  s_waitcnt vmcnt(0)
  v_cmp_eq_u32 vcc, -1, v139
  s_cbranch_vccz ka\sfx\()_x_pf_86
  s_cmp_lt_u32 s45, 400000
  s_cbranch_scc1 ka\sfx\()_x_pf_86_pr
  s_branch ka\sfx\()_abort
ka\sfx\()_x_pf_86:
  buffer_load_dwordx4 v[112:115], v124, s[8:11], s48 offen sc1
  buffer_load_dwordx4 v[116:119], v125, s[8:11], s48 offen sc1
  s_add_u32 s45, s45, 1
  s_waitcnt vmcnt(1)
  ds_write_b128 v127, v[112:115] offset:0
  v_max3_u32 v139, v112, v113, v114
  v_max_u32 v139, v139, v115
  s_waitcnt vmcnt(0)
  ds_write_b128 v127, v[116:119] offset:4096
  v_max3_u32 v139, v139, v116, v117
  v_max3_u32 v139, v139, v118, v119
  v_cmp_eq_u32 vcc, -1, v139
  s_cbranch_vccz ka\sfx\()_x_pf_86_ok
  s_cmp_lt_u32 s45, 400000
  s_cbranch_scc1 ka\sfx\()_x_pf_86
  s_branch ka\sfx\()_abort
ka\sfx\()_x_pf_86_ok:
  v_smfmac_f32_16x16x64_bf16 v[60:63], v[112:115], a[24:31], v110
  v_smfmac_f32_16x16x64_bf16 v[64:67], v[112:115], v[44:51], v110
  ds_read_b128 v[44:47], v129 offset:22528
  v_smfmac_f32_16x16x64_bf16 v[68:71], v[112:115], a[104:111], v110
  ds_read_b128 v[48:51], v129 offset:23552
  v_smfmac_f32_16x16x64_bf16 v[72:75], v[112:115], v[52:59], v110
  ds_read_b128 v[52:55], v129 offset:6144
  s_waitcnt lgkmcnt(3)
  s_barrier
  v_smfmac_f32_16x16x64_bf16 v[36:39], v[112:115], a[184:191], v110
  ds_read_b128 v[56:59], v129 offset:7168
  ds_read_b128 v[4:7], v128 offset:0
  s_waitcnt lgkmcnt(3)
  v_smfmac_f32_16x16x64_bf16 v[40:43], v[112:115], v[44:51], v110
  ds_read_b128 v[44:47], v129 offset:16384
  ds_read_b128 v[8:11], v128 offset:1024
  v_smfmac_f32_16x16x64_bf16 v[60:63], v[116:119], a[56:63], v110
  ds_read_b128 v[48:51], v129 offset:17408
  ds_read_b128 v[12:15], v128 offset:2048
  s_waitcnt lgkmcnt(5)
  v_smfmac_f32_16x16x64_bf16 v[64:67], v[116:119], v[52:59], v110
  ds_read_b128 v[52:55], v129 offset:26624
  ds_read_b128 v[16:19], v128 offset:4096
  v_smfmac_f32_16x16x64_bf16 v[68:71], v[116:119], a[136:143], v110
  ds_read_b128 v[56:59], v129 offset:27648
  ds_read_b128 v[20:23], v128 offset:5120
  s_waitcnt lgkmcnt(5)
  v_smfmac_f32_16x16x64_bf16 v[72:75], v[116:119], v[44:51], v110
  ds_read_b128 v[44:47], v129 offset:0
  ds_read_b128 v[24:27], v128 offset:6144
  v_smfmac_f32_16x16x64_bf16 v[36:39], v[116:119], a[216:223], v110
  ds_read_b128 v[48:51], v129 offset:1024
  ds_read_b128 v[28:31], v128 offset:8192
  s_waitcnt lgkmcnt(5)
  v_smfmac_f32_16x16x64_bf16 v[40:43], v[116:119], v[52:59], v110
  ds_read_b128 v[52:55], v129 offset:4096
  ds_read_b128 v[32:35], v128 offset:9216
  v_smfmac_f32_16x16x64_bf16 v[60:63], v[4:7], a[0:7], v110
  ds_read_b128 v[56:59], v129 offset:5120
  v_smfmac_f32_16x16x64_bf16 v[64:67], v[4:7], a[240:247], v110
  v_smfmac_f32_16x16x64_bf16 v[60:63], v[8:11], a[8:15], v110
  s_waitcnt lgkmcnt(4)
  v_smfmac_f32_16x16x64_bf16 v[64:67], v[8:11], v[44:51], v110
  ds_read_b128 v[44:47], v129 offset:8192
  v_smfmac_f32_16x16x64_bf16 v[60:63], v[12:15], a[16:23], v110
  ds_read_b128 v[48:51], v129 offset:9216
  v_smfmac_f32_16x16x64_bf16 v[64:67], v[12:15], a[248:255], v110
  v_smfmac_f32_16x16x64_bf16 v[60:63], v[16:19], a[32:39], v110
  v_smfmac_f32_16x16x64_bf16 v[64:67], v[16:19], v[152:159], v110
  v_smfmac_f32_16x16x64_bf16 v[60:63], v[20:23], a[40:47], v110
  s_waitcnt lgkmcnt(2)
  v_smfmac_f32_16x16x64_bf16 v[64:67], v[20:23], v[52:59], v110
  ds_read_b128 v[52:55], v129 offset:10240
  v_smfmac_f32_16x16x64_bf16 v[60:63], v[24:27], a[48:55], v110
  ds_read_b128 v[56:59], v129 offset:11264
  v_smfmac_f32_16x16x64_bf16 v[64:67], v[24:27], v[160:167], v110
  v_smfmac_f32_16x16x64_bf16 v[60:63], v[28:31], a[64:71], v110
  v_smfmac_f32_16x16x64_bf16 v[64:67], v[28:31], v[168:175], v110
  v_smfmac_f32_16x16x64_bf16 v[60:63], v[32:35], a[72:79], v110
  s_waitcnt lgkmcnt(2)
  v_smfmac_f32_16x16x64_bf16 v[64:67], v[32:35], v[44:51], v110
  ds_read_b128 v[44:47], v129 offset:14336
  v_smfmac_f32_16x16x64_bf16 v[68:71], v[4:7], a[80:87], v110
  ds_read_b128 v[48:51], v129 offset:15360
  v_smfmac_f32_16x16x64_bf16 v[72:75], v[4:7], v[176:183], v110
  v_permlane32_swap_b32 v60, v64
  v_smfmac_f32_16x16x64_bf16 v[68:71], v[8:11], a[88:95], v110
  s_waitcnt lgkmcnt(2)
  v_smfmac_f32_16x16x64_bf16 v[72:75], v[8:11], v[52:59], v110
  ds_read_b128 v[52:55], v129 offset:18432
  v_permlane32_swap_b32 v61, v65
  v_smfmac_f32_16x16x64_bf16 v[68:71], v[12:15], a[96:103], v110
  ds_read_b128 v[56:59], v129 offset:19456
  v_smfmac_f32_16x16x64_bf16 v[72:75], v[12:15], v[184:191], v110
  v_permlane32_swap_b32 v62, v66
  v_smfmac_f32_16x16x64_bf16 v[68:71], v[16:19], a[112:119], v110
  v_permlane32_swap_b32 v63, v67
  v_smfmac_f32_16x16x64_bf16 v[72:75], v[16:19], v[192:199], v110
  v_add_f32 v60, v60, v64
  v_smfmac_f32_16x16x64_bf16 v[68:71], v[20:23], a[120:127], v110
  v_add_f32 v61, v61, v65
  s_waitcnt lgkmcnt(2)
  v_smfmac_f32_16x16x64_bf16 v[72:75], v[20:23], v[44:51], v110
  ds_read_b128 v[44:47], v129 offset:20480
  v_add_f32 v62, v62, v66
  v_smfmac_f32_16x16x64_bf16 v[68:71], v[24:27], a[128:135], v110
  ds_read_b128 v[48:51], v129 offset:21504
  v_add_f32 v63, v63, v67
  v_smfmac_f32_16x16x64_bf16 v[72:75], v[24:27], v[200:207], v110
  v_cvt_pk_bf16_f32 v100, v60, v61
  v_smfmac_f32_16x16x64_bf16 v[68:71], v[28:31], a[144:151], v110
  v_cvt_pk_bf16_f32 v101, v62, v63
  v_smfmac_f32_16x16x64_bf16 v[72:75], v[28:31], v[208:215], v110
  v_smfmac_f32_16x16x64_bf16 v[68:71], v[32:35], a[152:159], v110
  s_waitcnt lgkmcnt(2)
  v_smfmac_f32_16x16x64_bf16 v[72:75], v[32:35], v[52:59], v110
  ds_read_b128 v[52:55], v129 offset:24576
  v_smfmac_f32_16x16x64_bf16 v[36:39], v[4:7], a[160:167], v110
  ds_read_b128 v[56:59], v129 offset:25600
  v_smfmac_f32_16x16x64_bf16 v[40:43], v[4:7], v[216:223], v110
  v_permlane32_swap_b32 v68, v72
  v_smfmac_f32_16x16x64_bf16 v[36:39], v[8:11], a[168:175], v110
  s_waitcnt lgkmcnt(2)
  v_smfmac_f32_16x16x64_bf16 v[40:43], v[8:11], v[44:51], v110
  ds_read_b128 v[44:47], v129 offset:28672
  v_permlane32_swap_b32 v69, v73
  v_smfmac_f32_16x16x64_bf16 v[36:39], v[12:15], a[176:183], v110
  ds_read_b128 v[48:51], v129 offset:29696
  v_smfmac_f32_16x16x64_bf16 v[40:43], v[12:15], v[224:231], v110
  v_permlane32_swap_b32 v70, v74
  v_smfmac_f32_16x16x64_bf16 v[36:39], v[16:19], a[192:199], v110
  v_permlane32_swap_b32 v71, v75
  v_smfmac_f32_16x16x64_bf16 v[40:43], v[16:19], v[232:239], v110
  v_add_f32 v68, v68, v72
  v_smfmac_f32_16x16x64_bf16 v[36:39], v[20:23], a[200:207], v110
  v_add_f32 v69, v69, v73
  s_waitcnt lgkmcnt(2)
  v_smfmac_f32_16x16x64_bf16 v[40:43], v[20:23], v[52:59], v110
  v_add_f32 v70, v70, v74
  v_smfmac_f32_16x16x64_bf16 v[36:39], v[24:27], a[208:215], v110
  v_add_f32 v71, v71, v75
  v_smfmac_f32_16x16x64_bf16 v[40:43], v[24:27], v[240:247], v110
  v_cvt_pk_bf16_f32 v102, v68, v69
  v_smfmac_f32_16x16x64_bf16 v[36:39], v[28:31], a[224:231], v110
  v_cvt_pk_bf16_f32 v103, v70, v71
  v_smfmac_f32_16x16x64_bf16 v[40:43], v[28:31], v[248:255], v110
  v_smfmac_f32_16x16x64_bf16 v[36:39], v[32:35], a[232:239], v110
  s_waitcnt lgkmcnt(0)
  v_smfmac_f32_16x16x64_bf16 v[40:43], v[32:35], v[44:51], v110
  v_mfma_f32_16x16x16_bf16 v[142:145], v[100:101], v[108:109], 0
  v_mfma_f32_16x16x16_bf16 v[146:149], v[102:103], v[108:109], 0
  s_nop 1
  v_permlane32_swap_b32 v36, v40
  v_permlane32_swap_b32 v37, v41
  v_permlane32_swap_b32 v38, v42
  v_permlane32_swap_b32 v39, v43
  v_add_f32 v36, v36, v40
  v_add_f32 v37, v37, v41
  v_add_f32 v38, v38, v42
  v_add_f32 v39, v39, v43
  v_cvt_pk_bf16_f32 v104, v36, v37
  v_cvt_pk_bf16_f32 v105, v38, v39
  v_cvt_pk_bf16_f32 v44, v142, v143
  v_cvt_pk_bf16_f32 v45, v144, v145
  v_mfma_f32_16x16x16_bf16 v[142:145], v[104:105], v[108:109], 0
  v_cvt_pk_bf16_f32 v46, v146, v147
  v_cvt_pk_bf16_f32 v47, v148, v149
  s_nop 1
  v_mfma_f32_16x16x32_bf16 v[76:79], v[44:47], v[44:47], 0
  v_mfma_f32_16x16x32_bf16 v[80:83], v[88:91], v[44:47], 0
  v_cvt_pk_bf16_f32 v106, v142, v143
  v_cvt_pk_bf16_f32 v107, v144, v145
  v_mfma_f32_16x16x32_bf16 v[84:87], v[92:95], v[44:47], 0
  s_nop 0
  v_mfma_f32_16x16x16_bf16 v[76:79], v[106:107], v[106:107], v[76:79]
  v_mfma_f32_16x16x16_bf16 v[80:83], v[96:97], v[106:107], v[80:83]
  v_mfma_f32_16x16x16_bf16 v[84:87], v[98:99], v[106:107], v[84:87]
  s_mov_b32 exec_lo, 0
  s_mov_b32 exec_hi, 0x00ff00ff
  s_nop 3
  ds_write_b128 v130, v[76:79]
  s_mov_b32 exec_lo, 0x00ff00ff
  ds_write_b128 v130, v[80:83] offset:1024
  s_nop 0
  ds_write_b128 v130, v[84:87] offset:2048
  s_mov_b64 exec, -1
  s_waitcnt lgkmcnt(0)
  s_barrier
  ds_write_b64 v131, v[44:45]
  ds_write_b64 v131, v[46:47] offset:512
  ds_write_b64 v131, v[106:107] offset:1024
  ds_read_b128 v[44:47], v137 offset:0
  ds_read_b128 v[48:51], v137 offset:1024
  ds_read_b128 v[52:55], v137 offset:2048
  ds_read_b128 v[56:59], v137 offset:3072
  ds_read_b128 v[68:71], v137 offset:4096
  ds_read_b128 v[72:75], v137 offset:5120
  s_waitcnt lgkmcnt(0)
  s_barrier
  s_mov_b32 s28, s50
  buffer_load_dwordx4 v[4:7], v132, s[8:11], s28 offen sc1
  buffer_load_dwordx4 v[8:11], v132, s[8:11], s28 offen offset:1024 sc1
  s_add_u32 s28, s28, 2048
  buffer_load_dwordx4 v[12:15], v132, s[8:11], s28 offen sc1
  buffer_load_dwordx4 v[16:19], v132, s[8:11], s28 offen offset:1024 sc1
  s_add_u32 s28, s28, 2048
  buffer_load_dwordx4 v[20:23], v132, s[8:11], s28 offen sc1
  buffer_load_dwordx4 v[24:27], v132, s[8:11], s28 offen offset:1024 sc1
  s_add_u32 s28, s28, 2048
  buffer_load_dwordx4 v[28:31], v132, s[8:11], s28 offen sc1
  buffer_load_dwordx4 v[32:35], v132, s[8:11], s28 offen offset:1024 sc1
  s_add_u32 s28, s28, 2048
  buffer_load_dwordx4 v[36:39], v132, s[8:11], s28 offen sc1
  buffer_load_dwordx4 v[40:43], v132, s[8:11], s28 offen offset:1024 sc1
  s_add_u32 s28, s28, 2048
  buffer_load_dwordx4 v[60:63], v132, s[8:11], s28 offen sc1
  buffer_load_dwordx4 v[64:67], v132, s[8:11], s28 offen offset:1024 sc1
  s_add_u32 s28, s28, 2048
  ds_read_b64 v[76:77], v136 offset:0
  ds_read_b64 v[78:79], v136 offset:512
  ds_read_b64 v[80:81], v136 offset:1024
  ds_read_b64 v[82:83], v136 offset:1536
  ds_read_b64 v[84:85], v136 offset:2048
  ds_read_b64 v[86:87], v136 offset:2560
  ds_read_b64 v[88:89], v136 offset:3072
  ds_read_b64 v[90:91], v136 offset:3584
  ds_read_b64 v[92:93], v136 offset:4096
  ds_read_b64 v[94:95], v136 offset:4608
  ds_read_b64 v[96:97], v136 offset:5120
  ds_read_b64 v[98:99], v136 offset:5632
  s_waitcnt lgkmcnt(0)
  s_cmp_ge_u32 s51, 63
  s_cbranch_scc1 xq_87_\sfx\()
  s_add_u32 s96, s51, 1
  s_cmp_gt_u32 s52, s96
  s_cbranch_scc1 ka\sfx\()_x_wp_88_ok
  s_mov_b32 s45, 0
ka\sfx\()_x_wp_88_spin:
  buffer_load_dword v2, v138, s[8:11], 0 offen sc1
  s_add_u32 s45, s45, 1
  s_waitcnt vmcnt(0)
  v_min_u32_dpp v3, v2, v2 quad_perm:[1,0,3,2] row_mask:0xf bank_mask:0xf
  s_nop 1
  v_min_u32_dpp v2, v3, v3 quad_perm:[2,3,0,1] row_mask:0xf bank_mask:0xf
  s_nop 1
  v_min_u32_dpp v3, v2, v2 row_half_mirror row_mask:0xf bank_mask:0xf
  s_nop 1
  v_min_u32_dpp v2, v3, v3 quad_perm:[0,1,2,3] row_mask:0xf bank_mask:0xf
  s_nop 0
  v_readfirstlane_b32 s52, v2
  s_cmp_gt_u32 s52, s96
  s_cbranch_scc1 ka\sfx\()_x_wp_88_ok
  s_cmp_lt_u32 s45, 400000
  s_cbranch_scc1 ka\sfx\()_x_wp_88_spin
  s_branch ka\sfx\()_abort
ka\sfx\()_x_wp_88_ok:
  s_add_u32 s95, s63, s93
  s_add_u32 s95, s95, 12288
  s_add_u32 m0, s94, 0
  s_add_u32 s28, s95, 0
  buffer_load_dwordx4 v132, s[8:11], s28 offen sc1 lds
  s_add_u32 m0, s94, 1024
  s_add_u32 s28, s95, 2048
  buffer_load_dwordx4 v132, s[8:11], s28 offen sc1 lds
  s_add_u32 m0, s94, 2048
  s_add_u32 s28, s95, 4096
  buffer_load_dwordx4 v132, s[8:11], s28 offen sc1 lds
  s_add_u32 m0, s94, 3072
  s_add_u32 s28, s95, 6144
  buffer_load_dwordx4 v132, s[8:11], s28 offen sc1 lds
  s_add_u32 m0, s94, 4096
  s_add_u32 s28, s95, 8192
  buffer_load_dwordx4 v132, s[8:11], s28 offen sc1 lds
  s_add_u32 m0, s94, 5120
  s_add_u32 s28, s95, 10240
  buffer_load_dwordx4 v132, s[8:11], s28 offen sc1 lds
  s_branch xq_87_j_\sfx\()
xq_87_\sfx\():
  s_waitcnt vmcnt(0)
xq_87_j_\sfx\():
  s_waitcnt vmcnt(16)
  v_mfma_f32_16x16x32_bf16 v[112:115], v[76:79], v[44:47], 0
  v_mfma_f32_16x16x32_bf16 v[116:119], v[4:7], v[44:47], 0
  v_mfma_f32_16x16x32_bf16 v[120:123], v[8:11], v[44:47], 0
  s_waitcnt vmcnt(14)
  v_mfma_f32_16x16x32_bf16 v[112:115], v[80:83], v[48:51], v[112:115]
  v_mfma_f32_16x16x32_bf16 v[116:119], v[12:15], v[48:51], v[116:119]
  v_mfma_f32_16x16x32_bf16 v[120:123], v[16:19], v[48:51], v[120:123]
  s_waitcnt vmcnt(12)
  v_mfma_f32_16x16x32_bf16 v[112:115], v[84:87], v[52:55], v[112:115]
  v_mfma_f32_16x16x32_bf16 v[116:119], v[20:23], v[52:55], v[116:119]
  v_mfma_f32_16x16x32_bf16 v[120:123], v[24:27], v[52:55], v[120:123]
  s_waitcnt vmcnt(10)
  v_mfma_f32_16x16x32_bf16 v[112:115], v[88:91], v[56:59], v[112:115]
  v_mfma_f32_16x16x32_bf16 v[116:119], v[28:31], v[56:59], v[116:119]
  v_mfma_f32_16x16x32_bf16 v[120:123], v[32:35], v[56:59], v[120:123]
  s_waitcnt vmcnt(8)
  v_mfma_f32_16x16x32_bf16 v[112:115], v[92:95], v[68:71], v[112:115]
  v_mfma_f32_16x16x32_bf16 v[116:119], v[36:39], v[68:71], v[116:119]
  v_mfma_f32_16x16x32_bf16 v[120:123], v[40:43], v[68:71], v[120:123]
  s_waitcnt vmcnt(6)
  v_mfma_f32_16x16x32_bf16 v[112:115], v[96:99], v[72:75], v[112:115]
  v_mfma_f32_16x16x32_bf16 v[116:119], v[60:63], v[72:75], v[116:119]
  v_mfma_f32_16x16x32_bf16 v[120:123], v[64:67], v[72:75], v[120:123]
  s_nop 8
  v_cndmask_b32 v112, v135, v112, s[66:67]
  v_cndmask_b32 v113, v135, v113, s[66:67]
  v_cndmask_b32 v114, v135, v114, s[66:67]
  v_cndmask_b32 v115, v135, v115, s[66:67]
  v_cndmask_b32 v116, v135, v116, s[76:77]
  v_cndmask_b32 v120, v135, v120, s[84:85]
  v_cndmask_b32 v117, v135, v117, s[78:79]
  v_cndmask_b32 v121, v135, v121, s[86:87]
  v_cndmask_b32 v118, v135, v118, s[80:81]
  v_cndmask_b32 v122, v135, v122, s[88:89]
  v_cndmask_b32 v119, v135, v119, s[82:83]
  v_cndmask_b32 v123, v135, v123, s[90:91]
  v_max3_f32 v4, v112, v113, v114
  v_max3_f32 v5, v115, v116, v117
  v_max3_f32 v6, v118, v119, v120
  v_max3_f32 v7, v121, v122, v123
  v_max3_f32 v4, v4, v5, v6
  v_max_f32 v4, v4, v7
  v_mov_b32 v5, v4
  s_nop 1
  v_permlane16_swap_b32 v4, v5
  v_max_f32 v4, v4, v5
  v_mov_b32 v5, v4
  s_nop 1
  v_permlane32_swap_b32 v4, v5
  v_max_f32 v4, v4, v5
  v_mul_f32 v4, s64, v4
  v_fma_f32 v112, v112, s64, -v4
  v_fma_f32 v113, v113, s64, -v4
  v_fma_f32 v114, v114, s64, -v4
  v_fma_f32 v115, v115, s64, -v4
  v_fma_f32 v116, v116, s64, -v4
  v_fma_f32 v117, v117, s64, -v4
  v_fma_f32 v118, v118, s64, -v4
  v_fma_f32 v119, v119, s64, -v4
  v_fma_f32 v120, v120, s64, -v4
  v_fma_f32 v121, v121, s64, -v4
  v_fma_f32 v122, v122, s64, -v4
  v_fma_f32 v123, v123, s64, -v4
  v_exp_f32 v112, v112
  v_exp_f32 v113, v113
  v_exp_f32 v114, v114
  v_exp_f32 v115, v115
  v_exp_f32 v116, v116
  v_exp_f32 v117, v117
  v_exp_f32 v118, v118
  v_exp_f32 v119, v119
  v_exp_f32 v120, v120
  v_exp_f32 v121, v121
  v_exp_f32 v122, v122
  v_exp_f32 v123, v123
  v_add_f32 v5, v112, v113
  v_add_f32 v6, v114, v115
  v_add_f32 v7, v116, v117
  v_add_f32 v8, v118, v119
  v_add_f32 v9, v120, v121
  v_add_f32 v10, v122, v123
  v_add_f32 v5, v5, v6
  v_add_f32 v7, v7, v8
  v_add_f32 v9, v9, v10
  v_add_f32 v5, v5, v7
  v_add_f32 v5, v5, v9
  v_mov_b32 v6, v5
  s_nop 1
  v_permlane16_swap_b32 v5, v6
  v_add_f32 v5, v5, v6
  v_mov_b32 v6, v5
  s_nop 1
  v_permlane32_swap_b32 v5, v6
  v_add_f32 v5, v5, v6
  v_rcp_f32 v5, v5
  s_nop 0
  v_mul_f32 v112, v112, v5
  v_mul_f32 v113, v113, v5
  v_mul_f32 v114, v114, v5
  v_mul_f32 v115, v115, v5
  v_mul_f32 v116, v116, v5
  v_mul_f32 v117, v117, v5
  v_mul_f32 v118, v118, v5
  v_mul_f32 v119, v119, v5
  v_mul_f32 v120, v120, v5
  v_mul_f32 v121, v121, v5
  v_mul_f32 v122, v122, v5
  v_mul_f32 v123, v123, v5
  v_cvt_pk_bf16_f32 v8, v112, v113
  v_cvt_pk_bf16_f32 v9, v114, v115
  v_cvt_pk_bf16_f32 v10, v116, v117
  v_cvt_pk_bf16_f32 v11, v118, v119
  v_cvt_pk_bf16_f32 v12, v120, v121
  v_cvt_pk_bf16_f32 v13, v122, v123
  buffer_store_dwordx2 v[10:11], v133, s[8:11], s92 offen \pol
  buffer_store_dwordx2 v[12:13], v133, s[8:11], s92 offen offset:256 \pol
  buffer_store_dwordx2 v[8:9], v134, s[8:11], s92 offen \pol
  s_add_u32 s92, s92, 20480
  s_cmp_ge_u32 s51, 63
  s_cbranch_scc1 ka\sfx\()_x_done
  v_mov_b32 v60, 0
  v_mov_b32 v61, 0
  v_mov_b32 v62, 0
  v_mov_b32 v63, 0
  v_mov_b32 v64, 0
  v_mov_b32 v65, 0
  v_mov_b32 v66, 0
  v_mov_b32 v67, 0
  v_mov_b32 v68, 0
  v_mov_b32 v69, 0
  v_mov_b32 v70, 0
  v_mov_b32 v71, 0
  v_mov_b32 v72, 0
  v_mov_b32 v73, 0
  v_mov_b32 v74, 0
  v_mov_b32 v75, 0
  v_mov_b32 v36, 0
  v_mov_b32 v37, 0
  v_mov_b32 v38, 0
  v_mov_b32 v39, 0
  v_mov_b32 v40, 0
  v_mov_b32 v41, 0
  v_mov_b32 v42, 0
  v_mov_b32 v43, 0
  s_add_u32 s97, s97, 10240
  s_mov_b32 s48, s97
  s_add_u32 s49, s49, 5120
  s_add_u32 s98, s49, 5120
  s_add_u32 s50, s50, 12288
  s_add_u32 s63, s63, 12288
  s_add_u32 s51, s51, 1
  s_cmp_gt_u32 s52, s51
  s_cbranch_scc1 ka\sfx\()_x_wp_89_ok
  s_mov_b32 s45, 0
ka\sfx\()_x_wp_89_spin:
  buffer_load_dword v2, v138, s[8:11], 0 offen sc1
  s_add_u32 s45, s45, 1
  s_waitcnt vmcnt(0)
  v_min_u32_dpp v3, v2, v2 quad_perm:[1,0,3,2] row_mask:0xf bank_mask:0xf
  s_nop 1
  v_min_u32_dpp v2, v3, v3 quad_perm:[2,3,0,1] row_mask:0xf bank_mask:0xf
  s_nop 1
  v_min_u32_dpp v3, v2, v2 row_half_mirror row_mask:0xf bank_mask:0xf
  s_nop 1
  v_min_u32_dpp v2, v3, v3 quad_perm:[0,1,2,3] row_mask:0xf bank_mask:0xf
  s_nop 0
  v_readfirstlane_b32 s52, v2
  s_cmp_gt_u32 s52, s51
  s_cbranch_scc1 ka\sfx\()_x_wp_89_ok
  s_cmp_lt_u32 s45, 400000
  s_cbranch_scc1 ka\sfx\()_x_wp_89_spin
  s_branch ka\sfx\()_abort
ka\sfx\()_x_wp_89_ok:
  s_add_u32 s28, s50, s53
  buffer_load_dwordx2 v[88:89], v132, s[8:11], s28 offen offset:0 sc1
  buffer_load_dwordx2 v[92:93], v132, s[8:11], s28 offen offset:1024 sc1
  s_add_u32 s28, s50, s54
  buffer_load_dwordx2 v[90:91], v132, s[8:11], s28 offen offset:0 sc1
  buffer_load_dwordx2 v[94:95], v132, s[8:11], s28 offen offset:1024 sc1
  s_add_u32 s28, s50, s55
  buffer_load_dwordx2 v[96:97], v132, s[8:11], s28 offen offset:0 sc1
  buffer_load_dwordx2 v[98:99], v132, s[8:11], s28 offen offset:1024 sc1
  s_branch ka\sfx\()_x_w3l
ka\sfx\()_x_done:
  s_waitcnt vmcnt(0) lgkmcnt(0)
  s_branch ka\sfx\()_exit
ka\sfx\()_y:
  v_and_b32 v1, 63, v0
  v_lshlrev_b32 v178, 4, v1
  s_and_b32 s28, s21, 1
  s_lshl_b32 s46, s23, 1
  s_add_u32 s46, s46, s28
  s_lshr_b32 s28, s21, 1
  s_lshl_b32 s28, s28, 2
  s_lshl_b32 s47, s20, 3
  s_add_u32 s47, s47, s28
  s_mul_i32 s28, s47, 40
  s_add_u32 s28, s28, s46
  s_mul_i32 s28, s28, 20480
  s_add_u32 s28, s28, 0x2e00000
  s_add_u32 s29, s28, 0
  buffer_load_dwordx4 a[0:3], v178, s[8:11], s29 offen
  buffer_load_dwordx4 a[4:7], v178, s[8:11], s29 offen offset:1024
  s_add_u32 s29, s28, 2048
  buffer_load_dwordx4 a[8:11], v178, s[8:11], s29 offen
  buffer_load_dwordx4 a[12:15], v178, s[8:11], s29 offen offset:1024
  s_add_u32 s29, s28, 4096
  buffer_load_dwordx4 a[16:19], v178, s[8:11], s29 offen
  buffer_load_dwordx4 a[20:23], v178, s[8:11], s29 offen offset:1024
  s_add_u32 s29, s28, 6144
  buffer_load_dwordx4 a[24:27], v178, s[8:11], s29 offen
  buffer_load_dwordx4 a[28:31], v178, s[8:11], s29 offen offset:1024
  s_add_u32 s29, s28, 8192
  buffer_load_dwordx4 a[32:35], v178, s[8:11], s29 offen
  buffer_load_dwordx4 a[36:39], v178, s[8:11], s29 offen offset:1024
  s_add_u32 s29, s28, 10240
  buffer_load_dwordx4 a[40:43], v178, s[8:11], s29 offen
  buffer_load_dwordx4 a[44:47], v178, s[8:11], s29 offen offset:1024
  s_add_u32 s29, s28, 12288
  buffer_load_dwordx4 a[48:51], v178, s[8:11], s29 offen
  buffer_load_dwordx4 a[52:55], v178, s[8:11], s29 offen offset:1024
  s_add_u32 s29, s28, 14336
  buffer_load_dwordx4 a[56:59], v178, s[8:11], s29 offen
  buffer_load_dwordx4 a[60:63], v178, s[8:11], s29 offen offset:1024
  s_add_u32 s29, s28, 16384
  buffer_load_dwordx4 a[64:67], v178, s[8:11], s29 offen
  buffer_load_dwordx4 a[68:71], v178, s[8:11], s29 offen offset:1024
  s_add_u32 s29, s28, 18432
  buffer_load_dwordx4 a[72:75], v178, s[8:11], s29 offen
  buffer_load_dwordx4 a[76:79], v178, s[8:11], s29 offen offset:1024
  s_add_u32 s29, s28, 819200
  buffer_load_dwordx4 a[80:83], v178, s[8:11], s29 offen
  buffer_load_dwordx4 a[84:87], v178, s[8:11], s29 offen offset:1024
  s_add_u32 s29, s28, 821248
  buffer_load_dwordx4 a[88:91], v178, s[8:11], s29 offen
  buffer_load_dwordx4 a[92:95], v178, s[8:11], s29 offen offset:1024
  s_add_u32 s29, s28, 823296
  buffer_load_dwordx4 a[96:99], v178, s[8:11], s29 offen
  buffer_load_dwordx4 a[100:103], v178, s[8:11], s29 offen offset:1024
  s_add_u32 s29, s28, 825344
  buffer_load_dwordx4 a[104:107], v178, s[8:11], s29 offen
  buffer_load_dwordx4 a[108:111], v178, s[8:11], s29 offen offset:1024
  s_add_u32 s29, s28, 827392
  buffer_load_dwordx4 a[112:115], v178, s[8:11], s29 offen
  buffer_load_dwordx4 a[116:119], v178, s[8:11], s29 offen offset:1024
  s_add_u32 s29, s28, 829440
  buffer_load_dwordx4 a[120:123], v178, s[8:11], s29 offen
  buffer_load_dwordx4 a[124:127], v178, s[8:11], s29 offen offset:1024
  s_add_u32 s29, s28, 831488
  buffer_load_dwordx4 a[128:131], v178, s[8:11], s29 offen
  buffer_load_dwordx4 a[132:135], v178, s[8:11], s29 offen offset:1024
  s_add_u32 s29, s28, 833536
  buffer_load_dwordx4 a[136:139], v178, s[8:11], s29 offen
  buffer_load_dwordx4 a[140:143], v178, s[8:11], s29 offen offset:1024
  s_add_u32 s29, s28, 835584
  buffer_load_dwordx4 a[144:147], v178, s[8:11], s29 offen
  buffer_load_dwordx4 a[148:151], v178, s[8:11], s29 offen offset:1024
  s_add_u32 s29, s28, 837632
  buffer_load_dwordx4 a[152:155], v178, s[8:11], s29 offen
  buffer_load_dwordx4 a[156:159], v178, s[8:11], s29 offen offset:1024
  s_waitcnt vmcnt(30)
  s_cmp_eq_u32 s21, 3
  s_cbranch_scc0 lna_90_\sfx\()
  s_mov_b64 s[24:25], exec
  s_mov_b64 exec, 1
  s_and_b32 s45, s2, 7
  s_lshl_b32 s45, s45, 7
  s_add_u32 s45, s45, 10240
  v_mov_b32 v2, s45
  v_mov_b32 v3, 1
  buffer_atomic_add v3, v2, s[8:11], 0 offen
  s_mov_b64 exec, s[24:25]
lna_90_\sfx\():
  s_add_u32 s29, s28, 1638400
  buffer_load_dwordx4 a[160:163], v178, s[8:11], s29 offen
  buffer_load_dwordx4 a[164:167], v178, s[8:11], s29 offen offset:1024
  s_add_u32 s29, s28, 1640448
  buffer_load_dwordx4 a[168:171], v178, s[8:11], s29 offen
  buffer_load_dwordx4 a[172:175], v178, s[8:11], s29 offen offset:1024
  s_add_u32 s29, s28, 1642496
  buffer_load_dwordx4 a[176:179], v178, s[8:11], s29 offen
  buffer_load_dwordx4 a[180:183], v178, s[8:11], s29 offen offset:1024
  s_add_u32 s29, s28, 1644544
  buffer_load_dwordx4 a[184:187], v178, s[8:11], s29 offen
  buffer_load_dwordx4 a[188:191], v178, s[8:11], s29 offen offset:1024
  s_add_u32 s29, s28, 1646592
  buffer_load_dwordx4 a[192:195], v178, s[8:11], s29 offen
  buffer_load_dwordx4 a[196:199], v178, s[8:11], s29 offen offset:1024
  s_add_u32 s29, s28, 1648640
  buffer_load_dwordx4 a[200:203], v178, s[8:11], s29 offen
  buffer_load_dwordx4 a[204:207], v178, s[8:11], s29 offen offset:1024
  s_add_u32 s29, s28, 1650688
  buffer_load_dwordx4 a[208:211], v178, s[8:11], s29 offen
  buffer_load_dwordx4 a[212:215], v178, s[8:11], s29 offen offset:1024
  s_add_u32 s29, s28, 1652736
  buffer_load_dwordx4 a[216:219], v178, s[8:11], s29 offen
  buffer_load_dwordx4 a[220:223], v178, s[8:11], s29 offen offset:1024
  s_add_u32 s29, s28, 1654784
  buffer_load_dwordx4 a[224:227], v178, s[8:11], s29 offen
  buffer_load_dwordx4 a[228:231], v178, s[8:11], s29 offen offset:1024
  s_add_u32 s29, s28, 1656832
  buffer_load_dwordx4 a[232:235], v178, s[8:11], s29 offen
  buffer_load_dwordx4 a[236:239], v178, s[8:11], s29 offen offset:1024
  s_waitcnt vmcnt(30)
  s_add_u32 s29, s28, 2457600
  buffer_load_dwordx4 a[240:243], v178, s[8:11], s29 offen
  buffer_load_dwordx4 a[244:247], v178, s[8:11], s29 offen offset:1024
  s_add_u32 s29, s28, 2459648
  buffer_load_dwordx4 a[248:251], v178, s[8:11], s29 offen
  buffer_load_dwordx4 a[252:255], v178, s[8:11], s29 offen offset:1024
  s_add_u32 s29, s28, 2461696
  buffer_load_dwordx4 v[192:195], v178, s[8:11], s29 offen
  buffer_load_dwordx4 v[196:199], v178, s[8:11], s29 offen offset:1024
  s_add_u32 s29, s28, 2463744
  buffer_load_dwordx4 v[200:203], v178, s[8:11], s29 offen
  buffer_load_dwordx4 v[204:207], v178, s[8:11], s29 offen offset:1024
  s_add_u32 s29, s28, 2465792
  buffer_load_dwordx4 v[208:211], v178, s[8:11], s29 offen
  buffer_load_dwordx4 v[212:215], v178, s[8:11], s29 offen offset:1024
  s_add_u32 s29, s28, 2467840
  buffer_load_dwordx4 v[216:219], v178, s[8:11], s29 offen
  buffer_load_dwordx4 v[220:223], v178, s[8:11], s29 offen offset:1024
  s_add_u32 s29, s28, 2469888
  buffer_load_dwordx4 v[224:227], v178, s[8:11], s29 offen
  buffer_load_dwordx4 v[228:231], v178, s[8:11], s29 offen offset:1024
  s_add_u32 s29, s28, 2471936
  buffer_load_dwordx4 v[232:235], v178, s[8:11], s29 offen
  buffer_load_dwordx4 v[236:239], v178, s[8:11], s29 offen offset:1024
  s_add_u32 s29, s28, 2473984
  buffer_load_dwordx4 v[240:243], v178, s[8:11], s29 offen
  buffer_load_dwordx4 v[244:247], v178, s[8:11], s29 offen offset:1024
  s_add_u32 s29, s28, 2476032
  buffer_load_dwordx4 v[248:251], v178, s[8:11], s29 offen
  buffer_load_dwordx4 v[252:255], v178, s[8:11], s29 offen offset:1024
  s_waitcnt vmcnt(30)
  v_mov_b32 v172, 0x44444444
  v_mov_b32 v2, 0xeeeeeeee
  v_and_b32 v3, 8, v1
  v_cmp_ne_u32 vcc, 0, v3
  s_nop 1
  v_cndmask_b32 v172, v172, v2, vcc
  s_lshl_b32 s28, s21, 10
  v_add_u32 v173, s28, v178
  v_add_u32 v174, 4096, v173
  v_add_u32 v175, 8192, v173
  v_add_u32 v176, 0, v173
  v_add_u32 v177, 0, v178
  v_add_u32 v179, 10240, v173
  s_xor_b32 s28, s21, 2
  s_lshl_b32 s28, s28, 10
  s_add_u32 s28, s28, 10240
  v_add_u32 v180, s28, v178
  v_and_b32 v4, 15, v1
  v_lshrrev_b32 v5, 4, v1
  v_and_b32 v6, 7, v1
  v_lshlrev_b32 v7, 3, v5
  v_add_u32 v7, v7, v6
  v_lshlrev_b32 v185, 4, v7
  v_add_u32 v182, 4096, v178
  v_mov_b32 v8, 0x40000000
  v_cmp_gt_u32 vcc, 8, v4
  s_nop 1
  v_cndmask_b32 v184, v8, v185, vcc
  v_lshlrev_b32 v7, 4, v4
  v_lshlrev_b32 v9, 2, v5
  v_add_u32 v7, v7, v9
  v_cndmask_b32 v186, v8, v7, vcc
  s_lshl_b32 s28, s20, 5
  s_add_u32 s28, s28, 3072
  v_lshlrev_b32 v7, 2, v6
  v_add_u32 v187, s28, v7
  v_and_b32 v7, 1, v5
  v_lshlrev_b32 v7, 3, v7
  v_lshrrev_b32 v9, 1, v5
  v_lshlrev_b32 v9, 5, v9
  v_add_u32 v9, v9, v4
  v_lshlrev_b32 v9, 4, v9
  v_add_u32 v189, v7, v9
  v_mov_b32 v44, 0
  v_mov_b32 v45, 0
  v_mov_b32 v46, 0
  v_mov_b32 v47, 0
  v_mov_b32 v48, 0
  v_mov_b32 v49, 0
  v_mov_b32 v50, 0
  v_mov_b32 v51, 0
  v_mov_b32 v52, 0
  v_mov_b32 v53, 0
  v_mov_b32 v54, 0
  v_mov_b32 v55, 0
  v_mov_b32 v56, 0
  v_mov_b32 v57, 0
  v_mov_b32 v58, 0
  v_mov_b32 v59, 0
  s_mul_i32 s97, s20, 655360
  s_add_u32 s97, s97, 0x400000
  s_mov_b32 s48, 0x4000
  s_mul_i32 s49, s20, 327680
  s_add_u32 s49, s49, 0x700000
  s_and_b32 s28, s21, 1
  s_mul_i32 s28, s28, 0
  s_add_u32 s49, s49, s28
  s_mul_i32 s50, s20, 327680
  s_lshl_b32 s28, s46, 10
  s_add_u32 s50, s50, s28
  s_add_u32 s50, s50, 0x9000000
  s_mov_b32 s51, 0
  s_mov_b32 s52, 0
  s_mov_b32 s53, 0
  s_mov_b32 s61, 0
  s_add_u32 s29, s20, 0
  s_and_b32 s29, s29, 3
  s_mul_i32 s29, s29, 20
  s_add_u32 s29, s29, s23
  s_lshr_b32 s28, s29, 3
  s_lshl_b32 s28, s28, 14
  s_and_b32 s29, s29, 7
  s_lshl_b32 s29, s29, 10
  s_add_u32 s28, s28, s29
  s_and_b32 s29, s21, 1
  s_lshl_b32 s29, s29, 9
  s_add_u32 s28, s28, s29
  s_add_u32 s28, s28, s61
  s_add_u32 s56, s28, 0xa00000
  s_mov_b32 s66, s56
  s_add_u32 s29, s20, 1
  s_and_b32 s29, s29, 3
  s_mul_i32 s29, s29, 20
  s_add_u32 s29, s29, s23
  s_lshr_b32 s28, s29, 3
  s_lshl_b32 s28, s28, 14
  s_and_b32 s29, s29, 7
  s_lshl_b32 s29, s29, 10
  s_add_u32 s28, s28, s29
  s_and_b32 s29, s21, 1
  s_lshl_b32 s29, s29, 9
  s_add_u32 s28, s28, s29
  s_add_u32 s28, s28, s61
  s_add_u32 s57, s28, 0xa00000
  s_mov_b32 s67, s57
  s_add_u32 s29, s20, 2
  s_and_b32 s29, s29, 3
  s_mul_i32 s29, s29, 20
  s_add_u32 s29, s29, s23
  s_lshr_b32 s28, s29, 3
  s_lshl_b32 s28, s28, 14
  s_and_b32 s29, s29, 7
  s_lshl_b32 s29, s29, 10
  s_add_u32 s28, s28, s29
  s_and_b32 s29, s21, 1
  s_lshl_b32 s29, s29, 9
  s_add_u32 s28, s28, s29
  s_add_u32 s28, s28, s61
  s_add_u32 s58, s28, 0xa00000
  s_mov_b32 s68, s58
  s_add_u32 s29, s20, 3
  s_and_b32 s29, s29, 3
  s_mul_i32 s29, s29, 20
  s_add_u32 s29, s29, s23
  s_lshr_b32 s28, s29, 3
  s_lshl_b32 s28, s28, 14
  s_and_b32 s29, s29, 7
  s_lshl_b32 s29, s29, 10
  s_add_u32 s28, s28, s29
  s_and_b32 s29, s21, 1
  s_lshl_b32 s29, s29, 9
  s_add_u32 s28, s28, s29
  s_add_u32 s28, s28, s61
  s_add_u32 s59, s28, 0xa00000
  s_mov_b32 s69, s59
  v_mov_b32 v124, -1
  v_mov_b32 v125, -1
  v_mov_b32 v126, -1
  v_mov_b32 v127, -1
  s_lshr_b32 s28, s46, 2
  s_lshl_b32 s28, s28, 10
  s_and_b32 s29, s46, 3
  s_lshl_b32 s29, s29, 8
  s_add_u32 s28, s28, s29
  s_add_u32 s60, s28, s97
  s_add_u32 s60, s60, 10240
  s_and_b32 s28, s21, 1
  s_lshl_b32 s28, s28, 10
  s_add_u32 s28, s28, 32768
  v_add_u32 v181, s28, v178
  v_add_u32 v183, 65536, v178
  s_waitcnt vmcnt(0)
  s_cmp_ge_u32 s21, 2
  s_cbranch_scc1 ka\sfx\()_y_tok
ka\sfx\()_y_crit:
  s_add_u32 s98, s48, 4096
  s_add_u32 s100, s48, 8192
  s_mov_b32 s45, 0
ka\sfx\()_y_pf_91:
  buffer_load_dwordx4 v[160:163], v173, s[8:11], s48 offen sc1
  buffer_load_dwordx4 v[164:167], v173, s[8:11], s48 offen offset:2048 sc1
  buffer_load_dwordx4 v[168:171], v173, s[8:11], s98 offen sc1
  buffer_load_dwordx4 v[68:71], v173, s[8:11], s98 offen offset:2048 sc1
  buffer_load_dwordx4 v[72:75], v173, s[8:11], s100 offen sc1
  s_add_u32 s45, s45, 1
  s_waitcnt vmcnt(4)
  ds_write_b128 v176, v[160:163] offset:0
  v_max3_u32 v190, v160, v161, v162
  v_max_u32 v190, v190, v163
  s_waitcnt vmcnt(3)
  ds_write_b128 v176, v[164:167] offset:2048
  v_max3_u32 v190, v190, v164, v165
  v_max3_u32 v190, v190, v166, v167
  s_waitcnt vmcnt(2)
  ds_write_b128 v176, v[168:171] offset:4096
  v_max3_u32 v190, v190, v168, v169
  v_max3_u32 v190, v190, v170, v171
  s_waitcnt vmcnt(1)
  ds_write_b128 v176, v[68:71] offset:6144
  v_max3_u32 v190, v190, v68, v69
  v_max3_u32 v190, v190, v70, v71
  s_waitcnt vmcnt(0)
  ds_write_b128 v176, v[72:75] offset:8192
  v_max3_u32 v190, v190, v72, v73
  v_max3_u32 v190, v190, v74, v75
  v_cmp_eq_u32 vcc, -1, v190
  s_cbranch_vccz ka\sfx\()_y_pf_91_ok
  s_cmp_lt_u32 s45, 400000
  s_cbranch_scc1 ka\sfx\()_y_pf_91
  s_branch ka\sfx\()_abort
ka\sfx\()_y_pf_91_ok:
  s_waitcnt lgkmcnt(0)
  s_barrier
  ds_read_b128 v[4:7], v177 offset:0
  ds_read_b128 v[8:11], v177 offset:1024
  ds_read_b128 v[12:15], v177 offset:2048
  ds_read_b128 v[16:19], v177 offset:3072
  ds_read_b128 v[20:23], v177 offset:4096
  ds_read_b128 v[24:27], v177 offset:5120
  ds_read_b128 v[28:31], v177 offset:6144
  ds_read_b128 v[32:35], v177 offset:7168
  ds_read_b128 v[36:39], v177 offset:8192
  ds_read_b128 v[40:43], v177 offset:9216
  s_cmp_eq_u32 s51, 7
  s_cbranch_scc0 ka\sfx\()_y_nosel
  v_mov_b32 v2, 5056
  s_mov_b32 s45, 0
ka\sfx\()_y_sel:
  buffer_load_dword v3, v2, s[8:11], 0 offen sc1
  s_add_u32 s45, s45, 1
  s_waitcnt vmcnt(0)
  v_readfirstlane_b32 s61, v3
  s_cmp_lg_u32 s61, 0
  s_cbranch_scc1 ka\sfx\()_y_selok
  s_cmp_lt_u32 s45, 400000
  s_cbranch_scc1 ka\sfx\()_y_sel
  s_branch ka\sfx\()_abort
ka\sfx\()_y_selok:
  s_and_b32 s61, s61, 2
  s_lshl_b32 s61, s61, 12
ka\sfx\()_y_nosel:
  s_cmp_lt_u32 s51, 2
  s_cbranch_scc1 ka\sfx\()_y_norst
  s_sub_u32 s28, s51, 2
  s_and_b32 s28, s28, 3
  s_mul_i32 s28, s28, 163840
  s_add_u32 s28, s28, s56
  v_mov_b32 v160, -1
  v_mov_b32 v161, -1
  v_mov_b32 v162, -1
  v_mov_b32 v163, -1
  buffer_store_dwordx4 v[160:163], v184, s[8:11], s28 offen sc1
ka\sfx\()_y_norst:
  s_waitcnt lgkmcnt(9)
  v_smfmac_f32_16x16x64_bf16 v[44:47], v[4:7], a[0:7], v172
  v_smfmac_f32_16x16x64_bf16 v[48:51], v[4:7], a[80:87], v172
  v_smfmac_f32_16x16x64_bf16 v[52:55], v[4:7], a[160:167], v172
  v_smfmac_f32_16x16x64_bf16 v[56:59], v[4:7], a[240:247], v172
  s_waitcnt lgkmcnt(8)
  v_smfmac_f32_16x16x64_bf16 v[44:47], v[8:11], a[8:15], v172
  v_smfmac_f32_16x16x64_bf16 v[48:51], v[8:11], a[88:95], v172
  v_smfmac_f32_16x16x64_bf16 v[52:55], v[8:11], a[168:175], v172
  v_smfmac_f32_16x16x64_bf16 v[56:59], v[8:11], a[248:255], v172
  s_waitcnt lgkmcnt(7)
  v_smfmac_f32_16x16x64_bf16 v[44:47], v[12:15], a[16:23], v172
  v_smfmac_f32_16x16x64_bf16 v[48:51], v[12:15], a[96:103], v172
  v_smfmac_f32_16x16x64_bf16 v[52:55], v[12:15], a[176:183], v172
  v_smfmac_f32_16x16x64_bf16 v[56:59], v[12:15], v[192:199], v172
  s_waitcnt lgkmcnt(6)
  v_smfmac_f32_16x16x64_bf16 v[44:47], v[16:19], a[24:31], v172
  v_smfmac_f32_16x16x64_bf16 v[48:51], v[16:19], a[104:111], v172
  v_smfmac_f32_16x16x64_bf16 v[52:55], v[16:19], a[184:191], v172
  v_smfmac_f32_16x16x64_bf16 v[56:59], v[16:19], v[200:207], v172
  s_waitcnt lgkmcnt(5)
  v_smfmac_f32_16x16x64_bf16 v[44:47], v[20:23], a[32:39], v172
  v_smfmac_f32_16x16x64_bf16 v[48:51], v[20:23], a[112:119], v172
  v_smfmac_f32_16x16x64_bf16 v[52:55], v[20:23], a[192:199], v172
  v_smfmac_f32_16x16x64_bf16 v[56:59], v[20:23], v[208:215], v172
  s_waitcnt lgkmcnt(4)
  v_smfmac_f32_16x16x64_bf16 v[44:47], v[24:27], a[40:47], v172
  v_smfmac_f32_16x16x64_bf16 v[48:51], v[24:27], a[120:127], v172
  v_smfmac_f32_16x16x64_bf16 v[52:55], v[24:27], a[200:207], v172
  v_smfmac_f32_16x16x64_bf16 v[56:59], v[24:27], v[216:223], v172
  s_waitcnt lgkmcnt(3)
  v_smfmac_f32_16x16x64_bf16 v[44:47], v[28:31], a[48:55], v172
  v_smfmac_f32_16x16x64_bf16 v[48:51], v[28:31], a[128:135], v172
  v_smfmac_f32_16x16x64_bf16 v[52:55], v[28:31], a[208:215], v172
  v_smfmac_f32_16x16x64_bf16 v[56:59], v[28:31], v[224:231], v172
  s_waitcnt lgkmcnt(2)
  v_smfmac_f32_16x16x64_bf16 v[44:47], v[32:35], a[56:63], v172
  v_smfmac_f32_16x16x64_bf16 v[48:51], v[32:35], a[136:143], v172
  v_smfmac_f32_16x16x64_bf16 v[52:55], v[32:35], a[216:223], v172
  v_smfmac_f32_16x16x64_bf16 v[56:59], v[32:35], v[232:239], v172
  s_waitcnt lgkmcnt(1)
  v_smfmac_f32_16x16x64_bf16 v[44:47], v[36:39], a[64:71], v172
  v_smfmac_f32_16x16x64_bf16 v[48:51], v[36:39], a[144:151], v172
  v_smfmac_f32_16x16x64_bf16 v[52:55], v[36:39], a[224:231], v172
  v_smfmac_f32_16x16x64_bf16 v[56:59], v[36:39], v[240:247], v172
  s_waitcnt lgkmcnt(0)
  v_smfmac_f32_16x16x64_bf16 v[44:47], v[40:43], a[72:79], v172
  v_smfmac_f32_16x16x64_bf16 v[48:51], v[40:43], a[152:159], v172
  v_smfmac_f32_16x16x64_bf16 v[52:55], v[40:43], a[232:239], v172
  v_smfmac_f32_16x16x64_bf16 v[56:59], v[40:43], v[248:255], v172
  s_nop 9
  v_permlane32_swap_b32 v44, v48
  v_permlane32_swap_b32 v45, v49
  v_permlane32_swap_b32 v46, v50
  v_permlane32_swap_b32 v47, v51
  v_permlane32_swap_b32 v52, v56
  v_permlane32_swap_b32 v53, v57
  v_permlane32_swap_b32 v54, v58
  v_permlane32_swap_b32 v55, v59
  v_add_f32 v44, v44, v48
  v_add_f32 v45, v45, v49
  v_add_f32 v46, v46, v50
  v_add_f32 v47, v47, v51
  v_add_f32 v52, v52, v56
  v_add_f32 v53, v53, v57
  v_add_f32 v54, v54, v58
  v_add_f32 v55, v55, v59
  v_cvt_pk_bf16_f32 v60, v44, v45
  v_cvt_pk_bf16_f32 v61, v46, v47
  v_cvt_pk_bf16_f32 v62, v52, v53
  v_cvt_pk_bf16_f32 v63, v54, v55
  ds_write_b128 v179, v[60:63]
  v_mov_b32 v44, 0
  v_mov_b32 v45, 0
  v_mov_b32 v46, 0
  v_mov_b32 v47, 0
  v_mov_b32 v48, 0
  v_mov_b32 v49, 0
  v_mov_b32 v50, 0
  v_mov_b32 v51, 0
  v_mov_b32 v52, 0
  v_mov_b32 v53, 0
  v_mov_b32 v54, 0
  v_mov_b32 v55, 0
  v_mov_b32 v56, 0
  v_mov_b32 v57, 0
  v_mov_b32 v58, 0
  v_mov_b32 v59, 0
  s_waitcnt lgkmcnt(0)
  s_barrier
  s_cmp_ge_u32 s51, 63
  s_cbranch_scc1 ka\sfx\()_y_crit_end
  ds_read_b128 v[64:67], v180
  ds_read_b128 v[68:71], v181 offset:0
  ds_read_b128 v[72:75], v181 offset:2048
  ds_read_b128 v[76:79], v181 offset:4096
  ds_read_b128 v[80:83], v181 offset:6144
  ds_read_b128 v[84:87], v181 offset:8192
  ds_read_b128 v[88:91], v181 offset:10240
  ds_read_b128 v[92:95], v181 offset:12288
  ds_read_b128 v[96:99], v181 offset:14336
  v_xor_b32 v181, 0x4000, v181
  s_mov_b32 s45, 0
  buffer_load_dwordx4 v[100:103], v178, s[8:11], s49 offen offset:0 sc1
  buffer_load_dwordx4 v[104:107], v178, s[8:11], s49 offen offset:1024 sc1
  buffer_load_dwordx4 v[108:111], v178, s[8:11], s49 offen offset:2048 sc1
  buffer_load_dwordx4 v[112:115], v178, s[8:11], s49 offen offset:3072 sc1
  buffer_load_dwordx4 v[116:119], v182, s[8:11], s49 offen sc1
yp_92_\sfx\():
  buffer_load_dwordx4 v[120:123], v178, s[8:11], s49 offen offset:0 sc1
  buffer_load_dwordx4 v[124:127], v178, s[8:11], s49 offen offset:1024 sc1
  buffer_load_dwordx4 v[128:131], v178, s[8:11], s49 offen offset:2048 sc1
  buffer_load_dwordx4 v[132:135], v178, s[8:11], s49 offen offset:3072 sc1
  buffer_load_dwordx4 v[136:139], v182, s[8:11], s49 offen sc1
  s_waitcnt vmcnt(9) lgkmcnt(0)
  v_mfma_f32_16x16x32_bf16 v[140:143], v[68:71], v[100:103], 0
  v_max_u32 v190, v100, v102
  v_mfma_f32_16x16x32_bf16 v[144:147], v[72:75], v[100:103], 0
  s_waitcnt vmcnt(8)
  v_mfma_f32_16x16x32_bf16 v[140:143], v[76:79], v[104:107], v[140:143]
  v_max3_u32 v190, v190, v104, v106
  v_mfma_f32_16x16x32_bf16 v[144:147], v[80:83], v[104:107], v[144:147]
  s_waitcnt vmcnt(7)
  v_mfma_f32_16x16x32_bf16 v[140:143], v[84:87], v[108:111], v[140:143]
  v_max3_u32 v190, v190, v108, v110
  v_mfma_f32_16x16x32_bf16 v[144:147], v[88:91], v[108:111], v[144:147]
  s_waitcnt vmcnt(6)
  v_mfma_f32_16x16x32_bf16 v[140:143], v[92:95], v[112:115], v[140:143]
  v_max3_u32 v190, v190, v112, v114
  v_mfma_f32_16x16x32_bf16 v[144:147], v[96:99], v[112:115], v[144:147]
  s_waitcnt vmcnt(5)
  v_mfma_f32_16x16x32_bf16 v[140:143], v[60:63], v[116:119], v[140:143]
  v_max3_u32 v190, v190, v116, v117
  v_mfma_f32_16x16x32_bf16 v[144:147], v[64:67], v[116:119], v[144:147]
  v_max3_u32 v190, v190, v118, v119
  v_cmp_eq_u32 vcc, -1, v190
  s_cbranch_vccz yp_92_okA_\sfx\()
  buffer_load_dwordx4 v[100:103], v178, s[8:11], s49 offen offset:0 sc1
  buffer_load_dwordx4 v[104:107], v178, s[8:11], s49 offen offset:1024 sc1
  buffer_load_dwordx4 v[108:111], v178, s[8:11], s49 offen offset:2048 sc1
  buffer_load_dwordx4 v[112:115], v178, s[8:11], s49 offen offset:3072 sc1
  buffer_load_dwordx4 v[116:119], v182, s[8:11], s49 offen sc1
  s_waitcnt vmcnt(9) lgkmcnt(0)
  v_mfma_f32_16x16x32_bf16 v[148:151], v[68:71], v[120:123], 0
  v_max_u32 v190, v120, v122
  v_mfma_f32_16x16x32_bf16 v[152:155], v[72:75], v[120:123], 0
  s_waitcnt vmcnt(8)
  v_mfma_f32_16x16x32_bf16 v[148:151], v[76:79], v[124:127], v[148:151]
  v_max3_u32 v190, v190, v124, v126
  v_mfma_f32_16x16x32_bf16 v[152:155], v[80:83], v[124:127], v[152:155]
  s_waitcnt vmcnt(7)
  v_mfma_f32_16x16x32_bf16 v[148:151], v[84:87], v[128:131], v[148:151]
  v_max3_u32 v190, v190, v128, v130
  v_mfma_f32_16x16x32_bf16 v[152:155], v[88:91], v[128:131], v[152:155]
  s_waitcnt vmcnt(6)
  v_mfma_f32_16x16x32_bf16 v[148:151], v[92:95], v[132:135], v[148:151]
  v_max3_u32 v190, v190, v132, v134
  v_mfma_f32_16x16x32_bf16 v[152:155], v[96:99], v[132:135], v[152:155]
  s_waitcnt vmcnt(5)
  v_mfma_f32_16x16x32_bf16 v[148:151], v[60:63], v[136:139], v[148:151]
  v_max3_u32 v190, v190, v136, v137
  v_mfma_f32_16x16x32_bf16 v[152:155], v[64:67], v[136:139], v[152:155]
  v_max3_u32 v190, v190, v138, v139
  v_cmp_eq_u32 vcc, -1, v190
  s_cbranch_vccz yp_92_okB_\sfx\()
  s_add_u32 s45, s45, 1
  s_cmp_lt_u32 s45, 400000
  s_cbranch_scc1 yp_92_c_\sfx\()
  s_branch ka\sfx\()_abort
yp_92_c_\sfx\():
  s_branch yp_92_\sfx\()
yp_92_okB_\sfx\():
  s_nop 4
  v_add_f32_dpp v140, v152, v148 row_ror:8 row_mask:0xf bank_mask:0xf
  v_add_f32_dpp v141, v153, v149 row_ror:8 row_mask:0xf bank_mask:0xf
  v_add_f32_dpp v142, v154, v150 row_ror:8 row_mask:0xf bank_mask:0xf
  v_add_f32_dpp v143, v155, v151 row_ror:8 row_mask:0xf bank_mask:0xf
  s_branch yp_92_j_\sfx\()
yp_92_okA_\sfx\():
  s_nop 4
  v_add_f32_dpp v140, v144, v140 row_ror:8 row_mask:0xf bank_mask:0xf
  v_add_f32_dpp v141, v145, v141 row_ror:8 row_mask:0xf bank_mask:0xf
  v_add_f32_dpp v142, v146, v142 row_ror:8 row_mask:0xf bank_mask:0xf
  v_add_f32_dpp v143, v147, v143 row_ror:8 row_mask:0xf bank_mask:0xf
yp_92_j_\sfx\():
  buffer_load_dwordx4 v[4:7], v185, s[8:11], s67 offen sc1
  buffer_load_dwordx4 v[8:11], v185, s[8:11], s68 offen sc1
  buffer_load_dwordx4 v[12:15], v185, s[8:11], s69 offen sc1
  buffer_store_dwordx4 v[140:143], v184, s[8:11], s66 offen sc1
  s_mov_b32 s45, 0
  buffer_load_dwordx4 v[148:151], v185, s[8:11], s67 offen sc1
  buffer_load_dwordx4 v[152:155], v185, s[8:11], s68 offen sc1
  buffer_load_dwordx4 v[156:159], v185, s[8:11], s69 offen sc1
  s_waitcnt vmcnt(4)
  v_max3_u32 v190, v4, v7, v8
  v_max3_u32 v190, v190, v11, v12
  v_max_u32 v190, v190, v15
  v_add_f32 v160, v140, v4
  v_add_f32 v161, v141, v5
  v_add_f32 v162, v142, v6
  v_add_f32 v163, v143, v7
  v_cmp_eq_u32 vcc, -1, v190
  v_add_f32 v164, v8, v12
  v_add_f32 v165, v9, v13
  v_add_f32 v166, v10, v14
  v_add_f32 v167, v11, v15
  s_cbranch_vccz yc_93_ok_\sfx\()
yc_93_\sfx\():
  buffer_load_dwordx4 v[4:7], v185, s[8:11], s67 offen sc1
  buffer_load_dwordx4 v[8:11], v185, s[8:11], s68 offen sc1
  buffer_load_dwordx4 v[12:15], v185, s[8:11], s69 offen sc1
  s_waitcnt vmcnt(3)
  v_max3_u32 v190, v148, v151, v152
  v_max3_u32 v190, v190, v155, v156
  v_max_u32 v190, v190, v159
  v_add_f32 v160, v140, v148
  v_add_f32 v161, v141, v149
  v_add_f32 v162, v142, v150
  v_add_f32 v163, v143, v151
  v_cmp_eq_u32 vcc, -1, v190
  v_add_f32 v164, v152, v156
  v_add_f32 v165, v153, v157
  v_add_f32 v166, v154, v158
  v_add_f32 v167, v155, v159
  s_cbranch_vccz yc_93_ok_\sfx\()
  buffer_load_dwordx4 v[148:151], v185, s[8:11], s67 offen sc1
  buffer_load_dwordx4 v[152:155], v185, s[8:11], s68 offen sc1
  buffer_load_dwordx4 v[156:159], v185, s[8:11], s69 offen sc1
  s_waitcnt vmcnt(3)
  v_max3_u32 v190, v4, v7, v8
  v_max3_u32 v190, v190, v11, v12
  v_max_u32 v190, v190, v15
  v_add_f32 v160, v140, v4
  v_add_f32 v161, v141, v5
  v_add_f32 v162, v142, v6
  v_add_f32 v163, v143, v7
  v_cmp_eq_u32 vcc, -1, v190
  v_add_f32 v164, v8, v12
  v_add_f32 v165, v9, v13
  v_add_f32 v166, v10, v14
  v_add_f32 v167, v11, v15
  s_cbranch_vccz yc_93_ok_\sfx\()
  s_add_u32 s45, s45, 1
  s_cmp_lt_u32 s45, 400000
  s_cbranch_scc1 yc_93_\sfx\()
  s_branch ka\sfx\()_abort
yc_93_ok_\sfx\():
  v_add_f32 v160, v160, v164
  v_add_f32 v161, v161, v165
  v_add_f32 v162, v162, v166
  v_add_f32 v163, v163, v167
  v_cvt_pk_bf16_f32 v168, v160, v161
  v_cvt_pk_bf16_f32 v169, v162, v163
  buffer_store_dword v168, v186, s[8:11], s60 offen \pol
  buffer_store_dword v169, v186, s[8:11], s60 offen offset:128 \pol
  s_add_u32 s97, s97, 10240
  s_mov_b32 s48, s97
  s_add_u32 s60, s60, 10240
  s_add_u32 s49, s49, 5120
  s_add_u32 s56, s56, s61
  s_add_u32 s57, s57, s61
  s_add_u32 s58, s58, s61
  s_add_u32 s59, s59, s61
  s_mov_b32 s61, 0
  s_add_u32 s28, s51, 1
  s_and_b32 s28, s28, 3
  s_mul_i32 s28, s28, 163840
  s_add_u32 s66, s56, s28
  s_add_u32 s67, s57, s28
  s_add_u32 s68, s58, s28
  s_add_u32 s69, s59, s28
  s_add_u32 s51, s51, 1
  s_branch ka\sfx\()_y_crit
ka\sfx\()_y_crit_end:
  s_waitcnt vmcnt(0) lgkmcnt(0)
  s_branch ka\sfx\()_exit
ka\sfx\()_y_tok:
  s_mul_i32 s61, s20, 1310720
  s_add_u32 s61, s61, 0xe00000
  s_mul_i32 s62, s20, 2621440
  s_lshl_b32 s28, s46, 10
  s_add_u32 s62, s62, s28
  s_add_u32 s62, s62, 0x1a00000
  s_mov_b32 s54, 0
  s_and_b32 s63, s21, 1
  s_lshl_b32 s63, s63, 10
  s_add_u32 s63, s63, 32768
  s_and_b32 s64, s21, 1
  s_mul_i32 s64, s64, 10240
ka\sfx\()_y_tokl:
  s_barrier
  ds_read_b128 v[4:7], v177 offset:0
  ds_read_b128 v[8:11], v177 offset:1024
  ds_read_b128 v[12:15], v177 offset:2048
  ds_read_b128 v[16:19], v177 offset:3072
  ds_read_b128 v[20:23], v177 offset:4096
  ds_read_b128 v[24:27], v177 offset:5120
  ds_read_b128 v[28:31], v177 offset:6144
  ds_read_b128 v[32:35], v177 offset:7168
  ds_read_b128 v[36:39], v177 offset:8192
  ds_read_b128 v[40:43], v177 offset:9216
  s_cmp_gt_u32 s52, s51
  s_cbranch_scc1 ka\sfx\()_y_wp_94_ok
  s_mov_b32 s45, 0
ka\sfx\()_y_wp_94_spin:
  buffer_load_dword v2, v187, s[8:11], 0 offen sc1
  s_add_u32 s45, s45, 1
  s_waitcnt vmcnt(0)
  v_min_u32_dpp v3, v2, v2 quad_perm:[1,0,3,2] row_mask:0xf bank_mask:0xf
  s_nop 1
  v_min_u32_dpp v2, v3, v3 quad_perm:[2,3,0,1] row_mask:0xf bank_mask:0xf
  s_nop 1
  v_min_u32_dpp v3, v2, v2 row_half_mirror row_mask:0xf bank_mask:0xf
  s_nop 1
  v_min_u32_dpp v2, v3, v3 quad_perm:[0,1,2,3] row_mask:0xf bank_mask:0xf
  s_nop 0
  v_readfirstlane_b32 s52, v2
  s_cmp_gt_u32 s52, s51
  s_cbranch_scc1 ka\sfx\()_y_wp_94_ok
  s_cmp_lt_u32 s45, 400000
  s_cbranch_scc1 ka\sfx\()_y_wp_94_spin
  s_branch ka\sfx\()_abort
ka\sfx\()_y_wp_94_ok:
  s_add_u32 s65, s61, s64
  s_waitcnt lgkmcnt(9)
  v_smfmac_f32_16x16x64_bf16 v[44:47], v[4:7], a[0:7], v172
  s_add_u32 m0, s63, 0
  s_add_u32 s28, s50, 0
  buffer_load_dwordx4 v178, s[8:11], s28 offen sc1 lds
  v_smfmac_f32_16x16x64_bf16 v[48:51], v[4:7], a[80:87], v172
  v_smfmac_f32_16x16x64_bf16 v[52:55], v[4:7], a[160:167], v172
  s_add_u32 m0, s63, 2048
  s_add_u32 s28, s50, 40960
  buffer_load_dwordx4 v178, s[8:11], s28 offen sc1 lds
  v_smfmac_f32_16x16x64_bf16 v[56:59], v[4:7], a[240:247], v172
  s_waitcnt lgkmcnt(8)
  v_smfmac_f32_16x16x64_bf16 v[44:47], v[8:11], a[8:15], v172
  s_add_u32 m0, s63, 4096
  s_add_u32 s28, s50, 81920
  buffer_load_dwordx4 v178, s[8:11], s28 offen sc1 lds
  v_smfmac_f32_16x16x64_bf16 v[48:51], v[8:11], a[88:95], v172
  v_smfmac_f32_16x16x64_bf16 v[52:55], v[8:11], a[168:175], v172
  s_add_u32 m0, s63, 6144
  s_add_u32 s28, s50, 122880
  buffer_load_dwordx4 v178, s[8:11], s28 offen sc1 lds
  v_smfmac_f32_16x16x64_bf16 v[56:59], v[8:11], a[248:255], v172
  s_waitcnt lgkmcnt(7)
  v_smfmac_f32_16x16x64_bf16 v[44:47], v[12:15], a[16:23], v172
  s_add_u32 m0, s63, 8192
  s_add_u32 s28, s50, 163840
  buffer_load_dwordx4 v178, s[8:11], s28 offen sc1 lds
  v_smfmac_f32_16x16x64_bf16 v[48:51], v[12:15], a[96:103], v172
  v_smfmac_f32_16x16x64_bf16 v[52:55], v[12:15], a[176:183], v172
  s_add_u32 m0, s63, 10240
  s_add_u32 s28, s50, 204800
  buffer_load_dwordx4 v178, s[8:11], s28 offen sc1 lds
  v_smfmac_f32_16x16x64_bf16 v[56:59], v[12:15], v[192:199], v172
  s_waitcnt lgkmcnt(6)
  v_smfmac_f32_16x16x64_bf16 v[44:47], v[16:19], a[24:31], v172
  s_add_u32 m0, s63, 12288
  s_add_u32 s28, s50, 245760
  buffer_load_dwordx4 v178, s[8:11], s28 offen sc1 lds
  v_smfmac_f32_16x16x64_bf16 v[48:51], v[16:19], a[104:111], v172
  v_smfmac_f32_16x16x64_bf16 v[52:55], v[16:19], a[184:191], v172
  s_add_u32 m0, s63, 14336
  s_add_u32 s28, s50, 286720
  buffer_load_dwordx4 v178, s[8:11], s28 offen sc1 lds
  v_smfmac_f32_16x16x64_bf16 v[56:59], v[16:19], v[200:207], v172
  s_waitcnt lgkmcnt(5)
  v_smfmac_f32_16x16x64_bf16 v[44:47], v[20:23], a[32:39], v172
  s_add_u32 m0, s64, 65536
  s_add_u32 s28, s65, 0
  buffer_load_dwordx4 v178, s[8:11], s28 offen sc1 lds
  v_smfmac_f32_16x16x64_bf16 v[48:51], v[20:23], a[112:119], v172
  v_smfmac_f32_16x16x64_bf16 v[52:55], v[20:23], a[192:199], v172
  s_add_u32 m0, s64, 66560
  s_add_u32 s28, s65, 1024
  buffer_load_dwordx4 v178, s[8:11], s28 offen sc1 lds
  v_smfmac_f32_16x16x64_bf16 v[56:59], v[20:23], v[208:215], v172
  s_waitcnt lgkmcnt(4)
  v_smfmac_f32_16x16x64_bf16 v[44:47], v[24:27], a[40:47], v172
  s_add_u32 m0, s64, 67584
  s_add_u32 s28, s65, 2048
  buffer_load_dwordx4 v178, s[8:11], s28 offen sc1 lds
  v_smfmac_f32_16x16x64_bf16 v[48:51], v[24:27], a[120:127], v172
  v_smfmac_f32_16x16x64_bf16 v[52:55], v[24:27], a[200:207], v172
  s_add_u32 m0, s64, 68608
  s_add_u32 s28, s65, 3072
  buffer_load_dwordx4 v178, s[8:11], s28 offen sc1 lds
  v_smfmac_f32_16x16x64_bf16 v[56:59], v[24:27], v[216:223], v172
  s_waitcnt lgkmcnt(3)
  v_smfmac_f32_16x16x64_bf16 v[44:47], v[28:31], a[48:55], v172
  s_add_u32 m0, s64, 69632
  s_add_u32 s28, s65, 4096
  buffer_load_dwordx4 v178, s[8:11], s28 offen sc1 lds
  v_smfmac_f32_16x16x64_bf16 v[48:51], v[28:31], a[128:135], v172
  v_smfmac_f32_16x16x64_bf16 v[52:55], v[28:31], a[208:215], v172
  s_add_u32 m0, s64, 70656
  s_add_u32 s28, s65, 5120
  buffer_load_dwordx4 v178, s[8:11], s28 offen sc1 lds
  v_smfmac_f32_16x16x64_bf16 v[56:59], v[28:31], v[224:231], v172
  s_waitcnt lgkmcnt(2)
  v_smfmac_f32_16x16x64_bf16 v[44:47], v[32:35], a[56:63], v172
  s_add_u32 m0, s64, 71680
  s_add_u32 s28, s65, 6144
  buffer_load_dwordx4 v178, s[8:11], s28 offen sc1 lds
  v_smfmac_f32_16x16x64_bf16 v[48:51], v[32:35], a[136:143], v172
  v_smfmac_f32_16x16x64_bf16 v[52:55], v[32:35], a[216:223], v172
  s_add_u32 m0, s64, 72704
  s_add_u32 s28, s65, 7168
  buffer_load_dwordx4 v178, s[8:11], s28 offen sc1 lds
  v_smfmac_f32_16x16x64_bf16 v[56:59], v[32:35], v[232:239], v172
  s_waitcnt lgkmcnt(1)
  v_smfmac_f32_16x16x64_bf16 v[44:47], v[36:39], a[64:71], v172
  s_add_u32 m0, s64, 73728
  s_add_u32 s28, s65, 8192
  buffer_load_dwordx4 v178, s[8:11], s28 offen sc1 lds
  v_smfmac_f32_16x16x64_bf16 v[48:51], v[36:39], a[144:151], v172
  v_smfmac_f32_16x16x64_bf16 v[52:55], v[36:39], a[224:231], v172
  s_add_u32 m0, s64, 74752
  s_add_u32 s28, s65, 9216
  buffer_load_dwordx4 v178, s[8:11], s28 offen sc1 lds
  v_smfmac_f32_16x16x64_bf16 v[56:59], v[36:39], v[240:247], v172
  s_waitcnt lgkmcnt(0)
  v_smfmac_f32_16x16x64_bf16 v[44:47], v[40:43], a[72:79], v172
  v_smfmac_f32_16x16x64_bf16 v[48:51], v[40:43], a[152:159], v172
  v_smfmac_f32_16x16x64_bf16 v[52:55], v[40:43], a[232:239], v172
  v_smfmac_f32_16x16x64_bf16 v[56:59], v[40:43], v[248:255], v172
  s_xor_b32 s63, s63, 0x4000
  s_add_u32 s50, s50, 1310720
  s_nop 9
  v_permlane32_swap_b32 v44, v48
  v_permlane32_swap_b32 v45, v49
  v_permlane32_swap_b32 v46, v50
  v_permlane32_swap_b32 v47, v51
  v_permlane32_swap_b32 v52, v56
  v_permlane32_swap_b32 v53, v57
  v_permlane32_swap_b32 v54, v58
  v_permlane32_swap_b32 v55, v59
  v_add_f32 v44, v44, v48
  v_add_f32 v45, v45, v49
  v_add_f32 v46, v46, v50
  v_add_f32 v47, v47, v51
  v_add_f32 v52, v52, v56
  v_add_f32 v53, v53, v57
  v_add_f32 v54, v54, v58
  v_add_f32 v55, v55, v59
  v_cvt_pk_bf16_f32 v64, v44, v45
  v_cvt_pk_bf16_f32 v65, v46, v47
  v_cvt_pk_bf16_f32 v66, v52, v53
  v_cvt_pk_bf16_f32 v67, v54, v55
  ds_write_b128 v179, v[64:67]
  v_mov_b32 v44, 0
  v_mov_b32 v45, 0
  v_mov_b32 v46, 0
  v_mov_b32 v47, 0
  v_mov_b32 v48, 0
  v_mov_b32 v49, 0
  v_mov_b32 v50, 0
  v_mov_b32 v51, 0
  v_mov_b32 v52, 0
  v_mov_b32 v53, 0
  v_mov_b32 v54, 0
  v_mov_b32 v55, 0
  v_mov_b32 v56, 0
  v_mov_b32 v57, 0
  v_mov_b32 v58, 0
  v_mov_b32 v59, 0
  s_waitcnt vmcnt(0) lgkmcnt(0)
  s_barrier
  ds_read_b128 v[60:63], v180
  s_cmp_eq_u32 s51, 0
  s_cbranch_scc1 yt_95_\sfx\()
  ds_read_b128 v[68:71], v181 offset:0
  ds_read_b128 v[72:75], v181 offset:2048
  ds_read_b128 v[76:79], v181 offset:4096
  ds_read_b128 v[80:83], v181 offset:6144
  ds_read_b128 v[84:87], v181 offset:8192
  ds_read_b128 v[88:91], v181 offset:10240
  ds_read_b128 v[92:95], v181 offset:12288
  ds_read_b128 v[96:99], v181 offset:14336
  s_mov_b32 s45, 0
ytp_96_\sfx\():
  s_waitcnt lgkmcnt(0)
  ds_read_b128 v[100:103], v183 offset:0
  ds_read_b128 v[104:107], v183 offset:2048
  ds_read_b128 v[108:111], v183 offset:4096
  ds_read_b128 v[112:115], v183 offset:6144
  ds_read_b128 v[116:119], v183 offset:8192
  ds_read_b128 v[120:123], v183 offset:10240
  ds_read_b128 v[124:127], v183 offset:12288
  ds_read_b128 v[128:131], v183 offset:14336
  ds_read_b128 v[132:135], v183 offset:16384
  ds_read_b128 v[136:139], v183 offset:18432
  s_waitcnt lgkmcnt(0)
  v_max_u32 v190, v100, v102
  v_max3_u32 v190, v190, v104, v106
  v_max3_u32 v190, v190, v108, v110
  v_max3_u32 v190, v190, v112, v114
  v_max3_u32 v190, v190, v116, v118
  v_max3_u32 v190, v190, v120, v122
  v_max3_u32 v190, v190, v124, v126
  v_max3_u32 v190, v190, v128, v130
  v_max3_u32 v190, v190, v132, v134
  v_max3_u32 v190, v190, v136, v138
  v_cmp_eq_u32 vcc, -1, v190
  s_cbranch_vccz ytp_96_ok_\sfx\()
  s_add_u32 s45, s45, 1
  s_cmp_lt_u32 s45, 400000
  s_cbranch_scc0 ka\sfx\()_abort
ytp_96_dma_\sfx\():
  s_mov_b32 m0, 65536
  s_add_u32 s28, s61, 0
  buffer_load_dwordx4 v178, s[8:11], s28 offen sc1 lds
  s_mov_b32 m0, 66560
  s_add_u32 s28, s61, 1024
  buffer_load_dwordx4 v178, s[8:11], s28 offen sc1 lds
  s_mov_b32 m0, 67584
  s_add_u32 s28, s61, 2048
  buffer_load_dwordx4 v178, s[8:11], s28 offen sc1 lds
  s_mov_b32 m0, 68608
  s_add_u32 s28, s61, 3072
  buffer_load_dwordx4 v178, s[8:11], s28 offen sc1 lds
  s_mov_b32 m0, 69632
  s_add_u32 s28, s61, 4096
  buffer_load_dwordx4 v178, s[8:11], s28 offen sc1 lds
  s_mov_b32 m0, 70656
  s_add_u32 s28, s61, 5120
  buffer_load_dwordx4 v178, s[8:11], s28 offen sc1 lds
  s_mov_b32 m0, 71680
  s_add_u32 s28, s61, 6144
  buffer_load_dwordx4 v178, s[8:11], s28 offen sc1 lds
  s_mov_b32 m0, 72704
  s_add_u32 s28, s61, 7168
  buffer_load_dwordx4 v178, s[8:11], s28 offen sc1 lds
  s_mov_b32 m0, 73728
  s_add_u32 s28, s61, 8192
  buffer_load_dwordx4 v178, s[8:11], s28 offen sc1 lds
  s_mov_b32 m0, 74752
  s_add_u32 s28, s61, 9216
  buffer_load_dwordx4 v178, s[8:11], s28 offen sc1 lds
  s_mov_b32 m0, 75776
  s_add_u32 s28, s61, 10240
  buffer_load_dwordx4 v178, s[8:11], s28 offen sc1 lds
  s_mov_b32 m0, 76800
  s_add_u32 s28, s61, 11264
  buffer_load_dwordx4 v178, s[8:11], s28 offen sc1 lds
  s_mov_b32 m0, 77824
  s_add_u32 s28, s61, 12288
  buffer_load_dwordx4 v178, s[8:11], s28 offen sc1 lds
  s_mov_b32 m0, 78848
  s_add_u32 s28, s61, 13312
  buffer_load_dwordx4 v178, s[8:11], s28 offen sc1 lds
  s_mov_b32 m0, 79872
  s_add_u32 s28, s61, 14336
  buffer_load_dwordx4 v178, s[8:11], s28 offen sc1 lds
  s_mov_b32 m0, 80896
  s_add_u32 s28, s61, 15360
  buffer_load_dwordx4 v178, s[8:11], s28 offen sc1 lds
  s_mov_b32 m0, 81920
  s_add_u32 s28, s61, 16384
  buffer_load_dwordx4 v178, s[8:11], s28 offen sc1 lds
  s_mov_b32 m0, 82944
  s_add_u32 s28, s61, 17408
  buffer_load_dwordx4 v178, s[8:11], s28 offen sc1 lds
  s_mov_b32 m0, 83968
  s_add_u32 s28, s61, 18432
  buffer_load_dwordx4 v178, s[8:11], s28 offen sc1 lds
  s_mov_b32 m0, 84992
  s_add_u32 s28, s61, 19456
  buffer_load_dwordx4 v178, s[8:11], s28 offen sc1 lds
  s_waitcnt vmcnt(0)
  s_branch ytp_96_\sfx\()
ytp_96_ok_\sfx\():
  v_mfma_f32_16x16x32_bf16 v[140:143], v[68:71], v[100:103], 0
  v_mfma_f32_16x16x32_bf16 v[140:143], v[72:75], v[104:107], v[140:143]
  v_mfma_f32_16x16x32_bf16 v[140:143], v[76:79], v[108:111], v[140:143]
  v_mfma_f32_16x16x32_bf16 v[140:143], v[80:83], v[112:115], v[140:143]
  v_mfma_f32_16x16x32_bf16 v[140:143], v[84:87], v[116:119], v[140:143]
  v_mfma_f32_16x16x32_bf16 v[140:143], v[88:91], v[120:123], v[140:143]
  v_mfma_f32_16x16x32_bf16 v[140:143], v[92:95], v[124:127], v[140:143]
  v_mfma_f32_16x16x32_bf16 v[140:143], v[96:99], v[128:131], v[140:143]
  v_mfma_f32_16x16x32_bf16 v[140:143], v[148:151], v[132:135], v[140:143]
  v_mfma_f32_16x16x32_bf16 v[140:143], v[152:155], v[136:139], v[140:143]
  s_nop 8
  v_cvt_pk_bf16_f32 v144, v140, v141
  v_cvt_pk_bf16_f32 v145, v142, v143
  s_add_u32 s28, s62, 0
  buffer_store_dwordx2 v[144:145], v189, s[8:11], s28 offen
  s_nop 1
  s_mov_b32 s45, 0
ytp_97_\sfx\():
  s_waitcnt lgkmcnt(0)
  ds_read_b128 v[100:103], v183 offset:1024
  ds_read_b128 v[104:107], v183 offset:3072
  ds_read_b128 v[108:111], v183 offset:5120
  ds_read_b128 v[112:115], v183 offset:7168
  ds_read_b128 v[116:119], v183 offset:9216
  ds_read_b128 v[120:123], v183 offset:11264
  ds_read_b128 v[124:127], v183 offset:13312
  ds_read_b128 v[128:131], v183 offset:15360
  ds_read_b128 v[132:135], v183 offset:17408
  ds_read_b128 v[136:139], v183 offset:19456
  s_waitcnt lgkmcnt(0)
  v_max_u32 v190, v100, v102
  v_max3_u32 v190, v190, v104, v106
  v_max3_u32 v190, v190, v108, v110
  v_max3_u32 v190, v190, v112, v114
  v_max3_u32 v190, v190, v116, v118
  v_max3_u32 v190, v190, v120, v122
  v_max3_u32 v190, v190, v124, v126
  v_max3_u32 v190, v190, v128, v130
  v_max3_u32 v190, v190, v132, v134
  v_max3_u32 v190, v190, v136, v138
  v_cmp_eq_u32 vcc, -1, v190
  s_cbranch_vccz ytp_97_ok_\sfx\()
  s_add_u32 s45, s45, 1
  s_cmp_lt_u32 s45, 400000
  s_cbranch_scc0 ka\sfx\()_abort
ytp_97_dma_\sfx\():
  s_mov_b32 m0, 65536
  s_add_u32 s28, s61, 0
  buffer_load_dwordx4 v178, s[8:11], s28 offen sc1 lds
  s_mov_b32 m0, 66560
  s_add_u32 s28, s61, 1024
  buffer_load_dwordx4 v178, s[8:11], s28 offen sc1 lds
  s_mov_b32 m0, 67584
  s_add_u32 s28, s61, 2048
  buffer_load_dwordx4 v178, s[8:11], s28 offen sc1 lds
  s_mov_b32 m0, 68608
  s_add_u32 s28, s61, 3072
  buffer_load_dwordx4 v178, s[8:11], s28 offen sc1 lds
  s_mov_b32 m0, 69632
  s_add_u32 s28, s61, 4096
  buffer_load_dwordx4 v178, s[8:11], s28 offen sc1 lds
  s_mov_b32 m0, 70656
  s_add_u32 s28, s61, 5120
  buffer_load_dwordx4 v178, s[8:11], s28 offen sc1 lds
  s_mov_b32 m0, 71680
  s_add_u32 s28, s61, 6144
  buffer_load_dwordx4 v178, s[8:11], s28 offen sc1 lds
  s_mov_b32 m0, 72704
  s_add_u32 s28, s61, 7168
  buffer_load_dwordx4 v178, s[8:11], s28 offen sc1 lds
  s_mov_b32 m0, 73728
  s_add_u32 s28, s61, 8192
  buffer_load_dwordx4 v178, s[8:11], s28 offen sc1 lds
  s_mov_b32 m0, 74752
  s_add_u32 s28, s61, 9216
  buffer_load_dwordx4 v178, s[8:11], s28 offen sc1 lds
  s_mov_b32 m0, 75776
  s_add_u32 s28, s61, 10240
  buffer_load_dwordx4 v178, s[8:11], s28 offen sc1 lds
  s_mov_b32 m0, 76800
  s_add_u32 s28, s61, 11264
  buffer_load_dwordx4 v178, s[8:11], s28 offen sc1 lds
  s_mov_b32 m0, 77824
  s_add_u32 s28, s61, 12288
  buffer_load_dwordx4 v178, s[8:11], s28 offen sc1 lds
  s_mov_b32 m0, 78848
  s_add_u32 s28, s61, 13312
  buffer_load_dwordx4 v178, s[8:11], s28 offen sc1 lds
  s_mov_b32 m0, 79872
  s_add_u32 s28, s61, 14336
  buffer_load_dwordx4 v178, s[8:11], s28 offen sc1 lds
  s_mov_b32 m0, 80896
  s_add_u32 s28, s61, 15360
  buffer_load_dwordx4 v178, s[8:11], s28 offen sc1 lds
  s_mov_b32 m0, 81920
  s_add_u32 s28, s61, 16384
  buffer_load_dwordx4 v178, s[8:11], s28 offen sc1 lds
  s_mov_b32 m0, 82944
  s_add_u32 s28, s61, 17408
  buffer_load_dwordx4 v178, s[8:11], s28 offen sc1 lds
  s_mov_b32 m0, 83968
  s_add_u32 s28, s61, 18432
  buffer_load_dwordx4 v178, s[8:11], s28 offen sc1 lds
  s_mov_b32 m0, 84992
  s_add_u32 s28, s61, 19456
  buffer_load_dwordx4 v178, s[8:11], s28 offen sc1 lds
  s_waitcnt vmcnt(0)
  s_branch ytp_97_\sfx\()
ytp_97_ok_\sfx\():
  v_mfma_f32_16x16x32_bf16 v[140:143], v[68:71], v[100:103], 0
  v_mfma_f32_16x16x32_bf16 v[140:143], v[72:75], v[104:107], v[140:143]
  v_mfma_f32_16x16x32_bf16 v[140:143], v[76:79], v[108:111], v[140:143]
  v_mfma_f32_16x16x32_bf16 v[140:143], v[80:83], v[112:115], v[140:143]
  v_mfma_f32_16x16x32_bf16 v[140:143], v[84:87], v[116:119], v[140:143]
  v_mfma_f32_16x16x32_bf16 v[140:143], v[88:91], v[120:123], v[140:143]
  v_mfma_f32_16x16x32_bf16 v[140:143], v[92:95], v[124:127], v[140:143]
  v_mfma_f32_16x16x32_bf16 v[140:143], v[96:99], v[128:131], v[140:143]
  v_mfma_f32_16x16x32_bf16 v[140:143], v[148:151], v[132:135], v[140:143]
  v_mfma_f32_16x16x32_bf16 v[140:143], v[152:155], v[136:139], v[140:143]
  s_nop 8
  v_cvt_pk_bf16_f32 v144, v140, v141
  v_cvt_pk_bf16_f32 v145, v142, v143
  s_add_u32 s28, s62, 256
  buffer_store_dwordx2 v[144:145], v189, s[8:11], s28 offen
  s_nop 1
  s_add_u32 s61, s61, 20480
  s_add_u32 s62, s62, 40960
  s_add_u32 s54, s54, 1
  v_xor_b32 v181, 0x4000, v181
yt_95_\sfx\():
  s_waitcnt lgkmcnt(0)
  v_mov_b32 v148, v60
  v_mov_b32 v149, v61
  v_mov_b32 v150, v62
  v_mov_b32 v151, v63
  v_mov_b32 v152, v64
  v_mov_b32 v153, v65
  v_mov_b32 v154, v66
  v_mov_b32 v155, v67
  s_add_u32 s97, s97, 10240
  s_mov_b32 s48, s97
  s_add_u32 s51, s51, 1
  s_cmp_lt_u32 s51, 64
  s_cbranch_scc1 ka\sfx\()_y_tokl
  s_barrier
  ds_read_b128 v[68:71], v181 offset:0
  ds_read_b128 v[72:75], v181 offset:2048
  ds_read_b128 v[76:79], v181 offset:4096
  ds_read_b128 v[80:83], v181 offset:6144
  ds_read_b128 v[84:87], v181 offset:8192
  ds_read_b128 v[88:91], v181 offset:10240
  ds_read_b128 v[92:95], v181 offset:12288
  ds_read_b128 v[96:99], v181 offset:14336
  s_mov_b32 s45, 0
  s_branch ytp_98_dma_\sfx\()
ytp_98_\sfx\():
  s_waitcnt lgkmcnt(0)
  ds_read_b128 v[100:103], v183 offset:0
  ds_read_b128 v[104:107], v183 offset:2048
  ds_read_b128 v[108:111], v183 offset:4096
  ds_read_b128 v[112:115], v183 offset:6144
  ds_read_b128 v[116:119], v183 offset:8192
  ds_read_b128 v[120:123], v183 offset:10240
  ds_read_b128 v[124:127], v183 offset:12288
  ds_read_b128 v[128:131], v183 offset:14336
  ds_read_b128 v[132:135], v183 offset:16384
  ds_read_b128 v[136:139], v183 offset:18432
  s_waitcnt lgkmcnt(0)
  v_max_u32 v190, v100, v102
  v_max3_u32 v190, v190, v104, v106
  v_max3_u32 v190, v190, v108, v110
  v_max3_u32 v190, v190, v112, v114
  v_max3_u32 v190, v190, v116, v118
  v_max3_u32 v190, v190, v120, v122
  v_max3_u32 v190, v190, v124, v126
  v_max3_u32 v190, v190, v128, v130
  v_max3_u32 v190, v190, v132, v134
  v_max3_u32 v190, v190, v136, v138
  v_cmp_eq_u32 vcc, -1, v190
  s_cbranch_vccz ytp_98_ok_\sfx\()
  s_add_u32 s45, s45, 1
  s_cmp_lt_u32 s45, 400000
  s_cbranch_scc0 ka\sfx\()_abort
ytp_98_dma_\sfx\():
  s_mov_b32 m0, 65536
  s_add_u32 s28, s61, 0
  buffer_load_dwordx4 v178, s[8:11], s28 offen sc1 lds
  s_mov_b32 m0, 66560
  s_add_u32 s28, s61, 1024
  buffer_load_dwordx4 v178, s[8:11], s28 offen sc1 lds
  s_mov_b32 m0, 67584
  s_add_u32 s28, s61, 2048
  buffer_load_dwordx4 v178, s[8:11], s28 offen sc1 lds
  s_mov_b32 m0, 68608
  s_add_u32 s28, s61, 3072
  buffer_load_dwordx4 v178, s[8:11], s28 offen sc1 lds
  s_mov_b32 m0, 69632
  s_add_u32 s28, s61, 4096
  buffer_load_dwordx4 v178, s[8:11], s28 offen sc1 lds
  s_mov_b32 m0, 70656
  s_add_u32 s28, s61, 5120
  buffer_load_dwordx4 v178, s[8:11], s28 offen sc1 lds
  s_mov_b32 m0, 71680
  s_add_u32 s28, s61, 6144
  buffer_load_dwordx4 v178, s[8:11], s28 offen sc1 lds
  s_mov_b32 m0, 72704
  s_add_u32 s28, s61, 7168
  buffer_load_dwordx4 v178, s[8:11], s28 offen sc1 lds
  s_mov_b32 m0, 73728
  s_add_u32 s28, s61, 8192
  buffer_load_dwordx4 v178, s[8:11], s28 offen sc1 lds
  s_mov_b32 m0, 74752
  s_add_u32 s28, s61, 9216
  buffer_load_dwordx4 v178, s[8:11], s28 offen sc1 lds
  s_mov_b32 m0, 75776
  s_add_u32 s28, s61, 10240
  buffer_load_dwordx4 v178, s[8:11], s28 offen sc1 lds
  s_mov_b32 m0, 76800
  s_add_u32 s28, s61, 11264
  buffer_load_dwordx4 v178, s[8:11], s28 offen sc1 lds
  s_mov_b32 m0, 77824
  s_add_u32 s28, s61, 12288
  buffer_load_dwordx4 v178, s[8:11], s28 offen sc1 lds
  s_mov_b32 m0, 78848
  s_add_u32 s28, s61, 13312
  buffer_load_dwordx4 v178, s[8:11], s28 offen sc1 lds
  s_mov_b32 m0, 79872
  s_add_u32 s28, s61, 14336
  buffer_load_dwordx4 v178, s[8:11], s28 offen sc1 lds
  s_mov_b32 m0, 80896
  s_add_u32 s28, s61, 15360
  buffer_load_dwordx4 v178, s[8:11], s28 offen sc1 lds
  s_mov_b32 m0, 81920
  s_add_u32 s28, s61, 16384
  buffer_load_dwordx4 v178, s[8:11], s28 offen sc1 lds
  s_mov_b32 m0, 82944
  s_add_u32 s28, s61, 17408
  buffer_load_dwordx4 v178, s[8:11], s28 offen sc1 lds
  s_mov_b32 m0, 83968
  s_add_u32 s28, s61, 18432
  buffer_load_dwordx4 v178, s[8:11], s28 offen sc1 lds
  s_mov_b32 m0, 84992
  s_add_u32 s28, s61, 19456
  buffer_load_dwordx4 v178, s[8:11], s28 offen sc1 lds
  s_waitcnt vmcnt(0)
  s_branch ytp_98_\sfx\()
ytp_98_ok_\sfx\():
  v_mfma_f32_16x16x32_bf16 v[140:143], v[68:71], v[100:103], 0
  v_mfma_f32_16x16x32_bf16 v[140:143], v[72:75], v[104:107], v[140:143]
  v_mfma_f32_16x16x32_bf16 v[140:143], v[76:79], v[108:111], v[140:143]
  v_mfma_f32_16x16x32_bf16 v[140:143], v[80:83], v[112:115], v[140:143]
  v_mfma_f32_16x16x32_bf16 v[140:143], v[84:87], v[116:119], v[140:143]
  v_mfma_f32_16x16x32_bf16 v[140:143], v[88:91], v[120:123], v[140:143]
  v_mfma_f32_16x16x32_bf16 v[140:143], v[92:95], v[124:127], v[140:143]
  v_mfma_f32_16x16x32_bf16 v[140:143], v[96:99], v[128:131], v[140:143]
  v_mfma_f32_16x16x32_bf16 v[140:143], v[148:151], v[132:135], v[140:143]
  v_mfma_f32_16x16x32_bf16 v[140:143], v[152:155], v[136:139], v[140:143]
  s_nop 8
  v_cvt_pk_bf16_f32 v144, v140, v141
  v_cvt_pk_bf16_f32 v145, v142, v143
  s_add_u32 s28, s62, 0
  buffer_store_dwordx2 v[144:145], v189, s[8:11], s28 offen
  s_nop 1
  s_mov_b32 s45, 0
ytp_99_\sfx\():
  s_waitcnt lgkmcnt(0)
  ds_read_b128 v[100:103], v183 offset:1024
  ds_read_b128 v[104:107], v183 offset:3072
  ds_read_b128 v[108:111], v183 offset:5120
  ds_read_b128 v[112:115], v183 offset:7168
  ds_read_b128 v[116:119], v183 offset:9216
  ds_read_b128 v[120:123], v183 offset:11264
  ds_read_b128 v[124:127], v183 offset:13312
  ds_read_b128 v[128:131], v183 offset:15360
  ds_read_b128 v[132:135], v183 offset:17408
  ds_read_b128 v[136:139], v183 offset:19456
  s_waitcnt lgkmcnt(0)
  v_max_u32 v190, v100, v102
  v_max3_u32 v190, v190, v104, v106
  v_max3_u32 v190, v190, v108, v110
  v_max3_u32 v190, v190, v112, v114
  v_max3_u32 v190, v190, v116, v118
  v_max3_u32 v190, v190, v120, v122
  v_max3_u32 v190, v190, v124, v126
  v_max3_u32 v190, v190, v128, v130
  v_max3_u32 v190, v190, v132, v134
  v_max3_u32 v190, v190, v136, v138
  v_cmp_eq_u32 vcc, -1, v190
  s_cbranch_vccz ytp_99_ok_\sfx\()
  s_add_u32 s45, s45, 1
  s_cmp_lt_u32 s45, 400000
  s_cbranch_scc0 ka\sfx\()_abort
ytp_99_dma_\sfx\():
  s_mov_b32 m0, 65536
  s_add_u32 s28, s61, 0
  buffer_load_dwordx4 v178, s[8:11], s28 offen sc1 lds
  s_mov_b32 m0, 66560
  s_add_u32 s28, s61, 1024
  buffer_load_dwordx4 v178, s[8:11], s28 offen sc1 lds
  s_mov_b32 m0, 67584
  s_add_u32 s28, s61, 2048
  buffer_load_dwordx4 v178, s[8:11], s28 offen sc1 lds
  s_mov_b32 m0, 68608
  s_add_u32 s28, s61, 3072
  buffer_load_dwordx4 v178, s[8:11], s28 offen sc1 lds
  s_mov_b32 m0, 69632
  s_add_u32 s28, s61, 4096
  buffer_load_dwordx4 v178, s[8:11], s28 offen sc1 lds
  s_mov_b32 m0, 70656
  s_add_u32 s28, s61, 5120
  buffer_load_dwordx4 v178, s[8:11], s28 offen sc1 lds
  s_mov_b32 m0, 71680
  s_add_u32 s28, s61, 6144
  buffer_load_dwordx4 v178, s[8:11], s28 offen sc1 lds
  s_mov_b32 m0, 72704
  s_add_u32 s28, s61, 7168
  buffer_load_dwordx4 v178, s[8:11], s28 offen sc1 lds
  s_mov_b32 m0, 73728
  s_add_u32 s28, s61, 8192
  buffer_load_dwordx4 v178, s[8:11], s28 offen sc1 lds
  s_mov_b32 m0, 74752
  s_add_u32 s28, s61, 9216
  buffer_load_dwordx4 v178, s[8:11], s28 offen sc1 lds
  s_mov_b32 m0, 75776
  s_add_u32 s28, s61, 10240
  buffer_load_dwordx4 v178, s[8:11], s28 offen sc1 lds
  s_mov_b32 m0, 76800
  s_add_u32 s28, s61, 11264
  buffer_load_dwordx4 v178, s[8:11], s28 offen sc1 lds
  s_mov_b32 m0, 77824
  s_add_u32 s28, s61, 12288
  buffer_load_dwordx4 v178, s[8:11], s28 offen sc1 lds
  s_mov_b32 m0, 78848
  s_add_u32 s28, s61, 13312
  buffer_load_dwordx4 v178, s[8:11], s28 offen sc1 lds
  s_mov_b32 m0, 79872
  s_add_u32 s28, s61, 14336
  buffer_load_dwordx4 v178, s[8:11], s28 offen sc1 lds
  s_mov_b32 m0, 80896
  s_add_u32 s28, s61, 15360
  buffer_load_dwordx4 v178, s[8:11], s28 offen sc1 lds
  s_mov_b32 m0, 81920
  s_add_u32 s28, s61, 16384
  buffer_load_dwordx4 v178, s[8:11], s28 offen sc1 lds
  s_mov_b32 m0, 82944
  s_add_u32 s28, s61, 17408
  buffer_load_dwordx4 v178, s[8:11], s28 offen sc1 lds
  s_mov_b32 m0, 83968
  s_add_u32 s28, s61, 18432
  buffer_load_dwordx4 v178, s[8:11], s28 offen sc1 lds
  s_mov_b32 m0, 84992
  s_add_u32 s28, s61, 19456
  buffer_load_dwordx4 v178, s[8:11], s28 offen sc1 lds
  s_waitcnt vmcnt(0)
  s_branch ytp_99_\sfx\()
ytp_99_ok_\sfx\():
  v_mfma_f32_16x16x32_bf16 v[140:143], v[68:71], v[100:103], 0
  v_mfma_f32_16x16x32_bf16 v[140:143], v[72:75], v[104:107], v[140:143]
  v_mfma_f32_16x16x32_bf16 v[140:143], v[76:79], v[108:111], v[140:143]
  v_mfma_f32_16x16x32_bf16 v[140:143], v[80:83], v[112:115], v[140:143]
  v_mfma_f32_16x16x32_bf16 v[140:143], v[84:87], v[116:119], v[140:143]
  v_mfma_f32_16x16x32_bf16 v[140:143], v[88:91], v[120:123], v[140:143]
  v_mfma_f32_16x16x32_bf16 v[140:143], v[92:95], v[124:127], v[140:143]
  v_mfma_f32_16x16x32_bf16 v[140:143], v[96:99], v[128:131], v[140:143]
  v_mfma_f32_16x16x32_bf16 v[140:143], v[148:151], v[132:135], v[140:143]
  v_mfma_f32_16x16x32_bf16 v[140:143], v[152:155], v[136:139], v[140:143]
  s_nop 8
  v_cvt_pk_bf16_f32 v144, v140, v141
  v_cvt_pk_bf16_f32 v145, v142, v143
  s_add_u32 s28, s62, 256
  buffer_store_dwordx2 v[144:145], v189, s[8:11], s28 offen
  s_nop 1
  s_add_u32 s61, s61, 20480
  s_add_u32 s62, s62, 40960
  s_add_u32 s54, s54, 1
  v_xor_b32 v181, 0x4000, v181
  s_waitcnt vmcnt(0)
  s_branch ka\sfx\()_exit
ka\sfx\()_abort:
  s_branch ka_abort
ka\sfx\()_exit:
  s_branch ka_exit
.endm
CHAINROLES f,
CHAINROLES s, sc1
ka_abort:
  s_load_dwordx2 s[6:7], s[0:1], 88
  v_mov_b32 v2, 80
  v_mov_b32 v3, 1
  s_waitcnt lgkmcnt(0)
  s_mov_b64 exec, 1
  global_atomic_add v2, v3, s[6:7]
  s_waitcnt vmcnt(0)
ka_exit:
  s_endpgm

.section .rodata,"a"
.p2align 6
.amdhsa_kernel ka2_kernel
  .amdhsa_next_free_vgpr 512
  .amdhsa_next_free_sgpr 102
  .amdhsa_accum_offset 256
  .amdhsa_group_segment_fixed_size 0
  .amdhsa_kernarg_size 104
  .amdhsa_user_sgpr_count 2
  .amdhsa_user_sgpr_kernarg_segment_ptr 1
  .amdhsa_system_sgpr_workgroup_id_x 1
.end_amdhsa_kernel
.text
.globl kb2_kernel
.p2align 8
.type kb2_kernel,@function
kb2_kernel:
  s_cmp_ge_u32 s2, 256
  s_cbranch_scc1 kb2_exit
  s_load_dwordx2 s[36:37], s[0:1], 0
  s_load_dwordx2 s[38:39], s[0:1], 80
  s_load_dwordx2 s[4:5], s[0:1], 96
  v_lshrrev_b32 v1, 6, v0
  s_nop 0
  v_readfirstlane_b32 s21, v1
  v_and_b32 v1, 63, v0
  v_lshlrev_b32 v2, 4, v1
  s_waitcnt lgkmcnt(0)
  s_mov_b32 s8, s4
  s_and_b32 s9, s5, 0xffff
  s_mov_b32 s10, 0x10000000
  s_mov_b32 s11, 0x20000
  s_mov_b32 s12, s36
  s_and_b32 s13, s37, 0xffff
  s_mov_b32 s14, 0x280000
  s_mov_b32 s15, 0x20000
  s_mov_b32 s16, s38
  s_and_b32 s17, s39, 0xffff
  s_mov_b32 s18, 0x280000
  s_mov_b32 s19, 0x20000
  s_and_b32 s22, s2, 7
  s_lshl_b32 s22, s22, 2
  s_bfe_u32 s23, s2, 0x20003
  s_add_u32 s22, s22, s23
  s_lshr_b32 s23, s2, 5
  s_lshl_b32 s46, s23, 7
  s_add_u32 s46, s46, 0xa000
  s_add_u32 s48, s46, 0x1400
  s_lshl_b32 s47, s22, 7
  s_add_u32 s47, s47, 0xa400
  s_lshr_b32 s26, s2, 2
  s_and_b32 s27, s2, 3
  s_lshl_b32 s27, s27, 3
  v_and_b32 v5, 7, v1
  v_bfe_u32 v6, v1, 3, 1
  v_lshrrev_b32 v7, 4, v1
  v_lshlrev_b32 v8, 5, v6
  v_add_u32 v8, v8, v5
  v_add_u32 v8, s27, v8
  v_lshlrev_b32 v8, 4, v8
  v_lshlrev_b32 v9, 11, v7
  v_add_u32 v9, v9, v8
  v_lshlrev_b32 v10, 10, v7
  v_add_u32 v10, v10, v8
  s_mul_i32 s28, s26, 81920
  s_lshl_b32 s29, s21, 13
  s_add_u32 s28, s28, s29
  s_cmp_lt_u32 s21, 2
  s_cselect_b32 s49, 3, 2
  v_mov_b32 v32, 0
  v_mov_b32 v33, 0
  v_mov_b32 v34, 0
  v_mov_b32 v35, 0
  v_mov_b32 v36, 0
  v_mov_b32 v37, 0
  v_mov_b32 v38, 0
  v_mov_b32 v39, 0
  v_mov_b32 v56, 0
  v_mov_b32 v57, 0
  v_mov_b32 v58, 0
  v_mov_b32 v59, 0
  v_mov_b32 v68, 0
  v_mov_b32 v69, 0
  v_mov_b32 v70, 0
  v_mov_b32 v71, 0
  v_mov_b32 v80, 0
  v_mov_b32 v81, 0
  v_mov_b32 v82, 0
  v_mov_b32 v83, 0
  v_mov_b32 v92, 0
  v_mov_b32 v93, 0
  v_mov_b32 v94, 0
  v_mov_b32 v95, 0
  s_mul_i32 s33, s26, 40960
  s_lshl_b32 s30, s21, 12
  s_add_u32 s33, s33, s30
  s_add_u32 s30, s33, 27262976
  buffer_load_dwordx4 v[48:51], v10, s[8:11], s30 offen
  s_add_u32 s30, s33, 29884416
  buffer_load_dwordx4 v[60:63], v10, s[8:11], s30 offen
  s_add_u32 s30, s33, 32505856
  buffer_load_dwordx4 v[72:75], v10, s[8:11], s30 offen
  s_add_u32 s30, s33, 35127296
  buffer_load_dwordx4 v[84:87], v10, s[8:11], s30 offen
  s_add_u32 s30, s28, 20971520
  buffer_load_dwordx4 v[16:19], v9, s[8:11], s30 offen
  s_add_u32 s30, s28, 20972544
  buffer_load_dwordx4 v[20:23], v9, s[8:11], s30 offen
  s_add_u32 s30, s33, 27279360
  buffer_load_dwordx4 v[52:55], v10, s[8:11], s30 offen
  s_add_u32 s30, s33, 29900800
  buffer_load_dwordx4 v[64:67], v10, s[8:11], s30 offen
  s_add_u32 s30, s33, 32522240
  buffer_load_dwordx4 v[76:79], v10, s[8:11], s30 offen
  s_add_u32 s30, s33, 35143680
  buffer_load_dwordx4 v[88:91], v10, s[8:11], s30 offen
  s_add_u32 s30, s28, 21004288
  buffer_load_dwordx4 v[24:27], v9, s[8:11], s30 offen
  s_add_u32 s30, s28, 21005312
  buffer_load_dwordx4 v[28:31], v9, s[8:11], s30 offen
  s_cmp_lt_u32 s21, 2
  s_cbranch_scc0 g3_100
  s_add_u32 s30, s33, 27295744
  buffer_load_dwordx4 v[56:59], v10, s[8:11], s30 offen
  s_add_u32 s30, s33, 29917184
  buffer_load_dwordx4 v[68:71], v10, s[8:11], s30 offen
  s_add_u32 s30, s33, 32538624
  buffer_load_dwordx4 v[80:83], v10, s[8:11], s30 offen
  s_add_u32 s30, s33, 35160064
  buffer_load_dwordx4 v[92:95], v10, s[8:11], s30 offen
  s_add_u32 s30, s28, 21037056
  buffer_load_dwordx4 v[32:35], v9, s[8:11], s30 offen
  s_add_u32 s30, s28, 21038080
  buffer_load_dwordx4 v[36:39], v9, s[8:11], s30 offen
g3_100:
  s_mul_i32 s30, s22, 122880
  s_mul_i32 s31, s21, 30720
  s_add_u32 s30, s30, s31
  s_add_u32 s30, s30, 0xe100000
  s_add_u32 m0, s31, 0
  s_add_u32 s29, s30, 0
  buffer_load_dwordx4 v2, s[8:11], s29 offen lds
  s_add_u32 m0, s31, 1024
  s_add_u32 s29, s30, 1024
  buffer_load_dwordx4 v2, s[8:11], s29 offen lds
  s_add_u32 m0, s31, 2048
  s_add_u32 s29, s30, 2048
  buffer_load_dwordx4 v2, s[8:11], s29 offen lds
  s_add_u32 m0, s31, 3072
  s_add_u32 s29, s30, 3072
  buffer_load_dwordx4 v2, s[8:11], s29 offen lds
  s_add_u32 m0, s31, 4096
  s_add_u32 s29, s30, 4096
  buffer_load_dwordx4 v2, s[8:11], s29 offen lds
  s_add_u32 m0, s31, 5120
  s_add_u32 s29, s30, 5120
  buffer_load_dwordx4 v2, s[8:11], s29 offen lds
  s_add_u32 m0, s31, 6144
  s_add_u32 s29, s30, 6144
  buffer_load_dwordx4 v2, s[8:11], s29 offen lds
  s_add_u32 m0, s31, 7168
  s_add_u32 s29, s30, 7168
  buffer_load_dwordx4 v2, s[8:11], s29 offen lds
  s_add_u32 m0, s31, 8192
  s_add_u32 s29, s30, 8192
  buffer_load_dwordx4 v2, s[8:11], s29 offen lds
  s_add_u32 m0, s31, 9216
  s_add_u32 s29, s30, 9216
  buffer_load_dwordx4 v2, s[8:11], s29 offen lds
  s_add_u32 m0, s31, 10240
  s_add_u32 s29, s30, 10240
  buffer_load_dwordx4 v2, s[8:11], s29 offen lds
  s_add_u32 m0, s31, 11264
  s_add_u32 s29, s30, 11264
  buffer_load_dwordx4 v2, s[8:11], s29 offen lds
  s_add_u32 m0, s31, 12288
  s_add_u32 s29, s30, 12288
  buffer_load_dwordx4 v2, s[8:11], s29 offen lds
  s_add_u32 m0, s31, 13312
  s_add_u32 s29, s30, 13312
  buffer_load_dwordx4 v2, s[8:11], s29 offen lds
  s_add_u32 m0, s31, 14336
  s_add_u32 s29, s30, 14336
  buffer_load_dwordx4 v2, s[8:11], s29 offen lds
  s_add_u32 m0, s31, 15360
  s_add_u32 s29, s30, 15360
  buffer_load_dwordx4 v2, s[8:11], s29 offen lds
  s_add_u32 m0, s31, 16384
  s_add_u32 s29, s30, 16384
  buffer_load_dwordx4 v2, s[8:11], s29 offen lds
  s_add_u32 m0, s31, 17408
  s_add_u32 s29, s30, 17408
  buffer_load_dwordx4 v2, s[8:11], s29 offen lds
  s_add_u32 m0, s31, 18432
  s_add_u32 s29, s30, 18432
  buffer_load_dwordx4 v2, s[8:11], s29 offen lds
  s_add_u32 m0, s31, 19456
  s_add_u32 s29, s30, 19456
  buffer_load_dwordx4 v2, s[8:11], s29 offen lds
  s_add_u32 m0, s31, 20480
  s_add_u32 s29, s30, 20480
  buffer_load_dwordx4 v2, s[8:11], s29 offen lds
  s_add_u32 m0, s31, 21504
  s_add_u32 s29, s30, 21504
  buffer_load_dwordx4 v2, s[8:11], s29 offen lds
  s_add_u32 m0, s31, 22528
  s_add_u32 s29, s30, 22528
  buffer_load_dwordx4 v2, s[8:11], s29 offen lds
  s_add_u32 m0, s31, 23552
  s_add_u32 s29, s30, 23552
  buffer_load_dwordx4 v2, s[8:11], s29 offen lds
  s_add_u32 m0, s31, 24576
  s_add_u32 s29, s30, 24576
  buffer_load_dwordx4 v2, s[8:11], s29 offen lds
  s_add_u32 m0, s31, 25600
  s_add_u32 s29, s30, 25600
  buffer_load_dwordx4 v2, s[8:11], s29 offen lds
  s_add_u32 m0, s31, 26624
  s_add_u32 s29, s30, 26624
  buffer_load_dwordx4 v2, s[8:11], s29 offen lds
  s_add_u32 m0, s31, 27648
  s_add_u32 s29, s30, 27648
  buffer_load_dwordx4 v2, s[8:11], s29 offen lds
  s_add_u32 m0, s31, 28672
  s_add_u32 s29, s30, 28672
  buffer_load_dwordx4 v2, s[8:11], s29 offen lds
  s_add_u32 m0, s31, 29696
  s_add_u32 s29, s30, 29696
  buffer_load_dwordx4 v2, s[8:11], s29 offen lds
  s_waitcnt vmcnt(30)
  v_lshlrev_b32 v12, 16, v48
  v_and_b32 v13, 0xffff0000, v48
  v_pk_add_f32 v[16:17], v[16:17], v[12:13]
  v_lshlrev_b32 v12, 16, v49
  v_and_b32 v13, 0xffff0000, v49
  v_pk_add_f32 v[18:19], v[18:19], v[12:13]
  v_lshlrev_b32 v12, 16, v50
  v_and_b32 v13, 0xffff0000, v50
  v_pk_add_f32 v[20:21], v[20:21], v[12:13]
  v_lshlrev_b32 v12, 16, v51
  v_and_b32 v13, 0xffff0000, v51
  v_pk_add_f32 v[22:23], v[22:23], v[12:13]
  v_lshlrev_b32 v12, 16, v52
  v_and_b32 v13, 0xffff0000, v52
  v_pk_add_f32 v[24:25], v[24:25], v[12:13]
  v_lshlrev_b32 v12, 16, v53
  v_and_b32 v13, 0xffff0000, v53
  v_pk_add_f32 v[26:27], v[26:27], v[12:13]
  v_lshlrev_b32 v12, 16, v54
  v_and_b32 v13, 0xffff0000, v54
  v_pk_add_f32 v[28:29], v[28:29], v[12:13]
  v_lshlrev_b32 v12, 16, v55
  v_and_b32 v13, 0xffff0000, v55
  v_pk_add_f32 v[30:31], v[30:31], v[12:13]
  v_lshlrev_b32 v12, 16, v56
  v_and_b32 v13, 0xffff0000, v56
  v_pk_add_f32 v[32:33], v[32:33], v[12:13]
  v_lshlrev_b32 v12, 16, v57
  v_and_b32 v13, 0xffff0000, v57
  v_pk_add_f32 v[34:35], v[34:35], v[12:13]
  v_lshlrev_b32 v12, 16, v58
  v_and_b32 v13, 0xffff0000, v58
  v_pk_add_f32 v[36:37], v[36:37], v[12:13]
  v_lshlrev_b32 v12, 16, v59
  v_and_b32 v13, 0xffff0000, v59
  v_pk_add_f32 v[38:39], v[38:39], v[12:13]
  v_lshlrev_b32 v12, 16, v60
  v_and_b32 v13, 0xffff0000, v60
  v_pk_add_f32 v[16:17], v[16:17], v[12:13]
  v_lshlrev_b32 v12, 16, v61
  v_and_b32 v13, 0xffff0000, v61
  v_pk_add_f32 v[18:19], v[18:19], v[12:13]
  v_lshlrev_b32 v12, 16, v62
  v_and_b32 v13, 0xffff0000, v62
  v_pk_add_f32 v[20:21], v[20:21], v[12:13]
  v_lshlrev_b32 v12, 16, v63
  v_and_b32 v13, 0xffff0000, v63
  v_pk_add_f32 v[22:23], v[22:23], v[12:13]
  v_lshlrev_b32 v12, 16, v64
  v_and_b32 v13, 0xffff0000, v64
  v_pk_add_f32 v[24:25], v[24:25], v[12:13]
  v_lshlrev_b32 v12, 16, v65
  v_and_b32 v13, 0xffff0000, v65
  v_pk_add_f32 v[26:27], v[26:27], v[12:13]
  v_lshlrev_b32 v12, 16, v66
  v_and_b32 v13, 0xffff0000, v66
  v_pk_add_f32 v[28:29], v[28:29], v[12:13]
  v_lshlrev_b32 v12, 16, v67
  v_and_b32 v13, 0xffff0000, v67
  v_pk_add_f32 v[30:31], v[30:31], v[12:13]
  v_lshlrev_b32 v12, 16, v68
  v_and_b32 v13, 0xffff0000, v68
  v_pk_add_f32 v[32:33], v[32:33], v[12:13]
  v_lshlrev_b32 v12, 16, v69
  v_and_b32 v13, 0xffff0000, v69
  v_pk_add_f32 v[34:35], v[34:35], v[12:13]
  v_lshlrev_b32 v12, 16, v70
  v_and_b32 v13, 0xffff0000, v70
  v_pk_add_f32 v[36:37], v[36:37], v[12:13]
  v_lshlrev_b32 v12, 16, v71
  v_and_b32 v13, 0xffff0000, v71
  v_pk_add_f32 v[38:39], v[38:39], v[12:13]
  v_lshlrev_b32 v12, 16, v72
  v_and_b32 v13, 0xffff0000, v72
  v_pk_add_f32 v[16:17], v[16:17], v[12:13]
  v_lshlrev_b32 v12, 16, v73
  v_and_b32 v13, 0xffff0000, v73
  v_pk_add_f32 v[18:19], v[18:19], v[12:13]
  v_lshlrev_b32 v12, 16, v74
  v_and_b32 v13, 0xffff0000, v74
  v_pk_add_f32 v[20:21], v[20:21], v[12:13]
  v_lshlrev_b32 v12, 16, v75
  v_and_b32 v13, 0xffff0000, v75
  v_pk_add_f32 v[22:23], v[22:23], v[12:13]
  v_lshlrev_b32 v12, 16, v76
  v_and_b32 v13, 0xffff0000, v76
  v_pk_add_f32 v[24:25], v[24:25], v[12:13]
  v_lshlrev_b32 v12, 16, v77
  v_and_b32 v13, 0xffff0000, v77
  v_pk_add_f32 v[26:27], v[26:27], v[12:13]
  v_lshlrev_b32 v12, 16, v78
  v_and_b32 v13, 0xffff0000, v78
  v_pk_add_f32 v[28:29], v[28:29], v[12:13]
  v_lshlrev_b32 v12, 16, v79
  v_and_b32 v13, 0xffff0000, v79
  v_pk_add_f32 v[30:31], v[30:31], v[12:13]
  v_lshlrev_b32 v12, 16, v80
  v_and_b32 v13, 0xffff0000, v80
  v_pk_add_f32 v[32:33], v[32:33], v[12:13]
  v_lshlrev_b32 v12, 16, v81
  v_and_b32 v13, 0xffff0000, v81
  v_pk_add_f32 v[34:35], v[34:35], v[12:13]
  v_lshlrev_b32 v12, 16, v82
  v_and_b32 v13, 0xffff0000, v82
  v_pk_add_f32 v[36:37], v[36:37], v[12:13]
  v_lshlrev_b32 v12, 16, v83
  v_and_b32 v13, 0xffff0000, v83
  v_pk_add_f32 v[38:39], v[38:39], v[12:13]
  v_lshlrev_b32 v12, 16, v84
  v_and_b32 v13, 0xffff0000, v84
  v_pk_add_f32 v[16:17], v[16:17], v[12:13]
  v_lshlrev_b32 v12, 16, v85
  v_and_b32 v13, 0xffff0000, v85
  v_pk_add_f32 v[18:19], v[18:19], v[12:13]
  v_lshlrev_b32 v12, 16, v86
  v_and_b32 v13, 0xffff0000, v86
  v_pk_add_f32 v[20:21], v[20:21], v[12:13]
  v_lshlrev_b32 v12, 16, v87
  v_and_b32 v13, 0xffff0000, v87
  v_pk_add_f32 v[22:23], v[22:23], v[12:13]
  v_lshlrev_b32 v12, 16, v88
  v_and_b32 v13, 0xffff0000, v88
  v_pk_add_f32 v[24:25], v[24:25], v[12:13]
  v_lshlrev_b32 v12, 16, v89
  v_and_b32 v13, 0xffff0000, v89
  v_pk_add_f32 v[26:27], v[26:27], v[12:13]
  v_lshlrev_b32 v12, 16, v90
  v_and_b32 v13, 0xffff0000, v90
  v_pk_add_f32 v[28:29], v[28:29], v[12:13]
  v_lshlrev_b32 v12, 16, v91
  v_and_b32 v13, 0xffff0000, v91
  v_pk_add_f32 v[30:31], v[30:31], v[12:13]
  v_lshlrev_b32 v12, 16, v92
  v_and_b32 v13, 0xffff0000, v92
  v_pk_add_f32 v[32:33], v[32:33], v[12:13]
  v_lshlrev_b32 v12, 16, v93
  v_and_b32 v13, 0xffff0000, v93
  v_pk_add_f32 v[34:35], v[34:35], v[12:13]
  v_lshlrev_b32 v12, 16, v94
  v_and_b32 v13, 0xffff0000, v94
  v_pk_add_f32 v[36:37], v[36:37], v[12:13]
  v_lshlrev_b32 v12, 16, v95
  v_and_b32 v13, 0xffff0000, v95
  v_pk_add_f32 v[38:39], v[38:39], v[12:13]
  s_add_u32 s30, s28, 20971520
  buffer_store_dwordx4 v[16:19], v9, s[8:11], s30 offen sc1
  s_add_u32 s30, s28, 20972544
  buffer_store_dwordx4 v[20:23], v9, s[8:11], s30 offen sc1
  s_add_u32 s30, s28, 21004288
  buffer_store_dwordx4 v[24:27], v9, s[8:11], s30 offen sc1
  s_add_u32 s30, s28, 21005312
  buffer_store_dwordx4 v[28:31], v9, s[8:11], s30 offen sc1
  s_cmp_lt_u32 s21, 2
  s_cbranch_scc0 g3_101
  s_add_u32 s30, s28, 21037056
  buffer_store_dwordx4 v[32:35], v9, s[8:11], s30 offen sc1
  s_add_u32 s30, s28, 21038080
  buffer_store_dwordx4 v[36:39], v9, s[8:11], s30 offen sc1
g3_101:
  v_add_f32 v12, v16, v17
  v_add_f32 v12, v12, v18
  v_add_f32 v12, v12, v19
  v_add_f32 v12, v12, v20
  v_add_f32 v12, v12, v21
  v_add_f32 v12, v12, v22
  v_add_f32 v12, v12, v23
  v_add_f32 v12, v12, v24
  v_add_f32 v12, v12, v25
  v_add_f32 v12, v12, v26
  v_add_f32 v12, v12, v27
  v_add_f32 v12, v12, v28
  v_add_f32 v12, v12, v29
  v_add_f32 v12, v12, v30
  v_add_f32 v12, v12, v31
  v_add_f32 v12, v12, v32
  v_add_f32 v12, v12, v33
  v_add_f32 v12, v12, v34
  v_add_f32 v12, v12, v35
  v_add_f32 v12, v12, v36
  v_add_f32 v12, v12, v37
  v_add_f32 v12, v12, v38
  v_add_f32 v12, v12, v39
  s_nop 1
  v_add_f32_dpp v12, v12, v12 row_ror:8 row_mask:0xf bank_mask:0xf
  v_mov_b32 v13, v12
  s_nop 1
  v_permlane16_swap_b32 v12, v13
  v_add_f32 v12, v12, v13
  v_mov_b32 v13, v12
  s_nop 1
  v_permlane32_swap_b32 v12, v13
  v_add_f32 v12, v12, v13
  v_lshlrev_b32 v14, 2, v5
  v_add_u32 v14, 131072, v14
  s_lshl_b32 s30, s21, 5
  v_add_u32 v15, s30, v14
  ds_write_b32 v15, v12
  s_waitcnt lgkmcnt(0)
  s_barrier
  ds_read_b32 v48, v14
  ds_read_b32 v49, v14 offset:32
  ds_read_b32 v50, v14 offset:64
  ds_read_b32 v51, v14 offset:96
  s_waitcnt lgkmcnt(0)
  v_add_f32 v48, v48, v49
  v_add_f32 v50, v50, v51
  v_add_f32 v48, v48, v50
  v_mul_f32 v48, 0x3acccccd, v48
  v_sub_f32 v56, v16, v48
  v_sub_f32 v57, v17, v48
  v_sub_f32 v58, v18, v48
  v_sub_f32 v59, v19, v48
  v_sub_f32 v60, v20, v48
  v_sub_f32 v61, v21, v48
  v_sub_f32 v62, v22, v48
  v_sub_f32 v63, v23, v48
  v_sub_f32 v64, v24, v48
  v_sub_f32 v65, v25, v48
  v_sub_f32 v66, v26, v48
  v_sub_f32 v67, v27, v48
  v_sub_f32 v68, v28, v48
  v_sub_f32 v69, v29, v48
  v_sub_f32 v70, v30, v48
  v_sub_f32 v71, v31, v48
  v_sub_f32 v72, v32, v48
  v_sub_f32 v73, v33, v48
  v_sub_f32 v74, v34, v48
  v_sub_f32 v75, v35, v48
  v_sub_f32 v76, v36, v48
  v_sub_f32 v77, v37, v48
  v_sub_f32 v78, v38, v48
  v_sub_f32 v79, v39, v48
  s_cmp_lt_u32 s21, 2
  s_cbranch_scc1 g3z_102
  v_mov_b32 v72, 0
  v_mov_b32 v73, 0
  v_mov_b32 v74, 0
  v_mov_b32 v75, 0
  v_mov_b32 v76, 0
  v_mov_b32 v77, 0
  v_mov_b32 v78, 0
  v_mov_b32 v79, 0
g3z_102:
  v_mul_f32 v12, v56, v56
  v_fmac_f32 v12, v57, v57
  v_fmac_f32 v12, v58, v58
  v_fmac_f32 v12, v59, v59
  v_fmac_f32 v12, v60, v60
  v_fmac_f32 v12, v61, v61
  v_fmac_f32 v12, v62, v62
  v_fmac_f32 v12, v63, v63
  v_fmac_f32 v12, v64, v64
  v_fmac_f32 v12, v65, v65
  v_fmac_f32 v12, v66, v66
  v_fmac_f32 v12, v67, v67
  v_fmac_f32 v12, v68, v68
  v_fmac_f32 v12, v69, v69
  v_fmac_f32 v12, v70, v70
  v_fmac_f32 v12, v71, v71
  v_fmac_f32 v12, v72, v72
  v_fmac_f32 v12, v73, v73
  v_fmac_f32 v12, v74, v74
  v_fmac_f32 v12, v75, v75
  v_fmac_f32 v12, v76, v76
  v_fmac_f32 v12, v77, v77
  v_fmac_f32 v12, v78, v78
  v_fmac_f32 v12, v79, v79
  s_nop 1
  v_add_f32_dpp v12, v12, v12 row_ror:8 row_mask:0xf bank_mask:0xf
  v_mov_b32 v13, v12
  s_nop 1
  v_permlane16_swap_b32 v12, v13
  v_add_f32 v12, v12, v13
  v_mov_b32 v13, v12
  s_nop 1
  v_permlane32_swap_b32 v12, v13
  v_add_f32 v12, v12, v13
  v_lshlrev_b32 v14, 2, v5
  v_add_u32 v14, 131328, v14
  s_lshl_b32 s30, s21, 5
  v_add_u32 v15, s30, v14
  ds_write_b32 v15, v12
  s_waitcnt lgkmcnt(0)
  s_barrier
  ds_read_b32 v48, v14
  ds_read_b32 v49, v14 offset:32
  ds_read_b32 v50, v14 offset:64
  ds_read_b32 v51, v14 offset:96
  s_waitcnt lgkmcnt(0)
  v_add_f32 v48, v48, v49
  v_add_f32 v50, v50, v51
  v_add_f32 v48, v48, v50
  v_mov_b32 v49, 0x3727c5ac
  v_fmac_f32 v49, 0x3acccccd, v48
  v_rsq_f32 v49, v49
  s_nop 0
  v_mul_f32 v56, v56, v49
  v_mul_f32 v57, v57, v49
  v_mul_f32 v58, v58, v49
  v_mul_f32 v59, v59, v49
  v_mul_f32 v60, v60, v49
  v_mul_f32 v61, v61, v49
  v_mul_f32 v62, v62, v49
  v_mul_f32 v63, v63, v49
  v_mul_f32 v64, v64, v49
  v_mul_f32 v65, v65, v49
  v_mul_f32 v66, v66, v49
  v_mul_f32 v67, v67, v49
  v_mul_f32 v68, v68, v49
  v_mul_f32 v69, v69, v49
  v_mul_f32 v70, v70, v49
  v_mul_f32 v71, v71, v49
  v_mul_f32 v72, v72, v49
  v_mul_f32 v73, v73, v49
  v_mul_f32 v74, v74, v49
  v_mul_f32 v75, v75, v49
  v_mul_f32 v76, v76, v49
  v_mul_f32 v77, v77, v49
  v_mul_f32 v78, v78, v49
  v_mul_f32 v79, v79, v49
  v_cvt_pk_bf16_f32 v80, v56, v57
  v_cvt_pk_bf16_f32 v81, v58, v59
  v_cvt_pk_bf16_f32 v82, v60, v61
  v_cvt_pk_bf16_f32 v83, v62, v63
  v_cvt_pk_bf16_f32 v84, v64, v65
  v_cvt_pk_bf16_f32 v85, v66, v67
  v_cvt_pk_bf16_f32 v86, v68, v69
  v_cvt_pk_bf16_f32 v87, v70, v71
  v_cvt_pk_bf16_f32 v88, v72, v73
  v_cvt_pk_bf16_f32 v89, v74, v75
  v_cvt_pk_bf16_f32 v90, v76, v77
  v_cvt_pk_bf16_f32 v91, v78, v79
  s_mul_i32 s30, s26, 40960
  s_lshl_b32 s31, s21, 12
  s_add_u32 s30, s30, s31
  s_add_u32 s30, s30, 0x100000
  s_add_u32 s31, s30, 0
  buffer_store_dwordx4 v[80:83], v10, s[8:11], s31 offen sc1
  s_add_u32 s31, s30, 16384
  buffer_store_dwordx4 v[84:87], v10, s[8:11], s31 offen sc1
  s_cmp_lt_u32 s21, 2
  s_cbranch_scc0 g3_103
  s_add_u32 s31, s30, 32768
  buffer_store_dwordx4 v[88:91], v10, s[8:11], s31 offen sc1
g3_103:
  s_waitcnt vmcnt(0)
  s_barrier
  s_cmp_eq_u32 s21, 0
  s_cbranch_scc0 arr_104
  s_mov_b64 s[24:25], exec
  s_mov_b64 exec, 1
  v_mov_b32 v3, 0
  v_mov_b32 v4, 1
  buffer_atomic_add v4, v3, s[8:11], s46 offen
  s_mov_b64 exec, s[24:25]
arr_104:
  s_mov_b32 s45, 0
  v_mov_b32 v3, 0
aw_105:
  buffer_load_dword v4, v3, s[8:11], s46 offen sc1
  s_add_u32 s45, s45, 1
  s_waitcnt vmcnt(0)
  v_readfirstlane_b32 s29, v4
  s_cmp_ge_u32 s29, 32
  s_cbranch_scc1 aw_105_ok
  s_cmp_lt_u32 s45, 400000
  s_cbranch_scc1 aw_105
  s_branch kb2_abort
aw_105_ok:
  s_barrier
  s_lshl_b32 s26, s23, 3
  s_lshl_b32 s27, s21, 1
  s_add_u32 s24, s26, s27
  s_mul_i32 s27, s24, 40960
  s_add_u32 s27, s27, 0x100000
  s_add_u32 s28, s27, 40960
  v_mov_b32 v3, v2
  v_add_u32 v4, 65536, v2
  v_lshlrev_b32 v5, 7, v1
  s_add_u32 s29, s27, 0
  buffer_load_dword v10, v5, s[8:11], s29 offen sc1
  s_add_u32 s29, s27, 8192
  buffer_load_dword v10, v5, s[8:11], s29 offen sc1
  s_add_u32 s29, s27, 16384
  buffer_load_dword v10, v5, s[8:11], s29 offen sc1
  s_add_u32 s29, s27, 24576
  buffer_load_dword v10, v5, s[8:11], s29 offen sc1
  s_add_u32 s29, s27, 32768
  buffer_load_dword v10, v5, s[8:11], s29 offen sc1
  s_add_u32 s29, s27, 40960
  buffer_load_dword v10, v5, s[8:11], s29 offen sc1
  s_add_u32 s29, s27, 49152
  buffer_load_dword v10, v5, s[8:11], s29 offen sc1
  s_add_u32 s29, s27, 57344
  buffer_load_dword v10, v5, s[8:11], s29 offen sc1
  s_add_u32 s29, s27, 65536
  buffer_load_dword v10, v5, s[8:11], s29 offen sc1
  s_add_u32 s29, s27, 73728
  buffer_load_dword v10, v5, s[8:11], s29 offen sc1
  s_mov_b32 s30, 0x3ea52b5c
  v_mov_b32 v5, 0
  v_cmp_gt_u32 s[34:35], 32, v1
  v_mov_b32 v6, 1.0
  v_and_b32 v7, 31, v1
  v_cndmask_b32 v6, v5, v6, s[34:35]
  v_cmp_eq_u32 s[32:33], 20, v7
  v_mov_b32 v8, 1.0
  s_lshl_b32 s31, s22, 6
  s_add_u32 s31, s31, s24
  s_lshl_b32 s31, s31, 11
  v_mov_b32 v9, 0
  s_add_u32 s29, s27, 0
  buffer_load_dwordx4 v[16:19], v2, s[8:11], s29 offen sc1
  s_add_u32 s29, s27, 1024
  buffer_load_dwordx4 v[20:23], v2, s[8:11], s29 offen sc1
  s_add_u32 s29, s27, 2048
  buffer_load_dwordx4 v[24:27], v2, s[8:11], s29 offen sc1
  s_add_u32 s29, s27, 3072
  buffer_load_dwordx4 v[28:31], v2, s[8:11], s29 offen sc1
  s_add_u32 s29, s27, 4096
  buffer_load_dwordx4 v[32:35], v2, s[8:11], s29 offen sc1
  s_add_u32 s29, s27, 5120
  buffer_load_dwordx4 v[36:39], v2, s[8:11], s29 offen sc1
  s_add_u32 s29, s27, 6144
  buffer_load_dwordx4 v[40:43], v2, s[8:11], s29 offen sc1
  s_add_u32 s29, s27, 7168
  buffer_load_dwordx4 v[44:47], v2, s[8:11], s29 offen sc1
  s_add_u32 s29, s27, 8192
  buffer_load_dwordx4 v[48:51], v2, s[8:11], s29 offen sc1
  s_add_u32 s29, s27, 9216
  buffer_load_dwordx4 v[52:55], v2, s[8:11], s29 offen sc1
  s_add_u32 s29, s27, 10240
  buffer_load_dwordx4 v[56:59], v2, s[8:11], s29 offen sc1
  s_add_u32 s29, s27, 11264
  buffer_load_dwordx4 v[60:63], v2, s[8:11], s29 offen sc1
  s_add_u32 s29, s27, 12288
  buffer_load_dwordx4 v[64:67], v2, s[8:11], s29 offen sc1
  s_add_u32 s29, s27, 13312
  buffer_load_dwordx4 v[68:71], v2, s[8:11], s29 offen sc1
  s_add_u32 s29, s27, 14336
  buffer_load_dwordx4 v[72:75], v2, s[8:11], s29 offen sc1
  ds_read_b128 v[208:211], v3 offset:0
  ds_read_b128 v[212:215], v3 offset:40960
  ds_read_b128 v[216:219], v4 offset:16384
  s_add_u32 s29, s27, 15360
  buffer_load_dwordx4 v[76:79], v2, s[8:11], s29 offen sc1
  ds_read_b128 v[220:223], v3 offset:1024
  ds_read_b128 v[224:227], v3 offset:41984
  ds_read_b128 v[228:231], v4 offset:17408
  s_waitcnt lgkmcnt(3)
  s_waitcnt vmcnt(15)
  v_mfma_f32_32x32x16_bf16 v[80:95], v[208:211], v[16:19], 0
  v_mfma_f32_32x32x16_bf16 v[96:111], v[212:215], v[16:19], 0
  v_mfma_f32_32x32x16_bf16 v[112:127], v[16:19], v[216:219], 0
  s_add_u32 s29, s27, 16384
  buffer_load_dwordx4 v[16:19], v2, s[8:11], s29 offen sc1
  ds_read_b128 v[208:211], v3 offset:2048
  ds_read_b128 v[212:215], v3 offset:43008
  ds_read_b128 v[216:219], v4 offset:18432
  s_waitcnt lgkmcnt(3)
  s_waitcnt vmcnt(15)
  v_mfma_f32_32x32x16_bf16 v[80:95], v[220:223], v[20:23], v[80:95]
  v_mfma_f32_32x32x16_bf16 v[96:111], v[224:227], v[20:23], v[96:111]
  v_mfma_f32_32x32x16_bf16 v[112:127], v[20:23], v[228:231], v[112:127]
  s_add_u32 s29, s27, 17408
  buffer_load_dwordx4 v[20:23], v2, s[8:11], s29 offen sc1
  ds_read_b128 v[220:223], v3 offset:3072
  ds_read_b128 v[224:227], v3 offset:44032
  ds_read_b128 v[228:231], v4 offset:19456
  s_waitcnt lgkmcnt(3)
  s_waitcnt vmcnt(15)
  v_mfma_f32_32x32x16_bf16 v[80:95], v[208:211], v[24:27], v[80:95]
  v_mfma_f32_32x32x16_bf16 v[96:111], v[212:215], v[24:27], v[96:111]
  v_mfma_f32_32x32x16_bf16 v[112:127], v[24:27], v[216:219], v[112:127]
  s_add_u32 s29, s27, 18432
  buffer_load_dwordx4 v[24:27], v2, s[8:11], s29 offen sc1
  ds_read_b128 v[208:211], v3 offset:4096
  ds_read_b128 v[212:215], v3 offset:45056
  ds_read_b128 v[216:219], v4 offset:20480
  s_waitcnt lgkmcnt(3)
  s_waitcnt vmcnt(15)
  v_mfma_f32_32x32x16_bf16 v[80:95], v[220:223], v[28:31], v[80:95]
  v_mfma_f32_32x32x16_bf16 v[96:111], v[224:227], v[28:31], v[96:111]
  v_mfma_f32_32x32x16_bf16 v[112:127], v[28:31], v[228:231], v[112:127]
  s_add_u32 s29, s27, 19456
  buffer_load_dwordx4 v[28:31], v2, s[8:11], s29 offen sc1
  ds_read_b128 v[220:223], v3 offset:5120
  ds_read_b128 v[224:227], v3 offset:46080
  ds_read_b128 v[228:231], v4 offset:21504
  s_waitcnt lgkmcnt(3)
  s_waitcnt vmcnt(15)
  v_mfma_f32_32x32x16_bf16 v[80:95], v[208:211], v[32:35], v[80:95]
  v_mfma_f32_32x32x16_bf16 v[96:111], v[212:215], v[32:35], v[96:111]
  v_mfma_f32_32x32x16_bf16 v[112:127], v[32:35], v[216:219], v[112:127]
  s_add_u32 s29, s27, 20480
  buffer_load_dwordx4 v[32:35], v2, s[8:11], s29 offen sc1
  ds_read_b128 v[208:211], v3 offset:6144
  ds_read_b128 v[212:215], v3 offset:47104
  ds_read_b128 v[216:219], v4 offset:22528
  s_waitcnt lgkmcnt(3)
  s_waitcnt vmcnt(15)
  v_mfma_f32_32x32x16_bf16 v[80:95], v[220:223], v[36:39], v[80:95]
  v_mfma_f32_32x32x16_bf16 v[96:111], v[224:227], v[36:39], v[96:111]
  v_mfma_f32_32x32x16_bf16 v[112:127], v[36:39], v[228:231], v[112:127]
  s_add_u32 s29, s27, 21504
  buffer_load_dwordx4 v[36:39], v2, s[8:11], s29 offen sc1
  ds_read_b128 v[220:223], v3 offset:7168
  ds_read_b128 v[224:227], v3 offset:48128
  ds_read_b128 v[228:231], v4 offset:23552
  s_waitcnt lgkmcnt(3)
  s_waitcnt vmcnt(15)
  v_mfma_f32_32x32x16_bf16 v[80:95], v[208:211], v[40:43], v[80:95]
  v_mfma_f32_32x32x16_bf16 v[96:111], v[212:215], v[40:43], v[96:111]
  v_mfma_f32_32x32x16_bf16 v[112:127], v[40:43], v[216:219], v[112:127]
  s_add_u32 s29, s27, 22528
  buffer_load_dwordx4 v[40:43], v2, s[8:11], s29 offen sc1
  ds_read_b128 v[208:211], v3 offset:8192
  ds_read_b128 v[212:215], v3 offset:49152
  ds_read_b128 v[216:219], v4 offset:24576
  s_waitcnt lgkmcnt(3)
  s_waitcnt vmcnt(15)
  v_mfma_f32_32x32x16_bf16 v[80:95], v[220:223], v[44:47], v[80:95]
  v_mfma_f32_32x32x16_bf16 v[96:111], v[224:227], v[44:47], v[96:111]
  v_mfma_f32_32x32x16_bf16 v[112:127], v[44:47], v[228:231], v[112:127]
  s_add_u32 s29, s27, 23552
  buffer_load_dwordx4 v[44:47], v2, s[8:11], s29 offen sc1
  ds_read_b128 v[220:223], v3 offset:9216
  ds_read_b128 v[224:227], v3 offset:50176
  ds_read_b128 v[228:231], v4 offset:25600
  s_waitcnt lgkmcnt(3)
  s_waitcnt vmcnt(15)
  v_mfma_f32_32x32x16_bf16 v[80:95], v[208:211], v[48:51], v[80:95]
  v_mfma_f32_32x32x16_bf16 v[96:111], v[212:215], v[48:51], v[96:111]
  v_mfma_f32_32x32x16_bf16 v[112:127], v[48:51], v[216:219], v[112:127]
  s_add_u32 s29, s27, 24576
  buffer_load_dwordx4 v[48:51], v2, s[8:11], s29 offen sc1
  ds_read_b128 v[208:211], v3 offset:10240
  ds_read_b128 v[212:215], v3 offset:51200
  ds_read_b128 v[216:219], v4 offset:26624
  s_waitcnt lgkmcnt(3)
  s_waitcnt vmcnt(15)
  v_mfma_f32_32x32x16_bf16 v[80:95], v[220:223], v[52:55], v[80:95]
  v_mfma_f32_32x32x16_bf16 v[96:111], v[224:227], v[52:55], v[96:111]
  v_mfma_f32_32x32x16_bf16 v[112:127], v[52:55], v[228:231], v[112:127]
  s_add_u32 s29, s27, 25600
  buffer_load_dwordx4 v[52:55], v2, s[8:11], s29 offen sc1
  ds_read_b128 v[220:223], v3 offset:11264
  ds_read_b128 v[224:227], v3 offset:52224
  ds_read_b128 v[228:231], v4 offset:27648
  s_waitcnt lgkmcnt(3)
  s_waitcnt vmcnt(15)
  v_mfma_f32_32x32x16_bf16 v[80:95], v[208:211], v[56:59], v[80:95]
  v_mfma_f32_32x32x16_bf16 v[96:111], v[212:215], v[56:59], v[96:111]
  v_mfma_f32_32x32x16_bf16 v[112:127], v[56:59], v[216:219], v[112:127]
  s_add_u32 s29, s27, 26624
  buffer_load_dwordx4 v[56:59], v2, s[8:11], s29 offen sc1
  ds_read_b128 v[208:211], v3 offset:12288
  ds_read_b128 v[212:215], v3 offset:53248
  ds_read_b128 v[216:219], v4 offset:28672
  s_waitcnt lgkmcnt(3)
  s_waitcnt vmcnt(15)
  v_mfma_f32_32x32x16_bf16 v[80:95], v[220:223], v[60:63], v[80:95]
  v_mfma_f32_32x32x16_bf16 v[96:111], v[224:227], v[60:63], v[96:111]
  v_mfma_f32_32x32x16_bf16 v[112:127], v[60:63], v[228:231], v[112:127]
  s_add_u32 s29, s27, 27648
  buffer_load_dwordx4 v[60:63], v2, s[8:11], s29 offen sc1
  ds_read_b128 v[220:223], v3 offset:13312
  ds_read_b128 v[224:227], v3 offset:54272
  ds_read_b128 v[228:231], v4 offset:29696
  s_waitcnt lgkmcnt(3)
  s_waitcnt vmcnt(15)
  v_mfma_f32_32x32x16_bf16 v[80:95], v[208:211], v[64:67], v[80:95]
  v_mfma_f32_32x32x16_bf16 v[96:111], v[212:215], v[64:67], v[96:111]
  v_mfma_f32_32x32x16_bf16 v[112:127], v[64:67], v[216:219], v[112:127]
  s_add_u32 s29, s27, 28672
  buffer_load_dwordx4 v[64:67], v2, s[8:11], s29 offen sc1
  ds_read_b128 v[208:211], v3 offset:14336
  ds_read_b128 v[212:215], v3 offset:55296
  ds_read_b128 v[216:219], v4 offset:30720
  s_waitcnt lgkmcnt(3)
  s_waitcnt vmcnt(15)
  v_mfma_f32_32x32x16_bf16 v[80:95], v[220:223], v[68:71], v[80:95]
  v_mfma_f32_32x32x16_bf16 v[96:111], v[224:227], v[68:71], v[96:111]
  v_mfma_f32_32x32x16_bf16 v[112:127], v[68:71], v[228:231], v[112:127]
  s_add_u32 s29, s27, 29696
  buffer_load_dwordx4 v[68:71], v2, s[8:11], s29 offen sc1
  ds_read_b128 v[220:223], v3 offset:15360
  ds_read_b128 v[224:227], v3 offset:56320
  ds_read_b128 v[228:231], v4 offset:31744
  s_waitcnt lgkmcnt(3)
  s_waitcnt vmcnt(15)
  v_mfma_f32_32x32x16_bf16 v[80:95], v[208:211], v[72:75], v[80:95]
  v_mfma_f32_32x32x16_bf16 v[96:111], v[212:215], v[72:75], v[96:111]
  v_mfma_f32_32x32x16_bf16 v[112:127], v[72:75], v[216:219], v[112:127]
  s_add_u32 s29, s27, 30720
  buffer_load_dwordx4 v[72:75], v2, s[8:11], s29 offen sc1
  ds_read_b128 v[208:211], v3 offset:16384
  ds_read_b128 v[212:215], v3 offset:57344
  ds_read_b128 v[216:219], v4 offset:32768
  s_waitcnt lgkmcnt(3)
  s_waitcnt vmcnt(15)
  v_mfma_f32_32x32x16_bf16 v[80:95], v[220:223], v[76:79], v[80:95]
  v_mfma_f32_32x32x16_bf16 v[96:111], v[224:227], v[76:79], v[96:111]
  v_mfma_f32_32x32x16_bf16 v[112:127], v[76:79], v[228:231], v[112:127]
  s_add_u32 s29, s27, 31744
  buffer_load_dwordx4 v[76:79], v2, s[8:11], s29 offen sc1
  ds_read_b128 v[220:223], v3 offset:17408
  ds_read_b128 v[224:227], v3 offset:58368
  ds_read_b128 v[228:231], v4 offset:33792
  s_waitcnt lgkmcnt(3)
  s_waitcnt vmcnt(15)
  v_mfma_f32_32x32x16_bf16 v[80:95], v[208:211], v[16:19], v[80:95]
  v_mfma_f32_32x32x16_bf16 v[96:111], v[212:215], v[16:19], v[96:111]
  v_mfma_f32_32x32x16_bf16 v[112:127], v[16:19], v[216:219], v[112:127]
  s_add_u32 s29, s27, 32768
  buffer_load_dwordx4 v[16:19], v2, s[8:11], s29 offen sc1
  ds_read_b128 v[208:211], v3 offset:18432
  ds_read_b128 v[212:215], v3 offset:59392
  ds_read_b128 v[216:219], v4 offset:34816
  s_waitcnt lgkmcnt(3)
  s_waitcnt vmcnt(15)
  v_mfma_f32_32x32x16_bf16 v[80:95], v[220:223], v[20:23], v[80:95]
  v_mfma_f32_32x32x16_bf16 v[96:111], v[224:227], v[20:23], v[96:111]
  v_mfma_f32_32x32x16_bf16 v[112:127], v[20:23], v[228:231], v[112:127]
  s_add_u32 s29, s27, 33792
  buffer_load_dwordx4 v[20:23], v2, s[8:11], s29 offen sc1
  ds_read_b128 v[220:223], v3 offset:19456
  ds_read_b128 v[224:227], v3 offset:60416
  ds_read_b128 v[228:231], v4 offset:35840
  s_waitcnt lgkmcnt(3)
  s_waitcnt vmcnt(15)
  v_mfma_f32_32x32x16_bf16 v[80:95], v[208:211], v[24:27], v[80:95]
  v_mfma_f32_32x32x16_bf16 v[96:111], v[212:215], v[24:27], v[96:111]
  v_mfma_f32_32x32x16_bf16 v[112:127], v[24:27], v[216:219], v[112:127]
  s_add_u32 s29, s27, 34816
  buffer_load_dwordx4 v[24:27], v2, s[8:11], s29 offen sc1
  ds_read_b128 v[208:211], v3 offset:20480
  ds_read_b128 v[212:215], v3 offset:61440
  ds_read_b128 v[216:219], v4 offset:36864
  s_waitcnt lgkmcnt(3)
  s_waitcnt vmcnt(15)
  v_mfma_f32_32x32x16_bf16 v[80:95], v[220:223], v[28:31], v[80:95]
  v_mfma_f32_32x32x16_bf16 v[96:111], v[224:227], v[28:31], v[96:111]
  v_mfma_f32_32x32x16_bf16 v[112:127], v[28:31], v[228:231], v[112:127]
  s_add_u32 s29, s27, 35840
  buffer_load_dwordx4 v[28:31], v2, s[8:11], s29 offen sc1
  ds_read_b128 v[220:223], v3 offset:21504
  ds_read_b128 v[224:227], v3 offset:62464
  ds_read_b128 v[228:231], v4 offset:37888
  s_waitcnt lgkmcnt(3)
  s_waitcnt vmcnt(15)
  v_mfma_f32_32x32x16_bf16 v[80:95], v[208:211], v[32:35], v[80:95]
  v_mfma_f32_32x32x16_bf16 v[96:111], v[212:215], v[32:35], v[96:111]
  v_mfma_f32_32x32x16_bf16 v[112:127], v[32:35], v[216:219], v[112:127]
  s_add_u32 s29, s27, 36864
  buffer_load_dwordx4 v[32:35], v2, s[8:11], s29 offen sc1
  ds_read_b128 v[208:211], v3 offset:22528
  ds_read_b128 v[212:215], v3 offset:63488
  ds_read_b128 v[216:219], v4 offset:38912
  s_waitcnt lgkmcnt(3)
  s_waitcnt vmcnt(15)
  v_mfma_f32_32x32x16_bf16 v[80:95], v[220:223], v[36:39], v[80:95]
  v_mfma_f32_32x32x16_bf16 v[96:111], v[224:227], v[36:39], v[96:111]
  v_mfma_f32_32x32x16_bf16 v[112:127], v[36:39], v[228:231], v[112:127]
  s_add_u32 s29, s27, 37888
  buffer_load_dwordx4 v[36:39], v2, s[8:11], s29 offen sc1
  ds_read_b128 v[220:223], v3 offset:23552
  ds_read_b128 v[224:227], v3 offset:64512
  ds_read_b128 v[228:231], v4 offset:39936
  s_waitcnt lgkmcnt(3)
  s_waitcnt vmcnt(15)
  v_mfma_f32_32x32x16_bf16 v[80:95], v[208:211], v[40:43], v[80:95]
  v_mfma_f32_32x32x16_bf16 v[96:111], v[212:215], v[40:43], v[96:111]
  v_mfma_f32_32x32x16_bf16 v[112:127], v[40:43], v[216:219], v[112:127]
  s_add_u32 s29, s27, 38912
  buffer_load_dwordx4 v[40:43], v2, s[8:11], s29 offen sc1
  ds_read_b128 v[208:211], v3 offset:24576
  ds_read_b128 v[212:215], v4 offset:0
  ds_read_b128 v[216:219], v4 offset:40960
  s_waitcnt lgkmcnt(3)
  s_waitcnt vmcnt(15)
  v_mfma_f32_32x32x16_bf16 v[80:95], v[220:223], v[44:47], v[80:95]
  v_mfma_f32_32x32x16_bf16 v[96:111], v[224:227], v[44:47], v[96:111]
  v_mfma_f32_32x32x16_bf16 v[112:127], v[44:47], v[228:231], v[112:127]
  s_add_u32 s29, s27, 39936
  buffer_load_dwordx4 v[44:47], v2, s[8:11], s29 offen sc1
  ds_read_b128 v[220:223], v3 offset:25600
  ds_read_b128 v[224:227], v4 offset:1024
  ds_read_b128 v[228:231], v4 offset:41984
  s_waitcnt lgkmcnt(3)
  s_waitcnt vmcnt(15)
  v_mfma_f32_32x32x16_bf16 v[80:95], v[208:211], v[48:51], v[80:95]
  v_mfma_f32_32x32x16_bf16 v[96:111], v[212:215], v[48:51], v[96:111]
  v_mfma_f32_32x32x16_bf16 v[112:127], v[48:51], v[216:219], v[112:127]
  s_add_u32 s29, s28, 0
  buffer_load_dwordx4 v[48:51], v2, s[8:11], s29 offen sc1
  ds_read_b128 v[208:211], v3 offset:26624
  ds_read_b128 v[212:215], v4 offset:2048
  ds_read_b128 v[216:219], v4 offset:43008
  s_waitcnt lgkmcnt(3)
  s_waitcnt vmcnt(15)
  v_mfma_f32_32x32x16_bf16 v[80:95], v[220:223], v[52:55], v[80:95]
  v_mfma_f32_32x32x16_bf16 v[96:111], v[224:227], v[52:55], v[96:111]
  v_mfma_f32_32x32x16_bf16 v[112:127], v[52:55], v[228:231], v[112:127]
  s_add_u32 s29, s28, 1024
  buffer_load_dwordx4 v[52:55], v2, s[8:11], s29 offen sc1
  ds_read_b128 v[220:223], v3 offset:27648
  ds_read_b128 v[224:227], v4 offset:3072
  ds_read_b128 v[228:231], v4 offset:44032
  s_waitcnt lgkmcnt(3)
  s_waitcnt vmcnt(15)
  v_mfma_f32_32x32x16_bf16 v[80:95], v[208:211], v[56:59], v[80:95]
  v_mfma_f32_32x32x16_bf16 v[96:111], v[212:215], v[56:59], v[96:111]
  v_mfma_f32_32x32x16_bf16 v[112:127], v[56:59], v[216:219], v[112:127]
  s_add_u32 s29, s28, 2048
  buffer_load_dwordx4 v[56:59], v2, s[8:11], s29 offen sc1
  ds_read_b128 v[208:211], v3 offset:28672
  ds_read_b128 v[212:215], v4 offset:4096
  ds_read_b128 v[216:219], v4 offset:45056
  s_waitcnt lgkmcnt(3)
  s_waitcnt vmcnt(15)
  v_mfma_f32_32x32x16_bf16 v[80:95], v[220:223], v[60:63], v[80:95]
  v_mfma_f32_32x32x16_bf16 v[96:111], v[224:227], v[60:63], v[96:111]
  v_mfma_f32_32x32x16_bf16 v[112:127], v[60:63], v[228:231], v[112:127]
  s_add_u32 s29, s28, 3072
  buffer_load_dwordx4 v[60:63], v2, s[8:11], s29 offen sc1
  ds_read_b128 v[220:223], v3 offset:29696
  ds_read_b128 v[224:227], v4 offset:5120
  ds_read_b128 v[228:231], v4 offset:46080
  s_waitcnt lgkmcnt(3)
  s_waitcnt vmcnt(15)
  v_mfma_f32_32x32x16_bf16 v[80:95], v[208:211], v[64:67], v[80:95]
  v_mfma_f32_32x32x16_bf16 v[96:111], v[212:215], v[64:67], v[96:111]
  v_mfma_f32_32x32x16_bf16 v[112:127], v[64:67], v[216:219], v[112:127]
  s_add_u32 s29, s28, 4096
  buffer_load_dwordx4 v[64:67], v2, s[8:11], s29 offen sc1
  ds_read_b128 v[208:211], v3 offset:30720
  ds_read_b128 v[212:215], v4 offset:6144
  ds_read_b128 v[216:219], v4 offset:47104
  s_waitcnt lgkmcnt(3)
  s_waitcnt vmcnt(15)
  v_mfma_f32_32x32x16_bf16 v[80:95], v[220:223], v[68:71], v[80:95]
  v_mfma_f32_32x32x16_bf16 v[96:111], v[224:227], v[68:71], v[96:111]
  v_mfma_f32_32x32x16_bf16 v[112:127], v[68:71], v[228:231], v[112:127]
  s_add_u32 s29, s28, 5120
  buffer_load_dwordx4 v[68:71], v2, s[8:11], s29 offen sc1
  ds_read_b128 v[220:223], v3 offset:31744
  ds_read_b128 v[224:227], v4 offset:7168
  ds_read_b128 v[228:231], v4 offset:48128
  s_waitcnt lgkmcnt(3)
  s_waitcnt vmcnt(15)
  v_mfma_f32_32x32x16_bf16 v[80:95], v[208:211], v[72:75], v[80:95]
  v_mfma_f32_32x32x16_bf16 v[96:111], v[212:215], v[72:75], v[96:111]
  v_mfma_f32_32x32x16_bf16 v[112:127], v[72:75], v[216:219], v[112:127]
  s_add_u32 s29, s28, 6144
  buffer_load_dwordx4 v[72:75], v2, s[8:11], s29 offen sc1
  ds_read_b128 v[208:211], v3 offset:32768
  ds_read_b128 v[212:215], v4 offset:8192
  ds_read_b128 v[216:219], v4 offset:49152
  s_waitcnt lgkmcnt(3)
  s_waitcnt vmcnt(15)
  v_mfma_f32_32x32x16_bf16 v[80:95], v[220:223], v[76:79], v[80:95]
  v_mfma_f32_32x32x16_bf16 v[96:111], v[224:227], v[76:79], v[96:111]
  v_mfma_f32_32x32x16_bf16 v[112:127], v[76:79], v[228:231], v[112:127]
  s_add_u32 s29, s28, 7168
  buffer_load_dwordx4 v[76:79], v2, s[8:11], s29 offen sc1
  ds_read_b128 v[220:223], v3 offset:33792
  ds_read_b128 v[224:227], v4 offset:9216
  ds_read_b128 v[228:231], v4 offset:50176
  s_waitcnt lgkmcnt(3)
  s_waitcnt vmcnt(15)
  v_mfma_f32_32x32x16_bf16 v[80:95], v[208:211], v[16:19], v[80:95]
  v_mfma_f32_32x32x16_bf16 v[96:111], v[212:215], v[16:19], v[96:111]
  v_mfma_f32_32x32x16_bf16 v[112:127], v[16:19], v[216:219], v[112:127]
  s_add_u32 s29, s28, 8192
  buffer_load_dwordx4 v[16:19], v2, s[8:11], s29 offen sc1
  ds_read_b128 v[208:211], v3 offset:34816
  ds_read_b128 v[212:215], v4 offset:10240
  ds_read_b128 v[216:219], v4 offset:51200
  s_waitcnt lgkmcnt(3)
  s_waitcnt vmcnt(15)
  v_mfma_f32_32x32x16_bf16 v[80:95], v[220:223], v[20:23], v[80:95]
  v_mfma_f32_32x32x16_bf16 v[96:111], v[224:227], v[20:23], v[96:111]
  v_mfma_f32_32x32x16_bf16 v[112:127], v[20:23], v[228:231], v[112:127]
  s_add_u32 s29, s28, 9216
  buffer_load_dwordx4 v[20:23], v2, s[8:11], s29 offen sc1
  ds_read_b128 v[220:223], v3 offset:35840
  ds_read_b128 v[224:227], v4 offset:11264
  ds_read_b128 v[228:231], v4 offset:52224
  s_waitcnt lgkmcnt(3)
  s_waitcnt vmcnt(15)
  v_mfma_f32_32x32x16_bf16 v[80:95], v[208:211], v[24:27], v[80:95]
  v_mfma_f32_32x32x16_bf16 v[96:111], v[212:215], v[24:27], v[96:111]
  v_mfma_f32_32x32x16_bf16 v[112:127], v[24:27], v[216:219], v[112:127]
  s_add_u32 s29, s28, 10240
  buffer_load_dwordx4 v[24:27], v2, s[8:11], s29 offen sc1
  ds_read_b128 v[208:211], v3 offset:36864
  ds_read_b128 v[212:215], v4 offset:12288
  ds_read_b128 v[216:219], v4 offset:53248
  s_waitcnt lgkmcnt(3)
  s_waitcnt vmcnt(15)
  v_mfma_f32_32x32x16_bf16 v[80:95], v[220:223], v[28:31], v[80:95]
  v_mfma_f32_32x32x16_bf16 v[96:111], v[224:227], v[28:31], v[96:111]
  v_mfma_f32_32x32x16_bf16 v[112:127], v[28:31], v[228:231], v[112:127]
  s_add_u32 s29, s28, 11264
  buffer_load_dwordx4 v[28:31], v2, s[8:11], s29 offen sc1
  ds_read_b128 v[220:223], v3 offset:37888
  ds_read_b128 v[224:227], v4 offset:13312
  ds_read_b128 v[228:231], v4 offset:54272
  s_waitcnt lgkmcnt(3)
  s_waitcnt vmcnt(15)
  v_mfma_f32_32x32x16_bf16 v[80:95], v[208:211], v[32:35], v[80:95]
  v_mfma_f32_32x32x16_bf16 v[96:111], v[212:215], v[32:35], v[96:111]
  v_mfma_f32_32x32x16_bf16 v[112:127], v[32:35], v[216:219], v[112:127]
  s_add_u32 s29, s28, 12288
  buffer_load_dwordx4 v[32:35], v2, s[8:11], s29 offen sc1
  ds_read_b128 v[208:211], v3 offset:38912
  ds_read_b128 v[212:215], v4 offset:14336
  ds_read_b128 v[216:219], v4 offset:55296
  s_waitcnt lgkmcnt(3)
  s_waitcnt vmcnt(15)
  v_mfma_f32_32x32x16_bf16 v[80:95], v[220:223], v[36:39], v[80:95]
  v_mfma_f32_32x32x16_bf16 v[96:111], v[224:227], v[36:39], v[96:111]
  v_mfma_f32_32x32x16_bf16 v[112:127], v[36:39], v[228:231], v[112:127]
  s_add_u32 s29, s28, 13312
  buffer_load_dwordx4 v[36:39], v2, s[8:11], s29 offen sc1
  ds_read_b128 v[220:223], v3 offset:39936
  ds_read_b128 v[224:227], v4 offset:15360
  ds_read_b128 v[228:231], v4 offset:56320
  s_waitcnt lgkmcnt(3)
  s_waitcnt vmcnt(15)
  v_mfma_f32_32x32x16_bf16 v[80:95], v[208:211], v[40:43], v[80:95]
  v_mfma_f32_32x32x16_bf16 v[96:111], v[212:215], v[40:43], v[96:111]
  v_mfma_f32_32x32x16_bf16 v[112:127], v[40:43], v[216:219], v[112:127]
  s_add_u32 s29, s28, 14336
  buffer_load_dwordx4 v[40:43], v2, s[8:11], s29 offen sc1
  ds_read_b128 v[208:211], v3 offset:0
  ds_read_b128 v[212:215], v3 offset:40960
  ds_read_b128 v[216:219], v4 offset:16384
  s_waitcnt lgkmcnt(3)
  s_waitcnt vmcnt(15)
  v_mfma_f32_32x32x16_bf16 v[80:95], v[220:223], v[44:47], v[80:95]
  v_mfma_f32_32x32x16_bf16 v[96:111], v[224:227], v[44:47], v[96:111]
  v_mfma_f32_32x32x16_bf16 v[112:127], v[44:47], v[228:231], v[112:127]
  s_add_u32 s29, s28, 15360
  buffer_load_dwordx4 v[44:47], v2, s[8:11], s29 offen sc1
  ds_read_b128 v[220:223], v3 offset:1024
  ds_read_b128 v[224:227], v3 offset:41984
  ds_read_b128 v[228:231], v4 offset:17408
  s_waitcnt lgkmcnt(3)
  s_waitcnt vmcnt(15)
  v_mfma_f32_32x32x16_bf16 v[128:143], v[208:211], v[48:51], 0
  v_mfma_f32_32x32x16_bf16 v[144:159], v[212:215], v[48:51], 0
  v_mfma_f32_32x32x16_bf16 v[160:175], v[48:51], v[216:219], 0
  s_add_u32 s29, s28, 16384
  buffer_load_dwordx4 v[48:51], v2, s[8:11], s29 offen sc1
  ds_read_b128 v[208:211], v3 offset:2048
  ds_read_b128 v[212:215], v3 offset:43008
  ds_read_b128 v[216:219], v4 offset:18432
  s_waitcnt lgkmcnt(3)
  s_waitcnt vmcnt(15)
  v_mfma_f32_32x32x16_bf16 v[128:143], v[220:223], v[52:55], v[128:143]
  v_mfma_f32_32x32x16_bf16 v[144:159], v[224:227], v[52:55], v[144:159]
  v_mfma_f32_32x32x16_bf16 v[160:175], v[52:55], v[228:231], v[160:175]
  s_add_u32 s29, s28, 17408
  buffer_load_dwordx4 v[52:55], v2, s[8:11], s29 offen sc1
  ds_read_b128 v[220:223], v3 offset:3072
  ds_read_b128 v[224:227], v3 offset:44032
  ds_read_b128 v[228:231], v4 offset:19456
  s_waitcnt lgkmcnt(3)
  s_waitcnt vmcnt(15)
  v_mfma_f32_32x32x16_bf16 v[128:143], v[208:211], v[56:59], v[128:143]
  v_max3_f32 v9, v9, abs(v96), abs(v97)
  v_max3_f32 v9, v9, abs(v98), abs(v99)
  v_mfma_f32_32x32x16_bf16 v[144:159], v[212:215], v[56:59], v[144:159]
  v_max3_f32 v9, v9, abs(v100), abs(v101)
  v_max3_f32 v9, v9, abs(v102), abs(v103)
  v_mfma_f32_32x32x16_bf16 v[160:175], v[56:59], v[216:219], v[160:175]
  v_max3_f32 v9, v9, abs(v104), abs(v105)
  v_max3_f32 v9, v9, abs(v106), abs(v107)
  s_add_u32 s29, s28, 18432
  buffer_load_dwordx4 v[56:59], v2, s[8:11], s29 offen sc1
  ds_read_b128 v[208:211], v3 offset:4096
  ds_read_b128 v[212:215], v3 offset:45056
  ds_read_b128 v[216:219], v4 offset:20480
  s_waitcnt lgkmcnt(3)
  s_waitcnt vmcnt(15)
  v_mfma_f32_32x32x16_bf16 v[128:143], v[220:223], v[60:63], v[128:143]
  v_max3_f32 v9, v9, abs(v108), abs(v109)
  v_max3_f32 v9, v9, abs(v110), abs(v111)
  v_mfma_f32_32x32x16_bf16 v[144:159], v[224:227], v[60:63], v[144:159]
  v_add_f32 v108, v108, v6
  v_cvt_pk_bf16_f32 v232, v96, v97
  v_mfma_f32_32x32x16_bf16 v[160:175], v[60:63], v[228:231], v[160:175]
  v_cvt_pk_bf16_f32 v233, v98, v99
  v_cvt_pk_bf16_f32 v234, v100, v101
  s_add_u32 s29, s28, 19456
  buffer_load_dwordx4 v[60:63], v2, s[8:11], s29 offen sc1
  ds_read_b128 v[220:223], v3 offset:5120
  ds_read_b128 v[224:227], v3 offset:46080
  ds_read_b128 v[228:231], v4 offset:21504
  s_waitcnt lgkmcnt(3)
  s_waitcnt vmcnt(15)
  v_mfma_f32_32x32x16_bf16 v[128:143], v[208:211], v[64:67], v[128:143]
  v_cvt_pk_bf16_f32 v235, v102, v103
  v_cvt_pk_bf16_f32 v236, v104, v105
  v_mfma_f32_32x32x16_bf16 v[144:159], v[212:215], v[64:67], v[144:159]
  v_cvt_pk_bf16_f32 v237, v106, v107
  v_cvt_pk_bf16_f32 v238, v108, v109
  v_mfma_f32_32x32x16_bf16 v[160:175], v[64:67], v[216:219], v[160:175]
  v_cvt_pk_bf16_f32 v239, v110, v111
  s_add_u32 s26, s31, 245366784
  s_add_u32 s29, s28, 20480
  buffer_load_dwordx4 v[64:67], v2, s[8:11], s29 offen sc1
  ds_read_b128 v[208:211], v3 offset:6144
  ds_read_b128 v[212:215], v3 offset:47104
  ds_read_b128 v[216:219], v4 offset:22528
  s_waitcnt lgkmcnt(3)
  s_waitcnt vmcnt(15)
  v_mfma_f32_32x32x16_bf16 v[128:143], v[220:223], v[68:71], v[128:143]
  buffer_store_dwordx4 v[232:235], v2, s[8:11], s26 offen sc1
  buffer_store_dwordx4 v[236:239], v2, s[8:11], s26 offen offset:1024 sc1
  v_mfma_f32_32x32x16_bf16 v[144:159], v[224:227], v[68:71], v[144:159]
  v_cndmask_b32 v112, v112, v8, s[32:33]
  v_cndmask_b32 v113, v113, v8, s[32:33]
  v_mfma_f32_32x32x16_bf16 v[160:175], v[68:71], v[228:231], v[160:175]
  v_cndmask_b32 v114, v114, v8, s[32:33]
  v_cndmask_b32 v115, v115, v8, s[32:33]
  s_add_u32 s29, s28, 21504
  buffer_load_dwordx4 v[68:71], v2, s[8:11], s29 offen sc1
  ds_read_b128 v[220:223], v3 offset:7168
  ds_read_b128 v[224:227], v3 offset:48128
  ds_read_b128 v[228:231], v4 offset:23552
  s_waitcnt lgkmcnt(3)
  s_waitcnt vmcnt(17)
  v_mfma_f32_32x32x16_bf16 v[128:143], v[208:211], v[72:75], v[128:143]
  v_cndmask_b32 v116, v116, v8, s[32:33]
  v_cndmask_b32 v117, v117, v8, s[32:33]
  v_mfma_f32_32x32x16_bf16 v[144:159], v[212:215], v[72:75], v[144:159]
  v_cndmask_b32 v118, v118, v8, s[32:33]
  v_cndmask_b32 v119, v119, v8, s[32:33]
  v_mfma_f32_32x32x16_bf16 v[160:175], v[72:75], v[216:219], v[160:175]
  v_cndmask_b32 v120, v120, v8, s[32:33]
  v_cndmask_b32 v121, v121, v8, s[32:33]
  s_add_u32 s29, s28, 22528
  buffer_load_dwordx4 v[72:75], v2, s[8:11], s29 offen sc1
  ds_read_b128 v[208:211], v3 offset:8192
  ds_read_b128 v[212:215], v3 offset:49152
  ds_read_b128 v[216:219], v4 offset:24576
  s_waitcnt lgkmcnt(3)
  s_waitcnt vmcnt(17)
  v_mfma_f32_32x32x16_bf16 v[128:143], v[220:223], v[76:79], v[128:143]
  v_cndmask_b32 v122, v122, v8, s[32:33]
  v_cndmask_b32 v123, v123, v8, s[32:33]
  v_mfma_f32_32x32x16_bf16 v[144:159], v[224:227], v[76:79], v[144:159]
  v_cndmask_b32 v124, v124, v8, s[32:33]
  v_cndmask_b32 v125, v125, v8, s[32:33]
  v_mfma_f32_32x32x16_bf16 v[160:175], v[76:79], v[228:231], v[160:175]
  v_cndmask_b32 v126, v126, v8, s[32:33]
  v_cndmask_b32 v127, v127, v8, s[32:33]
  s_add_u32 s29, s28, 23552
  buffer_load_dwordx4 v[76:79], v2, s[8:11], s29 offen sc1
  ds_read_b128 v[220:223], v3 offset:9216
  ds_read_b128 v[224:227], v3 offset:50176
  ds_read_b128 v[228:231], v4 offset:25600
  s_waitcnt lgkmcnt(3)
  s_waitcnt vmcnt(17)
  v_mfma_f32_32x32x16_bf16 v[128:143], v[208:211], v[16:19], v[128:143]
  v_cvt_pk_bf16_f32 v240, v112, v113
  v_cvt_pk_bf16_f32 v241, v114, v115
  v_mfma_f32_32x32x16_bf16 v[144:159], v[212:215], v[16:19], v[144:159]
  v_cvt_pk_bf16_f32 v242, v116, v117
  v_cvt_pk_bf16_f32 v243, v118, v119
  v_mfma_f32_32x32x16_bf16 v[160:175], v[16:19], v[216:219], v[160:175]
  v_cvt_pk_bf16_f32 v244, v120, v121
  v_cvt_pk_bf16_f32 v245, v122, v123
  s_add_u32 s29, s28, 24576
  buffer_load_dwordx4 v[16:19], v2, s[8:11], s29 offen sc1
  ds_read_b128 v[208:211], v3 offset:10240
  ds_read_b128 v[212:215], v3 offset:51200
  ds_read_b128 v[216:219], v4 offset:26624
  s_waitcnt lgkmcnt(3)
  s_waitcnt vmcnt(17)
  v_mfma_f32_32x32x16_bf16 v[128:143], v[220:223], v[20:23], v[128:143]
  v_cvt_pk_bf16_f32 v246, v124, v125
  v_cvt_pk_bf16_f32 v247, v126, v127
  v_mfma_f32_32x32x16_bf16 v[144:159], v[224:227], v[20:23], v[144:159]
  s_add_u32 s26, s31, 249561088
  buffer_store_dwordx4 v[240:243], v2, s[8:11], s26 offen sc1
  v_mfma_f32_32x32x16_bf16 v[160:175], v[20:23], v[228:231], v[160:175]
  buffer_store_dwordx4 v[244:247], v2, s[8:11], s26 offen offset:1024 sc1
  v_mul_f32 v80, s30, v80
  s_add_u32 s29, s28, 25600
  buffer_load_dwordx4 v[20:23], v2, s[8:11], s29 offen sc1
  ds_read_b128 v[220:223], v3 offset:11264
  ds_read_b128 v[224:227], v3 offset:52224
  ds_read_b128 v[228:231], v4 offset:27648
  s_waitcnt lgkmcnt(3)
  s_waitcnt vmcnt(19)
  v_mfma_f32_32x32x16_bf16 v[128:143], v[208:211], v[24:27], v[128:143]
  v_mul_f32 v81, s30, v81
  v_mul_f32 v82, s30, v82
  v_mfma_f32_32x32x16_bf16 v[144:159], v[212:215], v[24:27], v[144:159]
  v_mul_f32 v83, s30, v83
  v_mul_f32 v84, s30, v84
  v_mfma_f32_32x32x16_bf16 v[160:175], v[24:27], v[216:219], v[160:175]
  v_mul_f32 v85, s30, v85
  v_mul_f32 v86, s30, v86
  s_add_u32 s29, s28, 26624
  buffer_load_dwordx4 v[24:27], v2, s[8:11], s29 offen sc1
  ds_read_b128 v[208:211], v3 offset:12288
  ds_read_b128 v[212:215], v3 offset:53248
  ds_read_b128 v[216:219], v4 offset:28672
  s_waitcnt lgkmcnt(3)
  s_waitcnt vmcnt(19)
  v_mfma_f32_32x32x16_bf16 v[128:143], v[220:223], v[28:31], v[128:143]
  v_mul_f32 v87, s30, v87
  v_mul_f32 v88, s30, v88
  v_mfma_f32_32x32x16_bf16 v[144:159], v[224:227], v[28:31], v[144:159]
  v_mul_f32 v89, s30, v89
  v_mul_f32 v90, s30, v90
  v_mfma_f32_32x32x16_bf16 v[160:175], v[28:31], v[228:231], v[160:175]
  v_mul_f32 v91, s30, v91
  v_mul_f32 v92, s30, v92
  s_add_u32 s29, s28, 27648
  buffer_load_dwordx4 v[28:31], v2, s[8:11], s29 offen sc1
  ds_read_b128 v[220:223], v3 offset:13312
  ds_read_b128 v[224:227], v3 offset:54272
  ds_read_b128 v[228:231], v4 offset:29696
  s_waitcnt lgkmcnt(3)
  s_waitcnt vmcnt(19)
  v_mfma_f32_32x32x16_bf16 v[128:143], v[208:211], v[32:35], v[128:143]
  v_mul_f32 v93, s30, v93
  v_mul_f32 v94, s30, v94
  v_mfma_f32_32x32x16_bf16 v[144:159], v[212:215], v[32:35], v[144:159]
  v_mul_f32 v95, s30, v95
  v_cvt_pk_bf16_f32 v192, v80, v81
  v_mfma_f32_32x32x16_bf16 v[160:175], v[32:35], v[216:219], v[160:175]
  v_cvt_pk_bf16_f32 v193, v82, v83
  v_cvt_pk_bf16_f32 v194, v84, v85
  s_add_u32 s29, s28, 28672
  buffer_load_dwordx4 v[32:35], v2, s[8:11], s29 offen sc1
  ds_read_b128 v[208:211], v3 offset:14336
  ds_read_b128 v[212:215], v3 offset:55296
  ds_read_b128 v[216:219], v4 offset:30720
  s_waitcnt lgkmcnt(3)
  s_waitcnt vmcnt(19)
  v_mfma_f32_32x32x16_bf16 v[128:143], v[220:223], v[36:39], v[128:143]
  v_cvt_pk_bf16_f32 v195, v86, v87
  v_cvt_pk_bf16_f32 v196, v88, v89
  v_mfma_f32_32x32x16_bf16 v[144:159], v[224:227], v[36:39], v[144:159]
  v_cvt_pk_bf16_f32 v197, v90, v91
  v_cvt_pk_bf16_f32 v198, v92, v93
  v_mfma_f32_32x32x16_bf16 v[160:175], v[36:39], v[228:231], v[160:175]
  v_cvt_pk_bf16_f32 v199, v94, v95
  s_add_u32 s29, s28, 29696
  buffer_load_dwordx4 v[36:39], v2, s[8:11], s29 offen sc1
  ds_read_b128 v[220:223], v3 offset:15360
  ds_read_b128 v[224:227], v3 offset:56320
  ds_read_b128 v[228:231], v4 offset:31744
  s_waitcnt lgkmcnt(3)
  s_waitcnt vmcnt(19)
  v_mfma_f32_32x32x16_bf16 v[128:143], v[208:211], v[40:43], v[128:143]
  v_mfma_f32_32x32x16_bf16 v[144:159], v[212:215], v[40:43], v[144:159]
  v_mfma_f32_32x32x16_bf16 v[160:175], v[40:43], v[216:219], v[160:175]
  s_add_u32 s29, s28, 30720
  buffer_load_dwordx4 v[40:43], v2, s[8:11], s29 offen sc1
  ds_read_b128 v[208:211], v3 offset:16384
  ds_read_b128 v[212:215], v3 offset:57344
  ds_read_b128 v[216:219], v4 offset:32768
  s_waitcnt lgkmcnt(3)
  s_waitcnt vmcnt(19)
  v_mfma_f32_32x32x16_bf16 v[128:143], v[220:223], v[44:47], v[128:143]
  v_mfma_f32_32x32x16_bf16 v[144:159], v[224:227], v[44:47], v[144:159]
  v_mfma_f32_32x32x16_bf16 v[160:175], v[44:47], v[228:231], v[160:175]
  s_add_u32 s29, s28, 31744
  buffer_load_dwordx4 v[44:47], v2, s[8:11], s29 offen sc1
  ds_read_b128 v[220:223], v3 offset:17408
  ds_read_b128 v[224:227], v3 offset:58368
  ds_read_b128 v[228:231], v4 offset:33792
  s_waitcnt lgkmcnt(3)
  s_waitcnt vmcnt(19)
  v_mfma_f32_32x32x16_bf16 v[128:143], v[208:211], v[48:51], v[128:143]
  v_mfma_f32_32x32x16_bf16 v[144:159], v[212:215], v[48:51], v[144:159]
  v_mfma_f32_32x32x16_bf16 v[160:175], v[48:51], v[216:219], v[160:175]
  s_add_u32 s29, s28, 32768
  buffer_load_dwordx4 v[48:51], v2, s[8:11], s29 offen sc1
  ds_read_b128 v[208:211], v3 offset:18432
  ds_read_b128 v[212:215], v3 offset:59392
  ds_read_b128 v[216:219], v4 offset:34816
  s_waitcnt lgkmcnt(3)
  s_waitcnt vmcnt(19)
  v_mfma_f32_32x32x16_bf16 v[128:143], v[220:223], v[52:55], v[128:143]
  v_mfma_f32_32x32x16_bf16 v[144:159], v[224:227], v[52:55], v[144:159]
  v_mfma_f32_32x32x16_bf16 v[160:175], v[52:55], v[228:231], v[160:175]
  s_add_u32 s29, s28, 33792
  buffer_load_dwordx4 v[52:55], v2, s[8:11], s29 offen sc1
  ds_read_b128 v[220:223], v3 offset:19456
  ds_read_b128 v[224:227], v3 offset:60416
  ds_read_b128 v[228:231], v4 offset:35840
  s_waitcnt lgkmcnt(3)
  s_waitcnt vmcnt(19)
  v_mfma_f32_32x32x16_bf16 v[128:143], v[208:211], v[56:59], v[128:143]
  v_mfma_f32_32x32x16_bf16 v[144:159], v[212:215], v[56:59], v[144:159]
  v_mfma_f32_32x32x16_bf16 v[160:175], v[56:59], v[216:219], v[160:175]
  s_add_u32 s29, s28, 34816
  buffer_load_dwordx4 v[56:59], v2, s[8:11], s29 offen sc1
  ds_read_b128 v[208:211], v3 offset:20480
  ds_read_b128 v[212:215], v3 offset:61440
  ds_read_b128 v[216:219], v4 offset:36864
  s_waitcnt lgkmcnt(3)
  s_waitcnt vmcnt(19)
  v_mfma_f32_32x32x16_bf16 v[128:143], v[220:223], v[60:63], v[128:143]
  v_mfma_f32_32x32x16_bf16 v[144:159], v[224:227], v[60:63], v[144:159]
  v_mfma_f32_32x32x16_bf16 v[160:175], v[60:63], v[228:231], v[160:175]
  s_add_u32 s29, s28, 35840
  buffer_load_dwordx4 v[60:63], v2, s[8:11], s29 offen sc1
  ds_read_b128 v[220:223], v3 offset:21504
  ds_read_b128 v[224:227], v3 offset:62464
  ds_read_b128 v[228:231], v4 offset:37888
  s_waitcnt lgkmcnt(3)
  s_waitcnt vmcnt(19)
  v_mfma_f32_32x32x16_bf16 v[128:143], v[208:211], v[64:67], v[128:143]
  v_mfma_f32_32x32x16_bf16 v[144:159], v[212:215], v[64:67], v[144:159]
  v_mfma_f32_32x32x16_bf16 v[160:175], v[64:67], v[216:219], v[160:175]
  s_add_u32 s29, s28, 36864
  buffer_load_dwordx4 v[64:67], v2, s[8:11], s29 offen sc1
  ds_read_b128 v[208:211], v3 offset:22528
  ds_read_b128 v[212:215], v3 offset:63488
  ds_read_b128 v[216:219], v4 offset:38912
  s_waitcnt lgkmcnt(3)
  s_waitcnt vmcnt(17)
  v_mfma_f32_32x32x16_bf16 v[128:143], v[220:223], v[68:71], v[128:143]
  v_mfma_f32_32x32x16_bf16 v[144:159], v[224:227], v[68:71], v[144:159]
  v_mfma_f32_32x32x16_bf16 v[160:175], v[68:71], v[228:231], v[160:175]
  s_add_u32 s29, s28, 37888
  buffer_load_dwordx4 v[68:71], v2, s[8:11], s29 offen sc1
  ds_read_b128 v[220:223], v3 offset:23552
  ds_read_b128 v[224:227], v3 offset:64512
  ds_read_b128 v[228:231], v4 offset:39936
  s_waitcnt lgkmcnt(3)
  s_waitcnt vmcnt(17)
  v_mfma_f32_32x32x16_bf16 v[128:143], v[208:211], v[72:75], v[128:143]
  v_mfma_f32_32x32x16_bf16 v[144:159], v[212:215], v[72:75], v[144:159]
  v_mfma_f32_32x32x16_bf16 v[160:175], v[72:75], v[216:219], v[160:175]
  s_add_u32 s29, s28, 38912
  buffer_load_dwordx4 v[72:75], v2, s[8:11], s29 offen sc1
  ds_read_b128 v[208:211], v3 offset:24576
  ds_read_b128 v[212:215], v4 offset:0
  ds_read_b128 v[216:219], v4 offset:40960
  s_waitcnt lgkmcnt(3)
  s_waitcnt vmcnt(17)
  v_mfma_f32_32x32x16_bf16 v[128:143], v[220:223], v[76:79], v[128:143]
  v_mfma_f32_32x32x16_bf16 v[144:159], v[224:227], v[76:79], v[144:159]
  v_mfma_f32_32x32x16_bf16 v[160:175], v[76:79], v[228:231], v[160:175]
  s_add_u32 s29, s28, 39936
  buffer_load_dwordx4 v[76:79], v2, s[8:11], s29 offen sc1
  ds_read_b128 v[220:223], v3 offset:25600
  ds_read_b128 v[224:227], v4 offset:1024
  ds_read_b128 v[228:231], v4 offset:41984
  s_waitcnt lgkmcnt(3)
  s_waitcnt vmcnt(17)
  v_mfma_f32_32x32x16_bf16 v[128:143], v[208:211], v[16:19], v[128:143]
  v_mfma_f32_32x32x16_bf16 v[144:159], v[212:215], v[16:19], v[144:159]
  v_mfma_f32_32x32x16_bf16 v[160:175], v[16:19], v[216:219], v[160:175]
  ds_read_b128 v[208:211], v3 offset:26624
  ds_read_b128 v[212:215], v4 offset:2048
  ds_read_b128 v[216:219], v4 offset:43008
  s_waitcnt lgkmcnt(3)
  s_waitcnt vmcnt(14)
  v_mfma_f32_32x32x16_bf16 v[128:143], v[220:223], v[20:23], v[128:143]
  v_mfma_f32_32x32x16_bf16 v[144:159], v[224:227], v[20:23], v[144:159]
  v_mfma_f32_32x32x16_bf16 v[160:175], v[20:23], v[228:231], v[160:175]
  ds_read_b128 v[220:223], v3 offset:27648
  ds_read_b128 v[224:227], v4 offset:3072
  ds_read_b128 v[228:231], v4 offset:44032
  s_waitcnt lgkmcnt(3)
  s_waitcnt vmcnt(13)
  v_mfma_f32_32x32x16_bf16 v[128:143], v[208:211], v[24:27], v[128:143]
  v_mfma_f32_32x32x16_bf16 v[144:159], v[212:215], v[24:27], v[144:159]
  v_mfma_f32_32x32x16_bf16 v[160:175], v[24:27], v[216:219], v[160:175]
  ds_read_b128 v[208:211], v3 offset:28672
  ds_read_b128 v[212:215], v4 offset:4096
  ds_read_b128 v[216:219], v4 offset:45056
  s_waitcnt lgkmcnt(3)
  s_waitcnt vmcnt(12)
  v_mfma_f32_32x32x16_bf16 v[128:143], v[220:223], v[28:31], v[128:143]
  v_mfma_f32_32x32x16_bf16 v[144:159], v[224:227], v[28:31], v[144:159]
  v_mfma_f32_32x32x16_bf16 v[160:175], v[28:31], v[228:231], v[160:175]
  ds_read_b128 v[220:223], v3 offset:29696
  ds_read_b128 v[224:227], v4 offset:5120
  ds_read_b128 v[228:231], v4 offset:46080
  s_waitcnt lgkmcnt(3)
  s_waitcnt vmcnt(11)
  v_mfma_f32_32x32x16_bf16 v[128:143], v[208:211], v[32:35], v[128:143]
  v_mfma_f32_32x32x16_bf16 v[144:159], v[212:215], v[32:35], v[144:159]
  v_mfma_f32_32x32x16_bf16 v[160:175], v[32:35], v[216:219], v[160:175]
  ds_read_b128 v[208:211], v3 offset:30720
  ds_read_b128 v[212:215], v4 offset:6144
  ds_read_b128 v[216:219], v4 offset:47104
  s_waitcnt lgkmcnt(3)
  s_waitcnt vmcnt(10)
  v_mfma_f32_32x32x16_bf16 v[128:143], v[220:223], v[36:39], v[128:143]
  v_mfma_f32_32x32x16_bf16 v[144:159], v[224:227], v[36:39], v[144:159]
  v_mfma_f32_32x32x16_bf16 v[160:175], v[36:39], v[228:231], v[160:175]
  ds_read_b128 v[220:223], v3 offset:31744
  ds_read_b128 v[224:227], v4 offset:7168
  ds_read_b128 v[228:231], v4 offset:48128
  s_waitcnt lgkmcnt(3)
  s_waitcnt vmcnt(9)
  v_mfma_f32_32x32x16_bf16 v[128:143], v[208:211], v[40:43], v[128:143]
  v_mfma_f32_32x32x16_bf16 v[144:159], v[212:215], v[40:43], v[144:159]
  v_mfma_f32_32x32x16_bf16 v[160:175], v[40:43], v[216:219], v[160:175]
  ds_read_b128 v[208:211], v3 offset:32768
  ds_read_b128 v[212:215], v4 offset:8192
  ds_read_b128 v[216:219], v4 offset:49152
  s_waitcnt lgkmcnt(3)
  s_waitcnt vmcnt(8)
  v_mfma_f32_32x32x16_bf16 v[128:143], v[220:223], v[44:47], v[128:143]
  v_mfma_f32_32x32x16_bf16 v[144:159], v[224:227], v[44:47], v[144:159]
  v_mfma_f32_32x32x16_bf16 v[160:175], v[44:47], v[228:231], v[160:175]
  ds_read_b128 v[220:223], v3 offset:33792
  ds_read_b128 v[224:227], v4 offset:9216
  ds_read_b128 v[228:231], v4 offset:50176
  s_waitcnt lgkmcnt(3)
  s_waitcnt vmcnt(7)
  v_mfma_f32_32x32x16_bf16 v[128:143], v[208:211], v[48:51], v[128:143]
  v_mfma_f32_32x32x16_bf16 v[144:159], v[212:215], v[48:51], v[144:159]
  v_mfma_f32_32x32x16_bf16 v[160:175], v[48:51], v[216:219], v[160:175]
  ds_read_b128 v[208:211], v3 offset:34816
  ds_read_b128 v[212:215], v4 offset:10240
  ds_read_b128 v[216:219], v4 offset:51200
  s_waitcnt lgkmcnt(3)
  s_waitcnt vmcnt(6)
  v_mfma_f32_32x32x16_bf16 v[128:143], v[220:223], v[52:55], v[128:143]
  v_mfma_f32_32x32x16_bf16 v[144:159], v[224:227], v[52:55], v[144:159]
  v_mfma_f32_32x32x16_bf16 v[160:175], v[52:55], v[228:231], v[160:175]
  ds_read_b128 v[220:223], v3 offset:35840
  ds_read_b128 v[224:227], v4 offset:11264
  ds_read_b128 v[228:231], v4 offset:52224
  s_waitcnt lgkmcnt(3)
  s_waitcnt vmcnt(5)
  v_mfma_f32_32x32x16_bf16 v[128:143], v[208:211], v[56:59], v[128:143]
  v_mfma_f32_32x32x16_bf16 v[144:159], v[212:215], v[56:59], v[144:159]
  v_mfma_f32_32x32x16_bf16 v[160:175], v[56:59], v[216:219], v[160:175]
  ds_read_b128 v[208:211], v3 offset:36864
  ds_read_b128 v[212:215], v4 offset:12288
  ds_read_b128 v[216:219], v4 offset:53248
  s_waitcnt lgkmcnt(3)
  s_waitcnt vmcnt(4)
  v_mfma_f32_32x32x16_bf16 v[128:143], v[220:223], v[60:63], v[128:143]
  v_mfma_f32_32x32x16_bf16 v[144:159], v[224:227], v[60:63], v[144:159]
  v_mfma_f32_32x32x16_bf16 v[160:175], v[60:63], v[228:231], v[160:175]
  ds_read_b128 v[220:223], v3 offset:37888
  ds_read_b128 v[224:227], v4 offset:13312
  ds_read_b128 v[228:231], v4 offset:54272
  s_waitcnt lgkmcnt(3)
  s_waitcnt vmcnt(3)
  v_mfma_f32_32x32x16_bf16 v[128:143], v[208:211], v[64:67], v[128:143]
  v_mfma_f32_32x32x16_bf16 v[144:159], v[212:215], v[64:67], v[144:159]
  v_mfma_f32_32x32x16_bf16 v[160:175], v[64:67], v[216:219], v[160:175]
  ds_read_b128 v[208:211], v3 offset:38912
  ds_read_b128 v[212:215], v4 offset:14336
  ds_read_b128 v[216:219], v4 offset:55296
  s_waitcnt lgkmcnt(3)
  s_waitcnt vmcnt(2)
  v_mfma_f32_32x32x16_bf16 v[128:143], v[220:223], v[68:71], v[128:143]
  v_mfma_f32_32x32x16_bf16 v[144:159], v[224:227], v[68:71], v[144:159]
  v_mfma_f32_32x32x16_bf16 v[160:175], v[68:71], v[228:231], v[160:175]
  ds_read_b128 v[220:223], v3 offset:39936
  ds_read_b128 v[224:227], v4 offset:15360
  ds_read_b128 v[228:231], v4 offset:56320
  s_waitcnt lgkmcnt(3)
  s_waitcnt vmcnt(1)
  v_mfma_f32_32x32x16_bf16 v[128:143], v[208:211], v[72:75], v[128:143]
  v_mfma_f32_32x32x16_bf16 v[144:159], v[212:215], v[72:75], v[144:159]
  v_mfma_f32_32x32x16_bf16 v[160:175], v[72:75], v[216:219], v[160:175]
  s_waitcnt lgkmcnt(0)
  s_waitcnt vmcnt(0)
  v_mfma_f32_32x32x16_bf16 v[128:143], v[220:223], v[76:79], v[128:143]
  v_mfma_f32_32x32x16_bf16 v[144:159], v[224:227], v[76:79], v[144:159]
  v_mfma_f32_32x32x16_bf16 v[160:175], v[76:79], v[228:231], v[160:175]
  s_nop 11
  v_max3_f32 v9, v9, abs(v144), abs(v145)
  v_max3_f32 v9, v9, abs(v146), abs(v147)
  v_max3_f32 v9, v9, abs(v148), abs(v149)
  v_max3_f32 v9, v9, abs(v150), abs(v151)
  v_max3_f32 v9, v9, abs(v152), abs(v153)
  v_max3_f32 v9, v9, abs(v154), abs(v155)
  v_max3_f32 v9, v9, abs(v156), abs(v157)
  v_max3_f32 v9, v9, abs(v158), abs(v159)
  v_add_f32 v156, v156, v6
  v_cvt_pk_bf16_f32 v232, v144, v145
  v_cvt_pk_bf16_f32 v233, v146, v147
  v_cvt_pk_bf16_f32 v234, v148, v149
  v_cvt_pk_bf16_f32 v235, v150, v151
  v_cvt_pk_bf16_f32 v236, v152, v153
  v_cvt_pk_bf16_f32 v237, v154, v155
  v_cvt_pk_bf16_f32 v238, v156, v157
  v_cvt_pk_bf16_f32 v239, v158, v159
  s_add_u32 s26, s31, 245368832
  buffer_store_dwordx4 v[232:235], v2, s[8:11], s26 offen sc1
  buffer_store_dwordx4 v[236:239], v2, s[8:11], s26 offen offset:1024 sc1
  v_cndmask_b32 v160, v160, v8, s[32:33]
  v_cndmask_b32 v161, v161, v8, s[32:33]
  v_cndmask_b32 v162, v162, v8, s[32:33]
  v_cndmask_b32 v163, v163, v8, s[32:33]
  v_cndmask_b32 v164, v164, v8, s[32:33]
  v_cndmask_b32 v165, v165, v8, s[32:33]
  v_cndmask_b32 v166, v166, v8, s[32:33]
  v_cndmask_b32 v167, v167, v8, s[32:33]
  v_cndmask_b32 v168, v168, v8, s[32:33]
  v_cndmask_b32 v169, v169, v8, s[32:33]
  v_cndmask_b32 v170, v170, v8, s[32:33]
  v_cndmask_b32 v171, v171, v8, s[32:33]
  v_cndmask_b32 v172, v172, v8, s[32:33]
  v_cndmask_b32 v173, v173, v8, s[32:33]
  v_cndmask_b32 v174, v174, v8, s[32:33]
  v_cndmask_b32 v175, v175, v8, s[32:33]
  v_cvt_pk_bf16_f32 v240, v160, v161
  v_cvt_pk_bf16_f32 v241, v162, v163
  v_cvt_pk_bf16_f32 v242, v164, v165
  v_cvt_pk_bf16_f32 v243, v166, v167
  v_cvt_pk_bf16_f32 v244, v168, v169
  v_cvt_pk_bf16_f32 v245, v170, v171
  v_cvt_pk_bf16_f32 v246, v172, v173
  v_cvt_pk_bf16_f32 v247, v174, v175
  s_add_u32 s26, s31, 249563136
  buffer_store_dwordx4 v[240:243], v2, s[8:11], s26 offen sc1
  buffer_store_dwordx4 v[244:247], v2, s[8:11], s26 offen offset:1024 sc1
  v_mul_f32 v128, s30, v128
  v_mul_f32 v129, s30, v129
  v_mul_f32 v130, s30, v130
  v_mul_f32 v131, s30, v131
  v_mul_f32 v132, s30, v132
  v_mul_f32 v133, s30, v133
  v_mul_f32 v134, s30, v134
  v_mul_f32 v135, s30, v135
  v_mul_f32 v136, s30, v136
  v_mul_f32 v137, s30, v137
  v_mul_f32 v138, s30, v138
  v_mul_f32 v139, s30, v139
  v_mul_f32 v140, s30, v140
  v_mul_f32 v141, s30, v141
  v_mul_f32 v142, s30, v142
  v_mul_f32 v143, s30, v143
  v_cvt_pk_bf16_f32 v200, v128, v129
  v_cvt_pk_bf16_f32 v201, v130, v131
  v_cvt_pk_bf16_f32 v202, v132, v133
  v_cvt_pk_bf16_f32 v203, v134, v135
  v_cvt_pk_bf16_f32 v204, v136, v137
  v_cvt_pk_bf16_f32 v205, v138, v139
  v_cvt_pk_bf16_f32 v206, v140, v141
  v_cvt_pk_bf16_f32 v207, v142, v143
  s_nop 1
  v_max_f32_dpp v10, v9, v9 quad_perm:[1,0,3,2] row_mask:0xf bank_mask:0xf
  s_nop 1
  v_max_f32_dpp v9, v10, v10 quad_perm:[2,3,0,1] row_mask:0xf bank_mask:0xf
  s_nop 1
  v_max_f32_dpp v10, v9, v9 row_half_mirror row_mask:0xf bank_mask:0xf
  s_nop 1
  v_max_f32_dpp v9, v10, v10 row_mirror row_mask:0xf bank_mask:0xf
  v_mov_b32 v10, v9
  s_nop 1
  v_permlane16_swap_b32 v9, v10
  v_max_f32 v9, v9, v10
  v_mov_b32 v10, v9
  s_nop 1
  v_permlane32_swap_b32 v9, v10
  v_max_f32 v9, v9, v10
  s_lshl_b32 s51, s22, 7
  s_add_u32 s51, s51, 0xf600000
  s_lshl_b32 s26, s23, 4
  s_lshl_b32 s29, s21, 2
  s_add_u32 s26, s26, s29
  v_mov_b32 v11, s26
  s_mov_b64 s[40:41], exec
  s_mov_b64 exec, 1
  buffer_store_dword v9, v11, s[8:11], s51 offen sc1
  s_mov_b64 exec, s[40:41]
  s_mov_b32 s52, s24
  s_waitcnt vmcnt(0)
  s_barrier
  s_cmp_eq_u32 s21, 0
  s_cbranch_scc0 arr_106
  s_mov_b64 s[24:25], exec
  s_mov_b64 exec, 1
  v_mov_b32 v3, 0
  v_mov_b32 v4, 1
  buffer_atomic_add v4, v3, s[8:11], s47 offen
  s_mov_b64 exec, s[24:25]
arr_106:
  s_and_b32 s26, s2, 3
  s_mul_i32 s26, s26, 10
  s_mul_i32 s27, s21, 3
  s_cmp_eq_u32 s21, 3
  s_cselect_b32 s27, 8, s27
  s_add_u32 s50, s26, s27
  s_mul_i32 s26, s50, 20480
  s_add_u32 s26, s26, 0xe000000
  s_add_u32 s27, s26, 0
  buffer_load_dwordx4 a[0:3], v2, s[8:11], s27 offen
  s_add_u32 s27, s26, 1024
  buffer_load_dwordx4 a[4:7], v2, s[8:11], s27 offen
  s_add_u32 s27, s26, 2048
  buffer_load_dwordx4 a[8:11], v2, s[8:11], s27 offen
  s_add_u32 s27, s26, 3072
  buffer_load_dwordx4 a[12:15], v2, s[8:11], s27 offen
  s_add_u32 s27, s26, 4096
  buffer_load_dwordx4 a[16:19], v2, s[8:11], s27 offen
  s_add_u32 s27, s26, 5120
  buffer_load_dwordx4 a[20:23], v2, s[8:11], s27 offen
  s_add_u32 s27, s26, 6144
  buffer_load_dwordx4 a[24:27], v2, s[8:11], s27 offen
  s_add_u32 s27, s26, 7168
  buffer_load_dwordx4 a[28:31], v2, s[8:11], s27 offen
  s_add_u32 s27, s26, 8192
  buffer_load_dwordx4 a[32:35], v2, s[8:11], s27 offen
  s_add_u32 s27, s26, 9216
  buffer_load_dwordx4 a[36:39], v2, s[8:11], s27 offen
  s_add_u32 s27, s26, 10240
  buffer_load_dwordx4 a[40:43], v2, s[8:11], s27 offen
  s_add_u32 s27, s26, 11264
  buffer_load_dwordx4 a[44:47], v2, s[8:11], s27 offen
  s_add_u32 s27, s26, 12288
  buffer_load_dwordx4 a[48:51], v2, s[8:11], s27 offen
  s_add_u32 s27, s26, 13312
  buffer_load_dwordx4 a[52:55], v2, s[8:11], s27 offen
  s_add_u32 s27, s26, 14336
  buffer_load_dwordx4 a[56:59], v2, s[8:11], s27 offen
  s_add_u32 s27, s26, 15360
  buffer_load_dwordx4 a[60:63], v2, s[8:11], s27 offen
  s_add_u32 s27, s26, 16384
  buffer_load_dwordx4 a[64:67], v2, s[8:11], s27 offen
  s_add_u32 s27, s26, 17408
  buffer_load_dwordx4 a[68:71], v2, s[8:11], s27 offen
  s_add_u32 s27, s26, 18432
  buffer_load_dwordx4 a[72:75], v2, s[8:11], s27 offen
  s_add_u32 s27, s26, 19456
  buffer_load_dwordx4 a[76:79], v2, s[8:11], s27 offen
  s_add_u32 s27, s26, 20480
  buffer_load_dwordx4 a[80:83], v2, s[8:11], s27 offen
  s_add_u32 s27, s26, 21504
  buffer_load_dwordx4 a[84:87], v2, s[8:11], s27 offen
  s_add_u32 s27, s26, 22528
  buffer_load_dwordx4 a[88:91], v2, s[8:11], s27 offen
  s_add_u32 s27, s26, 23552
  buffer_load_dwordx4 a[92:95], v2, s[8:11], s27 offen
  s_add_u32 s27, s26, 24576
  buffer_load_dwordx4 a[96:99], v2, s[8:11], s27 offen
  s_add_u32 s27, s26, 25600
  buffer_load_dwordx4 a[100:103], v2, s[8:11], s27 offen
  s_add_u32 s27, s26, 26624
  buffer_load_dwordx4 a[104:107], v2, s[8:11], s27 offen
  s_add_u32 s27, s26, 27648
  buffer_load_dwordx4 a[108:111], v2, s[8:11], s27 offen
  s_add_u32 s27, s26, 28672
  buffer_load_dwordx4 a[112:115], v2, s[8:11], s27 offen
  s_add_u32 s27, s26, 29696
  buffer_load_dwordx4 a[116:119], v2, s[8:11], s27 offen
  s_add_u32 s27, s26, 30720
  buffer_load_dwordx4 a[120:123], v2, s[8:11], s27 offen
  s_add_u32 s27, s26, 31744
  buffer_load_dwordx4 a[124:127], v2, s[8:11], s27 offen
  s_add_u32 s27, s26, 32768
  buffer_load_dwordx4 a[128:131], v2, s[8:11], s27 offen
  s_add_u32 s27, s26, 33792
  buffer_load_dwordx4 a[132:135], v2, s[8:11], s27 offen
  s_add_u32 s27, s26, 34816
  buffer_load_dwordx4 a[136:139], v2, s[8:11], s27 offen
  s_add_u32 s27, s26, 35840
  buffer_load_dwordx4 a[140:143], v2, s[8:11], s27 offen
  s_add_u32 s27, s26, 36864
  buffer_load_dwordx4 a[144:147], v2, s[8:11], s27 offen
  s_add_u32 s27, s26, 37888
  buffer_load_dwordx4 a[148:151], v2, s[8:11], s27 offen
  s_add_u32 s27, s26, 38912
  buffer_load_dwordx4 a[152:155], v2, s[8:11], s27 offen
  s_add_u32 s27, s26, 39936
  buffer_load_dwordx4 a[156:159], v2, s[8:11], s27 offen
  s_cmp_lt_u32 s21, 2
  s_cbranch_scc0 g3_107
  s_add_u32 s27, s26, 40960
  buffer_load_dwordx4 a[160:163], v2, s[8:11], s27 offen
  s_add_u32 s27, s26, 41984
  buffer_load_dwordx4 a[164:167], v2, s[8:11], s27 offen
  s_add_u32 s27, s26, 43008
  buffer_load_dwordx4 a[168:171], v2, s[8:11], s27 offen
  s_add_u32 s27, s26, 44032
  buffer_load_dwordx4 a[172:175], v2, s[8:11], s27 offen
  s_add_u32 s27, s26, 45056
  buffer_load_dwordx4 a[176:179], v2, s[8:11], s27 offen
  s_add_u32 s27, s26, 46080
  buffer_load_dwordx4 a[180:183], v2, s[8:11], s27 offen
  s_add_u32 s27, s26, 47104
  buffer_load_dwordx4 a[184:187], v2, s[8:11], s27 offen
  s_add_u32 s27, s26, 48128
  buffer_load_dwordx4 a[188:191], v2, s[8:11], s27 offen
  s_add_u32 s27, s26, 49152
  buffer_load_dwordx4 a[192:195], v2, s[8:11], s27 offen
  s_add_u32 s27, s26, 50176
  buffer_load_dwordx4 a[196:199], v2, s[8:11], s27 offen
  s_add_u32 s27, s26, 51200
  buffer_load_dwordx4 a[200:203], v2, s[8:11], s27 offen
  s_add_u32 s27, s26, 52224
  buffer_load_dwordx4 a[204:207], v2, s[8:11], s27 offen
  s_add_u32 s27, s26, 53248
  buffer_load_dwordx4 a[208:211], v2, s[8:11], s27 offen
  s_add_u32 s27, s26, 54272
  buffer_load_dwordx4 a[212:215], v2, s[8:11], s27 offen
  s_add_u32 s27, s26, 55296
  buffer_load_dwordx4 a[216:219], v2, s[8:11], s27 offen
  s_add_u32 s27, s26, 56320
  buffer_load_dwordx4 a[220:223], v2, s[8:11], s27 offen
  s_add_u32 s27, s26, 57344
  buffer_load_dwordx4 a[224:227], v2, s[8:11], s27 offen
  s_add_u32 s27, s26, 58368
  buffer_load_dwordx4 a[228:231], v2, s[8:11], s27 offen
  s_add_u32 s27, s26, 59392
  buffer_load_dwordx4 a[232:235], v2, s[8:11], s27 offen
  s_add_u32 s27, s26, 60416
  buffer_load_dwordx4 a[236:239], v2, s[8:11], s27 offen
g3_107:
  v_mov_b32 v12, 0
  v_lshlrev_b32 v6, 16, v192
  v_and_b32 v7, 0xffff0000, v192
  v_add_f32_e64 v12, v12, abs(v6)
  v_add_f32_e64 v12, v12, abs(v7)
  v_lshlrev_b32 v6, 16, v193
  v_and_b32 v7, 0xffff0000, v193
  v_add_f32_e64 v12, v12, abs(v6)
  v_add_f32_e64 v12, v12, abs(v7)
  v_lshlrev_b32 v6, 16, v194
  v_and_b32 v7, 0xffff0000, v194
  v_add_f32_e64 v12, v12, abs(v6)
  v_add_f32_e64 v12, v12, abs(v7)
  v_lshlrev_b32 v6, 16, v195
  v_and_b32 v7, 0xffff0000, v195
  v_add_f32_e64 v12, v12, abs(v6)
  v_add_f32_e64 v12, v12, abs(v7)
  v_lshlrev_b32 v6, 16, v196
  v_and_b32 v7, 0xffff0000, v196
  v_add_f32_e64 v12, v12, abs(v6)
  v_add_f32_e64 v12, v12, abs(v7)
  v_lshlrev_b32 v6, 16, v197
  v_and_b32 v7, 0xffff0000, v197
  v_add_f32_e64 v12, v12, abs(v6)
  v_add_f32_e64 v12, v12, abs(v7)
  v_lshlrev_b32 v6, 16, v198
  v_and_b32 v7, 0xffff0000, v198
  v_add_f32_e64 v12, v12, abs(v6)
  v_add_f32_e64 v12, v12, abs(v7)
  v_lshlrev_b32 v6, 16, v199
  v_and_b32 v7, 0xffff0000, v199
  v_add_f32_e64 v12, v12, abs(v6)
  v_add_f32_e64 v12, v12, abs(v7)
  v_mov_b32 v6, v12
  s_nop 1
  v_permlane32_swap_b32 v12, v6
  v_add_f32 v12, v12, v6
  v_mov_b32 v13, 0
  v_lshlrev_b32 v6, 16, v200
  v_and_b32 v7, 0xffff0000, v200
  v_add_f32_e64 v13, v13, abs(v6)
  v_add_f32_e64 v13, v13, abs(v7)
  v_lshlrev_b32 v6, 16, v201
  v_and_b32 v7, 0xffff0000, v201
  v_add_f32_e64 v13, v13, abs(v6)
  v_add_f32_e64 v13, v13, abs(v7)
  v_lshlrev_b32 v6, 16, v202
  v_and_b32 v7, 0xffff0000, v202
  v_add_f32_e64 v13, v13, abs(v6)
  v_add_f32_e64 v13, v13, abs(v7)
  v_lshlrev_b32 v6, 16, v203
  v_and_b32 v7, 0xffff0000, v203
  v_add_f32_e64 v13, v13, abs(v6)
  v_add_f32_e64 v13, v13, abs(v7)
  v_lshlrev_b32 v6, 16, v204
  v_and_b32 v7, 0xffff0000, v204
  v_add_f32_e64 v13, v13, abs(v6)
  v_add_f32_e64 v13, v13, abs(v7)
  v_lshlrev_b32 v6, 16, v205
  v_and_b32 v7, 0xffff0000, v205
  v_add_f32_e64 v13, v13, abs(v6)
  v_add_f32_e64 v13, v13, abs(v7)
  v_lshlrev_b32 v6, 16, v206
  v_and_b32 v7, 0xffff0000, v206
  v_add_f32_e64 v13, v13, abs(v6)
  v_add_f32_e64 v13, v13, abs(v7)
  v_lshlrev_b32 v6, 16, v207
  v_and_b32 v7, 0xffff0000, v207
  v_add_f32_e64 v13, v13, abs(v6)
  v_add_f32_e64 v13, v13, abs(v7)
  v_mov_b32 v6, v13
  s_nop 1
  v_permlane32_swap_b32 v13, v6
  v_add_f32 v13, v13, v6
  s_mov_b32 s45, 0
  v_mov_b32 v3, 0
aw_108:
  buffer_load_dword v4, v3, s[8:11], s47 offen sc1
  s_add_u32 s45, s45, 1
  s_waitcnt vmcnt(0)
  v_readfirstlane_b32 s29, v4
  s_cmp_ge_u32 s29, 8
  s_cbranch_scc1 aw_108_ok
  s_cmp_lt_u32 s45, 400000
  s_cbranch_scc1 aw_108
  s_branch kb2_abort
aw_108_ok:
  v_and_b32 v3, 31, v1
  v_lshlrev_b32 v3, 2, v3
  buffer_load_dword v4, v3, s[8:11], s51 offen sc1
  s_lshl_b32 s25, s22, 6
  s_lshl_b32 s27, s25, 11
  s_add_u32 s28, s27, 0xee00000
  s_add_u32 s27, s27, 0xea00000
  s_mov_b32 s41, 0
  s_mul_i32 s53, s41, 32768
  s_lshl_b32 s31, s21, 13
  s_add_u32 s53, s53, s31
  s_add_u32 m0, s31, 0
  s_add_u32 s29, s53, s27
  s_add_u32 s29, s29, 0
  buffer_load_dwordx4 v2, s[8:11], s29 offen sc1 lds
  s_add_u32 m0, s31, 1024
  s_add_u32 s29, s53, s27
  s_add_u32 s29, s29, 1024
  buffer_load_dwordx4 v2, s[8:11], s29 offen sc1 lds
  s_add_u32 m0, s31, 2048
  s_add_u32 s29, s53, s27
  s_add_u32 s29, s29, 2048
  buffer_load_dwordx4 v2, s[8:11], s29 offen sc1 lds
  s_add_u32 m0, s31, 3072
  s_add_u32 s29, s53, s27
  s_add_u32 s29, s29, 3072
  buffer_load_dwordx4 v2, s[8:11], s29 offen sc1 lds
  s_add_u32 m0, s31, 4096
  s_add_u32 s29, s53, s27
  s_add_u32 s29, s29, 4096
  buffer_load_dwordx4 v2, s[8:11], s29 offen sc1 lds
  s_add_u32 m0, s31, 5120
  s_add_u32 s29, s53, s27
  s_add_u32 s29, s29, 5120
  buffer_load_dwordx4 v2, s[8:11], s29 offen sc1 lds
  s_add_u32 m0, s31, 6144
  s_add_u32 s29, s53, s27
  s_add_u32 s29, s29, 6144
  buffer_load_dwordx4 v2, s[8:11], s29 offen sc1 lds
  s_add_u32 m0, s31, 7168
  s_add_u32 s29, s53, s27
  s_add_u32 s29, s29, 7168
  buffer_load_dwordx4 v2, s[8:11], s29 offen sc1 lds
  s_add_u32 m0, s31, 32768
  s_add_u32 s29, s53, s28
  s_add_u32 s29, s29, 0
  buffer_load_dwordx4 v2, s[8:11], s29 offen sc1 lds
  s_add_u32 m0, s31, 33792
  s_add_u32 s29, s53, s28
  s_add_u32 s29, s29, 1024
  buffer_load_dwordx4 v2, s[8:11], s29 offen sc1 lds
  s_add_u32 m0, s31, 34816
  s_add_u32 s29, s53, s28
  s_add_u32 s29, s29, 2048
  buffer_load_dwordx4 v2, s[8:11], s29 offen sc1 lds
  s_add_u32 m0, s31, 35840
  s_add_u32 s29, s53, s28
  s_add_u32 s29, s29, 3072
  buffer_load_dwordx4 v2, s[8:11], s29 offen sc1 lds
  s_add_u32 m0, s31, 36864
  s_add_u32 s29, s53, s28
  s_add_u32 s29, s29, 4096
  buffer_load_dwordx4 v2, s[8:11], s29 offen sc1 lds
  s_add_u32 m0, s31, 37888
  s_add_u32 s29, s53, s28
  s_add_u32 s29, s29, 5120
  buffer_load_dwordx4 v2, s[8:11], s29 offen sc1 lds
  s_add_u32 m0, s31, 38912
  s_add_u32 s29, s53, s28
  s_add_u32 s29, s29, 6144
  buffer_load_dwordx4 v2, s[8:11], s29 offen sc1 lds
  s_add_u32 m0, s31, 39936
  s_add_u32 s29, s53, s28
  s_add_u32 s29, s29, 7168
  buffer_load_dwordx4 v2, s[8:11], s29 offen sc1 lds
  s_waitcnt vmcnt(16)
  v_max_f32_dpp v5, v4, v4 quad_perm:[1,0,3,2] row_mask:0xf bank_mask:0xf
  s_nop 1
  v_max_f32_dpp v4, v5, v5 quad_perm:[2,3,0,1] row_mask:0xf bank_mask:0xf
  s_nop 1
  v_max_f32_dpp v5, v4, v4 row_half_mirror row_mask:0xf bank_mask:0xf
  s_nop 1
  v_max_f32_dpp v4, v5, v5 row_mirror row_mask:0xf bank_mask:0xf
  v_mov_b32 v5, v4
  s_nop 1
  v_permlane16_swap_b32 v4, v5
  v_max_f32 v4, v4, v5
  v_mul_f32 v12, v12, v4
  v_mul_f32 v12, 0x3f820000, v12
  v_mul_f32 v13, v13, v4
  v_mul_f32 v13, 0x3f820000, v13
  s_mov_b32 s40, 0
kb2_main:
  v_lshrrev_b32 v5, 16, v12
  v_or_b32 v5, 0x8000, v5
  v_and_b32 v6, 0xffff0000, v198
  v_or_b32 v5, v5, v6
  v_cndmask_b32 v198, v198, v5, s[34:35]
  v_lshrrev_b32 v5, 16, v13
  v_or_b32 v5, 0x8000, v5
  v_and_b32 v6, 0xffff0000, v206
  v_or_b32 v5, v5, v6
  v_cndmask_b32 v206, v206, v5, s[34:35]
kb2_main2:
  v_mov_b32 v112, 0
  v_mov_b32 v113, 0
  v_mov_b32 v114, 0
  v_mov_b32 v115, 0
  v_mov_b32 v116, 0
  v_mov_b32 v117, 0
  v_mov_b32 v118, 0
  v_mov_b32 v119, 0
  v_mov_b32 v120, 0
  v_mov_b32 v121, 0
  v_mov_b32 v122, 0
  v_mov_b32 v123, 0
  v_mov_b32 v124, 0
  v_mov_b32 v125, 0
  v_mov_b32 v126, 0
  v_mov_b32 v127, 0
  v_mov_b32 v128, 0
  v_mov_b32 v129, 0
  v_mov_b32 v130, 0
  v_mov_b32 v131, 0
  v_mov_b32 v132, 0
  v_mov_b32 v133, 0
  v_mov_b32 v134, 0
  v_mov_b32 v135, 0
  v_mov_b32 v136, 0
  v_mov_b32 v137, 0
  v_mov_b32 v138, 0
  v_mov_b32 v139, 0
  v_mov_b32 v140, 0
  v_mov_b32 v141, 0
  v_mov_b32 v142, 0
  v_mov_b32 v143, 0
  v_mov_b32 v3, v2
  v_add_u32 v4, 65536, v2
kb2_chunk2:
  s_waitcnt vmcnt(0)
  s_barrier
  s_add_u32 s41, s41, 1
  s_min_u32 s29, s41, 3
  s_mul_i32 s53, s29, 32768
  s_lshl_b32 s31, s21, 13
  s_add_u32 s53, s53, s31
  ds_read_b128 v[32:35], v3 offset:0
  ds_read_b128 v[36:39], v3 offset:1024
  ds_read_b128 v[48:51], v3 offset:32768
  ds_read_b128 v[52:55], v3 offset:33792
  ds_read_b128 v[40:43], v3 offset:2048
  ds_read_b128 v[44:47], v3 offset:3072
  s_waitcnt lgkmcnt(4)
  v_mfma_f32_32x32x16_bf16 v[64:79], v[32:35], v[192:195], 0
  v_mfma_f32_32x32x16_bf16 v[64:79], v[36:39], v[196:199], v[64:79]
  s_nop 11
  v_exp_f32 v64, v64
  v_exp_f32 v65, v65
  v_exp_f32 v66, v66
  v_exp_f32 v67, v67
  v_cvt_pk_bf16_f32 v96, v64, v65
  v_exp_f32 v68, v68
  v_exp_f32 v69, v69
  v_cvt_pk_bf16_f32 v97, v66, v67
  v_exp_f32 v70, v70
  v_mfma_f32_32x32x16_bf16 v[80:95], v[32:35], v[200:203], 0
  v_exp_f32 v71, v71
  v_cvt_pk_bf16_f32 v98, v68, v69
  v_exp_f32 v72, v72
  v_exp_f32 v73, v73
  v_cvt_pk_bf16_f32 v99, v70, v71
  v_mfma_f32_32x32x16_bf16 v[80:95], v[36:39], v[204:207], v[80:95]
  v_exp_f32 v74, v74
  v_exp_f32 v75, v75
  ds_read_b128 v[56:59], v3 offset:34816
  v_cvt_pk_bf16_f32 v100, v72, v73
  v_exp_f32 v76, v76
  v_exp_f32 v77, v77
  ds_read_b128 v[60:63], v3 offset:35840
  v_cvt_pk_bf16_f32 v101, v74, v75
  v_exp_f32 v78, v78
  s_add_u32 m0, s31, 65536
  s_add_u32 s29, s53, s27
  s_add_u32 s29, s29, 0
  buffer_load_dwordx4 v2, s[8:11], s29 offen sc1 lds
  v_exp_f32 v79, v79
  v_cvt_pk_bf16_f32 v102, v76, v77
  v_cvt_pk_bf16_f32 v103, v78, v79
  s_waitcnt lgkmcnt(4)
  v_mfma_f32_32x32x16_bf16 v[112:127], v[48:51], v[96:99], v[112:127]
  v_exp_f32 v80, v80
  v_exp_f32 v81, v81
  v_exp_f32 v82, v82
  v_exp_f32 v83, v83
  v_mfma_f32_32x32x16_bf16 v[112:127], v[52:55], v[100:103], v[112:127]
  v_cvt_pk_bf16_f32 v104, v80, v81
  v_exp_f32 v84, v84
  v_exp_f32 v85, v85
  v_cvt_pk_bf16_f32 v105, v82, v83
  v_exp_f32 v86, v86
  s_waitcnt lgkmcnt(2)
  v_mfma_f32_32x32x16_bf16 v[64:79], v[40:43], v[192:195], 0
  v_exp_f32 v87, v87
  v_cvt_pk_bf16_f32 v106, v84, v85
  v_exp_f32 v88, v88
  v_exp_f32 v89, v89
  v_cvt_pk_bf16_f32 v107, v86, v87
  v_mfma_f32_32x32x16_bf16 v[64:79], v[44:47], v[196:199], v[64:79]
  v_exp_f32 v90, v90
  v_exp_f32 v91, v91
  ds_read_b128 v[32:35], v3 offset:4096
  v_cvt_pk_bf16_f32 v108, v88, v89
  v_exp_f32 v92, v92
  v_exp_f32 v93, v93
  ds_read_b128 v[36:39], v3 offset:5120
  v_cvt_pk_bf16_f32 v109, v90, v91
  v_exp_f32 v94, v94
  v_exp_f32 v95, v95
  v_cvt_pk_bf16_f32 v110, v92, v93
  v_cvt_pk_bf16_f32 v111, v94, v95
  v_mfma_f32_32x32x16_bf16 v[128:143], v[48:51], v[104:107], v[128:143]
  v_exp_f32 v64, v64
  v_exp_f32 v65, v65
  v_exp_f32 v66, v66
  v_exp_f32 v67, v67
  v_mfma_f32_32x32x16_bf16 v[128:143], v[52:55], v[108:111], v[128:143]
  v_cvt_pk_bf16_f32 v96, v64, v65
  v_exp_f32 v68, v68
  v_exp_f32 v69, v69
  v_cvt_pk_bf16_f32 v97, v66, v67
  v_exp_f32 v70, v70
  v_mfma_f32_32x32x16_bf16 v[80:95], v[40:43], v[200:203], 0
  v_exp_f32 v71, v71
  v_cvt_pk_bf16_f32 v98, v68, v69
  v_exp_f32 v72, v72
  v_exp_f32 v73, v73
  v_cvt_pk_bf16_f32 v99, v70, v71
  v_mfma_f32_32x32x16_bf16 v[80:95], v[44:47], v[204:207], v[80:95]
  v_exp_f32 v74, v74
  v_exp_f32 v75, v75
  ds_read_b128 v[48:51], v3 offset:36864
  v_cvt_pk_bf16_f32 v100, v72, v73
  v_exp_f32 v76, v76
  v_exp_f32 v77, v77
  ds_read_b128 v[52:55], v3 offset:37888
  v_cvt_pk_bf16_f32 v101, v74, v75
  v_exp_f32 v78, v78
  s_add_u32 m0, s31, 66560
  s_add_u32 s29, s53, s27
  s_add_u32 s29, s29, 1024
  buffer_load_dwordx4 v2, s[8:11], s29 offen sc1 lds
  v_exp_f32 v79, v79
  v_cvt_pk_bf16_f32 v102, v76, v77
  v_cvt_pk_bf16_f32 v103, v78, v79
  s_waitcnt lgkmcnt(4)
  v_mfma_f32_32x32x16_bf16 v[112:127], v[56:59], v[96:99], v[112:127]
  v_exp_f32 v80, v80
  v_exp_f32 v81, v81
  v_exp_f32 v82, v82
  v_exp_f32 v83, v83
  v_mfma_f32_32x32x16_bf16 v[112:127], v[60:63], v[100:103], v[112:127]
  v_cvt_pk_bf16_f32 v104, v80, v81
  v_exp_f32 v84, v84
  v_exp_f32 v85, v85
  v_cvt_pk_bf16_f32 v105, v82, v83
  v_exp_f32 v86, v86
  s_waitcnt lgkmcnt(2)
  v_mfma_f32_32x32x16_bf16 v[64:79], v[32:35], v[192:195], 0
  v_exp_f32 v87, v87
  v_cvt_pk_bf16_f32 v106, v84, v85
  v_exp_f32 v88, v88
  v_exp_f32 v89, v89
  v_cvt_pk_bf16_f32 v107, v86, v87
  v_mfma_f32_32x32x16_bf16 v[64:79], v[36:39], v[196:199], v[64:79]
  v_exp_f32 v90, v90
  v_exp_f32 v91, v91
  ds_read_b128 v[40:43], v3 offset:6144
  v_cvt_pk_bf16_f32 v108, v88, v89
  v_exp_f32 v92, v92
  v_exp_f32 v93, v93
  ds_read_b128 v[44:47], v3 offset:7168
  v_cvt_pk_bf16_f32 v109, v90, v91
  v_exp_f32 v94, v94
  v_exp_f32 v95, v95
  v_cvt_pk_bf16_f32 v110, v92, v93
  v_cvt_pk_bf16_f32 v111, v94, v95
  v_mfma_f32_32x32x16_bf16 v[128:143], v[56:59], v[104:107], v[128:143]
  v_exp_f32 v64, v64
  v_exp_f32 v65, v65
  v_exp_f32 v66, v66
  v_exp_f32 v67, v67
  v_mfma_f32_32x32x16_bf16 v[128:143], v[60:63], v[108:111], v[128:143]
  v_cvt_pk_bf16_f32 v96, v64, v65
  v_exp_f32 v68, v68
  v_exp_f32 v69, v69
  v_cvt_pk_bf16_f32 v97, v66, v67
  v_exp_f32 v70, v70
  v_mfma_f32_32x32x16_bf16 v[80:95], v[32:35], v[200:203], 0
  v_exp_f32 v71, v71
  v_cvt_pk_bf16_f32 v98, v68, v69
  v_exp_f32 v72, v72
  v_exp_f32 v73, v73
  v_cvt_pk_bf16_f32 v99, v70, v71
  v_mfma_f32_32x32x16_bf16 v[80:95], v[36:39], v[204:207], v[80:95]
  v_exp_f32 v74, v74
  v_exp_f32 v75, v75
  ds_read_b128 v[56:59], v3 offset:38912
  v_cvt_pk_bf16_f32 v100, v72, v73
  v_exp_f32 v76, v76
  v_exp_f32 v77, v77
  ds_read_b128 v[60:63], v3 offset:39936
  v_cvt_pk_bf16_f32 v101, v74, v75
  v_exp_f32 v78, v78
  s_add_u32 m0, s31, 67584
  s_add_u32 s29, s53, s27
  s_add_u32 s29, s29, 2048
  buffer_load_dwordx4 v2, s[8:11], s29 offen sc1 lds
  v_exp_f32 v79, v79
  v_cvt_pk_bf16_f32 v102, v76, v77
  v_cvt_pk_bf16_f32 v103, v78, v79
  s_waitcnt lgkmcnt(4)
  v_mfma_f32_32x32x16_bf16 v[112:127], v[48:51], v[96:99], v[112:127]
  v_exp_f32 v80, v80
  v_exp_f32 v81, v81
  v_exp_f32 v82, v82
  v_exp_f32 v83, v83
  v_mfma_f32_32x32x16_bf16 v[112:127], v[52:55], v[100:103], v[112:127]
  v_cvt_pk_bf16_f32 v104, v80, v81
  v_exp_f32 v84, v84
  v_exp_f32 v85, v85
  v_cvt_pk_bf16_f32 v105, v82, v83
  v_exp_f32 v86, v86
  s_waitcnt lgkmcnt(2)
  v_mfma_f32_32x32x16_bf16 v[64:79], v[40:43], v[192:195], 0
  v_exp_f32 v87, v87
  v_cvt_pk_bf16_f32 v106, v84, v85
  v_exp_f32 v88, v88
  v_exp_f32 v89, v89
  v_cvt_pk_bf16_f32 v107, v86, v87
  v_mfma_f32_32x32x16_bf16 v[64:79], v[44:47], v[196:199], v[64:79]
  v_exp_f32 v90, v90
  v_exp_f32 v91, v91
  ds_read_b128 v[32:35], v3 offset:8192
  v_cvt_pk_bf16_f32 v108, v88, v89
  v_exp_f32 v92, v92
  v_exp_f32 v93, v93
  ds_read_b128 v[36:39], v3 offset:9216
  v_cvt_pk_bf16_f32 v109, v90, v91
  v_exp_f32 v94, v94
  v_exp_f32 v95, v95
  v_cvt_pk_bf16_f32 v110, v92, v93
  v_cvt_pk_bf16_f32 v111, v94, v95
  v_mfma_f32_32x32x16_bf16 v[128:143], v[48:51], v[104:107], v[128:143]
  v_exp_f32 v64, v64
  v_exp_f32 v65, v65
  v_exp_f32 v66, v66
  v_exp_f32 v67, v67
  v_mfma_f32_32x32x16_bf16 v[128:143], v[52:55], v[108:111], v[128:143]
  v_cvt_pk_bf16_f32 v96, v64, v65
  v_exp_f32 v68, v68
  v_exp_f32 v69, v69
  v_cvt_pk_bf16_f32 v97, v66, v67
  v_exp_f32 v70, v70
  v_mfma_f32_32x32x16_bf16 v[80:95], v[40:43], v[200:203], 0
  v_exp_f32 v71, v71
  v_cvt_pk_bf16_f32 v98, v68, v69
  v_exp_f32 v72, v72
  v_exp_f32 v73, v73
  v_cvt_pk_bf16_f32 v99, v70, v71
  v_mfma_f32_32x32x16_bf16 v[80:95], v[44:47], v[204:207], v[80:95]
  v_exp_f32 v74, v74
  v_exp_f32 v75, v75
  ds_read_b128 v[48:51], v3 offset:40960
  v_cvt_pk_bf16_f32 v100, v72, v73
  v_exp_f32 v76, v76
  v_exp_f32 v77, v77
  ds_read_b128 v[52:55], v3 offset:41984
  v_cvt_pk_bf16_f32 v101, v74, v75
  v_exp_f32 v78, v78
  s_add_u32 m0, s31, 68608
  s_add_u32 s29, s53, s27
  s_add_u32 s29, s29, 3072
  buffer_load_dwordx4 v2, s[8:11], s29 offen sc1 lds
  v_exp_f32 v79, v79
  v_cvt_pk_bf16_f32 v102, v76, v77
  v_cvt_pk_bf16_f32 v103, v78, v79
  s_waitcnt lgkmcnt(4)
  v_mfma_f32_32x32x16_bf16 v[112:127], v[56:59], v[96:99], v[112:127]
  v_exp_f32 v80, v80
  v_exp_f32 v81, v81
  v_exp_f32 v82, v82
  v_exp_f32 v83, v83
  v_mfma_f32_32x32x16_bf16 v[112:127], v[60:63], v[100:103], v[112:127]
  v_cvt_pk_bf16_f32 v104, v80, v81
  v_exp_f32 v84, v84
  v_exp_f32 v85, v85
  v_cvt_pk_bf16_f32 v105, v82, v83
  v_exp_f32 v86, v86
  s_waitcnt lgkmcnt(2)
  v_mfma_f32_32x32x16_bf16 v[64:79], v[32:35], v[192:195], 0
  v_exp_f32 v87, v87
  v_cvt_pk_bf16_f32 v106, v84, v85
  v_exp_f32 v88, v88
  v_exp_f32 v89, v89
  v_cvt_pk_bf16_f32 v107, v86, v87
  v_mfma_f32_32x32x16_bf16 v[64:79], v[36:39], v[196:199], v[64:79]
  v_exp_f32 v90, v90
  v_exp_f32 v91, v91
  ds_read_b128 v[40:43], v3 offset:10240
  v_cvt_pk_bf16_f32 v108, v88, v89
  v_exp_f32 v92, v92
  v_exp_f32 v93, v93
  ds_read_b128 v[44:47], v3 offset:11264
  v_cvt_pk_bf16_f32 v109, v90, v91
  v_exp_f32 v94, v94
  v_exp_f32 v95, v95
  v_cvt_pk_bf16_f32 v110, v92, v93
  v_cvt_pk_bf16_f32 v111, v94, v95
  v_mfma_f32_32x32x16_bf16 v[128:143], v[56:59], v[104:107], v[128:143]
  v_exp_f32 v64, v64
  v_exp_f32 v65, v65
  v_exp_f32 v66, v66
  v_exp_f32 v67, v67
  v_mfma_f32_32x32x16_bf16 v[128:143], v[60:63], v[108:111], v[128:143]
  v_cvt_pk_bf16_f32 v96, v64, v65
  v_exp_f32 v68, v68
  v_exp_f32 v69, v69
  v_cvt_pk_bf16_f32 v97, v66, v67
  v_exp_f32 v70, v70
  v_mfma_f32_32x32x16_bf16 v[80:95], v[32:35], v[200:203], 0
  v_exp_f32 v71, v71
  v_cvt_pk_bf16_f32 v98, v68, v69
  v_exp_f32 v72, v72
  v_exp_f32 v73, v73
  v_cvt_pk_bf16_f32 v99, v70, v71
  v_mfma_f32_32x32x16_bf16 v[80:95], v[36:39], v[204:207], v[80:95]
  v_exp_f32 v74, v74
  v_exp_f32 v75, v75
  ds_read_b128 v[56:59], v3 offset:43008
  v_cvt_pk_bf16_f32 v100, v72, v73
  v_exp_f32 v76, v76
  v_exp_f32 v77, v77
  ds_read_b128 v[60:63], v3 offset:44032
  v_cvt_pk_bf16_f32 v101, v74, v75
  v_exp_f32 v78, v78
  s_add_u32 m0, s31, 69632
  s_add_u32 s29, s53, s27
  s_add_u32 s29, s29, 4096
  buffer_load_dwordx4 v2, s[8:11], s29 offen sc1 lds
  v_exp_f32 v79, v79
  v_cvt_pk_bf16_f32 v102, v76, v77
  v_cvt_pk_bf16_f32 v103, v78, v79
  s_waitcnt lgkmcnt(4)
  v_mfma_f32_32x32x16_bf16 v[112:127], v[48:51], v[96:99], v[112:127]
  v_exp_f32 v80, v80
  v_exp_f32 v81, v81
  v_exp_f32 v82, v82
  v_exp_f32 v83, v83
  v_mfma_f32_32x32x16_bf16 v[112:127], v[52:55], v[100:103], v[112:127]
  v_cvt_pk_bf16_f32 v104, v80, v81
  v_exp_f32 v84, v84
  v_exp_f32 v85, v85
  v_cvt_pk_bf16_f32 v105, v82, v83
  v_exp_f32 v86, v86
  s_waitcnt lgkmcnt(2)
  v_mfma_f32_32x32x16_bf16 v[64:79], v[40:43], v[192:195], 0
  v_exp_f32 v87, v87
  v_cvt_pk_bf16_f32 v106, v84, v85
  v_exp_f32 v88, v88
  v_exp_f32 v89, v89
  v_cvt_pk_bf16_f32 v107, v86, v87
  v_mfma_f32_32x32x16_bf16 v[64:79], v[44:47], v[196:199], v[64:79]
  v_exp_f32 v90, v90
  v_exp_f32 v91, v91
  ds_read_b128 v[32:35], v3 offset:12288
  v_cvt_pk_bf16_f32 v108, v88, v89
  v_exp_f32 v92, v92
  v_exp_f32 v93, v93
  ds_read_b128 v[36:39], v3 offset:13312
  v_cvt_pk_bf16_f32 v109, v90, v91
  v_exp_f32 v94, v94
  v_exp_f32 v95, v95
  v_cvt_pk_bf16_f32 v110, v92, v93
  v_cvt_pk_bf16_f32 v111, v94, v95
  v_mfma_f32_32x32x16_bf16 v[128:143], v[48:51], v[104:107], v[128:143]
  v_exp_f32 v64, v64
  v_exp_f32 v65, v65
  v_exp_f32 v66, v66
  v_exp_f32 v67, v67
  v_mfma_f32_32x32x16_bf16 v[128:143], v[52:55], v[108:111], v[128:143]
  v_cvt_pk_bf16_f32 v96, v64, v65
  v_exp_f32 v68, v68
  v_exp_f32 v69, v69
  v_cvt_pk_bf16_f32 v97, v66, v67
  v_exp_f32 v70, v70
  v_mfma_f32_32x32x16_bf16 v[80:95], v[40:43], v[200:203], 0
  v_exp_f32 v71, v71
  v_cvt_pk_bf16_f32 v98, v68, v69
  v_exp_f32 v72, v72
  v_exp_f32 v73, v73
  v_cvt_pk_bf16_f32 v99, v70, v71
  v_mfma_f32_32x32x16_bf16 v[80:95], v[44:47], v[204:207], v[80:95]
  v_exp_f32 v74, v74
  v_exp_f32 v75, v75
  ds_read_b128 v[48:51], v3 offset:45056
  v_cvt_pk_bf16_f32 v100, v72, v73
  v_exp_f32 v76, v76
  v_exp_f32 v77, v77
  ds_read_b128 v[52:55], v3 offset:46080
  v_cvt_pk_bf16_f32 v101, v74, v75
  v_exp_f32 v78, v78
  s_add_u32 m0, s31, 70656
  s_add_u32 s29, s53, s27
  s_add_u32 s29, s29, 5120
  buffer_load_dwordx4 v2, s[8:11], s29 offen sc1 lds
  v_exp_f32 v79, v79
  v_cvt_pk_bf16_f32 v102, v76, v77
  v_cvt_pk_bf16_f32 v103, v78, v79
  s_waitcnt lgkmcnt(4)
  v_mfma_f32_32x32x16_bf16 v[112:127], v[56:59], v[96:99], v[112:127]
  v_exp_f32 v80, v80
  v_exp_f32 v81, v81
  v_exp_f32 v82, v82
  v_exp_f32 v83, v83
  v_mfma_f32_32x32x16_bf16 v[112:127], v[60:63], v[100:103], v[112:127]
  v_cvt_pk_bf16_f32 v104, v80, v81
  v_exp_f32 v84, v84
  v_exp_f32 v85, v85
  v_cvt_pk_bf16_f32 v105, v82, v83
  v_exp_f32 v86, v86
  s_waitcnt lgkmcnt(2)
  v_mfma_f32_32x32x16_bf16 v[64:79], v[32:35], v[192:195], 0
  v_exp_f32 v87, v87
  v_cvt_pk_bf16_f32 v106, v84, v85
  v_exp_f32 v88, v88
  v_exp_f32 v89, v89
  v_cvt_pk_bf16_f32 v107, v86, v87
  v_mfma_f32_32x32x16_bf16 v[64:79], v[36:39], v[196:199], v[64:79]
  v_exp_f32 v90, v90
  v_exp_f32 v91, v91
  ds_read_b128 v[40:43], v3 offset:14336
  v_cvt_pk_bf16_f32 v108, v88, v89
  v_exp_f32 v92, v92
  v_exp_f32 v93, v93
  ds_read_b128 v[44:47], v3 offset:15360
  v_cvt_pk_bf16_f32 v109, v90, v91
  v_exp_f32 v94, v94
  v_exp_f32 v95, v95
  v_cvt_pk_bf16_f32 v110, v92, v93
  v_cvt_pk_bf16_f32 v111, v94, v95
  v_mfma_f32_32x32x16_bf16 v[128:143], v[56:59], v[104:107], v[128:143]
  v_exp_f32 v64, v64
  v_exp_f32 v65, v65
  v_exp_f32 v66, v66
  v_exp_f32 v67, v67
  v_mfma_f32_32x32x16_bf16 v[128:143], v[60:63], v[108:111], v[128:143]
  v_cvt_pk_bf16_f32 v96, v64, v65
  v_exp_f32 v68, v68
  v_exp_f32 v69, v69
  v_cvt_pk_bf16_f32 v97, v66, v67
  v_exp_f32 v70, v70
  v_mfma_f32_32x32x16_bf16 v[80:95], v[32:35], v[200:203], 0
  v_exp_f32 v71, v71
  v_cvt_pk_bf16_f32 v98, v68, v69
  v_exp_f32 v72, v72
  v_exp_f32 v73, v73
  v_cvt_pk_bf16_f32 v99, v70, v71
  v_mfma_f32_32x32x16_bf16 v[80:95], v[36:39], v[204:207], v[80:95]
  v_exp_f32 v74, v74
  v_exp_f32 v75, v75
  ds_read_b128 v[56:59], v3 offset:47104
  v_cvt_pk_bf16_f32 v100, v72, v73
  v_exp_f32 v76, v76
  v_exp_f32 v77, v77
  ds_read_b128 v[60:63], v3 offset:48128
  v_cvt_pk_bf16_f32 v101, v74, v75
  v_exp_f32 v78, v78
  s_add_u32 m0, s31, 71680
  s_add_u32 s29, s53, s27
  s_add_u32 s29, s29, 6144
  buffer_load_dwordx4 v2, s[8:11], s29 offen sc1 lds
  v_exp_f32 v79, v79
  v_cvt_pk_bf16_f32 v102, v76, v77
  v_cvt_pk_bf16_f32 v103, v78, v79
  s_waitcnt lgkmcnt(4)
  v_mfma_f32_32x32x16_bf16 v[112:127], v[48:51], v[96:99], v[112:127]
  v_exp_f32 v80, v80
  v_exp_f32 v81, v81
  v_exp_f32 v82, v82
  v_exp_f32 v83, v83
  v_mfma_f32_32x32x16_bf16 v[112:127], v[52:55], v[100:103], v[112:127]
  v_cvt_pk_bf16_f32 v104, v80, v81
  v_exp_f32 v84, v84
  v_exp_f32 v85, v85
  v_cvt_pk_bf16_f32 v105, v82, v83
  v_exp_f32 v86, v86
  s_waitcnt lgkmcnt(2)
  v_mfma_f32_32x32x16_bf16 v[64:79], v[40:43], v[192:195], 0
  v_exp_f32 v87, v87
  v_cvt_pk_bf16_f32 v106, v84, v85
  v_exp_f32 v88, v88
  v_exp_f32 v89, v89
  v_cvt_pk_bf16_f32 v107, v86, v87
  v_mfma_f32_32x32x16_bf16 v[64:79], v[44:47], v[196:199], v[64:79]
  v_exp_f32 v90, v90
  v_exp_f32 v91, v91
  ds_read_b128 v[32:35], v3 offset:16384
  v_cvt_pk_bf16_f32 v108, v88, v89
  v_exp_f32 v92, v92
  v_exp_f32 v93, v93
  ds_read_b128 v[36:39], v3 offset:17408
  v_cvt_pk_bf16_f32 v109, v90, v91
  v_exp_f32 v94, v94
  v_exp_f32 v95, v95
  v_cvt_pk_bf16_f32 v110, v92, v93
  v_cvt_pk_bf16_f32 v111, v94, v95
  v_mfma_f32_32x32x16_bf16 v[128:143], v[48:51], v[104:107], v[128:143]
  v_exp_f32 v64, v64
  v_exp_f32 v65, v65
  v_exp_f32 v66, v66
  v_exp_f32 v67, v67
  v_mfma_f32_32x32x16_bf16 v[128:143], v[52:55], v[108:111], v[128:143]
  v_cvt_pk_bf16_f32 v96, v64, v65
  v_exp_f32 v68, v68
  v_exp_f32 v69, v69
  v_cvt_pk_bf16_f32 v97, v66, v67
  v_exp_f32 v70, v70
  v_mfma_f32_32x32x16_bf16 v[80:95], v[40:43], v[200:203], 0
  v_exp_f32 v71, v71
  v_cvt_pk_bf16_f32 v98, v68, v69
  v_exp_f32 v72, v72
  v_exp_f32 v73, v73
  v_cvt_pk_bf16_f32 v99, v70, v71
  v_mfma_f32_32x32x16_bf16 v[80:95], v[44:47], v[204:207], v[80:95]
  v_exp_f32 v74, v74
  v_exp_f32 v75, v75
  ds_read_b128 v[48:51], v3 offset:49152
  v_cvt_pk_bf16_f32 v100, v72, v73
  v_exp_f32 v76, v76
  v_exp_f32 v77, v77
  ds_read_b128 v[52:55], v3 offset:50176
  v_cvt_pk_bf16_f32 v101, v74, v75
  v_exp_f32 v78, v78
  s_add_u32 m0, s31, 72704
  s_add_u32 s29, s53, s27
  s_add_u32 s29, s29, 7168
  buffer_load_dwordx4 v2, s[8:11], s29 offen sc1 lds
  v_exp_f32 v79, v79
  v_cvt_pk_bf16_f32 v102, v76, v77
  v_cvt_pk_bf16_f32 v103, v78, v79
  s_waitcnt lgkmcnt(4)
  v_mfma_f32_32x32x16_bf16 v[112:127], v[56:59], v[96:99], v[112:127]
  v_exp_f32 v80, v80
  v_exp_f32 v81, v81
  v_exp_f32 v82, v82
  v_exp_f32 v83, v83
  v_mfma_f32_32x32x16_bf16 v[112:127], v[60:63], v[100:103], v[112:127]
  v_cvt_pk_bf16_f32 v104, v80, v81
  v_exp_f32 v84, v84
  v_exp_f32 v85, v85
  v_cvt_pk_bf16_f32 v105, v82, v83
  v_exp_f32 v86, v86
  s_waitcnt lgkmcnt(2)
  v_mfma_f32_32x32x16_bf16 v[64:79], v[32:35], v[192:195], 0
  v_exp_f32 v87, v87
  v_cvt_pk_bf16_f32 v106, v84, v85
  v_exp_f32 v88, v88
  v_exp_f32 v89, v89
  v_cvt_pk_bf16_f32 v107, v86, v87
  v_mfma_f32_32x32x16_bf16 v[64:79], v[36:39], v[196:199], v[64:79]
  v_exp_f32 v90, v90
  v_exp_f32 v91, v91
  ds_read_b128 v[40:43], v3 offset:18432
  v_cvt_pk_bf16_f32 v108, v88, v89
  v_exp_f32 v92, v92
  v_exp_f32 v93, v93
  ds_read_b128 v[44:47], v3 offset:19456
  v_cvt_pk_bf16_f32 v109, v90, v91
  v_exp_f32 v94, v94
  v_exp_f32 v95, v95
  v_cvt_pk_bf16_f32 v110, v92, v93
  v_cvt_pk_bf16_f32 v111, v94, v95
  v_mfma_f32_32x32x16_bf16 v[128:143], v[56:59], v[104:107], v[128:143]
  v_exp_f32 v64, v64
  v_exp_f32 v65, v65
  v_exp_f32 v66, v66
  v_exp_f32 v67, v67
  v_mfma_f32_32x32x16_bf16 v[128:143], v[60:63], v[108:111], v[128:143]
  v_cvt_pk_bf16_f32 v96, v64, v65
  v_exp_f32 v68, v68
  v_exp_f32 v69, v69
  v_cvt_pk_bf16_f32 v97, v66, v67
  v_exp_f32 v70, v70
  v_mfma_f32_32x32x16_bf16 v[80:95], v[32:35], v[200:203], 0
  v_exp_f32 v71, v71
  v_cvt_pk_bf16_f32 v98, v68, v69
  v_exp_f32 v72, v72
  v_exp_f32 v73, v73
  v_cvt_pk_bf16_f32 v99, v70, v71
  v_mfma_f32_32x32x16_bf16 v[80:95], v[36:39], v[204:207], v[80:95]
  v_exp_f32 v74, v74
  v_exp_f32 v75, v75
  ds_read_b128 v[56:59], v3 offset:51200
  v_cvt_pk_bf16_f32 v100, v72, v73
  v_exp_f32 v76, v76
  v_exp_f32 v77, v77
  ds_read_b128 v[60:63], v3 offset:52224
  v_cvt_pk_bf16_f32 v101, v74, v75
  v_exp_f32 v78, v78
  s_add_u32 m0, s31, 98304
  s_add_u32 s29, s53, s28
  s_add_u32 s29, s29, 0
  buffer_load_dwordx4 v2, s[8:11], s29 offen sc1 lds
  v_exp_f32 v79, v79
  v_cvt_pk_bf16_f32 v102, v76, v77
  v_cvt_pk_bf16_f32 v103, v78, v79
  s_waitcnt lgkmcnt(4)
  v_mfma_f32_32x32x16_bf16 v[112:127], v[48:51], v[96:99], v[112:127]
  v_exp_f32 v80, v80
  v_exp_f32 v81, v81
  v_exp_f32 v82, v82
  v_exp_f32 v83, v83
  v_mfma_f32_32x32x16_bf16 v[112:127], v[52:55], v[100:103], v[112:127]
  v_cvt_pk_bf16_f32 v104, v80, v81
  v_exp_f32 v84, v84
  v_exp_f32 v85, v85
  v_cvt_pk_bf16_f32 v105, v82, v83
  v_exp_f32 v86, v86
  s_waitcnt lgkmcnt(2)
  v_mfma_f32_32x32x16_bf16 v[64:79], v[40:43], v[192:195], 0
  v_exp_f32 v87, v87
  v_cvt_pk_bf16_f32 v106, v84, v85
  v_exp_f32 v88, v88
  v_exp_f32 v89, v89
  v_cvt_pk_bf16_f32 v107, v86, v87
  v_mfma_f32_32x32x16_bf16 v[64:79], v[44:47], v[196:199], v[64:79]
  v_exp_f32 v90, v90
  v_exp_f32 v91, v91
  ds_read_b128 v[32:35], v3 offset:20480
  v_cvt_pk_bf16_f32 v108, v88, v89
  v_exp_f32 v92, v92
  v_exp_f32 v93, v93
  ds_read_b128 v[36:39], v3 offset:21504
  v_cvt_pk_bf16_f32 v109, v90, v91
  v_exp_f32 v94, v94
  v_exp_f32 v95, v95
  v_cvt_pk_bf16_f32 v110, v92, v93
  v_cvt_pk_bf16_f32 v111, v94, v95
  v_mfma_f32_32x32x16_bf16 v[128:143], v[48:51], v[104:107], v[128:143]
  v_exp_f32 v64, v64
  v_exp_f32 v65, v65
  v_exp_f32 v66, v66
  v_exp_f32 v67, v67
  v_mfma_f32_32x32x16_bf16 v[128:143], v[52:55], v[108:111], v[128:143]
  v_cvt_pk_bf16_f32 v96, v64, v65
  v_exp_f32 v68, v68
  v_exp_f32 v69, v69
  v_cvt_pk_bf16_f32 v97, v66, v67
  v_exp_f32 v70, v70
  v_mfma_f32_32x32x16_bf16 v[80:95], v[40:43], v[200:203], 0
  v_exp_f32 v71, v71
  v_cvt_pk_bf16_f32 v98, v68, v69
  v_exp_f32 v72, v72
  v_exp_f32 v73, v73
  v_cvt_pk_bf16_f32 v99, v70, v71
  v_mfma_f32_32x32x16_bf16 v[80:95], v[44:47], v[204:207], v[80:95]
  v_exp_f32 v74, v74
  v_exp_f32 v75, v75
  ds_read_b128 v[48:51], v3 offset:53248
  v_cvt_pk_bf16_f32 v100, v72, v73
  v_exp_f32 v76, v76
  v_exp_f32 v77, v77
  ds_read_b128 v[52:55], v3 offset:54272
  v_cvt_pk_bf16_f32 v101, v74, v75
  v_exp_f32 v78, v78
  s_add_u32 m0, s31, 99328
  s_add_u32 s29, s53, s28
  s_add_u32 s29, s29, 1024
  buffer_load_dwordx4 v2, s[8:11], s29 offen sc1 lds
  v_exp_f32 v79, v79
  v_cvt_pk_bf16_f32 v102, v76, v77
  v_cvt_pk_bf16_f32 v103, v78, v79
  s_waitcnt lgkmcnt(4)
  v_mfma_f32_32x32x16_bf16 v[112:127], v[56:59], v[96:99], v[112:127]
  v_exp_f32 v80, v80
  v_exp_f32 v81, v81
  v_exp_f32 v82, v82
  v_exp_f32 v83, v83
  v_mfma_f32_32x32x16_bf16 v[112:127], v[60:63], v[100:103], v[112:127]
  v_cvt_pk_bf16_f32 v104, v80, v81
  v_exp_f32 v84, v84
  v_exp_f32 v85, v85
  v_cvt_pk_bf16_f32 v105, v82, v83
  v_exp_f32 v86, v86
  s_waitcnt lgkmcnt(2)
  v_mfma_f32_32x32x16_bf16 v[64:79], v[32:35], v[192:195], 0
  v_exp_f32 v87, v87
  v_cvt_pk_bf16_f32 v106, v84, v85
  v_exp_f32 v88, v88
  v_exp_f32 v89, v89
  v_cvt_pk_bf16_f32 v107, v86, v87
  v_mfma_f32_32x32x16_bf16 v[64:79], v[36:39], v[196:199], v[64:79]
  v_exp_f32 v90, v90
  v_exp_f32 v91, v91
  ds_read_b128 v[40:43], v3 offset:22528
  v_cvt_pk_bf16_f32 v108, v88, v89
  v_exp_f32 v92, v92
  v_exp_f32 v93, v93
  ds_read_b128 v[44:47], v3 offset:23552
  v_cvt_pk_bf16_f32 v109, v90, v91
  v_exp_f32 v94, v94
  v_exp_f32 v95, v95
  v_cvt_pk_bf16_f32 v110, v92, v93
  v_cvt_pk_bf16_f32 v111, v94, v95
  v_mfma_f32_32x32x16_bf16 v[128:143], v[56:59], v[104:107], v[128:143]
  v_exp_f32 v64, v64
  v_exp_f32 v65, v65
  v_exp_f32 v66, v66
  v_exp_f32 v67, v67
  v_mfma_f32_32x32x16_bf16 v[128:143], v[60:63], v[108:111], v[128:143]
  v_cvt_pk_bf16_f32 v96, v64, v65
  v_exp_f32 v68, v68
  v_exp_f32 v69, v69
  v_cvt_pk_bf16_f32 v97, v66, v67
  v_exp_f32 v70, v70
  v_mfma_f32_32x32x16_bf16 v[80:95], v[32:35], v[200:203], 0
  v_exp_f32 v71, v71
  v_cvt_pk_bf16_f32 v98, v68, v69
  v_exp_f32 v72, v72
  v_exp_f32 v73, v73
  v_cvt_pk_bf16_f32 v99, v70, v71
  v_mfma_f32_32x32x16_bf16 v[80:95], v[36:39], v[204:207], v[80:95]
  v_exp_f32 v74, v74
  v_exp_f32 v75, v75
  ds_read_b128 v[56:59], v3 offset:55296
  v_cvt_pk_bf16_f32 v100, v72, v73
  v_exp_f32 v76, v76
  v_exp_f32 v77, v77
  ds_read_b128 v[60:63], v3 offset:56320
  v_cvt_pk_bf16_f32 v101, v74, v75
  v_exp_f32 v78, v78
  s_add_u32 m0, s31, 100352
  s_add_u32 s29, s53, s28
  s_add_u32 s29, s29, 2048
  buffer_load_dwordx4 v2, s[8:11], s29 offen sc1 lds
  v_exp_f32 v79, v79
  v_cvt_pk_bf16_f32 v102, v76, v77
  v_cvt_pk_bf16_f32 v103, v78, v79
  s_waitcnt lgkmcnt(4)
  v_mfma_f32_32x32x16_bf16 v[112:127], v[48:51], v[96:99], v[112:127]
  v_exp_f32 v80, v80
  v_exp_f32 v81, v81
  v_exp_f32 v82, v82
  v_exp_f32 v83, v83
  v_mfma_f32_32x32x16_bf16 v[112:127], v[52:55], v[100:103], v[112:127]
  v_cvt_pk_bf16_f32 v104, v80, v81
  v_exp_f32 v84, v84
  v_exp_f32 v85, v85
  v_cvt_pk_bf16_f32 v105, v82, v83
  v_exp_f32 v86, v86
  s_waitcnt lgkmcnt(2)
  v_mfma_f32_32x32x16_bf16 v[64:79], v[40:43], v[192:195], 0
  v_exp_f32 v87, v87
  v_cvt_pk_bf16_f32 v106, v84, v85
  v_exp_f32 v88, v88
  v_exp_f32 v89, v89
  v_cvt_pk_bf16_f32 v107, v86, v87
  v_mfma_f32_32x32x16_bf16 v[64:79], v[44:47], v[196:199], v[64:79]
  v_exp_f32 v90, v90
  v_exp_f32 v91, v91
  ds_read_b128 v[32:35], v3 offset:24576
  v_cvt_pk_bf16_f32 v108, v88, v89
  v_exp_f32 v92, v92
  v_exp_f32 v93, v93
  ds_read_b128 v[36:39], v3 offset:25600
  v_cvt_pk_bf16_f32 v109, v90, v91
  v_exp_f32 v94, v94
  v_exp_f32 v95, v95
  v_cvt_pk_bf16_f32 v110, v92, v93
  v_cvt_pk_bf16_f32 v111, v94, v95
  v_mfma_f32_32x32x16_bf16 v[128:143], v[48:51], v[104:107], v[128:143]
  v_exp_f32 v64, v64
  v_exp_f32 v65, v65
  v_exp_f32 v66, v66
  v_exp_f32 v67, v67
  v_mfma_f32_32x32x16_bf16 v[128:143], v[52:55], v[108:111], v[128:143]
  v_cvt_pk_bf16_f32 v96, v64, v65
  v_exp_f32 v68, v68
  v_exp_f32 v69, v69
  v_cvt_pk_bf16_f32 v97, v66, v67
  v_exp_f32 v70, v70
  v_mfma_f32_32x32x16_bf16 v[80:95], v[40:43], v[200:203], 0
  v_exp_f32 v71, v71
  v_cvt_pk_bf16_f32 v98, v68, v69
  v_exp_f32 v72, v72
  v_exp_f32 v73, v73
  v_cvt_pk_bf16_f32 v99, v70, v71
  v_mfma_f32_32x32x16_bf16 v[80:95], v[44:47], v[204:207], v[80:95]
  v_exp_f32 v74, v74
  v_exp_f32 v75, v75
  ds_read_b128 v[48:51], v3 offset:57344
  v_cvt_pk_bf16_f32 v100, v72, v73
  v_exp_f32 v76, v76
  v_exp_f32 v77, v77
  ds_read_b128 v[52:55], v3 offset:58368
  v_cvt_pk_bf16_f32 v101, v74, v75
  v_exp_f32 v78, v78
  s_add_u32 m0, s31, 101376
  s_add_u32 s29, s53, s28
  s_add_u32 s29, s29, 3072
  buffer_load_dwordx4 v2, s[8:11], s29 offen sc1 lds
  v_exp_f32 v79, v79
  v_cvt_pk_bf16_f32 v102, v76, v77
  v_cvt_pk_bf16_f32 v103, v78, v79
  s_waitcnt lgkmcnt(4)
  v_mfma_f32_32x32x16_bf16 v[112:127], v[56:59], v[96:99], v[112:127]
  v_exp_f32 v80, v80
  v_exp_f32 v81, v81
  v_exp_f32 v82, v82
  v_exp_f32 v83, v83
  v_mfma_f32_32x32x16_bf16 v[112:127], v[60:63], v[100:103], v[112:127]
  v_cvt_pk_bf16_f32 v104, v80, v81
  v_exp_f32 v84, v84
  v_exp_f32 v85, v85
  v_cvt_pk_bf16_f32 v105, v82, v83
  v_exp_f32 v86, v86
  s_waitcnt lgkmcnt(2)
  v_mfma_f32_32x32x16_bf16 v[64:79], v[32:35], v[192:195], 0
  v_exp_f32 v87, v87
  v_cvt_pk_bf16_f32 v106, v84, v85
  v_exp_f32 v88, v88
  v_exp_f32 v89, v89
  v_cvt_pk_bf16_f32 v107, v86, v87
  v_mfma_f32_32x32x16_bf16 v[64:79], v[36:39], v[196:199], v[64:79]
  v_exp_f32 v90, v90
  v_exp_f32 v91, v91
  ds_read_b128 v[40:43], v3 offset:26624
  v_cvt_pk_bf16_f32 v108, v88, v89
  v_exp_f32 v92, v92
  v_exp_f32 v93, v93
  ds_read_b128 v[44:47], v3 offset:27648
  v_cvt_pk_bf16_f32 v109, v90, v91
  v_exp_f32 v94, v94
  v_exp_f32 v95, v95
  v_cvt_pk_bf16_f32 v110, v92, v93
  v_cvt_pk_bf16_f32 v111, v94, v95
  v_mfma_f32_32x32x16_bf16 v[128:143], v[56:59], v[104:107], v[128:143]
  v_exp_f32 v64, v64
  v_exp_f32 v65, v65
  v_exp_f32 v66, v66
  v_exp_f32 v67, v67
  v_mfma_f32_32x32x16_bf16 v[128:143], v[60:63], v[108:111], v[128:143]
  v_cvt_pk_bf16_f32 v96, v64, v65
  v_exp_f32 v68, v68
  v_exp_f32 v69, v69
  v_cvt_pk_bf16_f32 v97, v66, v67
  v_exp_f32 v70, v70
  v_mfma_f32_32x32x16_bf16 v[80:95], v[32:35], v[200:203], 0
  v_exp_f32 v71, v71
  v_cvt_pk_bf16_f32 v98, v68, v69
  v_exp_f32 v72, v72
  v_exp_f32 v73, v73
  v_cvt_pk_bf16_f32 v99, v70, v71
  v_mfma_f32_32x32x16_bf16 v[80:95], v[36:39], v[204:207], v[80:95]
  v_exp_f32 v74, v74
  v_exp_f32 v75, v75
  ds_read_b128 v[56:59], v3 offset:59392
  v_cvt_pk_bf16_f32 v100, v72, v73
  v_exp_f32 v76, v76
  v_exp_f32 v77, v77
  ds_read_b128 v[60:63], v3 offset:60416
  v_cvt_pk_bf16_f32 v101, v74, v75
  v_exp_f32 v78, v78
  s_add_u32 m0, s31, 102400
  s_add_u32 s29, s53, s28
  s_add_u32 s29, s29, 4096
  buffer_load_dwordx4 v2, s[8:11], s29 offen sc1 lds
  v_exp_f32 v79, v79
  v_cvt_pk_bf16_f32 v102, v76, v77
  v_cvt_pk_bf16_f32 v103, v78, v79
  s_waitcnt lgkmcnt(4)
  v_mfma_f32_32x32x16_bf16 v[112:127], v[48:51], v[96:99], v[112:127]
  v_exp_f32 v80, v80
  v_exp_f32 v81, v81
  v_exp_f32 v82, v82
  v_exp_f32 v83, v83
  v_mfma_f32_32x32x16_bf16 v[112:127], v[52:55], v[100:103], v[112:127]
  v_cvt_pk_bf16_f32 v104, v80, v81
  v_exp_f32 v84, v84
  v_exp_f32 v85, v85
  v_cvt_pk_bf16_f32 v105, v82, v83
  v_exp_f32 v86, v86
  s_waitcnt lgkmcnt(2)
  v_mfma_f32_32x32x16_bf16 v[64:79], v[40:43], v[192:195], 0
  v_exp_f32 v87, v87
  v_cvt_pk_bf16_f32 v106, v84, v85
  v_exp_f32 v88, v88
  v_exp_f32 v89, v89
  v_cvt_pk_bf16_f32 v107, v86, v87
  v_mfma_f32_32x32x16_bf16 v[64:79], v[44:47], v[196:199], v[64:79]
  v_exp_f32 v90, v90
  v_exp_f32 v91, v91
  ds_read_b128 v[32:35], v3 offset:28672
  v_cvt_pk_bf16_f32 v108, v88, v89
  v_exp_f32 v92, v92
  v_exp_f32 v93, v93
  ds_read_b128 v[36:39], v3 offset:29696
  v_cvt_pk_bf16_f32 v109, v90, v91
  v_exp_f32 v94, v94
  v_exp_f32 v95, v95
  v_cvt_pk_bf16_f32 v110, v92, v93
  v_cvt_pk_bf16_f32 v111, v94, v95
  v_mfma_f32_32x32x16_bf16 v[128:143], v[48:51], v[104:107], v[128:143]
  v_exp_f32 v64, v64
  v_exp_f32 v65, v65
  v_exp_f32 v66, v66
  v_exp_f32 v67, v67
  v_mfma_f32_32x32x16_bf16 v[128:143], v[52:55], v[108:111], v[128:143]
  v_cvt_pk_bf16_f32 v96, v64, v65
  v_exp_f32 v68, v68
  v_exp_f32 v69, v69
  v_cvt_pk_bf16_f32 v97, v66, v67
  v_exp_f32 v70, v70
  v_mfma_f32_32x32x16_bf16 v[80:95], v[40:43], v[200:203], 0
  v_exp_f32 v71, v71
  v_cvt_pk_bf16_f32 v98, v68, v69
  v_exp_f32 v72, v72
  v_exp_f32 v73, v73
  v_cvt_pk_bf16_f32 v99, v70, v71
  v_mfma_f32_32x32x16_bf16 v[80:95], v[44:47], v[204:207], v[80:95]
  v_exp_f32 v74, v74
  v_exp_f32 v75, v75
  ds_read_b128 v[48:51], v3 offset:61440
  v_cvt_pk_bf16_f32 v100, v72, v73
  v_exp_f32 v76, v76
  v_exp_f32 v77, v77
  ds_read_b128 v[52:55], v3 offset:62464
  v_cvt_pk_bf16_f32 v101, v74, v75
  v_exp_f32 v78, v78
  s_add_u32 m0, s31, 103424
  s_add_u32 s29, s53, s28
  s_add_u32 s29, s29, 5120
  buffer_load_dwordx4 v2, s[8:11], s29 offen sc1 lds
  v_exp_f32 v79, v79
  v_cvt_pk_bf16_f32 v102, v76, v77
  v_cvt_pk_bf16_f32 v103, v78, v79
  s_waitcnt lgkmcnt(4)
  v_mfma_f32_32x32x16_bf16 v[112:127], v[56:59], v[96:99], v[112:127]
  v_exp_f32 v80, v80
  v_exp_f32 v81, v81
  v_exp_f32 v82, v82
  v_exp_f32 v83, v83
  v_mfma_f32_32x32x16_bf16 v[112:127], v[60:63], v[100:103], v[112:127]
  v_cvt_pk_bf16_f32 v104, v80, v81
  v_exp_f32 v84, v84
  v_exp_f32 v85, v85
  v_cvt_pk_bf16_f32 v105, v82, v83
  v_exp_f32 v86, v86
  s_waitcnt lgkmcnt(2)
  v_mfma_f32_32x32x16_bf16 v[64:79], v[32:35], v[192:195], 0
  v_exp_f32 v87, v87
  v_cvt_pk_bf16_f32 v106, v84, v85
  v_exp_f32 v88, v88
  v_exp_f32 v89, v89
  v_cvt_pk_bf16_f32 v107, v86, v87
  v_mfma_f32_32x32x16_bf16 v[64:79], v[36:39], v[196:199], v[64:79]
  v_exp_f32 v90, v90
  v_exp_f32 v91, v91
  ds_read_b128 v[40:43], v3 offset:30720
  v_cvt_pk_bf16_f32 v108, v88, v89
  v_exp_f32 v92, v92
  v_exp_f32 v93, v93
  ds_read_b128 v[44:47], v3 offset:31744
  v_cvt_pk_bf16_f32 v109, v90, v91
  v_exp_f32 v94, v94
  v_exp_f32 v95, v95
  v_cvt_pk_bf16_f32 v110, v92, v93
  v_cvt_pk_bf16_f32 v111, v94, v95
  v_mfma_f32_32x32x16_bf16 v[128:143], v[56:59], v[104:107], v[128:143]
  v_exp_f32 v64, v64
  v_exp_f32 v65, v65
  v_exp_f32 v66, v66
  v_exp_f32 v67, v67
  v_mfma_f32_32x32x16_bf16 v[128:143], v[60:63], v[108:111], v[128:143]
  v_cvt_pk_bf16_f32 v96, v64, v65
  v_exp_f32 v68, v68
  v_exp_f32 v69, v69
  v_cvt_pk_bf16_f32 v97, v66, v67
  v_exp_f32 v70, v70
  v_mfma_f32_32x32x16_bf16 v[80:95], v[32:35], v[200:203], 0
  v_exp_f32 v71, v71
  v_cvt_pk_bf16_f32 v98, v68, v69
  v_exp_f32 v72, v72
  v_exp_f32 v73, v73
  v_cvt_pk_bf16_f32 v99, v70, v71
  v_mfma_f32_32x32x16_bf16 v[80:95], v[36:39], v[204:207], v[80:95]
  v_exp_f32 v74, v74
  v_exp_f32 v75, v75
  ds_read_b128 v[56:59], v3 offset:63488
  v_cvt_pk_bf16_f32 v100, v72, v73
  v_exp_f32 v76, v76
  v_exp_f32 v77, v77
  ds_read_b128 v[60:63], v3 offset:64512
  v_cvt_pk_bf16_f32 v101, v74, v75
  v_exp_f32 v78, v78
  s_add_u32 m0, s31, 104448
  s_add_u32 s29, s53, s28
  s_add_u32 s29, s29, 6144
  buffer_load_dwordx4 v2, s[8:11], s29 offen sc1 lds
  v_exp_f32 v79, v79
  v_cvt_pk_bf16_f32 v102, v76, v77
  v_cvt_pk_bf16_f32 v103, v78, v79
  s_waitcnt lgkmcnt(4)
  v_mfma_f32_32x32x16_bf16 v[112:127], v[48:51], v[96:99], v[112:127]
  v_exp_f32 v80, v80
  v_exp_f32 v81, v81
  v_exp_f32 v82, v82
  v_exp_f32 v83, v83
  v_mfma_f32_32x32x16_bf16 v[112:127], v[52:55], v[100:103], v[112:127]
  v_cvt_pk_bf16_f32 v104, v80, v81
  v_exp_f32 v84, v84
  v_exp_f32 v85, v85
  v_cvt_pk_bf16_f32 v105, v82, v83
  v_exp_f32 v86, v86
  s_waitcnt lgkmcnt(2)
  v_mfma_f32_32x32x16_bf16 v[64:79], v[40:43], v[192:195], 0
  v_exp_f32 v87, v87
  v_cvt_pk_bf16_f32 v106, v84, v85
  v_exp_f32 v88, v88
  v_exp_f32 v89, v89
  v_cvt_pk_bf16_f32 v107, v86, v87
  v_mfma_f32_32x32x16_bf16 v[64:79], v[44:47], v[196:199], v[64:79]
  v_exp_f32 v90, v90
  v_exp_f32 v91, v91
  v_cvt_pk_bf16_f32 v108, v88, v89
  v_exp_f32 v92, v92
  v_exp_f32 v93, v93
  v_cvt_pk_bf16_f32 v109, v90, v91
  v_exp_f32 v94, v94
  v_exp_f32 v95, v95
  v_cvt_pk_bf16_f32 v110, v92, v93
  v_cvt_pk_bf16_f32 v111, v94, v95
  v_mfma_f32_32x32x16_bf16 v[128:143], v[48:51], v[104:107], v[128:143]
  v_exp_f32 v64, v64
  v_exp_f32 v65, v65
  v_exp_f32 v66, v66
  v_exp_f32 v67, v67
  v_mfma_f32_32x32x16_bf16 v[128:143], v[52:55], v[108:111], v[128:143]
  v_cvt_pk_bf16_f32 v96, v64, v65
  v_exp_f32 v68, v68
  v_exp_f32 v69, v69
  v_cvt_pk_bf16_f32 v97, v66, v67
  v_exp_f32 v70, v70
  v_mfma_f32_32x32x16_bf16 v[80:95], v[40:43], v[200:203], 0
  v_exp_f32 v71, v71
  v_cvt_pk_bf16_f32 v98, v68, v69
  v_exp_f32 v72, v72
  v_exp_f32 v73, v73
  v_cvt_pk_bf16_f32 v99, v70, v71
  v_mfma_f32_32x32x16_bf16 v[80:95], v[44:47], v[204:207], v[80:95]
  v_exp_f32 v74, v74
  v_exp_f32 v75, v75
  v_cvt_pk_bf16_f32 v100, v72, v73
  v_exp_f32 v76, v76
  v_exp_f32 v77, v77
  v_cvt_pk_bf16_f32 v101, v74, v75
  v_exp_f32 v78, v78
  s_add_u32 m0, s31, 105472
  s_add_u32 s29, s53, s28
  s_add_u32 s29, s29, 7168
  buffer_load_dwordx4 v2, s[8:11], s29 offen sc1 lds
  v_exp_f32 v79, v79
  v_cvt_pk_bf16_f32 v102, v76, v77
  v_cvt_pk_bf16_f32 v103, v78, v79
  s_waitcnt lgkmcnt(0)
  v_mfma_f32_32x32x16_bf16 v[112:127], v[56:59], v[96:99], v[112:127]
  v_exp_f32 v80, v80
  v_exp_f32 v81, v81
  v_exp_f32 v82, v82
  v_exp_f32 v83, v83
  v_mfma_f32_32x32x16_bf16 v[112:127], v[60:63], v[100:103], v[112:127]
  v_cvt_pk_bf16_f32 v104, v80, v81
  v_exp_f32 v84, v84
  v_exp_f32 v85, v85
  v_cvt_pk_bf16_f32 v105, v82, v83
  v_exp_f32 v86, v86
  v_exp_f32 v87, v87
  v_cvt_pk_bf16_f32 v106, v84, v85
  v_exp_f32 v88, v88
  v_exp_f32 v89, v89
  v_cvt_pk_bf16_f32 v107, v86, v87
  v_exp_f32 v90, v90
  v_exp_f32 v91, v91
  v_cvt_pk_bf16_f32 v108, v88, v89
  v_exp_f32 v92, v92
  v_exp_f32 v93, v93
  v_cvt_pk_bf16_f32 v109, v90, v91
  v_exp_f32 v94, v94
  v_exp_f32 v95, v95
  v_cvt_pk_bf16_f32 v110, v92, v93
  v_cvt_pk_bf16_f32 v111, v94, v95
  s_nop 1
  v_mfma_f32_32x32x16_bf16 v[128:143], v[56:59], v[104:107], v[128:143]
  v_mfma_f32_32x32x16_bf16 v[128:143], v[60:63], v[108:111], v[128:143]
  s_waitcnt vmcnt(0)
  s_barrier
  s_add_u32 s41, s41, 1
  s_min_u32 s29, s41, 3
  s_mul_i32 s53, s29, 32768
  s_lshl_b32 s31, s21, 13
  s_add_u32 s53, s53, s31
  ds_read_b128 v[32:35], v4 offset:0
  ds_read_b128 v[36:39], v4 offset:1024
  ds_read_b128 v[48:51], v4 offset:32768
  ds_read_b128 v[52:55], v4 offset:33792
  ds_read_b128 v[40:43], v4 offset:2048
  ds_read_b128 v[44:47], v4 offset:3072
  s_waitcnt lgkmcnt(4)
  v_mfma_f32_32x32x16_bf16 v[64:79], v[32:35], v[192:195], 0
  v_mfma_f32_32x32x16_bf16 v[64:79], v[36:39], v[196:199], v[64:79]
  s_nop 11
  v_exp_f32 v64, v64
  v_exp_f32 v65, v65
  v_exp_f32 v66, v66
  v_exp_f32 v67, v67
  v_cvt_pk_bf16_f32 v96, v64, v65
  v_exp_f32 v68, v68
  v_exp_f32 v69, v69
  v_cvt_pk_bf16_f32 v97, v66, v67
  v_exp_f32 v70, v70
  v_mfma_f32_32x32x16_bf16 v[80:95], v[32:35], v[200:203], 0
  v_exp_f32 v71, v71
  v_cvt_pk_bf16_f32 v98, v68, v69
  v_exp_f32 v72, v72
  v_exp_f32 v73, v73
  v_cvt_pk_bf16_f32 v99, v70, v71
  v_mfma_f32_32x32x16_bf16 v[80:95], v[36:39], v[204:207], v[80:95]
  v_exp_f32 v74, v74
  v_exp_f32 v75, v75
  ds_read_b128 v[56:59], v4 offset:34816
  v_cvt_pk_bf16_f32 v100, v72, v73
  v_exp_f32 v76, v76
  v_exp_f32 v77, v77
  ds_read_b128 v[60:63], v4 offset:35840
  v_cvt_pk_bf16_f32 v101, v74, v75
  v_exp_f32 v78, v78
  s_add_u32 m0, s31, 0
  s_add_u32 s29, s53, s27
  s_add_u32 s29, s29, 0
  buffer_load_dwordx4 v2, s[8:11], s29 offen sc1 lds
  v_exp_f32 v79, v79
  v_cvt_pk_bf16_f32 v102, v76, v77
  v_cvt_pk_bf16_f32 v103, v78, v79
  s_waitcnt lgkmcnt(4)
  v_mfma_f32_32x32x16_bf16 v[112:127], v[48:51], v[96:99], v[112:127]
  v_exp_f32 v80, v80
  v_exp_f32 v81, v81
  v_exp_f32 v82, v82
  v_exp_f32 v83, v83
  v_mfma_f32_32x32x16_bf16 v[112:127], v[52:55], v[100:103], v[112:127]
  v_cvt_pk_bf16_f32 v104, v80, v81
  v_exp_f32 v84, v84
  v_exp_f32 v85, v85
  v_cvt_pk_bf16_f32 v105, v82, v83
  v_exp_f32 v86, v86
  s_waitcnt lgkmcnt(2)
  v_mfma_f32_32x32x16_bf16 v[64:79], v[40:43], v[192:195], 0
  v_exp_f32 v87, v87
  v_cvt_pk_bf16_f32 v106, v84, v85
  v_exp_f32 v88, v88
  v_exp_f32 v89, v89
  v_cvt_pk_bf16_f32 v107, v86, v87
  v_mfma_f32_32x32x16_bf16 v[64:79], v[44:47], v[196:199], v[64:79]
  v_exp_f32 v90, v90
  v_exp_f32 v91, v91
  ds_read_b128 v[32:35], v4 offset:4096
  v_cvt_pk_bf16_f32 v108, v88, v89
  v_exp_f32 v92, v92
  v_exp_f32 v93, v93
  ds_read_b128 v[36:39], v4 offset:5120
  v_cvt_pk_bf16_f32 v109, v90, v91
  v_exp_f32 v94, v94
  v_exp_f32 v95, v95
  v_cvt_pk_bf16_f32 v110, v92, v93
  v_cvt_pk_bf16_f32 v111, v94, v95
  v_mfma_f32_32x32x16_bf16 v[128:143], v[48:51], v[104:107], v[128:143]
  v_exp_f32 v64, v64
  v_exp_f32 v65, v65
  v_exp_f32 v66, v66
  v_exp_f32 v67, v67
  v_mfma_f32_32x32x16_bf16 v[128:143], v[52:55], v[108:111], v[128:143]
  v_cvt_pk_bf16_f32 v96, v64, v65
  v_exp_f32 v68, v68
  v_exp_f32 v69, v69
  v_cvt_pk_bf16_f32 v97, v66, v67
  v_exp_f32 v70, v70
  v_mfma_f32_32x32x16_bf16 v[80:95], v[40:43], v[200:203], 0
  v_exp_f32 v71, v71
  v_cvt_pk_bf16_f32 v98, v68, v69
  v_exp_f32 v72, v72
  v_exp_f32 v73, v73
  v_cvt_pk_bf16_f32 v99, v70, v71
  v_mfma_f32_32x32x16_bf16 v[80:95], v[44:47], v[204:207], v[80:95]
  v_exp_f32 v74, v74
  v_exp_f32 v75, v75
  ds_read_b128 v[48:51], v4 offset:36864
  v_cvt_pk_bf16_f32 v100, v72, v73
  v_exp_f32 v76, v76
  v_exp_f32 v77, v77
  ds_read_b128 v[52:55], v4 offset:37888
  v_cvt_pk_bf16_f32 v101, v74, v75
  v_exp_f32 v78, v78
  s_add_u32 m0, s31, 1024
  s_add_u32 s29, s53, s27
  s_add_u32 s29, s29, 1024
  buffer_load_dwordx4 v2, s[8:11], s29 offen sc1 lds
  v_exp_f32 v79, v79
  v_cvt_pk_bf16_f32 v102, v76, v77
  v_cvt_pk_bf16_f32 v103, v78, v79
  s_waitcnt lgkmcnt(4)
  v_mfma_f32_32x32x16_bf16 v[112:127], v[56:59], v[96:99], v[112:127]
  v_exp_f32 v80, v80
  v_exp_f32 v81, v81
  v_exp_f32 v82, v82
  v_exp_f32 v83, v83
  v_mfma_f32_32x32x16_bf16 v[112:127], v[60:63], v[100:103], v[112:127]
  v_cvt_pk_bf16_f32 v104, v80, v81
  v_exp_f32 v84, v84
  v_exp_f32 v85, v85
  v_cvt_pk_bf16_f32 v105, v82, v83
  v_exp_f32 v86, v86
  s_waitcnt lgkmcnt(2)
  v_mfma_f32_32x32x16_bf16 v[64:79], v[32:35], v[192:195], 0
  v_exp_f32 v87, v87
  v_cvt_pk_bf16_f32 v106, v84, v85
  v_exp_f32 v88, v88
  v_exp_f32 v89, v89
  v_cvt_pk_bf16_f32 v107, v86, v87
  v_mfma_f32_32x32x16_bf16 v[64:79], v[36:39], v[196:199], v[64:79]
  v_exp_f32 v90, v90
  v_exp_f32 v91, v91
  ds_read_b128 v[40:43], v4 offset:6144
  v_cvt_pk_bf16_f32 v108, v88, v89
  v_exp_f32 v92, v92
  v_exp_f32 v93, v93
  ds_read_b128 v[44:47], v4 offset:7168
  v_cvt_pk_bf16_f32 v109, v90, v91
  v_exp_f32 v94, v94
  v_exp_f32 v95, v95
  v_cvt_pk_bf16_f32 v110, v92, v93
  v_cvt_pk_bf16_f32 v111, v94, v95
  v_mfma_f32_32x32x16_bf16 v[128:143], v[56:59], v[104:107], v[128:143]
  v_exp_f32 v64, v64
  v_exp_f32 v65, v65
  v_exp_f32 v66, v66
  v_exp_f32 v67, v67
  v_mfma_f32_32x32x16_bf16 v[128:143], v[60:63], v[108:111], v[128:143]
  v_cvt_pk_bf16_f32 v96, v64, v65
  v_exp_f32 v68, v68
  v_exp_f32 v69, v69
  v_cvt_pk_bf16_f32 v97, v66, v67
  v_exp_f32 v70, v70
  v_mfma_f32_32x32x16_bf16 v[80:95], v[32:35], v[200:203], 0
  v_exp_f32 v71, v71
  v_cvt_pk_bf16_f32 v98, v68, v69
  v_exp_f32 v72, v72
  v_exp_f32 v73, v73
  v_cvt_pk_bf16_f32 v99, v70, v71
  v_mfma_f32_32x32x16_bf16 v[80:95], v[36:39], v[204:207], v[80:95]
  v_exp_f32 v74, v74
  v_exp_f32 v75, v75
  ds_read_b128 v[56:59], v4 offset:38912
  v_cvt_pk_bf16_f32 v100, v72, v73
  v_exp_f32 v76, v76
  v_exp_f32 v77, v77
  ds_read_b128 v[60:63], v4 offset:39936
  v_cvt_pk_bf16_f32 v101, v74, v75
  v_exp_f32 v78, v78
  s_add_u32 m0, s31, 2048
  s_add_u32 s29, s53, s27
  s_add_u32 s29, s29, 2048
  buffer_load_dwordx4 v2, s[8:11], s29 offen sc1 lds
  v_exp_f32 v79, v79
  v_cvt_pk_bf16_f32 v102, v76, v77
  v_cvt_pk_bf16_f32 v103, v78, v79
  s_waitcnt lgkmcnt(4)
  v_mfma_f32_32x32x16_bf16 v[112:127], v[48:51], v[96:99], v[112:127]
  v_exp_f32 v80, v80
  v_exp_f32 v81, v81
  v_exp_f32 v82, v82
  v_exp_f32 v83, v83
  v_mfma_f32_32x32x16_bf16 v[112:127], v[52:55], v[100:103], v[112:127]
  v_cvt_pk_bf16_f32 v104, v80, v81
  v_exp_f32 v84, v84
  v_exp_f32 v85, v85
  v_cvt_pk_bf16_f32 v105, v82, v83
  v_exp_f32 v86, v86
  s_waitcnt lgkmcnt(2)
  v_mfma_f32_32x32x16_bf16 v[64:79], v[40:43], v[192:195], 0
  v_exp_f32 v87, v87
  v_cvt_pk_bf16_f32 v106, v84, v85
  v_exp_f32 v88, v88
  v_exp_f32 v89, v89
  v_cvt_pk_bf16_f32 v107, v86, v87
  v_mfma_f32_32x32x16_bf16 v[64:79], v[44:47], v[196:199], v[64:79]
  v_exp_f32 v90, v90
  v_exp_f32 v91, v91
  ds_read_b128 v[32:35], v4 offset:8192
  v_cvt_pk_bf16_f32 v108, v88, v89
  v_exp_f32 v92, v92
  v_exp_f32 v93, v93
  ds_read_b128 v[36:39], v4 offset:9216
  v_cvt_pk_bf16_f32 v109, v90, v91
  v_exp_f32 v94, v94
  v_exp_f32 v95, v95
  v_cvt_pk_bf16_f32 v110, v92, v93
  v_cvt_pk_bf16_f32 v111, v94, v95
  v_mfma_f32_32x32x16_bf16 v[128:143], v[48:51], v[104:107], v[128:143]
  v_exp_f32 v64, v64
  v_exp_f32 v65, v65
  v_exp_f32 v66, v66
  v_exp_f32 v67, v67
  v_mfma_f32_32x32x16_bf16 v[128:143], v[52:55], v[108:111], v[128:143]
  v_cvt_pk_bf16_f32 v96, v64, v65
  v_exp_f32 v68, v68
  v_exp_f32 v69, v69
  v_cvt_pk_bf16_f32 v97, v66, v67
  v_exp_f32 v70, v70
  v_mfma_f32_32x32x16_bf16 v[80:95], v[40:43], v[200:203], 0
  v_exp_f32 v71, v71
  v_cvt_pk_bf16_f32 v98, v68, v69
  v_exp_f32 v72, v72
  v_exp_f32 v73, v73
  v_cvt_pk_bf16_f32 v99, v70, v71
  v_mfma_f32_32x32x16_bf16 v[80:95], v[44:47], v[204:207], v[80:95]
  v_exp_f32 v74, v74
  v_exp_f32 v75, v75
  ds_read_b128 v[48:51], v4 offset:40960
  v_cvt_pk_bf16_f32 v100, v72, v73
  v_exp_f32 v76, v76
  v_exp_f32 v77, v77
  ds_read_b128 v[52:55], v4 offset:41984
  v_cvt_pk_bf16_f32 v101, v74, v75
  v_exp_f32 v78, v78
  s_add_u32 m0, s31, 3072
  s_add_u32 s29, s53, s27
  s_add_u32 s29, s29, 3072
  buffer_load_dwordx4 v2, s[8:11], s29 offen sc1 lds
  v_exp_f32 v79, v79
  v_cvt_pk_bf16_f32 v102, v76, v77
  v_cvt_pk_bf16_f32 v103, v78, v79
  s_waitcnt lgkmcnt(4)
  v_mfma_f32_32x32x16_bf16 v[112:127], v[56:59], v[96:99], v[112:127]
  v_exp_f32 v80, v80
  v_exp_f32 v81, v81
  v_exp_f32 v82, v82
  v_exp_f32 v83, v83
  v_mfma_f32_32x32x16_bf16 v[112:127], v[60:63], v[100:103], v[112:127]
  v_cvt_pk_bf16_f32 v104, v80, v81
  v_exp_f32 v84, v84
  v_exp_f32 v85, v85
  v_cvt_pk_bf16_f32 v105, v82, v83
  v_exp_f32 v86, v86
  s_waitcnt lgkmcnt(2)
  v_mfma_f32_32x32x16_bf16 v[64:79], v[32:35], v[192:195], 0
  v_exp_f32 v87, v87
  v_cvt_pk_bf16_f32 v106, v84, v85
  v_exp_f32 v88, v88
  v_exp_f32 v89, v89
  v_cvt_pk_bf16_f32 v107, v86, v87
  v_mfma_f32_32x32x16_bf16 v[64:79], v[36:39], v[196:199], v[64:79]
  v_exp_f32 v90, v90
  v_exp_f32 v91, v91
  ds_read_b128 v[40:43], v4 offset:10240
  v_cvt_pk_bf16_f32 v108, v88, v89
  v_exp_f32 v92, v92
  v_exp_f32 v93, v93
  ds_read_b128 v[44:47], v4 offset:11264
  v_cvt_pk_bf16_f32 v109, v90, v91
  v_exp_f32 v94, v94
  v_exp_f32 v95, v95
  v_cvt_pk_bf16_f32 v110, v92, v93
  v_cvt_pk_bf16_f32 v111, v94, v95
  v_mfma_f32_32x32x16_bf16 v[128:143], v[56:59], v[104:107], v[128:143]
  v_exp_f32 v64, v64
  v_exp_f32 v65, v65
  v_exp_f32 v66, v66
  v_exp_f32 v67, v67
  v_mfma_f32_32x32x16_bf16 v[128:143], v[60:63], v[108:111], v[128:143]
  v_cvt_pk_bf16_f32 v96, v64, v65
  v_exp_f32 v68, v68
  v_exp_f32 v69, v69
  v_cvt_pk_bf16_f32 v97, v66, v67
  v_exp_f32 v70, v70
  v_mfma_f32_32x32x16_bf16 v[80:95], v[32:35], v[200:203], 0
  v_exp_f32 v71, v71
  v_cvt_pk_bf16_f32 v98, v68, v69
  v_exp_f32 v72, v72
  v_exp_f32 v73, v73
  v_cvt_pk_bf16_f32 v99, v70, v71
  v_mfma_f32_32x32x16_bf16 v[80:95], v[36:39], v[204:207], v[80:95]
  v_exp_f32 v74, v74
  v_exp_f32 v75, v75
  ds_read_b128 v[56:59], v4 offset:43008
  v_cvt_pk_bf16_f32 v100, v72, v73
  v_exp_f32 v76, v76
  v_exp_f32 v77, v77
  ds_read_b128 v[60:63], v4 offset:44032
  v_cvt_pk_bf16_f32 v101, v74, v75
  v_exp_f32 v78, v78
  s_add_u32 m0, s31, 4096
  s_add_u32 s29, s53, s27
  s_add_u32 s29, s29, 4096
  buffer_load_dwordx4 v2, s[8:11], s29 offen sc1 lds
  v_exp_f32 v79, v79
  v_cvt_pk_bf16_f32 v102, v76, v77
  v_cvt_pk_bf16_f32 v103, v78, v79
  s_waitcnt lgkmcnt(4)
  v_mfma_f32_32x32x16_bf16 v[112:127], v[48:51], v[96:99], v[112:127]
  v_exp_f32 v80, v80
  v_exp_f32 v81, v81
  v_exp_f32 v82, v82
  v_exp_f32 v83, v83
  v_mfma_f32_32x32x16_bf16 v[112:127], v[52:55], v[100:103], v[112:127]
  v_cvt_pk_bf16_f32 v104, v80, v81
  v_exp_f32 v84, v84
  v_exp_f32 v85, v85
  v_cvt_pk_bf16_f32 v105, v82, v83
  v_exp_f32 v86, v86
  s_waitcnt lgkmcnt(2)
  v_mfma_f32_32x32x16_bf16 v[64:79], v[40:43], v[192:195], 0
  v_exp_f32 v87, v87
  v_cvt_pk_bf16_f32 v106, v84, v85
  v_exp_f32 v88, v88
  v_exp_f32 v89, v89
  v_cvt_pk_bf16_f32 v107, v86, v87
  v_mfma_f32_32x32x16_bf16 v[64:79], v[44:47], v[196:199], v[64:79]
  v_exp_f32 v90, v90
  v_exp_f32 v91, v91
  ds_read_b128 v[32:35], v4 offset:12288
  v_cvt_pk_bf16_f32 v108, v88, v89
  v_exp_f32 v92, v92
  v_exp_f32 v93, v93
  ds_read_b128 v[36:39], v4 offset:13312
  v_cvt_pk_bf16_f32 v109, v90, v91
  v_exp_f32 v94, v94
  v_exp_f32 v95, v95
  v_cvt_pk_bf16_f32 v110, v92, v93
  v_cvt_pk_bf16_f32 v111, v94, v95
  v_mfma_f32_32x32x16_bf16 v[128:143], v[48:51], v[104:107], v[128:143]
  v_exp_f32 v64, v64
  v_exp_f32 v65, v65
  v_exp_f32 v66, v66
  v_exp_f32 v67, v67
  v_mfma_f32_32x32x16_bf16 v[128:143], v[52:55], v[108:111], v[128:143]
  v_cvt_pk_bf16_f32 v96, v64, v65
  v_exp_f32 v68, v68
  v_exp_f32 v69, v69
  v_cvt_pk_bf16_f32 v97, v66, v67
  v_exp_f32 v70, v70
  v_mfma_f32_32x32x16_bf16 v[80:95], v[40:43], v[200:203], 0
  v_exp_f32 v71, v71
  v_cvt_pk_bf16_f32 v98, v68, v69
  v_exp_f32 v72, v72
  v_exp_f32 v73, v73
  v_cvt_pk_bf16_f32 v99, v70, v71
  v_mfma_f32_32x32x16_bf16 v[80:95], v[44:47], v[204:207], v[80:95]
  v_exp_f32 v74, v74
  v_exp_f32 v75, v75
  ds_read_b128 v[48:51], v4 offset:45056
  v_cvt_pk_bf16_f32 v100, v72, v73
  v_exp_f32 v76, v76
  v_exp_f32 v77, v77
  ds_read_b128 v[52:55], v4 offset:46080
  v_cvt_pk_bf16_f32 v101, v74, v75
  v_exp_f32 v78, v78
  s_add_u32 m0, s31, 5120
  s_add_u32 s29, s53, s27
  s_add_u32 s29, s29, 5120
  buffer_load_dwordx4 v2, s[8:11], s29 offen sc1 lds
  v_exp_f32 v79, v79
  v_cvt_pk_bf16_f32 v102, v76, v77
  v_cvt_pk_bf16_f32 v103, v78, v79
  s_waitcnt lgkmcnt(4)
  v_mfma_f32_32x32x16_bf16 v[112:127], v[56:59], v[96:99], v[112:127]
  v_exp_f32 v80, v80
  v_exp_f32 v81, v81
  v_exp_f32 v82, v82
  v_exp_f32 v83, v83
  v_mfma_f32_32x32x16_bf16 v[112:127], v[60:63], v[100:103], v[112:127]
  v_cvt_pk_bf16_f32 v104, v80, v81
  v_exp_f32 v84, v84
  v_exp_f32 v85, v85
  v_cvt_pk_bf16_f32 v105, v82, v83
  v_exp_f32 v86, v86
  s_waitcnt lgkmcnt(2)
  v_mfma_f32_32x32x16_bf16 v[64:79], v[32:35], v[192:195], 0
  v_exp_f32 v87, v87
  v_cvt_pk_bf16_f32 v106, v84, v85
  v_exp_f32 v88, v88
  v_exp_f32 v89, v89
  v_cvt_pk_bf16_f32 v107, v86, v87
  v_mfma_f32_32x32x16_bf16 v[64:79], v[36:39], v[196:199], v[64:79]
  v_exp_f32 v90, v90
  v_exp_f32 v91, v91
  ds_read_b128 v[40:43], v4 offset:14336
  v_cvt_pk_bf16_f32 v108, v88, v89
  v_exp_f32 v92, v92
  v_exp_f32 v93, v93
  ds_read_b128 v[44:47], v4 offset:15360
  v_cvt_pk_bf16_f32 v109, v90, v91
  v_exp_f32 v94, v94
  v_exp_f32 v95, v95
  v_cvt_pk_bf16_f32 v110, v92, v93
  v_cvt_pk_bf16_f32 v111, v94, v95
  v_mfma_f32_32x32x16_bf16 v[128:143], v[56:59], v[104:107], v[128:143]
  v_exp_f32 v64, v64
  v_exp_f32 v65, v65
  v_exp_f32 v66, v66
  v_exp_f32 v67, v67
  v_mfma_f32_32x32x16_bf16 v[128:143], v[60:63], v[108:111], v[128:143]
  v_cvt_pk_bf16_f32 v96, v64, v65
  v_exp_f32 v68, v68
  v_exp_f32 v69, v69
  v_cvt_pk_bf16_f32 v97, v66, v67
  v_exp_f32 v70, v70
  v_mfma_f32_32x32x16_bf16 v[80:95], v[32:35], v[200:203], 0
  v_exp_f32 v71, v71
  v_cvt_pk_bf16_f32 v98, v68, v69
  v_exp_f32 v72, v72
  v_exp_f32 v73, v73
  v_cvt_pk_bf16_f32 v99, v70, v71
  v_mfma_f32_32x32x16_bf16 v[80:95], v[36:39], v[204:207], v[80:95]
  v_exp_f32 v74, v74
  v_exp_f32 v75, v75
  ds_read_b128 v[56:59], v4 offset:47104
  v_cvt_pk_bf16_f32 v100, v72, v73
  v_exp_f32 v76, v76
  v_exp_f32 v77, v77
  ds_read_b128 v[60:63], v4 offset:48128
  v_cvt_pk_bf16_f32 v101, v74, v75
  v_exp_f32 v78, v78
  s_add_u32 m0, s31, 6144
  s_add_u32 s29, s53, s27
  s_add_u32 s29, s29, 6144
  buffer_load_dwordx4 v2, s[8:11], s29 offen sc1 lds
  v_exp_f32 v79, v79
  v_cvt_pk_bf16_f32 v102, v76, v77
  v_cvt_pk_bf16_f32 v103, v78, v79
  s_waitcnt lgkmcnt(4)
  v_mfma_f32_32x32x16_bf16 v[112:127], v[48:51], v[96:99], v[112:127]
  v_exp_f32 v80, v80
  v_exp_f32 v81, v81
  v_exp_f32 v82, v82
  v_exp_f32 v83, v83
  v_mfma_f32_32x32x16_bf16 v[112:127], v[52:55], v[100:103], v[112:127]
  v_cvt_pk_bf16_f32 v104, v80, v81
  v_exp_f32 v84, v84
  v_exp_f32 v85, v85
  v_cvt_pk_bf16_f32 v105, v82, v83
  v_exp_f32 v86, v86
  s_waitcnt lgkmcnt(2)
  v_mfma_f32_32x32x16_bf16 v[64:79], v[40:43], v[192:195], 0
  v_exp_f32 v87, v87
  v_cvt_pk_bf16_f32 v106, v84, v85
  v_exp_f32 v88, v88
  v_exp_f32 v89, v89
  v_cvt_pk_bf16_f32 v107, v86, v87
  v_mfma_f32_32x32x16_bf16 v[64:79], v[44:47], v[196:199], v[64:79]
  v_exp_f32 v90, v90
  v_exp_f32 v91, v91
  ds_read_b128 v[32:35], v4 offset:16384
  v_cvt_pk_bf16_f32 v108, v88, v89
  v_exp_f32 v92, v92
  v_exp_f32 v93, v93
  ds_read_b128 v[36:39], v4 offset:17408
  v_cvt_pk_bf16_f32 v109, v90, v91
  v_exp_f32 v94, v94
  v_exp_f32 v95, v95
  v_cvt_pk_bf16_f32 v110, v92, v93
  v_cvt_pk_bf16_f32 v111, v94, v95
  v_mfma_f32_32x32x16_bf16 v[128:143], v[48:51], v[104:107], v[128:143]
  v_exp_f32 v64, v64
  v_exp_f32 v65, v65
  v_exp_f32 v66, v66
  v_exp_f32 v67, v67
  v_mfma_f32_32x32x16_bf16 v[128:143], v[52:55], v[108:111], v[128:143]
  v_cvt_pk_bf16_f32 v96, v64, v65
  v_exp_f32 v68, v68
  v_exp_f32 v69, v69
  v_cvt_pk_bf16_f32 v97, v66, v67
  v_exp_f32 v70, v70
  v_mfma_f32_32x32x16_bf16 v[80:95], v[40:43], v[200:203], 0
  v_exp_f32 v71, v71
  v_cvt_pk_bf16_f32 v98, v68, v69
  v_exp_f32 v72, v72
  v_exp_f32 v73, v73
  v_cvt_pk_bf16_f32 v99, v70, v71
  v_mfma_f32_32x32x16_bf16 v[80:95], v[44:47], v[204:207], v[80:95]
  v_exp_f32 v74, v74
  v_exp_f32 v75, v75
  ds_read_b128 v[48:51], v4 offset:49152
  v_cvt_pk_bf16_f32 v100, v72, v73
  v_exp_f32 v76, v76
  v_exp_f32 v77, v77
  ds_read_b128 v[52:55], v4 offset:50176
  v_cvt_pk_bf16_f32 v101, v74, v75
  v_exp_f32 v78, v78
  s_add_u32 m0, s31, 7168
  s_add_u32 s29, s53, s27
  s_add_u32 s29, s29, 7168
  buffer_load_dwordx4 v2, s[8:11], s29 offen sc1 lds
  v_exp_f32 v79, v79
  v_cvt_pk_bf16_f32 v102, v76, v77
  v_cvt_pk_bf16_f32 v103, v78, v79
  s_waitcnt lgkmcnt(4)
  v_mfma_f32_32x32x16_bf16 v[112:127], v[56:59], v[96:99], v[112:127]
  v_exp_f32 v80, v80
  v_exp_f32 v81, v81
  v_exp_f32 v82, v82
  v_exp_f32 v83, v83
  v_mfma_f32_32x32x16_bf16 v[112:127], v[60:63], v[100:103], v[112:127]
  v_cvt_pk_bf16_f32 v104, v80, v81
  v_exp_f32 v84, v84
  v_exp_f32 v85, v85
  v_cvt_pk_bf16_f32 v105, v82, v83
  v_exp_f32 v86, v86
  s_waitcnt lgkmcnt(2)
  v_mfma_f32_32x32x16_bf16 v[64:79], v[32:35], v[192:195], 0
  v_exp_f32 v87, v87
  v_cvt_pk_bf16_f32 v106, v84, v85
  v_exp_f32 v88, v88
  v_exp_f32 v89, v89
  v_cvt_pk_bf16_f32 v107, v86, v87
  v_mfma_f32_32x32x16_bf16 v[64:79], v[36:39], v[196:199], v[64:79]
  v_exp_f32 v90, v90
  v_exp_f32 v91, v91
  ds_read_b128 v[40:43], v4 offset:18432
  v_cvt_pk_bf16_f32 v108, v88, v89
  v_exp_f32 v92, v92
  v_exp_f32 v93, v93
  ds_read_b128 v[44:47], v4 offset:19456
  v_cvt_pk_bf16_f32 v109, v90, v91
  v_exp_f32 v94, v94
  v_exp_f32 v95, v95
  v_cvt_pk_bf16_f32 v110, v92, v93
  v_cvt_pk_bf16_f32 v111, v94, v95
  v_mfma_f32_32x32x16_bf16 v[128:143], v[56:59], v[104:107], v[128:143]
  v_exp_f32 v64, v64
  v_exp_f32 v65, v65
  v_exp_f32 v66, v66
  v_exp_f32 v67, v67
  v_mfma_f32_32x32x16_bf16 v[128:143], v[60:63], v[108:111], v[128:143]
  v_cvt_pk_bf16_f32 v96, v64, v65
  v_exp_f32 v68, v68
  v_exp_f32 v69, v69
  v_cvt_pk_bf16_f32 v97, v66, v67
  v_exp_f32 v70, v70
  v_mfma_f32_32x32x16_bf16 v[80:95], v[32:35], v[200:203], 0
  v_exp_f32 v71, v71
  v_cvt_pk_bf16_f32 v98, v68, v69
  v_exp_f32 v72, v72
  v_exp_f32 v73, v73
  v_cvt_pk_bf16_f32 v99, v70, v71
  v_mfma_f32_32x32x16_bf16 v[80:95], v[36:39], v[204:207], v[80:95]
  v_exp_f32 v74, v74
  v_exp_f32 v75, v75
  ds_read_b128 v[56:59], v4 offset:51200
  v_cvt_pk_bf16_f32 v100, v72, v73
  v_exp_f32 v76, v76
  v_exp_f32 v77, v77
  ds_read_b128 v[60:63], v4 offset:52224
  v_cvt_pk_bf16_f32 v101, v74, v75
  v_exp_f32 v78, v78
  s_add_u32 m0, s31, 32768
  s_add_u32 s29, s53, s28
  s_add_u32 s29, s29, 0
  buffer_load_dwordx4 v2, s[8:11], s29 offen sc1 lds
  v_exp_f32 v79, v79
  v_cvt_pk_bf16_f32 v102, v76, v77
  v_cvt_pk_bf16_f32 v103, v78, v79
  s_waitcnt lgkmcnt(4)
  v_mfma_f32_32x32x16_bf16 v[112:127], v[48:51], v[96:99], v[112:127]
  v_exp_f32 v80, v80
  v_exp_f32 v81, v81
  v_exp_f32 v82, v82
  v_exp_f32 v83, v83
  v_mfma_f32_32x32x16_bf16 v[112:127], v[52:55], v[100:103], v[112:127]
  v_cvt_pk_bf16_f32 v104, v80, v81
  v_exp_f32 v84, v84
  v_exp_f32 v85, v85
  v_cvt_pk_bf16_f32 v105, v82, v83
  v_exp_f32 v86, v86
  s_waitcnt lgkmcnt(2)
  v_mfma_f32_32x32x16_bf16 v[64:79], v[40:43], v[192:195], 0
  v_exp_f32 v87, v87
  v_cvt_pk_bf16_f32 v106, v84, v85
  v_exp_f32 v88, v88
  v_exp_f32 v89, v89
  v_cvt_pk_bf16_f32 v107, v86, v87
  v_mfma_f32_32x32x16_bf16 v[64:79], v[44:47], v[196:199], v[64:79]
  v_exp_f32 v90, v90
  v_exp_f32 v91, v91
  ds_read_b128 v[32:35], v4 offset:20480
  v_cvt_pk_bf16_f32 v108, v88, v89
  v_exp_f32 v92, v92
  v_exp_f32 v93, v93
  ds_read_b128 v[36:39], v4 offset:21504
  v_cvt_pk_bf16_f32 v109, v90, v91
  v_exp_f32 v94, v94
  v_exp_f32 v95, v95
  v_cvt_pk_bf16_f32 v110, v92, v93
  v_cvt_pk_bf16_f32 v111, v94, v95
  v_mfma_f32_32x32x16_bf16 v[128:143], v[48:51], v[104:107], v[128:143]
  v_exp_f32 v64, v64
  v_exp_f32 v65, v65
  v_exp_f32 v66, v66
  v_exp_f32 v67, v67
  v_mfma_f32_32x32x16_bf16 v[128:143], v[52:55], v[108:111], v[128:143]
  v_cvt_pk_bf16_f32 v96, v64, v65
  v_exp_f32 v68, v68
  v_exp_f32 v69, v69
  v_cvt_pk_bf16_f32 v97, v66, v67
  v_exp_f32 v70, v70
  v_mfma_f32_32x32x16_bf16 v[80:95], v[40:43], v[200:203], 0
  v_exp_f32 v71, v71
  v_cvt_pk_bf16_f32 v98, v68, v69
  v_exp_f32 v72, v72
  v_exp_f32 v73, v73
  v_cvt_pk_bf16_f32 v99, v70, v71
  v_mfma_f32_32x32x16_bf16 v[80:95], v[44:47], v[204:207], v[80:95]
  v_exp_f32 v74, v74
  v_exp_f32 v75, v75
  ds_read_b128 v[48:51], v4 offset:53248
  v_cvt_pk_bf16_f32 v100, v72, v73
  v_exp_f32 v76, v76
  v_exp_f32 v77, v77
  ds_read_b128 v[52:55], v4 offset:54272
  v_cvt_pk_bf16_f32 v101, v74, v75
  v_exp_f32 v78, v78
  s_add_u32 m0, s31, 33792
  s_add_u32 s29, s53, s28
  s_add_u32 s29, s29, 1024
  buffer_load_dwordx4 v2, s[8:11], s29 offen sc1 lds
  v_exp_f32 v79, v79
  v_cvt_pk_bf16_f32 v102, v76, v77
  v_cvt_pk_bf16_f32 v103, v78, v79
  s_waitcnt lgkmcnt(4)
  v_mfma_f32_32x32x16_bf16 v[112:127], v[56:59], v[96:99], v[112:127]
  v_exp_f32 v80, v80
  v_exp_f32 v81, v81
  v_exp_f32 v82, v82
  v_exp_f32 v83, v83
  v_mfma_f32_32x32x16_bf16 v[112:127], v[60:63], v[100:103], v[112:127]
  v_cvt_pk_bf16_f32 v104, v80, v81
  v_exp_f32 v84, v84
  v_exp_f32 v85, v85
  v_cvt_pk_bf16_f32 v105, v82, v83
  v_exp_f32 v86, v86
  s_waitcnt lgkmcnt(2)
  v_mfma_f32_32x32x16_bf16 v[64:79], v[32:35], v[192:195], 0
  v_exp_f32 v87, v87
  v_cvt_pk_bf16_f32 v106, v84, v85
  v_exp_f32 v88, v88
  v_exp_f32 v89, v89
  v_cvt_pk_bf16_f32 v107, v86, v87
  v_mfma_f32_32x32x16_bf16 v[64:79], v[36:39], v[196:199], v[64:79]
  v_exp_f32 v90, v90
  v_exp_f32 v91, v91
  ds_read_b128 v[40:43], v4 offset:22528
  v_cvt_pk_bf16_f32 v108, v88, v89
  v_exp_f32 v92, v92
  v_exp_f32 v93, v93
  ds_read_b128 v[44:47], v4 offset:23552
  v_cvt_pk_bf16_f32 v109, v90, v91
  v_exp_f32 v94, v94
  v_exp_f32 v95, v95
  v_cvt_pk_bf16_f32 v110, v92, v93
  v_cvt_pk_bf16_f32 v111, v94, v95
  v_mfma_f32_32x32x16_bf16 v[128:143], v[56:59], v[104:107], v[128:143]
  v_exp_f32 v64, v64
  v_exp_f32 v65, v65
  v_exp_f32 v66, v66
  v_exp_f32 v67, v67
  v_mfma_f32_32x32x16_bf16 v[128:143], v[60:63], v[108:111], v[128:143]
  v_cvt_pk_bf16_f32 v96, v64, v65
  v_exp_f32 v68, v68
  v_exp_f32 v69, v69
  v_cvt_pk_bf16_f32 v97, v66, v67
  v_exp_f32 v70, v70
  v_mfma_f32_32x32x16_bf16 v[80:95], v[32:35], v[200:203], 0
  v_exp_f32 v71, v71
  v_cvt_pk_bf16_f32 v98, v68, v69
  v_exp_f32 v72, v72
  v_exp_f32 v73, v73
  v_cvt_pk_bf16_f32 v99, v70, v71
  v_mfma_f32_32x32x16_bf16 v[80:95], v[36:39], v[204:207], v[80:95]
  v_exp_f32 v74, v74
  v_exp_f32 v75, v75
  ds_read_b128 v[56:59], v4 offset:55296
  v_cvt_pk_bf16_f32 v100, v72, v73
  v_exp_f32 v76, v76
  v_exp_f32 v77, v77
  ds_read_b128 v[60:63], v4 offset:56320
  v_cvt_pk_bf16_f32 v101, v74, v75
  v_exp_f32 v78, v78
  s_add_u32 m0, s31, 34816
  s_add_u32 s29, s53, s28
  s_add_u32 s29, s29, 2048
  buffer_load_dwordx4 v2, s[8:11], s29 offen sc1 lds
  v_exp_f32 v79, v79
  v_cvt_pk_bf16_f32 v102, v76, v77
  v_cvt_pk_bf16_f32 v103, v78, v79
  s_waitcnt lgkmcnt(4)
  v_mfma_f32_32x32x16_bf16 v[112:127], v[48:51], v[96:99], v[112:127]
  v_exp_f32 v80, v80
  v_exp_f32 v81, v81
  v_exp_f32 v82, v82
  v_exp_f32 v83, v83
  v_mfma_f32_32x32x16_bf16 v[112:127], v[52:55], v[100:103], v[112:127]
  v_cvt_pk_bf16_f32 v104, v80, v81
  v_exp_f32 v84, v84
  v_exp_f32 v85, v85
  v_cvt_pk_bf16_f32 v105, v82, v83
  v_exp_f32 v86, v86
  s_waitcnt lgkmcnt(2)
  v_mfma_f32_32x32x16_bf16 v[64:79], v[40:43], v[192:195], 0
  v_exp_f32 v87, v87
  v_cvt_pk_bf16_f32 v106, v84, v85
  v_exp_f32 v88, v88
  v_exp_f32 v89, v89
  v_cvt_pk_bf16_f32 v107, v86, v87
  v_mfma_f32_32x32x16_bf16 v[64:79], v[44:47], v[196:199], v[64:79]
  v_exp_f32 v90, v90
  v_exp_f32 v91, v91
  ds_read_b128 v[32:35], v4 offset:24576
  v_cvt_pk_bf16_f32 v108, v88, v89
  v_exp_f32 v92, v92
  v_exp_f32 v93, v93
  ds_read_b128 v[36:39], v4 offset:25600
  v_cvt_pk_bf16_f32 v109, v90, v91
  v_exp_f32 v94, v94
  v_exp_f32 v95, v95
  v_cvt_pk_bf16_f32 v110, v92, v93
  v_cvt_pk_bf16_f32 v111, v94, v95
  v_mfma_f32_32x32x16_bf16 v[128:143], v[48:51], v[104:107], v[128:143]
  v_exp_f32 v64, v64
  v_exp_f32 v65, v65
  v_exp_f32 v66, v66
  v_exp_f32 v67, v67
  v_mfma_f32_32x32x16_bf16 v[128:143], v[52:55], v[108:111], v[128:143]
  v_cvt_pk_bf16_f32 v96, v64, v65
  v_exp_f32 v68, v68
  v_exp_f32 v69, v69
  v_cvt_pk_bf16_f32 v97, v66, v67
  v_exp_f32 v70, v70
  v_mfma_f32_32x32x16_bf16 v[80:95], v[40:43], v[200:203], 0
  v_exp_f32 v71, v71
  v_cvt_pk_bf16_f32 v98, v68, v69
  v_exp_f32 v72, v72
  v_exp_f32 v73, v73
  v_cvt_pk_bf16_f32 v99, v70, v71
  v_mfma_f32_32x32x16_bf16 v[80:95], v[44:47], v[204:207], v[80:95]
  v_exp_f32 v74, v74
  v_exp_f32 v75, v75
  ds_read_b128 v[48:51], v4 offset:57344
  v_cvt_pk_bf16_f32 v100, v72, v73
  v_exp_f32 v76, v76
  v_exp_f32 v77, v77
  ds_read_b128 v[52:55], v4 offset:58368
  v_cvt_pk_bf16_f32 v101, v74, v75
  v_exp_f32 v78, v78
  s_add_u32 m0, s31, 35840
  s_add_u32 s29, s53, s28
  s_add_u32 s29, s29, 3072
  buffer_load_dwordx4 v2, s[8:11], s29 offen sc1 lds
  v_exp_f32 v79, v79
  v_cvt_pk_bf16_f32 v102, v76, v77
  v_cvt_pk_bf16_f32 v103, v78, v79
  s_waitcnt lgkmcnt(4)
  v_mfma_f32_32x32x16_bf16 v[112:127], v[56:59], v[96:99], v[112:127]
  v_exp_f32 v80, v80
  v_exp_f32 v81, v81
  v_exp_f32 v82, v82
  v_exp_f32 v83, v83
  v_mfma_f32_32x32x16_bf16 v[112:127], v[60:63], v[100:103], v[112:127]
  v_cvt_pk_bf16_f32 v104, v80, v81
  v_exp_f32 v84, v84
  v_exp_f32 v85, v85
  v_cvt_pk_bf16_f32 v105, v82, v83
  v_exp_f32 v86, v86
  s_waitcnt lgkmcnt(2)
  v_mfma_f32_32x32x16_bf16 v[64:79], v[32:35], v[192:195], 0
  v_exp_f32 v87, v87
  v_cvt_pk_bf16_f32 v106, v84, v85
  v_exp_f32 v88, v88
  v_exp_f32 v89, v89
  v_cvt_pk_bf16_f32 v107, v86, v87
  v_mfma_f32_32x32x16_bf16 v[64:79], v[36:39], v[196:199], v[64:79]
  v_exp_f32 v90, v90
  v_exp_f32 v91, v91
  ds_read_b128 v[40:43], v4 offset:26624
  v_cvt_pk_bf16_f32 v108, v88, v89
  v_exp_f32 v92, v92
  v_exp_f32 v93, v93
  ds_read_b128 v[44:47], v4 offset:27648
  v_cvt_pk_bf16_f32 v109, v90, v91
  v_exp_f32 v94, v94
  v_exp_f32 v95, v95
  v_cvt_pk_bf16_f32 v110, v92, v93
  v_cvt_pk_bf16_f32 v111, v94, v95
  v_mfma_f32_32x32x16_bf16 v[128:143], v[56:59], v[104:107], v[128:143]
  v_exp_f32 v64, v64
  v_exp_f32 v65, v65
  v_exp_f32 v66, v66
  v_exp_f32 v67, v67
  v_mfma_f32_32x32x16_bf16 v[128:143], v[60:63], v[108:111], v[128:143]
  v_cvt_pk_bf16_f32 v96, v64, v65
  v_exp_f32 v68, v68
  v_exp_f32 v69, v69
  v_cvt_pk_bf16_f32 v97, v66, v67
  v_exp_f32 v70, v70
  v_mfma_f32_32x32x16_bf16 v[80:95], v[32:35], v[200:203], 0
  v_exp_f32 v71, v71
  v_cvt_pk_bf16_f32 v98, v68, v69
  v_exp_f32 v72, v72
  v_exp_f32 v73, v73
  v_cvt_pk_bf16_f32 v99, v70, v71
  v_mfma_f32_32x32x16_bf16 v[80:95], v[36:39], v[204:207], v[80:95]
  v_exp_f32 v74, v74
  v_exp_f32 v75, v75
  ds_read_b128 v[56:59], v4 offset:59392
  v_cvt_pk_bf16_f32 v100, v72, v73
  v_exp_f32 v76, v76
  v_exp_f32 v77, v77
  ds_read_b128 v[60:63], v4 offset:60416
  v_cvt_pk_bf16_f32 v101, v74, v75
  v_exp_f32 v78, v78
  s_add_u32 m0, s31, 36864
  s_add_u32 s29, s53, s28
  s_add_u32 s29, s29, 4096
  buffer_load_dwordx4 v2, s[8:11], s29 offen sc1 lds
  v_exp_f32 v79, v79
  v_cvt_pk_bf16_f32 v102, v76, v77
  v_cvt_pk_bf16_f32 v103, v78, v79
  s_waitcnt lgkmcnt(4)
  v_mfma_f32_32x32x16_bf16 v[112:127], v[48:51], v[96:99], v[112:127]
  v_exp_f32 v80, v80
  v_exp_f32 v81, v81
  v_exp_f32 v82, v82
  v_exp_f32 v83, v83
  v_mfma_f32_32x32x16_bf16 v[112:127], v[52:55], v[100:103], v[112:127]
  v_cvt_pk_bf16_f32 v104, v80, v81
  v_exp_f32 v84, v84
  v_exp_f32 v85, v85
  v_cvt_pk_bf16_f32 v105, v82, v83
  v_exp_f32 v86, v86
  s_waitcnt lgkmcnt(2)
  v_mfma_f32_32x32x16_bf16 v[64:79], v[40:43], v[192:195], 0
  v_exp_f32 v87, v87
  v_cvt_pk_bf16_f32 v106, v84, v85
  v_exp_f32 v88, v88
  v_exp_f32 v89, v89
  v_cvt_pk_bf16_f32 v107, v86, v87
  v_mfma_f32_32x32x16_bf16 v[64:79], v[44:47], v[196:199], v[64:79]
  v_exp_f32 v90, v90
  v_exp_f32 v91, v91
  ds_read_b128 v[32:35], v4 offset:28672
  v_cvt_pk_bf16_f32 v108, v88, v89
  v_exp_f32 v92, v92
  v_exp_f32 v93, v93
  ds_read_b128 v[36:39], v4 offset:29696
  v_cvt_pk_bf16_f32 v109, v90, v91
  v_exp_f32 v94, v94
  v_exp_f32 v95, v95
  v_cvt_pk_bf16_f32 v110, v92, v93
  v_cvt_pk_bf16_f32 v111, v94, v95
  v_mfma_f32_32x32x16_bf16 v[128:143], v[48:51], v[104:107], v[128:143]
  v_exp_f32 v64, v64
  v_exp_f32 v65, v65
  v_exp_f32 v66, v66
  v_exp_f32 v67, v67
  v_mfma_f32_32x32x16_bf16 v[128:143], v[52:55], v[108:111], v[128:143]
  v_cvt_pk_bf16_f32 v96, v64, v65
  v_exp_f32 v68, v68
  v_exp_f32 v69, v69
  v_cvt_pk_bf16_f32 v97, v66, v67
  v_exp_f32 v70, v70
  v_mfma_f32_32x32x16_bf16 v[80:95], v[40:43], v[200:203], 0
  v_exp_f32 v71, v71
  v_cvt_pk_bf16_f32 v98, v68, v69
  v_exp_f32 v72, v72
  v_exp_f32 v73, v73
  v_cvt_pk_bf16_f32 v99, v70, v71
  v_mfma_f32_32x32x16_bf16 v[80:95], v[44:47], v[204:207], v[80:95]
  v_exp_f32 v74, v74
  v_exp_f32 v75, v75
  ds_read_b128 v[48:51], v4 offset:61440
  v_cvt_pk_bf16_f32 v100, v72, v73
  v_exp_f32 v76, v76
  v_exp_f32 v77, v77
  ds_read_b128 v[52:55], v4 offset:62464
  v_cvt_pk_bf16_f32 v101, v74, v75
  v_exp_f32 v78, v78
  s_add_u32 m0, s31, 37888
  s_add_u32 s29, s53, s28
  s_add_u32 s29, s29, 5120
  buffer_load_dwordx4 v2, s[8:11], s29 offen sc1 lds
  v_exp_f32 v79, v79
  v_cvt_pk_bf16_f32 v102, v76, v77
  v_cvt_pk_bf16_f32 v103, v78, v79
  s_waitcnt lgkmcnt(4)
  v_mfma_f32_32x32x16_bf16 v[112:127], v[56:59], v[96:99], v[112:127]
  v_exp_f32 v80, v80
  v_exp_f32 v81, v81
  v_exp_f32 v82, v82
  v_exp_f32 v83, v83
  v_mfma_f32_32x32x16_bf16 v[112:127], v[60:63], v[100:103], v[112:127]
  v_cvt_pk_bf16_f32 v104, v80, v81
  v_exp_f32 v84, v84
  v_exp_f32 v85, v85
  v_cvt_pk_bf16_f32 v105, v82, v83
  v_exp_f32 v86, v86
  s_waitcnt lgkmcnt(2)
  v_mfma_f32_32x32x16_bf16 v[64:79], v[32:35], v[192:195], 0
  v_exp_f32 v87, v87
  v_cvt_pk_bf16_f32 v106, v84, v85
  v_exp_f32 v88, v88
  v_exp_f32 v89, v89
  v_cvt_pk_bf16_f32 v107, v86, v87
  v_mfma_f32_32x32x16_bf16 v[64:79], v[36:39], v[196:199], v[64:79]
  v_exp_f32 v90, v90
  v_exp_f32 v91, v91
  ds_read_b128 v[40:43], v4 offset:30720
  v_cvt_pk_bf16_f32 v108, v88, v89
  v_exp_f32 v92, v92
  v_exp_f32 v93, v93
  ds_read_b128 v[44:47], v4 offset:31744
  v_cvt_pk_bf16_f32 v109, v90, v91
  v_exp_f32 v94, v94
  v_exp_f32 v95, v95
  v_cvt_pk_bf16_f32 v110, v92, v93
  v_cvt_pk_bf16_f32 v111, v94, v95
  v_mfma_f32_32x32x16_bf16 v[128:143], v[56:59], v[104:107], v[128:143]
  v_exp_f32 v64, v64
  v_exp_f32 v65, v65
  v_exp_f32 v66, v66
  v_exp_f32 v67, v67
  v_mfma_f32_32x32x16_bf16 v[128:143], v[60:63], v[108:111], v[128:143]
  v_cvt_pk_bf16_f32 v96, v64, v65
  v_exp_f32 v68, v68
  v_exp_f32 v69, v69
  v_cvt_pk_bf16_f32 v97, v66, v67
  v_exp_f32 v70, v70
  v_mfma_f32_32x32x16_bf16 v[80:95], v[32:35], v[200:203], 0
  v_exp_f32 v71, v71
  v_cvt_pk_bf16_f32 v98, v68, v69
  v_exp_f32 v72, v72
  v_exp_f32 v73, v73
  v_cvt_pk_bf16_f32 v99, v70, v71
  v_mfma_f32_32x32x16_bf16 v[80:95], v[36:39], v[204:207], v[80:95]
  v_exp_f32 v74, v74
  v_exp_f32 v75, v75
  ds_read_b128 v[56:59], v4 offset:63488
  v_cvt_pk_bf16_f32 v100, v72, v73
  v_exp_f32 v76, v76
  v_exp_f32 v77, v77
  ds_read_b128 v[60:63], v4 offset:64512
  v_cvt_pk_bf16_f32 v101, v74, v75
  v_exp_f32 v78, v78
  s_add_u32 m0, s31, 38912
  s_add_u32 s29, s53, s28
  s_add_u32 s29, s29, 6144
  buffer_load_dwordx4 v2, s[8:11], s29 offen sc1 lds
  v_exp_f32 v79, v79
  v_cvt_pk_bf16_f32 v102, v76, v77
  v_cvt_pk_bf16_f32 v103, v78, v79
  s_waitcnt lgkmcnt(4)
  v_mfma_f32_32x32x16_bf16 v[112:127], v[48:51], v[96:99], v[112:127]
  v_exp_f32 v80, v80
  v_exp_f32 v81, v81
  v_exp_f32 v82, v82
  v_exp_f32 v83, v83
  v_mfma_f32_32x32x16_bf16 v[112:127], v[52:55], v[100:103], v[112:127]
  v_cvt_pk_bf16_f32 v104, v80, v81
  v_exp_f32 v84, v84
  v_exp_f32 v85, v85
  v_cvt_pk_bf16_f32 v105, v82, v83
  v_exp_f32 v86, v86
  s_waitcnt lgkmcnt(2)
  v_mfma_f32_32x32x16_bf16 v[64:79], v[40:43], v[192:195], 0
  v_exp_f32 v87, v87
  v_cvt_pk_bf16_f32 v106, v84, v85
  v_exp_f32 v88, v88
  v_exp_f32 v89, v89
  v_cvt_pk_bf16_f32 v107, v86, v87
  v_mfma_f32_32x32x16_bf16 v[64:79], v[44:47], v[196:199], v[64:79]
  v_exp_f32 v90, v90
  v_exp_f32 v91, v91
  v_cvt_pk_bf16_f32 v108, v88, v89
  v_exp_f32 v92, v92
  v_exp_f32 v93, v93
  v_cvt_pk_bf16_f32 v109, v90, v91
  v_exp_f32 v94, v94
  v_exp_f32 v95, v95
  v_cvt_pk_bf16_f32 v110, v92, v93
  v_cvt_pk_bf16_f32 v111, v94, v95
  v_mfma_f32_32x32x16_bf16 v[128:143], v[48:51], v[104:107], v[128:143]
  v_exp_f32 v64, v64
  v_exp_f32 v65, v65
  v_exp_f32 v66, v66
  v_exp_f32 v67, v67
  v_mfma_f32_32x32x16_bf16 v[128:143], v[52:55], v[108:111], v[128:143]
  v_cvt_pk_bf16_f32 v96, v64, v65
  v_exp_f32 v68, v68
  v_exp_f32 v69, v69
  v_cvt_pk_bf16_f32 v97, v66, v67
  v_exp_f32 v70, v70
  v_mfma_f32_32x32x16_bf16 v[80:95], v[40:43], v[200:203], 0
  v_exp_f32 v71, v71
  v_cvt_pk_bf16_f32 v98, v68, v69
  v_exp_f32 v72, v72
  v_exp_f32 v73, v73
  v_cvt_pk_bf16_f32 v99, v70, v71
  v_mfma_f32_32x32x16_bf16 v[80:95], v[44:47], v[204:207], v[80:95]
  v_exp_f32 v74, v74
  v_exp_f32 v75, v75
  v_cvt_pk_bf16_f32 v100, v72, v73
  v_exp_f32 v76, v76
  v_exp_f32 v77, v77
  v_cvt_pk_bf16_f32 v101, v74, v75
  v_exp_f32 v78, v78
  s_add_u32 m0, s31, 39936
  s_add_u32 s29, s53, s28
  s_add_u32 s29, s29, 7168
  buffer_load_dwordx4 v2, s[8:11], s29 offen sc1 lds
  v_exp_f32 v79, v79
  v_cvt_pk_bf16_f32 v102, v76, v77
  v_cvt_pk_bf16_f32 v103, v78, v79
  s_waitcnt lgkmcnt(0)
  v_mfma_f32_32x32x16_bf16 v[112:127], v[56:59], v[96:99], v[112:127]
  v_exp_f32 v80, v80
  v_exp_f32 v81, v81
  v_exp_f32 v82, v82
  v_exp_f32 v83, v83
  v_mfma_f32_32x32x16_bf16 v[112:127], v[60:63], v[100:103], v[112:127]
  v_cvt_pk_bf16_f32 v104, v80, v81
  v_exp_f32 v84, v84
  v_exp_f32 v85, v85
  v_cvt_pk_bf16_f32 v105, v82, v83
  v_exp_f32 v86, v86
  v_exp_f32 v87, v87
  v_cvt_pk_bf16_f32 v106, v84, v85
  v_exp_f32 v88, v88
  v_exp_f32 v89, v89
  v_cvt_pk_bf16_f32 v107, v86, v87
  v_exp_f32 v90, v90
  v_exp_f32 v91, v91
  v_cvt_pk_bf16_f32 v108, v88, v89
  v_exp_f32 v92, v92
  v_exp_f32 v93, v93
  v_cvt_pk_bf16_f32 v109, v90, v91
  v_exp_f32 v94, v94
  v_exp_f32 v95, v95
  v_cvt_pk_bf16_f32 v110, v92, v93
  v_cvt_pk_bf16_f32 v111, v94, v95
  s_nop 1
  v_mfma_f32_32x32x16_bf16 v[128:143], v[56:59], v[104:107], v[128:143]
  v_mfma_f32_32x32x16_bf16 v[128:143], v[60:63], v[108:111], v[128:143]
  s_cmp_lt_u32 s41, 4
  s_cbranch_scc1 kb2_chunk2
  s_nop 11
  v_mov_b32 v5, v120
  v_mov_b32 v6, v120
  s_nop 1
  v_permlane32_swap_b32 v5, v6
  v_mov_b32 v14, v6
  v_mov_b32 v5, v136
  v_mov_b32 v6, v136
  s_nop 1
  v_permlane32_swap_b32 v5, v6
  v_mov_b32 v15, v6
  s_cmp_eq_u32 s40, 0
  s_cbranch_scc0 kb2_fin
  v_min_f32 v5, v14, v15
  v_cmp_gt_f32 vcc, 0x12800000, v5
  v_cmp_u_f32 s[36:37], v5, v5
  s_nop 1
  s_or_b64 vcc, vcc, s[36:37]
  s_cmp_lg_u64 vcc, 0
  s_cselect_b32 s42, 1, 0
  v_mov_b32 v5, s42
  s_lshl_b32 s30, s21, 2
  s_add_u32 s30, s30, 131584
  v_mov_b32 v6, s30
  ds_write_b32 v6, v5
  s_waitcnt vmcnt(0) lgkmcnt(0)
  s_barrier
  v_mov_b32 v6, 131584
  ds_read_b128 v[8:11], v6
  s_waitcnt lgkmcnt(0)
  v_or_b32 v8, v8, v9
  v_or_b32 v10, v10, v11
  v_or_b32 v8, v8, v10
  s_nop 0
  v_readfirstlane_b32 s42, v8
  s_cmp_eq_u32 s42, 0
  s_cbranch_scc1 kb2_fin
  s_mov_b32 s40, 1
  v_and_b32 v5, 0xffff0000, v198
  v_cndmask_b32 v198, v198, v5, s[34:35]
  v_mov_b32 v12, 0xff7fffff
  v_and_b32 v5, 0xffff0000, v206
  v_cndmask_b32 v206, v206, v5, s[34:35]
  v_mov_b32 v13, 0xff7fffff
  s_mov_b32 s41, 0
kb2_mx:
  s_lshl_b32 s30, s41, 11
  s_add_u32 s30, s30, s27
  buffer_load_dwordx4 v[32:35], v2, s[8:11], s30 offen sc1
  buffer_load_dwordx4 v[36:39], v2, s[8:11], s30 offen offset:1024 sc1
  s_waitcnt vmcnt(0)
  v_mfma_f32_32x32x16_bf16 v[64:79], v[32:35], v[192:195], 0
  v_mfma_f32_32x32x16_bf16 v[64:79], v[36:39], v[196:199], v[64:79]
  v_mfma_f32_32x32x16_bf16 v[80:95], v[32:35], v[200:203], 0
  v_mfma_f32_32x32x16_bf16 v[80:95], v[36:39], v[204:207], v[80:95]
  s_nop 11
  v_max3_f32 v12, v12, v64, v65
  v_max3_f32 v12, v12, v66, v67
  v_max3_f32 v12, v12, v68, v69
  v_max3_f32 v12, v12, v70, v71
  v_max3_f32 v12, v12, v72, v73
  v_max3_f32 v12, v12, v74, v75
  v_max3_f32 v12, v12, v76, v77
  v_max3_f32 v12, v12, v78, v79
  v_max3_f32 v13, v13, v80, v81
  v_max3_f32 v13, v13, v82, v83
  v_max3_f32 v13, v13, v84, v85
  v_max3_f32 v13, v13, v86, v87
  v_max3_f32 v13, v13, v88, v89
  v_max3_f32 v13, v13, v90, v91
  v_max3_f32 v13, v13, v92, v93
  v_max3_f32 v13, v13, v94, v95
  s_add_u32 s41, s41, 1
  s_cmp_lt_u32 s41, 64
  s_cbranch_scc1 kb2_mx
  v_mov_b32 v5, v12
  s_nop 1
  v_permlane32_swap_b32 v12, v5
  v_max_f32 v12, v12, v5
  v_cvt_pk_bf16_f32 v5, v12, v12
  v_and_b32 v5, 0xffff, v5
  v_xor_b32 v5, 0x8000, v5
  v_and_b32 v6, 0xffff0000, v198
  v_or_b32 v5, v5, v6
  v_cndmask_b32 v198, v198, v5, s[34:35]
  v_mov_b32 v5, v13
  s_nop 1
  v_permlane32_swap_b32 v13, v5
  v_max_f32 v13, v13, v5
  v_cvt_pk_bf16_f32 v5, v13, v13
  v_and_b32 v5, 0xffff, v5
  v_xor_b32 v5, 0x8000, v5
  v_and_b32 v6, 0xffff0000, v206
  v_or_b32 v5, v5, v6
  v_cndmask_b32 v206, v206, v5, s[34:35]
  s_barrier
  s_mov_b32 s41, 0
  s_mul_i32 s53, s41, 32768
  s_lshl_b32 s31, s21, 13
  s_add_u32 s53, s53, s31
  s_add_u32 m0, s31, 0
  s_add_u32 s29, s53, s27
  s_add_u32 s29, s29, 0
  buffer_load_dwordx4 v2, s[8:11], s29 offen sc1 lds
  s_add_u32 m0, s31, 1024
  s_add_u32 s29, s53, s27
  s_add_u32 s29, s29, 1024
  buffer_load_dwordx4 v2, s[8:11], s29 offen sc1 lds
  s_add_u32 m0, s31, 2048
  s_add_u32 s29, s53, s27
  s_add_u32 s29, s29, 2048
  buffer_load_dwordx4 v2, s[8:11], s29 offen sc1 lds
  s_add_u32 m0, s31, 3072
  s_add_u32 s29, s53, s27
  s_add_u32 s29, s29, 3072
  buffer_load_dwordx4 v2, s[8:11], s29 offen sc1 lds
  s_add_u32 m0, s31, 4096
  s_add_u32 s29, s53, s27
  s_add_u32 s29, s29, 4096
  buffer_load_dwordx4 v2, s[8:11], s29 offen sc1 lds
  s_add_u32 m0, s31, 5120
  s_add_u32 s29, s53, s27
  s_add_u32 s29, s29, 5120
  buffer_load_dwordx4 v2, s[8:11], s29 offen sc1 lds
  s_add_u32 m0, s31, 6144
  s_add_u32 s29, s53, s27
  s_add_u32 s29, s29, 6144
  buffer_load_dwordx4 v2, s[8:11], s29 offen sc1 lds
  s_add_u32 m0, s31, 7168
  s_add_u32 s29, s53, s27
  s_add_u32 s29, s29, 7168
  buffer_load_dwordx4 v2, s[8:11], s29 offen sc1 lds
  s_add_u32 m0, s31, 32768
  s_add_u32 s29, s53, s28
  s_add_u32 s29, s29, 0
  buffer_load_dwordx4 v2, s[8:11], s29 offen sc1 lds
  s_add_u32 m0, s31, 33792
  s_add_u32 s29, s53, s28
  s_add_u32 s29, s29, 1024
  buffer_load_dwordx4 v2, s[8:11], s29 offen sc1 lds
  s_add_u32 m0, s31, 34816
  s_add_u32 s29, s53, s28
  s_add_u32 s29, s29, 2048
  buffer_load_dwordx4 v2, s[8:11], s29 offen sc1 lds
  s_add_u32 m0, s31, 35840
  s_add_u32 s29, s53, s28
  s_add_u32 s29, s29, 3072
  buffer_load_dwordx4 v2, s[8:11], s29 offen sc1 lds
  s_add_u32 m0, s31, 36864
  s_add_u32 s29, s53, s28
  s_add_u32 s29, s29, 4096
  buffer_load_dwordx4 v2, s[8:11], s29 offen sc1 lds
  s_add_u32 m0, s31, 37888
  s_add_u32 s29, s53, s28
  s_add_u32 s29, s29, 5120
  buffer_load_dwordx4 v2, s[8:11], s29 offen sc1 lds
  s_add_u32 m0, s31, 38912
  s_add_u32 s29, s53, s28
  s_add_u32 s29, s29, 6144
  buffer_load_dwordx4 v2, s[8:11], s29 offen sc1 lds
  s_add_u32 m0, s31, 39936
  s_add_u32 s29, s53, s28
  s_add_u32 s29, s29, 7168
  buffer_load_dwordx4 v2, s[8:11], s29 offen sc1 lds
  s_branch kb2_main2
kb2_fin:
  v_and_b32 v3, 15, v1
  v_bfe_u32 v11, v1, 4, 1
  v_mul_u32_u24 v11, 20480, v11
  v_lshrrev_b32 v4, 5, v1
  s_mul_i32 s30, s22, 20
  v_lshlrev_b32 v5, 2, v4
  v_add_u32 v5, 0, v5
  v_add_u32 v5, s30, v5
  v_lshrrev_b32 v6, 5, v5
  v_lshlrev_b32 v6, 10, v6
  v_bfe_u32 v7, v5, 3, 2
  v_lshlrev_b32 v7, 4, v7
  v_add_u32 v7, v7, v3
  v_lshlrev_b32 v7, 4, v7
  v_add_u32 v6, v6, v7
  v_bfe_u32 v7, v5, 2, 1
  v_lshlrev_b32 v7, 3, v7
  v_add_u32 v6, v6, v7
  v_add_u32 v32, v6, v11
  v_lshlrev_b32 v5, 2, v4
  v_add_u32 v5, 8, v5
  v_add_u32 v5, s30, v5
  v_lshrrev_b32 v6, 5, v5
  v_lshlrev_b32 v6, 10, v6
  v_bfe_u32 v7, v5, 3, 2
  v_lshlrev_b32 v7, 4, v7
  v_add_u32 v7, v7, v3
  v_lshlrev_b32 v7, 4, v7
  v_add_u32 v6, v6, v7
  v_bfe_u32 v7, v5, 2, 1
  v_lshlrev_b32 v7, 3, v7
  v_add_u32 v6, v6, v7
  v_add_u32 v33, v6, v11
  v_lshlrev_b32 v5, 2, v4
  v_add_u32 v5, 16, v5
  v_add_u32 v5, s30, v5
  v_lshrrev_b32 v6, 5, v5
  v_lshlrev_b32 v6, 10, v6
  v_bfe_u32 v7, v5, 3, 2
  v_lshlrev_b32 v7, 4, v7
  v_add_u32 v7, v7, v3
  v_lshlrev_b32 v7, 4, v7
  v_add_u32 v6, v6, v7
  v_bfe_u32 v7, v5, 2, 1
  v_lshlrev_b32 v7, 3, v7
  v_add_u32 v6, v6, v7
  v_add_u32 v34, v6, v11
  v_mov_b32 v5, 0x40000000
  v_cndmask_b32 v34, v5, v34, s[34:35]
  v_rcp_f32 v5, v14
  s_nop 0
  v_mul_f32 v112, v112, v5
  v_mul_f32 v113, v113, v5
  v_mul_f32 v114, v114, v5
  v_mul_f32 v115, v115, v5
  v_mul_f32 v116, v116, v5
  v_mul_f32 v117, v117, v5
  v_mul_f32 v118, v118, v5
  v_mul_f32 v119, v119, v5
  v_mul_f32 v120, v120, v5
  v_mul_f32 v121, v121, v5
  v_mul_f32 v122, v122, v5
  v_mul_f32 v123, v123, v5
  v_cvt_pk_bf16_f32 v40, v112, v113
  v_cvt_pk_bf16_f32 v41, v114, v115
  v_cvt_pk_bf16_f32 v42, v116, v117
  v_cvt_pk_bf16_f32 v43, v118, v119
  v_cvt_pk_bf16_f32 v44, v120, v121
  v_cvt_pk_bf16_f32 v45, v122, v123
  s_add_u32 s31, s52, 0
  s_mul_i32 s31, s31, 40960
  s_add_u32 s31, s31, 0xf200000
  buffer_store_dwordx2 v[40:41], v32, s[8:11], s31 offen sc1
  buffer_store_dwordx2 v[42:43], v33, s[8:11], s31 offen sc1
  buffer_store_dwordx2 v[44:45], v34, s[8:11], s31 offen sc1
  v_rcp_f32 v5, v15
  s_nop 0
  v_mul_f32 v128, v128, v5
  v_mul_f32 v129, v129, v5
  v_mul_f32 v130, v130, v5
  v_mul_f32 v131, v131, v5
  v_mul_f32 v132, v132, v5
  v_mul_f32 v133, v133, v5
  v_mul_f32 v134, v134, v5
  v_mul_f32 v135, v135, v5
  v_mul_f32 v136, v136, v5
  v_mul_f32 v137, v137, v5
  v_mul_f32 v138, v138, v5
  v_mul_f32 v139, v139, v5
  v_cvt_pk_bf16_f32 v48, v128, v129
  v_cvt_pk_bf16_f32 v49, v130, v131
  v_cvt_pk_bf16_f32 v50, v132, v133
  v_cvt_pk_bf16_f32 v51, v134, v135
  v_cvt_pk_bf16_f32 v52, v136, v137
  v_cvt_pk_bf16_f32 v53, v138, v139
  s_add_u32 s31, s52, 1
  s_mul_i32 s31, s31, 40960
  s_add_u32 s31, s31, 0xf200000
  buffer_store_dwordx2 v[48:49], v32, s[8:11], s31 offen sc1
  buffer_store_dwordx2 v[50:51], v33, s[8:11], s31 offen sc1
  buffer_store_dwordx2 v[52:53], v34, s[8:11], s31 offen sc1
  s_waitcnt vmcnt(0)
  s_barrier
  s_cmp_eq_u32 s21, 0
  s_cbranch_scc0 arr_109
  s_mov_b64 s[24:25], exec
  s_mov_b64 exec, 1
  v_mov_b32 v3, 0
  v_mov_b32 v4, 1
  buffer_atomic_add v4, v3, s[8:11], s48 offen
  s_mov_b64 exec, s[24:25]
arr_109:
  v_and_b32 v5, 15, v1
  v_lshrrev_b32 v6, 4, v1
  v_and_b32 v7, 1, v6
  v_lshlrev_b32 v7, 10, v7
  v_lshrrev_b32 v8, 1, v6
  v_lshlrev_b32 v8, 5, v8
  v_add_u32 v8, v8, v5
  v_lshlrev_b32 v8, 4, v8
  v_add_u32 v9, v7, v8
  s_lshr_b32 s26, s2, 2
  s_mul_i32 s27, s26, 81920
  s_lshl_b32 s28, s50, 11
  s_add_u32 s27, s27, s28
  s_add_u32 s27, s27, 0x1400000
  s_add_u32 s28, s27, 0
  buffer_load_dwordx4 v[16:19], v9, s[8:11], s28 offen sc1
  s_add_u32 s28, s27, 256
  buffer_load_dwordx4 v[20:23], v9, s[8:11], s28 offen sc1
  s_add_u32 s28, s27, 2048
  buffer_load_dwordx4 v[24:27], v9, s[8:11], s28 offen sc1
  s_add_u32 s28, s27, 2304
  buffer_load_dwordx4 v[28:31], v9, s[8:11], s28 offen sc1
  s_cmp_lt_u32 s21, 2
  s_cbranch_scc0 g3_110
  s_add_u32 s28, s27, 4096
  buffer_load_dwordx4 v[32:35], v9, s[8:11], s28 offen sc1
  s_add_u32 s28, s27, 4352
  buffer_load_dwordx4 v[36:39], v9, s[8:11], s28 offen sc1
g3_110:
  s_mov_b32 s45, 0
  v_mov_b32 v3, 0
aw_111:
  buffer_load_dword v4, v3, s[8:11], s48 offen sc1
  s_add_u32 s45, s45, 1
  s_waitcnt vmcnt(0)
  v_readfirstlane_b32 s29, v4
  s_cmp_ge_u32 s29, 32
  s_cbranch_scc1 aw_111_ok
  s_cmp_lt_u32 s45, 400000
  s_cbranch_scc1 aw_111
  s_branch kb2_abort
aw_111_ok:
  s_mul_i32 s28, s26, 40960
  s_mul_i32 s31, s21, 10240
  s_add_u32 s28, s28, s31
  s_add_u32 s28, s28, 0xf200000
  s_add_u32 m0, s31, 0
  s_add_u32 s29, s28, 0
  buffer_load_dwordx4 v2, s[8:11], s29 offen sc1 lds
  s_add_u32 m0, s31, 1024
  s_add_u32 s29, s28, 1024
  buffer_load_dwordx4 v2, s[8:11], s29 offen sc1 lds
  s_add_u32 m0, s31, 2048
  s_add_u32 s29, s28, 2048
  buffer_load_dwordx4 v2, s[8:11], s29 offen sc1 lds
  s_add_u32 m0, s31, 3072
  s_add_u32 s29, s28, 3072
  buffer_load_dwordx4 v2, s[8:11], s29 offen sc1 lds
  s_add_u32 m0, s31, 4096
  s_add_u32 s29, s28, 4096
  buffer_load_dwordx4 v2, s[8:11], s29 offen sc1 lds
  s_add_u32 m0, s31, 5120
  s_add_u32 s29, s28, 5120
  buffer_load_dwordx4 v2, s[8:11], s29 offen sc1 lds
  s_add_u32 m0, s31, 6144
  s_add_u32 s29, s28, 6144
  buffer_load_dwordx4 v2, s[8:11], s29 offen sc1 lds
  s_add_u32 m0, s31, 7168
  s_add_u32 s29, s28, 7168
  buffer_load_dwordx4 v2, s[8:11], s29 offen sc1 lds
  s_add_u32 m0, s31, 8192
  s_add_u32 s29, s28, 8192
  buffer_load_dwordx4 v2, s[8:11], s29 offen sc1 lds
  s_add_u32 m0, s31, 9216
  s_add_u32 s29, s28, 9216
  buffer_load_dwordx4 v2, s[8:11], s29 offen sc1 lds
  s_waitcnt vmcnt(0)
  s_barrier
  ds_read_b128 v[80:83], v2 offset:0
  ds_read_b128 v[84:87], v2 offset:20480
  ds_read_b128 v[88:91], v2 offset:1024
  ds_read_b128 v[92:95], v2 offset:21504
  ds_read_b128 v[96:99], v2 offset:2048
  ds_read_b128 v[100:103], v2 offset:22528
  s_waitcnt lgkmcnt(4)
  v_mfma_f32_16x16x32_bf16 v[48:51], a[0:3], v[80:83], 0
  v_mfma_f32_16x16x32_bf16 v[52:55], a[0:3], v[84:87], 0
  v_mfma_f32_16x16x32_bf16 v[56:59], a[80:83], v[80:83], 0
  v_mfma_f32_16x16x32_bf16 v[60:63], a[80:83], v[84:87], 0
  v_mfma_f32_16x16x32_bf16 v[64:67], a[160:163], v[80:83], 0
  v_mfma_f32_16x16x32_bf16 v[68:71], a[160:163], v[84:87], 0
  ds_read_b128 v[80:83], v2 offset:3072
  ds_read_b128 v[84:87], v2 offset:23552
  s_waitcnt lgkmcnt(4)
  v_mfma_f32_16x16x32_bf16 v[48:51], a[4:7], v[88:91], v[48:51]
  v_mfma_f32_16x16x32_bf16 v[52:55], a[4:7], v[92:95], v[52:55]
  v_mfma_f32_16x16x32_bf16 v[56:59], a[84:87], v[88:91], v[56:59]
  v_mfma_f32_16x16x32_bf16 v[60:63], a[84:87], v[92:95], v[60:63]
  v_mfma_f32_16x16x32_bf16 v[64:67], a[164:167], v[88:91], v[64:67]
  v_mfma_f32_16x16x32_bf16 v[68:71], a[164:167], v[92:95], v[68:71]
  ds_read_b128 v[88:91], v2 offset:4096
  ds_read_b128 v[92:95], v2 offset:24576
  s_waitcnt lgkmcnt(4)
  v_mfma_f32_16x16x32_bf16 v[48:51], a[8:11], v[96:99], v[48:51]
  v_mfma_f32_16x16x32_bf16 v[52:55], a[8:11], v[100:103], v[52:55]
  v_mfma_f32_16x16x32_bf16 v[56:59], a[88:91], v[96:99], v[56:59]
  v_mfma_f32_16x16x32_bf16 v[60:63], a[88:91], v[100:103], v[60:63]
  v_mfma_f32_16x16x32_bf16 v[64:67], a[168:171], v[96:99], v[64:67]
  v_mfma_f32_16x16x32_bf16 v[68:71], a[168:171], v[100:103], v[68:71]
  ds_read_b128 v[96:99], v2 offset:5120
  ds_read_b128 v[100:103], v2 offset:25600
  s_waitcnt lgkmcnt(4)
  v_mfma_f32_16x16x32_bf16 v[48:51], a[12:15], v[80:83], v[48:51]
  v_mfma_f32_16x16x32_bf16 v[52:55], a[12:15], v[84:87], v[52:55]
  v_mfma_f32_16x16x32_bf16 v[56:59], a[92:95], v[80:83], v[56:59]
  v_mfma_f32_16x16x32_bf16 v[60:63], a[92:95], v[84:87], v[60:63]
  v_mfma_f32_16x16x32_bf16 v[64:67], a[172:175], v[80:83], v[64:67]
  v_mfma_f32_16x16x32_bf16 v[68:71], a[172:175], v[84:87], v[68:71]
  ds_read_b128 v[80:83], v2 offset:6144
  ds_read_b128 v[84:87], v2 offset:26624
  s_waitcnt lgkmcnt(4)
  v_mfma_f32_16x16x32_bf16 v[48:51], a[16:19], v[88:91], v[48:51]
  v_mfma_f32_16x16x32_bf16 v[52:55], a[16:19], v[92:95], v[52:55]
  v_mfma_f32_16x16x32_bf16 v[56:59], a[96:99], v[88:91], v[56:59]
  v_mfma_f32_16x16x32_bf16 v[60:63], a[96:99], v[92:95], v[60:63]
  v_mfma_f32_16x16x32_bf16 v[64:67], a[176:179], v[88:91], v[64:67]
  v_mfma_f32_16x16x32_bf16 v[68:71], a[176:179], v[92:95], v[68:71]
  ds_read_b128 v[88:91], v2 offset:7168
  ds_read_b128 v[92:95], v2 offset:27648
  s_waitcnt lgkmcnt(4)
  v_mfma_f32_16x16x32_bf16 v[48:51], a[20:23], v[96:99], v[48:51]
  v_mfma_f32_16x16x32_bf16 v[52:55], a[20:23], v[100:103], v[52:55]
  v_mfma_f32_16x16x32_bf16 v[56:59], a[100:103], v[96:99], v[56:59]
  v_mfma_f32_16x16x32_bf16 v[60:63], a[100:103], v[100:103], v[60:63]
  v_mfma_f32_16x16x32_bf16 v[64:67], a[180:183], v[96:99], v[64:67]
  v_mfma_f32_16x16x32_bf16 v[68:71], a[180:183], v[100:103], v[68:71]
  ds_read_b128 v[96:99], v2 offset:8192
  ds_read_b128 v[100:103], v2 offset:28672
  s_waitcnt lgkmcnt(4)
  v_mfma_f32_16x16x32_bf16 v[48:51], a[24:27], v[80:83], v[48:51]
  v_mfma_f32_16x16x32_bf16 v[52:55], a[24:27], v[84:87], v[52:55]
  v_mfma_f32_16x16x32_bf16 v[56:59], a[104:107], v[80:83], v[56:59]
  v_mfma_f32_16x16x32_bf16 v[60:63], a[104:107], v[84:87], v[60:63]
  v_mfma_f32_16x16x32_bf16 v[64:67], a[184:187], v[80:83], v[64:67]
  v_mfma_f32_16x16x32_bf16 v[68:71], a[184:187], v[84:87], v[68:71]
  ds_read_b128 v[80:83], v2 offset:9216
  ds_read_b128 v[84:87], v2 offset:29696
  s_waitcnt lgkmcnt(4)
  v_mfma_f32_16x16x32_bf16 v[48:51], a[28:31], v[88:91], v[48:51]
  v_mfma_f32_16x16x32_bf16 v[52:55], a[28:31], v[92:95], v[52:55]
  v_mfma_f32_16x16x32_bf16 v[56:59], a[108:111], v[88:91], v[56:59]
  v_mfma_f32_16x16x32_bf16 v[60:63], a[108:111], v[92:95], v[60:63]
  v_mfma_f32_16x16x32_bf16 v[64:67], a[188:191], v[88:91], v[64:67]
  v_mfma_f32_16x16x32_bf16 v[68:71], a[188:191], v[92:95], v[68:71]
  ds_read_b128 v[88:91], v2 offset:10240
  ds_read_b128 v[92:95], v2 offset:30720
  s_waitcnt lgkmcnt(4)
  v_mfma_f32_16x16x32_bf16 v[48:51], a[32:35], v[96:99], v[48:51]
  v_mfma_f32_16x16x32_bf16 v[52:55], a[32:35], v[100:103], v[52:55]
  v_mfma_f32_16x16x32_bf16 v[56:59], a[112:115], v[96:99], v[56:59]
  v_mfma_f32_16x16x32_bf16 v[60:63], a[112:115], v[100:103], v[60:63]
  v_mfma_f32_16x16x32_bf16 v[64:67], a[192:195], v[96:99], v[64:67]
  v_mfma_f32_16x16x32_bf16 v[68:71], a[192:195], v[100:103], v[68:71]
  ds_read_b128 v[96:99], v2 offset:11264
  ds_read_b128 v[100:103], v2 offset:31744
  s_waitcnt lgkmcnt(4)
  v_mfma_f32_16x16x32_bf16 v[48:51], a[36:39], v[80:83], v[48:51]
  v_mfma_f32_16x16x32_bf16 v[52:55], a[36:39], v[84:87], v[52:55]
  v_mfma_f32_16x16x32_bf16 v[56:59], a[116:119], v[80:83], v[56:59]
  v_mfma_f32_16x16x32_bf16 v[60:63], a[116:119], v[84:87], v[60:63]
  v_mfma_f32_16x16x32_bf16 v[64:67], a[196:199], v[80:83], v[64:67]
  v_mfma_f32_16x16x32_bf16 v[68:71], a[196:199], v[84:87], v[68:71]
  ds_read_b128 v[80:83], v2 offset:12288
  ds_read_b128 v[84:87], v2 offset:32768
  s_waitcnt lgkmcnt(4)
  v_mfma_f32_16x16x32_bf16 v[48:51], a[40:43], v[88:91], v[48:51]
  v_mfma_f32_16x16x32_bf16 v[52:55], a[40:43], v[92:95], v[52:55]
  v_mfma_f32_16x16x32_bf16 v[56:59], a[120:123], v[88:91], v[56:59]
  v_mfma_f32_16x16x32_bf16 v[60:63], a[120:123], v[92:95], v[60:63]
  v_mfma_f32_16x16x32_bf16 v[64:67], a[200:203], v[88:91], v[64:67]
  v_mfma_f32_16x16x32_bf16 v[68:71], a[200:203], v[92:95], v[68:71]
  ds_read_b128 v[88:91], v2 offset:13312
  ds_read_b128 v[92:95], v2 offset:33792
  s_waitcnt lgkmcnt(4)
  v_mfma_f32_16x16x32_bf16 v[48:51], a[44:47], v[96:99], v[48:51]
  v_mfma_f32_16x16x32_bf16 v[52:55], a[44:47], v[100:103], v[52:55]
  v_mfma_f32_16x16x32_bf16 v[56:59], a[124:127], v[96:99], v[56:59]
  v_mfma_f32_16x16x32_bf16 v[60:63], a[124:127], v[100:103], v[60:63]
  v_mfma_f32_16x16x32_bf16 v[64:67], a[204:207], v[96:99], v[64:67]
  v_mfma_f32_16x16x32_bf16 v[68:71], a[204:207], v[100:103], v[68:71]
  ds_read_b128 v[96:99], v2 offset:14336
  ds_read_b128 v[100:103], v2 offset:34816
  s_waitcnt lgkmcnt(4)
  v_mfma_f32_16x16x32_bf16 v[48:51], a[48:51], v[80:83], v[48:51]
  v_mfma_f32_16x16x32_bf16 v[52:55], a[48:51], v[84:87], v[52:55]
  v_mfma_f32_16x16x32_bf16 v[56:59], a[128:131], v[80:83], v[56:59]
  v_mfma_f32_16x16x32_bf16 v[60:63], a[128:131], v[84:87], v[60:63]
  v_mfma_f32_16x16x32_bf16 v[64:67], a[208:211], v[80:83], v[64:67]
  v_mfma_f32_16x16x32_bf16 v[68:71], a[208:211], v[84:87], v[68:71]
  ds_read_b128 v[80:83], v2 offset:15360
  ds_read_b128 v[84:87], v2 offset:35840
  s_waitcnt lgkmcnt(4)
  v_mfma_f32_16x16x32_bf16 v[48:51], a[52:55], v[88:91], v[48:51]
  v_mfma_f32_16x16x32_bf16 v[52:55], a[52:55], v[92:95], v[52:55]
  v_mfma_f32_16x16x32_bf16 v[56:59], a[132:135], v[88:91], v[56:59]
  v_mfma_f32_16x16x32_bf16 v[60:63], a[132:135], v[92:95], v[60:63]
  v_mfma_f32_16x16x32_bf16 v[64:67], a[212:215], v[88:91], v[64:67]
  v_mfma_f32_16x16x32_bf16 v[68:71], a[212:215], v[92:95], v[68:71]
  ds_read_b128 v[88:91], v2 offset:16384
  ds_read_b128 v[92:95], v2 offset:36864
  s_waitcnt lgkmcnt(4)
  v_mfma_f32_16x16x32_bf16 v[48:51], a[56:59], v[96:99], v[48:51]
  v_mfma_f32_16x16x32_bf16 v[52:55], a[56:59], v[100:103], v[52:55]
  v_mfma_f32_16x16x32_bf16 v[56:59], a[136:139], v[96:99], v[56:59]
  v_mfma_f32_16x16x32_bf16 v[60:63], a[136:139], v[100:103], v[60:63]
  v_mfma_f32_16x16x32_bf16 v[64:67], a[216:219], v[96:99], v[64:67]
  v_mfma_f32_16x16x32_bf16 v[68:71], a[216:219], v[100:103], v[68:71]
  ds_read_b128 v[96:99], v2 offset:17408
  ds_read_b128 v[100:103], v2 offset:37888
  s_waitcnt lgkmcnt(4)
  v_mfma_f32_16x16x32_bf16 v[48:51], a[60:63], v[80:83], v[48:51]
  v_mfma_f32_16x16x32_bf16 v[52:55], a[60:63], v[84:87], v[52:55]
  v_mfma_f32_16x16x32_bf16 v[56:59], a[140:143], v[80:83], v[56:59]
  v_mfma_f32_16x16x32_bf16 v[60:63], a[140:143], v[84:87], v[60:63]
  v_mfma_f32_16x16x32_bf16 v[64:67], a[220:223], v[80:83], v[64:67]
  v_mfma_f32_16x16x32_bf16 v[68:71], a[220:223], v[84:87], v[68:71]
  ds_read_b128 v[80:83], v2 offset:18432
  ds_read_b128 v[84:87], v2 offset:38912
  s_waitcnt lgkmcnt(4)
  v_mfma_f32_16x16x32_bf16 v[48:51], a[64:67], v[88:91], v[48:51]
  v_mfma_f32_16x16x32_bf16 v[52:55], a[64:67], v[92:95], v[52:55]
  v_mfma_f32_16x16x32_bf16 v[56:59], a[144:147], v[88:91], v[56:59]
  v_mfma_f32_16x16x32_bf16 v[60:63], a[144:147], v[92:95], v[60:63]
  v_mfma_f32_16x16x32_bf16 v[64:67], a[224:227], v[88:91], v[64:67]
  v_mfma_f32_16x16x32_bf16 v[68:71], a[224:227], v[92:95], v[68:71]
  ds_read_b128 v[88:91], v2 offset:19456
  ds_read_b128 v[92:95], v2 offset:39936
  s_waitcnt lgkmcnt(4)
  v_mfma_f32_16x16x32_bf16 v[48:51], a[68:71], v[96:99], v[48:51]
  v_mfma_f32_16x16x32_bf16 v[52:55], a[68:71], v[100:103], v[52:55]
  v_mfma_f32_16x16x32_bf16 v[56:59], a[148:151], v[96:99], v[56:59]
  v_mfma_f32_16x16x32_bf16 v[60:63], a[148:151], v[100:103], v[60:63]
  v_mfma_f32_16x16x32_bf16 v[64:67], a[228:231], v[96:99], v[64:67]
  v_mfma_f32_16x16x32_bf16 v[68:71], a[228:231], v[100:103], v[68:71]
  s_waitcnt lgkmcnt(2)
  v_mfma_f32_16x16x32_bf16 v[48:51], a[72:75], v[80:83], v[48:51]
  v_mfma_f32_16x16x32_bf16 v[52:55], a[72:75], v[84:87], v[52:55]
  v_mfma_f32_16x16x32_bf16 v[56:59], a[152:155], v[80:83], v[56:59]
  v_mfma_f32_16x16x32_bf16 v[60:63], a[152:155], v[84:87], v[60:63]
  v_mfma_f32_16x16x32_bf16 v[64:67], a[232:235], v[80:83], v[64:67]
  v_mfma_f32_16x16x32_bf16 v[68:71], a[232:235], v[84:87], v[68:71]
  s_waitcnt lgkmcnt(0)
  v_mfma_f32_16x16x32_bf16 v[48:51], a[76:79], v[88:91], v[48:51]
  v_mfma_f32_16x16x32_bf16 v[52:55], a[76:79], v[92:95], v[52:55]
  v_mfma_f32_16x16x32_bf16 v[56:59], a[156:159], v[88:91], v[56:59]
  v_mfma_f32_16x16x32_bf16 v[60:63], a[156:159], v[92:95], v[60:63]
  v_mfma_f32_16x16x32_bf16 v[64:67], a[236:239], v[88:91], v[64:67]
  v_mfma_f32_16x16x32_bf16 v[68:71], a[236:239], v[92:95], v[68:71]
  s_nop 7
  v_mul_u32_u24 v10, 1280, v5
  v_lshlrev_b32 v11, 3, v6
  v_add_u32 v10, v10, v11
  s_mul_i32 s30, s26, 40960
  s_lshl_b32 s31, s50, 5
  s_add_u32 s30, s30, s31
  v_add_f32 v48, v48, v16
  v_add_f32 v49, v49, v17
  v_add_f32 v50, v50, v18
  v_add_f32 v51, v51, v19
  v_cvt_pk_bf16_f32 v48, v48, v49
  v_cvt_pk_bf16_f32 v49, v50, v51
  s_add_u32 s28, s30, 0
  buffer_store_dwordx2 v[48:49], v10, s[16:19], s28 offen
  v_add_f32 v52, v52, v20
  v_add_f32 v53, v53, v21
  v_add_f32 v54, v54, v22
  v_add_f32 v55, v55, v23
  v_cvt_pk_bf16_f32 v52, v52, v53
  v_cvt_pk_bf16_f32 v53, v54, v55
  s_add_u32 s28, s30, 20480
  buffer_store_dwordx2 v[52:53], v10, s[16:19], s28 offen
  v_add_f32 v56, v56, v24
  v_add_f32 v57, v57, v25
  v_add_f32 v58, v58, v26
  v_add_f32 v59, v59, v27
  v_cvt_pk_bf16_f32 v56, v56, v57
  v_cvt_pk_bf16_f32 v57, v58, v59
  s_add_u32 s28, s30, 32
  buffer_store_dwordx2 v[56:57], v10, s[16:19], s28 offen
  v_add_f32 v60, v60, v28
  v_add_f32 v61, v61, v29
  v_add_f32 v62, v62, v30
  v_add_f32 v63, v63, v31
  v_cvt_pk_bf16_f32 v60, v60, v61
  v_cvt_pk_bf16_f32 v61, v62, v63
  s_add_u32 s28, s30, 20512
  buffer_store_dwordx2 v[60:61], v10, s[16:19], s28 offen
  s_cmp_lt_u32 s21, 2
  s_cbranch_scc0 g3_112
  v_add_f32 v64, v64, v32
  v_add_f32 v65, v65, v33
  v_add_f32 v66, v66, v34
  v_add_f32 v67, v67, v35
  v_cvt_pk_bf16_f32 v64, v64, v65
  v_cvt_pk_bf16_f32 v65, v66, v67
  s_add_u32 s28, s30, 64
  buffer_store_dwordx2 v[64:65], v10, s[16:19], s28 offen
  v_add_f32 v68, v68, v36
  v_add_f32 v69, v69, v37
  v_add_f32 v70, v70, v38
  v_add_f32 v71, v71, v39
  v_cvt_pk_bf16_f32 v68, v68, v69
  v_cvt_pk_bf16_f32 v69, v70, v71
  s_add_u32 s28, s30, 20544
  buffer_store_dwordx2 v[68:69], v10, s[16:19], s28 offen
g3_112:
  s_endpgm
kb2_abort:
  s_load_dwordx2 s[6:7], s[0:1], 88
  v_mov_b32 v2, 80
  v_mov_b32 v3, 1
  s_waitcnt lgkmcnt(0)
  s_mov_b64 exec, 1
  global_atomic_add v2, v3, s[6:7]
  s_waitcnt vmcnt(0)
kb2_exit:
  s_endpgm

.section .rodata,"a"
.p2align 6
.amdhsa_kernel kb2_kernel
  .amdhsa_next_free_vgpr 512
  .amdhsa_next_free_sgpr 102
  .amdhsa_accum_offset 256
  .amdhsa_group_segment_fixed_size 0
  .amdhsa_kernarg_size 104
  .amdhsa_user_sgpr_count 2
  .amdhsa_user_sgpr_kernarg_segment_ptr 1
  .amdhsa_system_sgpr_workgroup_id_x 1
.end_amdhsa_kernel
```

```asm
; @launch kernel=prep_kernel grid=(256,1,1) block=(256,1,1) lds=32768
; @launch kernel=ka1_kernel grid=(256,1,1) block=(256,1,1) lds=163840
; @launch kernel=kb1_kernel grid=(256,1,1) block=(256,1,1) lds=135168
; @launch kernel=ka2_kernel grid=(256,1,1) block=(256,1,1) lds=163840
; @launch kernel=kb2_kernel grid=(256,1,1) block=(256,1,1) lds=135168
.amdgcn_target "amdgcn-amd-amdhsa--gfx950"
.text
.globl prep_kernel
.p2align 8
.type prep_kernel,@function
prep_kernel:
  s_cmp_ge_u32 s2, 256
  s_cbranch_scc1 k0_exit
  s_load_dwordx2 s[38:39], s[0:1], 8
  s_load_dwordx4 s[40:43], s[0:1], 32
  s_load_dwordx4 s[44:47], s[0:1], 16
  s_load_dwordx2 s[4:5], s[0:1], 96
  v_lshrrev_b32 v1, 6, v0
  s_nop 0
  v_readfirstlane_b32 s21, v1
  v_and_b32 v1, 63, v0
  v_lshlrev_b32 v2, 4, v1
  s_waitcnt lgkmcnt(0)
  s_mov_b32 s8, s4
  s_and_b32 s9, s5, 0xffff
  s_mov_b32 s10, 0x10000000
  s_mov_b32 s11, 0x20000
  s_mov_b32 s12, s40
  s_and_b32 s13, s41, 0xffff
  s_mov_b32 s14, 0x780000
  s_mov_b32 s15, 0x20000
  s_mov_b32 s16, s42
  s_and_b32 s17, s43, 0xffff
  s_mov_b32 s18, 0x780000
  s_mov_b32 s19, 0x20000
  v_mov_b32 v208, -1
  v_mov_b32 v209, -1
  v_mov_b32 v210, -1
  v_mov_b32 v211, -1
  s_lshl_b32 s28, s2, 2
  s_add_u32 s28, s28, s21
  s_add_u32 s29, s28, 0
  s_cmp_lt_u32 s29, 2560
  s_cbranch_scc0 f_1
  s_lshl_b32 s29, s29, 10
  s_add_u32 s29, s29, 0x400000
  buffer_store_dwordx4 v[208:211], v2, s[8:11], s29 offen
f_1:
  s_add_u32 s29, s28, 1024
  s_cmp_lt_u32 s29, 2560
  s_cbranch_scc0 f_2
  s_lshl_b32 s29, s29, 10
  s_add_u32 s29, s29, 0x400000
  buffer_store_dwordx4 v[208:211], v2, s[8:11], s29 offen
f_2:
  s_add_u32 s29, s28, 2048
  s_cmp_lt_u32 s29, 2560
  s_cbranch_scc0 f_3
  s_lshl_b32 s29, s29, 10
  s_add_u32 s29, s29, 0x400000
  buffer_store_dwordx4 v[208:211], v2, s[8:11], s29 offen
f_3:
  s_add_u32 s29, s28, 0
  s_cmp_lt_u32 s29, 1280
  s_cbranch_scc0 f_4
  s_lshl_b32 s29, s29, 10
  s_add_u32 s29, s29, 0x700000
  buffer_store_dwordx4 v[208:211], v2, s[8:11], s29 offen
f_4:
  s_add_u32 s29, s28, 1024
  s_cmp_lt_u32 s29, 1280
  s_cbranch_scc0 f_5
  s_lshl_b32 s29, s29, 10
  s_add_u32 s29, s29, 0x700000
  buffer_store_dwordx4 v[208:211], v2, s[8:11], s29 offen
f_5:
  s_add_u32 s29, s28, 0
  s_cmp_lt_u32 s29, 640
  s_cbranch_scc0 f_6
  s_lshl_b32 s29, s29, 10
  s_add_u32 s29, s29, 0xa00000
  buffer_store_dwordx4 v[208:211], v2, s[8:11], s29 offen
f_6:
  s_add_u32 s29, s28, 0
  s_cmp_lt_u32 s29, 5120
  s_cbranch_scc0 f_7
  s_lshl_b32 s29, s29, 10
  s_add_u32 s29, s29, 0xe00000
  buffer_store_dwordx4 v[208:211], v2, s[8:11], s29 offen
f_7:
  s_add_u32 s29, s28, 1024
  s_cmp_lt_u32 s29, 5120
  s_cbranch_scc0 f_8
  s_lshl_b32 s29, s29, 10
  s_add_u32 s29, s29, 0xe00000
  buffer_store_dwordx4 v[208:211], v2, s[8:11], s29 offen
f_8:
  s_add_u32 s29, s28, 2048
  s_cmp_lt_u32 s29, 5120
  s_cbranch_scc0 f_9
  s_lshl_b32 s29, s29, 10
  s_add_u32 s29, s29, 0xe00000
  buffer_store_dwordx4 v[208:211], v2, s[8:11], s29 offen
f_9:
  s_add_u32 s29, s28, 3072
  s_cmp_lt_u32 s29, 5120
  s_cbranch_scc0 f_10
  s_lshl_b32 s29, s29, 10
  s_add_u32 s29, s29, 0xe00000
  buffer_store_dwordx4 v[208:211], v2, s[8:11], s29 offen
f_10:
  s_add_u32 s29, s28, 4096
  s_cmp_lt_u32 s29, 5120
  s_cbranch_scc0 f_11
  s_lshl_b32 s29, s29, 10
  s_add_u32 s29, s29, 0xe00000
  buffer_store_dwordx4 v[208:211], v2, s[8:11], s29 offen
f_11:
  s_and_b32 s22, s2, 7
  s_lshl_b32 s22, s22, 2
  s_lshr_b32 s23, s2, 6
  s_add_u32 s22, s22, s23
  s_bfe_u32 s23, s2, 0x30003
  v_lshrrev_b32 v8, 3, v1
  v_bfe_u32 v9, v1, 1, 2
  v_and_b32 v10, 1, v1
  s_mul_i32 s24, s22, 245760
  s_mul_i32 s25, s23, 160
  s_add_u32 s24, s24, s25
  s_add_u32 s26, s21, 0
  s_cmp_lt_u32 s26, 30
  s_cbranch_scc0 wd_12
  s_lshl_b32 s27, s26, 3
  v_add_u32 v11, s27, v8
  v_mul_u32_u24 v12, 52429, v11
  v_lshrrev_b32 v12, 18, v12
  v_mul_u32_u24 v13, 5, v12
  v_sub_u32 v13, v11, v13
  v_lshlrev_b32 v12, 2, v12
  v_add_u32 v12, v12, v9
  v_mul_u32_u24 v12, 1280, v12
  v_lshlrev_b32 v13, 5, v13
  v_add_u32 v12, v12, v13
  v_lshlrev_b32 v13, 4, v10
  v_add_u32 v12, v12, v13
  s_lshl_b32 m0, s26, 10
  s_nop 0
  buffer_load_dwordx4 v12, s[16:19], s24 offen lds
wd_12:
  s_add_u32 s26, s21, 4
  s_cmp_lt_u32 s26, 30
  s_cbranch_scc0 wd_13
  s_lshl_b32 s27, s26, 3
  v_add_u32 v11, s27, v8
  v_mul_u32_u24 v12, 52429, v11
  v_lshrrev_b32 v12, 18, v12
  v_mul_u32_u24 v13, 5, v12
  v_sub_u32 v13, v11, v13
  v_lshlrev_b32 v12, 2, v12
  v_add_u32 v12, v12, v9
  v_mul_u32_u24 v12, 1280, v12
  v_lshlrev_b32 v13, 5, v13
  v_add_u32 v12, v12, v13
  v_lshlrev_b32 v13, 4, v10
  v_add_u32 v12, v12, v13
  s_lshl_b32 m0, s26, 10
  s_nop 0
  buffer_load_dwordx4 v12, s[16:19], s24 offen lds
wd_13:
  s_add_u32 s26, s21, 8
  s_cmp_lt_u32 s26, 30
  s_cbranch_scc0 wd_14
  s_lshl_b32 s27, s26, 3
  v_add_u32 v11, s27, v8
  v_mul_u32_u24 v12, 52429, v11
  v_lshrrev_b32 v12, 18, v12
  v_mul_u32_u24 v13, 5, v12
  v_sub_u32 v13, v11, v13
  v_lshlrev_b32 v12, 2, v12
  v_add_u32 v12, v12, v9
  v_mul_u32_u24 v12, 1280, v12
  v_lshlrev_b32 v13, 5, v13
  v_add_u32 v12, v12, v13
  v_lshlrev_b32 v13, 4, v10
  v_add_u32 v12, v12, v13
  s_lshl_b32 m0, s26, 10
  s_nop 0
  buffer_load_dwordx4 v12, s[16:19], s24 offen lds
wd_14:
  s_add_u32 s26, s21, 12
  s_cmp_lt_u32 s26, 30
  s_cbranch_scc0 wd_15
  s_lshl_b32 s27, s26, 3
  v_add_u32 v11, s27, v8
  v_mul_u32_u24 v12, 52429, v11
  v_lshrrev_b32 v12, 18, v12
  v_mul_u32_u24 v13, 5, v12
  v_sub_u32 v13, v11, v13
  v_lshlrev_b32 v12, 2, v12
  v_add_u32 v12, v12, v9
  v_mul_u32_u24 v12, 1280, v12
  v_lshlrev_b32 v13, 5, v13
  v_add_u32 v12, v12, v13
  v_lshlrev_b32 v13, 4, v10
  v_add_u32 v12, v12, v13
  s_lshl_b32 m0, s26, 10
  s_nop 0
  buffer_load_dwordx4 v12, s[16:19], s24 offen lds
wd_15:
  s_add_u32 s26, s21, 16
  s_cmp_lt_u32 s26, 30
  s_cbranch_scc0 wd_16
  s_lshl_b32 s27, s26, 3
  v_add_u32 v11, s27, v8
  v_mul_u32_u24 v12, 52429, v11
  v_lshrrev_b32 v12, 18, v12
  v_mul_u32_u24 v13, 5, v12
  v_sub_u32 v13, v11, v13
  v_lshlrev_b32 v12, 2, v12
  v_add_u32 v12, v12, v9
  v_mul_u32_u24 v12, 1280, v12
  v_lshlrev_b32 v13, 5, v13
  v_add_u32 v12, v12, v13
  v_lshlrev_b32 v13, 4, v10
  v_add_u32 v12, v12, v13
  s_lshl_b32 m0, s26, 10
  s_nop 0
  buffer_load_dwordx4 v12, s[16:19], s24 offen lds
wd_16:
  s_add_u32 s26, s21, 20
  s_cmp_lt_u32 s26, 30
  s_cbranch_scc0 wd_17
  s_lshl_b32 s27, s26, 3
  v_add_u32 v11, s27, v8
  v_mul_u32_u24 v12, 52429, v11
  v_lshrrev_b32 v12, 18, v12
  v_mul_u32_u24 v13, 5, v12
  v_sub_u32 v13, v11, v13
  v_lshlrev_b32 v12, 2, v12
  v_add_u32 v12, v12, v9
  v_mul_u32_u24 v12, 1280, v12
  v_lshlrev_b32 v13, 5, v13
  v_add_u32 v12, v12, v13
  v_lshlrev_b32 v13, 4, v10
  v_add_u32 v12, v12, v13
  s_lshl_b32 m0, s26, 10
  s_nop 0
  buffer_load_dwordx4 v12, s[16:19], s24 offen lds
wd_17:
  s_add_u32 s26, s21, 24
  s_cmp_lt_u32 s26, 30
  s_cbranch_scc0 wd_18
  s_lshl_b32 s27, s26, 3
  v_add_u32 v11, s27, v8
  v_mul_u32_u24 v12, 52429, v11
  v_lshrrev_b32 v12, 18, v12
  v_mul_u32_u24 v13, 5, v12
  v_sub_u32 v13, v11, v13
  v_lshlrev_b32 v12, 2, v12
  v_add_u32 v12, v12, v9
  v_mul_u32_u24 v12, 1280, v12
  v_lshlrev_b32 v13, 5, v13
  v_add_u32 v12, v12, v13
  v_lshlrev_b32 v13, 4, v10
  v_add_u32 v12, v12, v13
  s_lshl_b32 m0, s26, 10
  s_nop 0
  buffer_load_dwordx4 v12, s[16:19], s24 offen lds
wd_18:
  s_add_u32 s26, s21, 28
  s_cmp_lt_u32 s26, 30
  s_cbranch_scc0 wd_19
  s_lshl_b32 s27, s26, 3
  v_add_u32 v11, s27, v8
  v_mul_u32_u24 v12, 52429, v11
  v_lshrrev_b32 v12, 18, v12
  v_mul_u32_u24 v13, 5, v12
  v_sub_u32 v13, v11, v13
  v_lshlrev_b32 v12, 2, v12
  v_add_u32 v12, v12, v9
  v_mul_u32_u24 v12, 1280, v12
  v_lshlrev_b32 v13, 5, v13
  v_add_u32 v12, v12, v13
  v_lshlrev_b32 v13, 4, v10
  v_add_u32 v12, v12, v13
  s_lshl_b32 m0, s26, 10
  s_nop 0
  buffer_load_dwordx4 v12, s[16:19], s24 offen lds
wd_19:
  v_and_b32 v8, 15, v1
  v_lshrrev_b32 v9, 2, v8
  v_lshlrev_b32 v9, 3, v9
  v_and_b32 v10, 3, v8
  v_add_u32 v9, v9, v10
  v_mul_u32_u24 v9, 12288, v9
  v_lshrrev_b32 v10, 4, v1
  v_lshlrev_b32 v10, 4, v10
  v_add_u32 v9, v9, v10
  v_add_u32 v10, 49152, v9
  s_mul_i32 s24, s22, 384
  s_mul_i32 s25, s21, 1966080
  s_add_u32 s24, s24, s25
  s_add_u32 s27, s24, 0
  buffer_load_dwordx4 a[120:123], v9, s[12:15], s27 offen offset:0
  buffer_load_dwordx4 a[124:127], v9, s[12:15], s27 offen offset:64
  buffer_load_dwordx4 a[128:131], v9, s[12:15], s27 offen offset:128
  buffer_load_dwordx4 a[132:135], v9, s[12:15], s27 offen offset:192
  buffer_load_dwordx4 a[136:139], v9, s[12:15], s27 offen offset:256
  buffer_load_dwordx4 a[140:143], v9, s[12:15], s27 offen offset:320
  buffer_load_dwordx4 a[144:147], v10, s[12:15], s27 offen offset:0
  buffer_load_dwordx4 a[148:151], v10, s[12:15], s27 offen offset:64
  buffer_load_dwordx4 a[152:155], v10, s[12:15], s27 offen offset:128
  buffer_load_dwordx4 a[156:159], v10, s[12:15], s27 offen offset:192
  buffer_load_dwordx4 a[160:163], v10, s[12:15], s27 offen offset:256
  buffer_load_dwordx4 a[164:167], v10, s[12:15], s27 offen offset:320
  s_add_u32 s27, s24, 393216
  buffer_load_dwordx4 a[168:171], v9, s[12:15], s27 offen offset:0
  buffer_load_dwordx4 a[172:175], v9, s[12:15], s27 offen offset:64
  buffer_load_dwordx4 a[176:179], v9, s[12:15], s27 offen offset:128
  buffer_load_dwordx4 a[180:183], v9, s[12:15], s27 offen offset:192
  buffer_load_dwordx4 a[184:187], v9, s[12:15], s27 offen offset:256
  buffer_load_dwordx4 a[188:191], v9, s[12:15], s27 offen offset:320
  buffer_load_dwordx4 a[192:195], v10, s[12:15], s27 offen offset:0
  buffer_load_dwordx4 a[196:199], v10, s[12:15], s27 offen offset:64
  buffer_load_dwordx4 a[200:203], v10, s[12:15], s27 offen offset:128
  buffer_load_dwordx4 a[204:207], v10, s[12:15], s27 offen offset:192
  buffer_load_dwordx4 a[208:211], v10, s[12:15], s27 offen offset:256
  buffer_load_dwordx4 a[212:215], v10, s[12:15], s27 offen offset:320
  s_add_u32 s27, s24, 786432
  buffer_load_dwordx4 v[64:67], v9, s[12:15], s27 offen offset:0
  buffer_load_dwordx4 v[68:71], v9, s[12:15], s27 offen offset:64
  buffer_load_dwordx4 v[72:75], v9, s[12:15], s27 offen offset:128
  buffer_load_dwordx4 v[76:79], v9, s[12:15], s27 offen offset:192
  buffer_load_dwordx4 v[80:83], v9, s[12:15], s27 offen offset:256
  buffer_load_dwordx4 v[84:87], v9, s[12:15], s27 offen offset:320
  buffer_load_dwordx4 v[88:91], v10, s[12:15], s27 offen offset:0
  buffer_load_dwordx4 v[92:95], v10, s[12:15], s27 offen offset:64
  buffer_load_dwordx4 v[96:99], v10, s[12:15], s27 offen offset:128
  buffer_load_dwordx4 v[100:103], v10, s[12:15], s27 offen offset:192
  buffer_load_dwordx4 v[104:107], v10, s[12:15], s27 offen offset:256
  buffer_load_dwordx4 v[108:111], v10, s[12:15], s27 offen offset:320
  s_mul_i32 s26, s22, 40
  s_mul_i32 s27, s23, 5
  s_add_u32 s26, s26, s27
  s_mul_i32 s26, s26, 20
  s_mul_i32 s27, s21, 5
  s_add_u32 s26, s26, s27
  s_lshl_b32 s26, s26, 10
  s_add_u32 s26, s26, 0x2e00000
  v_lshrrev_b32 v8, 4, v1
  v_mul_u32_u24 v8, 1280, v8
  v_bfe_u32 v11, v1, 2, 2
  v_lshlrev_b32 v11, 5, v11
  v_add_u32 v8, v8, v11
  v_bfe_u32 v11, v1, 1, 1
  v_lshlrev_b32 v11, 4, v11
  v_add_u32 v8, v8, v11
  v_and_b32 v11, 1, v1
  v_lshlrev_b32 v11, 3, v11
  v_add_u32 v8, v8, v11
  s_waitcnt vmcnt(36)
  s_barrier
  ds_read_b64_tr_b16 a[0:1], v8 offset:0
  ds_read_b64_tr_b16 a[2:3], v8 offset:640
  ds_read_b64_tr_b16 a[4:5], v8 offset:128
  ds_read_b64_tr_b16 a[6:7], v8 offset:768
  ds_read_b64_tr_b16 a[8:9], v8 offset:256
  ds_read_b64_tr_b16 a[10:11], v8 offset:896
  ds_read_b64_tr_b16 a[12:13], v8 offset:384
  ds_read_b64_tr_b16 a[14:15], v8 offset:1024
  ds_read_b64_tr_b16 a[16:17], v8 offset:512
  ds_read_b64_tr_b16 a[18:19], v8 offset:1152
  ds_read_b64_tr_b16 a[20:21], v8 offset:5120
  ds_read_b64_tr_b16 a[22:23], v8 offset:5760
  s_waitcnt lgkmcnt(0)
  ds_read_b64_tr_b16 a[24:25], v8 offset:5248
  ds_read_b64_tr_b16 a[26:27], v8 offset:5888
  ds_read_b64_tr_b16 a[28:29], v8 offset:5376
  ds_read_b64_tr_b16 a[30:31], v8 offset:6016
  ds_read_b64_tr_b16 a[32:33], v8 offset:5504
  ds_read_b64_tr_b16 a[34:35], v8 offset:6144
  ds_read_b64_tr_b16 a[36:37], v8 offset:5632
  ds_read_b64_tr_b16 a[38:39], v8 offset:6272
  ds_read_b64_tr_b16 a[40:41], v8 offset:10240
  ds_read_b64_tr_b16 a[42:43], v8 offset:10880
  ds_read_b64_tr_b16 a[44:45], v8 offset:10368
  ds_read_b64_tr_b16 a[46:47], v8 offset:11008
  s_waitcnt lgkmcnt(0)
  ds_read_b64_tr_b16 a[48:49], v8 offset:10496
  ds_read_b64_tr_b16 a[50:51], v8 offset:11136
  ds_read_b64_tr_b16 a[52:53], v8 offset:10624
  ds_read_b64_tr_b16 a[54:55], v8 offset:11264
  ds_read_b64_tr_b16 a[56:57], v8 offset:10752
  ds_read_b64_tr_b16 a[58:59], v8 offset:11392
  ds_read_b64_tr_b16 a[60:61], v8 offset:15360
  ds_read_b64_tr_b16 a[62:63], v8 offset:16000
  ds_read_b64_tr_b16 a[64:65], v8 offset:15488
  ds_read_b64_tr_b16 a[66:67], v8 offset:16128
  ds_read_b64_tr_b16 a[68:69], v8 offset:15616
  ds_read_b64_tr_b16 a[70:71], v8 offset:16256
  s_waitcnt lgkmcnt(0)
  ds_read_b64_tr_b16 a[72:73], v8 offset:15744
  ds_read_b64_tr_b16 a[74:75], v8 offset:16384
  ds_read_b64_tr_b16 a[76:77], v8 offset:15872
  ds_read_b64_tr_b16 a[78:79], v8 offset:16512
  ds_read_b64_tr_b16 a[80:81], v8 offset:20480
  ds_read_b64_tr_b16 a[82:83], v8 offset:21120
  ds_read_b64_tr_b16 a[84:85], v8 offset:20608
  ds_read_b64_tr_b16 a[86:87], v8 offset:21248
  ds_read_b64_tr_b16 a[88:89], v8 offset:20736
  ds_read_b64_tr_b16 a[90:91], v8 offset:21376
  ds_read_b64_tr_b16 a[92:93], v8 offset:20864
  ds_read_b64_tr_b16 a[94:95], v8 offset:21504
  s_waitcnt lgkmcnt(0)
  ds_read_b64_tr_b16 a[96:97], v8 offset:20992
  ds_read_b64_tr_b16 a[98:99], v8 offset:21632
  ds_read_b64_tr_b16 a[100:101], v8 offset:25600
  ds_read_b64_tr_b16 a[102:103], v8 offset:26240
  ds_read_b64_tr_b16 a[104:105], v8 offset:25728
  ds_read_b64_tr_b16 a[106:107], v8 offset:26368
  ds_read_b64_tr_b16 a[108:109], v8 offset:25856
  ds_read_b64_tr_b16 a[110:111], v8 offset:26496
  ds_read_b64_tr_b16 a[112:113], v8 offset:25984
  ds_read_b64_tr_b16 a[114:115], v8 offset:26624
  ds_read_b64_tr_b16 a[116:117], v8 offset:26112
  ds_read_b64_tr_b16 a[118:119], v8 offset:26752
  s_waitcnt lgkmcnt(0)
  s_waitcnt lgkmcnt(0)
  s_add_u32 s27, s24, 1179648
  buffer_load_dwordx4 v[112:115], v9, s[12:15], s27 offen offset:0
  buffer_load_dwordx4 v[116:119], v9, s[12:15], s27 offen offset:64
  buffer_load_dwordx4 v[120:123], v9, s[12:15], s27 offen offset:128
  buffer_load_dwordx4 v[124:127], v9, s[12:15], s27 offen offset:192
  buffer_load_dwordx4 v[128:131], v9, s[12:15], s27 offen offset:256
  buffer_load_dwordx4 v[132:135], v9, s[12:15], s27 offen offset:320
  buffer_load_dwordx4 v[136:139], v10, s[12:15], s27 offen offset:0
  buffer_load_dwordx4 v[140:143], v10, s[12:15], s27 offen offset:64
  buffer_load_dwordx4 v[144:147], v10, s[12:15], s27 offen offset:128
  buffer_load_dwordx4 v[148:151], v10, s[12:15], s27 offen offset:192
  buffer_load_dwordx4 v[152:155], v10, s[12:15], s27 offen offset:256
  buffer_load_dwordx4 v[156:159], v10, s[12:15], s27 offen offset:320
  s_add_u32 s27, s24, 1572864
  buffer_load_dwordx4 v[160:163], v9, s[12:15], s27 offen offset:0
  buffer_load_dwordx4 v[164:167], v9, s[12:15], s27 offen offset:64
  buffer_load_dwordx4 v[168:171], v9, s[12:15], s27 offen offset:128
  buffer_load_dwordx4 v[172:175], v9, s[12:15], s27 offen offset:192
  buffer_load_dwordx4 v[176:179], v9, s[12:15], s27 offen offset:256
  buffer_load_dwordx4 v[180:183], v9, s[12:15], s27 offen offset:320
  buffer_load_dwordx4 v[184:187], v10, s[12:15], s27 offen offset:0
  buffer_load_dwordx4 v[188:191], v10, s[12:15], s27 offen offset:64
  buffer_load_dwordx4 v[192:195], v10, s[12:15], s27 offen offset:128
  buffer_load_dwordx4 v[196:199], v10, s[12:15], s27 offen offset:192
  buffer_load_dwordx4 v[200:203], v10, s[12:15], s27 offen offset:256
  buffer_load_dwordx4 v[204:207], v10, s[12:15], s27 offen offset:320
  s_waitcnt vmcnt(48)
  v_mfma_f32_16x16x32_bf16 v[16:19], a[120:123], a[0:3], 0
  v_mfma_f32_16x16x32_bf16 v[20:23], a[120:123], a[4:7], 0
  v_mfma_f32_16x16x32_bf16 v[24:27], a[120:123], a[8:11], 0
  v_mfma_f32_16x16x32_bf16 v[28:31], a[120:123], a[12:15], 0
  v_mfma_f32_16x16x32_bf16 v[32:35], a[120:123], a[16:19], 0
  v_mfma_f32_16x16x32_bf16 v[36:39], a[144:147], a[0:3], 0
  v_mfma_f32_16x16x32_bf16 v[40:43], a[144:147], a[4:7], 0
  v_mfma_f32_16x16x32_bf16 v[44:47], a[144:147], a[8:11], 0
  v_mfma_f32_16x16x32_bf16 v[48:51], a[144:147], a[12:15], 0
  v_mfma_f32_16x16x32_bf16 v[52:55], a[144:147], a[16:19], 0
  v_mfma_f32_16x16x32_bf16 v[16:19], a[124:127], a[20:23], v[16:19]
  v_mfma_f32_16x16x32_bf16 v[20:23], a[124:127], a[24:27], v[20:23]
  v_mfma_f32_16x16x32_bf16 v[24:27], a[124:127], a[28:31], v[24:27]
  v_mfma_f32_16x16x32_bf16 v[28:31], a[124:127], a[32:35], v[28:31]
  v_mfma_f32_16x16x32_bf16 v[32:35], a[124:127], a[36:39], v[32:35]
  v_mfma_f32_16x16x32_bf16 v[36:39], a[148:151], a[20:23], v[36:39]
  v_mfma_f32_16x16x32_bf16 v[40:43], a[148:151], a[24:27], v[40:43]
  v_mfma_f32_16x16x32_bf16 v[44:47], a[148:151], a[28:31], v[44:47]
  v_mfma_f32_16x16x32_bf16 v[48:51], a[148:151], a[32:35], v[48:51]
  v_mfma_f32_16x16x32_bf16 v[52:55], a[148:151], a[36:39], v[52:55]
  v_mfma_f32_16x16x32_bf16 v[16:19], a[128:131], a[40:43], v[16:19]
  v_mfma_f32_16x16x32_bf16 v[20:23], a[128:131], a[44:47], v[20:23]
  v_mfma_f32_16x16x32_bf16 v[24:27], a[128:131], a[48:51], v[24:27]
  v_mfma_f32_16x16x32_bf16 v[28:31], a[128:131], a[52:55], v[28:31]
  v_mfma_f32_16x16x32_bf16 v[32:35], a[128:131], a[56:59], v[32:35]
  v_mfma_f32_16x16x32_bf16 v[36:39], a[152:155], a[40:43], v[36:39]
  v_mfma_f32_16x16x32_bf16 v[40:43], a[152:155], a[44:47], v[40:43]
  v_mfma_f32_16x16x32_bf16 v[44:47], a[152:155], a[48:51], v[44:47]
  v_mfma_f32_16x16x32_bf16 v[48:51], a[152:155], a[52:55], v[48:51]
  v_mfma_f32_16x16x32_bf16 v[52:55], a[152:155], a[56:59], v[52:55]
  v_mfma_f32_16x16x32_bf16 v[16:19], a[132:135], a[60:63], v[16:19]
  v_mfma_f32_16x16x32_bf16 v[20:23], a[132:135], a[64:67], v[20:23]
  v_mfma_f32_16x16x32_bf16 v[24:27], a[132:135], a[68:71], v[24:27]
  v_mfma_f32_16x16x32_bf16 v[28:31], a[132:135], a[72:75], v[28:31]
  v_mfma_f32_16x16x32_bf16 v[32:35], a[132:135], a[76:79], v[32:35]
  v_mfma_f32_16x16x32_bf16 v[36:39], a[156:159], a[60:63], v[36:39]
  v_mfma_f32_16x16x32_bf16 v[40:43], a[156:159], a[64:67], v[40:43]
  v_mfma_f32_16x16x32_bf16 v[44:47], a[156:159], a[68:71], v[44:47]
  v_mfma_f32_16x16x32_bf16 v[48:51], a[156:159], a[72:75], v[48:51]
  v_mfma_f32_16x16x32_bf16 v[52:55], a[156:159], a[76:79], v[52:55]
  v_mfma_f32_16x16x32_bf16 v[16:19], a[136:139], a[80:83], v[16:19]
  v_mfma_f32_16x16x32_bf16 v[20:23], a[136:139], a[84:87], v[20:23]
  v_mfma_f32_16x16x32_bf16 v[24:27], a[136:139], a[88:91], v[24:27]
  v_mfma_f32_16x16x32_bf16 v[28:31], a[136:139], a[92:95], v[28:31]
  v_mfma_f32_16x16x32_bf16 v[32:35], a[136:139], a[96:99], v[32:35]
  v_mfma_f32_16x16x32_bf16 v[36:39], a[160:163], a[80:83], v[36:39]
  v_mfma_f32_16x16x32_bf16 v[40:43], a[160:163], a[84:87], v[40:43]
  v_mfma_f32_16x16x32_bf16 v[44:47], a[160:163], a[88:91], v[44:47]
  v_mfma_f32_16x16x32_bf16 v[48:51], a[160:163], a[92:95], v[48:51]
  v_mfma_f32_16x16x32_bf16 v[52:55], a[160:163], a[96:99], v[52:55]
  v_mfma_f32_16x16x32_bf16 v[16:19], a[140:143], a[100:103], v[16:19]
  v_mfma_f32_16x16x32_bf16 v[20:23], a[140:143], a[104:107], v[20:23]
  v_mfma_f32_16x16x32_bf16 v[24:27], a[140:143], a[108:111], v[24:27]
  v_mfma_f32_16x16x32_bf16 v[28:31], a[140:143], a[112:115], v[28:31]
  v_mfma_f32_16x16x32_bf16 v[32:35], a[140:143], a[116:119], v[32:35]
  v_mfma_f32_16x16x32_bf16 v[36:39], a[164:167], a[100:103], v[36:39]
  v_mfma_f32_16x16x32_bf16 v[40:43], a[164:167], a[104:107], v[40:43]
  v_mfma_f32_16x16x32_bf16 v[44:47], a[164:167], a[108:111], v[44:47]
  v_mfma_f32_16x16x32_bf16 v[48:51], a[164:167], a[112:115], v[48:51]
  v_mfma_f32_16x16x32_bf16 v[52:55], a[164:167], a[116:119], v[52:55]
  s_nop 7
  v_cvt_pk_bf16_f32 v212, v16, v17
  v_cvt_pk_bf16_f32 v213, v18, v19
  v_cvt_pk_bf16_f32 v214, v36, v37
  v_cvt_pk_bf16_f32 v215, v38, v39
  s_add_u32 s27, s26, 0
  buffer_store_dwordx4 v[212:215], v2, s[8:11], s27 offen
  v_cvt_pk_bf16_f32 v216, v20, v21
  v_cvt_pk_bf16_f32 v217, v22, v23
  v_cvt_pk_bf16_f32 v218, v40, v41
  v_cvt_pk_bf16_f32 v219, v42, v43
  s_add_u32 s27, s26, 20480
  buffer_store_dwordx4 v[216:219], v2, s[8:11], s27 offen
  v_cvt_pk_bf16_f32 v220, v24, v25
  v_cvt_pk_bf16_f32 v221, v26, v27
  v_cvt_pk_bf16_f32 v222, v44, v45
  v_cvt_pk_bf16_f32 v223, v46, v47
  s_add_u32 s27, s26, 40960
  buffer_store_dwordx4 v[220:223], v2, s[8:11], s27 offen
  v_cvt_pk_bf16_f32 v224, v28, v29
  v_cvt_pk_bf16_f32 v225, v30, v31
  v_cvt_pk_bf16_f32 v226, v48, v49
  v_cvt_pk_bf16_f32 v227, v50, v51
  s_add_u32 s27, s26, 61440
  buffer_store_dwordx4 v[224:227], v2, s[8:11], s27 offen
  v_cvt_pk_bf16_f32 v212, v32, v33
  v_cvt_pk_bf16_f32 v213, v34, v35
  v_cvt_pk_bf16_f32 v214, v52, v53
  v_cvt_pk_bf16_f32 v215, v54, v55
  s_add_u32 s27, s26, 81920
  buffer_store_dwordx4 v[212:215], v2, s[8:11], s27 offen
  s_waitcnt vmcnt(41)
  v_mfma_f32_16x16x32_bf16 v[16:19], a[168:171], a[0:3], 0
  v_mfma_f32_16x16x32_bf16 v[20:23], a[168:171], a[4:7], 0
  v_mfma_f32_16x16x32_bf16 v[24:27], a[168:171], a[8:11], 0
  v_mfma_f32_16x16x32_bf16 v[28:31], a[168:171], a[12:15], 0
  v_mfma_f32_16x16x32_bf16 v[32:35], a[168:171], a[16:19], 0
  v_mfma_f32_16x16x32_bf16 v[36:39], a[192:195], a[0:3], 0
  v_mfma_f32_16x16x32_bf16 v[40:43], a[192:195], a[4:7], 0
  v_mfma_f32_16x16x32_bf16 v[44:47], a[192:195], a[8:11], 0
  v_mfma_f32_16x16x32_bf16 v[48:51], a[192:195], a[12:15], 0
  v_mfma_f32_16x16x32_bf16 v[52:55], a[192:195], a[16:19], 0
  v_mfma_f32_16x16x32_bf16 v[16:19], a[172:175], a[20:23], v[16:19]
  v_mfma_f32_16x16x32_bf16 v[20:23], a[172:175], a[24:27], v[20:23]
  v_mfma_f32_16x16x32_bf16 v[24:27], a[172:175], a[28:31], v[24:27]
  v_mfma_f32_16x16x32_bf16 v[28:31], a[172:175], a[32:35], v[28:31]
  v_mfma_f32_16x16x32_bf16 v[32:35], a[172:175], a[36:39], v[32:35]
  v_mfma_f32_16x16x32_bf16 v[36:39], a[196:199], a[20:23], v[36:39]
  v_mfma_f32_16x16x32_bf16 v[40:43], a[196:199], a[24:27], v[40:43]
  v_mfma_f32_16x16x32_bf16 v[44:47], a[196:199], a[28:31], v[44:47]
  v_mfma_f32_16x16x32_bf16 v[48:51], a[196:199], a[32:35], v[48:51]
  v_mfma_f32_16x16x32_bf16 v[52:55], a[196:199], a[36:39], v[52:55]
  v_mfma_f32_16x16x32_bf16 v[16:19], a[176:179], a[40:43], v[16:19]
  v_mfma_f32_16x16x32_bf16 v[20:23], a[176:179], a[44:47], v[20:23]
  v_mfma_f32_16x16x32_bf16 v[24:27], a[176:179], a[48:51], v[24:27]
  v_mfma_f32_16x16x32_bf16 v[28:31], a[176:179], a[52:55], v[28:31]
  v_mfma_f32_16x16x32_bf16 v[32:35], a[176:179], a[56:59], v[32:35]
  v_mfma_f32_16x16x32_bf16 v[36:39], a[200:203], a[40:43], v[36:39]
  v_mfma_f32_16x16x32_bf16 v[40:43], a[200:203], a[44:47], v[40:43]
  v_mfma_f32_16x16x32_bf16 v[44:47], a[200:203], a[48:51], v[44:47]
  v_mfma_f32_16x16x32_bf16 v[48:51], a[200:203], a[52:55], v[48:51]
  v_mfma_f32_16x16x32_bf16 v[52:55], a[200:203], a[56:59], v[52:55]
  v_mfma_f32_16x16x32_bf16 v[16:19], a[180:183], a[60:63], v[16:19]
  v_mfma_f32_16x16x32_bf16 v[20:23], a[180:183], a[64:67], v[20:23]
  v_mfma_f32_16x16x32_bf16 v[24:27], a[180:183], a[68:71], v[24:27]
  v_mfma_f32_16x16x32_bf16 v[28:31], a[180:183], a[72:75], v[28:31]
  v_mfma_f32_16x16x32_bf16 v[32:35], a[180:183], a[76:79], v[32:35]
  v_mfma_f32_16x16x32_bf16 v[36:39], a[204:207], a[60:63], v[36:39]
  v_mfma_f32_16x16x32_bf16 v[40:43], a[204:207], a[64:67], v[40:43]
  v_mfma_f32_16x16x32_bf16 v[44:47], a[204:207], a[68:71], v[44:47]
  v_mfma_f32_16x16x32_bf16 v[48:51], a[204:207], a[72:75], v[48:51]
  v_mfma_f32_16x16x32_bf16 v[52:55], a[204:207], a[76:79], v[52:55]
  v_mfma_f32_16x16x32_bf16 v[16:19], a[184:187], a[80:83], v[16:19]
  v_mfma_f32_16x16x32_bf16 v[20:23], a[184:187], a[84:87], v[20:23]
  v_mfma_f32_16x16x32_bf16 v[24:27], a[184:187], a[88:91], v[24:27]
  v_mfma_f32_16x16x32_bf16 v[28:31], a[184:187], a[92:95], v[28:31]
  v_mfma_f32_16x16x32_bf16 v[32:35], a[184:187], a[96:99], v[32:35]
  v_mfma_f32_16x16x32_bf16 v[36:39], a[208:211], a[80:83], v[36:39]
  v_mfma_f32_16x16x32_bf16 v[40:43], a[208:211], a[84:87], v[40:43]
  v_mfma_f32_16x16x32_bf16 v[44:47], a[208:211], a[88:91], v[44:47]
  v_mfma_f32_16x16x32_bf16 v[48:51], a[208:211], a[92:95], v[48:51]
  v_mfma_f32_16x16x32_bf16 v[52:55], a[208:211], a[96:99], v[52:55]
  v_mfma_f32_16x16x32_bf16 v[16:19], a[188:191], a[100:103], v[16:19]
  v_mfma_f32_16x16x32_bf16 v[20:23], a[188:191], a[104:107], v[20:23]
  v_mfma_f32_16x16x32_bf16 v[24:27], a[188:191], a[108:111], v[24:27]
  v_mfma_f32_16x16x32_bf16 v[28:31], a[188:191], a[112:115], v[28:31]
  v_mfma_f32_16x16x32_bf16 v[32:35], a[188:191], a[116:119], v[32:35]
  v_mfma_f32_16x16x32_bf16 v[36:39], a[212:215], a[100:103], v[36:39]
  v_mfma_f32_16x16x32_bf16 v[40:43], a[212:215], a[104:107], v[40:43]
  v_mfma_f32_16x16x32_bf16 v[44:47], a[212:215], a[108:111], v[44:47]
  v_mfma_f32_16x16x32_bf16 v[48:51], a[212:215], a[112:115], v[48:51]
  v_mfma_f32_16x16x32_bf16 v[52:55], a[212:215], a[116:119], v[52:55]
  s_nop 7
  v_cvt_pk_bf16_f32 v212, v16, v17
  v_cvt_pk_bf16_f32 v213, v18, v19
  v_cvt_pk_bf16_f32 v214, v36, v37
  v_cvt_pk_bf16_f32 v215, v38, v39
  s_add_u32 s27, s26, 1024
  buffer_store_dwordx4 v[212:215], v2, s[8:11], s27 offen
  v_cvt_pk_bf16_f32 v216, v20, v21
  v_cvt_pk_bf16_f32 v217, v22, v23
  v_cvt_pk_bf16_f32 v218, v40, v41
  v_cvt_pk_bf16_f32 v219, v42, v43
  s_add_u32 s27, s26, 21504
  buffer_store_dwordx4 v[216:219], v2, s[8:11], s27 offen
  v_cvt_pk_bf16_f32 v220, v24, v25
  v_cvt_pk_bf16_f32 v221, v26, v27
  v_cvt_pk_bf16_f32 v222, v44, v45
  v_cvt_pk_bf16_f32 v223, v46, v47
  s_add_u32 s27, s26, 41984
  buffer_store_dwordx4 v[220:223], v2, s[8:11], s27 offen
  v_cvt_pk_bf16_f32 v224, v28, v29
  v_cvt_pk_bf16_f32 v225, v30, v31
  v_cvt_pk_bf16_f32 v226, v48, v49
  v_cvt_pk_bf16_f32 v227, v50, v51
  s_add_u32 s27, s26, 62464
  buffer_store_dwordx4 v[224:227], v2, s[8:11], s27 offen
  v_cvt_pk_bf16_f32 v212, v32, v33
  v_cvt_pk_bf16_f32 v213, v34, v35
  v_cvt_pk_bf16_f32 v214, v52, v53
  v_cvt_pk_bf16_f32 v215, v54, v55
  s_add_u32 s27, s26, 82944
  buffer_store_dwordx4 v[212:215], v2, s[8:11], s27 offen
  s_waitcnt vmcnt(34)
  v_mfma_f32_16x16x32_bf16 v[16:19], v[64:67], a[0:3], 0
  v_mfma_f32_16x16x32_bf16 v[20:23], v[64:67], a[4:7], 0
  v_mfma_f32_16x16x32_bf16 v[24:27], v[64:67], a[8:11], 0
  v_mfma_f32_16x16x32_bf16 v[28:31], v[64:67], a[12:15], 0
  v_mfma_f32_16x16x32_bf16 v[32:35], v[64:67], a[16:19], 0
  v_mfma_f32_16x16x32_bf16 v[36:39], v[88:91], a[0:3], 0
  v_mfma_f32_16x16x32_bf16 v[40:43], v[88:91], a[4:7], 0
  v_mfma_f32_16x16x32_bf16 v[44:47], v[88:91], a[8:11], 0
  v_mfma_f32_16x16x32_bf16 v[48:51], v[88:91], a[12:15], 0
  v_mfma_f32_16x16x32_bf16 v[52:55], v[88:91], a[16:19], 0
  v_mfma_f32_16x16x32_bf16 v[16:19], v[68:71], a[20:23], v[16:19]
  v_mfma_f32_16x16x32_bf16 v[20:23], v[68:71], a[24:27], v[20:23]
  v_mfma_f32_16x16x32_bf16 v[24:27], v[68:71], a[28:31], v[24:27]
  v_mfma_f32_16x16x32_bf16 v[28:31], v[68:71], a[32:35], v[28:31]
  v_mfma_f32_16x16x32_bf16 v[32:35], v[68:71], a[36:39], v[32:35]
  v_mfma_f32_16x16x32_bf16 v[36:39], v[92:95], a[20:23], v[36:39]
  v_mfma_f32_16x16x32_bf16 v[40:43], v[92:95], a[24:27], v[40:43]
  v_mfma_f32_16x16x32_bf16 v[44:47], v[92:95], a[28:31], v[44:47]
  v_mfma_f32_16x16x32_bf16 v[48:51], v[92:95], a[32:35], v[48:51]
  v_mfma_f32_16x16x32_bf16 v[52:55], v[92:95], a[36:39], v[52:55]
  v_mfma_f32_16x16x32_bf16 v[16:19], v[72:75], a[40:43], v[16:19]
  v_mfma_f32_16x16x32_bf16 v[20:23], v[72:75], a[44:47], v[20:23]
  v_mfma_f32_16x16x32_bf16 v[24:27], v[72:75], a[48:51], v[24:27]
  v_mfma_f32_16x16x32_bf16 v[28:31], v[72:75], a[52:55], v[28:31]
  v_mfma_f32_16x16x32_bf16 v[32:35], v[72:75], a[56:59], v[32:35]
  v_mfma_f32_16x16x32_bf16 v[36:39], v[96:99], a[40:43], v[36:39]
  v_mfma_f32_16x16x32_bf16 v[40:43], v[96:99], a[44:47], v[40:43]
  v_mfma_f32_16x16x32_bf16 v[44:47], v[96:99], a[48:51], v[44:47]
  v_mfma_f32_16x16x32_bf16 v[48:51], v[96:99], a[52:55], v[48:51]
  v_mfma_f32_16x16x32_bf16 v[52:55], v[96:99], a[56:59], v[52:55]
  v_mfma_f32_16x16x32_bf16 v[16:19], v[76:79], a[60:63], v[16:19]
  v_mfma_f32_16x16x32_bf16 v[20:23], v[76:79], a[64:67], v[20:23]
  v_mfma_f32_16x16x32_bf16 v[24:27], v[76:79], a[68:71], v[24:27]
  v_mfma_f32_16x16x32_bf16 v[28:31], v[76:79], a[72:75], v[28:31]
  v_mfma_f32_16x16x32_bf16 v[32:35], v[76:79], a[76:79], v[32:35]
  v_mfma_f32_16x16x32_bf16 v[36:39], v[100:103], a[60:63], v[36:39]
  v_mfma_f32_16x16x32_bf16 v[40:43], v[100:103], a[64:67], v[40:43]
  v_mfma_f32_16x16x32_bf16 v[44:47], v[100:103], a[68:71], v[44:47]
  v_mfma_f32_16x16x32_bf16 v[48:51], v[100:103], a[72:75], v[48:51]
  v_mfma_f32_16x16x32_bf16 v[52:55], v[100:103], a[76:79], v[52:55]
  v_mfma_f32_16x16x32_bf16 v[16:19], v[80:83], a[80:83], v[16:19]
  v_mfma_f32_16x16x32_bf16 v[20:23], v[80:83], a[84:87], v[20:23]
  v_mfma_f32_16x16x32_bf16 v[24:27], v[80:83], a[88:91], v[24:27]
  v_mfma_f32_16x16x32_bf16 v[28:31], v[80:83], a[92:95], v[28:31]
  v_mfma_f32_16x16x32_bf16 v[32:35], v[80:83], a[96:99], v[32:35]
  v_mfma_f32_16x16x32_bf16 v[36:39], v[104:107], a[80:83], v[36:39]
  v_mfma_f32_16x16x32_bf16 v[40:43], v[104:107], a[84:87], v[40:43]
  v_mfma_f32_16x16x32_bf16 v[44:47], v[104:107], a[88:91], v[44:47]
  v_mfma_f32_16x16x32_bf16 v[48:51], v[104:107], a[92:95], v[48:51]
  v_mfma_f32_16x16x32_bf16 v[52:55], v[104:107], a[96:99], v[52:55]
  v_mfma_f32_16x16x32_bf16 v[16:19], v[84:87], a[100:103], v[16:19]
  v_mfma_f32_16x16x32_bf16 v[20:23], v[84:87], a[104:107], v[20:23]
  v_mfma_f32_16x16x32_bf16 v[24:27], v[84:87], a[108:111], v[24:27]
  v_mfma_f32_16x16x32_bf16 v[28:31], v[84:87], a[112:115], v[28:31]
  v_mfma_f32_16x16x32_bf16 v[32:35], v[84:87], a[116:119], v[32:35]
  v_mfma_f32_16x16x32_bf16 v[36:39], v[108:111], a[100:103], v[36:39]
  v_mfma_f32_16x16x32_bf16 v[40:43], v[108:111], a[104:107], v[40:43]
  v_mfma_f32_16x16x32_bf16 v[44:47], v[108:111], a[108:111], v[44:47]
  v_mfma_f32_16x16x32_bf16 v[48:51], v[108:111], a[112:115], v[48:51]
  v_mfma_f32_16x16x32_bf16 v[52:55], v[108:111], a[116:119], v[52:55]
  s_nop 7
  v_cvt_pk_bf16_f32 v212, v16, v17
  v_cvt_pk_bf16_f32 v213, v18, v19
  v_cvt_pk_bf16_f32 v214, v36, v37
  v_cvt_pk_bf16_f32 v215, v38, v39
  s_add_u32 s27, s26, 2048
  buffer_store_dwordx4 v[212:215], v2, s[8:11], s27 offen
  v_cvt_pk_bf16_f32 v216, v20, v21
  v_cvt_pk_bf16_f32 v217, v22, v23
  v_cvt_pk_bf16_f32 v218, v40, v41
  v_cvt_pk_bf16_f32 v219, v42, v43
  s_add_u32 s27, s26, 22528
  buffer_store_dwordx4 v[216:219], v2, s[8:11], s27 offen
  v_cvt_pk_bf16_f32 v220, v24, v25
  v_cvt_pk_bf16_f32 v221, v26, v27
  v_cvt_pk_bf16_f32 v222, v44, v45
  v_cvt_pk_bf16_f32 v223, v46, v47
  s_add_u32 s27, s26, 43008
  buffer_store_dwordx4 v[220:223], v2, s[8:11], s27 offen
  v_cvt_pk_bf16_f32 v224, v28, v29
  v_cvt_pk_bf16_f32 v225, v30, v31
  v_cvt_pk_bf16_f32 v226, v48, v49
  v_cvt_pk_bf16_f32 v227, v50, v51
  s_add_u32 s27, s26, 63488
  buffer_store_dwordx4 v[224:227], v2, s[8:11], s27 offen
  v_cvt_pk_bf16_f32 v212, v32, v33
  v_cvt_pk_bf16_f32 v213, v34, v35
  v_cvt_pk_bf16_f32 v214, v52, v53
  v_cvt_pk_bf16_f32 v215, v54, v55
  s_add_u32 s27, s26, 83968
  buffer_store_dwordx4 v[212:215], v2, s[8:11], s27 offen
  s_waitcnt vmcnt(27)
  v_mfma_f32_16x16x32_bf16 v[16:19], v[112:115], a[0:3], 0
  v_mfma_f32_16x16x32_bf16 v[20:23], v[112:115], a[4:7], 0
  v_mfma_f32_16x16x32_bf16 v[24:27], v[112:115], a[8:11], 0
  v_mfma_f32_16x16x32_bf16 v[28:31], v[112:115], a[12:15], 0
  v_mfma_f32_16x16x32_bf16 v[32:35], v[112:115], a[16:19], 0
  v_mfma_f32_16x16x32_bf16 v[36:39], v[136:139], a[0:3], 0
  v_mfma_f32_16x16x32_bf16 v[40:43], v[136:139], a[4:7], 0
  v_mfma_f32_16x16x32_bf16 v[44:47], v[136:139], a[8:11], 0
  v_mfma_f32_16x16x32_bf16 v[48:51], v[136:139], a[12:15], 0
  v_mfma_f32_16x16x32_bf16 v[52:55], v[136:139], a[16:19], 0
  v_mfma_f32_16x16x32_bf16 v[16:19], v[116:119], a[20:23], v[16:19]
  v_mfma_f32_16x16x32_bf16 v[20:23], v[116:119], a[24:27], v[20:23]
  v_mfma_f32_16x16x32_bf16 v[24:27], v[116:119], a[28:31], v[24:27]
  v_mfma_f32_16x16x32_bf16 v[28:31], v[116:119], a[32:35], v[28:31]
  v_mfma_f32_16x16x32_bf16 v[32:35], v[116:119], a[36:39], v[32:35]
  v_mfma_f32_16x16x32_bf16 v[36:39], v[140:143], a[20:23], v[36:39]
  v_mfma_f32_16x16x32_bf16 v[40:43], v[140:143], a[24:27], v[40:43]
  v_mfma_f32_16x16x32_bf16 v[44:47], v[140:143], a[28:31], v[44:47]
  v_mfma_f32_16x16x32_bf16 v[48:51], v[140:143], a[32:35], v[48:51]
  v_mfma_f32_16x16x32_bf16 v[52:55], v[140:143], a[36:39], v[52:55]
  v_mfma_f32_16x16x32_bf16 v[16:19], v[120:123], a[40:43], v[16:19]
  v_mfma_f32_16x16x32_bf16 v[20:23], v[120:123], a[44:47], v[20:23]
  v_mfma_f32_16x16x32_bf16 v[24:27], v[120:123], a[48:51], v[24:27]
  v_mfma_f32_16x16x32_bf16 v[28:31], v[120:123], a[52:55], v[28:31]
  v_mfma_f32_16x16x32_bf16 v[32:35], v[120:123], a[56:59], v[32:35]
  v_mfma_f32_16x16x32_bf16 v[36:39], v[144:147], a[40:43], v[36:39]
  v_mfma_f32_16x16x32_bf16 v[40:43], v[144:147], a[44:47], v[40:43]
  v_mfma_f32_16x16x32_bf16 v[44:47], v[144:147], a[48:51], v[44:47]
  v_mfma_f32_16x16x32_bf16 v[48:51], v[144:147], a[52:55], v[48:51]
  v_mfma_f32_16x16x32_bf16 v[52:55], v[144:147], a[56:59], v[52:55]
  v_mfma_f32_16x16x32_bf16 v[16:19], v[124:127], a[60:63], v[16:19]
  v_mfma_f32_16x16x32_bf16 v[20:23], v[124:127], a[64:67], v[20:23]
  v_mfma_f32_16x16x32_bf16 v[24:27], v[124:127], a[68:71], v[24:27]
  v_mfma_f32_16x16x32_bf16 v[28:31], v[124:127], a[72:75], v[28:31]
  v_mfma_f32_16x16x32_bf16 v[32:35], v[124:127], a[76:79], v[32:35]
  v_mfma_f32_16x16x32_bf16 v[36:39], v[148:151], a[60:63], v[36:39]
  v_mfma_f32_16x16x32_bf16 v[40:43], v[148:151], a[64:67], v[40:43]
  v_mfma_f32_16x16x32_bf16 v[44:47], v[148:151], a[68:71], v[44:47]
  v_mfma_f32_16x16x32_bf16 v[48:51], v[148:151], a[72:75], v[48:51]
  v_mfma_f32_16x16x32_bf16 v[52:55], v[148:151], a[76:79], v[52:55]
  v_mfma_f32_16x16x32_bf16 v[16:19], v[128:131], a[80:83], v[16:19]
  v_mfma_f32_16x16x32_bf16 v[20:23], v[128:131], a[84:87], v[20:23]
  v_mfma_f32_16x16x32_bf16 v[24:27], v[128:131], a[88:91], v[24:27]
  v_mfma_f32_16x16x32_bf16 v[28:31], v[128:131], a[92:95], v[28:31]
  v_mfma_f32_16x16x32_bf16 v[32:35], v[128:131], a[96:99], v[32:35]
  v_mfma_f32_16x16x32_bf16 v[36:39], v[152:155], a[80:83], v[36:39]
  v_mfma_f32_16x16x32_bf16 v[40:43], v[152:155], a[84:87], v[40:43]
  v_mfma_f32_16x16x32_bf16 v[44:47], v[152:155], a[88:91], v[44:47]
  v_mfma_f32_16x16x32_bf16 v[48:51], v[152:155], a[92:95], v[48:51]
  v_mfma_f32_16x16x32_bf16 v[52:55], v[152:155], a[96:99], v[52:55]
  v_mfma_f32_16x16x32_bf16 v[16:19], v[132:135], a[100:103], v[16:19]
  v_mfma_f32_16x16x32_bf16 v[20:23], v[132:135], a[104:107], v[20:23]
  v_mfma_f32_16x16x32_bf16 v[24:27], v[132:135], a[108:111], v[24:27]
  v_mfma_f32_16x16x32_bf16 v[28:31], v[132:135], a[112:115], v[28:31]
  v_mfma_f32_16x16x32_bf16 v[32:35], v[132:135], a[116:119], v[32:35]
  v_mfma_f32_16x16x32_bf16 v[36:39], v[156:159], a[100:103], v[36:39]
  v_mfma_f32_16x16x32_bf16 v[40:43], v[156:159], a[104:107], v[40:43]
  v_mfma_f32_16x16x32_bf16 v[44:47], v[156:159], a[108:111], v[44:47]
  v_mfma_f32_16x16x32_bf16 v[48:51], v[156:159], a[112:115], v[48:51]
  v_mfma_f32_16x16x32_bf16 v[52:55], v[156:159], a[116:119], v[52:55]
  s_nop 7
  v_cvt_pk_bf16_f32 v212, v16, v17
  v_cvt_pk_bf16_f32 v213, v18, v19
  v_cvt_pk_bf16_f32 v214, v36, v37
  v_cvt_pk_bf16_f32 v215, v38, v39
  s_add_u32 s27, s26, 3072
  buffer_store_dwordx4 v[212:215], v2, s[8:11], s27 offen
  v_cvt_pk_bf16_f32 v216, v20, v21
  v_cvt_pk_bf16_f32 v217, v22, v23
  v_cvt_pk_bf16_f32 v218, v40, v41
  v_cvt_pk_bf16_f32 v219, v42, v43
  s_add_u32 s27, s26, 23552
  buffer_store_dwordx4 v[216:219], v2, s[8:11], s27 offen
  v_cvt_pk_bf16_f32 v220, v24, v25
  v_cvt_pk_bf16_f32 v221, v26, v27
  v_cvt_pk_bf16_f32 v222, v44, v45
  v_cvt_pk_bf16_f32 v223, v46, v47
  s_add_u32 s27, s26, 44032
  buffer_store_dwordx4 v[220:223], v2, s[8:11], s27 offen
  v_cvt_pk_bf16_f32 v224, v28, v29
  v_cvt_pk_bf16_f32 v225, v30, v31
  v_cvt_pk_bf16_f32 v226, v48, v49
  v_cvt_pk_bf16_f32 v227, v50, v51
  s_add_u32 s27, s26, 64512
  buffer_store_dwordx4 v[224:227], v2, s[8:11], s27 offen
  v_cvt_pk_bf16_f32 v212, v32, v33
  v_cvt_pk_bf16_f32 v213, v34, v35
  v_cvt_pk_bf16_f32 v214, v52, v53
  v_cvt_pk_bf16_f32 v215, v54, v55
  s_add_u32 s27, s26, 84992
  buffer_store_dwordx4 v[212:215], v2, s[8:11], s27 offen
  s_waitcnt vmcnt(20)
  v_mfma_f32_16x16x32_bf16 v[16:19], v[160:163], a[0:3], 0
  v_mfma_f32_16x16x32_bf16 v[20:23], v[160:163], a[4:7], 0
  v_mfma_f32_16x16x32_bf16 v[24:27], v[160:163], a[8:11], 0
  v_mfma_f32_16x16x32_bf16 v[28:31], v[160:163], a[12:15], 0
  v_mfma_f32_16x16x32_bf16 v[32:35], v[160:163], a[16:19], 0
  v_mfma_f32_16x16x32_bf16 v[36:39], v[184:187], a[0:3], 0
  v_mfma_f32_16x16x32_bf16 v[40:43], v[184:187], a[4:7], 0
  v_mfma_f32_16x16x32_bf16 v[44:47], v[184:187], a[8:11], 0
  v_mfma_f32_16x16x32_bf16 v[48:51], v[184:187], a[12:15], 0
  v_mfma_f32_16x16x32_bf16 v[52:55], v[184:187], a[16:19], 0
  v_mfma_f32_16x16x32_bf16 v[16:19], v[164:167], a[20:23], v[16:19]
  v_mfma_f32_16x16x32_bf16 v[20:23], v[164:167], a[24:27], v[20:23]
  v_mfma_f32_16x16x32_bf16 v[24:27], v[164:167], a[28:31], v[24:27]
  v_mfma_f32_16x16x32_bf16 v[28:31], v[164:167], a[32:35], v[28:31]
  v_mfma_f32_16x16x32_bf16 v[32:35], v[164:167], a[36:39], v[32:35]
  v_mfma_f32_16x16x32_bf16 v[36:39], v[188:191], a[20:23], v[36:39]
  v_mfma_f32_16x16x32_bf16 v[40:43], v[188:191], a[24:27], v[40:43]
  v_mfma_f32_16x16x32_bf16 v[44:47], v[188:191], a[28:31], v[44:47]
  v_mfma_f32_16x16x32_bf16 v[48:51], v[188:191], a[32:35], v[48:51]
  v_mfma_f32_16x16x32_bf16 v[52:55], v[188:191], a[36:39], v[52:55]
  v_mfma_f32_16x16x32_bf16 v[16:19], v[168:171], a[40:43], v[16:19]
  v_mfma_f32_16x16x32_bf16 v[20:23], v[168:171], a[44:47], v[20:23]
  v_mfma_f32_16x16x32_bf16 v[24:27], v[168:171], a[48:51], v[24:27]
  v_mfma_f32_16x16x32_bf16 v[28:31], v[168:171], a[52:55], v[28:31]
  v_mfma_f32_16x16x32_bf16 v[32:35], v[168:171], a[56:59], v[32:35]
  v_mfma_f32_16x16x32_bf16 v[36:39], v[192:195], a[40:43], v[36:39]
  v_mfma_f32_16x16x32_bf16 v[40:43], v[192:195], a[44:47], v[40:43]
  v_mfma_f32_16x16x32_bf16 v[44:47], v[192:195], a[48:51], v[44:47]
  v_mfma_f32_16x16x32_bf16 v[48:51], v[192:195], a[52:55], v[48:51]
  v_mfma_f32_16x16x32_bf16 v[52:55], v[192:195], a[56:59], v[52:55]
  v_mfma_f32_16x16x32_bf16 v[16:19], v[172:175], a[60:63], v[16:19]
  v_mfma_f32_16x16x32_bf16 v[20:23], v[172:175], a[64:67], v[20:23]
  v_mfma_f32_16x16x32_bf16 v[24:27], v[172:175], a[68:71], v[24:27]
  v_mfma_f32_16x16x32_bf16 v[28:31], v[172:175], a[72:75], v[28:31]
  v_mfma_f32_16x16x32_bf16 v[32:35], v[172:175], a[76:79], v[32:35]
  v_mfma_f32_16x16x32_bf16 v[36:39], v[196:199], a[60:63], v[36:39]
  v_mfma_f32_16x16x32_bf16 v[40:43], v[196:199], a[64:67], v[40:43]
  v_mfma_f32_16x16x32_bf16 v[44:47], v[196:199], a[68:71], v[44:47]
  v_mfma_f32_16x16x32_bf16 v[48:51], v[196:199], a[72:75], v[48:51]
  v_mfma_f32_16x16x32_bf16 v[52:55], v[196:199], a[76:79], v[52:55]
  v_mfma_f32_16x16x32_bf16 v[16:19], v[176:179], a[80:83], v[16:19]
  v_mfma_f32_16x16x32_bf16 v[20:23], v[176:179], a[84:87], v[20:23]
  v_mfma_f32_16x16x32_bf16 v[24:27], v[176:179], a[88:91], v[24:27]
  v_mfma_f32_16x16x32_bf16 v[28:31], v[176:179], a[92:95], v[28:31]
  v_mfma_f32_16x16x32_bf16 v[32:35], v[176:179], a[96:99], v[32:35]
  v_mfma_f32_16x16x32_bf16 v[36:39], v[200:203], a[80:83], v[36:39]
  v_mfma_f32_16x16x32_bf16 v[40:43], v[200:203], a[84:87], v[40:43]
  v_mfma_f32_16x16x32_bf16 v[44:47], v[200:203], a[88:91], v[44:47]
  v_mfma_f32_16x16x32_bf16 v[48:51], v[200:203], a[92:95], v[48:51]
  v_mfma_f32_16x16x32_bf16 v[52:55], v[200:203], a[96:99], v[52:55]
  v_mfma_f32_16x16x32_bf16 v[16:19], v[180:183], a[100:103], v[16:19]
  v_mfma_f32_16x16x32_bf16 v[20:23], v[180:183], a[104:107], v[20:23]
  v_mfma_f32_16x16x32_bf16 v[24:27], v[180:183], a[108:111], v[24:27]
  v_mfma_f32_16x16x32_bf16 v[28:31], v[180:183], a[112:115], v[28:31]
  v_mfma_f32_16x16x32_bf16 v[32:35], v[180:183], a[116:119], v[32:35]
  v_mfma_f32_16x16x32_bf16 v[36:39], v[204:207], a[100:103], v[36:39]
  v_mfma_f32_16x16x32_bf16 v[40:43], v[204:207], a[104:107], v[40:43]
  v_mfma_f32_16x16x32_bf16 v[44:47], v[204:207], a[108:111], v[44:47]
  v_mfma_f32_16x16x32_bf16 v[48:51], v[204:207], a[112:115], v[48:51]
  v_mfma_f32_16x16x32_bf16 v[52:55], v[204:207], a[116:119], v[52:55]
  s_nop 7
  v_cvt_pk_bf16_f32 v212, v16, v17
  v_cvt_pk_bf16_f32 v213, v18, v19
  v_cvt_pk_bf16_f32 v214, v36, v37
  v_cvt_pk_bf16_f32 v215, v38, v39
  s_add_u32 s27, s26, 4096
  buffer_store_dwordx4 v[212:215], v2, s[8:11], s27 offen
  v_cvt_pk_bf16_f32 v216, v20, v21
  v_cvt_pk_bf16_f32 v217, v22, v23
  v_cvt_pk_bf16_f32 v218, v40, v41
  v_cvt_pk_bf16_f32 v219, v42, v43
  s_add_u32 s27, s26, 24576
  buffer_store_dwordx4 v[216:219], v2, s[8:11], s27 offen
  v_cvt_pk_bf16_f32 v220, v24, v25
  v_cvt_pk_bf16_f32 v221, v26, v27
  v_cvt_pk_bf16_f32 v222, v44, v45
  v_cvt_pk_bf16_f32 v223, v46, v47
  s_add_u32 s27, s26, 45056
  buffer_store_dwordx4 v[220:223], v2, s[8:11], s27 offen
  v_cvt_pk_bf16_f32 v224, v28, v29
  v_cvt_pk_bf16_f32 v225, v30, v31
  v_cvt_pk_bf16_f32 v226, v48, v49
  v_cvt_pk_bf16_f32 v227, v50, v51
  s_add_u32 s27, s26, 65536
  buffer_store_dwordx4 v[224:227], v2, s[8:11], s27 offen
  v_cvt_pk_bf16_f32 v212, v32, v33
  v_cvt_pk_bf16_f32 v213, v34, v35
  v_cvt_pk_bf16_f32 v214, v52, v53
  v_cvt_pk_bf16_f32 v215, v54, v55
  s_add_u32 s27, s26, 86016
  buffer_store_dwordx4 v[212:215], v2, s[8:11], s27 offen
  s_cmp_eq_u32 s2, 0
  s_cbranch_scc0 z_20
  s_cmp_eq_u32 s21, 0
  s_cbranch_scc0 z_20
  v_mov_b32 v8, 0
  v_mov_b32 v9, 0
  v_mov_b32 v10, 0
  v_mov_b32 v11, 0
  s_mov_b32 s26, 0x0
  buffer_store_dwordx4 v[8:11], v2, s[8:11], s26 offen
  s_add_u32 s26, s26, 1024
  buffer_store_dwordx4 v[8:11], v2, s[8:11], s26 offen
  s_add_u32 s26, s26, 1024
  buffer_store_dwordx4 v[8:11], v2, s[8:11], s26 offen
  s_add_u32 s26, s26, 1024
  buffer_store_dwordx4 v[8:11], v2, s[8:11], s26 offen
  s_add_u32 s26, s26, 1024
  buffer_store_dwordx4 v[8:11], v2, s[8:11], s26 offen
  s_add_u32 s26, s26, 1024
  buffer_store_dwordx4 v[8:11], v2, s[8:11], s26 offen
  s_add_u32 s26, s26, 1024
  s_mov_b32 s26, 0x2000
  buffer_store_dwordx4 v[8:11], v2, s[8:11], s26 offen
  s_add_u32 s26, s26, 1024
  buffer_store_dwordx4 v[8:11], v2, s[8:11], s26 offen
  s_add_u32 s26, s26, 1024
  buffer_store_dwordx4 v[8:11], v2, s[8:11], s26 offen
  s_add_u32 s26, s26, 1024
  s_mov_b32 s26, 0x8000
  buffer_store_dwordx4 v[8:11], v2, s[8:11], s26 offen
  s_add_u32 s26, s26, 1024
  buffer_store_dwordx4 v[8:11], v2, s[8:11], s26 offen
  s_add_u32 s26, s26, 1024
  buffer_store_dwordx4 v[8:11], v2, s[8:11], s26 offen
  s_add_u32 s26, s26, 1024
  buffer_store_dwordx4 v[8:11], v2, s[8:11], s26 offen
  s_add_u32 s26, s26, 1024
  buffer_store_dwordx4 v[8:11], v2, s[8:11], s26 offen
  s_add_u32 s26, s26, 1024
  buffer_store_dwordx4 v[8:11], v2, s[8:11], s26 offen
  s_add_u32 s26, s26, 1024
  buffer_store_dwordx4 v[8:11], v2, s[8:11], s26 offen
  s_add_u32 s26, s26, 1024
  buffer_store_dwordx4 v[8:11], v2, s[8:11], s26 offen
  s_add_u32 s26, s26, 1024
  buffer_store_dwordx4 v[8:11], v2, s[8:11], s26 offen
  s_add_u32 s26, s26, 1024
  buffer_store_dwordx4 v[8:11], v2, s[8:11], s26 offen
  s_add_u32 s26, s26, 1024
  buffer_store_dwordx4 v[8:11], v2, s[8:11], s26 offen
  s_add_u32 s26, s26, 1024
  buffer_store_dwordx4 v[8:11], v2, s[8:11], s26 offen
  s_add_u32 s26, s26, 1024
  buffer_store_dwordx4 v[8:11], v2, s[8:11], s26 offen
  s_add_u32 s26, s26, 1024
  buffer_store_dwordx4 v[8:11], v2, s[8:11], s26 offen
  s_add_u32 s26, s26, 1024
  buffer_store_dwordx4 v[8:11], v2, s[8:11], s26 offen
  s_add_u32 s26, s26, 1024
  buffer_store_dwordx4 v[8:11], v2, s[8:11], s26 offen
  s_add_u32 s26, s26, 1024
z_20:
  s_cmp_eq_u32 s2, 1
  s_cbranch_scc0 m0_21
  s_cmp_eq_u32 s21, 0
  s_cbranch_scc0 m0_21
  s_mov_b32 s12, s38
  s_and_b32 s13, s39, 0xffff
  s_mov_b32 s14, 0x2800
  s_mov_b32 s15, 0x20000
  v_and_b32 v8, 7, v1
  v_mul_u32_u24 v8, 1280, v8
  v_lshrrev_b32 v9, 4, v1
  v_lshlrev_b32 v9, 5, v9
  v_add_u32 v8, v8, v9
  v_bfe_u32 v9, v1, 3, 1
  v_lshlrev_b32 v9, 2, v9
  v_add_u32 v8, v8, v9
  s_mov_b32 s26, 0x4000
  buffer_load_dword v16, v8, s[12:15], 0 offen offset:0
  buffer_load_dword v17, v8, s[12:15], 0 offen offset:8
  buffer_load_dword v18, v8, s[12:15], 0 offen offset:16
  buffer_load_dword v19, v8, s[12:15], 0 offen offset:24
  buffer_load_dword v20, v8, s[12:15], 0 offen offset:128
  buffer_load_dword v21, v8, s[12:15], 0 offen offset:136
  buffer_load_dword v22, v8, s[12:15], 0 offen offset:144
  buffer_load_dword v23, v8, s[12:15], 0 offen offset:152
  buffer_load_dword v24, v8, s[12:15], 0 offen offset:256
  buffer_load_dword v25, v8, s[12:15], 0 offen offset:264
  buffer_load_dword v26, v8, s[12:15], 0 offen offset:272
  buffer_load_dword v27, v8, s[12:15], 0 offen offset:280
  buffer_load_dword v28, v8, s[12:15], 0 offen offset:384
  buffer_load_dword v29, v8, s[12:15], 0 offen offset:392
  buffer_load_dword v30, v8, s[12:15], 0 offen offset:400
  buffer_load_dword v31, v8, s[12:15], 0 offen offset:408
  buffer_load_dword v32, v8, s[12:15], 0 offen offset:512
  buffer_load_dword v33, v8, s[12:15], 0 offen offset:520
  buffer_load_dword v34, v8, s[12:15], 0 offen offset:528
  buffer_load_dword v35, v8, s[12:15], 0 offen offset:536
  buffer_load_dword v36, v8, s[12:15], 0 offen offset:640
  buffer_load_dword v37, v8, s[12:15], 0 offen offset:648
  buffer_load_dword v38, v8, s[12:15], 0 offen offset:656
  buffer_load_dword v39, v8, s[12:15], 0 offen offset:664
  buffer_load_dword v40, v8, s[12:15], 0 offen offset:768
  buffer_load_dword v41, v8, s[12:15], 0 offen offset:776
  buffer_load_dword v42, v8, s[12:15], 0 offen offset:784
  buffer_load_dword v43, v8, s[12:15], 0 offen offset:792
  buffer_load_dword v44, v8, s[12:15], 0 offen offset:896
  buffer_load_dword v45, v8, s[12:15], 0 offen offset:904
  buffer_load_dword v46, v8, s[12:15], 0 offen offset:912
  buffer_load_dword v47, v8, s[12:15], 0 offen offset:920
  buffer_load_dword v48, v8, s[12:15], 0 offen offset:1024
  buffer_load_dword v49, v8, s[12:15], 0 offen offset:1032
  buffer_load_dword v50, v8, s[12:15], 0 offen offset:1040
  buffer_load_dword v51, v8, s[12:15], 0 offen offset:1048
  buffer_load_dword v52, v8, s[12:15], 0 offen offset:1152
  buffer_load_dword v53, v8, s[12:15], 0 offen offset:1160
  buffer_load_dword v54, v8, s[12:15], 0 offen offset:1168
  buffer_load_dword v55, v8, s[12:15], 0 offen offset:1176
  s_waitcnt vmcnt(0)
  buffer_store_dwordx4 v[16:19], v2, s[8:11], s26 offen
  s_add_u32 s26, s26, 1024
  buffer_store_dwordx4 v[20:23], v2, s[8:11], s26 offen
  s_add_u32 s26, s26, 1024
  buffer_store_dwordx4 v[24:27], v2, s[8:11], s26 offen
  s_add_u32 s26, s26, 1024
  buffer_store_dwordx4 v[28:31], v2, s[8:11], s26 offen
  s_add_u32 s26, s26, 1024
  buffer_store_dwordx4 v[32:35], v2, s[8:11], s26 offen
  s_add_u32 s26, s26, 1024
  buffer_store_dwordx4 v[36:39], v2, s[8:11], s26 offen
  s_add_u32 s26, s26, 1024
  buffer_store_dwordx4 v[40:43], v2, s[8:11], s26 offen
  s_add_u32 s26, s26, 1024
  buffer_store_dwordx4 v[44:47], v2, s[8:11], s26 offen
  s_add_u32 s26, s26, 1024
  buffer_store_dwordx4 v[48:51], v2, s[8:11], s26 offen
  s_add_u32 s26, s26, 1024
  buffer_store_dwordx4 v[52:55], v2, s[8:11], s26 offen
  s_add_u32 s26, s26, 1024
m0_21:
k0_exit:
  s_endpgm

.section .rodata,"a"
.p2align 6
.amdhsa_kernel prep_kernel
  .amdhsa_next_free_vgpr 512
  .amdhsa_next_free_sgpr 102
  .amdhsa_accum_offset 256
  .amdhsa_group_segment_fixed_size 0
  .amdhsa_kernarg_size 104
  .amdhsa_user_sgpr_count 2
  .amdhsa_user_sgpr_kernarg_segment_ptr 1
  .amdhsa_system_sgpr_workgroup_id_x 1
.end_amdhsa_kernel
.text
.globl ka1_kernel
.p2align 8
.type ka1_kernel,@function
ka1_kernel:
  s_mov_b32 s99, 0
  s_branch ka_body

.section .rodata,"a"
.p2align 6
.amdhsa_kernel ka1_kernel
  .amdhsa_next_free_vgpr 512
  .amdhsa_next_free_sgpr 102
  .amdhsa_accum_offset 256
  .amdhsa_group_segment_fixed_size 0
  .amdhsa_kernarg_size 104
  .amdhsa_user_sgpr_count 2
  .amdhsa_user_sgpr_kernarg_segment_ptr 1
  .amdhsa_system_sgpr_workgroup_id_x 1
.end_amdhsa_kernel
.text
.globl kb1_kernel
.p2align 8
.type kb1_kernel,@function
kb1_kernel:
  s_cmp_ge_u32 s2, 256
  s_cbranch_scc1 kb1_exit
  s_load_dwordx2 s[36:37], s[0:1], 0
  s_load_dwordx2 s[38:39], s[0:1], 80
  s_load_dwordx2 s[4:5], s[0:1], 96
  v_lshrrev_b32 v1, 6, v0
  s_nop 0
  v_readfirstlane_b32 s21, v1
  v_and_b32 v1, 63, v0
  v_lshlrev_b32 v2, 4, v1
  s_waitcnt lgkmcnt(0)
  s_mov_b32 s8, s4
  s_and_b32 s9, s5, 0xffff
  s_mov_b32 s10, 0x10000000
  s_mov_b32 s11, 0x20000
  s_mov_b32 s12, s36
  s_and_b32 s13, s37, 0xffff
  s_mov_b32 s14, 0x280000
  s_mov_b32 s15, 0x20000
  s_mov_b32 s16, s38
  s_and_b32 s17, s39, 0xffff
  s_mov_b32 s18, 0x280000
  s_mov_b32 s19, 0x20000
  s_and_b32 s22, s2, 7
  s_lshl_b32 s22, s22, 2
  s_bfe_u32 s23, s2, 0x20003
  s_add_u32 s22, s22, s23
  s_lshr_b32 s23, s2, 5
  s_lshl_b32 s46, s23, 7
  s_add_u32 s46, s46, 0x8000
  s_add_u32 s48, s46, 0x1400
  s_lshl_b32 s47, s22, 7
  s_add_u32 s47, s47, 0x8400
  s_lshr_b32 s26, s2, 2
  s_and_b32 s27, s2, 3
  s_lshl_b32 s27, s27, 3
  v_and_b32 v5, 7, v1
  v_bfe_u32 v6, v1, 3, 1
  v_lshrrev_b32 v7, 4, v1
  v_lshlrev_b32 v8, 5, v6
  v_add_u32 v8, v8, v5
  v_add_u32 v8, s27, v8
  v_lshlrev_b32 v8, 4, v8
  v_lshlrev_b32 v9, 11, v7
  v_add_u32 v9, v9, v8
  v_lshlrev_b32 v10, 10, v7
  v_add_u32 v10, v10, v8
  s_mul_i32 s28, s26, 81920
  s_lshl_b32 s29, s21, 13
  s_add_u32 s28, s28, s29
  s_cmp_lt_u32 s21, 2
  s_cselect_b32 s49, 3, 2
  v_mov_b32 v32, 0
  v_mov_b32 v33, 0
  v_mov_b32 v34, 0
  v_mov_b32 v35, 0
  v_mov_b32 v36, 0
  v_mov_b32 v37, 0
  v_mov_b32 v38, 0
  v_mov_b32 v39, 0
  v_mov_b32 v56, 0
  v_mov_b32 v57, 0
  v_mov_b32 v58, 0
  v_mov_b32 v59, 0
  v_mov_b32 v68, 0
  v_mov_b32 v69, 0
  v_mov_b32 v70, 0
  v_mov_b32 v71, 0
  v_mov_b32 v80, 0
  v_mov_b32 v81, 0
  v_mov_b32 v82, 0
  v_mov_b32 v83, 0
  v_mov_b32 v92, 0
  v_mov_b32 v93, 0
  v_mov_b32 v94, 0
  v_mov_b32 v95, 0
  s_mul_i32 s33, s26, 40960
  s_lshl_b32 s30, s21, 12
  s_add_u32 s33, s33, s30
  s_add_u32 s30, s33, 27262976
  buffer_load_dwordx4 v[48:51], v10, s[8:11], s30 offen
  s_add_u32 s30, s33, 29884416
  buffer_load_dwordx4 v[60:63], v10, s[8:11], s30 offen
  s_add_u32 s30, s33, 32505856
  buffer_load_dwordx4 v[72:75], v10, s[8:11], s30 offen
  s_add_u32 s30, s33, 35127296
  buffer_load_dwordx4 v[84:87], v10, s[8:11], s30 offen
  s_add_u32 s30, s33, 27279360
  buffer_load_dwordx4 v[52:55], v10, s[8:11], s30 offen
  s_add_u32 s30, s33, 29900800
  buffer_load_dwordx4 v[64:67], v10, s[8:11], s30 offen
  s_add_u32 s30, s33, 32522240
  buffer_load_dwordx4 v[76:79], v10, s[8:11], s30 offen
  s_add_u32 s30, s33, 35143680
  buffer_load_dwordx4 v[88:91], v10, s[8:11], s30 offen
  s_cmp_lt_u32 s21, 2
  s_cbranch_scc0 g3_22
  s_add_u32 s30, s33, 27295744
  buffer_load_dwordx4 v[56:59], v10, s[8:11], s30 offen
  s_add_u32 s30, s33, 29917184
  buffer_load_dwordx4 v[68:71], v10, s[8:11], s30 offen
  s_add_u32 s30, s33, 32538624
  buffer_load_dwordx4 v[80:83], v10, s[8:11], s30 offen
  s_add_u32 s30, s33, 35160064
  buffer_load_dwordx4 v[92:95], v10, s[8:11], s30 offen
g3_22:
  s_lshl_b32 s30, s26, 5
  s_add_u32 s30, s30, s27
  v_add_u32 v11, s30, v5
  v_mul_u32_u24 v11, 1280, v11
  v_lshlrev_b32 v12, 5, v7
  v_add_u32 v11, v11, v12
  v_lshlrev_b32 v12, 4, v6
  v_add_u32 v11, v11, v12
  s_lshl_b32 s30, s21, 7
  buffer_load_dwordx4 v[144:147], v11, s[12:15], s30 offen offset:0
  buffer_load_dwordx4 v[148:151], v11, s[12:15], s30 offen offset:512
  s_cmp_lt_u32 s21, 2
  s_cbranch_scc0 g3_23
  buffer_load_dwordx4 v[152:155], v11, s[12:15], s30 offen offset:1024
g3_23:
  s_mul_i32 s30, s22, 122880
  s_mul_i32 s31, s21, 30720
  s_add_u32 s30, s30, s31
  s_add_u32 s30, s30, 0xe100000
  s_add_u32 m0, s31, 0
  s_add_u32 s29, s30, 0
  buffer_load_dwordx4 v2, s[8:11], s29 offen lds
  s_add_u32 m0, s31, 1024
  s_add_u32 s29, s30, 1024
  buffer_load_dwordx4 v2, s[8:11], s29 offen lds
  s_add_u32 m0, s31, 2048
  s_add_u32 s29, s30, 2048
  buffer_load_dwordx4 v2, s[8:11], s29 offen lds
  s_add_u32 m0, s31, 3072
  s_add_u32 s29, s30, 3072
  buffer_load_dwordx4 v2, s[8:11], s29 offen lds
  s_add_u32 m0, s31, 4096
  s_add_u32 s29, s30, 4096
  buffer_load_dwordx4 v2, s[8:11], s29 offen lds
  s_add_u32 m0, s31, 5120
  s_add_u32 s29, s30, 5120
  buffer_load_dwordx4 v2, s[8:11], s29 offen lds
  s_add_u32 m0, s31, 6144
  s_add_u32 s29, s30, 6144
  buffer_load_dwordx4 v2, s[8:11], s29 offen lds
  s_add_u32 m0, s31, 7168
  s_add_u32 s29, s30, 7168
  buffer_load_dwordx4 v2, s[8:11], s29 offen lds
  s_add_u32 m0, s31, 8192
  s_add_u32 s29, s30, 8192
  buffer_load_dwordx4 v2, s[8:11], s29 offen lds
  s_add_u32 m0, s31, 9216
  s_add_u32 s29, s30, 9216
  buffer_load_dwordx4 v2, s[8:11], s29 offen lds
  s_add_u32 m0, s31, 10240
  s_add_u32 s29, s30, 10240
  buffer_load_dwordx4 v2, s[8:11], s29 offen lds
  s_add_u32 m0, s31, 11264
  s_add_u32 s29, s30, 11264
  buffer_load_dwordx4 v2, s[8:11], s29 offen lds
  s_add_u32 m0, s31, 12288
  s_add_u32 s29, s30, 12288
  buffer_load_dwordx4 v2, s[8:11], s29 offen lds
  s_add_u32 m0, s31, 13312
  s_add_u32 s29, s30, 13312
  buffer_load_dwordx4 v2, s[8:11], s29 offen lds
  s_add_u32 m0, s31, 14336
  s_add_u32 s29, s30, 14336
  buffer_load_dwordx4 v2, s[8:11], s29 offen lds
  s_add_u32 m0, s31, 15360
  s_add_u32 s29, s30, 15360
  buffer_load_dwordx4 v2, s[8:11], s29 offen lds
  s_add_u32 m0, s31, 16384
  s_add_u32 s29, s30, 16384
  buffer_load_dwordx4 v2, s[8:11], s29 offen lds
  s_add_u32 m0, s31, 17408
  s_add_u32 s29, s30, 17408
  buffer_load_dwordx4 v2, s[8:11], s29 offen lds
  s_add_u32 m0, s31, 18432
  s_add_u32 s29, s30, 18432
  buffer_load_dwordx4 v2, s[8:11], s29 offen lds
  s_add_u32 m0, s31, 19456
  s_add_u32 s29, s30, 19456
  buffer_load_dwordx4 v2, s[8:11], s29 offen lds
  s_add_u32 m0, s31, 20480
  s_add_u32 s29, s30, 20480
  buffer_load_dwordx4 v2, s[8:11], s29 offen lds
  s_add_u32 m0, s31, 21504
  s_add_u32 s29, s30, 21504
  buffer_load_dwordx4 v2, s[8:11], s29 offen lds
  s_add_u32 m0, s31, 22528
  s_add_u32 s29, s30, 22528
  buffer_load_dwordx4 v2, s[8:11], s29 offen lds
  s_add_u32 m0, s31, 23552
  s_add_u32 s29, s30, 23552
  buffer_load_dwordx4 v2, s[8:11], s29 offen lds
  s_add_u32 m0, s31, 24576
  s_add_u32 s29, s30, 24576
  buffer_load_dwordx4 v2, s[8:11], s29 offen lds
  s_add_u32 m0, s31, 25600
  s_add_u32 s29, s30, 25600
  buffer_load_dwordx4 v2, s[8:11], s29 offen lds
  s_add_u32 m0, s31, 26624
  s_add_u32 s29, s30, 26624
  buffer_load_dwordx4 v2, s[8:11], s29 offen lds
  s_add_u32 m0, s31, 27648
  s_add_u32 s29, s30, 27648
  buffer_load_dwordx4 v2, s[8:11], s29 offen lds
  s_add_u32 m0, s31, 28672
  s_add_u32 s29, s30, 28672
  buffer_load_dwordx4 v2, s[8:11], s29 offen lds
  s_add_u32 m0, s31, 29696
  s_add_u32 s29, s30, 29696
  buffer_load_dwordx4 v2, s[8:11], s29 offen lds
  s_waitcnt vmcnt(30)
  v_lshlrev_b32 v16, 16, v144
  v_and_b32 v17, 0xffff0000, v144
  v_lshlrev_b32 v18, 16, v145
  v_and_b32 v19, 0xffff0000, v145
  v_lshlrev_b32 v20, 16, v146
  v_and_b32 v21, 0xffff0000, v146
  v_lshlrev_b32 v22, 16, v147
  v_and_b32 v23, 0xffff0000, v147
  v_lshlrev_b32 v24, 16, v148
  v_and_b32 v25, 0xffff0000, v148
  v_lshlrev_b32 v26, 16, v149
  v_and_b32 v27, 0xffff0000, v149
  v_lshlrev_b32 v28, 16, v150
  v_and_b32 v29, 0xffff0000, v150
  v_lshlrev_b32 v30, 16, v151
  v_and_b32 v31, 0xffff0000, v151
  s_cmp_lt_u32 s21, 2
  s_cbranch_scc0 g3_24
  v_lshlrev_b32 v32, 16, v152
  v_and_b32 v33, 0xffff0000, v152
  v_lshlrev_b32 v34, 16, v153
  v_and_b32 v35, 0xffff0000, v153
  v_lshlrev_b32 v36, 16, v154
  v_and_b32 v37, 0xffff0000, v154
  v_lshlrev_b32 v38, 16, v155
  v_and_b32 v39, 0xffff0000, v155
g3_24:
  v_lshlrev_b32 v12, 16, v48
  v_and_b32 v13, 0xffff0000, v48
  v_pk_add_f32 v[16:17], v[16:17], v[12:13]
  v_lshlrev_b32 v12, 16, v49
  v_and_b32 v13, 0xffff0000, v49
  v_pk_add_f32 v[18:19], v[18:19], v[12:13]
  v_lshlrev_b32 v12, 16, v50
  v_and_b32 v13, 0xffff0000, v50
  v_pk_add_f32 v[20:21], v[20:21], v[12:13]
  v_lshlrev_b32 v12, 16, v51
  v_and_b32 v13, 0xffff0000, v51
  v_pk_add_f32 v[22:23], v[22:23], v[12:13]
  v_lshlrev_b32 v12, 16, v52
  v_and_b32 v13, 0xffff0000, v52
  v_pk_add_f32 v[24:25], v[24:25], v[12:13]
  v_lshlrev_b32 v12, 16, v53
  v_and_b32 v13, 0xffff0000, v53
  v_pk_add_f32 v[26:27], v[26:27], v[12:13]
  v_lshlrev_b32 v12, 16, v54
  v_and_b32 v13, 0xffff0000, v54
  v_pk_add_f32 v[28:29], v[28:29], v[12:13]
  v_lshlrev_b32 v12, 16, v55
  v_and_b32 v13, 0xffff0000, v55
  v_pk_add_f32 v[30:31], v[30:31], v[12:13]
  v_lshlrev_b32 v12, 16, v56
  v_and_b32 v13, 0xffff0000, v56
  v_pk_add_f32 v[32:33], v[32:33], v[12:13]
  v_lshlrev_b32 v12, 16, v57
  v_and_b32 v13, 0xffff0000, v57
  v_pk_add_f32 v[34:35], v[34:35], v[12:13]
  v_lshlrev_b32 v12, 16, v58
  v_and_b32 v13, 0xffff0000, v58
  v_pk_add_f32 v[36:37], v[36:37], v[12:13]
  v_lshlrev_b32 v12, 16, v59
  v_and_b32 v13, 0xffff0000, v59
  v_pk_add_f32 v[38:39], v[38:39], v[12:13]
  v_lshlrev_b32 v12, 16, v60
  v_and_b32 v13, 0xffff0000, v60
  v_pk_add_f32 v[16:17], v[16:17], v[12:13]
  v_lshlrev_b32 v12, 16, v61
  v_and_b32 v13, 0xffff0000, v61
  v_pk_add_f32 v[18:19], v[18:19], v[12:13]
  v_lshlrev_b32 v12, 16, v62
  v_and_b32 v13, 0xffff0000, v62
  v_pk_add_f32 v[20:21], v[20:21], v[12:13]
  v_lshlrev_b32 v12, 16, v63
  v_and_b32 v13, 0xffff0000, v63
  v_pk_add_f32 v[22:23], v[22:23], v[12:13]
  v_lshlrev_b32 v12, 16, v64
  v_and_b32 v13, 0xffff0000, v64
  v_pk_add_f32 v[24:25], v[24:25], v[12:13]
  v_lshlrev_b32 v12, 16, v65
  v_and_b32 v13, 0xffff0000, v65
  v_pk_add_f32 v[26:27], v[26:27], v[12:13]
  v_lshlrev_b32 v12, 16, v66
  v_and_b32 v13, 0xffff0000, v66
  v_pk_add_f32 v[28:29], v[28:29], v[12:13]
  v_lshlrev_b32 v12, 16, v67
  v_and_b32 v13, 0xffff0000, v67
  v_pk_add_f32 v[30:31], v[30:31], v[12:13]
  v_lshlrev_b32 v12, 16, v68
  v_and_b32 v13, 0xffff0000, v68
  v_pk_add_f32 v[32:33], v[32:33], v[12:13]
  v_lshlrev_b32 v12, 16, v69
  v_and_b32 v13, 0xffff0000, v69
  v_pk_add_f32 v[34:35], v[34:35], v[12:13]
  v_lshlrev_b32 v12, 16, v70
  v_and_b32 v13, 0xffff0000, v70
  v_pk_add_f32 v[36:37], v[36:37], v[12:13]
  v_lshlrev_b32 v12, 16, v71
  v_and_b32 v13, 0xffff0000, v71
  v_pk_add_f32 v[38:39], v[38:39], v[12:13]
  v_lshlrev_b32 v12, 16, v72
  v_and_b32 v13, 0xffff0000, v72
  v_pk_add_f32 v[16:17], v[16:17], v[12:13]
  v_lshlrev_b32 v12, 16, v73
  v_and_b32 v13, 0xffff0000, v73
  v_pk_add_f32 v[18:19], v[18:19], v[12:13]
  v_lshlrev_b32 v12, 16, v74
  v_and_b32 v13, 0xffff0000, v74
  v_pk_add_f32 v[20:21], v[20:21], v[12:13]
  v_lshlrev_b32 v12, 16, v75
  v_and_b32 v13, 0xffff0000, v75
  v_pk_add_f32 v[22:23], v[22:23], v[12:13]
  v_lshlrev_b32 v12, 16, v76
  v_and_b32 v13, 0xffff0000, v76
  v_pk_add_f32 v[24:25], v[24:25], v[12:13]
  v_lshlrev_b32 v12, 16, v77
  v_and_b32 v13, 0xffff0000, v77
  v_pk_add_f32 v[26:27], v[26:27], v[12:13]
  v_lshlrev_b32 v12, 16, v78
  v_and_b32 v13, 0xffff0000, v78
  v_pk_add_f32 v[28:29], v[28:29], v[12:13]
  v_lshlrev_b32 v12, 16, v79
  v_and_b32 v13, 0xffff0000, v79
  v_pk_add_f32 v[30:31], v[30:31], v[12:13]
  v_lshlrev_b32 v12, 16, v80
  v_and_b32 v13, 0xffff0000, v80
  v_pk_add_f32 v[32:33], v[32:33], v[12:13]
  v_lshlrev_b32 v12, 16, v81
  v_and_b32 v13, 0xffff0000, v81
  v_pk_add_f32 v[34:35], v[34:35], v[12:13]
  v_lshlrev_b32 v12, 16, v82
  v_and_b32 v13, 0xffff0000, v82
  v_pk_add_f32 v[36:37], v[36:37], v[12:13]
  v_lshlrev_b32 v12, 16, v83
  v_and_b32 v13, 0xffff0000, v83
  v_pk_add_f32 v[38:39], v[38:39], v[12:13]
  v_lshlrev_b32 v12, 16, v84
  v_and_b32 v13, 0xffff0000, v84
  v_pk_add_f32 v[16:17], v[16:17], v[12:13]
  v_lshlrev_b32 v12, 16, v85
  v_and_b32 v13, 0xffff0000, v85
  v_pk_add_f32 v[18:19], v[18:19], v[12:13]
  v_lshlrev_b32 v12, 16, v86
  v_and_b32 v13, 0xffff0000, v86
  v_pk_add_f32 v[20:21], v[20:21], v[12:13]
  v_lshlrev_b32 v12, 16, v87
  v_and_b32 v13, 0xffff0000, v87
  v_pk_add_f32 v[22:23], v[22:23], v[12:13]
  v_lshlrev_b32 v12, 16, v88
  v_and_b32 v13, 0xffff0000, v88
  v_pk_add_f32 v[24:25], v[24:25], v[12:13]
  v_lshlrev_b32 v12, 16, v89
  v_and_b32 v13, 0xffff0000, v89
  v_pk_add_f32 v[26:27], v[26:27], v[12:13]
  v_lshlrev_b32 v12, 16, v90
  v_and_b32 v13, 0xffff0000, v90
  v_pk_add_f32 v[28:29], v[28:29], v[12:13]
  v_lshlrev_b32 v12, 16, v91
  v_and_b32 v13, 0xffff0000, v91
  v_pk_add_f32 v[30:31], v[30:31], v[12:13]
  v_lshlrev_b32 v12, 16, v92
  v_and_b32 v13, 0xffff0000, v92
  v_pk_add_f32 v[32:33], v[32:33], v[12:13]
  v_lshlrev_b32 v12, 16, v93
  v_and_b32 v13, 0xffff0000, v93
  v_pk_add_f32 v[34:35], v[34:35], v[12:13]
  v_lshlrev_b32 v12, 16, v94
  v_and_b32 v13, 0xffff0000, v94
  v_pk_add_f32 v[36:37], v[36:37], v[12:13]
  v_lshlrev_b32 v12, 16, v95
  v_and_b32 v13, 0xffff0000, v95
  v_pk_add_f32 v[38:39], v[38:39], v[12:13]
  s_add_u32 s30, s28, 20971520
  buffer_store_dwordx4 v[16:19], v9, s[8:11], s30 offen sc1
  s_add_u32 s30, s28, 20972544
  buffer_store_dwordx4 v[20:23], v9, s[8:11], s30 offen sc1
  s_add_u32 s30, s28, 21004288
  buffer_store_dwordx4 v[24:27], v9, s[8:11], s30 offen sc1
  s_add_u32 s30, s28, 21005312
  buffer_store_dwordx4 v[28:31], v9, s[8:11], s30 offen sc1
  s_cmp_lt_u32 s21, 2
  s_cbranch_scc0 g3_25
  s_add_u32 s30, s28, 21037056
  buffer_store_dwordx4 v[32:35], v9, s[8:11], s30 offen sc1
  s_add_u32 s30, s28, 21038080
  buffer_store_dwordx4 v[36:39], v9, s[8:11], s30 offen sc1
g3_25:
  v_add_f32 v12, v16, v17
  v_add_f32 v12, v12, v18
  v_add_f32 v12, v12, v19
  v_add_f32 v12, v12, v20
  v_add_f32 v12, v12, v21
  v_add_f32 v12, v12, v22
  v_add_f32 v12, v12, v23
  v_add_f32 v12, v12, v24
  v_add_f32 v12, v12, v25
  v_add_f32 v12, v12, v26
  v_add_f32 v12, v12, v27
  v_add_f32 v12, v12, v28
  v_add_f32 v12, v12, v29
  v_add_f32 v12, v12, v30
  v_add_f32 v12, v12, v31
  v_add_f32 v12, v12, v32
  v_add_f32 v12, v12, v33
  v_add_f32 v12, v12, v34
  v_add_f32 v12, v12, v35
  v_add_f32 v12, v12, v36
  v_add_f32 v12, v12, v37
  v_add_f32 v12, v12, v38
  v_add_f32 v12, v12, v39
  s_nop 1
  v_add_f32_dpp v12, v12, v12 row_ror:8 row_mask:0xf bank_mask:0xf
  v_mov_b32 v13, v12
  s_nop 1
  v_permlane16_swap_b32 v12, v13
  v_add_f32 v12, v12, v13
  v_mov_b32 v13, v12
  s_nop 1
  v_permlane32_swap_b32 v12, v13
  v_add_f32 v12, v12, v13
  v_lshlrev_b32 v14, 2, v5
  v_add_u32 v14, 131072, v14
  s_lshl_b32 s30, s21, 5
  v_add_u32 v15, s30, v14
  ds_write_b32 v15, v12
  s_waitcnt lgkmcnt(0)
  s_barrier
  ds_read_b32 v48, v14
  ds_read_b32 v49, v14 offset:32
  ds_read_b32 v50, v14 offset:64
  ds_read_b32 v51, v14 offset:96
  s_waitcnt lgkmcnt(0)
  v_add_f32 v48, v48, v49
  v_add_f32 v50, v50, v51
  v_add_f32 v48, v48, v50
  v_mul_f32 v48, 0x3acccccd, v48
  v_sub_f32 v56, v16, v48
  v_sub_f32 v57, v17, v48
  v_sub_f32 v58, v18, v48
  v_sub_f32 v59, v19, v48
  v_sub_f32 v60, v20, v48
  v_sub_f32 v61, v21, v48
  v_sub_f32 v62, v22, v48
  v_sub_f32 v63, v23, v48
  v_sub_f32 v64, v24, v48
  v_sub_f32 v65, v25, v48
  v_sub_f32 v66, v26, v48
  v_sub_f32 v67, v27, v48
  v_sub_f32 v68, v28, v48
  v_sub_f32 v69, v29, v48
  v_sub_f32 v70, v30, v48
  v_sub_f32 v71, v31, v48
  v_sub_f32 v72, v32, v48
  v_sub_f32 v73, v33, v48
  v_sub_f32 v74, v34, v48
  v_sub_f32 v75, v35, v48
  v_sub_f32 v76, v36, v48
  v_sub_f32 v77, v37, v48
  v_sub_f32 v78, v38, v48
  v_sub_f32 v79, v39, v48
  s_cmp_lt_u32 s21, 2
  s_cbranch_scc1 g3z_26
  v_mov_b32 v72, 0
  v_mov_b32 v73, 0
  v_mov_b32 v74, 0
  v_mov_b32 v75, 0
  v_mov_b32 v76, 0
  v_mov_b32 v77, 0
  v_mov_b32 v78, 0
  v_mov_b32 v79, 0
g3z_26:
  v_mul_f32 v12, v56, v56
  v_fmac_f32 v12, v57, v57
  v_fmac_f32 v12, v58, v58
  v_fmac_f32 v12, v59, v59
  v_fmac_f32 v12, v60, v60
  v_fmac_f32 v12, v61, v61
  v_fmac_f32 v12, v62, v62
  v_fmac_f32 v12, v63, v63
  v_fmac_f32 v12, v64, v64
  v_fmac_f32 v12, v65, v65
  v_fmac_f32 v12, v66, v66
  v_fmac_f32 v12, v67, v67
  v_fmac_f32 v12, v68, v68
  v_fmac_f32 v12, v69, v69
  v_fmac_f32 v12, v70, v70
  v_fmac_f32 v12, v71, v71
  v_fmac_f32 v12, v72, v72
  v_fmac_f32 v12, v73, v73
  v_fmac_f32 v12, v74, v74
  v_fmac_f32 v12, v75, v75
  v_fmac_f32 v12, v76, v76
  v_fmac_f32 v12, v77, v77
  v_fmac_f32 v12, v78, v78
  v_fmac_f32 v12, v79, v79
  s_nop 1
  v_add_f32_dpp v12, v12, v12 row_ror:8 row_mask:0xf bank_mask:0xf
  v_mov_b32 v13, v12
  s_nop 1
  v_permlane16_swap_b32 v12, v13
  v_add_f32 v12, v12, v13
  v_mov_b32 v13, v12
  s_nop 1
  v_permlane32_swap_b32 v12, v13
  v_add_f32 v12, v12, v13
  v_lshlrev_b32 v14, 2, v5
  v_add_u32 v14, 131328, v14
  s_lshl_b32 s30, s21, 5
  v_add_u32 v15, s30, v14
  ds_write_b32 v15, v12
  s_waitcnt lgkmcnt(0)
  s_barrier
  ds_read_b32 v48, v14
  ds_read_b32 v49, v14 offset:32
  ds_read_b32 v50, v14 offset:64
  ds_read_b32 v51, v14 offset:96
  s_waitcnt lgkmcnt(0)
  v_add_f32 v48, v48, v49
  v_add_f32 v50, v50, v51
  v_add_f32 v48, v48, v50
  v_mov_b32 v49, 0x3727c5ac
  v_fmac_f32 v49, 0x3acccccd, v48
  v_rsq_f32 v49, v49
  s_nop 0
  v_mul_f32 v56, v56, v49
  v_mul_f32 v57, v57, v49
  v_mul_f32 v58, v58, v49
  v_mul_f32 v59, v59, v49
  v_mul_f32 v60, v60, v49
  v_mul_f32 v61, v61, v49
  v_mul_f32 v62, v62, v49
  v_mul_f32 v63, v63, v49
  v_mul_f32 v64, v64, v49
  v_mul_f32 v65, v65, v49
  v_mul_f32 v66, v66, v49
  v_mul_f32 v67, v67, v49
  v_mul_f32 v68, v68, v49
  v_mul_f32 v69, v69, v49
  v_mul_f32 v70, v70, v49
  v_mul_f32 v71, v71, v49
  v_mul_f32 v72, v72, v49
  v_mul_f32 v73, v73, v49
  v_mul_f32 v74, v74, v49
  v_mul_f32 v75, v75, v49
  v_mul_f32 v76, v76, v49
  v_mul_f32 v77, v77, v49
  v_mul_f32 v78, v78, v49
  v_mul_f32 v79, v79, v49
  v_cvt_pk_bf16_f32 v80, v56, v57
  v_cvt_pk_bf16_f32 v81, v58, v59
  v_cvt_pk_bf16_f32 v82, v60, v61
  v_cvt_pk_bf16_f32 v83, v62, v63
  v_cvt_pk_bf16_f32 v84, v64, v65
  v_cvt_pk_bf16_f32 v85, v66, v67
  v_cvt_pk_bf16_f32 v86, v68, v69
  v_cvt_pk_bf16_f32 v87, v70, v71
  v_cvt_pk_bf16_f32 v88, v72, v73
  v_cvt_pk_bf16_f32 v89, v74, v75
  v_cvt_pk_bf16_f32 v90, v76, v77
  v_cvt_pk_bf16_f32 v91, v78, v79
  s_mul_i32 s30, s26, 40960
  s_lshl_b32 s31, s21, 12
  s_add_u32 s30, s30, s31
  s_add_u32 s30, s30, 0x100000
  s_add_u32 s31, s30, 0
  buffer_store_dwordx4 v[80:83], v10, s[8:11], s31 offen sc1
  s_add_u32 s31, s30, 16384
  buffer_store_dwordx4 v[84:87], v10, s[8:11], s31 offen sc1
  s_cmp_lt_u32 s21, 2
  s_cbranch_scc0 g3_27
  s_add_u32 s31, s30, 32768
  buffer_store_dwordx4 v[88:91], v10, s[8:11], s31 offen sc1
g3_27:
  s_waitcnt vmcnt(0)
  s_barrier
  s_cmp_eq_u32 s21, 0
  s_cbranch_scc0 arr_28
  s_mov_b64 s[24:25], exec
  s_mov_b64 exec, 1
  v_mov_b32 v3, 0
  v_mov_b32 v4, 1
  buffer_atomic_add v4, v3, s[8:11], s46 offen
  s_mov_b64 exec, s[24:25]
arr_28:
  s_mov_b32 s45, 0
  v_mov_b32 v3, 0
aw_29:
  buffer_load_dword v4, v3, s[8:11], s46 offen sc1
  s_add_u32 s45, s45, 1
  s_waitcnt vmcnt(0)
  v_readfirstlane_b32 s29, v4
  s_cmp_ge_u32 s29, 32
  s_cbranch_scc1 aw_29_ok
  s_cmp_lt_u32 s45, 400000
  s_cbranch_scc1 aw_29
  s_branch kb1_abort
aw_29_ok:
  s_barrier
  s_lshl_b32 s26, s23, 3
  s_lshl_b32 s27, s21, 1
  s_add_u32 s24, s26, s27
  s_mul_i32 s27, s24, 40960
  s_add_u32 s27, s27, 0x100000
  s_add_u32 s28, s27, 40960
  v_mov_b32 v3, v2
  v_add_u32 v4, 65536, v2
  v_lshlrev_b32 v5, 7, v1
  s_add_u32 s29, s27, 0
  buffer_load_dword v10, v5, s[8:11], s29 offen sc1
  s_add_u32 s29, s27, 8192
  buffer_load_dword v10, v5, s[8:11], s29 offen sc1
  s_add_u32 s29, s27, 16384
  buffer_load_dword v10, v5, s[8:11], s29 offen sc1
  s_add_u32 s29, s27, 24576
  buffer_load_dword v10, v5, s[8:11], s29 offen sc1
  s_add_u32 s29, s27, 32768
  buffer_load_dword v10, v5, s[8:11], s29 offen sc1
  s_add_u32 s29, s27, 40960
  buffer_load_dword v10, v5, s[8:11], s29 offen sc1
  s_add_u32 s29, s27, 49152
  buffer_load_dword v10, v5, s[8:11], s29 offen sc1
  s_add_u32 s29, s27, 57344
  buffer_load_dword v10, v5, s[8:11], s29 offen sc1
  s_add_u32 s29, s27, 65536
  buffer_load_dword v10, v5, s[8:11], s29 offen sc1
  s_add_u32 s29, s27, 73728
  buffer_load_dword v10, v5, s[8:11], s29 offen sc1
  s_mov_b32 s30, 0x3ea52b5c
  v_mov_b32 v5, 0
  v_cmp_gt_u32 s[34:35], 32, v1
  v_mov_b32 v6, 1.0
  v_and_b32 v7, 31, v1
  v_cndmask_b32 v6, v5, v6, s[34:35]
  v_cmp_eq_u32 s[32:33], 20, v7
  v_mov_b32 v8, 1.0
  s_lshl_b32 s31, s22, 6
  s_add_u32 s31, s31, s24
  s_lshl_b32 s31, s31, 11
  v_mov_b32 v9, 0
  s_add_u32 s29, s27, 0
  buffer_load_dwordx4 v[16:19], v2, s[8:11], s29 offen sc1
  s_add_u32 s29, s27, 1024
  buffer_load_dwordx4 v[20:23], v2, s[8:11], s29 offen sc1
  s_add_u32 s29, s27, 2048
  buffer_load_dwordx4 v[24:27], v2, s[8:11], s29 offen sc1
  s_add_u32 s29, s27, 3072
  buffer_load_dwordx4 v[28:31], v2, s[8:11], s29 offen sc1
  s_add_u32 s29, s27, 4096
  buffer_load_dwordx4 v[32:35], v2, s[8:11], s29 offen sc1
  s_add_u32 s29, s27, 5120
  buffer_load_dwordx4 v[36:39], v2, s[8:11], s29 offen sc1
  s_add_u32 s29, s27, 6144
  buffer_load_dwordx4 v[40:43], v2, s[8:11], s29 offen sc1
  s_add_u32 s29, s27, 7168
  buffer_load_dwordx4 v[44:47], v2, s[8:11], s29 offen sc1
  s_add_u32 s29, s27, 8192
  buffer_load_dwordx4 v[48:51], v2, s[8:11], s29 offen sc1
  s_add_u32 s29, s27, 9216
  buffer_load_dwordx4 v[52:55], v2, s[8:11], s29 offen sc1
  s_add_u32 s29, s27, 10240
  buffer_load_dwordx4 v[56:59], v2, s[8:11], s29 offen sc1
  s_add_u32 s29, s27, 11264
  buffer_load_dwordx4 v[60:63], v2, s[8:11], s29 offen sc1
  s_add_u32 s29, s27, 12288
  buffer_load_dwordx4 v[64:67], v2, s[8:11], s29 offen sc1
  s_add_u32 s29, s27, 13312
  buffer_load_dwordx4 v[68:71], v2, s[8:11], s29 offen sc1
  s_add_u32 s29, s27, 14336
  buffer_load_dwordx4 v[72:75], v2, s[8:11], s29 offen sc1
  ds_read_b128 v[208:211], v3 offset:0
  ds_read_b128 v[212:215], v3 offset:40960
  ds_read_b128 v[216:219], v4 offset:16384
  s_add_u32 s29, s27, 15360
  buffer_load_dwordx4 v[76:79], v2, s[8:11], s29 offen sc1
  ds_read_b128 v[220:223], v3 offset:1024
  ds_read_b128 v[224:227], v3 offset:41984
  ds_read_b128 v[228:231], v4 offset:17408
  s_waitcnt lgkmcnt(3)
  s_waitcnt vmcnt(15)
  v_mfma_f32_32x32x16_bf16 v[80:95], v[208:211], v[16:19], 0
  v_mfma_f32_32x32x16_bf16 v[96:111], v[212:215], v[16:19], 0
  v_mfma_f32_32x32x16_bf16 v[112:127], v[16:19], v[216:219], 0
  s_add_u32 s29, s27, 16384
  buffer_load_dwordx4 v[16:19], v2, s[8:11], s29 offen sc1
  ds_read_b128 v[208:211], v3 offset:2048
  ds_read_b128 v[212:215], v3 offset:43008
  ds_read_b128 v[216:219], v4 offset:18432
  s_waitcnt lgkmcnt(3)
  s_waitcnt vmcnt(15)
  v_mfma_f32_32x32x16_bf16 v[80:95], v[220:223], v[20:23], v[80:95]
  v_mfma_f32_32x32x16_bf16 v[96:111], v[224:227], v[20:23], v[96:111]
  v_mfma_f32_32x32x16_bf16 v[112:127], v[20:23], v[228:231], v[112:127]
  s_add_u32 s29, s27, 17408
  buffer_load_dwordx4 v[20:23], v2, s[8:11], s29 offen sc1
  ds_read_b128 v[220:223], v3 offset:3072
  ds_read_b128 v[224:227], v3 offset:44032
  ds_read_b128 v[228:231], v4 offset:19456
  s_waitcnt lgkmcnt(3)
  s_waitcnt vmcnt(15)
  v_mfma_f32_32x32x16_bf16 v[80:95], v[208:211], v[24:27], v[80:95]
  v_mfma_f32_32x32x16_bf16 v[96:111], v[212:215], v[24:27], v[96:111]
  v_mfma_f32_32x32x16_bf16 v[112:127], v[24:27], v[216:219], v[112:127]
  s_add_u32 s29, s27, 18432
  buffer_load_dwordx4 v[24:27], v2, s[8:11], s29 offen sc1
  ds_read_b128 v[208:211], v3 offset:4096
  ds_read_b128 v[212:215], v3 offset:45056
  ds_read_b128 v[216:219], v4 offset:20480
  s_waitcnt lgkmcnt(3)
  s_waitcnt vmcnt(15)
  v_mfma_f32_32x32x16_bf16 v[80:95], v[220:223], v[28:31], v[80:95]
  v_mfma_f32_32x32x16_bf16 v[96:111], v[224:227], v[28:31], v[96:111]
  v_mfma_f32_32x32x16_bf16 v[112:127], v[28:31], v[228:231], v[112:127]
  s_add_u32 s29, s27, 19456
  buffer_load_dwordx4 v[28:31], v2, s[8:11], s29 offen sc1
  ds_read_b128 v[220:223], v3 offset:5120
  ds_read_b128 v[224:227], v3 offset:46080
  ds_read_b128 v[228:231], v4 offset:21504
  s_waitcnt lgkmcnt(3)
  s_waitcnt vmcnt(15)
  v_mfma_f32_32x32x16_bf16 v[80:95], v[208:211], v[32:35], v[80:95]
  v_mfma_f32_32x32x16_bf16 v[96:111], v[212:215], v[32:35], v[96:111]
  v_mfma_f32_32x32x16_bf16 v[112:127], v[32:35], v[216:219], v[112:127]
  s_add_u32 s29, s27, 20480
  buffer_load_dwordx4 v[32:35], v2, s[8:11], s29 offen sc1
  ds_read_b128 v[208:211], v3 offset:6144
  ds_read_b128 v[212:215], v3 offset:47104
  ds_read_b128 v[216:219], v4 offset:22528
  s_waitcnt lgkmcnt(3)
  s_waitcnt vmcnt(15)
  v_mfma_f32_32x32x16_bf16 v[80:95], v[220:223], v[36:39], v[80:95]
  v_mfma_f32_32x32x16_bf16 v[96:111], v[224:227], v[36:39], v[96:111]
  v_mfma_f32_32x32x16_bf16 v[112:127], v[36:39], v[228:231], v[112:127]
  s_add_u32 s29, s27, 21504
  buffer_load_dwordx4 v[36:39], v2, s[8:11], s29 offen sc1
  ds_read_b128 v[220:223], v3 offset:7168
  ds_read_b128 v[224:227], v3 offset:48128
  ds_read_b128 v[228:231], v4 offset:23552
  s_waitcnt lgkmcnt(3)
  s_waitcnt vmcnt(15)
  v_mfma_f32_32x32x16_bf16 v[80:95], v[208:211], v[40:43], v[80:95]
  v_mfma_f32_32x32x16_bf16 v[96:111], v[212:215], v[40:43], v[96:111]
  v_mfma_f32_32x32x16_bf16 v[112:127], v[40:43], v[216:219], v[112:127]
  s_add_u32 s29, s27, 22528
  buffer_load_dwordx4 v[40:43], v2, s[8:11], s29 offen sc1
  ds_read_b128 v[208:211], v3 offset:8192
  ds_read_b128 v[212:215], v3 offset:49152
  ds_read_b128 v[216:219], v4 offset:24576
  s_waitcnt lgkmcnt(3)
  s_waitcnt vmcnt(15)
  v_mfma_f32_32x32x16_bf16 v[80:95], v[220:223], v[44:47], v[80:95]
  v_mfma_f32_32x32x16_bf16 v[96:111], v[224:227], v[44:47], v[96:111]
  v_mfma_f32_32x32x16_bf16 v[112:127], v[44:47], v[228:231], v[112:127]
  s_add_u32 s29, s27, 23552
  buffer_load_dwordx4 v[44:47], v2, s[8:11], s29 offen sc1
  ds_read_b128 v[220:223], v3 offset:9216
  ds_read_b128 v[224:227], v3 offset:50176
  ds_read_b128 v[228:231], v4 offset:25600
  s_waitcnt lgkmcnt(3)
  s_waitcnt vmcnt(15)
  v_mfma_f32_32x32x16_bf16 v[80:95], v[208:211], v[48:51], v[80:95]
  v_mfma_f32_32x32x16_bf16 v[96:111], v[212:215], v[48:51], v[96:111]
  v_mfma_f32_32x32x16_bf16 v[112:127], v[48:51], v[216:219], v[112:127]
  s_add_u32 s29, s27, 24576
  buffer_load_dwordx4 v[48:51], v2, s[8:11], s29 offen sc1
  ds_read_b128 v[208:211], v3 offset:10240
  ds_read_b128 v[212:215], v3 offset:51200
  ds_read_b128 v[216:219], v4 offset:26624
  s_waitcnt lgkmcnt(3)
  s_waitcnt vmcnt(15)
  v_mfma_f32_32x32x16_bf16 v[80:95], v[220:223], v[52:55], v[80:95]
  v_mfma_f32_32x32x16_bf16 v[96:111], v[224:227], v[52:55], v[96:111]
  v_mfma_f32_32x32x16_bf16 v[112:127], v[52:55], v[228:231], v[112:127]
  s_add_u32 s29, s27, 25600
  buffer_load_dwordx4 v[52:55], v2, s[8:11], s29 offen sc1
  ds_read_b128 v[220:223], v3 offset:11264
  ds_read_b128 v[224:227], v3 offset:52224
  ds_read_b128 v[228:231], v4 offset:27648
  s_waitcnt lgkmcnt(3)
  s_waitcnt vmcnt(15)
  v_mfma_f32_32x32x16_bf16 v[80:95], v[208:211], v[56:59], v[80:95]
  v_mfma_f32_32x32x16_bf16 v[96:111], v[212:215], v[56:59], v[96:111]
  v_mfma_f32_32x32x16_bf16 v[112:127], v[56:59], v[216:219], v[112:127]
  s_add_u32 s29, s27, 26624
  buffer_load_dwordx4 v[56:59], v2, s[8:11], s29 offen sc1
  ds_read_b128 v[208:211], v3 offset:12288
  ds_read_b128 v[212:215], v3 offset:53248
  ds_read_b128 v[216:219], v4 offset:28672
  s_waitcnt lgkmcnt(3)
  s_waitcnt vmcnt(15)
  v_mfma_f32_32x32x16_bf16 v[80:95], v[220:223], v[60:63], v[80:95]
  v_mfma_f32_32x32x16_bf16 v[96:111], v[224:227], v[60:63], v[96:111]
  v_mfma_f32_32x32x16_bf16 v[112:127], v[60:63], v[228:231], v[112:127]
  s_add_u32 s29, s27, 27648
  buffer_load_dwordx4 v[60:63], v2, s[8:11], s29 offen sc1
  ds_read_b128 v[220:223], v3 offset:13312
  ds_read_b128 v[224:227], v3 offset:54272
  ds_read_b128 v[228:231], v4 offset:29696
  s_waitcnt lgkmcnt(3)
  s_waitcnt vmcnt(15)
  v_mfma_f32_32x32x16_bf16 v[80:95], v[208:211], v[64:67], v[80:95]
  v_mfma_f32_32x32x16_bf16 v[96:111], v[212:215], v[64:67], v[96:111]
  v_mfma_f32_32x32x16_bf16 v[112:127], v[64:67], v[216:219], v[112:127]
  s_add_u32 s29, s27, 28672
  buffer_load_dwordx4 v[64:67], v2, s[8:11], s29 offen sc1
  ds_read_b128 v[208:211], v3 offset:14336
  ds_read_b128 v[212:215], v3 offset:55296
  ds_read_b128 v[216:219], v4 offset:30720
  s_waitcnt lgkmcnt(3)
  s_waitcnt vmcnt(15)
  v_mfma_f32_32x32x16_bf16 v[80:95], v[220:223], v[68:71], v[80:95]
  v_mfma_f32_32x32x16_bf16 v[96:111], v[224:227], v[68:71], v[96:111]
  v_mfma_f32_32x32x16_bf16 v[112:127], v[68:71], v[228:231], v[112:127]
  s_add_u32 s29, s27, 29696
  buffer_load_dwordx4 v[68:71], v2, s[8:11], s29 offen sc1
  ds_read_b128 v[220:223], v3 offset:15360
  ds_read_b128 v[224:227], v3 offset:56320
  ds_read_b128 v[228:231], v4 offset:31744
  s_waitcnt lgkmcnt(3)
  s_waitcnt vmcnt(15)
  v_mfma_f32_32x32x16_bf16 v[80:95], v[208:211], v[72:75], v[80:95]
  v_mfma_f32_32x32x16_bf16 v[96:111], v[212:215], v[72:75], v[96:111]
  v_mfma_f32_32x32x16_bf16 v[112:127], v[72:75], v[216:219], v[112:127]
  s_add_u32 s29, s27, 30720
  buffer_load_dwordx4 v[72:75], v2, s[8:11], s29 offen sc1
  ds_read_b128 v[208:211], v3 offset:16384
  ds_read_b128 v[212:215], v3 offset:57344
  ds_read_b128 v[216:219], v4 offset:32768
  s_waitcnt lgkmcnt(3)
  s_waitcnt vmcnt(15)
  v_mfma_f32_32x32x16_bf16 v[80:95], v[220:223], v[76:79], v[80:95]
  v_mfma_f32_32x32x16_bf16 v[96:111], v[224:227], v[76:79], v[96:111]
  v_mfma_f32_32x32x16_bf16 v[112:127], v[76:79], v[228:231], v[112:127]
  s_add_u32 s29, s27, 31744
  buffer_load_dwordx4 v[76:79], v2, s[8:11], s29 offen sc1
  ds_read_b128 v[220:223], v3 offset:17408
  ds_read_b128 v[224:227], v3 offset:58368
  ds_read_b128 v[228:231], v4 offset:33792
  s_waitcnt lgkmcnt(3)
  s_waitcnt vmcnt(15)
  v_mfma_f32_32x32x16_bf16 v[80:95], v[208:211], v[16:19], v[80:95]
  v_mfma_f32_32x32x16_bf16 v[96:111], v[212:215], v[16:19], v[96:111]
  v_mfma_f32_32x32x16_bf16 v[112:127], v[16:19], v[216:219], v[112:127]
  s_add_u32 s29, s27, 32768
  buffer_load_dwordx4 v[16:19], v2, s[8:11], s29 offen sc1
  ds_read_b128 v[208:211], v3 offset:18432
  ds_read_b128 v[212:215], v3 offset:59392
  ds_read_b128 v[216:219], v4 offset:34816
  s_waitcnt lgkmcnt(3)
  s_waitcnt vmcnt(15)
  v_mfma_f32_32x32x16_bf16 v[80:95], v[220:223], v[20:23], v[80:95]
  v_mfma_f32_32x32x16_bf16 v[96:111], v[224:227], v[20:23], v[96:111]
  v_mfma_f32_32x32x16_bf16 v[112:127], v[20:23], v[228:231], v[112:127]
  s_add_u32 s29, s27, 33792
  buffer_load_dwordx4 v[20:23], v2, s[8:11], s29 offen sc1
  ds_read_b128 v[220:223], v3 offset:19456
  ds_read_b128 v[224:227], v3 offset:60416
  ds_read_b128 v[228:231], v4 offset:35840
  s_waitcnt lgkmcnt(3)
  s_waitcnt vmcnt(15)
  v_mfma_f32_32x32x16_bf16 v[80:95], v[208:211], v[24:27], v[80:95]
  v_mfma_f32_32x32x16_bf16 v[96:111], v[212:215], v[24:27], v[96:111]
  v_mfma_f32_32x32x16_bf16 v[112:127], v[24:27], v[216:219], v[112:127]
  s_add_u32 s29, s27, 34816
  buffer_load_dwordx4 v[24:27], v2, s[8:11], s29 offen sc1
  ds_read_b128 v[208:211], v3 offset:20480
  ds_read_b128 v[212:215], v3 offset:61440
  ds_read_b128 v[216:219], v4 offset:36864
  s_waitcnt lgkmcnt(3)
  s_waitcnt vmcnt(15)
  v_mfma_f32_32x32x16_bf16 v[80:95], v[220:223], v[28:31], v[80:95]
  v_mfma_f32_32x32x16_bf16 v[96:111], v[224:227], v[28:31], v[96:111]
  v_mfma_f32_32x32x16_bf16 v[112:127], v[28:31], v[228:231], v[112:127]
  s_add_u32 s29, s27, 35840
  buffer_load_dwordx4 v[28:31], v2, s[8:11], s29 offen sc1
  ds_read_b128 v[220:223], v3 offset:21504
  ds_read_b128 v[224:227], v3 offset:62464
  ds_read_b128 v[228:231], v4 offset:37888
  s_waitcnt lgkmcnt(3)
  s_waitcnt vmcnt(15)
  v_mfma_f32_32x32x16_bf16 v[80:95], v[208:211], v[32:35], v[80:95]
  v_mfma_f32_32x32x16_bf16 v[96:111], v[212:215], v[32:35], v[96:111]
  v_mfma_f32_32x32x16_bf16 v[112:127], v[32:35], v[216:219], v[112:127]
  s_add_u32 s29, s27, 36864
  buffer_load_dwordx4 v[32:35], v2, s[8:11], s29 offen sc1
  ds_read_b128 v[208:211], v3 offset:22528
  ds_read_b128 v[212:215], v3 offset:63488
  ds_read_b128 v[216:219], v4 offset:38912
  s_waitcnt lgkmcnt(3)
  s_waitcnt vmcnt(15)
  v_mfma_f32_32x32x16_bf16 v[80:95], v[220:223], v[36:39], v[80:95]
  v_mfma_f32_32x32x16_bf16 v[96:111], v[224:227], v[36:39], v[96:111]
  v_mfma_f32_32x32x16_bf16 v[112:127], v[36:39], v[228:231], v[112:127]
  s_add_u32 s29, s27, 37888
  buffer_load_dwordx4 v[36:39], v2, s[8:11], s29 offen sc1
  ds_read_b128 v[220:223], v3 offset:23552
  ds_read_b128 v[224:227], v3 offset:64512
  ds_read_b128 v[228:231], v4 offset:39936
  s_waitcnt lgkmcnt(3)
  s_waitcnt vmcnt(15)
  v_mfma_f32_32x32x16_bf16 v[80:95], v[208:211], v[40:43], v[80:95]
  v_mfma_f32_32x32x16_bf16 v[96:111], v[212:215], v[40:43], v[96:111]
  v_mfma_f32_32x32x16_bf16 v[112:127], v[40:43], v[216:219], v[112:127]
  s_add_u32 s29, s27, 38912
  buffer_load_dwordx4 v[40:43], v2, s[8:11], s29 offen sc1
  ds_read_b128 v[208:211], v3 offset:24576
  ds_read_b128 v[212:215], v4 offset:0
  ds_read_b128 v[216:219], v4 offset:40960
  s_waitcnt lgkmcnt(3)
  s_waitcnt vmcnt(15)
  v_mfma_f32_32x32x16_bf16 v[80:95], v[220:223], v[44:47], v[80:95]
  v_mfma_f32_32x32x16_bf16 v[96:111], v[224:227], v[44:47], v[96:111]
  v_mfma_f32_32x32x16_bf16 v[112:127], v[44:47], v[228:231], v[112:127]
  s_add_u32 s29, s27, 39936
  buffer_load_dwordx4 v[44:47], v2, s[8:11], s29 offen sc1
  ds_read_b128 v[220:223], v3 offset:25600
  ds_read_b128 v[224:227], v4 offset:1024
  ds_read_b128 v[228:231], v4 offset:41984
  s_waitcnt lgkmcnt(3)
  s_waitcnt vmcnt(15)
  v_mfma_f32_32x32x16_bf16 v[80:95], v[208:211], v[48:51], v[80:95]
  v_mfma_f32_32x32x16_bf16 v[96:111], v[212:215], v[48:51], v[96:111]
  v_mfma_f32_32x32x16_bf16 v[112:127], v[48:51], v[216:219], v[112:127]
  s_add_u32 s29, s28, 0
  buffer_load_dwordx4 v[48:51], v2, s[8:11], s29 offen sc1
  ds_read_b128 v[208:211], v3 offset:26624
  ds_read_b128 v[212:215], v4 offset:2048
  ds_read_b128 v[216:219], v4 offset:43008
  s_waitcnt lgkmcnt(3)
  s_waitcnt vmcnt(15)
  v_mfma_f32_32x32x16_bf16 v[80:95], v[220:223], v[52:55], v[80:95]
  v_mfma_f32_32x32x16_bf16 v[96:111], v[224:227], v[52:55], v[96:111]
  v_mfma_f32_32x32x16_bf16 v[112:127], v[52:55], v[228:231], v[112:127]
  s_add_u32 s29, s28, 1024
  buffer_load_dwordx4 v[52:55], v2, s[8:11], s29 offen sc1
  ds_read_b128 v[220:223], v3 offset:27648
  ds_read_b128 v[224:227], v4 offset:3072
  ds_read_b128 v[228:231], v4 offset:44032
  s_waitcnt lgkmcnt(3)
  s_waitcnt vmcnt(15)
  v_mfma_f32_32x32x16_bf16 v[80:95], v[208:211], v[56:59], v[80:95]
  v_mfma_f32_32x32x16_bf16 v[96:111], v[212:215], v[56:59], v[96:111]
  v_mfma_f32_32x32x16_bf16 v[112:127], v[56:59], v[216:219], v[112:127]
  s_add_u32 s29, s28, 2048
  buffer_load_dwordx4 v[56:59], v2, s[8:11], s29 offen sc1
  ds_read_b128 v[208:211], v3 offset:28672
  ds_read_b128 v[212:215], v4 offset:4096
  ds_read_b128 v[216:219], v4 offset:45056
  s_waitcnt lgkmcnt(3)
  s_waitcnt vmcnt(15)
  v_mfma_f32_32x32x16_bf16 v[80:95], v[220:223], v[60:63], v[80:95]
  v_mfma_f32_32x32x16_bf16 v[96:111], v[224:227], v[60:63], v[96:111]
  v_mfma_f32_32x32x16_bf16 v[112:127], v[60:63], v[228:231], v[112:127]
  s_add_u32 s29, s28, 3072
  buffer_load_dwordx4 v[60:63], v2, s[8:11], s29 offen sc1
  ds_read_b128 v[220:223], v3 offset:29696
  ds_read_b128 v[224:227], v4 offset:5120
  ds_read_b128 v[228:231], v4 offset:46080
  s_waitcnt lgkmcnt(3)
  s_waitcnt vmcnt(15)
  v_mfma_f32_32x32x16_bf16 v[80:95], v[208:211], v[64:67], v[80:95]
  v_mfma_f32_32x32x16_bf16 v[96:111], v[212:215], v[64:67], v[96:111]
  v_mfma_f32_32x32x16_bf16 v[112:127], v[64:67], v[216:219], v[112:127]
  s_add_u32 s29, s28, 4096
  buffer_load_dwordx4 v[64:67], v2, s[8:11], s29 offen sc1
  ds_read_b128 v[208:211], v3 offset:30720
  ds_read_b128 v[212:215], v4 offset:6144
  ds_read_b128 v[216:219], v4 offset:47104
  s_waitcnt lgkmcnt(3)
  s_waitcnt vmcnt(15)
  v_mfma_f32_32x32x16_bf16 v[80:95], v[220:223], v[68:71], v[80:95]
  v_mfma_f32_32x32x16_bf16 v[96:111], v[224:227], v[68:71], v[96:111]
  v_mfma_f32_32x32x16_bf16 v[112:127], v[68:71], v[228:231], v[112:127]
  s_add_u32 s29, s28, 5120
  buffer_load_dwordx4 v[68:71], v2, s[8:11], s29 offen sc1
  ds_read_b128 v[220:223], v3 offset:31744
  ds_read_b128 v[224:227], v4 offset:7168
  ds_read_b128 v[228:231], v4 offset:48128
  s_waitcnt lgkmcnt(3)
  s_waitcnt vmcnt(15)
  v_mfma_f32_32x32x16_bf16 v[80:95], v[208:211], v[72:75], v[80:95]
  v_mfma_f32_32x32x16_bf16 v[96:111], v[212:215], v[72:75], v[96:111]
  v_mfma_f32_32x32x16_bf16 v[112:127], v[72:75], v[216:219], v[112:127]
  s_add_u32 s29, s28, 6144
  buffer_load_dwordx4 v[72:75], v2, s[8:11], s29 offen sc1
  ds_read_b128 v[208:211], v3 offset:32768
  ds_read_b128 v[212:215], v4 offset:8192
  ds_read_b128 v[216:219], v4 offset:49152
  s_waitcnt lgkmcnt(3)
  s_waitcnt vmcnt(15)
  v_mfma_f32_32x32x16_bf16 v[80:95], v[220:223], v[76:79], v[80:95]
  v_mfma_f32_32x32x16_bf16 v[96:111], v[224:227], v[76:79], v[96:111]
  v_mfma_f32_32x32x16_bf16 v[112:127], v[76:79], v[228:231], v[112:127]
  s_add_u32 s29, s28, 7168
  buffer_load_dwordx4 v[76:79], v2, s[8:11], s29 offen sc1
  ds_read_b128 v[220:223], v3 offset:33792
  ds_read_b128 v[224:227], v4 offset:9216
  ds_read_b128 v[228:231], v4 offset:50176
  s_waitcnt lgkmcnt(3)
  s_waitcnt vmcnt(15)
  v_mfma_f32_32x32x16_bf16 v[80:95], v[208:211], v[16:19], v[80:95]
  v_mfma_f32_32x32x16_bf16 v[96:111], v[212:215], v[16:19], v[96:111]
  v_mfma_f32_32x32x16_bf16 v[112:127], v[16:19], v[216:219], v[112:127]
  s_add_u32 s29, s28, 8192
  buffer_load_dwordx4 v[16:19], v2, s[8:11], s29 offen sc1
  ds_read_b128 v[208:211], v3 offset:34816
  ds_read_b128 v[212:215], v4 offset:10240
  ds_read_b128 v[216:219], v4 offset:51200
  s_waitcnt lgkmcnt(3)
  s_waitcnt vmcnt(15)
  v_mfma_f32_32x32x16_bf16 v[80:95], v[220:223], v[20:23], v[80:95]
  v_mfma_f32_32x32x16_bf16 v[96:111], v[224:227], v[20:23], v[96:111]
  v_mfma_f32_32x32x16_bf16 v[112:127], v[20:23], v[228:231], v[112:127]
  s_add_u32 s29, s28, 9216
  buffer_load_dwordx4 v[20:23], v2, s[8:11], s29 offen sc1
  ds_read_b128 v[220:223], v3 offset:35840
  ds_read_b128 v[224:227], v4 offset:11264
  ds_read_b128 v[228:231], v4 offset:52224
  s_waitcnt lgkmcnt(3)
  s_waitcnt vmcnt(15)
  v_mfma_f32_32x32x16_bf16 v[80:95], v[208:211], v[24:27], v[80:95]
  v_mfma_f32_32x32x16_bf16 v[96:111], v[212:215], v[24:27], v[96:111]
  v_mfma_f32_32x32x16_bf16 v[112:127], v[24:27], v[216:219], v[112:127]
  s_add_u32 s29, s28, 10240
  buffer_load_dwordx4 v[24:27], v2, s[8:11], s29 offen sc1
  ds_read_b128 v[208:211], v3 offset:36864
  ds_read_b128 v[212:215], v4 offset:12288
  ds_read_b128 v[216:219], v4 offset:53248
  s_waitcnt lgkmcnt(3)
  s_waitcnt vmcnt(15)
  v_mfma_f32_32x32x16_bf16 v[80:95], v[220:223], v[28:31], v[80:95]
  v_mfma_f32_32x32x16_bf16 v[96:111], v[224:227], v[28:31], v[96:111]
  v_mfma_f32_32x32x16_bf16 v[112:127], v[28:31], v[228:231], v[112:127]
  s_add_u32 s29, s28, 11264
  buffer_load_dwordx4 v[28:31], v2, s[8:11], s29 offen sc1
  ds_read_b128 v[220:223], v3 offset:37888
  ds_read_b128 v[224:227], v4 offset:13312
  ds_read_b128 v[228:231], v4 offset:54272
  s_waitcnt lgkmcnt(3)
  s_waitcnt vmcnt(15)
  v_mfma_f32_32x32x16_bf16 v[80:95], v[208:211], v[32:35], v[80:95]
  v_mfma_f32_32x32x16_bf16 v[96:111], v[212:215], v[32:35], v[96:111]
  v_mfma_f32_32x32x16_bf16 v[112:127], v[32:35], v[216:219], v[112:127]
  s_add_u32 s29, s28, 12288
  buffer_load_dwordx4 v[32:35], v2, s[8:11], s29 offen sc1
  ds_read_b128 v[208:211], v3 offset:38912
  ds_read_b128 v[212:215], v4 offset:14336
  ds_read_b128 v[216:219], v4 offset:55296
  s_waitcnt lgkmcnt(3)
  s_waitcnt vmcnt(15)
  v_mfma_f32_32x32x16_bf16 v[80:95], v[220:223], v[36:39], v[80:95]
  v_mfma_f32_32x32x16_bf16 v[96:111], v[224:227], v[36:39], v[96:111]
  v_mfma_f32_32x32x16_bf16 v[112:127], v[36:39], v[228:231], v[112:127]
  s_add_u32 s29, s28, 13312
  buffer_load_dwordx4 v[36:39], v2, s[8:11], s29 offen sc1
  ds_read_b128 v[220:223], v3 offset:39936
  ds_read_b128 v[224:227], v4 offset:15360
  ds_read_b128 v[228:231], v4 offset:56320
  s_waitcnt lgkmcnt(3)
  s_waitcnt vmcnt(15)
  v_mfma_f32_32x32x16_bf16 v[80:95], v[208:211], v[40:43], v[80:95]
  v_mfma_f32_32x32x16_bf16 v[96:111], v[212:215], v[40:43], v[96:111]
  v_mfma_f32_32x32x16_bf16 v[112:127], v[40:43], v[216:219], v[112:127]
  s_add_u32 s29, s28, 14336
  buffer_load_dwordx4 v[40:43], v2, s[8:11], s29 offen sc1
  ds_read_b128 v[208:211], v3 offset:0
  ds_read_b128 v[212:215], v3 offset:40960
  ds_read_b128 v[216:219], v4 offset:16384
  s_waitcnt lgkmcnt(3)
  s_waitcnt vmcnt(15)
  v_mfma_f32_32x32x16_bf16 v[80:95], v[220:223], v[44:47], v[80:95]
  v_mfma_f32_32x32x16_bf16 v[96:111], v[224:227], v[44:47], v[96:111]
  v_mfma_f32_32x32x16_bf16 v[112:127], v[44:47], v[228:231], v[112:127]
  s_add_u32 s29, s28, 15360
  buffer_load_dwordx4 v[44:47], v2, s[8:11], s29 offen sc1
  ds_read_b128 v[220:223], v3 offset:1024
  ds_read_b128 v[224:227], v3 offset:41984
  ds_read_b128 v[228:231], v4 offset:17408
  s_waitcnt lgkmcnt(3)
  s_waitcnt vmcnt(15)
  v_mfma_f32_32x32x16_bf16 v[128:143], v[208:211], v[48:51], 0
  v_mfma_f32_32x32x16_bf16 v[144:159], v[212:215], v[48:51], 0
  v_mfma_f32_32x32x16_bf16 v[160:175], v[48:51], v[216:219], 0
  s_add_u32 s29, s28, 16384
  buffer_load_dwordx4 v[48:51], v2, s[8:11], s29 offen sc1
  ds_read_b128 v[208:211], v3 offset:2048
  ds_read_b128 v[212:215], v3 offset:43008
  ds_read_b128 v[216:219], v4 offset:18432
  s_waitcnt lgkmcnt(3)
  s_waitcnt vmcnt(15)
  v_mfma_f32_32x32x16_bf16 v[128:143], v[220:223], v[52:55], v[128:143]
  v_mfma_f32_32x32x16_bf16 v[144:159], v[224:227], v[52:55], v[144:159]
  v_mfma_f32_32x32x16_bf16 v[160:175], v[52:55], v[228:231], v[160:175]
  s_add_u32 s29, s28, 17408
  buffer_load_dwordx4 v[52:55], v2, s[8:11], s29 offen sc1
  ds_read_b128 v[220:223], v3 offset:3072
  ds_read_b128 v[224:227], v3 offset:44032
  ds_read_b128 v[228:231], v4 offset:19456
  s_waitcnt lgkmcnt(3)
  s_waitcnt vmcnt(15)
  v_mfma_f32_32x32x16_bf16 v[128:143], v[208:211], v[56:59], v[128:143]
  v_max3_f32 v9, v9, abs(v96), abs(v97)
  v_max3_f32 v9, v9, abs(v98), abs(v99)
  v_mfma_f32_32x32x16_bf16 v[144:159], v[212:215], v[56:59], v[144:159]
  v_max3_f32 v9, v9, abs(v100), abs(v101)
  v_max3_f32 v9, v9, abs(v102), abs(v103)
  v_mfma_f32_32x32x16_bf16 v[160:175], v[56:59], v[216:219], v[160:175]
  v_max3_f32 v9, v9, abs(v104), abs(v105)
  v_max3_f32 v9, v9, abs(v106), abs(v107)
  s_add_u32 s29, s28, 18432
  buffer_load_dwordx4 v[56:59], v2, s[8:11], s29 offen sc1
  ds_read_b128 v[208:211], v3 offset:4096
  ds_read_b128 v[212:215], v3 offset:45056
  ds_read_b128 v[216:219], v4 offset:20480
  s_waitcnt lgkmcnt(3)
  s_waitcnt vmcnt(15)
  v_mfma_f32_32x32x16_bf16 v[128:143], v[220:223], v[60:63], v[128:143]
  v_max3_f32 v9, v9, abs(v108), abs(v109)
  v_max3_f32 v9, v9, abs(v110), abs(v111)
  v_mfma_f32_32x32x16_bf16 v[144:159], v[224:227], v[60:63], v[144:159]
  v_add_f32 v108, v108, v6
  v_cvt_pk_bf16_f32 v232, v96, v97
  v_mfma_f32_32x32x16_bf16 v[160:175], v[60:63], v[228:231], v[160:175]
  v_cvt_pk_bf16_f32 v233, v98, v99
  v_cvt_pk_bf16_f32 v234, v100, v101
  s_add_u32 s29, s28, 19456
  buffer_load_dwordx4 v[60:63], v2, s[8:11], s29 offen sc1
  ds_read_b128 v[220:223], v3 offset:5120
  ds_read_b128 v[224:227], v3 offset:46080
  ds_read_b128 v[228:231], v4 offset:21504
  s_waitcnt lgkmcnt(3)
  s_waitcnt vmcnt(15)
  v_mfma_f32_32x32x16_bf16 v[128:143], v[208:211], v[64:67], v[128:143]
  v_cvt_pk_bf16_f32 v235, v102, v103
  v_cvt_pk_bf16_f32 v236, v104, v105
  v_mfma_f32_32x32x16_bf16 v[144:159], v[212:215], v[64:67], v[144:159]
  v_cvt_pk_bf16_f32 v237, v106, v107
  v_cvt_pk_bf16_f32 v238, v108, v109
  v_mfma_f32_32x32x16_bf16 v[160:175], v[64:67], v[216:219], v[160:175]
  v_cvt_pk_bf16_f32 v239, v110, v111
  s_add_u32 s26, s31, 245366784
  s_add_u32 s29, s28, 20480
  buffer_load_dwordx4 v[64:67], v2, s[8:11], s29 offen sc1
  ds_read_b128 v[208:211], v3 offset:6144
  ds_read_b128 v[212:215], v3 offset:47104
  ds_read_b128 v[216:219], v4 offset:22528
  s_waitcnt lgkmcnt(3)
  s_waitcnt vmcnt(15)
  v_mfma_f32_32x32x16_bf16 v[128:143], v[220:223], v[68:71], v[128:143]
  buffer_store_dwordx4 v[232:235], v2, s[8:11], s26 offen sc1
  buffer_store_dwordx4 v[236:239], v2, s[8:11], s26 offen offset:1024 sc1
  v_mfma_f32_32x32x16_bf16 v[144:159], v[224:227], v[68:71], v[144:159]
  v_cndmask_b32 v112, v112, v8, s[32:33]
  v_cndmask_b32 v113, v113, v8, s[32:33]
  v_mfma_f32_32x32x16_bf16 v[160:175], v[68:71], v[228:231], v[160:175]
  v_cndmask_b32 v114, v114, v8, s[32:33]
  v_cndmask_b32 v115, v115, v8, s[32:33]
  s_add_u32 s29, s28, 21504
  buffer_load_dwordx4 v[68:71], v2, s[8:11], s29 offen sc1
  ds_read_b128 v[220:223], v3 offset:7168
  ds_read_b128 v[224:227], v3 offset:48128
  ds_read_b128 v[228:231], v4 offset:23552
  s_waitcnt lgkmcnt(3)
  s_waitcnt vmcnt(17)
  v_mfma_f32_32x32x16_bf16 v[128:143], v[208:211], v[72:75], v[128:143]
  v_cndmask_b32 v116, v116, v8, s[32:33]
  v_cndmask_b32 v117, v117, v8, s[32:33]
  v_mfma_f32_32x32x16_bf16 v[144:159], v[212:215], v[72:75], v[144:159]
  v_cndmask_b32 v118, v118, v8, s[32:33]
  v_cndmask_b32 v119, v119, v8, s[32:33]
  v_mfma_f32_32x32x16_bf16 v[160:175], v[72:75], v[216:219], v[160:175]
  v_cndmask_b32 v120, v120, v8, s[32:33]
  v_cndmask_b32 v121, v121, v8, s[32:33]
  s_add_u32 s29, s28, 22528
  buffer_load_dwordx4 v[72:75], v2, s[8:11], s29 offen sc1
  ds_read_b128 v[208:211], v3 offset:8192
  ds_read_b128 v[212:215], v3 offset:49152
  ds_read_b128 v[216:219], v4 offset:24576
  s_waitcnt lgkmcnt(3)
  s_waitcnt vmcnt(17)
  v_mfma_f32_32x32x16_bf16 v[128:143], v[220:223], v[76:79], v[128:143]
  v_cndmask_b32 v122, v122, v8, s[32:33]
  v_cndmask_b32 v123, v123, v8, s[32:33]
  v_mfma_f32_32x32x16_bf16 v[144:159], v[224:227], v[76:79], v[144:159]
  v_cndmask_b32 v124, v124, v8, s[32:33]
  v_cndmask_b32 v125, v125, v8, s[32:33]
  v_mfma_f32_32x32x16_bf16 v[160:175], v[76:79], v[228:231], v[160:175]
  v_cndmask_b32 v126, v126, v8, s[32:33]
  v_cndmask_b32 v127, v127, v8, s[32:33]
  s_add_u32 s29, s28, 23552
  buffer_load_dwordx4 v[76:79], v2, s[8:11], s29 offen sc1
  ds_read_b128 v[220:223], v3 offset:9216
  ds_read_b128 v[224:227], v3 offset:50176
  ds_read_b128 v[228:231], v4 offset:25600
  s_waitcnt lgkmcnt(3)
  s_waitcnt vmcnt(17)
  v_mfma_f32_32x32x16_bf16 v[128:143], v[208:211], v[16:19], v[128:143]
  v_cvt_pk_bf16_f32 v240, v112, v113
  v_cvt_pk_bf16_f32 v241, v114, v115
  v_mfma_f32_32x32x16_bf16 v[144:159], v[212:215], v[16:19], v[144:159]
  v_cvt_pk_bf16_f32 v242, v116, v117
  v_cvt_pk_bf16_f32 v243, v118, v119
  v_mfma_f32_32x32x16_bf16 v[160:175], v[16:19], v[216:219], v[160:175]
  v_cvt_pk_bf16_f32 v244, v120, v121
  v_cvt_pk_bf16_f32 v245, v122, v123
  s_add_u32 s29, s28, 24576
  buffer_load_dwordx4 v[16:19], v2, s[8:11], s29 offen sc1
  ds_read_b128 v[208:211], v3 offset:10240
  ds_read_b128 v[212:215], v3 offset:51200
  ds_read_b128 v[216:219], v4 offset:26624
  s_waitcnt lgkmcnt(3)
  s_waitcnt vmcnt(17)
  v_mfma_f32_32x32x16_bf16 v[128:143], v[220:223], v[20:23], v[128:143]
  v_cvt_pk_bf16_f32 v246, v124, v125
  v_cvt_pk_bf16_f32 v247, v126, v127
  v_mfma_f32_32x32x16_bf16 v[144:159], v[224:227], v[20:23], v[144:159]
  s_add_u32 s26, s31, 249561088
  buffer_store_dwordx4 v[240:243], v2, s[8:11], s26 offen sc1
  v_mfma_f32_32x32x16_bf16 v[160:175], v[20:23], v[228:231], v[160:175]
  buffer_store_dwordx4 v[244:247], v2, s[8:11], s26 offen offset:1024 sc1
  v_mul_f32 v80, s30, v80
  s_add_u32 s29, s28, 25600
  buffer_load_dwordx4 v[20:23], v2, s[8:11], s29 offen sc1
  ds_read_b128 v[220:223], v3 offset:11264
  ds_read_b128 v[224:227], v3 offset:52224
  ds_read_b128 v[228:231], v4 offset:27648
  s_waitcnt lgkmcnt(3)
  s_waitcnt vmcnt(19)
  v_mfma_f32_32x32x16_bf16 v[128:143], v[208:211], v[24:27], v[128:143]
  v_mul_f32 v81, s30, v81
  v_mul_f32 v82, s30, v82
  v_mfma_f32_32x32x16_bf16 v[144:159], v[212:215], v[24:27], v[144:159]
  v_mul_f32 v83, s30, v83
  v_mul_f32 v84, s30, v84
  v_mfma_f32_32x32x16_bf16 v[160:175], v[24:27], v[216:219], v[160:175]
  v_mul_f32 v85, s30, v85
  v_mul_f32 v86, s30, v86
  s_add_u32 s29, s28, 26624
  buffer_load_dwordx4 v[24:27], v2, s[8:11], s29 offen sc1
  ds_read_b128 v[208:211], v3 offset:12288
  ds_read_b128 v[212:215], v3 offset:53248
  ds_read_b128 v[216:219], v4 offset:28672
  s_waitcnt lgkmcnt(3)
  s_waitcnt vmcnt(19)
  v_mfma_f32_32x32x16_bf16 v[128:143], v[220:223], v[28:31], v[128:143]
  v_mul_f32 v87, s30, v87
  v_mul_f32 v88, s30, v88
  v_mfma_f32_32x32x16_bf16 v[144:159], v[224:227], v[28:31], v[144:159]
  v_mul_f32 v89, s30, v89
  v_mul_f32 v90, s30, v90
  v_mfma_f32_32x32x16_bf16 v[160:175], v[28:31], v[228:231], v[160:175]
  v_mul_f32 v91, s30, v91
  v_mul_f32 v92, s30, v92
  s_add_u32 s29, s28, 27648
  buffer_load_dwordx4 v[28:31], v2, s[8:11], s29 offen sc1
  ds_read_b128 v[220:223], v3 offset:13312
  ds_read_b128 v[224:227], v3 offset:54272
  ds_read_b128 v[228:231], v4 offset:29696
  s_waitcnt lgkmcnt(3)
  s_waitcnt vmcnt(19)
  v_mfma_f32_32x32x16_bf16 v[128:143], v[208:211], v[32:35], v[128:143]
  v_mul_f32 v93, s30, v93
  v_mul_f32 v94, s30, v94
  v_mfma_f32_32x32x16_bf16 v[144:159], v[212:215], v[32:35], v[144:159]
  v_mul_f32 v95, s30, v95
  v_cvt_pk_bf16_f32 v192, v80, v81
  v_mfma_f32_32x32x16_bf16 v[160:175], v[32:35], v[216:219], v[160:175]
  v_cvt_pk_bf16_f32 v193, v82, v83
  v_cvt_pk_bf16_f32 v194, v84, v85
  s_add_u32 s29, s28, 28672
  buffer_load_dwordx4 v[32:35], v2, s[8:11], s29 offen sc1
  ds_read_b128 v[208:211], v3 offset:14336
  ds_read_b128 v[212:215], v3 offset:55296
  ds_read_b128 v[216:219], v4 offset:30720
  s_waitcnt lgkmcnt(3)
  s_waitcnt vmcnt(19)
  v_mfma_f32_32x32x16_bf16 v[128:143], v[220:223], v[36:39], v[128:143]
  v_cvt_pk_bf16_f32 v195, v86, v87
  v_cvt_pk_bf16_f32 v196, v88, v89
  v_mfma_f32_32x32x16_bf16 v[144:159], v[224:227], v[36:39], v[144:159]
  v_cvt_pk_bf16_f32 v197, v90, v91
  v_cvt_pk_bf16_f32 v198, v92, v93
  v_mfma_f32_32x32x16_bf16 v[160:175], v[36:39], v[228:231], v[160:175]
  v_cvt_pk_bf16_f32 v199, v94, v95
  s_add_u32 s29, s28, 29696
  buffer_load_dwordx4 v[36:39], v2, s[8:11], s29 offen sc1
  ds_read_b128 v[220:223], v3 offset:15360
  ds_read_b128 v[224:227], v3 offset:56320
  ds_read_b128 v[228:231], v4 offset:31744
  s_waitcnt lgkmcnt(3)
  s_waitcnt vmcnt(19)
  v_mfma_f32_32x32x16_bf16 v[128:143], v[208:211], v[40:43], v[128:143]
  v_mfma_f32_32x32x16_bf16 v[144:159], v[212:215], v[40:43], v[144:159]
  v_mfma_f32_32x32x16_bf16 v[160:175], v[40:43], v[216:219], v[160:175]
  s_add_u32 s29, s28, 30720
  buffer_load_dwordx4 v[40:43], v2, s[8:11], s29 offen sc1
  ds_read_b128 v[208:211], v3 offset:16384
  ds_read_b128 v[212:215], v3 offset:57344
  ds_read_b128 v[216:219], v4 offset:32768
  s_waitcnt lgkmcnt(3)
  s_waitcnt vmcnt(19)
  v_mfma_f32_32x32x16_bf16 v[128:143], v[220:223], v[44:47], v[128:143]
  v_mfma_f32_32x32x16_bf16 v[144:159], v[224:227], v[44:47], v[144:159]
  v_mfma_f32_32x32x16_bf16 v[160:175], v[44:47], v[228:231], v[160:175]
  s_add_u32 s29, s28, 31744
  buffer_load_dwordx4 v[44:47], v2, s[8:11], s29 offen sc1
  ds_read_b128 v[220:223], v3 offset:17408
  ds_read_b128 v[224:227], v3 offset:58368
  ds_read_b128 v[228:231], v4 offset:33792
  s_waitcnt lgkmcnt(3)
  s_waitcnt vmcnt(19)
  v_mfma_f32_32x32x16_bf16 v[128:143], v[208:211], v[48:51], v[128:143]
  v_mfma_f32_32x32x16_bf16 v[144:159], v[212:215], v[48:51], v[144:159]
  v_mfma_f32_32x32x16_bf16 v[160:175], v[48:51], v[216:219], v[160:175]
  s_add_u32 s29, s28, 32768
  buffer_load_dwordx4 v[48:51], v2, s[8:11], s29 offen sc1
  ds_read_b128 v[208:211], v3 offset:18432
  ds_read_b128 v[212:215], v3 offset:59392
  ds_read_b128 v[216:219], v4 offset:34816
  s_waitcnt lgkmcnt(3)
  s_waitcnt vmcnt(19)
  v_mfma_f32_32x32x16_bf16 v[128:143], v[220:223], v[52:55], v[128:143]
  v_mfma_f32_32x32x16_bf16 v[144:159], v[224:227], v[52:55], v[144:159]
  v_mfma_f32_32x32x16_bf16 v[160:175], v[52:55], v[228:231], v[160:175]
  s_add_u32 s29, s28, 33792
  buffer_load_dwordx4 v[52:55], v2, s[8:11], s29 offen sc1
  ds_read_b128 v[220:223], v3 offset:19456
  ds_read_b128 v[224:227], v3 offset:60416
  ds_read_b128 v[228:231], v4 offset:35840
  s_waitcnt lgkmcnt(3)
  s_waitcnt vmcnt(19)
  v_mfma_f32_32x32x16_bf16 v[128:143], v[208:211], v[56:59], v[128:143]
  v_mfma_f32_32x32x16_bf16 v[144:159], v[212:215], v[56:59], v[144:159]
  v_mfma_f32_32x32x16_bf16 v[160:175], v[56:59], v[216:219], v[160:175]
  s_add_u32 s29, s28, 34816
  buffer_load_dwordx4 v[56:59], v2, s[8:11], s29 offen sc1
  ds_read_b128 v[208:211], v3 offset:20480
  ds_read_b128 v[212:215], v3 offset:61440
  ds_read_b128 v[216:219], v4 offset:36864
  s_waitcnt lgkmcnt(3)
  s_waitcnt vmcnt(19)
  v_mfma_f32_32x32x16_bf16 v[128:143], v[220:223], v[60:63], v[128:143]
  v_mfma_f32_32x32x16_bf16 v[144:159], v[224:227], v[60:63], v[144:159]
  v_mfma_f32_32x32x16_bf16 v[160:175], v[60:63], v[228:231], v[160:175]
  s_add_u32 s29, s28, 35840
  buffer_load_dwordx4 v[60:63], v2, s[8:11], s29 offen sc1
  ds_read_b128 v[220:223], v3 offset:21504
  ds_read_b128 v[224:227], v3 offset:62464
  ds_read_b128 v[228:231], v4 offset:37888
  s_waitcnt lgkmcnt(3)
  s_waitcnt vmcnt(19)
  v_mfma_f32_32x32x16_bf16 v[128:143], v[208:211], v[64:67], v[128:143]
  v_mfma_f32_32x32x16_bf16 v[144:159], v[212:215], v[64:67], v[144:159]
  v_mfma_f32_32x32x16_bf16 v[160:175], v[64:67], v[216:219], v[160:175]
  s_add_u32 s29, s28, 36864
  buffer_load_dwordx4 v[64:67], v2, s[8:11], s29 offen sc1
  ds_read_b128 v[208:211], v3 offset:22528
  ds_read_b128 v[212:215], v3 offset:63488
  ds_read_b128 v[216:219], v4 offset:38912
  s_waitcnt lgkmcnt(3)
  s_waitcnt vmcnt(17)
  v_mfma_f32_32x32x16_bf16 v[128:143], v[220:223], v[68:71], v[128:143]
  v_mfma_f32_32x32x16_bf16 v[144:159], v[224:227], v[68:71], v[144:159]
  v_mfma_f32_32x32x16_bf16 v[160:175], v[68:71], v[228:231], v[160:175]
  s_add_u32 s29, s28, 37888
  buffer_load_dwordx4 v[68:71], v2, s[8:11], s29 offen sc1
  ds_read_b128 v[220:223], v3 offset:23552
  ds_read_b128 v[224:227], v3 offset:64512
  ds_read_b128 v[228:231], v4 offset:39936
  s_waitcnt lgkmcnt(3)
  s_waitcnt vmcnt(17)
  v_mfma_f32_32x32x16_bf16 v[128:143], v[208:211], v[72:75], v[128:143]
  v_mfma_f32_32x32x16_bf16 v[144:159], v[212:215], v[72:75], v[144:159]
  v_mfma_f32_32x32x16_bf16 v[160:175], v[72:75], v[216:219], v[160:175]
  s_add_u32 s29, s28, 38912
  buffer_load_dwordx4 v[72:75], v2, s[8:11], s29 offen sc1
  ds_read_b128 v[208:211], v3 offset:24576
  ds_read_b128 v[212:215], v4 offset:0
  ds_read_b128 v[216:219], v4 offset:40960
  s_waitcnt lgkmcnt(3)
  s_waitcnt vmcnt(17)
  v_mfma_f32_32x32x16_bf16 v[128:143], v[220:223], v[76:79], v[128:143]
  v_mfma_f32_32x32x16_bf16 v[144:159], v[224:227], v[76:79], v[144:159]
  v_mfma_f32_32x32x16_bf16 v[160:175], v[76:79], v[228:231], v[160:175]
  s_add_u32 s29, s28, 39936
  buffer_load_dwordx4 v[76:79], v2, s[8:11], s29 offen sc1
  ds_read_b128 v[220:223], v3 offset:25600
  ds_read_b128 v[224:227], v4 offset:1024
  ds_read_b128 v[228:231], v4 offset:41984
  s_waitcnt lgkmcnt(3)
  s_waitcnt vmcnt(17)
  v_mfma_f32_32x32x16_bf16 v[128:143], v[208:211], v[16:19], v[128:143]
  v_mfma_f32_32x32x16_bf16 v[144:159], v[212:215], v[16:19], v[144:159]
  v_mfma_f32_32x32x16_bf16 v[160:175], v[16:19], v[216:219], v[160:175]
  ds_read_b128 v[208:211], v3 offset:26624
  ds_read_b128 v[212:215], v4 offset:2048
  ds_read_b128 v[216:219], v4 offset:43008
  s_waitcnt lgkmcnt(3)
  s_waitcnt vmcnt(14)
  v_mfma_f32_32x32x16_bf16 v[128:143], v[220:223], v[20:23], v[128:143]
  v_mfma_f32_32x32x16_bf16 v[144:159], v[224:227], v[20:23], v[144:159]
  v_mfma_f32_32x32x16_bf16 v[160:175], v[20:23], v[228:231], v[160:175]
  ds_read_b128 v[220:223], v3 offset:27648
  ds_read_b128 v[224:227], v4 offset:3072
  ds_read_b128 v[228:231], v4 offset:44032
  s_waitcnt lgkmcnt(3)
  s_waitcnt vmcnt(13)
  v_mfma_f32_32x32x16_bf16 v[128:143], v[208:211], v[24:27], v[128:143]
  v_mfma_f32_32x32x16_bf16 v[144:159], v[212:215], v[24:27], v[144:159]
  v_mfma_f32_32x32x16_bf16 v[160:175], v[24:27], v[216:219], v[160:175]
  ds_read_b128 v[208:211], v3 offset:28672
  ds_read_b128 v[212:215], v4 offset:4096
  ds_read_b128 v[216:219], v4 offset:45056
  s_waitcnt lgkmcnt(3)
  s_waitcnt vmcnt(12)
  v_mfma_f32_32x32x16_bf16 v[128:143], v[220:223], v[28:31], v[128:143]
  v_mfma_f32_32x32x16_bf16 v[144:159], v[224:227], v[28:31], v[144:159]
  v_mfma_f32_32x32x16_bf16 v[160:175], v[28:31], v[228:231], v[160:175]
  ds_read_b128 v[220:223], v3 offset:29696
  ds_read_b128 v[224:227], v4 offset:5120
  ds_read_b128 v[228:231], v4 offset:46080
  s_waitcnt lgkmcnt(3)
  s_waitcnt vmcnt(11)
  v_mfma_f32_32x32x16_bf16 v[128:143], v[208:211], v[32:35], v[128:143]
  v_mfma_f32_32x32x16_bf16 v[144:159], v[212:215], v[32:35], v[144:159]
  v_mfma_f32_32x32x16_bf16 v[160:175], v[32:35], v[216:219], v[160:175]
  ds_read_b128 v[208:211], v3 offset:30720
  ds_read_b128 v[212:215], v4 offset:6144
  ds_read_b128 v[216:219], v4 offset:47104
  s_waitcnt lgkmcnt(3)
  s_waitcnt vmcnt(10)
  v_mfma_f32_32x32x16_bf16 v[128:143], v[220:223], v[36:39], v[128:143]
  v_mfma_f32_32x32x16_bf16 v[144:159], v[224:227], v[36:39], v[144:159]
  v_mfma_f32_32x32x16_bf16 v[160:175], v[36:39], v[228:231], v[160:175]
  ds_read_b128 v[220:223], v3 offset:31744
  ds_read_b128 v[224:227], v4 offset:7168
  ds_read_b128 v[228:231], v4 offset:48128
  s_waitcnt lgkmcnt(3)
  s_waitcnt vmcnt(9)
  v_mfma_f32_32x32x16_bf16 v[128:143], v[208:211], v[40:43], v[128:143]
  v_mfma_f32_32x32x16_bf16 v[144:159], v[212:215], v[40:43], v[144:159]
  v_mfma_f32_32x32x16_bf16 v[160:175], v[40:43], v[216:219], v[160:175]
  ds_read_b128 v[208:211], v3 offset:32768
  ds_read_b128 v[212:215], v4 offset:8192
  ds_read_b128 v[216:219], v4 offset:49152
  s_waitcnt lgkmcnt(3)
  s_waitcnt vmcnt(8)
  v_mfma_f32_32x32x16_bf16 v[128:143], v[220:223], v[44:47], v[128:143]
  v_mfma_f32_32x32x16_bf16 v[144:159], v[224:227], v[44:47], v[144:159]
  v_mfma_f32_32x32x16_bf16 v[160:175], v[44:47], v[228:231], v[160:175]
  ds_read_b128 v[220:223], v3 offset:33792
  ds_read_b128 v[224:227], v4 offset:9216
  ds_read_b128 v[228:231], v4 offset:50176
  s_waitcnt lgkmcnt(3)
  s_waitcnt vmcnt(7)
  v_mfma_f32_32x32x16_bf16 v[128:143], v[208:211], v[48:51], v[128:143]
  v_mfma_f32_32x32x16_bf16 v[144:159], v[212:215], v[48:51], v[144:159]
  v_mfma_f32_32x32x16_bf16 v[160:175], v[48:51], v[216:219], v[160:175]
  ds_read_b128 v[208:211], v3 offset:34816
  ds_read_b128 v[212:215], v4 offset:10240
  ds_read_b128 v[216:219], v4 offset:51200
  s_waitcnt lgkmcnt(3)
  s_waitcnt vmcnt(6)
  v_mfma_f32_32x32x16_bf16 v[128:143], v[220:223], v[52:55], v[128:143]
  v_mfma_f32_32x32x16_bf16 v[144:159], v[224:227], v[52:55], v[144:159]
  v_mfma_f32_32x32x16_bf16 v[160:175], v[52:55], v[228:231], v[160:175]
  ds_read_b128 v[220:223], v3 offset:35840
  ds_read_b128 v[224:227], v4 offset:11264
  ds_read_b128 v[228:231], v4 offset:52224
  s_waitcnt lgkmcnt(3)
  s_waitcnt vmcnt(5)
  v_mfma_f32_32x32x16_bf16 v[128:143], v[208:211], v[56:59], v[128:143]
  v_mfma_f32_32x32x16_bf16 v[144:159], v[212:215], v[56:59], v[144:159]
  v_mfma_f32_32x32x16_bf16 v[160:175], v[56:59], v[216:219], v[160:175]
  ds_read_b128 v[208:211], v3 offset:36864
  ds_read_b128 v[212:215], v4 offset:12288
  ds_read_b128 v[216:219], v4 offset:53248
  s_waitcnt lgkmcnt(3)
  s_waitcnt vmcnt(4)
  v_mfma_f32_32x32x16_bf16 v[128:143], v[220:223], v[60:63], v[128:143]
  v_mfma_f32_32x32x16_bf16 v[144:159], v[224:227], v[60:63], v[144:159]
  v_mfma_f32_32x32x16_bf16 v[160:175], v[60:63], v[228:231], v[160:175]
  ds_read_b128 v[220:223], v3 offset:37888
  ds_read_b128 v[224:227], v4 offset:13312
  ds_read_b128 v[228:231], v4 offset:54272
  s_waitcnt lgkmcnt(3)
  s_waitcnt vmcnt(3)
  v_mfma_f32_32x32x16_bf16 v[128:143], v[208:211], v[64:67], v[128:143]
  v_mfma_f32_32x32x16_bf16 v[144:159], v[212:215], v[64:67], v[144:159]
  v_mfma_f32_32x32x16_bf16 v[160:175], v[64:67], v[216:219], v[160:175]
  ds_read_b128 v[208:211], v3 offset:38912
  ds_read_b128 v[212:215], v4 offset:14336
  ds_read_b128 v[216:219], v4 offset:55296
  s_waitcnt lgkmcnt(3)
  s_waitcnt vmcnt(2)
  v_mfma_f32_32x32x16_bf16 v[128:143], v[220:223], v[68:71], v[128:143]
  v_mfma_f32_32x32x16_bf16 v[144:159], v[224:227], v[68:71], v[144:159]
  v_mfma_f32_32x32x16_bf16 v[160:175], v[68:71], v[228:231], v[160:175]
  ds_read_b128 v[220:223], v3 offset:39936
  ds_read_b128 v[224:227], v4 offset:15360
  ds_read_b128 v[228:231], v4 offset:56320
  s_waitcnt lgkmcnt(3)
  s_waitcnt vmcnt(1)
  v_mfma_f32_32x32x16_bf16 v[128:143], v[208:211], v[72:75], v[128:143]
  v_mfma_f32_32x32x16_bf16 v[144:159], v[212:215], v[72:75], v[144:159]
  v_mfma_f32_32x32x16_bf16 v[160:175], v[72:75], v[216:219], v[160:175]
  s_waitcnt lgkmcnt(0)
  s_waitcnt vmcnt(0)
  v_mfma_f32_32x32x16_bf16 v[128:143], v[220:223], v[76:79], v[128:143]
  v_mfma_f32_32x32x16_bf16 v[144:159], v[224:227], v[76:79], v[144:159]
  v_mfma_f32_32x32x16_bf16 v[160:175], v[76:79], v[228:231], v[160:175]
  s_nop 11
  v_max3_f32 v9, v9, abs(v144), abs(v145)
  v_max3_f32 v9, v9, abs(v146), abs(v147)
  v_max3_f32 v9, v9, abs(v148), abs(v149)
  v_max3_f32 v9, v9, abs(v150), abs(v151)
  v_max3_f32 v9, v9, abs(v152), abs(v153)
  v_max3_f32 v9, v9, abs(v154), abs(v155)
  v_max3_f32 v9, v9, abs(v156), abs(v157)
  v_max3_f32 v9, v9, abs(v158), abs(v159)
  v_add_f32 v156, v156, v6
  v_cvt_pk_bf16_f32 v232, v144, v145
  v_cvt_pk_bf16_f32 v233, v146, v147
  v_cvt_pk_bf16_f32 v234, v148, v149
  v_cvt_pk_bf16_f32 v235, v150, v151
  v_cvt_pk_bf16_f32 v236, v152, v153
  v_cvt_pk_bf16_f32 v237, v154, v155
  v_cvt_pk_bf16_f32 v238, v156, v157
  v_cvt_pk_bf16_f32 v239, v158, v159
  s_add_u32 s26, s31, 245368832
  buffer_store_dwordx4 v[232:235], v2, s[8:11], s26 offen sc1
  buffer_store_dwordx4 v[236:239], v2, s[8:11], s26 offen offset:1024 sc1
  v_cndmask_b32 v160, v160, v8, s[32:33]
  v_cndmask_b32 v161, v161, v8, s[32:33]
  v_cndmask_b32 v162, v162, v8, s[32:33]
  v_cndmask_b32 v163, v163, v8, s[32:33]
  v_cndmask_b32 v164, v164, v8, s[32:33]
  v_cndmask_b32 v165, v165, v8, s[32:33]
  v_cndmask_b32 v166, v166, v8, s[32:33]
  v_cndmask_b32 v167, v167, v8, s[32:33]
  v_cndmask_b32 v168, v168, v8, s[32:33]
  v_cndmask_b32 v169, v169, v8, s[32:33]
  v_cndmask_b32 v170, v170, v8, s[32:33]
  v_cndmask_b32 v171, v171, v8, s[32:33]
  v_cndmask_b32 v172, v172, v8, s[32:33]
  v_cndmask_b32 v173, v173, v8, s[32:33]
  v_cndmask_b32 v174, v174, v8, s[32:33]
  v_cndmask_b32 v175, v175, v8, s[32:33]
  v_cvt_pk_bf16_f32 v240, v160, v161
  v_cvt_pk_bf16_f32 v241, v162, v163
  v_cvt_pk_bf16_f32 v242, v164, v165
  v_cvt_pk_bf16_f32 v243, v166, v167
  v_cvt_pk_bf16_f32 v244, v168, v169
  v_cvt_pk_bf16_f32 v245, v170, v171
  v_cvt_pk_bf16_f32 v246, v172, v173
  v_cvt_pk_bf16_f32 v247, v174, v175
  s_add_u32 s26, s31, 249563136
  buffer_store_dwordx4 v[240:243], v2, s[8:11], s26 offen sc1
  buffer_store_dwordx4 v[244:247], v2, s[8:11], s26 offen offset:1024 sc1
  v_mul_f32 v128, s30, v128
  v_mul_f32 v129, s30, v129
  v_mul_f32 v130, s30, v130
  v_mul_f32 v131, s30, v131
  v_mul_f32 v132, s30, v132
  v_mul_f32 v133, s30, v133
  v_mul_f32 v134, s30, v134
  v_mul_f32 v135, s30, v135
  v_mul_f32 v136, s30, v136
  v_mul_f32 v137, s30, v137
  v_mul_f32 v138, s30, v138
  v_mul_f32 v139, s30, v139
  v_mul_f32 v140, s30, v140
  v_mul_f32 v141, s30, v141
  v_mul_f32 v142, s30, v142
  v_mul_f32 v143, s30, v143
  v_cvt_pk_bf16_f32 v200, v128, v129
  v_cvt_pk_bf16_f32 v201, v130, v131
  v_cvt_pk_bf16_f32 v202, v132, v133
  v_cvt_pk_bf16_f32 v203, v134, v135
  v_cvt_pk_bf16_f32 v204, v136, v137
  v_cvt_pk_bf16_f32 v205, v138, v139
  v_cvt_pk_bf16_f32 v206, v140, v141
  v_cvt_pk_bf16_f32 v207, v142, v143
  s_nop 1
  v_max_f32_dpp v10, v9, v9 quad_perm:[1,0,3,2] row_mask:0xf bank_mask:0xf
  s_nop 1
  v_max_f32_dpp v9, v10, v10 quad_perm:[2,3,0,1] row_mask:0xf bank_mask:0xf
  s_nop 1
  v_max_f32_dpp v10, v9, v9 row_half_mirror row_mask:0xf bank_mask:0xf
  s_nop 1
  v_max_f32_dpp v9, v10, v10 row_mirror row_mask:0xf bank_mask:0xf
  v_mov_b32 v10, v9
  s_nop 1
  v_permlane16_swap_b32 v9, v10
  v_max_f32 v9, v9, v10
  v_mov_b32 v10, v9
  s_nop 1
  v_permlane32_swap_b32 v9, v10
  v_max_f32 v9, v9, v10
  s_lshl_b32 s51, s22, 7
  s_add_u32 s51, s51, 0xf600000
  s_lshl_b32 s26, s23, 4
  s_lshl_b32 s29, s21, 2
  s_add_u32 s26, s26, s29
  v_mov_b32 v11, s26
  s_mov_b64 s[40:41], exec
  s_mov_b64 exec, 1
  buffer_store_dword v9, v11, s[8:11], s51 offen sc1
  s_mov_b64 exec, s[40:41]
  s_mov_b32 s52, s24
  s_waitcnt vmcnt(0)
  s_barrier
  s_cmp_eq_u32 s21, 0
  s_cbranch_scc0 arr_30
  s_mov_b64 s[24:25], exec
  s_mov_b64 exec, 1
  v_mov_b32 v3, 0
  v_mov_b32 v4, 1
  buffer_atomic_add v4, v3, s[8:11], s47 offen
  s_mov_b64 exec, s[24:25]
arr_30:
  s_and_b32 s26, s2, 3
  s_mul_i32 s26, s26, 10
  s_mul_i32 s27, s21, 3
  s_cmp_eq_u32 s21, 3
  s_cselect_b32 s27, 8, s27
  s_add_u32 s50, s26, s27
  s_mul_i32 s26, s50, 20480
  s_add_u32 s26, s26, 0xe000000
  s_add_u32 s27, s26, 0
  buffer_load_dwordx4 a[0:3], v2, s[8:11], s27 offen
  s_add_u32 s27, s26, 1024
  buffer_load_dwordx4 a[4:7], v2, s[8:11], s27 offen
  s_add_u32 s27, s26, 2048
  buffer_load_dwordx4 a[8:11], v2, s[8:11], s27 offen
  s_add_u32 s27, s26, 3072
  buffer_load_dwordx4 a[12:15], v2, s[8:11], s27 offen
  s_add_u32 s27, s26, 4096
  buffer_load_dwordx4 a[16:19], v2, s[8:11], s27 offen
  s_add_u32 s27, s26, 5120
  buffer_load_dwordx4 a[20:23], v2, s[8:11], s27 offen
  s_add_u32 s27, s26, 6144
  buffer_load_dwordx4 a[24:27], v2, s[8:11], s27 offen
  s_add_u32 s27, s26, 7168
  buffer_load_dwordx4 a[28:31], v2, s[8:11], s27 offen
  s_add_u32 s27, s26, 8192
  buffer_load_dwordx4 a[32:35], v2, s[8:11], s27 offen
  s_add_u32 s27, s26, 9216
  buffer_load_dwordx4 a[36:39], v2, s[8:11], s27 offen
  s_add_u32 s27, s26, 10240
  buffer_load_dwordx4 a[40:43], v2, s[8:11], s27 offen
  s_add_u32 s27, s26, 11264
  buffer_load_dwordx4 a[44:47], v2, s[8:11], s27 offen
  s_add_u32 s27, s26, 12288
  buffer_load_dwordx4 a[48:51], v2, s[8:11], s27 offen
  s_add_u32 s27, s26, 13312
  buffer_load_dwordx4 a[52:55], v2, s[8:11], s27 offen
  s_add_u32 s27, s26, 14336
  buffer_load_dwordx4 a[56:59], v2, s[8:11], s27 offen
  s_add_u32 s27, s26, 15360
  buffer_load_dwordx4 a[60:63], v2, s[8:11], s27 offen
  s_add_u32 s27, s26, 16384
  buffer_load_dwordx4 a[64:67], v2, s[8:11], s27 offen
  s_add_u32 s27, s26, 17408
  buffer_load_dwordx4 a[68:71], v2, s[8:11], s27 offen
  s_add_u32 s27, s26, 18432
  buffer_load_dwordx4 a[72:75], v2, s[8:11], s27 offen
  s_add_u32 s27, s26, 19456
  buffer_load_dwordx4 a[76:79], v2, s[8:11], s27 offen
  s_add_u32 s27, s26, 20480
  buffer_load_dwordx4 a[80:83], v2, s[8:11], s27 offen
  s_add_u32 s27, s26, 21504
  buffer_load_dwordx4 a[84:87], v2, s[8:11], s27 offen
  s_add_u32 s27, s26, 22528
  buffer_load_dwordx4 a[88:91], v2, s[8:11], s27 offen
  s_add_u32 s27, s26, 23552
  buffer_load_dwordx4 a[92:95], v2, s[8:11], s27 offen
  s_add_u32 s27, s26, 24576
  buffer_load_dwordx4 a[96:99], v2, s[8:11], s27 offen
  s_add_u32 s27, s26, 25600
  buffer_load_dwordx4 a[100:103], v2, s[8:11], s27 offen
  s_add_u32 s27, s26, 26624
  buffer_load_dwordx4 a[104:107], v2, s[8:11], s27 offen
  s_add_u32 s27, s26, 27648
  buffer_load_dwordx4 a[108:111], v2, s[8:11], s27 offen
  s_add_u32 s27, s26, 28672
  buffer_load_dwordx4 a[112:115], v2, s[8:11], s27 offen
  s_add_u32 s27, s26, 29696
  buffer_load_dwordx4 a[116:119], v2, s[8:11], s27 offen
  s_add_u32 s27, s26, 30720
  buffer_load_dwordx4 a[120:123], v2, s[8:11], s27 offen
  s_add_u32 s27, s26, 31744
  buffer_load_dwordx4 a[124:127], v2, s[8:11], s27 offen
  s_add_u32 s27, s26, 32768
  buffer_load_dwordx4 a[128:131], v2, s[8:11], s27 offen
  s_add_u32 s27, s26, 33792
  buffer_load_dwordx4 a[132:135], v2, s[8:11], s27 offen
  s_add_u32 s27, s26, 34816
  buffer_load_dwordx4 a[136:139], v2, s[8:11], s27 offen
  s_add_u32 s27, s26, 35840
  buffer_load_dwordx4 a[140:143], v2, s[8:11], s27 offen
  s_add_u32 s27, s26, 36864
  buffer_load_dwordx4 a[144:147], v2, s[8:11], s27 offen
  s_add_u32 s27, s26, 37888
  buffer_load_dwordx4 a[148:151], v2, s[8:11], s27 offen
  s_add_u32 s27, s26, 38912
  buffer_load_dwordx4 a[152:155], v2, s[8:11], s27 offen
  s_add_u32 s27, s26, 39936
  buffer_load_dwordx4 a[156:159], v2, s[8:11], s27 offen
  s_cmp_lt_u32 s21, 2
  s_cbranch_scc0 g3_31
  s_add_u32 s27, s26, 40960
  buffer_load_dwordx4 a[160:163], v2, s[8:11], s27 offen
  s_add_u32 s27, s26, 41984
  buffer_load_dwordx4 a[164:167], v2, s[8:11], s27 offen
  s_add_u32 s27, s26, 43008
  buffer_load_dwordx4 a[168:171], v2, s[8:11], s27 offen
  s_add_u32 s27, s26, 44032
  buffer_load_dwordx4 a[172:175], v2, s[8:11], s27 offen
  s_add_u32 s27, s26, 45056
  buffer_load_dwordx4 a[176:179], v2, s[8:11], s27 offen
  s_add_u32 s27, s26, 46080
  buffer_load_dwordx4 a[180:183], v2, s[8:11], s27 offen
  s_add_u32 s27, s26, 47104
  buffer_load_dwordx4 a[184:187], v2, s[8:11], s27 offen
  s_add_u32 s27, s26, 48128
  buffer_load_dwordx4 a[188:191], v2, s[8:11], s27 offen
  s_add_u32 s27, s26, 49152
  buffer_load_dwordx4 a[192:195], v2, s[8:11], s27 offen
  s_add_u32 s27, s26, 50176
  buffer_load_dwordx4 a[196:199], v2, s[8:11], s27 offen
  s_add_u32 s27, s26, 51200
  buffer_load_dwordx4 a[200:203], v2, s[8:11], s27 offen
  s_add_u32 s27, s26, 52224
  buffer_load_dwordx4 a[204:207], v2, s[8:11], s27 offen
  s_add_u32 s27, s26, 53248
  buffer_load_dwordx4 a[208:211], v2, s[8:11], s27 offen
  s_add_u32 s27, s26, 54272
  buffer_load_dwordx4 a[212:215], v2, s[8:11], s27 offen
  s_add_u32 s27, s26, 55296
  buffer_load_dwordx4 a[216:219], v2, s[8:11], s27 offen
  s_add_u32 s27, s26, 56320
  buffer_load_dwordx4 a[220:223], v2, s[8:11], s27 offen
  s_add_u32 s27, s26, 57344
  buffer_load_dwordx4 a[224:227], v2, s[8:11], s27 offen
  s_add_u32 s27, s26, 58368
  buffer_load_dwordx4 a[228:231], v2, s[8:11], s27 offen
  s_add_u32 s27, s26, 59392
  buffer_load_dwordx4 a[232:235], v2, s[8:11], s27 offen
  s_add_u32 s27, s26, 60416
  buffer_load_dwordx4 a[236:239], v2, s[8:11], s27 offen
g3_31:
  v_mov_b32 v12, 0
  v_lshlrev_b32 v6, 16, v192
  v_and_b32 v7, 0xffff0000, v192
  v_add_f32_e64 v12, v12, abs(v6)
  v_add_f32_e64 v12, v12, abs(v7)
  v_lshlrev_b32 v6, 16, v193
  v_and_b32 v7, 0xffff0000, v193
  v_add_f32_e64 v12, v12, abs(v6)
  v_add_f32_e64 v12, v12, abs(v7)
  v_lshlrev_b32 v6, 16, v194
  v_and_b32 v7, 0xffff0000, v194
  v_add_f32_e64 v12, v12, abs(v6)
  v_add_f32_e64 v12, v12, abs(v7)
  v_lshlrev_b32 v6, 16, v195
  v_and_b32 v7, 0xffff0000, v195
  v_add_f32_e64 v12, v12, abs(v6)
  v_add_f32_e64 v12, v12, abs(v7)
  v_lshlrev_b32 v6, 16, v196
  v_and_b32 v7, 0xffff0000, v196
  v_add_f32_e64 v12, v12, abs(v6)
  v_add_f32_e64 v12, v12, abs(v7)
  v_lshlrev_b32 v6, 16, v197
  v_and_b32 v7, 0xffff0000, v197
  v_add_f32_e64 v12, v12, abs(v6)
  v_add_f32_e64 v12, v12, abs(v7)
  v_lshlrev_b32 v6, 16, v198
  v_and_b32 v7, 0xffff0000, v198
  v_add_f32_e64 v12, v12, abs(v6)
  v_add_f32_e64 v12, v12, abs(v7)
  v_lshlrev_b32 v6, 16, v199
  v_and_b32 v7, 0xffff0000, v199
  v_add_f32_e64 v12, v12, abs(v6)
  v_add_f32_e64 v12, v12, abs(v7)
  v_mov_b32 v6, v12
  s_nop 1
  v_permlane32_swap_b32 v12, v6
  v_add_f32 v12, v12, v6
  v_mov_b32 v13, 0
  v_lshlrev_b32 v6, 16, v200
  v_and_b32 v7, 0xffff0000, v200
  v_add_f32_e64 v13, v13, abs(v6)
  v_add_f32_e64 v13, v13, abs(v7)
  v_lshlrev_b32 v6, 16, v201
  v_and_b32 v7, 0xffff0000, v201
  v_add_f32_e64 v13, v13, abs(v6)
  v_add_f32_e64 v13, v13, abs(v7)
  v_lshlrev_b32 v6, 16, v202
  v_and_b32 v7, 0xffff0000, v202
  v_add_f32_e64 v13, v13, abs(v6)
  v_add_f32_e64 v13, v13, abs(v7)
  v_lshlrev_b32 v6, 16, v203
  v_and_b32 v7, 0xffff0000, v203
  v_add_f32_e64 v13, v13, abs(v6)
  v_add_f32_e64 v13, v13, abs(v7)
  v_lshlrev_b32 v6, 16, v204
  v_and_b32 v7, 0xffff0000, v204
  v_add_f32_e64 v13, v13, abs(v6)
  v_add_f32_e64 v13, v13, abs(v7)
  v_lshlrev_b32 v6, 16, v205
  v_and_b32 v7, 0xffff0000, v205
  v_add_f32_e64 v13, v13, abs(v6)
  v_add_f32_e64 v13, v13, abs(v7)
  v_lshlrev_b32 v6, 16, v206
  v_and_b32 v7, 0xffff0000, v206
  v_add_f32_e64 v13, v13, abs(v6)
  v_add_f32_e64 v13, v13, abs(v7)
  v_lshlrev_b32 v6, 16, v207
  v_and_b32 v7, 0xffff0000, v207
  v_add_f32_e64 v13, v13, abs(v6)
  v_add_f32_e64 v13, v13, abs(v7)
  v_mov_b32 v6, v13
  s_nop 1
  v_permlane32_swap_b32 v13, v6
  v_add_f32 v13, v13, v6
  v_mov_b32 v8, -1
  v_mov_b32 v9, -1
  v_mov_b32 v10, -1
  v_mov_b32 v11, -1
  s_lshl_b32 s30, s2, 2
  s_add_u32 s30, s30, s21
  s_add_u32 s31, s30, 0
  s_cmp_lt_u32 s31, 2560
  s_cbranch_scc0 f_32
  s_lshl_b32 s31, s31, 10
  s_add_u32 s31, s31, 0x400000
  buffer_store_dwordx4 v[8:11], v2, s[8:11], s31 offen
f_32:
  s_add_u32 s31, s30, 1024
  s_cmp_lt_u32 s31, 2560
  s_cbranch_scc0 f_33
  s_lshl_b32 s31, s31, 10
  s_add_u32 s31, s31, 0x400000
  buffer_store_dwordx4 v[8:11], v2, s[8:11], s31 offen
f_33:
  s_add_u32 s31, s30, 2048
  s_cmp_lt_u32 s31, 2560
  s_cbranch_scc0 f_34
  s_lshl_b32 s31, s31, 10
  s_add_u32 s31, s31, 0x400000
  buffer_store_dwordx4 v[8:11], v2, s[8:11], s31 offen
f_34:
  s_add_u32 s31, s30, 0
  s_cmp_lt_u32 s31, 1280
  s_cbranch_scc0 f_35
  s_lshl_b32 s31, s31, 10
  s_add_u32 s31, s31, 0x700000
  buffer_store_dwordx4 v[8:11], v2, s[8:11], s31 offen
f_35:
  s_add_u32 s31, s30, 1024
  s_cmp_lt_u32 s31, 1280
  s_cbranch_scc0 f_36
  s_lshl_b32 s31, s31, 10
  s_add_u32 s31, s31, 0x700000
  buffer_store_dwordx4 v[8:11], v2, s[8:11], s31 offen
f_36:
  s_add_u32 s31, s30, 0
  s_cmp_lt_u32 s31, 640
  s_cbranch_scc0 f_37
  s_lshl_b32 s31, s31, 10
  s_add_u32 s31, s31, 0xa00000
  buffer_store_dwordx4 v[8:11], v2, s[8:11], s31 offen
f_37:
  s_add_u32 s31, s30, 0
  s_cmp_lt_u32 s31, 5120
  s_cbranch_scc0 f_38
  s_lshl_b32 s31, s31, 10
  s_add_u32 s31, s31, 0xe00000
  buffer_store_dwordx4 v[8:11], v2, s[8:11], s31 offen
f_38:
  s_add_u32 s31, s30, 1024
  s_cmp_lt_u32 s31, 5120
  s_cbranch_scc0 f_39
  s_lshl_b32 s31, s31, 10
  s_add_u32 s31, s31, 0xe00000
  buffer_store_dwordx4 v[8:11], v2, s[8:11], s31 offen
f_39:
  s_add_u32 s31, s30, 2048
  s_cmp_lt_u32 s31, 5120
  s_cbranch_scc0 f_40
  s_lshl_b32 s31, s31, 10
  s_add_u32 s31, s31, 0xe00000
  buffer_store_dwordx4 v[8:11], v2, s[8:11], s31 offen
f_40:
  s_add_u32 s31, s30, 3072
  s_cmp_lt_u32 s31, 5120
  s_cbranch_scc0 f_41
  s_lshl_b32 s31, s31, 10
  s_add_u32 s31, s31, 0xe00000
  buffer_store_dwordx4 v[8:11], v2, s[8:11], s31 offen
f_41:
  s_add_u32 s31, s30, 4096
  s_cmp_lt_u32 s31, 5120
  s_cbranch_scc0 f_42
  s_lshl_b32 s31, s31, 10
  s_add_u32 s31, s31, 0xe00000
  buffer_store_dwordx4 v[8:11], v2, s[8:11], s31 offen
f_42:
  s_cmp_eq_u32 s2, 0
  s_cbranch_scc0 z_43
  s_cmp_eq_u32 s21, 0
  s_cbranch_scc0 z_43
  v_mov_b32 v8, 0
  v_mov_b32 v9, 0
  v_mov_b32 v10, 0
  v_mov_b32 v11, 0
  s_mov_b32 s30, 0x0
  buffer_store_dwordx4 v[8:11], v2, s[8:11], s30 offen
  s_add_u32 s30, s30, 1024
  buffer_store_dwordx4 v[8:11], v2, s[8:11], s30 offen
  s_add_u32 s30, s30, 1024
  buffer_store_dwordx4 v[8:11], v2, s[8:11], s30 offen
  s_add_u32 s30, s30, 1024
  buffer_store_dwordx4 v[8:11], v2, s[8:11], s30 offen
  s_add_u32 s30, s30, 1024
  buffer_store_dwordx4 v[8:11], v2, s[8:11], s30 offen
  s_add_u32 s30, s30, 1024
  s_mov_b32 s30, 0x2000
  buffer_store_dwordx4 v[8:11], v2, s[8:11], s30 offen
  s_add_u32 s30, s30, 1024
  buffer_store_dwordx4 v[8:11], v2, s[8:11], s30 offen
  s_add_u32 s30, s30, 1024
  buffer_store_dwordx4 v[8:11], v2, s[8:11], s30 offen
  s_add_u32 s30, s30, 1024
z_43:
  s_mov_b32 s45, 0
  v_mov_b32 v3, 0
aw_44:
  buffer_load_dword v4, v3, s[8:11], s47 offen sc1
  s_add_u32 s45, s45, 1
  s_waitcnt vmcnt(0)
  v_readfirstlane_b32 s29, v4
  s_cmp_ge_u32 s29, 8
  s_cbranch_scc1 aw_44_ok
  s_cmp_lt_u32 s45, 400000
  s_cbranch_scc1 aw_44
  s_branch kb1_abort
aw_44_ok:
  v_and_b32 v3, 31, v1
  v_lshlrev_b32 v3, 2, v3
  buffer_load_dword v4, v3, s[8:11], s51 offen sc1
  s_lshl_b32 s25, s22, 6
  s_lshl_b32 s27, s25, 11
  s_add_u32 s28, s27, 0xee00000
  s_add_u32 s27, s27, 0xea00000
  s_mov_b32 s41, 0
  s_mul_i32 s53, s41, 32768
  s_lshl_b32 s31, s21, 13
  s_add_u32 s53, s53, s31
  s_add_u32 m0, s31, 0
  s_add_u32 s29, s53, s27
  s_add_u32 s29, s29, 0
  buffer_load_dwordx4 v2, s[8:11], s29 offen sc1 lds
  s_add_u32 m0, s31, 1024
  s_add_u32 s29, s53, s27
  s_add_u32 s29, s29, 1024
  buffer_load_dwordx4 v2, s[8:11], s29 offen sc1 lds
  s_add_u32 m0, s31, 2048
  s_add_u32 s29, s53, s27
  s_add_u32 s29, s29, 2048
  buffer_load_dwordx4 v2, s[8:11], s29 offen sc1 lds
  s_add_u32 m0, s31, 3072
  s_add_u32 s29, s53, s27
  s_add_u32 s29, s29, 3072
  buffer_load_dwordx4 v2, s[8:11], s29 offen sc1 lds
  s_add_u32 m0, s31, 4096
  s_add_u32 s29, s53, s27
  s_add_u32 s29, s29, 4096
  buffer_load_dwordx4 v2, s[8:11], s29 offen sc1 lds
  s_add_u32 m0, s31, 5120
  s_add_u32 s29, s53, s27
  s_add_u32 s29, s29, 5120
  buffer_load_dwordx4 v2, s[8:11], s29 offen sc1 lds
  s_add_u32 m0, s31, 6144
  s_add_u32 s29, s53, s27
  s_add_u32 s29, s29, 6144
  buffer_load_dwordx4 v2, s[8:11], s29 offen sc1 lds
  s_add_u32 m0, s31, 7168
  s_add_u32 s29, s53, s27
  s_add_u32 s29, s29, 7168
  buffer_load_dwordx4 v2, s[8:11], s29 offen sc1 lds
  s_add_u32 m0, s31, 32768
  s_add_u32 s29, s53, s28
  s_add_u32 s29, s29, 0
  buffer_load_dwordx4 v2, s[8:11], s29 offen sc1 lds
  s_add_u32 m0, s31, 33792
  s_add_u32 s29, s53, s28
  s_add_u32 s29, s29, 1024
  buffer_load_dwordx4 v2, s[8:11], s29 offen sc1 lds
  s_add_u32 m0, s31, 34816
  s_add_u32 s29, s53, s28
  s_add_u32 s29, s29, 2048
  buffer_load_dwordx4 v2, s[8:11], s29 offen sc1 lds
  s_add_u32 m0, s31, 35840
  s_add_u32 s29, s53, s28
  s_add_u32 s29, s29, 3072
  buffer_load_dwordx4 v2, s[8:11], s29 offen sc1 lds
  s_add_u32 m0, s31, 36864
  s_add_u32 s29, s53, s28
  s_add_u32 s29, s29, 4096
  buffer_load_dwordx4 v2, s[8:11], s29 offen sc1 lds
  s_add_u32 m0, s31, 37888
  s_add_u32 s29, s53, s28
  s_add_u32 s29, s29, 5120
  buffer_load_dwordx4 v2, s[8:11], s29 offen sc1 lds
  s_add_u32 m0, s31, 38912
  s_add_u32 s29, s53, s28
  s_add_u32 s29, s29, 6144
  buffer_load_dwordx4 v2, s[8:11], s29 offen sc1 lds
  s_add_u32 m0, s31, 39936
  s_add_u32 s29, s53, s28
  s_add_u32 s29, s29, 7168
  buffer_load_dwordx4 v2, s[8:11], s29 offen sc1 lds
  s_waitcnt vmcnt(16)
  v_max_f32_dpp v5, v4, v4 quad_perm:[1,0,3,2] row_mask:0xf bank_mask:0xf
  s_nop 1
  v_max_f32_dpp v4, v5, v5 quad_perm:[2,3,0,1] row_mask:0xf bank_mask:0xf
  s_nop 1
  v_max_f32_dpp v5, v4, v4 row_half_mirror row_mask:0xf bank_mask:0xf
  s_nop 1
  v_max_f32_dpp v4, v5, v5 row_mirror row_mask:0xf bank_mask:0xf
  v_mov_b32 v5, v4
  s_nop 1
  v_permlane16_swap_b32 v4, v5
  v_max_f32 v4, v4, v5
  v_mul_f32 v12, v12, v4
  v_mul_f32 v12, 0x3f820000, v12
  v_mul_f32 v13, v13, v4
  v_mul_f32 v13, 0x3f820000, v13
  s_mov_b32 s40, 0
kb1_main:
  v_lshrrev_b32 v5, 16, v12
  v_or_b32 v5, 0x8000, v5
  v_and_b32 v6, 0xffff0000, v198
  v_or_b32 v5, v5, v6
  v_cndmask_b32 v198, v198, v5, s[34:35]
  v_lshrrev_b32 v5, 16, v13
  v_or_b32 v5, 0x8000, v5
  v_and_b32 v6, 0xffff0000, v206
  v_or_b32 v5, v5, v6
  v_cndmask_b32 v206, v206, v5, s[34:35]
kb1_main2:
  v_mov_b32 v112, 0
  v_mov_b32 v113, 0
  v_mov_b32 v114, 0
  v_mov_b32 v115, 0
  v_mov_b32 v116, 0
  v_mov_b32 v117, 0
  v_mov_b32 v118, 0
  v_mov_b32 v119, 0
  v_mov_b32 v120, 0
  v_mov_b32 v121, 0
  v_mov_b32 v122, 0
  v_mov_b32 v123, 0
  v_mov_b32 v124, 0
  v_mov_b32 v125, 0
  v_mov_b32 v126, 0
  v_mov_b32 v127, 0
  v_mov_b32 v128, 0
  v_mov_b32 v129, 0
  v_mov_b32 v130, 0
  v_mov_b32 v131, 0
  v_mov_b32 v132, 0
  v_mov_b32 v133, 0
  v_mov_b32 v134, 0
  v_mov_b32 v135, 0
  v_mov_b32 v136, 0
  v_mov_b32 v137, 0
  v_mov_b32 v138, 0
  v_mov_b32 v139, 0
  v_mov_b32 v140, 0
  v_mov_b32 v141, 0
  v_mov_b32 v142, 0
  v_mov_b32 v143, 0
  v_mov_b32 v3, v2
  v_add_u32 v4, 65536, v2
kb1_chunk2:
  s_waitcnt vmcnt(0)
  s_barrier
  s_add_u32 s41, s41, 1
  s_min_u32 s29, s41, 3
  s_mul_i32 s53, s29, 32768
  s_lshl_b32 s31, s21, 13
  s_add_u32 s53, s53, s31
  ds_read_b128 v[32:35], v3 offset:0
  ds_read_b128 v[36:39], v3 offset:1024
  ds_read_b128 v[48:51], v3 offset:32768
  ds_read_b128 v[52:55], v3 offset:33792
  ds_read_b128 v[40:43], v3 offset:2048
  ds_read_b128 v[44:47], v3 offset:3072
  s_waitcnt lgkmcnt(4)
  v_mfma_f32_32x32x16_bf16 v[64:79], v[32:35], v[192:195], 0
  v_mfma_f32_32x32x16_bf16 v[64:79], v[36:39], v[196:199], v[64:79]
  s_nop 11
  v_exp_f32 v64, v64
  v_exp_f32 v65, v65
  v_exp_f32 v66, v66
  v_exp_f32 v67, v67
  v_cvt_pk_bf16_f32 v96, v64, v65
  v_exp_f32 v68, v68
  v_exp_f32 v69, v69
  v_cvt_pk_bf16_f32 v97, v66, v67
  v_exp_f32 v70, v70
  v_mfma_f32_32x32x16_bf16 v[80:95], v[32:35], v[200:203], 0
  v_exp_f32 v71, v71
  v_cvt_pk_bf16_f32 v98, v68, v69
  v_exp_f32 v72, v72
  v_exp_f32 v73, v73
  v_cvt_pk_bf16_f32 v99, v70, v71
  v_mfma_f32_32x32x16_bf16 v[80:95], v[36:39], v[204:207], v[80:95]
  v_exp_f32 v74, v74
  v_exp_f32 v75, v75
  ds_read_b128 v[56:59], v3 offset:34816
  v_cvt_pk_bf16_f32 v100, v72, v73
  v_exp_f32 v76, v76
  v_exp_f32 v77, v77
  ds_read_b128 v[60:63], v3 offset:35840
  v_cvt_pk_bf16_f32 v101, v74, v75
  v_exp_f32 v78, v78
  s_add_u32 m0, s31, 65536
  s_add_u32 s29, s53, s27
  s_add_u32 s29, s29, 0
  buffer_load_dwordx4 v2, s[8:11], s29 offen sc1 lds
  v_exp_f32 v79, v79
  v_cvt_pk_bf16_f32 v102, v76, v77
  v_cvt_pk_bf16_f32 v103, v78, v79
  s_waitcnt lgkmcnt(4)
  v_mfma_f32_32x32x16_bf16 v[112:127], v[48:51], v[96:99], v[112:127]
  v_exp_f32 v80, v80
  v_exp_f32 v81, v81
  v_exp_f32 v82, v82
  v_exp_f32 v83, v83
  v_mfma_f32_32x32x16_bf16 v[112:127], v[52:55], v[100:103], v[112:127]
  v_cvt_pk_bf16_f32 v104, v80, v81
  v_exp_f32 v84, v84
  v_exp_f32 v85, v85
  v_cvt_pk_bf16_f32 v105, v82, v83
  v_exp_f32 v86, v86
  s_waitcnt lgkmcnt(2)
  v_mfma_f32_32x32x16_bf16 v[64:79], v[40:43], v[192:195], 0
  v_exp_f32 v87, v87
  v_cvt_pk_bf16_f32 v106, v84, v85
  v_exp_f32 v88, v88
  v_exp_f32 v89, v89
  v_cvt_pk_bf16_f32 v107, v86, v87
  v_mfma_f32_32x32x16_bf16 v[64:79], v[44:47], v[196:199], v[64:79]
  v_exp_f32 v90, v90
  v_exp_f32 v91, v91
  ds_read_b128 v[32:35], v3 offset:4096
  v_cvt_pk_bf16_f32 v108, v88, v89
  v_exp_f32 v92, v92
  v_exp_f32 v93, v93
  ds_read_b128 v[36:39], v3 offset:5120
  v_cvt_pk_bf16_f32 v109, v90, v91
  v_exp_f32 v94, v94
  v_exp_f32 v95, v95
  v_cvt_pk_bf16_f32 v110, v92, v93
  v_cvt_pk_bf16_f32 v111, v94, v95
  v_mfma_f32_32x32x16_bf16 v[128:143], v[48:51], v[104:107], v[128:143]
  v_exp_f32 v64, v64
  v_exp_f32 v65, v65
  v_exp_f32 v66, v66
  v_exp_f32 v67, v67
  v_mfma_f32_32x32x16_bf16 v[128:143], v[52:55], v[108:111], v[128:143]
  v_cvt_pk_bf16_f32 v96, v64, v65
  v_exp_f32 v68, v68
  v_exp_f32 v69, v69
  v_cvt_pk_bf16_f32 v97, v66, v67
  v_exp_f32 v70, v70
  v_mfma_f32_32x32x16_bf16 v[80:95], v[40:43], v[200:203], 0
  v_exp_f32 v71, v71
  v_cvt_pk_bf16_f32 v98, v68, v69
  v_exp_f32 v72, v72
  v_exp_f32 v73, v73
  v_cvt_pk_bf16_f32 v99, v70, v71
  v_mfma_f32_32x32x16_bf16 v[80:95], v[44:47], v[204:207], v[80:95]
  v_exp_f32 v74, v74
  v_exp_f32 v75, v75
  ds_read_b128 v[48:51], v3 offset:36864
  v_cvt_pk_bf16_f32 v100, v72, v73
  v_exp_f32 v76, v76
  v_exp_f32 v77, v77
  ds_read_b128 v[52:55], v3 offset:37888
  v_cvt_pk_bf16_f32 v101, v74, v75
  v_exp_f32 v78, v78
  s_add_u32 m0, s31, 66560
  s_add_u32 s29, s53, s27
  s_add_u32 s29, s29, 1024
  buffer_load_dwordx4 v2, s[8:11], s29 offen sc1 lds
  v_exp_f32 v79, v79
  v_cvt_pk_bf16_f32 v102, v76, v77
  v_cvt_pk_bf16_f32 v103, v78, v79
  s_waitcnt lgkmcnt(4)
  v_mfma_f32_32x32x16_bf16 v[112:127], v[56:59], v[96:99], v[112:127]
  v_exp_f32 v80, v80
  v_exp_f32 v81, v81
  v_exp_f32 v82, v82
  v_exp_f32 v83, v83
  v_mfma_f32_32x32x16_bf16 v[112:127], v[60:63], v[100:103], v[112:127]
  v_cvt_pk_bf16_f32 v104, v80, v81
  v_exp_f32 v84, v84
  v_exp_f32 v85, v85
  v_cvt_pk_bf16_f32 v105, v82, v83
  v_exp_f32 v86, v86
  s_waitcnt lgkmcnt(2)
  v_mfma_f32_32x32x16_bf16 v[64:79], v[32:35], v[192:195], 0
  v_exp_f32 v87, v87
  v_cvt_pk_bf16_f32 v106, v84, v85
  v_exp_f32 v88, v88
  v_exp_f32 v89, v89
  v_cvt_pk_bf16_f32 v107, v86, v87
  v_mfma_f32_32x32x16_bf16 v[64:79], v[36:39], v[196:199], v[64:79]
  v_exp_f32 v90, v90
  v_exp_f32 v91, v91
  ds_read_b128 v[40:43], v3 offset:6144
  v_cvt_pk_bf16_f32 v108, v88, v89
  v_exp_f32 v92, v92
  v_exp_f32 v93, v93
  ds_read_b128 v[44:47], v3 offset:7168
  v_cvt_pk_bf16_f32 v109, v90, v91
  v_exp_f32 v94, v94
  v_exp_f32 v95, v95
  v_cvt_pk_bf16_f32 v110, v92, v93
  v_cvt_pk_bf16_f32 v111, v94, v95
  v_mfma_f32_32x32x16_bf16 v[128:143], v[56:59], v[104:107], v[128:143]
  v_exp_f32 v64, v64
  v_exp_f32 v65, v65
  v_exp_f32 v66, v66
  v_exp_f32 v67, v67
  v_mfma_f32_32x32x16_bf16 v[128:143], v[60:63], v[108:111], v[128:143]
  v_cvt_pk_bf16_f32 v96, v64, v65
  v_exp_f32 v68, v68
  v_exp_f32 v69, v69
  v_cvt_pk_bf16_f32 v97, v66, v67
  v_exp_f32 v70, v70
  v_mfma_f32_32x32x16_bf16 v[80:95], v[32:35], v[200:203], 0
  v_exp_f32 v71, v71
  v_cvt_pk_bf16_f32 v98, v68, v69
  v_exp_f32 v72, v72
  v_exp_f32 v73, v73
  v_cvt_pk_bf16_f32 v99, v70, v71
  v_mfma_f32_32x32x16_bf16 v[80:95], v[36:39], v[204:207], v[80:95]
  v_exp_f32 v74, v74
  v_exp_f32 v75, v75
  ds_read_b128 v[56:59], v3 offset:38912
  v_cvt_pk_bf16_f32 v100, v72, v73
  v_exp_f32 v76, v76
  v_exp_f32 v77, v77
  ds_read_b128 v[60:63], v3 offset:39936
  v_cvt_pk_bf16_f32 v101, v74, v75
  v_exp_f32 v78, v78
  s_add_u32 m0, s31, 67584
  s_add_u32 s29, s53, s27
  s_add_u32 s29, s29, 2048
  buffer_load_dwordx4 v2, s[8:11], s29 offen sc1 lds
  v_exp_f32 v79, v79
  v_cvt_pk_bf16_f32 v102, v76, v77
  v_cvt_pk_bf16_f32 v103, v78, v79
  s_waitcnt lgkmcnt(4)
  v_mfma_f32_32x32x16_bf16 v[112:127], v[48:51], v[96:99], v[112:127]
  v_exp_f32 v80, v80
  v_exp_f32 v81, v81
  v_exp_f32 v82, v82
  v_exp_f32 v83, v83
  v_mfma_f32_32x32x16_bf16 v[112:127], v[52:55], v[100:103], v[112:127]
  v_cvt_pk_bf16_f32 v104, v80, v81
  v_exp_f32 v84, v84
  v_exp_f32 v85, v85
  v_cvt_pk_bf16_f32 v105, v82, v83
  v_exp_f32 v86, v86
  s_waitcnt lgkmcnt(2)
  v_mfma_f32_32x32x16_bf16 v[64:79], v[40:43], v[192:195], 0
  v_exp_f32 v87, v87
  v_cvt_pk_bf16_f32 v106, v84, v85
  v_exp_f32 v88, v88
  v_exp_f32 v89, v89
  v_cvt_pk_bf16_f32 v107, v86, v87
  v_mfma_f32_32x32x16_bf16 v[64:79], v[44:47], v[196:199], v[64:79]
  v_exp_f32 v90, v90
  v_exp_f32 v91, v91
  ds_read_b128 v[32:35], v3 offset:8192
  v_cvt_pk_bf16_f32 v108, v88, v89
  v_exp_f32 v92, v92
  v_exp_f32 v93, v93
  ds_read_b128 v[36:39], v3 offset:9216
  v_cvt_pk_bf16_f32 v109, v90, v91
  v_exp_f32 v94, v94
  v_exp_f32 v95, v95
  v_cvt_pk_bf16_f32 v110, v92, v93
  v_cvt_pk_bf16_f32 v111, v94, v95
  v_mfma_f32_32x32x16_bf16 v[128:143], v[48:51], v[104:107], v[128:143]
  v_exp_f32 v64, v64
  v_exp_f32 v65, v65
  v_exp_f32 v66, v66
  v_exp_f32 v67, v67
  v_mfma_f32_32x32x16_bf16 v[128:143], v[52:55], v[108:111], v[128:143]
  v_cvt_pk_bf16_f32 v96, v64, v65
  v_exp_f32 v68, v68
  v_exp_f32 v69, v69
  v_cvt_pk_bf16_f32 v97, v66, v67
  v_exp_f32 v70, v70
  v_mfma_f32_32x32x16_bf16 v[80:95], v[40:43], v[200:203], 0
  v_exp_f32 v71, v71
  v_cvt_pk_bf16_f32 v98, v68, v69
  v_exp_f32 v72, v72
  v_exp_f32 v73, v73
  v_cvt_pk_bf16_f32 v99, v70, v71
  v_mfma_f32_32x32x16_bf16 v[80:95], v[44:47], v[204:207], v[80:95]
  v_exp_f32 v74, v74
  v_exp_f32 v75, v75
  ds_read_b128 v[48:51], v3 offset:40960
  v_cvt_pk_bf16_f32 v100, v72, v73
  v_exp_f32 v76, v76
  v_exp_f32 v77, v77
  ds_read_b128 v[52:55], v3 offset:41984
  v_cvt_pk_bf16_f32 v101, v74, v75
  v_exp_f32 v78, v78
  s_add_u32 m0, s31, 68608
  s_add_u32 s29, s53, s27
  s_add_u32 s29, s29, 3072
  buffer_load_dwordx4 v2, s[8:11], s29 offen sc1 lds
  v_exp_f32 v79, v79
  v_cvt_pk_bf16_f32 v102, v76, v77
  v_cvt_pk_bf16_f32 v103, v78, v79
  s_waitcnt lgkmcnt(4)
  v_mfma_f32_32x32x16_bf16 v[112:127], v[56:59], v[96:99], v[112:127]
  v_exp_f32 v80, v80
  v_exp_f32 v81, v81
  v_exp_f32 v82, v82
  v_exp_f32 v83, v83
  v_mfma_f32_32x32x16_bf16 v[112:127], v[60:63], v[100:103], v[112:127]
  v_cvt_pk_bf16_f32 v104, v80, v81
  v_exp_f32 v84, v84
  v_exp_f32 v85, v85
  v_cvt_pk_bf16_f32 v105, v82, v83
  v_exp_f32 v86, v86
  s_waitcnt lgkmcnt(2)
  v_mfma_f32_32x32x16_bf16 v[64:79], v[32:35], v[192:195], 0
  v_exp_f32 v87, v87
  v_cvt_pk_bf16_f32 v106, v84, v85
  v_exp_f32 v88, v88
  v_exp_f32 v89, v89
  v_cvt_pk_bf16_f32 v107, v86, v87
  v_mfma_f32_32x32x16_bf16 v[64:79], v[36:39], v[196:199], v[64:79]
  v_exp_f32 v90, v90
  v_exp_f32 v91, v91
  ds_read_b128 v[40:43], v3 offset:10240
  v_cvt_pk_bf16_f32 v108, v88, v89
  v_exp_f32 v92, v92
  v_exp_f32 v93, v93
  ds_read_b128 v[44:47], v3 offset:11264
  v_cvt_pk_bf16_f32 v109, v90, v91
  v_exp_f32 v94, v94
  v_exp_f32 v95, v95
  v_cvt_pk_bf16_f32 v110, v92, v93
  v_cvt_pk_bf16_f32 v111, v94, v95
  v_mfma_f32_32x32x16_bf16 v[128:143], v[56:59], v[104:107], v[128:143]
  v_exp_f32 v64, v64
  v_exp_f32 v65, v65
  v_exp_f32 v66, v66
  v_exp_f32 v67, v67
  v_mfma_f32_32x32x16_bf16 v[128:143], v[60:63], v[108:111], v[128:143]
  v_cvt_pk_bf16_f32 v96, v64, v65
  v_exp_f32 v68, v68
  v_exp_f32 v69, v69
  v_cvt_pk_bf16_f32 v97, v66, v67
  v_exp_f32 v70, v70
  v_mfma_f32_32x32x16_bf16 v[80:95], v[32:35], v[200:203], 0
  v_exp_f32 v71, v71
  v_cvt_pk_bf16_f32 v98, v68, v69
  v_exp_f32 v72, v72
  v_exp_f32 v73, v73
  v_cvt_pk_bf16_f32 v99, v70, v71
  v_mfma_f32_32x32x16_bf16 v[80:95], v[36:39], v[204:207], v[80:95]
  v_exp_f32 v74, v74
  v_exp_f32 v75, v75
  ds_read_b128 v[56:59], v3 offset:43008
  v_cvt_pk_bf16_f32 v100, v72, v73
  v_exp_f32 v76, v76
  v_exp_f32 v77, v77
  ds_read_b128 v[60:63], v3 offset:44032
  v_cvt_pk_bf16_f32 v101, v74, v75
  v_exp_f32 v78, v78
  s_add_u32 m0, s31, 69632
  s_add_u32 s29, s53, s27
  s_add_u32 s29, s29, 4096
  buffer_load_dwordx4 v2, s[8:11], s29 offen sc1 lds
  v_exp_f32 v79, v79
  v_cvt_pk_bf16_f32 v102, v76, v77
  v_cvt_pk_bf16_f32 v103, v78, v79
  s_waitcnt lgkmcnt(4)
  v_mfma_f32_32x32x16_bf16 v[112:127], v[48:51], v[96:99], v[112:127]
  v_exp_f32 v80, v80
  v_exp_f32 v81, v81
  v_exp_f32 v82, v82
  v_exp_f32 v83, v83
  v_mfma_f32_32x32x16_bf16 v[112:127], v[52:55], v[100:103], v[112:127]
  v_cvt_pk_bf16_f32 v104, v80, v81
  v_exp_f32 v84, v84
  v_exp_f32 v85, v85
  v_cvt_pk_bf16_f32 v105, v82, v83
  v_exp_f32 v86, v86
  s_waitcnt lgkmcnt(2)
  v_mfma_f32_32x32x16_bf16 v[64:79], v[40:43], v[192:195], 0
  v_exp_f32 v87, v87
  v_cvt_pk_bf16_f32 v106, v84, v85
  v_exp_f32 v88, v88
  v_exp_f32 v89, v89
  v_cvt_pk_bf16_f32 v107, v86, v87
  v_mfma_f32_32x32x16_bf16 v[64:79], v[44:47], v[196:199], v[64:79]
  v_exp_f32 v90, v90
  v_exp_f32 v91, v91
  ds_read_b128 v[32:35], v3 offset:12288
  v_cvt_pk_bf16_f32 v108, v88, v89
  v_exp_f32 v92, v92
  v_exp_f32 v93, v93
  ds_read_b128 v[36:39], v3 offset:13312
  v_cvt_pk_bf16_f32 v109, v90, v91
  v_exp_f32 v94, v94
  v_exp_f32 v95, v95
  v_cvt_pk_bf16_f32 v110, v92, v93
  v_cvt_pk_bf16_f32 v111, v94, v95
  v_mfma_f32_32x32x16_bf16 v[128:143], v[48:51], v[104:107], v[128:143]
  v_exp_f32 v64, v64
  v_exp_f32 v65, v65
  v_exp_f32 v66, v66
  v_exp_f32 v67, v67
  v_mfma_f32_32x32x16_bf16 v[128:143], v[52:55], v[108:111], v[128:143]
  v_cvt_pk_bf16_f32 v96, v64, v65
  v_exp_f32 v68, v68
  v_exp_f32 v69, v69
  v_cvt_pk_bf16_f32 v97, v66, v67
  v_exp_f32 v70, v70
  v_mfma_f32_32x32x16_bf16 v[80:95], v[40:43], v[200:203], 0
  v_exp_f32 v71, v71
  v_cvt_pk_bf16_f32 v98, v68, v69
  v_exp_f32 v72, v72
  v_exp_f32 v73, v73
  v_cvt_pk_bf16_f32 v99, v70, v71
  v_mfma_f32_32x32x16_bf16 v[80:95], v[44:47], v[204:207], v[80:95]
  v_exp_f32 v74, v74
  v_exp_f32 v75, v75
  ds_read_b128 v[48:51], v3 offset:45056
  v_cvt_pk_bf16_f32 v100, v72, v73
  v_exp_f32 v76, v76
  v_exp_f32 v77, v77
  ds_read_b128 v[52:55], v3 offset:46080
  v_cvt_pk_bf16_f32 v101, v74, v75
  v_exp_f32 v78, v78
  s_add_u32 m0, s31, 70656
  s_add_u32 s29, s53, s27
  s_add_u32 s29, s29, 5120
  buffer_load_dwordx4 v2, s[8:11], s29 offen sc1 lds
  v_exp_f32 v79, v79
  v_cvt_pk_bf16_f32 v102, v76, v77
  v_cvt_pk_bf16_f32 v103, v78, v79
  s_waitcnt lgkmcnt(4)
  v_mfma_f32_32x32x16_bf16 v[112:127], v[56:59], v[96:99], v[112:127]
  v_exp_f32 v80, v80
  v_exp_f32 v81, v81
  v_exp_f32 v82, v82
  v_exp_f32 v83, v83
  v_mfma_f32_32x32x16_bf16 v[112:127], v[60:63], v[100:103], v[112:127]
  v_cvt_pk_bf16_f32 v104, v80, v81
  v_exp_f32 v84, v84
  v_exp_f32 v85, v85
  v_cvt_pk_bf16_f32 v105, v82, v83
  v_exp_f32 v86, v86
  s_waitcnt lgkmcnt(2)
  v_mfma_f32_32x32x16_bf16 v[64:79], v[32:35], v[192:195], 0
  v_exp_f32 v87, v87
  v_cvt_pk_bf16_f32 v106, v84, v85
  v_exp_f32 v88, v88
  v_exp_f32 v89, v89
  v_cvt_pk_bf16_f32 v107, v86, v87
  v_mfma_f32_32x32x16_bf16 v[64:79], v[36:39], v[196:199], v[64:79]
  v_exp_f32 v90, v90
  v_exp_f32 v91, v91
  ds_read_b128 v[40:43], v3 offset:14336
  v_cvt_pk_bf16_f32 v108, v88, v89
  v_exp_f32 v92, v92
  v_exp_f32 v93, v93
  ds_read_b128 v[44:47], v3 offset:15360
  v_cvt_pk_bf16_f32 v109, v90, v91
  v_exp_f32 v94, v94
  v_exp_f32 v95, v95
  v_cvt_pk_bf16_f32 v110, v92, v93
  v_cvt_pk_bf16_f32 v111, v94, v95
  v_mfma_f32_32x32x16_bf16 v[128:143], v[56:59], v[104:107], v[128:143]
  v_exp_f32 v64, v64
  v_exp_f32 v65, v65
  v_exp_f32 v66, v66
  v_exp_f32 v67, v67
  v_mfma_f32_32x32x16_bf16 v[128:143], v[60:63], v[108:111], v[128:143]
  v_cvt_pk_bf16_f32 v96, v64, v65
  v_exp_f32 v68, v68
  v_exp_f32 v69, v69
  v_cvt_pk_bf16_f32 v97, v66, v67
  v_exp_f32 v70, v70
  v_mfma_f32_32x32x16_bf16 v[80:95], v[32:35], v[200:203], 0
  v_exp_f32 v71, v71
  v_cvt_pk_bf16_f32 v98, v68, v69
  v_exp_f32 v72, v72
  v_exp_f32 v73, v73
  v_cvt_pk_bf16_f32 v99, v70, v71
  v_mfma_f32_32x32x16_bf16 v[80:95], v[36:39], v[204:207], v[80:95]
  v_exp_f32 v74, v74
  v_exp_f32 v75, v75
  ds_read_b128 v[56:59], v3 offset:47104
  v_cvt_pk_bf16_f32 v100, v72, v73
  v_exp_f32 v76, v76
  v_exp_f32 v77, v77
  ds_read_b128 v[60:63], v3 offset:48128
  v_cvt_pk_bf16_f32 v101, v74, v75
  v_exp_f32 v78, v78
  s_add_u32 m0, s31, 71680
  s_add_u32 s29, s53, s27
  s_add_u32 s29, s29, 6144
  buffer_load_dwordx4 v2, s[8:11], s29 offen sc1 lds
  v_exp_f32 v79, v79
  v_cvt_pk_bf16_f32 v102, v76, v77
  v_cvt_pk_bf16_f32 v103, v78, v79
  s_waitcnt lgkmcnt(4)
  v_mfma_f32_32x32x16_bf16 v[112:127], v[48:51], v[96:99], v[112:127]
  v_exp_f32 v80, v80
  v_exp_f32 v81, v81
  v_exp_f32 v82, v82
  v_exp_f32 v83, v83
  v_mfma_f32_32x32x16_bf16 v[112:127], v[52:55], v[100:103], v[112:127]
  v_cvt_pk_bf16_f32 v104, v80, v81
  v_exp_f32 v84, v84
  v_exp_f32 v85, v85
  v_cvt_pk_bf16_f32 v105, v82, v83
  v_exp_f32 v86, v86
  s_waitcnt lgkmcnt(2)
  v_mfma_f32_32x32x16_bf16 v[64:79], v[40:43], v[192:195], 0
  v_exp_f32 v87, v87
  v_cvt_pk_bf16_f32 v106, v84, v85
  v_exp_f32 v88, v88
  v_exp_f32 v89, v89
  v_cvt_pk_bf16_f32 v107, v86, v87
  v_mfma_f32_32x32x16_bf16 v[64:79], v[44:47], v[196:199], v[64:79]
  v_exp_f32 v90, v90
  v_exp_f32 v91, v91
  ds_read_b128 v[32:35], v3 offset:16384
  v_cvt_pk_bf16_f32 v108, v88, v89
  v_exp_f32 v92, v92
  v_exp_f32 v93, v93
  ds_read_b128 v[36:39], v3 offset:17408
  v_cvt_pk_bf16_f32 v109, v90, v91
  v_exp_f32 v94, v94
  v_exp_f32 v95, v95
  v_cvt_pk_bf16_f32 v110, v92, v93
  v_cvt_pk_bf16_f32 v111, v94, v95
  v_mfma_f32_32x32x16_bf16 v[128:143], v[48:51], v[104:107], v[128:143]
  v_exp_f32 v64, v64
  v_exp_f32 v65, v65
  v_exp_f32 v66, v66
  v_exp_f32 v67, v67
  v_mfma_f32_32x32x16_bf16 v[128:143], v[52:55], v[108:111], v[128:143]
  v_cvt_pk_bf16_f32 v96, v64, v65
  v_exp_f32 v68, v68
  v_exp_f32 v69, v69
  v_cvt_pk_bf16_f32 v97, v66, v67
  v_exp_f32 v70, v70
  v_mfma_f32_32x32x16_bf16 v[80:95], v[40:43], v[200:203], 0
  v_exp_f32 v71, v71
  v_cvt_pk_bf16_f32 v98, v68, v69
  v_exp_f32 v72, v72
  v_exp_f32 v73, v73
  v_cvt_pk_bf16_f32 v99, v70, v71
  v_mfma_f32_32x32x16_bf16 v[80:95], v[44:47], v[204:207], v[80:95]
  v_exp_f32 v74, v74
  v_exp_f32 v75, v75
  ds_read_b128 v[48:51], v3 offset:49152
  v_cvt_pk_bf16_f32 v100, v72, v73
  v_exp_f32 v76, v76
  v_exp_f32 v77, v77
  ds_read_b128 v[52:55], v3 offset:50176
  v_cvt_pk_bf16_f32 v101, v74, v75
  v_exp_f32 v78, v78
  s_add_u32 m0, s31, 72704
  s_add_u32 s29, s53, s27
  s_add_u32 s29, s29, 7168
  buffer_load_dwordx4 v2, s[8:11], s29 offen sc1 lds
  v_exp_f32 v79, v79
  v_cvt_pk_bf16_f32 v102, v76, v77
  v_cvt_pk_bf16_f32 v103, v78, v79
  s_waitcnt lgkmcnt(4)
  v_mfma_f32_32x32x16_bf16 v[112:127], v[56:59], v[96:99], v[112:127]
  v_exp_f32 v80, v80
  v_exp_f32 v81, v81
  v_exp_f32 v82, v82
  v_exp_f32 v83, v83
  v_mfma_f32_32x32x16_bf16 v[112:127], v[60:63], v[100:103], v[112:127]
  v_cvt_pk_bf16_f32 v104, v80, v81
  v_exp_f32 v84, v84
  v_exp_f32 v85, v85
  v_cvt_pk_bf16_f32 v105, v82, v83
  v_exp_f32 v86, v86
  s_waitcnt lgkmcnt(2)
  v_mfma_f32_32x32x16_bf16 v[64:79], v[32:35], v[192:195], 0
  v_exp_f32 v87, v87
  v_cvt_pk_bf16_f32 v106, v84, v85
  v_exp_f32 v88, v88
  v_exp_f32 v89, v89
  v_cvt_pk_bf16_f32 v107, v86, v87
  v_mfma_f32_32x32x16_bf16 v[64:79], v[36:39], v[196:199], v[64:79]
  v_exp_f32 v90, v90
  v_exp_f32 v91, v91
  ds_read_b128 v[40:43], v3 offset:18432
  v_cvt_pk_bf16_f32 v108, v88, v89
  v_exp_f32 v92, v92
  v_exp_f32 v93, v93
  ds_read_b128 v[44:47], v3 offset:19456
  v_cvt_pk_bf16_f32 v109, v90, v91
  v_exp_f32 v94, v94
  v_exp_f32 v95, v95
  v_cvt_pk_bf16_f32 v110, v92, v93
  v_cvt_pk_bf16_f32 v111, v94, v95
  v_mfma_f32_32x32x16_bf16 v[128:143], v[56:59], v[104:107], v[128:143]
  v_exp_f32 v64, v64
  v_exp_f32 v65, v65
  v_exp_f32 v66, v66
  v_exp_f32 v67, v67
  v_mfma_f32_32x32x16_bf16 v[128:143], v[60:63], v[108:111], v[128:143]
  v_cvt_pk_bf16_f32 v96, v64, v65
  v_exp_f32 v68, v68
  v_exp_f32 v69, v69
  v_cvt_pk_bf16_f32 v97, v66, v67
  v_exp_f32 v70, v70
  v_mfma_f32_32x32x16_bf16 v[80:95], v[32:35], v[200:203], 0
  v_exp_f32 v71, v71
  v_cvt_pk_bf16_f32 v98, v68, v69
  v_exp_f32 v72, v72
  v_exp_f32 v73, v73
  v_cvt_pk_bf16_f32 v99, v70, v71
  v_mfma_f32_32x32x16_bf16 v[80:95], v[36:39], v[204:207], v[80:95]
  v_exp_f32 v74, v74
  v_exp_f32 v75, v75
  ds_read_b128 v[56:59], v3 offset:51200
  v_cvt_pk_bf16_f32 v100, v72, v73
  v_exp_f32 v76, v76
  v_exp_f32 v77, v77
  ds_read_b128 v[60:63], v3 offset:52224
  v_cvt_pk_bf16_f32 v101, v74, v75
  v_exp_f32 v78, v78
  s_add_u32 m0, s31, 98304
  s_add_u32 s29, s53, s28
  s_add_u32 s29, s29, 0
  buffer_load_dwordx4 v2, s[8:11], s29 offen sc1 lds
  v_exp_f32 v79, v79
  v_cvt_pk_bf16_f32 v102, v76, v77
  v_cvt_pk_bf16_f32 v103, v78, v79
  s_waitcnt lgkmcnt(4)
  v_mfma_f32_32x32x16_bf16 v[112:127], v[48:51], v[96:99], v[112:127]
  v_exp_f32 v80, v80
  v_exp_f32 v81, v81
  v_exp_f32 v82, v82
  v_exp_f32 v83, v83
  v_mfma_f32_32x32x16_bf16 v[112:127], v[52:55], v[100:103], v[112:127]
  v_cvt_pk_bf16_f32 v104, v80, v81
  v_exp_f32 v84, v84
  v_exp_f32 v85, v85
  v_cvt_pk_bf16_f32 v105, v82, v83
  v_exp_f32 v86, v86
  s_waitcnt lgkmcnt(2)
  v_mfma_f32_32x32x16_bf16 v[64:79], v[40:43], v[192:195], 0
  v_exp_f32 v87, v87
  v_cvt_pk_bf16_f32 v106, v84, v85
  v_exp_f32 v88, v88
  v_exp_f32 v89, v89
  v_cvt_pk_bf16_f32 v107, v86, v87
  v_mfma_f32_32x32x16_bf16 v[64:79], v[44:47], v[196:199], v[64:79]
  v_exp_f32 v90, v90
  v_exp_f32 v91, v91
  ds_read_b128 v[32:35], v3 offset:20480
  v_cvt_pk_bf16_f32 v108, v88, v89
  v_exp_f32 v92, v92
  v_exp_f32 v93, v93
  ds_read_b128 v[36:39], v3 offset:21504
  v_cvt_pk_bf16_f32 v109, v90, v91
  v_exp_f32 v94, v94
  v_exp_f32 v95, v95
  v_cvt_pk_bf16_f32 v110, v92, v93
  v_cvt_pk_bf16_f32 v111, v94, v95
  v_mfma_f32_32x32x16_bf16 v[128:143], v[48:51], v[104:107], v[128:143]
  v_exp_f32 v64, v64
  v_exp_f32 v65, v65
  v_exp_f32 v66, v66
  v_exp_f32 v67, v67
  v_mfma_f32_32x32x16_bf16 v[128:143], v[52:55], v[108:111], v[128:143]
  v_cvt_pk_bf16_f32 v96, v64, v65
  v_exp_f32 v68, v68
  v_exp_f32 v69, v69
  v_cvt_pk_bf16_f32 v97, v66, v67
  v_exp_f32 v70, v70
  v_mfma_f32_32x32x16_bf16 v[80:95], v[40:43], v[200:203], 0
  v_exp_f32 v71, v71
  v_cvt_pk_bf16_f32 v98, v68, v69
  v_exp_f32 v72, v72
  v_exp_f32 v73, v73
  v_cvt_pk_bf16_f32 v99, v70, v71
  v_mfma_f32_32x32x16_bf16 v[80:95], v[44:47], v[204:207], v[80:95]
  v_exp_f32 v74, v74
  v_exp_f32 v75, v75
  ds_read_b128 v[48:51], v3 offset:53248
  v_cvt_pk_bf16_f32 v100, v72, v73
  v_exp_f32 v76, v76
  v_exp_f32 v77, v77
  ds_read_b128 v[52:55], v3 offset:54272
  v_cvt_pk_bf16_f32 v101, v74, v75
  v_exp_f32 v78, v78
  s_add_u32 m0, s31, 99328
  s_add_u32 s29, s53, s28
  s_add_u32 s29, s29, 1024
  buffer_load_dwordx4 v2, s[8:11], s29 offen sc1 lds
  v_exp_f32 v79, v79
  v_cvt_pk_bf16_f32 v102, v76, v77
  v_cvt_pk_bf16_f32 v103, v78, v79
  s_waitcnt lgkmcnt(4)
  v_mfma_f32_32x32x16_bf16 v[112:127], v[56:59], v[96:99], v[112:127]
  v_exp_f32 v80, v80
  v_exp_f32 v81, v81
  v_exp_f32 v82, v82
  v_exp_f32 v83, v83
  v_mfma_f32_32x32x16_bf16 v[112:127], v[60:63], v[100:103], v[112:127]
  v_cvt_pk_bf16_f32 v104, v80, v81
  v_exp_f32 v84, v84
  v_exp_f32 v85, v85
  v_cvt_pk_bf16_f32 v105, v82, v83
  v_exp_f32 v86, v86
  s_waitcnt lgkmcnt(2)
  v_mfma_f32_32x32x16_bf16 v[64:79], v[32:35], v[192:195], 0
  v_exp_f32 v87, v87
  v_cvt_pk_bf16_f32 v106, v84, v85
  v_exp_f32 v88, v88
  v_exp_f32 v89, v89
  v_cvt_pk_bf16_f32 v107, v86, v87
  v_mfma_f32_32x32x16_bf16 v[64:79], v[36:39], v[196:199], v[64:79]
  v_exp_f32 v90, v90
  v_exp_f32 v91, v91
  ds_read_b128 v[40:43], v3 offset:22528
  v_cvt_pk_bf16_f32 v108, v88, v89
  v_exp_f32 v92, v92
  v_exp_f32 v93, v93
  ds_read_b128 v[44:47], v3 offset:23552
  v_cvt_pk_bf16_f32 v109, v90, v91
  v_exp_f32 v94, v94
  v_exp_f32 v95, v95
  v_cvt_pk_bf16_f32 v110, v92, v93
  v_cvt_pk_bf16_f32 v111, v94, v95
  v_mfma_f32_32x32x16_bf16 v[128:143], v[56:59], v[104:107], v[128:143]
  v_exp_f32 v64, v64
  v_exp_f32 v65, v65
  v_exp_f32 v66, v66
  v_exp_f32 v67, v67
  v_mfma_f32_32x32x16_bf16 v[128:143], v[60:63], v[108:111], v[128:143]
  v_cvt_pk_bf16_f32 v96, v64, v65
  v_exp_f32 v68, v68
  v_exp_f32 v69, v69
  v_cvt_pk_bf16_f32 v97, v66, v67
  v_exp_f32 v70, v70
  v_mfma_f32_32x32x16_bf16 v[80:95], v[32:35], v[200:203], 0
  v_exp_f32 v71, v71
  v_cvt_pk_bf16_f32 v98, v68, v69
  v_exp_f32 v72, v72
  v_exp_f32 v73, v73
  v_cvt_pk_bf16_f32 v99, v70, v71
  v_mfma_f32_32x32x16_bf16 v[80:95], v[36:39], v[204:207], v[80:95]
  v_exp_f32 v74, v74
  v_exp_f32 v75, v75
  ds_read_b128 v[56:59], v3 offset:55296
  v_cvt_pk_bf16_f32 v100, v72, v73
  v_exp_f32 v76, v76
  v_exp_f32 v77, v77
  ds_read_b128 v[60:63], v3 offset:56320
  v_cvt_pk_bf16_f32 v101, v74, v75
  v_exp_f32 v78, v78
  s_add_u32 m0, s31, 100352
  s_add_u32 s29, s53, s28
  s_add_u32 s29, s29, 2048
  buffer_load_dwordx4 v2, s[8:11], s29 offen sc1 lds
  v_exp_f32 v79, v79
  v_cvt_pk_bf16_f32 v102, v76, v77
  v_cvt_pk_bf16_f32 v103, v78, v79
  s_waitcnt lgkmcnt(4)
  v_mfma_f32_32x32x16_bf16 v[112:127], v[48:51], v[96:99], v[112:127]
  v_exp_f32 v80, v80
  v_exp_f32 v81, v81
  v_exp_f32 v82, v82
  v_exp_f32 v83, v83
  v_mfma_f32_32x32x16_bf16 v[112:127], v[52:55], v[100:103], v[112:127]
  v_cvt_pk_bf16_f32 v104, v80, v81
  v_exp_f32 v84, v84
  v_exp_f32 v85, v85
  v_cvt_pk_bf16_f32 v105, v82, v83
  v_exp_f32 v86, v86
  s_waitcnt lgkmcnt(2)
  v_mfma_f32_32x32x16_bf16 v[64:79], v[40:43], v[192:195], 0
  v_exp_f32 v87, v87
  v_cvt_pk_bf16_f32 v106, v84, v85
  v_exp_f32 v88, v88
  v_exp_f32 v89, v89
  v_cvt_pk_bf16_f32 v107, v86, v87
  v_mfma_f32_32x32x16_bf16 v[64:79], v[44:47], v[196:199], v[64:79]
  v_exp_f32 v90, v90
  v_exp_f32 v91, v91
  ds_read_b128 v[32:35], v3 offset:24576
  v_cvt_pk_bf16_f32 v108, v88, v89
  v_exp_f32 v92, v92
  v_exp_f32 v93, v93
  ds_read_b128 v[36:39], v3 offset:25600
  v_cvt_pk_bf16_f32 v109, v90, v91
  v_exp_f32 v94, v94
  v_exp_f32 v95, v95
  v_cvt_pk_bf16_f32 v110, v92, v93
  v_cvt_pk_bf16_f32 v111, v94, v95
  v_mfma_f32_32x32x16_bf16 v[128:143], v[48:51], v[104:107], v[128:143]
  v_exp_f32 v64, v64
  v_exp_f32 v65, v65
  v_exp_f32 v66, v66
  v_exp_f32 v67, v67
  v_mfma_f32_32x32x16_bf16 v[128:143], v[52:55], v[108:111], v[128:143]
  v_cvt_pk_bf16_f32 v96, v64, v65
  v_exp_f32 v68, v68
  v_exp_f32 v69, v69
  v_cvt_pk_bf16_f32 v97, v66, v67
  v_exp_f32 v70, v70
  v_mfma_f32_32x32x16_bf16 v[80:95], v[40:43], v[200:203], 0
  v_exp_f32 v71, v71
  v_cvt_pk_bf16_f32 v98, v68, v69
  v_exp_f32 v72, v72
  v_exp_f32 v73, v73
  v_cvt_pk_bf16_f32 v99, v70, v71
  v_mfma_f32_32x32x16_bf16 v[80:95], v[44:47], v[204:207], v[80:95]
  v_exp_f32 v74, v74
  v_exp_f32 v75, v75
  ds_read_b128 v[48:51], v3 offset:57344
  v_cvt_pk_bf16_f32 v100, v72, v73
  v_exp_f32 v76, v76
  v_exp_f32 v77, v77
  ds_read_b128 v[52:55], v3 offset:58368
  v_cvt_pk_bf16_f32 v101, v74, v75
  v_exp_f32 v78, v78
  s_add_u32 m0, s31, 101376
  s_add_u32 s29, s53, s28
  s_add_u32 s29, s29, 3072
  buffer_load_dwordx4 v2, s[8:11], s29 offen sc1 lds
  v_exp_f32 v79, v79
  v_cvt_pk_bf16_f32 v102, v76, v77
  v_cvt_pk_bf16_f32 v103, v78, v79
  s_waitcnt lgkmcnt(4)
  v_mfma_f32_32x32x16_bf16 v[112:127], v[56:59], v[96:99], v[112:127]
  v_exp_f32 v80, v80
  v_exp_f32 v81, v81
  v_exp_f32 v82, v82
  v_exp_f32 v83, v83
  v_mfma_f32_32x32x16_bf16 v[112:127], v[60:63], v[100:103], v[112:127]
  v_cvt_pk_bf16_f32 v104, v80, v81
  v_exp_f32 v84, v84
  v_exp_f32 v85, v85
  v_cvt_pk_bf16_f32 v105, v82, v83
  v_exp_f32 v86, v86
  s_waitcnt lgkmcnt(2)
  v_mfma_f32_32x32x16_bf16 v[64:79], v[32:35], v[192:195], 0
  v_exp_f32 v87, v87
  v_cvt_pk_bf16_f32 v106, v84, v85
  v_exp_f32 v88, v88
  v_exp_f32 v89, v89
  v_cvt_pk_bf16_f32 v107, v86, v87
  v_mfma_f32_32x32x16_bf16 v[64:79], v[36:39], v[196:199], v[64:79]
  v_exp_f32 v90, v90
  v_exp_f32 v91, v91
  ds_read_b128 v[40:43], v3 offset:26624
  v_cvt_pk_bf16_f32 v108, v88, v89
  v_exp_f32 v92, v92
  v_exp_f32 v93, v93
  ds_read_b128 v[44:47], v3 offset:27648
  v_cvt_pk_bf16_f32 v109, v90, v91
  v_exp_f32 v94, v94
  v_exp_f32 v95, v95
  v_cvt_pk_bf16_f32 v110, v92, v93
  v_cvt_pk_bf16_f32 v111, v94, v95
  v_mfma_f32_32x32x16_bf16 v[128:143], v[56:59], v[104:107], v[128:143]
  v_exp_f32 v64, v64
  v_exp_f32 v65, v65
  v_exp_f32 v66, v66
  v_exp_f32 v67, v67
  v_mfma_f32_32x32x16_bf16 v[128:143], v[60:63], v[108:111], v[128:143]
  v_cvt_pk_bf16_f32 v96, v64, v65
  v_exp_f32 v68, v68
  v_exp_f32 v69, v69
  v_cvt_pk_bf16_f32 v97, v66, v67
  v_exp_f32 v70, v70
  v_mfma_f32_32x32x16_bf16 v[80:95], v[32:35], v[200:203], 0
  v_exp_f32 v71, v71
  v_cvt_pk_bf16_f32 v98, v68, v69
  v_exp_f32 v72, v72
  v_exp_f32 v73, v73
  v_cvt_pk_bf16_f32 v99, v70, v71
  v_mfma_f32_32x32x16_bf16 v[80:95], v[36:39], v[204:207], v[80:95]
  v_exp_f32 v74, v74
  v_exp_f32 v75, v75
  ds_read_b128 v[56:59], v3 offset:59392
  v_cvt_pk_bf16_f32 v100, v72, v73
  v_exp_f32 v76, v76
  v_exp_f32 v77, v77
  ds_read_b128 v[60:63], v3 offset:60416
  v_cvt_pk_bf16_f32 v101, v74, v75
  v_exp_f32 v78, v78
  s_add_u32 m0, s31, 102400
  s_add_u32 s29, s53, s28
  s_add_u32 s29, s29, 4096
  buffer_load_dwordx4 v2, s[8:11], s29 offen sc1 lds
  v_exp_f32 v79, v79
  v_cvt_pk_bf16_f32 v102, v76, v77
  v_cvt_pk_bf16_f32 v103, v78, v79
  s_waitcnt lgkmcnt(4)
  v_mfma_f32_32x32x16_bf16 v[112:127], v[48:51], v[96:99], v[112:127]
  v_exp_f32 v80, v80
  v_exp_f32 v81, v81
  v_exp_f32 v82, v82
  v_exp_f32 v83, v83
  v_mfma_f32_32x32x16_bf16 v[112:127], v[52:55], v[100:103], v[112:127]
  v_cvt_pk_bf16_f32 v104, v80, v81
  v_exp_f32 v84, v84
  v_exp_f32 v85, v85
  v_cvt_pk_bf16_f32 v105, v82, v83
  v_exp_f32 v86, v86
  s_waitcnt lgkmcnt(2)
  v_mfma_f32_32x32x16_bf16 v[64:79], v[40:43], v[192:195], 0
  v_exp_f32 v87, v87
  v_cvt_pk_bf16_f32 v106, v84, v85
  v_exp_f32 v88, v88
  v_exp_f32 v89, v89
  v_cvt_pk_bf16_f32 v107, v86, v87
  v_mfma_f32_32x32x16_bf16 v[64:79], v[44:47], v[196:199], v[64:79]
  v_exp_f32 v90, v90
  v_exp_f32 v91, v91
  ds_read_b128 v[32:35], v3 offset:28672
  v_cvt_pk_bf16_f32 v108, v88, v89
  v_exp_f32 v92, v92
  v_exp_f32 v93, v93
  ds_read_b128 v[36:39], v3 offset:29696
  v_cvt_pk_bf16_f32 v109, v90, v91
  v_exp_f32 v94, v94
  v_exp_f32 v95, v95
  v_cvt_pk_bf16_f32 v110, v92, v93
  v_cvt_pk_bf16_f32 v111, v94, v95
  v_mfma_f32_32x32x16_bf16 v[128:143], v[48:51], v[104:107], v[128:143]
  v_exp_f32 v64, v64
  v_exp_f32 v65, v65
  v_exp_f32 v66, v66
  v_exp_f32 v67, v67
  v_mfma_f32_32x32x16_bf16 v[128:143], v[52:55], v[108:111], v[128:143]
  v_cvt_pk_bf16_f32 v96, v64, v65
  v_exp_f32 v68, v68
  v_exp_f32 v69, v69
  v_cvt_pk_bf16_f32 v97, v66, v67
  v_exp_f32 v70, v70
  v_mfma_f32_32x32x16_bf16 v[80:95], v[40:43], v[200:203], 0
  v_exp_f32 v71, v71
  v_cvt_pk_bf16_f32 v98, v68, v69
  v_exp_f32 v72, v72
  v_exp_f32 v73, v73
  v_cvt_pk_bf16_f32 v99, v70, v71
  v_mfma_f32_32x32x16_bf16 v[80:95], v[44:47], v[204:207], v[80:95]
  v_exp_f32 v74, v74
  v_exp_f32 v75, v75
  ds_read_b128 v[48:51], v3 offset:61440
  v_cvt_pk_bf16_f32 v100, v72, v73
  v_exp_f32 v76, v76
  v_exp_f32 v77, v77
  ds_read_b128 v[52:55], v3 offset:62464
  v_cvt_pk_bf16_f32 v101, v74, v75
  v_exp_f32 v78, v78
  s_add_u32 m0, s31, 103424
  s_add_u32 s29, s53, s28
  s_add_u32 s29, s29, 5120
  buffer_load_dwordx4 v2, s[8:11], s29 offen sc1 lds
  v_exp_f32 v79, v79
  v_cvt_pk_bf16_f32 v102, v76, v77
  v_cvt_pk_bf16_f32 v103, v78, v79
  s_waitcnt lgkmcnt(4)
  v_mfma_f32_32x32x16_bf16 v[112:127], v[56:59], v[96:99], v[112:127]
  v_exp_f32 v80, v80
  v_exp_f32 v81, v81
  v_exp_f32 v82, v82
  v_exp_f32 v83, v83
  v_mfma_f32_32x32x16_bf16 v[112:127], v[60:63], v[100:103], v[112:127]
  v_cvt_pk_bf16_f32 v104, v80, v81
  v_exp_f32 v84, v84
  v_exp_f32 v85, v85
  v_cvt_pk_bf16_f32 v105, v82, v83
  v_exp_f32 v86, v86
  s_waitcnt lgkmcnt(2)
  v_mfma_f32_32x32x16_bf16 v[64:79], v[32:35], v[192:195], 0
  v_exp_f32 v87, v87
  v_cvt_pk_bf16_f32 v106, v84, v85
  v_exp_f32 v88, v88
  v_exp_f32 v89, v89
  v_cvt_pk_bf16_f32 v107, v86, v87
  v_mfma_f32_32x32x16_bf16 v[64:79], v[36:39], v[196:199], v[64:79]
  v_exp_f32 v90, v90
  v_exp_f32 v91, v91
  ds_read_b128 v[40:43], v3 offset:30720
  v_cvt_pk_bf16_f32 v108, v88, v89
  v_exp_f32 v92, v92
  v_exp_f32 v93, v93
  ds_read_b128 v[44:47], v3 offset:31744
  v_cvt_pk_bf16_f32 v109, v90, v91
  v_exp_f32 v94, v94
  v_exp_f32 v95, v95
  v_cvt_pk_bf16_f32 v110, v92, v93
  v_cvt_pk_bf16_f32 v111, v94, v95
  v_mfma_f32_32x32x16_bf16 v[128:143], v[56:59], v[104:107], v[128:143]
  v_exp_f32 v64, v64
  v_exp_f32 v65, v65
  v_exp_f32 v66, v66
  v_exp_f32 v67, v67
  v_mfma_f32_32x32x16_bf16 v[128:143], v[60:63], v[108:111], v[128:143]
  v_cvt_pk_bf16_f32 v96, v64, v65
  v_exp_f32 v68, v68
  v_exp_f32 v69, v69
  v_cvt_pk_bf16_f32 v97, v66, v67
  v_exp_f32 v70, v70
  v_mfma_f32_32x32x16_bf16 v[80:95], v[32:35], v[200:203], 0
  v_exp_f32 v71, v71
  v_cvt_pk_bf16_f32 v98, v68, v69
  v_exp_f32 v72, v72
  v_exp_f32 v73, v73
  v_cvt_pk_bf16_f32 v99, v70, v71
  v_mfma_f32_32x32x16_bf16 v[80:95], v[36:39], v[204:207], v[80:95]
  v_exp_f32 v74, v74
  v_exp_f32 v75, v75
  ds_read_b128 v[56:59], v3 offset:63488
  v_cvt_pk_bf16_f32 v100, v72, v73
  v_exp_f32 v76, v76
  v_exp_f32 v77, v77
  ds_read_b128 v[60:63], v3 offset:64512
  v_cvt_pk_bf16_f32 v101, v74, v75
  v_exp_f32 v78, v78
  s_add_u32 m0, s31, 104448
  s_add_u32 s29, s53, s28
  s_add_u32 s29, s29, 6144
  buffer_load_dwordx4 v2, s[8:11], s29 offen sc1 lds
  v_exp_f32 v79, v79
  v_cvt_pk_bf16_f32 v102, v76, v77
  v_cvt_pk_bf16_f32 v103, v78, v79
  s_waitcnt lgkmcnt(4)
  v_mfma_f32_32x32x16_bf16 v[112:127], v[48:51], v[96:99], v[112:127]
  v_exp_f32 v80, v80
  v_exp_f32 v81, v81
  v_exp_f32 v82, v82
  v_exp_f32 v83, v83
  v_mfma_f32_32x32x16_bf16 v[112:127], v[52:55], v[100:103], v[112:127]
  v_cvt_pk_bf16_f32 v104, v80, v81
  v_exp_f32 v84, v84
  v_exp_f32 v85, v85
  v_cvt_pk_bf16_f32 v105, v82, v83
  v_exp_f32 v86, v86
  s_waitcnt lgkmcnt(2)
  v_mfma_f32_32x32x16_bf16 v[64:79], v[40:43], v[192:195], 0
  v_exp_f32 v87, v87
  v_cvt_pk_bf16_f32 v106, v84, v85
  v_exp_f32 v88, v88
  v_exp_f32 v89, v89
  v_cvt_pk_bf16_f32 v107, v86, v87
  v_mfma_f32_32x32x16_bf16 v[64:79], v[44:47], v[196:199], v[64:79]
  v_exp_f32 v90, v90
  v_exp_f32 v91, v91
  v_cvt_pk_bf16_f32 v108, v88, v89
  v_exp_f32 v92, v92
  v_exp_f32 v93, v93
  v_cvt_pk_bf16_f32 v109, v90, v91
  v_exp_f32 v94, v94
  v_exp_f32 v95, v95
  v_cvt_pk_bf16_f32 v110, v92, v93
  v_cvt_pk_bf16_f32 v111, v94, v95
  v_mfma_f32_32x32x16_bf16 v[128:143], v[48:51], v[104:107], v[128:143]
  v_exp_f32 v64, v64
  v_exp_f32 v65, v65
  v_exp_f32 v66, v66
  v_exp_f32 v67, v67
  v_mfma_f32_32x32x16_bf16 v[128:143], v[52:55], v[108:111], v[128:143]
  v_cvt_pk_bf16_f32 v96, v64, v65
  v_exp_f32 v68, v68
  v_exp_f32 v69, v69
  v_cvt_pk_bf16_f32 v97, v66, v67
  v_exp_f32 v70, v70
  v_mfma_f32_32x32x16_bf16 v[80:95], v[40:43], v[200:203], 0
  v_exp_f32 v71, v71
  v_cvt_pk_bf16_f32 v98, v68, v69
  v_exp_f32 v72, v72
  v_exp_f32 v73, v73
  v_cvt_pk_bf16_f32 v99, v70, v71
  v_mfma_f32_32x32x16_bf16 v[80:95], v[44:47], v[204:207], v[80:95]
  v_exp_f32 v74, v74
  v_exp_f32 v75, v75
  v_cvt_pk_bf16_f32 v100, v72, v73
  v_exp_f32 v76, v76
  v_exp_f32 v77, v77
  v_cvt_pk_bf16_f32 v101, v74, v75
  v_exp_f32 v78, v78
  s_add_u32 m0, s31, 105472
  s_add_u32 s29, s53, s28
  s_add_u32 s29, s29, 7168
  buffer_load_dwordx4 v2, s[8:11], s29 offen sc1 lds
  v_exp_f32 v79, v79
  v_cvt_pk_bf16_f32 v102, v76, v77
  v_cvt_pk_bf16_f32 v103, v78, v79
  s_waitcnt lgkmcnt(0)
  v_mfma_f32_32x32x16_bf16 v[112:127], v[56:59], v[96:99], v[112:127]
  v_exp_f32 v80, v80
  v_exp_f32 v81, v81
  v_exp_f32 v82, v82
  v_exp_f32 v83, v83
  v_mfma_f32_32x32x16_bf16 v[112:127], v[60:63], v[100:103], v[112:127]
  v_cvt_pk_bf16_f32 v104, v80, v81
  v_exp_f32 v84, v84
  v_exp_f32 v85, v85
  v_cvt_pk_bf16_f32 v105, v82, v83
  v_exp_f32 v86, v86
  v_exp_f32 v87, v87
  v_cvt_pk_bf16_f32 v106, v84, v85
  v_exp_f32 v88, v88
  v_exp_f32 v89, v89
  v_cvt_pk_bf16_f32 v107, v86, v87
  v_exp_f32 v90, v90
  v_exp_f32 v91, v91
  v_cvt_pk_bf16_f32 v108, v88, v89
  v_exp_f32 v92, v92
  v_exp_f32 v93, v93
  v_cvt_pk_bf16_f32 v109, v90, v91
  v_exp_f32 v94, v94
  v_exp_f32 v95, v95
  v_cvt_pk_bf16_f32 v110, v92, v93
  v_cvt_pk_bf16_f32 v111, v94, v95
  s_nop 1
  v_mfma_f32_32x32x16_bf16 v[128:143], v[56:59], v[104:107], v[128:143]
  v_mfma_f32_32x32x16_bf16 v[128:143], v[60:63], v[108:111], v[128:143]
  s_waitcnt vmcnt(0)
  s_barrier
  s_add_u32 s41, s41, 1
  s_min_u32 s29, s41, 3
  s_mul_i32 s53, s29, 32768
  s_lshl_b32 s31, s21, 13
  s_add_u32 s53, s53, s31
  ds_read_b128 v[32:35], v4 offset:0
  ds_read_b128 v[36:39], v4 offset:1024
  ds_read_b128 v[48:51], v4 offset:32768
  ds_read_b128 v[52:55], v4 offset:33792
  ds_read_b128 v[40:43], v4 offset:2048
  ds_read_b128 v[44:47], v4 offset:3072
  s_waitcnt lgkmcnt(4)
  v_mfma_f32_32x32x16_bf16 v[64:79], v[32:35], v[192:195], 0
  v_mfma_f32_32x32x16_bf16 v[64:79], v[36:39], v[196:199], v[64:79]
  s_nop 11
  v_exp_f32 v64, v64
  v_exp_f32 v65, v65
  v_exp_f32 v66, v66
  v_exp_f32 v67, v67
  v_cvt_pk_bf16_f32 v96, v64, v65
  v_exp_f32 v68, v68
  v_exp_f32 v69, v69
  v_cvt_pk_bf16_f32 v97, v66, v67
  v_exp_f32 v70, v70
  v_mfma_f32_32x32x16_bf16 v[80:95], v[32:35], v[200:203], 0
  v_exp_f32 v71, v71
  v_cvt_pk_bf16_f32 v98, v68, v69
  v_exp_f32 v72, v72
  v_exp_f32 v73, v73
  v_cvt_pk_bf16_f32 v99, v70, v71
  v_mfma_f32_32x32x16_bf16 v[80:95], v[36:39], v[204:207], v[80:95]
  v_exp_f32 v74, v74
  v_exp_f32 v75, v75
  ds_read_b128 v[56:59], v4 offset:34816
  v_cvt_pk_bf16_f32 v100, v72, v73
  v_exp_f32 v76, v76
  v_exp_f32 v77, v77
  ds_read_b128 v[60:63], v4 offset:35840
  v_cvt_pk_bf16_f32 v101, v74, v75
  v_exp_f32 v78, v78
  s_add_u32 m0, s31, 0
  s_add_u32 s29, s53, s27
  s_add_u32 s29, s29, 0
  buffer_load_dwordx4 v2, s[8:11], s29 offen sc1 lds
  v_exp_f32 v79, v79
  v_cvt_pk_bf16_f32 v102, v76, v77
  v_cvt_pk_bf16_f32 v103, v78, v79
  s_waitcnt lgkmcnt(4)
  v_mfma_f32_32x32x16_bf16 v[112:127], v[48:51], v[96:99], v[112:127]
  v_exp_f32 v80, v80
  v_exp_f32 v81, v81
  v_exp_f32 v82, v82
  v_exp_f32 v83, v83
  v_mfma_f32_32x32x16_bf16 v[112:127], v[52:55], v[100:103], v[112:127]
  v_cvt_pk_bf16_f32 v104, v80, v81
  v_exp_f32 v84, v84
  v_exp_f32 v85, v85
  v_cvt_pk_bf16_f32 v105, v82, v83
  v_exp_f32 v86, v86
  s_waitcnt lgkmcnt(2)
  v_mfma_f32_32x32x16_bf16 v[64:79], v[40:43], v[192:195], 0
  v_exp_f32 v87, v87
  v_cvt_pk_bf16_f32 v106, v84, v85
  v_exp_f32 v88, v88
  v_exp_f32 v89, v89
  v_cvt_pk_bf16_f32 v107, v86, v87
  v_mfma_f32_32x32x16_bf16 v[64:79], v[44:47], v[196:199], v[64:79]
  v_exp_f32 v90, v90
  v_exp_f32 v91, v91
  ds_read_b128 v[32:35], v4 offset:4096
  v_cvt_pk_bf16_f32 v108, v88, v89
  v_exp_f32 v92, v92
  v_exp_f32 v93, v93
  ds_read_b128 v[36:39], v4 offset:5120
  v_cvt_pk_bf16_f32 v109, v90, v91
  v_exp_f32 v94, v94
  v_exp_f32 v95, v95
  v_cvt_pk_bf16_f32 v110, v92, v93
  v_cvt_pk_bf16_f32 v111, v94, v95
  v_mfma_f32_32x32x16_bf16 v[128:143], v[48:51], v[104:107], v[128:143]
  v_exp_f32 v64, v64
  v_exp_f32 v65, v65
  v_exp_f32 v66, v66
  v_exp_f32 v67, v67
  v_mfma_f32_32x32x16_bf16 v[128:143], v[52:55], v[108:111], v[128:143]
  v_cvt_pk_bf16_f32 v96, v64, v65
  v_exp_f32 v68, v68
  v_exp_f32 v69, v69
  v_cvt_pk_bf16_f32 v97, v66, v67
  v_exp_f32 v70, v70
  v_mfma_f32_32x32x16_bf16 v[80:95], v[40:43], v[200:203], 0
  v_exp_f32 v71, v71
  v_cvt_pk_bf16_f32 v98, v68, v69
  v_exp_f32 v72, v72
  v_exp_f32 v73, v73
  v_cvt_pk_bf16_f32 v99, v70, v71
  v_mfma_f32_32x32x16_bf16 v[80:95], v[44:47], v[204:207], v[80:95]
  v_exp_f32 v74, v74
  v_exp_f32 v75, v75
  ds_read_b128 v[48:51], v4 offset:36864
  v_cvt_pk_bf16_f32 v100, v72, v73
  v_exp_f32 v76, v76
  v_exp_f32 v77, v77
  ds_read_b128 v[52:55], v4 offset:37888
  v_cvt_pk_bf16_f32 v101, v74, v75
  v_exp_f32 v78, v78
  s_add_u32 m0, s31, 1024
  s_add_u32 s29, s53, s27
  s_add_u32 s29, s29, 1024
  buffer_load_dwordx4 v2, s[8:11], s29 offen sc1 lds
  v_exp_f32 v79, v79
  v_cvt_pk_bf16_f32 v102, v76, v77
  v_cvt_pk_bf16_f32 v103, v78, v79
  s_waitcnt lgkmcnt(4)
  v_mfma_f32_32x32x16_bf16 v[112:127], v[56:59], v[96:99], v[112:127]
  v_exp_f32 v80, v80
  v_exp_f32 v81, v81
  v_exp_f32 v82, v82
  v_exp_f32 v83, v83
  v_mfma_f32_32x32x16_bf16 v[112:127], v[60:63], v[100:103], v[112:127]
  v_cvt_pk_bf16_f32 v104, v80, v81
  v_exp_f32 v84, v84
  v_exp_f32 v85, v85
  v_cvt_pk_bf16_f32 v105, v82, v83
  v_exp_f32 v86, v86
  s_waitcnt lgkmcnt(2)
  v_mfma_f32_32x32x16_bf16 v[64:79], v[32:35], v[192:195], 0
  v_exp_f32 v87, v87
  v_cvt_pk_bf16_f32 v106, v84, v85
  v_exp_f32 v88, v88
  v_exp_f32 v89, v89
  v_cvt_pk_bf16_f32 v107, v86, v87
  v_mfma_f32_32x32x16_bf16 v[64:79], v[36:39], v[196:199], v[64:79]
  v_exp_f32 v90, v90
  v_exp_f32 v91, v91
  ds_read_b128 v[40:43], v4 offset:6144
  v_cvt_pk_bf16_f32 v108, v88, v89
  v_exp_f32 v92, v92
  v_exp_f32 v93, v93
  ds_read_b128 v[44:47], v4 offset:7168
  v_cvt_pk_bf16_f32 v109, v90, v91
  v_exp_f32 v94, v94
  v_exp_f32 v95, v95
  v_cvt_pk_bf16_f32 v110, v92, v93
  v_cvt_pk_bf16_f32 v111, v94, v95
  v_mfma_f32_32x32x16_bf16 v[128:143], v[56:59], v[104:107], v[128:143]
  v_exp_f32 v64, v64
  v_exp_f32 v65, v65
  v_exp_f32 v66, v66
  v_exp_f32 v67, v67
  v_mfma_f32_32x32x16_bf16 v[128:143], v[60:63], v[108:111], v[128:143]
  v_cvt_pk_bf16_f32 v96, v64, v65
  v_exp_f32 v68, v68
  v_exp_f32 v69, v69
  v_cvt_pk_bf16_f32 v97, v66, v67
  v_exp_f32 v70, v70
  v_mfma_f32_32x32x16_bf16 v[80:95], v[32:35], v[200:203], 0
  v_exp_f32 v71, v71
  v_cvt_pk_bf16_f32 v98, v68, v69
  v_exp_f32 v72, v72
  v_exp_f32 v73, v73
  v_cvt_pk_bf16_f32 v99, v70, v71
  v_mfma_f32_32x32x16_bf16 v[80:95], v[36:39], v[204:207], v[80:95]
  v_exp_f32 v74, v74
  v_exp_f32 v75, v75
  ds_read_b128 v[56:59], v4 offset:38912
  v_cvt_pk_bf16_f32 v100, v72, v73
  v_exp_f32 v76, v76
  v_exp_f32 v77, v77
  ds_read_b128 v[60:63], v4 offset:39936
  v_cvt_pk_bf16_f32 v101, v74, v75
  v_exp_f32 v78, v78
  s_add_u32 m0, s31, 2048
  s_add_u32 s29, s53, s27
  s_add_u32 s29, s29, 2048
  buffer_load_dwordx4 v2, s[8:11], s29 offen sc1 lds
  v_exp_f32 v79, v79
  v_cvt_pk_bf16_f32 v102, v76, v77
  v_cvt_pk_bf16_f32 v103, v78, v79
  s_waitcnt lgkmcnt(4)
  v_mfma_f32_32x32x16_bf16 v[112:127], v[48:51], v[96:99], v[112:127]
  v_exp_f32 v80, v80
  v_exp_f32 v81, v81
  v_exp_f32 v82, v82
  v_exp_f32 v83, v83
  v_mfma_f32_32x32x16_bf16 v[112:127], v[52:55], v[100:103], v[112:127]
  v_cvt_pk_bf16_f32 v104, v80, v81
  v_exp_f32 v84, v84
  v_exp_f32 v85, v85
  v_cvt_pk_bf16_f32 v105, v82, v83
  v_exp_f32 v86, v86
  s_waitcnt lgkmcnt(2)
  v_mfma_f32_32x32x16_bf16 v[64:79], v[40:43], v[192:195], 0
  v_exp_f32 v87, v87
  v_cvt_pk_bf16_f32 v106, v84, v85
  v_exp_f32 v88, v88
  v_exp_f32 v89, v89
  v_cvt_pk_bf16_f32 v107, v86, v87
  v_mfma_f32_32x32x16_bf16 v[64:79], v[44:47], v[196:199], v[64:79]
  v_exp_f32 v90, v90
  v_exp_f32 v91, v91
  ds_read_b128 v[32:35], v4 offset:8192
  v_cvt_pk_bf16_f32 v108, v88, v89
  v_exp_f32 v92, v92
  v_exp_f32 v93, v93
  ds_read_b128 v[36:39], v4 offset:9216
  v_cvt_pk_bf16_f32 v109, v90, v91
  v_exp_f32 v94, v94
  v_exp_f32 v95, v95
  v_cvt_pk_bf16_f32 v110, v92, v93
  v_cvt_pk_bf16_f32 v111, v94, v95
  v_mfma_f32_32x32x16_bf16 v[128:143], v[48:51], v[104:107], v[128:143]
  v_exp_f32 v64, v64
  v_exp_f32 v65, v65
  v_exp_f32 v66, v66
  v_exp_f32 v67, v67
  v_mfma_f32_32x32x16_bf16 v[128:143], v[52:55], v[108:111], v[128:143]
  v_cvt_pk_bf16_f32 v96, v64, v65
  v_exp_f32 v68, v68
  v_exp_f32 v69, v69
  v_cvt_pk_bf16_f32 v97, v66, v67
  v_exp_f32 v70, v70
  v_mfma_f32_32x32x16_bf16 v[80:95], v[40:43], v[200:203], 0
  v_exp_f32 v71, v71
  v_cvt_pk_bf16_f32 v98, v68, v69
  v_exp_f32 v72, v72
  v_exp_f32 v73, v73
  v_cvt_pk_bf16_f32 v99, v70, v71
  v_mfma_f32_32x32x16_bf16 v[80:95], v[44:47], v[204:207], v[80:95]
  v_exp_f32 v74, v74
  v_exp_f32 v75, v75
  ds_read_b128 v[48:51], v4 offset:40960
  v_cvt_pk_bf16_f32 v100, v72, v73
  v_exp_f32 v76, v76
  v_exp_f32 v77, v77
  ds_read_b128 v[52:55], v4 offset:41984
  v_cvt_pk_bf16_f32 v101, v74, v75
  v_exp_f32 v78, v78
  s_add_u32 m0, s31, 3072
  s_add_u32 s29, s53, s27
  s_add_u32 s29, s29, 3072
  buffer_load_dwordx4 v2, s[8:11], s29 offen sc1 lds
  v_exp_f32 v79, v79
  v_cvt_pk_bf16_f32 v102, v76, v77
  v_cvt_pk_bf16_f32 v103, v78, v79
  s_waitcnt lgkmcnt(4)
  v_mfma_f32_32x32x16_bf16 v[112:127], v[56:59], v[96:99], v[112:127]
  v_exp_f32 v80, v80
  v_exp_f32 v81, v81
  v_exp_f32 v82, v82
  v_exp_f32 v83, v83
  v_mfma_f32_32x32x16_bf16 v[112:127], v[60:63], v[100:103], v[112:127]
  v_cvt_pk_bf16_f32 v104, v80, v81
  v_exp_f32 v84, v84
  v_exp_f32 v85, v85
  v_cvt_pk_bf16_f32 v105, v82, v83
  v_exp_f32 v86, v86
  s_waitcnt lgkmcnt(2)
  v_mfma_f32_32x32x16_bf16 v[64:79], v[32:35], v[192:195], 0
  v_exp_f32 v87, v87
  v_cvt_pk_bf16_f32 v106, v84, v85
  v_exp_f32 v88, v88
  v_exp_f32 v89, v89
  v_cvt_pk_bf16_f32 v107, v86, v87
  v_mfma_f32_32x32x16_bf16 v[64:79], v[36:39], v[196:199], v[64:79]
  v_exp_f32 v90, v90
  v_exp_f32 v91, v91
  ds_read_b128 v[40:43], v4 offset:10240
  v_cvt_pk_bf16_f32 v108, v88, v89
  v_exp_f32 v92, v92
  v_exp_f32 v93, v93
  ds_read_b128 v[44:47], v4 offset:11264
  v_cvt_pk_bf16_f32 v109, v90, v91
  v_exp_f32 v94, v94
  v_exp_f32 v95, v95
  v_cvt_pk_bf16_f32 v110, v92, v93
  v_cvt_pk_bf16_f32 v111, v94, v95
  v_mfma_f32_32x32x16_bf16 v[128:143], v[56:59], v[104:107], v[128:143]
  v_exp_f32 v64, v64
  v_exp_f32 v65, v65
  v_exp_f32 v66, v66
  v_exp_f32 v67, v67
  v_mfma_f32_32x32x16_bf16 v[128:143], v[60:63], v[108:111], v[128:143]
  v_cvt_pk_bf16_f32 v96, v64, v65
  v_exp_f32 v68, v68
  v_exp_f32 v69, v69
  v_cvt_pk_bf16_f32 v97, v66, v67
  v_exp_f32 v70, v70
  v_mfma_f32_32x32x16_bf16 v[80:95], v[32:35], v[200:203], 0
  v_exp_f32 v71, v71
  v_cvt_pk_bf16_f32 v98, v68, v69
  v_exp_f32 v72, v72
  v_exp_f32 v73, v73
  v_cvt_pk_bf16_f32 v99, v70, v71
  v_mfma_f32_32x32x16_bf16 v[80:95], v[36:39], v[204:207], v[80:95]
  v_exp_f32 v74, v74
  v_exp_f32 v75, v75
  ds_read_b128 v[56:59], v4 offset:43008
  v_cvt_pk_bf16_f32 v100, v72, v73
  v_exp_f32 v76, v76
  v_exp_f32 v77, v77
  ds_read_b128 v[60:63], v4 offset:44032
  v_cvt_pk_bf16_f32 v101, v74, v75
  v_exp_f32 v78, v78
  s_add_u32 m0, s31, 4096
  s_add_u32 s29, s53, s27
  s_add_u32 s29, s29, 4096
  buffer_load_dwordx4 v2, s[8:11], s29 offen sc1 lds
  v_exp_f32 v79, v79
  v_cvt_pk_bf16_f32 v102, v76, v77
  v_cvt_pk_bf16_f32 v103, v78, v79
  s_waitcnt lgkmcnt(4)
  v_mfma_f32_32x32x16_bf16 v[112:127], v[48:51], v[96:99], v[112:127]
  v_exp_f32 v80, v80
  v_exp_f32 v81, v81
  v_exp_f32 v82, v82
  v_exp_f32 v83, v83
  v_mfma_f32_32x32x16_bf16 v[112:127], v[52:55], v[100:103], v[112:127]
  v_cvt_pk_bf16_f32 v104, v80, v81
  v_exp_f32 v84, v84
  v_exp_f32 v85, v85
  v_cvt_pk_bf16_f32 v105, v82, v83
  v_exp_f32 v86, v86
  s_waitcnt lgkmcnt(2)
  v_mfma_f32_32x32x16_bf16 v[64:79], v[40:43], v[192:195], 0
  v_exp_f32 v87, v87
  v_cvt_pk_bf16_f32 v106, v84, v85
  v_exp_f32 v88, v88
  v_exp_f32 v89, v89
  v_cvt_pk_bf16_f32 v107, v86, v87
  v_mfma_f32_32x32x16_bf16 v[64:79], v[44:47], v[196:199], v[64:79]
  v_exp_f32 v90, v90
  v_exp_f32 v91, v91
  ds_read_b128 v[32:35], v4 offset:12288
  v_cvt_pk_bf16_f32 v108, v88, v89
  v_exp_f32 v92, v92
  v_exp_f32 v93, v93
  ds_read_b128 v[36:39], v4 offset:13312
  v_cvt_pk_bf16_f32 v109, v90, v91
  v_exp_f32 v94, v94
  v_exp_f32 v95, v95
  v_cvt_pk_bf16_f32 v110, v92, v93
  v_cvt_pk_bf16_f32 v111, v94, v95
  v_mfma_f32_32x32x16_bf16 v[128:143], v[48:51], v[104:107], v[128:143]
  v_exp_f32 v64, v64
  v_exp_f32 v65, v65
  v_exp_f32 v66, v66
  v_exp_f32 v67, v67
  v_mfma_f32_32x32x16_bf16 v[128:143], v[52:55], v[108:111], v[128:143]
  v_cvt_pk_bf16_f32 v96, v64, v65
  v_exp_f32 v68, v68
  v_exp_f32 v69, v69
  v_cvt_pk_bf16_f32 v97, v66, v67
  v_exp_f32 v70, v70
  v_mfma_f32_32x32x16_bf16 v[80:95], v[40:43], v[200:203], 0
  v_exp_f32 v71, v71
  v_cvt_pk_bf16_f32 v98, v68, v69
  v_exp_f32 v72, v72
  v_exp_f32 v73, v73
  v_cvt_pk_bf16_f32 v99, v70, v71
  v_mfma_f32_32x32x16_bf16 v[80:95], v[44:47], v[204:207], v[80:95]
  v_exp_f32 v74, v74
  v_exp_f32 v75, v75
  ds_read_b128 v[48:51], v4 offset:45056
  v_cvt_pk_bf16_f32 v100, v72, v73
  v_exp_f32 v76, v76
  v_exp_f32 v77, v77
  ds_read_b128 v[52:55], v4 offset:46080
  v_cvt_pk_bf16_f32 v101, v74, v75
  v_exp_f32 v78, v78
  s_add_u32 m0, s31, 5120
  s_add_u32 s29, s53, s27
  s_add_u32 s29, s29, 5120
  buffer_load_dwordx4 v2, s[8:11], s29 offen sc1 lds
  v_exp_f32 v79, v79
  v_cvt_pk_bf16_f32 v102, v76, v77
  v_cvt_pk_bf16_f32 v103, v78, v79
  s_waitcnt lgkmcnt(4)
  v_mfma_f32_32x32x16_bf16 v[112:127], v[56:59], v[96:99], v[112:127]
  v_exp_f32 v80, v80
  v_exp_f32 v81, v81
  v_exp_f32 v82, v82
  v_exp_f32 v83, v83
  v_mfma_f32_32x32x16_bf16 v[112:127], v[60:63], v[100:103], v[112:127]
  v_cvt_pk_bf16_f32 v104, v80, v81
  v_exp_f32 v84, v84
  v_exp_f32 v85, v85
  v_cvt_pk_bf16_f32 v105, v82, v83
  v_exp_f32 v86, v86
  s_waitcnt lgkmcnt(2)
  v_mfma_f32_32x32x16_bf16 v[64:79], v[32:35], v[192:195], 0
  v_exp_f32 v87, v87
  v_cvt_pk_bf16_f32 v106, v84, v85
  v_exp_f32 v88, v88
  v_exp_f32 v89, v89
  v_cvt_pk_bf16_f32 v107, v86, v87
  v_mfma_f32_32x32x16_bf16 v[64:79], v[36:39], v[196:199], v[64:79]
  v_exp_f32 v90, v90
  v_exp_f32 v91, v91
  ds_read_b128 v[40:43], v4 offset:14336
  v_cvt_pk_bf16_f32 v108, v88, v89
  v_exp_f32 v92, v92
  v_exp_f32 v93, v93
  ds_read_b128 v[44:47], v4 offset:15360
  v_cvt_pk_bf16_f32 v109, v90, v91
  v_exp_f32 v94, v94
  v_exp_f32 v95, v95
  v_cvt_pk_bf16_f32 v110, v92, v93
  v_cvt_pk_bf16_f32 v111, v94, v95
  v_mfma_f32_32x32x16_bf16 v[128:143], v[56:59], v[104:107], v[128:143]
  v_exp_f32 v64, v64
  v_exp_f32 v65, v65
  v_exp_f32 v66, v66
  v_exp_f32 v67, v67
  v_mfma_f32_32x32x16_bf16 v[128:143], v[60:63], v[108:111], v[128:143]
  v_cvt_pk_bf16_f32 v96, v64, v65
  v_exp_f32 v68, v68
  v_exp_f32 v69, v69
  v_cvt_pk_bf16_f32 v97, v66, v67
  v_exp_f32 v70, v70
  v_mfma_f32_32x32x16_bf16 v[80:95], v[32:35], v[200:203], 0
  v_exp_f32 v71, v71
  v_cvt_pk_bf16_f32 v98, v68, v69
  v_exp_f32 v72, v72
  v_exp_f32 v73, v73
  v_cvt_pk_bf16_f32 v99, v70, v71
  v_mfma_f32_32x32x16_bf16 v[80:95], v[36:39], v[204:207], v[80:95]
  v_exp_f32 v74, v74
  v_exp_f32 v75, v75
  ds_read_b128 v[56:59], v4 offset:47104
  v_cvt_pk_bf16_f32 v100, v72, v73
  v_exp_f32 v76, v76
  v_exp_f32 v77, v77
  ds_read_b128 v[60:63], v4 offset:48128
  v_cvt_pk_bf16_f32 v101, v74, v75
  v_exp_f32 v78, v78
  s_add_u32 m0, s31, 6144
  s_add_u32 s29, s53, s27
  s_add_u32 s29, s29, 6144
  buffer_load_dwordx4 v2, s[8:11], s29 offen sc1 lds
  v_exp_f32 v79, v79
  v_cvt_pk_bf16_f32 v102, v76, v77
  v_cvt_pk_bf16_f32 v103, v78, v79
  s_waitcnt lgkmcnt(4)
  v_mfma_f32_32x32x16_bf16 v[112:127], v[48:51], v[96:99], v[112:127]
  v_exp_f32 v80, v80
  v_exp_f32 v81, v81
  v_exp_f32 v82, v82
  v_exp_f32 v83, v83
  v_mfma_f32_32x32x16_bf16 v[112:127], v[52:55], v[100:103], v[112:127]
  v_cvt_pk_bf16_f32 v104, v80, v81
  v_exp_f32 v84, v84
  v_exp_f32 v85, v85
  v_cvt_pk_bf16_f32 v105, v82, v83
  v_exp_f32 v86, v86
  s_waitcnt lgkmcnt(2)
  v_mfma_f32_32x32x16_bf16 v[64:79], v[40:43], v[192:195], 0
  v_exp_f32 v87, v87
  v_cvt_pk_bf16_f32 v106, v84, v85
  v_exp_f32 v88, v88
  v_exp_f32 v89, v89
  v_cvt_pk_bf16_f32 v107, v86, v87
  v_mfma_f32_32x32x16_bf16 v[64:79], v[44:47], v[196:199], v[64:79]
  v_exp_f32 v90, v90
  v_exp_f32 v91, v91
  ds_read_b128 v[32:35], v4 offset:16384
  v_cvt_pk_bf16_f32 v108, v88, v89
  v_exp_f32 v92, v92
  v_exp_f32 v93, v93
  ds_read_b128 v[36:39], v4 offset:17408
  v_cvt_pk_bf16_f32 v109, v90, v91
  v_exp_f32 v94, v94
  v_exp_f32 v95, v95
  v_cvt_pk_bf16_f32 v110, v92, v93
  v_cvt_pk_bf16_f32 v111, v94, v95
  v_mfma_f32_32x32x16_bf16 v[128:143], v[48:51], v[104:107], v[128:143]
  v_exp_f32 v64, v64
  v_exp_f32 v65, v65
  v_exp_f32 v66, v66
  v_exp_f32 v67, v67
  v_mfma_f32_32x32x16_bf16 v[128:143], v[52:55], v[108:111], v[128:143]
  v_cvt_pk_bf16_f32 v96, v64, v65
  v_exp_f32 v68, v68
  v_exp_f32 v69, v69
  v_cvt_pk_bf16_f32 v97, v66, v67
  v_exp_f32 v70, v70
  v_mfma_f32_32x32x16_bf16 v[80:95], v[40:43], v[200:203], 0
  v_exp_f32 v71, v71
  v_cvt_pk_bf16_f32 v98, v68, v69
  v_exp_f32 v72, v72
  v_exp_f32 v73, v73
  v_cvt_pk_bf16_f32 v99, v70, v71
  v_mfma_f32_32x32x16_bf16 v[80:95], v[44:47], v[204:207], v[80:95]
  v_exp_f32 v74, v74
  v_exp_f32 v75, v75
  ds_read_b128 v[48:51], v4 offset:49152
  v_cvt_pk_bf16_f32 v100, v72, v73
  v_exp_f32 v76, v76
  v_exp_f32 v77, v77
  ds_read_b128 v[52:55], v4 offset:50176
  v_cvt_pk_bf16_f32 v101, v74, v75
  v_exp_f32 v78, v78
  s_add_u32 m0, s31, 7168
  s_add_u32 s29, s53, s27
  s_add_u32 s29, s29, 7168
  buffer_load_dwordx4 v2, s[8:11], s29 offen sc1 lds
  v_exp_f32 v79, v79
  v_cvt_pk_bf16_f32 v102, v76, v77
  v_cvt_pk_bf16_f32 v103, v78, v79
  s_waitcnt lgkmcnt(4)
  v_mfma_f32_32x32x16_bf16 v[112:127], v[56:59], v[96:99], v[112:127]
  v_exp_f32 v80, v80
  v_exp_f32 v81, v81
  v_exp_f32 v82, v82
  v_exp_f32 v83, v83
  v_mfma_f32_32x32x16_bf16 v[112:127], v[60:63], v[100:103], v[112:127]
  v_cvt_pk_bf16_f32 v104, v80, v81
  v_exp_f32 v84, v84
  v_exp_f32 v85, v85
  v_cvt_pk_bf16_f32 v105, v82, v83
  v_exp_f32 v86, v86
  s_waitcnt lgkmcnt(2)
  v_mfma_f32_32x32x16_bf16 v[64:79], v[32:35], v[192:195], 0
  v_exp_f32 v87, v87
  v_cvt_pk_bf16_f32 v106, v84, v85
  v_exp_f32 v88, v88
  v_exp_f32 v89, v89
  v_cvt_pk_bf16_f32 v107, v86, v87
  v_mfma_f32_32x32x16_bf16 v[64:79], v[36:39], v[196:199], v[64:79]
  v_exp_f32 v90, v90
  v_exp_f32 v91, v91
  ds_read_b128 v[40:43], v4 offset:18432
  v_cvt_pk_bf16_f32 v108, v88, v89
  v_exp_f32 v92, v92
  v_exp_f32 v93, v93
  ds_read_b128 v[44:47], v4 offset:19456
  v_cvt_pk_bf16_f32 v109, v90, v91
  v_exp_f32 v94, v94
  v_exp_f32 v95, v95
  v_cvt_pk_bf16_f32 v110, v92, v93
  v_cvt_pk_bf16_f32 v111, v94, v95
  v_mfma_f32_32x32x16_bf16 v[128:143], v[56:59], v[104:107], v[128:143]
  v_exp_f32 v64, v64
  v_exp_f32 v65, v65
  v_exp_f32 v66, v66
  v_exp_f32 v67, v67
  v_mfma_f32_32x32x16_bf16 v[128:143], v[60:63], v[108:111], v[128:143]
  v_cvt_pk_bf16_f32 v96, v64, v65
  v_exp_f32 v68, v68
  v_exp_f32 v69, v69
  v_cvt_pk_bf16_f32 v97, v66, v67
  v_exp_f32 v70, v70
  v_mfma_f32_32x32x16_bf16 v[80:95], v[32:35], v[200:203], 0
  v_exp_f32 v71, v71
  v_cvt_pk_bf16_f32 v98, v68, v69
  v_exp_f32 v72, v72
  v_exp_f32 v73, v73
  v_cvt_pk_bf16_f32 v99, v70, v71
  v_mfma_f32_32x32x16_bf16 v[80:95], v[36:39], v[204:207], v[80:95]
  v_exp_f32 v74, v74
  v_exp_f32 v75, v75
  ds_read_b128 v[56:59], v4 offset:51200
  v_cvt_pk_bf16_f32 v100, v72, v73
  v_exp_f32 v76, v76
  v_exp_f32 v77, v77
  ds_read_b128 v[60:63], v4 offset:52224
  v_cvt_pk_bf16_f32 v101, v74, v75
  v_exp_f32 v78, v78
  s_add_u32 m0, s31, 32768
  s_add_u32 s29, s53, s28
  s_add_u32 s29, s29, 0
  buffer_load_dwordx4 v2, s[8:11], s29 offen sc1 lds
  v_exp_f32 v79, v79
  v_cvt_pk_bf16_f32 v102, v76, v77
  v_cvt_pk_bf16_f32 v103, v78, v79
  s_waitcnt lgkmcnt(4)
  v_mfma_f32_32x32x16_bf16 v[112:127], v[48:51], v[96:99], v[112:127]
  v_exp_f32 v80, v80
  v_exp_f32 v81, v81
  v_exp_f32 v82, v82
  v_exp_f32 v83, v83
  v_mfma_f32_32x32x16_bf16 v[112:127], v[52:55], v[100:103], v[112:127]
  v_cvt_pk_bf16_f32 v104, v80, v81
  v_exp_f32 v84, v84
  v_exp_f32 v85, v85
  v_cvt_pk_bf16_f32 v105, v82, v83
  v_exp_f32 v86, v86
  s_waitcnt lgkmcnt(2)
  v_mfma_f32_32x32x16_bf16 v[64:79], v[40:43], v[192:195], 0
  v_exp_f32 v87, v87
  v_cvt_pk_bf16_f32 v106, v84, v85
  v_exp_f32 v88, v88
  v_exp_f32 v89, v89
  v_cvt_pk_bf16_f32 v107, v86, v87
  v_mfma_f32_32x32x16_bf16 v[64:79], v[44:47], v[196:199], v[64:79]
  v_exp_f32 v90, v90
  v_exp_f32 v91, v91
  ds_read_b128 v[32:35], v4 offset:20480
  v_cvt_pk_bf16_f32 v108, v88, v89
  v_exp_f32 v92, v92
  v_exp_f32 v93, v93
  ds_read_b128 v[36:39], v4 offset:21504
  v_cvt_pk_bf16_f32 v109, v90, v91
  v_exp_f32 v94, v94
  v_exp_f32 v95, v95
  v_cvt_pk_bf16_f32 v110, v92, v93
  v_cvt_pk_bf16_f32 v111, v94, v95
  v_mfma_f32_32x32x16_bf16 v[128:143], v[48:51], v[104:107], v[128:143]
  v_exp_f32 v64, v64
  v_exp_f32 v65, v65
  v_exp_f32 v66, v66
  v_exp_f32 v67, v67
  v_mfma_f32_32x32x16_bf16 v[128:143], v[52:55], v[108:111], v[128:143]
  v_cvt_pk_bf16_f32 v96, v64, v65
  v_exp_f32 v68, v68
  v_exp_f32 v69, v69
  v_cvt_pk_bf16_f32 v97, v66, v67
  v_exp_f32 v70, v70
  v_mfma_f32_32x32x16_bf16 v[80:95], v[40:43], v[200:203], 0
  v_exp_f32 v71, v71
  v_cvt_pk_bf16_f32 v98, v68, v69
  v_exp_f32 v72, v72
  v_exp_f32 v73, v73
  v_cvt_pk_bf16_f32 v99, v70, v71
  v_mfma_f32_32x32x16_bf16 v[80:95], v[44:47], v[204:207], v[80:95]
  v_exp_f32 v74, v74
  v_exp_f32 v75, v75
  ds_read_b128 v[48:51], v4 offset:53248
  v_cvt_pk_bf16_f32 v100, v72, v73
  v_exp_f32 v76, v76
  v_exp_f32 v77, v77
  ds_read_b128 v[52:55], v4 offset:54272
  v_cvt_pk_bf16_f32 v101, v74, v75
  v_exp_f32 v78, v78
  s_add_u32 m0, s31, 33792
  s_add_u32 s29, s53, s28
  s_add_u32 s29, s29, 1024
  buffer_load_dwordx4 v2, s[8:11], s29 offen sc1 lds
  v_exp_f32 v79, v79
  v_cvt_pk_bf16_f32 v102, v76, v77
  v_cvt_pk_bf16_f32 v103, v78, v79
  s_waitcnt lgkmcnt(4)
  v_mfma_f32_32x32x16_bf16 v[112:127], v[56:59], v[96:99], v[112:127]
  v_exp_f32 v80, v80
  v_exp_f32 v81, v81
  v_exp_f32 v82, v82
  v_exp_f32 v83, v83
  v_mfma_f32_32x32x16_bf16 v[112:127], v[60:63], v[100:103], v[112:127]
  v_cvt_pk_bf16_f32 v104, v80, v81
  v_exp_f32 v84, v84
  v_exp_f32 v85, v85
  v_cvt_pk_bf16_f32 v105, v82, v83
  v_exp_f32 v86, v86
  s_waitcnt lgkmcnt(2)
  v_mfma_f32_32x32x16_bf16 v[64:79], v[32:35], v[192:195], 0
  v_exp_f32 v87, v87
  v_cvt_pk_bf16_f32 v106, v84, v85
  v_exp_f32 v88, v88
  v_exp_f32 v89, v89
  v_cvt_pk_bf16_f32 v107, v86, v87
  v_mfma_f32_32x32x16_bf16 v[64:79], v[36:39], v[196:199], v[64:79]
  v_exp_f32 v90, v90
  v_exp_f32 v91, v91
  ds_read_b128 v[40:43], v4 offset:22528
  v_cvt_pk_bf16_f32 v108, v88, v89
  v_exp_f32 v92, v92
  v_exp_f32 v93, v93
  ds_read_b128 v[44:47], v4 offset:23552
  v_cvt_pk_bf16_f32 v109, v90, v91
  v_exp_f32 v94, v94
  v_exp_f32 v95, v95
  v_cvt_pk_bf16_f32 v110, v92, v93
  v_cvt_pk_bf16_f32 v111, v94, v95
  v_mfma_f32_32x32x16_bf16 v[128:143], v[56:59], v[104:107], v[128:143]
  v_exp_f32 v64, v64
  v_exp_f32 v65, v65
  v_exp_f32 v66, v66
  v_exp_f32 v67, v67
  v_mfma_f32_32x32x16_bf16 v[128:143], v[60:63], v[108:111], v[128:143]
  v_cvt_pk_bf16_f32 v96, v64, v65
  v_exp_f32 v68, v68
  v_exp_f32 v69, v69
  v_cvt_pk_bf16_f32 v97, v66, v67
  v_exp_f32 v70, v70
  v_mfma_f32_32x32x16_bf16 v[80:95], v[32:35], v[200:203], 0
  v_exp_f32 v71, v71
  v_cvt_pk_bf16_f32 v98, v68, v69
  v_exp_f32 v72, v72
  v_exp_f32 v73, v73
  v_cvt_pk_bf16_f32 v99, v70, v71
  v_mfma_f32_32x32x16_bf16 v[80:95], v[36:39], v[204:207], v[80:95]
  v_exp_f32 v74, v74
  v_exp_f32 v75, v75
  ds_read_b128 v[56:59], v4 offset:55296
  v_cvt_pk_bf16_f32 v100, v72, v73
  v_exp_f32 v76, v76
  v_exp_f32 v77, v77
  ds_read_b128 v[60:63], v4 offset:56320
  v_cvt_pk_bf16_f32 v101, v74, v75
  v_exp_f32 v78, v78
  s_add_u32 m0, s31, 34816
  s_add_u32 s29, s53, s28
  s_add_u32 s29, s29, 2048
  buffer_load_dwordx4 v2, s[8:11], s29 offen sc1 lds
  v_exp_f32 v79, v79
  v_cvt_pk_bf16_f32 v102, v76, v77
  v_cvt_pk_bf16_f32 v103, v78, v79
  s_waitcnt lgkmcnt(4)
  v_mfma_f32_32x32x16_bf16 v[112:127], v[48:51], v[96:99], v[112:127]
  v_exp_f32 v80, v80
  v_exp_f32 v81, v81
  v_exp_f32 v82, v82
  v_exp_f32 v83, v83
  v_mfma_f32_32x32x16_bf16 v[112:127], v[52:55], v[100:103], v[112:127]
  v_cvt_pk_bf16_f32 v104, v80, v81
  v_exp_f32 v84, v84
  v_exp_f32 v85, v85
  v_cvt_pk_bf16_f32 v105, v82, v83
  v_exp_f32 v86, v86
  s_waitcnt lgkmcnt(2)
  v_mfma_f32_32x32x16_bf16 v[64:79], v[40:43], v[192:195], 0
  v_exp_f32 v87, v87
  v_cvt_pk_bf16_f32 v106, v84, v85
  v_exp_f32 v88, v88
  v_exp_f32 v89, v89
  v_cvt_pk_bf16_f32 v107, v86, v87
  v_mfma_f32_32x32x16_bf16 v[64:79], v[44:47], v[196:199], v[64:79]
  v_exp_f32 v90, v90
  v_exp_f32 v91, v91
  ds_read_b128 v[32:35], v4 offset:24576
  v_cvt_pk_bf16_f32 v108, v88, v89
  v_exp_f32 v92, v92
  v_exp_f32 v93, v93
  ds_read_b128 v[36:39], v4 offset:25600
  v_cvt_pk_bf16_f32 v109, v90, v91
  v_exp_f32 v94, v94
  v_exp_f32 v95, v95
  v_cvt_pk_bf16_f32 v110, v92, v93
  v_cvt_pk_bf16_f32 v111, v94, v95
  v_mfma_f32_32x32x16_bf16 v[128:143], v[48:51], v[104:107], v[128:143]
  v_exp_f32 v64, v64
  v_exp_f32 v65, v65
  v_exp_f32 v66, v66
  v_exp_f32 v67, v67
  v_mfma_f32_32x32x16_bf16 v[128:143], v[52:55], v[108:111], v[128:143]
  v_cvt_pk_bf16_f32 v96, v64, v65
  v_exp_f32 v68, v68
  v_exp_f32 v69, v69
  v_cvt_pk_bf16_f32 v97, v66, v67
  v_exp_f32 v70, v70
  v_mfma_f32_32x32x16_bf16 v[80:95], v[40:43], v[200:203], 0
  v_exp_f32 v71, v71
  v_cvt_pk_bf16_f32 v98, v68, v69
  v_exp_f32 v72, v72
  v_exp_f32 v73, v73
  v_cvt_pk_bf16_f32 v99, v70, v71
  v_mfma_f32_32x32x16_bf16 v[80:95], v[44:47], v[204:207], v[80:95]
  v_exp_f32 v74, v74
  v_exp_f32 v75, v75
  ds_read_b128 v[48:51], v4 offset:57344
  v_cvt_pk_bf16_f32 v100, v72, v73
  v_exp_f32 v76, v76
  v_exp_f32 v77, v77
  ds_read_b128 v[52:55], v4 offset:58368
  v_cvt_pk_bf16_f32 v101, v74, v75
  v_exp_f32 v78, v78
  s_add_u32 m0, s31, 35840
  s_add_u32 s29, s53, s28
  s_add_u32 s29, s29, 3072
  buffer_load_dwordx4 v2, s[8:11], s29 offen sc1 lds
  v_exp_f32 v79, v79
  v_cvt_pk_bf16_f32 v102, v76, v77
  v_cvt_pk_bf16_f32 v103, v78, v79
  s_waitcnt lgkmcnt(4)
  v_mfma_f32_32x32x16_bf16 v[112:127], v[56:59], v[96:99], v[112:127]
  v_exp_f32 v80, v80
  v_exp_f32 v81, v81
  v_exp_f32 v82, v82
  v_exp_f32 v83, v83
  v_mfma_f32_32x32x16_bf16 v[112:127], v[60:63], v[100:103], v[112:127]
  v_cvt_pk_bf16_f32 v104, v80, v81
  v_exp_f32 v84, v84
  v_exp_f32 v85, v85
  v_cvt_pk_bf16_f32 v105, v82, v83
  v_exp_f32 v86, v86
  s_waitcnt lgkmcnt(2)
  v_mfma_f32_32x32x16_bf16 v[64:79], v[32:35], v[192:195], 0
  v_exp_f32 v87, v87
  v_cvt_pk_bf16_f32 v106, v84, v85
  v_exp_f32 v88, v88
  v_exp_f32 v89, v89
  v_cvt_pk_bf16_f32 v107, v86, v87
  v_mfma_f32_32x32x16_bf16 v[64:79], v[36:39], v[196:199], v[64:79]
  v_exp_f32 v90, v90
  v_exp_f32 v91, v91
  ds_read_b128 v[40:43], v4 offset:26624
  v_cvt_pk_bf16_f32 v108, v88, v89
  v_exp_f32 v92, v92
  v_exp_f32 v93, v93
  ds_read_b128 v[44:47], v4 offset:27648
  v_cvt_pk_bf16_f32 v109, v90, v91
  v_exp_f32 v94, v94
  v_exp_f32 v95, v95
  v_cvt_pk_bf16_f32 v110, v92, v93
  v_cvt_pk_bf16_f32 v111, v94, v95
  v_mfma_f32_32x32x16_bf16 v[128:143], v[56:59], v[104:107], v[128:143]
  v_exp_f32 v64, v64
  v_exp_f32 v65, v65
  v_exp_f32 v66, v66
  v_exp_f32 v67, v67
  v_mfma_f32_32x32x16_bf16 v[128:143], v[60:63], v[108:111], v[128:143]
  v_cvt_pk_bf16_f32 v96, v64, v65
  v_exp_f32 v68, v68
  v_exp_f32 v69, v69
  v_cvt_pk_bf16_f32 v97, v66, v67
  v_exp_f32 v70, v70
  v_mfma_f32_32x32x16_bf16 v[80:95], v[32:35], v[200:203], 0
  v_exp_f32 v71, v71
  v_cvt_pk_bf16_f32 v98, v68, v69
  v_exp_f32 v72, v72
  v_exp_f32 v73, v73
  v_cvt_pk_bf16_f32 v99, v70, v71
  v_mfma_f32_32x32x16_bf16 v[80:95], v[36:39], v[204:207], v[80:95]
  v_exp_f32 v74, v74
  v_exp_f32 v75, v75
  ds_read_b128 v[56:59], v4 offset:59392
  v_cvt_pk_bf16_f32 v100, v72, v73
  v_exp_f32 v76, v76
  v_exp_f32 v77, v77
  ds_read_b128 v[60:63], v4 offset:60416
  v_cvt_pk_bf16_f32 v101, v74, v75
  v_exp_f32 v78, v78
  s_add_u32 m0, s31, 36864
  s_add_u32 s29, s53, s28
  s_add_u32 s29, s29, 4096
  buffer_load_dwordx4 v2, s[8:11], s29 offen sc1 lds
  v_exp_f32 v79, v79
  v_cvt_pk_bf16_f32 v102, v76, v77
  v_cvt_pk_bf16_f32 v103, v78, v79
  s_waitcnt lgkmcnt(4)
  v_mfma_f32_32x32x16_bf16 v[112:127], v[48:51], v[96:99], v[112:127]
  v_exp_f32 v80, v80
  v_exp_f32 v81, v81
  v_exp_f32 v82, v82
  v_exp_f32 v83, v83
  v_mfma_f32_32x32x16_bf16 v[112:127], v[52:55], v[100:103], v[112:127]
  v_cvt_pk_bf16_f32 v104, v80, v81
  v_exp_f32 v84, v84
  v_exp_f32 v85, v85
  v_cvt_pk_bf16_f32 v105, v82, v83
  v_exp_f32 v86, v86
  s_waitcnt lgkmcnt(2)
  v_mfma_f32_32x32x16_bf16 v[64:79], v[40:43], v[192:195], 0
  v_exp_f32 v87, v87
  v_cvt_pk_bf16_f32 v106, v84, v85
  v_exp_f32 v88, v88
  v_exp_f32 v89, v89
  v_cvt_pk_bf16_f32 v107, v86, v87
  v_mfma_f32_32x32x16_bf16 v[64:79], v[44:47], v[196:199], v[64:79]
  v_exp_f32 v90, v90
  v_exp_f32 v91, v91
  ds_read_b128 v[32:35], v4 offset:28672
  v_cvt_pk_bf16_f32 v108, v88, v89
  v_exp_f32 v92, v92
  v_exp_f32 v93, v93
  ds_read_b128 v[36:39], v4 offset:29696
  v_cvt_pk_bf16_f32 v109, v90, v91
  v_exp_f32 v94, v94
  v_exp_f32 v95, v95
  v_cvt_pk_bf16_f32 v110, v92, v93
  v_cvt_pk_bf16_f32 v111, v94, v95
  v_mfma_f32_32x32x16_bf16 v[128:143], v[48:51], v[104:107], v[128:143]
  v_exp_f32 v64, v64
  v_exp_f32 v65, v65
  v_exp_f32 v66, v66
  v_exp_f32 v67, v67
  v_mfma_f32_32x32x16_bf16 v[128:143], v[52:55], v[108:111], v[128:143]
  v_cvt_pk_bf16_f32 v96, v64, v65
  v_exp_f32 v68, v68
  v_exp_f32 v69, v69
  v_cvt_pk_bf16_f32 v97, v66, v67
  v_exp_f32 v70, v70
  v_mfma_f32_32x32x16_bf16 v[80:95], v[40:43], v[200:203], 0
  v_exp_f32 v71, v71
  v_cvt_pk_bf16_f32 v98, v68, v69
  v_exp_f32 v72, v72
  v_exp_f32 v73, v73
  v_cvt_pk_bf16_f32 v99, v70, v71
  v_mfma_f32_32x32x16_bf16 v[80:95], v[44:47], v[204:207], v[80:95]
  v_exp_f32 v74, v74
  v_exp_f32 v75, v75
  ds_read_b128 v[48:51], v4 offset:61440
  v_cvt_pk_bf16_f32 v100, v72, v73
  v_exp_f32 v76, v76
  v_exp_f32 v77, v77
  ds_read_b128 v[52:55], v4 offset:62464
  v_cvt_pk_bf16_f32 v101, v74, v75
  v_exp_f32 v78, v78
  s_add_u32 m0, s31, 37888
  s_add_u32 s29, s53, s28
  s_add_u32 s29, s29, 5120
  buffer_load_dwordx4 v2, s[8:11], s29 offen sc1 lds
  v_exp_f32 v79, v79
  v_cvt_pk_bf16_f32 v102, v76, v77
  v_cvt_pk_bf16_f32 v103, v78, v79
  s_waitcnt lgkmcnt(4)
  v_mfma_f32_32x32x16_bf16 v[112:127], v[56:59], v[96:99], v[112:127]
  v_exp_f32 v80, v80
  v_exp_f32 v81, v81
  v_exp_f32 v82, v82
  v_exp_f32 v83, v83
  v_mfma_f32_32x32x16_bf16 v[112:127], v[60:63], v[100:103], v[112:127]
  v_cvt_pk_bf16_f32 v104, v80, v81
  v_exp_f32 v84, v84
  v_exp_f32 v85, v85
  v_cvt_pk_bf16_f32 v105, v82, v83
  v_exp_f32 v86, v86
  s_waitcnt lgkmcnt(2)
  v_mfma_f32_32x32x16_bf16 v[64:79], v[32:35], v[192:195], 0
  v_exp_f32 v87, v87
  v_cvt_pk_bf16_f32 v106, v84, v85
  v_exp_f32 v88, v88
  v_exp_f32 v89, v89
  v_cvt_pk_bf16_f32 v107, v86, v87
  v_mfma_f32_32x32x16_bf16 v[64:79], v[36:39], v[196:199], v[64:79]
  v_exp_f32 v90, v90
  v_exp_f32 v91, v91
  ds_read_b128 v[40:43], v4 offset:30720
  v_cvt_pk_bf16_f32 v108, v88, v89
  v_exp_f32 v92, v92
  v_exp_f32 v93, v93
  ds_read_b128 v[44:47], v4 offset:31744
  v_cvt_pk_bf16_f32 v109, v90, v91
  v_exp_f32 v94, v94
  v_exp_f32 v95, v95
  v_cvt_pk_bf16_f32 v110, v92, v93
  v_cvt_pk_bf16_f32 v111, v94, v95
  v_mfma_f32_32x32x16_bf16 v[128:143], v[56:59], v[104:107], v[128:143]
  v_exp_f32 v64, v64
  v_exp_f32 v65, v65
  v_exp_f32 v66, v66
  v_exp_f32 v67, v67
  v_mfma_f32_32x32x16_bf16 v[128:143], v[60:63], v[108:111], v[128:143]
  v_cvt_pk_bf16_f32 v96, v64, v65
  v_exp_f32 v68, v68
  v_exp_f32 v69, v69
  v_cvt_pk_bf16_f32 v97, v66, v67
  v_exp_f32 v70, v70
  v_mfma_f32_32x32x16_bf16 v[80:95], v[32:35], v[200:203], 0
  v_exp_f32 v71, v71
  v_cvt_pk_bf16_f32 v98, v68, v69
  v_exp_f32 v72, v72
  v_exp_f32 v73, v73
  v_cvt_pk_bf16_f32 v99, v70, v71
  v_mfma_f32_32x32x16_bf16 v[80:95], v[36:39], v[204:207], v[80:95]
  v_exp_f32 v74, v74
  v_exp_f32 v75, v75
  ds_read_b128 v[56:59], v4 offset:63488
  v_cvt_pk_bf16_f32 v100, v72, v73
  v_exp_f32 v76, v76
  v_exp_f32 v77, v77
  ds_read_b128 v[60:63], v4 offset:64512
  v_cvt_pk_bf16_f32 v101, v74, v75
  v_exp_f32 v78, v78
  s_add_u32 m0, s31, 38912
  s_add_u32 s29, s53, s28
  s_add_u32 s29, s29, 6144
  buffer_load_dwordx4 v2, s[8:11], s29 offen sc1 lds
  v_exp_f32 v79, v79
  v_cvt_pk_bf16_f32 v102, v76, v77
  v_cvt_pk_bf16_f32 v103, v78, v79
  s_waitcnt lgkmcnt(4)
  v_mfma_f32_32x32x16_bf16 v[112:127], v[48:51], v[96:99], v[112:127]
  v_exp_f32 v80, v80
  v_exp_f32 v81, v81
  v_exp_f32 v82, v82
  v_exp_f32 v83, v83
  v_mfma_f32_32x32x16_bf16 v[112:127], v[52:55], v[100:103], v[112:127]
  v_cvt_pk_bf16_f32 v104, v80, v81
  v_exp_f32 v84, v84
  v_exp_f32 v85, v85
  v_cvt_pk_bf16_f32 v105, v82, v83
  v_exp_f32 v86, v86
  s_waitcnt lgkmcnt(2)
  v_mfma_f32_32x32x16_bf16 v[64:79], v[40:43], v[192:195], 0
  v_exp_f32 v87, v87
  v_cvt_pk_bf16_f32 v106, v84, v85
  v_exp_f32 v88, v88
  v_exp_f32 v89, v89
  v_cvt_pk_bf16_f32 v107, v86, v87
  v_mfma_f32_32x32x16_bf16 v[64:79], v[44:47], v[196:199], v[64:79]
  v_exp_f32 v90, v90
  v_exp_f32 v91, v91
  v_cvt_pk_bf16_f32 v108, v88, v89
  v_exp_f32 v92, v92
  v_exp_f32 v93, v93
  v_cvt_pk_bf16_f32 v109, v90, v91
  v_exp_f32 v94, v94
  v_exp_f32 v95, v95
  v_cvt_pk_bf16_f32 v110, v92, v93
  v_cvt_pk_bf16_f32 v111, v94, v95
  v_mfma_f32_32x32x16_bf16 v[128:143], v[48:51], v[104:107], v[128:143]
  v_exp_f32 v64, v64
  v_exp_f32 v65, v65
  v_exp_f32 v66, v66
  v_exp_f32 v67, v67
  v_mfma_f32_32x32x16_bf16 v[128:143], v[52:55], v[108:111], v[128:143]
  v_cvt_pk_bf16_f32 v96, v64, v65
  v_exp_f32 v68, v68
  v_exp_f32 v69, v69
  v_cvt_pk_bf16_f32 v97, v66, v67
  v_exp_f32 v70, v70
  v_mfma_f32_32x32x16_bf16 v[80:95], v[40:43], v[200:203], 0
  v_exp_f32 v71, v71
  v_cvt_pk_bf16_f32 v98, v68, v69
  v_exp_f32 v72, v72
  v_exp_f32 v73, v73
  v_cvt_pk_bf16_f32 v99, v70, v71
  v_mfma_f32_32x32x16_bf16 v[80:95], v[44:47], v[204:207], v[80:95]
  v_exp_f32 v74, v74
  v_exp_f32 v75, v75
  v_cvt_pk_bf16_f32 v100, v72, v73
  v_exp_f32 v76, v76
  v_exp_f32 v77, v77
  v_cvt_pk_bf16_f32 v101, v74, v75
  v_exp_f32 v78, v78
  s_add_u32 m0, s31, 39936
  s_add_u32 s29, s53, s28
  s_add_u32 s29, s29, 7168
  buffer_load_dwordx4 v2, s[8:11], s29 offen sc1 lds
  v_exp_f32 v79, v79
  v_cvt_pk_bf16_f32 v102, v76, v77
  v_cvt_pk_bf16_f32 v103, v78, v79
  s_waitcnt lgkmcnt(0)
  v_mfma_f32_32x32x16_bf16 v[112:127], v[56:59], v[96:99], v[112:127]
  v_exp_f32 v80, v80
  v_exp_f32 v81, v81
  v_exp_f32 v82, v82
  v_exp_f32 v83, v83
  v_mfma_f32_32x32x16_bf16 v[112:127], v[60:63], v[100:103], v[112:127]
  v_cvt_pk_bf16_f32 v104, v80, v81
  v_exp_f32 v84, v84
  v_exp_f32 v85, v85
  v_cvt_pk_bf16_f32 v105, v82, v83
  v_exp_f32 v86, v86
  v_exp_f32 v87, v87
  v_cvt_pk_bf16_f32 v106, v84, v85
  v_exp_f32 v88, v88
  v_exp_f32 v89, v89
  v_cvt_pk_bf16_f32 v107, v86, v87
  v_exp_f32 v90, v90
  v_exp_f32 v91, v91
  v_cvt_pk_bf16_f32 v108, v88, v89
  v_exp_f32 v92, v92
  v_exp_f32 v93, v93
  v_cvt_pk_bf16_f32 v109, v90, v91
  v_exp_f32 v94, v94
  v_exp_f32 v95, v95
  v_cvt_pk_bf16_f32 v110, v92, v93
  v_cvt_pk_bf16_f32 v111, v94, v95
  s_nop 1
  v_mfma_f32_32x32x16_bf16 v[128:143], v[56:59], v[104:107], v[128:143]
  v_mfma_f32_32x32x16_bf16 v[128:143], v[60:63], v[108:111], v[128:143]
  s_cmp_lt_u32 s41, 4
  s_cbranch_scc1 kb1_chunk2
  s_nop 11
  v_mov_b32 v5, v120
  v_mov_b32 v6, v120
  s_nop 1
  v_permlane32_swap_b32 v5, v6
  v_mov_b32 v14, v6
  v_mov_b32 v5, v136
  v_mov_b32 v6, v136
  s_nop 1
  v_permlane32_swap_b32 v5, v6
  v_mov_b32 v15, v6
  s_cmp_eq_u32 s40, 0
  s_cbranch_scc0 kb1_fin
  v_min_f32 v5, v14, v15
  v_cmp_gt_f32 vcc, 0x12800000, v5
  v_cmp_u_f32 s[36:37], v5, v5
  s_nop 1
  s_or_b64 vcc, vcc, s[36:37]
  s_cmp_lg_u64 vcc, 0
  s_cselect_b32 s42, 1, 0
  v_mov_b32 v5, s42
  s_lshl_b32 s30, s21, 2
  s_add_u32 s30, s30, 131584
  v_mov_b32 v6, s30
  ds_write_b32 v6, v5
  s_waitcnt vmcnt(0) lgkmcnt(0)
  s_barrier
  v_mov_b32 v6, 131584
  ds_read_b128 v[8:11], v6
  s_waitcnt lgkmcnt(0)
  v_or_b32 v8, v8, v9
  v_or_b32 v10, v10, v11
  v_or_b32 v8, v8, v10
  s_nop 0
  v_readfirstlane_b32 s42, v8
  s_cmp_eq_u32 s42, 0
  s_cbranch_scc1 kb1_fin
  s_mov_b32 s40, 1
  v_and_b32 v5, 0xffff0000, v198
  v_cndmask_b32 v198, v198, v5, s[34:35]
  v_mov_b32 v12, 0xff7fffff
  v_and_b32 v5, 0xffff0000, v206
  v_cndmask_b32 v206, v206, v5, s[34:35]
  v_mov_b32 v13, 0xff7fffff
  s_mov_b32 s41, 0
kb1_mx:
  s_lshl_b32 s30, s41, 11
  s_add_u32 s30, s30, s27
  buffer_load_dwordx4 v[32:35], v2, s[8:11], s30 offen sc1
  buffer_load_dwordx4 v[36:39], v2, s[8:11], s30 offen offset:1024 sc1
  s_waitcnt vmcnt(0)
  v_mfma_f32_32x32x16_bf16 v[64:79], v[32:35], v[192:195], 0
  v_mfma_f32_32x32x16_bf16 v[64:79], v[36:39], v[196:199], v[64:79]
  v_mfma_f32_32x32x16_bf16 v[80:95], v[32:35], v[200:203], 0
  v_mfma_f32_32x32x16_bf16 v[80:95], v[36:39], v[204:207], v[80:95]
  s_nop 11
  v_max3_f32 v12, v12, v64, v65
  v_max3_f32 v12, v12, v66, v67
  v_max3_f32 v12, v12, v68, v69
  v_max3_f32 v12, v12, v70, v71
  v_max3_f32 v12, v12, v72, v73
  v_max3_f32 v12, v12, v74, v75
  v_max3_f32 v12, v12, v76, v77
  v_max3_f32 v12, v12, v78, v79
  v_max3_f32 v13, v13, v80, v81
  v_max3_f32 v13, v13, v82, v83
  v_max3_f32 v13, v13, v84, v85
  v_max3_f32 v13, v13, v86, v87
  v_max3_f32 v13, v13, v88, v89
  v_max3_f32 v13, v13, v90, v91
  v_max3_f32 v13, v13, v92, v93
  v_max3_f32 v13, v13, v94, v95
  s_add_u32 s41, s41, 1
  s_cmp_lt_u32 s41, 64
  s_cbranch_scc1 kb1_mx
  v_mov_b32 v5, v12
  s_nop 1
  v_permlane32_swap_b32 v12, v5
  v_max_f32 v12, v12, v5
  v_cvt_pk_bf16_f32 v5, v12, v12
  v_and_b32 v5, 0xffff, v5
  v_xor_b32 v5, 0x8000, v5
  v_and_b32 v6, 0xffff0000, v198
  v_or_b32 v5, v5, v6
  v_cndmask_b32 v198, v198, v5, s[34:35]
  v_mov_b32 v5, v13
  s_nop 1
  v_permlane32_swap_b32 v13, v5
  v_max_f32 v13, v13, v5
  v_cvt_pk_bf16_f32 v5, v13, v13
  v_and_b32 v5, 0xffff, v5
  v_xor_b32 v5, 0x8000, v5
  v_and_b32 v6, 0xffff0000, v206
  v_or_b32 v5, v5, v6
  v_cndmask_b32 v206, v206, v5, s[34:35]
  s_barrier
  s_mov_b32 s41, 0
  s_mul_i32 s53, s41, 32768
  s_lshl_b32 s31, s21, 13
  s_add_u32 s53, s53, s31
  s_add_u32 m0, s31, 0
  s_add_u32 s29, s53, s27
  s_add_u32 s29, s29, 0
  buffer_load_dwordx4 v2, s[8:11], s29 offen sc1 lds
  s_add_u32 m0, s31, 1024
  s_add_u32 s29, s53, s27
  s_add_u32 s29, s29, 1024
  buffer_load_dwordx4 v2, s[8:11], s29 offen sc1 lds
  s_add_u32 m0, s31, 2048
  s_add_u32 s29, s53, s27
  s_add_u32 s29, s29, 2048
  buffer_load_dwordx4 v2, s[8:11], s29 offen sc1 lds
  s_add_u32 m0, s31, 3072
  s_add_u32 s29, s53, s27
  s_add_u32 s29, s29, 3072
  buffer_load_dwordx4 v2, s[8:11], s29 offen sc1 lds
  s_add_u32 m0, s31, 4096
  s_add_u32 s29, s53, s27
  s_add_u32 s29, s29, 4096
  buffer_load_dwordx4 v2, s[8:11], s29 offen sc1 lds
  s_add_u32 m0, s31, 5120
  s_add_u32 s29, s53, s27
  s_add_u32 s29, s29, 5120
  buffer_load_dwordx4 v2, s[8:11], s29 offen sc1 lds
  s_add_u32 m0, s31, 6144
  s_add_u32 s29, s53, s27
  s_add_u32 s29, s29, 6144
  buffer_load_dwordx4 v2, s[8:11], s29 offen sc1 lds
  s_add_u32 m0, s31, 7168
  s_add_u32 s29, s53, s27
  s_add_u32 s29, s29, 7168
  buffer_load_dwordx4 v2, s[8:11], s29 offen sc1 lds
  s_add_u32 m0, s31, 32768
  s_add_u32 s29, s53, s28
  s_add_u32 s29, s29, 0
  buffer_load_dwordx4 v2, s[8:11], s29 offen sc1 lds
  s_add_u32 m0, s31, 33792
  s_add_u32 s29, s53, s28
  s_add_u32 s29, s29, 1024
  buffer_load_dwordx4 v2, s[8:11], s29 offen sc1 lds
  s_add_u32 m0, s31, 34816
  s_add_u32 s29, s53, s28
  s_add_u32 s29, s29, 2048
  buffer_load_dwordx4 v2, s[8:11], s29 offen sc1 lds
  s_add_u32 m0, s31, 35840
  s_add_u32 s29, s53, s28
  s_add_u32 s29, s29, 3072
  buffer_load_dwordx4 v2, s[8:11], s29 offen sc1 lds
  s_add_u32 m0, s31, 36864
  s_add_u32 s29, s53, s28
  s_add_u32 s29, s29, 4096
  buffer_load_dwordx4 v2, s[8:11], s29 offen sc1 lds
  s_add_u32 m0, s31, 37888
  s_add_u32 s29, s53, s28
  s_add_u32 s29, s29, 5120
  buffer_load_dwordx4 v2, s[8:11], s29 offen sc1 lds
  s_add_u32 m0, s31, 38912
  s_add_u32 s29, s53, s28
  s_add_u32 s29, s29, 6144
  buffer_load_dwordx4 v2, s[8:11], s29 offen sc1 lds
  s_add_u32 m0, s31, 39936
  s_add_u32 s29, s53, s28
  s_add_u32 s29, s29, 7168
  buffer_load_dwordx4 v2, s[8:11], s29 offen sc1 lds
  s_branch kb1_main2
kb1_fin:
  v_and_b32 v3, 15, v1
  v_bfe_u32 v11, v1, 4, 1
  v_mul_u32_u24 v11, 20480, v11
  v_lshrrev_b32 v4, 5, v1
  s_mul_i32 s30, s22, 20
  v_lshlrev_b32 v5, 2, v4
  v_add_u32 v5, 0, v5
  v_add_u32 v5, s30, v5
  v_lshrrev_b32 v6, 5, v5
  v_lshlrev_b32 v6, 10, v6
  v_bfe_u32 v7, v5, 3, 2
  v_lshlrev_b32 v7, 4, v7
  v_add_u32 v7, v7, v3
  v_lshlrev_b32 v7, 4, v7
  v_add_u32 v6, v6, v7
  v_bfe_u32 v7, v5, 2, 1
  v_lshlrev_b32 v7, 3, v7
  v_add_u32 v6, v6, v7
  v_add_u32 v32, v6, v11
  v_lshlrev_b32 v5, 2, v4
  v_add_u32 v5, 8, v5
  v_add_u32 v5, s30, v5
  v_lshrrev_b32 v6, 5, v5
  v_lshlrev_b32 v6, 10, v6
  v_bfe_u32 v7, v5, 3, 2
  v_lshlrev_b32 v7, 4, v7
  v_add_u32 v7, v7, v3
  v_lshlrev_b32 v7, 4, v7
  v_add_u32 v6, v6, v7
  v_bfe_u32 v7, v5, 2, 1
  v_lshlrev_b32 v7, 3, v7
  v_add_u32 v6, v6, v7
  v_add_u32 v33, v6, v11
  v_lshlrev_b32 v5, 2, v4
  v_add_u32 v5, 16, v5
  v_add_u32 v5, s30, v5
  v_lshrrev_b32 v6, 5, v5
  v_lshlrev_b32 v6, 10, v6
  v_bfe_u32 v7, v5, 3, 2
  v_lshlrev_b32 v7, 4, v7
  v_add_u32 v7, v7, v3
  v_lshlrev_b32 v7, 4, v7
  v_add_u32 v6, v6, v7
  v_bfe_u32 v7, v5, 2, 1
  v_lshlrev_b32 v7, 3, v7
  v_add_u32 v6, v6, v7
  v_add_u32 v34, v6, v11
  v_mov_b32 v5, 0x40000000
  v_cndmask_b32 v34, v5, v34, s[34:35]
  v_rcp_f32 v5, v14
  s_nop 0
  v_mul_f32 v112, v112, v5
  v_mul_f32 v113, v113, v5
  v_mul_f32 v114, v114, v5
  v_mul_f32 v115, v115, v5
  v_mul_f32 v116, v116, v5
  v_mul_f32 v117, v117, v5
  v_mul_f32 v118, v118, v5
  v_mul_f32 v119, v119, v5
  v_mul_f32 v120, v120, v5
  v_mul_f32 v121, v121, v5
  v_mul_f32 v122, v122, v5
  v_mul_f32 v123, v123, v5
  v_cvt_pk_bf16_f32 v40, v112, v113
  v_cvt_pk_bf16_f32 v41, v114, v115
  v_cvt_pk_bf16_f32 v42, v116, v117
  v_cvt_pk_bf16_f32 v43, v118, v119
  v_cvt_pk_bf16_f32 v44, v120, v121
  v_cvt_pk_bf16_f32 v45, v122, v123
  s_add_u32 s31, s52, 0
  s_mul_i32 s31, s31, 40960
  s_add_u32 s31, s31, 0xf200000
  buffer_store_dwordx2 v[40:41], v32, s[8:11], s31 offen sc1
  buffer_store_dwordx2 v[42:43], v33, s[8:11], s31 offen sc1
  buffer_store_dwordx2 v[44:45], v34, s[8:11], s31 offen sc1
  v_rcp_f32 v5, v15
  s_nop 0
  v_mul_f32 v128, v128, v5
  v_mul_f32 v129, v129, v5
  v_mul_f32 v130, v130, v5
  v_mul_f32 v131, v131, v5
  v_mul_f32 v132, v132, v5
  v_mul_f32 v133, v133, v5
  v_mul_f32 v134, v134, v5
  v_mul_f32 v135, v135, v5
  v_mul_f32 v136, v136, v5
  v_mul_f32 v137, v137, v5
  v_mul_f32 v138, v138, v5
  v_mul_f32 v139, v139, v5
  v_cvt_pk_bf16_f32 v48, v128, v129
  v_cvt_pk_bf16_f32 v49, v130, v131
  v_cvt_pk_bf16_f32 v50, v132, v133
  v_cvt_pk_bf16_f32 v51, v134, v135
  v_cvt_pk_bf16_f32 v52, v136, v137
  v_cvt_pk_bf16_f32 v53, v138, v139
  s_add_u32 s31, s52, 1
  s_mul_i32 s31, s31, 40960
  s_add_u32 s31, s31, 0xf200000
  buffer_store_dwordx2 v[48:49], v32, s[8:11], s31 offen sc1
  buffer_store_dwordx2 v[50:51], v33, s[8:11], s31 offen sc1
  buffer_store_dwordx2 v[52:53], v34, s[8:11], s31 offen sc1
  s_waitcnt vmcnt(0)
  s_barrier
  s_cmp_eq_u32 s21, 0
  s_cbranch_scc0 arr_45
  s_mov_b64 s[24:25], exec
  s_mov_b64 exec, 1
  v_mov_b32 v3, 0
  v_mov_b32 v4, 1
  buffer_atomic_add v4, v3, s[8:11], s48 offen
  s_mov_b64 exec, s[24:25]
arr_45:
  v_and_b32 v5, 15, v1
  v_lshrrev_b32 v6, 4, v1
  v_and_b32 v7, 1, v6
  v_lshlrev_b32 v7, 10, v7
  v_lshrrev_b32 v8, 1, v6
  v_lshlrev_b32 v8, 5, v8
  v_add_u32 v8, v8, v5
  v_lshlrev_b32 v8, 4, v8
  v_add_u32 v9, v7, v8
  s_lshr_b32 s26, s2, 2
  s_mul_i32 s27, s26, 81920
  s_lshl_b32 s28, s50, 11
  s_add_u32 s27, s27, s28
  s_add_u32 s27, s27, 0x1400000
  s_add_u32 s28, s27, 0
  buffer_load_dwordx4 v[16:19], v9, s[8:11], s28 offen sc1
  s_add_u32 s28, s27, 256
  buffer_load_dwordx4 v[20:23], v9, s[8:11], s28 offen sc1
  s_add_u32 s28, s27, 2048
  buffer_load_dwordx4 v[24:27], v9, s[8:11], s28 offen sc1
  s_add_u32 s28, s27, 2304
  buffer_load_dwordx4 v[28:31], v9, s[8:11], s28 offen sc1
  s_cmp_lt_u32 s21, 2
  s_cbranch_scc0 g3_46
  s_add_u32 s28, s27, 4096
  buffer_load_dwordx4 v[32:35], v9, s[8:11], s28 offen sc1
  s_add_u32 s28, s27, 4352
  buffer_load_dwordx4 v[36:39], v9, s[8:11], s28 offen sc1
g3_46:
  s_mov_b32 s45, 0
  v_mov_b32 v3, 0
aw_47:
  buffer_load_dword v4, v3, s[8:11], s48 offen sc1
  s_add_u32 s45, s45, 1
  s_waitcnt vmcnt(0)
  v_readfirstlane_b32 s29, v4
  s_cmp_ge_u32 s29, 32
  s_cbranch_scc1 aw_47_ok
  s_cmp_lt_u32 s45, 400000
  s_cbranch_scc1 aw_47
  s_branch kb1_abort
aw_47_ok:
  s_mul_i32 s28, s26, 40960
  s_mul_i32 s31, s21, 10240
  s_add_u32 s28, s28, s31
  s_add_u32 s28, s28, 0xf200000
  s_add_u32 m0, s31, 0
  s_add_u32 s29, s28, 0
  buffer_load_dwordx4 v2, s[8:11], s29 offen sc1 lds
  s_add_u32 m0, s31, 1024
  s_add_u32 s29, s28, 1024
  buffer_load_dwordx4 v2, s[8:11], s29 offen sc1 lds
  s_add_u32 m0, s31, 2048
  s_add_u32 s29, s28, 2048
  buffer_load_dwordx4 v2, s[8:11], s29 offen sc1 lds
  s_add_u32 m0, s31, 3072
  s_add_u32 s29, s28, 3072
  buffer_load_dwordx4 v2, s[8:11], s29 offen sc1 lds
  s_add_u32 m0, s31, 4096
  s_add_u32 s29, s28, 4096
  buffer_load_dwordx4 v2, s[8:11], s29 offen sc1 lds
  s_add_u32 m0, s31, 5120
  s_add_u32 s29, s28, 5120
  buffer_load_dwordx4 v2, s[8:11], s29 offen sc1 lds
  s_add_u32 m0, s31, 6144
  s_add_u32 s29, s28, 6144
  buffer_load_dwordx4 v2, s[8:11], s29 offen sc1 lds
  s_add_u32 m0, s31, 7168
  s_add_u32 s29, s28, 7168
  buffer_load_dwordx4 v2, s[8:11], s29 offen sc1 lds
  s_add_u32 m0, s31, 8192
  s_add_u32 s29, s28, 8192
  buffer_load_dwordx4 v2, s[8:11], s29 offen sc1 lds
  s_add_u32 m0, s31, 9216
  s_add_u32 s29, s28, 9216
  buffer_load_dwordx4 v2, s[8:11], s29 offen sc1 lds
  s_waitcnt vmcnt(0)
  s_barrier
  ds_read_b128 v[80:83], v2 offset:0
  ds_read_b128 v[84:87], v2 offset:20480
  ds_read_b128 v[88:91], v2 offset:1024
  ds_read_b128 v[92:95], v2 offset:21504
  ds_read_b128 v[96:99], v2 offset:2048
  ds_read_b128 v[100:103], v2 offset:22528
  s_waitcnt lgkmcnt(4)
  v_mfma_f32_16x16x32_bf16 v[48:51], a[0:3], v[80:83], 0
  v_mfma_f32_16x16x32_bf16 v[52:55], a[0:3], v[84:87], 0
  v_mfma_f32_16x16x32_bf16 v[56:59], a[80:83], v[80:83], 0
  v_mfma_f32_16x16x32_bf16 v[60:63], a[80:83], v[84:87], 0
  v_mfma_f32_16x16x32_bf16 v[64:67], a[160:163], v[80:83], 0
  v_mfma_f32_16x16x32_bf16 v[68:71], a[160:163], v[84:87], 0
  ds_read_b128 v[80:83], v2 offset:3072
  ds_read_b128 v[84:87], v2 offset:23552
  s_waitcnt lgkmcnt(4)
  v_mfma_f32_16x16x32_bf16 v[48:51], a[4:7], v[88:91], v[48:51]
  v_mfma_f32_16x16x32_bf16 v[52:55], a[4:7], v[92:95], v[52:55]
  v_mfma_f32_16x16x32_bf16 v[56:59], a[84:87], v[88:91], v[56:59]
  v_mfma_f32_16x16x32_bf16 v[60:63], a[84:87], v[92:95], v[60:63]
  v_mfma_f32_16x16x32_bf16 v[64:67], a[164:167], v[88:91], v[64:67]
  v_mfma_f32_16x16x32_bf16 v[68:71], a[164:167], v[92:95], v[68:71]
  ds_read_b128 v[88:91], v2 offset:4096
  ds_read_b128 v[92:95], v2 offset:24576
  s_waitcnt lgkmcnt(4)
  v_mfma_f32_16x16x32_bf16 v[48:51], a[8:11], v[96:99], v[48:51]
  v_mfma_f32_16x16x32_bf16 v[52:55], a[8:11], v[100:103], v[52:55]
  v_mfma_f32_16x16x32_bf16 v[56:59], a[88:91], v[96:99], v[56:59]
  v_mfma_f32_16x16x32_bf16 v[60:63], a[88:91], v[100:103], v[60:63]
  v_mfma_f32_16x16x32_bf16 v[64:67], a[168:171], v[96:99], v[64:67]
  v_mfma_f32_16x16x32_bf16 v[68:71], a[168:171], v[100:103], v[68:71]
  ds_read_b128 v[96:99], v2 offset:5120
  ds_read_b128 v[100:103], v2 offset:25600
  s_waitcnt lgkmcnt(4)
  v_mfma_f32_16x16x32_bf16 v[48:51], a[12:15], v[80:83], v[48:51]
  v_mfma_f32_16x16x32_bf16 v[52:55], a[12:15], v[84:87], v[52:55]
  v_mfma_f32_16x16x32_bf16 v[56:59], a[92:95], v[80:83], v[56:59]
  v_mfma_f32_16x16x32_bf16 v[60:63], a[92:95], v[84:87], v[60:63]
  v_mfma_f32_16x16x32_bf16 v[64:67], a[172:175], v[80:83], v[64:67]
  v_mfma_f32_16x16x32_bf16 v[68:71], a[172:175], v[84:87], v[68:71]
  ds_read_b128 v[80:83], v2 offset:6144
  ds_read_b128 v[84:87], v2 offset:26624
  s_waitcnt lgkmcnt(4)
  v_mfma_f32_16x16x32_bf16 v[48:51], a[16:19], v[88:91], v[48:51]
  v_mfma_f32_16x16x32_bf16 v[52:55], a[16:19], v[92:95], v[52:55]
  v_mfma_f32_16x16x32_bf16 v[56:59], a[96:99], v[88:91], v[56:59]
  v_mfma_f32_16x16x32_bf16 v[60:63], a[96:99], v[92:95], v[60:63]
  v_mfma_f32_16x16x32_bf16 v[64:67], a[176:179], v[88:91], v[64:67]
  v_mfma_f32_16x16x32_bf16 v[68:71], a[176:179], v[92:95], v[68:71]
  ds_read_b128 v[88:91], v2 offset:7168
  ds_read_b128 v[92:95], v2 offset:27648
  s_waitcnt lgkmcnt(4)
  v_mfma_f32_16x16x32_bf16 v[48:51], a[20:23], v[96:99], v[48:51]
  v_mfma_f32_16x16x32_bf16 v[52:55], a[20:23], v[100:103], v[52:55]
  v_mfma_f32_16x16x32_bf16 v[56:59], a[100:103], v[96:99], v[56:59]
  v_mfma_f32_16x16x32_bf16 v[60:63], a[100:103], v[100:103], v[60:63]
  v_mfma_f32_16x16x32_bf16 v[64:67], a[180:183], v[96:99], v[64:67]
  v_mfma_f32_16x16x32_bf16 v[68:71], a[180:183], v[100:103], v[68:71]
  ds_read_b128 v[96:99], v2 offset:8192
  ds_read_b128 v[100:103], v2 offset:28672
  s_waitcnt lgkmcnt(4)
  v_mfma_f32_16x16x32_bf16 v[48:51], a[24:27], v[80:83], v[48:51]
  v_mfma_f32_16x16x32_bf16 v[52:55], a[24:27], v[84:87], v[52:55]
  v_mfma_f32_16x16x32_bf16 v[56:59], a[104:107], v[80:83], v[56:59]
  v_mfma_f32_16x16x32_bf16 v[60:63], a[104:107], v[84:87], v[60:63]
  v_mfma_f32_16x16x32_bf16 v[64:67], a[184:187], v[80:83], v[64:67]
  v_mfma_f32_16x16x32_bf16 v[68:71], a[184:187], v[84:87], v[68:71]
  ds_read_b128 v[80:83], v2 offset:9216
  ds_read_b128 v[84:87], v2 offset:29696
  s_waitcnt lgkmcnt(4)
  v_mfma_f32_16x16x32_bf16 v[48:51], a[28:31], v[88:91], v[48:51]
  v_mfma_f32_16x16x32_bf16 v[52:55], a[28:31], v[92:95], v[52:55]
  v_mfma_f32_16x16x32_bf16 v[56:59], a[108:111], v[88:91], v[56:59]
  v_mfma_f32_16x16x32_bf16 v[60:63], a[108:111], v[92:95], v[60:63]
  v_mfma_f32_16x16x32_bf16 v[64:67], a[188:191], v[88:91], v[64:67]
  v_mfma_f32_16x16x32_bf16 v[68:71], a[188:191], v[92:95], v[68:71]
  ds_read_b128 v[88:91], v2 offset:10240
  ds_read_b128 v[92:95], v2 offset:30720
  s_waitcnt lgkmcnt(4)
  v_mfma_f32_16x16x32_bf16 v[48:51], a[32:35], v[96:99], v[48:51]
  v_mfma_f32_16x16x32_bf16 v[52:55], a[32:35], v[100:103], v[52:55]
  v_mfma_f32_16x16x32_bf16 v[56:59], a[112:115], v[96:99], v[56:59]
  v_mfma_f32_16x16x32_bf16 v[60:63], a[112:115], v[100:103], v[60:63]
  v_mfma_f32_16x16x32_bf16 v[64:67], a[192:195], v[96:99], v[64:67]
  v_mfma_f32_16x16x32_bf16 v[68:71], a[192:195], v[100:103], v[68:71]
  ds_read_b128 v[96:99], v2 offset:11264
  ds_read_b128 v[100:103], v2 offset:31744
  s_waitcnt lgkmcnt(4)
  v_mfma_f32_16x16x32_bf16 v[48:51], a[36:39], v[80:83], v[48:51]
  v_mfma_f32_16x16x32_bf16 v[52:55], a[36:39], v[84:87], v[52:55]
  v_mfma_f32_16x16x32_bf16 v[56:59], a[116:119], v[80:83], v[56:59]
  v_mfma_f32_16x16x32_bf16 v[60:63], a[116:119], v[84:87], v[60:63]
  v_mfma_f32_16x16x32_bf16 v[64:67], a[196:199], v[80:83], v[64:67]
  v_mfma_f32_16x16x32_bf16 v[68:71], a[196:199], v[84:87], v[68:71]
  ds_read_b128 v[80:83], v2 offset:12288
  ds_read_b128 v[84:87], v2 offset:32768
  s_waitcnt lgkmcnt(4)
  v_mfma_f32_16x16x32_bf16 v[48:51], a[40:43], v[88:91], v[48:51]
  v_mfma_f32_16x16x32_bf16 v[52:55], a[40:43], v[92:95], v[52:55]
  v_mfma_f32_16x16x32_bf16 v[56:59], a[120:123], v[88:91], v[56:59]
  v_mfma_f32_16x16x32_bf16 v[60:63], a[120:123], v[92:95], v[60:63]
  v_mfma_f32_16x16x32_bf16 v[64:67], a[200:203], v[88:91], v[64:67]
  v_mfma_f32_16x16x32_bf16 v[68:71], a[200:203], v[92:95], v[68:71]
  ds_read_b128 v[88:91], v2 offset:13312
  ds_read_b128 v[92:95], v2 offset:33792
  s_waitcnt lgkmcnt(4)
  v_mfma_f32_16x16x32_bf16 v[48:51], a[44:47], v[96:99], v[48:51]
  v_mfma_f32_16x16x32_bf16 v[52:55], a[44:47], v[100:103], v[52:55]
  v_mfma_f32_16x16x32_bf16 v[56:59], a[124:127], v[96:99], v[56:59]
  v_mfma_f32_16x16x32_bf16 v[60:63], a[124:127], v[100:103], v[60:63]
  v_mfma_f32_16x16x32_bf16 v[64:67], a[204:207], v[96:99], v[64:67]
  v_mfma_f32_16x16x32_bf16 v[68:71], a[204:207], v[100:103], v[68:71]
  ds_read_b128 v[96:99], v2 offset:14336
  ds_read_b128 v[100:103], v2 offset:34816
  s_waitcnt lgkmcnt(4)
  v_mfma_f32_16x16x32_bf16 v[48:51], a[48:51], v[80:83], v[48:51]
  v_mfma_f32_16x16x32_bf16 v[52:55], a[48:51], v[84:87], v[52:55]
  v_mfma_f32_16x16x32_bf16 v[56:59], a[128:131], v[80:83], v[56:59]
  v_mfma_f32_16x16x32_bf16 v[60:63], a[128:131], v[84:87], v[60:63]
  v_mfma_f32_16x16x32_bf16 v[64:67], a[208:211], v[80:83], v[64:67]
  v_mfma_f32_16x16x32_bf16 v[68:71], a[208:211], v[84:87], v[68:71]
  ds_read_b128 v[80:83], v2 offset:15360
  ds_read_b128 v[84:87], v2 offset:35840
  s_waitcnt lgkmcnt(4)
  v_mfma_f32_16x16x32_bf16 v[48:51], a[52:55], v[88:91], v[48:51]
  v_mfma_f32_16x16x32_bf16 v[52:55], a[52:55], v[92:95], v[52:55]
  v_mfma_f32_16x16x32_bf16 v[56:59], a[132:135], v[88:91], v[56:59]
  v_mfma_f32_16x16x32_bf16 v[60:63], a[132:135], v[92:95], v[60:63]
  v_mfma_f32_16x16x32_bf16 v[64:67], a[212:215], v[88:91], v[64:67]
  v_mfma_f32_16x16x32_bf16 v[68:71], a[212:215], v[92:95], v[68:71]
  ds_read_b128 v[88:91], v2 offset:16384
  ds_read_b128 v[92:95], v2 offset:36864
  s_waitcnt lgkmcnt(4)
  v_mfma_f32_16x16x32_bf16 v[48:51], a[56:59], v[96:99], v[48:51]
  v_mfma_f32_16x16x32_bf16 v[52:55], a[56:59], v[100:103], v[52:55]
  v_mfma_f32_16x16x32_bf16 v[56:59], a[136:139], v[96:99], v[56:59]
  v_mfma_f32_16x16x32_bf16 v[60:63], a[136:139], v[100:103], v[60:63]
  v_mfma_f32_16x16x32_bf16 v[64:67], a[216:219], v[96:99], v[64:67]
  v_mfma_f32_16x16x32_bf16 v[68:71], a[216:219], v[100:103], v[68:71]
  ds_read_b128 v[96:99], v2 offset:17408
  ds_read_b128 v[100:103], v2 offset:37888
  s_waitcnt lgkmcnt(4)
  v_mfma_f32_16x16x32_bf16 v[48:51], a[60:63], v[80:83], v[48:51]
  v_mfma_f32_16x16x32_bf16 v[52:55], a[60:63], v[84:87], v[52:55]
  v_mfma_f32_16x16x32_bf16 v[56:59], a[140:143], v[80:83], v[56:59]
  v_mfma_f32_16x16x32_bf16 v[60:63], a[140:143], v[84:87], v[60:63]
  v_mfma_f32_16x16x32_bf16 v[64:67], a[220:223], v[80:83], v[64:67]
  v_mfma_f32_16x16x32_bf16 v[68:71], a[220:223], v[84:87], v[68:71]
  ds_read_b128 v[80:83], v2 offset:18432
  ds_read_b128 v[84:87], v2 offset:38912
  s_waitcnt lgkmcnt(4)
  v_mfma_f32_16x16x32_bf16 v[48:51], a[64:67], v[88:91], v[48:51]
  v_mfma_f32_16x16x32_bf16 v[52:55], a[64:67], v[92:95], v[52:55]
  v_mfma_f32_16x16x32_bf16 v[56:59], a[144:147], v[88:91], v[56:59]
  v_mfma_f32_16x16x32_bf16 v[60:63], a[144:147], v[92:95], v[60:63]
  v_mfma_f32_16x16x32_bf16 v[64:67], a[224:227], v[88:91], v[64:67]
  v_mfma_f32_16x16x32_bf16 v[68:71], a[224:227], v[92:95], v[68:71]
  ds_read_b128 v[88:91], v2 offset:19456
  ds_read_b128 v[92:95], v2 offset:39936
  s_waitcnt lgkmcnt(4)
  v_mfma_f32_16x16x32_bf16 v[48:51], a[68:71], v[96:99], v[48:51]
  v_mfma_f32_16x16x32_bf16 v[52:55], a[68:71], v[100:103], v[52:55]
  v_mfma_f32_16x16x32_bf16 v[56:59], a[148:151], v[96:99], v[56:59]
  v_mfma_f32_16x16x32_bf16 v[60:63], a[148:151], v[100:103], v[60:63]
  v_mfma_f32_16x16x32_bf16 v[64:67], a[228:231], v[96:99], v[64:67]
  v_mfma_f32_16x16x32_bf16 v[68:71], a[228:231], v[100:103], v[68:71]
  s_waitcnt lgkmcnt(2)
  v_mfma_f32_16x16x32_bf16 v[48:51], a[72:75], v[80:83], v[48:51]
  v_mfma_f32_16x16x32_bf16 v[52:55], a[72:75], v[84:87], v[52:55]
  v_mfma_f32_16x16x32_bf16 v[56:59], a[152:155], v[80:83], v[56:59]
  v_mfma_f32_16x16x32_bf16 v[60:63], a[152:155], v[84:87], v[60:63]
  v_mfma_f32_16x16x32_bf16 v[64:67], a[232:235], v[80:83], v[64:67]
  v_mfma_f32_16x16x32_bf16 v[68:71], a[232:235], v[84:87], v[68:71]
  s_waitcnt lgkmcnt(0)
  v_mfma_f32_16x16x32_bf16 v[48:51], a[76:79], v[88:91], v[48:51]
  v_mfma_f32_16x16x32_bf16 v[52:55], a[76:79], v[92:95], v[52:55]
  v_mfma_f32_16x16x32_bf16 v[56:59], a[156:159], v[88:91], v[56:59]
  v_mfma_f32_16x16x32_bf16 v[60:63], a[156:159], v[92:95], v[60:63]
  v_mfma_f32_16x16x32_bf16 v[64:67], a[236:239], v[88:91], v[64:67]
  v_mfma_f32_16x16x32_bf16 v[68:71], a[236:239], v[92:95], v[68:71]
  s_nop 7
  v_add_f32 v48, v48, v16
  v_add_f32 v49, v49, v17
  v_add_f32 v50, v50, v18
  v_add_f32 v51, v51, v19
  s_add_u32 s28, s27, 0
  buffer_store_dwordx4 v[48:51], v9, s[8:11], s28 offen
  v_add_f32 v52, v52, v20
  v_add_f32 v53, v53, v21
  v_add_f32 v54, v54, v22
  v_add_f32 v55, v55, v23
  s_add_u32 s28, s27, 256
  buffer_store_dwordx4 v[52:55], v9, s[8:11], s28 offen
  v_add_f32 v56, v56, v24
  v_add_f32 v57, v57, v25
  v_add_f32 v58, v58, v26
  v_add_f32 v59, v59, v27
  s_add_u32 s28, s27, 2048
  buffer_store_dwordx4 v[56:59], v9, s[8:11], s28 offen
  v_add_f32 v60, v60, v28
  v_add_f32 v61, v61, v29
  v_add_f32 v62, v62, v30
  v_add_f32 v63, v63, v31
  s_add_u32 s28, s27, 2304
  buffer_store_dwordx4 v[60:63], v9, s[8:11], s28 offen
  s_cmp_lt_u32 s21, 2
  s_cbranch_scc0 g3_48
  v_add_f32 v64, v64, v32
  v_add_f32 v65, v65, v33
  v_add_f32 v66, v66, v34
  v_add_f32 v67, v67, v35
  s_add_u32 s28, s27, 4096
  buffer_store_dwordx4 v[64:67], v9, s[8:11], s28 offen
  v_add_f32 v68, v68, v36
  v_add_f32 v69, v69, v37
  v_add_f32 v70, v70, v38
  v_add_f32 v71, v71, v39
  s_add_u32 s28, s27, 4352
  buffer_store_dwordx4 v[68:71], v9, s[8:11], s28 offen
g3_48:
  s_endpgm
kb1_abort:
  s_load_dwordx2 s[6:7], s[0:1], 88
  v_mov_b32 v2, 80
  v_mov_b32 v3, 1
  s_waitcnt lgkmcnt(0)
  s_mov_b64 exec, 1
  global_atomic_add v2, v3, s[6:7]
  s_waitcnt vmcnt(0)
kb1_exit:
  s_endpgm

.section .rodata,"a"
.p2align 6
.amdhsa_kernel kb1_kernel
  .amdhsa_next_free_vgpr 512
  .amdhsa_next_free_sgpr 102
  .amdhsa_accum_offset 256
  .amdhsa_group_segment_fixed_size 0
  .amdhsa_kernarg_size 104
  .amdhsa_user_sgpr_count 2
  .amdhsa_user_sgpr_kernarg_segment_ptr 1
  .amdhsa_system_sgpr_workgroup_id_x 1
.end_amdhsa_kernel
.text
.globl ka2_kernel
.p2align 8
.type ka2_kernel,@function
ka2_kernel:
  s_mov_b32 s99, 1
ka_body:
  s_cmp_ge_u32 s2, 256
  s_cbranch_scc1 ka_exit

  s_load_dwordx2 s[4:5], s[0:1], 96
  s_load_dwordx2 s[6:7], s[0:1], 88
  s_load_dwordx4 s[36:39], s[0:1], 16
  s_load_dwordx4 s[40:43], s[0:1], 32
  s_getreg_b32 s26, hwreg(HW_REG_XCC_ID)
  s_and_b32 s26, s26, 15
  v_lshrrev_b32 v1, 6, v0
  s_nop 0
  v_readfirstlane_b32 s21, v1
  s_waitcnt lgkmcnt(0)
  s_mov_b32 s8, s4
  s_and_b32 s9, s5, 0xffff
  s_mov_b32 s10, 0x10000000
  s_mov_b32 s11, 0x20000
  s_cmp_eq_u32 s21, 3
  s_cbranch_scc0 lnu_49_x
  v_and_b32 v1, 63, v0
  v_and_b32 v5, 7, v1
  v_bfe_u32 v6, v1, 3, 1
  v_lshrrev_b32 v7, 4, v1
  v_lshlrev_b32 v8, 5, v6
  v_add_u32 v8, v8, v5
  v_lshlrev_b32 v8, 4, v8
  v_lshlrev_b32 v10, 10, v7
  v_add_u32 v10, v10, v8
  s_lshr_b32 s46, s2, 2
  s_and_b32 s47, s2, 3
  s_lshl_b32 s47, s47, 7
  s_cmp_eq_u32 s99, 1
  s_cbranch_scc0 lnu_49_b
  v_lshlrev_b32 v9, 11, v7
  v_add_u32 v9, v9, v8
  s_mul_i32 s48, s46, 81920
  s_add_u32 s48, s48, s47
  s_add_u32 s48, s48, 0x1400000
  s_add_u32 s49, s48, 0
  buffer_load_dwordx4 v[16:19], v9, s[8:11], s49 offen
  s_add_u32 s49, s48, 1024
  buffer_load_dwordx4 v[20:23], v9, s[8:11], s49 offen
  s_add_u32 s49, s48, 8192
  buffer_load_dwordx4 v[24:27], v9, s[8:11], s49 offen
  s_add_u32 s49, s48, 9216
  buffer_load_dwordx4 v[28:31], v9, s[8:11], s49 offen
  s_add_u32 s49, s48, 16384
  buffer_load_dwordx4 v[32:35], v9, s[8:11], s49 offen
  s_add_u32 s49, s48, 17408
  buffer_load_dwordx4 v[36:39], v9, s[8:11], s49 offen
  s_add_u32 s49, s48, 24576
  buffer_load_dwordx4 v[40:43], v9, s[8:11], s49 offen
  s_add_u32 s49, s48, 25600
  buffer_load_dwordx4 v[44:47], v9, s[8:11], s49 offen
  s_add_u32 s49, s48, 32768
  buffer_load_dwordx4 v[48:51], v9, s[8:11], s49 offen
  s_add_u32 s49, s48, 33792
  buffer_load_dwordx4 v[52:55], v9, s[8:11], s49 offen
  s_add_u32 s49, s48, 40960
  buffer_load_dwordx4 v[56:59], v9, s[8:11], s49 offen
  s_add_u32 s49, s48, 41984
  buffer_load_dwordx4 v[60:63], v9, s[8:11], s49 offen
  s_add_u32 s49, s48, 49152
  buffer_load_dwordx4 v[64:67], v9, s[8:11], s49 offen
  s_add_u32 s49, s48, 50176
  buffer_load_dwordx4 v[68:71], v9, s[8:11], s49 offen
  s_add_u32 s49, s48, 57344
  buffer_load_dwordx4 v[72:75], v9, s[8:11], s49 offen
  s_add_u32 s49, s48, 58368
  buffer_load_dwordx4 v[76:79], v9, s[8:11], s49 offen
  s_add_u32 s49, s48, 65536
  buffer_load_dwordx4 v[80:83], v9, s[8:11], s49 offen
  s_add_u32 s49, s48, 66560
  buffer_load_dwordx4 v[84:87], v9, s[8:11], s49 offen
  s_add_u32 s49, s48, 73728
  buffer_load_dwordx4 v[88:91], v9, s[8:11], s49 offen
  s_add_u32 s49, s48, 74752
  buffer_load_dwordx4 v[92:95], v9, s[8:11], s49 offen
  s_waitcnt vmcnt(0)
  s_branch lnu_49_f
lnu_49_b:
  s_load_dwordx2 s[48:49], s[0:1], 0
  v_mul_u32_u24 v11, 1280, v5
  v_lshlrev_b32 v12, 5, v7
  v_add_u32 v11, v11, v12
  v_lshlrev_b32 v12, 4, v6
  v_add_u32 v11, v11, v12
  s_waitcnt lgkmcnt(0)
  s_mov_b32 s12, s48
  s_and_b32 s13, s49, 0xffff
  s_mov_b32 s14, 0x280000
  s_mov_b32 s15, 0x20000
  s_mul_i32 s49, s2, 10240
  buffer_load_dwordx4 v[56:59], v11, s[12:15], s49 offen offset:0
  buffer_load_dwordx4 v[60:63], v11, s[12:15], s49 offen offset:128
  buffer_load_dwordx4 v[64:67], v11, s[12:15], s49 offen offset:256
  buffer_load_dwordx4 v[68:71], v11, s[12:15], s49 offen offset:384
  buffer_load_dwordx4 v[72:75], v11, s[12:15], s49 offen offset:512
  buffer_load_dwordx4 v[76:79], v11, s[12:15], s49 offen offset:640
  buffer_load_dwordx4 v[80:83], v11, s[12:15], s49 offen offset:768
  buffer_load_dwordx4 v[84:87], v11, s[12:15], s49 offen offset:896
  buffer_load_dwordx4 v[88:91], v11, s[12:15], s49 offen offset:1024
  buffer_load_dwordx4 v[92:95], v11, s[12:15], s49 offen offset:1152
  s_waitcnt vmcnt(0)
  v_mov_b32 v4, v56
  v_lshlrev_b32 v16, 16, v4
  v_and_b32 v17, 0xffff0000, v4
  v_mov_b32 v4, v57
  v_lshlrev_b32 v18, 16, v4
  v_and_b32 v19, 0xffff0000, v4
  v_mov_b32 v4, v58
  v_lshlrev_b32 v20, 16, v4
  v_and_b32 v21, 0xffff0000, v4
  v_mov_b32 v4, v59
  v_lshlrev_b32 v22, 16, v4
  v_and_b32 v23, 0xffff0000, v4
  v_mov_b32 v4, v60
  v_lshlrev_b32 v24, 16, v4
  v_and_b32 v25, 0xffff0000, v4
  v_mov_b32 v4, v61
  v_lshlrev_b32 v26, 16, v4
  v_and_b32 v27, 0xffff0000, v4
  v_mov_b32 v4, v62
  v_lshlrev_b32 v28, 16, v4
  v_and_b32 v29, 0xffff0000, v4
  v_mov_b32 v4, v63
  v_lshlrev_b32 v30, 16, v4
  v_and_b32 v31, 0xffff0000, v4
  v_mov_b32 v4, v64
  v_lshlrev_b32 v32, 16, v4
  v_and_b32 v33, 0xffff0000, v4
  v_mov_b32 v4, v65
  v_lshlrev_b32 v34, 16, v4
  v_and_b32 v35, 0xffff0000, v4
  v_mov_b32 v4, v66
  v_lshlrev_b32 v36, 16, v4
  v_and_b32 v37, 0xffff0000, v4
  v_mov_b32 v4, v67
  v_lshlrev_b32 v38, 16, v4
  v_and_b32 v39, 0xffff0000, v4
  v_mov_b32 v4, v68
  v_lshlrev_b32 v40, 16, v4
  v_and_b32 v41, 0xffff0000, v4
  v_mov_b32 v4, v69
  v_lshlrev_b32 v42, 16, v4
  v_and_b32 v43, 0xffff0000, v4
  v_mov_b32 v4, v70
  v_lshlrev_b32 v44, 16, v4
  v_and_b32 v45, 0xffff0000, v4
  v_mov_b32 v4, v71
  v_lshlrev_b32 v46, 16, v4
  v_and_b32 v47, 0xffff0000, v4
  v_mov_b32 v4, v72
  v_lshlrev_b32 v48, 16, v4
  v_and_b32 v49, 0xffff0000, v4
  v_mov_b32 v4, v73
  v_lshlrev_b32 v50, 16, v4
  v_and_b32 v51, 0xffff0000, v4
  v_mov_b32 v4, v74
  v_lshlrev_b32 v52, 16, v4
  v_and_b32 v53, 0xffff0000, v4
  v_mov_b32 v4, v75
  v_lshlrev_b32 v54, 16, v4
  v_and_b32 v55, 0xffff0000, v4
  v_mov_b32 v4, v76
  v_lshlrev_b32 v56, 16, v4
  v_and_b32 v57, 0xffff0000, v4
  v_mov_b32 v4, v77
  v_lshlrev_b32 v58, 16, v4
  v_and_b32 v59, 0xffff0000, v4
  v_mov_b32 v4, v78
  v_lshlrev_b32 v60, 16, v4
  v_and_b32 v61, 0xffff0000, v4
  v_mov_b32 v4, v79
  v_lshlrev_b32 v62, 16, v4
  v_and_b32 v63, 0xffff0000, v4
  v_mov_b32 v4, v80
  v_lshlrev_b32 v64, 16, v4
  v_and_b32 v65, 0xffff0000, v4
  v_mov_b32 v4, v81
  v_lshlrev_b32 v66, 16, v4
  v_and_b32 v67, 0xffff0000, v4
  v_mov_b32 v4, v82
  v_lshlrev_b32 v68, 16, v4
  v_and_b32 v69, 0xffff0000, v4
  v_mov_b32 v4, v83
  v_lshlrev_b32 v70, 16, v4
  v_and_b32 v71, 0xffff0000, v4
  v_mov_b32 v4, v84
  v_lshlrev_b32 v72, 16, v4
  v_and_b32 v73, 0xffff0000, v4
  v_mov_b32 v4, v85
  v_lshlrev_b32 v74, 16, v4
  v_and_b32 v75, 0xffff0000, v4
  v_mov_b32 v4, v86
  v_lshlrev_b32 v76, 16, v4
  v_and_b32 v77, 0xffff0000, v4
  v_mov_b32 v4, v87
  v_lshlrev_b32 v78, 16, v4
  v_and_b32 v79, 0xffff0000, v4
  v_mov_b32 v4, v88
  v_lshlrev_b32 v80, 16, v4
  v_and_b32 v81, 0xffff0000, v4
  v_mov_b32 v4, v89
  v_lshlrev_b32 v82, 16, v4
  v_and_b32 v83, 0xffff0000, v4
  v_mov_b32 v4, v90
  v_lshlrev_b32 v84, 16, v4
  v_and_b32 v85, 0xffff0000, v4
  v_mov_b32 v4, v91
  v_lshlrev_b32 v86, 16, v4
  v_and_b32 v87, 0xffff0000, v4
  v_mov_b32 v4, v92
  v_lshlrev_b32 v88, 16, v4
  v_and_b32 v89, 0xffff0000, v4
  v_mov_b32 v4, v93
  v_lshlrev_b32 v90, 16, v4
  v_and_b32 v91, 0xffff0000, v4
  v_mov_b32 v4, v94
  v_lshlrev_b32 v92, 16, v4
  v_and_b32 v93, 0xffff0000, v4
  v_mov_b32 v4, v95
  v_lshlrev_b32 v94, 16, v4
  v_and_b32 v95, 0xffff0000, v4
lnu_49_f:
  v_pk_add_f32 v[12:13], v[16:17], v[18:19]
  v_pk_add_f32 v[12:13], v[12:13], v[20:21]
  v_pk_add_f32 v[12:13], v[12:13], v[22:23]
  v_pk_add_f32 v[12:13], v[12:13], v[24:25]
  v_pk_add_f32 v[12:13], v[12:13], v[26:27]
  v_pk_add_f32 v[12:13], v[12:13], v[28:29]
  v_pk_add_f32 v[12:13], v[12:13], v[30:31]
  v_pk_add_f32 v[12:13], v[12:13], v[32:33]
  v_pk_add_f32 v[12:13], v[12:13], v[34:35]
  v_pk_add_f32 v[12:13], v[12:13], v[36:37]
  v_pk_add_f32 v[12:13], v[12:13], v[38:39]
  v_pk_add_f32 v[12:13], v[12:13], v[40:41]
  v_pk_add_f32 v[12:13], v[12:13], v[42:43]
  v_pk_add_f32 v[12:13], v[12:13], v[44:45]
  v_pk_add_f32 v[12:13], v[12:13], v[46:47]
  v_pk_add_f32 v[12:13], v[12:13], v[48:49]
  v_pk_add_f32 v[12:13], v[12:13], v[50:51]
  v_pk_add_f32 v[12:13], v[12:13], v[52:53]
  v_pk_add_f32 v[12:13], v[12:13], v[54:55]
  v_pk_add_f32 v[12:13], v[12:13], v[56:57]
  v_pk_add_f32 v[12:13], v[12:13], v[58:59]
  v_pk_add_f32 v[12:13], v[12:13], v[60:61]
  v_pk_add_f32 v[12:13], v[12:13], v[62:63]
  v_pk_add_f32 v[12:13], v[12:13], v[64:65]
  v_pk_add_f32 v[12:13], v[12:13], v[66:67]
  v_pk_add_f32 v[12:13], v[12:13], v[68:69]
  v_pk_add_f32 v[12:13], v[12:13], v[70:71]
  v_pk_add_f32 v[12:13], v[12:13], v[72:73]
  v_pk_add_f32 v[12:13], v[12:13], v[74:75]
  v_pk_add_f32 v[12:13], v[12:13], v[76:77]
  v_pk_add_f32 v[12:13], v[12:13], v[78:79]
  v_pk_add_f32 v[12:13], v[12:13], v[80:81]
  v_pk_add_f32 v[12:13], v[12:13], v[82:83]
  v_pk_add_f32 v[12:13], v[12:13], v[84:85]
  v_pk_add_f32 v[12:13], v[12:13], v[86:87]
  v_pk_add_f32 v[12:13], v[12:13], v[88:89]
  v_pk_add_f32 v[12:13], v[12:13], v[90:91]
  v_pk_add_f32 v[12:13], v[12:13], v[92:93]
  v_pk_add_f32 v[12:13], v[12:13], v[94:95]
  v_add_f32 v12, v12, v13
  s_nop 1
  v_add_f32_dpp v12, v12, v12 row_ror:8 row_mask:0xf bank_mask:0xf
  v_mov_b32 v13, v12
  s_nop 1
  v_permlane16_swap_b32 v12, v13
  v_add_f32 v12, v12, v13
  v_mov_b32 v13, v12
  s_nop 1
  v_permlane32_swap_b32 v12, v13
  v_add_f32 v12, v12, v13
  v_mul_f32 v12, 0xbacccccd, v12
  v_mov_b32 v13, v12
  v_pk_add_f32 v[16:17], v[16:17], v[12:13]
  v_pk_add_f32 v[18:19], v[18:19], v[12:13]
  v_pk_add_f32 v[20:21], v[20:21], v[12:13]
  v_pk_add_f32 v[22:23], v[22:23], v[12:13]
  v_pk_add_f32 v[24:25], v[24:25], v[12:13]
  v_pk_add_f32 v[26:27], v[26:27], v[12:13]
  v_pk_add_f32 v[28:29], v[28:29], v[12:13]
  v_pk_add_f32 v[30:31], v[30:31], v[12:13]
  v_pk_add_f32 v[32:33], v[32:33], v[12:13]
  v_pk_add_f32 v[34:35], v[34:35], v[12:13]
  v_pk_add_f32 v[36:37], v[36:37], v[12:13]
  v_pk_add_f32 v[38:39], v[38:39], v[12:13]
  v_pk_add_f32 v[40:41], v[40:41], v[12:13]
  v_pk_add_f32 v[42:43], v[42:43], v[12:13]
  v_pk_add_f32 v[44:45], v[44:45], v[12:13]
  v_pk_add_f32 v[46:47], v[46:47], v[12:13]
  v_pk_add_f32 v[48:49], v[48:49], v[12:13]
  v_pk_add_f32 v[50:51], v[50:51], v[12:13]
  v_pk_add_f32 v[52:53], v[52:53], v[12:13]
  v_pk_add_f32 v[54:55], v[54:55], v[12:13]
  v_pk_add_f32 v[56:57], v[56:57], v[12:13]
  v_pk_add_f32 v[58:59], v[58:59], v[12:13]
  v_pk_add_f32 v[60:61], v[60:61], v[12:13]
  v_pk_add_f32 v[62:63], v[62:63], v[12:13]
  v_pk_add_f32 v[64:65], v[64:65], v[12:13]
  v_pk_add_f32 v[66:67], v[66:67], v[12:13]
  v_pk_add_f32 v[68:69], v[68:69], v[12:13]
  v_pk_add_f32 v[70:71], v[70:71], v[12:13]
  v_pk_add_f32 v[72:73], v[72:73], v[12:13]
  v_pk_add_f32 v[74:75], v[74:75], v[12:13]
  v_pk_add_f32 v[76:77], v[76:77], v[12:13]
  v_pk_add_f32 v[78:79], v[78:79], v[12:13]
  v_pk_add_f32 v[80:81], v[80:81], v[12:13]
  v_pk_add_f32 v[82:83], v[82:83], v[12:13]
  v_pk_add_f32 v[84:85], v[84:85], v[12:13]
  v_pk_add_f32 v[86:87], v[86:87], v[12:13]
  v_pk_add_f32 v[88:89], v[88:89], v[12:13]
  v_pk_add_f32 v[90:91], v[90:91], v[12:13]
  v_pk_add_f32 v[92:93], v[92:93], v[12:13]
  v_pk_add_f32 v[94:95], v[94:95], v[12:13]
  v_pk_mul_f32 v[12:13], v[16:17], v[16:17]
  v_pk_fma_f32 v[12:13], v[18:19], v[18:19], v[12:13]
  v_pk_fma_f32 v[12:13], v[20:21], v[20:21], v[12:13]
  v_pk_fma_f32 v[12:13], v[22:23], v[22:23], v[12:13]
  v_pk_fma_f32 v[12:13], v[24:25], v[24:25], v[12:13]
  v_pk_fma_f32 v[12:13], v[26:27], v[26:27], v[12:13]
  v_pk_fma_f32 v[12:13], v[28:29], v[28:29], v[12:13]
  v_pk_fma_f32 v[12:13], v[30:31], v[30:31], v[12:13]
  v_pk_fma_f32 v[12:13], v[32:33], v[32:33], v[12:13]
  v_pk_fma_f32 v[12:13], v[34:35], v[34:35], v[12:13]
  v_pk_fma_f32 v[12:13], v[36:37], v[36:37], v[12:13]
  v_pk_fma_f32 v[12:13], v[38:39], v[38:39], v[12:13]
  v_pk_fma_f32 v[12:13], v[40:41], v[40:41], v[12:13]
  v_pk_fma_f32 v[12:13], v[42:43], v[42:43], v[12:13]
  v_pk_fma_f32 v[12:13], v[44:45], v[44:45], v[12:13]
  v_pk_fma_f32 v[12:13], v[46:47], v[46:47], v[12:13]
  v_pk_fma_f32 v[12:13], v[48:49], v[48:49], v[12:13]
  v_pk_fma_f32 v[12:13], v[50:51], v[50:51], v[12:13]
  v_pk_fma_f32 v[12:13], v[52:53], v[52:53], v[12:13]
  v_pk_fma_f32 v[12:13], v[54:55], v[54:55], v[12:13]
  v_pk_fma_f32 v[12:13], v[56:57], v[56:57], v[12:13]
  v_pk_fma_f32 v[12:13], v[58:59], v[58:59], v[12:13]
  v_pk_fma_f32 v[12:13], v[60:61], v[60:61], v[12:13]
  v_pk_fma_f32 v[12:13], v[62:63], v[62:63], v[12:13]
  v_pk_fma_f32 v[12:13], v[64:65], v[64:65], v[12:13]
  v_pk_fma_f32 v[12:13], v[66:67], v[66:67], v[12:13]
  v_pk_fma_f32 v[12:13], v[68:69], v[68:69], v[12:13]
  v_pk_fma_f32 v[12:13], v[70:71], v[70:71], v[12:13]
  v_pk_fma_f32 v[12:13], v[72:73], v[72:73], v[12:13]
  v_pk_fma_f32 v[12:13], v[74:75], v[74:75], v[12:13]
  v_pk_fma_f32 v[12:13], v[76:77], v[76:77], v[12:13]
  v_pk_fma_f32 v[12:13], v[78:79], v[78:79], v[12:13]
  v_pk_fma_f32 v[12:13], v[80:81], v[80:81], v[12:13]
  v_pk_fma_f32 v[12:13], v[82:83], v[82:83], v[12:13]
  v_pk_fma_f32 v[12:13], v[84:85], v[84:85], v[12:13]
  v_pk_fma_f32 v[12:13], v[86:87], v[86:87], v[12:13]
  v_pk_fma_f32 v[12:13], v[88:89], v[88:89], v[12:13]
  v_pk_fma_f32 v[12:13], v[90:91], v[90:91], v[12:13]
  v_pk_fma_f32 v[12:13], v[92:93], v[92:93], v[12:13]
  v_pk_fma_f32 v[12:13], v[94:95], v[94:95], v[12:13]
  v_add_f32 v12, v12, v13
  s_nop 1
  v_add_f32_dpp v12, v12, v12 row_ror:8 row_mask:0xf bank_mask:0xf
  v_mov_b32 v13, v12
  s_nop 1
  v_permlane16_swap_b32 v12, v13
  v_add_f32 v12, v12, v13
  v_mov_b32 v13, v12
  s_nop 1
  v_permlane32_swap_b32 v12, v13
  v_add_f32 v12, v12, v13
  v_mov_b32 v13, 0x3727c5ac
  v_fmac_f32 v13, 0x3acccccd, v12
  v_rsq_f32 v12, v13
  s_nop 0
  v_mov_b32 v13, v12
  v_pk_mul_f32 v[16:17], v[16:17], v[12:13]
  v_pk_mul_f32 v[18:19], v[18:19], v[12:13]
  v_pk_mul_f32 v[20:21], v[20:21], v[12:13]
  v_pk_mul_f32 v[22:23], v[22:23], v[12:13]
  v_pk_mul_f32 v[24:25], v[24:25], v[12:13]
  v_pk_mul_f32 v[26:27], v[26:27], v[12:13]
  v_pk_mul_f32 v[28:29], v[28:29], v[12:13]
  v_pk_mul_f32 v[30:31], v[30:31], v[12:13]
  v_pk_mul_f32 v[32:33], v[32:33], v[12:13]
  v_pk_mul_f32 v[34:35], v[34:35], v[12:13]
  v_pk_mul_f32 v[36:37], v[36:37], v[12:13]
  v_pk_mul_f32 v[38:39], v[38:39], v[12:13]
  v_pk_mul_f32 v[40:41], v[40:41], v[12:13]
  v_pk_mul_f32 v[42:43], v[42:43], v[12:13]
  v_pk_mul_f32 v[44:45], v[44:45], v[12:13]
  v_pk_mul_f32 v[46:47], v[46:47], v[12:13]
  v_pk_mul_f32 v[48:49], v[48:49], v[12:13]
  v_pk_mul_f32 v[50:51], v[50:51], v[12:13]
  v_pk_mul_f32 v[52:53], v[52:53], v[12:13]
  v_pk_mul_f32 v[54:55], v[54:55], v[12:13]
  v_pk_mul_f32 v[56:57], v[56:57], v[12:13]
  v_pk_mul_f32 v[58:59], v[58:59], v[12:13]
  v_pk_mul_f32 v[60:61], v[60:61], v[12:13]
  v_pk_mul_f32 v[62:63], v[62:63], v[12:13]
  v_pk_mul_f32 v[64:65], v[64:65], v[12:13]
  v_pk_mul_f32 v[66:67], v[66:67], v[12:13]
  v_pk_mul_f32 v[68:69], v[68:69], v[12:13]
  v_pk_mul_f32 v[70:71], v[70:71], v[12:13]
  v_pk_mul_f32 v[72:73], v[72:73], v[12:13]
  v_pk_mul_f32 v[74:75], v[74:75], v[12:13]
  v_pk_mul_f32 v[76:77], v[76:77], v[12:13]
  v_pk_mul_f32 v[78:79], v[78:79], v[12:13]
  v_pk_mul_f32 v[80:81], v[80:81], v[12:13]
  v_pk_mul_f32 v[82:83], v[82:83], v[12:13]
  v_pk_mul_f32 v[84:85], v[84:85], v[12:13]
  v_pk_mul_f32 v[86:87], v[86:87], v[12:13]
  v_pk_mul_f32 v[88:89], v[88:89], v[12:13]
  v_pk_mul_f32 v[90:91], v[90:91], v[12:13]
  v_pk_mul_f32 v[92:93], v[92:93], v[12:13]
  v_pk_mul_f32 v[94:95], v[94:95], v[12:13]
  v_cvt_pk_bf16_f32 v16, v16, v17
  v_cvt_pk_bf16_f32 v17, v18, v19
  v_cvt_pk_bf16_f32 v18, v20, v21
  v_cvt_pk_bf16_f32 v19, v22, v23
  v_cvt_pk_bf16_f32 v20, v24, v25
  v_cvt_pk_bf16_f32 v21, v26, v27
  v_cvt_pk_bf16_f32 v22, v28, v29
  v_cvt_pk_bf16_f32 v23, v30, v31
  v_cvt_pk_bf16_f32 v24, v32, v33
  v_cvt_pk_bf16_f32 v25, v34, v35
  v_cvt_pk_bf16_f32 v26, v36, v37
  v_cvt_pk_bf16_f32 v27, v38, v39
  v_cvt_pk_bf16_f32 v28, v40, v41
  v_cvt_pk_bf16_f32 v29, v42, v43
  v_cvt_pk_bf16_f32 v30, v44, v45
  v_cvt_pk_bf16_f32 v31, v46, v47
  v_cvt_pk_bf16_f32 v32, v48, v49
  v_cvt_pk_bf16_f32 v33, v50, v51
  v_cvt_pk_bf16_f32 v34, v52, v53
  v_cvt_pk_bf16_f32 v35, v54, v55
  v_cvt_pk_bf16_f32 v36, v56, v57
  v_cvt_pk_bf16_f32 v37, v58, v59
  v_cvt_pk_bf16_f32 v38, v60, v61
  v_cvt_pk_bf16_f32 v39, v62, v63
  v_cvt_pk_bf16_f32 v40, v64, v65
  v_cvt_pk_bf16_f32 v41, v66, v67
  v_cvt_pk_bf16_f32 v42, v68, v69
  v_cvt_pk_bf16_f32 v43, v70, v71
  v_cvt_pk_bf16_f32 v44, v72, v73
  v_cvt_pk_bf16_f32 v45, v74, v75
  v_cvt_pk_bf16_f32 v46, v76, v77
  v_cvt_pk_bf16_f32 v47, v78, v79
  v_cvt_pk_bf16_f32 v48, v80, v81
  v_cvt_pk_bf16_f32 v49, v82, v83
  v_cvt_pk_bf16_f32 v50, v84, v85
  v_cvt_pk_bf16_f32 v51, v86, v87
  v_cvt_pk_bf16_f32 v52, v88, v89
  v_cvt_pk_bf16_f32 v53, v90, v91
  v_cvt_pk_bf16_f32 v54, v92, v93
  v_cvt_pk_bf16_f32 v55, v94, v95
  s_mul_i32 s48, s46, 40960
  s_add_u32 s48, s48, s47
  s_add_u32 s48, s48, 0x100000
  s_add_u32 s49, s48, 0
  buffer_store_dwordx4 v[16:19], v10, s[8:11], s49 offen sc1
  s_add_u32 s49, s48, 4096
  buffer_store_dwordx4 v[20:23], v10, s[8:11], s49 offen sc1
  s_add_u32 s49, s48, 8192
  buffer_store_dwordx4 v[24:27], v10, s[8:11], s49 offen sc1
  s_add_u32 s49, s48, 12288
  buffer_store_dwordx4 v[28:31], v10, s[8:11], s49 offen sc1
  s_add_u32 s49, s48, 16384
  buffer_store_dwordx4 v[32:35], v10, s[8:11], s49 offen sc1
  s_add_u32 s49, s48, 20480
  buffer_store_dwordx4 v[36:39], v10, s[8:11], s49 offen sc1
  s_add_u32 s49, s48, 24576
  buffer_store_dwordx4 v[40:43], v10, s[8:11], s49 offen sc1
  s_add_u32 s49, s48, 28672
  buffer_store_dwordx4 v[44:47], v10, s[8:11], s49 offen sc1
  s_add_u32 s49, s48, 32768
  buffer_store_dwordx4 v[48:51], v10, s[8:11], s49 offen sc1
  s_add_u32 s49, s48, 36864
  buffer_store_dwordx4 v[52:55], v10, s[8:11], s49 offen sc1
lnu_49_x:
  s_cmp_eq_u32 s21, 0
  s_cbranch_scc0 ka_cen_done
  s_mov_b64 s[24:25], exec
  s_mov_b64 exec, 1
  v_mov_b32 v3, 1
  s_lshl_b32 s27, s26, 7
  s_add_u32 s27, s27, 0x2000
  v_mov_b32 v4, 0
  buffer_atomic_add v3, v4, s[8:11], s27 offen sc0
  s_mov_b64 exec, 0xffff
  v_lshlrev_b32 v4, 7, v0
  s_mov_b32 s27, 0x2000
  s_mov_b32 s45, 0
  s_waitcnt vmcnt(0)
  v_mov_b32 v5, v3
ka_cen_spin:
  buffer_load_dword v7, v4, s[8:11], s27 offen sc1
  s_add_u32 s45, s45, 1
  s_waitcnt vmcnt(0)
  v_add_u32_dpp v8, v7, v7 quad_perm:[1,0,3,2] row_mask:0xf bank_mask:0xf
  s_nop 1
  v_add_u32_dpp v9, v8, v8 quad_perm:[2,3,0,1] row_mask:0xf bank_mask:0xf
  s_nop 1
  v_add_u32_dpp v8, v9, v9 row_half_mirror row_mask:0xf bank_mask:0xf
  s_nop 1
  v_add_u32_dpp v9, v8, v8 row_mirror row_mask:0xf bank_mask:0xf
  s_nop 0
  v_readfirstlane_b32 s28, v9
  s_cmp_ge_u32 s28, 256
  s_cbranch_scc1 ka_cen_ok
  s_cmp_lt_u32 s45, 400000
  s_cbranch_scc1 ka_cen_spin
ka_cen_ok:
  v_cmp_gt_u32 vcc, s26, v0
  s_nop 1
  v_cndmask_b32 v8, 0, v7, vcc
  s_nop 1
  v_add_u32_dpp v9, v8, v8 quad_perm:[1,0,3,2] row_mask:0xf bank_mask:0xf
  s_nop 1
  v_add_u32_dpp v8, v9, v9 quad_perm:[2,3,0,1] row_mask:0xf bank_mask:0xf
  s_nop 1
  v_add_u32_dpp v9, v8, v8 row_half_mirror row_mask:0xf bank_mask:0xf
  s_nop 1
  v_add_u32_dpp v8, v9, v9 row_mirror row_mask:0xf bank_mask:0xf
  v_add_u32 v6, v8, v5
  s_mov_b64 exec, 0xff
  v_cmp_ne_u32 vcc, 32, v7
  s_nop 1
  s_cmp_eq_u64 vcc, 0
  s_cselect_b32 s27, 1, 0
  s_cmp_ge_u32 s27, 1
  s_cselect_b32 s27, 1, 0
  s_mov_b64 exec, 1
  v_mov_b32 v8, s27
  v_mov_b32 v4, 0
  v_mov_b32 v9, 0
  ds_write_b128 v4, v[6:9]
  ds_write_b32 v4, v5 offset:16
  s_waitcnt lgkmcnt(0)
  s_mov_b64 exec, s[24:25]
ka_cen_done:
  s_barrier
  v_mov_b32 v4, 0
  ds_read_b128 v[6:9], v4
  ds_read_b32 v5, v4 offset:16
  s_waitcnt lgkmcnt(0)
  v_readfirstlane_b32 s27, v6
  v_readfirstlane_b32 s44, v8
  v_readfirstlane_b32 s28, v5
  s_barrier
  s_cmp_eq_u32 s44, 1
  s_cbranch_scc1 ka_cen_fast
  s_lshr_b32 s20, s27, 5
  s_and_b32 s22, s27, 31
  s_branch ka_cen_end
ka_cen_fast:
  s_mov_b32 s20, s26
  s_mov_b32 s22, s28
ka_cen_end:
  s_and_b32 s20, s20, 7
  s_and_b32 s22, s22, 31
  s_cmp_lt_u32 s20, 4
  s_cbranch_scc0 ka_bulk
  s_cmp_lt_u32 s22, 8
  s_cbranch_scc0 ka_noty
  s_lshl_b32 s23, s20, 3
  s_add_u32 s23, s23, s22
  s_cmp_eq_u32 s44, 1
  s_cbranch_scc1 kaf_x
  s_branch kas_x
ka_noty:
  s_cmp_lt_u32 s22, 28
  s_cbranch_scc0 ka_spare
  s_sub_u32 s23, s22, 8
  s_cmp_eq_u32 s44, 1
  s_cbranch_scc1 kaf_y
  s_branch kas_y
ka_bulk:
  s_sub_u32 s28, s20, 4
  s_lshl_b32 s23, s22, 2
  s_add_u32 s23, s23, s28
  s_cmp_lt_u32 s23, 72
  s_cbranch_scc1 ka_qkv
  s_sub_u32 s23, s23, 72
  s_cmp_lt_u32 s23, 32
  s_cbranch_scc1 ka_u
  s_sub_u32 s23, s23, 32
  s_branch ka_ln
ka_ln:
  v_and_b32 v1, 63, v0
  s_lshl_b32 s46, s23, 2
  s_add_u32 s46, s46, s21
  v_and_b32 v5, 7, v1
  v_bfe_u32 v6, v1, 3, 1
  v_lshrrev_b32 v7, 4, v1
  v_lshlrev_b32 v8, 5, v6
  v_add_u32 v8, v8, v5
  v_lshlrev_b32 v8, 4, v8
  v_lshlrev_b32 v9, 11, v7
  v_add_u32 v9, v9, v8
  v_lshlrev_b32 v10, 10, v7
  v_add_u32 v10, v10, v8
  v_mul_u32_u24 v11, 1280, v5
  v_lshlrev_b32 v12, 5, v7
  v_add_u32 v11, v11, v12
  v_lshlrev_b32 v12, 4, v6
  v_add_u32 v11, v11, v12
  s_load_dwordx2 s[36:37], s[0:1], 0
  s_load_dwordx4 s[40:43], s[0:1], 64
  s_waitcnt lgkmcnt(0)
  s_mov_b32 s12, s36
  s_and_b32 s13, s37, 0xffff
  s_mov_b32 s14, 0x280000
  s_mov_b32 s15, 0x20000

  s_cmp_eq_u32 s21, 3
  s_cbranch_scc0 lna_50
  s_waitcnt vmcnt(0)
  s_mov_b64 s[24:25], exec
  s_mov_b64 exec, 1
  s_and_b32 s45, s2, 7
  s_lshl_b32 s45, s45, 7
  s_add_u32 s45, s45, 10240
  v_mov_b32 v2, s45
  v_mov_b32 v3, 1
  buffer_atomic_add v3, v2, s[8:11], 0 offen
  s_mov_b64 exec, s[24:25]
lna_50:
  s_cmp_eq_u32 s99, 0
  s_cbranch_scc0 ka_lnx
  s_mov_b32 s12, s42
  s_and_b32 s13, s43, 0xffff
  s_mov_b32 s14, 0xc8000
  s_mov_b32 s15, 0x20000
  s_mov_b32 s16, s40
  s_and_b32 s17, s41, 0xffff
  s_mov_b32 s18, 0x258000
  s_mov_b32 s19, 0x20000
  v_lshlrev_b32 v2, 4, v1
  v_and_b32 v8, 31, v1
  v_lshrrev_b32 v9, 5, v1
  v_lshrrev_b32 v10, 4, v8
  v_lshlrev_b32 v10, 4, v10
  v_bfe_u32 v11, v8, 2, 1
  v_lshlrev_b32 v11, 3, v11
  v_add_u32 v10, v10, v11
  v_bfe_u32 v11, v8, 3, 1
  v_lshlrev_b32 v11, 2, v11
  v_add_u32 v10, v10, v11
  v_and_b32 v11, 3, v8
  v_add_u32 v10, v10, v11
  v_mul_u32_u24 v12, 30720, v9
  v_lshlrev_b32 v13, 1, v10
  v_add_u32 v13, v13, v12
  v_lshlrev_b32 v14, 1, v8
  v_add_u32 v14, v14, v12
  v_cmp_gt_u32 s[50:51], 20, v10
  v_cmp_gt_u32 s[52:53], 20, v8
  v_lshrrev_b32 v15, 4, v1
  v_mul_u32_u24 v15, 10240, v15
  v_and_b32 v16, 15, v1
  v_lshlrev_b32 v16, 1, v16
  v_add_u32 v15, v15, v16
  s_mov_b32 s46, s23
ka_gl:
  s_barrier
  s_cmp_lt_u32 s46, 40
  s_cbranch_scc0 ka_gwo
  s_mul_i32 s28, s46, 61440
  s_lshl_b32 s29, s21, 10
  s_add_u32 s29, s29, 0
  s_mov_b32 m0, s29
  s_add_u32 s30, s28, s29
  buffer_load_dwordx4 v2, s[16:19], s30 offen lds
  s_lshl_b32 s29, s21, 10
  s_add_u32 s29, s29, 4096
  s_mov_b32 m0, s29
  s_add_u32 s30, s28, s29
  buffer_load_dwordx4 v2, s[16:19], s30 offen lds
  s_lshl_b32 s29, s21, 10
  s_add_u32 s29, s29, 8192
  s_mov_b32 m0, s29
  s_add_u32 s30, s28, s29
  buffer_load_dwordx4 v2, s[16:19], s30 offen lds
  s_lshl_b32 s29, s21, 10
  s_add_u32 s29, s29, 12288
  s_mov_b32 m0, s29
  s_add_u32 s30, s28, s29
  buffer_load_dwordx4 v2, s[16:19], s30 offen lds
  s_lshl_b32 s29, s21, 10
  s_add_u32 s29, s29, 16384
  s_mov_b32 m0, s29
  s_add_u32 s30, s28, s29
  buffer_load_dwordx4 v2, s[16:19], s30 offen lds
  s_lshl_b32 s29, s21, 10
  s_add_u32 s29, s29, 20480
  s_mov_b32 m0, s29
  s_add_u32 s30, s28, s29
  buffer_load_dwordx4 v2, s[16:19], s30 offen lds
  s_lshl_b32 s29, s21, 10
  s_add_u32 s29, s29, 24576
  s_mov_b32 m0, s29
  s_add_u32 s30, s28, s29
  buffer_load_dwordx4 v2, s[16:19], s30 offen lds
  s_lshl_b32 s29, s21, 10
  s_add_u32 s29, s29, 28672
  s_mov_b32 m0, s29
  s_add_u32 s30, s28, s29
  buffer_load_dwordx4 v2, s[16:19], s30 offen lds
  s_lshl_b32 s29, s21, 10
  s_add_u32 s29, s29, 32768
  s_mov_b32 m0, s29
  s_add_u32 s30, s28, s29
  buffer_load_dwordx4 v2, s[16:19], s30 offen lds
  s_lshl_b32 s29, s21, 10
  s_add_u32 s29, s29, 36864
  s_mov_b32 m0, s29
  s_add_u32 s30, s28, s29
  buffer_load_dwordx4 v2, s[16:19], s30 offen lds
  s_lshl_b32 s29, s21, 10
  s_add_u32 s29, s29, 40960
  s_mov_b32 m0, s29
  s_add_u32 s30, s28, s29
  buffer_load_dwordx4 v2, s[16:19], s30 offen lds
  s_lshl_b32 s29, s21, 10
  s_add_u32 s29, s29, 45056
  s_mov_b32 m0, s29
  s_add_u32 s30, s28, s29
  buffer_load_dwordx4 v2, s[16:19], s30 offen lds
  s_lshl_b32 s29, s21, 10
  s_add_u32 s29, s29, 49152
  s_mov_b32 m0, s29
  s_add_u32 s30, s28, s29
  buffer_load_dwordx4 v2, s[16:19], s30 offen lds
  s_lshl_b32 s29, s21, 10
  s_add_u32 s29, s29, 53248
  s_mov_b32 m0, s29
  s_add_u32 s30, s28, s29
  buffer_load_dwordx4 v2, s[16:19], s30 offen lds
  s_lshl_b32 s29, s21, 10
  s_add_u32 s29, s29, 57344
  s_mov_b32 m0, s29
  s_add_u32 s30, s28, s29
  buffer_load_dwordx4 v2, s[16:19], s30 offen lds
  s_waitcnt vmcnt(0)
  s_barrier
  s_lshl_b32 s47, s21, 3
ka_gh:
  s_mul_i32 s28, s47, 40
  s_add_u32 s28, s28, 0
  v_add_u32 v17, s28, v13
  ds_read_u16 v20, v17 offset:0
  ds_read_u16 v21, v17 offset:3840
  ds_read_u16 v22, v17 offset:7680
  ds_read_u16 v23, v17 offset:11520
  ds_read_u16 v24, v17 offset:15360
  ds_read_u16 v25, v17 offset:19200
  ds_read_u16 v26, v17 offset:23040
  ds_read_u16 v27, v17 offset:26880
  s_waitcnt lgkmcnt(0)
  v_lshl_or_b32 v28, v21, 16, v20
  v_cndmask_b32 v28, 0, v28, s[50:51]
  v_lshl_or_b32 v29, v23, 16, v22
  v_cndmask_b32 v29, 0, v29, s[50:51]
  v_lshl_or_b32 v30, v25, 16, v24
  v_cndmask_b32 v30, 0, v30, s[50:51]
  v_lshl_or_b32 v31, v27, 16, v26
  v_cndmask_b32 v31, 0, v31, s[50:51]
  s_mul_i32 s28, s47, 3
  s_add_u32 s28, s28, 0
  s_mul_i32 s28, s28, 40
  s_add_u32 s28, s28, s46
  s_lshl_b32 s28, s28, 10
  s_add_u32 s28, s28, 0xe100000
  buffer_store_dwordx4 v[28:31], v2, s[8:11], s28 offen
  s_nop 1
  s_mul_i32 s28, s47, 40
  s_add_u32 s28, s28, 1280
  v_add_u32 v17, s28, v13
  ds_read_u16 v20, v17 offset:0
  ds_read_u16 v21, v17 offset:3840
  ds_read_u16 v22, v17 offset:7680
  ds_read_u16 v23, v17 offset:11520
  ds_read_u16 v24, v17 offset:15360
  ds_read_u16 v25, v17 offset:19200
  ds_read_u16 v26, v17 offset:23040
  ds_read_u16 v27, v17 offset:26880
  s_waitcnt lgkmcnt(0)
  v_lshl_or_b32 v28, v21, 16, v20
  v_cndmask_b32 v28, 0, v28, s[50:51]
  v_lshl_or_b32 v29, v23, 16, v22
  v_cndmask_b32 v29, 0, v29, s[50:51]
  v_lshl_or_b32 v30, v25, 16, v24
  v_cndmask_b32 v30, 0, v30, s[50:51]
  v_lshl_or_b32 v31, v27, 16, v26
  v_cndmask_b32 v31, 0, v31, s[50:51]
  s_mul_i32 s28, s47, 3
  s_add_u32 s28, s28, 1
  s_mul_i32 s28, s28, 40
  s_add_u32 s28, s28, s46
  s_lshl_b32 s28, s28, 10
  s_add_u32 s28, s28, 0xe100000
  buffer_store_dwordx4 v[28:31], v2, s[8:11], s28 offen
  s_nop 1
  s_mul_i32 s28, s47, 40
  s_add_u32 s28, s28, 2560
  v_add_u32 v17, s28, v14
  ds_read_u16 v20, v17 offset:0
  ds_read_u16 v21, v17 offset:3840
  ds_read_u16 v22, v17 offset:7680
  ds_read_u16 v23, v17 offset:11520
  ds_read_u16 v24, v17 offset:15360
  ds_read_u16 v25, v17 offset:19200
  ds_read_u16 v26, v17 offset:23040
  ds_read_u16 v27, v17 offset:26880
  s_waitcnt lgkmcnt(0)
  v_lshl_or_b32 v28, v21, 16, v20
  v_cndmask_b32 v28, 0, v28, s[52:53]
  v_lshl_or_b32 v29, v23, 16, v22
  v_cndmask_b32 v29, 0, v29, s[52:53]
  v_lshl_or_b32 v30, v25, 16, v24
  v_cndmask_b32 v30, 0, v30, s[52:53]
  v_lshl_or_b32 v31, v27, 16, v26
  v_cndmask_b32 v31, 0, v31, s[52:53]
  s_mul_i32 s28, s47, 3
  s_add_u32 s28, s28, 2
  s_mul_i32 s28, s28, 40
  s_add_u32 s28, s28, s46
  s_lshl_b32 s28, s28, 10
  s_add_u32 s28, s28, 0xe100000
  buffer_store_dwordx4 v[28:31], v2, s[8:11], s28 offen
  s_nop 1
  s_add_u32 s47, s47, 1
  s_and_b32 s28, s47, 7
  s_cmp_lg_u32 s28, 0
  s_cbranch_scc1 ka_gh
  s_branch ka_gn
ka_gwo:
  s_sub_u32 s48, s46, 40
  s_mul_i32 s28, s48, 40960
  s_lshl_b32 s29, s21, 10
  s_add_u32 s29, s29, 0
  s_mov_b32 m0, s29
  s_add_u32 s30, s28, s29
  buffer_load_dwordx4 v2, s[12:15], s30 offen lds
  s_lshl_b32 s29, s21, 10
  s_add_u32 s29, s29, 4096
  s_mov_b32 m0, s29
  s_add_u32 s30, s28, s29
  buffer_load_dwordx4 v2, s[12:15], s30 offen lds
  s_lshl_b32 s29, s21, 10
  s_add_u32 s29, s29, 8192
  s_mov_b32 m0, s29
  s_add_u32 s30, s28, s29
  buffer_load_dwordx4 v2, s[12:15], s30 offen lds
  s_lshl_b32 s29, s21, 10
  s_add_u32 s29, s29, 12288
  s_mov_b32 m0, s29
  s_add_u32 s30, s28, s29
  buffer_load_dwordx4 v2, s[12:15], s30 offen lds
  s_lshl_b32 s29, s21, 10
  s_add_u32 s29, s29, 16384
  s_mov_b32 m0, s29
  s_add_u32 s30, s28, s29
  buffer_load_dwordx4 v2, s[12:15], s30 offen lds
  s_lshl_b32 s29, s21, 10
  s_add_u32 s29, s29, 20480
  s_mov_b32 m0, s29
  s_add_u32 s30, s28, s29
  buffer_load_dwordx4 v2, s[12:15], s30 offen lds
  s_lshl_b32 s29, s21, 10
  s_add_u32 s29, s29, 24576
  s_mov_b32 m0, s29
  s_add_u32 s30, s28, s29
  buffer_load_dwordx4 v2, s[12:15], s30 offen lds
  s_lshl_b32 s29, s21, 10
  s_add_u32 s29, s29, 28672
  s_mov_b32 m0, s29
  s_add_u32 s30, s28, s29
  buffer_load_dwordx4 v2, s[12:15], s30 offen lds
  s_lshl_b32 s29, s21, 10
  s_add_u32 s29, s29, 32768
  s_mov_b32 m0, s29
  s_add_u32 s30, s28, s29
  buffer_load_dwordx4 v2, s[12:15], s30 offen lds
  s_lshl_b32 s29, s21, 10
  s_add_u32 s29, s29, 36864
  s_mov_b32 m0, s29
  s_add_u32 s30, s28, s29
  buffer_load_dwordx4 v2, s[12:15], s30 offen lds
  s_waitcnt vmcnt(0)
  s_barrier
  s_mul_i32 s47, s21, 10
  s_add_u32 s49, s47, 10
ka_gc:
  s_lshl_b32 s28, s47, 5
  v_add_u32 v17, s28, v15
  ds_read_u16 v20, v17 offset:0
  ds_read_u16 v21, v17 offset:1280
  ds_read_u16 v22, v17 offset:2560
  ds_read_u16 v23, v17 offset:3840
  ds_read_u16 v24, v17 offset:5120
  ds_read_u16 v25, v17 offset:6400
  ds_read_u16 v26, v17 offset:7680
  ds_read_u16 v27, v17 offset:8960
  s_waitcnt lgkmcnt(0)
  v_lshl_or_b32 v28, v21, 16, v20
  v_lshl_or_b32 v29, v23, 16, v22
  v_lshl_or_b32 v30, v25, 16, v24
  v_lshl_or_b32 v31, v27, 16, v26
  s_mul_i32 s28, s47, 20
  s_add_u32 s28, s28, s48
  s_lshl_b32 s28, s28, 10
  s_add_u32 s28, s28, 0xe000000
  buffer_store_dwordx4 v[28:31], v2, s[8:11], s28 offen
  s_add_u32 s47, s47, 1
  s_cmp_lt_u32 s47, s49
  s_cbranch_scc1 ka_gc
ka_gn:
  s_add_u32 s46, s46, 24
  s_cmp_lt_u32 s46, 60
  s_cbranch_scc1 ka_gl
ka_lnx:
  s_waitcnt vmcnt(0)
  s_branch ka_exit
ka_spare:
  s_cmp_eq_u32 s21, 3
  s_cbranch_scc0 lna_51
  s_waitcnt vmcnt(0)
  s_mov_b64 s[24:25], exec
  s_mov_b64 exec, 1
  s_and_b32 s45, s2, 7
  s_lshl_b32 s45, s45, 7
  s_add_u32 s45, s45, 10240
  v_mov_b32 v2, s45
  v_mov_b32 v3, 1
  buffer_atomic_add v3, v2, s[8:11], 0 offen
  s_mov_b64 exec, s[24:25]
lna_51:
ka_pf:
  v_and_b32 v1, 63, v0
  v_lshlrev_b32 v4, 6, v1
  s_sub_u32 s46, s22, 28
  s_lshl_b32 s46, s46, 2
  s_add_u32 s46, s46, s21
  s_mul_i32 s28, s20, 24
  v_and_b32 v5, 15, v1
  v_min_u32 v5, 11, v5
  v_cmp_le_u32 vcc, 6, v5
  v_subrev_u32 v6, 6, v5
  v_mov_b32 v7, 0x400
  v_cndmask_b32 v5, v5, v6, vcc
  v_cndmask_b32 v7, 0, v7, vcc
  v_lshlrev_b32 v5, 2, v5
  v_add_u32 v5, v5, v7
  s_add_u32 s28, s28, 0
  v_add_u32 v5, s28, v5
  v_and_b32 v6, 7, v1
  v_lshlrev_b32 v6, 2, v6
  s_lshl_b32 s28, s20, 5
  s_add_u32 s28, s28, 3072
  v_add_u32 v6, s28, v6
  s_mul_i32 s47, s20, 327680
  s_mul_i32 s28, s46, 20480
  s_add_u32 s47, s47, s28
  s_add_u32 s47, s47, 0x9000000
  s_mul_i32 s28, s46, 3
  s_add_u32 s28, s28, 0
  s_cmp_ge_u32 s28, 24
  s_cselect_b32 s29, 0x1800000, 0
  s_cselect_b32 s30, 24, 0
  s_sub_u32 s28, s28, s30
  s_mul_i32 s30, s28, 43
  s_lshr_b32 s30, s30, 7
  s_mul_i32 s31, s30, 3
  s_sub_u32 s31, s28, s31
  s_lshl_b32 s28, s20, 3
  s_add_u32 s30, s30, s28
  s_mul_i32 s30, s30, 786432
  s_lshl_b32 s31, s31, 12
  s_add_u32 s30, s30, s31
  s_add_u32 s30, s30, 0x4800000
  s_add_u32 s48, s30, s29
  s_mul_i32 s28, s46, 3
  s_add_u32 s28, s28, 1
  s_cmp_ge_u32 s28, 24
  s_cselect_b32 s29, 0x1800000, 0
  s_cselect_b32 s30, 24, 0
  s_sub_u32 s28, s28, s30
  s_mul_i32 s30, s28, 43
  s_lshr_b32 s30, s30, 7
  s_mul_i32 s31, s30, 3
  s_sub_u32 s31, s28, s31
  s_lshl_b32 s28, s20, 3
  s_add_u32 s30, s30, s28
  s_mul_i32 s30, s30, 786432
  s_lshl_b32 s31, s31, 12
  s_add_u32 s30, s30, s31
  s_add_u32 s30, s30, 0x4800000
  s_add_u32 s49, s30, s29
  s_mul_i32 s28, s46, 3
  s_add_u32 s28, s28, 2
  s_cmp_ge_u32 s28, 24
  s_cselect_b32 s29, 0x1800000, 0
  s_cselect_b32 s30, 24, 0
  s_sub_u32 s28, s28, s30
  s_mul_i32 s30, s28, 43
  s_lshr_b32 s30, s30, 7
  s_mul_i32 s31, s30, 3
  s_sub_u32 s31, s28, s31
  s_lshl_b32 s28, s20, 3
  s_add_u32 s30, s30, s28
  s_mul_i32 s30, s30, 786432
  s_lshl_b32 s31, s31, 12
  s_add_u32 s30, s30, s31
  s_add_u32 s30, s30, 0x4800000
  s_add_u32 s50, s30, s29
  s_mul_i32 s28, s20, 327680
  s_add_u32 s28, s28, 0x700000
  s_lshl_b32 s29, s46, 12
  s_add_u32 s51, s28, s29
  s_mov_b32 s52, 5120
  s_cmp_ge_u32 s46, 3
  s_cbranch_scc0 ka_pf1
  s_mul_i32 s28, s20, 655360
  s_add_u32 s28, s28, 0x402800
  s_sub_u32 s29, s46, 3
  s_lshl_b32 s29, s29, 12
  s_add_u32 s51, s28, s29
  s_mov_b32 s52, 10240
  s_cmp_ge_u32 s46, 6
  s_cbranch_scc0 ka_pf1
  s_mul_i32 s28, s20, 1310720
  s_add_u32 s28, s28, 0xe00000
  s_sub_u32 s29, s46, 6
  s_lshl_b32 s29, s29, 12
  s_add_u32 s51, s28, s29
  s_mov_b32 s52, 20480
ka_pf1:
  s_mul_i32 s53, s20, 655360
  s_add_u32 s53, s53, 0x400000
  s_mov_b32 s54, 0
  s_mov_b32 s55, 0
  s_mov_b32 s56, 0
  v_mov_b32 v7, 0
ka_pfl:
  s_cmp_gt_u32 s54, 3
  s_cbranch_scc0 ka_pfgo
  s_sub_u32 s28, s54, 3
  s_mul_i32 s28, s28, 10240
  s_add_u32 s28, s28, s53
  s_mov_b32 s45, 0
ka_pfw:
  buffer_load_dword v8, v7, s[8:11], s28 offen sc1
  s_add_u32 s45, s45, 1
  s_waitcnt vmcnt(0)
  v_readfirstlane_b32 s29, v8
  s_cmp_lg_u32 s29, -1
  s_cbranch_scc1 ka_pfgo
  s_sleep 4
  s_cmp_lt_u32 s45, 400000
  s_cbranch_scc1 ka_pfw
  s_branch ka_exit
ka_pfgo:
  s_cmp_eq_u32 s54, 6
  s_cbranch_scc0 ka_pfnm
  s_cmp_eq_u32 s20, 0
  s_cbranch_scc0 ka_pfnm
  s_cmp_eq_u32 s46, 15
  s_cbranch_scc0 ka_pfnm
  v_and_b32 v8, 7, v1
  v_lshlrev_b32 v8, 8, v8
  v_bfe_u32 v9, v1, 3, 1
  v_lshlrev_b32 v9, 13, v9
  v_add_u32 v8, v8, v9
  s_mov_b32 s28, 0xaa0000
  buffer_store_dword v7, v8, s[8:11], s28 offen sc1
  s_waitcnt vmcnt(0)
  s_mov_b64 s[24:25], exec
  s_mov_b64 exec, 1
  s_mov_b32 s30, -1
  s_mov_b32 s31, -1
  s_mov_b32 s28, 0xaa0000
  s_memtime s[32:33]
  s_waitcnt lgkmcnt(0)
  buffer_load_dword v9, v7, s[8:11], s28 offen sc1
  s_waitcnt vmcnt(0)
  s_memtime s[34:35]
  s_waitcnt lgkmcnt(0)
  s_sub_u32 s34, s34, s32
  s_min_u32 s30, s30, s34
  s_mov_b32 s28, 0xaa2000
  s_memtime s[32:33]
  s_waitcnt lgkmcnt(0)
  buffer_load_dword v9, v7, s[8:11], s28 offen sc1
  s_waitcnt vmcnt(0)
  s_memtime s[34:35]
  s_waitcnt lgkmcnt(0)
  s_sub_u32 s34, s34, s32
  s_min_u32 s31, s31, s34
  s_mov_b32 s28, 0xaa0100
  s_memtime s[32:33]
  s_waitcnt lgkmcnt(0)
  buffer_load_dword v9, v7, s[8:11], s28 offen sc1
  s_waitcnt vmcnt(0)
  s_memtime s[34:35]
  s_waitcnt lgkmcnt(0)
  s_sub_u32 s34, s34, s32
  s_min_u32 s30, s30, s34
  s_mov_b32 s28, 0xaa2100
  s_memtime s[32:33]
  s_waitcnt lgkmcnt(0)
  buffer_load_dword v9, v7, s[8:11], s28 offen sc1
  s_waitcnt vmcnt(0)
  s_memtime s[34:35]
  s_waitcnt lgkmcnt(0)
  s_sub_u32 s34, s34, s32
  s_min_u32 s31, s31, s34
  s_mov_b32 s28, 0xaa0200
  s_memtime s[32:33]
  s_waitcnt lgkmcnt(0)
  buffer_load_dword v9, v7, s[8:11], s28 offen sc1
  s_waitcnt vmcnt(0)
  s_memtime s[34:35]
  s_waitcnt lgkmcnt(0)
  s_sub_u32 s34, s34, s32
  s_min_u32 s30, s30, s34
  s_mov_b32 s28, 0xaa2200
  s_memtime s[32:33]
  s_waitcnt lgkmcnt(0)
  buffer_load_dword v9, v7, s[8:11], s28 offen sc1
  s_waitcnt vmcnt(0)
  s_memtime s[34:35]
  s_waitcnt lgkmcnt(0)
  s_sub_u32 s34, s34, s32
  s_min_u32 s31, s31, s34
  s_mov_b32 s28, 0xaa0300
  s_memtime s[32:33]
  s_waitcnt lgkmcnt(0)
  buffer_load_dword v9, v7, s[8:11], s28 offen sc1
  s_waitcnt vmcnt(0)
  s_memtime s[34:35]
  s_waitcnt lgkmcnt(0)
  s_sub_u32 s34, s34, s32
  s_min_u32 s30, s30, s34
  s_mov_b32 s28, 0xaa2300
  s_memtime s[32:33]
  s_waitcnt lgkmcnt(0)
  buffer_load_dword v9, v7, s[8:11], s28 offen sc1
  s_waitcnt vmcnt(0)
  s_memtime s[34:35]
  s_waitcnt lgkmcnt(0)
  s_sub_u32 s34, s34, s32
  s_min_u32 s31, s31, s34
  s_mov_b32 s28, 0xaa0400
  s_memtime s[32:33]
  s_waitcnt lgkmcnt(0)
  buffer_load_dword v9, v7, s[8:11], s28 offen sc1
  s_waitcnt vmcnt(0)
  s_memtime s[34:35]
  s_waitcnt lgkmcnt(0)
  s_sub_u32 s34, s34, s32
  s_min_u32 s30, s30, s34
  s_mov_b32 s28, 0xaa2400
  s_memtime s[32:33]
  s_waitcnt lgkmcnt(0)
  buffer_load_dword v9, v7, s[8:11], s28 offen sc1
  s_waitcnt vmcnt(0)
  s_memtime s[34:35]
  s_waitcnt lgkmcnt(0)
  s_sub_u32 s34, s34, s32
  s_min_u32 s31, s31, s34
  s_mov_b32 s28, 0xaa0500
  s_memtime s[32:33]
  s_waitcnt lgkmcnt(0)
  buffer_load_dword v9, v7, s[8:11], s28 offen sc1
  s_waitcnt vmcnt(0)
  s_memtime s[34:35]
  s_waitcnt lgkmcnt(0)
  s_sub_u32 s34, s34, s32
  s_min_u32 s30, s30, s34
  s_mov_b32 s28, 0xaa2500
  s_memtime s[32:33]
  s_waitcnt lgkmcnt(0)
  buffer_load_dword v9, v7, s[8:11], s28 offen sc1
  s_waitcnt vmcnt(0)
  s_memtime s[34:35]
  s_waitcnt lgkmcnt(0)
  s_sub_u32 s34, s34, s32
  s_min_u32 s31, s31, s34
  s_cmp_le_u32 s30, s31
  s_cselect_b32 s28, 1, 2
  v_mov_b32 v9, s28
  v_mov_b32 v8, 5056
  buffer_store_dword v9, v8, s[8:11], 0 offen sc1
  v_mov_b32 v9, s30
  buffer_store_dword v9, v8, s[8:11], 0 offen offset:4 sc1
  v_mov_b32 v9, s31
  buffer_store_dword v9, v8, s[8:11], 0 offen offset:8 sc1
  s_mov_b64 exec, s[24:25]
ka_pfnm:
  s_cmp_lt_u32 s46, 11
  s_cbranch_scc0 ka_pf2
  buffer_load_dword v9, v4, s[8:11], s51 offen sc1
ka_pf2:
  s_cmp_gt_u32 s55, s54
  s_cbranch_scc1 ka_wp_52_ok
  s_mov_b32 s45, 0
ka_wp_52_spin:
  buffer_load_dword v2, v5, s[8:11], 0 offen sc1
  s_add_u32 s45, s45, 1
  s_waitcnt vmcnt(0)
  v_min_u32_dpp v3, v2, v2 quad_perm:[1,0,3,2] row_mask:0xf bank_mask:0xf
  s_nop 1
  v_min_u32_dpp v2, v3, v3 quad_perm:[2,3,0,1] row_mask:0xf bank_mask:0xf
  s_nop 1
  v_min_u32_dpp v3, v2, v2 row_half_mirror row_mask:0xf bank_mask:0xf
  s_nop 1
  v_min_u32_dpp v2, v3, v3 row_mirror row_mask:0xf bank_mask:0xf
  s_nop 0
  v_readfirstlane_b32 s55, v2
  s_cmp_gt_u32 s55, s54
  s_cbranch_scc1 ka_wp_52_ok
  s_cmp_lt_u32 s45, 400000
  s_cbranch_scc1 ka_wp_52_spin
  s_branch ka_abort
ka_wp_52_ok:
  buffer_load_dword v10, v4, s[8:11], s48 offen sc1
  buffer_load_dword v11, v4, s[8:11], s49 offen sc1
  buffer_load_dword v12, v4, s[8:11], s50 offen sc1
  s_cmp_gt_u32 s56, s54
  s_cbranch_scc1 ka_wp_53_ok
  s_mov_b32 s45, 0
ka_wp_53_spin:
  buffer_load_dword v2, v6, s[8:11], 0 offen sc1
  s_add_u32 s45, s45, 1
  s_waitcnt vmcnt(0)
  v_min_u32_dpp v3, v2, v2 quad_perm:[1,0,3,2] row_mask:0xf bank_mask:0xf
  s_nop 1
  v_min_u32_dpp v2, v3, v3 quad_perm:[2,3,0,1] row_mask:0xf bank_mask:0xf
  s_nop 1
  v_min_u32_dpp v3, v2, v2 row_half_mirror row_mask:0xf bank_mask:0xf
  s_nop 1
  v_min_u32_dpp v2, v3, v3 quad_perm:[0,1,2,3] row_mask:0xf bank_mask:0xf
  s_nop 0
  v_readfirstlane_b32 s56, v2
  s_cmp_gt_u32 s56, s54
  s_cbranch_scc1 ka_wp_53_ok
  s_cmp_lt_u32 s45, 400000
  s_cbranch_scc1 ka_wp_53_spin
  s_branch ka_abort
ka_wp_53_ok:
  s_add_u32 s28, s47, 0
  buffer_load_dword v13, v4, s[8:11], s28 offen sc1
  s_add_u32 s28, s47, 4096
  buffer_load_dword v14, v4, s[8:11], s28 offen sc1
  s_add_u32 s28, s47, 8192
  buffer_load_dword v15, v4, s[8:11], s28 offen sc1
  s_add_u32 s28, s47, 12288
  buffer_load_dword v16, v4, s[8:11], s28 offen sc1
  s_add_u32 s28, s47, 16384
  buffer_load_dword v17, v4, s[8:11], s28 offen sc1
  s_add_u32 s47, s47, 1310720
  s_add_u32 s48, s48, 12288
  s_add_u32 s49, s49, 12288
  s_add_u32 s50, s50, 12288
  s_add_u32 s51, s51, s52
  s_add_u32 s54, s54, 1
  s_waitcnt vmcnt(0)
  s_cmp_lt_u32 s54, 64
  s_cbranch_scc1 ka_pfl
  s_branch ka_exit
ka_qkv:
  s_mul_i32 s26, s23, 43
  s_lshr_b32 s26, s26, 10
  s_mul_i32 s27, s26, 24
  s_sub_u32 s27, s23, s27
  s_cmp_eq_u32 s26, 0
  s_cselect_b32 s28, s36, s38
  s_cselect_b32 s29, s37, s39
  s_cmp_eq_u32 s26, 2
  s_cselect_b32 s28, s40, s28
  s_cselect_b32 s29, s41, s29
  s_mov_b32 s12, s28
  s_and_b32 s13, s29, 0xffff
  s_mov_b32 s14, 0x780000
  s_mov_b32 s15, 0x20000
  s_mul_i32 s46, s26, 0x1800000
  s_add_u32 s46, s46, 0x4800000
  s_lshl_b32 s47, s26, 10
  s_lshl_b32 s28, s27, 2
  s_add_u32 s47, s47, s28
  s_add_u32 s47, s47, 0
  s_lshl_b32 s28, s27, 3
  s_lshl_b32 s29, s21, 1
  s_add_u32 s28, s28, s29
  s_add_u32 s29, s28, 0
  s_mul_i32 s30, s29, 171
  s_lshr_b32 s30, s30, 10
  s_mul_i32 s31, s30, 6
  s_sub_u32 s31, s29, s31
  s_mul_i32 s30, s30, 786432
  s_lshl_b32 s31, s31, 11
  s_add_u32 s30, s30, s31
  s_add_u32 s48, s30, s46
  s_add_u32 s29, s28, 1
  s_mul_i32 s30, s29, 171
  s_lshr_b32 s30, s30, 10
  s_mul_i32 s31, s30, 6
  s_sub_u32 s31, s29, s31
  s_mul_i32 s30, s30, 786432
  s_lshl_b32 s31, s31, 11
  s_add_u32 s30, s30, s31
  s_add_u32 s49, s30, s46
  v_and_b32 v1, 63, v0
  v_lshrrev_b32 v2, 4, v1
  v_bfe_u32 v3, v1, 2, 2
  v_and_b32 v4, 3, v1
  s_lshr_b32 s28, s21, 1
  s_lshl_b32 s28, s28, 2
  v_add_u32 v5, s28, v3
  v_mul_u32_u24 v5, 12288, v5
  s_and_b32 s28, s21, 1
  s_lshl_b32 s28, s28, 8
  s_lshl_b32 s29, s27, 9
  s_add_u32 s28, s28, s29
  v_add_u32 v5, s28, v5
  v_lshlrev_b32 v6, 6, v2
  v_add_u32 v5, v5, v6
  v_lshlrev_b32 v6, 4, v4
  v_add_u32 v5, v5, v6
  v_lshrrev_b32 v6, 1, v2
  v_lshlrev_b32 v7, 12, v6
  v_lshlrev_b32 v6, 6, v3
  v_add_u32 v7, v7, v6
  v_and_b32 v6, 1, v2
  v_lshlrev_b32 v6, 5, v6
  v_add_u32 v7, v7, v6
  v_lshrrev_b32 v6, 1, v4
  v_lshlrev_b32 v6, 4, v6
  v_add_u32 v7, v7, v6
  v_and_b32 v6, 1, v4
  v_lshlrev_b32 v6, 3, v6
  v_add_u32 v7, v7, v6
  s_lshl_b32 s28, s21, 9
  v_add_u32 v7, s28, v7
  v_lshlrev_b32 v14, 4, v1
  s_lshl_b32 s28, s21, 10
  v_add_u32 v6, s28, v14
  v_and_b32 v15, 7, v1
  v_lshlrev_b32 v15, 7, v15
  v_add_u32 v15, 10240, v15
  s_mov_b32 s51, 0x100000
  s_lshl_b32 s29, s21, 10
  s_add_u32 m0, s29, 0
  s_mov_b32 s28, 0
  buffer_load_dwordx4 v5, s[12:15], s28 offen lds
  s_lshl_b32 s29, s21, 10
  s_add_u32 m0, s29, 4096
  s_mov_b32 s28, 98304
  buffer_load_dwordx4 v5, s[12:15], s28 offen lds
  s_lshl_b32 s29, s21, 10
  s_add_u32 m0, s29, 8192
  s_mov_b32 s28, 196608
  buffer_load_dwordx4 v5, s[12:15], s28 offen lds
  s_lshl_b32 s29, s21, 10
  s_add_u32 m0, s29, 12288
  s_mov_b32 s28, 294912
  buffer_load_dwordx4 v5, s[12:15], s28 offen lds
  s_lshl_b32 s29, s21, 10
  s_add_u32 m0, s29, 16384
  s_mov_b32 s28, 393216
  buffer_load_dwordx4 v5, s[12:15], s28 offen lds
  s_lshl_b32 s29, s21, 10
  s_add_u32 m0, s29, 20480
  s_mov_b32 s28, 491520
  buffer_load_dwordx4 v5, s[12:15], s28 offen lds
  s_lshl_b32 s29, s21, 10
  s_add_u32 m0, s29, 24576
  s_mov_b32 s28, 589824
  buffer_load_dwordx4 v5, s[12:15], s28 offen lds
  s_lshl_b32 s29, s21, 10
  s_add_u32 m0, s29, 28672
  s_mov_b32 s28, 688128
  buffer_load_dwordx4 v5, s[12:15], s28 offen lds
  s_lshl_b32 s29, s21, 10
  s_add_u32 m0, s29, 32768
  s_mov_b32 s28, 786432
  buffer_load_dwordx4 v5, s[12:15], s28 offen lds
  s_lshl_b32 s29, s21, 10
  s_add_u32 m0, s29, 36864
  s_mov_b32 s28, 884736
  buffer_load_dwordx4 v5, s[12:15], s28 offen lds
  s_lshl_b32 s29, s21, 10
  s_add_u32 m0, s29, 40960
  s_mov_b32 s28, 983040
  buffer_load_dwordx4 v5, s[12:15], s28 offen lds
  s_lshl_b32 s29, s21, 10
  s_add_u32 m0, s29, 45056
  s_mov_b32 s28, 1081344
  buffer_load_dwordx4 v5, s[12:15], s28 offen lds
  s_lshl_b32 s29, s21, 10
  s_add_u32 m0, s29, 49152
  s_mov_b32 s28, 1179648
  buffer_load_dwordx4 v5, s[12:15], s28 offen lds
  s_lshl_b32 s29, s21, 10
  s_add_u32 m0, s29, 53248
  s_mov_b32 s28, 1277952
  buffer_load_dwordx4 v5, s[12:15], s28 offen lds
  s_lshl_b32 s29, s21, 10
  s_add_u32 m0, s29, 57344
  s_mov_b32 s28, 1376256
  buffer_load_dwordx4 v5, s[12:15], s28 offen lds
  s_lshl_b32 s29, s21, 10
  s_add_u32 m0, s29, 61440
  s_mov_b32 s28, 1474560
  buffer_load_dwordx4 v5, s[12:15], s28 offen lds
  s_lshl_b32 s29, s21, 10
  s_add_u32 m0, s29, 65536
  s_mov_b32 s28, 1572864
  buffer_load_dwordx4 v5, s[12:15], s28 offen lds
  s_lshl_b32 s29, s21, 10
  s_add_u32 m0, s29, 69632
  s_mov_b32 s28, 1671168
  buffer_load_dwordx4 v5, s[12:15], s28 offen lds
  s_lshl_b32 s29, s21, 10
  s_add_u32 m0, s29, 73728
  s_mov_b32 s28, 1769472
  buffer_load_dwordx4 v5, s[12:15], s28 offen lds
  s_lshl_b32 s29, s21, 10
  s_add_u32 m0, s29, 77824
  s_mov_b32 s28, 1867776
  buffer_load_dwordx4 v5, s[12:15], s28 offen lds
  s_lshl_b32 s29, s21, 10
  s_add_u32 m0, s29, 81920
  s_mov_b32 s28, 1966080
  buffer_load_dwordx4 v5, s[12:15], s28 offen lds
  s_lshl_b32 s29, s21, 10
  s_add_u32 m0, s29, 86016
  s_mov_b32 s28, 2064384
  buffer_load_dwordx4 v5, s[12:15], s28 offen lds
  s_lshl_b32 s29, s21, 10
  s_add_u32 m0, s29, 90112
  s_mov_b32 s28, 2162688
  buffer_load_dwordx4 v5, s[12:15], s28 offen lds
  s_lshl_b32 s29, s21, 10
  s_add_u32 m0, s29, 94208
  s_mov_b32 s28, 2260992
  buffer_load_dwordx4 v5, s[12:15], s28 offen lds
  s_waitcnt vmcnt(20)
  s_cmp_eq_u32 s21, 3
  s_cbranch_scc0 lna_54
  s_mov_b64 s[24:25], exec
  s_mov_b64 exec, 1
  s_and_b32 s45, s2, 7
  s_lshl_b32 s45, s45, 7
  s_add_u32 s45, s45, 10240
  v_mov_b32 v2, s45
  v_mov_b32 v3, 1
  buffer_atomic_add v3, v2, s[8:11], 0 offen
  s_mov_b64 exec, s[24:25]
lna_54:
  s_barrier
  s_lshl_b32 s29, s21, 10
  s_add_u32 m0, s29, 98304
  s_mov_b32 s28, 2359296
  buffer_load_dwordx4 v5, s[12:15], s28 offen lds
  s_lshl_b32 s29, s21, 10
  s_add_u32 m0, s29, 102400
  s_mov_b32 s28, 2457600
  buffer_load_dwordx4 v5, s[12:15], s28 offen lds
  s_lshl_b32 s29, s21, 10
  s_add_u32 m0, s29, 106496
  s_mov_b32 s28, 2555904
  buffer_load_dwordx4 v5, s[12:15], s28 offen lds
  s_lshl_b32 s29, s21, 10
  s_add_u32 m0, s29, 110592
  s_mov_b32 s28, 2654208
  buffer_load_dwordx4 v5, s[12:15], s28 offen lds
  v_add_u32 v8, 0, v7
  ds_read_b64_tr_b16 a[0:1], v8 offset:0
  ds_read_b64_tr_b16 a[2:3], v8 offset:2048
  ds_read_b64_tr_b16 a[4:5], v8 offset:8192
  ds_read_b64_tr_b16 a[6:7], v8 offset:10240
  ds_read_b64_tr_b16 a[160:161], v8 offset:256
  ds_read_b64_tr_b16 a[162:163], v8 offset:2304
  ds_read_b64_tr_b16 a[164:165], v8 offset:8448
  ds_read_b64_tr_b16 a[166:167], v8 offset:10496
  s_waitcnt lgkmcnt(0)
  s_waitcnt vmcnt(20)
  s_barrier
  s_lshl_b32 s29, s21, 10
  s_add_u32 m0, s29, 0
  s_mov_b32 s28, 2752512
  buffer_load_dwordx4 v5, s[12:15], s28 offen lds
  s_lshl_b32 s29, s21, 10
  s_add_u32 m0, s29, 4096
  s_mov_b32 s28, 2850816
  buffer_load_dwordx4 v5, s[12:15], s28 offen lds
  s_lshl_b32 s29, s21, 10
  s_add_u32 m0, s29, 8192
  s_mov_b32 s28, 2949120
  buffer_load_dwordx4 v5, s[12:15], s28 offen lds
  s_lshl_b32 s29, s21, 10
  s_add_u32 m0, s29, 12288
  s_mov_b32 s28, 3047424
  buffer_load_dwordx4 v5, s[12:15], s28 offen lds
  v_add_u32 v8, 16384, v7
  ds_read_b64_tr_b16 a[8:9], v8 offset:0
  ds_read_b64_tr_b16 a[10:11], v8 offset:2048
  ds_read_b64_tr_b16 a[12:13], v8 offset:8192
  ds_read_b64_tr_b16 a[14:15], v8 offset:10240
  ds_read_b64_tr_b16 a[168:169], v8 offset:256
  ds_read_b64_tr_b16 a[170:171], v8 offset:2304
  ds_read_b64_tr_b16 a[172:173], v8 offset:8448
  ds_read_b64_tr_b16 a[174:175], v8 offset:10496
  s_waitcnt lgkmcnt(0)
  s_waitcnt vmcnt(20)
  s_barrier
  s_lshl_b32 s29, s21, 10
  s_add_u32 m0, s29, 16384
  s_mov_b32 s28, 3145728
  buffer_load_dwordx4 v5, s[12:15], s28 offen lds
  s_lshl_b32 s29, s21, 10
  s_add_u32 m0, s29, 20480
  s_mov_b32 s28, 3244032
  buffer_load_dwordx4 v5, s[12:15], s28 offen lds
  s_lshl_b32 s29, s21, 10
  s_add_u32 m0, s29, 24576
  s_mov_b32 s28, 3342336
  buffer_load_dwordx4 v5, s[12:15], s28 offen lds
  s_lshl_b32 s29, s21, 10
  s_add_u32 m0, s29, 28672
  s_mov_b32 s28, 3440640
  buffer_load_dwordx4 v5, s[12:15], s28 offen lds
  v_add_u32 v8, 32768, v7
  ds_read_b64_tr_b16 a[16:17], v8 offset:0
  ds_read_b64_tr_b16 a[18:19], v8 offset:2048
  ds_read_b64_tr_b16 a[20:21], v8 offset:8192
  ds_read_b64_tr_b16 a[22:23], v8 offset:10240
  ds_read_b64_tr_b16 a[176:177], v8 offset:256
  ds_read_b64_tr_b16 a[178:179], v8 offset:2304
  ds_read_b64_tr_b16 a[180:181], v8 offset:8448
  ds_read_b64_tr_b16 a[182:183], v8 offset:10496
  s_waitcnt lgkmcnt(0)
  s_waitcnt vmcnt(20)
  s_barrier
  s_lshl_b32 s29, s21, 10
  s_add_u32 m0, s29, 32768
  s_mov_b32 s28, 3538944
  buffer_load_dwordx4 v5, s[12:15], s28 offen lds
  s_lshl_b32 s29, s21, 10
  s_add_u32 m0, s29, 36864
  s_mov_b32 s28, 3637248
  buffer_load_dwordx4 v5, s[12:15], s28 offen lds
  s_lshl_b32 s29, s21, 10
  s_add_u32 m0, s29, 40960
  s_mov_b32 s28, 3735552
  buffer_load_dwordx4 v5, s[12:15], s28 offen lds
  s_lshl_b32 s29, s21, 10
  s_add_u32 m0, s29, 45056
  s_mov_b32 s28, 3833856
  buffer_load_dwordx4 v5, s[12:15], s28 offen lds
  v_add_u32 v8, 49152, v7
  ds_read_b64_tr_b16 a[24:25], v8 offset:0
  ds_read_b64_tr_b16 a[26:27], v8 offset:2048
  ds_read_b64_tr_b16 a[28:29], v8 offset:8192
  ds_read_b64_tr_b16 a[30:31], v8 offset:10240
  ds_read_b64_tr_b16 a[184:185], v8 offset:256
  ds_read_b64_tr_b16 a[186:187], v8 offset:2304
  ds_read_b64_tr_b16 a[188:189], v8 offset:8448
  ds_read_b64_tr_b16 a[190:191], v8 offset:10496
  s_waitcnt lgkmcnt(0)
  s_waitcnt vmcnt(20)
  s_barrier
  s_lshl_b32 s29, s21, 10
  s_add_u32 m0, s29, 49152
  s_mov_b32 s28, 3932160
  buffer_load_dwordx4 v5, s[12:15], s28 offen lds
  s_lshl_b32 s29, s21, 10
  s_add_u32 m0, s29, 53248
  s_mov_b32 s28, 4030464
  buffer_load_dwordx4 v5, s[12:15], s28 offen lds
  s_lshl_b32 s29, s21, 10
  s_add_u32 m0, s29, 57344
  s_mov_b32 s28, 4128768
  buffer_load_dwordx4 v5, s[12:15], s28 offen lds
  s_lshl_b32 s29, s21, 10
  s_add_u32 m0, s29, 61440
  s_mov_b32 s28, 4227072
  buffer_load_dwordx4 v5, s[12:15], s28 offen lds
  v_add_u32 v8, 65536, v7
  ds_read_b64_tr_b16 a[32:33], v8 offset:0
  ds_read_b64_tr_b16 a[34:35], v8 offset:2048
  ds_read_b64_tr_b16 a[36:37], v8 offset:8192
  ds_read_b64_tr_b16 a[38:39], v8 offset:10240
  ds_read_b64_tr_b16 a[192:193], v8 offset:256
  ds_read_b64_tr_b16 a[194:195], v8 offset:2304
  ds_read_b64_tr_b16 a[196:197], v8 offset:8448
  ds_read_b64_tr_b16 a[198:199], v8 offset:10496
  s_waitcnt lgkmcnt(0)
  s_waitcnt vmcnt(20)
  s_barrier
  s_lshl_b32 s29, s21, 10
  s_add_u32 m0, s29, 65536
  s_mov_b32 s28, 4325376
  buffer_load_dwordx4 v5, s[12:15], s28 offen lds
  s_lshl_b32 s29, s21, 10
  s_add_u32 m0, s29, 69632
  s_mov_b32 s28, 4423680
  buffer_load_dwordx4 v5, s[12:15], s28 offen lds
  s_lshl_b32 s29, s21, 10
  s_add_u32 m0, s29, 73728
  s_mov_b32 s28, 4521984
  buffer_load_dwordx4 v5, s[12:15], s28 offen lds
  s_lshl_b32 s29, s21, 10
  s_add_u32 m0, s29, 77824
  s_mov_b32 s28, 4620288
  buffer_load_dwordx4 v5, s[12:15], s28 offen lds
  v_add_u32 v8, 81920, v7
  ds_read_b64_tr_b16 a[40:41], v8 offset:0
  ds_read_b64_tr_b16 a[42:43], v8 offset:2048
  ds_read_b64_tr_b16 a[44:45], v8 offset:8192
  ds_read_b64_tr_b16 a[46:47], v8 offset:10240
  ds_read_b64_tr_b16 a[200:201], v8 offset:256
  ds_read_b64_tr_b16 a[202:203], v8 offset:2304
  ds_read_b64_tr_b16 a[204:205], v8 offset:8448
  ds_read_b64_tr_b16 a[206:207], v8 offset:10496
  s_waitcnt lgkmcnt(0)
  s_waitcnt vmcnt(20)
  s_barrier
  s_lshl_b32 s29, s21, 10
  s_add_u32 m0, s29, 81920
  s_mov_b32 s28, 4718592
  buffer_load_dwordx4 v5, s[12:15], s28 offen lds
  s_lshl_b32 s29, s21, 10
  s_add_u32 m0, s29, 86016
  s_mov_b32 s28, 4816896
  buffer_load_dwordx4 v5, s[12:15], s28 offen lds
  s_lshl_b32 s29, s21, 10
  s_add_u32 m0, s29, 90112
  s_mov_b32 s28, 4915200
  buffer_load_dwordx4 v5, s[12:15], s28 offen lds
  s_lshl_b32 s29, s21, 10
  s_add_u32 m0, s29, 94208
  s_mov_b32 s28, 5013504
  buffer_load_dwordx4 v5, s[12:15], s28 offen lds
  buffer_load_dword v13, v15, s[8:11], 0 offen sc1
  v_add_u32 v8, 98304, v7
  ds_read_b64_tr_b16 a[48:49], v8 offset:0
  ds_read_b64_tr_b16 a[50:51], v8 offset:2048
  ds_read_b64_tr_b16 a[52:53], v8 offset:8192
  ds_read_b64_tr_b16 a[54:55], v8 offset:10240
  ds_read_b64_tr_b16 a[208:209], v8 offset:256
  ds_read_b64_tr_b16 a[210:211], v8 offset:2304
  ds_read_b64_tr_b16 a[212:213], v8 offset:8448
  ds_read_b64_tr_b16 a[214:215], v8 offset:10496
  s_waitcnt lgkmcnt(0)
  s_waitcnt vmcnt(21)
  s_barrier
  s_lshl_b32 s29, s21, 10
  s_add_u32 m0, s29, 98304
  s_mov_b32 s28, 5111808
  buffer_load_dwordx4 v5, s[12:15], s28 offen lds
  s_lshl_b32 s29, s21, 10
  s_add_u32 m0, s29, 102400
  s_mov_b32 s28, 5210112
  buffer_load_dwordx4 v5, s[12:15], s28 offen lds
  s_lshl_b32 s29, s21, 10
  s_add_u32 m0, s29, 106496
  s_mov_b32 s28, 5308416
  buffer_load_dwordx4 v5, s[12:15], s28 offen lds
  s_lshl_b32 s29, s21, 10
  s_add_u32 m0, s29, 110592
  s_mov_b32 s28, 5406720
  buffer_load_dwordx4 v5, s[12:15], s28 offen lds
  v_add_u32 v8, 0, v7
  ds_read_b64_tr_b16 a[56:57], v8 offset:0
  ds_read_b64_tr_b16 a[58:59], v8 offset:2048
  ds_read_b64_tr_b16 a[60:61], v8 offset:8192
  ds_read_b64_tr_b16 a[62:63], v8 offset:10240
  ds_read_b64_tr_b16 a[216:217], v8 offset:256
  ds_read_b64_tr_b16 a[218:219], v8 offset:2304
  ds_read_b64_tr_b16 a[220:221], v8 offset:8448
  ds_read_b64_tr_b16 a[222:223], v8 offset:10496
  s_waitcnt lgkmcnt(0)
  s_waitcnt vmcnt(21)
  s_barrier
  s_lshl_b32 s29, s21, 10
  s_add_u32 m0, s29, 0
  s_mov_b32 s28, 5505024
  buffer_load_dwordx4 v5, s[12:15], s28 offen lds
  s_lshl_b32 s29, s21, 10
  s_add_u32 m0, s29, 4096
  s_mov_b32 s28, 5603328
  buffer_load_dwordx4 v5, s[12:15], s28 offen lds
  s_lshl_b32 s29, s21, 10
  s_add_u32 m0, s29, 8192
  s_mov_b32 s28, 5701632
  buffer_load_dwordx4 v5, s[12:15], s28 offen lds
  s_lshl_b32 s29, s21, 10
  s_add_u32 m0, s29, 12288
  s_mov_b32 s28, 5799936
  buffer_load_dwordx4 v5, s[12:15], s28 offen lds
  v_add_u32 v8, 16384, v7
  ds_read_b64_tr_b16 a[64:65], v8 offset:0
  ds_read_b64_tr_b16 a[66:67], v8 offset:2048
  ds_read_b64_tr_b16 a[68:69], v8 offset:8192
  ds_read_b64_tr_b16 a[70:71], v8 offset:10240
  ds_read_b64_tr_b16 a[224:225], v8 offset:256
  ds_read_b64_tr_b16 a[226:227], v8 offset:2304
  ds_read_b64_tr_b16 a[228:229], v8 offset:8448
  ds_read_b64_tr_b16 a[230:231], v8 offset:10496
  s_waitcnt lgkmcnt(0)
  s_waitcnt vmcnt(21)
  s_barrier
  s_lshl_b32 s29, s21, 10
  s_add_u32 m0, s29, 16384
  s_mov_b32 s28, 5898240
  buffer_load_dwordx4 v5, s[12:15], s28 offen lds
  s_lshl_b32 s29, s21, 10
  s_add_u32 m0, s29, 20480
  s_mov_b32 s28, 5996544
  buffer_load_dwordx4 v5, s[12:15], s28 offen lds
  s_lshl_b32 s29, s21, 10
  s_add_u32 m0, s29, 24576
  s_mov_b32 s28, 6094848
  buffer_load_dwordx4 v5, s[12:15], s28 offen lds
  s_lshl_b32 s29, s21, 10
  s_add_u32 m0, s29, 28672
  s_mov_b32 s28, 6193152
  buffer_load_dwordx4 v5, s[12:15], s28 offen lds
  v_add_u32 v8, 32768, v7
  ds_read_b64_tr_b16 a[72:73], v8 offset:0
  ds_read_b64_tr_b16 a[74:75], v8 offset:2048
  ds_read_b64_tr_b16 a[76:77], v8 offset:8192
  ds_read_b64_tr_b16 a[78:79], v8 offset:10240
  ds_read_b64_tr_b16 a[232:233], v8 offset:256
  ds_read_b64_tr_b16 a[234:235], v8 offset:2304
  ds_read_b64_tr_b16 a[236:237], v8 offset:8448
  ds_read_b64_tr_b16 a[238:239], v8 offset:10496
  s_waitcnt lgkmcnt(0)
  s_waitcnt vmcnt(21)
  s_barrier
  s_lshl_b32 s29, s21, 10
  s_add_u32 m0, s29, 32768
  s_mov_b32 s28, 6291456
  buffer_load_dwordx4 v5, s[12:15], s28 offen lds
  s_lshl_b32 s29, s21, 10
  s_add_u32 m0, s29, 36864
  s_mov_b32 s28, 6389760
  buffer_load_dwordx4 v5, s[12:15], s28 offen lds
  s_lshl_b32 s29, s21, 10
  s_add_u32 m0, s29, 40960
  s_mov_b32 s28, 6488064
  buffer_load_dwordx4 v5, s[12:15], s28 offen lds
  s_lshl_b32 s29, s21, 10
  s_add_u32 m0, s29, 45056
  s_mov_b32 s28, 6586368
  buffer_load_dwordx4 v5, s[12:15], s28 offen lds
  v_add_u32 v8, 49152, v7
  ds_read_b64_tr_b16 a[80:81], v8 offset:0
  ds_read_b64_tr_b16 a[82:83], v8 offset:2048
  ds_read_b64_tr_b16 a[84:85], v8 offset:8192
  ds_read_b64_tr_b16 a[86:87], v8 offset:10240
  ds_read_b64_tr_b16 a[240:241], v8 offset:256
  ds_read_b64_tr_b16 a[242:243], v8 offset:2304
  ds_read_b64_tr_b16 a[244:245], v8 offset:8448
  ds_read_b64_tr_b16 a[246:247], v8 offset:10496
  s_waitcnt lgkmcnt(0)
  s_waitcnt vmcnt(21)
  s_barrier
  s_lshl_b32 s29, s21, 10
  s_add_u32 m0, s29, 49152
  s_mov_b32 s28, 6684672
  buffer_load_dwordx4 v5, s[12:15], s28 offen lds
  s_lshl_b32 s29, s21, 10
  s_add_u32 m0, s29, 53248
  s_mov_b32 s28, 6782976
  buffer_load_dwordx4 v5, s[12:15], s28 offen lds
  s_lshl_b32 s29, s21, 10
  s_add_u32 m0, s29, 57344
  s_mov_b32 s28, 6881280
  buffer_load_dwordx4 v5, s[12:15], s28 offen lds
  s_lshl_b32 s29, s21, 10
  s_add_u32 m0, s29, 61440
  s_mov_b32 s28, 6979584
  buffer_load_dwordx4 v5, s[12:15], s28 offen lds
  v_add_u32 v8, 65536, v7
  ds_read_b64_tr_b16 a[88:89], v8 offset:0
  ds_read_b64_tr_b16 a[90:91], v8 offset:2048
  ds_read_b64_tr_b16 a[92:93], v8 offset:8192
  ds_read_b64_tr_b16 a[94:95], v8 offset:10240
  ds_read_b64_tr_b16 a[248:249], v8 offset:256
  ds_read_b64_tr_b16 a[250:251], v8 offset:2304
  ds_read_b64_tr_b16 a[252:253], v8 offset:8448
  ds_read_b64_tr_b16 a[254:255], v8 offset:10496
  s_waitcnt lgkmcnt(0)
  s_waitcnt vmcnt(21)
  s_barrier
  s_lshl_b32 s29, s21, 10
  s_add_u32 m0, s29, 65536
  s_mov_b32 s28, 7077888
  buffer_load_dwordx4 v5, s[12:15], s28 offen lds
  s_lshl_b32 s29, s21, 10
  s_add_u32 m0, s29, 69632
  s_mov_b32 s28, 7176192
  buffer_load_dwordx4 v5, s[12:15], s28 offen lds
  s_lshl_b32 s29, s21, 10
  s_add_u32 m0, s29, 73728
  s_mov_b32 s28, 7274496
  buffer_load_dwordx4 v5, s[12:15], s28 offen lds
  s_lshl_b32 s29, s21, 10
  s_add_u32 m0, s29, 77824
  s_mov_b32 s28, 7372800
  buffer_load_dwordx4 v5, s[12:15], s28 offen lds
  v_add_u32 v8, 81920, v7
  ds_read_b64_tr_b16 a[96:97], v8 offset:0
  ds_read_b64_tr_b16 a[98:99], v8 offset:2048
  ds_read_b64_tr_b16 a[100:101], v8 offset:8192
  ds_read_b64_tr_b16 a[102:103], v8 offset:10240
  ds_read_b64_tr_b16 v[192:193], v8 offset:256
  ds_read_b64_tr_b16 v[194:195], v8 offset:2304
  ds_read_b64_tr_b16 v[196:197], v8 offset:8448
  ds_read_b64_tr_b16 v[198:199], v8 offset:10496
  s_waitcnt lgkmcnt(0)
  s_waitcnt vmcnt(20)
  v_min_u32_dpp v2, v13, v13 quad_perm:[1,0,3,2] row_mask:0xf bank_mask:0xf
  s_nop 1
  v_min_u32_dpp v3, v2, v2 quad_perm:[2,3,0,1] row_mask:0xf bank_mask:0xf
  s_nop 1
  v_min_u32_dpp v2, v3, v3 row_half_mirror row_mask:0xf bank_mask:0xf
  s_nop 0
  v_readfirstlane_b32 s28, v2
  s_cmp_ge_u32 s28, 32
  s_cbranch_scc1 xw_55_ok
  s_mov_b32 s45, 0
xw_55:
  buffer_load_dword v13, v15, s[8:11], 0 offen sc1
  s_add_u32 s45, s45, 1
  s_waitcnt vmcnt(0)
  v_min_u32_dpp v2, v13, v13 quad_perm:[1,0,3,2] row_mask:0xf bank_mask:0xf
  s_nop 1
  v_min_u32_dpp v3, v2, v2 quad_perm:[2,3,0,1] row_mask:0xf bank_mask:0xf
  s_nop 1
  v_min_u32_dpp v2, v3, v3 row_half_mirror row_mask:0xf bank_mask:0xf
  s_nop 0
  v_readfirstlane_b32 s28, v2
  s_cmp_ge_u32 s28, 32
  s_cbranch_scc1 xw_55_ok
  s_cmp_lt_u32 s45, 400000
  s_cbranch_scc1 xw_55
  s_branch ka_abort
xw_55_ok:
  s_lshl_b32 s29, s21, 10
  s_add_u32 m0, s29, 122880
  s_add_u32 s28, s51, 0
  buffer_load_dwordx4 v6, s[8:11], s28 offen sc1 lds
  s_lshl_b32 s29, s21, 10
  s_add_u32 m0, s29, 126976
  s_add_u32 s28, s51, 4096
  buffer_load_dwordx4 v6, s[8:11], s28 offen sc1 lds
  s_lshl_b32 s29, s21, 10
  s_add_u32 m0, s29, 131072
  s_add_u32 s28, s51, 8192
  buffer_load_dwordx4 v6, s[8:11], s28 offen sc1 lds
  s_lshl_b32 s29, s21, 10
  s_add_u32 m0, s29, 135168
  s_add_u32 s28, s51, 12288
  buffer_load_dwordx4 v6, s[8:11], s28 offen sc1 lds
  s_lshl_b32 s29, s21, 10
  s_add_u32 m0, s29, 139264
  s_add_u32 s28, s51, 16384
  buffer_load_dwordx4 v6, s[8:11], s28 offen sc1 lds
  s_lshl_b32 s29, s21, 10
  s_add_u32 m0, s29, 143360
  s_add_u32 s28, s51, 20480
  buffer_load_dwordx4 v6, s[8:11], s28 offen sc1 lds
  s_lshl_b32 s29, s21, 10
  s_add_u32 m0, s29, 147456
  s_add_u32 s28, s51, 24576
  buffer_load_dwordx4 v6, s[8:11], s28 offen sc1 lds
  s_lshl_b32 s29, s21, 10
  s_add_u32 m0, s29, 151552
  s_add_u32 s28, s51, 28672
  buffer_load_dwordx4 v6, s[8:11], s28 offen sc1 lds
  s_lshl_b32 s29, s21, 10
  s_add_u32 m0, s29, 155648
  s_add_u32 s28, s51, 32768
  buffer_load_dwordx4 v6, s[8:11], s28 offen sc1 lds
  s_lshl_b32 s29, s21, 10
  s_add_u32 m0, s29, 159744
  s_add_u32 s28, s51, 36864
  buffer_load_dwordx4 v6, s[8:11], s28 offen sc1 lds
  s_add_u32 s51, s51, 40960
  s_barrier
  s_lshl_b32 s29, s21, 10
  s_add_u32 m0, s29, 81920
  s_mov_b32 s28, 7471104
  buffer_load_dwordx4 v5, s[12:15], s28 offen lds
  s_lshl_b32 s29, s21, 10
  s_add_u32 m0, s29, 86016
  s_mov_b32 s28, 7569408
  buffer_load_dwordx4 v5, s[12:15], s28 offen lds
  s_lshl_b32 s29, s21, 10
  s_add_u32 m0, s29, 90112
  s_mov_b32 s28, 7667712
  buffer_load_dwordx4 v5, s[12:15], s28 offen lds
  s_lshl_b32 s29, s21, 10
  s_add_u32 m0, s29, 94208
  s_mov_b32 s28, 7766016
  buffer_load_dwordx4 v5, s[12:15], s28 offen lds
  v_add_u32 v8, 98304, v7
  ds_read_b64_tr_b16 a[104:105], v8 offset:0
  ds_read_b64_tr_b16 a[106:107], v8 offset:2048
  ds_read_b64_tr_b16 a[108:109], v8 offset:8192
  ds_read_b64_tr_b16 a[110:111], v8 offset:10240
  ds_read_b64_tr_b16 v[200:201], v8 offset:256
  ds_read_b64_tr_b16 v[202:203], v8 offset:2304
  ds_read_b64_tr_b16 v[204:205], v8 offset:8448
  ds_read_b64_tr_b16 v[206:207], v8 offset:10496
  s_waitcnt lgkmcnt(0)
  s_waitcnt vmcnt(30)
  s_barrier
  v_add_u32 v8, 0, v7
  ds_read_b64_tr_b16 a[112:113], v8 offset:0
  ds_read_b64_tr_b16 a[114:115], v8 offset:2048
  ds_read_b64_tr_b16 a[116:117], v8 offset:8192
  ds_read_b64_tr_b16 a[118:119], v8 offset:10240
  ds_read_b64_tr_b16 v[208:209], v8 offset:256
  ds_read_b64_tr_b16 v[210:211], v8 offset:2304
  ds_read_b64_tr_b16 v[212:213], v8 offset:8448
  ds_read_b64_tr_b16 v[214:215], v8 offset:10496
  s_waitcnt lgkmcnt(0)
  s_waitcnt vmcnt(26)
  s_barrier
  v_add_u32 v8, 16384, v7
  ds_read_b64_tr_b16 a[120:121], v8 offset:0
  ds_read_b64_tr_b16 a[122:123], v8 offset:2048
  ds_read_b64_tr_b16 a[124:125], v8 offset:8192
  ds_read_b64_tr_b16 a[126:127], v8 offset:10240
  ds_read_b64_tr_b16 v[216:217], v8 offset:256
  ds_read_b64_tr_b16 v[218:219], v8 offset:2304
  ds_read_b64_tr_b16 v[220:221], v8 offset:8448
  ds_read_b64_tr_b16 v[222:223], v8 offset:10496
  s_waitcnt lgkmcnt(0)
  s_waitcnt vmcnt(22)
  s_barrier
  v_add_u32 v8, 32768, v7
  ds_read_b64_tr_b16 a[128:129], v8 offset:0
  ds_read_b64_tr_b16 a[130:131], v8 offset:2048
  ds_read_b64_tr_b16 a[132:133], v8 offset:8192
  ds_read_b64_tr_b16 a[134:135], v8 offset:10240
  ds_read_b64_tr_b16 v[224:225], v8 offset:256
  ds_read_b64_tr_b16 v[226:227], v8 offset:2304
  ds_read_b64_tr_b16 v[228:229], v8 offset:8448
  ds_read_b64_tr_b16 v[230:231], v8 offset:10496
  s_waitcnt lgkmcnt(0)
  s_waitcnt vmcnt(18)
  s_barrier
  v_add_u32 v8, 49152, v7
  ds_read_b64_tr_b16 a[136:137], v8 offset:0
  ds_read_b64_tr_b16 a[138:139], v8 offset:2048
  ds_read_b64_tr_b16 a[140:141], v8 offset:8192
  ds_read_b64_tr_b16 a[142:143], v8 offset:10240
  ds_read_b64_tr_b16 v[232:233], v8 offset:256
  ds_read_b64_tr_b16 v[234:235], v8 offset:2304
  ds_read_b64_tr_b16 v[236:237], v8 offset:8448
  ds_read_b64_tr_b16 v[238:239], v8 offset:10496
  s_waitcnt lgkmcnt(0)
  s_waitcnt vmcnt(14)
  s_barrier
  v_add_u32 v8, 65536, v7
  ds_read_b64_tr_b16 a[144:145], v8 offset:0
  ds_read_b64_tr_b16 a[146:147], v8 offset:2048
  ds_read_b64_tr_b16 a[148:149], v8 offset:8192
  ds_read_b64_tr_b16 a[150:151], v8 offset:10240
  ds_read_b64_tr_b16 v[240:241], v8 offset:256
  ds_read_b64_tr_b16 v[242:243], v8 offset:2304
  ds_read_b64_tr_b16 v[244:245], v8 offset:8448
  ds_read_b64_tr_b16 v[246:247], v8 offset:10496
  s_waitcnt lgkmcnt(0)
  s_waitcnt vmcnt(0)
  s_barrier
  v_add_u32 v8, 81920, v7
  ds_read_b64_tr_b16 a[152:153], v8 offset:0
  ds_read_b64_tr_b16 a[154:155], v8 offset:2048
  ds_read_b64_tr_b16 a[156:157], v8 offset:8192
  ds_read_b64_tr_b16 a[158:159], v8 offset:10240
  ds_read_b64_tr_b16 v[248:249], v8 offset:256
  ds_read_b64_tr_b16 v[250:251], v8 offset:2304
  ds_read_b64_tr_b16 v[252:253], v8 offset:8448
  ds_read_b64_tr_b16 v[254:255], v8 offset:10496
  s_waitcnt lgkmcnt(0)
  s_barrier
  v_lshlrev_b32 v5, 4, v1
  v_add_u32 v9, 122880, v5
  v_mov_b32 v10, v5
  v_bfe_u32 v2, v1, 4, 1
  v_lshlrev_b32 v11, 10, v2
  v_and_b32 v2, 15, v1
  v_lshlrev_b32 v2, 4, v2
  v_add_u32 v11, v11, v2
  v_lshrrev_b32 v2, 5, v1
  v_lshlrev_b32 v2, 9, v2
  v_add_u32 v11, v11, v2
  v_mov_b32 v12, s47
  s_mov_b32 s50, 0
ka_qkv_loop:
  s_cmp_eq_u32 s50, 0
  s_cbranch_scc0 q0_56
  s_waitcnt vmcnt(0)
q0_56:
  s_waitcnt vmcnt(4)
  s_barrier
  s_cmp_ge_u32 s50, 63
  s_cbranch_scc1 qn_57_n
  s_lshl_b32 s29, s21, 10
  s_add_u32 m0, s29, 0
  s_add_u32 s28, s51, 0
  buffer_load_dwordx4 v6, s[8:11], s28 offen sc1 lds
  s_lshl_b32 s29, s21, 10
  s_add_u32 m0, s29, 4096
  s_add_u32 s28, s51, 4096
  buffer_load_dwordx4 v6, s[8:11], s28 offen sc1 lds
  s_lshl_b32 s29, s21, 10
  s_add_u32 m0, s29, 8192
  s_add_u32 s28, s51, 8192
  buffer_load_dwordx4 v6, s[8:11], s28 offen sc1 lds
  s_lshl_b32 s29, s21, 10
  s_add_u32 m0, s29, 12288
  s_add_u32 s28, s51, 12288
  buffer_load_dwordx4 v6, s[8:11], s28 offen sc1 lds
  s_lshl_b32 s29, s21, 10
  s_add_u32 m0, s29, 16384
  s_add_u32 s28, s51, 16384
  buffer_load_dwordx4 v6, s[8:11], s28 offen sc1 lds
  s_lshl_b32 s29, s21, 10
  s_add_u32 m0, s29, 20480
  s_add_u32 s28, s51, 20480
  buffer_load_dwordx4 v6, s[8:11], s28 offen sc1 lds
  s_lshl_b32 s29, s21, 10
  s_add_u32 m0, s29, 24576
  s_add_u32 s28, s51, 24576
  buffer_load_dwordx4 v6, s[8:11], s28 offen sc1 lds
  s_lshl_b32 s29, s21, 10
  s_add_u32 m0, s29, 28672
  s_add_u32 s28, s51, 28672
  buffer_load_dwordx4 v6, s[8:11], s28 offen sc1 lds
  s_lshl_b32 s29, s21, 10
  s_add_u32 m0, s29, 32768
  s_add_u32 s28, s51, 32768
  buffer_load_dwordx4 v6, s[8:11], s28 offen sc1 lds
  s_lshl_b32 s29, s21, 10
  s_add_u32 m0, s29, 36864
  s_add_u32 s28, s51, 36864
  buffer_load_dwordx4 v6, s[8:11], s28 offen sc1 lds
  s_add_u32 s51, s51, 40960
  s_branch qn_57
qn_57_n:
  s_waitcnt vmcnt(0)
qn_57:
  ds_read_b128 v[128:131], v9 offset:0
  ds_read_b128 v[132:135], v9 offset:1024
  ds_read_b128 v[136:139], v9 offset:2048
  ds_read_b128 v[140:143], v9 offset:3072
  s_waitcnt lgkmcnt(3)
  v_mfma_f32_32x32x16_bf16 v[64:79], a[0:3], v[128:131], 0
  v_mfma_f32_32x32x16_bf16 v[80:95], a[160:163], v[128:131], 0
  ds_read_b128 v[128:131], v9 offset:4096
  s_waitcnt lgkmcnt(3)
  v_mfma_f32_32x32x16_bf16 v[64:79], a[4:7], v[132:135], v[64:79]
  v_mfma_f32_32x32x16_bf16 v[80:95], a[164:167], v[132:135], v[80:95]
  ds_read_b128 v[132:135], v9 offset:5120
  s_waitcnt lgkmcnt(3)
  v_mfma_f32_32x32x16_bf16 v[64:79], a[8:11], v[136:139], v[64:79]
  v_mfma_f32_32x32x16_bf16 v[80:95], a[168:171], v[136:139], v[80:95]
  ds_read_b128 v[136:139], v9 offset:6144
  s_waitcnt lgkmcnt(3)
  v_mfma_f32_32x32x16_bf16 v[64:79], a[12:15], v[140:143], v[64:79]
  v_mfma_f32_32x32x16_bf16 v[80:95], a[172:175], v[140:143], v[80:95]
  ds_read_b128 v[140:143], v9 offset:7168
  s_waitcnt lgkmcnt(3)
  v_mfma_f32_32x32x16_bf16 v[64:79], a[16:19], v[128:131], v[64:79]
  v_mfma_f32_32x32x16_bf16 v[80:95], a[176:179], v[128:131], v[80:95]
  ds_read_b128 v[128:131], v9 offset:8192
  s_waitcnt lgkmcnt(3)
  v_mfma_f32_32x32x16_bf16 v[64:79], a[20:23], v[132:135], v[64:79]
  v_mfma_f32_32x32x16_bf16 v[80:95], a[180:183], v[132:135], v[80:95]
  ds_read_b128 v[132:135], v9 offset:9216
  s_waitcnt lgkmcnt(3)
  v_mfma_f32_32x32x16_bf16 v[64:79], a[24:27], v[136:139], v[64:79]
  v_mfma_f32_32x32x16_bf16 v[80:95], a[184:187], v[136:139], v[80:95]
  ds_read_b128 v[136:139], v9 offset:10240
  s_waitcnt lgkmcnt(3)
  v_mfma_f32_32x32x16_bf16 v[64:79], a[28:31], v[140:143], v[64:79]
  v_mfma_f32_32x32x16_bf16 v[80:95], a[188:191], v[140:143], v[80:95]
  ds_read_b128 v[140:143], v9 offset:11264
  s_waitcnt lgkmcnt(3)
  v_mfma_f32_32x32x16_bf16 v[64:79], a[32:35], v[128:131], v[64:79]
  v_mfma_f32_32x32x16_bf16 v[80:95], a[192:195], v[128:131], v[80:95]
  ds_read_b128 v[128:131], v9 offset:12288
  s_waitcnt lgkmcnt(3)
  v_mfma_f32_32x32x16_bf16 v[64:79], a[36:39], v[132:135], v[64:79]
  v_mfma_f32_32x32x16_bf16 v[80:95], a[196:199], v[132:135], v[80:95]
  ds_read_b128 v[132:135], v9 offset:13312
  s_waitcnt lgkmcnt(3)
  v_mfma_f32_32x32x16_bf16 v[64:79], a[40:43], v[136:139], v[64:79]
  v_mfma_f32_32x32x16_bf16 v[80:95], a[200:203], v[136:139], v[80:95]
  ds_read_b128 v[136:139], v9 offset:14336
  s_waitcnt lgkmcnt(3)
  v_mfma_f32_32x32x16_bf16 v[64:79], a[44:47], v[140:143], v[64:79]
  v_mfma_f32_32x32x16_bf16 v[80:95], a[204:207], v[140:143], v[80:95]
  ds_read_b128 v[140:143], v9 offset:15360
  s_waitcnt lgkmcnt(3)
  v_mfma_f32_32x32x16_bf16 v[64:79], a[48:51], v[128:131], v[64:79]
  v_mfma_f32_32x32x16_bf16 v[80:95], a[208:211], v[128:131], v[80:95]
  ds_read_b128 v[128:131], v9 offset:16384
  s_waitcnt lgkmcnt(3)
  v_mfma_f32_32x32x16_bf16 v[64:79], a[52:55], v[132:135], v[64:79]
  v_mfma_f32_32x32x16_bf16 v[80:95], a[212:215], v[132:135], v[80:95]
  ds_read_b128 v[132:135], v9 offset:17408
  s_waitcnt lgkmcnt(3)
  v_mfma_f32_32x32x16_bf16 v[64:79], a[56:59], v[136:139], v[64:79]
  v_mfma_f32_32x32x16_bf16 v[80:95], a[216:219], v[136:139], v[80:95]
  ds_read_b128 v[136:139], v9 offset:18432
  s_waitcnt lgkmcnt(3)
  v_mfma_f32_32x32x16_bf16 v[64:79], a[60:63], v[140:143], v[64:79]
  v_mfma_f32_32x32x16_bf16 v[80:95], a[220:223], v[140:143], v[80:95]
  ds_read_b128 v[140:143], v9 offset:19456
  s_waitcnt lgkmcnt(3)
  v_mfma_f32_32x32x16_bf16 v[64:79], a[64:67], v[128:131], v[64:79]
  v_mfma_f32_32x32x16_bf16 v[80:95], a[224:227], v[128:131], v[80:95]
  ds_read_b128 v[128:131], v9 offset:20480
  s_waitcnt lgkmcnt(3)
  v_mfma_f32_32x32x16_bf16 v[64:79], a[68:71], v[132:135], v[64:79]
  v_mfma_f32_32x32x16_bf16 v[80:95], a[228:231], v[132:135], v[80:95]
  ds_read_b128 v[132:135], v9 offset:21504
  s_waitcnt lgkmcnt(3)
  v_mfma_f32_32x32x16_bf16 v[64:79], a[72:75], v[136:139], v[64:79]
  v_mfma_f32_32x32x16_bf16 v[80:95], a[232:235], v[136:139], v[80:95]
  ds_read_b128 v[136:139], v9 offset:22528
  s_waitcnt lgkmcnt(3)
  v_mfma_f32_32x32x16_bf16 v[64:79], a[76:79], v[140:143], v[64:79]
  v_mfma_f32_32x32x16_bf16 v[80:95], a[236:239], v[140:143], v[80:95]
  ds_read_b128 v[140:143], v9 offset:23552
  s_waitcnt lgkmcnt(3)
  v_mfma_f32_32x32x16_bf16 v[64:79], a[80:83], v[128:131], v[64:79]
  v_mfma_f32_32x32x16_bf16 v[80:95], a[240:243], v[128:131], v[80:95]
  ds_read_b128 v[128:131], v9 offset:24576
  s_waitcnt lgkmcnt(3)
  v_mfma_f32_32x32x16_bf16 v[64:79], a[84:87], v[132:135], v[64:79]
  v_mfma_f32_32x32x16_bf16 v[80:95], a[244:247], v[132:135], v[80:95]
  ds_read_b128 v[132:135], v9 offset:25600
  s_waitcnt lgkmcnt(3)
  v_mfma_f32_32x32x16_bf16 v[64:79], a[88:91], v[136:139], v[64:79]
  v_mfma_f32_32x32x16_bf16 v[80:95], a[248:251], v[136:139], v[80:95]
  ds_read_b128 v[136:139], v9 offset:26624
  s_waitcnt lgkmcnt(3)
  v_mfma_f32_32x32x16_bf16 v[64:79], a[92:95], v[140:143], v[64:79]
  v_mfma_f32_32x32x16_bf16 v[80:95], a[252:255], v[140:143], v[80:95]
  ds_read_b128 v[140:143], v9 offset:27648
  s_cmp_le_u32 s50, 2
  s_cbranch_scc1 mp_58
  s_waitcnt vmcnt(10)
  s_barrier
  s_cmp_eq_u32 s21, 0
  s_cbranch_scc0 mp_58
  v_mov_b32 v13, s50
  s_mov_b64 s[24:25], exec
  s_mov_b64 exec, 1
  buffer_store_dword v13, v12, s[8:11], 0 offen sc1
  s_mov_b64 exec, s[24:25]
mp_58:
  s_waitcnt lgkmcnt(3)
  v_mfma_f32_32x32x16_bf16 v[64:79], a[96:99], v[128:131], v[64:79]
  v_mfma_f32_32x32x16_bf16 v[80:95], v[192:195], v[128:131], v[80:95]
  ds_read_b128 v[128:131], v9 offset:28672
  s_waitcnt lgkmcnt(3)
  v_mfma_f32_32x32x16_bf16 v[64:79], a[100:103], v[132:135], v[64:79]
  v_mfma_f32_32x32x16_bf16 v[80:95], v[196:199], v[132:135], v[80:95]
  ds_read_b128 v[132:135], v9 offset:29696
  s_waitcnt lgkmcnt(3)
  v_mfma_f32_32x32x16_bf16 v[64:79], a[104:107], v[136:139], v[64:79]
  v_mfma_f32_32x32x16_bf16 v[80:95], v[200:203], v[136:139], v[80:95]
  ds_read_b128 v[136:139], v9 offset:30720
  s_waitcnt lgkmcnt(3)
  v_mfma_f32_32x32x16_bf16 v[64:79], a[108:111], v[140:143], v[64:79]
  v_mfma_f32_32x32x16_bf16 v[80:95], v[204:207], v[140:143], v[80:95]
  ds_read_b128 v[140:143], v9 offset:31744
  s_waitcnt lgkmcnt(3)
  v_mfma_f32_32x32x16_bf16 v[64:79], a[112:115], v[128:131], v[64:79]
  v_mfma_f32_32x32x16_bf16 v[80:95], v[208:211], v[128:131], v[80:95]
  ds_read_b128 v[128:131], v9 offset:32768
  s_waitcnt lgkmcnt(3)
  v_mfma_f32_32x32x16_bf16 v[64:79], a[116:119], v[132:135], v[64:79]
  v_mfma_f32_32x32x16_bf16 v[80:95], v[212:215], v[132:135], v[80:95]
  ds_read_b128 v[132:135], v9 offset:33792
  s_waitcnt lgkmcnt(3)
  v_mfma_f32_32x32x16_bf16 v[64:79], a[120:123], v[136:139], v[64:79]
  v_mfma_f32_32x32x16_bf16 v[80:95], v[216:219], v[136:139], v[80:95]
  ds_read_b128 v[136:139], v9 offset:34816
  s_waitcnt lgkmcnt(3)
  v_mfma_f32_32x32x16_bf16 v[64:79], a[124:127], v[140:143], v[64:79]
  v_mfma_f32_32x32x16_bf16 v[80:95], v[220:223], v[140:143], v[80:95]
  ds_read_b128 v[140:143], v9 offset:35840
  s_waitcnt lgkmcnt(3)
  v_mfma_f32_32x32x16_bf16 v[64:79], a[128:131], v[128:131], v[64:79]
  v_mfma_f32_32x32x16_bf16 v[80:95], v[224:227], v[128:131], v[80:95]
  ds_read_b128 v[128:131], v9 offset:36864
  s_waitcnt lgkmcnt(3)
  v_mfma_f32_32x32x16_bf16 v[64:79], a[132:135], v[132:135], v[64:79]
  v_mfma_f32_32x32x16_bf16 v[80:95], v[228:231], v[132:135], v[80:95]
  ds_read_b128 v[132:135], v9 offset:37888
  s_waitcnt lgkmcnt(3)
  v_mfma_f32_32x32x16_bf16 v[64:79], a[136:139], v[136:139], v[64:79]
  v_mfma_f32_32x32x16_bf16 v[80:95], v[232:235], v[136:139], v[80:95]
  ds_read_b128 v[136:139], v9 offset:38912
  s_waitcnt lgkmcnt(3)
  v_mfma_f32_32x32x16_bf16 v[64:79], a[140:143], v[140:143], v[64:79]
  v_mfma_f32_32x32x16_bf16 v[80:95], v[236:239], v[140:143], v[80:95]
  ds_read_b128 v[140:143], v9 offset:39936
  s_waitcnt lgkmcnt(3)
  v_mfma_f32_32x32x16_bf16 v[64:79], a[144:147], v[128:131], v[64:79]
  v_mfma_f32_32x32x16_bf16 v[80:95], v[240:243], v[128:131], v[80:95]
  s_waitcnt lgkmcnt(2)
  v_mfma_f32_32x32x16_bf16 v[64:79], a[148:151], v[132:135], v[64:79]
  v_mfma_f32_32x32x16_bf16 v[80:95], v[244:247], v[132:135], v[80:95]
  s_waitcnt lgkmcnt(1)
  v_mfma_f32_32x32x16_bf16 v[64:79], a[152:155], v[136:139], v[64:79]
  v_mfma_f32_32x32x16_bf16 v[80:95], v[248:251], v[136:139], v[80:95]
  s_waitcnt lgkmcnt(0)
  v_mfma_f32_32x32x16_bf16 v[64:79], a[156:159], v[140:143], v[64:79]
  v_mfma_f32_32x32x16_bf16 v[80:95], v[252:255], v[140:143], v[80:95]
  s_nop 11
  v_cvt_pk_bf16_f32 v144, v64, v65
  v_cvt_pk_bf16_f32 v145, v66, v67
  v_cvt_pk_bf16_f32 v146, v68, v69
  v_cvt_pk_bf16_f32 v147, v70, v71
  v_cvt_pk_bf16_f32 v148, v72, v73
  v_cvt_pk_bf16_f32 v149, v74, v75
  v_cvt_pk_bf16_f32 v150, v76, v77
  v_cvt_pk_bf16_f32 v151, v78, v79
  v_cvt_pk_bf16_f32 v152, v80, v81
  v_cvt_pk_bf16_f32 v153, v82, v83
  v_cvt_pk_bf16_f32 v154, v84, v85
  v_cvt_pk_bf16_f32 v155, v86, v87
  v_cvt_pk_bf16_f32 v156, v88, v89
  v_cvt_pk_bf16_f32 v157, v90, v91
  v_cvt_pk_bf16_f32 v158, v92, v93
  v_cvt_pk_bf16_f32 v159, v94, v95
  s_mul_i32 s28, s50, 12288
  s_add_u32 s29, s28, s48
  buffer_store_dwordx4 v[144:147], v11, s[8:11], s29 offen offset:0 sc1
  buffer_store_dwordx4 v[148:151], v11, s[8:11], s29 offen offset:256 sc1
  s_add_u32 s29, s28, s49
  buffer_store_dwordx4 v[152:155], v11, s[8:11], s29 offen offset:0 sc1
  buffer_store_dwordx4 v[156:159], v11, s[8:11], s29 offen offset:256 sc1
  s_add_u32 s50, s50, 1
  s_cmp_le_u32 s50, 2
  s_cbranch_scc0 ep_59
  s_waitcnt vmcnt(0)
  s_barrier
  s_cmp_eq_u32 s21, 0
  s_cbranch_scc0 ep_59
  v_mov_b32 v13, s50
  s_mov_b64 s[24:25], exec
  s_mov_b64 exec, 1
  buffer_store_dword v13, v12, s[8:11], 0 offen sc1
  s_mov_b64 exec, s[24:25]
ep_59:
  s_waitcnt vmcnt(4)
  s_barrier
  s_cmp_ge_u32 s50, 63
  s_cbranch_scc1 qn_60_n
  s_lshl_b32 s29, s21, 10
  s_add_u32 m0, s29, 122880
  s_add_u32 s28, s51, 0
  buffer_load_dwordx4 v6, s[8:11], s28 offen sc1 lds
  s_lshl_b32 s29, s21, 10
  s_add_u32 m0, s29, 126976
  s_add_u32 s28, s51, 4096
  buffer_load_dwordx4 v6, s[8:11], s28 offen sc1 lds
  s_lshl_b32 s29, s21, 10
  s_add_u32 m0, s29, 131072
  s_add_u32 s28, s51, 8192
  buffer_load_dwordx4 v6, s[8:11], s28 offen sc1 lds
  s_lshl_b32 s29, s21, 10
  s_add_u32 m0, s29, 135168
  s_add_u32 s28, s51, 12288
  buffer_load_dwordx4 v6, s[8:11], s28 offen sc1 lds
  s_lshl_b32 s29, s21, 10
  s_add_u32 m0, s29, 139264
  s_add_u32 s28, s51, 16384
  buffer_load_dwordx4 v6, s[8:11], s28 offen sc1 lds
  s_lshl_b32 s29, s21, 10
  s_add_u32 m0, s29, 143360
  s_add_u32 s28, s51, 20480
  buffer_load_dwordx4 v6, s[8:11], s28 offen sc1 lds
  s_lshl_b32 s29, s21, 10
  s_add_u32 m0, s29, 147456
  s_add_u32 s28, s51, 24576
  buffer_load_dwordx4 v6, s[8:11], s28 offen sc1 lds
  s_lshl_b32 s29, s21, 10
  s_add_u32 m0, s29, 151552
  s_add_u32 s28, s51, 28672
  buffer_load_dwordx4 v6, s[8:11], s28 offen sc1 lds
  s_lshl_b32 s29, s21, 10
  s_add_u32 m0, s29, 155648
  s_add_u32 s28, s51, 32768
  buffer_load_dwordx4 v6, s[8:11], s28 offen sc1 lds
  s_lshl_b32 s29, s21, 10
  s_add_u32 m0, s29, 159744
  s_add_u32 s28, s51, 36864
  buffer_load_dwordx4 v6, s[8:11], s28 offen sc1 lds
  s_add_u32 s51, s51, 40960
  s_branch qn_60
qn_60_n:
  s_waitcnt vmcnt(0)
qn_60:
  ds_read_b128 v[128:131], v10 offset:0
  ds_read_b128 v[132:135], v10 offset:1024
  ds_read_b128 v[136:139], v10 offset:2048
  ds_read_b128 v[140:143], v10 offset:3072
  s_waitcnt lgkmcnt(3)
  v_mfma_f32_32x32x16_bf16 v[64:79], a[0:3], v[128:131], 0
  v_mfma_f32_32x32x16_bf16 v[80:95], a[160:163], v[128:131], 0
  ds_read_b128 v[128:131], v10 offset:4096
  s_waitcnt lgkmcnt(3)
  v_mfma_f32_32x32x16_bf16 v[64:79], a[4:7], v[132:135], v[64:79]
  v_mfma_f32_32x32x16_bf16 v[80:95], a[164:167], v[132:135], v[80:95]
  ds_read_b128 v[132:135], v10 offset:5120
  s_waitcnt lgkmcnt(3)
  v_mfma_f32_32x32x16_bf16 v[64:79], a[8:11], v[136:139], v[64:79]
  v_mfma_f32_32x32x16_bf16 v[80:95], a[168:171], v[136:139], v[80:95]
  ds_read_b128 v[136:139], v10 offset:6144
  s_waitcnt lgkmcnt(3)
  v_mfma_f32_32x32x16_bf16 v[64:79], a[12:15], v[140:143], v[64:79]
  v_mfma_f32_32x32x16_bf16 v[80:95], a[172:175], v[140:143], v[80:95]
  ds_read_b128 v[140:143], v10 offset:7168
  s_waitcnt lgkmcnt(3)
  v_mfma_f32_32x32x16_bf16 v[64:79], a[16:19], v[128:131], v[64:79]
  v_mfma_f32_32x32x16_bf16 v[80:95], a[176:179], v[128:131], v[80:95]
  ds_read_b128 v[128:131], v10 offset:8192
  s_waitcnt lgkmcnt(3)
  v_mfma_f32_32x32x16_bf16 v[64:79], a[20:23], v[132:135], v[64:79]
  v_mfma_f32_32x32x16_bf16 v[80:95], a[180:183], v[132:135], v[80:95]
  ds_read_b128 v[132:135], v10 offset:9216
  s_waitcnt lgkmcnt(3)
  v_mfma_f32_32x32x16_bf16 v[64:79], a[24:27], v[136:139], v[64:79]
  v_mfma_f32_32x32x16_bf16 v[80:95], a[184:187], v[136:139], v[80:95]
  ds_read_b128 v[136:139], v10 offset:10240
  s_waitcnt lgkmcnt(3)
  v_mfma_f32_32x32x16_bf16 v[64:79], a[28:31], v[140:143], v[64:79]
  v_mfma_f32_32x32x16_bf16 v[80:95], a[188:191], v[140:143], v[80:95]
  ds_read_b128 v[140:143], v10 offset:11264
  s_waitcnt lgkmcnt(3)
  v_mfma_f32_32x32x16_bf16 v[64:79], a[32:35], v[128:131], v[64:79]
  v_mfma_f32_32x32x16_bf16 v[80:95], a[192:195], v[128:131], v[80:95]
  ds_read_b128 v[128:131], v10 offset:12288
  s_waitcnt lgkmcnt(3)
  v_mfma_f32_32x32x16_bf16 v[64:79], a[36:39], v[132:135], v[64:79]
  v_mfma_f32_32x32x16_bf16 v[80:95], a[196:199], v[132:135], v[80:95]
  ds_read_b128 v[132:135], v10 offset:13312
  s_waitcnt lgkmcnt(3)
  v_mfma_f32_32x32x16_bf16 v[64:79], a[40:43], v[136:139], v[64:79]
  v_mfma_f32_32x32x16_bf16 v[80:95], a[200:203], v[136:139], v[80:95]
  ds_read_b128 v[136:139], v10 offset:14336
  s_waitcnt lgkmcnt(3)
  v_mfma_f32_32x32x16_bf16 v[64:79], a[44:47], v[140:143], v[64:79]
  v_mfma_f32_32x32x16_bf16 v[80:95], a[204:207], v[140:143], v[80:95]
  ds_read_b128 v[140:143], v10 offset:15360
  s_waitcnt lgkmcnt(3)
  v_mfma_f32_32x32x16_bf16 v[64:79], a[48:51], v[128:131], v[64:79]
  v_mfma_f32_32x32x16_bf16 v[80:95], a[208:211], v[128:131], v[80:95]
  ds_read_b128 v[128:131], v10 offset:16384
  s_waitcnt lgkmcnt(3)
  v_mfma_f32_32x32x16_bf16 v[64:79], a[52:55], v[132:135], v[64:79]
  v_mfma_f32_32x32x16_bf16 v[80:95], a[212:215], v[132:135], v[80:95]
  ds_read_b128 v[132:135], v10 offset:17408
  s_waitcnt lgkmcnt(3)
  v_mfma_f32_32x32x16_bf16 v[64:79], a[56:59], v[136:139], v[64:79]
  v_mfma_f32_32x32x16_bf16 v[80:95], a[216:219], v[136:139], v[80:95]
  ds_read_b128 v[136:139], v10 offset:18432
  s_waitcnt lgkmcnt(3)
  v_mfma_f32_32x32x16_bf16 v[64:79], a[60:63], v[140:143], v[64:79]
  v_mfma_f32_32x32x16_bf16 v[80:95], a[220:223], v[140:143], v[80:95]
  ds_read_b128 v[140:143], v10 offset:19456
  s_waitcnt lgkmcnt(3)
  v_mfma_f32_32x32x16_bf16 v[64:79], a[64:67], v[128:131], v[64:79]
  v_mfma_f32_32x32x16_bf16 v[80:95], a[224:227], v[128:131], v[80:95]
  ds_read_b128 v[128:131], v10 offset:20480
  s_waitcnt lgkmcnt(3)
  v_mfma_f32_32x32x16_bf16 v[64:79], a[68:71], v[132:135], v[64:79]
  v_mfma_f32_32x32x16_bf16 v[80:95], a[228:231], v[132:135], v[80:95]
  ds_read_b128 v[132:135], v10 offset:21504
  s_waitcnt lgkmcnt(3)
  v_mfma_f32_32x32x16_bf16 v[64:79], a[72:75], v[136:139], v[64:79]
  v_mfma_f32_32x32x16_bf16 v[80:95], a[232:235], v[136:139], v[80:95]
  ds_read_b128 v[136:139], v10 offset:22528
  s_waitcnt lgkmcnt(3)
  v_mfma_f32_32x32x16_bf16 v[64:79], a[76:79], v[140:143], v[64:79]
  v_mfma_f32_32x32x16_bf16 v[80:95], a[236:239], v[140:143], v[80:95]
  ds_read_b128 v[140:143], v10 offset:23552
  s_waitcnt lgkmcnt(3)
  v_mfma_f32_32x32x16_bf16 v[64:79], a[80:83], v[128:131], v[64:79]
  v_mfma_f32_32x32x16_bf16 v[80:95], a[240:243], v[128:131], v[80:95]
  ds_read_b128 v[128:131], v10 offset:24576
  s_waitcnt lgkmcnt(3)
  v_mfma_f32_32x32x16_bf16 v[64:79], a[84:87], v[132:135], v[64:79]
  v_mfma_f32_32x32x16_bf16 v[80:95], a[244:247], v[132:135], v[80:95]
  ds_read_b128 v[132:135], v10 offset:25600
  s_waitcnt lgkmcnt(3)
  v_mfma_f32_32x32x16_bf16 v[64:79], a[88:91], v[136:139], v[64:79]
  v_mfma_f32_32x32x16_bf16 v[80:95], a[248:251], v[136:139], v[80:95]
  ds_read_b128 v[136:139], v10 offset:26624
  s_waitcnt lgkmcnt(3)
  v_mfma_f32_32x32x16_bf16 v[64:79], a[92:95], v[140:143], v[64:79]
  v_mfma_f32_32x32x16_bf16 v[80:95], a[252:255], v[140:143], v[80:95]
  ds_read_b128 v[140:143], v10 offset:27648
  s_cmp_le_u32 s50, 2
  s_cbranch_scc1 mp_61
  s_waitcnt vmcnt(10)
  s_barrier
  s_cmp_eq_u32 s21, 0
  s_cbranch_scc0 mp_61
  v_mov_b32 v13, s50
  s_mov_b64 s[24:25], exec
  s_mov_b64 exec, 1
  buffer_store_dword v13, v12, s[8:11], 0 offen sc1
  s_mov_b64 exec, s[24:25]
mp_61:
  s_waitcnt lgkmcnt(3)
  v_mfma_f32_32x32x16_bf16 v[64:79], a[96:99], v[128:131], v[64:79]
  v_mfma_f32_32x32x16_bf16 v[80:95], v[192:195], v[128:131], v[80:95]
  ds_read_b128 v[128:131], v10 offset:28672
  s_waitcnt lgkmcnt(3)
  v_mfma_f32_32x32x16_bf16 v[64:79], a[100:103], v[132:135], v[64:79]
  v_mfma_f32_32x32x16_bf16 v[80:95], v[196:199], v[132:135], v[80:95]
  ds_read_b128 v[132:135], v10 offset:29696
  s_waitcnt lgkmcnt(3)
  v_mfma_f32_32x32x16_bf16 v[64:79], a[104:107], v[136:139], v[64:79]
  v_mfma_f32_32x32x16_bf16 v[80:95], v[200:203], v[136:139], v[80:95]
  ds_read_b128 v[136:139], v10 offset:30720
  s_waitcnt lgkmcnt(3)
  v_mfma_f32_32x32x16_bf16 v[64:79], a[108:111], v[140:143], v[64:79]
  v_mfma_f32_32x32x16_bf16 v[80:95], v[204:207], v[140:143], v[80:95]
  ds_read_b128 v[140:143], v10 offset:31744
  s_waitcnt lgkmcnt(3)
  v_mfma_f32_32x32x16_bf16 v[64:79], a[112:115], v[128:131], v[64:79]
  v_mfma_f32_32x32x16_bf16 v[80:95], v[208:211], v[128:131], v[80:95]
  ds_read_b128 v[128:131], v10 offset:32768
  s_waitcnt lgkmcnt(3)
  v_mfma_f32_32x32x16_bf16 v[64:79], a[116:119], v[132:135], v[64:79]
  v_mfma_f32_32x32x16_bf16 v[80:95], v[212:215], v[132:135], v[80:95]
  ds_read_b128 v[132:135], v10 offset:33792
  s_waitcnt lgkmcnt(3)
  v_mfma_f32_32x32x16_bf16 v[64:79], a[120:123], v[136:139], v[64:79]
  v_mfma_f32_32x32x16_bf16 v[80:95], v[216:219], v[136:139], v[80:95]
  ds_read_b128 v[136:139], v10 offset:34816
  s_waitcnt lgkmcnt(3)
  v_mfma_f32_32x32x16_bf16 v[64:79], a[124:127], v[140:143], v[64:79]
  v_mfma_f32_32x32x16_bf16 v[80:95], v[220:223], v[140:143], v[80:95]
  ds_read_b128 v[140:143], v10 offset:35840
  s_waitcnt lgkmcnt(3)
  v_mfma_f32_32x32x16_bf16 v[64:79], a[128:131], v[128:131], v[64:79]
  v_mfma_f32_32x32x16_bf16 v[80:95], v[224:227], v[128:131], v[80:95]
  ds_read_b128 v[128:131], v10 offset:36864
  s_waitcnt lgkmcnt(3)
  v_mfma_f32_32x32x16_bf16 v[64:79], a[132:135], v[132:135], v[64:79]
  v_mfma_f32_32x32x16_bf16 v[80:95], v[228:231], v[132:135], v[80:95]
  ds_read_b128 v[132:135], v10 offset:37888
  s_waitcnt lgkmcnt(3)
  v_mfma_f32_32x32x16_bf16 v[64:79], a[136:139], v[136:139], v[64:79]
  v_mfma_f32_32x32x16_bf16 v[80:95], v[232:235], v[136:139], v[80:95]
  ds_read_b128 v[136:139], v10 offset:38912
  s_waitcnt lgkmcnt(3)
  v_mfma_f32_32x32x16_bf16 v[64:79], a[140:143], v[140:143], v[64:79]
  v_mfma_f32_32x32x16_bf16 v[80:95], v[236:239], v[140:143], v[80:95]
  ds_read_b128 v[140:143], v10 offset:39936
  s_waitcnt lgkmcnt(3)
  v_mfma_f32_32x32x16_bf16 v[64:79], a[144:147], v[128:131], v[64:79]
  v_mfma_f32_32x32x16_bf16 v[80:95], v[240:243], v[128:131], v[80:95]
  s_waitcnt lgkmcnt(2)
  v_mfma_f32_32x32x16_bf16 v[64:79], a[148:151], v[132:135], v[64:79]
  v_mfma_f32_32x32x16_bf16 v[80:95], v[244:247], v[132:135], v[80:95]
  s_waitcnt lgkmcnt(1)
  v_mfma_f32_32x32x16_bf16 v[64:79], a[152:155], v[136:139], v[64:79]
  v_mfma_f32_32x32x16_bf16 v[80:95], v[248:251], v[136:139], v[80:95]
  s_waitcnt lgkmcnt(0)
  v_mfma_f32_32x32x16_bf16 v[64:79], a[156:159], v[140:143], v[64:79]
  v_mfma_f32_32x32x16_bf16 v[80:95], v[252:255], v[140:143], v[80:95]
  s_nop 11
  v_cvt_pk_bf16_f32 v144, v64, v65
  v_cvt_pk_bf16_f32 v145, v66, v67
  v_cvt_pk_bf16_f32 v146, v68, v69
  v_cvt_pk_bf16_f32 v147, v70, v71
  v_cvt_pk_bf16_f32 v148, v72, v73
  v_cvt_pk_bf16_f32 v149, v74, v75
  v_cvt_pk_bf16_f32 v150, v76, v77
  v_cvt_pk_bf16_f32 v151, v78, v79
  v_cvt_pk_bf16_f32 v152, v80, v81
  v_cvt_pk_bf16_f32 v153, v82, v83
  v_cvt_pk_bf16_f32 v154, v84, v85
  v_cvt_pk_bf16_f32 v155, v86, v87
  v_cvt_pk_bf16_f32 v156, v88, v89
  v_cvt_pk_bf16_f32 v157, v90, v91
  v_cvt_pk_bf16_f32 v158, v92, v93
  v_cvt_pk_bf16_f32 v159, v94, v95
  s_mul_i32 s28, s50, 12288
  s_add_u32 s29, s28, s48
  buffer_store_dwordx4 v[144:147], v11, s[8:11], s29 offen offset:0 sc1
  buffer_store_dwordx4 v[148:151], v11, s[8:11], s29 offen offset:256 sc1
  s_add_u32 s29, s28, s49
  buffer_store_dwordx4 v[152:155], v11, s[8:11], s29 offen offset:0 sc1
  buffer_store_dwordx4 v[156:159], v11, s[8:11], s29 offen offset:256 sc1
  s_add_u32 s50, s50, 1
  s_cmp_le_u32 s50, 2
  s_cbranch_scc0 ep_62
  s_waitcnt vmcnt(0)
  s_barrier
  s_cmp_eq_u32 s21, 0
  s_cbranch_scc0 ep_62
  v_mov_b32 v13, s50
  s_mov_b64 s[24:25], exec
  s_mov_b64 exec, 1
  buffer_store_dword v13, v12, s[8:11], 0 offen sc1
  s_mov_b64 exec, s[24:25]
ep_62:
  s_cmp_lt_u32 s50, 64
  s_cbranch_scc1 ka_qkv_loop
  s_waitcnt vmcnt(0)
  s_barrier
  s_cmp_eq_u32 s21, 0
  s_cbranch_scc0 ka_exit
  v_mov_b32 v13, 64
  s_mov_b64 exec, 1
  buffer_store_dword v13, v12, s[8:11], 0 offen sc1
  s_waitcnt vmcnt(0)
  s_branch ka_exit
ka_u:
  s_mov_b32 s12, s42
  s_and_b32 s13, s43, 0xffff
  s_mov_b32 s14, 0x780000
  s_mov_b32 s15, 0x20000
  v_and_b32 v1, 63, v0
  v_lshrrev_b32 v2, 4, v1
  v_bfe_u32 v3, v1, 2, 2
  v_and_b32 v4, 3, v1
  s_lshl_b32 s28, s21, 3
  v_add_u32 v5, s28, v3
  v_mul_u32_u24 v5, 1280, v5
  v_lshlrev_b32 v6, 6, v2
  v_add_u32 v5, v5, v6
  v_lshlrev_b32 v6, 4, v4
  v_add_u32 v5, v5, v6
  v_lshrrev_b32 v6, 1, v2
  v_mul_u32_u24 v7, 20480, v6
  v_lshlrev_b32 v6, 6, v3
  v_add_u32 v7, v7, v6
  v_and_b32 v6, 1, v2
  v_lshlrev_b32 v6, 5, v6
  v_add_u32 v7, v7, v6
  v_lshrrev_b32 v6, 1, v4
  v_lshlrev_b32 v6, 4, v6
  v_add_u32 v7, v7, v6
  v_and_b32 v6, 1, v4
  v_lshlrev_b32 v6, 3, v6
  v_add_u32 v7, v7, v6
  s_mul_i32 s28, s21, 1280
  v_add_u32 v7, s28, v7
  s_mul_i32 s46, s23, 245760
  s_mul_i32 s29, s21, 10240
  s_add_u32 m0, s29, 0
  s_add_u32 s28, s46, 0
  buffer_load_dwordx4 v5, s[12:15], s28 offen lds
  s_mul_i32 s29, s21, 10240
  s_add_u32 m0, s29, 1024
  s_add_u32 s28, s46, 256
  buffer_load_dwordx4 v5, s[12:15], s28 offen lds
  s_mul_i32 s29, s21, 10240
  s_add_u32 m0, s29, 2048
  s_add_u32 s28, s46, 512
  buffer_load_dwordx4 v5, s[12:15], s28 offen lds
  s_mul_i32 s29, s21, 10240
  s_add_u32 m0, s29, 3072
  s_add_u32 s28, s46, 768
  buffer_load_dwordx4 v5, s[12:15], s28 offen lds
  s_mul_i32 s29, s21, 10240
  s_add_u32 m0, s29, 4096
  s_add_u32 s28, s46, 1024
  buffer_load_dwordx4 v5, s[12:15], s28 offen lds
  s_mul_i32 s29, s21, 10240
  s_add_u32 m0, s29, 5120
  s_add_u32 s28, s46, 5120
  buffer_load_dwordx4 v5, s[12:15], s28 offen lds
  s_mul_i32 s29, s21, 10240
  s_add_u32 m0, s29, 6144
  s_add_u32 s28, s46, 5376
  buffer_load_dwordx4 v5, s[12:15], s28 offen lds
  s_mul_i32 s29, s21, 10240
  s_add_u32 m0, s29, 7168
  s_add_u32 s28, s46, 5632
  buffer_load_dwordx4 v5, s[12:15], s28 offen lds
  s_mul_i32 s29, s21, 10240
  s_add_u32 m0, s29, 8192
  s_add_u32 s28, s46, 5888
  buffer_load_dwordx4 v5, s[12:15], s28 offen lds
  s_mul_i32 s29, s21, 10240
  s_add_u32 m0, s29, 9216
  s_add_u32 s28, s46, 6144
  buffer_load_dwordx4 v5, s[12:15], s28 offen lds
  s_mul_i32 s29, s21, 10240
  s_add_u32 m0, s29, 40960
  s_add_u32 s28, s46, 40960
  buffer_load_dwordx4 v5, s[12:15], s28 offen lds
  s_mul_i32 s29, s21, 10240
  s_add_u32 m0, s29, 41984
  s_add_u32 s28, s46, 41216
  buffer_load_dwordx4 v5, s[12:15], s28 offen lds
  s_mul_i32 s29, s21, 10240
  s_add_u32 m0, s29, 43008
  s_add_u32 s28, s46, 41472
  buffer_load_dwordx4 v5, s[12:15], s28 offen lds
  s_mul_i32 s29, s21, 10240
  s_add_u32 m0, s29, 44032
  s_add_u32 s28, s46, 41728
  buffer_load_dwordx4 v5, s[12:15], s28 offen lds
  s_mul_i32 s29, s21, 10240
  s_add_u32 m0, s29, 45056
  s_add_u32 s28, s46, 41984
  buffer_load_dwordx4 v5, s[12:15], s28 offen lds
  s_mul_i32 s29, s21, 10240
  s_add_u32 m0, s29, 46080
  s_add_u32 s28, s46, 46080
  buffer_load_dwordx4 v5, s[12:15], s28 offen lds
  s_mul_i32 s29, s21, 10240
  s_add_u32 m0, s29, 47104
  s_add_u32 s28, s46, 46336
  buffer_load_dwordx4 v5, s[12:15], s28 offen lds
  s_mul_i32 s29, s21, 10240
  s_add_u32 m0, s29, 48128
  s_add_u32 s28, s46, 46592
  buffer_load_dwordx4 v5, s[12:15], s28 offen lds
  s_mul_i32 s29, s21, 10240
  s_add_u32 m0, s29, 49152
  s_add_u32 s28, s46, 46848
  buffer_load_dwordx4 v5, s[12:15], s28 offen lds
  s_mul_i32 s29, s21, 10240
  s_add_u32 m0, s29, 50176
  s_add_u32 s28, s46, 47104
  buffer_load_dwordx4 v5, s[12:15], s28 offen lds
  s_waitcnt vmcnt(10)
  s_cmp_eq_u32 s21, 3
  s_cbranch_scc0 lna_63
  s_mov_b64 s[24:25], exec
  s_mov_b64 exec, 1
  s_and_b32 s45, s2, 7
  s_lshl_b32 s45, s45, 7
  s_add_u32 s45, s45, 10240
  v_mov_b32 v2, s45
  v_mov_b32 v3, 1
  buffer_atomic_add v3, v2, s[8:11], 0 offen
  s_mov_b64 exec, s[24:25]
lna_63:
  s_barrier
  s_mul_i32 s29, s21, 10240
  s_add_u32 m0, s29, 81920
  s_add_u32 s28, s46, 81920
  buffer_load_dwordx4 v5, s[12:15], s28 offen lds
  s_mul_i32 s29, s21, 10240
  s_add_u32 m0, s29, 82944
  s_add_u32 s28, s46, 82176
  buffer_load_dwordx4 v5, s[12:15], s28 offen lds
  s_mul_i32 s29, s21, 10240
  s_add_u32 m0, s29, 83968
  s_add_u32 s28, s46, 82432
  buffer_load_dwordx4 v5, s[12:15], s28 offen lds
  s_mul_i32 s29, s21, 10240
  s_add_u32 m0, s29, 84992
  s_add_u32 s28, s46, 82688
  buffer_load_dwordx4 v5, s[12:15], s28 offen lds
  s_mul_i32 s29, s21, 10240
  s_add_u32 m0, s29, 86016
  s_add_u32 s28, s46, 82944
  buffer_load_dwordx4 v5, s[12:15], s28 offen lds
  s_mul_i32 s29, s21, 10240
  s_add_u32 m0, s29, 87040
  s_add_u32 s28, s46, 87040
  buffer_load_dwordx4 v5, s[12:15], s28 offen lds
  s_mul_i32 s29, s21, 10240
  s_add_u32 m0, s29, 88064
  s_add_u32 s28, s46, 87296
  buffer_load_dwordx4 v5, s[12:15], s28 offen lds
  s_mul_i32 s29, s21, 10240
  s_add_u32 m0, s29, 89088
  s_add_u32 s28, s46, 87552
  buffer_load_dwordx4 v5, s[12:15], s28 offen lds
  s_mul_i32 s29, s21, 10240
  s_add_u32 m0, s29, 90112
  s_add_u32 s28, s46, 87808
  buffer_load_dwordx4 v5, s[12:15], s28 offen lds
  s_mul_i32 s29, s21, 10240
  s_add_u32 m0, s29, 91136
  s_add_u32 s28, s46, 88064
  buffer_load_dwordx4 v5, s[12:15], s28 offen lds
  v_add_u32 v8, 0, v7
  ds_read_b64_tr_b16 a[0:1], v8 offset:0
  ds_read_b64_tr_b16 a[2:3], v8 offset:10240
  ds_read_b64_tr_b16 a[4:5], v8 offset:5120
  ds_read_b64_tr_b16 a[6:7], v8 offset:15360
  ds_read_b64_tr_b16 a[48:49], v8 offset:256
  ds_read_b64_tr_b16 a[50:51], v8 offset:10496
  ds_read_b64_tr_b16 a[52:53], v8 offset:5376
  ds_read_b64_tr_b16 a[54:55], v8 offset:15616
  ds_read_b64_tr_b16 a[96:97], v8 offset:512
  ds_read_b64_tr_b16 a[98:99], v8 offset:10752
  ds_read_b64_tr_b16 a[100:101], v8 offset:5632
  ds_read_b64_tr_b16 a[102:103], v8 offset:15872
  s_waitcnt lgkmcnt(0)
  ds_read_b64_tr_b16 a[144:145], v8 offset:768
  ds_read_b64_tr_b16 a[146:147], v8 offset:11008
  ds_read_b64_tr_b16 a[148:149], v8 offset:5888
  ds_read_b64_tr_b16 a[150:151], v8 offset:16128
  ds_read_b64_tr_b16 a[192:193], v8 offset:1024
  ds_read_b64_tr_b16 a[194:195], v8 offset:11264
  ds_read_b64_tr_b16 a[196:197], v8 offset:6144
  ds_read_b64_tr_b16 a[198:199], v8 offset:16384
  s_waitcnt lgkmcnt(0)
  s_waitcnt vmcnt(10)
  s_barrier
  s_mul_i32 s29, s21, 10240
  s_add_u32 m0, s29, 0
  s_add_u32 s28, s46, 122880
  buffer_load_dwordx4 v5, s[12:15], s28 offen lds
  s_mul_i32 s29, s21, 10240
  s_add_u32 m0, s29, 1024
  s_add_u32 s28, s46, 123136
  buffer_load_dwordx4 v5, s[12:15], s28 offen lds
  s_mul_i32 s29, s21, 10240
  s_add_u32 m0, s29, 2048
  s_add_u32 s28, s46, 123392
  buffer_load_dwordx4 v5, s[12:15], s28 offen lds
  s_mul_i32 s29, s21, 10240
  s_add_u32 m0, s29, 3072
  s_add_u32 s28, s46, 123648
  buffer_load_dwordx4 v5, s[12:15], s28 offen lds
  s_mul_i32 s29, s21, 10240
  s_add_u32 m0, s29, 4096
  s_add_u32 s28, s46, 123904
  buffer_load_dwordx4 v5, s[12:15], s28 offen lds
  s_mul_i32 s29, s21, 10240
  s_add_u32 m0, s29, 5120
  s_add_u32 s28, s46, 128000
  buffer_load_dwordx4 v5, s[12:15], s28 offen lds
  s_mul_i32 s29, s21, 10240
  s_add_u32 m0, s29, 6144
  s_add_u32 s28, s46, 128256
  buffer_load_dwordx4 v5, s[12:15], s28 offen lds
  s_mul_i32 s29, s21, 10240
  s_add_u32 m0, s29, 7168
  s_add_u32 s28, s46, 128512
  buffer_load_dwordx4 v5, s[12:15], s28 offen lds
  s_mul_i32 s29, s21, 10240
  s_add_u32 m0, s29, 8192
  s_add_u32 s28, s46, 128768
  buffer_load_dwordx4 v5, s[12:15], s28 offen lds
  s_mul_i32 s29, s21, 10240
  s_add_u32 m0, s29, 9216
  s_add_u32 s28, s46, 129024
  buffer_load_dwordx4 v5, s[12:15], s28 offen lds
  v_add_u32 v8, 40960, v7
  ds_read_b64_tr_b16 a[8:9], v8 offset:0
  ds_read_b64_tr_b16 a[10:11], v8 offset:10240
  ds_read_b64_tr_b16 a[12:13], v8 offset:5120
  ds_read_b64_tr_b16 a[14:15], v8 offset:15360
  ds_read_b64_tr_b16 a[56:57], v8 offset:256
  ds_read_b64_tr_b16 a[58:59], v8 offset:10496
  ds_read_b64_tr_b16 a[60:61], v8 offset:5376
  ds_read_b64_tr_b16 a[62:63], v8 offset:15616
  ds_read_b64_tr_b16 a[104:105], v8 offset:512
  ds_read_b64_tr_b16 a[106:107], v8 offset:10752
  ds_read_b64_tr_b16 a[108:109], v8 offset:5632
  ds_read_b64_tr_b16 a[110:111], v8 offset:15872
  s_waitcnt lgkmcnt(0)
  ds_read_b64_tr_b16 a[152:153], v8 offset:768
  ds_read_b64_tr_b16 a[154:155], v8 offset:11008
  ds_read_b64_tr_b16 a[156:157], v8 offset:5888
  ds_read_b64_tr_b16 a[158:159], v8 offset:16128
  ds_read_b64_tr_b16 a[200:201], v8 offset:1024
  ds_read_b64_tr_b16 a[202:203], v8 offset:11264
  ds_read_b64_tr_b16 a[204:205], v8 offset:6144
  ds_read_b64_tr_b16 a[206:207], v8 offset:16384
  s_waitcnt lgkmcnt(0)
  s_waitcnt vmcnt(10)
  s_barrier
  s_mul_i32 s29, s21, 10240
  s_add_u32 m0, s29, 40960
  s_add_u32 s28, s46, 163840
  buffer_load_dwordx4 v5, s[12:15], s28 offen lds
  s_mul_i32 s29, s21, 10240
  s_add_u32 m0, s29, 41984
  s_add_u32 s28, s46, 164096
  buffer_load_dwordx4 v5, s[12:15], s28 offen lds
  s_mul_i32 s29, s21, 10240
  s_add_u32 m0, s29, 43008
  s_add_u32 s28, s46, 164352
  buffer_load_dwordx4 v5, s[12:15], s28 offen lds
  s_mul_i32 s29, s21, 10240
  s_add_u32 m0, s29, 44032
  s_add_u32 s28, s46, 164608
  buffer_load_dwordx4 v5, s[12:15], s28 offen lds
  s_mul_i32 s29, s21, 10240
  s_add_u32 m0, s29, 45056
  s_add_u32 s28, s46, 164864
  buffer_load_dwordx4 v5, s[12:15], s28 offen lds
  s_mul_i32 s29, s21, 10240
  s_add_u32 m0, s29, 46080
  s_add_u32 s28, s46, 168960
  buffer_load_dwordx4 v5, s[12:15], s28 offen lds
  s_mul_i32 s29, s21, 10240
  s_add_u32 m0, s29, 47104
  s_add_u32 s28, s46, 169216
  buffer_load_dwordx4 v5, s[12:15], s28 offen lds
  s_mul_i32 s29, s21, 10240
  s_add_u32 m0, s29, 48128
  s_add_u32 s28, s46, 169472
  buffer_load_dwordx4 v5, s[12:15], s28 offen lds
  s_mul_i32 s29, s21, 10240
  s_add_u32 m0, s29, 49152
  s_add_u32 s28, s46, 169728
  buffer_load_dwordx4 v5, s[12:15], s28 offen lds
  s_mul_i32 s29, s21, 10240
  s_add_u32 m0, s29, 50176
  s_add_u32 s28, s46, 169984
  buffer_load_dwordx4 v5, s[12:15], s28 offen lds
  v_add_u32 v8, 81920, v7
  ds_read_b64_tr_b16 a[16:17], v8 offset:0
  ds_read_b64_tr_b16 a[18:19], v8 offset:10240
  ds_read_b64_tr_b16 a[20:21], v8 offset:5120
  ds_read_b64_tr_b16 a[22:23], v8 offset:15360
  ds_read_b64_tr_b16 a[64:65], v8 offset:256
  ds_read_b64_tr_b16 a[66:67], v8 offset:10496
  ds_read_b64_tr_b16 a[68:69], v8 offset:5376
  ds_read_b64_tr_b16 a[70:71], v8 offset:15616
  ds_read_b64_tr_b16 a[112:113], v8 offset:512
  ds_read_b64_tr_b16 a[114:115], v8 offset:10752
  ds_read_b64_tr_b16 a[116:117], v8 offset:5632
  ds_read_b64_tr_b16 a[118:119], v8 offset:15872
  s_waitcnt lgkmcnt(0)
  ds_read_b64_tr_b16 a[160:161], v8 offset:768
  ds_read_b64_tr_b16 a[162:163], v8 offset:11008
  ds_read_b64_tr_b16 a[164:165], v8 offset:5888
  ds_read_b64_tr_b16 a[166:167], v8 offset:16128
  ds_read_b64_tr_b16 a[208:209], v8 offset:1024
  ds_read_b64_tr_b16 a[210:211], v8 offset:11264
  ds_read_b64_tr_b16 a[212:213], v8 offset:6144
  ds_read_b64_tr_b16 a[214:215], v8 offset:16384
  s_waitcnt lgkmcnt(0)
  s_waitcnt vmcnt(10)
  s_barrier
  s_mul_i32 s29, s21, 10240
  s_add_u32 m0, s29, 81920
  s_add_u32 s28, s46, 204800
  buffer_load_dwordx4 v5, s[12:15], s28 offen lds
  s_mul_i32 s29, s21, 10240
  s_add_u32 m0, s29, 82944
  s_add_u32 s28, s46, 205056
  buffer_load_dwordx4 v5, s[12:15], s28 offen lds
  s_mul_i32 s29, s21, 10240
  s_add_u32 m0, s29, 83968
  s_add_u32 s28, s46, 205312
  buffer_load_dwordx4 v5, s[12:15], s28 offen lds
  s_mul_i32 s29, s21, 10240
  s_add_u32 m0, s29, 84992
  s_add_u32 s28, s46, 205568
  buffer_load_dwordx4 v5, s[12:15], s28 offen lds
  s_mul_i32 s29, s21, 10240
  s_add_u32 m0, s29, 86016
  s_add_u32 s28, s46, 205824
  buffer_load_dwordx4 v5, s[12:15], s28 offen lds
  s_mul_i32 s29, s21, 10240
  s_add_u32 m0, s29, 87040
  s_add_u32 s28, s46, 209920
  buffer_load_dwordx4 v5, s[12:15], s28 offen lds
  s_mul_i32 s29, s21, 10240
  s_add_u32 m0, s29, 88064
  s_add_u32 s28, s46, 210176
  buffer_load_dwordx4 v5, s[12:15], s28 offen lds
  s_mul_i32 s29, s21, 10240
  s_add_u32 m0, s29, 89088
  s_add_u32 s28, s46, 210432
  buffer_load_dwordx4 v5, s[12:15], s28 offen lds
  s_mul_i32 s29, s21, 10240
  s_add_u32 m0, s29, 90112
  s_add_u32 s28, s46, 210688
  buffer_load_dwordx4 v5, s[12:15], s28 offen lds
  s_mul_i32 s29, s21, 10240
  s_add_u32 m0, s29, 91136
  s_add_u32 s28, s46, 210944
  buffer_load_dwordx4 v5, s[12:15], s28 offen lds
  v_add_u32 v8, 0, v7
  ds_read_b64_tr_b16 a[24:25], v8 offset:0
  ds_read_b64_tr_b16 a[26:27], v8 offset:10240
  ds_read_b64_tr_b16 a[28:29], v8 offset:5120
  ds_read_b64_tr_b16 a[30:31], v8 offset:15360
  ds_read_b64_tr_b16 a[72:73], v8 offset:256
  ds_read_b64_tr_b16 a[74:75], v8 offset:10496
  ds_read_b64_tr_b16 a[76:77], v8 offset:5376
  ds_read_b64_tr_b16 a[78:79], v8 offset:15616
  ds_read_b64_tr_b16 a[120:121], v8 offset:512
  ds_read_b64_tr_b16 a[122:123], v8 offset:10752
  ds_read_b64_tr_b16 a[124:125], v8 offset:5632
  ds_read_b64_tr_b16 a[126:127], v8 offset:15872
  s_waitcnt lgkmcnt(0)
  ds_read_b64_tr_b16 a[168:169], v8 offset:768
  ds_read_b64_tr_b16 a[170:171], v8 offset:11008
  ds_read_b64_tr_b16 a[172:173], v8 offset:5888
  ds_read_b64_tr_b16 a[174:175], v8 offset:16128
  ds_read_b64_tr_b16 a[216:217], v8 offset:1024
  ds_read_b64_tr_b16 a[218:219], v8 offset:11264
  ds_read_b64_tr_b16 a[220:221], v8 offset:6144
  ds_read_b64_tr_b16 a[222:223], v8 offset:16384
  s_waitcnt lgkmcnt(0)
  s_waitcnt vmcnt(10)
  s_barrier
  v_add_u32 v8, 40960, v7
  ds_read_b64_tr_b16 a[32:33], v8 offset:0
  ds_read_b64_tr_b16 a[34:35], v8 offset:10240
  ds_read_b64_tr_b16 a[36:37], v8 offset:5120
  ds_read_b64_tr_b16 a[38:39], v8 offset:15360
  ds_read_b64_tr_b16 a[80:81], v8 offset:256
  ds_read_b64_tr_b16 a[82:83], v8 offset:10496
  ds_read_b64_tr_b16 a[84:85], v8 offset:5376
  ds_read_b64_tr_b16 a[86:87], v8 offset:15616
  ds_read_b64_tr_b16 a[128:129], v8 offset:512
  ds_read_b64_tr_b16 a[130:131], v8 offset:10752
  ds_read_b64_tr_b16 a[132:133], v8 offset:5632
  ds_read_b64_tr_b16 a[134:135], v8 offset:15872
  s_waitcnt lgkmcnt(0)
  ds_read_b64_tr_b16 a[176:177], v8 offset:768
  ds_read_b64_tr_b16 a[178:179], v8 offset:11008
  ds_read_b64_tr_b16 a[180:181], v8 offset:5888
  ds_read_b64_tr_b16 a[182:183], v8 offset:16128
  ds_read_b64_tr_b16 a[224:225], v8 offset:1024
  ds_read_b64_tr_b16 a[226:227], v8 offset:11264
  ds_read_b64_tr_b16 a[228:229], v8 offset:6144
  ds_read_b64_tr_b16 a[230:231], v8 offset:16384
  s_waitcnt lgkmcnt(0)
  s_waitcnt vmcnt(0)
  s_barrier
  v_add_u32 v8, 81920, v7
  ds_read_b64_tr_b16 a[40:41], v8 offset:0
  ds_read_b64_tr_b16 a[42:43], v8 offset:10240
  ds_read_b64_tr_b16 a[44:45], v8 offset:5120
  ds_read_b64_tr_b16 a[46:47], v8 offset:15360
  ds_read_b64_tr_b16 a[88:89], v8 offset:256
  ds_read_b64_tr_b16 a[90:91], v8 offset:10496
  ds_read_b64_tr_b16 a[92:93], v8 offset:5376
  ds_read_b64_tr_b16 a[94:95], v8 offset:15616
  ds_read_b64_tr_b16 a[136:137], v8 offset:512
  ds_read_b64_tr_b16 a[138:139], v8 offset:10752
  ds_read_b64_tr_b16 a[140:141], v8 offset:5632
  ds_read_b64_tr_b16 a[142:143], v8 offset:15872
  s_waitcnt lgkmcnt(0)
  ds_read_b64_tr_b16 a[184:185], v8 offset:768
  ds_read_b64_tr_b16 a[186:187], v8 offset:11008
  ds_read_b64_tr_b16 a[188:189], v8 offset:5888
  ds_read_b64_tr_b16 a[190:191], v8 offset:16128
  ds_read_b64_tr_b16 a[232:233], v8 offset:1024
  ds_read_b64_tr_b16 a[234:235], v8 offset:11264
  ds_read_b64_tr_b16 a[236:237], v8 offset:6144
  ds_read_b64_tr_b16 a[238:239], v8 offset:16384
  s_waitcnt lgkmcnt(0)
  s_barrier
  v_lshlrev_b32 v5, 4, v1
  s_lshl_b32 s28, s21, 10
  v_add_u32 v6, s28, v5
  v_bfe_u32 v2, v1, 4, 1
  v_lshlrev_b32 v9, 10, v2
  v_and_b32 v2, 15, v1
  v_lshlrev_b32 v2, 4, v2
  v_add_u32 v9, v9, v2
  v_lshrrev_b32 v3, 5, v1
  v_lshlrev_b32 v3, 8, v3
  v_add_u32 v9, v9, v3
  v_add_u32 v10, 12288, v9
  v_bfe_u32 v3, v1, 4, 1
  v_lshlrev_b32 v11, 10, v3
  v_add_u32 v11, v11, v2
  v_lshrrev_b32 v3, 5, v1
  v_lshlrev_b32 v3, 9, v3
  v_add_u32 v11, v11, v3
  s_mul_i32 s28, s23, 6
  s_lshr_b32 s29, s28, 3
  s_add_u32 s28, s28, 5
  s_lshr_b32 s28, s28, 3
  v_and_b32 v2, 1, v1
  v_mov_b32 v12, s29
  v_mov_b32 v13, s28
  v_cmp_eq_u32 vcc, 1, v2
  s_nop 1
  v_cndmask_b32 v12, v12, v13, vcc
  v_lshlrev_b32 v12, 2, v12
  v_add_u32 v12, 2048, v12
  s_lshl_b32 s28, s23, 2
  s_add_u32 s28, s28, 3072
  v_mov_b32 v14, s28
  s_mul_i32 s47, s23, 786432
  s_add_u32 s47, s47, 0x7800000
  s_mul_i32 s48, s23, 40960
  s_mul_i32 s28, s21, 10240
  s_add_u32 s48, s48, s28
  s_add_u32 s48, s48, 0x9000000
  s_mov_b32 s50, 0
  s_mov_b32 s52, 0
  s_mov_b32 s54, 0
  s_mov_b32 s53, 0
  s_cmp_gt_u32 s52, s53
  s_cbranch_scc1 ka_wp_64_ok
  s_mov_b32 s45, 0
ka_wp_64_spin:
  buffer_load_dword v2, v12, s[8:11], 0 offen sc1
  s_add_u32 s45, s45, 1
  s_waitcnt vmcnt(0)
  v_min_u32_dpp v3, v2, v2 quad_perm:[1,0,3,2] row_mask:0xf bank_mask:0xf
  s_nop 1
  v_min_u32_dpp v2, v3, v3 quad_perm:[2,3,0,1] row_mask:0xf bank_mask:0xf
  s_nop 1
  v_min_u32_dpp v3, v2, v2 row_half_mirror row_mask:0xf bank_mask:0xf
  s_nop 1
  v_min_u32_dpp v2, v3, v3 quad_perm:[0,1,2,3] row_mask:0xf bank_mask:0xf
  s_nop 0
  v_readfirstlane_b32 s52, v2
  s_cmp_gt_u32 s52, s53
  s_cbranch_scc1 ka_wp_64_ok
  s_cmp_lt_u32 s45, 400000
  s_cbranch_scc1 ka_wp_64_spin
  s_branch ka_abort
ka_wp_64_ok:
  s_lshl_b32 s29, s21, 10
  s_add_u32 m0, s29, 0
  s_add_u32 s28, s47, 0
  buffer_load_dwordx4 v6, s[8:11], s28 offen sc1 lds
  s_lshl_b32 s29, s21, 10
  s_add_u32 m0, s29, 4096
  s_add_u32 s28, s47, 4096
  buffer_load_dwordx4 v6, s[8:11], s28 offen sc1 lds
  s_lshl_b32 s29, s21, 10
  s_add_u32 m0, s29, 8192
  s_add_u32 s28, s47, 8192
  buffer_load_dwordx4 v6, s[8:11], s28 offen sc1 lds
  s_add_u32 s47, s47, 12288
ka_u_loop:
  s_cmp_eq_u32 s50, 0
  s_cbranch_scc0 u0_65
  s_waitcnt vmcnt(0)
u0_65:
  s_waitcnt vmcnt(10)
  s_cmp_eq_u32 s54, 0
  s_cbranch_scc1 ud_66
  s_waitcnt vmcnt(0)
ud_66:
  s_barrier
  ds_read_b128 v[16:19], v9 offset:0
  ds_read_b128 v[20:23], v9 offset:512
  ds_read_b128 v[24:27], v9 offset:2048
  ds_read_b128 v[28:31], v9 offset:2560
  ds_read_b128 v[32:35], v9 offset:4096
  ds_read_b128 v[36:39], v9 offset:4608
  ds_read_b128 v[40:43], v9 offset:6144
  ds_read_b128 v[44:47], v9 offset:6656
  ds_read_b128 v[48:51], v9 offset:8192
  ds_read_b128 v[52:55], v9 offset:8704
  ds_read_b128 v[56:59], v9 offset:10240
  ds_read_b128 v[60:63], v9 offset:10752
  s_mov_b32 s54, 0
  s_cmp_ge_u32 s50, 63
  s_cbranch_scc1 un_67_n
  s_add_u32 s53, s50, 1
  s_cmp_gt_u32 s52, s53
  s_cbranch_scc1 un_67_go
  buffer_load_dword v2, v12, s[8:11], 0 offen sc1
  s_waitcnt vmcnt(0)
  v_min_u32_dpp v3, v2, v2 quad_perm:[1,0,3,2] row_mask:0xf bank_mask:0xf
  s_nop 0
  v_readfirstlane_b32 s52, v3
  s_cmp_gt_u32 s52, s53
  s_cbranch_scc1 un_67_go2
  s_mov_b32 s54, 1
  s_branch un_67
un_67_go2:
un_67_go:
  s_lshl_b32 s29, s21, 10
  s_add_u32 m0, s29, 12288
  s_add_u32 s28, s47, 0
  buffer_load_dwordx4 v6, s[8:11], s28 offen sc1 lds
  s_lshl_b32 s29, s21, 10
  s_add_u32 m0, s29, 16384
  s_add_u32 s28, s47, 4096
  buffer_load_dwordx4 v6, s[8:11], s28 offen sc1 lds
  s_lshl_b32 s29, s21, 10
  s_add_u32 m0, s29, 20480
  s_add_u32 s28, s47, 8192
  buffer_load_dwordx4 v6, s[8:11], s28 offen sc1 lds
  s_add_u32 s47, s47, 12288
  s_branch un_67
un_67_n:
  s_waitcnt vmcnt(0)
un_67:
  s_mul_i32 s30, s50, 1310720
  s_add_u32 s30, s30, s48
  s_waitcnt lgkmcnt(11)
  v_mfma_f32_32x32x16_bf16 v[64:79], v[16:19], a[0:3], 0
  s_waitcnt lgkmcnt(10)
  v_mfma_f32_32x32x16_bf16 v[64:79], v[20:23], a[4:7], v[64:79]
  s_waitcnt lgkmcnt(9)
  v_mfma_f32_32x32x16_bf16 v[64:79], v[24:27], a[8:11], v[64:79]
  s_waitcnt lgkmcnt(8)
  v_mfma_f32_32x32x16_bf16 v[64:79], v[28:31], a[12:15], v[64:79]
  s_waitcnt lgkmcnt(7)
  v_mfma_f32_32x32x16_bf16 v[64:79], v[32:35], a[16:19], v[64:79]
  s_waitcnt lgkmcnt(6)
  v_mfma_f32_32x32x16_bf16 v[64:79], v[36:39], a[20:23], v[64:79]
  s_waitcnt lgkmcnt(5)
  v_mfma_f32_32x32x16_bf16 v[64:79], v[40:43], a[24:27], v[64:79]
  s_waitcnt lgkmcnt(4)
  v_mfma_f32_32x32x16_bf16 v[64:79], v[44:47], a[28:31], v[64:79]
  s_waitcnt lgkmcnt(3)
  v_mfma_f32_32x32x16_bf16 v[64:79], v[48:51], a[32:35], v[64:79]
  s_waitcnt lgkmcnt(2)
  v_mfma_f32_32x32x16_bf16 v[64:79], v[52:55], a[36:39], v[64:79]
  s_waitcnt lgkmcnt(1)
  v_mfma_f32_32x32x16_bf16 v[64:79], v[56:59], a[40:43], v[64:79]
  s_waitcnt lgkmcnt(0)
  v_mfma_f32_32x32x16_bf16 v[64:79], v[60:63], a[44:47], v[64:79]
  v_mfma_f32_32x32x16_bf16 v[80:95], v[16:19], a[48:51], 0
  v_mfma_f32_32x32x16_bf16 v[80:95], v[20:23], a[52:55], v[80:95]
  v_mfma_f32_32x32x16_bf16 v[80:95], v[24:27], a[56:59], v[80:95]
  v_cvt_pk_bf16_f32 v96, v64, v65
  v_cvt_pk_bf16_f32 v97, v66, v67
  v_mfma_f32_32x32x16_bf16 v[80:95], v[28:31], a[60:63], v[80:95]
  v_cvt_pk_bf16_f32 v98, v68, v69
  v_cvt_pk_bf16_f32 v99, v70, v71
  v_mfma_f32_32x32x16_bf16 v[80:95], v[32:35], a[64:67], v[80:95]
  v_cvt_pk_bf16_f32 v100, v72, v73
  v_cvt_pk_bf16_f32 v101, v74, v75
  v_mfma_f32_32x32x16_bf16 v[80:95], v[36:39], a[68:71], v[80:95]
  v_cvt_pk_bf16_f32 v102, v76, v77
  v_cvt_pk_bf16_f32 v103, v78, v79
  v_mfma_f32_32x32x16_bf16 v[80:95], v[40:43], a[72:75], v[80:95]
  s_add_u32 s29, s30, 0
  buffer_store_dwordx4 v[96:99], v11, s[8:11], s29 offen offset:0 sc1
  v_mfma_f32_32x32x16_bf16 v[80:95], v[44:47], a[76:79], v[80:95]
  buffer_store_dwordx4 v[100:103], v11, s[8:11], s29 offen offset:256 sc1
  v_mfma_f32_32x32x16_bf16 v[80:95], v[48:51], a[80:83], v[80:95]
  v_mfma_f32_32x32x16_bf16 v[80:95], v[52:55], a[84:87], v[80:95]
  v_mfma_f32_32x32x16_bf16 v[80:95], v[56:59], a[88:91], v[80:95]
  v_mfma_f32_32x32x16_bf16 v[80:95], v[60:63], a[92:95], v[80:95]
  v_mfma_f32_32x32x16_bf16 v[64:79], v[16:19], a[96:99], 0
  v_mfma_f32_32x32x16_bf16 v[64:79], v[20:23], a[100:103], v[64:79]
  v_mfma_f32_32x32x16_bf16 v[64:79], v[24:27], a[104:107], v[64:79]
  v_cvt_pk_bf16_f32 v96, v80, v81
  v_cvt_pk_bf16_f32 v97, v82, v83
  v_mfma_f32_32x32x16_bf16 v[64:79], v[28:31], a[108:111], v[64:79]
  v_cvt_pk_bf16_f32 v98, v84, v85
  v_cvt_pk_bf16_f32 v99, v86, v87
  v_mfma_f32_32x32x16_bf16 v[64:79], v[32:35], a[112:115], v[64:79]
  v_cvt_pk_bf16_f32 v100, v88, v89
  v_cvt_pk_bf16_f32 v101, v90, v91
  v_mfma_f32_32x32x16_bf16 v[64:79], v[36:39], a[116:119], v[64:79]
  v_cvt_pk_bf16_f32 v102, v92, v93
  v_cvt_pk_bf16_f32 v103, v94, v95
  v_mfma_f32_32x32x16_bf16 v[64:79], v[40:43], a[120:123], v[64:79]
  s_add_u32 s29, s30, 2048
  buffer_store_dwordx4 v[96:99], v11, s[8:11], s29 offen offset:0 sc1
  v_mfma_f32_32x32x16_bf16 v[64:79], v[44:47], a[124:127], v[64:79]
  buffer_store_dwordx4 v[100:103], v11, s[8:11], s29 offen offset:256 sc1
  v_mfma_f32_32x32x16_bf16 v[64:79], v[48:51], a[128:131], v[64:79]
  v_mfma_f32_32x32x16_bf16 v[64:79], v[52:55], a[132:135], v[64:79]
  v_mfma_f32_32x32x16_bf16 v[64:79], v[56:59], a[136:139], v[64:79]
  v_mfma_f32_32x32x16_bf16 v[64:79], v[60:63], a[140:143], v[64:79]
  s_cmp_le_u32 s50, 2
  s_cbranch_scc1 mp_68
  s_waitcnt vmcnt(7)
  s_barrier
  s_cmp_eq_u32 s21, 0
  s_cbranch_scc0 mp_68
  v_mov_b32 v13, s50
  s_mov_b64 s[24:25], exec
  s_mov_b64 exec, 1
  buffer_store_dword v13, v14, s[8:11], 0 offen sc1
  s_mov_b64 exec, s[24:25]
mp_68:
  v_mfma_f32_32x32x16_bf16 v[80:95], v[16:19], a[144:147], 0
  v_mfma_f32_32x32x16_bf16 v[80:95], v[20:23], a[148:151], v[80:95]
  v_mfma_f32_32x32x16_bf16 v[80:95], v[24:27], a[152:155], v[80:95]
  v_cvt_pk_bf16_f32 v96, v64, v65
  v_cvt_pk_bf16_f32 v97, v66, v67
  v_mfma_f32_32x32x16_bf16 v[80:95], v[28:31], a[156:159], v[80:95]
  v_cvt_pk_bf16_f32 v98, v68, v69
  v_cvt_pk_bf16_f32 v99, v70, v71
  v_mfma_f32_32x32x16_bf16 v[80:95], v[32:35], a[160:163], v[80:95]
  v_cvt_pk_bf16_f32 v100, v72, v73
  v_cvt_pk_bf16_f32 v101, v74, v75
  v_mfma_f32_32x32x16_bf16 v[80:95], v[36:39], a[164:167], v[80:95]
  v_cvt_pk_bf16_f32 v102, v76, v77
  v_cvt_pk_bf16_f32 v103, v78, v79
  v_mfma_f32_32x32x16_bf16 v[80:95], v[40:43], a[168:171], v[80:95]
  s_add_u32 s29, s30, 4096
  buffer_store_dwordx4 v[96:99], v11, s[8:11], s29 offen offset:0 sc1
  v_mfma_f32_32x32x16_bf16 v[80:95], v[44:47], a[172:175], v[80:95]
  buffer_store_dwordx4 v[100:103], v11, s[8:11], s29 offen offset:256 sc1
  v_mfma_f32_32x32x16_bf16 v[80:95], v[48:51], a[176:179], v[80:95]
  v_mfma_f32_32x32x16_bf16 v[80:95], v[52:55], a[180:183], v[80:95]
  v_mfma_f32_32x32x16_bf16 v[80:95], v[56:59], a[184:187], v[80:95]
  v_mfma_f32_32x32x16_bf16 v[80:95], v[60:63], a[188:191], v[80:95]
  v_mfma_f32_32x32x16_bf16 v[64:79], v[16:19], a[192:195], 0
  v_mfma_f32_32x32x16_bf16 v[64:79], v[20:23], a[196:199], v[64:79]
  v_mfma_f32_32x32x16_bf16 v[64:79], v[24:27], a[200:203], v[64:79]
  v_cvt_pk_bf16_f32 v96, v80, v81
  v_cvt_pk_bf16_f32 v97, v82, v83
  v_mfma_f32_32x32x16_bf16 v[64:79], v[28:31], a[204:207], v[64:79]
  v_cvt_pk_bf16_f32 v98, v84, v85
  v_cvt_pk_bf16_f32 v99, v86, v87
  v_mfma_f32_32x32x16_bf16 v[64:79], v[32:35], a[208:211], v[64:79]
  v_cvt_pk_bf16_f32 v100, v88, v89
  v_cvt_pk_bf16_f32 v101, v90, v91
  v_mfma_f32_32x32x16_bf16 v[64:79], v[36:39], a[212:215], v[64:79]
  v_cvt_pk_bf16_f32 v102, v92, v93
  v_cvt_pk_bf16_f32 v103, v94, v95
  v_mfma_f32_32x32x16_bf16 v[64:79], v[40:43], a[216:219], v[64:79]
  s_add_u32 s29, s30, 6144
  buffer_store_dwordx4 v[96:99], v11, s[8:11], s29 offen offset:0 sc1
  v_mfma_f32_32x32x16_bf16 v[64:79], v[44:47], a[220:223], v[64:79]
  buffer_store_dwordx4 v[100:103], v11, s[8:11], s29 offen offset:256 sc1
  v_mfma_f32_32x32x16_bf16 v[64:79], v[48:51], a[224:227], v[64:79]
  v_mfma_f32_32x32x16_bf16 v[64:79], v[52:55], a[228:231], v[64:79]
  v_mfma_f32_32x32x16_bf16 v[64:79], v[56:59], a[232:235], v[64:79]
  v_mfma_f32_32x32x16_bf16 v[64:79], v[60:63], a[236:239], v[64:79]
  s_nop 11
  v_cvt_pk_bf16_f32 v96, v64, v65
  v_cvt_pk_bf16_f32 v97, v66, v67
  v_cvt_pk_bf16_f32 v98, v68, v69
  v_cvt_pk_bf16_f32 v99, v70, v71
  v_cvt_pk_bf16_f32 v100, v72, v73
  v_cvt_pk_bf16_f32 v101, v74, v75
  v_cvt_pk_bf16_f32 v102, v76, v77
  v_cvt_pk_bf16_f32 v103, v78, v79
  s_add_u32 s29, s30, 8192
  buffer_store_dwordx4 v[96:99], v11, s[8:11], s29 offen offset:0 sc1
  buffer_store_dwordx4 v[100:103], v11, s[8:11], s29 offen offset:256 sc1
  s_cmp_eq_u32 s54, 0
  s_cbranch_scc1 udf_69
  s_cmp_gt_u32 s52, s53
  s_cbranch_scc1 ka_wp_70_ok
  s_mov_b32 s45, 0
ka_wp_70_spin:
  buffer_load_dword v2, v12, s[8:11], 0 offen sc1
  s_add_u32 s45, s45, 1
  s_waitcnt vmcnt(0)
  v_min_u32_dpp v3, v2, v2 quad_perm:[1,0,3,2] row_mask:0xf bank_mask:0xf
  s_nop 1
  v_min_u32_dpp v2, v3, v3 quad_perm:[2,3,0,1] row_mask:0xf bank_mask:0xf
  s_nop 1
  v_min_u32_dpp v3, v2, v2 row_half_mirror row_mask:0xf bank_mask:0xf
  s_nop 1
  v_min_u32_dpp v2, v3, v3 quad_perm:[0,1,2,3] row_mask:0xf bank_mask:0xf
  s_nop 0
  v_readfirstlane_b32 s52, v2
  s_cmp_gt_u32 s52, s53
  s_cbranch_scc1 ka_wp_70_ok
  s_cmp_lt_u32 s45, 400000
  s_cbranch_scc1 ka_wp_70_spin
  s_branch ka_abort
ka_wp_70_ok:
  s_lshl_b32 s29, s21, 10
  s_add_u32 m0, s29, 12288
  s_add_u32 s28, s47, 0
  buffer_load_dwordx4 v6, s[8:11], s28 offen sc1 lds
  s_lshl_b32 s29, s21, 10
  s_add_u32 m0, s29, 16384
  s_add_u32 s28, s47, 4096
  buffer_load_dwordx4 v6, s[8:11], s28 offen sc1 lds
  s_lshl_b32 s29, s21, 10
  s_add_u32 m0, s29, 20480
  s_add_u32 s28, s47, 8192
  buffer_load_dwordx4 v6, s[8:11], s28 offen sc1 lds
  s_add_u32 s47, s47, 12288
udf_69:
  s_add_u32 s50, s50, 1
  s_cmp_le_u32 s50, 2
  s_cbranch_scc0 ep_71
  s_waitcnt vmcnt(0)
  s_barrier
  s_cmp_eq_u32 s21, 0
  s_cbranch_scc0 ep_71
  v_mov_b32 v13, s50
  s_mov_b64 s[24:25], exec
  s_mov_b64 exec, 1
  buffer_store_dword v13, v14, s[8:11], 0 offen sc1
  s_mov_b64 exec, s[24:25]
ep_71:
  s_waitcnt vmcnt(10)
  s_cmp_eq_u32 s54, 0
  s_cbranch_scc1 ud_72
  s_waitcnt vmcnt(0)
ud_72:
  s_barrier
  ds_read_b128 v[16:19], v10 offset:0
  ds_read_b128 v[20:23], v10 offset:512
  ds_read_b128 v[24:27], v10 offset:2048
  ds_read_b128 v[28:31], v10 offset:2560
  ds_read_b128 v[32:35], v10 offset:4096
  ds_read_b128 v[36:39], v10 offset:4608
  ds_read_b128 v[40:43], v10 offset:6144
  ds_read_b128 v[44:47], v10 offset:6656
  ds_read_b128 v[48:51], v10 offset:8192
  ds_read_b128 v[52:55], v10 offset:8704
  ds_read_b128 v[56:59], v10 offset:10240
  ds_read_b128 v[60:63], v10 offset:10752
  s_mov_b32 s54, 0
  s_cmp_ge_u32 s50, 63
  s_cbranch_scc1 un_73_n
  s_add_u32 s53, s50, 1
  s_cmp_gt_u32 s52, s53
  s_cbranch_scc1 un_73_go
  buffer_load_dword v2, v12, s[8:11], 0 offen sc1
  s_waitcnt vmcnt(0)
  v_min_u32_dpp v3, v2, v2 quad_perm:[1,0,3,2] row_mask:0xf bank_mask:0xf
  s_nop 0
  v_readfirstlane_b32 s52, v3
  s_cmp_gt_u32 s52, s53
  s_cbranch_scc1 un_73_go2
  s_mov_b32 s54, 1
  s_branch un_73
un_73_go2:
un_73_go:
  s_lshl_b32 s29, s21, 10
  s_add_u32 m0, s29, 0
  s_add_u32 s28, s47, 0
  buffer_load_dwordx4 v6, s[8:11], s28 offen sc1 lds
  s_lshl_b32 s29, s21, 10
  s_add_u32 m0, s29, 4096
  s_add_u32 s28, s47, 4096
  buffer_load_dwordx4 v6, s[8:11], s28 offen sc1 lds
  s_lshl_b32 s29, s21, 10
  s_add_u32 m0, s29, 8192
  s_add_u32 s28, s47, 8192
  buffer_load_dwordx4 v6, s[8:11], s28 offen sc1 lds
  s_add_u32 s47, s47, 12288
  s_branch un_73
un_73_n:
  s_waitcnt vmcnt(0)
un_73:
  s_mul_i32 s30, s50, 1310720
  s_add_u32 s30, s30, s48
  s_waitcnt lgkmcnt(11)
  v_mfma_f32_32x32x16_bf16 v[64:79], v[16:19], a[0:3], 0
  s_waitcnt lgkmcnt(10)
  v_mfma_f32_32x32x16_bf16 v[64:79], v[20:23], a[4:7], v[64:79]
  s_waitcnt lgkmcnt(9)
  v_mfma_f32_32x32x16_bf16 v[64:79], v[24:27], a[8:11], v[64:79]
  s_waitcnt lgkmcnt(8)
  v_mfma_f32_32x32x16_bf16 v[64:79], v[28:31], a[12:15], v[64:79]
  s_waitcnt lgkmcnt(7)
  v_mfma_f32_32x32x16_bf16 v[64:79], v[32:35], a[16:19], v[64:79]
  s_waitcnt lgkmcnt(6)
  v_mfma_f32_32x32x16_bf16 v[64:79], v[36:39], a[20:23], v[64:79]
  s_waitcnt lgkmcnt(5)
  v_mfma_f32_32x32x16_bf16 v[64:79], v[40:43], a[24:27], v[64:79]
  s_waitcnt lgkmcnt(4)
  v_mfma_f32_32x32x16_bf16 v[64:79], v[44:47], a[28:31], v[64:79]
  s_waitcnt lgkmcnt(3)
  v_mfma_f32_32x32x16_bf16 v[64:79], v[48:51], a[32:35], v[64:79]
  s_waitcnt lgkmcnt(2)
  v_mfma_f32_32x32x16_bf16 v[64:79], v[52:55], a[36:39], v[64:79]
  s_waitcnt lgkmcnt(1)
  v_mfma_f32_32x32x16_bf16 v[64:79], v[56:59], a[40:43], v[64:79]
  s_waitcnt lgkmcnt(0)
  v_mfma_f32_32x32x16_bf16 v[64:79], v[60:63], a[44:47], v[64:79]
  v_mfma_f32_32x32x16_bf16 v[80:95], v[16:19], a[48:51], 0
  v_mfma_f32_32x32x16_bf16 v[80:95], v[20:23], a[52:55], v[80:95]
  v_mfma_f32_32x32x16_bf16 v[80:95], v[24:27], a[56:59], v[80:95]
  v_cvt_pk_bf16_f32 v96, v64, v65
  v_cvt_pk_bf16_f32 v97, v66, v67
  v_mfma_f32_32x32x16_bf16 v[80:95], v[28:31], a[60:63], v[80:95]
  v_cvt_pk_bf16_f32 v98, v68, v69
  v_cvt_pk_bf16_f32 v99, v70, v71
  v_mfma_f32_32x32x16_bf16 v[80:95], v[32:35], a[64:67], v[80:95]
  v_cvt_pk_bf16_f32 v100, v72, v73
  v_cvt_pk_bf16_f32 v101, v74, v75
  v_mfma_f32_32x32x16_bf16 v[80:95], v[36:39], a[68:71], v[80:95]
  v_cvt_pk_bf16_f32 v102, v76, v77
  v_cvt_pk_bf16_f32 v103, v78, v79
  v_mfma_f32_32x32x16_bf16 v[80:95], v[40:43], a[72:75], v[80:95]
  s_add_u32 s29, s30, 0
  buffer_store_dwordx4 v[96:99], v11, s[8:11], s29 offen offset:0 sc1
  v_mfma_f32_32x32x16_bf16 v[80:95], v[44:47], a[76:79], v[80:95]
  buffer_store_dwordx4 v[100:103], v11, s[8:11], s29 offen offset:256 sc1
  v_mfma_f32_32x32x16_bf16 v[80:95], v[48:51], a[80:83], v[80:95]
  v_mfma_f32_32x32x16_bf16 v[80:95], v[52:55], a[84:87], v[80:95]
  v_mfma_f32_32x32x16_bf16 v[80:95], v[56:59], a[88:91], v[80:95]
  v_mfma_f32_32x32x16_bf16 v[80:95], v[60:63], a[92:95], v[80:95]
  v_mfma_f32_32x32x16_bf16 v[64:79], v[16:19], a[96:99], 0
  v_mfma_f32_32x32x16_bf16 v[64:79], v[20:23], a[100:103], v[64:79]
  v_mfma_f32_32x32x16_bf16 v[64:79], v[24:27], a[104:107], v[64:79]
  v_cvt_pk_bf16_f32 v96, v80, v81
  v_cvt_pk_bf16_f32 v97, v82, v83
  v_mfma_f32_32x32x16_bf16 v[64:79], v[28:31], a[108:111], v[64:79]
  v_cvt_pk_bf16_f32 v98, v84, v85
  v_cvt_pk_bf16_f32 v99, v86, v87
  v_mfma_f32_32x32x16_bf16 v[64:79], v[32:35], a[112:115], v[64:79]
  v_cvt_pk_bf16_f32 v100, v88, v89
  v_cvt_pk_bf16_f32 v101, v90, v91
  v_mfma_f32_32x32x16_bf16 v[64:79], v[36:39], a[116:119], v[64:79]
  v_cvt_pk_bf16_f32 v102, v92, v93
  v_cvt_pk_bf16_f32 v103, v94, v95
  v_mfma_f32_32x32x16_bf16 v[64:79], v[40:43], a[120:123], v[64:79]
  s_add_u32 s29, s30, 2048
  buffer_store_dwordx4 v[96:99], v11, s[8:11], s29 offen offset:0 sc1
  v_mfma_f32_32x32x16_bf16 v[64:79], v[44:47], a[124:127], v[64:79]
  buffer_store_dwordx4 v[100:103], v11, s[8:11], s29 offen offset:256 sc1
  v_mfma_f32_32x32x16_bf16 v[64:79], v[48:51], a[128:131], v[64:79]
  v_mfma_f32_32x32x16_bf16 v[64:79], v[52:55], a[132:135], v[64:79]
  v_mfma_f32_32x32x16_bf16 v[64:79], v[56:59], a[136:139], v[64:79]
  v_mfma_f32_32x32x16_bf16 v[64:79], v[60:63], a[140:143], v[64:79]
  s_cmp_le_u32 s50, 2
  s_cbranch_scc1 mp_74
  s_waitcnt vmcnt(7)
  s_barrier
  s_cmp_eq_u32 s21, 0
  s_cbranch_scc0 mp_74
  v_mov_b32 v13, s50
  s_mov_b64 s[24:25], exec
  s_mov_b64 exec, 1
  buffer_store_dword v13, v14, s[8:11], 0 offen sc1
  s_mov_b64 exec, s[24:25]
mp_74:
  v_mfma_f32_32x32x16_bf16 v[80:95], v[16:19], a[144:147], 0
  v_mfma_f32_32x32x16_bf16 v[80:95], v[20:23], a[148:151], v[80:95]
  v_mfma_f32_32x32x16_bf16 v[80:95], v[24:27], a[152:155], v[80:95]
  v_cvt_pk_bf16_f32 v96, v64, v65
  v_cvt_pk_bf16_f32 v97, v66, v67
  v_mfma_f32_32x32x16_bf16 v[80:95], v[28:31], a[156:159], v[80:95]
  v_cvt_pk_bf16_f32 v98, v68, v69
  v_cvt_pk_bf16_f32 v99, v70, v71
  v_mfma_f32_32x32x16_bf16 v[80:95], v[32:35], a[160:163], v[80:95]
  v_cvt_pk_bf16_f32 v100, v72, v73
  v_cvt_pk_bf16_f32 v101, v74, v75
  v_mfma_f32_32x32x16_bf16 v[80:95], v[36:39], a[164:167], v[80:95]
  v_cvt_pk_bf16_f32 v102, v76, v77
  v_cvt_pk_bf16_f32 v103, v78, v79
  v_mfma_f32_32x32x16_bf16 v[80:95], v[40:43], a[168:171], v[80:95]
  s_add_u32 s29, s30, 4096
  buffer_store_dwordx4 v[96:99], v11, s[8:11], s29 offen offset:0 sc1
  v_mfma_f32_32x32x16_bf16 v[80:95], v[44:47], a[172:175], v[80:95]
  buffer_store_dwordx4 v[100:103], v11, s[8:11], s29 offen offset:256 sc1
  v_mfma_f32_32x32x16_bf16 v[80:95], v[48:51], a[176:179], v[80:95]
  v_mfma_f32_32x32x16_bf16 v[80:95], v[52:55], a[180:183], v[80:95]
  v_mfma_f32_32x32x16_bf16 v[80:95], v[56:59], a[184:187], v[80:95]
  v_mfma_f32_32x32x16_bf16 v[80:95], v[60:63], a[188:191], v[80:95]
  v_mfma_f32_32x32x16_bf16 v[64:79], v[16:19], a[192:195], 0
  v_mfma_f32_32x32x16_bf16 v[64:79], v[20:23], a[196:199], v[64:79]
  v_mfma_f32_32x32x16_bf16 v[64:79], v[24:27], a[200:203], v[64:79]
  v_cvt_pk_bf16_f32 v96, v80, v81
  v_cvt_pk_bf16_f32 v97, v82, v83
  v_mfma_f32_32x32x16_bf16 v[64:79], v[28:31], a[204:207], v[64:79]
  v_cvt_pk_bf16_f32 v98, v84, v85
  v_cvt_pk_bf16_f32 v99, v86, v87
  v_mfma_f32_32x32x16_bf16 v[64:79], v[32:35], a[208:211], v[64:79]
  v_cvt_pk_bf16_f32 v100, v88, v89
  v_cvt_pk_bf16_f32 v101, v90, v91
  v_mfma_f32_32x32x16_bf16 v[64:79], v[36:39], a[212:215], v[64:79]
  v_cvt_pk_bf16_f32 v102, v92, v93
  v_cvt_pk_bf16_f32 v103, v94, v95
  v_mfma_f32_32x32x16_bf16 v[64:79], v[40:43], a[216:219], v[64:79]
  s_add_u32 s29, s30, 6144
  buffer_store_dwordx4 v[96:99], v11, s[8:11], s29 offen offset:0 sc1
  v_mfma_f32_32x32x16_bf16 v[64:79], v[44:47], a[220:223], v[64:79]
  buffer_store_dwordx4 v[100:103], v11, s[8:11], s29 offen offset:256 sc1
  v_mfma_f32_32x32x16_bf16 v[64:79], v[48:51], a[224:227], v[64:79]
  v_mfma_f32_32x32x16_bf16 v[64:79], v[52:55], a[228:231], v[64:79]
  v_mfma_f32_32x32x16_bf16 v[64:79], v[56:59], a[232:235], v[64:79]
  v_mfma_f32_32x32x16_bf16 v[64:79], v[60:63], a[236:239], v[64:79]
  s_nop 11
  v_cvt_pk_bf16_f32 v96, v64, v65
  v_cvt_pk_bf16_f32 v97, v66, v67
  v_cvt_pk_bf16_f32 v98, v68, v69
  v_cvt_pk_bf16_f32 v99, v70, v71
  v_cvt_pk_bf16_f32 v100, v72, v73
  v_cvt_pk_bf16_f32 v101, v74, v75
  v_cvt_pk_bf16_f32 v102, v76, v77
  v_cvt_pk_bf16_f32 v103, v78, v79
  s_add_u32 s29, s30, 8192
  buffer_store_dwordx4 v[96:99], v11, s[8:11], s29 offen offset:0 sc1
  buffer_store_dwordx4 v[100:103], v11, s[8:11], s29 offen offset:256 sc1
  s_cmp_eq_u32 s54, 0
  s_cbranch_scc1 udf_75
  s_cmp_gt_u32 s52, s53
  s_cbranch_scc1 ka_wp_76_ok
  s_mov_b32 s45, 0
ka_wp_76_spin:
  buffer_load_dword v2, v12, s[8:11], 0 offen sc1
  s_add_u32 s45, s45, 1
  s_waitcnt vmcnt(0)
  v_min_u32_dpp v3, v2, v2 quad_perm:[1,0,3,2] row_mask:0xf bank_mask:0xf
  s_nop 1
  v_min_u32_dpp v2, v3, v3 quad_perm:[2,3,0,1] row_mask:0xf bank_mask:0xf
  s_nop 1
  v_min_u32_dpp v3, v2, v2 row_half_mirror row_mask:0xf bank_mask:0xf
  s_nop 1
  v_min_u32_dpp v2, v3, v3 quad_perm:[0,1,2,3] row_mask:0xf bank_mask:0xf
  s_nop 0
  v_readfirstlane_b32 s52, v2
  s_cmp_gt_u32 s52, s53
  s_cbranch_scc1 ka_wp_76_ok
  s_cmp_lt_u32 s45, 400000
  s_cbranch_scc1 ka_wp_76_spin
  s_branch ka_abort
ka_wp_76_ok:
  s_lshl_b32 s29, s21, 10
  s_add_u32 m0, s29, 0
  s_add_u32 s28, s47, 0
  buffer_load_dwordx4 v6, s[8:11], s28 offen sc1 lds
  s_lshl_b32 s29, s21, 10
  s_add_u32 m0, s29, 4096
  s_add_u32 s28, s47, 4096
  buffer_load_dwordx4 v6, s[8:11], s28 offen sc1 lds
  s_lshl_b32 s29, s21, 10
  s_add_u32 m0, s29, 8192
  s_add_u32 s28, s47, 8192
  buffer_load_dwordx4 v6, s[8:11], s28 offen sc1 lds
  s_add_u32 s47, s47, 12288
udf_75:
  s_add_u32 s50, s50, 1
  s_cmp_le_u32 s50, 2
  s_cbranch_scc0 ep_77
  s_waitcnt vmcnt(0)
  s_barrier
  s_cmp_eq_u32 s21, 0
  s_cbranch_scc0 ep_77
  v_mov_b32 v13, s50
  s_mov_b64 s[24:25], exec
  s_mov_b64 exec, 1
  buffer_store_dword v13, v14, s[8:11], 0 offen sc1
  s_mov_b64 exec, s[24:25]
ep_77:
  s_cmp_lt_u32 s50, 64
  s_cbranch_scc1 ka_u_loop
  s_waitcnt vmcnt(0)
  s_barrier
  s_cmp_eq_u32 s21, 0
  s_cbranch_scc0 ka_exit
  v_mov_b32 v13, 64
  s_mov_b64 exec, 1
  buffer_store_dword v13, v14, s[8:11], 0 offen sc1
  s_waitcnt vmcnt(0)
  s_branch ka_exit
.macro CHAINROLES sfx, pol
ka\sfx\()_x:
  s_mov_b32 s12, s36
  s_and_b32 s13, s37, 0xffff
  s_mov_b32 s14, 0x780000
  s_mov_b32 s15, 0x20000
  s_mov_b32 s16, s38
  s_and_b32 s17, s39, 0xffff
  s_mov_b32 s18, 0x780000
  s_mov_b32 s19, 0x20000
  v_and_b32 v1, 63, v0
  v_lshrrev_b32 v2, 4, v1
  v_bfe_u32 v3, v1, 3, 1
  v_bfe_u32 v4, v1, 1, 2
  v_and_b32 v5, 1, v1
  s_mul_i32 s46, s23, 384
  s_lshl_b32 s28, s21, 2
  s_add_u32 s28, s28, 0
  v_add_u32 v6, s28, v2
  v_mul_u32_u24 v7, 43, v6
  v_lshrrev_b32 v7, 9, v7
  v_mul_u32_u24 v8, 12, v7
  v_sub_u32 v8, v6, v8
  v_lshrrev_b32 v9, 1, v7
  v_lshlrev_b32 v9, 4, v9
  v_and_b32 v10, 1, v7
  v_lshlrev_b32 v10, 2, v10
  v_add_u32 v9, v9, v10
  v_lshlrev_b32 v10, 3, v3
  v_add_u32 v9, v9, v10
  v_add_u32 v9, v9, v4
  v_mul_u32_u24 v9, 12288, v9
  v_lshrrev_b32 v10, 1, v8
  v_lshlrev_b32 v10, 2, v10
  v_lshlrev_b32 v11, 1, v5
  v_add_u32 v10, v10, v11
  v_and_b32 v11, 1, v8
  v_add_u32 v10, v10, v11
  v_lshlrev_b32 v10, 4, v10
  v_add_u32 v9, v9, v10
  v_add_u32 v136, s46, v9
  s_lshl_b32 s28, s21, 2
  s_add_u32 s28, s28, 16
  v_add_u32 v6, s28, v2
  v_mul_u32_u24 v7, 43, v6
  v_lshrrev_b32 v7, 9, v7
  v_mul_u32_u24 v8, 12, v7
  v_sub_u32 v8, v6, v8
  v_lshrrev_b32 v9, 1, v7
  v_lshlrev_b32 v9, 4, v9
  v_and_b32 v10, 1, v7
  v_lshlrev_b32 v10, 2, v10
  v_add_u32 v9, v9, v10
  v_lshlrev_b32 v10, 3, v3
  v_add_u32 v9, v9, v10
  v_add_u32 v9, v9, v4
  v_mul_u32_u24 v9, 12288, v9
  v_lshrrev_b32 v10, 1, v8
  v_lshlrev_b32 v10, 2, v10
  v_lshlrev_b32 v11, 1, v5
  v_add_u32 v10, v10, v11
  v_and_b32 v11, 1, v8
  v_add_u32 v10, v10, v11
  v_lshlrev_b32 v10, 4, v10
  v_add_u32 v9, v9, v10
  v_add_u32 v137, s46, v9
  s_lshl_b32 s28, s21, 2
  s_add_u32 s28, s28, 32
  v_add_u32 v6, s28, v2
  v_mul_u32_u24 v7, 43, v6
  v_lshrrev_b32 v7, 9, v7
  v_mul_u32_u24 v8, 12, v7
  v_sub_u32 v8, v6, v8
  v_lshrrev_b32 v9, 1, v7
  v_lshlrev_b32 v9, 4, v9
  v_and_b32 v10, 1, v7
  v_lshlrev_b32 v10, 2, v10
  v_add_u32 v9, v9, v10
  v_lshlrev_b32 v10, 3, v3
  v_add_u32 v9, v9, v10
  v_add_u32 v9, v9, v4
  v_mul_u32_u24 v9, 12288, v9
  v_lshrrev_b32 v10, 1, v8
  v_lshlrev_b32 v10, 2, v10
  v_lshlrev_b32 v11, 1, v5
  v_add_u32 v10, v10, v11
  v_and_b32 v11, 1, v8
  v_add_u32 v10, v10, v11
  v_lshlrev_b32 v10, 4, v10
  v_add_u32 v9, v9, v10
  v_add_u32 v138, s46, v9
  s_lshl_b32 s28, s21, 2
  s_add_u32 s28, s28, 48
  v_add_u32 v6, s28, v2
  v_mul_u32_u24 v7, 43, v6
  v_lshrrev_b32 v7, 9, v7
  v_mul_u32_u24 v8, 12, v7
  v_sub_u32 v8, v6, v8
  v_lshrrev_b32 v9, 1, v7
  v_lshlrev_b32 v9, 4, v9
  v_and_b32 v10, 1, v7
  v_lshlrev_b32 v10, 2, v10
  v_add_u32 v9, v9, v10
  v_lshlrev_b32 v10, 3, v3
  v_add_u32 v9, v9, v10
  v_add_u32 v9, v9, v4
  v_mul_u32_u24 v9, 12288, v9
  v_lshrrev_b32 v10, 1, v8
  v_lshlrev_b32 v10, 2, v10
  v_lshlrev_b32 v11, 1, v5
  v_add_u32 v10, v10, v11
  v_and_b32 v11, 1, v8
  v_add_u32 v10, v10, v11
  v_lshlrev_b32 v10, 4, v10
  v_add_u32 v9, v9, v10
  v_add_u32 v139, s46, v9
  s_lshl_b32 s28, s21, 2
  s_add_u32 s28, s28, 64
  v_add_u32 v6, s28, v2
  v_mul_u32_u24 v7, 43, v6
  v_lshrrev_b32 v7, 9, v7
  v_mul_u32_u24 v8, 12, v7
  v_sub_u32 v8, v6, v8
  v_lshrrev_b32 v9, 1, v7
  v_lshlrev_b32 v9, 4, v9
  v_and_b32 v10, 1, v7
  v_lshlrev_b32 v10, 2, v10
  v_add_u32 v9, v9, v10
  v_lshlrev_b32 v10, 3, v3
  v_add_u32 v9, v9, v10
  v_add_u32 v9, v9, v4
  v_mul_u32_u24 v9, 12288, v9
  v_lshrrev_b32 v10, 1, v8
  v_lshlrev_b32 v10, 2, v10
  v_lshlrev_b32 v11, 1, v5
  v_add_u32 v10, v10, v11
  v_and_b32 v11, 1, v8
  v_add_u32 v10, v10, v11
  v_lshlrev_b32 v10, 4, v10
  v_add_u32 v9, v9, v10
  v_add_u32 v140, s46, v9
  s_lshl_b32 s28, s21, 2
  s_add_u32 s28, s28, 80
  v_add_u32 v6, s28, v2
  v_mul_u32_u24 v7, 43, v6
  v_lshrrev_b32 v7, 9, v7
  v_mul_u32_u24 v8, 12, v7
  v_sub_u32 v8, v6, v8
  v_lshrrev_b32 v9, 1, v7
  v_lshlrev_b32 v9, 4, v9
  v_and_b32 v10, 1, v7
  v_lshlrev_b32 v10, 2, v10
  v_add_u32 v9, v9, v10
  v_lshlrev_b32 v10, 3, v3
  v_add_u32 v9, v9, v10
  v_add_u32 v9, v9, v4
  v_mul_u32_u24 v9, 12288, v9
  v_lshrrev_b32 v10, 1, v8
  v_lshlrev_b32 v10, 2, v10
  v_lshlrev_b32 v11, 1, v5
  v_add_u32 v10, v10, v11
  v_and_b32 v11, 1, v8
  v_add_u32 v10, v10, v11
  v_lshlrev_b32 v10, 4, v10
  v_add_u32 v9, v9, v10
  v_add_u32 v141, s46, v9
  v_lshrrev_b32 v6, 1, v2
  v_mul_u32_u24 v142, 6144, v6
  v_and_b32 v6, 1, v2
  v_lshlrev_b32 v6, 7, v6
  v_add_u32 v142, v142, v6
  v_bfe_u32 v6, v1, 2, 2
  v_lshlrev_b32 v6, 5, v6
  v_add_u32 v142, v142, v6
  v_and_b32 v6, 1, v1
  v_lshlrev_b32 v6, 4, v6
  v_add_u32 v142, v142, v6
  v_bfe_u32 v6, v1, 1, 1
  v_lshlrev_b32 v6, 3, v6
  v_add_u32 v142, v142, v6
  s_mul_i32 s28, s21, 768
  v_add_u32 v142, s28, v142
  s_lshl_b32 s29, s21, 10
  s_add_u32 m0, s29, 0
  s_mov_b32 s28, 0
  buffer_load_dwordx4 v136, s[12:15], s28 offen lds
  s_lshl_b32 s29, s21, 10
  s_add_u32 m0, s29, 4096
  s_mov_b32 s28, 0
  buffer_load_dwordx4 v137, s[12:15], s28 offen lds
  s_lshl_b32 s29, s21, 10
  s_add_u32 m0, s29, 8192
  s_mov_b32 s28, 0
  buffer_load_dwordx4 v138, s[12:15], s28 offen lds
  s_lshl_b32 s29, s21, 10
  s_add_u32 m0, s29, 12288
  s_mov_b32 s28, 0
  buffer_load_dwordx4 v139, s[12:15], s28 offen lds
  s_lshl_b32 s29, s21, 10
  s_add_u32 m0, s29, 16384
  s_mov_b32 s28, 0
  buffer_load_dwordx4 v140, s[12:15], s28 offen lds
  s_lshl_b32 s29, s21, 10
  s_add_u32 m0, s29, 20480
  s_mov_b32 s28, 0
  buffer_load_dwordx4 v141, s[12:15], s28 offen lds
  s_lshl_b32 s29, s21, 10
  s_add_u32 m0, s29, 24576
  s_mov_b32 s28, 786432
  buffer_load_dwordx4 v136, s[12:15], s28 offen lds
  s_lshl_b32 s29, s21, 10
  s_add_u32 m0, s29, 28672
  s_mov_b32 s28, 786432
  buffer_load_dwordx4 v137, s[12:15], s28 offen lds
  s_lshl_b32 s29, s21, 10
  s_add_u32 m0, s29, 32768
  s_mov_b32 s28, 786432
  buffer_load_dwordx4 v138, s[12:15], s28 offen lds
  s_lshl_b32 s29, s21, 10
  s_add_u32 m0, s29, 36864
  s_mov_b32 s28, 786432
  buffer_load_dwordx4 v139, s[12:15], s28 offen lds
  s_lshl_b32 s29, s21, 10
  s_add_u32 m0, s29, 40960
  s_mov_b32 s28, 786432
  buffer_load_dwordx4 v140, s[12:15], s28 offen lds
  s_lshl_b32 s29, s21, 10
  s_add_u32 m0, s29, 45056
  s_mov_b32 s28, 786432
  buffer_load_dwordx4 v141, s[12:15], s28 offen lds
  s_lshl_b32 s29, s21, 10
  s_add_u32 m0, s29, 49152
  s_mov_b32 s28, 1572864
  buffer_load_dwordx4 v136, s[12:15], s28 offen lds
  s_lshl_b32 s29, s21, 10
  s_add_u32 m0, s29, 53248
  s_mov_b32 s28, 1572864
  buffer_load_dwordx4 v137, s[12:15], s28 offen lds
  s_lshl_b32 s29, s21, 10
  s_add_u32 m0, s29, 57344
  s_mov_b32 s28, 1572864
  buffer_load_dwordx4 v138, s[12:15], s28 offen lds
  s_lshl_b32 s29, s21, 10
  s_add_u32 m0, s29, 61440
  s_mov_b32 s28, 1572864
  buffer_load_dwordx4 v139, s[12:15], s28 offen lds
  s_lshl_b32 s29, s21, 10
  s_add_u32 m0, s29, 65536
  s_mov_b32 s28, 1572864
  buffer_load_dwordx4 v140, s[12:15], s28 offen lds
  s_lshl_b32 s29, s21, 10
  s_add_u32 m0, s29, 69632
  s_mov_b32 s28, 1572864
  buffer_load_dwordx4 v141, s[12:15], s28 offen lds
  s_lshl_b32 s29, s21, 10
  s_add_u32 m0, s29, 73728
  s_mov_b32 s28, 2359296
  buffer_load_dwordx4 v136, s[12:15], s28 offen lds
  s_lshl_b32 s29, s21, 10
  s_add_u32 m0, s29, 77824
  s_mov_b32 s28, 2359296
  buffer_load_dwordx4 v137, s[12:15], s28 offen lds
  s_lshl_b32 s29, s21, 10
  s_add_u32 m0, s29, 81920
  s_mov_b32 s28, 2359296
  buffer_load_dwordx4 v138, s[12:15], s28 offen lds
  s_lshl_b32 s29, s21, 10
  s_add_u32 m0, s29, 86016
  s_mov_b32 s28, 2359296
  buffer_load_dwordx4 v139, s[12:15], s28 offen lds
  s_lshl_b32 s29, s21, 10
  s_add_u32 m0, s29, 90112
  s_mov_b32 s28, 2359296
  buffer_load_dwordx4 v140, s[12:15], s28 offen lds
  s_lshl_b32 s29, s21, 10
  s_add_u32 m0, s29, 94208
  s_mov_b32 s28, 2359296
  buffer_load_dwordx4 v141, s[12:15], s28 offen lds
  s_lshl_b32 s29, s21, 10
  s_add_u32 m0, s29, 98304
  s_mov_b32 s28, 3145728
  buffer_load_dwordx4 v136, s[12:15], s28 offen lds
  s_lshl_b32 s29, s21, 10
  s_add_u32 m0, s29, 102400
  s_mov_b32 s28, 3145728
  buffer_load_dwordx4 v137, s[12:15], s28 offen lds
  s_lshl_b32 s29, s21, 10
  s_add_u32 m0, s29, 106496
  s_mov_b32 s28, 3145728
  buffer_load_dwordx4 v138, s[12:15], s28 offen lds
  s_lshl_b32 s29, s21, 10
  s_add_u32 m0, s29, 110592
  s_mov_b32 s28, 3145728
  buffer_load_dwordx4 v139, s[12:15], s28 offen lds
  s_lshl_b32 s29, s21, 10
  s_add_u32 m0, s29, 114688
  s_mov_b32 s28, 3145728
  buffer_load_dwordx4 v140, s[12:15], s28 offen lds
  s_lshl_b32 s29, s21, 10
  s_add_u32 m0, s29, 118784
  s_mov_b32 s28, 3145728
  buffer_load_dwordx4 v141, s[12:15], s28 offen lds
  s_waitcnt vmcnt(24)
  s_cmp_eq_u32 s21, 3
  s_cbranch_scc0 lna_78_\sfx\()
  s_mov_b64 s[24:25], exec
  s_mov_b64 exec, 1
  s_and_b32 s45, s2, 7
  s_lshl_b32 s45, s45, 7
  s_add_u32 s45, s45, 10240
  v_mov_b32 v2, s45
  v_mov_b32 v3, 1
  buffer_atomic_add v3, v2, s[8:11], 0 offen
  s_mov_b64 exec, s[24:25]
lna_78_\sfx\():
  s_barrier
  s_lshl_b32 s29, s21, 10
  s_add_u32 m0, s29, 122880
  s_mov_b32 s28, 3932160
  buffer_load_dwordx4 v136, s[12:15], s28 offen lds
  s_lshl_b32 s29, s21, 10
  s_add_u32 m0, s29, 126976
  s_mov_b32 s28, 3932160
  buffer_load_dwordx4 v137, s[12:15], s28 offen lds
  s_lshl_b32 s29, s21, 10
  s_add_u32 m0, s29, 131072
  s_mov_b32 s28, 3932160
  buffer_load_dwordx4 v138, s[12:15], s28 offen lds
  s_lshl_b32 s29, s21, 10
  s_add_u32 m0, s29, 135168
  s_mov_b32 s28, 3932160
  buffer_load_dwordx4 v139, s[12:15], s28 offen lds
  s_lshl_b32 s29, s21, 10
  s_add_u32 m0, s29, 139264
  s_mov_b32 s28, 3932160
  buffer_load_dwordx4 v140, s[12:15], s28 offen lds
  s_lshl_b32 s29, s21, 10
  s_add_u32 m0, s29, 143360
  s_mov_b32 s28, 3932160
  buffer_load_dwordx4 v141, s[12:15], s28 offen lds
  v_add_u32 v143, 0, v142
  ds_read_b64_tr_b16 a[0:1], v143 offset:0
  ds_read_b64_tr_b16 a[2:3], v143 offset:3072
  ds_read_b64_tr_b16 a[4:5], v143 offset:12288
  ds_read_b64_tr_b16 a[6:7], v143 offset:15360
  ds_read_b64_tr_b16 a[80:81], v143 offset:256
  ds_read_b64_tr_b16 a[82:83], v143 offset:3328
  ds_read_b64_tr_b16 a[84:85], v143 offset:12544
  ds_read_b64_tr_b16 a[86:87], v143 offset:15616
  ds_read_b64_tr_b16 a[160:161], v143 offset:512
  ds_read_b64_tr_b16 a[162:163], v143 offset:3584
  ds_read_b64_tr_b16 a[164:165], v143 offset:12800
  ds_read_b64_tr_b16 a[166:167], v143 offset:15872
  s_waitcnt lgkmcnt(0)
  s_waitcnt vmcnt(24)
  s_barrier
  s_lshl_b32 s29, s21, 10
  s_add_u32 m0, s29, 0
  s_mov_b32 s28, 4718592
  buffer_load_dwordx4 v136, s[12:15], s28 offen lds
  s_lshl_b32 s29, s21, 10
  s_add_u32 m0, s29, 4096
  s_mov_b32 s28, 4718592
  buffer_load_dwordx4 v137, s[12:15], s28 offen lds
  s_lshl_b32 s29, s21, 10
  s_add_u32 m0, s29, 8192
  s_mov_b32 s28, 4718592
  buffer_load_dwordx4 v138, s[12:15], s28 offen lds
  s_lshl_b32 s29, s21, 10
  s_add_u32 m0, s29, 12288
  s_mov_b32 s28, 4718592
  buffer_load_dwordx4 v139, s[12:15], s28 offen lds
  s_lshl_b32 s29, s21, 10
  s_add_u32 m0, s29, 16384
  s_mov_b32 s28, 4718592
  buffer_load_dwordx4 v140, s[12:15], s28 offen lds
  s_lshl_b32 s29, s21, 10
  s_add_u32 m0, s29, 20480
  s_mov_b32 s28, 4718592
  buffer_load_dwordx4 v141, s[12:15], s28 offen lds
  v_add_u32 v143, 24576, v142
  ds_read_b64_tr_b16 a[8:9], v143 offset:0
  ds_read_b64_tr_b16 a[10:11], v143 offset:3072
  ds_read_b64_tr_b16 a[12:13], v143 offset:12288
  ds_read_b64_tr_b16 a[14:15], v143 offset:15360
  ds_read_b64_tr_b16 a[88:89], v143 offset:256
  ds_read_b64_tr_b16 a[90:91], v143 offset:3328
  ds_read_b64_tr_b16 a[92:93], v143 offset:12544
  ds_read_b64_tr_b16 a[94:95], v143 offset:15616
  ds_read_b64_tr_b16 a[168:169], v143 offset:512
  ds_read_b64_tr_b16 a[170:171], v143 offset:3584
  ds_read_b64_tr_b16 a[172:173], v143 offset:12800
  ds_read_b64_tr_b16 a[174:175], v143 offset:15872
  s_waitcnt lgkmcnt(0)
  s_waitcnt vmcnt(24)
  s_barrier
  s_lshl_b32 s29, s21, 10
  s_add_u32 m0, s29, 24576
  s_mov_b32 s28, 5505024
  buffer_load_dwordx4 v136, s[12:15], s28 offen lds
  s_lshl_b32 s29, s21, 10
  s_add_u32 m0, s29, 28672
  s_mov_b32 s28, 5505024
  buffer_load_dwordx4 v137, s[12:15], s28 offen lds
  s_lshl_b32 s29, s21, 10
  s_add_u32 m0, s29, 32768
  s_mov_b32 s28, 5505024
  buffer_load_dwordx4 v138, s[12:15], s28 offen lds
  s_lshl_b32 s29, s21, 10
  s_add_u32 m0, s29, 36864
  s_mov_b32 s28, 5505024
  buffer_load_dwordx4 v139, s[12:15], s28 offen lds
  s_lshl_b32 s29, s21, 10
  s_add_u32 m0, s29, 40960
  s_mov_b32 s28, 5505024
  buffer_load_dwordx4 v140, s[12:15], s28 offen lds
  s_lshl_b32 s29, s21, 10
  s_add_u32 m0, s29, 45056
  s_mov_b32 s28, 5505024
  buffer_load_dwordx4 v141, s[12:15], s28 offen lds
  v_add_u32 v143, 49152, v142
  ds_read_b64_tr_b16 a[16:17], v143 offset:0
  ds_read_b64_tr_b16 a[18:19], v143 offset:3072
  ds_read_b64_tr_b16 a[20:21], v143 offset:12288
  ds_read_b64_tr_b16 a[22:23], v143 offset:15360
  ds_read_b64_tr_b16 a[96:97], v143 offset:256
  ds_read_b64_tr_b16 a[98:99], v143 offset:3328
  ds_read_b64_tr_b16 a[100:101], v143 offset:12544
  ds_read_b64_tr_b16 a[102:103], v143 offset:15616
  ds_read_b64_tr_b16 a[176:177], v143 offset:512
  ds_read_b64_tr_b16 a[178:179], v143 offset:3584
  ds_read_b64_tr_b16 a[180:181], v143 offset:12800
  ds_read_b64_tr_b16 a[182:183], v143 offset:15872
  s_waitcnt lgkmcnt(0)
  s_waitcnt vmcnt(24)
  s_barrier
  s_lshl_b32 s29, s21, 10
  s_add_u32 m0, s29, 49152
  s_mov_b32 s28, 6291456
  buffer_load_dwordx4 v136, s[12:15], s28 offen lds
  s_lshl_b32 s29, s21, 10
  s_add_u32 m0, s29, 53248
  s_mov_b32 s28, 6291456
  buffer_load_dwordx4 v137, s[12:15], s28 offen lds
  s_lshl_b32 s29, s21, 10
  s_add_u32 m0, s29, 57344
  s_mov_b32 s28, 6291456
  buffer_load_dwordx4 v138, s[12:15], s28 offen lds
  s_lshl_b32 s29, s21, 10
  s_add_u32 m0, s29, 61440
  s_mov_b32 s28, 6291456
  buffer_load_dwordx4 v139, s[12:15], s28 offen lds
  s_lshl_b32 s29, s21, 10
  s_add_u32 m0, s29, 65536
  s_mov_b32 s28, 6291456
  buffer_load_dwordx4 v140, s[12:15], s28 offen lds
  s_lshl_b32 s29, s21, 10
  s_add_u32 m0, s29, 69632
  s_mov_b32 s28, 6291456
  buffer_load_dwordx4 v141, s[12:15], s28 offen lds
  v_add_u32 v143, 73728, v142
  ds_read_b64_tr_b16 a[24:25], v143 offset:0
  ds_read_b64_tr_b16 a[26:27], v143 offset:3072
  ds_read_b64_tr_b16 a[28:29], v143 offset:12288
  ds_read_b64_tr_b16 a[30:31], v143 offset:15360
  ds_read_b64_tr_b16 a[104:105], v143 offset:256
  ds_read_b64_tr_b16 a[106:107], v143 offset:3328
  ds_read_b64_tr_b16 a[108:109], v143 offset:12544
  ds_read_b64_tr_b16 a[110:111], v143 offset:15616
  ds_read_b64_tr_b16 a[184:185], v143 offset:512
  ds_read_b64_tr_b16 a[186:187], v143 offset:3584
  ds_read_b64_tr_b16 a[188:189], v143 offset:12800
  ds_read_b64_tr_b16 a[190:191], v143 offset:15872
  s_waitcnt lgkmcnt(0)
  s_waitcnt vmcnt(24)
  s_barrier
  s_lshl_b32 s29, s21, 10
  s_add_u32 m0, s29, 73728
  s_mov_b32 s28, 7077888
  buffer_load_dwordx4 v136, s[12:15], s28 offen lds
  s_lshl_b32 s29, s21, 10
  s_add_u32 m0, s29, 77824
  s_mov_b32 s28, 7077888
  buffer_load_dwordx4 v137, s[12:15], s28 offen lds
  s_lshl_b32 s29, s21, 10
  s_add_u32 m0, s29, 81920
  s_mov_b32 s28, 7077888
  buffer_load_dwordx4 v138, s[12:15], s28 offen lds
  s_lshl_b32 s29, s21, 10
  s_add_u32 m0, s29, 86016
  s_mov_b32 s28, 7077888
  buffer_load_dwordx4 v139, s[12:15], s28 offen lds
  s_lshl_b32 s29, s21, 10
  s_add_u32 m0, s29, 90112
  s_mov_b32 s28, 7077888
  buffer_load_dwordx4 v140, s[12:15], s28 offen lds
  s_lshl_b32 s29, s21, 10
  s_add_u32 m0, s29, 94208
  s_mov_b32 s28, 7077888
  buffer_load_dwordx4 v141, s[12:15], s28 offen lds
  v_add_u32 v143, 98304, v142
  ds_read_b64_tr_b16 a[32:33], v143 offset:0
  ds_read_b64_tr_b16 a[34:35], v143 offset:3072
  ds_read_b64_tr_b16 a[36:37], v143 offset:12288
  ds_read_b64_tr_b16 a[38:39], v143 offset:15360
  ds_read_b64_tr_b16 a[112:113], v143 offset:256
  ds_read_b64_tr_b16 a[114:115], v143 offset:3328
  ds_read_b64_tr_b16 a[116:117], v143 offset:12544
  ds_read_b64_tr_b16 a[118:119], v143 offset:15616
  ds_read_b64_tr_b16 a[192:193], v143 offset:512
  ds_read_b64_tr_b16 a[194:195], v143 offset:3584
  ds_read_b64_tr_b16 a[196:197], v143 offset:12800
  ds_read_b64_tr_b16 a[198:199], v143 offset:15872
  s_waitcnt lgkmcnt(0)
  s_waitcnt vmcnt(24)
  s_barrier
  s_lshl_b32 s29, s21, 10
  s_add_u32 m0, s29, 98304
  s_mov_b32 s28, 0
  buffer_load_dwordx4 v136, s[16:19], s28 offen lds
  s_lshl_b32 s29, s21, 10
  s_add_u32 m0, s29, 102400
  s_mov_b32 s28, 0
  buffer_load_dwordx4 v137, s[16:19], s28 offen lds
  s_lshl_b32 s29, s21, 10
  s_add_u32 m0, s29, 106496
  s_mov_b32 s28, 0
  buffer_load_dwordx4 v138, s[16:19], s28 offen lds
  s_lshl_b32 s29, s21, 10
  s_add_u32 m0, s29, 110592
  s_mov_b32 s28, 0
  buffer_load_dwordx4 v139, s[16:19], s28 offen lds
  s_lshl_b32 s29, s21, 10
  s_add_u32 m0, s29, 114688
  s_mov_b32 s28, 0
  buffer_load_dwordx4 v140, s[16:19], s28 offen lds
  s_lshl_b32 s29, s21, 10
  s_add_u32 m0, s29, 118784
  s_mov_b32 s28, 0
  buffer_load_dwordx4 v141, s[16:19], s28 offen lds
  v_add_u32 v143, 122880, v142
  ds_read_b64_tr_b16 a[40:41], v143 offset:0
  ds_read_b64_tr_b16 a[42:43], v143 offset:3072
  ds_read_b64_tr_b16 a[44:45], v143 offset:12288
  ds_read_b64_tr_b16 a[46:47], v143 offset:15360
  ds_read_b64_tr_b16 a[120:121], v143 offset:256
  ds_read_b64_tr_b16 a[122:123], v143 offset:3328
  ds_read_b64_tr_b16 a[124:125], v143 offset:12544
  ds_read_b64_tr_b16 a[126:127], v143 offset:15616
  ds_read_b64_tr_b16 a[200:201], v143 offset:512
  ds_read_b64_tr_b16 a[202:203], v143 offset:3584
  ds_read_b64_tr_b16 a[204:205], v143 offset:12800
  ds_read_b64_tr_b16 a[206:207], v143 offset:15872
  s_waitcnt lgkmcnt(0)
  s_waitcnt vmcnt(24)
  s_barrier
  s_lshl_b32 s29, s21, 10
  s_add_u32 m0, s29, 122880
  s_mov_b32 s28, 1572864
  buffer_load_dwordx4 v136, s[16:19], s28 offen lds
  s_lshl_b32 s29, s21, 10
  s_add_u32 m0, s29, 126976
  s_mov_b32 s28, 1572864
  buffer_load_dwordx4 v137, s[16:19], s28 offen lds
  s_lshl_b32 s29, s21, 10
  s_add_u32 m0, s29, 131072
  s_mov_b32 s28, 1572864
  buffer_load_dwordx4 v138, s[16:19], s28 offen lds
  s_lshl_b32 s29, s21, 10
  s_add_u32 m0, s29, 135168
  s_mov_b32 s28, 1572864
  buffer_load_dwordx4 v139, s[16:19], s28 offen lds
  s_lshl_b32 s29, s21, 10
  s_add_u32 m0, s29, 139264
  s_mov_b32 s28, 1572864
  buffer_load_dwordx4 v140, s[16:19], s28 offen lds
  s_lshl_b32 s29, s21, 10
  s_add_u32 m0, s29, 143360
  s_mov_b32 s28, 1572864
  buffer_load_dwordx4 v141, s[16:19], s28 offen lds
  v_add_u32 v143, 0, v142
  ds_read_b64_tr_b16 a[48:49], v143 offset:0
  ds_read_b64_tr_b16 a[50:51], v143 offset:3072
  ds_read_b64_tr_b16 a[52:53], v143 offset:12288
  ds_read_b64_tr_b16 a[54:55], v143 offset:15360
  ds_read_b64_tr_b16 a[128:129], v143 offset:256
  ds_read_b64_tr_b16 a[130:131], v143 offset:3328
  ds_read_b64_tr_b16 a[132:133], v143 offset:12544
  ds_read_b64_tr_b16 a[134:135], v143 offset:15616
  ds_read_b64_tr_b16 a[208:209], v143 offset:512
  ds_read_b64_tr_b16 a[210:211], v143 offset:3584
  ds_read_b64_tr_b16 a[212:213], v143 offset:12800
  ds_read_b64_tr_b16 a[214:215], v143 offset:15872
  s_waitcnt lgkmcnt(0)
  s_waitcnt vmcnt(24)
  s_barrier
  s_lshl_b32 s29, s21, 10
  s_add_u32 m0, s29, 0
  s_mov_b32 s28, 3145728
  buffer_load_dwordx4 v136, s[16:19], s28 offen lds
  s_lshl_b32 s29, s21, 10
  s_add_u32 m0, s29, 4096
  s_mov_b32 s28, 3145728
  buffer_load_dwordx4 v137, s[16:19], s28 offen lds
  s_lshl_b32 s29, s21, 10
  s_add_u32 m0, s29, 8192
  s_mov_b32 s28, 3145728
  buffer_load_dwordx4 v138, s[16:19], s28 offen lds
  s_lshl_b32 s29, s21, 10
  s_add_u32 m0, s29, 12288
  s_mov_b32 s28, 3145728
  buffer_load_dwordx4 v139, s[16:19], s28 offen lds
  s_lshl_b32 s29, s21, 10
  s_add_u32 m0, s29, 16384
  s_mov_b32 s28, 3145728
  buffer_load_dwordx4 v140, s[16:19], s28 offen lds
  s_lshl_b32 s29, s21, 10
  s_add_u32 m0, s29, 20480
  s_mov_b32 s28, 3145728
  buffer_load_dwordx4 v141, s[16:19], s28 offen lds
  v_add_u32 v143, 24576, v142
  ds_read_b64_tr_b16 a[56:57], v143 offset:0
  ds_read_b64_tr_b16 a[58:59], v143 offset:3072
  ds_read_b64_tr_b16 a[60:61], v143 offset:12288
  ds_read_b64_tr_b16 a[62:63], v143 offset:15360
  ds_read_b64_tr_b16 a[136:137], v143 offset:256
  ds_read_b64_tr_b16 a[138:139], v143 offset:3328
  ds_read_b64_tr_b16 a[140:141], v143 offset:12544
  ds_read_b64_tr_b16 a[142:143], v143 offset:15616
  ds_read_b64_tr_b16 a[216:217], v143 offset:512
  ds_read_b64_tr_b16 a[218:219], v143 offset:3584
  ds_read_b64_tr_b16 a[220:221], v143 offset:12800
  ds_read_b64_tr_b16 a[222:223], v143 offset:15872
  s_waitcnt lgkmcnt(0)
  s_waitcnt vmcnt(24)
  s_barrier
  s_lshl_b32 s29, s21, 10
  s_add_u32 m0, s29, 24576
  s_mov_b32 s28, 4718592
  buffer_load_dwordx4 v136, s[16:19], s28 offen lds
  s_lshl_b32 s29, s21, 10
  s_add_u32 m0, s29, 28672
  s_mov_b32 s28, 4718592
  buffer_load_dwordx4 v137, s[16:19], s28 offen lds
  s_lshl_b32 s29, s21, 10
  s_add_u32 m0, s29, 32768
  s_mov_b32 s28, 4718592
  buffer_load_dwordx4 v138, s[16:19], s28 offen lds
  s_lshl_b32 s29, s21, 10
  s_add_u32 m0, s29, 36864
  s_mov_b32 s28, 4718592
  buffer_load_dwordx4 v139, s[16:19], s28 offen lds
  s_lshl_b32 s29, s21, 10
  s_add_u32 m0, s29, 40960
  s_mov_b32 s28, 4718592
  buffer_load_dwordx4 v140, s[16:19], s28 offen lds
  s_lshl_b32 s29, s21, 10
  s_add_u32 m0, s29, 45056
  s_mov_b32 s28, 4718592
  buffer_load_dwordx4 v141, s[16:19], s28 offen lds
  v_add_u32 v143, 49152, v142
  ds_read_b64_tr_b16 a[64:65], v143 offset:0
  ds_read_b64_tr_b16 a[66:67], v143 offset:3072
  ds_read_b64_tr_b16 a[68:69], v143 offset:12288
  ds_read_b64_tr_b16 a[70:71], v143 offset:15360
  ds_read_b64_tr_b16 a[144:145], v143 offset:256
  ds_read_b64_tr_b16 a[146:147], v143 offset:3328
  ds_read_b64_tr_b16 a[148:149], v143 offset:12544
  ds_read_b64_tr_b16 a[150:151], v143 offset:15616
  ds_read_b64_tr_b16 a[224:225], v143 offset:512
  ds_read_b64_tr_b16 a[226:227], v143 offset:3584
  ds_read_b64_tr_b16 a[228:229], v143 offset:12800
  ds_read_b64_tr_b16 a[230:231], v143 offset:15872
  s_waitcnt lgkmcnt(0)
  s_waitcnt vmcnt(24)
  s_barrier
  s_lshl_b32 s29, s21, 10
  s_add_u32 m0, s29, 49152
  s_mov_b32 s28, 6291456
  buffer_load_dwordx4 v136, s[16:19], s28 offen lds
  s_lshl_b32 s29, s21, 10
  s_add_u32 m0, s29, 53248
  s_mov_b32 s28, 6291456
  buffer_load_dwordx4 v137, s[16:19], s28 offen lds
  s_lshl_b32 s29, s21, 10
  s_add_u32 m0, s29, 57344
  s_mov_b32 s28, 6291456
  buffer_load_dwordx4 v138, s[16:19], s28 offen lds
  s_lshl_b32 s29, s21, 10
  s_add_u32 m0, s29, 61440
  s_mov_b32 s28, 6291456
  buffer_load_dwordx4 v139, s[16:19], s28 offen lds
  s_lshl_b32 s29, s21, 10
  s_add_u32 m0, s29, 65536
  s_mov_b32 s28, 6291456
  buffer_load_dwordx4 v140, s[16:19], s28 offen lds
  s_lshl_b32 s29, s21, 10
  s_add_u32 m0, s29, 69632
  s_mov_b32 s28, 6291456
  buffer_load_dwordx4 v141, s[16:19], s28 offen lds
  v_add_u32 v143, 73728, v142
  ds_read_b64_tr_b16 a[72:73], v143 offset:0
  ds_read_b64_tr_b16 a[74:75], v143 offset:3072
  ds_read_b64_tr_b16 a[76:77], v143 offset:12288
  ds_read_b64_tr_b16 a[78:79], v143 offset:15360
  ds_read_b64_tr_b16 a[152:153], v143 offset:256
  ds_read_b64_tr_b16 a[154:155], v143 offset:3328
  ds_read_b64_tr_b16 a[156:157], v143 offset:12544
  ds_read_b64_tr_b16 a[158:159], v143 offset:15616
  ds_read_b64_tr_b16 a[232:233], v143 offset:512
  ds_read_b64_tr_b16 a[234:235], v143 offset:3584
  ds_read_b64_tr_b16 a[236:237], v143 offset:12800
  ds_read_b64_tr_b16 a[238:239], v143 offset:15872
  s_waitcnt lgkmcnt(0)
  s_waitcnt vmcnt(24)
  s_barrier
  s_lshl_b32 s29, s21, 10
  s_add_u32 m0, s29, 73728
  s_mov_b32 s28, 786432
  buffer_load_dwordx4 v136, s[16:19], s28 offen lds
  s_lshl_b32 s29, s21, 10
  s_add_u32 m0, s29, 77824
  s_mov_b32 s28, 786432
  buffer_load_dwordx4 v137, s[16:19], s28 offen lds
  s_lshl_b32 s29, s21, 10
  s_add_u32 m0, s29, 81920
  s_mov_b32 s28, 786432
  buffer_load_dwordx4 v138, s[16:19], s28 offen lds
  s_lshl_b32 s29, s21, 10
  s_add_u32 m0, s29, 86016
  s_mov_b32 s28, 786432
  buffer_load_dwordx4 v139, s[16:19], s28 offen lds
  s_lshl_b32 s29, s21, 10
  s_add_u32 m0, s29, 90112
  s_mov_b32 s28, 786432
  buffer_load_dwordx4 v140, s[16:19], s28 offen lds
  s_lshl_b32 s29, s21, 10
  s_add_u32 m0, s29, 94208
  s_mov_b32 s28, 786432
  buffer_load_dwordx4 v141, s[16:19], s28 offen lds
  v_add_u32 v143, 98304, v142
  ds_read_b64_tr_b16 a[240:241], v143 offset:0
  ds_read_b64_tr_b16 a[242:243], v143 offset:3072
  ds_read_b64_tr_b16 a[244:245], v143 offset:12288
  ds_read_b64_tr_b16 a[246:247], v143 offset:15360
  ds_read_b64_tr_b16 v[176:177], v143 offset:256
  ds_read_b64_tr_b16 v[178:179], v143 offset:3328
  ds_read_b64_tr_b16 v[180:181], v143 offset:12544
  ds_read_b64_tr_b16 v[182:183], v143 offset:15616
  ds_read_b64_tr_b16 v[216:217], v143 offset:512
  ds_read_b64_tr_b16 v[218:219], v143 offset:3584
  ds_read_b64_tr_b16 v[220:221], v143 offset:12800
  ds_read_b64_tr_b16 v[222:223], v143 offset:15872
  s_waitcnt lgkmcnt(0)
  s_waitcnt vmcnt(24)
  s_barrier
  s_lshl_b32 s29, s21, 10
  s_add_u32 m0, s29, 98304
  s_mov_b32 s28, 2359296
  buffer_load_dwordx4 v136, s[16:19], s28 offen lds
  s_lshl_b32 s29, s21, 10
  s_add_u32 m0, s29, 102400
  s_mov_b32 s28, 2359296
  buffer_load_dwordx4 v137, s[16:19], s28 offen lds
  s_lshl_b32 s29, s21, 10
  s_add_u32 m0, s29, 106496
  s_mov_b32 s28, 2359296
  buffer_load_dwordx4 v138, s[16:19], s28 offen lds
  s_lshl_b32 s29, s21, 10
  s_add_u32 m0, s29, 110592
  s_mov_b32 s28, 2359296
  buffer_load_dwordx4 v139, s[16:19], s28 offen lds
  s_lshl_b32 s29, s21, 10
  s_add_u32 m0, s29, 114688
  s_mov_b32 s28, 2359296
  buffer_load_dwordx4 v140, s[16:19], s28 offen lds
  s_lshl_b32 s29, s21, 10
  s_add_u32 m0, s29, 118784
  s_mov_b32 s28, 2359296
  buffer_load_dwordx4 v141, s[16:19], s28 offen lds
  v_add_u32 v143, 122880, v142
  ds_read_b64_tr_b16 a[248:249], v143 offset:0
  ds_read_b64_tr_b16 a[250:251], v143 offset:3072
  ds_read_b64_tr_b16 a[252:253], v143 offset:12288
  ds_read_b64_tr_b16 a[254:255], v143 offset:15360
  ds_read_b64_tr_b16 v[184:185], v143 offset:256
  ds_read_b64_tr_b16 v[186:187], v143 offset:3328
  ds_read_b64_tr_b16 v[188:189], v143 offset:12544
  ds_read_b64_tr_b16 v[190:191], v143 offset:15616
  ds_read_b64_tr_b16 v[224:225], v143 offset:512
  ds_read_b64_tr_b16 v[226:227], v143 offset:3584
  ds_read_b64_tr_b16 v[228:229], v143 offset:12800
  ds_read_b64_tr_b16 v[230:231], v143 offset:15872
  s_waitcnt lgkmcnt(0)
  s_waitcnt vmcnt(24)
  s_barrier
  s_lshl_b32 s29, s21, 10
  s_add_u32 m0, s29, 122880
  s_mov_b32 s28, 3932160
  buffer_load_dwordx4 v136, s[16:19], s28 offen lds
  s_lshl_b32 s29, s21, 10
  s_add_u32 m0, s29, 126976
  s_mov_b32 s28, 3932160
  buffer_load_dwordx4 v137, s[16:19], s28 offen lds
  s_lshl_b32 s29, s21, 10
  s_add_u32 m0, s29, 131072
  s_mov_b32 s28, 3932160
  buffer_load_dwordx4 v138, s[16:19], s28 offen lds
  s_lshl_b32 s29, s21, 10
  s_add_u32 m0, s29, 135168
  s_mov_b32 s28, 3932160
  buffer_load_dwordx4 v139, s[16:19], s28 offen lds
  s_lshl_b32 s29, s21, 10
  s_add_u32 m0, s29, 139264
  s_mov_b32 s28, 3932160
  buffer_load_dwordx4 v140, s[16:19], s28 offen lds
  s_lshl_b32 s29, s21, 10
  s_add_u32 m0, s29, 143360
  s_mov_b32 s28, 3932160
  buffer_load_dwordx4 v141, s[16:19], s28 offen lds
  v_add_u32 v143, 0, v142
  ds_read_b64_tr_b16 v[152:153], v143 offset:0
  ds_read_b64_tr_b16 v[154:155], v143 offset:3072
  ds_read_b64_tr_b16 v[156:157], v143 offset:12288
  ds_read_b64_tr_b16 v[158:159], v143 offset:15360
  ds_read_b64_tr_b16 v[192:193], v143 offset:256
  ds_read_b64_tr_b16 v[194:195], v143 offset:3328
  ds_read_b64_tr_b16 v[196:197], v143 offset:12544
  ds_read_b64_tr_b16 v[198:199], v143 offset:15616
  ds_read_b64_tr_b16 v[232:233], v143 offset:512
  ds_read_b64_tr_b16 v[234:235], v143 offset:3584
  ds_read_b64_tr_b16 v[236:237], v143 offset:12800
  ds_read_b64_tr_b16 v[238:239], v143 offset:15872
  s_waitcnt lgkmcnt(0)
  s_waitcnt vmcnt(24)
  s_barrier
  s_lshl_b32 s29, s21, 10
  s_add_u32 m0, s29, 0
  s_mov_b32 s28, 5505024
  buffer_load_dwordx4 v136, s[16:19], s28 offen lds
  s_lshl_b32 s29, s21, 10
  s_add_u32 m0, s29, 4096
  s_mov_b32 s28, 5505024
  buffer_load_dwordx4 v137, s[16:19], s28 offen lds
  s_lshl_b32 s29, s21, 10
  s_add_u32 m0, s29, 8192
  s_mov_b32 s28, 5505024
  buffer_load_dwordx4 v138, s[16:19], s28 offen lds
  s_lshl_b32 s29, s21, 10
  s_add_u32 m0, s29, 12288
  s_mov_b32 s28, 5505024
  buffer_load_dwordx4 v139, s[16:19], s28 offen lds
  s_lshl_b32 s29, s21, 10
  s_add_u32 m0, s29, 16384
  s_mov_b32 s28, 5505024
  buffer_load_dwordx4 v140, s[16:19], s28 offen lds
  s_lshl_b32 s29, s21, 10
  s_add_u32 m0, s29, 20480
  s_mov_b32 s28, 5505024
  buffer_load_dwordx4 v141, s[16:19], s28 offen lds
  v_add_u32 v143, 24576, v142
  ds_read_b64_tr_b16 v[160:161], v143 offset:0
  ds_read_b64_tr_b16 v[162:163], v143 offset:3072
  ds_read_b64_tr_b16 v[164:165], v143 offset:12288
  ds_read_b64_tr_b16 v[166:167], v143 offset:15360
  ds_read_b64_tr_b16 v[200:201], v143 offset:256
  ds_read_b64_tr_b16 v[202:203], v143 offset:3328
  ds_read_b64_tr_b16 v[204:205], v143 offset:12544
  ds_read_b64_tr_b16 v[206:207], v143 offset:15616
  ds_read_b64_tr_b16 v[240:241], v143 offset:512
  ds_read_b64_tr_b16 v[242:243], v143 offset:3584
  ds_read_b64_tr_b16 v[244:245], v143 offset:12800
  ds_read_b64_tr_b16 v[246:247], v143 offset:15872
  s_waitcnt lgkmcnt(0)
  s_waitcnt vmcnt(24)
  s_barrier
  s_lshl_b32 s29, s21, 10
  s_add_u32 m0, s29, 24576
  s_mov_b32 s28, 7077888
  buffer_load_dwordx4 v136, s[16:19], s28 offen lds
  s_lshl_b32 s29, s21, 10
  s_add_u32 m0, s29, 28672
  s_mov_b32 s28, 7077888
  buffer_load_dwordx4 v137, s[16:19], s28 offen lds
  s_lshl_b32 s29, s21, 10
  s_add_u32 m0, s29, 32768
  s_mov_b32 s28, 7077888
  buffer_load_dwordx4 v138, s[16:19], s28 offen lds
  s_lshl_b32 s29, s21, 10
  s_add_u32 m0, s29, 36864
  s_mov_b32 s28, 7077888
  buffer_load_dwordx4 v139, s[16:19], s28 offen lds
  s_lshl_b32 s29, s21, 10
  s_add_u32 m0, s29, 40960
  s_mov_b32 s28, 7077888
  buffer_load_dwordx4 v140, s[16:19], s28 offen lds
  s_lshl_b32 s29, s21, 10
  s_add_u32 m0, s29, 45056
  s_mov_b32 s28, 7077888
  buffer_load_dwordx4 v141, s[16:19], s28 offen lds
  v_add_u32 v143, 49152, v142
  ds_read_b64_tr_b16 v[168:169], v143 offset:0
  ds_read_b64_tr_b16 v[170:171], v143 offset:3072
  ds_read_b64_tr_b16 v[172:173], v143 offset:12288
  ds_read_b64_tr_b16 v[174:175], v143 offset:15360
  ds_read_b64_tr_b16 v[208:209], v143 offset:256
  ds_read_b64_tr_b16 v[210:211], v143 offset:3328
  ds_read_b64_tr_b16 v[212:213], v143 offset:12544
  ds_read_b64_tr_b16 v[214:215], v143 offset:15616
  ds_read_b64_tr_b16 v[248:249], v143 offset:512
  ds_read_b64_tr_b16 v[250:251], v143 offset:3584
  ds_read_b64_tr_b16 v[252:253], v143 offset:12800
  ds_read_b64_tr_b16 v[254:255], v143 offset:15872
  s_waitcnt lgkmcnt(0)
  s_waitcnt vmcnt(24)
  s_barrier
  v_add_u32 v143, 73728, v142
  ds_read_b64_tr_b16 v[16:17], v143 offset:0
  ds_read_b64_tr_b16 v[18:19], v143 offset:3072
  ds_read_b64_tr_b16 v[20:21], v143 offset:12288
  ds_read_b64_tr_b16 v[22:23], v143 offset:15360
  ds_read_b64_tr_b16 v[24:25], v143 offset:256
  ds_read_b64_tr_b16 v[26:27], v143 offset:3328
  ds_read_b64_tr_b16 v[28:29], v143 offset:12544
  ds_read_b64_tr_b16 v[30:31], v143 offset:15616
  ds_read_b64_tr_b16 v[32:33], v143 offset:512
  ds_read_b64_tr_b16 v[34:35], v143 offset:3584
  ds_read_b64_tr_b16 v[36:37], v143 offset:12800
  ds_read_b64_tr_b16 v[38:39], v143 offset:15872
  s_waitcnt lgkmcnt(0)
  s_waitcnt vmcnt(18)
  s_barrier
  v_add_u32 v143, 98304, v142
  ds_read_b64_tr_b16 v[40:41], v143 offset:0
  ds_read_b64_tr_b16 v[42:43], v143 offset:3072
  ds_read_b64_tr_b16 v[44:45], v143 offset:12288
  ds_read_b64_tr_b16 v[46:47], v143 offset:15360
  ds_read_b64_tr_b16 v[48:49], v143 offset:256
  ds_read_b64_tr_b16 v[50:51], v143 offset:3328
  ds_read_b64_tr_b16 v[52:53], v143 offset:12544
  ds_read_b64_tr_b16 v[54:55], v143 offset:15616
  ds_read_b64_tr_b16 v[56:57], v143 offset:512
  ds_read_b64_tr_b16 v[58:59], v143 offset:3584
  ds_read_b64_tr_b16 v[60:61], v143 offset:12800
  ds_read_b64_tr_b16 v[62:63], v143 offset:15872
  s_waitcnt lgkmcnt(0)
  s_waitcnt vmcnt(12)
  s_barrier
  v_add_u32 v143, 122880, v142
  ds_read_b64_tr_b16 v[64:65], v143 offset:0
  ds_read_b64_tr_b16 v[66:67], v143 offset:3072
  ds_read_b64_tr_b16 v[68:69], v143 offset:12288
  ds_read_b64_tr_b16 v[70:71], v143 offset:15360
  ds_read_b64_tr_b16 v[72:73], v143 offset:256
  ds_read_b64_tr_b16 v[74:75], v143 offset:3328
  ds_read_b64_tr_b16 v[76:77], v143 offset:12544
  ds_read_b64_tr_b16 v[78:79], v143 offset:15616
  ds_read_b64_tr_b16 v[80:81], v143 offset:512
  ds_read_b64_tr_b16 v[82:83], v143 offset:3584
  ds_read_b64_tr_b16 v[84:85], v143 offset:12800
  ds_read_b64_tr_b16 v[86:87], v143 offset:15872
  s_waitcnt lgkmcnt(0)
  s_waitcnt vmcnt(6)
  s_barrier
  v_add_u32 v143, 0, v142
  ds_read_b64_tr_b16 v[88:89], v143 offset:0
  ds_read_b64_tr_b16 v[90:91], v143 offset:3072
  ds_read_b64_tr_b16 v[92:93], v143 offset:12288
  ds_read_b64_tr_b16 v[94:95], v143 offset:15360
  ds_read_b64_tr_b16 v[96:97], v143 offset:256
  ds_read_b64_tr_b16 v[98:99], v143 offset:3328
  ds_read_b64_tr_b16 v[100:101], v143 offset:12544
  ds_read_b64_tr_b16 v[102:103], v143 offset:15616
  ds_read_b64_tr_b16 v[104:105], v143 offset:512
  ds_read_b64_tr_b16 v[106:107], v143 offset:3584
  ds_read_b64_tr_b16 v[108:109], v143 offset:12800
  ds_read_b64_tr_b16 v[110:111], v143 offset:15872
  s_waitcnt lgkmcnt(0)
  s_waitcnt vmcnt(0)
  s_barrier
  v_add_u32 v143, 24576, v142
  ds_read_b64_tr_b16 v[112:113], v143 offset:0
  ds_read_b64_tr_b16 v[114:115], v143 offset:3072
  ds_read_b64_tr_b16 v[116:117], v143 offset:12288
  ds_read_b64_tr_b16 v[118:119], v143 offset:15360
  ds_read_b64_tr_b16 v[120:121], v143 offset:256
  ds_read_b64_tr_b16 v[122:123], v143 offset:3328
  ds_read_b64_tr_b16 v[124:125], v143 offset:12544
  ds_read_b64_tr_b16 v[126:127], v143 offset:15616
  ds_read_b64_tr_b16 v[128:129], v143 offset:512
  ds_read_b64_tr_b16 v[130:131], v143 offset:3584
  ds_read_b64_tr_b16 v[132:133], v143 offset:12800
  ds_read_b64_tr_b16 v[134:135], v143 offset:15872
  s_waitcnt lgkmcnt(0)
  s_barrier
  v_lshlrev_b32 v2, 4, v1
  s_mul_i32 s28, s21, 30720
  v_add_u32 v143, s28, v2
  ds_write_b128 v143, v[16:19] offset:0
  ds_write_b128 v143, v[20:23] offset:1024
  ds_write_b128 v143, v[24:27] offset:10240
  ds_write_b128 v143, v[28:31] offset:11264
  ds_write_b128 v143, v[32:35] offset:20480
  ds_write_b128 v143, v[36:39] offset:21504
  ds_write_b128 v143, v[40:43] offset:2048
  ds_write_b128 v143, v[44:47] offset:3072
  ds_write_b128 v143, v[48:51] offset:12288
  ds_write_b128 v143, v[52:55] offset:13312
  ds_write_b128 v143, v[56:59] offset:22528
  ds_write_b128 v143, v[60:63] offset:23552
  ds_write_b128 v143, v[64:67] offset:4096
  ds_write_b128 v143, v[68:71] offset:5120
  ds_write_b128 v143, v[72:75] offset:14336
  ds_write_b128 v143, v[76:79] offset:15360
  ds_write_b128 v143, v[80:83] offset:24576
  ds_write_b128 v143, v[84:87] offset:25600
  ds_write_b128 v143, v[88:91] offset:6144
  ds_write_b128 v143, v[92:95] offset:7168
  ds_write_b128 v143, v[96:99] offset:16384
  ds_write_b128 v143, v[100:103] offset:17408
  ds_write_b128 v143, v[104:107] offset:26624
  ds_write_b128 v143, v[108:111] offset:27648
  ds_write_b128 v143, v[112:115] offset:8192
  ds_write_b128 v143, v[116:119] offset:9216
  ds_write_b128 v143, v[120:123] offset:18432
  ds_write_b128 v143, v[124:127] offset:19456
  ds_write_b128 v143, v[128:131] offset:28672
  ds_write_b128 v143, v[132:135] offset:29696
  s_waitcnt lgkmcnt(0)
  v_and_b32 v1, 63, v0
  v_lshlrev_b32 v132, 4, v1
  s_mul_i32 s28, s21, 30720
  v_add_u32 v129, s28, v132
  s_lshl_b32 s28, s21, 10
  v_add_u32 v124, s28, v132
  v_add_u32 v125, 4096, v124
  v_add_u32 v126, 8192, v124
  v_add_u32 v127, 122880, v124
  v_add_u32 v128, 122880, v132
  v_lshrrev_b32 v2, 3, v1
  s_cmp_lt_u32 s21, 2
  s_cselect_b32 s28, 2, 1
  v_min_u32 v2, s28, v2
  v_lshlrev_b32 v2, 12, v2
  v_and_b32 v3, 7, v1
  v_lshlrev_b32 v3, 7, v3
  v_add_u32 v2, v2, v3
  s_lshl_b32 s28, s21, 10
  v_add_u32 v141, s28, v2
  v_and_b32 v2, 15, v1
  v_lshrrev_b32 v3, 4, v1
  v_add_u32 v3, v3, v2
  v_and_b32 v3, 3, v3
  v_lshlrev_b32 v3, 4, v3
  v_lshlrev_b32 v2, 6, v2
  v_add_u32 v2, v2, v3
  s_mul_i32 s28, s21, 3072
  s_add_u32 s28, s28, 133120
  v_add_u32 v130, s28, v2
  s_mul_i32 s28, s21, 1536
  s_add_u32 s28, s28, 145408
  v_lshlrev_b32 v2, 3, v1
  v_add_u32 v131, s28, v2
  v_mov_b32 v110, 0x44444444
  v_mov_b32 v2, 0xeeeeeeee
  v_and_b32 v3, 8, v1
  v_cmp_ne_u32 vcc, 0, v3
  s_nop 1
  v_cndmask_b32 v110, v110, v2, vcc
  v_and_b32 v4, 15, v1
  v_lshrrev_b32 v5, 4, v1
  v_lshlrev_b32 v6, 2, v5
  v_sub_u32 v6, v4, v6
  v_mov_b32 v7, 0x3f80
  v_mov_b32 v8, 0x3f800000
  v_mov_b32 v108, 0
  v_mov_b32 v109, 0
  v_cmp_eq_u32 vcc, 0, v6
  s_nop 1
  v_cndmask_b32 v108, v108, v7, vcc
  v_cmp_eq_u32 vcc, 1, v6
  s_nop 1
  v_cndmask_b32 v108, v108, v8, vcc
  v_cmp_eq_u32 vcc, 2, v6
  s_nop 1
  v_cndmask_b32 v109, v109, v7, vcc
  v_cmp_eq_u32 vcc, 3, v6
  s_nop 1
  v_cndmask_b32 v109, v109, v8, vcc
  s_mul_i32 s28, s23, 6
  s_lshr_b32 s29, s28, 3
  s_add_u32 s28, s28, 5
  s_lshr_b32 s28, s28, 3
  v_mov_b32 v6, s29
  v_mov_b32 v7, s28
  v_and_b32 v8, 1, v1
  v_cmp_eq_u32 vcc, 1, v8
  s_nop 1
  v_cndmask_b32 v6, v6, v7, vcc
  v_lshlrev_b32 v6, 2, v6
  v_bfe_u32 v8, v1, 1, 1
  v_lshlrev_b32 v8, 10, v8
  v_add_u32 v6, v6, v8
  v_add_u32 v138, 0, v6
  s_mul_i32 s97, s20, 655360
  s_add_u32 s97, s97, 0x400000
  s_mov_b32 s48, 0x4000
  s_mul_i32 s49, s20, 327680
  s_add_u32 s49, s49, 0x700000
  s_add_u32 s98, s49, 5120
  s_mul_i32 s50, s23, 786432
  s_add_u32 s63, s50, 0x4800000
  s_add_u32 s50, s50, 0x6000000
  s_mov_b32 s51, 0
  s_mov_b32 s52, 0
  s_mul_i32 s28, s21, 3
  s_add_u32 s28, s28, 0
  s_lshr_b32 s29, s28, 1
  s_lshl_b32 s29, s29, 11
  s_and_b32 s28, s28, 1
  s_lshl_b32 s28, s28, 3
  s_add_u32 s53, s29, s28
  s_mul_i32 s28, s21, 3
  s_add_u32 s28, s28, 1
  s_lshr_b32 s29, s28, 1
  s_lshl_b32 s29, s29, 11
  s_and_b32 s28, s28, 1
  s_lshl_b32 s28, s28, 3
  s_add_u32 s54, s29, s28
  s_mul_i32 s28, s21, 3
  s_add_u32 s28, s28, 2
  s_lshr_b32 s29, s28, 1
  s_lshl_b32 s29, s29, 11
  s_and_b32 s28, s28, 1
  s_lshl_b32 s28, s28, 3
  s_add_u32 s55, s29, s28
  v_mov_b32 v60, 0
  v_mov_b32 v61, 0
  v_mov_b32 v62, 0
  v_mov_b32 v63, 0
  v_mov_b32 v64, 0
  v_mov_b32 v65, 0
  v_mov_b32 v66, 0
  v_mov_b32 v67, 0
  v_mov_b32 v68, 0
  v_mov_b32 v69, 0
  v_mov_b32 v70, 0
  v_mov_b32 v71, 0
  v_mov_b32 v72, 0
  v_mov_b32 v73, 0
  v_mov_b32 v74, 0
  v_mov_b32 v75, 0
  v_mov_b32 v36, 0
  v_mov_b32 v37, 0
  v_mov_b32 v38, 0
  v_mov_b32 v39, 0
  v_mov_b32 v40, 0
  v_mov_b32 v41, 0
  v_mov_b32 v42, 0
  v_mov_b32 v43, 0
  s_barrier
  s_cmp_gt_u32 s52, s51
  s_cbranch_scc1 ka\sfx\()_x_wp_79_ok
  s_mov_b32 s45, 0
ka\sfx\()_x_wp_79_spin:
  buffer_load_dword v2, v138, s[8:11], 0 offen sc1
  s_add_u32 s45, s45, 1
  s_waitcnt vmcnt(0)
  v_min_u32_dpp v3, v2, v2 quad_perm:[1,0,3,2] row_mask:0xf bank_mask:0xf
  s_nop 1
  v_min_u32_dpp v2, v3, v3 quad_perm:[2,3,0,1] row_mask:0xf bank_mask:0xf
  s_nop 1
  v_min_u32_dpp v3, v2, v2 row_half_mirror row_mask:0xf bank_mask:0xf
  s_nop 1
  v_min_u32_dpp v2, v3, v3 quad_perm:[0,1,2,3] row_mask:0xf bank_mask:0xf
  s_nop 0
  v_readfirstlane_b32 s52, v2
  s_cmp_gt_u32 s52, s51
  s_cbranch_scc1 ka\sfx\()_x_wp_79_ok
  s_cmp_lt_u32 s45, 400000
  s_cbranch_scc1 ka\sfx\()_x_wp_79_spin
  s_branch ka\sfx\()_abort
ka\sfx\()_x_wp_79_ok:
  s_add_u32 s28, s50, s53
  buffer_load_dwordx2 v[88:89], v132, s[8:11], s28 offen offset:0 sc1
  buffer_load_dwordx2 v[92:93], v132, s[8:11], s28 offen offset:1024 sc1
  s_add_u32 s28, s50, s54
  buffer_load_dwordx2 v[90:91], v132, s[8:11], s28 offen offset:0 sc1
  buffer_load_dwordx2 v[94:95], v132, s[8:11], s28 offen offset:1024 sc1
  s_add_u32 s28, s50, s55
  buffer_load_dwordx2 v[96:97], v132, s[8:11], s28 offen offset:0 sc1
  buffer_load_dwordx2 v[98:99], v132, s[8:11], s28 offen offset:1024 sc1
  s_cmp_eq_u32 s21, 0
  s_cbranch_scc1 ka\sfx\()_x_w0
  s_cmp_eq_u32 s21, 1
  s_cbranch_scc1 ka\sfx\()_x_w1
  s_branch ka\sfx\()_x_w23
ka\sfx\()_x_w0:
  v_lshrrev_b32 v4, 3, v1
  v_and_b32 v5, 7, v1
  v_lshrrev_b32 v6, 2, v5
  v_and_b32 v7, 3, v5
  v_lshlrev_b32 v8, 10, v6
  v_lshlrev_b32 v9, 6, v4
  v_add_u32 v8, v8, v9
  v_add_u32 v9, v7, v4
  v_and_b32 v9, 3, v9
  v_lshlrev_b32 v9, 4, v9
  v_add_u32 v8, v8, v9
  v_add_u32 v133, 134144, v8
  v_add_u32 v8, 2, v6
  v_add_u32 v8, v8, v4
  v_and_b32 v8, 3, v8
  v_lshlrev_b32 v8, 4, v8
  v_lshlrev_b32 v9, 6, v4
  v_add_u32 v8, v8, v9
  v_lshlrev_b32 v9, 2, v7
  v_add_u32 v8, v8, v9
  v_add_u32 v134, 133120, v8
  s_and_b32 s26, s23, 7
  v_and_b32 v8, 1, v7
  v_lshlrev_b32 v8, 1, v8
  v_add_u32 v8, v8, v6
  v_lshlrev_b32 v8, 4, v8
  v_add_u32 v8, v8, v4
  v_lshlrev_b32 v8, 4, v8
  v_lshrrev_b32 v9, 1, v7
  v_lshlrev_b32 v9, 3, v9
  v_add_u32 v8, v8, v9
  s_lshr_b32 s28, s26, 1
  s_lshl_b32 s28, s28, 10
  s_and_b32 s29, s26, 1
  s_lshl_b32 s29, s29, 7
  s_add_u32 s28, s28, s29
  v_add_u32 v135, s28, v8
  v_lshlrev_b32 v8, 4, v6
  v_add_u32 v8, v8, v4
  v_lshlrev_b32 v8, 4, v8
  v_lshlrev_b32 v9, 1, v7
  v_add_u32 v8, v8, v9
  s_lshr_b32 s28, s26, 2
  s_lshl_b32 s28, s28, 7
  s_and_b32 s29, s26, 1
  s_lshl_b32 s29, s29, 9
  s_add_u32 s28, s28, s29
  s_bfe_u32 s29, s26, 0x10001
  s_lshl_b32 s29, s29, 3
  s_add_u32 s28, s28, s29
  s_add_u32 s28, s28, 4096
  v_add_u32 v8, s28, v8
  v_mov_b32 v9, 0x40000000
  v_and_b32 v10, 1, v5
  v_cmp_eq_u32 vcc, 0, v10
  s_nop 1
  v_cndmask_b32 v136, v9, v8, vcc
  s_mov_b32 s64, 0x3dd53b95
  s_mov_b32 s65, 0x3dd53b95
  v_mov_b32 v137, 0x42800000
ka\sfx\()_x_w0l:
  ds_read_b128 v[44:47], v129 offset:0
  ds_read_b128 v[48:51], v129 offset:1024
  ds_read_b128 v[52:55], v129 offset:2048
  ds_read_b128 v[56:59], v129 offset:3072
  s_waitcnt lgkmcnt(0)
  s_mov_b32 s45, 0
ka\sfx\()_x_pf_80_pr:
  buffer_load_dword v139, v141, s[8:11], s48 offen sc1
  s_add_u32 s45, s45, 1
  s_waitcnt vmcnt(0)
  v_cmp_eq_u32 vcc, -1, v139
  s_cbranch_vccz ka\sfx\()_x_pf_80
  s_cmp_lt_u32 s45, 400000
  s_cbranch_scc1 ka\sfx\()_x_pf_80_pr
  s_branch ka\sfx\()_abort
ka\sfx\()_x_pf_80:
  buffer_load_dwordx4 v[112:115], v124, s[8:11], s48 offen sc1
  buffer_load_dwordx4 v[116:119], v125, s[8:11], s48 offen sc1
  buffer_load_dwordx4 v[120:123], v126, s[8:11], s48 offen sc1
  s_add_u32 s45, s45, 1
  s_waitcnt vmcnt(2)
  ds_write_b128 v127, v[112:115] offset:0
  v_max3_u32 v139, v112, v113, v114
  v_max_u32 v139, v139, v115
  s_waitcnt vmcnt(1)
  ds_write_b128 v127, v[116:119] offset:4096
  v_max3_u32 v139, v139, v116, v117
  v_max3_u32 v139, v139, v118, v119
  s_waitcnt vmcnt(0)
  ds_write_b128 v127, v[120:123] offset:8192
  v_max3_u32 v139, v139, v120, v121
  v_max3_u32 v139, v139, v122, v123
  v_cmp_eq_u32 vcc, -1, v139
  s_cbranch_vccz ka\sfx\()_x_pf_80_ok
  s_cmp_lt_u32 s45, 400000
  s_cbranch_scc1 ka\sfx\()_x_pf_80
  s_branch ka\sfx\()_abort
ka\sfx\()_x_pf_80_ok:
  v_smfmac_f32_16x16x64_bf16 v[60:63], v[112:115], a[0:7], v110
  v_smfmac_f32_16x16x64_bf16 v[64:67], v[112:115], a[240:247], v110
  v_smfmac_f32_16x16x64_bf16 v[68:71], v[112:115], a[80:87], v110
  v_smfmac_f32_16x16x64_bf16 v[72:75], v[112:115], v[176:183], v110
  s_waitcnt lgkmcnt(0)
  s_barrier
  v_smfmac_f32_16x16x64_bf16 v[36:39], v[112:115], a[160:167], v110
  ds_read_b128 v[4:7], v128 offset:1024
  v_smfmac_f32_16x16x64_bf16 v[40:43], v[112:115], v[216:223], v110
  ds_read_b128 v[8:11], v128 offset:2048
  v_smfmac_f32_16x16x64_bf16 v[60:63], v[116:119], a[32:39], v110
  ds_read_b128 v[12:15], v128 offset:3072
  v_smfmac_f32_16x16x64_bf16 v[64:67], v[116:119], v[152:159], v110
  ds_read_b128 v[16:19], v128 offset:5120
  v_smfmac_f32_16x16x64_bf16 v[68:71], v[116:119], a[112:119], v110
  ds_read_b128 v[20:23], v128 offset:6144
  v_smfmac_f32_16x16x64_bf16 v[72:75], v[116:119], v[192:199], v110
  ds_read_b128 v[24:27], v128 offset:7168
  v_smfmac_f32_16x16x64_bf16 v[36:39], v[116:119], a[192:199], v110
  ds_read_b128 v[28:31], v128 offset:9216
  v_smfmac_f32_16x16x64_bf16 v[40:43], v[116:119], v[232:239], v110
  v_smfmac_f32_16x16x64_bf16 v[60:63], v[120:123], a[64:71], v110
  v_smfmac_f32_16x16x64_bf16 v[64:67], v[120:123], v[168:175], v110
  v_smfmac_f32_16x16x64_bf16 v[68:71], v[120:123], a[144:151], v110
  v_smfmac_f32_16x16x64_bf16 v[72:75], v[120:123], v[208:215], v110
  v_smfmac_f32_16x16x64_bf16 v[36:39], v[120:123], a[224:231], v110
  v_smfmac_f32_16x16x64_bf16 v[40:43], v[120:123], v[248:255], v110
  s_waitcnt lgkmcnt(6)
  v_smfmac_f32_16x16x64_bf16 v[60:63], v[4:7], a[8:15], v110
  v_smfmac_f32_16x16x64_bf16 v[64:67], v[4:7], v[44:51], v110
  ds_read_b128 v[44:47], v129 offset:4096
  s_waitcnt lgkmcnt(6)
  v_smfmac_f32_16x16x64_bf16 v[60:63], v[8:11], a[16:23], v110
  ds_read_b128 v[48:51], v129 offset:5120
  v_smfmac_f32_16x16x64_bf16 v[64:67], v[8:11], a[248:255], v110
  s_waitcnt lgkmcnt(6)
  v_smfmac_f32_16x16x64_bf16 v[60:63], v[12:15], a[24:31], v110
  v_smfmac_f32_16x16x64_bf16 v[64:67], v[12:15], v[52:59], v110
  ds_read_b128 v[52:55], v129 offset:6144
  s_waitcnt lgkmcnt(6)
  v_smfmac_f32_16x16x64_bf16 v[60:63], v[16:19], a[40:47], v110
  ds_read_b128 v[56:59], v129 offset:7168
  s_waitcnt lgkmcnt(2)
  v_smfmac_f32_16x16x64_bf16 v[64:67], v[16:19], v[44:51], v110
  ds_read_b128 v[44:47], v129 offset:8192
  v_smfmac_f32_16x16x64_bf16 v[60:63], v[20:23], a[48:55], v110
  ds_read_b128 v[48:51], v129 offset:9216
  v_smfmac_f32_16x16x64_bf16 v[64:67], v[20:23], v[160:167], v110
  v_smfmac_f32_16x16x64_bf16 v[60:63], v[24:27], a[56:63], v110
  s_waitcnt lgkmcnt(2)
  v_smfmac_f32_16x16x64_bf16 v[64:67], v[24:27], v[52:59], v110
  ds_read_b128 v[52:55], v129 offset:10240
  v_smfmac_f32_16x16x64_bf16 v[60:63], v[28:31], a[72:79], v110
  ds_read_b128 v[56:59], v129 offset:11264
  s_waitcnt lgkmcnt(2)
  v_smfmac_f32_16x16x64_bf16 v[64:67], v[28:31], v[44:51], v110
  ds_read_b128 v[44:47], v129 offset:12288
  v_smfmac_f32_16x16x64_bf16 v[68:71], v[4:7], a[88:95], v110
  ds_read_b128 v[48:51], v129 offset:13312
  s_waitcnt lgkmcnt(2)
  v_smfmac_f32_16x16x64_bf16 v[72:75], v[4:7], v[52:59], v110
  ds_read_b128 v[52:55], v129 offset:14336
  v_permlane32_swap_b32 v60, v64
  v_smfmac_f32_16x16x64_bf16 v[68:71], v[8:11], a[96:103], v110
  ds_read_b128 v[56:59], v129 offset:15360
  v_smfmac_f32_16x16x64_bf16 v[72:75], v[8:11], v[184:191], v110
  v_permlane32_swap_b32 v61, v65
  v_smfmac_f32_16x16x64_bf16 v[68:71], v[12:15], a[104:111], v110
  s_waitcnt lgkmcnt(2)
  v_smfmac_f32_16x16x64_bf16 v[72:75], v[12:15], v[44:51], v110
  ds_read_b128 v[44:47], v129 offset:16384
  v_permlane32_swap_b32 v62, v66
  v_smfmac_f32_16x16x64_bf16 v[68:71], v[16:19], a[120:127], v110
  ds_read_b128 v[48:51], v129 offset:17408
  v_permlane32_swap_b32 v63, v67
  s_waitcnt lgkmcnt(2)
  v_smfmac_f32_16x16x64_bf16 v[72:75], v[16:19], v[52:59], v110
  ds_read_b128 v[52:55], v129 offset:18432
  v_add_f32 v60, v60, v64
  v_smfmac_f32_16x16x64_bf16 v[68:71], v[20:23], a[128:135], v110
  ds_read_b128 v[56:59], v129 offset:19456
  v_add_f32 v61, v61, v65
  v_smfmac_f32_16x16x64_bf16 v[72:75], v[20:23], v[200:207], v110
  v_add_f32 v62, v62, v66
  v_smfmac_f32_16x16x64_bf16 v[68:71], v[24:27], a[136:143], v110
  v_add_f32 v63, v63, v67
  s_waitcnt lgkmcnt(2)
  v_smfmac_f32_16x16x64_bf16 v[72:75], v[24:27], v[44:51], v110
  ds_read_b128 v[44:47], v129 offset:20480
  v_cvt_pk_bf16_f32 v100, v60, v61
  v_smfmac_f32_16x16x64_bf16 v[68:71], v[28:31], a[152:159], v110
  ds_read_b128 v[48:51], v129 offset:21504
  v_cvt_pk_bf16_f32 v101, v62, v63
  s_waitcnt lgkmcnt(2)
  v_smfmac_f32_16x16x64_bf16 v[72:75], v[28:31], v[52:59], v110
  ds_read_b128 v[52:55], v129 offset:22528
  v_smfmac_f32_16x16x64_bf16 v[36:39], v[4:7], a[168:175], v110
  ds_read_b128 v[56:59], v129 offset:23552
  s_waitcnt lgkmcnt(2)
  v_smfmac_f32_16x16x64_bf16 v[40:43], v[4:7], v[44:51], v110
  ds_read_b128 v[44:47], v129 offset:24576
  v_permlane32_swap_b32 v68, v72
  v_smfmac_f32_16x16x64_bf16 v[36:39], v[8:11], a[176:183], v110
  ds_read_b128 v[48:51], v129 offset:25600
  v_smfmac_f32_16x16x64_bf16 v[40:43], v[8:11], v[224:231], v110
  v_permlane32_swap_b32 v69, v73
  v_smfmac_f32_16x16x64_bf16 v[36:39], v[12:15], a[184:191], v110
  s_waitcnt lgkmcnt(2)
  v_smfmac_f32_16x16x64_bf16 v[40:43], v[12:15], v[52:59], v110
  ds_read_b128 v[52:55], v129 offset:26624
  v_permlane32_swap_b32 v70, v74
  v_smfmac_f32_16x16x64_bf16 v[36:39], v[16:19], a[200:207], v110
  ds_read_b128 v[56:59], v129 offset:27648
  v_permlane32_swap_b32 v71, v75
  s_waitcnt lgkmcnt(2)
  v_smfmac_f32_16x16x64_bf16 v[40:43], v[16:19], v[44:51], v110
  ds_read_b128 v[44:47], v129 offset:28672
  v_add_f32 v68, v68, v72
  v_smfmac_f32_16x16x64_bf16 v[36:39], v[20:23], a[208:215], v110
  ds_read_b128 v[48:51], v129 offset:29696
  v_add_f32 v69, v69, v73
  v_smfmac_f32_16x16x64_bf16 v[40:43], v[20:23], v[240:247], v110
  v_add_f32 v70, v70, v74
  v_smfmac_f32_16x16x64_bf16 v[36:39], v[24:27], a[216:223], v110
  v_add_f32 v71, v71, v75
  s_waitcnt lgkmcnt(2)
  v_smfmac_f32_16x16x64_bf16 v[40:43], v[24:27], v[52:59], v110
  v_cvt_pk_bf16_f32 v102, v68, v69
  v_smfmac_f32_16x16x64_bf16 v[36:39], v[28:31], a[232:239], v110
  v_cvt_pk_bf16_f32 v103, v70, v71
  s_waitcnt lgkmcnt(0)
  v_smfmac_f32_16x16x64_bf16 v[40:43], v[28:31], v[44:51], v110
  v_mfma_f32_16x16x16_bf16 v[142:145], v[100:101], v[108:109], 0
  v_mfma_f32_16x16x16_bf16 v[146:149], v[102:103], v[108:109], 0
  s_nop 1
  v_permlane32_swap_b32 v36, v40
  v_permlane32_swap_b32 v37, v41
  v_permlane32_swap_b32 v38, v42
  v_permlane32_swap_b32 v39, v43
  v_add_f32 v36, v36, v40
  v_add_f32 v37, v37, v41
  v_add_f32 v38, v38, v42
  v_add_f32 v39, v39, v43
  v_cvt_pk_bf16_f32 v104, v36, v37
  v_cvt_pk_bf16_f32 v105, v38, v39
  v_cvt_pk_bf16_f32 v44, v142, v143
  v_cvt_pk_bf16_f32 v45, v144, v145
  v_mfma_f32_16x16x16_bf16 v[142:145], v[104:105], v[108:109], 0
  v_cvt_pk_bf16_f32 v46, v146, v147
  v_cvt_pk_bf16_f32 v47, v148, v149
  s_nop 1
  v_mfma_f32_16x16x32_bf16 v[76:79], v[44:47], v[44:47], 0
  v_mfma_f32_16x16x32_bf16 v[80:83], v[88:91], v[44:47], 0
  v_cvt_pk_bf16_f32 v106, v142, v143
  v_cvt_pk_bf16_f32 v107, v144, v145
  v_mfma_f32_16x16x32_bf16 v[84:87], v[92:95], v[44:47], 0
  s_nop 0
  v_mfma_f32_16x16x16_bf16 v[76:79], v[106:107], v[106:107], v[76:79]
  v_mfma_f32_16x16x16_bf16 v[80:83], v[96:97], v[106:107], v[80:83]
  v_mfma_f32_16x16x16_bf16 v[84:87], v[98:99], v[106:107], v[84:87]
  s_mov_b32 exec_lo, 0
  s_mov_b32 exec_hi, 0x00ff00ff
  s_nop 3
  ds_write_b128 v130, v[76:79]
  s_mov_b32 exec_lo, 0x00ff00ff
  ds_write_b128 v130, v[80:83] offset:1024
  s_nop 0
  ds_write_b128 v130, v[84:87] offset:2048
  s_mov_b64 exec, -1
  s_waitcnt lgkmcnt(0)
  s_barrier
  s_cmp_ge_u32 s51, 63
  s_cbranch_scc0 x63_81_\sfx\()
  ds_write_b64 v131, v[44:45]
  ds_write_b64 v131, v[46:47] offset:512
  ds_write_b64 v131, v[106:107] offset:1024
  s_branch ka\sfx\()_x_done
x63_81_\sfx\():
  ds_read_b128 v[4:7], v133 offset:0
  ds_read_b32 v20, v134 offset:0
  ds_read_b128 v[8:11], v133 offset:3072
  ds_read_b32 v21, v134 offset:3072
  ds_read_b128 v[12:15], v133 offset:6144
  ds_read_b32 v22, v134 offset:6144
  ds_read_b128 v[16:19], v133 offset:9216
  ds_read_b32 v23, v134 offset:9216
  s_waitcnt lgkmcnt(4)
  v_pk_add_f32 v[4:5], v[4:5], v[8:9]
  v_pk_add_f32 v[6:7], v[6:7], v[10:11]
  v_add_f32 v20, v20, v21
  s_waitcnt lgkmcnt(0)
  v_pk_add_f32 v[12:13], v[12:13], v[16:17]
  v_pk_add_f32 v[14:15], v[14:15], v[18:19]
  v_add_f32 v22, v22, v23
  v_pk_add_f32 v[4:5], v[4:5], v[12:13]
  v_pk_add_f32 v[6:7], v[6:7], v[14:15]
  v_add_f32 v8, v20, v22
  v_pk_mul_f32 v[4:5], v[4:5], s[64:65]
  v_pk_mul_f32 v[6:7], v[6:7], s[64:65]
  v_mul_f32 v8, s64, v8
  v_max3_f32 v24, abs(v4), abs(v5), abs(v6)
  v_max3_f32 v24, v24, abs(v7), abs(v8)
  v_cmp_nlt_f32 vcc, v24, v137
  s_cbranch_vccz smx_82_go_\sfx\()
  v_max3_f32 v24, v4, v5, v6
  v_max3_f32 v24, v24, v7, v8
  s_nop 1
  v_max_f32_dpp v25, v24, v24 quad_perm:[1,0,3,2] row_mask:0xf bank_mask:0xf
  s_nop 1
  v_max_f32_dpp v24, v25, v25 quad_perm:[2,3,0,1] row_mask:0xf bank_mask:0xf
  s_nop 1
  v_max_f32_dpp v25, v24, v24 row_half_mirror row_mask:0xf bank_mask:0xf
  v_sub_f32 v4, v4, v25
  v_sub_f32 v5, v5, v25
  v_sub_f32 v6, v6, v25
  v_sub_f32 v7, v7, v25
  v_sub_f32 v8, v8, v25
smx_82_go_\sfx\():
  v_exp_f32 v4, v4
  v_exp_f32 v5, v5
  v_exp_f32 v6, v6
  v_exp_f32 v7, v7
  v_exp_f32 v8, v8
  v_add_f32 v24, v4, v5
  v_add_f32 v25, v6, v7
  v_add_f32 v24, v24, v8
  v_add_f32 v24, v24, v25
  s_nop 1
  v_add_f32_dpp v25, v24, v24 quad_perm:[1,0,3,2] row_mask:0xf bank_mask:0xf
  s_nop 1
  v_add_f32_dpp v24, v25, v25 quad_perm:[2,3,0,1] row_mask:0xf bank_mask:0xf
  s_nop 1
  v_add_f32_dpp v25, v24, v24 row_half_mirror row_mask:0xf bank_mask:0xf
  v_rcp_f32 v24, v25
  s_nop 0
  v_mul_f32 v8, v8, v24
  v_pk_mul_f32 v[4:5], v[4:5], v[24:25] op_sel_hi:[1,0]
  v_pk_mul_f32 v[6:7], v[6:7], v[24:25] op_sel_hi:[1,0]
  v_mov_b32_dpp v9, v8 quad_perm:[1,0,3,2] row_mask:0xf bank_mask:0xf
  v_cvt_pk_bf16_f32 v10, v4, v5
  v_cvt_pk_bf16_f32 v11, v6, v7
  buffer_store_dwordx2 v[10:11], v135, s[8:11], s49 offen \pol
  v_cvt_pk_bf16_f32 v12, v8, v9
  buffer_store_dword v12, v136, s[8:11], s49 offen \pol
  ds_write_b64 v131, v[44:45]
  ds_write_b64 v131, v[46:47] offset:512
  ds_write_b64 v131, v[106:107] offset:1024
  s_waitcnt lgkmcnt(0)
  s_barrier
  v_mov_b32 v60, 0
  v_mov_b32 v61, 0
  v_mov_b32 v62, 0
  v_mov_b32 v63, 0
  v_mov_b32 v64, 0
  v_mov_b32 v65, 0
  v_mov_b32 v66, 0
  v_mov_b32 v67, 0
  v_mov_b32 v68, 0
  v_mov_b32 v69, 0
  v_mov_b32 v70, 0
  v_mov_b32 v71, 0
  v_mov_b32 v72, 0
  v_mov_b32 v73, 0
  v_mov_b32 v74, 0
  v_mov_b32 v75, 0
  v_mov_b32 v36, 0
  v_mov_b32 v37, 0
  v_mov_b32 v38, 0
  v_mov_b32 v39, 0
  v_mov_b32 v40, 0
  v_mov_b32 v41, 0
  v_mov_b32 v42, 0
  v_mov_b32 v43, 0
  s_add_u32 s97, s97, 10240
  s_mov_b32 s48, s97
  s_add_u32 s49, s49, 5120
  s_add_u32 s98, s49, 5120
  s_add_u32 s50, s50, 12288
  s_add_u32 s63, s63, 12288
  s_add_u32 s51, s51, 1
  s_cmp_gt_u32 s52, s51
  s_cbranch_scc1 ka\sfx\()_x_wp_83_ok
  s_mov_b32 s45, 0
ka\sfx\()_x_wp_83_spin:
  buffer_load_dword v2, v138, s[8:11], 0 offen sc1
  s_add_u32 s45, s45, 1
  s_waitcnt vmcnt(0)
  v_min_u32_dpp v3, v2, v2 quad_perm:[1,0,3,2] row_mask:0xf bank_mask:0xf
  s_nop 1
  v_min_u32_dpp v2, v3, v3 quad_perm:[2,3,0,1] row_mask:0xf bank_mask:0xf
  s_nop 1
  v_min_u32_dpp v3, v2, v2 row_half_mirror row_mask:0xf bank_mask:0xf
  s_nop 1
  v_min_u32_dpp v2, v3, v3 quad_perm:[0,1,2,3] row_mask:0xf bank_mask:0xf
  s_nop 0
  v_readfirstlane_b32 s52, v2
  s_cmp_gt_u32 s52, s51
  s_cbranch_scc1 ka\sfx\()_x_wp_83_ok
  s_cmp_lt_u32 s45, 400000
  s_cbranch_scc1 ka\sfx\()_x_wp_83_spin
  s_branch ka\sfx\()_abort
ka\sfx\()_x_wp_83_ok:
  s_add_u32 s28, s50, s53
  buffer_load_dwordx2 v[88:89], v132, s[8:11], s28 offen offset:0 sc1
  buffer_load_dwordx2 v[92:93], v132, s[8:11], s28 offen offset:1024 sc1
  s_add_u32 s28, s50, s54
  buffer_load_dwordx2 v[90:91], v132, s[8:11], s28 offen offset:0 sc1
  buffer_load_dwordx2 v[94:95], v132, s[8:11], s28 offen offset:1024 sc1
  s_add_u32 s28, s50, s55
  buffer_load_dwordx2 v[96:97], v132, s[8:11], s28 offen offset:0 sc1
  buffer_load_dwordx2 v[98:99], v132, s[8:11], s28 offen offset:1024 sc1
  s_branch ka\sfx\()_x_w0l
ka\sfx\()_x_w1:
ka\sfx\()_x_w1l:
  ds_read_b128 v[44:47], v129 offset:0
  ds_read_b128 v[48:51], v129 offset:1024
  ds_read_b128 v[52:55], v129 offset:10240
  ds_read_b128 v[56:59], v129 offset:11264
  s_waitcnt lgkmcnt(0)
  s_mov_b32 s45, 0
ka\sfx\()_x_pf_84_pr:
  buffer_load_dword v139, v141, s[8:11], s48 offen sc1
  s_add_u32 s45, s45, 1
  s_waitcnt vmcnt(0)
  v_cmp_eq_u32 vcc, -1, v139
  s_cbranch_vccz ka\sfx\()_x_pf_84
  s_cmp_lt_u32 s45, 400000
  s_cbranch_scc1 ka\sfx\()_x_pf_84_pr
  s_branch ka\sfx\()_abort
ka\sfx\()_x_pf_84:
  buffer_load_dwordx4 v[112:115], v124, s[8:11], s48 offen sc1
  buffer_load_dwordx4 v[116:119], v125, s[8:11], s48 offen sc1
  buffer_load_dwordx4 v[120:123], v126, s[8:11], s48 offen sc1
  s_add_u32 s45, s45, 1
  s_waitcnt vmcnt(2)
  ds_write_b128 v127, v[112:115] offset:0
  v_max3_u32 v139, v112, v113, v114
  v_max_u32 v139, v139, v115
  s_waitcnt vmcnt(1)
  ds_write_b128 v127, v[116:119] offset:4096
  v_max3_u32 v139, v139, v116, v117
  v_max3_u32 v139, v139, v118, v119
  s_waitcnt vmcnt(0)
  ds_write_b128 v127, v[120:123] offset:8192
  v_max3_u32 v139, v139, v120, v121
  v_max3_u32 v139, v139, v122, v123
  v_cmp_eq_u32 vcc, -1, v139
  s_cbranch_vccz ka\sfx\()_x_pf_84_ok
  s_cmp_lt_u32 s45, 400000
  s_cbranch_scc1 ka\sfx\()_x_pf_84
  s_branch ka\sfx\()_abort
ka\sfx\()_x_pf_84_ok:
  v_smfmac_f32_16x16x64_bf16 v[60:63], v[112:115], a[8:15], v110
  v_smfmac_f32_16x16x64_bf16 v[64:67], v[112:115], v[44:51], v110
  ds_read_b128 v[44:47], v129 offset:20480
  v_smfmac_f32_16x16x64_bf16 v[68:71], v[112:115], a[88:95], v110
  ds_read_b128 v[48:51], v129 offset:21504
  v_smfmac_f32_16x16x64_bf16 v[72:75], v[112:115], v[52:59], v110
  ds_read_b128 v[52:55], v129 offset:4096
  s_waitcnt lgkmcnt(3)
  s_barrier
  v_smfmac_f32_16x16x64_bf16 v[36:39], v[112:115], a[168:175], v110
  ds_read_b128 v[56:59], v129 offset:5120
  ds_read_b128 v[4:7], v128 offset:0
  s_waitcnt lgkmcnt(3)
  v_smfmac_f32_16x16x64_bf16 v[40:43], v[112:115], v[44:51], v110
  ds_read_b128 v[44:47], v129 offset:14336
  ds_read_b128 v[8:11], v128 offset:2048
  v_smfmac_f32_16x16x64_bf16 v[60:63], v[116:119], a[40:47], v110
  ds_read_b128 v[48:51], v129 offset:15360
  ds_read_b128 v[12:15], v128 offset:3072
  s_waitcnt lgkmcnt(5)
  v_smfmac_f32_16x16x64_bf16 v[64:67], v[116:119], v[52:59], v110
  ds_read_b128 v[52:55], v129 offset:24576
  ds_read_b128 v[16:19], v128 offset:4096
  v_smfmac_f32_16x16x64_bf16 v[68:71], v[116:119], a[120:127], v110
  ds_read_b128 v[56:59], v129 offset:25600
  ds_read_b128 v[20:23], v128 offset:6144
  s_waitcnt lgkmcnt(5)
  v_smfmac_f32_16x16x64_bf16 v[72:75], v[116:119], v[44:51], v110
  ds_read_b128 v[44:47], v129 offset:8192
  ds_read_b128 v[24:27], v128 offset:7168
  v_smfmac_f32_16x16x64_bf16 v[36:39], v[116:119], a[200:207], v110
  ds_read_b128 v[48:51], v129 offset:9216
  ds_read_b128 v[28:31], v128 offset:8192
  s_waitcnt lgkmcnt(5)
  v_smfmac_f32_16x16x64_bf16 v[40:43], v[116:119], v[52:59], v110
  ds_read_b128 v[52:55], v129 offset:18432
  v_smfmac_f32_16x16x64_bf16 v[60:63], v[120:123], a[72:79], v110
  ds_read_b128 v[56:59], v129 offset:19456
  s_waitcnt lgkmcnt(3)
  v_smfmac_f32_16x16x64_bf16 v[64:67], v[120:123], v[44:51], v110
  ds_read_b128 v[44:47], v129 offset:28672
  v_smfmac_f32_16x16x64_bf16 v[68:71], v[120:123], a[152:159], v110
  ds_read_b128 v[48:51], v129 offset:29696
  s_waitcnt lgkmcnt(2)
  v_smfmac_f32_16x16x64_bf16 v[72:75], v[120:123], v[52:59], v110
  ds_read_b128 v[52:55], v129 offset:2048
  v_smfmac_f32_16x16x64_bf16 v[36:39], v[120:123], a[232:239], v110
  ds_read_b128 v[56:59], v129 offset:3072
  s_waitcnt lgkmcnt(2)
  v_smfmac_f32_16x16x64_bf16 v[40:43], v[120:123], v[44:51], v110
  ds_read_b128 v[44:47], v129 offset:6144
  v_smfmac_f32_16x16x64_bf16 v[60:63], v[4:7], a[0:7], v110
  ds_read_b128 v[48:51], v129 offset:7168
  v_smfmac_f32_16x16x64_bf16 v[64:67], v[4:7], a[240:247], v110
  v_smfmac_f32_16x16x64_bf16 v[60:63], v[8:11], a[16:23], v110
  v_smfmac_f32_16x16x64_bf16 v[64:67], v[8:11], a[248:255], v110
  v_smfmac_f32_16x16x64_bf16 v[60:63], v[12:15], a[24:31], v110
  s_waitcnt lgkmcnt(2)
  v_smfmac_f32_16x16x64_bf16 v[64:67], v[12:15], v[52:59], v110
  ds_read_b128 v[52:55], v129 offset:12288
  v_smfmac_f32_16x16x64_bf16 v[60:63], v[16:19], a[32:39], v110
  ds_read_b128 v[56:59], v129 offset:13312
  v_smfmac_f32_16x16x64_bf16 v[64:67], v[16:19], v[152:159], v110
  v_smfmac_f32_16x16x64_bf16 v[60:63], v[20:23], a[48:55], v110
  v_smfmac_f32_16x16x64_bf16 v[64:67], v[20:23], v[160:167], v110
  v_smfmac_f32_16x16x64_bf16 v[60:63], v[24:27], a[56:63], v110
  s_waitcnt lgkmcnt(2)
  v_smfmac_f32_16x16x64_bf16 v[64:67], v[24:27], v[44:51], v110
  ds_read_b128 v[44:47], v129 offset:16384
  v_smfmac_f32_16x16x64_bf16 v[60:63], v[28:31], a[64:71], v110
  ds_read_b128 v[48:51], v129 offset:17408
  v_smfmac_f32_16x16x64_bf16 v[64:67], v[28:31], v[168:175], v110
  v_smfmac_f32_16x16x64_bf16 v[68:71], v[4:7], a[80:87], v110
  v_smfmac_f32_16x16x64_bf16 v[72:75], v[4:7], v[176:183], v110
  v_permlane32_swap_b32 v60, v64
  v_smfmac_f32_16x16x64_bf16 v[68:71], v[8:11], a[96:103], v110
  v_smfmac_f32_16x16x64_bf16 v[72:75], v[8:11], v[184:191], v110
  v_permlane32_swap_b32 v61, v65
  v_smfmac_f32_16x16x64_bf16 v[68:71], v[12:15], a[104:111], v110
  s_waitcnt lgkmcnt(2)
  v_smfmac_f32_16x16x64_bf16 v[72:75], v[12:15], v[52:59], v110
  ds_read_b128 v[52:55], v129 offset:22528
  v_permlane32_swap_b32 v62, v66
  v_smfmac_f32_16x16x64_bf16 v[68:71], v[16:19], a[112:119], v110
  ds_read_b128 v[56:59], v129 offset:23552
  v_permlane32_swap_b32 v63, v67
  v_smfmac_f32_16x16x64_bf16 v[72:75], v[16:19], v[192:199], v110
  v_add_f32 v60, v60, v64
  v_smfmac_f32_16x16x64_bf16 v[68:71], v[20:23], a[128:135], v110
  v_add_f32 v61, v61, v65
  v_smfmac_f32_16x16x64_bf16 v[72:75], v[20:23], v[200:207], v110
  v_add_f32 v62, v62, v66
  v_smfmac_f32_16x16x64_bf16 v[68:71], v[24:27], a[136:143], v110
  v_add_f32 v63, v63, v67
  s_waitcnt lgkmcnt(2)
  v_smfmac_f32_16x16x64_bf16 v[72:75], v[24:27], v[44:51], v110
  ds_read_b128 v[44:47], v129 offset:26624
  v_cvt_pk_bf16_f32 v100, v60, v61
  v_smfmac_f32_16x16x64_bf16 v[68:71], v[28:31], a[144:151], v110
  ds_read_b128 v[48:51], v129 offset:27648
  v_cvt_pk_bf16_f32 v101, v62, v63
  v_smfmac_f32_16x16x64_bf16 v[72:75], v[28:31], v[208:215], v110
  v_smfmac_f32_16x16x64_bf16 v[36:39], v[4:7], a[160:167], v110
  v_smfmac_f32_16x16x64_bf16 v[40:43], v[4:7], v[216:223], v110
  v_permlane32_swap_b32 v68, v72
  v_smfmac_f32_16x16x64_bf16 v[36:39], v[8:11], a[176:183], v110
  v_smfmac_f32_16x16x64_bf16 v[40:43], v[8:11], v[224:231], v110
  v_permlane32_swap_b32 v69, v73
  v_smfmac_f32_16x16x64_bf16 v[36:39], v[12:15], a[184:191], v110
  s_waitcnt lgkmcnt(2)
  v_smfmac_f32_16x16x64_bf16 v[40:43], v[12:15], v[52:59], v110
  v_permlane32_swap_b32 v70, v74
  v_smfmac_f32_16x16x64_bf16 v[36:39], v[16:19], a[192:199], v110
  v_permlane32_swap_b32 v71, v75
  v_smfmac_f32_16x16x64_bf16 v[40:43], v[16:19], v[232:239], v110
  v_add_f32 v68, v68, v72
  v_smfmac_f32_16x16x64_bf16 v[36:39], v[20:23], a[208:215], v110
  v_add_f32 v69, v69, v73
  v_smfmac_f32_16x16x64_bf16 v[40:43], v[20:23], v[240:247], v110
  v_add_f32 v70, v70, v74
  v_smfmac_f32_16x16x64_bf16 v[36:39], v[24:27], a[216:223], v110
  v_add_f32 v71, v71, v75
  s_waitcnt lgkmcnt(0)
  v_smfmac_f32_16x16x64_bf16 v[40:43], v[24:27], v[44:51], v110
  v_cvt_pk_bf16_f32 v102, v68, v69
  v_smfmac_f32_16x16x64_bf16 v[36:39], v[28:31], a[224:231], v110
  v_cvt_pk_bf16_f32 v103, v70, v71
  v_smfmac_f32_16x16x64_bf16 v[40:43], v[28:31], v[248:255], v110
  v_mfma_f32_16x16x16_bf16 v[142:145], v[100:101], v[108:109], 0
  v_mfma_f32_16x16x16_bf16 v[146:149], v[102:103], v[108:109], 0
  s_nop 1
  v_permlane32_swap_b32 v36, v40
  v_permlane32_swap_b32 v37, v41
  v_permlane32_swap_b32 v38, v42
  v_permlane32_swap_b32 v39, v43
  v_add_f32 v36, v36, v40
  v_add_f32 v37, v37, v41
  v_add_f32 v38, v38, v42
  v_add_f32 v39, v39, v43
  v_cvt_pk_bf16_f32 v104, v36, v37
  v_cvt_pk_bf16_f32 v105, v38, v39
  v_cvt_pk_bf16_f32 v44, v142, v143
  v_cvt_pk_bf16_f32 v45, v144, v145
  v_mfma_f32_16x16x16_bf16 v[142:145], v[104:105], v[108:109], 0
  v_cvt_pk_bf16_f32 v46, v146, v147
  v_cvt_pk_bf16_f32 v47, v148, v149
  s_nop 1
  v_mfma_f32_16x16x32_bf16 v[76:79], v[44:47], v[44:47], 0
  v_mfma_f32_16x16x32_bf16 v[80:83], v[88:91], v[44:47], 0
  v_cvt_pk_bf16_f32 v106, v142, v143
  v_cvt_pk_bf16_f32 v107, v144, v145
  v_mfma_f32_16x16x32_bf16 v[84:87], v[92:95], v[44:47], 0
  s_nop 0
  v_mfma_f32_16x16x16_bf16 v[76:79], v[106:107], v[106:107], v[76:79]
  v_mfma_f32_16x16x16_bf16 v[80:83], v[96:97], v[106:107], v[80:83]
  v_mfma_f32_16x16x16_bf16 v[84:87], v[98:99], v[106:107], v[84:87]
  s_mov_b32 exec_lo, 0
  s_mov_b32 exec_hi, 0x00ff00ff
  s_nop 3
  ds_write_b128 v130, v[76:79]
  s_mov_b32 exec_lo, 0x00ff00ff
  ds_write_b128 v130, v[80:83] offset:1024
  s_nop 0
  ds_write_b128 v130, v[84:87] offset:2048
  s_mov_b64 exec, -1
  s_waitcnt lgkmcnt(0)
  s_barrier
  ds_write_b64 v131, v[44:45]
  ds_write_b64 v131, v[46:47] offset:512
  ds_write_b64 v131, v[106:107] offset:1024
  s_waitcnt lgkmcnt(0)
  s_cmp_ge_u32 s51, 63
  s_cbranch_scc1 ka\sfx\()_x_done
  s_barrier
  v_mov_b32 v60, 0
  v_mov_b32 v61, 0
  v_mov_b32 v62, 0
  v_mov_b32 v63, 0
  v_mov_b32 v64, 0
  v_mov_b32 v65, 0
  v_mov_b32 v66, 0
  v_mov_b32 v67, 0
  v_mov_b32 v68, 0
  v_mov_b32 v69, 0
  v_mov_b32 v70, 0
  v_mov_b32 v71, 0
  v_mov_b32 v72, 0
  v_mov_b32 v73, 0
  v_mov_b32 v74, 0
  v_mov_b32 v75, 0
  v_mov_b32 v36, 0
  v_mov_b32 v37, 0
  v_mov_b32 v38, 0
  v_mov_b32 v39, 0
  v_mov_b32 v40, 0
  v_mov_b32 v41, 0
  v_mov_b32 v42, 0
  v_mov_b32 v43, 0
  s_add_u32 s97, s97, 10240
  s_mov_b32 s48, s97
  s_add_u32 s49, s49, 5120
  s_add_u32 s98, s49, 5120
  s_add_u32 s50, s50, 12288
  s_add_u32 s63, s63, 12288
  s_add_u32 s51, s51, 1
  s_cmp_gt_u32 s52, s51
  s_cbranch_scc1 ka\sfx\()_x_wp_85_ok
  s_mov_b32 s45, 0
ka\sfx\()_x_wp_85_spin:
  buffer_load_dword v2, v138, s[8:11], 0 offen sc1
  s_add_u32 s45, s45, 1
  s_waitcnt vmcnt(0)
  v_min_u32_dpp v3, v2, v2 quad_perm:[1,0,3,2] row_mask:0xf bank_mask:0xf
  s_nop 1
  v_min_u32_dpp v2, v3, v3 quad_perm:[2,3,0,1] row_mask:0xf bank_mask:0xf
  s_nop 1
  v_min_u32_dpp v3, v2, v2 row_half_mirror row_mask:0xf bank_mask:0xf
  s_nop 1
  v_min_u32_dpp v2, v3, v3 quad_perm:[0,1,2,3] row_mask:0xf bank_mask:0xf
  s_nop 0
  v_readfirstlane_b32 s52, v2
  s_cmp_gt_u32 s52, s51
  s_cbranch_scc1 ka\sfx\()_x_wp_85_ok
  s_cmp_lt_u32 s45, 400000
  s_cbranch_scc1 ka\sfx\()_x_wp_85_spin
  s_branch ka\sfx\()_abort
ka\sfx\()_x_wp_85_ok:
  s_add_u32 s28, s50, s53
  buffer_load_dwordx2 v[88:89], v132, s[8:11], s28 offen offset:0 sc1
  buffer_load_dwordx2 v[92:93], v132, s[8:11], s28 offen offset:1024 sc1
  s_add_u32 s28, s50, s54
  buffer_load_dwordx2 v[90:91], v132, s[8:11], s28 offen offset:0 sc1
  buffer_load_dwordx2 v[94:95], v132, s[8:11], s28 offen offset:1024 sc1
  s_add_u32 s28, s50, s55
  buffer_load_dwordx2 v[96:97], v132, s[8:11], s28 offen offset:0 sc1
  buffer_load_dwordx2 v[98:99], v132, s[8:11], s28 offen offset:1024 sc1
  s_branch ka\sfx\()_x_w1l
ka\sfx\()_x_w23:
  s_sub_u32 s65, s21, 2
  s_and_b32 s26, s23, 7
  v_and_b32 v4, 15, v1
  v_lshrrev_b32 v5, 4, v1
  v_and_b32 v6, 1, v5
  v_lshlrev_b32 v6, 5, v6
  v_add_u32 v6, v6, v4
  v_lshlrev_b32 v6, 4, v6
  v_lshrrev_b32 v7, 1, v5
  v_lshlrev_b32 v7, 3, v7
  v_add_u32 v6, v6, v7
  s_lshl_b32 s28, s26, 1
  s_add_u32 s28, s28, s65
  s_lshl_b32 s28, s28, 10
  v_add_u32 v133, s28, v6
  s_lshr_b32 s28, s26, 2
  s_lshl_b32 s28, s28, 1
  s_add_u32 s28, s28, s65
  s_lshl_b32 s28, s28, 10
  s_and_b32 s29, s26, 1
  s_lshl_b32 s29, s29, 9
  s_add_u32 s28, s28, s29
  s_bfe_u32 s29, s26, 0x10001
  s_lshl_b32 s29, s29, 3
  s_add_u32 s28, s28, s29
  s_add_u32 s28, s28, 15872
  v_lshlrev_b32 v6, 4, v5
  v_add_u32 v6, v6, v4
  v_lshlrev_b32 v6, 4, v6
  v_add_u32 v6, s28, v6
  v_mov_b32 v7, 0x40000000
  v_cmp_le_u32 vcc, 2, v5
  s_nop 1
  v_cndmask_b32 v134, v7, v6, vcc
  v_mov_b32 v135, 0xf149f2ca
  v_lshlrev_b32 v6, 3, v1
  v_add_u32 v136, 145408, v6
  s_mul_i32 s94, s65, 6144
  s_add_u32 s94, s94, 151552
  v_add_u32 v137, s94, v132
  v_cmp_le_u32 s[66:67], 2, v5
  v_lshlrev_b32 v6, 2, v5
  v_sub_u32 v6, v4, v6
  v_cmp_le_i32 s[68:69], 0, v6
  v_cmp_le_i32 s[70:71], 1, v6
  v_cmp_le_i32 s[72:73], 2, v6
  v_cmp_le_i32 s[74:75], 3, v6
  s_nop 1
  s_cmp_eq_u32 s65, 0
  s_cselect_b64 s[76:77], s[68:69], -1
  s_cselect_b64 s[84:85], 0, s[68:69]
  s_cselect_b64 s[78:79], s[70:71], -1
  s_cselect_b64 s[86:87], 0, s[70:71]
  s_cselect_b64 s[80:81], s[72:73], -1
  s_cselect_b64 s[88:89], 0, s[72:73]
  s_cselect_b64 s[82:83], s[74:75], -1
  s_cselect_b64 s[90:91], 0, s[74:75]
  s_mul_i32 s92, s20, 1310720
  s_add_u32 s92, s92, 0xe00000
  s_lshl_b32 s93, s65, 10
  s_mov_b32 s64, 0x3dd53b95
  s_add_u32 s95, s63, s93
  s_add_u32 m0, s94, 0
  s_add_u32 s28, s95, 0
  buffer_load_dwordx4 v132, s[8:11], s28 offen sc1 lds
  s_add_u32 m0, s94, 1024
  s_add_u32 s28, s95, 2048
  buffer_load_dwordx4 v132, s[8:11], s28 offen sc1 lds
  s_add_u32 m0, s94, 2048
  s_add_u32 s28, s95, 4096
  buffer_load_dwordx4 v132, s[8:11], s28 offen sc1 lds
  s_add_u32 m0, s94, 3072
  s_add_u32 s28, s95, 6144
  buffer_load_dwordx4 v132, s[8:11], s28 offen sc1 lds
  s_add_u32 m0, s94, 4096
  s_add_u32 s28, s95, 8192
  buffer_load_dwordx4 v132, s[8:11], s28 offen sc1 lds
  s_add_u32 m0, s94, 5120
  s_add_u32 s28, s95, 10240
  buffer_load_dwordx4 v132, s[8:11], s28 offen sc1 lds
  s_cmp_eq_u32 s21, 3
  s_cbranch_scc1 ka\sfx\()_x_w3l
ka\sfx\()_x_w2l:
  ds_read_b128 v[44:47], v129 offset:0
  ds_read_b128 v[48:51], v129 offset:1024
  ds_read_b128 v[52:55], v129 offset:2048
  ds_read_b128 v[56:59], v129 offset:3072
  s_waitcnt lgkmcnt(0)
  s_mov_b32 s45, 0
ka\sfx\()_x_pf_86_pr:
  buffer_load_dword v139, v141, s[8:11], s48 offen sc1
  s_add_u32 s45, s45, 1
  s_waitcnt vmcnt(0)
  v_cmp_eq_u32 vcc, -1, v139
  s_cbranch_vccz ka\sfx\()_x_pf_86
  s_cmp_lt_u32 s45, 400000
  s_cbranch_scc1 ka\sfx\()_x_pf_86_pr
  s_branch ka\sfx\()_abort
ka\sfx\()_x_pf_86:
  buffer_load_dwordx4 v[112:115], v124, s[8:11], s48 offen sc1
  buffer_load_dwordx4 v[116:119], v125, s[8:11], s48 offen sc1
  s_add_u32 s45, s45, 1
  s_waitcnt vmcnt(1)
  ds_write_b128 v127, v[112:115] offset:0
  v_max3_u32 v139, v112, v113, v114
  v_max_u32 v139, v139, v115
  s_waitcnt vmcnt(0)
  ds_write_b128 v127, v[116:119] offset:4096
  v_max3_u32 v139, v139, v116, v117
  v_max3_u32 v139, v139, v118, v119
  v_cmp_eq_u32 vcc, -1, v139
  s_cbranch_vccz ka\sfx\()_x_pf_86_ok
  s_cmp_lt_u32 s45, 400000
  s_cbranch_scc1 ka\sfx\()_x_pf_86
  s_branch ka\sfx\()_abort
ka\sfx\()_x_pf_86_ok:
  v_smfmac_f32_16x16x64_bf16 v[60:63], v[112:115], a[16:23], v110
  v_smfmac_f32_16x16x64_bf16 v[64:67], v[112:115], a[248:255], v110
  v_smfmac_f32_16x16x64_bf16 v[68:71], v[112:115], a[96:103], v110
  v_smfmac_f32_16x16x64_bf16 v[72:75], v[112:115], v[184:191], v110
  s_waitcnt lgkmcnt(0)
  s_barrier
  v_smfmac_f32_16x16x64_bf16 v[36:39], v[112:115], a[176:183], v110
  ds_read_b128 v[4:7], v128 offset:0
  v_smfmac_f32_16x16x64_bf16 v[40:43], v[112:115], v[224:231], v110
  ds_read_b128 v[8:11], v128 offset:1024
  v_smfmac_f32_16x16x64_bf16 v[60:63], v[116:119], a[48:55], v110
  ds_read_b128 v[12:15], v128 offset:3072
  v_smfmac_f32_16x16x64_bf16 v[64:67], v[116:119], v[160:167], v110
  ds_read_b128 v[16:19], v128 offset:4096
  v_smfmac_f32_16x16x64_bf16 v[68:71], v[116:119], a[128:135], v110
  ds_read_b128 v[20:23], v128 offset:5120
  v_smfmac_f32_16x16x64_bf16 v[72:75], v[116:119], v[200:207], v110
  ds_read_b128 v[24:27], v128 offset:7168
  v_smfmac_f32_16x16x64_bf16 v[36:39], v[116:119], a[208:215], v110
  ds_read_b128 v[28:31], v128 offset:8192
  v_smfmac_f32_16x16x64_bf16 v[40:43], v[116:119], v[240:247], v110
  ds_read_b128 v[32:35], v128 offset:9216
  s_waitcnt lgkmcnt(7)
  v_smfmac_f32_16x16x64_bf16 v[60:63], v[4:7], a[0:7], v110
  v_smfmac_f32_16x16x64_bf16 v[64:67], v[4:7], a[240:247], v110
  s_waitcnt lgkmcnt(6)
  v_smfmac_f32_16x16x64_bf16 v[60:63], v[8:11], a[8:15], v110
  v_smfmac_f32_16x16x64_bf16 v[64:67], v[8:11], v[44:51], v110
  ds_read_b128 v[44:47], v129 offset:4096
  s_waitcnt lgkmcnt(6)
  v_smfmac_f32_16x16x64_bf16 v[60:63], v[12:15], a[24:31], v110
  ds_read_b128 v[48:51], v129 offset:5120
  v_smfmac_f32_16x16x64_bf16 v[64:67], v[12:15], v[52:59], v110
  ds_read_b128 v[52:55], v129 offset:6144
  s_waitcnt lgkmcnt(7)
  v_smfmac_f32_16x16x64_bf16 v[60:63], v[16:19], a[32:39], v110
  ds_read_b128 v[56:59], v129 offset:7168
  v_smfmac_f32_16x16x64_bf16 v[64:67], v[16:19], v[152:159], v110
  s_waitcnt lgkmcnt(7)
  v_smfmac_f32_16x16x64_bf16 v[60:63], v[20:23], a[40:47], v110
  s_waitcnt lgkmcnt(2)
  v_smfmac_f32_16x16x64_bf16 v[64:67], v[20:23], v[44:51], v110
  ds_read_b128 v[44:47], v129 offset:8192
  v_smfmac_f32_16x16x64_bf16 v[60:63], v[24:27], a[56:63], v110
  ds_read_b128 v[48:51], v129 offset:9216
  s_waitcnt lgkmcnt(2)
  v_smfmac_f32_16x16x64_bf16 v[64:67], v[24:27], v[52:59], v110
  ds_read_b128 v[52:55], v129 offset:10240
  v_smfmac_f32_16x16x64_bf16 v[60:63], v[28:31], a[64:71], v110
  ds_read_b128 v[56:59], v129 offset:11264
  v_smfmac_f32_16x16x64_bf16 v[64:67], v[28:31], v[168:175], v110
  v_smfmac_f32_16x16x64_bf16 v[60:63], v[32:35], a[72:79], v110
  s_waitcnt lgkmcnt(2)
  v_smfmac_f32_16x16x64_bf16 v[64:67], v[32:35], v[44:51], v110
  ds_read_b128 v[44:47], v129 offset:12288
  v_smfmac_f32_16x16x64_bf16 v[68:71], v[4:7], a[80:87], v110
  ds_read_b128 v[48:51], v129 offset:13312
  v_smfmac_f32_16x16x64_bf16 v[72:75], v[4:7], v[176:183], v110
  v_permlane32_swap_b32 v60, v64
  v_smfmac_f32_16x16x64_bf16 v[68:71], v[8:11], a[88:95], v110
  s_waitcnt lgkmcnt(2)
  v_smfmac_f32_16x16x64_bf16 v[72:75], v[8:11], v[52:59], v110
  ds_read_b128 v[52:55], v129 offset:14336
  v_permlane32_swap_b32 v61, v65
  v_smfmac_f32_16x16x64_bf16 v[68:71], v[12:15], a[104:111], v110
  ds_read_b128 v[56:59], v129 offset:15360
  s_waitcnt lgkmcnt(2)
  v_smfmac_f32_16x16x64_bf16 v[72:75], v[12:15], v[44:51], v110
  ds_read_b128 v[44:47], v129 offset:16384
  v_permlane32_swap_b32 v62, v66
  v_smfmac_f32_16x16x64_bf16 v[68:71], v[16:19], a[112:119], v110
  ds_read_b128 v[48:51], v129 offset:17408
  v_permlane32_swap_b32 v63, v67
  v_smfmac_f32_16x16x64_bf16 v[72:75], v[16:19], v[192:199], v110
  v_add_f32 v60, v60, v64
  v_smfmac_f32_16x16x64_bf16 v[68:71], v[20:23], a[120:127], v110
  v_add_f32 v61, v61, v65
  s_waitcnt lgkmcnt(2)
  v_smfmac_f32_16x16x64_bf16 v[72:75], v[20:23], v[52:59], v110
  ds_read_b128 v[52:55], v129 offset:18432
  v_add_f32 v62, v62, v66
  v_smfmac_f32_16x16x64_bf16 v[68:71], v[24:27], a[136:143], v110
  ds_read_b128 v[56:59], v129 offset:19456
  v_add_f32 v63, v63, v67
  s_waitcnt lgkmcnt(2)
  v_smfmac_f32_16x16x64_bf16 v[72:75], v[24:27], v[44:51], v110
  ds_read_b128 v[44:47], v129 offset:20480
  v_cvt_pk_bf16_f32 v100, v60, v61
  v_smfmac_f32_16x16x64_bf16 v[68:71], v[28:31], a[144:151], v110
  ds_read_b128 v[48:51], v129 offset:21504
  v_cvt_pk_bf16_f32 v101, v62, v63
  v_smfmac_f32_16x16x64_bf16 v[72:75], v[28:31], v[208:215], v110
  v_smfmac_f32_16x16x64_bf16 v[68:71], v[32:35], a[152:159], v110
  s_waitcnt lgkmcnt(2)
  v_smfmac_f32_16x16x64_bf16 v[72:75], v[32:35], v[52:59], v110
  ds_read_b128 v[52:55], v129 offset:22528
  v_smfmac_f32_16x16x64_bf16 v[36:39], v[4:7], a[160:167], v110
  ds_read_b128 v[56:59], v129 offset:23552
  v_smfmac_f32_16x16x64_bf16 v[40:43], v[4:7], v[216:223], v110
  v_permlane32_swap_b32 v68, v72
  v_smfmac_f32_16x16x64_bf16 v[36:39], v[8:11], a[168:175], v110
  s_waitcnt lgkmcnt(2)
  v_smfmac_f32_16x16x64_bf16 v[40:43], v[8:11], v[44:51], v110
  ds_read_b128 v[44:47], v129 offset:24576
  v_permlane32_swap_b32 v69, v73
  v_smfmac_f32_16x16x64_bf16 v[36:39], v[12:15], a[184:191], v110
  ds_read_b128 v[48:51], v129 offset:25600
  s_waitcnt lgkmcnt(2)
  v_smfmac_f32_16x16x64_bf16 v[40:43], v[12:15], v[52:59], v110
  ds_read_b128 v[52:55], v129 offset:26624
  v_permlane32_swap_b32 v70, v74
  v_smfmac_f32_16x16x64_bf16 v[36:39], v[16:19], a[192:199], v110
  ds_read_b128 v[56:59], v129 offset:27648
  v_permlane32_swap_b32 v71, v75
  v_smfmac_f32_16x16x64_bf16 v[40:43], v[16:19], v[232:239], v110
  v_add_f32 v68, v68, v72
  v_smfmac_f32_16x16x64_bf16 v[36:39], v[20:23], a[200:207], v110
  v_add_f32 v69, v69, v73
  s_waitcnt lgkmcnt(2)
  v_smfmac_f32_16x16x64_bf16 v[40:43], v[20:23], v[44:51], v110
  ds_read_b128 v[44:47], v129 offset:28672
  v_add_f32 v70, v70, v74
  v_smfmac_f32_16x16x64_bf16 v[36:39], v[24:27], a[216:223], v110
  ds_read_b128 v[48:51], v129 offset:29696
  v_add_f32 v71, v71, v75
  s_waitcnt lgkmcnt(2)
  v_smfmac_f32_16x16x64_bf16 v[40:43], v[24:27], v[52:59], v110
  v_cvt_pk_bf16_f32 v102, v68, v69
  v_smfmac_f32_16x16x64_bf16 v[36:39], v[28:31], a[224:231], v110
  v_cvt_pk_bf16_f32 v103, v70, v71
  v_smfmac_f32_16x16x64_bf16 v[40:43], v[28:31], v[248:255], v110
  v_smfmac_f32_16x16x64_bf16 v[36:39], v[32:35], a[232:239], v110
  s_waitcnt lgkmcnt(0)
  v_smfmac_f32_16x16x64_bf16 v[40:43], v[32:35], v[44:51], v110
  v_mfma_f32_16x16x16_bf16 v[142:145], v[100:101], v[108:109], 0
  v_mfma_f32_16x16x16_bf16 v[146:149], v[102:103], v[108:109], 0
  s_nop 1
  v_permlane32_swap_b32 v36, v40
  v_permlane32_swap_b32 v37, v41
  v_permlane32_swap_b32 v38, v42
  v_permlane32_swap_b32 v39, v43
  v_add_f32 v36, v36, v40
  v_add_f32 v37, v37, v41
  v_add_f32 v38, v38, v42
  v_add_f32 v39, v39, v43
  v_cvt_pk_bf16_f32 v104, v36, v37
  v_cvt_pk_bf16_f32 v105, v38, v39
  v_cvt_pk_bf16_f32 v44, v142, v143
  v_cvt_pk_bf16_f32 v45, v144, v145
  v_mfma_f32_16x16x16_bf16 v[142:145], v[104:105], v[108:109], 0
  v_cvt_pk_bf16_f32 v46, v146, v147
  v_cvt_pk_bf16_f32 v47, v148, v149
  s_nop 1
  v_mfma_f32_16x16x32_bf16 v[76:79], v[44:47], v[44:47], 0
  v_mfma_f32_16x16x32_bf16 v[80:83], v[88:91], v[44:47], 0
  v_cvt_pk_bf16_f32 v106, v142, v143
  v_cvt_pk_bf16_f32 v107, v144, v145
  v_mfma_f32_16x16x32_bf16 v[84:87], v[92:95], v[44:47], 0
  s_nop 0
  v_mfma_f32_16x16x16_bf16 v[76:79], v[106:107], v[106:107], v[76:79]
  v_mfma_f32_16x16x16_bf16 v[80:83], v[96:97], v[106:107], v[80:83]
  v_mfma_f32_16x16x16_bf16 v[84:87], v[98:99], v[106:107], v[84:87]
  s_mov_b32 exec_lo, 0
  s_mov_b32 exec_hi, 0x00ff00ff
  s_nop 3
  ds_write_b128 v130, v[76:79]
  s_mov_b32 exec_lo, 0x00ff00ff
  ds_write_b128 v130, v[80:83] offset:1024
  s_nop 0
  ds_write_b128 v130, v[84:87] offset:2048
  s_mov_b64 exec, -1
  s_waitcnt lgkmcnt(0)
  s_barrier
  ds_write_b64 v131, v[44:45]
  ds_write_b64 v131, v[46:47] offset:512
  ds_write_b64 v131, v[106:107] offset:1024
  ds_read_b128 v[44:47], v137 offset:0
  ds_read_b128 v[48:51], v137 offset:1024
  ds_read_b128 v[52:55], v137 offset:2048
  ds_read_b128 v[56:59], v137 offset:3072
  ds_read_b128 v[68:71], v137 offset:4096
  ds_read_b128 v[72:75], v137 offset:5120
  s_waitcnt lgkmcnt(0)
  s_barrier
  s_mov_b32 s28, s50
  buffer_load_dwordx4 v[4:7], v132, s[8:11], s28 offen sc1
  buffer_load_dwordx4 v[8:11], v132, s[8:11], s28 offen offset:1024 sc1
  s_add_u32 s28, s28, 2048
  buffer_load_dwordx4 v[12:15], v132, s[8:11], s28 offen sc1
  buffer_load_dwordx4 v[16:19], v132, s[8:11], s28 offen offset:1024 sc1
  s_add_u32 s28, s28, 2048
  buffer_load_dwordx4 v[20:23], v132, s[8:11], s28 offen sc1
  buffer_load_dwordx4 v[24:27], v132, s[8:11], s28 offen offset:1024 sc1
  s_add_u32 s28, s28, 2048
  buffer_load_dwordx4 v[28:31], v132, s[8:11], s28 offen sc1
  buffer_load_dwordx4 v[32:35], v132, s[8:11], s28 offen offset:1024 sc1
  s_add_u32 s28, s28, 2048
  buffer_load_dwordx4 v[36:39], v132, s[8:11], s28 offen sc1
  buffer_load_dwordx4 v[40:43], v132, s[8:11], s28 offen offset:1024 sc1
  s_add_u32 s28, s28, 2048
  buffer_load_dwordx4 v[60:63], v132, s[8:11], s28 offen sc1
  buffer_load_dwordx4 v[64:67], v132, s[8:11], s28 offen offset:1024 sc1
  s_add_u32 s28, s28, 2048
  ds_read_b64 v[76:77], v136 offset:0
  ds_read_b64 v[78:79], v136 offset:512
  ds_read_b64 v[80:81], v136 offset:1024
  ds_read_b64 v[82:83], v136 offset:1536
  ds_read_b64 v[84:85], v136 offset:2048
  ds_read_b64 v[86:87], v136 offset:2560
  ds_read_b64 v[88:89], v136 offset:3072
  ds_read_b64 v[90:91], v136 offset:3584
  ds_read_b64 v[92:93], v136 offset:4096
  ds_read_b64 v[94:95], v136 offset:4608
  ds_read_b64 v[96:97], v136 offset:5120
  ds_read_b64 v[98:99], v136 offset:5632
  s_waitcnt lgkmcnt(0)
  s_cmp_ge_u32 s51, 63
  s_cbranch_scc1 xq_87_\sfx\()
  s_add_u32 s96, s51, 1
  s_cmp_gt_u32 s52, s96
  s_cbranch_scc1 ka\sfx\()_x_wp_88_ok
  s_mov_b32 s45, 0
ka\sfx\()_x_wp_88_spin:
  buffer_load_dword v2, v138, s[8:11], 0 offen sc1
  s_add_u32 s45, s45, 1
  s_waitcnt vmcnt(0)
  v_min_u32_dpp v3, v2, v2 quad_perm:[1,0,3,2] row_mask:0xf bank_mask:0xf
  s_nop 1
  v_min_u32_dpp v2, v3, v3 quad_perm:[2,3,0,1] row_mask:0xf bank_mask:0xf
  s_nop 1
  v_min_u32_dpp v3, v2, v2 row_half_mirror row_mask:0xf bank_mask:0xf
  s_nop 1
  v_min_u32_dpp v2, v3, v3 quad_perm:[0,1,2,3] row_mask:0xf bank_mask:0xf
  s_nop 0
  v_readfirstlane_b32 s52, v2
  s_cmp_gt_u32 s52, s96
  s_cbranch_scc1 ka\sfx\()_x_wp_88_ok
  s_cmp_lt_u32 s45, 400000
  s_cbranch_scc1 ka\sfx\()_x_wp_88_spin
  s_branch ka\sfx\()_abort
ka\sfx\()_x_wp_88_ok:
  s_add_u32 s95, s63, s93
  s_add_u32 s95, s95, 12288
  s_add_u32 m0, s94, 0
  s_add_u32 s28, s95, 0
  buffer_load_dwordx4 v132, s[8:11], s28 offen sc1 lds
  s_add_u32 m0, s94, 1024
  s_add_u32 s28, s95, 2048
  buffer_load_dwordx4 v132, s[8:11], s28 offen sc1 lds
  s_add_u32 m0, s94, 2048
  s_add_u32 s28, s95, 4096
  buffer_load_dwordx4 v132, s[8:11], s28 offen sc1 lds
  s_add_u32 m0, s94, 3072
  s_add_u32 s28, s95, 6144
  buffer_load_dwordx4 v132, s[8:11], s28 offen sc1 lds
  s_add_u32 m0, s94, 4096
  s_add_u32 s28, s95, 8192
  buffer_load_dwordx4 v132, s[8:11], s28 offen sc1 lds
  s_add_u32 m0, s94, 5120
  s_add_u32 s28, s95, 10240
  buffer_load_dwordx4 v132, s[8:11], s28 offen sc1 lds
  s_branch xq_87_j_\sfx\()
xq_87_\sfx\():
  s_waitcnt vmcnt(0)
xq_87_j_\sfx\():
  s_waitcnt vmcnt(16)
  v_mfma_f32_16x16x32_bf16 v[112:115], v[76:79], v[44:47], 0
  v_mfma_f32_16x16x32_bf16 v[116:119], v[4:7], v[44:47], 0
  v_mfma_f32_16x16x32_bf16 v[120:123], v[8:11], v[44:47], 0
  s_waitcnt vmcnt(14)
  v_mfma_f32_16x16x32_bf16 v[112:115], v[80:83], v[48:51], v[112:115]
  v_mfma_f32_16x16x32_bf16 v[116:119], v[12:15], v[48:51], v[116:119]
  v_mfma_f32_16x16x32_bf16 v[120:123], v[16:19], v[48:51], v[120:123]
  s_waitcnt vmcnt(12)
  v_mfma_f32_16x16x32_bf16 v[112:115], v[84:87], v[52:55], v[112:115]
  v_mfma_f32_16x16x32_bf16 v[116:119], v[20:23], v[52:55], v[116:119]
  v_mfma_f32_16x16x32_bf16 v[120:123], v[24:27], v[52:55], v[120:123]
  s_waitcnt vmcnt(10)
  v_mfma_f32_16x16x32_bf16 v[112:115], v[88:91], v[56:59], v[112:115]
  v_mfma_f32_16x16x32_bf16 v[116:119], v[28:31], v[56:59], v[116:119]
  v_mfma_f32_16x16x32_bf16 v[120:123], v[32:35], v[56:59], v[120:123]
  s_waitcnt vmcnt(8)
  v_mfma_f32_16x16x32_bf16 v[112:115], v[92:95], v[68:71], v[112:115]
  v_mfma_f32_16x16x32_bf16 v[116:119], v[36:39], v[68:71], v[116:119]
  v_mfma_f32_16x16x32_bf16 v[120:123], v[40:43], v[68:71], v[120:123]
  s_waitcnt vmcnt(6)
  v_mfma_f32_16x16x32_bf16 v[112:115], v[96:99], v[72:75], v[112:115]
  v_mfma_f32_16x16x32_bf16 v[116:119], v[60:63], v[72:75], v[116:119]
  v_mfma_f32_16x16x32_bf16 v[120:123], v[64:67], v[72:75], v[120:123]
  s_nop 8
  v_cndmask_b32 v112, v135, v112, s[66:67]
  v_cndmask_b32 v113, v135, v113, s[66:67]
  v_cndmask_b32 v114, v135, v114, s[66:67]
  v_cndmask_b32 v115, v135, v115, s[66:67]
  v_cndmask_b32 v116, v135, v116, s[76:77]
  v_cndmask_b32 v120, v135, v120, s[84:85]
  v_cndmask_b32 v117, v135, v117, s[78:79]
  v_cndmask_b32 v121, v135, v121, s[86:87]
  v_cndmask_b32 v118, v135, v118, s[80:81]
  v_cndmask_b32 v122, v135, v122, s[88:89]
  v_cndmask_b32 v119, v135, v119, s[82:83]
  v_cndmask_b32 v123, v135, v123, s[90:91]
  v_max3_f32 v4, v112, v113, v114
  v_max3_f32 v5, v115, v116, v117
  v_max3_f32 v6, v118, v119, v120
  v_max3_f32 v7, v121, v122, v123
  v_max3_f32 v4, v4, v5, v6
  v_max_f32 v4, v4, v7
  v_mov_b32 v5, v4
  s_nop 1
  v_permlane16_swap_b32 v4, v5
  v_max_f32 v4, v4, v5
  v_mov_b32 v5, v4
  s_nop 1
  v_permlane32_swap_b32 v4, v5
  v_max_f32 v4, v4, v5
  v_mul_f32 v4, s64, v4
  v_fma_f32 v112, v112, s64, -v4
  v_fma_f32 v113, v113, s64, -v4
  v_fma_f32 v114, v114, s64, -v4
  v_fma_f32 v115, v115, s64, -v4
  v_fma_f32 v116, v116, s64, -v4
  v_fma_f32 v117, v117, s64, -v4
  v_fma_f32 v118, v118, s64, -v4
  v_fma_f32 v119, v119, s64, -v4
  v_fma_f32 v120, v120, s64, -v4
  v_fma_f32 v121, v121, s64, -v4
  v_fma_f32 v122, v122, s64, -v4
  v_fma_f32 v123, v123, s64, -v4
  v_exp_f32 v112, v112
  v_exp_f32 v113, v113
  v_exp_f32 v114, v114
  v_exp_f32 v115, v115
  v_exp_f32 v116, v116
  v_exp_f32 v117, v117
  v_exp_f32 v118, v118
  v_exp_f32 v119, v119
  v_exp_f32 v120, v120
  v_exp_f32 v121, v121
  v_exp_f32 v122, v122
  v_exp_f32 v123, v123
  v_add_f32 v5, v112, v113
  v_add_f32 v6, v114, v115
  v_add_f32 v7, v116, v117
  v_add_f32 v8, v118, v119
  v_add_f32 v9, v120, v121
  v_add_f32 v10, v122, v123
  v_add_f32 v5, v5, v6
  v_add_f32 v7, v7, v8
  v_add_f32 v9, v9, v10
  v_add_f32 v5, v5, v7
  v_add_f32 v5, v5, v9
  v_mov_b32 v6, v5
  s_nop 1
  v_permlane16_swap_b32 v5, v6
  v_add_f32 v5, v5, v6
  v_mov_b32 v6, v5
  s_nop 1
  v_permlane32_swap_b32 v5, v6
  v_add_f32 v5, v5, v6
  v_rcp_f32 v5, v5
  s_nop 0
  v_mul_f32 v112, v112, v5
  v_mul_f32 v113, v113, v5
  v_mul_f32 v114, v114, v5
  v_mul_f32 v115, v115, v5
  v_mul_f32 v116, v116, v5
  v_mul_f32 v117, v117, v5
  v_mul_f32 v118, v118, v5
  v_mul_f32 v119, v119, v5
  v_mul_f32 v120, v120, v5
  v_mul_f32 v121, v121, v5
  v_mul_f32 v122, v122, v5
  v_mul_f32 v123, v123, v5
  v_cvt_pk_bf16_f32 v8, v112, v113
  v_cvt_pk_bf16_f32 v9, v114, v115
  v_cvt_pk_bf16_f32 v10, v116, v117
  v_cvt_pk_bf16_f32 v11, v118, v119
  v_cvt_pk_bf16_f32 v12, v120, v121
  v_cvt_pk_bf16_f32 v13, v122, v123
  buffer_store_dwordx2 v[10:11], v133, s[8:11], s92 offen \pol
  buffer_store_dwordx2 v[12:13], v133, s[8:11], s92 offen offset:256 \pol
  buffer_store_dwordx2 v[8:9], v134, s[8:11], s92 offen \pol
  s_add_u32 s92, s92, 20480
  s_cmp_ge_u32 s51, 63
  s_cbranch_scc1 ka\sfx\()_x_done
  v_mov_b32 v60, 0
  v_mov_b32 v61, 0
  v_mov_b32 v62, 0
  v_mov_b32 v63, 0
  v_mov_b32 v64, 0
  v_mov_b32 v65, 0
  v_mov_b32 v66, 0
  v_mov_b32 v67, 0
  v_mov_b32 v68, 0
  v_mov_b32 v69, 0
  v_mov_b32 v70, 0
  v_mov_b32 v71, 0
  v_mov_b32 v72, 0
  v_mov_b32 v73, 0
  v_mov_b32 v74, 0
  v_mov_b32 v75, 0
  v_mov_b32 v36, 0
  v_mov_b32 v37, 0
  v_mov_b32 v38, 0
  v_mov_b32 v39, 0
  v_mov_b32 v40, 0
  v_mov_b32 v41, 0
  v_mov_b32 v42, 0
  v_mov_b32 v43, 0
  s_add_u32 s97, s97, 10240
  s_mov_b32 s48, s97
  s_add_u32 s49, s49, 5120
  s_add_u32 s98, s49, 5120
  s_add_u32 s50, s50, 12288
  s_add_u32 s63, s63, 12288
  s_add_u32 s51, s51, 1
  s_cmp_gt_u32 s52, s51
  s_cbranch_scc1 ka\sfx\()_x_wp_89_ok
  s_mov_b32 s45, 0
ka\sfx\()_x_wp_89_spin:
  buffer_load_dword v2, v138, s[8:11], 0 offen sc1
  s_add_u32 s45, s45, 1
  s_waitcnt vmcnt(0)
  v_min_u32_dpp v3, v2, v2 quad_perm:[1,0,3,2] row_mask:0xf bank_mask:0xf
  s_nop 1
  v_min_u32_dpp v2, v3, v3 quad_perm:[2,3,0,1] row_mask:0xf bank_mask:0xf
  s_nop 1
  v_min_u32_dpp v3, v2, v2 row_half_mirror row_mask:0xf bank_mask:0xf
  s_nop 1
  v_min_u32_dpp v2, v3, v3 quad_perm:[0,1,2,3] row_mask:0xf bank_mask:0xf
  s_nop 0
  v_readfirstlane_b32 s52, v2
  s_cmp_gt_u32 s52, s51
  s_cbranch_scc1 ka\sfx\()_x_wp_89_ok
  s_cmp_lt_u32 s45, 400000
  s_cbranch_scc1 ka\sfx\()_x_wp_89_spin
  s_branch ka\sfx\()_abort
ka\sfx\()_x_wp_89_ok:
  s_add_u32 s28, s50, s53
  buffer_load_dwordx2 v[88:89], v132, s[8:11], s28 offen offset:0 sc1
  buffer_load_dwordx2 v[92:93], v132, s[8:11], s28 offen offset:1024 sc1
  s_add_u32 s28, s50, s54
  buffer_load_dwordx2 v[90:91], v132, s[8:11], s28 offen offset:0 sc1
  buffer_load_dwordx2 v[94:95], v132, s[8:11], s28 offen offset:1024 sc1
  s_add_u32 s28, s50, s55
  buffer_load_dwordx2 v[96:97], v132, s[8:11], s28 offen offset:0 sc1
  buffer_load_dwordx2 v[98:99], v132, s[8:11], s28 offen offset:1024 sc1
  s_branch ka\sfx\()_x_w2l
ka\sfx\()_x_w3l:
  ds_read_b128 v[44:47], v129 offset:2048
  ds_read_b128 v[48:51], v129 offset:3072
  ds_read_b128 v[52:55], v129 offset:12288
  ds_read_b128 v[56:59], v129 offset:13312
  s_waitcnt lgkmcnt(0)
  s_mov_b32 s45, 0
ka\sfx\()_x_pf_90_pr:
  buffer_load_dword v139, v141, s[8:11], s48 offen sc1
  s_add_u32 s45, s45, 1
  s_waitcnt vmcnt(0)
  v_cmp_eq_u32 vcc, -1, v139
  s_cbranch_vccz ka\sfx\()_x_pf_90
  s_cmp_lt_u32 s45, 400000
  s_cbranch_scc1 ka\sfx\()_x_pf_90_pr
  s_branch ka\sfx\()_abort
ka\sfx\()_x_pf_90:
  buffer_load_dwordx4 v[112:115], v124, s[8:11], s48 offen sc1
  buffer_load_dwordx4 v[116:119], v125, s[8:11], s48 offen sc1
  s_add_u32 s45, s45, 1
  s_waitcnt vmcnt(1)
  ds_write_b128 v127, v[112:115] offset:0
  v_max3_u32 v139, v112, v113, v114
  v_max_u32 v139, v139, v115
  s_waitcnt vmcnt(0)
  ds_write_b128 v127, v[116:119] offset:4096
  v_max3_u32 v139, v139, v116, v117
  v_max3_u32 v139, v139, v118, v119
  v_cmp_eq_u32 vcc, -1, v139
  s_cbranch_vccz ka\sfx\()_x_pf_90_ok
  s_cmp_lt_u32 s45, 400000
  s_cbranch_scc1 ka\sfx\()_x_pf_90
  s_branch ka\sfx\()_abort
ka\sfx\()_x_pf_90_ok:
  v_smfmac_f32_16x16x64_bf16 v[60:63], v[112:115], a[24:31], v110
  v_smfmac_f32_16x16x64_bf16 v[64:67], v[112:115], v[44:51], v110
  ds_read_b128 v[44:47], v129 offset:22528
  v_smfmac_f32_16x16x64_bf16 v[68:71], v[112:115], a[104:111], v110
  ds_read_b128 v[48:51], v129 offset:23552
  v_smfmac_f32_16x16x64_bf16 v[72:75], v[112:115], v[52:59], v110
  ds_read_b128 v[52:55], v129 offset:6144
  s_waitcnt lgkmcnt(3)
  s_barrier
  v_smfmac_f32_16x16x64_bf16 v[36:39], v[112:115], a[184:191], v110
  ds_read_b128 v[56:59], v129 offset:7168
  ds_read_b128 v[4:7], v128 offset:0
  s_waitcnt lgkmcnt(3)
  v_smfmac_f32_16x16x64_bf16 v[40:43], v[112:115], v[44:51], v110
  ds_read_b128 v[44:47], v129 offset:16384
  ds_read_b128 v[8:11], v128 offset:1024
  v_smfmac_f32_16x16x64_bf16 v[60:63], v[116:119], a[56:63], v110
  ds_read_b128 v[48:51], v129 offset:17408
  ds_read_b128 v[12:15], v128 offset:2048
  s_waitcnt lgkmcnt(5)
  v_smfmac_f32_16x16x64_bf16 v[64:67], v[116:119], v[52:59], v110
  ds_read_b128 v[52:55], v129 offset:26624
  ds_read_b128 v[16:19], v128 offset:4096
  v_smfmac_f32_16x16x64_bf16 v[68:71], v[116:119], a[136:143], v110
  ds_read_b128 v[56:59], v129 offset:27648
  ds_read_b128 v[20:23], v128 offset:5120
  s_waitcnt lgkmcnt(5)
  v_smfmac_f32_16x16x64_bf16 v[72:75], v[116:119], v[44:51], v110
  ds_read_b128 v[44:47], v129 offset:0
  ds_read_b128 v[24:27], v128 offset:6144
  v_smfmac_f32_16x16x64_bf16 v[36:39], v[116:119], a[216:223], v110
  ds_read_b128 v[48:51], v129 offset:1024
  ds_read_b128 v[28:31], v128 offset:8192
  s_waitcnt lgkmcnt(5)
  v_smfmac_f32_16x16x64_bf16 v[40:43], v[116:119], v[52:59], v110
  ds_read_b128 v[52:55], v129 offset:4096
  ds_read_b128 v[32:35], v128 offset:9216
  v_smfmac_f32_16x16x64_bf16 v[60:63], v[4:7], a[0:7], v110
  ds_read_b128 v[56:59], v129 offset:5120
  v_smfmac_f32_16x16x64_bf16 v[64:67], v[4:7], a[240:247], v110
  v_smfmac_f32_16x16x64_bf16 v[60:63], v[8:11], a[8:15], v110
  s_waitcnt lgkmcnt(4)
  v_smfmac_f32_16x16x64_bf16 v[64:67], v[8:11], v[44:51], v110
  ds_read_b128 v[44:47], v129 offset:8192
  v_smfmac_f32_16x16x64_bf16 v[60:63], v[12:15], a[16:23], v110
  ds_read_b128 v[48:51], v129 offset:9216
  v_smfmac_f32_16x16x64_bf16 v[64:67], v[12:15], a[248:255], v110
  v_smfmac_f32_16x16x64_bf16 v[60:63], v[16:19], a[32:39], v110
  v_smfmac_f32_16x16x64_bf16 v[64:67], v[16:19], v[152:159], v110
  v_smfmac_f32_16x16x64_bf16 v[60:63], v[20:23], a[40:47], v110
  s_waitcnt lgkmcnt(2)
  v_smfmac_f32_16x16x64_bf16 v[64:67], v[20:23], v[52:59], v110
  ds_read_b128 v[52:55], v129 offset:10240
  v_smfmac_f32_16x16x64_bf16 v[60:63], v[24:27], a[48:55], v110
  ds_read_b128 v[56:59], v129 offset:11264
  v_smfmac_f32_16x16x64_bf16 v[64:67], v[24:27], v[160:167], v110
  v_smfmac_f32_16x16x64_bf16 v[60:63], v[28:31], a[64:71], v110
  v_smfmac_f32_16x16x64_bf16 v[64:67], v[28:31], v[168:175], v110
  v_smfmac_f32_16x16x64_bf16 v[60:63], v[32:35], a[72:79], v110
  s_waitcnt lgkmcnt(2)
  v_smfmac_f32_16x16x64_bf16 v[64:67], v[32:35], v[44:51], v110
  ds_read_b128 v[44:47], v129 offset:14336
  v_smfmac_f32_16x16x64_bf16 v[68:71], v[4:7], a[80:87], v110
  ds_read_b128 v[48:51], v129 offset:15360
  v_smfmac_f32_16x16x64_bf16 v[72:75], v[4:7], v[176:183], v110
  v_permlane32_swap_b32 v60, v64
  v_smfmac_f32_16x16x64_bf16 v[68:71], v[8:11], a[88:95], v110
  s_waitcnt lgkmcnt(2)
  v_smfmac_f32_16x16x64_bf16 v[72:75], v[8:11], v[52:59], v110
  ds_read_b128 v[52:55], v129 offset:18432
  v_permlane32_swap_b32 v61, v65
  v_smfmac_f32_16x16x64_bf16 v[68:71], v[12:15], a[96:103], v110
  ds_read_b128 v[56:59], v129 offset:19456
  v_smfmac_f32_16x16x64_bf16 v[72:75], v[12:15], v[184:191], v110
  v_permlane32_swap_b32 v62, v66
  v_smfmac_f32_16x16x64_bf16 v[68:71], v[16:19], a[112:119], v110
  v_permlane32_swap_b32 v63, v67
  v_smfmac_f32_16x16x64_bf16 v[72:75], v[16:19], v[192:199], v110
  v_add_f32 v60, v60, v64
  v_smfmac_f32_16x16x64_bf16 v[68:71], v[20:23], a[120:127], v110
  v_add_f32 v61, v61, v65
  s_waitcnt lgkmcnt(2)
  v_smfmac_f32_16x16x64_bf16 v[72:75], v[20:23], v[44:51], v110
  ds_read_b128 v[44:47], v129 offset:20480
  v_add_f32 v62, v62, v66
  v_smfmac_f32_16x16x64_bf16 v[68:71], v[24:27], a[128:135], v110
  ds_read_b128 v[48:51], v129 offset:21504
  v_add_f32 v63, v63, v67
  v_smfmac_f32_16x16x64_bf16 v[72:75], v[24:27], v[200:207], v110
  v_cvt_pk_bf16_f32 v100, v60, v61
  v_smfmac_f32_16x16x64_bf16 v[68:71], v[28:31], a[144:151], v110
  v_cvt_pk_bf16_f32 v101, v62, v63
  v_smfmac_f32_16x16x64_bf16 v[72:75], v[28:31], v[208:215], v110
  v_smfmac_f32_16x16x64_bf16 v[68:71], v[32:35], a[152:159], v110
  s_waitcnt lgkmcnt(2)
  v_smfmac_f32_16x16x64_bf16 v[72:75], v[32:35], v[52:59], v110
  ds_read_b128 v[52:55], v129 offset:24576
  v_smfmac_f32_16x16x64_bf16 v[36:39], v[4:7], a[160:167], v110
  ds_read_b128 v[56:59], v129 offset:25600
  v_smfmac_f32_16x16x64_bf16 v[40:43], v[4:7], v[216:223], v110
  v_permlane32_swap_b32 v68, v72
  v_smfmac_f32_16x16x64_bf16 v[36:39], v[8:11], a[168:175], v110
  s_waitcnt lgkmcnt(2)
  v_smfmac_f32_16x16x64_bf16 v[40:43], v[8:11], v[44:51], v110
  ds_read_b128 v[44:47], v129 offset:28672
  v_permlane32_swap_b32 v69, v73
  v_smfmac_f32_16x16x64_bf16 v[36:39], v[12:15], a[176:183], v110
  ds_read_b128 v[48:51], v129 offset:29696
  v_smfmac_f32_16x16x64_bf16 v[40:43], v[12:15], v[224:231], v110
  v_permlane32_swap_b32 v70, v74
  v_smfmac_f32_16x16x64_bf16 v[36:39], v[16:19], a[192:199], v110
  v_permlane32_swap_b32 v71, v75
  v_smfmac_f32_16x16x64_bf16 v[40:43], v[16:19], v[232:239], v110
  v_add_f32 v68, v68, v72
  v_smfmac_f32_16x16x64_bf16 v[36:39], v[20:23], a[200:207], v110
  v_add_f32 v69, v69, v73
  s_waitcnt lgkmcnt(2)
  v_smfmac_f32_16x16x64_bf16 v[40:43], v[20:23], v[52:59], v110
  v_add_f32 v70, v70, v74
  v_smfmac_f32_16x16x64_bf16 v[36:39], v[24:27], a[208:215], v110
  v_add_f32 v71, v71, v75
  v_smfmac_f32_16x16x64_bf16 v[40:43], v[24:27], v[240:247], v110
  v_cvt_pk_bf16_f32 v102, v68, v69
  v_smfmac_f32_16x16x64_bf16 v[36:39], v[28:31], a[224:231], v110
  v_cvt_pk_bf16_f32 v103, v70, v71
  v_smfmac_f32_16x16x64_bf16 v[40:43], v[28:31], v[248:255], v110
  v_smfmac_f32_16x16x64_bf16 v[36:39], v[32:35], a[232:239], v110
  s_waitcnt lgkmcnt(0)
  v_smfmac_f32_16x16x64_bf16 v[40:43], v[32:35], v[44:51], v110
  v_mfma_f32_16x16x16_bf16 v[142:145], v[100:101], v[108:109], 0
  v_mfma_f32_16x16x16_bf16 v[146:149], v[102:103], v[108:109], 0
  s_nop 1
  v_permlane32_swap_b32 v36, v40
  v_permlane32_swap_b32 v37, v41
  v_permlane32_swap_b32 v38, v42
  v_permlane32_swap_b32 v39, v43
  v_add_f32 v36, v36, v40
  v_add_f32 v37, v37, v41
  v_add_f32 v38, v38, v42
  v_add_f32 v39, v39, v43
  v_cvt_pk_bf16_f32 v104, v36, v37
  v_cvt_pk_bf16_f32 v105, v38, v39
  v_cvt_pk_bf16_f32 v44, v142, v143
  v_cvt_pk_bf16_f32 v45, v144, v145
  v_mfma_f32_16x16x16_bf16 v[142:145], v[104:105], v[108:109], 0
  v_cvt_pk_bf16_f32 v46, v146, v147
  v_cvt_pk_bf16_f32 v47, v148, v149
  s_nop 1
  v_mfma_f32_16x16x32_bf16 v[76:79], v[44:47], v[44:47], 0
  v_mfma_f32_16x16x32_bf16 v[80:83], v[88:91], v[44:47], 0
  v_cvt_pk_bf16_f32 v106, v142, v143
  v_cvt_pk_bf16_f32 v107, v144, v145
  v_mfma_f32_16x16x32_bf16 v[84:87], v[92:95], v[44:47], 0
  s_nop 0
  v_mfma_f32_16x16x16_bf16 v[76:79], v[106:107], v[106:107], v[76:79]
  v_mfma_f32_16x16x16_bf16 v[80:83], v[96:97], v[106:107], v[80:83]
  v_mfma_f32_16x16x16_bf16 v[84:87], v[98:99], v[106:107], v[84:87]
  s_mov_b32 exec_lo, 0
  s_mov_b32 exec_hi, 0x00ff00ff
  s_nop 3
  ds_write_b128 v130, v[76:79]
  s_mov_b32 exec_lo, 0x00ff00ff
  ds_write_b128 v130, v[80:83] offset:1024
  s_nop 0
  ds_write_b128 v130, v[84:87] offset:2048
  s_mov_b64 exec, -1
  s_waitcnt lgkmcnt(0)
  s_barrier
  ds_write_b64 v131, v[44:45]
  ds_write_b64 v131, v[46:47] offset:512
  ds_write_b64 v131, v[106:107] offset:1024
  ds_read_b128 v[44:47], v137 offset:0
  ds_read_b128 v[48:51], v137 offset:1024
  ds_read_b128 v[52:55], v137 offset:2048
  ds_read_b128 v[56:59], v137 offset:3072
  ds_read_b128 v[68:71], v137 offset:4096
  ds_read_b128 v[72:75], v137 offset:5120
  s_waitcnt lgkmcnt(0)
  s_barrier
  s_mov_b32 s28, s50
  buffer_load_dwordx4 v[4:7], v132, s[8:11], s28 offen sc1
  buffer_load_dwordx4 v[8:11], v132, s[8:11], s28 offen offset:1024 sc1
  s_add_u32 s28, s28, 2048
  buffer_load_dwordx4 v[12:15], v132, s[8:11], s28 offen sc1
  buffer_load_dwordx4 v[16:19], v132, s[8:11], s28 offen offset:1024 sc1
  s_add_u32 s28, s28, 2048
  buffer_load_dwordx4 v[20:23], v132, s[8:11], s28 offen sc1
  buffer_load_dwordx4 v[24:27], v132, s[8:11], s28 offen offset:1024 sc1
  s_add_u32 s28, s28, 2048
  buffer_load_dwordx4 v[28:31], v132, s[8:11], s28 offen sc1
  buffer_load_dwordx4 v[32:35], v132, s[8:11], s28 offen offset:1024 sc1
  s_add_u32 s28, s28, 2048
  buffer_load_dwordx4 v[36:39], v132, s[8:11], s28 offen sc1
  buffer_load_dwordx4 v[40:43], v132, s[8:11], s28 offen offset:1024 sc1
  s_add_u32 s28, s28, 2048
  buffer_load_dwordx4 v[60:63], v132, s[8:11], s28 offen sc1
  buffer_load_dwordx4 v[64:67], v132, s[8:11], s28 offen offset:1024 sc1
  s_add_u32 s28, s28, 2048
  ds_read_b64 v[76:77], v136 offset:0
  ds_read_b64 v[78:79], v136 offset:512
  ds_read_b64 v[80:81], v136 offset:1024
  ds_read_b64 v[82:83], v136 offset:1536
  ds_read_b64 v[84:85], v136 offset:2048
  ds_read_b64 v[86:87], v136 offset:2560
  ds_read_b64 v[88:89], v136 offset:3072
  ds_read_b64 v[90:91], v136 offset:3584
  ds_read_b64 v[92:93], v136 offset:4096
  ds_read_b64 v[94:95], v136 offset:4608
  ds_read_b64 v[96:97], v136 offset:5120
  ds_read_b64 v[98:99], v136 offset:5632
  s_waitcnt lgkmcnt(0)
  s_cmp_ge_u32 s51, 63
  s_cbranch_scc1 xq_91_\sfx\()
  s_add_u32 s96, s51, 1
  s_cmp_gt_u32 s52, s96
  s_cbranch_scc1 ka\sfx\()_x_wp_92_ok
  s_mov_b32 s45, 0
ka\sfx\()_x_wp_92_spin:
  buffer_load_dword v2, v138, s[8:11], 0 offen sc1
  s_add_u32 s45, s45, 1
  s_waitcnt vmcnt(0)
  v_min_u32_dpp v3, v2, v2 quad_perm:[1,0,3,2] row_mask:0xf bank_mask:0xf
  s_nop 1
  v_min_u32_dpp v2, v3, v3 quad_perm:[2,3,0,1] row_mask:0xf bank_mask:0xf
  s_nop 1
  v_min_u32_dpp v3, v2, v2 row_half_mirror row_mask:0xf bank_mask:0xf
  s_nop 1
  v_min_u32_dpp v2, v3, v3 quad_perm:[0,1,2,3] row_mask:0xf bank_mask:0xf
  s_nop 0
  v_readfirstlane_b32 s52, v2
  s_cmp_gt_u32 s52, s96
  s_cbranch_scc1 ka\sfx\()_x_wp_92_ok
  s_cmp_lt_u32 s45, 400000
  s_cbranch_scc1 ka\sfx\()_x_wp_92_spin
  s_branch ka\sfx\()_abort
ka\sfx\()_x_wp_92_ok:
  s_add_u32 s95, s63, s93
  s_add_u32 s95, s95, 12288
  s_add_u32 m0, s94, 0
  s_add_u32 s28, s95, 0
  buffer_load_dwordx4 v132, s[8:11], s28 offen sc1 lds
  s_add_u32 m0, s94, 1024
  s_add_u32 s28, s95, 2048
  buffer_load_dwordx4 v132, s[8:11], s28 offen sc1 lds
  s_add_u32 m0, s94, 2048
  s_add_u32 s28, s95, 4096
  buffer_load_dwordx4 v132, s[8:11], s28 offen sc1 lds
  s_add_u32 m0, s94, 3072
  s_add_u32 s28, s95, 6144
  buffer_load_dwordx4 v132, s[8:11], s28 offen sc1 lds
  s_add_u32 m0, s94, 4096
  s_add_u32 s28, s95, 8192
  buffer_load_dwordx4 v132, s[8:11], s28 offen sc1 lds
  s_add_u32 m0, s94, 5120
  s_add_u32 s28, s95, 10240
  buffer_load_dwordx4 v132, s[8:11], s28 offen sc1 lds
  s_branch xq_91_j_\sfx\()
xq_91_\sfx\():
  s_waitcnt vmcnt(0)
xq_91_j_\sfx\():
  s_waitcnt vmcnt(16)
  v_mfma_f32_16x16x32_bf16 v[112:115], v[76:79], v[44:47], 0
  v_mfma_f32_16x16x32_bf16 v[116:119], v[4:7], v[44:47], 0
  v_mfma_f32_16x16x32_bf16 v[120:123], v[8:11], v[44:47], 0
  s_waitcnt vmcnt(14)
  v_mfma_f32_16x16x32_bf16 v[112:115], v[80:83], v[48:51], v[112:115]
  v_mfma_f32_16x16x32_bf16 v[116:119], v[12:15], v[48:51], v[116:119]
  v_mfma_f32_16x16x32_bf16 v[120:123], v[16:19], v[48:51], v[120:123]
  s_waitcnt vmcnt(12)
  v_mfma_f32_16x16x32_bf16 v[112:115], v[84:87], v[52:55], v[112:115]
  v_mfma_f32_16x16x32_bf16 v[116:119], v[20:23], v[52:55], v[116:119]
  v_mfma_f32_16x16x32_bf16 v[120:123], v[24:27], v[52:55], v[120:123]
  s_waitcnt vmcnt(10)
  v_mfma_f32_16x16x32_bf16 v[112:115], v[88:91], v[56:59], v[112:115]
  v_mfma_f32_16x16x32_bf16 v[116:119], v[28:31], v[56:59], v[116:119]
  v_mfma_f32_16x16x32_bf16 v[120:123], v[32:35], v[56:59], v[120:123]
  s_waitcnt vmcnt(8)
  v_mfma_f32_16x16x32_bf16 v[112:115], v[92:95], v[68:71], v[112:115]
  v_mfma_f32_16x16x32_bf16 v[116:119], v[36:39], v[68:71], v[116:119]
  v_mfma_f32_16x16x32_bf16 v[120:123], v[40:43], v[68:71], v[120:123]
  s_waitcnt vmcnt(6)
  v_mfma_f32_16x16x32_bf16 v[112:115], v[96:99], v[72:75], v[112:115]
  v_mfma_f32_16x16x32_bf16 v[116:119], v[60:63], v[72:75], v[116:119]
  v_mfma_f32_16x16x32_bf16 v[120:123], v[64:67], v[72:75], v[120:123]
  s_nop 8
  v_cndmask_b32 v112, v135, v112, s[66:67]
  v_cndmask_b32 v113, v135, v113, s[66:67]
  v_cndmask_b32 v114, v135, v114, s[66:67]
  v_cndmask_b32 v115, v135, v115, s[66:67]
  v_cndmask_b32 v116, v135, v116, s[76:77]
  v_cndmask_b32 v120, v135, v120, s[84:85]
  v_cndmask_b32 v117, v135, v117, s[78:79]
  v_cndmask_b32 v121, v135, v121, s[86:87]
  v_cndmask_b32 v118, v135, v118, s[80:81]
  v_cndmask_b32 v122, v135, v122, s[88:89]
  v_cndmask_b32 v119, v135, v119, s[82:83]
  v_cndmask_b32 v123, v135, v123, s[90:91]
  v_max3_f32 v4, v112, v113, v114
  v_max3_f32 v5, v115, v116, v117
  v_max3_f32 v6, v118, v119, v120
  v_max3_f32 v7, v121, v122, v123
  v_max3_f32 v4, v4, v5, v6
  v_max_f32 v4, v4, v7
  v_mov_b32 v5, v4
  s_nop 1
  v_permlane16_swap_b32 v4, v5
  v_max_f32 v4, v4, v5
  v_mov_b32 v5, v4
  s_nop 1
  v_permlane32_swap_b32 v4, v5
  v_max_f32 v4, v4, v5
  v_mul_f32 v4, s64, v4
  v_fma_f32 v112, v112, s64, -v4
  v_fma_f32 v113, v113, s64, -v4
  v_fma_f32 v114, v114, s64, -v4
  v_fma_f32 v115, v115, s64, -v4
  v_fma_f32 v116, v116, s64, -v4
  v_fma_f32 v117, v117, s64, -v4
  v_fma_f32 v118, v118, s64, -v4
  v_fma_f32 v119, v119, s64, -v4
  v_fma_f32 v120, v120, s64, -v4
  v_fma_f32 v121, v121, s64, -v4
  v_fma_f32 v122, v122, s64, -v4
  v_fma_f32 v123, v123, s64, -v4
  v_exp_f32 v112, v112
  v_exp_f32 v113, v113
  v_exp_f32 v114, v114
  v_exp_f32 v115, v115
  v_exp_f32 v116, v116
  v_exp_f32 v117, v117
  v_exp_f32 v118, v118
  v_exp_f32 v119, v119
  v_exp_f32 v120, v120
  v_exp_f32 v121, v121
  v_exp_f32 v122, v122
  v_exp_f32 v123, v123
  v_add_f32 v5, v112, v113
  v_add_f32 v6, v114, v115
  v_add_f32 v7, v116, v117
  v_add_f32 v8, v118, v119
  v_add_f32 v9, v120, v121
  v_add_f32 v10, v122, v123
  v_add_f32 v5, v5, v6
  v_add_f32 v7, v7, v8
  v_add_f32 v9, v9, v10
  v_add_f32 v5, v5, v7
  v_add_f32 v5, v5, v9
  v_mov_b32 v6, v5
  s_nop 1
  v_permlane16_swap_b32 v5, v6
  v_add_f32 v5, v5, v6
  v_mov_b32 v6, v5
  s_nop 1
  v_permlane32_swap_b32 v5, v6
  v_add_f32 v5, v5, v6
  v_rcp_f32 v5, v5
  s_nop 0
  v_mul_f32 v112, v112, v5
  v_mul_f32 v113, v113, v5
  v_mul_f32 v114, v114, v5
  v_mul_f32 v115, v115, v5
  v_mul_f32 v116, v116, v5
  v_mul_f32 v117, v117, v5
  v_mul_f32 v118, v118, v5
  v_mul_f32 v119, v119, v5
  v_mul_f32 v120, v120, v5
  v_mul_f32 v121, v121, v5
  v_mul_f32 v122, v122, v5
  v_mul_f32 v123, v123, v5
  v_cvt_pk_bf16_f32 v8, v112, v113
  v_cvt_pk_bf16_f32 v9, v114, v115
  v_cvt_pk_bf16_f32 v10, v116, v117
  v_cvt_pk_bf16_f32 v11, v118, v119
  v_cvt_pk_bf16_f32 v12, v120, v121
  v_cvt_pk_bf16_f32 v13, v122, v123
  buffer_store_dwordx2 v[10:11], v133, s[8:11], s92 offen \pol
  buffer_store_dwordx2 v[12:13], v133, s[8:11], s92 offen offset:256 \pol
  buffer_store_dwordx2 v[8:9], v134, s[8:11], s92 offen \pol
  s_add_u32 s92, s92, 20480
  s_cmp_ge_u32 s51, 63
  s_cbranch_scc1 ka\sfx\()_x_done
  v_mov_b32 v60, 0
  v_mov_b32 v61, 0
  v_mov_b32 v62, 0
  v_mov_b32 v63, 0
  v_mov_b32 v64, 0
  v_mov_b32 v65, 0
  v_mov_b32 v66, 0
  v_mov_b32 v67, 0
  v_mov_b32 v68, 0
  v_mov_b32 v69, 0
  v_mov_b32 v70, 0
  v_mov_b32 v71, 0
  v_mov_b32 v72, 0
  v_mov_b32 v73, 0
  v_mov_b32 v74, 0
  v_mov_b32 v75, 0
  v_mov_b32 v36, 0
  v_mov_b32 v37, 0
  v_mov_b32 v38, 0
  v_mov_b32 v39, 0
  v_mov_b32 v40, 0
  v_mov_b32 v41, 0
  v_mov_b32 v42, 0
  v_mov_b32 v43, 0
  s_add_u32 s97, s97, 10240
  s_mov_b32 s48, s97
  s_add_u32 s49, s49, 5120
  s_add_u32 s98, s49, 5120
  s_add_u32 s50, s50, 12288
  s_add_u32 s63, s63, 12288
  s_add_u32 s51, s51, 1
  s_cmp_gt_u32 s52, s51
  s_cbranch_scc1 ka\sfx\()_x_wp_93_ok
  s_mov_b32 s45, 0
ka\sfx\()_x_wp_93_spin:
  buffer_load_dword v2, v138, s[8:11], 0 offen sc1
  s_add_u32 s45, s45, 1
  s_waitcnt vmcnt(0)
  v_min_u32_dpp v3, v2, v2 quad_perm:[1,0,3,2] row_mask:0xf bank_mask:0xf
  s_nop 1
  v_min_u32_dpp v2, v3, v3 quad_perm:[2,3,0,1] row_mask:0xf bank_mask:0xf
  s_nop 1
  v_min_u32_dpp v3, v2, v2 row_half_mirror row_mask:0xf bank_mask:0xf
  s_nop 1
  v_min_u32_dpp v2, v3, v3 quad_perm:[0,1,2,3] row_mask:0xf bank_mask:0xf
  s_nop 0
  v_readfirstlane_b32 s52, v2
  s_cmp_gt_u32 s52, s51
  s_cbranch_scc1 ka\sfx\()_x_wp_93_ok
  s_cmp_lt_u32 s45, 400000
  s_cbranch_scc1 ka\sfx\()_x_wp_93_spin
  s_branch ka\sfx\()_abort
ka\sfx\()_x_wp_93_ok:
  s_add_u32 s28, s50, s53
  buffer_load_dwordx2 v[88:89], v132, s[8:11], s28 offen offset:0 sc1
  buffer_load_dwordx2 v[92:93], v132, s[8:11], s28 offen offset:1024 sc1
  s_add_u32 s28, s50, s54
  buffer_load_dwordx2 v[90:91], v132, s[8:11], s28 offen offset:0 sc1
  buffer_load_dwordx2 v[94:95], v132, s[8:11], s28 offen offset:1024 sc1
  s_add_u32 s28, s50, s55
  buffer_load_dwordx2 v[96:97], v132, s[8:11], s28 offen offset:0 sc1
  buffer_load_dwordx2 v[98:99], v132, s[8:11], s28 offen offset:1024 sc1
  s_branch ka\sfx\()_x_w3l
ka\sfx\()_x_done:
  s_waitcnt vmcnt(0) lgkmcnt(0)
  s_branch ka\sfx\()_exit
ka\sfx\()_y:
  v_and_b32 v1, 63, v0
  v_lshlrev_b32 v178, 4, v1
  s_and_b32 s28, s21, 1
  s_lshl_b32 s46, s23, 1
  s_add_u32 s46, s46, s28
  s_lshr_b32 s28, s21, 1
  s_lshl_b32 s28, s28, 2
  s_lshl_b32 s47, s20, 3
  s_add_u32 s47, s47, s28
  s_mul_i32 s28, s47, 40
  s_add_u32 s28, s28, s46
  s_mul_i32 s28, s28, 20480
  s_add_u32 s28, s28, 0x2e00000
  s_add_u32 s29, s28, 0
  buffer_load_dwordx4 a[0:3], v178, s[8:11], s29 offen
  buffer_load_dwordx4 a[4:7], v178, s[8:11], s29 offen offset:1024
  s_add_u32 s29, s28, 2048
  buffer_load_dwordx4 a[8:11], v178, s[8:11], s29 offen
  buffer_load_dwordx4 a[12:15], v178, s[8:11], s29 offen offset:1024
  s_add_u32 s29, s28, 4096
  buffer_load_dwordx4 a[16:19], v178, s[8:11], s29 offen
  buffer_load_dwordx4 a[20:23], v178, s[8:11], s29 offen offset:1024
  s_add_u32 s29, s28, 6144
  buffer_load_dwordx4 a[24:27], v178, s[8:11], s29 offen
  buffer_load_dwordx4 a[28:31], v178, s[8:11], s29 offen offset:1024
  s_add_u32 s29, s28, 8192
  buffer_load_dwordx4 a[32:35], v178, s[8:11], s29 offen
  buffer_load_dwordx4 a[36:39], v178, s[8:11], s29 offen offset:1024
  s_add_u32 s29, s28, 10240
  buffer_load_dwordx4 a[40:43], v178, s[8:11], s29 offen
  buffer_load_dwordx4 a[44:47], v178, s[8:11], s29 offen offset:1024
  s_add_u32 s29, s28, 12288
  buffer_load_dwordx4 a[48:51], v178, s[8:11], s29 offen
  buffer_load_dwordx4 a[52:55], v178, s[8:11], s29 offen offset:1024
  s_add_u32 s29, s28, 14336
  buffer_load_dwordx4 a[56:59], v178, s[8:11], s29 offen
  buffer_load_dwordx4 a[60:63], v178, s[8:11], s29 offen offset:1024
  s_add_u32 s29, s28, 16384
  buffer_load_dwordx4 a[64:67], v178, s[8:11], s29 offen
  buffer_load_dwordx4 a[68:71], v178, s[8:11], s29 offen offset:1024
  s_add_u32 s29, s28, 18432
  buffer_load_dwordx4 a[72:75], v178, s[8:11], s29 offen
  buffer_load_dwordx4 a[76:79], v178, s[8:11], s29 offen offset:1024
  s_add_u32 s29, s28, 819200
  buffer_load_dwordx4 a[80:83], v178, s[8:11], s29 offen
  buffer_load_dwordx4 a[84:87], v178, s[8:11], s29 offen offset:1024
  s_add_u32 s29, s28, 821248
  buffer_load_dwordx4 a[88:91], v178, s[8:11], s29 offen
  buffer_load_dwordx4 a[92:95], v178, s[8:11], s29 offen offset:1024
  s_add_u32 s29, s28, 823296
  buffer_load_dwordx4 a[96:99], v178, s[8:11], s29 offen
  buffer_load_dwordx4 a[100:103], v178, s[8:11], s29 offen offset:1024
  s_add_u32 s29, s28, 825344
  buffer_load_dwordx4 a[104:107], v178, s[8:11], s29 offen
  buffer_load_dwordx4 a[108:111], v178, s[8:11], s29 offen offset:1024
  s_add_u32 s29, s28, 827392
  buffer_load_dwordx4 a[112:115], v178, s[8:11], s29 offen
  buffer_load_dwordx4 a[116:119], v178, s[8:11], s29 offen offset:1024
  s_add_u32 s29, s28, 829440
  buffer_load_dwordx4 a[120:123], v178, s[8:11], s29 offen
  buffer_load_dwordx4 a[124:127], v178, s[8:11], s29 offen offset:1024
  s_add_u32 s29, s28, 831488
  buffer_load_dwordx4 a[128:131], v178, s[8:11], s29 offen
  buffer_load_dwordx4 a[132:135], v178, s[8:11], s29 offen offset:1024
  s_add_u32 s29, s28, 833536
  buffer_load_dwordx4 a[136:139], v178, s[8:11], s29 offen
  buffer_load_dwordx4 a[140:143], v178, s[8:11], s29 offen offset:1024
  s_add_u32 s29, s28, 835584
  buffer_load_dwordx4 a[144:147], v178, s[8:11], s29 offen
  buffer_load_dwordx4 a[148:151], v178, s[8:11], s29 offen offset:1024
  s_add_u32 s29, s28, 837632
  buffer_load_dwordx4 a[152:155], v178, s[8:11], s29 offen
  buffer_load_dwordx4 a[156:159], v178, s[8:11], s29 offen offset:1024
  s_waitcnt vmcnt(30)
  s_cmp_eq_u32 s21, 3
  s_cbranch_scc0 lna_94_\sfx\()
  s_mov_b64 s[24:25], exec
  s_mov_b64 exec, 1
  s_and_b32 s45, s2, 7
  s_lshl_b32 s45, s45, 7
  s_add_u32 s45, s45, 10240
  v_mov_b32 v2, s45
  v_mov_b32 v3, 1
  buffer_atomic_add v3, v2, s[8:11], 0 offen
  s_mov_b64 exec, s[24:25]
lna_94_\sfx\():
  s_add_u32 s29, s28, 1638400
  buffer_load_dwordx4 a[160:163], v178, s[8:11], s29 offen
  buffer_load_dwordx4 a[164:167], v178, s[8:11], s29 offen offset:1024
  s_add_u32 s29, s28, 1640448
  buffer_load_dwordx4 a[168:171], v178, s[8:11], s29 offen
  buffer_load_dwordx4 a[172:175], v178, s[8:11], s29 offen offset:1024
  s_add_u32 s29, s28, 1642496
  buffer_load_dwordx4 a[176:179], v178, s[8:11], s29 offen
  buffer_load_dwordx4 a[180:183], v178, s[8:11], s29 offen offset:1024
  s_add_u32 s29, s28, 1644544
  buffer_load_dwordx4 a[184:187], v178, s[8:11], s29 offen
  buffer_load_dwordx4 a[188:191], v178, s[8:11], s29 offen offset:1024
  s_add_u32 s29, s28, 1646592
  buffer_load_dwordx4 a[192:195], v178, s[8:11], s29 offen
  buffer_load_dwordx4 a[196:199], v178, s[8:11], s29 offen offset:1024
  s_add_u32 s29, s28, 1648640
  buffer_load_dwordx4 a[200:203], v178, s[8:11], s29 offen
  buffer_load_dwordx4 a[204:207], v178, s[8:11], s29 offen offset:1024
  s_add_u32 s29, s28, 1650688
  buffer_load_dwordx4 a[208:211], v178, s[8:11], s29 offen
  buffer_load_dwordx4 a[212:215], v178, s[8:11], s29 offen offset:1024
  s_add_u32 s29, s28, 1652736
  buffer_load_dwordx4 a[216:219], v178, s[8:11], s29 offen
  buffer_load_dwordx4 a[220:223], v178, s[8:11], s29 offen offset:1024
  s_add_u32 s29, s28, 1654784
  buffer_load_dwordx4 a[224:227], v178, s[8:11], s29 offen
  buffer_load_dwordx4 a[228:231], v178, s[8:11], s29 offen offset:1024
  s_add_u32 s29, s28, 1656832
  buffer_load_dwordx4 a[232:235], v178, s[8:11], s29 offen
  buffer_load_dwordx4 a[236:239], v178, s[8:11], s29 offen offset:1024
  s_waitcnt vmcnt(30)
  s_add_u32 s29, s28, 2457600
  buffer_load_dwordx4 a[240:243], v178, s[8:11], s29 offen
  buffer_load_dwordx4 a[244:247], v178, s[8:11], s29 offen offset:1024
  s_add_u32 s29, s28, 2459648
  buffer_load_dwordx4 a[248:251], v178, s[8:11], s29 offen
  buffer_load_dwordx4 a[252:255], v178, s[8:11], s29 offen offset:1024
  s_add_u32 s29, s28, 2461696
  buffer_load_dwordx4 v[192:195], v178, s[8:11], s29 offen
  buffer_load_dwordx4 v[196:199], v178, s[8:11], s29 offen offset:1024
  s_add_u32 s29, s28, 2463744
  buffer_load_dwordx4 v[200:203], v178, s[8:11], s29 offen
  buffer_load_dwordx4 v[204:207], v178, s[8:11], s29 offen offset:1024
  s_add_u32 s29, s28, 2465792
  buffer_load_dwordx4 v[208:211], v178, s[8:11], s29 offen
  buffer_load_dwordx4 v[212:215], v178, s[8:11], s29 offen offset:1024
  s_add_u32 s29, s28, 2467840
  buffer_load_dwordx4 v[216:219], v178, s[8:11], s29 offen
  buffer_load_dwordx4 v[220:223], v178, s[8:11], s29 offen offset:1024
  s_add_u32 s29, s28, 2469888
  buffer_load_dwordx4 v[224:227], v178, s[8:11], s29 offen
  buffer_load_dwordx4 v[228:231], v178, s[8:11], s29 offen offset:1024
  s_add_u32 s29, s28, 2471936
  buffer_load_dwordx4 v[232:235], v178, s[8:11], s29 offen
  buffer_load_dwordx4 v[236:239], v178, s[8:11], s29 offen offset:1024
  s_add_u32 s29, s28, 2473984
  buffer_load_dwordx4 v[240:243], v178, s[8:11], s29 offen
  buffer_load_dwordx4 v[244:247], v178, s[8:11], s29 offen offset:1024
  s_add_u32 s29, s28, 2476032
  buffer_load_dwordx4 v[248:251], v178, s[8:11], s29 offen
  buffer_load_dwordx4 v[252:255], v178, s[8:11], s29 offen offset:1024
  s_waitcnt vmcnt(30)
  v_mov_b32 v172, 0x44444444
  v_mov_b32 v2, 0xeeeeeeee
  v_and_b32 v3, 8, v1
  v_cmp_ne_u32 vcc, 0, v3
  s_nop 1
  v_cndmask_b32 v172, v172, v2, vcc
  s_lshl_b32 s28, s21, 10
  v_add_u32 v173, s28, v178
  v_add_u32 v174, 4096, v173
  v_add_u32 v175, 8192, v173
  v_add_u32 v176, 0, v173
  v_add_u32 v177, 0, v178
  v_add_u32 v179, 10240, v173
  s_xor_b32 s28, s21, 2
  s_lshl_b32 s28, s28, 10
  s_add_u32 s28, s28, 10240
  v_add_u32 v180, s28, v178
  v_and_b32 v4, 15, v1
  v_lshrrev_b32 v5, 4, v1
  v_and_b32 v6, 7, v1
  v_lshlrev_b32 v7, 3, v5
  v_add_u32 v7, v7, v6
  v_lshlrev_b32 v185, 4, v7
  v_add_u32 v182, 4096, v178
  v_mov_b32 v8, 0x40000000
  v_cmp_gt_u32 vcc, 8, v4
  s_nop 1
  v_cndmask_b32 v184, v8, v185, vcc
  v_lshlrev_b32 v7, 4, v4
  v_lshlrev_b32 v9, 2, v5
  v_add_u32 v7, v7, v9
  v_cndmask_b32 v186, v8, v7, vcc
  s_lshl_b32 s28, s20, 5
  s_add_u32 s28, s28, 3072
  v_lshlrev_b32 v7, 2, v6
  v_add_u32 v187, s28, v7
  v_and_b32 v7, 1, v5
  v_lshlrev_b32 v7, 3, v7
  v_lshrrev_b32 v9, 1, v5
  v_lshlrev_b32 v9, 5, v9
  v_add_u32 v9, v9, v4
  v_lshlrev_b32 v9, 4, v9
  v_add_u32 v189, v7, v9
  v_mov_b32 v44, 0
  v_mov_b32 v45, 0
  v_mov_b32 v46, 0
  v_mov_b32 v47, 0
  v_mov_b32 v48, 0
  v_mov_b32 v49, 0
  v_mov_b32 v50, 0
  v_mov_b32 v51, 0
  v_mov_b32 v52, 0
  v_mov_b32 v53, 0
  v_mov_b32 v54, 0
  v_mov_b32 v55, 0
  v_mov_b32 v56, 0
  v_mov_b32 v57, 0
  v_mov_b32 v58, 0
  v_mov_b32 v59, 0
  s_mul_i32 s97, s20, 655360
  s_add_u32 s97, s97, 0x400000
  s_mov_b32 s48, 0x4000
  s_mul_i32 s49, s20, 327680
  s_add_u32 s49, s49, 0x700000
  s_and_b32 s28, s21, 1
  s_mul_i32 s28, s28, 0
  s_add_u32 s49, s49, s28
  s_mul_i32 s50, s20, 327680
  s_lshl_b32 s28, s46, 10
  s_add_u32 s50, s50, s28
  s_add_u32 s50, s50, 0x9000000
  s_mov_b32 s51, 0
  s_mov_b32 s52, 0
  s_mov_b32 s53, 0
  s_mov_b32 s61, 0
  s_add_u32 s29, s20, 0
  s_and_b32 s29, s29, 3
  s_mul_i32 s29, s29, 20
  s_add_u32 s29, s29, s23
  s_lshr_b32 s28, s29, 3
  s_lshl_b32 s28, s28, 14
  s_and_b32 s29, s29, 7
  s_lshl_b32 s29, s29, 10
  s_add_u32 s28, s28, s29
  s_and_b32 s29, s21, 1
  s_lshl_b32 s29, s29, 9
  s_add_u32 s28, s28, s29
  s_add_u32 s28, s28, s61
  s_add_u32 s56, s28, 0xa00000
  s_mov_b32 s66, s56
  s_add_u32 s29, s20, 1
  s_and_b32 s29, s29, 3
  s_mul_i32 s29, s29, 20
  s_add_u32 s29, s29, s23
  s_lshr_b32 s28, s29, 3
  s_lshl_b32 s28, s28, 14
  s_and_b32 s29, s29, 7
  s_lshl_b32 s29, s29, 10
  s_add_u32 s28, s28, s29
  s_and_b32 s29, s21, 1
  s_lshl_b32 s29, s29, 9
  s_add_u32 s28, s28, s29
  s_add_u32 s28, s28, s61
  s_add_u32 s57, s28, 0xa00000
  s_mov_b32 s67, s57
  s_add_u32 s29, s20, 2
  s_and_b32 s29, s29, 3
  s_mul_i32 s29, s29, 20
  s_add_u32 s29, s29, s23
  s_lshr_b32 s28, s29, 3
  s_lshl_b32 s28, s28, 14
  s_and_b32 s29, s29, 7
  s_lshl_b32 s29, s29, 10
  s_add_u32 s28, s28, s29
  s_and_b32 s29, s21, 1
  s_lshl_b32 s29, s29, 9
  s_add_u32 s28, s28, s29
  s_add_u32 s28, s28, s61
  s_add_u32 s58, s28, 0xa00000
  s_mov_b32 s68, s58
  s_add_u32 s29, s20, 3
  s_and_b32 s29, s29, 3
  s_mul_i32 s29, s29, 20
  s_add_u32 s29, s29, s23
  s_lshr_b32 s28, s29, 3
  s_lshl_b32 s28, s28, 14
  s_and_b32 s29, s29, 7
  s_lshl_b32 s29, s29, 10
  s_add_u32 s28, s28, s29
  s_and_b32 s29, s21, 1
  s_lshl_b32 s29, s29, 9
  s_add_u32 s28, s28, s29
  s_add_u32 s28, s28, s61
  s_add_u32 s59, s28, 0xa00000
  s_mov_b32 s69, s59
  v_mov_b32 v124, -1
  v_mov_b32 v125, -1
  v_mov_b32 v126, -1
  v_mov_b32 v127, -1
  s_lshr_b32 s28, s46, 2
  s_lshl_b32 s28, s28, 10
  s_and_b32 s29, s46, 3
  s_lshl_b32 s29, s29, 8
  s_add_u32 s28, s28, s29
  s_add_u32 s60, s28, s97
  s_add_u32 s60, s60, 10240
  s_and_b32 s28, s21, 1
  s_lshl_b32 s28, s28, 10
  s_add_u32 s28, s28, 32768
  v_add_u32 v181, s28, v178
  v_add_u32 v183, 65536, v178
  s_waitcnt vmcnt(0)
  s_cmp_ge_u32 s21, 2
  s_cbranch_scc1 ka\sfx\()_y_tok
ka\sfx\()_y_crit:
  s_add_u32 s98, s48, 4096
  s_add_u32 s100, s48, 8192
  s_mov_b32 s45, 0
ka\sfx\()_y_pf_95:
  buffer_load_dwordx4 v[160:163], v173, s[8:11], s48 offen sc1
  buffer_load_dwordx4 v[164:167], v173, s[8:11], s48 offen offset:2048 sc1
  buffer_load_dwordx4 v[168:171], v173, s[8:11], s98 offen sc1
  buffer_load_dwordx4 v[68:71], v173, s[8:11], s98 offen offset:2048 sc1
  buffer_load_dwordx4 v[72:75], v173, s[8:11], s100 offen sc1
  s_add_u32 s45, s45, 1
  s_waitcnt vmcnt(4)
  ds_write_b128 v176, v[160:163] offset:0
  v_max3_u32 v190, v160, v161, v162
  v_max_u32 v190, v190, v163
  s_waitcnt vmcnt(3)
  ds_write_b128 v176, v[164:167] offset:2048
  v_max3_u32 v190, v190, v164, v165
  v_max3_u32 v190, v190, v166, v167
  s_waitcnt vmcnt(2)
  ds_write_b128 v176, v[168:171] offset:4096
  v_max3_u32 v190, v190, v168, v169
  v_max3_u32 v190, v190, v170, v171
  s_waitcnt vmcnt(1)
  ds_write_b128 v176, v[68:71] offset:6144
  v_max3_u32 v190, v190, v68, v69
  v_max3_u32 v190, v190, v70, v71
  s_waitcnt vmcnt(0)
  ds_write_b128 v176, v[72:75] offset:8192
  v_max3_u32 v190, v190, v72, v73
  v_max3_u32 v190, v190, v74, v75
  v_cmp_eq_u32 vcc, -1, v190
  s_cbranch_vccz ka\sfx\()_y_pf_95_ok
  s_cmp_lt_u32 s45, 400000
  s_cbranch_scc1 ka\sfx\()_y_pf_95
  s_branch ka\sfx\()_abort
ka\sfx\()_y_pf_95_ok:
  s_waitcnt lgkmcnt(0)
  s_barrier
  ds_read_b128 v[4:7], v177 offset:0
  ds_read_b128 v[8:11], v177 offset:1024
  ds_read_b128 v[12:15], v177 offset:2048
  ds_read_b128 v[16:19], v177 offset:3072
  ds_read_b128 v[20:23], v177 offset:4096
  ds_read_b128 v[24:27], v177 offset:5120
  ds_read_b128 v[28:31], v177 offset:6144
  ds_read_b128 v[32:35], v177 offset:7168
  ds_read_b128 v[36:39], v177 offset:8192
  ds_read_b128 v[40:43], v177 offset:9216
  s_cmp_eq_u32 s51, 7
  s_cbranch_scc0 ka\sfx\()_y_nosel
  v_mov_b32 v2, 5056
  s_mov_b32 s45, 0
ka\sfx\()_y_sel:
  buffer_load_dword v3, v2, s[8:11], 0 offen sc1
  s_add_u32 s45, s45, 1
  s_waitcnt vmcnt(0)
  v_readfirstlane_b32 s61, v3
  s_cmp_lg_u32 s61, 0
  s_cbranch_scc1 ka\sfx\()_y_selok
  s_cmp_lt_u32 s45, 400000
  s_cbranch_scc1 ka\sfx\()_y_sel
  s_branch ka\sfx\()_abort
ka\sfx\()_y_selok:
  s_and_b32 s61, s61, 2
  s_lshl_b32 s61, s61, 12
ka\sfx\()_y_nosel:
  s_cmp_lt_u32 s51, 2
  s_cbranch_scc1 ka\sfx\()_y_norst
  s_sub_u32 s28, s51, 2
  s_and_b32 s28, s28, 3
  s_mul_i32 s28, s28, 163840
  s_add_u32 s28, s28, s56
  v_mov_b32 v160, -1
  v_mov_b32 v161, -1
  v_mov_b32 v162, -1
  v_mov_b32 v163, -1
  buffer_store_dwordx4 v[160:163], v184, s[8:11], s28 offen sc1
ka\sfx\()_y_norst:
  s_waitcnt lgkmcnt(9)
  v_smfmac_f32_16x16x64_bf16 v[44:47], v[4:7], a[0:7], v172
  v_smfmac_f32_16x16x64_bf16 v[48:51], v[4:7], a[80:87], v172
  v_smfmac_f32_16x16x64_bf16 v[52:55], v[4:7], a[160:167], v172
  v_smfmac_f32_16x16x64_bf16 v[56:59], v[4:7], a[240:247], v172
  s_waitcnt lgkmcnt(8)
  v_smfmac_f32_16x16x64_bf16 v[44:47], v[8:11], a[8:15], v172
  v_smfmac_f32_16x16x64_bf16 v[48:51], v[8:11], a[88:95], v172
  v_smfmac_f32_16x16x64_bf16 v[52:55], v[8:11], a[168:175], v172
  v_smfmac_f32_16x16x64_bf16 v[56:59], v[8:11], a[248:255], v172
  s_waitcnt lgkmcnt(7)
  v_smfmac_f32_16x16x64_bf16 v[44:47], v[12:15], a[16:23], v172
  v_smfmac_f32_16x16x64_bf16 v[48:51], v[12:15], a[96:103], v172
  v_smfmac_f32_16x16x64_bf16 v[52:55], v[12:15], a[176:183], v172
  v_smfmac_f32_16x16x64_bf16 v[56:59], v[12:15], v[192:199], v172
  s_waitcnt lgkmcnt(6)
  v_smfmac_f32_16x16x64_bf16 v[44:47], v[16:19], a[24:31], v172
  v_smfmac_f32_16x16x64_bf16 v[48:51], v[16:19], a[104:111], v172
  v_smfmac_f32_16x16x64_bf16 v[52:55], v[16:19], a[184:191], v172
  v_smfmac_f32_16x16x64_bf16 v[56:59], v[16:19], v[200:207], v172
  s_waitcnt lgkmcnt(5)
  v_smfmac_f32_16x16x64_bf16 v[44:47], v[20:23], a[32:39], v172
  v_smfmac_f32_16x16x64_bf16 v[48:51], v[20:23], a[112:119], v172
  v_smfmac_f32_16x16x64_bf16 v[52:55], v[20:23], a[192:199], v172
  v_smfmac_f32_16x16x64_bf16 v[56:59], v[20:23], v[208:215], v172
  s_waitcnt lgkmcnt(4)
  v_smfmac_f32_16x16x64_bf16 v[44:47], v[24:27], a[40:47], v172
  v_smfmac_f32_16x16x64_bf16 v[48:51], v[24:27], a[120:127], v172
  v_smfmac_f32_16x16x64_bf16 v[52:55], v[24:27], a[200:207], v172
  v_smfmac_f32_16x16x64_bf16 v[56:59], v[24:27], v[216:223], v172
  s_waitcnt lgkmcnt(3)
  v_smfmac_f32_16x16x64_bf16 v[44:47], v[28:31], a[48:55], v172
  v_smfmac_f32_16x16x64_bf16 v[48:51], v[28:31], a[128:135], v172
  v_smfmac_f32_16x16x64_bf16 v[52:55], v[28:31], a[208:215], v172
  v_smfmac_f32_16x16x64_bf16 v[56:59], v[28:31], v[224:231], v172
  s_waitcnt lgkmcnt(2)
  v_smfmac_f32_16x16x64_bf16 v[44:47], v[32:35], a[56:63], v172
  v_smfmac_f32_16x16x64_bf16 v[48:51], v[32:35], a[136:143], v172
  v_smfmac_f32_16x16x64_bf16 v[52:55], v[32:35], a[216:223], v172
  v_smfmac_f32_16x16x64_bf16 v[56:59], v[32:35], v[232:239], v172
  s_waitcnt lgkmcnt(1)
  v_smfmac_f32_16x16x64_bf16 v[44:47], v[36:39], a[64:71], v172
  v_smfmac_f32_16x16x64_bf16 v[48:51], v[36:39], a[144:151], v172
  v_smfmac_f32_16x16x64_bf16 v[52:55], v[36:39], a[224:231], v172
  v_smfmac_f32_16x16x64_bf16 v[56:59], v[36:39], v[240:247], v172
  s_waitcnt lgkmcnt(0)
  v_smfmac_f32_16x16x64_bf16 v[44:47], v[40:43], a[72:79], v172
  v_smfmac_f32_16x16x64_bf16 v[48:51], v[40:43], a[152:159], v172
  v_smfmac_f32_16x16x64_bf16 v[52:55], v[40:43], a[232:239], v172
  v_smfmac_f32_16x16x64_bf16 v[56:59], v[40:43], v[248:255], v172
  s_nop 9
  v_permlane32_swap_b32 v44, v48
  v_permlane32_swap_b32 v45, v49
  v_permlane32_swap_b32 v46, v50
  v_permlane32_swap_b32 v47, v51
  v_permlane32_swap_b32 v52, v56
  v_permlane32_swap_b32 v53, v57
  v_permlane32_swap_b32 v54, v58
  v_permlane32_swap_b32 v55, v59
  v_add_f32 v44, v44, v48
  v_add_f32 v45, v45, v49
  v_add_f32 v46, v46, v50
  v_add_f32 v47, v47, v51
  v_add_f32 v52, v52, v56
  v_add_f32 v53, v53, v57
  v_add_f32 v54, v54, v58
  v_add_f32 v55, v55, v59
  v_cvt_pk_bf16_f32 v60, v44, v45
  v_cvt_pk_bf16_f32 v61, v46, v47
  v_cvt_pk_bf16_f32 v62, v52, v53
  v_cvt_pk_bf16_f32 v63, v54, v55
  ds_write_b128 v179, v[60:63]
  v_mov_b32 v44, 0
  v_mov_b32 v45, 0
  v_mov_b32 v46, 0
  v_mov_b32 v47, 0
  v_mov_b32 v48, 0
  v_mov_b32 v49, 0
  v_mov_b32 v50, 0
  v_mov_b32 v51, 0
  v_mov_b32 v52, 0
  v_mov_b32 v53, 0
  v_mov_b32 v54, 0
  v_mov_b32 v55, 0
  v_mov_b32 v56, 0
  v_mov_b32 v57, 0
  v_mov_b32 v58, 0
  v_mov_b32 v59, 0
  s_waitcnt lgkmcnt(0)
  s_barrier
  s_cmp_ge_u32 s51, 63
  s_cbranch_scc1 ka\sfx\()_y_crit_end
  ds_read_b128 v[64:67], v180
  ds_read_b128 v[68:71], v181 offset:0
  ds_read_b128 v[72:75], v181 offset:2048
  ds_read_b128 v[76:79], v181 offset:4096
  ds_read_b128 v[80:83], v181 offset:6144
  ds_read_b128 v[84:87], v181 offset:8192
  ds_read_b128 v[88:91], v181 offset:10240
  ds_read_b128 v[92:95], v181 offset:12288
  ds_read_b128 v[96:99], v181 offset:14336
  v_xor_b32 v181, 0x4000, v181
  s_mov_b32 s45, 0
  buffer_load_dwordx4 v[100:103], v178, s[8:11], s49 offen offset:0 sc1
  buffer_load_dwordx4 v[104:107], v178, s[8:11], s49 offen offset:1024 sc1
  buffer_load_dwordx4 v[108:111], v178, s[8:11], s49 offen offset:2048 sc1
  buffer_load_dwordx4 v[112:115], v178, s[8:11], s49 offen offset:3072 sc1
  buffer_load_dwordx4 v[116:119], v182, s[8:11], s49 offen sc1
yp_96_\sfx\():
  buffer_load_dwordx4 v[120:123], v178, s[8:11], s49 offen offset:0 sc1
  buffer_load_dwordx4 v[124:127], v178, s[8:11], s49 offen offset:1024 sc1
  buffer_load_dwordx4 v[128:131], v178, s[8:11], s49 offen offset:2048 sc1
  buffer_load_dwordx4 v[132:135], v178, s[8:11], s49 offen offset:3072 sc1
  buffer_load_dwordx4 v[136:139], v182, s[8:11], s49 offen sc1
  s_waitcnt vmcnt(9) lgkmcnt(0)
  v_mfma_f32_16x16x32_bf16 v[140:143], v[68:71], v[100:103], 0
  v_max_u32 v190, v100, v102
  v_mfma_f32_16x16x32_bf16 v[144:147], v[72:75], v[100:103], 0
  s_waitcnt vmcnt(8)
  v_mfma_f32_16x16x32_bf16 v[140:143], v[76:79], v[104:107], v[140:143]
  v_max3_u32 v190, v190, v104, v106
  v_mfma_f32_16x16x32_bf16 v[144:147], v[80:83], v[104:107], v[144:147]
  s_waitcnt vmcnt(7)
  v_mfma_f32_16x16x32_bf16 v[140:143], v[84:87], v[108:111], v[140:143]
  v_max3_u32 v190, v190, v108, v110
  v_mfma_f32_16x16x32_bf16 v[144:147], v[88:91], v[108:111], v[144:147]
  s_waitcnt vmcnt(6)
  v_mfma_f32_16x16x32_bf16 v[140:143], v[92:95], v[112:115], v[140:143]
  v_max3_u32 v190, v190, v112, v114
  v_mfma_f32_16x16x32_bf16 v[144:147], v[96:99], v[112:115], v[144:147]
  s_waitcnt vmcnt(5)
  v_mfma_f32_16x16x32_bf16 v[140:143], v[60:63], v[116:119], v[140:143]
  v_max3_u32 v190, v190, v116, v117
  v_mfma_f32_16x16x32_bf16 v[144:147], v[64:67], v[116:119], v[144:147]
  v_max3_u32 v190, v190, v118, v119
  v_cmp_eq_u32 vcc, -1, v190
  s_cbranch_vccz yp_96_okA_\sfx\()
  buffer_load_dwordx4 v[100:103], v178, s[8:11], s49 offen offset:0 sc1
  buffer_load_dwordx4 v[104:107], v178, s[8:11], s49 offen offset:1024 sc1
  buffer_load_dwordx4 v[108:111], v178, s[8:11], s49 offen offset:2048 sc1
  buffer_load_dwordx4 v[112:115], v178, s[8:11], s49 offen offset:3072 sc1
  buffer_load_dwordx4 v[116:119], v182, s[8:11], s49 offen sc1
  s_waitcnt vmcnt(9) lgkmcnt(0)
  v_mfma_f32_16x16x32_bf16 v[148:151], v[68:71], v[120:123], 0
  v_max_u32 v190, v120, v122
  v_mfma_f32_16x16x32_bf16 v[152:155], v[72:75], v[120:123], 0
  s_waitcnt vmcnt(8)
  v_mfma_f32_16x16x32_bf16 v[148:151], v[76:79], v[124:127], v[148:151]
  v_max3_u32 v190, v190, v124, v126
  v_mfma_f32_16x16x32_bf16 v[152:155], v[80:83], v[124:127], v[152:155]
  s_waitcnt vmcnt(7)
  v_mfma_f32_16x16x32_bf16 v[148:151], v[84:87], v[128:131], v[148:151]
  v_max3_u32 v190, v190, v128, v130
  v_mfma_f32_16x16x32_bf16 v[152:155], v[88:91], v[128:131], v[152:155]
  s_waitcnt vmcnt(6)
  v_mfma_f32_16x16x32_bf16 v[148:151], v[92:95], v[132:135], v[148:151]
  v_max3_u32 v190, v190, v132, v134
  v_mfma_f32_16x16x32_bf16 v[152:155], v[96:99], v[132:135], v[152:155]
  s_waitcnt vmcnt(5)
  v_mfma_f32_16x16x32_bf16 v[148:151], v[60:63], v[136:139], v[148:151]
  v_max3_u32 v190, v190, v136, v137
  v_mfma_f32_16x16x32_bf16 v[152:155], v[64:67], v[136:139], v[152:155]
  v_max3_u32 v190, v190, v138, v139
  v_cmp_eq_u32 vcc, -1, v190
  s_cbranch_vccz yp_96_okB_\sfx\()
  s_add_u32 s45, s45, 1
  s_cmp_lt_u32 s45, 400000
  s_cbranch_scc1 yp_96_c_\sfx\()
  s_branch ka\sfx\()_abort
yp_96_c_\sfx\():
  s_branch yp_96_\sfx\()
yp_96_okB_\sfx\():
  s_nop 4
  v_add_f32_dpp v140, v152, v148 row_ror:8 row_mask:0xf bank_mask:0xf
  v_add_f32_dpp v141, v153, v149 row_ror:8 row_mask:0xf bank_mask:0xf
  v_add_f32_dpp v142, v154, v150 row_ror:8 row_mask:0xf bank_mask:0xf
  v_add_f32_dpp v143, v155, v151 row_ror:8 row_mask:0xf bank_mask:0xf
  s_branch yp_96_j_\sfx\()
yp_96_okA_\sfx\():
  s_nop 4
  v_add_f32_dpp v140, v144, v140 row_ror:8 row_mask:0xf bank_mask:0xf
  v_add_f32_dpp v141, v145, v141 row_ror:8 row_mask:0xf bank_mask:0xf
  v_add_f32_dpp v142, v146, v142 row_ror:8 row_mask:0xf bank_mask:0xf
  v_add_f32_dpp v143, v147, v143 row_ror:8 row_mask:0xf bank_mask:0xf
yp_96_j_\sfx\():
  buffer_load_dwordx4 v[4:7], v185, s[8:11], s67 offen sc1
  buffer_load_dwordx4 v[8:11], v185, s[8:11], s68 offen sc1
  buffer_load_dwordx4 v[12:15], v185, s[8:11], s69 offen sc1
  buffer_store_dwordx4 v[140:143], v184, s[8:11], s66 offen sc1
  s_mov_b32 s45, 0
  buffer_load_dwordx4 v[148:151], v185, s[8:11], s67 offen sc1
  buffer_load_dwordx4 v[152:155], v185, s[8:11], s68 offen sc1
  buffer_load_dwordx4 v[156:159], v185, s[8:11], s69 offen sc1
  s_waitcnt vmcnt(4)
  v_max3_u32 v190, v4, v7, v8
  v_max3_u32 v190, v190, v11, v12
  v_max_u32 v190, v190, v15
  v_add_f32 v160, v140, v4
  v_add_f32 v161, v141, v5
  v_add_f32 v162, v142, v6
  v_add_f32 v163, v143, v7
  v_cmp_eq_u32 vcc, -1, v190
  v_add_f32 v164, v8, v12
  v_add_f32 v165, v9, v13
  v_add_f32 v166, v10, v14
  v_add_f32 v167, v11, v15
  s_cbranch_vccz yc_97_ok_\sfx\()
yc_97_\sfx\():
  buffer_load_dwordx4 v[4:7], v185, s[8:11], s67 offen sc1
  buffer_load_dwordx4 v[8:11], v185, s[8:11], s68 offen sc1
  buffer_load_dwordx4 v[12:15], v185, s[8:11], s69 offen sc1
  s_waitcnt vmcnt(3)
  v_max3_u32 v190, v148, v151, v152
  v_max3_u32 v190, v190, v155, v156
  v_max_u32 v190, v190, v159
  v_add_f32 v160, v140, v148
  v_add_f32 v161, v141, v149
  v_add_f32 v162, v142, v150
  v_add_f32 v163, v143, v151
  v_cmp_eq_u32 vcc, -1, v190
  v_add_f32 v164, v152, v156
  v_add_f32 v165, v153, v157
  v_add_f32 v166, v154, v158
  v_add_f32 v167, v155, v159
  s_cbranch_vccz yc_97_ok_\sfx\()
  buffer_load_dwordx4 v[148:151], v185, s[8:11], s67 offen sc1
  buffer_load_dwordx4 v[152:155], v185, s[8:11], s68 offen sc1
  buffer_load_dwordx4 v[156:159], v185, s[8:11], s69 offen sc1
  s_waitcnt vmcnt(3)
  v_max3_u32 v190, v4, v7, v8
  v_max3_u32 v190, v190, v11, v12
  v_max_u32 v190, v190, v15
  v_add_f32 v160, v140, v4
  v_add_f32 v161, v141, v5
  v_add_f32 v162, v142, v6
  v_add_f32 v163, v143, v7
  v_cmp_eq_u32 vcc, -1, v190
  v_add_f32 v164, v8, v12
  v_add_f32 v165, v9, v13
  v_add_f32 v166, v10, v14
  v_add_f32 v167, v11, v15
  s_cbranch_vccz yc_97_ok_\sfx\()
  s_add_u32 s45, s45, 1
  s_cmp_lt_u32 s45, 400000
  s_cbranch_scc1 yc_97_\sfx\()
  s_branch ka\sfx\()_abort
yc_97_ok_\sfx\():
  v_add_f32 v160, v160, v164
  v_add_f32 v161, v161, v165
  v_add_f32 v162, v162, v166
  v_add_f32 v163, v163, v167
  v_cvt_pk_bf16_f32 v168, v160, v161
  v_cvt_pk_bf16_f32 v169, v162, v163
  buffer_store_dword v168, v186, s[8:11], s60 offen \pol
  buffer_store_dword v169, v186, s[8:11], s60 offen offset:128 \pol
  s_add_u32 s97, s97, 10240
  s_mov_b32 s48, s97
  s_add_u32 s60, s60, 10240
  s_add_u32 s49, s49, 5120
  s_add_u32 s56, s56, s61
  s_add_u32 s57, s57, s61
  s_add_u32 s58, s58, s61
  s_add_u32 s59, s59, s61
  s_mov_b32 s61, 0
  s_add_u32 s28, s51, 1
  s_and_b32 s28, s28, 3
  s_mul_i32 s28, s28, 163840
  s_add_u32 s66, s56, s28
  s_add_u32 s67, s57, s28
  s_add_u32 s68, s58, s28
  s_add_u32 s69, s59, s28
  s_add_u32 s51, s51, 1
  s_branch ka\sfx\()_y_crit
ka\sfx\()_y_crit_end:
  s_waitcnt vmcnt(0) lgkmcnt(0)
  s_branch ka\sfx\()_exit
ka\sfx\()_y_tok:
  s_mul_i32 s61, s20, 1310720
  s_add_u32 s61, s61, 0xe00000
  s_mul_i32 s62, s20, 2621440
  s_lshl_b32 s28, s46, 10
  s_add_u32 s62, s62, s28
  s_add_u32 s62, s62, 0x1a00000
  s_mov_b32 s54, 0
  s_and_b32 s63, s21, 1
  s_lshl_b32 s63, s63, 10
  s_add_u32 s63, s63, 32768
  s_and_b32 s64, s21, 1
  s_mul_i32 s64, s64, 10240
ka\sfx\()_y_tokl:
  s_barrier
  ds_read_b128 v[4:7], v177 offset:0
  ds_read_b128 v[8:11], v177 offset:1024
  ds_read_b128 v[12:15], v177 offset:2048
  ds_read_b128 v[16:19], v177 offset:3072
  ds_read_b128 v[20:23], v177 offset:4096
  ds_read_b128 v[24:27], v177 offset:5120
  ds_read_b128 v[28:31], v177 offset:6144
  ds_read_b128 v[32:35], v177 offset:7168
  ds_read_b128 v[36:39], v177 offset:8192
  ds_read_b128 v[40:43], v177 offset:9216
  s_cmp_gt_u32 s52, s51
  s_cbranch_scc1 ka\sfx\()_y_wp_98_ok
  s_mov_b32 s45, 0
ka\sfx\()_y_wp_98_spin:
  buffer_load_dword v2, v187, s[8:11], 0 offen sc1
  s_add_u32 s45, s45, 1
  s_waitcnt vmcnt(0)
  v_min_u32_dpp v3, v2, v2 quad_perm:[1,0,3,2] row_mask:0xf bank_mask:0xf
  s_nop 1
  v_min_u32_dpp v2, v3, v3 quad_perm:[2,3,0,1] row_mask:0xf bank_mask:0xf
  s_nop 1
  v_min_u32_dpp v3, v2, v2 row_half_mirror row_mask:0xf bank_mask:0xf
  s_nop 1
  v_min_u32_dpp v2, v3, v3 quad_perm:[0,1,2,3] row_mask:0xf bank_mask:0xf
  s_nop 0
  v_readfirstlane_b32 s52, v2
  s_cmp_gt_u32 s52, s51
  s_cbranch_scc1 ka\sfx\()_y_wp_98_ok
  s_cmp_lt_u32 s45, 400000
  s_cbranch_scc1 ka\sfx\()_y_wp_98_spin
  s_branch ka\sfx\()_abort
ka\sfx\()_y_wp_98_ok:
  s_add_u32 s65, s61, s64
  s_waitcnt lgkmcnt(9)
  v_smfmac_f32_16x16x64_bf16 v[44:47], v[4:7], a[0:7], v172
  s_add_u32 m0, s63, 0
  s_add_u32 s28, s50, 0
  buffer_load_dwordx4 v178, s[8:11], s28 offen sc1 lds
  v_smfmac_f32_16x16x64_bf16 v[48:51], v[4:7], a[80:87], v172
  v_smfmac_f32_16x16x64_bf16 v[52:55], v[4:7], a[160:167], v172
  s_add_u32 m0, s63, 2048
  s_add_u32 s28, s50, 40960
  buffer_load_dwordx4 v178, s[8:11], s28 offen sc1 lds
  v_smfmac_f32_16x16x64_bf16 v[56:59], v[4:7], a[240:247], v172
  s_waitcnt lgkmcnt(8)
  v_smfmac_f32_16x16x64_bf16 v[44:47], v[8:11], a[8:15], v172
  s_add_u32 m0, s63, 4096
  s_add_u32 s28, s50, 81920
  buffer_load_dwordx4 v178, s[8:11], s28 offen sc1 lds
  v_smfmac_f32_16x16x64_bf16 v[48:51], v[8:11], a[88:95], v172
  v_smfmac_f32_16x16x64_bf16 v[52:55], v[8:11], a[168:175], v172
  s_add_u32 m0, s63, 6144
  s_add_u32 s28, s50, 122880
  buffer_load_dwordx4 v178, s[8:11], s28 offen sc1 lds
  v_smfmac_f32_16x16x64_bf16 v[56:59], v[8:11], a[248:255], v172
  s_waitcnt lgkmcnt(7)
  v_smfmac_f32_16x16x64_bf16 v[44:47], v[12:15], a[16:23], v172
  s_add_u32 m0, s63, 8192
  s_add_u32 s28, s50, 163840
  buffer_load_dwordx4 v178, s[8:11], s28 offen sc1 lds
  v_smfmac_f32_16x16x64_bf16 v[48:51], v[12:15], a[96:103], v172
  v_smfmac_f32_16x16x64_bf16 v[52:55], v[12:15], a[176:183], v172
  s_add_u32 m0, s63, 10240
  s_add_u32 s28, s50, 204800
  buffer_load_dwordx4 v178, s[8:11], s28 offen sc1 lds
  v_smfmac_f32_16x16x64_bf16 v[56:59], v[12:15], v[192:199], v172
  s_waitcnt lgkmcnt(6)
  v_smfmac_f32_16x16x64_bf16 v[44:47], v[16:19], a[24:31], v172
  s_add_u32 m0, s63, 12288
  s_add_u32 s28, s50, 245760
  buffer_load_dwordx4 v178, s[8:11], s28 offen sc1 lds
  v_smfmac_f32_16x16x64_bf16 v[48:51], v[16:19], a[104:111], v172
  v_smfmac_f32_16x16x64_bf16 v[52:55], v[16:19], a[184:191], v172
  s_add_u32 m0, s63, 14336
  s_add_u32 s28, s50, 286720
  buffer_load_dwordx4 v178, s[8:11], s28 offen sc1 lds
  v_smfmac_f32_16x16x64_bf16 v[56:59], v[16:19], v[200:207], v172
  s_waitcnt lgkmcnt(5)
  v_smfmac_f32_16x16x64_bf16 v[44:47], v[20:23], a[32:39], v172
  s_add_u32 m0, s64, 65536
  s_add_u32 s28, s65, 0
  buffer_load_dwordx4 v178, s[8:11], s28 offen sc1 lds
  v_smfmac_f32_16x16x64_bf16 v[48:51], v[20:23], a[112:119], v172
  v_smfmac_f32_16x16x64_bf16 v[52:55], v[20:23], a[192:199], v172
  s_add_u32 m0, s64, 66560
  s_add_u32 s28, s65, 1024
  buffer_load_dwordx4 v178, s[8:11], s28 offen sc1 lds
  v_smfmac_f32_16x16x64_bf16 v[56:59], v[20:23], v[208:215], v172
  s_waitcnt lgkmcnt(4)
  v_smfmac_f32_16x16x64_bf16 v[44:47], v[24:27], a[40:47], v172
  s_add_u32 m0, s64, 67584
  s_add_u32 s28, s65, 2048
  buffer_load_dwordx4 v178, s[8:11], s28 offen sc1 lds
  v_smfmac_f32_16x16x64_bf16 v[48:51], v[24:27], a[120:127], v172
  v_smfmac_f32_16x16x64_bf16 v[52:55], v[24:27], a[200:207], v172
  s_add_u32 m0, s64, 68608
  s_add_u32 s28, s65, 3072
  buffer_load_dwordx4 v178, s[8:11], s28 offen sc1 lds
  v_smfmac_f32_16x16x64_bf16 v[56:59], v[24:27], v[216:223], v172
  s_waitcnt lgkmcnt(3)
  v_smfmac_f32_16x16x64_bf16 v[44:47], v[28:31], a[48:55], v172
  s_add_u32 m0, s64, 69632
  s_add_u32 s28, s65, 4096
  buffer_load_dwordx4 v178, s[8:11], s28 offen sc1 lds
  v_smfmac_f32_16x16x64_bf16 v[48:51], v[28:31], a[128:135], v172
  v_smfmac_f32_16x16x64_bf16 v[52:55], v[28:31], a[208:215], v172
  s_add_u32 m0, s64, 70656
  s_add_u32 s28, s65, 5120
  buffer_load_dwordx4 v178, s[8:11], s28 offen sc1 lds
  v_smfmac_f32_16x16x64_bf16 v[56:59], v[28:31], v[224:231], v172
  s_waitcnt lgkmcnt(2)
  v_smfmac_f32_16x16x64_bf16 v[44:47], v[32:35], a[56:63], v172
  s_add_u32 m0, s64, 71680
  s_add_u32 s28, s65, 6144
  buffer_load_dwordx4 v178, s[8:11], s28 offen sc1 lds
  v_smfmac_f32_16x16x64_bf16 v[48:51], v[32:35], a[136:143], v172
  v_smfmac_f32_16x16x64_bf16 v[52:55], v[32:35], a[216:223], v172
  s_add_u32 m0, s64, 72704
  s_add_u32 s28, s65, 7168
  buffer_load_dwordx4 v178, s[8:11], s28 offen sc1 lds
  v_smfmac_f32_16x16x64_bf16 v[56:59], v[32:35], v[232:239], v172
  s_waitcnt lgkmcnt(1)
  v_smfmac_f32_16x16x64_bf16 v[44:47], v[36:39], a[64:71], v172
  s_add_u32 m0, s64, 73728
  s_add_u32 s28, s65, 8192
  buffer_load_dwordx4 v178, s[8:11], s28 offen sc1 lds
  v_smfmac_f32_16x16x64_bf16 v[48:51], v[36:39], a[144:151], v172
  v_smfmac_f32_16x16x64_bf16 v[52:55], v[36:39], a[224:231], v172
  s_add_u32 m0, s64, 74752
  s_add_u32 s28, s65, 9216
  buffer_load_dwordx4 v178, s[8:11], s28 offen sc1 lds
  v_smfmac_f32_16x16x64_bf16 v[56:59], v[36:39], v[240:247], v172
  s_waitcnt lgkmcnt(0)
  v_smfmac_f32_16x16x64_bf16 v[44:47], v[40:43], a[72:79], v172
  v_smfmac_f32_16x16x64_bf16 v[48:51], v[40:43], a[152:159], v172
  v_smfmac_f32_16x16x64_bf16 v[52:55], v[40:43], a[232:239], v172
  v_smfmac_f32_16x16x64_bf16 v[56:59], v[40:43], v[248:255], v172
  s_xor_b32 s63, s63, 0x4000
  s_add_u32 s50, s50, 1310720
  s_nop 9
  v_permlane32_swap_b32 v44, v48
  v_permlane32_swap_b32 v45, v49
  v_permlane32_swap_b32 v46, v50
  v_permlane32_swap_b32 v47, v51
  v_permlane32_swap_b32 v52, v56
  v_permlane32_swap_b32 v53, v57
  v_permlane32_swap_b32 v54, v58
  v_permlane32_swap_b32 v55, v59
  v_add_f32 v44, v44, v48
  v_add_f32 v45, v45, v49
  v_add_f32 v46, v46, v50
  v_add_f32 v47, v47, v51
  v_add_f32 v52, v52, v56
  v_add_f32 v53, v53, v57
  v_add_f32 v54, v54, v58
  v_add_f32 v55, v55, v59
  v_cvt_pk_bf16_f32 v64, v44, v45
  v_cvt_pk_bf16_f32 v65, v46, v47
  v_cvt_pk_bf16_f32 v66, v52, v53
  v_cvt_pk_bf16_f32 v67, v54, v55
  ds_write_b128 v179, v[64:67]
  v_mov_b32 v44, 0
  v_mov_b32 v45, 0
  v_mov_b32 v46, 0
  v_mov_b32 v47, 0
  v_mov_b32 v48, 0
  v_mov_b32 v49, 0
  v_mov_b32 v50, 0
  v_mov_b32 v51, 0
  v_mov_b32 v52, 0
  v_mov_b32 v53, 0
  v_mov_b32 v54, 0
  v_mov_b32 v55, 0
  v_mov_b32 v56, 0
  v_mov_b32 v57, 0
  v_mov_b32 v58, 0
  v_mov_b32 v59, 0
  s_waitcnt vmcnt(0) lgkmcnt(0)
  s_barrier
  ds_read_b128 v[60:63], v180
  s_cmp_eq_u32 s51, 0
  s_cbranch_scc1 yt_99_\sfx\()
  ds_read_b128 v[68:71], v181 offset:0
  ds_read_b128 v[72:75], v181 offset:2048
  ds_read_b128 v[76:79], v181 offset:4096
  ds_read_b128 v[80:83], v181 offset:6144
  ds_read_b128 v[84:87], v181 offset:8192
  ds_read_b128 v[88:91], v181 offset:10240
  ds_read_b128 v[92:95], v181 offset:12288
  ds_read_b128 v[96:99], v181 offset:14336
  s_mov_b32 s45, 0
ytp_100_\sfx\():
  s_waitcnt lgkmcnt(0)
  ds_read_b128 v[100:103], v183 offset:0
  ds_read_b128 v[104:107], v183 offset:2048
  ds_read_b128 v[108:111], v183 offset:4096
  ds_read_b128 v[112:115], v183 offset:6144
  ds_read_b128 v[116:119], v183 offset:8192
  ds_read_b128 v[120:123], v183 offset:10240
  ds_read_b128 v[124:127], v183 offset:12288
  ds_read_b128 v[128:131], v183 offset:14336
  ds_read_b128 v[132:135], v183 offset:16384
  ds_read_b128 v[136:139], v183 offset:18432
  s_waitcnt lgkmcnt(0)
  v_max_u32 v190, v100, v102
  v_max3_u32 v190, v190, v104, v106
  v_max3_u32 v190, v190, v108, v110
  v_max3_u32 v190, v190, v112, v114
  v_max3_u32 v190, v190, v116, v118
  v_max3_u32 v190, v190, v120, v122
  v_max3_u32 v190, v190, v124, v126
  v_max3_u32 v190, v190, v128, v130
  v_max3_u32 v190, v190, v132, v134
  v_max3_u32 v190, v190, v136, v138
  v_cmp_eq_u32 vcc, -1, v190
  s_cbranch_vccz ytp_100_ok_\sfx\()
  s_add_u32 s45, s45, 1
  s_cmp_lt_u32 s45, 400000
  s_cbranch_scc0 ka\sfx\()_abort
ytp_100_dma_\sfx\():
  s_mov_b32 m0, 65536
  s_add_u32 s28, s61, 0
  buffer_load_dwordx4 v178, s[8:11], s28 offen sc1 lds
  s_mov_b32 m0, 66560
  s_add_u32 s28, s61, 1024
  buffer_load_dwordx4 v178, s[8:11], s28 offen sc1 lds
  s_mov_b32 m0, 67584
  s_add_u32 s28, s61, 2048
  buffer_load_dwordx4 v178, s[8:11], s28 offen sc1 lds
  s_mov_b32 m0, 68608
  s_add_u32 s28, s61, 3072
  buffer_load_dwordx4 v178, s[8:11], s28 offen sc1 lds
  s_mov_b32 m0, 69632
  s_add_u32 s28, s61, 4096
  buffer_load_dwordx4 v178, s[8:11], s28 offen sc1 lds
  s_mov_b32 m0, 70656
  s_add_u32 s28, s61, 5120
  buffer_load_dwordx4 v178, s[8:11], s28 offen sc1 lds
  s_mov_b32 m0, 71680
  s_add_u32 s28, s61, 6144
  buffer_load_dwordx4 v178, s[8:11], s28 offen sc1 lds
  s_mov_b32 m0, 72704
  s_add_u32 s28, s61, 7168
  buffer_load_dwordx4 v178, s[8:11], s28 offen sc1 lds
  s_mov_b32 m0, 73728
  s_add_u32 s28, s61, 8192
  buffer_load_dwordx4 v178, s[8:11], s28 offen sc1 lds
  s_mov_b32 m0, 74752
  s_add_u32 s28, s61, 9216
  buffer_load_dwordx4 v178, s[8:11], s28 offen sc1 lds
  s_mov_b32 m0, 75776
  s_add_u32 s28, s61, 10240
  buffer_load_dwordx4 v178, s[8:11], s28 offen sc1 lds
  s_mov_b32 m0, 76800
  s_add_u32 s28, s61, 11264
  buffer_load_dwordx4 v178, s[8:11], s28 offen sc1 lds
  s_mov_b32 m0, 77824
  s_add_u32 s28, s61, 12288
  buffer_load_dwordx4 v178, s[8:11], s28 offen sc1 lds
  s_mov_b32 m0, 78848
  s_add_u32 s28, s61, 13312
  buffer_load_dwordx4 v178, s[8:11], s28 offen sc1 lds
  s_mov_b32 m0, 79872
  s_add_u32 s28, s61, 14336
  buffer_load_dwordx4 v178, s[8:11], s28 offen sc1 lds
  s_mov_b32 m0, 80896
  s_add_u32 s28, s61, 15360
  buffer_load_dwordx4 v178, s[8:11], s28 offen sc1 lds
  s_mov_b32 m0, 81920
  s_add_u32 s28, s61, 16384
  buffer_load_dwordx4 v178, s[8:11], s28 offen sc1 lds
  s_mov_b32 m0, 82944
  s_add_u32 s28, s61, 17408
  buffer_load_dwordx4 v178, s[8:11], s28 offen sc1 lds
  s_mov_b32 m0, 83968
  s_add_u32 s28, s61, 18432
  buffer_load_dwordx4 v178, s[8:11], s28 offen sc1 lds
  s_mov_b32 m0, 84992
  s_add_u32 s28, s61, 19456
  buffer_load_dwordx4 v178, s[8:11], s28 offen sc1 lds
  s_waitcnt vmcnt(0)
  s_branch ytp_100_\sfx\()
ytp_100_ok_\sfx\():
  v_mfma_f32_16x16x32_bf16 v[140:143], v[68:71], v[100:103], 0
  v_mfma_f32_16x16x32_bf16 v[140:143], v[72:75], v[104:107], v[140:143]
  v_mfma_f32_16x16x32_bf16 v[140:143], v[76:79], v[108:111], v[140:143]
  v_mfma_f32_16x16x32_bf16 v[140:143], v[80:83], v[112:115], v[140:143]
  v_mfma_f32_16x16x32_bf16 v[140:143], v[84:87], v[116:119], v[140:143]
  v_mfma_f32_16x16x32_bf16 v[140:143], v[88:91], v[120:123], v[140:143]
  v_mfma_f32_16x16x32_bf16 v[140:143], v[92:95], v[124:127], v[140:143]
  v_mfma_f32_16x16x32_bf16 v[140:143], v[96:99], v[128:131], v[140:143]
  v_mfma_f32_16x16x32_bf16 v[140:143], v[148:151], v[132:135], v[140:143]
  v_mfma_f32_16x16x32_bf16 v[140:143], v[152:155], v[136:139], v[140:143]
  s_nop 8
  v_cvt_pk_bf16_f32 v144, v140, v141
  v_cvt_pk_bf16_f32 v145, v142, v143
  s_add_u32 s28, s62, 0
  buffer_store_dwordx2 v[144:145], v189, s[8:11], s28 offen
  s_nop 1
  s_mov_b32 s45, 0
ytp_101_\sfx\():
  s_waitcnt lgkmcnt(0)
  ds_read_b128 v[100:103], v183 offset:1024
  ds_read_b128 v[104:107], v183 offset:3072
  ds_read_b128 v[108:111], v183 offset:5120
  ds_read_b128 v[112:115], v183 offset:7168
  ds_read_b128 v[116:119], v183 offset:9216
  ds_read_b128 v[120:123], v183 offset:11264
  ds_read_b128 v[124:127], v183 offset:13312
  ds_read_b128 v[128:131], v183 offset:15360
  ds_read_b128 v[132:135], v183 offset:17408
  ds_read_b128 v[136:139], v183 offset:19456
  s_waitcnt lgkmcnt(0)
  v_max_u32 v190, v100, v102
  v_max3_u32 v190, v190, v104, v106
  v_max3_u32 v190, v190, v108, v110
  v_max3_u32 v190, v190, v112, v114
  v_max3_u32 v190, v190, v116, v118
  v_max3_u32 v190, v190, v120, v122
  v_max3_u32 v190, v190, v124, v126
  v_max3_u32 v190, v190, v128, v130
  v_max3_u32 v190, v190, v132, v134
  v_max3_u32 v190, v190, v136, v138
  v_cmp_eq_u32 vcc, -1, v190
  s_cbranch_vccz ytp_101_ok_\sfx\()
  s_add_u32 s45, s45, 1
  s_cmp_lt_u32 s45, 400000
  s_cbranch_scc0 ka\sfx\()_abort
ytp_101_dma_\sfx\():
  s_mov_b32 m0, 65536
  s_add_u32 s28, s61, 0
  buffer_load_dwordx4 v178, s[8:11], s28 offen sc1 lds
  s_mov_b32 m0, 66560
  s_add_u32 s28, s61, 1024
  buffer_load_dwordx4 v178, s[8:11], s28 offen sc1 lds
  s_mov_b32 m0, 67584
  s_add_u32 s28, s61, 2048
  buffer_load_dwordx4 v178, s[8:11], s28 offen sc1 lds
  s_mov_b32 m0, 68608
  s_add_u32 s28, s61, 3072
  buffer_load_dwordx4 v178, s[8:11], s28 offen sc1 lds
  s_mov_b32 m0, 69632
  s_add_u32 s28, s61, 4096
  buffer_load_dwordx4 v178, s[8:11], s28 offen sc1 lds
  s_mov_b32 m0, 70656
  s_add_u32 s28, s61, 5120
  buffer_load_dwordx4 v178, s[8:11], s28 offen sc1 lds
  s_mov_b32 m0, 71680
  s_add_u32 s28, s61, 6144
  buffer_load_dwordx4 v178, s[8:11], s28 offen sc1 lds
  s_mov_b32 m0, 72704
  s_add_u32 s28, s61, 7168
  buffer_load_dwordx4 v178, s[8:11], s28 offen sc1 lds
  s_mov_b32 m0, 73728
  s_add_u32 s28, s61, 8192
  buffer_load_dwordx4 v178, s[8:11], s28 offen sc1 lds
  s_mov_b32 m0, 74752
  s_add_u32 s28, s61, 9216
  buffer_load_dwordx4 v178, s[8:11], s28 offen sc1 lds
  s_mov_b32 m0, 75776
  s_add_u32 s28, s61, 10240
  buffer_load_dwordx4 v178, s[8:11], s28 offen sc1 lds
  s_mov_b32 m0, 76800
  s_add_u32 s28, s61, 11264
  buffer_load_dwordx4 v178, s[8:11], s28 offen sc1 lds
  s_mov_b32 m0, 77824
  s_add_u32 s28, s61, 12288
  buffer_load_dwordx4 v178, s[8:11], s28 offen sc1 lds
  s_mov_b32 m0, 78848
  s_add_u32 s28, s61, 13312
  buffer_load_dwordx4 v178, s[8:11], s28 offen sc1 lds
  s_mov_b32 m0, 79872
  s_add_u32 s28, s61, 14336
  buffer_load_dwordx4 v178, s[8:11], s28 offen sc1 lds
  s_mov_b32 m0, 80896
  s_add_u32 s28, s61, 15360
  buffer_load_dwordx4 v178, s[8:11], s28 offen sc1 lds
  s_mov_b32 m0, 81920
  s_add_u32 s28, s61, 16384
  buffer_load_dwordx4 v178, s[8:11], s28 offen sc1 lds
  s_mov_b32 m0, 82944
  s_add_u32 s28, s61, 17408
  buffer_load_dwordx4 v178, s[8:11], s28 offen sc1 lds
  s_mov_b32 m0, 83968
  s_add_u32 s28, s61, 18432
  buffer_load_dwordx4 v178, s[8:11], s28 offen sc1 lds
  s_mov_b32 m0, 84992
  s_add_u32 s28, s61, 19456
  buffer_load_dwordx4 v178, s[8:11], s28 offen sc1 lds
  s_waitcnt vmcnt(0)
  s_branch ytp_101_\sfx\()
ytp_101_ok_\sfx\():
  v_mfma_f32_16x16x32_bf16 v[140:143], v[68:71], v[100:103], 0
  v_mfma_f32_16x16x32_bf16 v[140:143], v[72:75], v[104:107], v[140:143]
  v_mfma_f32_16x16x32_bf16 v[140:143], v[76:79], v[108:111], v[140:143]
  v_mfma_f32_16x16x32_bf16 v[140:143], v[80:83], v[112:115], v[140:143]
  v_mfma_f32_16x16x32_bf16 v[140:143], v[84:87], v[116:119], v[140:143]
  v_mfma_f32_16x16x32_bf16 v[140:143], v[88:91], v[120:123], v[140:143]
  v_mfma_f32_16x16x32_bf16 v[140:143], v[92:95], v[124:127], v[140:143]
  v_mfma_f32_16x16x32_bf16 v[140:143], v[96:99], v[128:131], v[140:143]
  v_mfma_f32_16x16x32_bf16 v[140:143], v[148:151], v[132:135], v[140:143]
  v_mfma_f32_16x16x32_bf16 v[140:143], v[152:155], v[136:139], v[140:143]
  s_nop 8
  v_cvt_pk_bf16_f32 v144, v140, v141
  v_cvt_pk_bf16_f32 v145, v142, v143
  s_add_u32 s28, s62, 256
  buffer_store_dwordx2 v[144:145], v189, s[8:11], s28 offen
  s_nop 1
  s_add_u32 s61, s61, 20480
  s_add_u32 s62, s62, 40960
  s_add_u32 s54, s54, 1
  v_xor_b32 v181, 0x4000, v181
yt_99_\sfx\():
  s_waitcnt lgkmcnt(0)
  v_mov_b32 v148, v60
  v_mov_b32 v149, v61
  v_mov_b32 v150, v62
  v_mov_b32 v151, v63
  v_mov_b32 v152, v64
  v_mov_b32 v153, v65
  v_mov_b32 v154, v66
  v_mov_b32 v155, v67
  s_add_u32 s97, s97, 10240
  s_mov_b32 s48, s97
  s_add_u32 s51, s51, 1
  s_cmp_lt_u32 s51, 64
  s_cbranch_scc1 ka\sfx\()_y_tokl
  s_barrier
  ds_read_b128 v[68:71], v181 offset:0
  ds_read_b128 v[72:75], v181 offset:2048
  ds_read_b128 v[76:79], v181 offset:4096
  ds_read_b128 v[80:83], v181 offset:6144
  ds_read_b128 v[84:87], v181 offset:8192
  ds_read_b128 v[88:91], v181 offset:10240
  ds_read_b128 v[92:95], v181 offset:12288
  ds_read_b128 v[96:99], v181 offset:14336
  s_mov_b32 s45, 0
  s_branch ytp_102_dma_\sfx\()
ytp_102_\sfx\():
  s_waitcnt lgkmcnt(0)
  ds_read_b128 v[100:103], v183 offset:0
  ds_read_b128 v[104:107], v183 offset:2048
  ds_read_b128 v[108:111], v183 offset:4096
  ds_read_b128 v[112:115], v183 offset:6144
  ds_read_b128 v[116:119], v183 offset:8192
  ds_read_b128 v[120:123], v183 offset:10240
  ds_read_b128 v[124:127], v183 offset:12288
  ds_read_b128 v[128:131], v183 offset:14336
  ds_read_b128 v[132:135], v183 offset:16384
  ds_read_b128 v[136:139], v183 offset:18432
  s_waitcnt lgkmcnt(0)
  v_max_u32 v190, v100, v102
  v_max3_u32 v190, v190, v104, v106
  v_max3_u32 v190, v190, v108, v110
  v_max3_u32 v190, v190, v112, v114
  v_max3_u32 v190, v190, v116, v118
  v_max3_u32 v190, v190, v120, v122
  v_max3_u32 v190, v190, v124, v126
  v_max3_u32 v190, v190, v128, v130
  v_max3_u32 v190, v190, v132, v134
  v_max3_u32 v190, v190, v136, v138
  v_cmp_eq_u32 vcc, -1, v190
  s_cbranch_vccz ytp_102_ok_\sfx\()
  s_add_u32 s45, s45, 1
  s_cmp_lt_u32 s45, 400000
  s_cbranch_scc0 ka\sfx\()_abort
ytp_102_dma_\sfx\():
  s_mov_b32 m0, 65536
  s_add_u32 s28, s61, 0
  buffer_load_dwordx4 v178, s[8:11], s28 offen sc1 lds
  s_mov_b32 m0, 66560
  s_add_u32 s28, s61, 1024
  buffer_load_dwordx4 v178, s[8:11], s28 offen sc1 lds
  s_mov_b32 m0, 67584
  s_add_u32 s28, s61, 2048
  buffer_load_dwordx4 v178, s[8:11], s28 offen sc1 lds
  s_mov_b32 m0, 68608
  s_add_u32 s28, s61, 3072
  buffer_load_dwordx4 v178, s[8:11], s28 offen sc1 lds
  s_mov_b32 m0, 69632
  s_add_u32 s28, s61, 4096
  buffer_load_dwordx4 v178, s[8:11], s28 offen sc1 lds
  s_mov_b32 m0, 70656
  s_add_u32 s28, s61, 5120
  buffer_load_dwordx4 v178, s[8:11], s28 offen sc1 lds
  s_mov_b32 m0, 71680
  s_add_u32 s28, s61, 6144
  buffer_load_dwordx4 v178, s[8:11], s28 offen sc1 lds
  s_mov_b32 m0, 72704
  s_add_u32 s28, s61, 7168
  buffer_load_dwordx4 v178, s[8:11], s28 offen sc1 lds
  s_mov_b32 m0, 73728
  s_add_u32 s28, s61, 8192
  buffer_load_dwordx4 v178, s[8:11], s28 offen sc1 lds
  s_mov_b32 m0, 74752
  s_add_u32 s28, s61, 9216
  buffer_load_dwordx4 v178, s[8:11], s28 offen sc1 lds
  s_mov_b32 m0, 75776
  s_add_u32 s28, s61, 10240
  buffer_load_dwordx4 v178, s[8:11], s28 offen sc1 lds
  s_mov_b32 m0, 76800
  s_add_u32 s28, s61, 11264
  buffer_load_dwordx4 v178, s[8:11], s28 offen sc1 lds
  s_mov_b32 m0, 77824
  s_add_u32 s28, s61, 12288
  buffer_load_dwordx4 v178, s[8:11], s28 offen sc1 lds
  s_mov_b32 m0, 78848
  s_add_u32 s28, s61, 13312
  buffer_load_dwordx4 v178, s[8:11], s28 offen sc1 lds
  s_mov_b32 m0, 79872
  s_add_u32 s28, s61, 14336
  buffer_load_dwordx4 v178, s[8:11], s28 offen sc1 lds
  s_mov_b32 m0, 80896
  s_add_u32 s28, s61, 15360
  buffer_load_dwordx4 v178, s[8:11], s28 offen sc1 lds
  s_mov_b32 m0, 81920
  s_add_u32 s28, s61, 16384
  buffer_load_dwordx4 v178, s[8:11], s28 offen sc1 lds
  s_mov_b32 m0, 82944
  s_add_u32 s28, s61, 17408
  buffer_load_dwordx4 v178, s[8:11], s28 offen sc1 lds
  s_mov_b32 m0, 83968
  s_add_u32 s28, s61, 18432
  buffer_load_dwordx4 v178, s[8:11], s28 offen sc1 lds
  s_mov_b32 m0, 84992
  s_add_u32 s28, s61, 19456
  buffer_load_dwordx4 v178, s[8:11], s28 offen sc1 lds
  s_waitcnt vmcnt(0)
  s_branch ytp_102_\sfx\()
ytp_102_ok_\sfx\():
  v_mfma_f32_16x16x32_bf16 v[140:143], v[68:71], v[100:103], 0
  v_mfma_f32_16x16x32_bf16 v[140:143], v[72:75], v[104:107], v[140:143]
  v_mfma_f32_16x16x32_bf16 v[140:143], v[76:79], v[108:111], v[140:143]
  v_mfma_f32_16x16x32_bf16 v[140:143], v[80:83], v[112:115], v[140:143]
  v_mfma_f32_16x16x32_bf16 v[140:143], v[84:87], v[116:119], v[140:143]
  v_mfma_f32_16x16x32_bf16 v[140:143], v[88:91], v[120:123], v[140:143]
  v_mfma_f32_16x16x32_bf16 v[140:143], v[92:95], v[124:127], v[140:143]
  v_mfma_f32_16x16x32_bf16 v[140:143], v[96:99], v[128:131], v[140:143]
  v_mfma_f32_16x16x32_bf16 v[140:143], v[148:151], v[132:135], v[140:143]
  v_mfma_f32_16x16x32_bf16 v[140:143], v[152:155], v[136:139], v[140:143]
  s_nop 8
  v_cvt_pk_bf16_f32 v144, v140, v141
  v_cvt_pk_bf16_f32 v145, v142, v143
  s_add_u32 s28, s62, 0
  buffer_store_dwordx2 v[144:145], v189, s[8:11], s28 offen
  s_nop 1
  s_mov_b32 s45, 0
ytp_103_\sfx\():
  s_waitcnt lgkmcnt(0)
  ds_read_b128 v[100:103], v183 offset:1024
  ds_read_b128 v[104:107], v183 offset:3072
  ds_read_b128 v[108:111], v183 offset:5120
  ds_read_b128 v[112:115], v183 offset:7168
  ds_read_b128 v[116:119], v183 offset:9216
  ds_read_b128 v[120:123], v183 offset:11264
  ds_read_b128 v[124:127], v183 offset:13312
  ds_read_b128 v[128:131], v183 offset:15360
  ds_read_b128 v[132:135], v183 offset:17408
  ds_read_b128 v[136:139], v183 offset:19456
  s_waitcnt lgkmcnt(0)
  v_max_u32 v190, v100, v102
  v_max3_u32 v190, v190, v104, v106
  v_max3_u32 v190, v190, v108, v110
  v_max3_u32 v190, v190, v112, v114
  v_max3_u32 v190, v190, v116, v118
  v_max3_u32 v190, v190, v120, v122
  v_max3_u32 v190, v190, v124, v126
  v_max3_u32 v190, v190, v128, v130
  v_max3_u32 v190, v190, v132, v134
  v_max3_u32 v190, v190, v136, v138
  v_cmp_eq_u32 vcc, -1, v190
  s_cbranch_vccz ytp_103_ok_\sfx\()
  s_add_u32 s45, s45, 1
  s_cmp_lt_u32 s45, 400000
  s_cbranch_scc0 ka\sfx\()_abort
ytp_103_dma_\sfx\():
  s_mov_b32 m0, 65536
  s_add_u32 s28, s61, 0
  buffer_load_dwordx4 v178, s[8:11], s28 offen sc1 lds
  s_mov_b32 m0, 66560
  s_add_u32 s28, s61, 1024
  buffer_load_dwordx4 v178, s[8:11], s28 offen sc1 lds
  s_mov_b32 m0, 67584
  s_add_u32 s28, s61, 2048
  buffer_load_dwordx4 v178, s[8:11], s28 offen sc1 lds
  s_mov_b32 m0, 68608
  s_add_u32 s28, s61, 3072
  buffer_load_dwordx4 v178, s[8:11], s28 offen sc1 lds
  s_mov_b32 m0, 69632
  s_add_u32 s28, s61, 4096
  buffer_load_dwordx4 v178, s[8:11], s28 offen sc1 lds
  s_mov_b32 m0, 70656
  s_add_u32 s28, s61, 5120
  buffer_load_dwordx4 v178, s[8:11], s28 offen sc1 lds
  s_mov_b32 m0, 71680
  s_add_u32 s28, s61, 6144
  buffer_load_dwordx4 v178, s[8:11], s28 offen sc1 lds
  s_mov_b32 m0, 72704
  s_add_u32 s28, s61, 7168
  buffer_load_dwordx4 v178, s[8:11], s28 offen sc1 lds
  s_mov_b32 m0, 73728
  s_add_u32 s28, s61, 8192
  buffer_load_dwordx4 v178, s[8:11], s28 offen sc1 lds
  s_mov_b32 m0, 74752
  s_add_u32 s28, s61, 9216
  buffer_load_dwordx4 v178, s[8:11], s28 offen sc1 lds
  s_mov_b32 m0, 75776
  s_add_u32 s28, s61, 10240
  buffer_load_dwordx4 v178, s[8:11], s28 offen sc1 lds
  s_mov_b32 m0, 76800
  s_add_u32 s28, s61, 11264
  buffer_load_dwordx4 v178, s[8:11], s28 offen sc1 lds
  s_mov_b32 m0, 77824
  s_add_u32 s28, s61, 12288
  buffer_load_dwordx4 v178, s[8:11], s28 offen sc1 lds
  s_mov_b32 m0, 78848
  s_add_u32 s28, s61, 13312
  buffer_load_dwordx4 v178, s[8:11], s28 offen sc1 lds
  s_mov_b32 m0, 79872
  s_add_u32 s28, s61, 14336
  buffer_load_dwordx4 v178, s[8:11], s28 offen sc1 lds
  s_mov_b32 m0, 80896
  s_add_u32 s28, s61, 15360
  buffer_load_dwordx4 v178, s[8:11], s28 offen sc1 lds
  s_mov_b32 m0, 81920
  s_add_u32 s28, s61, 16384
  buffer_load_dwordx4 v178, s[8:11], s28 offen sc1 lds
  s_mov_b32 m0, 82944
  s_add_u32 s28, s61, 17408
  buffer_load_dwordx4 v178, s[8:11], s28 offen sc1 lds
  s_mov_b32 m0, 83968
  s_add_u32 s28, s61, 18432
  buffer_load_dwordx4 v178, s[8:11], s28 offen sc1 lds
  s_mov_b32 m0, 84992
  s_add_u32 s28, s61, 19456
  buffer_load_dwordx4 v178, s[8:11], s28 offen sc1 lds
  s_waitcnt vmcnt(0)
  s_branch ytp_103_\sfx\()
ytp_103_ok_\sfx\():
  v_mfma_f32_16x16x32_bf16 v[140:143], v[68:71], v[100:103], 0
  v_mfma_f32_16x16x32_bf16 v[140:143], v[72:75], v[104:107], v[140:143]
  v_mfma_f32_16x16x32_bf16 v[140:143], v[76:79], v[108:111], v[140:143]
  v_mfma_f32_16x16x32_bf16 v[140:143], v[80:83], v[112:115], v[140:143]
  v_mfma_f32_16x16x32_bf16 v[140:143], v[84:87], v[116:119], v[140:143]
  v_mfma_f32_16x16x32_bf16 v[140:143], v[88:91], v[120:123], v[140:143]
  v_mfma_f32_16x16x32_bf16 v[140:143], v[92:95], v[124:127], v[140:143]
  v_mfma_f32_16x16x32_bf16 v[140:143], v[96:99], v[128:131], v[140:143]
  v_mfma_f32_16x16x32_bf16 v[140:143], v[148:151], v[132:135], v[140:143]
  v_mfma_f32_16x16x32_bf16 v[140:143], v[152:155], v[136:139], v[140:143]
  s_nop 8
  v_cvt_pk_bf16_f32 v144, v140, v141
  v_cvt_pk_bf16_f32 v145, v142, v143
  s_add_u32 s28, s62, 256
  buffer_store_dwordx2 v[144:145], v189, s[8:11], s28 offen
  s_nop 1
  s_add_u32 s61, s61, 20480
  s_add_u32 s62, s62, 40960
  s_add_u32 s54, s54, 1
  v_xor_b32 v181, 0x4000, v181
  s_waitcnt vmcnt(0)
  s_branch ka\sfx\()_exit
ka\sfx\()_abort:
  s_branch ka_abort
ka\sfx\()_exit:
  s_branch ka_exit
.endm
CHAINROLES f,
CHAINROLES s, sc1
ka_abort:
  s_load_dwordx2 s[6:7], s[0:1], 88
  v_mov_b32 v2, 80
  v_mov_b32 v3, 1
  s_waitcnt lgkmcnt(0)
  s_mov_b64 exec, 1
  global_atomic_add v2, v3, s[6:7]
  s_waitcnt vmcnt(0)
ka_exit:
  s_endpgm

.section .rodata,"a"
.p2align 6
.amdhsa_kernel ka2_kernel
  .amdhsa_next_free_vgpr 512
  .amdhsa_next_free_sgpr 102
  .amdhsa_accum_offset 256
  .amdhsa_group_segment_fixed_size 0
  .amdhsa_kernarg_size 104
  .amdhsa_user_sgpr_count 2
  .amdhsa_user_sgpr_kernarg_segment_ptr 1
  .amdhsa_system_sgpr_workgroup_id_x 1
.end_amdhsa_kernel
.text
.globl kb2_kernel
.p2align 8
.type kb2_kernel,@function
kb2_kernel:
  s_cmp_ge_u32 s2, 256
  s_cbranch_scc1 kb2_exit
  s_load_dwordx2 s[36:37], s[0:1], 0
  s_load_dwordx2 s[38:39], s[0:1], 80
  s_load_dwordx2 s[4:5], s[0:1], 96
  v_lshrrev_b32 v1, 6, v0
  s_nop 0
  v_readfirstlane_b32 s21, v1
  v_and_b32 v1, 63, v0
  v_lshlrev_b32 v2, 4, v1
  s_waitcnt lgkmcnt(0)
  s_mov_b32 s8, s4
  s_and_b32 s9, s5, 0xffff
  s_mov_b32 s10, 0x10000000
  s_mov_b32 s11, 0x20000
  s_mov_b32 s12, s36
  s_and_b32 s13, s37, 0xffff
  s_mov_b32 s14, 0x280000
  s_mov_b32 s15, 0x20000
  s_mov_b32 s16, s38
  s_and_b32 s17, s39, 0xffff
  s_mov_b32 s18, 0x280000
  s_mov_b32 s19, 0x20000
  s_and_b32 s22, s2, 7
  s_lshl_b32 s22, s22, 2
  s_bfe_u32 s23, s2, 0x20003
  s_add_u32 s22, s22, s23
  s_lshr_b32 s23, s2, 5
  s_lshl_b32 s46, s23, 7
  s_add_u32 s46, s46, 0xa000
  s_add_u32 s48, s46, 0x1400
  s_lshl_b32 s47, s22, 7
  s_add_u32 s47, s47, 0xa400
  s_lshr_b32 s26, s2, 2
  s_and_b32 s27, s2, 3
  s_lshl_b32 s27, s27, 3
  v_and_b32 v5, 7, v1
  v_bfe_u32 v6, v1, 3, 1
  v_lshrrev_b32 v7, 4, v1
  v_lshlrev_b32 v8, 5, v6
  v_add_u32 v8, v8, v5
  v_add_u32 v8, s27, v8
  v_lshlrev_b32 v8, 4, v8
  v_lshlrev_b32 v9, 11, v7
  v_add_u32 v9, v9, v8
  v_lshlrev_b32 v10, 10, v7
  v_add_u32 v10, v10, v8
  s_mul_i32 s28, s26, 81920
  s_lshl_b32 s29, s21, 13
  s_add_u32 s28, s28, s29
  s_cmp_lt_u32 s21, 2
  s_cselect_b32 s49, 3, 2
  v_mov_b32 v32, 0
  v_mov_b32 v33, 0
  v_mov_b32 v34, 0
  v_mov_b32 v35, 0
  v_mov_b32 v36, 0
  v_mov_b32 v37, 0
  v_mov_b32 v38, 0
  v_mov_b32 v39, 0
  v_mov_b32 v56, 0
  v_mov_b32 v57, 0
  v_mov_b32 v58, 0
  v_mov_b32 v59, 0
  v_mov_b32 v68, 0
  v_mov_b32 v69, 0
  v_mov_b32 v70, 0
  v_mov_b32 v71, 0
  v_mov_b32 v80, 0
  v_mov_b32 v81, 0
  v_mov_b32 v82, 0
  v_mov_b32 v83, 0
  v_mov_b32 v92, 0
  v_mov_b32 v93, 0
  v_mov_b32 v94, 0
  v_mov_b32 v95, 0
  s_mul_i32 s33, s26, 40960
  s_lshl_b32 s30, s21, 12
  s_add_u32 s33, s33, s30
  s_add_u32 s30, s33, 27262976
  buffer_load_dwordx4 v[48:51], v10, s[8:11], s30 offen
  s_add_u32 s30, s33, 29884416
  buffer_load_dwordx4 v[60:63], v10, s[8:11], s30 offen
  s_add_u32 s30, s33, 32505856
  buffer_load_dwordx4 v[72:75], v10, s[8:11], s30 offen
  s_add_u32 s30, s33, 35127296
  buffer_load_dwordx4 v[84:87], v10, s[8:11], s30 offen
  s_add_u32 s30, s28, 20971520
  buffer_load_dwordx4 v[16:19], v9, s[8:11], s30 offen
  s_add_u32 s30, s28, 20972544
  buffer_load_dwordx4 v[20:23], v9, s[8:11], s30 offen
  s_add_u32 s30, s33, 27279360
  buffer_load_dwordx4 v[52:55], v10, s[8:11], s30 offen
  s_add_u32 s30, s33, 29900800
  buffer_load_dwordx4 v[64:67], v10, s[8:11], s30 offen
  s_add_u32 s30, s33, 32522240
  buffer_load_dwordx4 v[76:79], v10, s[8:11], s30 offen
  s_add_u32 s30, s33, 35143680
  buffer_load_dwordx4 v[88:91], v10, s[8:11], s30 offen
  s_add_u32 s30, s28, 21004288
  buffer_load_dwordx4 v[24:27], v9, s[8:11], s30 offen
  s_add_u32 s30, s28, 21005312
  buffer_load_dwordx4 v[28:31], v9, s[8:11], s30 offen
  s_cmp_lt_u32 s21, 2
  s_cbranch_scc0 g3_104
  s_add_u32 s30, s33, 27295744
  buffer_load_dwordx4 v[56:59], v10, s[8:11], s30 offen
  s_add_u32 s30, s33, 29917184
  buffer_load_dwordx4 v[68:71], v10, s[8:11], s30 offen
  s_add_u32 s30, s33, 32538624
  buffer_load_dwordx4 v[80:83], v10, s[8:11], s30 offen
  s_add_u32 s30, s33, 35160064
  buffer_load_dwordx4 v[92:95], v10, s[8:11], s30 offen
  s_add_u32 s30, s28, 21037056
  buffer_load_dwordx4 v[32:35], v9, s[8:11], s30 offen
  s_add_u32 s30, s28, 21038080
  buffer_load_dwordx4 v[36:39], v9, s[8:11], s30 offen
g3_104:
  s_mul_i32 s30, s22, 122880
  s_mul_i32 s31, s21, 30720
  s_add_u32 s30, s30, s31
  s_add_u32 s30, s30, 0xe100000
  s_add_u32 m0, s31, 0
  s_add_u32 s29, s30, 0
  buffer_load_dwordx4 v2, s[8:11], s29 offen lds
  s_add_u32 m0, s31, 1024
  s_add_u32 s29, s30, 1024
  buffer_load_dwordx4 v2, s[8:11], s29 offen lds
  s_add_u32 m0, s31, 2048
  s_add_u32 s29, s30, 2048
  buffer_load_dwordx4 v2, s[8:11], s29 offen lds
  s_add_u32 m0, s31, 3072
  s_add_u32 s29, s30, 3072
  buffer_load_dwordx4 v2, s[8:11], s29 offen lds
  s_add_u32 m0, s31, 4096
  s_add_u32 s29, s30, 4096
  buffer_load_dwordx4 v2, s[8:11], s29 offen lds
  s_add_u32 m0, s31, 5120
  s_add_u32 s29, s30, 5120
  buffer_load_dwordx4 v2, s[8:11], s29 offen lds
  s_add_u32 m0, s31, 6144
  s_add_u32 s29, s30, 6144
  buffer_load_dwordx4 v2, s[8:11], s29 offen lds
  s_add_u32 m0, s31, 7168
  s_add_u32 s29, s30, 7168
  buffer_load_dwordx4 v2, s[8:11], s29 offen lds
  s_add_u32 m0, s31, 8192
  s_add_u32 s29, s30, 8192
  buffer_load_dwordx4 v2, s[8:11], s29 offen lds
  s_add_u32 m0, s31, 9216
  s_add_u32 s29, s30, 9216
  buffer_load_dwordx4 v2, s[8:11], s29 offen lds
  s_add_u32 m0, s31, 10240
  s_add_u32 s29, s30, 10240
  buffer_load_dwordx4 v2, s[8:11], s29 offen lds
  s_add_u32 m0, s31, 11264
  s_add_u32 s29, s30, 11264
  buffer_load_dwordx4 v2, s[8:11], s29 offen lds
  s_add_u32 m0, s31, 12288
  s_add_u32 s29, s30, 12288
  buffer_load_dwordx4 v2, s[8:11], s29 offen lds
  s_add_u32 m0, s31, 13312
  s_add_u32 s29, s30, 13312
  buffer_load_dwordx4 v2, s[8:11], s29 offen lds
  s_add_u32 m0, s31, 14336
  s_add_u32 s29, s30, 14336
  buffer_load_dwordx4 v2, s[8:11], s29 offen lds
  s_add_u32 m0, s31, 15360
  s_add_u32 s29, s30, 15360
  buffer_load_dwordx4 v2, s[8:11], s29 offen lds
  s_add_u32 m0, s31, 16384
  s_add_u32 s29, s30, 16384
  buffer_load_dwordx4 v2, s[8:11], s29 offen lds
  s_add_u32 m0, s31, 17408
  s_add_u32 s29, s30, 17408
  buffer_load_dwordx4 v2, s[8:11], s29 offen lds
  s_add_u32 m0, s31, 18432
  s_add_u32 s29, s30, 18432
  buffer_load_dwordx4 v2, s[8:11], s29 offen lds
  s_add_u32 m0, s31, 19456
  s_add_u32 s29, s30, 19456
  buffer_load_dwordx4 v2, s[8:11], s29 offen lds
  s_add_u32 m0, s31, 20480
  s_add_u32 s29, s30, 20480
  buffer_load_dwordx4 v2, s[8:11], s29 offen lds
  s_add_u32 m0, s31, 21504
  s_add_u32 s29, s30, 21504
  buffer_load_dwordx4 v2, s[8:11], s29 offen lds
  s_add_u32 m0, s31, 22528
  s_add_u32 s29, s30, 22528
  buffer_load_dwordx4 v2, s[8:11], s29 offen lds
  s_add_u32 m0, s31, 23552
  s_add_u32 s29, s30, 23552
  buffer_load_dwordx4 v2, s[8:11], s29 offen lds
  s_add_u32 m0, s31, 24576
  s_add_u32 s29, s30, 24576
  buffer_load_dwordx4 v2, s[8:11], s29 offen lds
  s_add_u32 m0, s31, 25600
  s_add_u32 s29, s30, 25600
  buffer_load_dwordx4 v2, s[8:11], s29 offen lds
  s_add_u32 m0, s31, 26624
  s_add_u32 s29, s30, 26624
  buffer_load_dwordx4 v2, s[8:11], s29 offen lds
  s_add_u32 m0, s31, 27648
  s_add_u32 s29, s30, 27648
  buffer_load_dwordx4 v2, s[8:11], s29 offen lds
  s_add_u32 m0, s31, 28672
  s_add_u32 s29, s30, 28672
  buffer_load_dwordx4 v2, s[8:11], s29 offen lds
  s_add_u32 m0, s31, 29696
  s_add_u32 s29, s30, 29696
  buffer_load_dwordx4 v2, s[8:11], s29 offen lds
  s_waitcnt vmcnt(30)
  v_lshlrev_b32 v12, 16, v48
  v_and_b32 v13, 0xffff0000, v48
  v_pk_add_f32 v[16:17], v[16:17], v[12:13]
  v_lshlrev_b32 v12, 16, v49
  v_and_b32 v13, 0xffff0000, v49
  v_pk_add_f32 v[18:19], v[18:19], v[12:13]
  v_lshlrev_b32 v12, 16, v50
  v_and_b32 v13, 0xffff0000, v50
  v_pk_add_f32 v[20:21], v[20:21], v[12:13]
  v_lshlrev_b32 v12, 16, v51
  v_and_b32 v13, 0xffff0000, v51
  v_pk_add_f32 v[22:23], v[22:23], v[12:13]
  v_lshlrev_b32 v12, 16, v52
  v_and_b32 v13, 0xffff0000, v52
  v_pk_add_f32 v[24:25], v[24:25], v[12:13]
  v_lshlrev_b32 v12, 16, v53
  v_and_b32 v13, 0xffff0000, v53
  v_pk_add_f32 v[26:27], v[26:27], v[12:13]
  v_lshlrev_b32 v12, 16, v54
  v_and_b32 v13, 0xffff0000, v54
  v_pk_add_f32 v[28:29], v[28:29], v[12:13]
  v_lshlrev_b32 v12, 16, v55
  v_and_b32 v13, 0xffff0000, v55
  v_pk_add_f32 v[30:31], v[30:31], v[12:13]
  v_lshlrev_b32 v12, 16, v56
  v_and_b32 v13, 0xffff0000, v56
  v_pk_add_f32 v[32:33], v[32:33], v[12:13]
  v_lshlrev_b32 v12, 16, v57
  v_and_b32 v13, 0xffff0000, v57
  v_pk_add_f32 v[34:35], v[34:35], v[12:13]
  v_lshlrev_b32 v12, 16, v58
  v_and_b32 v13, 0xffff0000, v58
  v_pk_add_f32 v[36:37], v[36:37], v[12:13]
  v_lshlrev_b32 v12, 16, v59
  v_and_b32 v13, 0xffff0000, v59
  v_pk_add_f32 v[38:39], v[38:39], v[12:13]
  v_lshlrev_b32 v12, 16, v60
  v_and_b32 v13, 0xffff0000, v60
  v_pk_add_f32 v[16:17], v[16:17], v[12:13]
  v_lshlrev_b32 v12, 16, v61
  v_and_b32 v13, 0xffff0000, v61
  v_pk_add_f32 v[18:19], v[18:19], v[12:13]
  v_lshlrev_b32 v12, 16, v62
  v_and_b32 v13, 0xffff0000, v62
  v_pk_add_f32 v[20:21], v[20:21], v[12:13]
  v_lshlrev_b32 v12, 16, v63
  v_and_b32 v13, 0xffff0000, v63
  v_pk_add_f32 v[22:23], v[22:23], v[12:13]
  v_lshlrev_b32 v12, 16, v64
  v_and_b32 v13, 0xffff0000, v64
  v_pk_add_f32 v[24:25], v[24:25], v[12:13]
  v_lshlrev_b32 v12, 16, v65
  v_and_b32 v13, 0xffff0000, v65
  v_pk_add_f32 v[26:27], v[26:27], v[12:13]
  v_lshlrev_b32 v12, 16, v66
  v_and_b32 v13, 0xffff0000, v66
  v_pk_add_f32 v[28:29], v[28:29], v[12:13]
  v_lshlrev_b32 v12, 16, v67
  v_and_b32 v13, 0xffff0000, v67
  v_pk_add_f32 v[30:31], v[30:31], v[12:13]
  v_lshlrev_b32 v12, 16, v68
  v_and_b32 v13, 0xffff0000, v68
  v_pk_add_f32 v[32:33], v[32:33], v[12:13]
  v_lshlrev_b32 v12, 16, v69
  v_and_b32 v13, 0xffff0000, v69
  v_pk_add_f32 v[34:35], v[34:35], v[12:13]
  v_lshlrev_b32 v12, 16, v70
  v_and_b32 v13, 0xffff0000, v70
  v_pk_add_f32 v[36:37], v[36:37], v[12:13]
  v_lshlrev_b32 v12, 16, v71
  v_and_b32 v13, 0xffff0000, v71
  v_pk_add_f32 v[38:39], v[38:39], v[12:13]
  v_lshlrev_b32 v12, 16, v72
  v_and_b32 v13, 0xffff0000, v72
  v_pk_add_f32 v[16:17], v[16:17], v[12:13]
  v_lshlrev_b32 v12, 16, v73
  v_and_b32 v13, 0xffff0000, v73
  v_pk_add_f32 v[18:19], v[18:19], v[12:13]
  v_lshlrev_b32 v12, 16, v74
  v_and_b32 v13, 0xffff0000, v74
  v_pk_add_f32 v[20:21], v[20:21], v[12:13]
  v_lshlrev_b32 v12, 16, v75
  v_and_b32 v13, 0xffff0000, v75
  v_pk_add_f32 v[22:23], v[22:23], v[12:13]
  v_lshlrev_b32 v12, 16, v76
  v_and_b32 v13, 0xffff0000, v76
  v_pk_add_f32 v[24:25], v[24:25], v[12:13]
  v_lshlrev_b32 v12, 16, v77
  v_and_b32 v13, 0xffff0000, v77
  v_pk_add_f32 v[26:27], v[26:27], v[12:13]
  v_lshlrev_b32 v12, 16, v78
  v_and_b32 v13, 0xffff0000, v78
  v_pk_add_f32 v[28:29], v[28:29], v[12:13]
  v_lshlrev_b32 v12, 16, v79
  v_and_b32 v13, 0xffff0000, v79
  v_pk_add_f32 v[30:31], v[30:31], v[12:13]
  v_lshlrev_b32 v12, 16, v80
  v_and_b32 v13, 0xffff0000, v80
  v_pk_add_f32 v[32:33], v[32:33], v[12:13]
  v_lshlrev_b32 v12, 16, v81
  v_and_b32 v13, 0xffff0000, v81
  v_pk_add_f32 v[34:35], v[34:35], v[12:13]
  v_lshlrev_b32 v12, 16, v82
  v_and_b32 v13, 0xffff0000, v82
  v_pk_add_f32 v[36:37], v[36:37], v[12:13]
  v_lshlrev_b32 v12, 16, v83
  v_and_b32 v13, 0xffff0000, v83
  v_pk_add_f32 v[38:39], v[38:39], v[12:13]
  v_lshlrev_b32 v12, 16, v84
  v_and_b32 v13, 0xffff0000, v84
  v_pk_add_f32 v[16:17], v[16:17], v[12:13]
  v_lshlrev_b32 v12, 16, v85
  v_and_b32 v13, 0xffff0000, v85
  v_pk_add_f32 v[18:19], v[18:19], v[12:13]
  v_lshlrev_b32 v12, 16, v86
  v_and_b32 v13, 0xffff0000, v86
  v_pk_add_f32 v[20:21], v[20:21], v[12:13]
  v_lshlrev_b32 v12, 16, v87
  v_and_b32 v13, 0xffff0000, v87
  v_pk_add_f32 v[22:23], v[22:23], v[12:13]
  v_lshlrev_b32 v12, 16, v88
  v_and_b32 v13, 0xffff0000, v88
  v_pk_add_f32 v[24:25], v[24:25], v[12:13]
  v_lshlrev_b32 v12, 16, v89
  v_and_b32 v13, 0xffff0000, v89
  v_pk_add_f32 v[26:27], v[26:27], v[12:13]
  v_lshlrev_b32 v12, 16, v90
  v_and_b32 v13, 0xffff0000, v90
  v_pk_add_f32 v[28:29], v[28:29], v[12:13]
  v_lshlrev_b32 v12, 16, v91
  v_and_b32 v13, 0xffff0000, v91
  v_pk_add_f32 v[30:31], v[30:31], v[12:13]
  v_lshlrev_b32 v12, 16, v92
  v_and_b32 v13, 0xffff0000, v92
  v_pk_add_f32 v[32:33], v[32:33], v[12:13]
  v_lshlrev_b32 v12, 16, v93
  v_and_b32 v13, 0xffff0000, v93
  v_pk_add_f32 v[34:35], v[34:35], v[12:13]
  v_lshlrev_b32 v12, 16, v94
  v_and_b32 v13, 0xffff0000, v94
  v_pk_add_f32 v[36:37], v[36:37], v[12:13]
  v_lshlrev_b32 v12, 16, v95
  v_and_b32 v13, 0xffff0000, v95
  v_pk_add_f32 v[38:39], v[38:39], v[12:13]
  s_add_u32 s30, s28, 20971520
  buffer_store_dwordx4 v[16:19], v9, s[8:11], s30 offen sc1
  s_add_u32 s30, s28, 20972544
  buffer_store_dwordx4 v[20:23], v9, s[8:11], s30 offen sc1
  s_add_u32 s30, s28, 21004288
  buffer_store_dwordx4 v[24:27], v9, s[8:11], s30 offen sc1
  s_add_u32 s30, s28, 21005312
  buffer_store_dwordx4 v[28:31], v9, s[8:11], s30 offen sc1
  s_cmp_lt_u32 s21, 2
  s_cbranch_scc0 g3_105
  s_add_u32 s30, s28, 21037056
  buffer_store_dwordx4 v[32:35], v9, s[8:11], s30 offen sc1
  s_add_u32 s30, s28, 21038080
  buffer_store_dwordx4 v[36:39], v9, s[8:11], s30 offen sc1
g3_105:
  v_add_f32 v12, v16, v17
  v_add_f32 v12, v12, v18
  v_add_f32 v12, v12, v19
  v_add_f32 v12, v12, v20
  v_add_f32 v12, v12, v21
  v_add_f32 v12, v12, v22
  v_add_f32 v12, v12, v23
  v_add_f32 v12, v12, v24
  v_add_f32 v12, v12, v25
  v_add_f32 v12, v12, v26
  v_add_f32 v12, v12, v27
  v_add_f32 v12, v12, v28
  v_add_f32 v12, v12, v29
  v_add_f32 v12, v12, v30
  v_add_f32 v12, v12, v31
  v_add_f32 v12, v12, v32
  v_add_f32 v12, v12, v33
  v_add_f32 v12, v12, v34
  v_add_f32 v12, v12, v35
  v_add_f32 v12, v12, v36
  v_add_f32 v12, v12, v37
  v_add_f32 v12, v12, v38
  v_add_f32 v12, v12, v39
  s_nop 1
  v_add_f32_dpp v12, v12, v12 row_ror:8 row_mask:0xf bank_mask:0xf
  v_mov_b32 v13, v12
  s_nop 1
  v_permlane16_swap_b32 v12, v13
  v_add_f32 v12, v12, v13
  v_mov_b32 v13, v12
  s_nop 1
  v_permlane32_swap_b32 v12, v13
  v_add_f32 v12, v12, v13
  v_lshlrev_b32 v14, 2, v5
  v_add_u32 v14, 131072, v14
  s_lshl_b32 s30, s21, 5
  v_add_u32 v15, s30, v14
  ds_write_b32 v15, v12
  s_waitcnt lgkmcnt(0)
  s_barrier
  ds_read_b32 v48, v14
  ds_read_b32 v49, v14 offset:32
  ds_read_b32 v50, v14 offset:64
  ds_read_b32 v51, v14 offset:96
  s_waitcnt lgkmcnt(0)
  v_add_f32 v48, v48, v49
  v_add_f32 v50, v50, v51
  v_add_f32 v48, v48, v50
  v_mul_f32 v48, 0x3acccccd, v48
  v_sub_f32 v56, v16, v48
  v_sub_f32 v57, v17, v48
  v_sub_f32 v58, v18, v48
  v_sub_f32 v59, v19, v48
  v_sub_f32 v60, v20, v48
  v_sub_f32 v61, v21, v48
  v_sub_f32 v62, v22, v48
  v_sub_f32 v63, v23, v48
  v_sub_f32 v64, v24, v48
  v_sub_f32 v65, v25, v48
  v_sub_f32 v66, v26, v48
  v_sub_f32 v67, v27, v48
  v_sub_f32 v68, v28, v48
  v_sub_f32 v69, v29, v48
  v_sub_f32 v70, v30, v48
  v_sub_f32 v71, v31, v48
  v_sub_f32 v72, v32, v48
  v_sub_f32 v73, v33, v48
  v_sub_f32 v74, v34, v48
  v_sub_f32 v75, v35, v48
  v_sub_f32 v76, v36, v48
  v_sub_f32 v77, v37, v48
  v_sub_f32 v78, v38, v48
  v_sub_f32 v79, v39, v48
  s_cmp_lt_u32 s21, 2
  s_cbranch_scc1 g3z_106
  v_mov_b32 v72, 0
  v_mov_b32 v73, 0
  v_mov_b32 v74, 0
  v_mov_b32 v75, 0
  v_mov_b32 v76, 0
  v_mov_b32 v77, 0
  v_mov_b32 v78, 0
  v_mov_b32 v79, 0
g3z_106:
  v_mul_f32 v12, v56, v56
  v_fmac_f32 v12, v57, v57
  v_fmac_f32 v12, v58, v58
  v_fmac_f32 v12, v59, v59
  v_fmac_f32 v12, v60, v60
  v_fmac_f32 v12, v61, v61
  v_fmac_f32 v12, v62, v62
  v_fmac_f32 v12, v63, v63
  v_fmac_f32 v12, v64, v64
  v_fmac_f32 v12, v65, v65
  v_fmac_f32 v12, v66, v66
  v_fmac_f32 v12, v67, v67
  v_fmac_f32 v12, v68, v68
  v_fmac_f32 v12, v69, v69
  v_fmac_f32 v12, v70, v70
  v_fmac_f32 v12, v71, v71
  v_fmac_f32 v12, v72, v72
  v_fmac_f32 v12, v73, v73
  v_fmac_f32 v12, v74, v74
  v_fmac_f32 v12, v75, v75
  v_fmac_f32 v12, v76, v76
  v_fmac_f32 v12, v77, v77
  v_fmac_f32 v12, v78, v78
  v_fmac_f32 v12, v79, v79
  s_nop 1
  v_add_f32_dpp v12, v12, v12 row_ror:8 row_mask:0xf bank_mask:0xf
  v_mov_b32 v13, v12
  s_nop 1
  v_permlane16_swap_b32 v12, v13
  v_add_f32 v12, v12, v13
  v_mov_b32 v13, v12
  s_nop 1
  v_permlane32_swap_b32 v12, v13
  v_add_f32 v12, v12, v13
  v_lshlrev_b32 v14, 2, v5
  v_add_u32 v14, 131328, v14
  s_lshl_b32 s30, s21, 5
  v_add_u32 v15, s30, v14
  ds_write_b32 v15, v12
  s_waitcnt lgkmcnt(0)
  s_barrier
  ds_read_b32 v48, v14
  ds_read_b32 v49, v14 offset:32
  ds_read_b32 v50, v14 offset:64
  ds_read_b32 v51, v14 offset:96
  s_waitcnt lgkmcnt(0)
  v_add_f32 v48, v48, v49
  v_add_f32 v50, v50, v51
  v_add_f32 v48, v48, v50
  v_mov_b32 v49, 0x3727c5ac
  v_fmac_f32 v49, 0x3acccccd, v48
  v_rsq_f32 v49, v49
  s_nop 0
  v_mul_f32 v56, v56, v49
  v_mul_f32 v57, v57, v49
  v_mul_f32 v58, v58, v49
  v_mul_f32 v59, v59, v49
  v_mul_f32 v60, v60, v49
  v_mul_f32 v61, v61, v49
  v_mul_f32 v62, v62, v49
  v_mul_f32 v63, v63, v49
  v_mul_f32 v64, v64, v49
  v_mul_f32 v65, v65, v49
  v_mul_f32 v66, v66, v49
  v_mul_f32 v67, v67, v49
  v_mul_f32 v68, v68, v49
  v_mul_f32 v69, v69, v49
  v_mul_f32 v70, v70, v49
  v_mul_f32 v71, v71, v49
  v_mul_f32 v72, v72, v49
  v_mul_f32 v73, v73, v49
  v_mul_f32 v74, v74, v49
  v_mul_f32 v75, v75, v49
  v_mul_f32 v76, v76, v49
  v_mul_f32 v77, v77, v49
  v_mul_f32 v78, v78, v49
  v_mul_f32 v79, v79, v49
  v_cvt_pk_bf16_f32 v80, v56, v57
  v_cvt_pk_bf16_f32 v81, v58, v59
  v_cvt_pk_bf16_f32 v82, v60, v61
  v_cvt_pk_bf16_f32 v83, v62, v63
  v_cvt_pk_bf16_f32 v84, v64, v65
  v_cvt_pk_bf16_f32 v85, v66, v67
  v_cvt_pk_bf16_f32 v86, v68, v69
  v_cvt_pk_bf16_f32 v87, v70, v71
  v_cvt_pk_bf16_f32 v88, v72, v73
  v_cvt_pk_bf16_f32 v89, v74, v75
  v_cvt_pk_bf16_f32 v90, v76, v77
  v_cvt_pk_bf16_f32 v91, v78, v79
  s_mul_i32 s30, s26, 40960
  s_lshl_b32 s31, s21, 12
  s_add_u32 s30, s30, s31
  s_add_u32 s30, s30, 0x100000
  s_add_u32 s31, s30, 0
  buffer_store_dwordx4 v[80:83], v10, s[8:11], s31 offen sc1
  s_add_u32 s31, s30, 16384
  buffer_store_dwordx4 v[84:87], v10, s[8:11], s31 offen sc1
  s_cmp_lt_u32 s21, 2
  s_cbranch_scc0 g3_107
  s_add_u32 s31, s30, 32768
  buffer_store_dwordx4 v[88:91], v10, s[8:11], s31 offen sc1
g3_107:
  s_waitcnt vmcnt(0)
  s_barrier
  s_cmp_eq_u32 s21, 0
  s_cbranch_scc0 arr_108
  s_mov_b64 s[24:25], exec
  s_mov_b64 exec, 1
  v_mov_b32 v3, 0
  v_mov_b32 v4, 1
  buffer_atomic_add v4, v3, s[8:11], s46 offen
  s_mov_b64 exec, s[24:25]
arr_108:
  s_mov_b32 s45, 0
  v_mov_b32 v3, 0
aw_109:
  buffer_load_dword v4, v3, s[8:11], s46 offen sc1
  s_add_u32 s45, s45, 1
  s_waitcnt vmcnt(0)
  v_readfirstlane_b32 s29, v4
  s_cmp_ge_u32 s29, 32
  s_cbranch_scc1 aw_109_ok
  s_cmp_lt_u32 s45, 400000
  s_cbranch_scc1 aw_109
  s_branch kb2_abort
aw_109_ok:
  s_barrier
  s_lshl_b32 s26, s23, 3
  s_lshl_b32 s27, s21, 1
  s_add_u32 s24, s26, s27
  s_mul_i32 s27, s24, 40960
  s_add_u32 s27, s27, 0x100000
  s_add_u32 s28, s27, 40960
  v_mov_b32 v3, v2
  v_add_u32 v4, 65536, v2
  v_lshlrev_b32 v5, 7, v1
  s_add_u32 s29, s27, 0
  buffer_load_dword v10, v5, s[8:11], s29 offen sc1
  s_add_u32 s29, s27, 8192
  buffer_load_dword v10, v5, s[8:11], s29 offen sc1
  s_add_u32 s29, s27, 16384
  buffer_load_dword v10, v5, s[8:11], s29 offen sc1
  s_add_u32 s29, s27, 24576
  buffer_load_dword v10, v5, s[8:11], s29 offen sc1
  s_add_u32 s29, s27, 32768
  buffer_load_dword v10, v5, s[8:11], s29 offen sc1
  s_add_u32 s29, s27, 40960
  buffer_load_dword v10, v5, s[8:11], s29 offen sc1
  s_add_u32 s29, s27, 49152
  buffer_load_dword v10, v5, s[8:11], s29 offen sc1
  s_add_u32 s29, s27, 57344
  buffer_load_dword v10, v5, s[8:11], s29 offen sc1
  s_add_u32 s29, s27, 65536
  buffer_load_dword v10, v5, s[8:11], s29 offen sc1
  s_add_u32 s29, s27, 73728
  buffer_load_dword v10, v5, s[8:11], s29 offen sc1
  s_mov_b32 s30, 0x3ea52b5c
  v_mov_b32 v5, 0
  v_cmp_gt_u32 s[34:35], 32, v1
  v_mov_b32 v6, 1.0
  v_and_b32 v7, 31, v1
  v_cndmask_b32 v6, v5, v6, s[34:35]
  v_cmp_eq_u32 s[32:33], 20, v7
  v_mov_b32 v8, 1.0
  s_lshl_b32 s31, s22, 6
  s_add_u32 s31, s31, s24
  s_lshl_b32 s31, s31, 11
  v_mov_b32 v9, 0
  s_add_u32 s29, s27, 0
  buffer_load_dwordx4 v[16:19], v2, s[8:11], s29 offen sc1
  s_add_u32 s29, s27, 1024
  buffer_load_dwordx4 v[20:23], v2, s[8:11], s29 offen sc1
  s_add_u32 s29, s27, 2048
  buffer_load_dwordx4 v[24:27], v2, s[8:11], s29 offen sc1
  s_add_u32 s29, s27, 3072
  buffer_load_dwordx4 v[28:31], v2, s[8:11], s29 offen sc1
  s_add_u32 s29, s27, 4096
  buffer_load_dwordx4 v[32:35], v2, s[8:11], s29 offen sc1
  s_add_u32 s29, s27, 5120
  buffer_load_dwordx4 v[36:39], v2, s[8:11], s29 offen sc1
  s_add_u32 s29, s27, 6144
  buffer_load_dwordx4 v[40:43], v2, s[8:11], s29 offen sc1
  s_add_u32 s29, s27, 7168
  buffer_load_dwordx4 v[44:47], v2, s[8:11], s29 offen sc1
  s_add_u32 s29, s27, 8192
  buffer_load_dwordx4 v[48:51], v2, s[8:11], s29 offen sc1
  s_add_u32 s29, s27, 9216
  buffer_load_dwordx4 v[52:55], v2, s[8:11], s29 offen sc1
  s_add_u32 s29, s27, 10240
  buffer_load_dwordx4 v[56:59], v2, s[8:11], s29 offen sc1
  s_add_u32 s29, s27, 11264
  buffer_load_dwordx4 v[60:63], v2, s[8:11], s29 offen sc1
  s_add_u32 s29, s27, 12288
  buffer_load_dwordx4 v[64:67], v2, s[8:11], s29 offen sc1
  s_add_u32 s29, s27, 13312
  buffer_load_dwordx4 v[68:71], v2, s[8:11], s29 offen sc1
  s_add_u32 s29, s27, 14336
  buffer_load_dwordx4 v[72:75], v2, s[8:11], s29 offen sc1
  ds_read_b128 v[208:211], v3 offset:0
  ds_read_b128 v[212:215], v3 offset:40960
  ds_read_b128 v[216:219], v4 offset:16384
  s_add_u32 s29, s27, 15360
  buffer_load_dwordx4 v[76:79], v2, s[8:11], s29 offen sc1
  ds_read_b128 v[220:223], v3 offset:1024
  ds_read_b128 v[224:227], v3 offset:41984
  ds_read_b128 v[228:231], v4 offset:17408
  s_waitcnt lgkmcnt(3)
  s_waitcnt vmcnt(15)
  v_mfma_f32_32x32x16_bf16 v[80:95], v[208:211], v[16:19], 0
  v_mfma_f32_32x32x16_bf16 v[96:111], v[212:215], v[16:19], 0
  v_mfma_f32_32x32x16_bf16 v[112:127], v[16:19], v[216:219], 0
  s_add_u32 s29, s27, 16384
  buffer_load_dwordx4 v[16:19], v2, s[8:11], s29 offen sc1
  ds_read_b128 v[208:211], v3 offset:2048
  ds_read_b128 v[212:215], v3 offset:43008
  ds_read_b128 v[216:219], v4 offset:18432
  s_waitcnt lgkmcnt(3)
  s_waitcnt vmcnt(15)
  v_mfma_f32_32x32x16_bf16 v[80:95], v[220:223], v[20:23], v[80:95]
  v_mfma_f32_32x32x16_bf16 v[96:111], v[224:227], v[20:23], v[96:111]
  v_mfma_f32_32x32x16_bf16 v[112:127], v[20:23], v[228:231], v[112:127]
  s_add_u32 s29, s27, 17408
  buffer_load_dwordx4 v[20:23], v2, s[8:11], s29 offen sc1
  ds_read_b128 v[220:223], v3 offset:3072
  ds_read_b128 v[224:227], v3 offset:44032
  ds_read_b128 v[228:231], v4 offset:19456
  s_waitcnt lgkmcnt(3)
  s_waitcnt vmcnt(15)
  v_mfma_f32_32x32x16_bf16 v[80:95], v[208:211], v[24:27], v[80:95]
  v_mfma_f32_32x32x16_bf16 v[96:111], v[212:215], v[24:27], v[96:111]
  v_mfma_f32_32x32x16_bf16 v[112:127], v[24:27], v[216:219], v[112:127]
  s_add_u32 s29, s27, 18432
  buffer_load_dwordx4 v[24:27], v2, s[8:11], s29 offen sc1
  ds_read_b128 v[208:211], v3 offset:4096
  ds_read_b128 v[212:215], v3 offset:45056
  ds_read_b128 v[216:219], v4 offset:20480
  s_waitcnt lgkmcnt(3)
  s_waitcnt vmcnt(15)
  v_mfma_f32_32x32x16_bf16 v[80:95], v[220:223], v[28:31], v[80:95]
  v_mfma_f32_32x32x16_bf16 v[96:111], v[224:227], v[28:31], v[96:111]
  v_mfma_f32_32x32x16_bf16 v[112:127], v[28:31], v[228:231], v[112:127]
  s_add_u32 s29, s27, 19456
  buffer_load_dwordx4 v[28:31], v2, s[8:11], s29 offen sc1
  ds_read_b128 v[220:223], v3 offset:5120
  ds_read_b128 v[224:227], v3 offset:46080
  ds_read_b128 v[228:231], v4 offset:21504
  s_waitcnt lgkmcnt(3)
  s_waitcnt vmcnt(15)
  v_mfma_f32_32x32x16_bf16 v[80:95], v[208:211], v[32:35], v[80:95]
  v_mfma_f32_32x32x16_bf16 v[96:111], v[212:215], v[32:35], v[96:111]
  v_mfma_f32_32x32x16_bf16 v[112:127], v[32:35], v[216:219], v[112:127]
  s_add_u32 s29, s27, 20480
  buffer_load_dwordx4 v[32:35], v2, s[8:11], s29 offen sc1
  ds_read_b128 v[208:211], v3 offset:6144
  ds_read_b128 v[212:215], v3 offset:47104
  ds_read_b128 v[216:219], v4 offset:22528
  s_waitcnt lgkmcnt(3)
  s_waitcnt vmcnt(15)
  v_mfma_f32_32x32x16_bf16 v[80:95], v[220:223], v[36:39], v[80:95]
  v_mfma_f32_32x32x16_bf16 v[96:111], v[224:227], v[36:39], v[96:111]
  v_mfma_f32_32x32x16_bf16 v[112:127], v[36:39], v[228:231], v[112:127]
  s_add_u32 s29, s27, 21504
  buffer_load_dwordx4 v[36:39], v2, s[8:11], s29 offen sc1
  ds_read_b128 v[220:223], v3 offset:7168
  ds_read_b128 v[224:227], v3 offset:48128
  ds_read_b128 v[228:231], v4 offset:23552
  s_waitcnt lgkmcnt(3)
  s_waitcnt vmcnt(15)
  v_mfma_f32_32x32x16_bf16 v[80:95], v[208:211], v[40:43], v[80:95]
  v_mfma_f32_32x32x16_bf16 v[96:111], v[212:215], v[40:43], v[96:111]
  v_mfma_f32_32x32x16_bf16 v[112:127], v[40:43], v[216:219], v[112:127]
  s_add_u32 s29, s27, 22528
  buffer_load_dwordx4 v[40:43], v2, s[8:11], s29 offen sc1
  ds_read_b128 v[208:211], v3 offset:8192
  ds_read_b128 v[212:215], v3 offset:49152
  ds_read_b128 v[216:219], v4 offset:24576
  s_waitcnt lgkmcnt(3)
  s_waitcnt vmcnt(15)
  v_mfma_f32_32x32x16_bf16 v[80:95], v[220:223], v[44:47], v[80:95]
  v_mfma_f32_32x32x16_bf16 v[96:111], v[224:227], v[44:47], v[96:111]
  v_mfma_f32_32x32x16_bf16 v[112:127], v[44:47], v[228:231], v[112:127]
  s_add_u32 s29, s27, 23552
  buffer_load_dwordx4 v[44:47], v2, s[8:11], s29 offen sc1
  ds_read_b128 v[220:223], v3 offset:9216
  ds_read_b128 v[224:227], v3 offset:50176
  ds_read_b128 v[228:231], v4 offset:25600
  s_waitcnt lgkmcnt(3)
  s_waitcnt vmcnt(15)
  v_mfma_f32_32x32x16_bf16 v[80:95], v[208:211], v[48:51], v[80:95]
  v_mfma_f32_32x32x16_bf16 v[96:111], v[212:215], v[48:51], v[96:111]
  v_mfma_f32_32x32x16_bf16 v[112:127], v[48:51], v[216:219], v[112:127]
  s_add_u32 s29, s27, 24576
  buffer_load_dwordx4 v[48:51], v2, s[8:11], s29 offen sc1
  ds_read_b128 v[208:211], v3 offset:10240
  ds_read_b128 v[212:215], v3 offset:51200
  ds_read_b128 v[216:219], v4 offset:26624
  s_waitcnt lgkmcnt(3)
  s_waitcnt vmcnt(15)
  v_mfma_f32_32x32x16_bf16 v[80:95], v[220:223], v[52:55], v[80:95]
  v_mfma_f32_32x32x16_bf16 v[96:111], v[224:227], v[52:55], v[96:111]
  v_mfma_f32_32x32x16_bf16 v[112:127], v[52:55], v[228:231], v[112:127]
  s_add_u32 s29, s27, 25600
  buffer_load_dwordx4 v[52:55], v2, s[8:11], s29 offen sc1
  ds_read_b128 v[220:223], v3 offset:11264
  ds_read_b128 v[224:227], v3 offset:52224
  ds_read_b128 v[228:231], v4 offset:27648
  s_waitcnt lgkmcnt(3)
  s_waitcnt vmcnt(15)
  v_mfma_f32_32x32x16_bf16 v[80:95], v[208:211], v[56:59], v[80:95]
  v_mfma_f32_32x32x16_bf16 v[96:111], v[212:215], v[56:59], v[96:111]
  v_mfma_f32_32x32x16_bf16 v[112:127], v[56:59], v[216:219], v[112:127]
  s_add_u32 s29, s27, 26624
  buffer_load_dwordx4 v[56:59], v2, s[8:11], s29 offen sc1
  ds_read_b128 v[208:211], v3 offset:12288
  ds_read_b128 v[212:215], v3 offset:53248
  ds_read_b128 v[216:219], v4 offset:28672
  s_waitcnt lgkmcnt(3)
  s_waitcnt vmcnt(15)
  v_mfma_f32_32x32x16_bf16 v[80:95], v[220:223], v[60:63], v[80:95]
  v_mfma_f32_32x32x16_bf16 v[96:111], v[224:227], v[60:63], v[96:111]
  v_mfma_f32_32x32x16_bf16 v[112:127], v[60:63], v[228:231], v[112:127]
  s_add_u32 s29, s27, 27648
  buffer_load_dwordx4 v[60:63], v2, s[8:11], s29 offen sc1
  ds_read_b128 v[220:223], v3 offset:13312
  ds_read_b128 v[224:227], v3 offset:54272
  ds_read_b128 v[228:231], v4 offset:29696
  s_waitcnt lgkmcnt(3)
  s_waitcnt vmcnt(15)
  v_mfma_f32_32x32x16_bf16 v[80:95], v[208:211], v[64:67], v[80:95]
  v_mfma_f32_32x32x16_bf16 v[96:111], v[212:215], v[64:67], v[96:111]
  v_mfma_f32_32x32x16_bf16 v[112:127], v[64:67], v[216:219], v[112:127]
  s_add_u32 s29, s27, 28672
  buffer_load_dwordx4 v[64:67], v2, s[8:11], s29 offen sc1
  ds_read_b128 v[208:211], v3 offset:14336
  ds_read_b128 v[212:215], v3 offset:55296
  ds_read_b128 v[216:219], v4 offset:30720
  s_waitcnt lgkmcnt(3)
  s_waitcnt vmcnt(15)
  v_mfma_f32_32x32x16_bf16 v[80:95], v[220:223], v[68:71], v[80:95]
  v_mfma_f32_32x32x16_bf16 v[96:111], v[224:227], v[68:71], v[96:111]
  v_mfma_f32_32x32x16_bf16 v[112:127], v[68:71], v[228:231], v[112:127]
  s_add_u32 s29, s27, 29696
  buffer_load_dwordx4 v[68:71], v2, s[8:11], s29 offen sc1
  ds_read_b128 v[220:223], v3 offset:15360
  ds_read_b128 v[224:227], v3 offset:56320
  ds_read_b128 v[228:231], v4 offset:31744
  s_waitcnt lgkmcnt(3)
  s_waitcnt vmcnt(15)
  v_mfma_f32_32x32x16_bf16 v[80:95], v[208:211], v[72:75], v[80:95]
  v_mfma_f32_32x32x16_bf16 v[96:111], v[212:215], v[72:75], v[96:111]
  v_mfma_f32_32x32x16_bf16 v[112:127], v[72:75], v[216:219], v[112:127]
  s_add_u32 s29, s27, 30720
  buffer_load_dwordx4 v[72:75], v2, s[8:11], s29 offen sc1
  ds_read_b128 v[208:211], v3 offset:16384
  ds_read_b128 v[212:215], v3 offset:57344
  ds_read_b128 v[216:219], v4 offset:32768
  s_waitcnt lgkmcnt(3)
  s_waitcnt vmcnt(15)
  v_mfma_f32_32x32x16_bf16 v[80:95], v[220:223], v[76:79], v[80:95]
  v_mfma_f32_32x32x16_bf16 v[96:111], v[224:227], v[76:79], v[96:111]
  v_mfma_f32_32x32x16_bf16 v[112:127], v[76:79], v[228:231], v[112:127]
  s_add_u32 s29, s27, 31744
  buffer_load_dwordx4 v[76:79], v2, s[8:11], s29 offen sc1
  ds_read_b128 v[220:223], v3 offset:17408
  ds_read_b128 v[224:227], v3 offset:58368
  ds_read_b128 v[228:231], v4 offset:33792
  s_waitcnt lgkmcnt(3)
  s_waitcnt vmcnt(15)
  v_mfma_f32_32x32x16_bf16 v[80:95], v[208:211], v[16:19], v[80:95]
  v_mfma_f32_32x32x16_bf16 v[96:111], v[212:215], v[16:19], v[96:111]
  v_mfma_f32_32x32x16_bf16 v[112:127], v[16:19], v[216:219], v[112:127]
  s_add_u32 s29, s27, 32768
  buffer_load_dwordx4 v[16:19], v2, s[8:11], s29 offen sc1
  ds_read_b128 v[208:211], v3 offset:18432
  ds_read_b128 v[212:215], v3 offset:59392
  ds_read_b128 v[216:219], v4 offset:34816
  s_waitcnt lgkmcnt(3)
  s_waitcnt vmcnt(15)
  v_mfma_f32_32x32x16_bf16 v[80:95], v[220:223], v[20:23], v[80:95]
  v_mfma_f32_32x32x16_bf16 v[96:111], v[224:227], v[20:23], v[96:111]
  v_mfma_f32_32x32x16_bf16 v[112:127], v[20:23], v[228:231], v[112:127]
  s_add_u32 s29, s27, 33792
  buffer_load_dwordx4 v[20:23], v2, s[8:11], s29 offen sc1
  ds_read_b128 v[220:223], v3 offset:19456
  ds_read_b128 v[224:227], v3 offset:60416
  ds_read_b128 v[228:231], v4 offset:35840
  s_waitcnt lgkmcnt(3)
  s_waitcnt vmcnt(15)
  v_mfma_f32_32x32x16_bf16 v[80:95], v[208:211], v[24:27], v[80:95]
  v_mfma_f32_32x32x16_bf16 v[96:111], v[212:215], v[24:27], v[96:111]
  v_mfma_f32_32x32x16_bf16 v[112:127], v[24:27], v[216:219], v[112:127]
  s_add_u32 s29, s27, 34816
  buffer_load_dwordx4 v[24:27], v2, s[8:11], s29 offen sc1
  ds_read_b128 v[208:211], v3 offset:20480
  ds_read_b128 v[212:215], v3 offset:61440
  ds_read_b128 v[216:219], v4 offset:36864
  s_waitcnt lgkmcnt(3)
  s_waitcnt vmcnt(15)
  v_mfma_f32_32x32x16_bf16 v[80:95], v[220:223], v[28:31], v[80:95]
  v_mfma_f32_32x32x16_bf16 v[96:111], v[224:227], v[28:31], v[96:111]
  v_mfma_f32_32x32x16_bf16 v[112:127], v[28:31], v[228:231], v[112:127]
  s_add_u32 s29, s27, 35840
  buffer_load_dwordx4 v[28:31], v2, s[8:11], s29 offen sc1
  ds_read_b128 v[220:223], v3 offset:21504
  ds_read_b128 v[224:227], v3 offset:62464
  ds_read_b128 v[228:231], v4 offset:37888
  s_waitcnt lgkmcnt(3)
  s_waitcnt vmcnt(15)
  v_mfma_f32_32x32x16_bf16 v[80:95], v[208:211], v[32:35], v[80:95]
  v_mfma_f32_32x32x16_bf16 v[96:111], v[212:215], v[32:35], v[96:111]
  v_mfma_f32_32x32x16_bf16 v[112:127], v[32:35], v[216:219], v[112:127]
  s_add_u32 s29, s27, 36864
  buffer_load_dwordx4 v[32:35], v2, s[8:11], s29 offen sc1
  ds_read_b128 v[208:211], v3 offset:22528
  ds_read_b128 v[212:215], v3 offset:63488
  ds_read_b128 v[216:219], v4 offset:38912
  s_waitcnt lgkmcnt(3)
  s_waitcnt vmcnt(15)
  v_mfma_f32_32x32x16_bf16 v[80:95], v[220:223], v[36:39], v[80:95]
  v_mfma_f32_32x32x16_bf16 v[96:111], v[224:227], v[36:39], v[96:111]
  v_mfma_f32_32x32x16_bf16 v[112:127], v[36:39], v[228:231], v[112:127]
  s_add_u32 s29, s27, 37888
  buffer_load_dwordx4 v[36:39], v2, s[8:11], s29 offen sc1
  ds_read_b128 v[220:223], v3 offset:23552
  ds_read_b128 v[224:227], v3 offset:64512
  ds_read_b128 v[228:231], v4 offset:39936
  s_waitcnt lgkmcnt(3)
  s_waitcnt vmcnt(15)
  v_mfma_f32_32x32x16_bf16 v[80:95], v[208:211], v[40:43], v[80:95]
  v_mfma_f32_32x32x16_bf16 v[96:111], v[212:215], v[40:43], v[96:111]
  v_mfma_f32_32x32x16_bf16 v[112:127], v[40:43], v[216:219], v[112:127]
  s_add_u32 s29, s27, 38912
  buffer_load_dwordx4 v[40:43], v2, s[8:11], s29 offen sc1
  ds_read_b128 v[208:211], v3 offset:24576
  ds_read_b128 v[212:215], v4 offset:0
  ds_read_b128 v[216:219], v4 offset:40960
  s_waitcnt lgkmcnt(3)
  s_waitcnt vmcnt(15)
  v_mfma_f32_32x32x16_bf16 v[80:95], v[220:223], v[44:47], v[80:95]
  v_mfma_f32_32x32x16_bf16 v[96:111], v[224:227], v[44:47], v[96:111]
  v_mfma_f32_32x32x16_bf16 v[112:127], v[44:47], v[228:231], v[112:127]
  s_add_u32 s29, s27, 39936
  buffer_load_dwordx4 v[44:47], v2, s[8:11], s29 offen sc1
  ds_read_b128 v[220:223], v3 offset:25600
  ds_read_b128 v[224:227], v4 offset:1024
  ds_read_b128 v[228:231], v4 offset:41984
  s_waitcnt lgkmcnt(3)
  s_waitcnt vmcnt(15)
  v_mfma_f32_32x32x16_bf16 v[80:95], v[208:211], v[48:51], v[80:95]
  v_mfma_f32_32x32x16_bf16 v[96:111], v[212:215], v[48:51], v[96:111]
  v_mfma_f32_32x32x16_bf16 v[112:127], v[48:51], v[216:219], v[112:127]
  s_add_u32 s29, s28, 0
  buffer_load_dwordx4 v[48:51], v2, s[8:11], s29 offen sc1
  ds_read_b128 v[208:211], v3 offset:26624
  ds_read_b128 v[212:215], v4 offset:2048
  ds_read_b128 v[216:219], v4 offset:43008
  s_waitcnt lgkmcnt(3)
  s_waitcnt vmcnt(15)
  v_mfma_f32_32x32x16_bf16 v[80:95], v[220:223], v[52:55], v[80:95]
  v_mfma_f32_32x32x16_bf16 v[96:111], v[224:227], v[52:55], v[96:111]
  v_mfma_f32_32x32x16_bf16 v[112:127], v[52:55], v[228:231], v[112:127]
  s_add_u32 s29, s28, 1024
  buffer_load_dwordx4 v[52:55], v2, s[8:11], s29 offen sc1
  ds_read_b128 v[220:223], v3 offset:27648
  ds_read_b128 v[224:227], v4 offset:3072
  ds_read_b128 v[228:231], v4 offset:44032
  s_waitcnt lgkmcnt(3)
  s_waitcnt vmcnt(15)
  v_mfma_f32_32x32x16_bf16 v[80:95], v[208:211], v[56:59], v[80:95]
  v_mfma_f32_32x32x16_bf16 v[96:111], v[212:215], v[56:59], v[96:111]
  v_mfma_f32_32x32x16_bf16 v[112:127], v[56:59], v[216:219], v[112:127]
  s_add_u32 s29, s28, 2048
  buffer_load_dwordx4 v[56:59], v2, s[8:11], s29 offen sc1
  ds_read_b128 v[208:211], v3 offset:28672
  ds_read_b128 v[212:215], v4 offset:4096
  ds_read_b128 v[216:219], v4 offset:45056
  s_waitcnt lgkmcnt(3)
  s_waitcnt vmcnt(15)
  v_mfma_f32_32x32x16_bf16 v[80:95], v[220:223], v[60:63], v[80:95]
  v_mfma_f32_32x32x16_bf16 v[96:111], v[224:227], v[60:63], v[96:111]
  v_mfma_f32_32x32x16_bf16 v[112:127], v[60:63], v[228:231], v[112:127]
  s_add_u32 s29, s28, 3072
  buffer_load_dwordx4 v[60:63], v2, s[8:11], s29 offen sc1
  ds_read_b128 v[220:223], v3 offset:29696
  ds_read_b128 v[224:227], v4 offset:5120
  ds_read_b128 v[228:231], v4 offset:46080
  s_waitcnt lgkmcnt(3)
  s_waitcnt vmcnt(15)
  v_mfma_f32_32x32x16_bf16 v[80:95], v[208:211], v[64:67], v[80:95]
  v_mfma_f32_32x32x16_bf16 v[96:111], v[212:215], v[64:67], v[96:111]
  v_mfma_f32_32x32x16_bf16 v[112:127], v[64:67], v[216:219], v[112:127]
  s_add_u32 s29, s28, 4096
  buffer_load_dwordx4 v[64:67], v2, s[8:11], s29 offen sc1
  ds_read_b128 v[208:211], v3 offset:30720
  ds_read_b128 v[212:215], v4 offset:6144
  ds_read_b128 v[216:219], v4 offset:47104
  s_waitcnt lgkmcnt(3)
  s_waitcnt vmcnt(15)
  v_mfma_f32_32x32x16_bf16 v[80:95], v[220:223], v[68:71], v[80:95]
  v_mfma_f32_32x32x16_bf16 v[96:111], v[224:227], v[68:71], v[96:111]
  v_mfma_f32_32x32x16_bf16 v[112:127], v[68:71], v[228:231], v[112:127]
  s_add_u32 s29, s28, 5120
  buffer_load_dwordx4 v[68:71], v2, s[8:11], s29 offen sc1
  ds_read_b128 v[220:223], v3 offset:31744
  ds_read_b128 v[224:227], v4 offset:7168
  ds_read_b128 v[228:231], v4 offset:48128
  s_waitcnt lgkmcnt(3)
  s_waitcnt vmcnt(15)
  v_mfma_f32_32x32x16_bf16 v[80:95], v[208:211], v[72:75], v[80:95]
  v_mfma_f32_32x32x16_bf16 v[96:111], v[212:215], v[72:75], v[96:111]
  v_mfma_f32_32x32x16_bf16 v[112:127], v[72:75], v[216:219], v[112:127]
  s_add_u32 s29, s28, 6144
  buffer_load_dwordx4 v[72:75], v2, s[8:11], s29 offen sc1
  ds_read_b128 v[208:211], v3 offset:32768
  ds_read_b128 v[212:215], v4 offset:8192
  ds_read_b128 v[216:219], v4 offset:49152
  s_waitcnt lgkmcnt(3)
  s_waitcnt vmcnt(15)
  v_mfma_f32_32x32x16_bf16 v[80:95], v[220:223], v[76:79], v[80:95]
  v_mfma_f32_32x32x16_bf16 v[96:111], v[224:227], v[76:79], v[96:111]
  v_mfma_f32_32x32x16_bf16 v[112:127], v[76:79], v[228:231], v[112:127]
  s_add_u32 s29, s28, 7168
  buffer_load_dwordx4 v[76:79], v2, s[8:11], s29 offen sc1
  ds_read_b128 v[220:223], v3 offset:33792
  ds_read_b128 v[224:227], v4 offset:9216
  ds_read_b128 v[228:231], v4 offset:50176
  s_waitcnt lgkmcnt(3)
  s_waitcnt vmcnt(15)
  v_mfma_f32_32x32x16_bf16 v[80:95], v[208:211], v[16:19], v[80:95]
  v_mfma_f32_32x32x16_bf16 v[96:111], v[212:215], v[16:19], v[96:111]
  v_mfma_f32_32x32x16_bf16 v[112:127], v[16:19], v[216:219], v[112:127]
  s_add_u32 s29, s28, 8192
  buffer_load_dwordx4 v[16:19], v2, s[8:11], s29 offen sc1
  ds_read_b128 v[208:211], v3 offset:34816
  ds_read_b128 v[212:215], v4 offset:10240
  ds_read_b128 v[216:219], v4 offset:51200
  s_waitcnt lgkmcnt(3)
  s_waitcnt vmcnt(15)
  v_mfma_f32_32x32x16_bf16 v[80:95], v[220:223], v[20:23], v[80:95]
  v_mfma_f32_32x32x16_bf16 v[96:111], v[224:227], v[20:23], v[96:111]
  v_mfma_f32_32x32x16_bf16 v[112:127], v[20:23], v[228:231], v[112:127]
  s_add_u32 s29, s28, 9216
  buffer_load_dwordx4 v[20:23], v2, s[8:11], s29 offen sc1
  ds_read_b128 v[220:223], v3 offset:35840
  ds_read_b128 v[224:227], v4 offset:11264
  ds_read_b128 v[228:231], v4 offset:52224
  s_waitcnt lgkmcnt(3)
  s_waitcnt vmcnt(15)
  v_mfma_f32_32x32x16_bf16 v[80:95], v[208:211], v[24:27], v[80:95]
  v_mfma_f32_32x32x16_bf16 v[96:111], v[212:215], v[24:27], v[96:111]
  v_mfma_f32_32x32x16_bf16 v[112:127], v[24:27], v[216:219], v[112:127]
  s_add_u32 s29, s28, 10240
  buffer_load_dwordx4 v[24:27], v2, s[8:11], s29 offen sc1
  ds_read_b128 v[208:211], v3 offset:36864
  ds_read_b128 v[212:215], v4 offset:12288
  ds_read_b128 v[216:219], v4 offset:53248
  s_waitcnt lgkmcnt(3)
  s_waitcnt vmcnt(15)
  v_mfma_f32_32x32x16_bf16 v[80:95], v[220:223], v[28:31], v[80:95]
  v_mfma_f32_32x32x16_bf16 v[96:111], v[224:227], v[28:31], v[96:111]
  v_mfma_f32_32x32x16_bf16 v[112:127], v[28:31], v[228:231], v[112:127]
  s_add_u32 s29, s28, 11264
  buffer_load_dwordx4 v[28:31], v2, s[8:11], s29 offen sc1
  ds_read_b128 v[220:223], v3 offset:37888
  ds_read_b128 v[224:227], v4 offset:13312
  ds_read_b128 v[228:231], v4 offset:54272
  s_waitcnt lgkmcnt(3)
  s_waitcnt vmcnt(15)
  v_mfma_f32_32x32x16_bf16 v[80:95], v[208:211], v[32:35], v[80:95]
  v_mfma_f32_32x32x16_bf16 v[96:111], v[212:215], v[32:35], v[96:111]
  v_mfma_f32_32x32x16_bf16 v[112:127], v[32:35], v[216:219], v[112:127]
  s_add_u32 s29, s28, 12288
  buffer_load_dwordx4 v[32:35], v2, s[8:11], s29 offen sc1
  ds_read_b128 v[208:211], v3 offset:38912
  ds_read_b128 v[212:215], v4 offset:14336
  ds_read_b128 v[216:219], v4 offset:55296
  s_waitcnt lgkmcnt(3)
  s_waitcnt vmcnt(15)
  v_mfma_f32_32x32x16_bf16 v[80:95], v[220:223], v[36:39], v[80:95]
  v_mfma_f32_32x32x16_bf16 v[96:111], v[224:227], v[36:39], v[96:111]
  v_mfma_f32_32x32x16_bf16 v[112:127], v[36:39], v[228:231], v[112:127]
  s_add_u32 s29, s28, 13312
  buffer_load_dwordx4 v[36:39], v2, s[8:11], s29 offen sc1
  ds_read_b128 v[220:223], v3 offset:39936
  ds_read_b128 v[224:227], v4 offset:15360
  ds_read_b128 v[228:231], v4 offset:56320
  s_waitcnt lgkmcnt(3)
  s_waitcnt vmcnt(15)
  v_mfma_f32_32x32x16_bf16 v[80:95], v[208:211], v[40:43], v[80:95]
  v_mfma_f32_32x32x16_bf16 v[96:111], v[212:215], v[40:43], v[96:111]
  v_mfma_f32_32x32x16_bf16 v[112:127], v[40:43], v[216:219], v[112:127]
  s_add_u32 s29, s28, 14336
  buffer_load_dwordx4 v[40:43], v2, s[8:11], s29 offen sc1
  ds_read_b128 v[208:211], v3 offset:0
  ds_read_b128 v[212:215], v3 offset:40960
  ds_read_b128 v[216:219], v4 offset:16384
  s_waitcnt lgkmcnt(3)
  s_waitcnt vmcnt(15)
  v_mfma_f32_32x32x16_bf16 v[80:95], v[220:223], v[44:47], v[80:95]
  v_mfma_f32_32x32x16_bf16 v[96:111], v[224:227], v[44:47], v[96:111]
  v_mfma_f32_32x32x16_bf16 v[112:127], v[44:47], v[228:231], v[112:127]
  s_add_u32 s29, s28, 15360
  buffer_load_dwordx4 v[44:47], v2, s[8:11], s29 offen sc1
  ds_read_b128 v[220:223], v3 offset:1024
  ds_read_b128 v[224:227], v3 offset:41984
  ds_read_b128 v[228:231], v4 offset:17408
  s_waitcnt lgkmcnt(3)
  s_waitcnt vmcnt(15)
  v_mfma_f32_32x32x16_bf16 v[128:143], v[208:211], v[48:51], 0
  v_mfma_f32_32x32x16_bf16 v[144:159], v[212:215], v[48:51], 0
  v_mfma_f32_32x32x16_bf16 v[160:175], v[48:51], v[216:219], 0
  s_add_u32 s29, s28, 16384
  buffer_load_dwordx4 v[48:51], v2, s[8:11], s29 offen sc1
  ds_read_b128 v[208:211], v3 offset:2048
  ds_read_b128 v[212:215], v3 offset:43008
  ds_read_b128 v[216:219], v4 offset:18432
  s_waitcnt lgkmcnt(3)
  s_waitcnt vmcnt(15)
  v_mfma_f32_32x32x16_bf16 v[128:143], v[220:223], v[52:55], v[128:143]
  v_mfma_f32_32x32x16_bf16 v[144:159], v[224:227], v[52:55], v[144:159]
  v_mfma_f32_32x32x16_bf16 v[160:175], v[52:55], v[228:231], v[160:175]
  s_add_u32 s29, s28, 17408
  buffer_load_dwordx4 v[52:55], v2, s[8:11], s29 offen sc1
  ds_read_b128 v[220:223], v3 offset:3072
  ds_read_b128 v[224:227], v3 offset:44032
  ds_read_b128 v[228:231], v4 offset:19456
  s_waitcnt lgkmcnt(3)
  s_waitcnt vmcnt(15)
  v_mfma_f32_32x32x16_bf16 v[128:143], v[208:211], v[56:59], v[128:143]
  v_max3_f32 v9, v9, abs(v96), abs(v97)
  v_max3_f32 v9, v9, abs(v98), abs(v99)
  v_mfma_f32_32x32x16_bf16 v[144:159], v[212:215], v[56:59], v[144:159]
  v_max3_f32 v9, v9, abs(v100), abs(v101)
  v_max3_f32 v9, v9, abs(v102), abs(v103)
  v_mfma_f32_32x32x16_bf16 v[160:175], v[56:59], v[216:219], v[160:175]
  v_max3_f32 v9, v9, abs(v104), abs(v105)
  v_max3_f32 v9, v9, abs(v106), abs(v107)
  s_add_u32 s29, s28, 18432
  buffer_load_dwordx4 v[56:59], v2, s[8:11], s29 offen sc1
  ds_read_b128 v[208:211], v3 offset:4096
  ds_read_b128 v[212:215], v3 offset:45056
  ds_read_b128 v[216:219], v4 offset:20480
  s_waitcnt lgkmcnt(3)
  s_waitcnt vmcnt(15)
  v_mfma_f32_32x32x16_bf16 v[128:143], v[220:223], v[60:63], v[128:143]
  v_max3_f32 v9, v9, abs(v108), abs(v109)
  v_max3_f32 v9, v9, abs(v110), abs(v111)
  v_mfma_f32_32x32x16_bf16 v[144:159], v[224:227], v[60:63], v[144:159]
  v_add_f32 v108, v108, v6
  v_cvt_pk_bf16_f32 v232, v96, v97
  v_mfma_f32_32x32x16_bf16 v[160:175], v[60:63], v[228:231], v[160:175]
  v_cvt_pk_bf16_f32 v233, v98, v99
  v_cvt_pk_bf16_f32 v234, v100, v101
  s_add_u32 s29, s28, 19456
  buffer_load_dwordx4 v[60:63], v2, s[8:11], s29 offen sc1
  ds_read_b128 v[220:223], v3 offset:5120
  ds_read_b128 v[224:227], v3 offset:46080
  ds_read_b128 v[228:231], v4 offset:21504
  s_waitcnt lgkmcnt(3)
  s_waitcnt vmcnt(15)
  v_mfma_f32_32x32x16_bf16 v[128:143], v[208:211], v[64:67], v[128:143]
  v_cvt_pk_bf16_f32 v235, v102, v103
  v_cvt_pk_bf16_f32 v236, v104, v105
  v_mfma_f32_32x32x16_bf16 v[144:159], v[212:215], v[64:67], v[144:159]
  v_cvt_pk_bf16_f32 v237, v106, v107
  v_cvt_pk_bf16_f32 v238, v108, v109
  v_mfma_f32_32x32x16_bf16 v[160:175], v[64:67], v[216:219], v[160:175]
  v_cvt_pk_bf16_f32 v239, v110, v111
  s_add_u32 s26, s31, 245366784
  s_add_u32 s29, s28, 20480
  buffer_load_dwordx4 v[64:67], v2, s[8:11], s29 offen sc1
  ds_read_b128 v[208:211], v3 offset:6144
  ds_read_b128 v[212:215], v3 offset:47104
  ds_read_b128 v[216:219], v4 offset:22528
  s_waitcnt lgkmcnt(3)
  s_waitcnt vmcnt(15)
  v_mfma_f32_32x32x16_bf16 v[128:143], v[220:223], v[68:71], v[128:143]
  buffer_store_dwordx4 v[232:235], v2, s[8:11], s26 offen sc1
  buffer_store_dwordx4 v[236:239], v2, s[8:11], s26 offen offset:1024 sc1
  v_mfma_f32_32x32x16_bf16 v[144:159], v[224:227], v[68:71], v[144:159]
  v_cndmask_b32 v112, v112, v8, s[32:33]
  v_cndmask_b32 v113, v113, v8, s[32:33]
  v_mfma_f32_32x32x16_bf16 v[160:175], v[68:71], v[228:231], v[160:175]
  v_cndmask_b32 v114, v114, v8, s[32:33]
  v_cndmask_b32 v115, v115, v8, s[32:33]
  s_add_u32 s29, s28, 21504
  buffer_load_dwordx4 v[68:71], v2, s[8:11], s29 offen sc1
  ds_read_b128 v[220:223], v3 offset:7168
  ds_read_b128 v[224:227], v3 offset:48128
  ds_read_b128 v[228:231], v4 offset:23552
  s_waitcnt lgkmcnt(3)
  s_waitcnt vmcnt(17)
  v_mfma_f32_32x32x16_bf16 v[128:143], v[208:211], v[72:75], v[128:143]
  v_cndmask_b32 v116, v116, v8, s[32:33]
  v_cndmask_b32 v117, v117, v8, s[32:33]
  v_mfma_f32_32x32x16_bf16 v[144:159], v[212:215], v[72:75], v[144:159]
  v_cndmask_b32 v118, v118, v8, s[32:33]
  v_cndmask_b32 v119, v119, v8, s[32:33]
  v_mfma_f32_32x32x16_bf16 v[160:175], v[72:75], v[216:219], v[160:175]
  v_cndmask_b32 v120, v120, v8, s[32:33]
  v_cndmask_b32 v121, v121, v8, s[32:33]
  s_add_u32 s29, s28, 22528
  buffer_load_dwordx4 v[72:75], v2, s[8:11], s29 offen sc1
  ds_read_b128 v[208:211], v3 offset:8192
  ds_read_b128 v[212:215], v3 offset:49152
  ds_read_b128 v[216:219], v4 offset:24576
  s_waitcnt lgkmcnt(3)
  s_waitcnt vmcnt(17)
  v_mfma_f32_32x32x16_bf16 v[128:143], v[220:223], v[76:79], v[128:143]
  v_cndmask_b32 v122, v122, v8, s[32:33]
  v_cndmask_b32 v123, v123, v8, s[32:33]
  v_mfma_f32_32x32x16_bf16 v[144:159], v[224:227], v[76:79], v[144:159]
  v_cndmask_b32 v124, v124, v8, s[32:33]
  v_cndmask_b32 v125, v125, v8, s[32:33]
  v_mfma_f32_32x32x16_bf16 v[160:175], v[76:79], v[228:231], v[160:175]
  v_cndmask_b32 v126, v126, v8, s[32:33]
  v_cndmask_b32 v127, v127, v8, s[32:33]
  s_add_u32 s29, s28, 23552
  buffer_load_dwordx4 v[76:79], v2, s[8:11], s29 offen sc1
  ds_read_b128 v[220:223], v3 offset:9216
  ds_read_b128 v[224:227], v3 offset:50176
  ds_read_b128 v[228:231], v4 offset:25600
  s_waitcnt lgkmcnt(3)
  s_waitcnt vmcnt(17)
  v_mfma_f32_32x32x16_bf16 v[128:143], v[208:211], v[16:19], v[128:143]
  v_cvt_pk_bf16_f32 v240, v112, v113
  v_cvt_pk_bf16_f32 v241, v114, v115
  v_mfma_f32_32x32x16_bf16 v[144:159], v[212:215], v[16:19], v[144:159]
  v_cvt_pk_bf16_f32 v242, v116, v117
  v_cvt_pk_bf16_f32 v243, v118, v119
  v_mfma_f32_32x32x16_bf16 v[160:175], v[16:19], v[216:219], v[160:175]
  v_cvt_pk_bf16_f32 v244, v120, v121
  v_cvt_pk_bf16_f32 v245, v122, v123
  s_add_u32 s29, s28, 24576
  buffer_load_dwordx4 v[16:19], v2, s[8:11], s29 offen sc1
  ds_read_b128 v[208:211], v3 offset:10240
  ds_read_b128 v[212:215], v3 offset:51200
  ds_read_b128 v[216:219], v4 offset:26624
  s_waitcnt lgkmcnt(3)
  s_waitcnt vmcnt(17)
  v_mfma_f32_32x32x16_bf16 v[128:143], v[220:223], v[20:23], v[128:143]
  v_cvt_pk_bf16_f32 v246, v124, v125
  v_cvt_pk_bf16_f32 v247, v126, v127
  v_mfma_f32_32x32x16_bf16 v[144:159], v[224:227], v[20:23], v[144:159]
  s_add_u32 s26, s31, 249561088
  buffer_store_dwordx4 v[240:243], v2, s[8:11], s26 offen sc1
  v_mfma_f32_32x32x16_bf16 v[160:175], v[20:23], v[228:231], v[160:175]
  buffer_store_dwordx4 v[244:247], v2, s[8:11], s26 offen offset:1024 sc1
  v_mul_f32 v80, s30, v80
  s_add_u32 s29, s28, 25600
  buffer_load_dwordx4 v[20:23], v2, s[8:11], s29 offen sc1
  ds_read_b128 v[220:223], v3 offset:11264
  ds_read_b128 v[224:227], v3 offset:52224
  ds_read_b128 v[228:231], v4 offset:27648
  s_waitcnt lgkmcnt(3)
  s_waitcnt vmcnt(19)
  v_mfma_f32_32x32x16_bf16 v[128:143], v[208:211], v[24:27], v[128:143]
  v_mul_f32 v81, s30, v81
  v_mul_f32 v82, s30, v82
  v_mfma_f32_32x32x16_bf16 v[144:159], v[212:215], v[24:27], v[144:159]
  v_mul_f32 v83, s30, v83
  v_mul_f32 v84, s30, v84
  v_mfma_f32_32x32x16_bf16 v[160:175], v[24:27], v[216:219], v[160:175]
  v_mul_f32 v85, s30, v85
  v_mul_f32 v86, s30, v86
  s_add_u32 s29, s28, 26624
  buffer_load_dwordx4 v[24:27], v2, s[8:11], s29 offen sc1
  ds_read_b128 v[208:211], v3 offset:12288
  ds_read_b128 v[212:215], v3 offset:53248
  ds_read_b128 v[216:219], v4 offset:28672
  s_waitcnt lgkmcnt(3)
  s_waitcnt vmcnt(19)
  v_mfma_f32_32x32x16_bf16 v[128:143], v[220:223], v[28:31], v[128:143]
  v_mul_f32 v87, s30, v87
  v_mul_f32 v88, s30, v88
  v_mfma_f32_32x32x16_bf16 v[144:159], v[224:227], v[28:31], v[144:159]
  v_mul_f32 v89, s30, v89
  v_mul_f32 v90, s30, v90
  v_mfma_f32_32x32x16_bf16 v[160:175], v[28:31], v[228:231], v[160:175]
  v_mul_f32 v91, s30, v91
  v_mul_f32 v92, s30, v92
  s_add_u32 s29, s28, 27648
  buffer_load_dwordx4 v[28:31], v2, s[8:11], s29 offen sc1
  ds_read_b128 v[220:223], v3 offset:13312
  ds_read_b128 v[224:227], v3 offset:54272
  ds_read_b128 v[228:231], v4 offset:29696
  s_waitcnt lgkmcnt(3)
  s_waitcnt vmcnt(19)
  v_mfma_f32_32x32x16_bf16 v[128:143], v[208:211], v[32:35], v[128:143]
  v_mul_f32 v93, s30, v93
  v_mul_f32 v94, s30, v94
  v_mfma_f32_32x32x16_bf16 v[144:159], v[212:215], v[32:35], v[144:159]
  v_mul_f32 v95, s30, v95
  v_cvt_pk_bf16_f32 v192, v80, v81
  v_mfma_f32_32x32x16_bf16 v[160:175], v[32:35], v[216:219], v[160:175]
  v_cvt_pk_bf16_f32 v193, v82, v83
  v_cvt_pk_bf16_f32 v194, v84, v85
  s_add_u32 s29, s28, 28672
  buffer_load_dwordx4 v[32:35], v2, s[8:11], s29 offen sc1
  ds_read_b128 v[208:211], v3 offset:14336
  ds_read_b128 v[212:215], v3 offset:55296
  ds_read_b128 v[216:219], v4 offset:30720
  s_waitcnt lgkmcnt(3)
  s_waitcnt vmcnt(19)
  v_mfma_f32_32x32x16_bf16 v[128:143], v[220:223], v[36:39], v[128:143]
  v_cvt_pk_bf16_f32 v195, v86, v87
  v_cvt_pk_bf16_f32 v196, v88, v89
  v_mfma_f32_32x32x16_bf16 v[144:159], v[224:227], v[36:39], v[144:159]
  v_cvt_pk_bf16_f32 v197, v90, v91
  v_cvt_pk_bf16_f32 v198, v92, v93
  v_mfma_f32_32x32x16_bf16 v[160:175], v[36:39], v[228:231], v[160:175]
  v_cvt_pk_bf16_f32 v199, v94, v95
  s_add_u32 s29, s28, 29696
  buffer_load_dwordx4 v[36:39], v2, s[8:11], s29 offen sc1
  ds_read_b128 v[220:223], v3 offset:15360
  ds_read_b128 v[224:227], v3 offset:56320
  ds_read_b128 v[228:231], v4 offset:31744
  s_waitcnt lgkmcnt(3)
  s_waitcnt vmcnt(19)
  v_mfma_f32_32x32x16_bf16 v[128:143], v[208:211], v[40:43], v[128:143]
  v_mfma_f32_32x32x16_bf16 v[144:159], v[212:215], v[40:43], v[144:159]
  v_mfma_f32_32x32x16_bf16 v[160:175], v[40:43], v[216:219], v[160:175]
  s_add_u32 s29, s28, 30720
  buffer_load_dwordx4 v[40:43], v2, s[8:11], s29 offen sc1
  ds_read_b128 v[208:211], v3 offset:16384
  ds_read_b128 v[212:215], v3 offset:57344
  ds_read_b128 v[216:219], v4 offset:32768
  s_waitcnt lgkmcnt(3)
  s_waitcnt vmcnt(19)
  v_mfma_f32_32x32x16_bf16 v[128:143], v[220:223], v[44:47], v[128:143]
  v_mfma_f32_32x32x16_bf16 v[144:159], v[224:227], v[44:47], v[144:159]
  v_mfma_f32_32x32x16_bf16 v[160:175], v[44:47], v[228:231], v[160:175]
  s_add_u32 s29, s28, 31744
  buffer_load_dwordx4 v[44:47], v2, s[8:11], s29 offen sc1
  ds_read_b128 v[220:223], v3 offset:17408
  ds_read_b128 v[224:227], v3 offset:58368
  ds_read_b128 v[228:231], v4 offset:33792
  s_waitcnt lgkmcnt(3)
  s_waitcnt vmcnt(19)
  v_mfma_f32_32x32x16_bf16 v[128:143], v[208:211], v[48:51], v[128:143]
  v_mfma_f32_32x32x16_bf16 v[144:159], v[212:215], v[48:51], v[144:159]
  v_mfma_f32_32x32x16_bf16 v[160:175], v[48:51], v[216:219], v[160:175]
  s_add_u32 s29, s28, 32768
  buffer_load_dwordx4 v[48:51], v2, s[8:11], s29 offen sc1
  ds_read_b128 v[208:211], v3 offset:18432
  ds_read_b128 v[212:215], v3 offset:59392
  ds_read_b128 v[216:219], v4 offset:34816
  s_waitcnt lgkmcnt(3)
  s_waitcnt vmcnt(19)
  v_mfma_f32_32x32x16_bf16 v[128:143], v[220:223], v[52:55], v[128:143]
  v_mfma_f32_32x32x16_bf16 v[144:159], v[224:227], v[52:55], v[144:159]
  v_mfma_f32_32x32x16_bf16 v[160:175], v[52:55], v[228:231], v[160:175]
  s_add_u32 s29, s28, 33792
  buffer_load_dwordx4 v[52:55], v2, s[8:11], s29 offen sc1
  ds_read_b128 v[220:223], v3 offset:19456
  ds_read_b128 v[224:227], v3 offset:60416
  ds_read_b128 v[228:231], v4 offset:35840
  s_waitcnt lgkmcnt(3)
  s_waitcnt vmcnt(19)
  v_mfma_f32_32x32x16_bf16 v[128:143], v[208:211], v[56:59], v[128:143]
  v_mfma_f32_32x32x16_bf16 v[144:159], v[212:215], v[56:59], v[144:159]
  v_mfma_f32_32x32x16_bf16 v[160:175], v[56:59], v[216:219], v[160:175]
  s_add_u32 s29, s28, 34816
  buffer_load_dwordx4 v[56:59], v2, s[8:11], s29 offen sc1
  ds_read_b128 v[208:211], v3 offset:20480
  ds_read_b128 v[212:215], v3 offset:61440
  ds_read_b128 v[216:219], v4 offset:36864
  s_waitcnt lgkmcnt(3)
  s_waitcnt vmcnt(19)
  v_mfma_f32_32x32x16_bf16 v[128:143], v[220:223], v[60:63], v[128:143]
  v_mfma_f32_32x32x16_bf16 v[144:159], v[224:227], v[60:63], v[144:159]
  v_mfma_f32_32x32x16_bf16 v[160:175], v[60:63], v[228:231], v[160:175]
  s_add_u32 s29, s28, 35840
  buffer_load_dwordx4 v[60:63], v2, s[8:11], s29 offen sc1
  ds_read_b128 v[220:223], v3 offset:21504
  ds_read_b128 v[224:227], v3 offset:62464
  ds_read_b128 v[228:231], v4 offset:37888
  s_waitcnt lgkmcnt(3)
  s_waitcnt vmcnt(19)
  v_mfma_f32_32x32x16_bf16 v[128:143], v[208:211], v[64:67], v[128:143]
  v_mfma_f32_32x32x16_bf16 v[144:159], v[212:215], v[64:67], v[144:159]
  v_mfma_f32_32x32x16_bf16 v[160:175], v[64:67], v[216:219], v[160:175]
  s_add_u32 s29, s28, 36864
  buffer_load_dwordx4 v[64:67], v2, s[8:11], s29 offen sc1
  ds_read_b128 v[208:211], v3 offset:22528
  ds_read_b128 v[212:215], v3 offset:63488
  ds_read_b128 v[216:219], v4 offset:38912
  s_waitcnt lgkmcnt(3)
  s_waitcnt vmcnt(17)
  v_mfma_f32_32x32x16_bf16 v[128:143], v[220:223], v[68:71], v[128:143]
  v_mfma_f32_32x32x16_bf16 v[144:159], v[224:227], v[68:71], v[144:159]
  v_mfma_f32_32x32x16_bf16 v[160:175], v[68:71], v[228:231], v[160:175]
  s_add_u32 s29, s28, 37888
  buffer_load_dwordx4 v[68:71], v2, s[8:11], s29 offen sc1
  ds_read_b128 v[220:223], v3 offset:23552
  ds_read_b128 v[224:227], v3 offset:64512
  ds_read_b128 v[228:231], v4 offset:39936
  s_waitcnt lgkmcnt(3)
  s_waitcnt vmcnt(17)
  v_mfma_f32_32x32x16_bf16 v[128:143], v[208:211], v[72:75], v[128:143]
  v_mfma_f32_32x32x16_bf16 v[144:159], v[212:215], v[72:75], v[144:159]
  v_mfma_f32_32x32x16_bf16 v[160:175], v[72:75], v[216:219], v[160:175]
  s_add_u32 s29, s28, 38912
  buffer_load_dwordx4 v[72:75], v2, s[8:11], s29 offen sc1
  ds_read_b128 v[208:211], v3 offset:24576
  ds_read_b128 v[212:215], v4 offset:0
  ds_read_b128 v[216:219], v4 offset:40960
  s_waitcnt lgkmcnt(3)
  s_waitcnt vmcnt(17)
  v_mfma_f32_32x32x16_bf16 v[128:143], v[220:223], v[76:79], v[128:143]
  v_mfma_f32_32x32x16_bf16 v[144:159], v[224:227], v[76:79], v[144:159]
  v_mfma_f32_32x32x16_bf16 v[160:175], v[76:79], v[228:231], v[160:175]
  s_add_u32 s29, s28, 39936
  buffer_load_dwordx4 v[76:79], v2, s[8:11], s29 offen sc1
  ds_read_b128 v[220:223], v3 offset:25600
  ds_read_b128 v[224:227], v4 offset:1024
  ds_read_b128 v[228:231], v4 offset:41984
  s_waitcnt lgkmcnt(3)
  s_waitcnt vmcnt(17)
  v_mfma_f32_32x32x16_bf16 v[128:143], v[208:211], v[16:19], v[128:143]
  v_mfma_f32_32x32x16_bf16 v[144:159], v[212:215], v[16:19], v[144:159]
  v_mfma_f32_32x32x16_bf16 v[160:175], v[16:19], v[216:219], v[160:175]
  ds_read_b128 v[208:211], v3 offset:26624
  ds_read_b128 v[212:215], v4 offset:2048
  ds_read_b128 v[216:219], v4 offset:43008
  s_waitcnt lgkmcnt(3)
  s_waitcnt vmcnt(14)
  v_mfma_f32_32x32x16_bf16 v[128:143], v[220:223], v[20:23], v[128:143]
  v_mfma_f32_32x32x16_bf16 v[144:159], v[224:227], v[20:23], v[144:159]
  v_mfma_f32_32x32x16_bf16 v[160:175], v[20:23], v[228:231], v[160:175]
  ds_read_b128 v[220:223], v3 offset:27648
  ds_read_b128 v[224:227], v4 offset:3072
  ds_read_b128 v[228:231], v4 offset:44032
  s_waitcnt lgkmcnt(3)
  s_waitcnt vmcnt(13)
  v_mfma_f32_32x32x16_bf16 v[128:143], v[208:211], v[24:27], v[128:143]
  v_mfma_f32_32x32x16_bf16 v[144:159], v[212:215], v[24:27], v[144:159]
  v_mfma_f32_32x32x16_bf16 v[160:175], v[24:27], v[216:219], v[160:175]
  ds_read_b128 v[208:211], v3 offset:28672
  ds_read_b128 v[212:215], v4 offset:4096
  ds_read_b128 v[216:219], v4 offset:45056
  s_waitcnt lgkmcnt(3)
  s_waitcnt vmcnt(12)
  v_mfma_f32_32x32x16_bf16 v[128:143], v[220:223], v[28:31], v[128:143]
  v_mfma_f32_32x32x16_bf16 v[144:159], v[224:227], v[28:31], v[144:159]
  v_mfma_f32_32x32x16_bf16 v[160:175], v[28:31], v[228:231], v[160:175]
  ds_read_b128 v[220:223], v3 offset:29696
  ds_read_b128 v[224:227], v4 offset:5120
  ds_read_b128 v[228:231], v4 offset:46080
  s_waitcnt lgkmcnt(3)
  s_waitcnt vmcnt(11)
  v_mfma_f32_32x32x16_bf16 v[128:143], v[208:211], v[32:35], v[128:143]
  v_mfma_f32_32x32x16_bf16 v[144:159], v[212:215], v[32:35], v[144:159]
  v_mfma_f32_32x32x16_bf16 v[160:175], v[32:35], v[216:219], v[160:175]
  ds_read_b128 v[208:211], v3 offset:30720
  ds_read_b128 v[212:215], v4 offset:6144
  ds_read_b128 v[216:219], v4 offset:47104
  s_waitcnt lgkmcnt(3)
  s_waitcnt vmcnt(10)
  v_mfma_f32_32x32x16_bf16 v[128:143], v[220:223], v[36:39], v[128:143]
  v_mfma_f32_32x32x16_bf16 v[144:159], v[224:227], v[36:39], v[144:159]
  v_mfma_f32_32x32x16_bf16 v[160:175], v[36:39], v[228:231], v[160:175]
  ds_read_b128 v[220:223], v3 offset:31744
  ds_read_b128 v[224:227], v4 offset:7168
  ds_read_b128 v[228:231], v4 offset:48128
  s_waitcnt lgkmcnt(3)
  s_waitcnt vmcnt(9)
  v_mfma_f32_32x32x16_bf16 v[128:143], v[208:211], v[40:43], v[128:143]
  v_mfma_f32_32x32x16_bf16 v[144:159], v[212:215], v[40:43], v[144:159]
  v_mfma_f32_32x32x16_bf16 v[160:175], v[40:43], v[216:219], v[160:175]
  ds_read_b128 v[208:211], v3 offset:32768
  ds_read_b128 v[212:215], v4 offset:8192
  ds_read_b128 v[216:219], v4 offset:49152
  s_waitcnt lgkmcnt(3)
  s_waitcnt vmcnt(8)
  v_mfma_f32_32x32x16_bf16 v[128:143], v[220:223], v[44:47], v[128:143]
  v_mfma_f32_32x32x16_bf16 v[144:159], v[224:227], v[44:47], v[144:159]
  v_mfma_f32_32x32x16_bf16 v[160:175], v[44:47], v[228:231], v[160:175]
  ds_read_b128 v[220:223], v3 offset:33792
  ds_read_b128 v[224:227], v4 offset:9216
  ds_read_b128 v[228:231], v4 offset:50176
  s_waitcnt lgkmcnt(3)
  s_waitcnt vmcnt(7)
  v_mfma_f32_32x32x16_bf16 v[128:143], v[208:211], v[48:51], v[128:143]
  v_mfma_f32_32x32x16_bf16 v[144:159], v[212:215], v[48:51], v[144:159]
  v_mfma_f32_32x32x16_bf16 v[160:175], v[48:51], v[216:219], v[160:175]
  ds_read_b128 v[208:211], v3 offset:34816
  ds_read_b128 v[212:215], v4 offset:10240
  ds_read_b128 v[216:219], v4 offset:51200
  s_waitcnt lgkmcnt(3)
  s_waitcnt vmcnt(6)
  v_mfma_f32_32x32x16_bf16 v[128:143], v[220:223], v[52:55], v[128:143]
  v_mfma_f32_32x32x16_bf16 v[144:159], v[224:227], v[52:55], v[144:159]
  v_mfma_f32_32x32x16_bf16 v[160:175], v[52:55], v[228:231], v[160:175]
  ds_read_b128 v[220:223], v3 offset:35840
  ds_read_b128 v[224:227], v4 offset:11264
  ds_read_b128 v[228:231], v4 offset:52224
  s_waitcnt lgkmcnt(3)
  s_waitcnt vmcnt(5)
  v_mfma_f32_32x32x16_bf16 v[128:143], v[208:211], v[56:59], v[128:143]
  v_mfma_f32_32x32x16_bf16 v[144:159], v[212:215], v[56:59], v[144:159]
  v_mfma_f32_32x32x16_bf16 v[160:175], v[56:59], v[216:219], v[160:175]
  ds_read_b128 v[208:211], v3 offset:36864
  ds_read_b128 v[212:215], v4 offset:12288
  ds_read_b128 v[216:219], v4 offset:53248
  s_waitcnt lgkmcnt(3)
  s_waitcnt vmcnt(4)
  v_mfma_f32_32x32x16_bf16 v[128:143], v[220:223], v[60:63], v[128:143]
  v_mfma_f32_32x32x16_bf16 v[144:159], v[224:227], v[60:63], v[144:159]
  v_mfma_f32_32x32x16_bf16 v[160:175], v[60:63], v[228:231], v[160:175]
  ds_read_b128 v[220:223], v3 offset:37888
  ds_read_b128 v[224:227], v4 offset:13312
  ds_read_b128 v[228:231], v4 offset:54272
  s_waitcnt lgkmcnt(3)
  s_waitcnt vmcnt(3)
  v_mfma_f32_32x32x16_bf16 v[128:143], v[208:211], v[64:67], v[128:143]
  v_mfma_f32_32x32x16_bf16 v[144:159], v[212:215], v[64:67], v[144:159]
  v_mfma_f32_32x32x16_bf16 v[160:175], v[64:67], v[216:219], v[160:175]
  ds_read_b128 v[208:211], v3 offset:38912
  ds_read_b128 v[212:215], v4 offset:14336
  ds_read_b128 v[216:219], v4 offset:55296
  s_waitcnt lgkmcnt(3)
  s_waitcnt vmcnt(2)
  v_mfma_f32_32x32x16_bf16 v[128:143], v[220:223], v[68:71], v[128:143]
  v_mfma_f32_32x32x16_bf16 v[144:159], v[224:227], v[68:71], v[144:159]
  v_mfma_f32_32x32x16_bf16 v[160:175], v[68:71], v[228:231], v[160:175]
  ds_read_b128 v[220:223], v3 offset:39936
  ds_read_b128 v[224:227], v4 offset:15360
  ds_read_b128 v[228:231], v4 offset:56320
  s_waitcnt lgkmcnt(3)
  s_waitcnt vmcnt(1)
  v_mfma_f32_32x32x16_bf16 v[128:143], v[208:211], v[72:75], v[128:143]
  v_mfma_f32_32x32x16_bf16 v[144:159], v[212:215], v[72:75], v[144:159]
  v_mfma_f32_32x32x16_bf16 v[160:175], v[72:75], v[216:219], v[160:175]
  s_waitcnt lgkmcnt(0)
  s_waitcnt vmcnt(0)
  v_mfma_f32_32x32x16_bf16 v[128:143], v[220:223], v[76:79], v[128:143]
  v_mfma_f32_32x32x16_bf16 v[144:159], v[224:227], v[76:79], v[144:159]
  v_mfma_f32_32x32x16_bf16 v[160:175], v[76:79], v[228:231], v[160:175]
  s_nop 11
  v_max3_f32 v9, v9, abs(v144), abs(v145)
  v_max3_f32 v9, v9, abs(v146), abs(v147)
  v_max3_f32 v9, v9, abs(v148), abs(v149)
  v_max3_f32 v9, v9, abs(v150), abs(v151)
  v_max3_f32 v9, v9, abs(v152), abs(v153)
  v_max3_f32 v9, v9, abs(v154), abs(v155)
  v_max3_f32 v9, v9, abs(v156), abs(v157)
  v_max3_f32 v9, v9, abs(v158), abs(v159)
  v_add_f32 v156, v156, v6
  v_cvt_pk_bf16_f32 v232, v144, v145
  v_cvt_pk_bf16_f32 v233, v146, v147
  v_cvt_pk_bf16_f32 v234, v148, v149
  v_cvt_pk_bf16_f32 v235, v150, v151
  v_cvt_pk_bf16_f32 v236, v152, v153
  v_cvt_pk_bf16_f32 v237, v154, v155
  v_cvt_pk_bf16_f32 v238, v156, v157
  v_cvt_pk_bf16_f32 v239, v158, v159
  s_add_u32 s26, s31, 245368832
  buffer_store_dwordx4 v[232:235], v2, s[8:11], s26 offen sc1
  buffer_store_dwordx4 v[236:239], v2, s[8:11], s26 offen offset:1024 sc1
  v_cndmask_b32 v160, v160, v8, s[32:33]
  v_cndmask_b32 v161, v161, v8, s[32:33]
  v_cndmask_b32 v162, v162, v8, s[32:33]
  v_cndmask_b32 v163, v163, v8, s[32:33]
  v_cndmask_b32 v164, v164, v8, s[32:33]
  v_cndmask_b32 v165, v165, v8, s[32:33]
  v_cndmask_b32 v166, v166, v8, s[32:33]
  v_cndmask_b32 v167, v167, v8, s[32:33]
  v_cndmask_b32 v168, v168, v8, s[32:33]
  v_cndmask_b32 v169, v169, v8, s[32:33]
  v_cndmask_b32 v170, v170, v8, s[32:33]
  v_cndmask_b32 v171, v171, v8, s[32:33]
  v_cndmask_b32 v172, v172, v8, s[32:33]
  v_cndmask_b32 v173, v173, v8, s[32:33]
  v_cndmask_b32 v174, v174, v8, s[32:33]
  v_cndmask_b32 v175, v175, v8, s[32:33]
  v_cvt_pk_bf16_f32 v240, v160, v161
  v_cvt_pk_bf16_f32 v241, v162, v163
  v_cvt_pk_bf16_f32 v242, v164, v165
  v_cvt_pk_bf16_f32 v243, v166, v167
  v_cvt_pk_bf16_f32 v244, v168, v169
  v_cvt_pk_bf16_f32 v245, v170, v171
  v_cvt_pk_bf16_f32 v246, v172, v173
  v_cvt_pk_bf16_f32 v247, v174, v175
  s_add_u32 s26, s31, 249563136
  buffer_store_dwordx4 v[240:243], v2, s[8:11], s26 offen sc1
  buffer_store_dwordx4 v[244:247], v2, s[8:11], s26 offen offset:1024 sc1
  v_mul_f32 v128, s30, v128
  v_mul_f32 v129, s30, v129
  v_mul_f32 v130, s30, v130
  v_mul_f32 v131, s30, v131
  v_mul_f32 v132, s30, v132
  v_mul_f32 v133, s30, v133
  v_mul_f32 v134, s30, v134
  v_mul_f32 v135, s30, v135
  v_mul_f32 v136, s30, v136
  v_mul_f32 v137, s30, v137
  v_mul_f32 v138, s30, v138
  v_mul_f32 v139, s30, v139
  v_mul_f32 v140, s30, v140
  v_mul_f32 v141, s30, v141
  v_mul_f32 v142, s30, v142
  v_mul_f32 v143, s30, v143
  v_cvt_pk_bf16_f32 v200, v128, v129
  v_cvt_pk_bf16_f32 v201, v130, v131
  v_cvt_pk_bf16_f32 v202, v132, v133
  v_cvt_pk_bf16_f32 v203, v134, v135
  v_cvt_pk_bf16_f32 v204, v136, v137
  v_cvt_pk_bf16_f32 v205, v138, v139
  v_cvt_pk_bf16_f32 v206, v140, v141
  v_cvt_pk_bf16_f32 v207, v142, v143
  s_nop 1
  v_max_f32_dpp v10, v9, v9 quad_perm:[1,0,3,2] row_mask:0xf bank_mask:0xf
  s_nop 1
  v_max_f32_dpp v9, v10, v10 quad_perm:[2,3,0,1] row_mask:0xf bank_mask:0xf
  s_nop 1
  v_max_f32_dpp v10, v9, v9 row_half_mirror row_mask:0xf bank_mask:0xf
  s_nop 1
  v_max_f32_dpp v9, v10, v10 row_mirror row_mask:0xf bank_mask:0xf
  v_mov_b32 v10, v9
  s_nop 1
  v_permlane16_swap_b32 v9, v10
  v_max_f32 v9, v9, v10
  v_mov_b32 v10, v9
  s_nop 1
  v_permlane32_swap_b32 v9, v10
  v_max_f32 v9, v9, v10
  s_lshl_b32 s51, s22, 7
  s_add_u32 s51, s51, 0xf600000
  s_lshl_b32 s26, s23, 4
  s_lshl_b32 s29, s21, 2
  s_add_u32 s26, s26, s29
  v_mov_b32 v11, s26
  s_mov_b64 s[40:41], exec
  s_mov_b64 exec, 1
  buffer_store_dword v9, v11, s[8:11], s51 offen sc1
  s_mov_b64 exec, s[40:41]
  s_mov_b32 s52, s24
  s_waitcnt vmcnt(0)
  s_barrier
  s_cmp_eq_u32 s21, 0
  s_cbranch_scc0 arr_110
  s_mov_b64 s[24:25], exec
  s_mov_b64 exec, 1
  v_mov_b32 v3, 0
  v_mov_b32 v4, 1
  buffer_atomic_add v4, v3, s[8:11], s47 offen
  s_mov_b64 exec, s[24:25]
arr_110:
  s_and_b32 s26, s2, 3
  s_mul_i32 s26, s26, 10
  s_mul_i32 s27, s21, 3
  s_cmp_eq_u32 s21, 3
  s_cselect_b32 s27, 8, s27
  s_add_u32 s50, s26, s27
  s_mul_i32 s26, s50, 20480
  s_add_u32 s26, s26, 0xe000000
  s_add_u32 s27, s26, 0
  buffer_load_dwordx4 a[0:3], v2, s[8:11], s27 offen
  s_add_u32 s27, s26, 1024
  buffer_load_dwordx4 a[4:7], v2, s[8:11], s27 offen
  s_add_u32 s27, s26, 2048
  buffer_load_dwordx4 a[8:11], v2, s[8:11], s27 offen
  s_add_u32 s27, s26, 3072
  buffer_load_dwordx4 a[12:15], v2, s[8:11], s27 offen
  s_add_u32 s27, s26, 4096
  buffer_load_dwordx4 a[16:19], v2, s[8:11], s27 offen
  s_add_u32 s27, s26, 5120
  buffer_load_dwordx4 a[20:23], v2, s[8:11], s27 offen
  s_add_u32 s27, s26, 6144
  buffer_load_dwordx4 a[24:27], v2, s[8:11], s27 offen
  s_add_u32 s27, s26, 7168
  buffer_load_dwordx4 a[28:31], v2, s[8:11], s27 offen
  s_add_u32 s27, s26, 8192
  buffer_load_dwordx4 a[32:35], v2, s[8:11], s27 offen
  s_add_u32 s27, s26, 9216
  buffer_load_dwordx4 a[36:39], v2, s[8:11], s27 offen
  s_add_u32 s27, s26, 10240
  buffer_load_dwordx4 a[40:43], v2, s[8:11], s27 offen
  s_add_u32 s27, s26, 11264
  buffer_load_dwordx4 a[44:47], v2, s[8:11], s27 offen
  s_add_u32 s27, s26, 12288
  buffer_load_dwordx4 a[48:51], v2, s[8:11], s27 offen
  s_add_u32 s27, s26, 13312
  buffer_load_dwordx4 a[52:55], v2, s[8:11], s27 offen
  s_add_u32 s27, s26, 14336
  buffer_load_dwordx4 a[56:59], v2, s[8:11], s27 offen
  s_add_u32 s27, s26, 15360
  buffer_load_dwordx4 a[60:63], v2, s[8:11], s27 offen
  s_add_u32 s27, s26, 16384
  buffer_load_dwordx4 a[64:67], v2, s[8:11], s27 offen
  s_add_u32 s27, s26, 17408
  buffer_load_dwordx4 a[68:71], v2, s[8:11], s27 offen
  s_add_u32 s27, s26, 18432
  buffer_load_dwordx4 a[72:75], v2, s[8:11], s27 offen
  s_add_u32 s27, s26, 19456
  buffer_load_dwordx4 a[76:79], v2, s[8:11], s27 offen
  s_add_u32 s27, s26, 20480
  buffer_load_dwordx4 a[80:83], v2, s[8:11], s27 offen
  s_add_u32 s27, s26, 21504
  buffer_load_dwordx4 a[84:87], v2, s[8:11], s27 offen
  s_add_u32 s27, s26, 22528
  buffer_load_dwordx4 a[88:91], v2, s[8:11], s27 offen
  s_add_u32 s27, s26, 23552
  buffer_load_dwordx4 a[92:95], v2, s[8:11], s27 offen
  s_add_u32 s27, s26, 24576
  buffer_load_dwordx4 a[96:99], v2, s[8:11], s27 offen
  s_add_u32 s27, s26, 25600
  buffer_load_dwordx4 a[100:103], v2, s[8:11], s27 offen
  s_add_u32 s27, s26, 26624
  buffer_load_dwordx4 a[104:107], v2, s[8:11], s27 offen
  s_add_u32 s27, s26, 27648
  buffer_load_dwordx4 a[108:111], v2, s[8:11], s27 offen
  s_add_u32 s27, s26, 28672
  buffer_load_dwordx4 a[112:115], v2, s[8:11], s27 offen
  s_add_u32 s27, s26, 29696
  buffer_load_dwordx4 a[116:119], v2, s[8:11], s27 offen
  s_add_u32 s27, s26, 30720
  buffer_load_dwordx4 a[120:123], v2, s[8:11], s27 offen
  s_add_u32 s27, s26, 31744
  buffer_load_dwordx4 a[124:127], v2, s[8:11], s27 offen
  s_add_u32 s27, s26, 32768
  buffer_load_dwordx4 a[128:131], v2, s[8:11], s27 offen
  s_add_u32 s27, s26, 33792
  buffer_load_dwordx4 a[132:135], v2, s[8:11], s27 offen
  s_add_u32 s27, s26, 34816
  buffer_load_dwordx4 a[136:139], v2, s[8:11], s27 offen
  s_add_u32 s27, s26, 35840
  buffer_load_dwordx4 a[140:143], v2, s[8:11], s27 offen
  s_add_u32 s27, s26, 36864
  buffer_load_dwordx4 a[144:147], v2, s[8:11], s27 offen
  s_add_u32 s27, s26, 37888
  buffer_load_dwordx4 a[148:151], v2, s[8:11], s27 offen
  s_add_u32 s27, s26, 38912
  buffer_load_dwordx4 a[152:155], v2, s[8:11], s27 offen
  s_add_u32 s27, s26, 39936
  buffer_load_dwordx4 a[156:159], v2, s[8:11], s27 offen
  s_cmp_lt_u32 s21, 2
  s_cbranch_scc0 g3_111
  s_add_u32 s27, s26, 40960
  buffer_load_dwordx4 a[160:163], v2, s[8:11], s27 offen
  s_add_u32 s27, s26, 41984
  buffer_load_dwordx4 a[164:167], v2, s[8:11], s27 offen
  s_add_u32 s27, s26, 43008
  buffer_load_dwordx4 a[168:171], v2, s[8:11], s27 offen
  s_add_u32 s27, s26, 44032
  buffer_load_dwordx4 a[172:175], v2, s[8:11], s27 offen
  s_add_u32 s27, s26, 45056
  buffer_load_dwordx4 a[176:179], v2, s[8:11], s27 offen
  s_add_u32 s27, s26, 46080
  buffer_load_dwordx4 a[180:183], v2, s[8:11], s27 offen
  s_add_u32 s27, s26, 47104
  buffer_load_dwordx4 a[184:187], v2, s[8:11], s27 offen
  s_add_u32 s27, s26, 48128
  buffer_load_dwordx4 a[188:191], v2, s[8:11], s27 offen
  s_add_u32 s27, s26, 49152
  buffer_load_dwordx4 a[192:195], v2, s[8:11], s27 offen
  s_add_u32 s27, s26, 50176
  buffer_load_dwordx4 a[196:199], v2, s[8:11], s27 offen
  s_add_u32 s27, s26, 51200
  buffer_load_dwordx4 a[200:203], v2, s[8:11], s27 offen
  s_add_u32 s27, s26, 52224
  buffer_load_dwordx4 a[204:207], v2, s[8:11], s27 offen
  s_add_u32 s27, s26, 53248
  buffer_load_dwordx4 a[208:211], v2, s[8:11], s27 offen
  s_add_u32 s27, s26, 54272
  buffer_load_dwordx4 a[212:215], v2, s[8:11], s27 offen
  s_add_u32 s27, s26, 55296
  buffer_load_dwordx4 a[216:219], v2, s[8:11], s27 offen
  s_add_u32 s27, s26, 56320
  buffer_load_dwordx4 a[220:223], v2, s[8:11], s27 offen
  s_add_u32 s27, s26, 57344
  buffer_load_dwordx4 a[224:227], v2, s[8:11], s27 offen
  s_add_u32 s27, s26, 58368
  buffer_load_dwordx4 a[228:231], v2, s[8:11], s27 offen
  s_add_u32 s27, s26, 59392
  buffer_load_dwordx4 a[232:235], v2, s[8:11], s27 offen
  s_add_u32 s27, s26, 60416
  buffer_load_dwordx4 a[236:239], v2, s[8:11], s27 offen
g3_111:
  v_mov_b32 v12, 0
  v_lshlrev_b32 v6, 16, v192
  v_and_b32 v7, 0xffff0000, v192
  v_add_f32_e64 v12, v12, abs(v6)
  v_add_f32_e64 v12, v12, abs(v7)
  v_lshlrev_b32 v6, 16, v193
  v_and_b32 v7, 0xffff0000, v193
  v_add_f32_e64 v12, v12, abs(v6)
  v_add_f32_e64 v12, v12, abs(v7)
  v_lshlrev_b32 v6, 16, v194
  v_and_b32 v7, 0xffff0000, v194
  v_add_f32_e64 v12, v12, abs(v6)
  v_add_f32_e64 v12, v12, abs(v7)
  v_lshlrev_b32 v6, 16, v195
  v_and_b32 v7, 0xffff0000, v195
  v_add_f32_e64 v12, v12, abs(v6)
  v_add_f32_e64 v12, v12, abs(v7)
  v_lshlrev_b32 v6, 16, v196
  v_and_b32 v7, 0xffff0000, v196
  v_add_f32_e64 v12, v12, abs(v6)
  v_add_f32_e64 v12, v12, abs(v7)
  v_lshlrev_b32 v6, 16, v197
  v_and_b32 v7, 0xffff0000, v197
  v_add_f32_e64 v12, v12, abs(v6)
  v_add_f32_e64 v12, v12, abs(v7)
  v_lshlrev_b32 v6, 16, v198
  v_and_b32 v7, 0xffff0000, v198
  v_add_f32_e64 v12, v12, abs(v6)
  v_add_f32_e64 v12, v12, abs(v7)
  v_lshlrev_b32 v6, 16, v199
  v_and_b32 v7, 0xffff0000, v199
  v_add_f32_e64 v12, v12, abs(v6)
  v_add_f32_e64 v12, v12, abs(v7)
  v_mov_b32 v6, v12
  s_nop 1
  v_permlane32_swap_b32 v12, v6
  v_add_f32 v12, v12, v6
  v_mov_b32 v13, 0
  v_lshlrev_b32 v6, 16, v200
  v_and_b32 v7, 0xffff0000, v200
  v_add_f32_e64 v13, v13, abs(v6)
  v_add_f32_e64 v13, v13, abs(v7)
  v_lshlrev_b32 v6, 16, v201
  v_and_b32 v7, 0xffff0000, v201
  v_add_f32_e64 v13, v13, abs(v6)
  v_add_f32_e64 v13, v13, abs(v7)
  v_lshlrev_b32 v6, 16, v202
  v_and_b32 v7, 0xffff0000, v202
  v_add_f32_e64 v13, v13, abs(v6)
  v_add_f32_e64 v13, v13, abs(v7)
  v_lshlrev_b32 v6, 16, v203
  v_and_b32 v7, 0xffff0000, v203
  v_add_f32_e64 v13, v13, abs(v6)
  v_add_f32_e64 v13, v13, abs(v7)
  v_lshlrev_b32 v6, 16, v204
  v_and_b32 v7, 0xffff0000, v204
  v_add_f32_e64 v13, v13, abs(v6)
  v_add_f32_e64 v13, v13, abs(v7)
  v_lshlrev_b32 v6, 16, v205
  v_and_b32 v7, 0xffff0000, v205
  v_add_f32_e64 v13, v13, abs(v6)
  v_add_f32_e64 v13, v13, abs(v7)
  v_lshlrev_b32 v6, 16, v206
  v_and_b32 v7, 0xffff0000, v206
  v_add_f32_e64 v13, v13, abs(v6)
  v_add_f32_e64 v13, v13, abs(v7)
  v_lshlrev_b32 v6, 16, v207
  v_and_b32 v7, 0xffff0000, v207
  v_add_f32_e64 v13, v13, abs(v6)
  v_add_f32_e64 v13, v13, abs(v7)
  v_mov_b32 v6, v13
  s_nop 1
  v_permlane32_swap_b32 v13, v6
  v_add_f32 v13, v13, v6
  s_mov_b32 s45, 0
  v_mov_b32 v3, 0
aw_112:
  buffer_load_dword v4, v3, s[8:11], s47 offen sc1
  s_add_u32 s45, s45, 1
  s_waitcnt vmcnt(0)
  v_readfirstlane_b32 s29, v4
  s_cmp_ge_u32 s29, 8
  s_cbranch_scc1 aw_112_ok
  s_cmp_lt_u32 s45, 400000
  s_cbranch_scc1 aw_112
  s_branch kb2_abort
aw_112_ok:
  v_and_b32 v3, 31, v1
  v_lshlrev_b32 v3, 2, v3
  buffer_load_dword v4, v3, s[8:11], s51 offen sc1
  s_lshl_b32 s25, s22, 6
  s_lshl_b32 s27, s25, 11
  s_add_u32 s28, s27, 0xee00000
  s_add_u32 s27, s27, 0xea00000
  s_mov_b32 s41, 0
  s_mul_i32 s53, s41, 32768
  s_lshl_b32 s31, s21, 13
  s_add_u32 s53, s53, s31
  s_add_u32 m0, s31, 0
  s_add_u32 s29, s53, s27
  s_add_u32 s29, s29, 0
  buffer_load_dwordx4 v2, s[8:11], s29 offen sc1 lds
  s_add_u32 m0, s31, 1024
  s_add_u32 s29, s53, s27
  s_add_u32 s29, s29, 1024
  buffer_load_dwordx4 v2, s[8:11], s29 offen sc1 lds
  s_add_u32 m0, s31, 2048
  s_add_u32 s29, s53, s27
  s_add_u32 s29, s29, 2048
  buffer_load_dwordx4 v2, s[8:11], s29 offen sc1 lds
  s_add_u32 m0, s31, 3072
  s_add_u32 s29, s53, s27
  s_add_u32 s29, s29, 3072
  buffer_load_dwordx4 v2, s[8:11], s29 offen sc1 lds
  s_add_u32 m0, s31, 4096
  s_add_u32 s29, s53, s27
  s_add_u32 s29, s29, 4096
  buffer_load_dwordx4 v2, s[8:11], s29 offen sc1 lds
  s_add_u32 m0, s31, 5120
  s_add_u32 s29, s53, s27
  s_add_u32 s29, s29, 5120
  buffer_load_dwordx4 v2, s[8:11], s29 offen sc1 lds
  s_add_u32 m0, s31, 6144
  s_add_u32 s29, s53, s27
  s_add_u32 s29, s29, 6144
  buffer_load_dwordx4 v2, s[8:11], s29 offen sc1 lds
  s_add_u32 m0, s31, 7168
  s_add_u32 s29, s53, s27
  s_add_u32 s29, s29, 7168
  buffer_load_dwordx4 v2, s[8:11], s29 offen sc1 lds
  s_add_u32 m0, s31, 32768
  s_add_u32 s29, s53, s28
  s_add_u32 s29, s29, 0
  buffer_load_dwordx4 v2, s[8:11], s29 offen sc1 lds
  s_add_u32 m0, s31, 33792
  s_add_u32 s29, s53, s28
  s_add_u32 s29, s29, 1024
  buffer_load_dwordx4 v2, s[8:11], s29 offen sc1 lds
  s_add_u32 m0, s31, 34816
  s_add_u32 s29, s53, s28
  s_add_u32 s29, s29, 2048
  buffer_load_dwordx4 v2, s[8:11], s29 offen sc1 lds
  s_add_u32 m0, s31, 35840
  s_add_u32 s29, s53, s28
  s_add_u32 s29, s29, 3072
  buffer_load_dwordx4 v2, s[8:11], s29 offen sc1 lds
  s_add_u32 m0, s31, 36864
  s_add_u32 s29, s53, s28
  s_add_u32 s29, s29, 4096
  buffer_load_dwordx4 v2, s[8:11], s29 offen sc1 lds
  s_add_u32 m0, s31, 37888
  s_add_u32 s29, s53, s28
  s_add_u32 s29, s29, 5120
  buffer_load_dwordx4 v2, s[8:11], s29 offen sc1 lds
  s_add_u32 m0, s31, 38912
  s_add_u32 s29, s53, s28
  s_add_u32 s29, s29, 6144
  buffer_load_dwordx4 v2, s[8:11], s29 offen sc1 lds
  s_add_u32 m0, s31, 39936
  s_add_u32 s29, s53, s28
  s_add_u32 s29, s29, 7168
  buffer_load_dwordx4 v2, s[8:11], s29 offen sc1 lds
  s_waitcnt vmcnt(16)
  v_max_f32_dpp v5, v4, v4 quad_perm:[1,0,3,2] row_mask:0xf bank_mask:0xf
  s_nop 1
  v_max_f32_dpp v4, v5, v5 quad_perm:[2,3,0,1] row_mask:0xf bank_mask:0xf
  s_nop 1
  v_max_f32_dpp v5, v4, v4 row_half_mirror row_mask:0xf bank_mask:0xf
  s_nop 1
  v_max_f32_dpp v4, v5, v5 row_mirror row_mask:0xf bank_mask:0xf
  v_mov_b32 v5, v4
  s_nop 1
  v_permlane16_swap_b32 v4, v5
  v_max_f32 v4, v4, v5
  v_mul_f32 v12, v12, v4
  v_mul_f32 v12, 0x3f820000, v12
  v_mul_f32 v13, v13, v4
  v_mul_f32 v13, 0x3f820000, v13
  s_mov_b32 s40, 0
kb2_main:
  v_lshrrev_b32 v5, 16, v12
  v_or_b32 v5, 0x8000, v5
  v_and_b32 v6, 0xffff0000, v198
  v_or_b32 v5, v5, v6
  v_cndmask_b32 v198, v198, v5, s[34:35]
  v_lshrrev_b32 v5, 16, v13
  v_or_b32 v5, 0x8000, v5
  v_and_b32 v6, 0xffff0000, v206
  v_or_b32 v5, v5, v6
  v_cndmask_b32 v206, v206, v5, s[34:35]
kb2_main2:
  v_mov_b32 v112, 0
  v_mov_b32 v113, 0
  v_mov_b32 v114, 0
  v_mov_b32 v115, 0
  v_mov_b32 v116, 0
  v_mov_b32 v117, 0
  v_mov_b32 v118, 0
  v_mov_b32 v119, 0
  v_mov_b32 v120, 0
  v_mov_b32 v121, 0
  v_mov_b32 v122, 0
  v_mov_b32 v123, 0
  v_mov_b32 v124, 0
  v_mov_b32 v125, 0
  v_mov_b32 v126, 0
  v_mov_b32 v127, 0
  v_mov_b32 v128, 0
  v_mov_b32 v129, 0
  v_mov_b32 v130, 0
  v_mov_b32 v131, 0
  v_mov_b32 v132, 0
  v_mov_b32 v133, 0
  v_mov_b32 v134, 0
  v_mov_b32 v135, 0
  v_mov_b32 v136, 0
  v_mov_b32 v137, 0
  v_mov_b32 v138, 0
  v_mov_b32 v139, 0
  v_mov_b32 v140, 0
  v_mov_b32 v141, 0
  v_mov_b32 v142, 0
  v_mov_b32 v143, 0
  v_mov_b32 v3, v2
  v_add_u32 v4, 65536, v2
kb2_chunk2:
  s_waitcnt vmcnt(0)
  s_barrier
  s_add_u32 s41, s41, 1
  s_min_u32 s29, s41, 3
  s_mul_i32 s53, s29, 32768
  s_lshl_b32 s31, s21, 13
  s_add_u32 s53, s53, s31
  ds_read_b128 v[32:35], v3 offset:0
  ds_read_b128 v[36:39], v3 offset:1024
  ds_read_b128 v[48:51], v3 offset:32768
  ds_read_b128 v[52:55], v3 offset:33792
  ds_read_b128 v[40:43], v3 offset:2048
  ds_read_b128 v[44:47], v3 offset:3072
  s_waitcnt lgkmcnt(4)
  v_mfma_f32_32x32x16_bf16 v[64:79], v[32:35], v[192:195], 0
  v_mfma_f32_32x32x16_bf16 v[64:79], v[36:39], v[196:199], v[64:79]
  s_nop 11
  v_exp_f32 v64, v64
  v_exp_f32 v65, v65
  v_exp_f32 v66, v66
  v_exp_f32 v67, v67
  v_cvt_pk_bf16_f32 v96, v64, v65
  v_exp_f32 v68, v68
  v_exp_f32 v69, v69
  v_cvt_pk_bf16_f32 v97, v66, v67
  v_exp_f32 v70, v70
  v_mfma_f32_32x32x16_bf16 v[80:95], v[32:35], v[200:203], 0
  v_exp_f32 v71, v71
  v_cvt_pk_bf16_f32 v98, v68, v69
  v_exp_f32 v72, v72
  v_exp_f32 v73, v73
  v_cvt_pk_bf16_f32 v99, v70, v71
  v_mfma_f32_32x32x16_bf16 v[80:95], v[36:39], v[204:207], v[80:95]
  v_exp_f32 v74, v74
  v_exp_f32 v75, v75
  ds_read_b128 v[56:59], v3 offset:34816
  v_cvt_pk_bf16_f32 v100, v72, v73
  v_exp_f32 v76, v76
  v_exp_f32 v77, v77
  ds_read_b128 v[60:63], v3 offset:35840
  v_cvt_pk_bf16_f32 v101, v74, v75
  v_exp_f32 v78, v78
  s_add_u32 m0, s31, 65536
  s_add_u32 s29, s53, s27
  s_add_u32 s29, s29, 0
  buffer_load_dwordx4 v2, s[8:11], s29 offen sc1 lds
  v_exp_f32 v79, v79
  v_cvt_pk_bf16_f32 v102, v76, v77
  v_cvt_pk_bf16_f32 v103, v78, v79
  s_waitcnt lgkmcnt(4)
  v_mfma_f32_32x32x16_bf16 v[112:127], v[48:51], v[96:99], v[112:127]
  v_exp_f32 v80, v80
  v_exp_f32 v81, v81
  v_exp_f32 v82, v82
  v_exp_f32 v83, v83
  v_mfma_f32_32x32x16_bf16 v[112:127], v[52:55], v[100:103], v[112:127]
  v_cvt_pk_bf16_f32 v104, v80, v81
  v_exp_f32 v84, v84
  v_exp_f32 v85, v85
  v_cvt_pk_bf16_f32 v105, v82, v83
  v_exp_f32 v86, v86
  s_waitcnt lgkmcnt(2)
  v_mfma_f32_32x32x16_bf16 v[64:79], v[40:43], v[192:195], 0
  v_exp_f32 v87, v87
  v_cvt_pk_bf16_f32 v106, v84, v85
  v_exp_f32 v88, v88
  v_exp_f32 v89, v89
  v_cvt_pk_bf16_f32 v107, v86, v87
  v_mfma_f32_32x32x16_bf16 v[64:79], v[44:47], v[196:199], v[64:79]
  v_exp_f32 v90, v90
  v_exp_f32 v91, v91
  ds_read_b128 v[32:35], v3 offset:4096
  v_cvt_pk_bf16_f32 v108, v88, v89
  v_exp_f32 v92, v92
  v_exp_f32 v93, v93
  ds_read_b128 v[36:39], v3 offset:5120
  v_cvt_pk_bf16_f32 v109, v90, v91
  v_exp_f32 v94, v94
  v_exp_f32 v95, v95
  v_cvt_pk_bf16_f32 v110, v92, v93
  v_cvt_pk_bf16_f32 v111, v94, v95
  v_mfma_f32_32x32x16_bf16 v[128:143], v[48:51], v[104:107], v[128:143]
  v_exp_f32 v64, v64
  v_exp_f32 v65, v65
  v_exp_f32 v66, v66
  v_exp_f32 v67, v67
  v_mfma_f32_32x32x16_bf16 v[128:143], v[52:55], v[108:111], v[128:143]
  v_cvt_pk_bf16_f32 v96, v64, v65
  v_exp_f32 v68, v68
  v_exp_f32 v69, v69
  v_cvt_pk_bf16_f32 v97, v66, v67
  v_exp_f32 v70, v70
  v_mfma_f32_32x32x16_bf16 v[80:95], v[40:43], v[200:203], 0
  v_exp_f32 v71, v71
  v_cvt_pk_bf16_f32 v98, v68, v69
  v_exp_f32 v72, v72
  v_exp_f32 v73, v73
  v_cvt_pk_bf16_f32 v99, v70, v71
  v_mfma_f32_32x32x16_bf16 v[80:95], v[44:47], v[204:207], v[80:95]
  v_exp_f32 v74, v74
  v_exp_f32 v75, v75
  ds_read_b128 v[48:51], v3 offset:36864
  v_cvt_pk_bf16_f32 v100, v72, v73
  v_exp_f32 v76, v76
  v_exp_f32 v77, v77
  ds_read_b128 v[52:55], v3 offset:37888
  v_cvt_pk_bf16_f32 v101, v74, v75
  v_exp_f32 v78, v78
  s_add_u32 m0, s31, 66560
  s_add_u32 s29, s53, s27
  s_add_u32 s29, s29, 1024
  buffer_load_dwordx4 v2, s[8:11], s29 offen sc1 lds
  v_exp_f32 v79, v79
  v_cvt_pk_bf16_f32 v102, v76, v77
  v_cvt_pk_bf16_f32 v103, v78, v79
  s_waitcnt lgkmcnt(4)
  v_mfma_f32_32x32x16_bf16 v[112:127], v[56:59], v[96:99], v[112:127]
  v_exp_f32 v80, v80
  v_exp_f32 v81, v81
  v_exp_f32 v82, v82
  v_exp_f32 v83, v83
  v_mfma_f32_32x32x16_bf16 v[112:127], v[60:63], v[100:103], v[112:127]
  v_cvt_pk_bf16_f32 v104, v80, v81
  v_exp_f32 v84, v84
  v_exp_f32 v85, v85
  v_cvt_pk_bf16_f32 v105, v82, v83
  v_exp_f32 v86, v86
  s_waitcnt lgkmcnt(2)
  v_mfma_f32_32x32x16_bf16 v[64:79], v[32:35], v[192:195], 0
  v_exp_f32 v87, v87
  v_cvt_pk_bf16_f32 v106, v84, v85
  v_exp_f32 v88, v88
  v_exp_f32 v89, v89
  v_cvt_pk_bf16_f32 v107, v86, v87
  v_mfma_f32_32x32x16_bf16 v[64:79], v[36:39], v[196:199], v[64:79]
  v_exp_f32 v90, v90
  v_exp_f32 v91, v91
  ds_read_b128 v[40:43], v3 offset:6144
  v_cvt_pk_bf16_f32 v108, v88, v89
  v_exp_f32 v92, v92
  v_exp_f32 v93, v93
  ds_read_b128 v[44:47], v3 offset:7168
  v_cvt_pk_bf16_f32 v109, v90, v91
  v_exp_f32 v94, v94
  v_exp_f32 v95, v95
  v_cvt_pk_bf16_f32 v110, v92, v93
  v_cvt_pk_bf16_f32 v111, v94, v95
  v_mfma_f32_32x32x16_bf16 v[128:143], v[56:59], v[104:107], v[128:143]
  v_exp_f32 v64, v64
  v_exp_f32 v65, v65
  v_exp_f32 v66, v66
  v_exp_f32 v67, v67
  v_mfma_f32_32x32x16_bf16 v[128:143], v[60:63], v[108:111], v[128:143]
  v_cvt_pk_bf16_f32 v96, v64, v65
  v_exp_f32 v68, v68
  v_exp_f32 v69, v69
  v_cvt_pk_bf16_f32 v97, v66, v67
  v_exp_f32 v70, v70
  v_mfma_f32_32x32x16_bf16 v[80:95], v[32:35], v[200:203], 0
  v_exp_f32 v71, v71
  v_cvt_pk_bf16_f32 v98, v68, v69
  v_exp_f32 v72, v72
  v_exp_f32 v73, v73
  v_cvt_pk_bf16_f32 v99, v70, v71
  v_mfma_f32_32x32x16_bf16 v[80:95], v[36:39], v[204:207], v[80:95]
  v_exp_f32 v74, v74
  v_exp_f32 v75, v75
  ds_read_b128 v[56:59], v3 offset:38912
  v_cvt_pk_bf16_f32 v100, v72, v73
  v_exp_f32 v76, v76
  v_exp_f32 v77, v77
  ds_read_b128 v[60:63], v3 offset:39936
  v_cvt_pk_bf16_f32 v101, v74, v75
  v_exp_f32 v78, v78
  s_add_u32 m0, s31, 67584
  s_add_u32 s29, s53, s27
  s_add_u32 s29, s29, 2048
  buffer_load_dwordx4 v2, s[8:11], s29 offen sc1 lds
  v_exp_f32 v79, v79
  v_cvt_pk_bf16_f32 v102, v76, v77
  v_cvt_pk_bf16_f32 v103, v78, v79
  s_waitcnt lgkmcnt(4)
  v_mfma_f32_32x32x16_bf16 v[112:127], v[48:51], v[96:99], v[112:127]
  v_exp_f32 v80, v80
  v_exp_f32 v81, v81
  v_exp_f32 v82, v82
  v_exp_f32 v83, v83
  v_mfma_f32_32x32x16_bf16 v[112:127], v[52:55], v[100:103], v[112:127]
  v_cvt_pk_bf16_f32 v104, v80, v81
  v_exp_f32 v84, v84
  v_exp_f32 v85, v85
  v_cvt_pk_bf16_f32 v105, v82, v83
  v_exp_f32 v86, v86
  s_waitcnt lgkmcnt(2)
  v_mfma_f32_32x32x16_bf16 v[64:79], v[40:43], v[192:195], 0
  v_exp_f32 v87, v87
  v_cvt_pk_bf16_f32 v106, v84, v85
  v_exp_f32 v88, v88
  v_exp_f32 v89, v89
  v_cvt_pk_bf16_f32 v107, v86, v87
  v_mfma_f32_32x32x16_bf16 v[64:79], v[44:47], v[196:199], v[64:79]
  v_exp_f32 v90, v90
  v_exp_f32 v91, v91
  ds_read_b128 v[32:35], v3 offset:8192
  v_cvt_pk_bf16_f32 v108, v88, v89
  v_exp_f32 v92, v92
  v_exp_f32 v93, v93
  ds_read_b128 v[36:39], v3 offset:9216
  v_cvt_pk_bf16_f32 v109, v90, v91
  v_exp_f32 v94, v94
  v_exp_f32 v95, v95
  v_cvt_pk_bf16_f32 v110, v92, v93
  v_cvt_pk_bf16_f32 v111, v94, v95
  v_mfma_f32_32x32x16_bf16 v[128:143], v[48:51], v[104:107], v[128:143]
  v_exp_f32 v64, v64
  v_exp_f32 v65, v65
  v_exp_f32 v66, v66
  v_exp_f32 v67, v67
  v_mfma_f32_32x32x16_bf16 v[128:143], v[52:55], v[108:111], v[128:143]
  v_cvt_pk_bf16_f32 v96, v64, v65
  v_exp_f32 v68, v68
  v_exp_f32 v69, v69
  v_cvt_pk_bf16_f32 v97, v66, v67
  v_exp_f32 v70, v70
  v_mfma_f32_32x32x16_bf16 v[80:95], v[40:43], v[200:203], 0
  v_exp_f32 v71, v71
  v_cvt_pk_bf16_f32 v98, v68, v69
  v_exp_f32 v72, v72
  v_exp_f32 v73, v73
  v_cvt_pk_bf16_f32 v99, v70, v71
  v_mfma_f32_32x32x16_bf16 v[80:95], v[44:47], v[204:207], v[80:95]
  v_exp_f32 v74, v74
  v_exp_f32 v75, v75
  ds_read_b128 v[48:51], v3 offset:40960
  v_cvt_pk_bf16_f32 v100, v72, v73
  v_exp_f32 v76, v76
  v_exp_f32 v77, v77
  ds_read_b128 v[52:55], v3 offset:41984
  v_cvt_pk_bf16_f32 v101, v74, v75
  v_exp_f32 v78, v78
  s_add_u32 m0, s31, 68608
  s_add_u32 s29, s53, s27
  s_add_u32 s29, s29, 3072
  buffer_load_dwordx4 v2, s[8:11], s29 offen sc1 lds
  v_exp_f32 v79, v79
  v_cvt_pk_bf16_f32 v102, v76, v77
  v_cvt_pk_bf16_f32 v103, v78, v79
  s_waitcnt lgkmcnt(4)
  v_mfma_f32_32x32x16_bf16 v[112:127], v[56:59], v[96:99], v[112:127]
  v_exp_f32 v80, v80
  v_exp_f32 v81, v81
  v_exp_f32 v82, v82
  v_exp_f32 v83, v83
  v_mfma_f32_32x32x16_bf16 v[112:127], v[60:63], v[100:103], v[112:127]
  v_cvt_pk_bf16_f32 v104, v80, v81
  v_exp_f32 v84, v84
  v_exp_f32 v85, v85
  v_cvt_pk_bf16_f32 v105, v82, v83
  v_exp_f32 v86, v86
  s_waitcnt lgkmcnt(2)
  v_mfma_f32_32x32x16_bf16 v[64:79], v[32:35], v[192:195], 0
  v_exp_f32 v87, v87
  v_cvt_pk_bf16_f32 v106, v84, v85
  v_exp_f32 v88, v88
  v_exp_f32 v89, v89
  v_cvt_pk_bf16_f32 v107, v86, v87
  v_mfma_f32_32x32x16_bf16 v[64:79], v[36:39], v[196:199], v[64:79]
  v_exp_f32 v90, v90
  v_exp_f32 v91, v91
  ds_read_b128 v[40:43], v3 offset:10240
  v_cvt_pk_bf16_f32 v108, v88, v89
  v_exp_f32 v92, v92
  v_exp_f32 v93, v93
  ds_read_b128 v[44:47], v3 offset:11264
  v_cvt_pk_bf16_f32 v109, v90, v91
  v_exp_f32 v94, v94
  v_exp_f32 v95, v95
  v_cvt_pk_bf16_f32 v110, v92, v93
  v_cvt_pk_bf16_f32 v111, v94, v95
  v_mfma_f32_32x32x16_bf16 v[128:143], v[56:59], v[104:107], v[128:143]
  v_exp_f32 v64, v64
  v_exp_f32 v65, v65
  v_exp_f32 v66, v66
  v_exp_f32 v67, v67
  v_mfma_f32_32x32x16_bf16 v[128:143], v[60:63], v[108:111], v[128:143]
  v_cvt_pk_bf16_f32 v96, v64, v65
  v_exp_f32 v68, v68
  v_exp_f32 v69, v69
  v_cvt_pk_bf16_f32 v97, v66, v67
  v_exp_f32 v70, v70
  v_mfma_f32_32x32x16_bf16 v[80:95], v[32:35], v[200:203], 0
  v_exp_f32 v71, v71
  v_cvt_pk_bf16_f32 v98, v68, v69
  v_exp_f32 v72, v72
  v_exp_f32 v73, v73
  v_cvt_pk_bf16_f32 v99, v70, v71
  v_mfma_f32_32x32x16_bf16 v[80:95], v[36:39], v[204:207], v[80:95]
  v_exp_f32 v74, v74
  v_exp_f32 v75, v75
  ds_read_b128 v[56:59], v3 offset:43008
  v_cvt_pk_bf16_f32 v100, v72, v73
  v_exp_f32 v76, v76
  v_exp_f32 v77, v77
  ds_read_b128 v[60:63], v3 offset:44032
  v_cvt_pk_bf16_f32 v101, v74, v75
  v_exp_f32 v78, v78
  s_add_u32 m0, s31, 69632
  s_add_u32 s29, s53, s27
  s_add_u32 s29, s29, 4096
  buffer_load_dwordx4 v2, s[8:11], s29 offen sc1 lds
  v_exp_f32 v79, v79
  v_cvt_pk_bf16_f32 v102, v76, v77
  v_cvt_pk_bf16_f32 v103, v78, v79
  s_waitcnt lgkmcnt(4)
  v_mfma_f32_32x32x16_bf16 v[112:127], v[48:51], v[96:99], v[112:127]
  v_exp_f32 v80, v80
  v_exp_f32 v81, v81
  v_exp_f32 v82, v82
  v_exp_f32 v83, v83
  v_mfma_f32_32x32x16_bf16 v[112:127], v[52:55], v[100:103], v[112:127]
  v_cvt_pk_bf16_f32 v104, v80, v81
  v_exp_f32 v84, v84
  v_exp_f32 v85, v85
  v_cvt_pk_bf16_f32 v105, v82, v83
  v_exp_f32 v86, v86
  s_waitcnt lgkmcnt(2)
  v_mfma_f32_32x32x16_bf16 v[64:79], v[40:43], v[192:195], 0
  v_exp_f32 v87, v87
  v_cvt_pk_bf16_f32 v106, v84, v85
  v_exp_f32 v88, v88
  v_exp_f32 v89, v89
  v_cvt_pk_bf16_f32 v107, v86, v87
  v_mfma_f32_32x32x16_bf16 v[64:79], v[44:47], v[196:199], v[64:79]
  v_exp_f32 v90, v90
  v_exp_f32 v91, v91
  ds_read_b128 v[32:35], v3 offset:12288
  v_cvt_pk_bf16_f32 v108, v88, v89
  v_exp_f32 v92, v92
  v_exp_f32 v93, v93
  ds_read_b128 v[36:39], v3 offset:13312
  v_cvt_pk_bf16_f32 v109, v90, v91
  v_exp_f32 v94, v94
  v_exp_f32 v95, v95
  v_cvt_pk_bf16_f32 v110, v92, v93
  v_cvt_pk_bf16_f32 v111, v94, v95
  v_mfma_f32_32x32x16_bf16 v[128:143], v[48:51], v[104:107], v[128:143]
  v_exp_f32 v64, v64
  v_exp_f32 v65, v65
  v_exp_f32 v66, v66
  v_exp_f32 v67, v67
  v_mfma_f32_32x32x16_bf16 v[128:143], v[52:55], v[108:111], v[128:143]
  v_cvt_pk_bf16_f32 v96, v64, v65
  v_exp_f32 v68, v68
  v_exp_f32 v69, v69
  v_cvt_pk_bf16_f32 v97, v66, v67
  v_exp_f32 v70, v70
  v_mfma_f32_32x32x16_bf16 v[80:95], v[40:43], v[200:203], 0
  v_exp_f32 v71, v71
  v_cvt_pk_bf16_f32 v98, v68, v69
  v_exp_f32 v72, v72
  v_exp_f32 v73, v73
  v_cvt_pk_bf16_f32 v99, v70, v71
  v_mfma_f32_32x32x16_bf16 v[80:95], v[44:47], v[204:207], v[80:95]
  v_exp_f32 v74, v74
  v_exp_f32 v75, v75
  ds_read_b128 v[48:51], v3 offset:45056
  v_cvt_pk_bf16_f32 v100, v72, v73
  v_exp_f32 v76, v76
  v_exp_f32 v77, v77
  ds_read_b128 v[52:55], v3 offset:46080
  v_cvt_pk_bf16_f32 v101, v74, v75
  v_exp_f32 v78, v78
  s_add_u32 m0, s31, 70656
  s_add_u32 s29, s53, s27
  s_add_u32 s29, s29, 5120
  buffer_load_dwordx4 v2, s[8:11], s29 offen sc1 lds
  v_exp_f32 v79, v79
  v_cvt_pk_bf16_f32 v102, v76, v77
  v_cvt_pk_bf16_f32 v103, v78, v79
  s_waitcnt lgkmcnt(4)
  v_mfma_f32_32x32x16_bf16 v[112:127], v[56:59], v[96:99], v[112:127]
  v_exp_f32 v80, v80
  v_exp_f32 v81, v81
  v_exp_f32 v82, v82
  v_exp_f32 v83, v83
  v_mfma_f32_32x32x16_bf16 v[112:127], v[60:63], v[100:103], v[112:127]
  v_cvt_pk_bf16_f32 v104, v80, v81
  v_exp_f32 v84, v84
  v_exp_f32 v85, v85
  v_cvt_pk_bf16_f32 v105, v82, v83
  v_exp_f32 v86, v86
  s_waitcnt lgkmcnt(2)
  v_mfma_f32_32x32x16_bf16 v[64:79], v[32:35], v[192:195], 0
  v_exp_f32 v87, v87
  v_cvt_pk_bf16_f32 v106, v84, v85
  v_exp_f32 v88, v88
  v_exp_f32 v89, v89
  v_cvt_pk_bf16_f32 v107, v86, v87
  v_mfma_f32_32x32x16_bf16 v[64:79], v[36:39], v[196:199], v[64:79]
  v_exp_f32 v90, v90
  v_exp_f32 v91, v91
  ds_read_b128 v[40:43], v3 offset:14336
  v_cvt_pk_bf16_f32 v108, v88, v89
  v_exp_f32 v92, v92
  v_exp_f32 v93, v93
  ds_read_b128 v[44:47], v3 offset:15360
  v_cvt_pk_bf16_f32 v109, v90, v91
  v_exp_f32 v94, v94
  v_exp_f32 v95, v95
  v_cvt_pk_bf16_f32 v110, v92, v93
  v_cvt_pk_bf16_f32 v111, v94, v95
  v_mfma_f32_32x32x16_bf16 v[128:143], v[56:59], v[104:107], v[128:143]
  v_exp_f32 v64, v64
  v_exp_f32 v65, v65
  v_exp_f32 v66, v66
  v_exp_f32 v67, v67
  v_mfma_f32_32x32x16_bf16 v[128:143], v[60:63], v[108:111], v[128:143]
  v_cvt_pk_bf16_f32 v96, v64, v65
  v_exp_f32 v68, v68
  v_exp_f32 v69, v69
  v_cvt_pk_bf16_f32 v97, v66, v67
  v_exp_f32 v70, v70
  v_mfma_f32_32x32x16_bf16 v[80:95], v[32:35], v[200:203], 0
  v_exp_f32 v71, v71
  v_cvt_pk_bf16_f32 v98, v68, v69
  v_exp_f32 v72, v72
  v_exp_f32 v73, v73
  v_cvt_pk_bf16_f32 v99, v70, v71
  v_mfma_f32_32x32x16_bf16 v[80:95], v[36:39], v[204:207], v[80:95]
  v_exp_f32 v74, v74
  v_exp_f32 v75, v75
  ds_read_b128 v[56:59], v3 offset:47104
  v_cvt_pk_bf16_f32 v100, v72, v73
  v_exp_f32 v76, v76
  v_exp_f32 v77, v77
  ds_read_b128 v[60:63], v3 offset:48128
  v_cvt_pk_bf16_f32 v101, v74, v75
  v_exp_f32 v78, v78
  s_add_u32 m0, s31, 71680
  s_add_u32 s29, s53, s27
  s_add_u32 s29, s29, 6144
  buffer_load_dwordx4 v2, s[8:11], s29 offen sc1 lds
  v_exp_f32 v79, v79
  v_cvt_pk_bf16_f32 v102, v76, v77
  v_cvt_pk_bf16_f32 v103, v78, v79
  s_waitcnt lgkmcnt(4)
  v_mfma_f32_32x32x16_bf16 v[112:127], v[48:51], v[96:99], v[112:127]
  v_exp_f32 v80, v80
  v_exp_f32 v81, v81
  v_exp_f32 v82, v82
  v_exp_f32 v83, v83
  v_mfma_f32_32x32x16_bf16 v[112:127], v[52:55], v[100:103], v[112:127]
  v_cvt_pk_bf16_f32 v104, v80, v81
  v_exp_f32 v84, v84
  v_exp_f32 v85, v85
  v_cvt_pk_bf16_f32 v105, v82, v83
  v_exp_f32 v86, v86
  s_waitcnt lgkmcnt(2)
  v_mfma_f32_32x32x16_bf16 v[64:79], v[40:43], v[192:195], 0
  v_exp_f32 v87, v87
  v_cvt_pk_bf16_f32 v106, v84, v85
  v_exp_f32 v88, v88
  v_exp_f32 v89, v89
  v_cvt_pk_bf16_f32 v107, v86, v87
  v_mfma_f32_32x32x16_bf16 v[64:79], v[44:47], v[196:199], v[64:79]
  v_exp_f32 v90, v90
  v_exp_f32 v91, v91
  ds_read_b128 v[32:35], v3 offset:16384
  v_cvt_pk_bf16_f32 v108, v88, v89
  v_exp_f32 v92, v92
  v_exp_f32 v93, v93
  ds_read_b128 v[36:39], v3 offset:17408
  v_cvt_pk_bf16_f32 v109, v90, v91
  v_exp_f32 v94, v94
  v_exp_f32 v95, v95
  v_cvt_pk_bf16_f32 v110, v92, v93
  v_cvt_pk_bf16_f32 v111, v94, v95
  v_mfma_f32_32x32x16_bf16 v[128:143], v[48:51], v[104:107], v[128:143]
  v_exp_f32 v64, v64
  v_exp_f32 v65, v65
  v_exp_f32 v66, v66
  v_exp_f32 v67, v67
  v_mfma_f32_32x32x16_bf16 v[128:143], v[52:55], v[108:111], v[128:143]
  v_cvt_pk_bf16_f32 v96, v64, v65
  v_exp_f32 v68, v68
  v_exp_f32 v69, v69
  v_cvt_pk_bf16_f32 v97, v66, v67
  v_exp_f32 v70, v70
  v_mfma_f32_32x32x16_bf16 v[80:95], v[40:43], v[200:203], 0
  v_exp_f32 v71, v71
  v_cvt_pk_bf16_f32 v98, v68, v69
  v_exp_f32 v72, v72
  v_exp_f32 v73, v73
  v_cvt_pk_bf16_f32 v99, v70, v71
  v_mfma_f32_32x32x16_bf16 v[80:95], v[44:47], v[204:207], v[80:95]
  v_exp_f32 v74, v74
  v_exp_f32 v75, v75
  ds_read_b128 v[48:51], v3 offset:49152
  v_cvt_pk_bf16_f32 v100, v72, v73
  v_exp_f32 v76, v76
  v_exp_f32 v77, v77
  ds_read_b128 v[52:55], v3 offset:50176
  v_cvt_pk_bf16_f32 v101, v74, v75
  v_exp_f32 v78, v78
  s_add_u32 m0, s31, 72704
  s_add_u32 s29, s53, s27
  s_add_u32 s29, s29, 7168
  buffer_load_dwordx4 v2, s[8:11], s29 offen sc1 lds
  v_exp_f32 v79, v79
  v_cvt_pk_bf16_f32 v102, v76, v77
  v_cvt_pk_bf16_f32 v103, v78, v79
  s_waitcnt lgkmcnt(4)
  v_mfma_f32_32x32x16_bf16 v[112:127], v[56:59], v[96:99], v[112:127]
  v_exp_f32 v80, v80
  v_exp_f32 v81, v81
  v_exp_f32 v82, v82
  v_exp_f32 v83, v83
  v_mfma_f32_32x32x16_bf16 v[112:127], v[60:63], v[100:103], v[112:127]
  v_cvt_pk_bf16_f32 v104, v80, v81
  v_exp_f32 v84, v84
  v_exp_f32 v85, v85
  v_cvt_pk_bf16_f32 v105, v82, v83
  v_exp_f32 v86, v86
  s_waitcnt lgkmcnt(2)
  v_mfma_f32_32x32x16_bf16 v[64:79], v[32:35], v[192:195], 0
  v_exp_f32 v87, v87
  v_cvt_pk_bf16_f32 v106, v84, v85
  v_exp_f32 v88, v88
  v_exp_f32 v89, v89
  v_cvt_pk_bf16_f32 v107, v86, v87
  v_mfma_f32_32x32x16_bf16 v[64:79], v[36:39], v[196:199], v[64:79]
  v_exp_f32 v90, v90
  v_exp_f32 v91, v91
  ds_read_b128 v[40:43], v3 offset:18432
  v_cvt_pk_bf16_f32 v108, v88, v89
  v_exp_f32 v92, v92
  v_exp_f32 v93, v93
  ds_read_b128 v[44:47], v3 offset:19456
  v_cvt_pk_bf16_f32 v109, v90, v91
  v_exp_f32 v94, v94
  v_exp_f32 v95, v95
  v_cvt_pk_bf16_f32 v110, v92, v93
  v_cvt_pk_bf16_f32 v111, v94, v95
  v_mfma_f32_32x32x16_bf16 v[128:143], v[56:59], v[104:107], v[128:143]
  v_exp_f32 v64, v64
  v_exp_f32 v65, v65
  v_exp_f32 v66, v66
  v_exp_f32 v67, v67
  v_mfma_f32_32x32x16_bf16 v[128:143], v[60:63], v[108:111], v[128:143]
  v_cvt_pk_bf16_f32 v96, v64, v65
  v_exp_f32 v68, v68
  v_exp_f32 v69, v69
  v_cvt_pk_bf16_f32 v97, v66, v67
  v_exp_f32 v70, v70
  v_mfma_f32_32x32x16_bf16 v[80:95], v[32:35], v[200:203], 0
  v_exp_f32 v71, v71
  v_cvt_pk_bf16_f32 v98, v68, v69
  v_exp_f32 v72, v72
  v_exp_f32 v73, v73
  v_cvt_pk_bf16_f32 v99, v70, v71
  v_mfma_f32_32x32x16_bf16 v[80:95], v[36:39], v[204:207], v[80:95]
  v_exp_f32 v74, v74
  v_exp_f32 v75, v75
  ds_read_b128 v[56:59], v3 offset:51200
  v_cvt_pk_bf16_f32 v100, v72, v73
  v_exp_f32 v76, v76
  v_exp_f32 v77, v77
  ds_read_b128 v[60:63], v3 offset:52224
  v_cvt_pk_bf16_f32 v101, v74, v75
  v_exp_f32 v78, v78
  s_add_u32 m0, s31, 98304
  s_add_u32 s29, s53, s28
  s_add_u32 s29, s29, 0
  buffer_load_dwordx4 v2, s[8:11], s29 offen sc1 lds
  v_exp_f32 v79, v79
  v_cvt_pk_bf16_f32 v102, v76, v77
  v_cvt_pk_bf16_f32 v103, v78, v79
  s_waitcnt lgkmcnt(4)
  v_mfma_f32_32x32x16_bf16 v[112:127], v[48:51], v[96:99], v[112:127]
  v_exp_f32 v80, v80
  v_exp_f32 v81, v81
  v_exp_f32 v82, v82
  v_exp_f32 v83, v83
  v_mfma_f32_32x32x16_bf16 v[112:127], v[52:55], v[100:103], v[112:127]
  v_cvt_pk_bf16_f32 v104, v80, v81
  v_exp_f32 v84, v84
  v_exp_f32 v85, v85
  v_cvt_pk_bf16_f32 v105, v82, v83
  v_exp_f32 v86, v86
  s_waitcnt lgkmcnt(2)
  v_mfma_f32_32x32x16_bf16 v[64:79], v[40:43], v[192:195], 0
  v_exp_f32 v87, v87
  v_cvt_pk_bf16_f32 v106, v84, v85
  v_exp_f32 v88, v88
  v_exp_f32 v89, v89
  v_cvt_pk_bf16_f32 v107, v86, v87
  v_mfma_f32_32x32x16_bf16 v[64:79], v[44:47], v[196:199], v[64:79]
  v_exp_f32 v90, v90
  v_exp_f32 v91, v91
  ds_read_b128 v[32:35], v3 offset:20480
  v_cvt_pk_bf16_f32 v108, v88, v89
  v_exp_f32 v92, v92
  v_exp_f32 v93, v93
  ds_read_b128 v[36:39], v3 offset:21504
  v_cvt_pk_bf16_f32 v109, v90, v91
  v_exp_f32 v94, v94
  v_exp_f32 v95, v95
  v_cvt_pk_bf16_f32 v110, v92, v93
  v_cvt_pk_bf16_f32 v111, v94, v95
  v_mfma_f32_32x32x16_bf16 v[128:143], v[48:51], v[104:107], v[128:143]
  v_exp_f32 v64, v64
  v_exp_f32 v65, v65
  v_exp_f32 v66, v66
  v_exp_f32 v67, v67
  v_mfma_f32_32x32x16_bf16 v[128:143], v[52:55], v[108:111], v[128:143]
  v_cvt_pk_bf16_f32 v96, v64, v65
  v_exp_f32 v68, v68
  v_exp_f32 v69, v69
  v_cvt_pk_bf16_f32 v97, v66, v67
  v_exp_f32 v70, v70
  v_mfma_f32_32x32x16_bf16 v[80:95], v[40:43], v[200:203], 0
  v_exp_f32 v71, v71
  v_cvt_pk_bf16_f32 v98, v68, v69
  v_exp_f32 v72, v72
  v_exp_f32 v73, v73
  v_cvt_pk_bf16_f32 v99, v70, v71
  v_mfma_f32_32x32x16_bf16 v[80:95], v[44:47], v[204:207], v[80:95]
  v_exp_f32 v74, v74
  v_exp_f32 v75, v75
  ds_read_b128 v[48:51], v3 offset:53248
  v_cvt_pk_bf16_f32 v100, v72, v73
  v_exp_f32 v76, v76
  v_exp_f32 v77, v77
  ds_read_b128 v[52:55], v3 offset:54272
  v_cvt_pk_bf16_f32 v101, v74, v75
  v_exp_f32 v78, v78
  s_add_u32 m0, s31, 99328
  s_add_u32 s29, s53, s28
  s_add_u32 s29, s29, 1024
  buffer_load_dwordx4 v2, s[8:11], s29 offen sc1 lds
  v_exp_f32 v79, v79
  v_cvt_pk_bf16_f32 v102, v76, v77
  v_cvt_pk_bf16_f32 v103, v78, v79
  s_waitcnt lgkmcnt(4)
  v_mfma_f32_32x32x16_bf16 v[112:127], v[56:59], v[96:99], v[112:127]
  v_exp_f32 v80, v80
  v_exp_f32 v81, v81
  v_exp_f32 v82, v82
  v_exp_f32 v83, v83
  v_mfma_f32_32x32x16_bf16 v[112:127], v[60:63], v[100:103], v[112:127]
  v_cvt_pk_bf16_f32 v104, v80, v81
  v_exp_f32 v84, v84
  v_exp_f32 v85, v85
  v_cvt_pk_bf16_f32 v105, v82, v83
  v_exp_f32 v86, v86
  s_waitcnt lgkmcnt(2)
  v_mfma_f32_32x32x16_bf16 v[64:79], v[32:35], v[192:195], 0
  v_exp_f32 v87, v87
  v_cvt_pk_bf16_f32 v106, v84, v85
  v_exp_f32 v88, v88
  v_exp_f32 v89, v89
  v_cvt_pk_bf16_f32 v107, v86, v87
  v_mfma_f32_32x32x16_bf16 v[64:79], v[36:39], v[196:199], v[64:79]
  v_exp_f32 v90, v90
  v_exp_f32 v91, v91
  ds_read_b128 v[40:43], v3 offset:22528
  v_cvt_pk_bf16_f32 v108, v88, v89
  v_exp_f32 v92, v92
  v_exp_f32 v93, v93
  ds_read_b128 v[44:47], v3 offset:23552
  v_cvt_pk_bf16_f32 v109, v90, v91
  v_exp_f32 v94, v94
  v_exp_f32 v95, v95
  v_cvt_pk_bf16_f32 v110, v92, v93
  v_cvt_pk_bf16_f32 v111, v94, v95
  v_mfma_f32_32x32x16_bf16 v[128:143], v[56:59], v[104:107], v[128:143]
  v_exp_f32 v64, v64
  v_exp_f32 v65, v65
  v_exp_f32 v66, v66
  v_exp_f32 v67, v67
  v_mfma_f32_32x32x16_bf16 v[128:143], v[60:63], v[108:111], v[128:143]
  v_cvt_pk_bf16_f32 v96, v64, v65
  v_exp_f32 v68, v68
  v_exp_f32 v69, v69
  v_cvt_pk_bf16_f32 v97, v66, v67
  v_exp_f32 v70, v70
  v_mfma_f32_32x32x16_bf16 v[80:95], v[32:35], v[200:203], 0
  v_exp_f32 v71, v71
  v_cvt_pk_bf16_f32 v98, v68, v69
  v_exp_f32 v72, v72
  v_exp_f32 v73, v73
  v_cvt_pk_bf16_f32 v99, v70, v71
  v_mfma_f32_32x32x16_bf16 v[80:95], v[36:39], v[204:207], v[80:95]
  v_exp_f32 v74, v74
  v_exp_f32 v75, v75
  ds_read_b128 v[56:59], v3 offset:55296
  v_cvt_pk_bf16_f32 v100, v72, v73
  v_exp_f32 v76, v76
  v_exp_f32 v77, v77
  ds_read_b128 v[60:63], v3 offset:56320
  v_cvt_pk_bf16_f32 v101, v74, v75
  v_exp_f32 v78, v78
  s_add_u32 m0, s31, 100352
  s_add_u32 s29, s53, s28
  s_add_u32 s29, s29, 2048
  buffer_load_dwordx4 v2, s[8:11], s29 offen sc1 lds
  v_exp_f32 v79, v79
  v_cvt_pk_bf16_f32 v102, v76, v77
  v_cvt_pk_bf16_f32 v103, v78, v79
  s_waitcnt lgkmcnt(4)
  v_mfma_f32_32x32x16_bf16 v[112:127], v[48:51], v[96:99], v[112:127]
  v_exp_f32 v80, v80
  v_exp_f32 v81, v81
  v_exp_f32 v82, v82
  v_exp_f32 v83, v83
  v_mfma_f32_32x32x16_bf16 v[112:127], v[52:55], v[100:103], v[112:127]
  v_cvt_pk_bf16_f32 v104, v80, v81
  v_exp_f32 v84, v84
  v_exp_f32 v85, v85
  v_cvt_pk_bf16_f32 v105, v82, v83
  v_exp_f32 v86, v86
  s_waitcnt lgkmcnt(2)
  v_mfma_f32_32x32x16_bf16 v[64:79], v[40:43], v[192:195], 0
  v_exp_f32 v87, v87
  v_cvt_pk_bf16_f32 v106, v84, v85
  v_exp_f32 v88, v88
  v_exp_f32 v89, v89
  v_cvt_pk_bf16_f32 v107, v86, v87
  v_mfma_f32_32x32x16_bf16 v[64:79], v[44:47], v[196:199], v[64:79]
  v_exp_f32 v90, v90
  v_exp_f32 v91, v91
  ds_read_b128 v[32:35], v3 offset:24576
  v_cvt_pk_bf16_f32 v108, v88, v89
  v_exp_f32 v92, v92
  v_exp_f32 v93, v93
  ds_read_b128 v[36:39], v3 offset:25600
  v_cvt_pk_bf16_f32 v109, v90, v91
  v_exp_f32 v94, v94
  v_exp_f32 v95, v95
  v_cvt_pk_bf16_f32 v110, v92, v93
  v_cvt_pk_bf16_f32 v111, v94, v95
  v_mfma_f32_32x32x16_bf16 v[128:143], v[48:51], v[104:107], v[128:143]
  v_exp_f32 v64, v64
  v_exp_f32 v65, v65
  v_exp_f32 v66, v66
  v_exp_f32 v67, v67
  v_mfma_f32_32x32x16_bf16 v[128:143], v[52:55], v[108:111], v[128:143]
  v_cvt_pk_bf16_f32 v96, v64, v65
  v_exp_f32 v68, v68
  v_exp_f32 v69, v69
  v_cvt_pk_bf16_f32 v97, v66, v67
  v_exp_f32 v70, v70
  v_mfma_f32_32x32x16_bf16 v[80:95], v[40:43], v[200:203], 0
  v_exp_f32 v71, v71
  v_cvt_pk_bf16_f32 v98, v68, v69
  v_exp_f32 v72, v72
  v_exp_f32 v73, v73
  v_cvt_pk_bf16_f32 v99, v70, v71
  v_mfma_f32_32x32x16_bf16 v[80:95], v[44:47], v[204:207], v[80:95]
  v_exp_f32 v74, v74
  v_exp_f32 v75, v75
  ds_read_b128 v[48:51], v3 offset:57344
  v_cvt_pk_bf16_f32 v100, v72, v73
  v_exp_f32 v76, v76
  v_exp_f32 v77, v77
  ds_read_b128 v[52:55], v3 offset:58368
  v_cvt_pk_bf16_f32 v101, v74, v75
  v_exp_f32 v78, v78
  s_add_u32 m0, s31, 101376
  s_add_u32 s29, s53, s28
  s_add_u32 s29, s29, 3072
  buffer_load_dwordx4 v2, s[8:11], s29 offen sc1 lds
  v_exp_f32 v79, v79
  v_cvt_pk_bf16_f32 v102, v76, v77
  v_cvt_pk_bf16_f32 v103, v78, v79
  s_waitcnt lgkmcnt(4)
  v_mfma_f32_32x32x16_bf16 v[112:127], v[56:59], v[96:99], v[112:127]
  v_exp_f32 v80, v80
  v_exp_f32 v81, v81
  v_exp_f32 v82, v82
  v_exp_f32 v83, v83
  v_mfma_f32_32x32x16_bf16 v[112:127], v[60:63], v[100:103], v[112:127]
  v_cvt_pk_bf16_f32 v104, v80, v81
  v_exp_f32 v84, v84
  v_exp_f32 v85, v85
  v_cvt_pk_bf16_f32 v105, v82, v83
  v_exp_f32 v86, v86
  s_waitcnt lgkmcnt(2)
  v_mfma_f32_32x32x16_bf16 v[64:79], v[32:35], v[192:195], 0
  v_exp_f32 v87, v87
  v_cvt_pk_bf16_f32 v106, v84, v85
  v_exp_f32 v88, v88
  v_exp_f32 v89, v89
  v_cvt_pk_bf16_f32 v107, v86, v87
  v_mfma_f32_32x32x16_bf16 v[64:79], v[36:39], v[196:199], v[64:79]
  v_exp_f32 v90, v90
  v_exp_f32 v91, v91
  ds_read_b128 v[40:43], v3 offset:26624
  v_cvt_pk_bf16_f32 v108, v88, v89
  v_exp_f32 v92, v92
  v_exp_f32 v93, v93
  ds_read_b128 v[44:47], v3 offset:27648
  v_cvt_pk_bf16_f32 v109, v90, v91
  v_exp_f32 v94, v94
  v_exp_f32 v95, v95
  v_cvt_pk_bf16_f32 v110, v92, v93
  v_cvt_pk_bf16_f32 v111, v94, v95
  v_mfma_f32_32x32x16_bf16 v[128:143], v[56:59], v[104:107], v[128:143]
  v_exp_f32 v64, v64
  v_exp_f32 v65, v65
  v_exp_f32 v66, v66
  v_exp_f32 v67, v67
  v_mfma_f32_32x32x16_bf16 v[128:143], v[60:63], v[108:111], v[128:143]
  v_cvt_pk_bf16_f32 v96, v64, v65
  v_exp_f32 v68, v68
  v_exp_f32 v69, v69
  v_cvt_pk_bf16_f32 v97, v66, v67
  v_exp_f32 v70, v70
  v_mfma_f32_32x32x16_bf16 v[80:95], v[32:35], v[200:203], 0
  v_exp_f32 v71, v71
  v_cvt_pk_bf16_f32 v98, v68, v69
  v_exp_f32 v72, v72
  v_exp_f32 v73, v73
  v_cvt_pk_bf16_f32 v99, v70, v71
  v_mfma_f32_32x32x16_bf16 v[80:95], v[36:39], v[204:207], v[80:95]
  v_exp_f32 v74, v74
  v_exp_f32 v75, v75
  ds_read_b128 v[56:59], v3 offset:59392
  v_cvt_pk_bf16_f32 v100, v72, v73
  v_exp_f32 v76, v76
  v_exp_f32 v77, v77
  ds_read_b128 v[60:63], v3 offset:60416
  v_cvt_pk_bf16_f32 v101, v74, v75
  v_exp_f32 v78, v78
  s_add_u32 m0, s31, 102400
  s_add_u32 s29, s53, s28
  s_add_u32 s29, s29, 4096
  buffer_load_dwordx4 v2, s[8:11], s29 offen sc1 lds
  v_exp_f32 v79, v79
  v_cvt_pk_bf16_f32 v102, v76, v77
  v_cvt_pk_bf16_f32 v103, v78, v79
  s_waitcnt lgkmcnt(4)
  v_mfma_f32_32x32x16_bf16 v[112:127], v[48:51], v[96:99], v[112:127]
  v_exp_f32 v80, v80
  v_exp_f32 v81, v81
  v_exp_f32 v82, v82
  v_exp_f32 v83, v83
  v_mfma_f32_32x32x16_bf16 v[112:127], v[52:55], v[100:103], v[112:127]
  v_cvt_pk_bf16_f32 v104, v80, v81
  v_exp_f32 v84, v84
  v_exp_f32 v85, v85
  v_cvt_pk_bf16_f32 v105, v82, v83
  v_exp_f32 v86, v86
  s_waitcnt lgkmcnt(2)
  v_mfma_f32_32x32x16_bf16 v[64:79], v[40:43], v[192:195], 0
  v_exp_f32 v87, v87
  v_cvt_pk_bf16_f32 v106, v84, v85
  v_exp_f32 v88, v88
  v_exp_f32 v89, v89
  v_cvt_pk_bf16_f32 v107, v86, v87
  v_mfma_f32_32x32x16_bf16 v[64:79], v[44:47], v[196:199], v[64:79]
  v_exp_f32 v90, v90
  v_exp_f32 v91, v91
  ds_read_b128 v[32:35], v3 offset:28672
  v_cvt_pk_bf16_f32 v108, v88, v89
  v_exp_f32 v92, v92
  v_exp_f32 v93, v93
  ds_read_b128 v[36:39], v3 offset:29696
  v_cvt_pk_bf16_f32 v109, v90, v91
  v_exp_f32 v94, v94
  v_exp_f32 v95, v95
  v_cvt_pk_bf16_f32 v110, v92, v93
  v_cvt_pk_bf16_f32 v111, v94, v95
  v_mfma_f32_32x32x16_bf16 v[128:143], v[48:51], v[104:107], v[128:143]
  v_exp_f32 v64, v64
  v_exp_f32 v65, v65
  v_exp_f32 v66, v66
  v_exp_f32 v67, v67
  v_mfma_f32_32x32x16_bf16 v[128:143], v[52:55], v[108:111], v[128:143]
  v_cvt_pk_bf16_f32 v96, v64, v65
  v_exp_f32 v68, v68
  v_exp_f32 v69, v69
  v_cvt_pk_bf16_f32 v97, v66, v67
  v_exp_f32 v70, v70
  v_mfma_f32_32x32x16_bf16 v[80:95], v[40:43], v[200:203], 0
  v_exp_f32 v71, v71
  v_cvt_pk_bf16_f32 v98, v68, v69
  v_exp_f32 v72, v72
  v_exp_f32 v73, v73
  v_cvt_pk_bf16_f32 v99, v70, v71
  v_mfma_f32_32x32x16_bf16 v[80:95], v[44:47], v[204:207], v[80:95]
  v_exp_f32 v74, v74
  v_exp_f32 v75, v75
  ds_read_b128 v[48:51], v3 offset:61440
  v_cvt_pk_bf16_f32 v100, v72, v73
  v_exp_f32 v76, v76
  v_exp_f32 v77, v77
  ds_read_b128 v[52:55], v3 offset:62464
  v_cvt_pk_bf16_f32 v101, v74, v75
  v_exp_f32 v78, v78
  s_add_u32 m0, s31, 103424
  s_add_u32 s29, s53, s28
  s_add_u32 s29, s29, 5120
  buffer_load_dwordx4 v2, s[8:11], s29 offen sc1 lds
  v_exp_f32 v79, v79
  v_cvt_pk_bf16_f32 v102, v76, v77
  v_cvt_pk_bf16_f32 v103, v78, v79
  s_waitcnt lgkmcnt(4)
  v_mfma_f32_32x32x16_bf16 v[112:127], v[56:59], v[96:99], v[112:127]
  v_exp_f32 v80, v80
  v_exp_f32 v81, v81
  v_exp_f32 v82, v82
  v_exp_f32 v83, v83
  v_mfma_f32_32x32x16_bf16 v[112:127], v[60:63], v[100:103], v[112:127]
  v_cvt_pk_bf16_f32 v104, v80, v81
  v_exp_f32 v84, v84
  v_exp_f32 v85, v85
  v_cvt_pk_bf16_f32 v105, v82, v83
  v_exp_f32 v86, v86
  s_waitcnt lgkmcnt(2)
  v_mfma_f32_32x32x16_bf16 v[64:79], v[32:35], v[192:195], 0
  v_exp_f32 v87, v87
  v_cvt_pk_bf16_f32 v106, v84, v85
  v_exp_f32 v88, v88
  v_exp_f32 v89, v89
  v_cvt_pk_bf16_f32 v107, v86, v87
  v_mfma_f32_32x32x16_bf16 v[64:79], v[36:39], v[196:199], v[64:79]
  v_exp_f32 v90, v90
  v_exp_f32 v91, v91
  ds_read_b128 v[40:43], v3 offset:30720
  v_cvt_pk_bf16_f32 v108, v88, v89
  v_exp_f32 v92, v92
  v_exp_f32 v93, v93
  ds_read_b128 v[44:47], v3 offset:31744
  v_cvt_pk_bf16_f32 v109, v90, v91
  v_exp_f32 v94, v94
  v_exp_f32 v95, v95
  v_cvt_pk_bf16_f32 v110, v92, v93
  v_cvt_pk_bf16_f32 v111, v94, v95
  v_mfma_f32_32x32x16_bf16 v[128:143], v[56:59], v[104:107], v[128:143]
  v_exp_f32 v64, v64
  v_exp_f32 v65, v65
  v_exp_f32 v66, v66
  v_exp_f32 v67, v67
  v_mfma_f32_32x32x16_bf16 v[128:143], v[60:63], v[108:111], v[128:143]
  v_cvt_pk_bf16_f32 v96, v64, v65
  v_exp_f32 v68, v68
  v_exp_f32 v69, v69
  v_cvt_pk_bf16_f32 v97, v66, v67
  v_exp_f32 v70, v70
  v_mfma_f32_32x32x16_bf16 v[80:95], v[32:35], v[200:203], 0
  v_exp_f32 v71, v71
  v_cvt_pk_bf16_f32 v98, v68, v69
  v_exp_f32 v72, v72
  v_exp_f32 v73, v73
  v_cvt_pk_bf16_f32 v99, v70, v71
  v_mfma_f32_32x32x16_bf16 v[80:95], v[36:39], v[204:207], v[80:95]
  v_exp_f32 v74, v74
  v_exp_f32 v75, v75
  ds_read_b128 v[56:59], v3 offset:63488
  v_cvt_pk_bf16_f32 v100, v72, v73
  v_exp_f32 v76, v76
  v_exp_f32 v77, v77
  ds_read_b128 v[60:63], v3 offset:64512
  v_cvt_pk_bf16_f32 v101, v74, v75
  v_exp_f32 v78, v78
  s_add_u32 m0, s31, 104448
  s_add_u32 s29, s53, s28
  s_add_u32 s29, s29, 6144
  buffer_load_dwordx4 v2, s[8:11], s29 offen sc1 lds
  v_exp_f32 v79, v79
  v_cvt_pk_bf16_f32 v102, v76, v77
  v_cvt_pk_bf16_f32 v103, v78, v79
  s_waitcnt lgkmcnt(4)
  v_mfma_f32_32x32x16_bf16 v[112:127], v[48:51], v[96:99], v[112:127]
  v_exp_f32 v80, v80
  v_exp_f32 v81, v81
  v_exp_f32 v82, v82
  v_exp_f32 v83, v83
  v_mfma_f32_32x32x16_bf16 v[112:127], v[52:55], v[100:103], v[112:127]
  v_cvt_pk_bf16_f32 v104, v80, v81
  v_exp_f32 v84, v84
  v_exp_f32 v85, v85
  v_cvt_pk_bf16_f32 v105, v82, v83
  v_exp_f32 v86, v86
  s_waitcnt lgkmcnt(2)
  v_mfma_f32_32x32x16_bf16 v[64:79], v[40:43], v[192:195], 0
  v_exp_f32 v87, v87
  v_cvt_pk_bf16_f32 v106, v84, v85
  v_exp_f32 v88, v88
  v_exp_f32 v89, v89
  v_cvt_pk_bf16_f32 v107, v86, v87
  v_mfma_f32_32x32x16_bf16 v[64:79], v[44:47], v[196:199], v[64:79]
  v_exp_f32 v90, v90
  v_exp_f32 v91, v91
  v_cvt_pk_bf16_f32 v108, v88, v89
  v_exp_f32 v92, v92
  v_exp_f32 v93, v93
  v_cvt_pk_bf16_f32 v109, v90, v91
  v_exp_f32 v94, v94
  v_exp_f32 v95, v95
  v_cvt_pk_bf16_f32 v110, v92, v93
  v_cvt_pk_bf16_f32 v111, v94, v95
  v_mfma_f32_32x32x16_bf16 v[128:143], v[48:51], v[104:107], v[128:143]
  v_exp_f32 v64, v64
  v_exp_f32 v65, v65
  v_exp_f32 v66, v66
  v_exp_f32 v67, v67
  v_mfma_f32_32x32x16_bf16 v[128:143], v[52:55], v[108:111], v[128:143]
  v_cvt_pk_bf16_f32 v96, v64, v65
  v_exp_f32 v68, v68
  v_exp_f32 v69, v69
  v_cvt_pk_bf16_f32 v97, v66, v67
  v_exp_f32 v70, v70
  v_mfma_f32_32x32x16_bf16 v[80:95], v[40:43], v[200:203], 0
  v_exp_f32 v71, v71
  v_cvt_pk_bf16_f32 v98, v68, v69
  v_exp_f32 v72, v72
  v_exp_f32 v73, v73
  v_cvt_pk_bf16_f32 v99, v70, v71
  v_mfma_f32_32x32x16_bf16 v[80:95], v[44:47], v[204:207], v[80:95]
  v_exp_f32 v74, v74
  v_exp_f32 v75, v75
  v_cvt_pk_bf16_f32 v100, v72, v73
  v_exp_f32 v76, v76
  v_exp_f32 v77, v77
  v_cvt_pk_bf16_f32 v101, v74, v75
  v_exp_f32 v78, v78
  s_add_u32 m0, s31, 105472
  s_add_u32 s29, s53, s28
  s_add_u32 s29, s29, 7168
  buffer_load_dwordx4 v2, s[8:11], s29 offen sc1 lds
  v_exp_f32 v79, v79
  v_cvt_pk_bf16_f32 v102, v76, v77
  v_cvt_pk_bf16_f32 v103, v78, v79
  s_waitcnt lgkmcnt(0)
  v_mfma_f32_32x32x16_bf16 v[112:127], v[56:59], v[96:99], v[112:127]
  v_exp_f32 v80, v80
  v_exp_f32 v81, v81
  v_exp_f32 v82, v82
  v_exp_f32 v83, v83
  v_mfma_f32_32x32x16_bf16 v[112:127], v[60:63], v[100:103], v[112:127]
  v_cvt_pk_bf16_f32 v104, v80, v81
  v_exp_f32 v84, v84
  v_exp_f32 v85, v85
  v_cvt_pk_bf16_f32 v105, v82, v83
  v_exp_f32 v86, v86
  v_exp_f32 v87, v87
  v_cvt_pk_bf16_f32 v106, v84, v85
  v_exp_f32 v88, v88
  v_exp_f32 v89, v89
  v_cvt_pk_bf16_f32 v107, v86, v87
  v_exp_f32 v90, v90
  v_exp_f32 v91, v91
  v_cvt_pk_bf16_f32 v108, v88, v89
  v_exp_f32 v92, v92
  v_exp_f32 v93, v93
  v_cvt_pk_bf16_f32 v109, v90, v91
  v_exp_f32 v94, v94
  v_exp_f32 v95, v95
  v_cvt_pk_bf16_f32 v110, v92, v93
  v_cvt_pk_bf16_f32 v111, v94, v95
  s_nop 1
  v_mfma_f32_32x32x16_bf16 v[128:143], v[56:59], v[104:107], v[128:143]
  v_mfma_f32_32x32x16_bf16 v[128:143], v[60:63], v[108:111], v[128:143]
  s_waitcnt vmcnt(0)
  s_barrier
  s_add_u32 s41, s41, 1
  s_min_u32 s29, s41, 3
  s_mul_i32 s53, s29, 32768
  s_lshl_b32 s31, s21, 13
  s_add_u32 s53, s53, s31
  ds_read_b128 v[32:35], v4 offset:0
  ds_read_b128 v[36:39], v4 offset:1024
  ds_read_b128 v[48:51], v4 offset:32768
  ds_read_b128 v[52:55], v4 offset:33792
  ds_read_b128 v[40:43], v4 offset:2048
  ds_read_b128 v[44:47], v4 offset:3072
  s_waitcnt lgkmcnt(4)
  v_mfma_f32_32x32x16_bf16 v[64:79], v[32:35], v[192:195], 0
  v_mfma_f32_32x32x16_bf16 v[64:79], v[36:39], v[196:199], v[64:79]
  s_nop 11
  v_exp_f32 v64, v64
  v_exp_f32 v65, v65
  v_exp_f32 v66, v66
  v_exp_f32 v67, v67
  v_cvt_pk_bf16_f32 v96, v64, v65
  v_exp_f32 v68, v68
  v_exp_f32 v69, v69
  v_cvt_pk_bf16_f32 v97, v66, v67
  v_exp_f32 v70, v70
  v_mfma_f32_32x32x16_bf16 v[80:95], v[32:35], v[200:203], 0
  v_exp_f32 v71, v71
  v_cvt_pk_bf16_f32 v98, v68, v69
  v_exp_f32 v72, v72
  v_exp_f32 v73, v73
  v_cvt_pk_bf16_f32 v99, v70, v71
  v_mfma_f32_32x32x16_bf16 v[80:95], v[36:39], v[204:207], v[80:95]
  v_exp_f32 v74, v74
  v_exp_f32 v75, v75
  ds_read_b128 v[56:59], v4 offset:34816
  v_cvt_pk_bf16_f32 v100, v72, v73
  v_exp_f32 v76, v76
  v_exp_f32 v77, v77
  ds_read_b128 v[60:63], v4 offset:35840
  v_cvt_pk_bf16_f32 v101, v74, v75
  v_exp_f32 v78, v78
  s_add_u32 m0, s31, 0
  s_add_u32 s29, s53, s27
  s_add_u32 s29, s29, 0
  buffer_load_dwordx4 v2, s[8:11], s29 offen sc1 lds
  v_exp_f32 v79, v79
  v_cvt_pk_bf16_f32 v102, v76, v77
  v_cvt_pk_bf16_f32 v103, v78, v79
  s_waitcnt lgkmcnt(4)
  v_mfma_f32_32x32x16_bf16 v[112:127], v[48:51], v[96:99], v[112:127]
  v_exp_f32 v80, v80
  v_exp_f32 v81, v81
  v_exp_f32 v82, v82
  v_exp_f32 v83, v83
  v_mfma_f32_32x32x16_bf16 v[112:127], v[52:55], v[100:103], v[112:127]
  v_cvt_pk_bf16_f32 v104, v80, v81
  v_exp_f32 v84, v84
  v_exp_f32 v85, v85
  v_cvt_pk_bf16_f32 v105, v82, v83
  v_exp_f32 v86, v86
  s_waitcnt lgkmcnt(2)
  v_mfma_f32_32x32x16_bf16 v[64:79], v[40:43], v[192:195], 0
  v_exp_f32 v87, v87
  v_cvt_pk_bf16_f32 v106, v84, v85
  v_exp_f32 v88, v88
  v_exp_f32 v89, v89
  v_cvt_pk_bf16_f32 v107, v86, v87
  v_mfma_f32_32x32x16_bf16 v[64:79], v[44:47], v[196:199], v[64:79]
  v_exp_f32 v90, v90
  v_exp_f32 v91, v91
  ds_read_b128 v[32:35], v4 offset:4096
  v_cvt_pk_bf16_f32 v108, v88, v89
  v_exp_f32 v92, v92
  v_exp_f32 v93, v93
  ds_read_b128 v[36:39], v4 offset:5120
  v_cvt_pk_bf16_f32 v109, v90, v91
  v_exp_f32 v94, v94
  v_exp_f32 v95, v95
  v_cvt_pk_bf16_f32 v110, v92, v93
  v_cvt_pk_bf16_f32 v111, v94, v95
  v_mfma_f32_32x32x16_bf16 v[128:143], v[48:51], v[104:107], v[128:143]
  v_exp_f32 v64, v64
  v_exp_f32 v65, v65
  v_exp_f32 v66, v66
  v_exp_f32 v67, v67
  v_mfma_f32_32x32x16_bf16 v[128:143], v[52:55], v[108:111], v[128:143]
  v_cvt_pk_bf16_f32 v96, v64, v65
  v_exp_f32 v68, v68
  v_exp_f32 v69, v69
  v_cvt_pk_bf16_f32 v97, v66, v67
  v_exp_f32 v70, v70
  v_mfma_f32_32x32x16_bf16 v[80:95], v[40:43], v[200:203], 0
  v_exp_f32 v71, v71
  v_cvt_pk_bf16_f32 v98, v68, v69
  v_exp_f32 v72, v72
  v_exp_f32 v73, v73
  v_cvt_pk_bf16_f32 v99, v70, v71
  v_mfma_f32_32x32x16_bf16 v[80:95], v[44:47], v[204:207], v[80:95]
  v_exp_f32 v74, v74
  v_exp_f32 v75, v75
  ds_read_b128 v[48:51], v4 offset:36864
  v_cvt_pk_bf16_f32 v100, v72, v73
  v_exp_f32 v76, v76
  v_exp_f32 v77, v77
  ds_read_b128 v[52:55], v4 offset:37888
  v_cvt_pk_bf16_f32 v101, v74, v75
  v_exp_f32 v78, v78
  s_add_u32 m0, s31, 1024
  s_add_u32 s29, s53, s27
  s_add_u32 s29, s29, 1024
  buffer_load_dwordx4 v2, s[8:11], s29 offen sc1 lds
  v_exp_f32 v79, v79
  v_cvt_pk_bf16_f32 v102, v76, v77
  v_cvt_pk_bf16_f32 v103, v78, v79
  s_waitcnt lgkmcnt(4)
  v_mfma_f32_32x32x16_bf16 v[112:127], v[56:59], v[96:99], v[112:127]
  v_exp_f32 v80, v80
  v_exp_f32 v81, v81
  v_exp_f32 v82, v82
  v_exp_f32 v83, v83
  v_mfma_f32_32x32x16_bf16 v[112:127], v[60:63], v[100:103], v[112:127]
  v_cvt_pk_bf16_f32 v104, v80, v81
  v_exp_f32 v84, v84
  v_exp_f32 v85, v85
  v_cvt_pk_bf16_f32 v105, v82, v83
  v_exp_f32 v86, v86
  s_waitcnt lgkmcnt(2)
  v_mfma_f32_32x32x16_bf16 v[64:79], v[32:35], v[192:195], 0
  v_exp_f32 v87, v87
  v_cvt_pk_bf16_f32 v106, v84, v85
  v_exp_f32 v88, v88
  v_exp_f32 v89, v89
  v_cvt_pk_bf16_f32 v107, v86, v87
  v_mfma_f32_32x32x16_bf16 v[64:79], v[36:39], v[196:199], v[64:79]
  v_exp_f32 v90, v90
  v_exp_f32 v91, v91
  ds_read_b128 v[40:43], v4 offset:6144
  v_cvt_pk_bf16_f32 v108, v88, v89
  v_exp_f32 v92, v92
  v_exp_f32 v93, v93
  ds_read_b128 v[44:47], v4 offset:7168
  v_cvt_pk_bf16_f32 v109, v90, v91
  v_exp_f32 v94, v94
  v_exp_f32 v95, v95
  v_cvt_pk_bf16_f32 v110, v92, v93
  v_cvt_pk_bf16_f32 v111, v94, v95
  v_mfma_f32_32x32x16_bf16 v[128:143], v[56:59], v[104:107], v[128:143]
  v_exp_f32 v64, v64
  v_exp_f32 v65, v65
  v_exp_f32 v66, v66
  v_exp_f32 v67, v67
  v_mfma_f32_32x32x16_bf16 v[128:143], v[60:63], v[108:111], v[128:143]
  v_cvt_pk_bf16_f32 v96, v64, v65
  v_exp_f32 v68, v68
  v_exp_f32 v69, v69
  v_cvt_pk_bf16_f32 v97, v66, v67
  v_exp_f32 v70, v70
  v_mfma_f32_32x32x16_bf16 v[80:95], v[32:35], v[200:203], 0
  v_exp_f32 v71, v71
  v_cvt_pk_bf16_f32 v98, v68, v69
  v_exp_f32 v72, v72
  v_exp_f32 v73, v73
  v_cvt_pk_bf16_f32 v99, v70, v71
  v_mfma_f32_32x32x16_bf16 v[80:95], v[36:39], v[204:207], v[80:95]
  v_exp_f32 v74, v74
  v_exp_f32 v75, v75
  ds_read_b128 v[56:59], v4 offset:38912
  v_cvt_pk_bf16_f32 v100, v72, v73
  v_exp_f32 v76, v76
  v_exp_f32 v77, v77
  ds_read_b128 v[60:63], v4 offset:39936
  v_cvt_pk_bf16_f32 v101, v74, v75
  v_exp_f32 v78, v78
  s_add_u32 m0, s31, 2048
  s_add_u32 s29, s53, s27
  s_add_u32 s29, s29, 2048
  buffer_load_dwordx4 v2, s[8:11], s29 offen sc1 lds
  v_exp_f32 v79, v79
  v_cvt_pk_bf16_f32 v102, v76, v77
  v_cvt_pk_bf16_f32 v103, v78, v79
  s_waitcnt lgkmcnt(4)
  v_mfma_f32_32x32x16_bf16 v[112:127], v[48:51], v[96:99], v[112:127]
  v_exp_f32 v80, v80
  v_exp_f32 v81, v81
  v_exp_f32 v82, v82
  v_exp_f32 v83, v83
  v_mfma_f32_32x32x16_bf16 v[112:127], v[52:55], v[100:103], v[112:127]
  v_cvt_pk_bf16_f32 v104, v80, v81
  v_exp_f32 v84, v84
  v_exp_f32 v85, v85
  v_cvt_pk_bf16_f32 v105, v82, v83
  v_exp_f32 v86, v86
  s_waitcnt lgkmcnt(2)
  v_mfma_f32_32x32x16_bf16 v[64:79], v[40:43], v[192:195], 0
  v_exp_f32 v87, v87
  v_cvt_pk_bf16_f32 v106, v84, v85
  v_exp_f32 v88, v88
  v_exp_f32 v89, v89
  v_cvt_pk_bf16_f32 v107, v86, v87
  v_mfma_f32_32x32x16_bf16 v[64:79], v[44:47], v[196:199], v[64:79]
  v_exp_f32 v90, v90
  v_exp_f32 v91, v91
  ds_read_b128 v[32:35], v4 offset:8192
  v_cvt_pk_bf16_f32 v108, v88, v89
  v_exp_f32 v92, v92
  v_exp_f32 v93, v93
  ds_read_b128 v[36:39], v4 offset:9216
  v_cvt_pk_bf16_f32 v109, v90, v91
  v_exp_f32 v94, v94
  v_exp_f32 v95, v95
  v_cvt_pk_bf16_f32 v110, v92, v93
  v_cvt_pk_bf16_f32 v111, v94, v95
  v_mfma_f32_32x32x16_bf16 v[128:143], v[48:51], v[104:107], v[128:143]
  v_exp_f32 v64, v64
  v_exp_f32 v65, v65
  v_exp_f32 v66, v66
  v_exp_f32 v67, v67
  v_mfma_f32_32x32x16_bf16 v[128:143], v[52:55], v[108:111], v[128:143]
  v_cvt_pk_bf16_f32 v96, v64, v65
  v_exp_f32 v68, v68
  v_exp_f32 v69, v69
  v_cvt_pk_bf16_f32 v97, v66, v67
  v_exp_f32 v70, v70
  v_mfma_f32_32x32x16_bf16 v[80:95], v[40:43], v[200:203], 0
  v_exp_f32 v71, v71
  v_cvt_pk_bf16_f32 v98, v68, v69
  v_exp_f32 v72, v72
  v_exp_f32 v73, v73
  v_cvt_pk_bf16_f32 v99, v70, v71
  v_mfma_f32_32x32x16_bf16 v[80:95], v[44:47], v[204:207], v[80:95]
  v_exp_f32 v74, v74
  v_exp_f32 v75, v75
  ds_read_b128 v[48:51], v4 offset:40960
  v_cvt_pk_bf16_f32 v100, v72, v73
  v_exp_f32 v76, v76
  v_exp_f32 v77, v77
  ds_read_b128 v[52:55], v4 offset:41984
  v_cvt_pk_bf16_f32 v101, v74, v75
  v_exp_f32 v78, v78
  s_add_u32 m0, s31, 3072
  s_add_u32 s29, s53, s27
  s_add_u32 s29, s29, 3072
  buffer_load_dwordx4 v2, s[8:11], s29 offen sc1 lds
  v_exp_f32 v79, v79
  v_cvt_pk_bf16_f32 v102, v76, v77
  v_cvt_pk_bf16_f32 v103, v78, v79
  s_waitcnt lgkmcnt(4)
  v_mfma_f32_32x32x16_bf16 v[112:127], v[56:59], v[96:99], v[112:127]
  v_exp_f32 v80, v80
  v_exp_f32 v81, v81
  v_exp_f32 v82, v82
  v_exp_f32 v83, v83
  v_mfma_f32_32x32x16_bf16 v[112:127], v[60:63], v[100:103], v[112:127]
  v_cvt_pk_bf16_f32 v104, v80, v81
  v_exp_f32 v84, v84
  v_exp_f32 v85, v85
  v_cvt_pk_bf16_f32 v105, v82, v83
  v_exp_f32 v86, v86
  s_waitcnt lgkmcnt(2)
  v_mfma_f32_32x32x16_bf16 v[64:79], v[32:35], v[192:195], 0
  v_exp_f32 v87, v87
  v_cvt_pk_bf16_f32 v106, v84, v85
  v_exp_f32 v88, v88
  v_exp_f32 v89, v89
  v_cvt_pk_bf16_f32 v107, v86, v87
  v_mfma_f32_32x32x16_bf16 v[64:79], v[36:39], v[196:199], v[64:79]
  v_exp_f32 v90, v90
  v_exp_f32 v91, v91
  ds_read_b128 v[40:43], v4 offset:10240
  v_cvt_pk_bf16_f32 v108, v88, v89
  v_exp_f32 v92, v92
  v_exp_f32 v93, v93
  ds_read_b128 v[44:47], v4 offset:11264
  v_cvt_pk_bf16_f32 v109, v90, v91
  v_exp_f32 v94, v94
  v_exp_f32 v95, v95
  v_cvt_pk_bf16_f32 v110, v92, v93
  v_cvt_pk_bf16_f32 v111, v94, v95
  v_mfma_f32_32x32x16_bf16 v[128:143], v[56:59], v[104:107], v[128:143]
  v_exp_f32 v64, v64
  v_exp_f32 v65, v65
  v_exp_f32 v66, v66
  v_exp_f32 v67, v67
  v_mfma_f32_32x32x16_bf16 v[128:143], v[60:63], v[108:111], v[128:143]
  v_cvt_pk_bf16_f32 v96, v64, v65
  v_exp_f32 v68, v68
  v_exp_f32 v69, v69
  v_cvt_pk_bf16_f32 v97, v66, v67
  v_exp_f32 v70, v70
  v_mfma_f32_32x32x16_bf16 v[80:95], v[32:35], v[200:203], 0
  v_exp_f32 v71, v71
  v_cvt_pk_bf16_f32 v98, v68, v69
  v_exp_f32 v72, v72
  v_exp_f32 v73, v73
  v_cvt_pk_bf16_f32 v99, v70, v71
  v_mfma_f32_32x32x16_bf16 v[80:95], v[36:39], v[204:207], v[80:95]
  v_exp_f32 v74, v74
  v_exp_f32 v75, v75
  ds_read_b128 v[56:59], v4 offset:43008
  v_cvt_pk_bf16_f32 v100, v72, v73
  v_exp_f32 v76, v76
  v_exp_f32 v77, v77
  ds_read_b128 v[60:63], v4 offset:44032
  v_cvt_pk_bf16_f32 v101, v74, v75
  v_exp_f32 v78, v78
  s_add_u32 m0, s31, 4096
  s_add_u32 s29, s53, s27
  s_add_u32 s29, s29, 4096
  buffer_load_dwordx4 v2, s[8:11], s29 offen sc1 lds
  v_exp_f32 v79, v79
  v_cvt_pk_bf16_f32 v102, v76, v77
  v_cvt_pk_bf16_f32 v103, v78, v79
  s_waitcnt lgkmcnt(4)
  v_mfma_f32_32x32x16_bf16 v[112:127], v[48:51], v[96:99], v[112:127]
  v_exp_f32 v80, v80
  v_exp_f32 v81, v81
  v_exp_f32 v82, v82
  v_exp_f32 v83, v83
  v_mfma_f32_32x32x16_bf16 v[112:127], v[52:55], v[100:103], v[112:127]
  v_cvt_pk_bf16_f32 v104, v80, v81
  v_exp_f32 v84, v84
  v_exp_f32 v85, v85
  v_cvt_pk_bf16_f32 v105, v82, v83
  v_exp_f32 v86, v86
  s_waitcnt lgkmcnt(2)
  v_mfma_f32_32x32x16_bf16 v[64:79], v[40:43], v[192:195], 0
  v_exp_f32 v87, v87
  v_cvt_pk_bf16_f32 v106, v84, v85
  v_exp_f32 v88, v88
  v_exp_f32 v89, v89
  v_cvt_pk_bf16_f32 v107, v86, v87
  v_mfma_f32_32x32x16_bf16 v[64:79], v[44:47], v[196:199], v[64:79]
  v_exp_f32 v90, v90
  v_exp_f32 v91, v91
  ds_read_b128 v[32:35], v4 offset:12288
  v_cvt_pk_bf16_f32 v108, v88, v89
  v_exp_f32 v92, v92
  v_exp_f32 v93, v93
  ds_read_b128 v[36:39], v4 offset:13312
  v_cvt_pk_bf16_f32 v109, v90, v91
  v_exp_f32 v94, v94
  v_exp_f32 v95, v95
  v_cvt_pk_bf16_f32 v110, v92, v93
  v_cvt_pk_bf16_f32 v111, v94, v95
  v_mfma_f32_32x32x16_bf16 v[128:143], v[48:51], v[104:107], v[128:143]
  v_exp_f32 v64, v64
  v_exp_f32 v65, v65
  v_exp_f32 v66, v66
  v_exp_f32 v67, v67
  v_mfma_f32_32x32x16_bf16 v[128:143], v[52:55], v[108:111], v[128:143]
  v_cvt_pk_bf16_f32 v96, v64, v65
  v_exp_f32 v68, v68
  v_exp_f32 v69, v69
  v_cvt_pk_bf16_f32 v97, v66, v67
  v_exp_f32 v70, v70
  v_mfma_f32_32x32x16_bf16 v[80:95], v[40:43], v[200:203], 0
  v_exp_f32 v71, v71
  v_cvt_pk_bf16_f32 v98, v68, v69
  v_exp_f32 v72, v72
  v_exp_f32 v73, v73
  v_cvt_pk_bf16_f32 v99, v70, v71
  v_mfma_f32_32x32x16_bf16 v[80:95], v[44:47], v[204:207], v[80:95]
  v_exp_f32 v74, v74
  v_exp_f32 v75, v75
  ds_read_b128 v[48:51], v4 offset:45056
  v_cvt_pk_bf16_f32 v100, v72, v73
  v_exp_f32 v76, v76
  v_exp_f32 v77, v77
  ds_read_b128 v[52:55], v4 offset:46080
  v_cvt_pk_bf16_f32 v101, v74, v75
  v_exp_f32 v78, v78
  s_add_u32 m0, s31, 5120
  s_add_u32 s29, s53, s27
  s_add_u32 s29, s29, 5120
  buffer_load_dwordx4 v2, s[8:11], s29 offen sc1 lds
  v_exp_f32 v79, v79
  v_cvt_pk_bf16_f32 v102, v76, v77
  v_cvt_pk_bf16_f32 v103, v78, v79
  s_waitcnt lgkmcnt(4)
  v_mfma_f32_32x32x16_bf16 v[112:127], v[56:59], v[96:99], v[112:127]
  v_exp_f32 v80, v80
  v_exp_f32 v81, v81
  v_exp_f32 v82, v82
  v_exp_f32 v83, v83
  v_mfma_f32_32x32x16_bf16 v[112:127], v[60:63], v[100:103], v[112:127]
  v_cvt_pk_bf16_f32 v104, v80, v81
  v_exp_f32 v84, v84
  v_exp_f32 v85, v85
  v_cvt_pk_bf16_f32 v105, v82, v83
  v_exp_f32 v86, v86
  s_waitcnt lgkmcnt(2)
  v_mfma_f32_32x32x16_bf16 v[64:79], v[32:35], v[192:195], 0
  v_exp_f32 v87, v87
  v_cvt_pk_bf16_f32 v106, v84, v85
  v_exp_f32 v88, v88
  v_exp_f32 v89, v89
  v_cvt_pk_bf16_f32 v107, v86, v87
  v_mfma_f32_32x32x16_bf16 v[64:79], v[36:39], v[196:199], v[64:79]
  v_exp_f32 v90, v90
  v_exp_f32 v91, v91
  ds_read_b128 v[40:43], v4 offset:14336
  v_cvt_pk_bf16_f32 v108, v88, v89
  v_exp_f32 v92, v92
  v_exp_f32 v93, v93
  ds_read_b128 v[44:47], v4 offset:15360
  v_cvt_pk_bf16_f32 v109, v90, v91
  v_exp_f32 v94, v94
  v_exp_f32 v95, v95
  v_cvt_pk_bf16_f32 v110, v92, v93
  v_cvt_pk_bf16_f32 v111, v94, v95
  v_mfma_f32_32x32x16_bf16 v[128:143], v[56:59], v[104:107], v[128:143]
  v_exp_f32 v64, v64
  v_exp_f32 v65, v65
  v_exp_f32 v66, v66
  v_exp_f32 v67, v67
  v_mfma_f32_32x32x16_bf16 v[128:143], v[60:63], v[108:111], v[128:143]
  v_cvt_pk_bf16_f32 v96, v64, v65
  v_exp_f32 v68, v68
  v_exp_f32 v69, v69
  v_cvt_pk_bf16_f32 v97, v66, v67
  v_exp_f32 v70, v70
  v_mfma_f32_32x32x16_bf16 v[80:95], v[32:35], v[200:203], 0
  v_exp_f32 v71, v71
  v_cvt_pk_bf16_f32 v98, v68, v69
  v_exp_f32 v72, v72
  v_exp_f32 v73, v73
  v_cvt_pk_bf16_f32 v99, v70, v71
  v_mfma_f32_32x32x16_bf16 v[80:95], v[36:39], v[204:207], v[80:95]
  v_exp_f32 v74, v74
  v_exp_f32 v75, v75
  ds_read_b128 v[56:59], v4 offset:47104
  v_cvt_pk_bf16_f32 v100, v72, v73
  v_exp_f32 v76, v76
  v_exp_f32 v77, v77
  ds_read_b128 v[60:63], v4 offset:48128
  v_cvt_pk_bf16_f32 v101, v74, v75
  v_exp_f32 v78, v78
  s_add_u32 m0, s31, 6144
  s_add_u32 s29, s53, s27
  s_add_u32 s29, s29, 6144
  buffer_load_dwordx4 v2, s[8:11], s29 offen sc1 lds
  v_exp_f32 v79, v79
  v_cvt_pk_bf16_f32 v102, v76, v77
  v_cvt_pk_bf16_f32 v103, v78, v79
  s_waitcnt lgkmcnt(4)
  v_mfma_f32_32x32x16_bf16 v[112:127], v[48:51], v[96:99], v[112:127]
  v_exp_f32 v80, v80
  v_exp_f32 v81, v81
  v_exp_f32 v82, v82
  v_exp_f32 v83, v83
  v_mfma_f32_32x32x16_bf16 v[112:127], v[52:55], v[100:103], v[112:127]
  v_cvt_pk_bf16_f32 v104, v80, v81
  v_exp_f32 v84, v84
  v_exp_f32 v85, v85
  v_cvt_pk_bf16_f32 v105, v82, v83
  v_exp_f32 v86, v86
  s_waitcnt lgkmcnt(2)
  v_mfma_f32_32x32x16_bf16 v[64:79], v[40:43], v[192:195], 0
  v_exp_f32 v87, v87
  v_cvt_pk_bf16_f32 v106, v84, v85
  v_exp_f32 v88, v88
  v_exp_f32 v89, v89
  v_cvt_pk_bf16_f32 v107, v86, v87
  v_mfma_f32_32x32x16_bf16 v[64:79], v[44:47], v[196:199], v[64:79]
  v_exp_f32 v90, v90
  v_exp_f32 v91, v91
  ds_read_b128 v[32:35], v4 offset:16384
  v_cvt_pk_bf16_f32 v108, v88, v89
  v_exp_f32 v92, v92
  v_exp_f32 v93, v93
  ds_read_b128 v[36:39], v4 offset:17408
  v_cvt_pk_bf16_f32 v109, v90, v91
  v_exp_f32 v94, v94
  v_exp_f32 v95, v95
  v_cvt_pk_bf16_f32 v110, v92, v93
  v_cvt_pk_bf16_f32 v111, v94, v95
  v_mfma_f32_32x32x16_bf16 v[128:143], v[48:51], v[104:107], v[128:143]
  v_exp_f32 v64, v64
  v_exp_f32 v65, v65
  v_exp_f32 v66, v66
  v_exp_f32 v67, v67
  v_mfma_f32_32x32x16_bf16 v[128:143], v[52:55], v[108:111], v[128:143]
  v_cvt_pk_bf16_f32 v96, v64, v65
  v_exp_f32 v68, v68
  v_exp_f32 v69, v69
  v_cvt_pk_bf16_f32 v97, v66, v67
  v_exp_f32 v70, v70
  v_mfma_f32_32x32x16_bf16 v[80:95], v[40:43], v[200:203], 0
  v_exp_f32 v71, v71
  v_cvt_pk_bf16_f32 v98, v68, v69
  v_exp_f32 v72, v72
  v_exp_f32 v73, v73
  v_cvt_pk_bf16_f32 v99, v70, v71
  v_mfma_f32_32x32x16_bf16 v[80:95], v[44:47], v[204:207], v[80:95]
  v_exp_f32 v74, v74
  v_exp_f32 v75, v75
  ds_read_b128 v[48:51], v4 offset:49152
  v_cvt_pk_bf16_f32 v100, v72, v73
  v_exp_f32 v76, v76
  v_exp_f32 v77, v77
  ds_read_b128 v[52:55], v4 offset:50176
  v_cvt_pk_bf16_f32 v101, v74, v75
  v_exp_f32 v78, v78
  s_add_u32 m0, s31, 7168
  s_add_u32 s29, s53, s27
  s_add_u32 s29, s29, 7168
  buffer_load_dwordx4 v2, s[8:11], s29 offen sc1 lds
  v_exp_f32 v79, v79
  v_cvt_pk_bf16_f32 v102, v76, v77
  v_cvt_pk_bf16_f32 v103, v78, v79
  s_waitcnt lgkmcnt(4)
  v_mfma_f32_32x32x16_bf16 v[112:127], v[56:59], v[96:99], v[112:127]
  v_exp_f32 v80, v80
  v_exp_f32 v81, v81
  v_exp_f32 v82, v82
  v_exp_f32 v83, v83
  v_mfma_f32_32x32x16_bf16 v[112:127], v[60:63], v[100:103], v[112:127]
  v_cvt_pk_bf16_f32 v104, v80, v81
  v_exp_f32 v84, v84
  v_exp_f32 v85, v85
  v_cvt_pk_bf16_f32 v105, v82, v83
  v_exp_f32 v86, v86
  s_waitcnt lgkmcnt(2)
  v_mfma_f32_32x32x16_bf16 v[64:79], v[32:35], v[192:195], 0
  v_exp_f32 v87, v87
  v_cvt_pk_bf16_f32 v106, v84, v85
  v_exp_f32 v88, v88
  v_exp_f32 v89, v89
  v_cvt_pk_bf16_f32 v107, v86, v87
  v_mfma_f32_32x32x16_bf16 v[64:79], v[36:39], v[196:199], v[64:79]
  v_exp_f32 v90, v90
  v_exp_f32 v91, v91
  ds_read_b128 v[40:43], v4 offset:18432
  v_cvt_pk_bf16_f32 v108, v88, v89
  v_exp_f32 v92, v92
  v_exp_f32 v93, v93
  ds_read_b128 v[44:47], v4 offset:19456
  v_cvt_pk_bf16_f32 v109, v90, v91
  v_exp_f32 v94, v94
  v_exp_f32 v95, v95
  v_cvt_pk_bf16_f32 v110, v92, v93
  v_cvt_pk_bf16_f32 v111, v94, v95
  v_mfma_f32_32x32x16_bf16 v[128:143], v[56:59], v[104:107], v[128:143]
  v_exp_f32 v64, v64
  v_exp_f32 v65, v65
  v_exp_f32 v66, v66
  v_exp_f32 v67, v67
  v_mfma_f32_32x32x16_bf16 v[128:143], v[60:63], v[108:111], v[128:143]
  v_cvt_pk_bf16_f32 v96, v64, v65
  v_exp_f32 v68, v68
  v_exp_f32 v69, v69
  v_cvt_pk_bf16_f32 v97, v66, v67
  v_exp_f32 v70, v70
  v_mfma_f32_32x32x16_bf16 v[80:95], v[32:35], v[200:203], 0
  v_exp_f32 v71, v71
  v_cvt_pk_bf16_f32 v98, v68, v69
  v_exp_f32 v72, v72
  v_exp_f32 v73, v73
  v_cvt_pk_bf16_f32 v99, v70, v71
  v_mfma_f32_32x32x16_bf16 v[80:95], v[36:39], v[204:207], v[80:95]
  v_exp_f32 v74, v74
  v_exp_f32 v75, v75
  ds_read_b128 v[56:59], v4 offset:51200
  v_cvt_pk_bf16_f32 v100, v72, v73
  v_exp_f32 v76, v76
  v_exp_f32 v77, v77
  ds_read_b128 v[60:63], v4 offset:52224
  v_cvt_pk_bf16_f32 v101, v74, v75
  v_exp_f32 v78, v78
  s_add_u32 m0, s31, 32768
  s_add_u32 s29, s53, s28
  s_add_u32 s29, s29, 0
  buffer_load_dwordx4 v2, s[8:11], s29 offen sc1 lds
  v_exp_f32 v79, v79
  v_cvt_pk_bf16_f32 v102, v76, v77
  v_cvt_pk_bf16_f32 v103, v78, v79
  s_waitcnt lgkmcnt(4)
  v_mfma_f32_32x32x16_bf16 v[112:127], v[48:51], v[96:99], v[112:127]
  v_exp_f32 v80, v80
  v_exp_f32 v81, v81
  v_exp_f32 v82, v82
  v_exp_f32 v83, v83
  v_mfma_f32_32x32x16_bf16 v[112:127], v[52:55], v[100:103], v[112:127]
  v_cvt_pk_bf16_f32 v104, v80, v81
  v_exp_f32 v84, v84
  v_exp_f32 v85, v85
  v_cvt_pk_bf16_f32 v105, v82, v83
  v_exp_f32 v86, v86
  s_waitcnt lgkmcnt(2)
  v_mfma_f32_32x32x16_bf16 v[64:79], v[40:43], v[192:195], 0
  v_exp_f32 v87, v87
  v_cvt_pk_bf16_f32 v106, v84, v85
  v_exp_f32 v88, v88
  v_exp_f32 v89, v89
  v_cvt_pk_bf16_f32 v107, v86, v87
  v_mfma_f32_32x32x16_bf16 v[64:79], v[44:47], v[196:199], v[64:79]
  v_exp_f32 v90, v90
  v_exp_f32 v91, v91
  ds_read_b128 v[32:35], v4 offset:20480
  v_cvt_pk_bf16_f32 v108, v88, v89
  v_exp_f32 v92, v92
  v_exp_f32 v93, v93
  ds_read_b128 v[36:39], v4 offset:21504
  v_cvt_pk_bf16_f32 v109, v90, v91
  v_exp_f32 v94, v94
  v_exp_f32 v95, v95
  v_cvt_pk_bf16_f32 v110, v92, v93
  v_cvt_pk_bf16_f32 v111, v94, v95
  v_mfma_f32_32x32x16_bf16 v[128:143], v[48:51], v[104:107], v[128:143]
  v_exp_f32 v64, v64
  v_exp_f32 v65, v65
  v_exp_f32 v66, v66
  v_exp_f32 v67, v67
  v_mfma_f32_32x32x16_bf16 v[128:143], v[52:55], v[108:111], v[128:143]
  v_cvt_pk_bf16_f32 v96, v64, v65
  v_exp_f32 v68, v68
  v_exp_f32 v69, v69
  v_cvt_pk_bf16_f32 v97, v66, v67
  v_exp_f32 v70, v70
  v_mfma_f32_32x32x16_bf16 v[80:95], v[40:43], v[200:203], 0
  v_exp_f32 v71, v71
  v_cvt_pk_bf16_f32 v98, v68, v69
  v_exp_f32 v72, v72
  v_exp_f32 v73, v73
  v_cvt_pk_bf16_f32 v99, v70, v71
  v_mfma_f32_32x32x16_bf16 v[80:95], v[44:47], v[204:207], v[80:95]
  v_exp_f32 v74, v74
  v_exp_f32 v75, v75
  ds_read_b128 v[48:51], v4 offset:53248
  v_cvt_pk_bf16_f32 v100, v72, v73
  v_exp_f32 v76, v76
  v_exp_f32 v77, v77
  ds_read_b128 v[52:55], v4 offset:54272
  v_cvt_pk_bf16_f32 v101, v74, v75
  v_exp_f32 v78, v78
  s_add_u32 m0, s31, 33792
  s_add_u32 s29, s53, s28
  s_add_u32 s29, s29, 1024
  buffer_load_dwordx4 v2, s[8:11], s29 offen sc1 lds
  v_exp_f32 v79, v79
  v_cvt_pk_bf16_f32 v102, v76, v77
  v_cvt_pk_bf16_f32 v103, v78, v79
  s_waitcnt lgkmcnt(4)
  v_mfma_f32_32x32x16_bf16 v[112:127], v[56:59], v[96:99], v[112:127]
  v_exp_f32 v80, v80
  v_exp_f32 v81, v81
  v_exp_f32 v82, v82
  v_exp_f32 v83, v83
  v_mfma_f32_32x32x16_bf16 v[112:127], v[60:63], v[100:103], v[112:127]
  v_cvt_pk_bf16_f32 v104, v80, v81
  v_exp_f32 v84, v84
  v_exp_f32 v85, v85
  v_cvt_pk_bf16_f32 v105, v82, v83
  v_exp_f32 v86, v86
  s_waitcnt lgkmcnt(2)
  v_mfma_f32_32x32x16_bf16 v[64:79], v[32:35], v[192:195], 0
  v_exp_f32 v87, v87
  v_cvt_pk_bf16_f32 v106, v84, v85
  v_exp_f32 v88, v88
  v_exp_f32 v89, v89
  v_cvt_pk_bf16_f32 v107, v86, v87
  v_mfma_f32_32x32x16_bf16 v[64:79], v[36:39], v[196:199], v[64:79]
  v_exp_f32 v90, v90
  v_exp_f32 v91, v91
  ds_read_b128 v[40:43], v4 offset:22528
  v_cvt_pk_bf16_f32 v108, v88, v89
  v_exp_f32 v92, v92
  v_exp_f32 v93, v93
  ds_read_b128 v[44:47], v4 offset:23552
  v_cvt_pk_bf16_f32 v109, v90, v91
  v_exp_f32 v94, v94
  v_exp_f32 v95, v95
  v_cvt_pk_bf16_f32 v110, v92, v93
  v_cvt_pk_bf16_f32 v111, v94, v95
  v_mfma_f32_32x32x16_bf16 v[128:143], v[56:59], v[104:107], v[128:143]
  v_exp_f32 v64, v64
  v_exp_f32 v65, v65
  v_exp_f32 v66, v66
  v_exp_f32 v67, v67
  v_mfma_f32_32x32x16_bf16 v[128:143], v[60:63], v[108:111], v[128:143]
  v_cvt_pk_bf16_f32 v96, v64, v65
  v_exp_f32 v68, v68
  v_exp_f32 v69, v69
  v_cvt_pk_bf16_f32 v97, v66, v67
  v_exp_f32 v70, v70
  v_mfma_f32_32x32x16_bf16 v[80:95], v[32:35], v[200:203], 0
  v_exp_f32 v71, v71
  v_cvt_pk_bf16_f32 v98, v68, v69
  v_exp_f32 v72, v72
  v_exp_f32 v73, v73
  v_cvt_pk_bf16_f32 v99, v70, v71
  v_mfma_f32_32x32x16_bf16 v[80:95], v[36:39], v[204:207], v[80:95]
  v_exp_f32 v74, v74
  v_exp_f32 v75, v75
  ds_read_b128 v[56:59], v4 offset:55296
  v_cvt_pk_bf16_f32 v100, v72, v73
  v_exp_f32 v76, v76
  v_exp_f32 v77, v77
  ds_read_b128 v[60:63], v4 offset:56320
  v_cvt_pk_bf16_f32 v101, v74, v75
  v_exp_f32 v78, v78
  s_add_u32 m0, s31, 34816
  s_add_u32 s29, s53, s28
  s_add_u32 s29, s29, 2048
  buffer_load_dwordx4 v2, s[8:11], s29 offen sc1 lds
  v_exp_f32 v79, v79
  v_cvt_pk_bf16_f32 v102, v76, v77
  v_cvt_pk_bf16_f32 v103, v78, v79
  s_waitcnt lgkmcnt(4)
  v_mfma_f32_32x32x16_bf16 v[112:127], v[48:51], v[96:99], v[112:127]
  v_exp_f32 v80, v80
  v_exp_f32 v81, v81
  v_exp_f32 v82, v82
  v_exp_f32 v83, v83
  v_mfma_f32_32x32x16_bf16 v[112:127], v[52:55], v[100:103], v[112:127]
  v_cvt_pk_bf16_f32 v104, v80, v81
  v_exp_f32 v84, v84
  v_exp_f32 v85, v85
  v_cvt_pk_bf16_f32 v105, v82, v83
  v_exp_f32 v86, v86
  s_waitcnt lgkmcnt(2)
  v_mfma_f32_32x32x16_bf16 v[64:79], v[40:43], v[192:195], 0
  v_exp_f32 v87, v87
  v_cvt_pk_bf16_f32 v106, v84, v85
  v_exp_f32 v88, v88
  v_exp_f32 v89, v89
  v_cvt_pk_bf16_f32 v107, v86, v87
  v_mfma_f32_32x32x16_bf16 v[64:79], v[44:47], v[196:199], v[64:79]
  v_exp_f32 v90, v90
  v_exp_f32 v91, v91
  ds_read_b128 v[32:35], v4 offset:24576
  v_cvt_pk_bf16_f32 v108, v88, v89
  v_exp_f32 v92, v92
  v_exp_f32 v93, v93
  ds_read_b128 v[36:39], v4 offset:25600
  v_cvt_pk_bf16_f32 v109, v90, v91
  v_exp_f32 v94, v94
  v_exp_f32 v95, v95
  v_cvt_pk_bf16_f32 v110, v92, v93
  v_cvt_pk_bf16_f32 v111, v94, v95
  v_mfma_f32_32x32x16_bf16 v[128:143], v[48:51], v[104:107], v[128:143]
  v_exp_f32 v64, v64
  v_exp_f32 v65, v65
  v_exp_f32 v66, v66
  v_exp_f32 v67, v67
  v_mfma_f32_32x32x16_bf16 v[128:143], v[52:55], v[108:111], v[128:143]
  v_cvt_pk_bf16_f32 v96, v64, v65
  v_exp_f32 v68, v68
  v_exp_f32 v69, v69
  v_cvt_pk_bf16_f32 v97, v66, v67
  v_exp_f32 v70, v70
  v_mfma_f32_32x32x16_bf16 v[80:95], v[40:43], v[200:203], 0
  v_exp_f32 v71, v71
  v_cvt_pk_bf16_f32 v98, v68, v69
  v_exp_f32 v72, v72
  v_exp_f32 v73, v73
  v_cvt_pk_bf16_f32 v99, v70, v71
  v_mfma_f32_32x32x16_bf16 v[80:95], v[44:47], v[204:207], v[80:95]
  v_exp_f32 v74, v74
  v_exp_f32 v75, v75
  ds_read_b128 v[48:51], v4 offset:57344
  v_cvt_pk_bf16_f32 v100, v72, v73
  v_exp_f32 v76, v76
  v_exp_f32 v77, v77
  ds_read_b128 v[52:55], v4 offset:58368
  v_cvt_pk_bf16_f32 v101, v74, v75
  v_exp_f32 v78, v78
  s_add_u32 m0, s31, 35840
  s_add_u32 s29, s53, s28
  s_add_u32 s29, s29, 3072
  buffer_load_dwordx4 v2, s[8:11], s29 offen sc1 lds
  v_exp_f32 v79, v79
  v_cvt_pk_bf16_f32 v102, v76, v77
  v_cvt_pk_bf16_f32 v103, v78, v79
  s_waitcnt lgkmcnt(4)
  v_mfma_f32_32x32x16_bf16 v[112:127], v[56:59], v[96:99], v[112:127]
  v_exp_f32 v80, v80
  v_exp_f32 v81, v81
  v_exp_f32 v82, v82
  v_exp_f32 v83, v83
  v_mfma_f32_32x32x16_bf16 v[112:127], v[60:63], v[100:103], v[112:127]
  v_cvt_pk_bf16_f32 v104, v80, v81
  v_exp_f32 v84, v84
  v_exp_f32 v85, v85
  v_cvt_pk_bf16_f32 v105, v82, v83
  v_exp_f32 v86, v86
  s_waitcnt lgkmcnt(2)
  v_mfma_f32_32x32x16_bf16 v[64:79], v[32:35], v[192:195], 0
  v_exp_f32 v87, v87
  v_cvt_pk_bf16_f32 v106, v84, v85
  v_exp_f32 v88, v88
  v_exp_f32 v89, v89
  v_cvt_pk_bf16_f32 v107, v86, v87
  v_mfma_f32_32x32x16_bf16 v[64:79], v[36:39], v[196:199], v[64:79]
  v_exp_f32 v90, v90
  v_exp_f32 v91, v91
  ds_read_b128 v[40:43], v4 offset:26624
  v_cvt_pk_bf16_f32 v108, v88, v89
  v_exp_f32 v92, v92
  v_exp_f32 v93, v93
  ds_read_b128 v[44:47], v4 offset:27648
  v_cvt_pk_bf16_f32 v109, v90, v91
  v_exp_f32 v94, v94
  v_exp_f32 v95, v95
  v_cvt_pk_bf16_f32 v110, v92, v93
  v_cvt_pk_bf16_f32 v111, v94, v95
  v_mfma_f32_32x32x16_bf16 v[128:143], v[56:59], v[104:107], v[128:143]
  v_exp_f32 v64, v64
  v_exp_f32 v65, v65
  v_exp_f32 v66, v66
  v_exp_f32 v67, v67
  v_mfma_f32_32x32x16_bf16 v[128:143], v[60:63], v[108:111], v[128:143]
  v_cvt_pk_bf16_f32 v96, v64, v65
  v_exp_f32 v68, v68
  v_exp_f32 v69, v69
  v_cvt_pk_bf16_f32 v97, v66, v67
  v_exp_f32 v70, v70
  v_mfma_f32_32x32x16_bf16 v[80:95], v[32:35], v[200:203], 0
  v_exp_f32 v71, v71
  v_cvt_pk_bf16_f32 v98, v68, v69
  v_exp_f32 v72, v72
  v_exp_f32 v73, v73
  v_cvt_pk_bf16_f32 v99, v70, v71
  v_mfma_f32_32x32x16_bf16 v[80:95], v[36:39], v[204:207], v[80:95]
  v_exp_f32 v74, v74
  v_exp_f32 v75, v75
  ds_read_b128 v[56:59], v4 offset:59392
  v_cvt_pk_bf16_f32 v100, v72, v73
  v_exp_f32 v76, v76
  v_exp_f32 v77, v77
  ds_read_b128 v[60:63], v4 offset:60416
  v_cvt_pk_bf16_f32 v101, v74, v75
  v_exp_f32 v78, v78
  s_add_u32 m0, s31, 36864
  s_add_u32 s29, s53, s28
  s_add_u32 s29, s29, 4096
  buffer_load_dwordx4 v2, s[8:11], s29 offen sc1 lds
  v_exp_f32 v79, v79
  v_cvt_pk_bf16_f32 v102, v76, v77
  v_cvt_pk_bf16_f32 v103, v78, v79
  s_waitcnt lgkmcnt(4)
  v_mfma_f32_32x32x16_bf16 v[112:127], v[48:51], v[96:99], v[112:127]
  v_exp_f32 v80, v80
  v_exp_f32 v81, v81
  v_exp_f32 v82, v82
  v_exp_f32 v83, v83
  v_mfma_f32_32x32x16_bf16 v[112:127], v[52:55], v[100:103], v[112:127]
  v_cvt_pk_bf16_f32 v104, v80, v81
  v_exp_f32 v84, v84
  v_exp_f32 v85, v85
  v_cvt_pk_bf16_f32 v105, v82, v83
  v_exp_f32 v86, v86
  s_waitcnt lgkmcnt(2)
  v_mfma_f32_32x32x16_bf16 v[64:79], v[40:43], v[192:195], 0
  v_exp_f32 v87, v87
  v_cvt_pk_bf16_f32 v106, v84, v85
  v_exp_f32 v88, v88
  v_exp_f32 v89, v89
  v_cvt_pk_bf16_f32 v107, v86, v87
  v_mfma_f32_32x32x16_bf16 v[64:79], v[44:47], v[196:199], v[64:79]
  v_exp_f32 v90, v90
  v_exp_f32 v91, v91
  ds_read_b128 v[32:35], v4 offset:28672
  v_cvt_pk_bf16_f32 v108, v88, v89
  v_exp_f32 v92, v92
  v_exp_f32 v93, v93
  ds_read_b128 v[36:39], v4 offset:29696
  v_cvt_pk_bf16_f32 v109, v90, v91
  v_exp_f32 v94, v94
  v_exp_f32 v95, v95
  v_cvt_pk_bf16_f32 v110, v92, v93
  v_cvt_pk_bf16_f32 v111, v94, v95
  v_mfma_f32_32x32x16_bf16 v[128:143], v[48:51], v[104:107], v[128:143]
  v_exp_f32 v64, v64
  v_exp_f32 v65, v65
  v_exp_f32 v66, v66
  v_exp_f32 v67, v67
  v_mfma_f32_32x32x16_bf16 v[128:143], v[52:55], v[108:111], v[128:143]
  v_cvt_pk_bf16_f32 v96, v64, v65
  v_exp_f32 v68, v68
  v_exp_f32 v69, v69
  v_cvt_pk_bf16_f32 v97, v66, v67
  v_exp_f32 v70, v70
  v_mfma_f32_32x32x16_bf16 v[80:95], v[40:43], v[200:203], 0
  v_exp_f32 v71, v71
  v_cvt_pk_bf16_f32 v98, v68, v69
  v_exp_f32 v72, v72
  v_exp_f32 v73, v73
  v_cvt_pk_bf16_f32 v99, v70, v71
  v_mfma_f32_32x32x16_bf16 v[80:95], v[44:47], v[204:207], v[80:95]
  v_exp_f32 v74, v74
  v_exp_f32 v75, v75
  ds_read_b128 v[48:51], v4 offset:61440
  v_cvt_pk_bf16_f32 v100, v72, v73
  v_exp_f32 v76, v76
  v_exp_f32 v77, v77
  ds_read_b128 v[52:55], v4 offset:62464
  v_cvt_pk_bf16_f32 v101, v74, v75
  v_exp_f32 v78, v78
  s_add_u32 m0, s31, 37888
  s_add_u32 s29, s53, s28
  s_add_u32 s29, s29, 5120
  buffer_load_dwordx4 v2, s[8:11], s29 offen sc1 lds
  v_exp_f32 v79, v79
  v_cvt_pk_bf16_f32 v102, v76, v77
  v_cvt_pk_bf16_f32 v103, v78, v79
  s_waitcnt lgkmcnt(4)
  v_mfma_f32_32x32x16_bf16 v[112:127], v[56:59], v[96:99], v[112:127]
  v_exp_f32 v80, v80
  v_exp_f32 v81, v81
  v_exp_f32 v82, v82
  v_exp_f32 v83, v83
  v_mfma_f32_32x32x16_bf16 v[112:127], v[60:63], v[100:103], v[112:127]
  v_cvt_pk_bf16_f32 v104, v80, v81
  v_exp_f32 v84, v84
  v_exp_f32 v85, v85
  v_cvt_pk_bf16_f32 v105, v82, v83
  v_exp_f32 v86, v86
  s_waitcnt lgkmcnt(2)
  v_mfma_f32_32x32x16_bf16 v[64:79], v[32:35], v[192:195], 0
  v_exp_f32 v87, v87
  v_cvt_pk_bf16_f32 v106, v84, v85
  v_exp_f32 v88, v88
  v_exp_f32 v89, v89
  v_cvt_pk_bf16_f32 v107, v86, v87
  v_mfma_f32_32x32x16_bf16 v[64:79], v[36:39], v[196:199], v[64:79]
  v_exp_f32 v90, v90
  v_exp_f32 v91, v91
  ds_read_b128 v[40:43], v4 offset:30720
  v_cvt_pk_bf16_f32 v108, v88, v89
  v_exp_f32 v92, v92
  v_exp_f32 v93, v93
  ds_read_b128 v[44:47], v4 offset:31744
  v_cvt_pk_bf16_f32 v109, v90, v91
  v_exp_f32 v94, v94
  v_exp_f32 v95, v95
  v_cvt_pk_bf16_f32 v110, v92, v93
  v_cvt_pk_bf16_f32 v111, v94, v95
  v_mfma_f32_32x32x16_bf16 v[128:143], v[56:59], v[104:107], v[128:143]
  v_exp_f32 v64, v64
  v_exp_f32 v65, v65
  v_exp_f32 v66, v66
  v_exp_f32 v67, v67
  v_mfma_f32_32x32x16_bf16 v[128:143], v[60:63], v[108:111], v[128:143]
  v_cvt_pk_bf16_f32 v96, v64, v65
  v_exp_f32 v68, v68
  v_exp_f32 v69, v69
  v_cvt_pk_bf16_f32 v97, v66, v67
  v_exp_f32 v70, v70
  v_mfma_f32_32x32x16_bf16 v[80:95], v[32:35], v[200:203], 0
  v_exp_f32 v71, v71
  v_cvt_pk_bf16_f32 v98, v68, v69
  v_exp_f32 v72, v72
  v_exp_f32 v73, v73
  v_cvt_pk_bf16_f32 v99, v70, v71
  v_mfma_f32_32x32x16_bf16 v[80:95], v[36:39], v[204:207], v[80:95]
  v_exp_f32 v74, v74
  v_exp_f32 v75, v75
  ds_read_b128 v[56:59], v4 offset:63488
  v_cvt_pk_bf16_f32 v100, v72, v73
  v_exp_f32 v76, v76
  v_exp_f32 v77, v77
  ds_read_b128 v[60:63], v4 offset:64512
  v_cvt_pk_bf16_f32 v101, v74, v75
  v_exp_f32 v78, v78
  s_add_u32 m0, s31, 38912
  s_add_u32 s29, s53, s28
  s_add_u32 s29, s29, 6144
  buffer_load_dwordx4 v2, s[8:11], s29 offen sc1 lds
  v_exp_f32 v79, v79
  v_cvt_pk_bf16_f32 v102, v76, v77
  v_cvt_pk_bf16_f32 v103, v78, v79
  s_waitcnt lgkmcnt(4)
  v_mfma_f32_32x32x16_bf16 v[112:127], v[48:51], v[96:99], v[112:127]
  v_exp_f32 v80, v80
  v_exp_f32 v81, v81
  v_exp_f32 v82, v82
  v_exp_f32 v83, v83
  v_mfma_f32_32x32x16_bf16 v[112:127], v[52:55], v[100:103], v[112:127]
  v_cvt_pk_bf16_f32 v104, v80, v81
  v_exp_f32 v84, v84
  v_exp_f32 v85, v85
  v_cvt_pk_bf16_f32 v105, v82, v83
  v_exp_f32 v86, v86
  s_waitcnt lgkmcnt(2)
  v_mfma_f32_32x32x16_bf16 v[64:79], v[40:43], v[192:195], 0
  v_exp_f32 v87, v87
  v_cvt_pk_bf16_f32 v106, v84, v85
  v_exp_f32 v88, v88
  v_exp_f32 v89, v89
  v_cvt_pk_bf16_f32 v107, v86, v87
  v_mfma_f32_32x32x16_bf16 v[64:79], v[44:47], v[196:199], v[64:79]
  v_exp_f32 v90, v90
  v_exp_f32 v91, v91
  v_cvt_pk_bf16_f32 v108, v88, v89
  v_exp_f32 v92, v92
  v_exp_f32 v93, v93
  v_cvt_pk_bf16_f32 v109, v90, v91
  v_exp_f32 v94, v94
  v_exp_f32 v95, v95
  v_cvt_pk_bf16_f32 v110, v92, v93
  v_cvt_pk_bf16_f32 v111, v94, v95
  v_mfma_f32_32x32x16_bf16 v[128:143], v[48:51], v[104:107], v[128:143]
  v_exp_f32 v64, v64
  v_exp_f32 v65, v65
  v_exp_f32 v66, v66
  v_exp_f32 v67, v67
  v_mfma_f32_32x32x16_bf16 v[128:143], v[52:55], v[108:111], v[128:143]
  v_cvt_pk_bf16_f32 v96, v64, v65
  v_exp_f32 v68, v68
  v_exp_f32 v69, v69
  v_cvt_pk_bf16_f32 v97, v66, v67
  v_exp_f32 v70, v70
  v_mfma_f32_32x32x16_bf16 v[80:95], v[40:43], v[200:203], 0
  v_exp_f32 v71, v71
  v_cvt_pk_bf16_f32 v98, v68, v69
  v_exp_f32 v72, v72
  v_exp_f32 v73, v73
  v_cvt_pk_bf16_f32 v99, v70, v71
  v_mfma_f32_32x32x16_bf16 v[80:95], v[44:47], v[204:207], v[80:95]
  v_exp_f32 v74, v74
  v_exp_f32 v75, v75
  v_cvt_pk_bf16_f32 v100, v72, v73
  v_exp_f32 v76, v76
  v_exp_f32 v77, v77
  v_cvt_pk_bf16_f32 v101, v74, v75
  v_exp_f32 v78, v78
  s_add_u32 m0, s31, 39936
  s_add_u32 s29, s53, s28
  s_add_u32 s29, s29, 7168
  buffer_load_dwordx4 v2, s[8:11], s29 offen sc1 lds
  v_exp_f32 v79, v79
  v_cvt_pk_bf16_f32 v102, v76, v77
  v_cvt_pk_bf16_f32 v103, v78, v79
  s_waitcnt lgkmcnt(0)
  v_mfma_f32_32x32x16_bf16 v[112:127], v[56:59], v[96:99], v[112:127]
  v_exp_f32 v80, v80
  v_exp_f32 v81, v81
  v_exp_f32 v82, v82
  v_exp_f32 v83, v83
  v_mfma_f32_32x32x16_bf16 v[112:127], v[60:63], v[100:103], v[112:127]
  v_cvt_pk_bf16_f32 v104, v80, v81
  v_exp_f32 v84, v84
  v_exp_f32 v85, v85
  v_cvt_pk_bf16_f32 v105, v82, v83
  v_exp_f32 v86, v86
  v_exp_f32 v87, v87
  v_cvt_pk_bf16_f32 v106, v84, v85
  v_exp_f32 v88, v88
  v_exp_f32 v89, v89
  v_cvt_pk_bf16_f32 v107, v86, v87
  v_exp_f32 v90, v90
  v_exp_f32 v91, v91
  v_cvt_pk_bf16_f32 v108, v88, v89
  v_exp_f32 v92, v92
  v_exp_f32 v93, v93
  v_cvt_pk_bf16_f32 v109, v90, v91
  v_exp_f32 v94, v94
  v_exp_f32 v95, v95
  v_cvt_pk_bf16_f32 v110, v92, v93
  v_cvt_pk_bf16_f32 v111, v94, v95
  s_nop 1
  v_mfma_f32_32x32x16_bf16 v[128:143], v[56:59], v[104:107], v[128:143]
  v_mfma_f32_32x32x16_bf16 v[128:143], v[60:63], v[108:111], v[128:143]
  s_cmp_lt_u32 s41, 4
  s_cbranch_scc1 kb2_chunk2
  s_nop 11
  v_mov_b32 v5, v120
  v_mov_b32 v6, v120
  s_nop 1
  v_permlane32_swap_b32 v5, v6
  v_mov_b32 v14, v6
  v_mov_b32 v5, v136
  v_mov_b32 v6, v136
  s_nop 1
  v_permlane32_swap_b32 v5, v6
  v_mov_b32 v15, v6
  s_cmp_eq_u32 s40, 0
  s_cbranch_scc0 kb2_fin
  v_min_f32 v5, v14, v15
  v_cmp_gt_f32 vcc, 0x12800000, v5
  v_cmp_u_f32 s[36:37], v5, v5
  s_nop 1
  s_or_b64 vcc, vcc, s[36:37]
  s_cmp_lg_u64 vcc, 0
  s_cselect_b32 s42, 1, 0
  v_mov_b32 v5, s42
  s_lshl_b32 s30, s21, 2
  s_add_u32 s30, s30, 131584
  v_mov_b32 v6, s30
  ds_write_b32 v6, v5
  s_waitcnt vmcnt(0) lgkmcnt(0)
  s_barrier
  v_mov_b32 v6, 131584
  ds_read_b128 v[8:11], v6
  s_waitcnt lgkmcnt(0)
  v_or_b32 v8, v8, v9
  v_or_b32 v10, v10, v11
  v_or_b32 v8, v8, v10
  s_nop 0
  v_readfirstlane_b32 s42, v8
  s_cmp_eq_u32 s42, 0
  s_cbranch_scc1 kb2_fin
  s_mov_b32 s40, 1
  v_and_b32 v5, 0xffff0000, v198
  v_cndmask_b32 v198, v198, v5, s[34:35]
  v_mov_b32 v12, 0xff7fffff
  v_and_b32 v5, 0xffff0000, v206
  v_cndmask_b32 v206, v206, v5, s[34:35]
  v_mov_b32 v13, 0xff7fffff
  s_mov_b32 s41, 0
kb2_mx:
  s_lshl_b32 s30, s41, 11
  s_add_u32 s30, s30, s27
  buffer_load_dwordx4 v[32:35], v2, s[8:11], s30 offen sc1
  buffer_load_dwordx4 v[36:39], v2, s[8:11], s30 offen offset:1024 sc1
  s_waitcnt vmcnt(0)
  v_mfma_f32_32x32x16_bf16 v[64:79], v[32:35], v[192:195], 0
  v_mfma_f32_32x32x16_bf16 v[64:79], v[36:39], v[196:199], v[64:79]
  v_mfma_f32_32x32x16_bf16 v[80:95], v[32:35], v[200:203], 0
  v_mfma_f32_32x32x16_bf16 v[80:95], v[36:39], v[204:207], v[80:95]
  s_nop 11
  v_max3_f32 v12, v12, v64, v65
  v_max3_f32 v12, v12, v66, v67
  v_max3_f32 v12, v12, v68, v69
  v_max3_f32 v12, v12, v70, v71
  v_max3_f32 v12, v12, v72, v73
  v_max3_f32 v12, v12, v74, v75
  v_max3_f32 v12, v12, v76, v77
  v_max3_f32 v12, v12, v78, v79
  v_max3_f32 v13, v13, v80, v81
  v_max3_f32 v13, v13, v82, v83
  v_max3_f32 v13, v13, v84, v85
  v_max3_f32 v13, v13, v86, v87
  v_max3_f32 v13, v13, v88, v89
  v_max3_f32 v13, v13, v90, v91
  v_max3_f32 v13, v13, v92, v93
  v_max3_f32 v13, v13, v94, v95
  s_add_u32 s41, s41, 1
  s_cmp_lt_u32 s41, 64
  s_cbranch_scc1 kb2_mx
  v_mov_b32 v5, v12
  s_nop 1
  v_permlane32_swap_b32 v12, v5
  v_max_f32 v12, v12, v5
  v_cvt_pk_bf16_f32 v5, v12, v12
  v_and_b32 v5, 0xffff, v5
  v_xor_b32 v5, 0x8000, v5
  v_and_b32 v6, 0xffff0000, v198
  v_or_b32 v5, v5, v6
  v_cndmask_b32 v198, v198, v5, s[34:35]
  v_mov_b32 v5, v13
  s_nop 1
  v_permlane32_swap_b32 v13, v5
  v_max_f32 v13, v13, v5
  v_cvt_pk_bf16_f32 v5, v13, v13
  v_and_b32 v5, 0xffff, v5
  v_xor_b32 v5, 0x8000, v5
  v_and_b32 v6, 0xffff0000, v206
  v_or_b32 v5, v5, v6
  v_cndmask_b32 v206, v206, v5, s[34:35]
  s_barrier
  s_mov_b32 s41, 0
  s_mul_i32 s53, s41, 32768
  s_lshl_b32 s31, s21, 13
  s_add_u32 s53, s53, s31
  s_add_u32 m0, s31, 0
  s_add_u32 s29, s53, s27
  s_add_u32 s29, s29, 0
  buffer_load_dwordx4 v2, s[8:11], s29 offen sc1 lds
  s_add_u32 m0, s31, 1024
  s_add_u32 s29, s53, s27
  s_add_u32 s29, s29, 1024
  buffer_load_dwordx4 v2, s[8:11], s29 offen sc1 lds
  s_add_u32 m0, s31, 2048
  s_add_u32 s29, s53, s27
  s_add_u32 s29, s29, 2048
  buffer_load_dwordx4 v2, s[8:11], s29 offen sc1 lds
  s_add_u32 m0, s31, 3072
  s_add_u32 s29, s53, s27
  s_add_u32 s29, s29, 3072
  buffer_load_dwordx4 v2, s[8:11], s29 offen sc1 lds
  s_add_u32 m0, s31, 4096
  s_add_u32 s29, s53, s27
  s_add_u32 s29, s29, 4096
  buffer_load_dwordx4 v2, s[8:11], s29 offen sc1 lds
  s_add_u32 m0, s31, 5120
  s_add_u32 s29, s53, s27
  s_add_u32 s29, s29, 5120
  buffer_load_dwordx4 v2, s[8:11], s29 offen sc1 lds
  s_add_u32 m0, s31, 6144
  s_add_u32 s29, s53, s27
  s_add_u32 s29, s29, 6144
  buffer_load_dwordx4 v2, s[8:11], s29 offen sc1 lds
  s_add_u32 m0, s31, 7168
  s_add_u32 s29, s53, s27
  s_add_u32 s29, s29, 7168
  buffer_load_dwordx4 v2, s[8:11], s29 offen sc1 lds
  s_add_u32 m0, s31, 32768
  s_add_u32 s29, s53, s28
  s_add_u32 s29, s29, 0
  buffer_load_dwordx4 v2, s[8:11], s29 offen sc1 lds
  s_add_u32 m0, s31, 33792
  s_add_u32 s29, s53, s28
  s_add_u32 s29, s29, 1024
  buffer_load_dwordx4 v2, s[8:11], s29 offen sc1 lds
  s_add_u32 m0, s31, 34816
  s_add_u32 s29, s53, s28
  s_add_u32 s29, s29, 2048
  buffer_load_dwordx4 v2, s[8:11], s29 offen sc1 lds
  s_add_u32 m0, s31, 35840
  s_add_u32 s29, s53, s28
  s_add_u32 s29, s29, 3072
  buffer_load_dwordx4 v2, s[8:11], s29 offen sc1 lds
  s_add_u32 m0, s31, 36864
  s_add_u32 s29, s53, s28
  s_add_u32 s29, s29, 4096
  buffer_load_dwordx4 v2, s[8:11], s29 offen sc1 lds
  s_add_u32 m0, s31, 37888
  s_add_u32 s29, s53, s28
  s_add_u32 s29, s29, 5120
  buffer_load_dwordx4 v2, s[8:11], s29 offen sc1 lds
  s_add_u32 m0, s31, 38912
  s_add_u32 s29, s53, s28
  s_add_u32 s29, s29, 6144
  buffer_load_dwordx4 v2, s[8:11], s29 offen sc1 lds
  s_add_u32 m0, s31, 39936
  s_add_u32 s29, s53, s28
  s_add_u32 s29, s29, 7168
  buffer_load_dwordx4 v2, s[8:11], s29 offen sc1 lds
  s_branch kb2_main2
kb2_fin:
  v_and_b32 v3, 15, v1
  v_bfe_u32 v11, v1, 4, 1
  v_mul_u32_u24 v11, 20480, v11
  v_lshrrev_b32 v4, 5, v1
  s_mul_i32 s30, s22, 20
  v_lshlrev_b32 v5, 2, v4
  v_add_u32 v5, 0, v5
  v_add_u32 v5, s30, v5
  v_lshrrev_b32 v6, 5, v5
  v_lshlrev_b32 v6, 10, v6
  v_bfe_u32 v7, v5, 3, 2
  v_lshlrev_b32 v7, 4, v7
  v_add_u32 v7, v7, v3
  v_lshlrev_b32 v7, 4, v7
  v_add_u32 v6, v6, v7
  v_bfe_u32 v7, v5, 2, 1
  v_lshlrev_b32 v7, 3, v7
  v_add_u32 v6, v6, v7
  v_add_u32 v32, v6, v11
  v_lshlrev_b32 v5, 2, v4
  v_add_u32 v5, 8, v5
  v_add_u32 v5, s30, v5
  v_lshrrev_b32 v6, 5, v5
  v_lshlrev_b32 v6, 10, v6
  v_bfe_u32 v7, v5, 3, 2
  v_lshlrev_b32 v7, 4, v7
  v_add_u32 v7, v7, v3
  v_lshlrev_b32 v7, 4, v7
  v_add_u32 v6, v6, v7
  v_bfe_u32 v7, v5, 2, 1
  v_lshlrev_b32 v7, 3, v7
  v_add_u32 v6, v6, v7
  v_add_u32 v33, v6, v11
  v_lshlrev_b32 v5, 2, v4
  v_add_u32 v5, 16, v5
  v_add_u32 v5, s30, v5
  v_lshrrev_b32 v6, 5, v5
  v_lshlrev_b32 v6, 10, v6
  v_bfe_u32 v7, v5, 3, 2
  v_lshlrev_b32 v7, 4, v7
  v_add_u32 v7, v7, v3
  v_lshlrev_b32 v7, 4, v7
  v_add_u32 v6, v6, v7
  v_bfe_u32 v7, v5, 2, 1
  v_lshlrev_b32 v7, 3, v7
  v_add_u32 v6, v6, v7
  v_add_u32 v34, v6, v11
  v_mov_b32 v5, 0x40000000
  v_cndmask_b32 v34, v5, v34, s[34:35]
  v_rcp_f32 v5, v14
  s_nop 0
  v_mul_f32 v112, v112, v5
  v_mul_f32 v113, v113, v5
  v_mul_f32 v114, v114, v5
  v_mul_f32 v115, v115, v5
  v_mul_f32 v116, v116, v5
  v_mul_f32 v117, v117, v5
  v_mul_f32 v118, v118, v5
  v_mul_f32 v119, v119, v5
  v_mul_f32 v120, v120, v5
  v_mul_f32 v121, v121, v5
  v_mul_f32 v122, v122, v5
  v_mul_f32 v123, v123, v5
  v_cvt_pk_bf16_f32 v40, v112, v113
  v_cvt_pk_bf16_f32 v41, v114, v115
  v_cvt_pk_bf16_f32 v42, v116, v117
  v_cvt_pk_bf16_f32 v43, v118, v119
  v_cvt_pk_bf16_f32 v44, v120, v121
  v_cvt_pk_bf16_f32 v45, v122, v123
  s_add_u32 s31, s52, 0
  s_mul_i32 s31, s31, 40960
  s_add_u32 s31, s31, 0xf200000
  buffer_store_dwordx2 v[40:41], v32, s[8:11], s31 offen sc1
  buffer_store_dwordx2 v[42:43], v33, s[8:11], s31 offen sc1
  buffer_store_dwordx2 v[44:45], v34, s[8:11], s31 offen sc1
  v_rcp_f32 v5, v15
  s_nop 0
  v_mul_f32 v128, v128, v5
  v_mul_f32 v129, v129, v5
  v_mul_f32 v130, v130, v5
  v_mul_f32 v131, v131, v5
  v_mul_f32 v132, v132, v5
  v_mul_f32 v133, v133, v5
  v_mul_f32 v134, v134, v5
  v_mul_f32 v135, v135, v5
  v_mul_f32 v136, v136, v5
  v_mul_f32 v137, v137, v5
  v_mul_f32 v138, v138, v5
  v_mul_f32 v139, v139, v5
  v_cvt_pk_bf16_f32 v48, v128, v129
  v_cvt_pk_bf16_f32 v49, v130, v131
  v_cvt_pk_bf16_f32 v50, v132, v133
  v_cvt_pk_bf16_f32 v51, v134, v135
  v_cvt_pk_bf16_f32 v52, v136, v137
  v_cvt_pk_bf16_f32 v53, v138, v139
  s_add_u32 s31, s52, 1
  s_mul_i32 s31, s31, 40960
  s_add_u32 s31, s31, 0xf200000
  buffer_store_dwordx2 v[48:49], v32, s[8:11], s31 offen sc1
  buffer_store_dwordx2 v[50:51], v33, s[8:11], s31 offen sc1
  buffer_store_dwordx2 v[52:53], v34, s[8:11], s31 offen sc1
  s_waitcnt vmcnt(0)
  s_barrier
  s_cmp_eq_u32 s21, 0
  s_cbranch_scc0 arr_113
  s_mov_b64 s[24:25], exec
  s_mov_b64 exec, 1
  v_mov_b32 v3, 0
  v_mov_b32 v4, 1
  buffer_atomic_add v4, v3, s[8:11], s48 offen
  s_mov_b64 exec, s[24:25]
arr_113:
  v_and_b32 v5, 15, v1
  v_lshrrev_b32 v6, 4, v1
  v_and_b32 v7, 1, v6
  v_lshlrev_b32 v7, 10, v7
  v_lshrrev_b32 v8, 1, v6
  v_lshlrev_b32 v8, 5, v8
  v_add_u32 v8, v8, v5
  v_lshlrev_b32 v8, 4, v8
  v_add_u32 v9, v7, v8
  s_lshr_b32 s26, s2, 2
  s_mul_i32 s27, s26, 81920
  s_lshl_b32 s28, s50, 11
  s_add_u32 s27, s27, s28
  s_add_u32 s27, s27, 0x1400000
  s_add_u32 s28, s27, 0
  buffer_load_dwordx4 v[16:19], v9, s[8:11], s28 offen sc1
  s_add_u32 s28, s27, 256
  buffer_load_dwordx4 v[20:23], v9, s[8:11], s28 offen sc1
  s_add_u32 s28, s27, 2048
  buffer_load_dwordx4 v[24:27], v9, s[8:11], s28 offen sc1
  s_add_u32 s28, s27, 2304
  buffer_load_dwordx4 v[28:31], v9, s[8:11], s28 offen sc1
  s_cmp_lt_u32 s21, 2
  s_cbranch_scc0 g3_114
  s_add_u32 s28, s27, 4096
  buffer_load_dwordx4 v[32:35], v9, s[8:11], s28 offen sc1
  s_add_u32 s28, s27, 4352
  buffer_load_dwordx4 v[36:39], v9, s[8:11], s28 offen sc1
g3_114:
  s_mov_b32 s45, 0
  v_mov_b32 v3, 0
aw_115:
  buffer_load_dword v4, v3, s[8:11], s48 offen sc1
  s_add_u32 s45, s45, 1
  s_waitcnt vmcnt(0)
  v_readfirstlane_b32 s29, v4
  s_cmp_ge_u32 s29, 32
  s_cbranch_scc1 aw_115_ok
  s_cmp_lt_u32 s45, 400000
  s_cbranch_scc1 aw_115
  s_branch kb2_abort
aw_115_ok:
  s_mul_i32 s28, s26, 40960
  s_mul_i32 s31, s21, 10240
  s_add_u32 s28, s28, s31
  s_add_u32 s28, s28, 0xf200000
  s_add_u32 m0, s31, 0
  s_add_u32 s29, s28, 0
  buffer_load_dwordx4 v2, s[8:11], s29 offen sc1 lds
  s_add_u32 m0, s31, 1024
  s_add_u32 s29, s28, 1024
  buffer_load_dwordx4 v2, s[8:11], s29 offen sc1 lds
  s_add_u32 m0, s31, 2048
  s_add_u32 s29, s28, 2048
  buffer_load_dwordx4 v2, s[8:11], s29 offen sc1 lds
  s_add_u32 m0, s31, 3072
  s_add_u32 s29, s28, 3072
  buffer_load_dwordx4 v2, s[8:11], s29 offen sc1 lds
  s_add_u32 m0, s31, 4096
  s_add_u32 s29, s28, 4096
  buffer_load_dwordx4 v2, s[8:11], s29 offen sc1 lds
  s_add_u32 m0, s31, 5120
  s_add_u32 s29, s28, 5120
  buffer_load_dwordx4 v2, s[8:11], s29 offen sc1 lds
  s_add_u32 m0, s31, 6144
  s_add_u32 s29, s28, 6144
  buffer_load_dwordx4 v2, s[8:11], s29 offen sc1 lds
  s_add_u32 m0, s31, 7168
  s_add_u32 s29, s28, 7168
  buffer_load_dwordx4 v2, s[8:11], s29 offen sc1 lds
  s_add_u32 m0, s31, 8192
  s_add_u32 s29, s28, 8192
  buffer_load_dwordx4 v2, s[8:11], s29 offen sc1 lds
  s_add_u32 m0, s31, 9216
  s_add_u32 s29, s28, 9216
  buffer_load_dwordx4 v2, s[8:11], s29 offen sc1 lds
  s_waitcnt vmcnt(0)
  s_barrier
  ds_read_b128 v[80:83], v2 offset:0
  ds_read_b128 v[84:87], v2 offset:20480
  ds_read_b128 v[88:91], v2 offset:1024
  ds_read_b128 v[92:95], v2 offset:21504
  ds_read_b128 v[96:99], v2 offset:2048
  ds_read_b128 v[100:103], v2 offset:22528
  s_waitcnt lgkmcnt(4)
  v_mfma_f32_16x16x32_bf16 v[48:51], a[0:3], v[80:83], 0
  v_mfma_f32_16x16x32_bf16 v[52:55], a[0:3], v[84:87], 0
  v_mfma_f32_16x16x32_bf16 v[56:59], a[80:83], v[80:83], 0
  v_mfma_f32_16x16x32_bf16 v[60:63], a[80:83], v[84:87], 0
  v_mfma_f32_16x16x32_bf16 v[64:67], a[160:163], v[80:83], 0
  v_mfma_f32_16x16x32_bf16 v[68:71], a[160:163], v[84:87], 0
  ds_read_b128 v[80:83], v2 offset:3072
  ds_read_b128 v[84:87], v2 offset:23552
  s_waitcnt lgkmcnt(4)
  v_mfma_f32_16x16x32_bf16 v[48:51], a[4:7], v[88:91], v[48:51]
  v_mfma_f32_16x16x32_bf16 v[52:55], a[4:7], v[92:95], v[52:55]
  v_mfma_f32_16x16x32_bf16 v[56:59], a[84:87], v[88:91], v[56:59]
  v_mfma_f32_16x16x32_bf16 v[60:63], a[84:87], v[92:95], v[60:63]
  v_mfma_f32_16x16x32_bf16 v[64:67], a[164:167], v[88:91], v[64:67]
  v_mfma_f32_16x16x32_bf16 v[68:71], a[164:167], v[92:95], v[68:71]
  ds_read_b128 v[88:91], v2 offset:4096
  ds_read_b128 v[92:95], v2 offset:24576
  s_waitcnt lgkmcnt(4)
  v_mfma_f32_16x16x32_bf16 v[48:51], a[8:11], v[96:99], v[48:51]
  v_mfma_f32_16x16x32_bf16 v[52:55], a[8:11], v[100:103], v[52:55]
  v_mfma_f32_16x16x32_bf16 v[56:59], a[88:91], v[96:99], v[56:59]
  v_mfma_f32_16x16x32_bf16 v[60:63], a[88:91], v[100:103], v[60:63]
  v_mfma_f32_16x16x32_bf16 v[64:67], a[168:171], v[96:99], v[64:67]
  v_mfma_f32_16x16x32_bf16 v[68:71], a[168:171], v[100:103], v[68:71]
  ds_read_b128 v[96:99], v2 offset:5120
  ds_read_b128 v[100:103], v2 offset:25600
  s_waitcnt lgkmcnt(4)
  v_mfma_f32_16x16x32_bf16 v[48:51], a[12:15], v[80:83], v[48:51]
  v_mfma_f32_16x16x32_bf16 v[52:55], a[12:15], v[84:87], v[52:55]
  v_mfma_f32_16x16x32_bf16 v[56:59], a[92:95], v[80:83], v[56:59]
  v_mfma_f32_16x16x32_bf16 v[60:63], a[92:95], v[84:87], v[60:63]
  v_mfma_f32_16x16x32_bf16 v[64:67], a[172:175], v[80:83], v[64:67]
  v_mfma_f32_16x16x32_bf16 v[68:71], a[172:175], v[84:87], v[68:71]
  ds_read_b128 v[80:83], v2 offset:6144
  ds_read_b128 v[84:87], v2 offset:26624
  s_waitcnt lgkmcnt(4)
  v_mfma_f32_16x16x32_bf16 v[48:51], a[16:19], v[88:91], v[48:51]
  v_mfma_f32_16x16x32_bf16 v[52:55], a[16:19], v[92:95], v[52:55]
  v_mfma_f32_16x16x32_bf16 v[56:59], a[96:99], v[88:91], v[56:59]
  v_mfma_f32_16x16x32_bf16 v[60:63], a[96:99], v[92:95], v[60:63]
  v_mfma_f32_16x16x32_bf16 v[64:67], a[176:179], v[88:91], v[64:67]
  v_mfma_f32_16x16x32_bf16 v[68:71], a[176:179], v[92:95], v[68:71]
  ds_read_b128 v[88:91], v2 offset:7168
  ds_read_b128 v[92:95], v2 offset:27648
  s_waitcnt lgkmcnt(4)
  v_mfma_f32_16x16x32_bf16 v[48:51], a[20:23], v[96:99], v[48:51]
  v_mfma_f32_16x16x32_bf16 v[52:55], a[20:23], v[100:103], v[52:55]
  v_mfma_f32_16x16x32_bf16 v[56:59], a[100:103], v[96:99], v[56:59]
  v_mfma_f32_16x16x32_bf16 v[60:63], a[100:103], v[100:103], v[60:63]
  v_mfma_f32_16x16x32_bf16 v[64:67], a[180:183], v[96:99], v[64:67]
  v_mfma_f32_16x16x32_bf16 v[68:71], a[180:183], v[100:103], v[68:71]
  ds_read_b128 v[96:99], v2 offset:8192
  ds_read_b128 v[100:103], v2 offset:28672
  s_waitcnt lgkmcnt(4)
  v_mfma_f32_16x16x32_bf16 v[48:51], a[24:27], v[80:83], v[48:51]
  v_mfma_f32_16x16x32_bf16 v[52:55], a[24:27], v[84:87], v[52:55]
  v_mfma_f32_16x16x32_bf16 v[56:59], a[104:107], v[80:83], v[56:59]
  v_mfma_f32_16x16x32_bf16 v[60:63], a[104:107], v[84:87], v[60:63]
  v_mfma_f32_16x16x32_bf16 v[64:67], a[184:187], v[80:83], v[64:67]
  v_mfma_f32_16x16x32_bf16 v[68:71], a[184:187], v[84:87], v[68:71]
  ds_read_b128 v[80:83], v2 offset:9216
  ds_read_b128 v[84:87], v2 offset:29696
  s_waitcnt lgkmcnt(4)
  v_mfma_f32_16x16x32_bf16 v[48:51], a[28:31], v[88:91], v[48:51]
  v_mfma_f32_16x16x32_bf16 v[52:55], a[28:31], v[92:95], v[52:55]
  v_mfma_f32_16x16x32_bf16 v[56:59], a[108:111], v[88:91], v[56:59]
  v_mfma_f32_16x16x32_bf16 v[60:63], a[108:111], v[92:95], v[60:63]
  v_mfma_f32_16x16x32_bf16 v[64:67], a[188:191], v[88:91], v[64:67]
  v_mfma_f32_16x16x32_bf16 v[68:71], a[188:191], v[92:95], v[68:71]
  ds_read_b128 v[88:91], v2 offset:10240
  ds_read_b128 v[92:95], v2 offset:30720
  s_waitcnt lgkmcnt(4)
  v_mfma_f32_16x16x32_bf16 v[48:51], a[32:35], v[96:99], v[48:51]
  v_mfma_f32_16x16x32_bf16 v[52:55], a[32:35], v[100:103], v[52:55]
  v_mfma_f32_16x16x32_bf16 v[56:59], a[112:115], v[96:99], v[56:59]
  v_mfma_f32_16x16x32_bf16 v[60:63], a[112:115], v[100:103], v[60:63]
  v_mfma_f32_16x16x32_bf16 v[64:67], a[192:195], v[96:99], v[64:67]
  v_mfma_f32_16x16x32_bf16 v[68:71], a[192:195], v[100:103], v[68:71]
  ds_read_b128 v[96:99], v2 offset:11264
  ds_read_b128 v[100:103], v2 offset:31744
  s_waitcnt lgkmcnt(4)
  v_mfma_f32_16x16x32_bf16 v[48:51], a[36:39], v[80:83], v[48:51]
  v_mfma_f32_16x16x32_bf16 v[52:55], a[36:39], v[84:87], v[52:55]
  v_mfma_f32_16x16x32_bf16 v[56:59], a[116:119], v[80:83], v[56:59]
  v_mfma_f32_16x16x32_bf16 v[60:63], a[116:119], v[84:87], v[60:63]
  v_mfma_f32_16x16x32_bf16 v[64:67], a[196:199], v[80:83], v[64:67]
  v_mfma_f32_16x16x32_bf16 v[68:71], a[196:199], v[84:87], v[68:71]
  ds_read_b128 v[80:83], v2 offset:12288
  ds_read_b128 v[84:87], v2 offset:32768
  s_waitcnt lgkmcnt(4)
  v_mfma_f32_16x16x32_bf16 v[48:51], a[40:43], v[88:91], v[48:51]
  v_mfma_f32_16x16x32_bf16 v[52:55], a[40:43], v[92:95], v[52:55]
  v_mfma_f32_16x16x32_bf16 v[56:59], a[120:123], v[88:91], v[56:59]
  v_mfma_f32_16x16x32_bf16 v[60:63], a[120:123], v[92:95], v[60:63]
  v_mfma_f32_16x16x32_bf16 v[64:67], a[200:203], v[88:91], v[64:67]
  v_mfma_f32_16x16x32_bf16 v[68:71], a[200:203], v[92:95], v[68:71]
  ds_read_b128 v[88:91], v2 offset:13312
  ds_read_b128 v[92:95], v2 offset:33792
  s_waitcnt lgkmcnt(4)
  v_mfma_f32_16x16x32_bf16 v[48:51], a[44:47], v[96:99], v[48:51]
  v_mfma_f32_16x16x32_bf16 v[52:55], a[44:47], v[100:103], v[52:55]
  v_mfma_f32_16x16x32_bf16 v[56:59], a[124:127], v[96:99], v[56:59]
  v_mfma_f32_16x16x32_bf16 v[60:63], a[124:127], v[100:103], v[60:63]
  v_mfma_f32_16x16x32_bf16 v[64:67], a[204:207], v[96:99], v[64:67]
  v_mfma_f32_16x16x32_bf16 v[68:71], a[204:207], v[100:103], v[68:71]
  ds_read_b128 v[96:99], v2 offset:14336
  ds_read_b128 v[100:103], v2 offset:34816
  s_waitcnt lgkmcnt(4)
  v_mfma_f32_16x16x32_bf16 v[48:51], a[48:51], v[80:83], v[48:51]
  v_mfma_f32_16x16x32_bf16 v[52:55], a[48:51], v[84:87], v[52:55]
  v_mfma_f32_16x16x32_bf16 v[56:59], a[128:131], v[80:83], v[56:59]
  v_mfma_f32_16x16x32_bf16 v[60:63], a[128:131], v[84:87], v[60:63]
  v_mfma_f32_16x16x32_bf16 v[64:67], a[208:211], v[80:83], v[64:67]
  v_mfma_f32_16x16x32_bf16 v[68:71], a[208:211], v[84:87], v[68:71]
  ds_read_b128 v[80:83], v2 offset:15360
  ds_read_b128 v[84:87], v2 offset:35840
  s_waitcnt lgkmcnt(4)
  v_mfma_f32_16x16x32_bf16 v[48:51], a[52:55], v[88:91], v[48:51]
  v_mfma_f32_16x16x32_bf16 v[52:55], a[52:55], v[92:95], v[52:55]
  v_mfma_f32_16x16x32_bf16 v[56:59], a[132:135], v[88:91], v[56:59]
  v_mfma_f32_16x16x32_bf16 v[60:63], a[132:135], v[92:95], v[60:63]
  v_mfma_f32_16x16x32_bf16 v[64:67], a[212:215], v[88:91], v[64:67]
  v_mfma_f32_16x16x32_bf16 v[68:71], a[212:215], v[92:95], v[68:71]
  ds_read_b128 v[88:91], v2 offset:16384
  ds_read_b128 v[92:95], v2 offset:36864
  s_waitcnt lgkmcnt(4)
  v_mfma_f32_16x16x32_bf16 v[48:51], a[56:59], v[96:99], v[48:51]
  v_mfma_f32_16x16x32_bf16 v[52:55], a[56:59], v[100:103], v[52:55]
  v_mfma_f32_16x16x32_bf16 v[56:59], a[136:139], v[96:99], v[56:59]
  v_mfma_f32_16x16x32_bf16 v[60:63], a[136:139], v[100:103], v[60:63]
  v_mfma_f32_16x16x32_bf16 v[64:67], a[216:219], v[96:99], v[64:67]
  v_mfma_f32_16x16x32_bf16 v[68:71], a[216:219], v[100:103], v[68:71]
  ds_read_b128 v[96:99], v2 offset:17408
  ds_read_b128 v[100:103], v2 offset:37888
  s_waitcnt lgkmcnt(4)
  v_mfma_f32_16x16x32_bf16 v[48:51], a[60:63], v[80:83], v[48:51]
  v_mfma_f32_16x16x32_bf16 v[52:55], a[60:63], v[84:87], v[52:55]
  v_mfma_f32_16x16x32_bf16 v[56:59], a[140:143], v[80:83], v[56:59]
  v_mfma_f32_16x16x32_bf16 v[60:63], a[140:143], v[84:87], v[60:63]
  v_mfma_f32_16x16x32_bf16 v[64:67], a[220:223], v[80:83], v[64:67]
  v_mfma_f32_16x16x32_bf16 v[68:71], a[220:223], v[84:87], v[68:71]
  ds_read_b128 v[80:83], v2 offset:18432
  ds_read_b128 v[84:87], v2 offset:38912
  s_waitcnt lgkmcnt(4)
  v_mfma_f32_16x16x32_bf16 v[48:51], a[64:67], v[88:91], v[48:51]
  v_mfma_f32_16x16x32_bf16 v[52:55], a[64:67], v[92:95], v[52:55]
  v_mfma_f32_16x16x32_bf16 v[56:59], a[144:147], v[88:91], v[56:59]
  v_mfma_f32_16x16x32_bf16 v[60:63], a[144:147], v[92:95], v[60:63]
  v_mfma_f32_16x16x32_bf16 v[64:67], a[224:227], v[88:91], v[64:67]
  v_mfma_f32_16x16x32_bf16 v[68:71], a[224:227], v[92:95], v[68:71]
  ds_read_b128 v[88:91], v2 offset:19456
  ds_read_b128 v[92:95], v2 offset:39936
  s_waitcnt lgkmcnt(4)
  v_mfma_f32_16x16x32_bf16 v[48:51], a[68:71], v[96:99], v[48:51]
  v_mfma_f32_16x16x32_bf16 v[52:55], a[68:71], v[100:103], v[52:55]
  v_mfma_f32_16x16x32_bf16 v[56:59], a[148:151], v[96:99], v[56:59]
  v_mfma_f32_16x16x32_bf16 v[60:63], a[148:151], v[100:103], v[60:63]
  v_mfma_f32_16x16x32_bf16 v[64:67], a[228:231], v[96:99], v[64:67]
  v_mfma_f32_16x16x32_bf16 v[68:71], a[228:231], v[100:103], v[68:71]
  s_waitcnt lgkmcnt(2)
  v_mfma_f32_16x16x32_bf16 v[48:51], a[72:75], v[80:83], v[48:51]
  v_mfma_f32_16x16x32_bf16 v[52:55], a[72:75], v[84:87], v[52:55]
  v_mfma_f32_16x16x32_bf16 v[56:59], a[152:155], v[80:83], v[56:59]
  v_mfma_f32_16x16x32_bf16 v[60:63], a[152:155], v[84:87], v[60:63]
  v_mfma_f32_16x16x32_bf16 v[64:67], a[232:235], v[80:83], v[64:67]
  v_mfma_f32_16x16x32_bf16 v[68:71], a[232:235], v[84:87], v[68:71]
  s_waitcnt lgkmcnt(0)
  v_mfma_f32_16x16x32_bf16 v[48:51], a[76:79], v[88:91], v[48:51]
  v_mfma_f32_16x16x32_bf16 v[52:55], a[76:79], v[92:95], v[52:55]
  v_mfma_f32_16x16x32_bf16 v[56:59], a[156:159], v[88:91], v[56:59]
  v_mfma_f32_16x16x32_bf16 v[60:63], a[156:159], v[92:95], v[60:63]
  v_mfma_f32_16x16x32_bf16 v[64:67], a[236:239], v[88:91], v[64:67]
  v_mfma_f32_16x16x32_bf16 v[68:71], a[236:239], v[92:95], v[68:71]
  s_nop 7
  v_mul_u32_u24 v10, 1280, v5
  v_lshlrev_b32 v11, 3, v6
  v_add_u32 v10, v10, v11
  s_mul_i32 s30, s26, 40960
  s_lshl_b32 s31, s50, 5
  s_add_u32 s30, s30, s31
  v_add_f32 v48, v48, v16
  v_add_f32 v49, v49, v17
  v_add_f32 v50, v50, v18
  v_add_f32 v51, v51, v19
  v_cvt_pk_bf16_f32 v48, v48, v49
  v_cvt_pk_bf16_f32 v49, v50, v51
  s_add_u32 s28, s30, 0
  buffer_store_dwordx2 v[48:49], v10, s[16:19], s28 offen
  v_add_f32 v52, v52, v20
  v_add_f32 v53, v53, v21
  v_add_f32 v54, v54, v22
  v_add_f32 v55, v55, v23
  v_cvt_pk_bf16_f32 v52, v52, v53
  v_cvt_pk_bf16_f32 v53, v54, v55
  s_add_u32 s28, s30, 20480
  buffer_store_dwordx2 v[52:53], v10, s[16:19], s28 offen
  v_add_f32 v56, v56, v24
  v_add_f32 v57, v57, v25
  v_add_f32 v58, v58, v26
  v_add_f32 v59, v59, v27
  v_cvt_pk_bf16_f32 v56, v56, v57
  v_cvt_pk_bf16_f32 v57, v58, v59
  s_add_u32 s28, s30, 32
  buffer_store_dwordx2 v[56:57], v10, s[16:19], s28 offen
  v_add_f32 v60, v60, v28
  v_add_f32 v61, v61, v29
  v_add_f32 v62, v62, v30
  v_add_f32 v63, v63, v31
  v_cvt_pk_bf16_f32 v60, v60, v61
  v_cvt_pk_bf16_f32 v61, v62, v63
  s_add_u32 s28, s30, 20512
  buffer_store_dwordx2 v[60:61], v10, s[16:19], s28 offen
  s_cmp_lt_u32 s21, 2
  s_cbranch_scc0 g3_116
  v_add_f32 v64, v64, v32
  v_add_f32 v65, v65, v33
  v_add_f32 v66, v66, v34
  v_add_f32 v67, v67, v35
  v_cvt_pk_bf16_f32 v64, v64, v65
  v_cvt_pk_bf16_f32 v65, v66, v67
  s_add_u32 s28, s30, 64
  buffer_store_dwordx2 v[64:65], v10, s[16:19], s28 offen
  v_add_f32 v68, v68, v36
  v_add_f32 v69, v69, v37
  v_add_f32 v70, v70, v38
  v_add_f32 v71, v71, v39
  v_cvt_pk_bf16_f32 v68, v68, v69
  v_cvt_pk_bf16_f32 v69, v70, v71
  s_add_u32 s28, s30, 20544
  buffer_store_dwordx2 v[68:69], v10, s[16:19], s28 offen
g3_116:
  s_endpgm
kb2_abort:
  s_load_dwordx2 s[6:7], s[0:1], 88
  v_mov_b32 v2, 80
  v_mov_b32 v3, 1
  s_waitcnt lgkmcnt(0)
  s_mov_b64 exec, 1
  global_atomic_add v2, v3, s[6:7]
  s_waitcnt vmcnt(0)
kb2_exit:
  s_endpgm

.section .rodata,"a"
.p2align 6
.amdhsa_kernel kb2_kernel
  .amdhsa_next_free_vgpr 512
  .amdhsa_next_free_sgpr 102
  .amdhsa_accum_offset 256
  .amdhsa_group_segment_fixed_size 0
  .amdhsa_kernarg_size 104
  .amdhsa_user_sgpr_count 2
  .amdhsa_user_sgpr_kernarg_segment_ptr 1
  .amdhsa_system_sgpr_workgroup_id_x 1
.end_amdhsa_kernel
```
